```python
import torch

def _softmax(x, axis=-1):
    return torch.softmax(x, dim=axis)

def _gelu(x):
    return torch.nn.functional.gelu(x, approximate='tanh')

def _silu(x):
    return torch.nn.functional.silu(x)

def _sigmoid(x):
    return torch.sigmoid(x)

def _layernorm(x, axis=-1, eps=1e-05):
    m = x.mean(dim=axis, keepdim=True)
    v = x.var(dim=axis, keepdim=True, unbiased=False)
    return (x - m) / torch.sqrt(v + eps)

def _scatter_add(tgt, idx, src, axis=0):
    return tgt.clone().index_add_(axis, idx, src)

def _segment_sum(src, seg, n):
    out = torch.zeros((n,) + src.shape[1:], dtype=src.dtype)
    return out.index_add_(0, seg, src)

def _pad(x, pw):
    flat = tuple((v for pair in reversed(pw) for v in pair))
    return torch.nn.functional.pad(x, flat)
kernel_name = 'concat_heads__spectral_gfnet__memory_aug_recurrent_mem_tr__prompt'

def setup_inputs():

    _w = lambda a: (lambda t: t.to(torch.bfloat16) if t.is_floating_point() else t)(torch.as_tensor(a))

    def _A_setup():
        B, S, D = (1, 2048, 1024)
        Df = D // 2 + 1
        return {'x': _w((lambda *s: torch.randn(*s, dtype=torch.bfloat16) * 0.05)(B, S, D)), 'w_r': _w((lambda *s: torch.randn(*s, dtype=torch.bfloat16) * 3.2)(S, Df) * 0.02), 'w_i': _w((lambda *s: torch.randn(*s, dtype=torch.bfloat16) * 3.2)(S, Df) * 0.02)}
    _A_in = _A_setup()

    def _B_setup():
        B, S, Dm = (1, 2048, 1024)
        H, Dh = (32, 128)
        M, seg = (8, 32)
        seg = min(seg, S)
        S = S // seg * seg
        return {'x': _w((lambda *s: torch.randn(*s, dtype=torch.bfloat16) * 0.05)(B, S, Dm)), 'mem0': _w((lambda *s: torch.randn(*s, dtype=torch.bfloat16) * 0.4)(B, M, Dm)), 'Wq': _w((lambda *s: torch.randn(*s, dtype=torch.bfloat16) * 6.4)(Dm, H, Dh) * Dm ** (-0.5)), 'Wk': _w((lambda *s: torch.randn(*s, dtype=torch.bfloat16) * 6.4)(Dm, H, Dh) * Dm ** (-0.5)), 'Wv': _w((lambda *s: torch.randn(*s, dtype=torch.bfloat16) * 0.4)(Dm, H, Dh) * Dm ** (-0.5)), 'Wo': _w((lambda *s: torch.randn(*s, dtype=torch.bfloat16) * 0.4)(H, Dh, Dm) * (H * Dh) ** (-0.5)), 'seg_len': seg}
    _B_in = _B_setup()
    return {'A_x': _A_in['x'], 'A_w_r': _A_in['w_r'], 'A_w_i': _A_in['w_i'], 'B_x': _B_in['x'], 'B_mem0': _B_in['mem0'], 'B_Wq': _B_in['Wq'], 'B_Wk': _B_in['Wk'], 'B_Wv': _B_in['Wv'], 'B_Wo': _B_in['Wo'], 'B_seg_len': _B_in['seg_len']}

def reference(A_x, A_w_r, A_w_i, B_x, B_mem0, B_Wq, B_Wk, B_Wv, B_Wo, B_seg_len):

    def _A_ref(x, w_r, w_i):
        B, S, D = x.shape
        X = (lambda x, axes=(-2, -1): torch.fft.rfft2(x.float(), dim=axes))(x, axes=(-2, -1))
        W = w_r + 1j * w_i
        X = X * W
        y = (lambda x, s, axes=(-2, -1): torch.fft.irfft2(x, s=s, dim=axes).to(torch.bfloat16))(X, (S, D), axes=(-2, -1))
        return y

    def _B_ref(x, mem0, Wq, Wk, Wv, Wo, seg_len):
        B, S, Dm = x.shape
        H, Dh = (Wq.shape[1], Wq.shape[2])
        M = mem0.shape[1]
        scale = Dh ** (-0.5)
        n_seg = S // seg_len
        L = M + seg_len
        idx = torch.arange(L)
        mask = (idx[:, None] < M) | (idx[:, None] >= idx[None, :])
        mem = mem0
        outs = []
        for s in range(n_seg):
            xs = x[:, s * seg_len:(s + 1) * seg_len, :].clone()
            h = torch.concatenate([mem, xs], axis=1)
            q = torch.einsum('btd,dhe->bhte', h, Wq)
            k = torch.einsum('btd,dhe->bhte', h, Wk)
            v = torch.einsum('btd,dhe->bhte', h, Wv)
            scores = torch.einsum('bhqe,bhke->bhqk', q, k) * scale
            scores = torch.where(mask[None, None], scores, -1000000000.0)
            p = _softmax(scores, axis=-1)
            o = torch.einsum('bhqk,bhke->bhqe', p, v)
            o = torch.einsum('bhte,hed->btd', o, Wo)
            mem = o[:, :M, :].clone()
            outs.append(o[:, M:, :])
        return torch.concatenate(outs, axis=1)
    a = _A_ref(A_x, A_w_r, A_w_i)
    b = _B_ref(B_x, B_mem0, B_Wq, B_Wk, B_Wv, B_Wo, B_seg_len)
    return torch.concatenate([a, b], axis=-1)
```

```asm
; @launch kernel=concat_heads__spectral_gfnet__memory_aug_recurrent_mem_tr__prompt_kernel grid=(256,1,1) block=(256,1,1) lds=131072
.amdgcn_target "amdgcn-amd-amdhsa--gfx950"
.text
.globl concat_heads__spectral_gfnet__memory_aug_recurrent_mem_tr__prompt_kernel
.p2align 8
.type concat_heads__spectral_gfnet__memory_aug_recurrent_mem_tr__prompt_kernel,@function
concat_heads__spectral_gfnet__memory_aug_recurrent_mem_tr__prompt_kernel:
    s_cmp_ge_u32 s2, 256
    s_cbranch_scc1 W_end
    s_bitcmp1_b32 s2, 2
    s_cbranch_scc0 R_entry
    s_cmp_ge_u32 s2, 256
    s_cbranch_scc1 W_end
    s_load_dwordx2 s[4:5], s[0:1], 96
    v_lshrrev_b32 v5, 6, v0
    v_and_b32 v1, 63, v0
    v_readfirstlane_b32 s16, v5
    s_mov_b32 s6, 268435456
    s_mov_b32 s7, 0x20000
    s_waitcnt lgkmcnt(0)
    s_load_dwordx2 s[94:95], s[0:1], 88
    s_lshr_b32 s90, s2, 6
    s_bfe_u32 s91, s2, 0x30003
    s_lshl_b32 s91, s91, 2
    s_and_b32 s17, s2, 3
    s_add_u32 s91, s91, s17
    s_mov_b32 s92, 0
    s_lshl_b32 s17, s91, 2
    s_add_u32 s17, s17, s16
    s_lshl_b32 s18, s90, 7
    s_add_u32 s18, s18, s17
    s_lshl_b32 s18, s18, 7
    s_add_u32 s18, s18, 100663296
    s_lshl_b32 s20, s16, 5
    s_add_u32 s20, s20, s91
    s_lshl_b32 s20, s20, 2
    s_add_u32 s20, s20, 100728832
    s_cmp_eq_u32 s90, 3
    s_cselect_b32 s18, s20, s18
    s_cselect_b64 exec, 7, 1
    v_mov_b32 v5, s18
    s_and_b32 s18, s17, 31
    s_lshl_b32 s18, s18, 2
    s_lshr_b32 s20, s91, 3
    s_add_u32 s18, s18, s20
    s_lshl_b32 s18, s18, 2
    s_add_u32 s18, s18, 100732928
    v_writelane_b32 v5, s18, 1
    s_lshl_b32 s18, s17, 2
    s_add_u32 s18, s18, 100733440
    v_writelane_b32 v5, s18, 2
    v_mov_b32 v6, 0
    buffer_store_dword v6, v5, s[4:7], 0 offen sc1
    s_mov_b64 exec, -1
    s_waitcnt vmcnt(0) lgkmcnt(0)
    s_barrier
    s_cmp_lg_u32 s16, 0
    s_cbranch_scc1 W_reg
    v_mov_b32 v5, 32
    v_mov_b32 v6, 1
    s_mov_b64 exec, 1
    global_atomic_add v5, v6, s[94:95] sc1
    s_mov_b64 exec, -1
W_reg:
    s_cmp_eq_u32 s90, 3
    s_cbranch_scc1 W_F
    s_load_dwordx2 s[12:13], s[0:1], 40
    s_load_dwordx2 s[28:29], s[0:1], 48
    s_load_dwordx2 s[30:31], s[0:1], 56
    s_load_dwordx2 s[8:9], s[0:1], 24
    s_mov_b32 s10, 4194304
    s_mov_b32 s11, 0x20000
    s_mov_b32 s14, 8388608
    s_mov_b32 s15, 0x20000
    s_waitcnt lgkmcnt(0)
    s_cmp_eq_u32 s90, 1
    s_cselect_b64 s[12:13], s[28:29], s[12:13]
    s_cmp_eq_u32 s90, 2
    s_cselect_b64 s[12:13], s[30:31], s[12:13]
    s_lshl_b32 s28, s91, 2
    s_add_u32 s28, s28, s16
    s_lshl_b32 s20, s28, 6
    v_lshrrev_b32 v5, 2, v1
    v_and_b32 v6, 3, v1
    v_lshlrev_b32 v7, 4, v6
    v_lshl_add_u32 v7, v5, 13, v7
    v_lshlrev_b32 v8, 4, v6
    v_bfe_u32 v5, v1, 2, 2
    v_lshrrev_b32 v6, 4, v1
    v_lshl_add_u32 v5, v6, 3, v5
    v_lshl_add_u32 v8, v5, 6, v8
    s_lshl_b32 s18, s16, 15
    v_add_u32 v8, s18, v8
    s_add_u32 m0, s18, 0
    s_nop 0
    buffer_load_dwordx4 v7, s[12:15], s20 offen lds
    s_add_u32 s20, s20, 131072
    s_add_u32 m0, s18, 1024
    s_nop 0
    buffer_load_dwordx4 v7, s[12:15], s20 offen lds
    s_add_u32 s20, s20, 131072
    s_add_u32 m0, s18, 2048
    s_nop 0
    buffer_load_dwordx4 v7, s[12:15], s20 offen lds
    s_add_u32 s20, s20, 131072
    s_add_u32 m0, s18, 3072
    s_nop 0
    buffer_load_dwordx4 v7, s[12:15], s20 offen lds
    s_add_u32 s20, s20, 131072
    s_add_u32 m0, s18, 4096
    s_nop 0
    buffer_load_dwordx4 v7, s[12:15], s20 offen lds
    s_add_u32 s20, s20, 131072
    s_add_u32 m0, s18, 5120
    s_nop 0
    buffer_load_dwordx4 v7, s[12:15], s20 offen lds
    s_add_u32 s20, s20, 131072
    s_add_u32 m0, s18, 6144
    s_nop 0
    buffer_load_dwordx4 v7, s[12:15], s20 offen lds
    s_add_u32 s20, s20, 131072
    s_add_u32 m0, s18, 7168
    s_nop 0
    buffer_load_dwordx4 v7, s[12:15], s20 offen lds
    s_add_u32 s20, s20, 131072
    s_add_u32 m0, s18, 8192
    s_nop 0
    buffer_load_dwordx4 v7, s[12:15], s20 offen lds
    s_add_u32 s20, s20, 131072
    s_add_u32 m0, s18, 9216
    s_nop 0
    buffer_load_dwordx4 v7, s[12:15], s20 offen lds
    s_add_u32 s20, s20, 131072
    s_add_u32 m0, s18, 10240
    s_nop 0
    buffer_load_dwordx4 v7, s[12:15], s20 offen lds
    s_add_u32 s20, s20, 131072
    s_add_u32 m0, s18, 11264
    s_nop 0
    buffer_load_dwordx4 v7, s[12:15], s20 offen lds
    s_add_u32 s20, s20, 131072
    s_add_u32 m0, s18, 12288
    s_nop 0
    buffer_load_dwordx4 v7, s[12:15], s20 offen lds
    s_add_u32 s20, s20, 131072
    s_add_u32 m0, s18, 13312
    s_nop 0
    buffer_load_dwordx4 v7, s[12:15], s20 offen lds
    s_add_u32 s20, s20, 131072
    s_add_u32 m0, s18, 14336
    s_nop 0
    buffer_load_dwordx4 v7, s[12:15], s20 offen lds
    s_add_u32 s20, s20, 131072
    s_add_u32 m0, s18, 15360
    s_nop 0
    buffer_load_dwordx4 v7, s[12:15], s20 offen lds
    s_add_u32 s20, s20, 131072
    s_add_u32 m0, s18, 16384
    s_nop 0
    buffer_load_dwordx4 v7, s[12:15], s20 offen lds
    s_add_u32 s20, s20, 131072
    s_add_u32 m0, s18, 17408
    s_nop 0
    buffer_load_dwordx4 v7, s[12:15], s20 offen lds
    s_add_u32 s20, s20, 131072
    s_add_u32 m0, s18, 18432
    s_nop 0
    buffer_load_dwordx4 v7, s[12:15], s20 offen lds
    s_add_u32 s20, s20, 131072
    s_add_u32 m0, s18, 19456
    s_nop 0
    buffer_load_dwordx4 v7, s[12:15], s20 offen lds
    s_add_u32 s20, s20, 131072
    s_add_u32 m0, s18, 20480
    s_nop 0
    buffer_load_dwordx4 v7, s[12:15], s20 offen lds
    s_add_u32 s20, s20, 131072
    s_add_u32 m0, s18, 21504
    s_nop 0
    buffer_load_dwordx4 v7, s[12:15], s20 offen lds
    s_add_u32 s20, s20, 131072
    s_add_u32 m0, s18, 22528
    s_nop 0
    buffer_load_dwordx4 v7, s[12:15], s20 offen lds
    s_add_u32 s20, s20, 131072
    s_add_u32 m0, s18, 23552
    s_nop 0
    buffer_load_dwordx4 v7, s[12:15], s20 offen lds
    s_add_u32 s20, s20, 131072
    s_add_u32 m0, s18, 24576
    s_nop 0
    buffer_load_dwordx4 v7, s[12:15], s20 offen lds
    s_add_u32 s20, s20, 131072
    s_add_u32 m0, s18, 25600
    s_nop 0
    buffer_load_dwordx4 v7, s[12:15], s20 offen lds
    s_add_u32 s20, s20, 131072
    s_add_u32 m0, s18, 26624
    s_nop 0
    buffer_load_dwordx4 v7, s[12:15], s20 offen lds
    s_add_u32 s20, s20, 131072
    s_add_u32 m0, s18, 27648
    s_nop 0
    buffer_load_dwordx4 v7, s[12:15], s20 offen lds
    s_add_u32 s20, s20, 131072
    s_add_u32 m0, s18, 28672
    s_nop 0
    buffer_load_dwordx4 v7, s[12:15], s20 offen lds
    s_add_u32 s20, s20, 131072
    s_add_u32 m0, s18, 29696
    s_nop 0
    buffer_load_dwordx4 v7, s[12:15], s20 offen lds
    s_add_u32 s20, s20, 131072
    s_add_u32 m0, s18, 30720
    s_nop 0
    buffer_load_dwordx4 v7, s[12:15], s20 offen lds
    s_add_u32 s20, s20, 131072
    s_add_u32 m0, s18, 31744
    s_nop 0
    buffer_load_dwordx4 v7, s[12:15], s20 offen lds
    s_add_u32 s20, s20, 131072
    s_waitcnt vmcnt(24)
    ds_read_b64_tr_b16 a[0:1], v8 offset:0
    ds_read_b64_tr_b16 a[2:3], v8 offset:256
    ds_read_b64_tr_b16 a[4:5], v8 offset:8
    ds_read_b64_tr_b16 a[6:7], v8 offset:264
    ds_read_b64_tr_b16 a[8:9], v8 offset:2048
    ds_read_b64_tr_b16 a[10:11], v8 offset:2304
    ds_read_b64_tr_b16 a[12:13], v8 offset:2056
    ds_read_b64_tr_b16 a[14:15], v8 offset:2312
    s_waitcnt lgkmcnt(7)
    ds_read_b64_tr_b16 a[16:17], v8 offset:4096
    ds_read_b64_tr_b16 a[18:19], v8 offset:4352
    ds_read_b64_tr_b16 a[20:21], v8 offset:4104
    ds_read_b64_tr_b16 a[22:23], v8 offset:4360
    ds_read_b64_tr_b16 a[24:25], v8 offset:6144
    ds_read_b64_tr_b16 a[26:27], v8 offset:6400
    ds_read_b64_tr_b16 a[28:29], v8 offset:6152
    ds_read_b64_tr_b16 a[30:31], v8 offset:6408
    s_waitcnt lgkmcnt(7)
    s_waitcnt vmcnt(16)
    ds_read_b64_tr_b16 a[32:33], v8 offset:8192
    ds_read_b64_tr_b16 a[34:35], v8 offset:8448
    ds_read_b64_tr_b16 a[36:37], v8 offset:8200
    ds_read_b64_tr_b16 a[38:39], v8 offset:8456
    ds_read_b64_tr_b16 a[40:41], v8 offset:10240
    ds_read_b64_tr_b16 a[42:43], v8 offset:10496
    ds_read_b64_tr_b16 a[44:45], v8 offset:10248
    ds_read_b64_tr_b16 a[46:47], v8 offset:10504
    s_waitcnt lgkmcnt(7)
    ds_read_b64_tr_b16 a[48:49], v8 offset:12288
    ds_read_b64_tr_b16 a[50:51], v8 offset:12544
    ds_read_b64_tr_b16 a[52:53], v8 offset:12296
    ds_read_b64_tr_b16 a[54:55], v8 offset:12552
    ds_read_b64_tr_b16 a[56:57], v8 offset:14336
    ds_read_b64_tr_b16 a[58:59], v8 offset:14592
    ds_read_b64_tr_b16 a[60:61], v8 offset:14344
    ds_read_b64_tr_b16 a[62:63], v8 offset:14600
    s_waitcnt lgkmcnt(7)
    s_waitcnt vmcnt(8)
    ds_read_b64_tr_b16 a[64:65], v8 offset:16384
    ds_read_b64_tr_b16 a[66:67], v8 offset:16640
    ds_read_b64_tr_b16 a[68:69], v8 offset:16392
    ds_read_b64_tr_b16 a[70:71], v8 offset:16648
    ds_read_b64_tr_b16 a[72:73], v8 offset:18432
    ds_read_b64_tr_b16 a[74:75], v8 offset:18688
    ds_read_b64_tr_b16 a[76:77], v8 offset:18440
    ds_read_b64_tr_b16 a[78:79], v8 offset:18696
    s_waitcnt lgkmcnt(7)
    ds_read_b64_tr_b16 a[80:81], v8 offset:20480
    ds_read_b64_tr_b16 a[82:83], v8 offset:20736
    ds_read_b64_tr_b16 a[84:85], v8 offset:20488
    ds_read_b64_tr_b16 a[86:87], v8 offset:20744
    ds_read_b64_tr_b16 a[88:89], v8 offset:22528
    ds_read_b64_tr_b16 a[90:91], v8 offset:22784
    ds_read_b64_tr_b16 a[92:93], v8 offset:22536
    ds_read_b64_tr_b16 a[94:95], v8 offset:22792
    s_waitcnt lgkmcnt(7)
    s_waitcnt vmcnt(0)
    ds_read_b64_tr_b16 a[96:97], v8 offset:24576
    ds_read_b64_tr_b16 a[98:99], v8 offset:24832
    ds_read_b64_tr_b16 a[100:101], v8 offset:24584
    ds_read_b64_tr_b16 a[102:103], v8 offset:24840
    ds_read_b64_tr_b16 a[104:105], v8 offset:26624
    ds_read_b64_tr_b16 a[106:107], v8 offset:26880
    ds_read_b64_tr_b16 a[108:109], v8 offset:26632
    ds_read_b64_tr_b16 a[110:111], v8 offset:26888
    s_waitcnt lgkmcnt(7)
    ds_read_b64_tr_b16 a[112:113], v8 offset:28672
    ds_read_b64_tr_b16 a[114:115], v8 offset:28928
    ds_read_b64_tr_b16 a[116:117], v8 offset:28680
    ds_read_b64_tr_b16 a[118:119], v8 offset:28936
    ds_read_b64_tr_b16 a[120:121], v8 offset:30720
    ds_read_b64_tr_b16 a[122:123], v8 offset:30976
    ds_read_b64_tr_b16 a[124:125], v8 offset:30728
    ds_read_b64_tr_b16 a[126:127], v8 offset:30984
    s_waitcnt lgkmcnt(7)
    s_waitcnt lgkmcnt(0)
    s_add_u32 m0, s18, 0
    s_nop 0
    buffer_load_dwordx4 v7, s[12:15], s20 offen lds
    s_add_u32 s20, s20, 131072
    s_add_u32 m0, s18, 1024
    s_nop 0
    buffer_load_dwordx4 v7, s[12:15], s20 offen lds
    s_add_u32 s20, s20, 131072
    s_add_u32 m0, s18, 2048
    s_nop 0
    buffer_load_dwordx4 v7, s[12:15], s20 offen lds
    s_add_u32 s20, s20, 131072
    s_add_u32 m0, s18, 3072
    s_nop 0
    buffer_load_dwordx4 v7, s[12:15], s20 offen lds
    s_add_u32 s20, s20, 131072
    s_add_u32 m0, s18, 4096
    s_nop 0
    buffer_load_dwordx4 v7, s[12:15], s20 offen lds
    s_add_u32 s20, s20, 131072
    s_add_u32 m0, s18, 5120
    s_nop 0
    buffer_load_dwordx4 v7, s[12:15], s20 offen lds
    s_add_u32 s20, s20, 131072
    s_add_u32 m0, s18, 6144
    s_nop 0
    buffer_load_dwordx4 v7, s[12:15], s20 offen lds
    s_add_u32 s20, s20, 131072
    s_add_u32 m0, s18, 7168
    s_nop 0
    buffer_load_dwordx4 v7, s[12:15], s20 offen lds
    s_add_u32 s20, s20, 131072
    s_add_u32 m0, s18, 8192
    s_nop 0
    buffer_load_dwordx4 v7, s[12:15], s20 offen lds
    s_add_u32 s20, s20, 131072
    s_add_u32 m0, s18, 9216
    s_nop 0
    buffer_load_dwordx4 v7, s[12:15], s20 offen lds
    s_add_u32 s20, s20, 131072
    s_add_u32 m0, s18, 10240
    s_nop 0
    buffer_load_dwordx4 v7, s[12:15], s20 offen lds
    s_add_u32 s20, s20, 131072
    s_add_u32 m0, s18, 11264
    s_nop 0
    buffer_load_dwordx4 v7, s[12:15], s20 offen lds
    s_add_u32 s20, s20, 131072
    s_add_u32 m0, s18, 12288
    s_nop 0
    buffer_load_dwordx4 v7, s[12:15], s20 offen lds
    s_add_u32 s20, s20, 131072
    s_add_u32 m0, s18, 13312
    s_nop 0
    buffer_load_dwordx4 v7, s[12:15], s20 offen lds
    s_add_u32 s20, s20, 131072
    s_add_u32 m0, s18, 14336
    s_nop 0
    buffer_load_dwordx4 v7, s[12:15], s20 offen lds
    s_add_u32 s20, s20, 131072
    s_add_u32 m0, s18, 15360
    s_nop 0
    buffer_load_dwordx4 v7, s[12:15], s20 offen lds
    s_add_u32 s20, s20, 131072
    s_add_u32 m0, s18, 16384
    s_nop 0
    buffer_load_dwordx4 v7, s[12:15], s20 offen lds
    s_add_u32 s20, s20, 131072
    s_add_u32 m0, s18, 17408
    s_nop 0
    buffer_load_dwordx4 v7, s[12:15], s20 offen lds
    s_add_u32 s20, s20, 131072
    s_add_u32 m0, s18, 18432
    s_nop 0
    buffer_load_dwordx4 v7, s[12:15], s20 offen lds
    s_add_u32 s20, s20, 131072
    s_add_u32 m0, s18, 19456
    s_nop 0
    buffer_load_dwordx4 v7, s[12:15], s20 offen lds
    s_add_u32 s20, s20, 131072
    s_add_u32 m0, s18, 20480
    s_nop 0
    buffer_load_dwordx4 v7, s[12:15], s20 offen lds
    s_add_u32 s20, s20, 131072
    s_add_u32 m0, s18, 21504
    s_nop 0
    buffer_load_dwordx4 v7, s[12:15], s20 offen lds
    s_add_u32 s20, s20, 131072
    s_add_u32 m0, s18, 22528
    s_nop 0
    buffer_load_dwordx4 v7, s[12:15], s20 offen lds
    s_add_u32 s20, s20, 131072
    s_add_u32 m0, s18, 23552
    s_nop 0
    buffer_load_dwordx4 v7, s[12:15], s20 offen lds
    s_add_u32 s20, s20, 131072
    s_add_u32 m0, s18, 24576
    s_nop 0
    buffer_load_dwordx4 v7, s[12:15], s20 offen lds
    s_add_u32 s20, s20, 131072
    s_add_u32 m0, s18, 25600
    s_nop 0
    buffer_load_dwordx4 v7, s[12:15], s20 offen lds
    s_add_u32 s20, s20, 131072
    s_add_u32 m0, s18, 26624
    s_nop 0
    buffer_load_dwordx4 v7, s[12:15], s20 offen lds
    s_add_u32 s20, s20, 131072
    s_add_u32 m0, s18, 27648
    s_nop 0
    buffer_load_dwordx4 v7, s[12:15], s20 offen lds
    s_add_u32 s20, s20, 131072
    s_add_u32 m0, s18, 28672
    s_nop 0
    buffer_load_dwordx4 v7, s[12:15], s20 offen lds
    s_add_u32 s20, s20, 131072
    s_add_u32 m0, s18, 29696
    s_nop 0
    buffer_load_dwordx4 v7, s[12:15], s20 offen lds
    s_add_u32 s20, s20, 131072
    s_add_u32 m0, s18, 30720
    s_nop 0
    buffer_load_dwordx4 v7, s[12:15], s20 offen lds
    s_add_u32 s20, s20, 131072
    s_add_u32 m0, s18, 31744
    s_nop 0
    buffer_load_dwordx4 v7, s[12:15], s20 offen lds
    s_add_u32 s20, s20, 131072
    s_waitcnt vmcnt(24)
    ds_read_b64_tr_b16 a[128:129], v8 offset:0
    ds_read_b64_tr_b16 a[130:131], v8 offset:256
    ds_read_b64_tr_b16 a[132:133], v8 offset:8
    ds_read_b64_tr_b16 a[134:135], v8 offset:264
    ds_read_b64_tr_b16 a[136:137], v8 offset:2048
    ds_read_b64_tr_b16 a[138:139], v8 offset:2304
    ds_read_b64_tr_b16 a[140:141], v8 offset:2056
    ds_read_b64_tr_b16 a[142:143], v8 offset:2312
    s_waitcnt lgkmcnt(7)
    ds_read_b64_tr_b16 a[144:145], v8 offset:4096
    ds_read_b64_tr_b16 a[146:147], v8 offset:4352
    ds_read_b64_tr_b16 a[148:149], v8 offset:4104
    ds_read_b64_tr_b16 a[150:151], v8 offset:4360
    ds_read_b64_tr_b16 a[152:153], v8 offset:6144
    ds_read_b64_tr_b16 a[154:155], v8 offset:6400
    ds_read_b64_tr_b16 a[156:157], v8 offset:6152
    ds_read_b64_tr_b16 a[158:159], v8 offset:6408
    s_waitcnt lgkmcnt(7)
    s_waitcnt vmcnt(16)
    ds_read_b64_tr_b16 a[160:161], v8 offset:8192
    ds_read_b64_tr_b16 a[162:163], v8 offset:8448
    ds_read_b64_tr_b16 a[164:165], v8 offset:8200
    ds_read_b64_tr_b16 a[166:167], v8 offset:8456
    ds_read_b64_tr_b16 a[168:169], v8 offset:10240
    ds_read_b64_tr_b16 a[170:171], v8 offset:10496
    ds_read_b64_tr_b16 a[172:173], v8 offset:10248
    ds_read_b64_tr_b16 a[174:175], v8 offset:10504
    s_waitcnt lgkmcnt(7)
    ds_read_b64_tr_b16 a[176:177], v8 offset:12288
    ds_read_b64_tr_b16 a[178:179], v8 offset:12544
    ds_read_b64_tr_b16 a[180:181], v8 offset:12296
    ds_read_b64_tr_b16 a[182:183], v8 offset:12552
    ds_read_b64_tr_b16 a[184:185], v8 offset:14336
    ds_read_b64_tr_b16 a[186:187], v8 offset:14592
    ds_read_b64_tr_b16 a[188:189], v8 offset:14344
    ds_read_b64_tr_b16 a[190:191], v8 offset:14600
    s_waitcnt lgkmcnt(7)
    s_waitcnt vmcnt(8)
    ds_read_b64_tr_b16 a[192:193], v8 offset:16384
    ds_read_b64_tr_b16 a[194:195], v8 offset:16640
    ds_read_b64_tr_b16 a[196:197], v8 offset:16392
    ds_read_b64_tr_b16 a[198:199], v8 offset:16648
    ds_read_b64_tr_b16 a[200:201], v8 offset:18432
    ds_read_b64_tr_b16 a[202:203], v8 offset:18688
    ds_read_b64_tr_b16 a[204:205], v8 offset:18440
    ds_read_b64_tr_b16 a[206:207], v8 offset:18696
    s_waitcnt lgkmcnt(7)
    ds_read_b64_tr_b16 a[208:209], v8 offset:20480
    ds_read_b64_tr_b16 a[210:211], v8 offset:20736
    ds_read_b64_tr_b16 a[212:213], v8 offset:20488
    ds_read_b64_tr_b16 a[214:215], v8 offset:20744
    ds_read_b64_tr_b16 a[216:217], v8 offset:22528
    ds_read_b64_tr_b16 a[218:219], v8 offset:22784
    ds_read_b64_tr_b16 a[220:221], v8 offset:22536
    ds_read_b64_tr_b16 a[222:223], v8 offset:22792
    s_waitcnt lgkmcnt(7)
    s_waitcnt vmcnt(0)
    ds_read_b64_tr_b16 a[224:225], v8 offset:24576
    ds_read_b64_tr_b16 a[226:227], v8 offset:24832
    ds_read_b64_tr_b16 a[228:229], v8 offset:24584
    ds_read_b64_tr_b16 a[230:231], v8 offset:24840
    ds_read_b64_tr_b16 a[232:233], v8 offset:26624
    ds_read_b64_tr_b16 a[234:235], v8 offset:26880
    ds_read_b64_tr_b16 a[236:237], v8 offset:26632
    ds_read_b64_tr_b16 a[238:239], v8 offset:26888
    s_waitcnt lgkmcnt(7)
    ds_read_b64_tr_b16 a[240:241], v8 offset:28672
    ds_read_b64_tr_b16 a[242:243], v8 offset:28928
    ds_read_b64_tr_b16 a[244:245], v8 offset:28680
    ds_read_b64_tr_b16 a[246:247], v8 offset:28936
    ds_read_b64_tr_b16 a[248:249], v8 offset:30720
    ds_read_b64_tr_b16 a[250:251], v8 offset:30976
    ds_read_b64_tr_b16 a[252:253], v8 offset:30728
    ds_read_b64_tr_b16 a[254:255], v8 offset:30984
    s_waitcnt lgkmcnt(7)
    s_waitcnt lgkmcnt(0)
    v_and_b32 v5, 15, v1
    v_bfe_u32 v6, v1, 1, 3
    v_lshrrev_b32 v7, 4, v1
    v_xor_b32 v6, v6, v7
    v_lshlrev_b32 v6, 4, v6
    v_lshl_add_u32 v10, v5, 7, v6
    s_lshl_b32 s19, s16, 10
    v_xor_b32 v11, 64, v10
    v_add_u32 v12, 0x10000, v10
    v_add_u32 v13, 0x10000, v11
    v_lshrrev_b32 v7, 3, v1
    s_lshl_b32 s17, s16, 3
    v_add_u32 v7, s17, v7
    v_bfe_u32 v8, v7, 1, 3
    v_xor_b32 v8, v8, v1
    v_and_b32 v8, 7, v8
    v_bfe_u32 v5, v7, 2, 2
    v_and_b32 v2, 3, v7
    v_lshl_add_u32 v2, v5, 3, v2
    v_bfe_u32 v5, v7, 4, 1
    v_lshl_add_u32 v2, v5, 2, v2
    v_bfe_u32 v5, v1, 2, 2
    v_and_b32 v3, 3, v1
    v_lshl_add_u32 v3, v5, 3, v3
    v_lshlrev_b32 v2, 11, v2
    v_lshl_add_u32 v2, v8, 4, v2
    v_and_b32 v5, 48, v1
    v_lshl_add_u32 v3, v3, 6, v5
    s_mul_i32 s21, s28, 133120
    s_mul_i32 s18, s90, 17825792
    s_add_u32 s21, s21, s18
    s_lshl_b32 s18, s90, 7
    s_add_u32 s17, s28, s18
    s_lshl_b32 s17, s17, 7
    s_add_u32 s17, s17, 100663296
    v_mov_b32 v4, s17
    v_mov_b32 v5, 1073741824
    v_cmp_eq_u32 vcc, 0, v1
    s_nop 1
    v_cndmask_b32 v4, v5, v4, vcc
    s_mov_b32 s20, 0
    s_mov_b32 s24, 65536
    s_mov_b32 s25, 2048
    s_barrier
    s_cmp_eq_u32 s90, 2
    s_cbranch_scc1 P_v
    s_mov_b32 s26, s25
    s_sub_u32 s25, s21, 1073741824
    s_mov_b32 s21, 1073741824
    s_mov_b32 s23, 0
    s_mov_b32 s22, 0
    s_add_u32 m0, s19, 0
    s_nop 0
    buffer_load_dwordx4 v2, s[8:11], s20 offen offset:0 lds
    s_add_u32 m0, s19, 3968
    s_nop 0
    buffer_load_dwordx4 v2, s[8:11], s20 offen offset:128 lds
    s_add_u32 m0, s19, 7936
    s_nop 0
    buffer_load_dwordx4 v2, s[8:11], s20 offen offset:256 lds
    s_add_u32 m0, s19, 11904
    s_nop 0
    buffer_load_dwordx4 v2, s[8:11], s20 offen offset:384 lds
    s_add_u32 m0, s19, 15872
    s_nop 0
    buffer_load_dwordx4 v2, s[8:11], s20 offen offset:512 lds
    s_add_u32 m0, s19, 19840
    s_nop 0
    buffer_load_dwordx4 v2, s[8:11], s20 offen offset:640 lds
    s_add_u32 m0, s19, 23808
    s_nop 0
    buffer_load_dwordx4 v2, s[8:11], s20 offen offset:768 lds
    s_add_u32 m0, s19, 27776
    s_nop 0
    buffer_load_dwordx4 v2, s[8:11], s20 offen offset:896 lds
    s_add_u32 m0, s19, 31744
    s_nop 0
    buffer_load_dwordx4 v2, s[8:11], s20 offen offset:1024 lds
    s_add_u32 m0, s19, 35712
    s_nop 0
    buffer_load_dwordx4 v2, s[8:11], s20 offen offset:1152 lds
    s_add_u32 m0, s19, 39680
    s_nop 0
    buffer_load_dwordx4 v2, s[8:11], s20 offen offset:1280 lds
    s_add_u32 m0, s19, 43648
    s_nop 0
    buffer_load_dwordx4 v2, s[8:11], s20 offen offset:1408 lds
    s_add_u32 m0, s19, 47616
    s_nop 0
    buffer_load_dwordx4 v2, s[8:11], s20 offen offset:1536 lds
    s_add_u32 m0, s19, 51584
    s_nop 0
    buffer_load_dwordx4 v2, s[8:11], s20 offen offset:1664 lds
    s_add_u32 m0, s19, 55552
    s_nop 0
    buffer_load_dwordx4 v2, s[8:11], s20 offen offset:1792 lds
    s_add_u32 m0, s19, 59520
    s_nop 0
    buffer_load_dwordx4 v2, s[8:11], s20 offen offset:1920 lds
    s_add_u32 s20, s20, s24
    s_add_u32 m0, s19, 65536
    s_nop 0
    buffer_load_dwordx4 v2, s[8:11], s20 offen offset:0 lds
    s_add_u32 m0, s19, 69504
    s_nop 0
    buffer_load_dwordx4 v2, s[8:11], s20 offen offset:128 lds
    s_add_u32 m0, s19, 73472
    s_nop 0
    buffer_load_dwordx4 v2, s[8:11], s20 offen offset:256 lds
    v_mov_b32 v9, s23
    s_add_u32 s23, s23, 1
    buffer_store_dword v9, v4, s[4:7], 0 offen sc1
    s_mov_b32 s23, 0
    s_waitcnt vmcnt(12)
    s_barrier
    ds_read_b128 v[20:23], v10 offset:0
    ds_read_b128 v[24:27], v10 offset:2048
    ds_read_b128 v[28:31], v11 offset:0
    ds_read_b128 v[32:35], v11 offset:2048
    ds_read_b128 v[36:39], v10 offset:4096
    ds_read_b128 v[40:43], v10 offset:6144
    ds_read_b128 v[44:47], v11 offset:4096
.p2align 6
P_qk_top:
    s_waitcnt lgkmcnt(6)
    v_mfma_f32_16x16x32_bf16 v[52:55], a[0:3], v[20:23], 0
    ds_read_b128 v[48:51], v11 offset:6144
    v_mfma_f32_16x16x32_bf16 v[56:59], a[4:7], v[20:23], 0
    s_waitcnt lgkmcnt(6)
    v_mfma_f32_16x16x32_bf16 v[60:63], a[0:3], v[24:27], 0
    ds_read_b128 v[20:23], v10 offset:8192
    s_add_u32 m0, s19, 77440
    v_mfma_f32_16x16x32_bf16 v[64:67], a[4:7], v[24:27], 0
    buffer_load_dwordx4 v2, s[8:11], s20 offen offset:384 lds
    s_waitcnt lgkmcnt(6)
    v_mfma_f32_16x16x32_bf16 v[52:55], a[8:11], v[28:31], v[52:55]
    ds_read_b128 v[24:27], v10 offset:10240
    v_mfma_f32_16x16x32_bf16 v[56:59], a[12:15], v[28:31], v[56:59]
    s_waitcnt lgkmcnt(6)
    v_mfma_f32_16x16x32_bf16 v[60:63], a[8:11], v[32:35], v[60:63]
    ds_read_b128 v[28:31], v11 offset:8192
    s_add_u32 m0, s19, 81408
    v_mfma_f32_16x16x32_bf16 v[64:67], a[12:15], v[32:35], v[64:67]
    buffer_load_dwordx4 v2, s[8:11], s20 offen offset:512 lds
    s_waitcnt lgkmcnt(6)
    v_mfma_f32_16x16x32_bf16 v[52:55], a[16:19], v[36:39], v[52:55]
    ds_read_b128 v[32:35], v11 offset:10240
    v_mfma_f32_16x16x32_bf16 v[56:59], a[20:23], v[36:39], v[56:59]
    s_waitcnt lgkmcnt(6)
    v_mfma_f32_16x16x32_bf16 v[60:63], a[16:19], v[40:43], v[60:63]
    ds_read_b128 v[36:39], v10 offset:12288
    s_add_u32 m0, s19, 85376
    v_mfma_f32_16x16x32_bf16 v[64:67], a[20:23], v[40:43], v[64:67]
    buffer_load_dwordx4 v2, s[8:11], s20 offen offset:640 lds
    s_waitcnt lgkmcnt(6)
    v_mfma_f32_16x16x32_bf16 v[52:55], a[24:27], v[44:47], v[52:55]
    ds_read_b128 v[40:43], v10 offset:14336
    v_mfma_f32_16x16x32_bf16 v[56:59], a[28:31], v[44:47], v[56:59]
    s_waitcnt lgkmcnt(6)
    v_mfma_f32_16x16x32_bf16 v[60:63], a[24:27], v[48:51], v[60:63]
    ds_read_b128 v[44:47], v11 offset:12288
    s_add_u32 m0, s19, 89344
    v_mfma_f32_16x16x32_bf16 v[64:67], a[28:31], v[48:51], v[64:67]
    buffer_load_dwordx4 v2, s[8:11], s20 offen offset:768 lds
    s_waitcnt lgkmcnt(6)
    v_mfma_f32_16x16x32_bf16 v[52:55], a[32:35], v[20:23], v[52:55]
    ds_read_b128 v[48:51], v11 offset:14336
    v_mfma_f32_16x16x32_bf16 v[56:59], a[36:39], v[20:23], v[56:59]
    s_waitcnt lgkmcnt(6)
    v_mfma_f32_16x16x32_bf16 v[60:63], a[32:35], v[24:27], v[60:63]
    ds_read_b128 v[20:23], v10 offset:16384
    s_add_u32 m0, s19, 93312
    v_mfma_f32_16x16x32_bf16 v[64:67], a[36:39], v[24:27], v[64:67]
    buffer_load_dwordx4 v2, s[8:11], s20 offen offset:896 lds
    s_waitcnt lgkmcnt(6)
    v_mfma_f32_16x16x32_bf16 v[52:55], a[40:43], v[28:31], v[52:55]
    ds_read_b128 v[24:27], v10 offset:18432
    v_mfma_f32_16x16x32_bf16 v[56:59], a[44:47], v[28:31], v[56:59]
    v_cvt_pk_bf16_f32 v84, v68, v69
    s_waitcnt lgkmcnt(6)
    v_mfma_f32_16x16x32_bf16 v[60:63], a[40:43], v[32:35], v[60:63]
    ds_read_b128 v[28:31], v11 offset:16384
    v_mfma_f32_16x16x32_bf16 v[64:67], a[44:47], v[32:35], v[64:67]
    v_cvt_pk_bf16_f32 v85, v70, v71
    s_waitcnt lgkmcnt(6)
    v_mfma_f32_16x16x32_bf16 v[52:55], a[48:51], v[36:39], v[52:55]
    ds_read_b128 v[32:35], v11 offset:18432
    v_mfma_f32_16x16x32_bf16 v[56:59], a[52:55], v[36:39], v[56:59]
    v_cvt_pk_bf16_f32 v86, v72, v73
    s_waitcnt lgkmcnt(6)
    v_mfma_f32_16x16x32_bf16 v[60:63], a[48:51], v[40:43], v[60:63]
    ds_read_b128 v[36:39], v10 offset:20480
    v_mfma_f32_16x16x32_bf16 v[64:67], a[52:55], v[40:43], v[64:67]
    v_cvt_pk_bf16_f32 v87, v74, v75
    s_waitcnt lgkmcnt(6)
    v_mfma_f32_16x16x32_bf16 v[52:55], a[56:59], v[44:47], v[52:55]
    ds_read_b128 v[40:43], v10 offset:22528
    v_mfma_f32_16x16x32_bf16 v[56:59], a[60:63], v[44:47], v[56:59]
    v_cvt_pk_bf16_f32 v88, v76, v77
    s_waitcnt lgkmcnt(6)
    v_mfma_f32_16x16x32_bf16 v[60:63], a[56:59], v[48:51], v[60:63]
    ds_read_b128 v[44:47], v11 offset:20480
    v_mfma_f32_16x16x32_bf16 v[64:67], a[60:63], v[48:51], v[64:67]
    v_cvt_pk_bf16_f32 v89, v78, v79
    buffer_store_dwordx4 v[84:87], v3, s[4:7], s21 offen offset:0 sc1
    s_waitcnt lgkmcnt(6)
    v_mfma_f32_16x16x32_bf16 v[52:55], a[64:67], v[20:23], v[52:55]
    ds_read_b128 v[48:51], v11 offset:22528
    v_mfma_f32_16x16x32_bf16 v[56:59], a[68:71], v[20:23], v[56:59]
    v_cvt_pk_bf16_f32 v90, v80, v81
    s_waitcnt lgkmcnt(6)
    v_mfma_f32_16x16x32_bf16 v[60:63], a[64:67], v[24:27], v[60:63]
    ds_read_b128 v[20:23], v10 offset:24576
    v_mfma_f32_16x16x32_bf16 v[64:67], a[68:71], v[24:27], v[64:67]
    v_cvt_pk_bf16_f32 v91, v82, v83
    s_waitcnt lgkmcnt(6)
    v_mfma_f32_16x16x32_bf16 v[52:55], a[72:75], v[28:31], v[52:55]
    ds_read_b128 v[24:27], v10 offset:26624
    v_mfma_f32_16x16x32_bf16 v[56:59], a[76:79], v[28:31], v[56:59]
    s_waitcnt lgkmcnt(6)
    v_mfma_f32_16x16x32_bf16 v[60:63], a[72:75], v[32:35], v[60:63]
    ds_read_b128 v[28:31], v11 offset:24576
    v_mfma_f32_16x16x32_bf16 v[64:67], a[76:79], v[32:35], v[64:67]
    buffer_store_dwordx4 v[88:91], v3, s[4:7], s21 offen offset:256 sc1
    s_waitcnt lgkmcnt(6)
    v_mfma_f32_16x16x32_bf16 v[52:55], a[80:83], v[36:39], v[52:55]
    ds_read_b128 v[32:35], v11 offset:26624
    v_mfma_f32_16x16x32_bf16 v[56:59], a[84:87], v[36:39], v[56:59]
    s_add_u32 s21, s21, s25
    s_mov_b32 s25, s26
    s_waitcnt lgkmcnt(6)
    v_mfma_f32_16x16x32_bf16 v[60:63], a[80:83], v[40:43], v[60:63]
    ds_read_b128 v[36:39], v10 offset:28672
    v_mfma_f32_16x16x32_bf16 v[64:67], a[84:87], v[40:43], v[64:67]
    s_waitcnt lgkmcnt(6)
    v_mfma_f32_16x16x32_bf16 v[52:55], a[88:91], v[44:47], v[52:55]
    ds_read_b128 v[40:43], v10 offset:30720
    v_mfma_f32_16x16x32_bf16 v[56:59], a[92:95], v[44:47], v[56:59]
    s_waitcnt lgkmcnt(6)
    v_mfma_f32_16x16x32_bf16 v[60:63], a[88:91], v[48:51], v[60:63]
    ds_read_b128 v[44:47], v11 offset:28672
    v_mfma_f32_16x16x32_bf16 v[64:67], a[92:95], v[48:51], v[64:67]
    s_waitcnt lgkmcnt(6)
    v_mfma_f32_16x16x32_bf16 v[52:55], a[96:99], v[20:23], v[52:55]
    ds_read_b128 v[48:51], v11 offset:30720
    v_mfma_f32_16x16x32_bf16 v[56:59], a[100:103], v[20:23], v[56:59]
    s_waitcnt lgkmcnt(6)
    v_mfma_f32_16x16x32_bf16 v[60:63], a[96:99], v[24:27], v[60:63]
    s_waitcnt vmcnt(11)
    s_barrier
    ds_read_b128 v[20:23], v10 offset:32768
    v_mfma_f32_16x16x32_bf16 v[64:67], a[100:103], v[24:27], v[64:67]
    s_waitcnt lgkmcnt(6)
    v_mfma_f32_16x16x32_bf16 v[52:55], a[104:107], v[28:31], v[52:55]
    ds_read_b128 v[24:27], v10 offset:34816
    s_add_u32 m0, s19, 97280
    v_mfma_f32_16x16x32_bf16 v[56:59], a[108:111], v[28:31], v[56:59]
    buffer_load_dwordx4 v2, s[8:11], s20 offen offset:1024 lds
    s_waitcnt lgkmcnt(6)
    v_mfma_f32_16x16x32_bf16 v[60:63], a[104:107], v[32:35], v[60:63]
    ds_read_b128 v[28:31], v11 offset:32768
    v_mfma_f32_16x16x32_bf16 v[64:67], a[108:111], v[32:35], v[64:67]
    s_waitcnt lgkmcnt(6)
    v_mfma_f32_16x16x32_bf16 v[52:55], a[112:115], v[36:39], v[52:55]
    ds_read_b128 v[32:35], v11 offset:34816
    s_add_u32 m0, s19, 101248
    v_mfma_f32_16x16x32_bf16 v[56:59], a[116:119], v[36:39], v[56:59]
    buffer_load_dwordx4 v2, s[8:11], s20 offen offset:1152 lds
    s_waitcnt lgkmcnt(6)
    v_mfma_f32_16x16x32_bf16 v[60:63], a[112:115], v[40:43], v[60:63]
    ds_read_b128 v[36:39], v10 offset:36864
    v_mfma_f32_16x16x32_bf16 v[64:67], a[116:119], v[40:43], v[64:67]
    s_waitcnt lgkmcnt(6)
    v_mfma_f32_16x16x32_bf16 v[52:55], a[120:123], v[44:47], v[52:55]
    ds_read_b128 v[40:43], v10 offset:38912
    s_add_u32 m0, s19, 105216
    v_mfma_f32_16x16x32_bf16 v[56:59], a[124:127], v[44:47], v[56:59]
    buffer_load_dwordx4 v2, s[8:11], s20 offen offset:1280 lds
    s_waitcnt lgkmcnt(6)
    v_mfma_f32_16x16x32_bf16 v[60:63], a[120:123], v[48:51], v[60:63]
    ds_read_b128 v[44:47], v11 offset:36864
    v_mfma_f32_16x16x32_bf16 v[64:67], a[124:127], v[48:51], v[64:67]
    s_waitcnt lgkmcnt(6)
    v_mfma_f32_16x16x32_bf16 v[52:55], a[128:131], v[20:23], v[52:55]
    ds_read_b128 v[48:51], v11 offset:38912
    v_mfma_f32_16x16x32_bf16 v[56:59], a[132:135], v[20:23], v[56:59]
    s_waitcnt lgkmcnt(6)
    v_mfma_f32_16x16x32_bf16 v[60:63], a[128:131], v[24:27], v[60:63]
    ds_read_b128 v[20:23], v10 offset:40960
    s_add_u32 m0, s19, 109184
    v_mfma_f32_16x16x32_bf16 v[64:67], a[132:135], v[24:27], v[64:67]
    buffer_load_dwordx4 v2, s[8:11], s20 offen offset:1408 lds
    s_waitcnt lgkmcnt(6)
    v_mfma_f32_16x16x32_bf16 v[52:55], a[136:139], v[28:31], v[52:55]
    ds_read_b128 v[24:27], v10 offset:43008
    v_mfma_f32_16x16x32_bf16 v[56:59], a[140:143], v[28:31], v[56:59]
    s_waitcnt lgkmcnt(6)
    v_mfma_f32_16x16x32_bf16 v[60:63], a[136:139], v[32:35], v[60:63]
    ds_read_b128 v[28:31], v11 offset:40960
    s_add_u32 m0, s19, 113152
    v_mfma_f32_16x16x32_bf16 v[64:67], a[140:143], v[32:35], v[64:67]
    buffer_load_dwordx4 v2, s[8:11], s20 offen offset:1536 lds
    s_waitcnt lgkmcnt(6)
    v_mfma_f32_16x16x32_bf16 v[52:55], a[144:147], v[36:39], v[52:55]
    ds_read_b128 v[32:35], v11 offset:43008
    v_mfma_f32_16x16x32_bf16 v[56:59], a[148:151], v[36:39], v[56:59]
    s_waitcnt lgkmcnt(6)
    v_mfma_f32_16x16x32_bf16 v[60:63], a[144:147], v[40:43], v[60:63]
    ds_read_b128 v[36:39], v10 offset:45056
    s_add_u32 m0, s19, 117120
    v_mfma_f32_16x16x32_bf16 v[64:67], a[148:151], v[40:43], v[64:67]
    buffer_load_dwordx4 v2, s[8:11], s20 offen offset:1664 lds
    s_waitcnt lgkmcnt(6)
    v_mfma_f32_16x16x32_bf16 v[52:55], a[152:155], v[44:47], v[52:55]
    ds_read_b128 v[40:43], v10 offset:47104
    v_mfma_f32_16x16x32_bf16 v[56:59], a[156:159], v[44:47], v[56:59]
    s_waitcnt lgkmcnt(6)
    v_mfma_f32_16x16x32_bf16 v[60:63], a[152:155], v[48:51], v[60:63]
    ds_read_b128 v[44:47], v11 offset:45056
    s_add_u32 m0, s19, 121088
    v_mfma_f32_16x16x32_bf16 v[64:67], a[156:159], v[48:51], v[64:67]
    buffer_load_dwordx4 v2, s[8:11], s20 offen offset:1792 lds
    s_waitcnt lgkmcnt(6)
    v_mfma_f32_16x16x32_bf16 v[52:55], a[160:163], v[20:23], v[52:55]
    ds_read_b128 v[48:51], v11 offset:47104
    v_mfma_f32_16x16x32_bf16 v[56:59], a[164:167], v[20:23], v[56:59]
    s_waitcnt lgkmcnt(6)
    v_mfma_f32_16x16x32_bf16 v[60:63], a[160:163], v[24:27], v[60:63]
    ds_read_b128 v[20:23], v10 offset:49152
    s_add_u32 m0, s19, 125056
    v_mfma_f32_16x16x32_bf16 v[64:67], a[164:167], v[24:27], v[64:67]
    buffer_load_dwordx4 v2, s[8:11], s20 offen offset:1920 lds
    s_waitcnt lgkmcnt(6)
    v_mfma_f32_16x16x32_bf16 v[52:55], a[168:171], v[28:31], v[52:55]
    ds_read_b128 v[24:27], v10 offset:51200
    v_mfma_f32_16x16x32_bf16 v[56:59], a[172:175], v[28:31], v[56:59]
    s_add_u32 s20, s20, s24
    s_waitcnt lgkmcnt(6)
    v_mfma_f32_16x16x32_bf16 v[60:63], a[168:171], v[32:35], v[60:63]
    ds_read_b128 v[28:31], v11 offset:49152
    v_mfma_f32_16x16x32_bf16 v[64:67], a[172:175], v[32:35], v[64:67]
    s_waitcnt lgkmcnt(6)
    v_mfma_f32_16x16x32_bf16 v[52:55], a[176:179], v[36:39], v[52:55]
    ds_read_b128 v[32:35], v11 offset:51200
    v_mfma_f32_16x16x32_bf16 v[56:59], a[180:183], v[36:39], v[56:59]
    s_waitcnt lgkmcnt(6)
    v_mfma_f32_16x16x32_bf16 v[60:63], a[176:179], v[40:43], v[60:63]
    ds_read_b128 v[36:39], v10 offset:53248
    v_mfma_f32_16x16x32_bf16 v[64:67], a[180:183], v[40:43], v[64:67]
    s_waitcnt lgkmcnt(6)
    v_mfma_f32_16x16x32_bf16 v[52:55], a[184:187], v[44:47], v[52:55]
    ds_read_b128 v[40:43], v10 offset:55296
    v_mfma_f32_16x16x32_bf16 v[56:59], a[188:191], v[44:47], v[56:59]
    s_waitcnt lgkmcnt(6)
    v_mfma_f32_16x16x32_bf16 v[60:63], a[184:187], v[48:51], v[60:63]
    ds_read_b128 v[44:47], v11 offset:53248
    v_mfma_f32_16x16x32_bf16 v[64:67], a[188:191], v[48:51], v[64:67]
    s_waitcnt lgkmcnt(6)
    v_mfma_f32_16x16x32_bf16 v[52:55], a[192:195], v[20:23], v[52:55]
    ds_read_b128 v[48:51], v11 offset:55296
    v_mfma_f32_16x16x32_bf16 v[56:59], a[196:199], v[20:23], v[56:59]
    s_waitcnt lgkmcnt(6)
    v_mfma_f32_16x16x32_bf16 v[60:63], a[192:195], v[24:27], v[60:63]
    ds_read_b128 v[20:23], v10 offset:57344
    v_mfma_f32_16x16x32_bf16 v[64:67], a[196:199], v[24:27], v[64:67]
    s_waitcnt lgkmcnt(6)
    v_mfma_f32_16x16x32_bf16 v[52:55], a[200:203], v[28:31], v[52:55]
    ds_read_b128 v[24:27], v10 offset:59392
    v_mfma_f32_16x16x32_bf16 v[56:59], a[204:207], v[28:31], v[56:59]
    s_waitcnt lgkmcnt(6)
    v_mfma_f32_16x16x32_bf16 v[60:63], a[200:203], v[32:35], v[60:63]
    ds_read_b128 v[28:31], v11 offset:57344
    v_mfma_f32_16x16x32_bf16 v[64:67], a[204:207], v[32:35], v[64:67]
    s_waitcnt lgkmcnt(6)
    v_mfma_f32_16x16x32_bf16 v[52:55], a[208:211], v[36:39], v[52:55]
    ds_read_b128 v[32:35], v11 offset:59392
    v_mfma_f32_16x16x32_bf16 v[56:59], a[212:215], v[36:39], v[56:59]
    s_waitcnt lgkmcnt(6)
    v_mfma_f32_16x16x32_bf16 v[60:63], a[208:211], v[40:43], v[60:63]
    ds_read_b128 v[36:39], v10 offset:61440
    v_mfma_f32_16x16x32_bf16 v[64:67], a[212:215], v[40:43], v[64:67]
    s_waitcnt lgkmcnt(6)
    v_mfma_f32_16x16x32_bf16 v[52:55], a[216:219], v[44:47], v[52:55]
    ds_read_b128 v[40:43], v10 offset:63488
    v_mfma_f32_16x16x32_bf16 v[56:59], a[220:223], v[44:47], v[56:59]
    s_waitcnt lgkmcnt(6)
    v_mfma_f32_16x16x32_bf16 v[60:63], a[216:219], v[48:51], v[60:63]
    ds_read_b128 v[44:47], v11 offset:61440
    v_mfma_f32_16x16x32_bf16 v[64:67], a[220:223], v[48:51], v[64:67]
    s_waitcnt lgkmcnt(6)
    v_mfma_f32_16x16x32_bf16 v[52:55], a[224:227], v[20:23], v[52:55]
    ds_read_b128 v[48:51], v11 offset:63488
    v_mfma_f32_16x16x32_bf16 v[56:59], a[228:231], v[20:23], v[56:59]
    s_waitcnt lgkmcnt(6)
    v_mfma_f32_16x16x32_bf16 v[60:63], a[224:227], v[24:27], v[60:63]
    s_waitcnt vmcnt(8)
    s_barrier
    ds_read_b128 v[20:23], v12 offset:0
    v_mfma_f32_16x16x32_bf16 v[64:67], a[228:231], v[24:27], v[64:67]
    s_waitcnt lgkmcnt(6)
    v_mfma_f32_16x16x32_bf16 v[52:55], a[232:235], v[28:31], v[52:55]
    ds_read_b128 v[24:27], v12 offset:2048
    s_add_u32 m0, s19, 0
    v_mfma_f32_16x16x32_bf16 v[56:59], a[236:239], v[28:31], v[56:59]
    buffer_load_dwordx4 v2, s[8:11], s20 offen offset:0 lds
    s_waitcnt lgkmcnt(6)
    v_mfma_f32_16x16x32_bf16 v[60:63], a[232:235], v[32:35], v[60:63]
    ds_read_b128 v[28:31], v13 offset:0
    v_mfma_f32_16x16x32_bf16 v[64:67], a[236:239], v[32:35], v[64:67]
    v_mov_b32 v9, s23
    s_add_u32 s23, s23, 1
    buffer_store_dword v9, v4, s[4:7], 0 offen sc1
    s_waitcnt lgkmcnt(6)
    v_mfma_f32_16x16x32_bf16 v[52:55], a[240:243], v[36:39], v[52:55]
    ds_read_b128 v[32:35], v13 offset:2048
    s_add_u32 m0, s19, 3968
    v_mfma_f32_16x16x32_bf16 v[56:59], a[244:247], v[36:39], v[56:59]
    buffer_load_dwordx4 v2, s[8:11], s20 offen offset:128 lds
    s_waitcnt lgkmcnt(6)
    v_mfma_f32_16x16x32_bf16 v[60:63], a[240:243], v[40:43], v[60:63]
    ds_read_b128 v[36:39], v12 offset:4096
    v_mfma_f32_16x16x32_bf16 v[64:67], a[244:247], v[40:43], v[64:67]
    s_waitcnt lgkmcnt(6)
    v_mfma_f32_16x16x32_bf16 v[52:55], a[248:251], v[44:47], v[52:55]
    ds_read_b128 v[40:43], v12 offset:6144
    s_add_u32 m0, s19, 7936
    v_mfma_f32_16x16x32_bf16 v[56:59], a[252:255], v[44:47], v[56:59]
    buffer_load_dwordx4 v2, s[8:11], s20 offen offset:256 lds
    s_waitcnt lgkmcnt(6)
    v_mfma_f32_16x16x32_bf16 v[60:63], a[248:251], v[48:51], v[60:63]
    ds_read_b128 v[44:47], v13 offset:4096
    v_mfma_f32_16x16x32_bf16 v[64:67], a[252:255], v[48:51], v[64:67]
    s_waitcnt lgkmcnt(6)
    v_mfma_f32_16x16x32_bf16 v[68:71], a[0:3], v[20:23], 0
    ds_read_b128 v[48:51], v13 offset:6144
    v_mfma_f32_16x16x32_bf16 v[72:75], a[4:7], v[20:23], 0
    s_waitcnt lgkmcnt(6)
    v_mfma_f32_16x16x32_bf16 v[76:79], a[0:3], v[24:27], 0
    ds_read_b128 v[20:23], v12 offset:8192
    s_add_u32 m0, s19, 11904
    v_mfma_f32_16x16x32_bf16 v[80:83], a[4:7], v[24:27], 0
    buffer_load_dwordx4 v2, s[8:11], s20 offen offset:384 lds
    s_waitcnt lgkmcnt(6)
    v_mfma_f32_16x16x32_bf16 v[68:71], a[8:11], v[28:31], v[68:71]
    ds_read_b128 v[24:27], v12 offset:10240
    v_mfma_f32_16x16x32_bf16 v[72:75], a[12:15], v[28:31], v[72:75]
    s_waitcnt lgkmcnt(6)
    v_mfma_f32_16x16x32_bf16 v[76:79], a[8:11], v[32:35], v[76:79]
    ds_read_b128 v[28:31], v13 offset:8192
    s_add_u32 m0, s19, 15872
    v_mfma_f32_16x16x32_bf16 v[80:83], a[12:15], v[32:35], v[80:83]
    buffer_load_dwordx4 v2, s[8:11], s20 offen offset:512 lds
    s_waitcnt lgkmcnt(6)
    v_mfma_f32_16x16x32_bf16 v[68:71], a[16:19], v[36:39], v[68:71]
    ds_read_b128 v[32:35], v13 offset:10240
    v_mfma_f32_16x16x32_bf16 v[72:75], a[20:23], v[36:39], v[72:75]
    s_waitcnt lgkmcnt(6)
    v_mfma_f32_16x16x32_bf16 v[76:79], a[16:19], v[40:43], v[76:79]
    ds_read_b128 v[36:39], v12 offset:12288
    s_add_u32 m0, s19, 19840
    v_mfma_f32_16x16x32_bf16 v[80:83], a[20:23], v[40:43], v[80:83]
    buffer_load_dwordx4 v2, s[8:11], s20 offen offset:640 lds
    s_waitcnt lgkmcnt(6)
    v_mfma_f32_16x16x32_bf16 v[68:71], a[24:27], v[44:47], v[68:71]
    ds_read_b128 v[40:43], v12 offset:14336
    v_mfma_f32_16x16x32_bf16 v[72:75], a[28:31], v[44:47], v[72:75]
    s_waitcnt lgkmcnt(6)
    v_mfma_f32_16x16x32_bf16 v[76:79], a[24:27], v[48:51], v[76:79]
    ds_read_b128 v[44:47], v13 offset:12288
    s_add_u32 m0, s19, 23808
    v_mfma_f32_16x16x32_bf16 v[80:83], a[28:31], v[48:51], v[80:83]
    buffer_load_dwordx4 v2, s[8:11], s20 offen offset:768 lds
    s_waitcnt lgkmcnt(6)
    v_mfma_f32_16x16x32_bf16 v[68:71], a[32:35], v[20:23], v[68:71]
    ds_read_b128 v[48:51], v13 offset:14336
    v_mfma_f32_16x16x32_bf16 v[72:75], a[36:39], v[20:23], v[72:75]
    s_waitcnt lgkmcnt(6)
    v_mfma_f32_16x16x32_bf16 v[76:79], a[32:35], v[24:27], v[76:79]
    ds_read_b128 v[20:23], v12 offset:16384
    s_add_u32 m0, s19, 27776
    v_mfma_f32_16x16x32_bf16 v[80:83], a[36:39], v[24:27], v[80:83]
    buffer_load_dwordx4 v2, s[8:11], s20 offen offset:896 lds
    s_waitcnt lgkmcnt(6)
    v_mfma_f32_16x16x32_bf16 v[68:71], a[40:43], v[28:31], v[68:71]
    ds_read_b128 v[24:27], v12 offset:18432
    v_mfma_f32_16x16x32_bf16 v[72:75], a[44:47], v[28:31], v[72:75]
    v_cvt_pk_bf16_f32 v84, v52, v53
    s_waitcnt lgkmcnt(6)
    v_mfma_f32_16x16x32_bf16 v[76:79], a[40:43], v[32:35], v[76:79]
    ds_read_b128 v[28:31], v13 offset:16384
    v_mfma_f32_16x16x32_bf16 v[80:83], a[44:47], v[32:35], v[80:83]
    v_cvt_pk_bf16_f32 v85, v54, v55
    s_waitcnt lgkmcnt(6)
    v_mfma_f32_16x16x32_bf16 v[68:71], a[48:51], v[36:39], v[68:71]
    ds_read_b128 v[32:35], v13 offset:18432
    v_mfma_f32_16x16x32_bf16 v[72:75], a[52:55], v[36:39], v[72:75]
    v_cvt_pk_bf16_f32 v86, v56, v57
    s_waitcnt lgkmcnt(6)
    v_mfma_f32_16x16x32_bf16 v[76:79], a[48:51], v[40:43], v[76:79]
    ds_read_b128 v[36:39], v12 offset:20480
    v_mfma_f32_16x16x32_bf16 v[80:83], a[52:55], v[40:43], v[80:83]
    v_cvt_pk_bf16_f32 v87, v58, v59
    s_waitcnt lgkmcnt(6)
    v_mfma_f32_16x16x32_bf16 v[68:71], a[56:59], v[44:47], v[68:71]
    ds_read_b128 v[40:43], v12 offset:22528
    v_mfma_f32_16x16x32_bf16 v[72:75], a[60:63], v[44:47], v[72:75]
    v_cvt_pk_bf16_f32 v88, v60, v61
    s_waitcnt lgkmcnt(6)
    v_mfma_f32_16x16x32_bf16 v[76:79], a[56:59], v[48:51], v[76:79]
    ds_read_b128 v[44:47], v13 offset:20480
    v_mfma_f32_16x16x32_bf16 v[80:83], a[60:63], v[48:51], v[80:83]
    v_cvt_pk_bf16_f32 v89, v62, v63
    buffer_store_dwordx4 v[84:87], v3, s[4:7], s21 offen offset:0 sc1
    s_waitcnt lgkmcnt(6)
    v_mfma_f32_16x16x32_bf16 v[68:71], a[64:67], v[20:23], v[68:71]
    ds_read_b128 v[48:51], v13 offset:22528
    v_mfma_f32_16x16x32_bf16 v[72:75], a[68:71], v[20:23], v[72:75]
    v_cvt_pk_bf16_f32 v90, v64, v65
    s_waitcnt lgkmcnt(6)
    v_mfma_f32_16x16x32_bf16 v[76:79], a[64:67], v[24:27], v[76:79]
    ds_read_b128 v[20:23], v12 offset:24576
    v_mfma_f32_16x16x32_bf16 v[80:83], a[68:71], v[24:27], v[80:83]
    v_cvt_pk_bf16_f32 v91, v66, v67
    s_waitcnt lgkmcnt(6)
    v_mfma_f32_16x16x32_bf16 v[68:71], a[72:75], v[28:31], v[68:71]
    ds_read_b128 v[24:27], v12 offset:26624
    v_mfma_f32_16x16x32_bf16 v[72:75], a[76:79], v[28:31], v[72:75]
    s_waitcnt lgkmcnt(6)
    v_mfma_f32_16x16x32_bf16 v[76:79], a[72:75], v[32:35], v[76:79]
    ds_read_b128 v[28:31], v13 offset:24576
    v_mfma_f32_16x16x32_bf16 v[80:83], a[76:79], v[32:35], v[80:83]
    buffer_store_dwordx4 v[88:91], v3, s[4:7], s21 offen offset:256 sc1
    s_waitcnt lgkmcnt(6)
    v_mfma_f32_16x16x32_bf16 v[68:71], a[80:83], v[36:39], v[68:71]
    ds_read_b128 v[32:35], v13 offset:26624
    v_mfma_f32_16x16x32_bf16 v[72:75], a[84:87], v[36:39], v[72:75]
    s_add_u32 s21, s21, s25
    s_mov_b32 s25, s26
    s_waitcnt lgkmcnt(6)
    v_mfma_f32_16x16x32_bf16 v[76:79], a[80:83], v[40:43], v[76:79]
    ds_read_b128 v[36:39], v12 offset:28672
    v_mfma_f32_16x16x32_bf16 v[80:83], a[84:87], v[40:43], v[80:83]
    s_waitcnt lgkmcnt(6)
    v_mfma_f32_16x16x32_bf16 v[68:71], a[88:91], v[44:47], v[68:71]
    ds_read_b128 v[40:43], v12 offset:30720
    v_mfma_f32_16x16x32_bf16 v[72:75], a[92:95], v[44:47], v[72:75]
    s_waitcnt lgkmcnt(6)
    v_mfma_f32_16x16x32_bf16 v[76:79], a[88:91], v[48:51], v[76:79]
    ds_read_b128 v[44:47], v13 offset:28672
    v_mfma_f32_16x16x32_bf16 v[80:83], a[92:95], v[48:51], v[80:83]
    s_waitcnt lgkmcnt(6)
    v_mfma_f32_16x16x32_bf16 v[68:71], a[96:99], v[20:23], v[68:71]
    ds_read_b128 v[48:51], v13 offset:30720
    v_mfma_f32_16x16x32_bf16 v[72:75], a[100:103], v[20:23], v[72:75]
    s_waitcnt lgkmcnt(6)
    v_mfma_f32_16x16x32_bf16 v[76:79], a[96:99], v[24:27], v[76:79]
    s_waitcnt vmcnt(11)
    s_barrier
    ds_read_b128 v[20:23], v12 offset:32768
    v_mfma_f32_16x16x32_bf16 v[80:83], a[100:103], v[24:27], v[80:83]
    s_waitcnt lgkmcnt(6)
    v_mfma_f32_16x16x32_bf16 v[68:71], a[104:107], v[28:31], v[68:71]
    ds_read_b128 v[24:27], v12 offset:34816
    s_add_u32 m0, s19, 31744
    v_mfma_f32_16x16x32_bf16 v[72:75], a[108:111], v[28:31], v[72:75]
    buffer_load_dwordx4 v2, s[8:11], s20 offen offset:1024 lds
    s_waitcnt lgkmcnt(6)
    v_mfma_f32_16x16x32_bf16 v[76:79], a[104:107], v[32:35], v[76:79]
    ds_read_b128 v[28:31], v13 offset:32768
    v_mfma_f32_16x16x32_bf16 v[80:83], a[108:111], v[32:35], v[80:83]
    s_waitcnt lgkmcnt(6)
    v_mfma_f32_16x16x32_bf16 v[68:71], a[112:115], v[36:39], v[68:71]
    ds_read_b128 v[32:35], v13 offset:34816
    s_add_u32 m0, s19, 35712
    v_mfma_f32_16x16x32_bf16 v[72:75], a[116:119], v[36:39], v[72:75]
    buffer_load_dwordx4 v2, s[8:11], s20 offen offset:1152 lds
    s_waitcnt lgkmcnt(6)
    v_mfma_f32_16x16x32_bf16 v[76:79], a[112:115], v[40:43], v[76:79]
    ds_read_b128 v[36:39], v12 offset:36864
    v_mfma_f32_16x16x32_bf16 v[80:83], a[116:119], v[40:43], v[80:83]
    s_waitcnt lgkmcnt(6)
    v_mfma_f32_16x16x32_bf16 v[68:71], a[120:123], v[44:47], v[68:71]
    ds_read_b128 v[40:43], v12 offset:38912
    s_add_u32 m0, s19, 39680
    v_mfma_f32_16x16x32_bf16 v[72:75], a[124:127], v[44:47], v[72:75]
    buffer_load_dwordx4 v2, s[8:11], s20 offen offset:1280 lds
    s_waitcnt lgkmcnt(6)
    v_mfma_f32_16x16x32_bf16 v[76:79], a[120:123], v[48:51], v[76:79]
    ds_read_b128 v[44:47], v13 offset:36864
    v_mfma_f32_16x16x32_bf16 v[80:83], a[124:127], v[48:51], v[80:83]
    s_waitcnt lgkmcnt(6)
    v_mfma_f32_16x16x32_bf16 v[68:71], a[128:131], v[20:23], v[68:71]
    ds_read_b128 v[48:51], v13 offset:38912
    v_mfma_f32_16x16x32_bf16 v[72:75], a[132:135], v[20:23], v[72:75]
    s_waitcnt lgkmcnt(6)
    v_mfma_f32_16x16x32_bf16 v[76:79], a[128:131], v[24:27], v[76:79]
    ds_read_b128 v[20:23], v12 offset:40960
    s_add_u32 m0, s19, 43648
    v_mfma_f32_16x16x32_bf16 v[80:83], a[132:135], v[24:27], v[80:83]
    buffer_load_dwordx4 v2, s[8:11], s20 offen offset:1408 lds
    s_waitcnt lgkmcnt(6)
    v_mfma_f32_16x16x32_bf16 v[68:71], a[136:139], v[28:31], v[68:71]
    ds_read_b128 v[24:27], v12 offset:43008
    v_mfma_f32_16x16x32_bf16 v[72:75], a[140:143], v[28:31], v[72:75]
    s_waitcnt lgkmcnt(6)
    v_mfma_f32_16x16x32_bf16 v[76:79], a[136:139], v[32:35], v[76:79]
    ds_read_b128 v[28:31], v13 offset:40960
    s_add_u32 m0, s19, 47616
    v_mfma_f32_16x16x32_bf16 v[80:83], a[140:143], v[32:35], v[80:83]
    buffer_load_dwordx4 v2, s[8:11], s20 offen offset:1536 lds
    s_waitcnt lgkmcnt(6)
    v_mfma_f32_16x16x32_bf16 v[68:71], a[144:147], v[36:39], v[68:71]
    ds_read_b128 v[32:35], v13 offset:43008
    v_mfma_f32_16x16x32_bf16 v[72:75], a[148:151], v[36:39], v[72:75]
    s_waitcnt lgkmcnt(6)
    v_mfma_f32_16x16x32_bf16 v[76:79], a[144:147], v[40:43], v[76:79]
    ds_read_b128 v[36:39], v12 offset:45056
    s_add_u32 m0, s19, 51584
    v_mfma_f32_16x16x32_bf16 v[80:83], a[148:151], v[40:43], v[80:83]
    buffer_load_dwordx4 v2, s[8:11], s20 offen offset:1664 lds
    s_waitcnt lgkmcnt(6)
    v_mfma_f32_16x16x32_bf16 v[68:71], a[152:155], v[44:47], v[68:71]
    ds_read_b128 v[40:43], v12 offset:47104
    v_mfma_f32_16x16x32_bf16 v[72:75], a[156:159], v[44:47], v[72:75]
    s_waitcnt lgkmcnt(6)
    v_mfma_f32_16x16x32_bf16 v[76:79], a[152:155], v[48:51], v[76:79]
    ds_read_b128 v[44:47], v13 offset:45056
    s_add_u32 m0, s19, 55552
    v_mfma_f32_16x16x32_bf16 v[80:83], a[156:159], v[48:51], v[80:83]
    buffer_load_dwordx4 v2, s[8:11], s20 offen offset:1792 lds
    s_waitcnt lgkmcnt(6)
    v_mfma_f32_16x16x32_bf16 v[68:71], a[160:163], v[20:23], v[68:71]
    ds_read_b128 v[48:51], v13 offset:47104
    v_mfma_f32_16x16x32_bf16 v[72:75], a[164:167], v[20:23], v[72:75]
    s_waitcnt lgkmcnt(6)
    v_mfma_f32_16x16x32_bf16 v[76:79], a[160:163], v[24:27], v[76:79]
    ds_read_b128 v[20:23], v12 offset:49152
    s_add_u32 m0, s19, 59520
    v_mfma_f32_16x16x32_bf16 v[80:83], a[164:167], v[24:27], v[80:83]
    buffer_load_dwordx4 v2, s[8:11], s20 offen offset:1920 lds
    s_waitcnt lgkmcnt(6)
    v_mfma_f32_16x16x32_bf16 v[68:71], a[168:171], v[28:31], v[68:71]
    ds_read_b128 v[24:27], v12 offset:51200
    v_mfma_f32_16x16x32_bf16 v[72:75], a[172:175], v[28:31], v[72:75]
    s_add_u32 s20, s20, s24
    s_waitcnt lgkmcnt(6)
    v_mfma_f32_16x16x32_bf16 v[76:79], a[168:171], v[32:35], v[76:79]
    ds_read_b128 v[28:31], v13 offset:49152
    v_mfma_f32_16x16x32_bf16 v[80:83], a[172:175], v[32:35], v[80:83]
    s_waitcnt lgkmcnt(6)
    v_mfma_f32_16x16x32_bf16 v[68:71], a[176:179], v[36:39], v[68:71]
    ds_read_b128 v[32:35], v13 offset:51200
    v_mfma_f32_16x16x32_bf16 v[72:75], a[180:183], v[36:39], v[72:75]
    s_waitcnt lgkmcnt(6)
    v_mfma_f32_16x16x32_bf16 v[76:79], a[176:179], v[40:43], v[76:79]
    ds_read_b128 v[36:39], v12 offset:53248
    v_mfma_f32_16x16x32_bf16 v[80:83], a[180:183], v[40:43], v[80:83]
    s_waitcnt lgkmcnt(6)
    v_mfma_f32_16x16x32_bf16 v[68:71], a[184:187], v[44:47], v[68:71]
    ds_read_b128 v[40:43], v12 offset:55296
    v_mfma_f32_16x16x32_bf16 v[72:75], a[188:191], v[44:47], v[72:75]
    s_waitcnt lgkmcnt(6)
    v_mfma_f32_16x16x32_bf16 v[76:79], a[184:187], v[48:51], v[76:79]
    ds_read_b128 v[44:47], v13 offset:53248
    v_mfma_f32_16x16x32_bf16 v[80:83], a[188:191], v[48:51], v[80:83]
    s_waitcnt lgkmcnt(6)
    v_mfma_f32_16x16x32_bf16 v[68:71], a[192:195], v[20:23], v[68:71]
    ds_read_b128 v[48:51], v13 offset:55296
    v_mfma_f32_16x16x32_bf16 v[72:75], a[196:199], v[20:23], v[72:75]
    s_waitcnt lgkmcnt(6)
    v_mfma_f32_16x16x32_bf16 v[76:79], a[192:195], v[24:27], v[76:79]
    ds_read_b128 v[20:23], v12 offset:57344
    v_mfma_f32_16x16x32_bf16 v[80:83], a[196:199], v[24:27], v[80:83]
    s_waitcnt lgkmcnt(6)
    v_mfma_f32_16x16x32_bf16 v[68:71], a[200:203], v[28:31], v[68:71]
    ds_read_b128 v[24:27], v12 offset:59392
    v_mfma_f32_16x16x32_bf16 v[72:75], a[204:207], v[28:31], v[72:75]
    s_waitcnt lgkmcnt(6)
    v_mfma_f32_16x16x32_bf16 v[76:79], a[200:203], v[32:35], v[76:79]
    ds_read_b128 v[28:31], v13 offset:57344
    v_mfma_f32_16x16x32_bf16 v[80:83], a[204:207], v[32:35], v[80:83]
    s_waitcnt lgkmcnt(6)
    v_mfma_f32_16x16x32_bf16 v[68:71], a[208:211], v[36:39], v[68:71]
    ds_read_b128 v[32:35], v13 offset:59392
    v_mfma_f32_16x16x32_bf16 v[72:75], a[212:215], v[36:39], v[72:75]
    s_waitcnt lgkmcnt(6)
    v_mfma_f32_16x16x32_bf16 v[76:79], a[208:211], v[40:43], v[76:79]
    ds_read_b128 v[36:39], v12 offset:61440
    v_mfma_f32_16x16x32_bf16 v[80:83], a[212:215], v[40:43], v[80:83]
    s_waitcnt lgkmcnt(6)
    v_mfma_f32_16x16x32_bf16 v[68:71], a[216:219], v[44:47], v[68:71]
    ds_read_b128 v[40:43], v12 offset:63488
    v_mfma_f32_16x16x32_bf16 v[72:75], a[220:223], v[44:47], v[72:75]
    s_waitcnt lgkmcnt(6)
    v_mfma_f32_16x16x32_bf16 v[76:79], a[216:219], v[48:51], v[76:79]
    ds_read_b128 v[44:47], v13 offset:61440
    v_mfma_f32_16x16x32_bf16 v[80:83], a[220:223], v[48:51], v[80:83]
    s_waitcnt lgkmcnt(6)
    v_mfma_f32_16x16x32_bf16 v[68:71], a[224:227], v[20:23], v[68:71]
    ds_read_b128 v[48:51], v13 offset:63488
    v_mfma_f32_16x16x32_bf16 v[72:75], a[228:231], v[20:23], v[72:75]
    s_waitcnt lgkmcnt(6)
    v_mfma_f32_16x16x32_bf16 v[76:79], a[224:227], v[24:27], v[76:79]
    s_waitcnt vmcnt(8)
    s_barrier
    ds_read_b128 v[20:23], v10 offset:0
    v_mfma_f32_16x16x32_bf16 v[80:83], a[228:231], v[24:27], v[80:83]
    s_waitcnt lgkmcnt(6)
    v_mfma_f32_16x16x32_bf16 v[68:71], a[232:235], v[28:31], v[68:71]
    ds_read_b128 v[24:27], v10 offset:2048
    s_add_u32 m0, s19, 65536
    v_mfma_f32_16x16x32_bf16 v[72:75], a[236:239], v[28:31], v[72:75]
    buffer_load_dwordx4 v2, s[8:11], s20 offen offset:0 lds
    s_waitcnt lgkmcnt(6)
    v_mfma_f32_16x16x32_bf16 v[76:79], a[232:235], v[32:35], v[76:79]
    ds_read_b128 v[28:31], v11 offset:0
    v_mfma_f32_16x16x32_bf16 v[80:83], a[236:239], v[32:35], v[80:83]
    v_mov_b32 v9, s23
    s_add_u32 s23, s23, 1
    buffer_store_dword v9, v4, s[4:7], 0 offen sc1
    s_waitcnt lgkmcnt(6)
    v_mfma_f32_16x16x32_bf16 v[68:71], a[240:243], v[36:39], v[68:71]
    ds_read_b128 v[32:35], v11 offset:2048
    s_add_u32 m0, s19, 69504
    v_mfma_f32_16x16x32_bf16 v[72:75], a[244:247], v[36:39], v[72:75]
    buffer_load_dwordx4 v2, s[8:11], s20 offen offset:128 lds
    s_waitcnt lgkmcnt(6)
    v_mfma_f32_16x16x32_bf16 v[76:79], a[240:243], v[40:43], v[76:79]
    ds_read_b128 v[36:39], v10 offset:4096
    v_mfma_f32_16x16x32_bf16 v[80:83], a[244:247], v[40:43], v[80:83]
    s_waitcnt lgkmcnt(6)
    v_mfma_f32_16x16x32_bf16 v[68:71], a[248:251], v[44:47], v[68:71]
    ds_read_b128 v[40:43], v10 offset:6144
    s_add_u32 m0, s19, 73472
    v_mfma_f32_16x16x32_bf16 v[72:75], a[252:255], v[44:47], v[72:75]
    buffer_load_dwordx4 v2, s[8:11], s20 offen offset:256 lds
    s_waitcnt lgkmcnt(6)
    v_mfma_f32_16x16x32_bf16 v[76:79], a[248:251], v[48:51], v[76:79]
    ds_read_b128 v[44:47], v11 offset:4096
    v_mfma_f32_16x16x32_bf16 v[80:83], a[252:255], v[48:51], v[80:83]
    s_add_u32 s22, s22, 2
    s_cmp_lt_u32 s22, 64
    s_cbranch_scc1 P_qk_top
    v_cvt_pk_bf16_f32 v84, v68, v69
    v_cvt_pk_bf16_f32 v85, v70, v71
    v_cvt_pk_bf16_f32 v86, v72, v73
    v_cvt_pk_bf16_f32 v87, v74, v75
    v_cvt_pk_bf16_f32 v88, v76, v77
    v_cvt_pk_bf16_f32 v89, v78, v79
    v_cvt_pk_bf16_f32 v90, v80, v81
    v_cvt_pk_bf16_f32 v91, v82, v83
    buffer_store_dwordx4 v[84:87], v3, s[4:7], s21 offen offset:0 sc1
    buffer_store_dwordx4 v[88:91], v3, s[4:7], s21 offen offset:256 sc1
    s_waitcnt vmcnt(0) lgkmcnt(0)
    v_mov_b32 v9, s23
    s_add_u32 s23, s23, 1
    buffer_store_dword v9, v4, s[4:7], 0 offen sc1
    s_branch W_U
P_v:
    s_mov_b32 s26, s25
    s_sub_u32 s25, s21, 1073741824
    s_mov_b32 s21, 1073741824
    s_mov_b32 s23, 0
    s_mov_b32 s22, 0
    s_add_u32 m0, s19, 0
    s_nop 0
    buffer_load_dwordx4 v2, s[8:11], s20 offen offset:0 lds
    s_add_u32 m0, s19, 3968
    s_nop 0
    buffer_load_dwordx4 v2, s[8:11], s20 offen offset:128 lds
    s_add_u32 m0, s19, 7936
    s_nop 0
    buffer_load_dwordx4 v2, s[8:11], s20 offen offset:256 lds
    s_add_u32 m0, s19, 11904
    s_nop 0
    buffer_load_dwordx4 v2, s[8:11], s20 offen offset:384 lds
    s_add_u32 m0, s19, 15872
    s_nop 0
    buffer_load_dwordx4 v2, s[8:11], s20 offen offset:512 lds
    s_add_u32 m0, s19, 19840
    s_nop 0
    buffer_load_dwordx4 v2, s[8:11], s20 offen offset:640 lds
    s_add_u32 m0, s19, 23808
    s_nop 0
    buffer_load_dwordx4 v2, s[8:11], s20 offen offset:768 lds
    s_add_u32 m0, s19, 27776
    s_nop 0
    buffer_load_dwordx4 v2, s[8:11], s20 offen offset:896 lds
    s_add_u32 m0, s19, 31744
    s_nop 0
    buffer_load_dwordx4 v2, s[8:11], s20 offen offset:1024 lds
    s_add_u32 m0, s19, 35712
    s_nop 0
    buffer_load_dwordx4 v2, s[8:11], s20 offen offset:1152 lds
    s_add_u32 m0, s19, 39680
    s_nop 0
    buffer_load_dwordx4 v2, s[8:11], s20 offen offset:1280 lds
    s_add_u32 m0, s19, 43648
    s_nop 0
    buffer_load_dwordx4 v2, s[8:11], s20 offen offset:1408 lds
    s_add_u32 m0, s19, 47616
    s_nop 0
    buffer_load_dwordx4 v2, s[8:11], s20 offen offset:1536 lds
    s_add_u32 m0, s19, 51584
    s_nop 0
    buffer_load_dwordx4 v2, s[8:11], s20 offen offset:1664 lds
    s_add_u32 m0, s19, 55552
    s_nop 0
    buffer_load_dwordx4 v2, s[8:11], s20 offen offset:1792 lds
    s_add_u32 m0, s19, 59520
    s_nop 0
    buffer_load_dwordx4 v2, s[8:11], s20 offen offset:1920 lds
    s_add_u32 s20, s20, s24
    s_add_u32 m0, s19, 65536
    s_nop 0
    buffer_load_dwordx4 v2, s[8:11], s20 offen offset:0 lds
    s_add_u32 m0, s19, 69504
    s_nop 0
    buffer_load_dwordx4 v2, s[8:11], s20 offen offset:128 lds
    s_add_u32 m0, s19, 73472
    s_nop 0
    buffer_load_dwordx4 v2, s[8:11], s20 offen offset:256 lds
    v_mov_b32 v9, s23
    s_add_u32 s23, s23, 1
    buffer_store_dword v9, v4, s[4:7], 0 offen sc1
    s_mov_b32 s23, 0
    s_waitcnt vmcnt(12)
    s_barrier
    ds_read_b128 v[20:23], v10 offset:0
    ds_read_b128 v[24:27], v10 offset:2048
    ds_read_b128 v[28:31], v11 offset:0
    ds_read_b128 v[32:35], v11 offset:2048
    ds_read_b128 v[36:39], v10 offset:4096
    ds_read_b128 v[40:43], v10 offset:6144
    ds_read_b128 v[44:47], v11 offset:4096
.p2align 6
P_v_top:
    s_waitcnt lgkmcnt(6)
    v_mfma_f32_16x16x32_bf16 v[52:55], v[20:23], a[0:3], 0
    ds_read_b128 v[48:51], v11 offset:6144
    v_mfma_f32_16x16x32_bf16 v[60:63], v[20:23], a[4:7], 0
    s_waitcnt lgkmcnt(6)
    v_mfma_f32_16x16x32_bf16 v[56:59], v[24:27], a[0:3], 0
    ds_read_b128 v[20:23], v10 offset:8192
    s_add_u32 m0, s19, 77440
    v_mfma_f32_16x16x32_bf16 v[64:67], v[24:27], a[4:7], 0
    buffer_load_dwordx4 v2, s[8:11], s20 offen offset:384 lds
    s_waitcnt lgkmcnt(6)
    v_mfma_f32_16x16x32_bf16 v[52:55], v[28:31], a[8:11], v[52:55]
    ds_read_b128 v[24:27], v10 offset:10240
    v_mfma_f32_16x16x32_bf16 v[60:63], v[28:31], a[12:15], v[60:63]
    s_waitcnt lgkmcnt(6)
    v_mfma_f32_16x16x32_bf16 v[56:59], v[32:35], a[8:11], v[56:59]
    ds_read_b128 v[28:31], v11 offset:8192
    s_add_u32 m0, s19, 81408
    v_mfma_f32_16x16x32_bf16 v[64:67], v[32:35], a[12:15], v[64:67]
    buffer_load_dwordx4 v2, s[8:11], s20 offen offset:512 lds
    s_waitcnt lgkmcnt(6)
    v_mfma_f32_16x16x32_bf16 v[52:55], v[36:39], a[16:19], v[52:55]
    ds_read_b128 v[32:35], v11 offset:10240
    v_mfma_f32_16x16x32_bf16 v[60:63], v[36:39], a[20:23], v[60:63]
    s_waitcnt lgkmcnt(6)
    v_mfma_f32_16x16x32_bf16 v[56:59], v[40:43], a[16:19], v[56:59]
    ds_read_b128 v[36:39], v10 offset:12288
    s_add_u32 m0, s19, 85376
    v_mfma_f32_16x16x32_bf16 v[64:67], v[40:43], a[20:23], v[64:67]
    buffer_load_dwordx4 v2, s[8:11], s20 offen offset:640 lds
    s_waitcnt lgkmcnt(6)
    v_mfma_f32_16x16x32_bf16 v[52:55], v[44:47], a[24:27], v[52:55]
    ds_read_b128 v[40:43], v10 offset:14336
    v_mfma_f32_16x16x32_bf16 v[60:63], v[44:47], a[28:31], v[60:63]
    s_waitcnt lgkmcnt(6)
    v_mfma_f32_16x16x32_bf16 v[56:59], v[48:51], a[24:27], v[56:59]
    ds_read_b128 v[44:47], v11 offset:12288
    s_add_u32 m0, s19, 89344
    v_mfma_f32_16x16x32_bf16 v[64:67], v[48:51], a[28:31], v[64:67]
    buffer_load_dwordx4 v2, s[8:11], s20 offen offset:768 lds
    s_waitcnt lgkmcnt(6)
    v_mfma_f32_16x16x32_bf16 v[52:55], v[20:23], a[32:35], v[52:55]
    ds_read_b128 v[48:51], v11 offset:14336
    v_mfma_f32_16x16x32_bf16 v[60:63], v[20:23], a[36:39], v[60:63]
    s_waitcnt lgkmcnt(6)
    v_mfma_f32_16x16x32_bf16 v[56:59], v[24:27], a[32:35], v[56:59]
    ds_read_b128 v[20:23], v10 offset:16384
    s_add_u32 m0, s19, 93312
    v_mfma_f32_16x16x32_bf16 v[64:67], v[24:27], a[36:39], v[64:67]
    buffer_load_dwordx4 v2, s[8:11], s20 offen offset:896 lds
    s_waitcnt lgkmcnt(6)
    v_mfma_f32_16x16x32_bf16 v[52:55], v[28:31], a[40:43], v[52:55]
    ds_read_b128 v[24:27], v10 offset:18432
    v_mfma_f32_16x16x32_bf16 v[60:63], v[28:31], a[44:47], v[60:63]
    v_cvt_pk_bf16_f32 v84, v68, v69
    s_waitcnt lgkmcnt(6)
    v_mfma_f32_16x16x32_bf16 v[56:59], v[32:35], a[40:43], v[56:59]
    ds_read_b128 v[28:31], v11 offset:16384
    v_mfma_f32_16x16x32_bf16 v[64:67], v[32:35], a[44:47], v[64:67]
    v_cvt_pk_bf16_f32 v85, v70, v71
    s_waitcnt lgkmcnt(6)
    v_mfma_f32_16x16x32_bf16 v[52:55], v[36:39], a[48:51], v[52:55]
    ds_read_b128 v[32:35], v11 offset:18432
    v_mfma_f32_16x16x32_bf16 v[60:63], v[36:39], a[52:55], v[60:63]
    v_cvt_pk_bf16_f32 v86, v72, v73
    s_waitcnt lgkmcnt(6)
    v_mfma_f32_16x16x32_bf16 v[56:59], v[40:43], a[48:51], v[56:59]
    ds_read_b128 v[36:39], v10 offset:20480
    v_mfma_f32_16x16x32_bf16 v[64:67], v[40:43], a[52:55], v[64:67]
    v_cvt_pk_bf16_f32 v87, v74, v75
    s_waitcnt lgkmcnt(6)
    v_mfma_f32_16x16x32_bf16 v[52:55], v[44:47], a[56:59], v[52:55]
    ds_read_b128 v[40:43], v10 offset:22528
    v_mfma_f32_16x16x32_bf16 v[60:63], v[44:47], a[60:63], v[60:63]
    v_cvt_pk_bf16_f32 v88, v76, v77
    s_waitcnt lgkmcnt(6)
    v_mfma_f32_16x16x32_bf16 v[56:59], v[48:51], a[56:59], v[56:59]
    ds_read_b128 v[44:47], v11 offset:20480
    v_mfma_f32_16x16x32_bf16 v[64:67], v[48:51], a[60:63], v[64:67]
    v_cvt_pk_bf16_f32 v89, v78, v79
    buffer_store_dwordx4 v[84:87], v3, s[4:7], s21 offen offset:0 sc1
    s_waitcnt lgkmcnt(6)
    v_mfma_f32_16x16x32_bf16 v[52:55], v[20:23], a[64:67], v[52:55]
    ds_read_b128 v[48:51], v11 offset:22528
    v_mfma_f32_16x16x32_bf16 v[60:63], v[20:23], a[68:71], v[60:63]
    v_cvt_pk_bf16_f32 v90, v80, v81
    s_waitcnt lgkmcnt(6)
    v_mfma_f32_16x16x32_bf16 v[56:59], v[24:27], a[64:67], v[56:59]
    ds_read_b128 v[20:23], v10 offset:24576
    v_mfma_f32_16x16x32_bf16 v[64:67], v[24:27], a[68:71], v[64:67]
    v_cvt_pk_bf16_f32 v91, v82, v83
    s_waitcnt lgkmcnt(6)
    v_mfma_f32_16x16x32_bf16 v[52:55], v[28:31], a[72:75], v[52:55]
    ds_read_b128 v[24:27], v10 offset:26624
    v_mfma_f32_16x16x32_bf16 v[60:63], v[28:31], a[76:79], v[60:63]
    s_waitcnt lgkmcnt(6)
    v_mfma_f32_16x16x32_bf16 v[56:59], v[32:35], a[72:75], v[56:59]
    ds_read_b128 v[28:31], v11 offset:24576
    v_mfma_f32_16x16x32_bf16 v[64:67], v[32:35], a[76:79], v[64:67]
    buffer_store_dwordx4 v[88:91], v3, s[4:7], s21 offen offset:256 sc1
    s_waitcnt lgkmcnt(6)
    v_mfma_f32_16x16x32_bf16 v[52:55], v[36:39], a[80:83], v[52:55]
    ds_read_b128 v[32:35], v11 offset:26624
    v_mfma_f32_16x16x32_bf16 v[60:63], v[36:39], a[84:87], v[60:63]
    s_add_u32 s21, s21, s25
    s_mov_b32 s25, s26
    s_waitcnt lgkmcnt(6)
    v_mfma_f32_16x16x32_bf16 v[56:59], v[40:43], a[80:83], v[56:59]
    ds_read_b128 v[36:39], v10 offset:28672
    v_mfma_f32_16x16x32_bf16 v[64:67], v[40:43], a[84:87], v[64:67]
    s_waitcnt lgkmcnt(6)
    v_mfma_f32_16x16x32_bf16 v[52:55], v[44:47], a[88:91], v[52:55]
    ds_read_b128 v[40:43], v10 offset:30720
    v_mfma_f32_16x16x32_bf16 v[60:63], v[44:47], a[92:95], v[60:63]
    s_waitcnt lgkmcnt(6)
    v_mfma_f32_16x16x32_bf16 v[56:59], v[48:51], a[88:91], v[56:59]
    ds_read_b128 v[44:47], v11 offset:28672
    v_mfma_f32_16x16x32_bf16 v[64:67], v[48:51], a[92:95], v[64:67]
    s_waitcnt lgkmcnt(6)
    v_mfma_f32_16x16x32_bf16 v[52:55], v[20:23], a[96:99], v[52:55]
    ds_read_b128 v[48:51], v11 offset:30720
    v_mfma_f32_16x16x32_bf16 v[60:63], v[20:23], a[100:103], v[60:63]
    s_waitcnt lgkmcnt(6)
    v_mfma_f32_16x16x32_bf16 v[56:59], v[24:27], a[96:99], v[56:59]
    s_waitcnt vmcnt(11)
    s_barrier
    ds_read_b128 v[20:23], v10 offset:32768
    v_mfma_f32_16x16x32_bf16 v[64:67], v[24:27], a[100:103], v[64:67]
    s_waitcnt lgkmcnt(6)
    v_mfma_f32_16x16x32_bf16 v[52:55], v[28:31], a[104:107], v[52:55]
    ds_read_b128 v[24:27], v10 offset:34816
    s_add_u32 m0, s19, 97280
    v_mfma_f32_16x16x32_bf16 v[60:63], v[28:31], a[108:111], v[60:63]
    buffer_load_dwordx4 v2, s[8:11], s20 offen offset:1024 lds
    s_waitcnt lgkmcnt(6)
    v_mfma_f32_16x16x32_bf16 v[56:59], v[32:35], a[104:107], v[56:59]
    ds_read_b128 v[28:31], v11 offset:32768
    v_mfma_f32_16x16x32_bf16 v[64:67], v[32:35], a[108:111], v[64:67]
    s_waitcnt lgkmcnt(6)
    v_mfma_f32_16x16x32_bf16 v[52:55], v[36:39], a[112:115], v[52:55]
    ds_read_b128 v[32:35], v11 offset:34816
    s_add_u32 m0, s19, 101248
    v_mfma_f32_16x16x32_bf16 v[60:63], v[36:39], a[116:119], v[60:63]
    buffer_load_dwordx4 v2, s[8:11], s20 offen offset:1152 lds
    s_waitcnt lgkmcnt(6)
    v_mfma_f32_16x16x32_bf16 v[56:59], v[40:43], a[112:115], v[56:59]
    ds_read_b128 v[36:39], v10 offset:36864
    v_mfma_f32_16x16x32_bf16 v[64:67], v[40:43], a[116:119], v[64:67]
    s_waitcnt lgkmcnt(6)
    v_mfma_f32_16x16x32_bf16 v[52:55], v[44:47], a[120:123], v[52:55]
    ds_read_b128 v[40:43], v10 offset:38912
    s_add_u32 m0, s19, 105216
    v_mfma_f32_16x16x32_bf16 v[60:63], v[44:47], a[124:127], v[60:63]
    buffer_load_dwordx4 v2, s[8:11], s20 offen offset:1280 lds
    s_waitcnt lgkmcnt(6)
    v_mfma_f32_16x16x32_bf16 v[56:59], v[48:51], a[120:123], v[56:59]
    ds_read_b128 v[44:47], v11 offset:36864
    v_mfma_f32_16x16x32_bf16 v[64:67], v[48:51], a[124:127], v[64:67]
    s_waitcnt lgkmcnt(6)
    v_mfma_f32_16x16x32_bf16 v[52:55], v[20:23], a[128:131], v[52:55]
    ds_read_b128 v[48:51], v11 offset:38912
    v_mfma_f32_16x16x32_bf16 v[60:63], v[20:23], a[132:135], v[60:63]
    s_waitcnt lgkmcnt(6)
    v_mfma_f32_16x16x32_bf16 v[56:59], v[24:27], a[128:131], v[56:59]
    ds_read_b128 v[20:23], v10 offset:40960
    s_add_u32 m0, s19, 109184
    v_mfma_f32_16x16x32_bf16 v[64:67], v[24:27], a[132:135], v[64:67]
    buffer_load_dwordx4 v2, s[8:11], s20 offen offset:1408 lds
    s_waitcnt lgkmcnt(6)
    v_mfma_f32_16x16x32_bf16 v[52:55], v[28:31], a[136:139], v[52:55]
    ds_read_b128 v[24:27], v10 offset:43008
    v_mfma_f32_16x16x32_bf16 v[60:63], v[28:31], a[140:143], v[60:63]
    s_waitcnt lgkmcnt(6)
    v_mfma_f32_16x16x32_bf16 v[56:59], v[32:35], a[136:139], v[56:59]
    ds_read_b128 v[28:31], v11 offset:40960
    s_add_u32 m0, s19, 113152
    v_mfma_f32_16x16x32_bf16 v[64:67], v[32:35], a[140:143], v[64:67]
    buffer_load_dwordx4 v2, s[8:11], s20 offen offset:1536 lds
    s_waitcnt lgkmcnt(6)
    v_mfma_f32_16x16x32_bf16 v[52:55], v[36:39], a[144:147], v[52:55]
    ds_read_b128 v[32:35], v11 offset:43008
    v_mfma_f32_16x16x32_bf16 v[60:63], v[36:39], a[148:151], v[60:63]
    s_waitcnt lgkmcnt(6)
    v_mfma_f32_16x16x32_bf16 v[56:59], v[40:43], a[144:147], v[56:59]
    ds_read_b128 v[36:39], v10 offset:45056
    s_add_u32 m0, s19, 117120
    v_mfma_f32_16x16x32_bf16 v[64:67], v[40:43], a[148:151], v[64:67]
    buffer_load_dwordx4 v2, s[8:11], s20 offen offset:1664 lds
    s_waitcnt lgkmcnt(6)
    v_mfma_f32_16x16x32_bf16 v[52:55], v[44:47], a[152:155], v[52:55]
    ds_read_b128 v[40:43], v10 offset:47104
    v_mfma_f32_16x16x32_bf16 v[60:63], v[44:47], a[156:159], v[60:63]
    s_waitcnt lgkmcnt(6)
    v_mfma_f32_16x16x32_bf16 v[56:59], v[48:51], a[152:155], v[56:59]
    ds_read_b128 v[44:47], v11 offset:45056
    s_add_u32 m0, s19, 121088
    v_mfma_f32_16x16x32_bf16 v[64:67], v[48:51], a[156:159], v[64:67]
    buffer_load_dwordx4 v2, s[8:11], s20 offen offset:1792 lds
    s_waitcnt lgkmcnt(6)
    v_mfma_f32_16x16x32_bf16 v[52:55], v[20:23], a[160:163], v[52:55]
    ds_read_b128 v[48:51], v11 offset:47104
    v_mfma_f32_16x16x32_bf16 v[60:63], v[20:23], a[164:167], v[60:63]
    s_waitcnt lgkmcnt(6)
    v_mfma_f32_16x16x32_bf16 v[56:59], v[24:27], a[160:163], v[56:59]
    ds_read_b128 v[20:23], v10 offset:49152
    s_add_u32 m0, s19, 125056
    v_mfma_f32_16x16x32_bf16 v[64:67], v[24:27], a[164:167], v[64:67]
    buffer_load_dwordx4 v2, s[8:11], s20 offen offset:1920 lds
    s_waitcnt lgkmcnt(6)
    v_mfma_f32_16x16x32_bf16 v[52:55], v[28:31], a[168:171], v[52:55]
    ds_read_b128 v[24:27], v10 offset:51200
    v_mfma_f32_16x16x32_bf16 v[60:63], v[28:31], a[172:175], v[60:63]
    s_add_u32 s20, s20, s24
    s_waitcnt lgkmcnt(6)
    v_mfma_f32_16x16x32_bf16 v[56:59], v[32:35], a[168:171], v[56:59]
    ds_read_b128 v[28:31], v11 offset:49152
    v_mfma_f32_16x16x32_bf16 v[64:67], v[32:35], a[172:175], v[64:67]
    s_waitcnt lgkmcnt(6)
    v_mfma_f32_16x16x32_bf16 v[52:55], v[36:39], a[176:179], v[52:55]
    ds_read_b128 v[32:35], v11 offset:51200
    v_mfma_f32_16x16x32_bf16 v[60:63], v[36:39], a[180:183], v[60:63]
    s_waitcnt lgkmcnt(6)
    v_mfma_f32_16x16x32_bf16 v[56:59], v[40:43], a[176:179], v[56:59]
    ds_read_b128 v[36:39], v10 offset:53248
    v_mfma_f32_16x16x32_bf16 v[64:67], v[40:43], a[180:183], v[64:67]
    s_waitcnt lgkmcnt(6)
    v_mfma_f32_16x16x32_bf16 v[52:55], v[44:47], a[184:187], v[52:55]
    ds_read_b128 v[40:43], v10 offset:55296
    v_mfma_f32_16x16x32_bf16 v[60:63], v[44:47], a[188:191], v[60:63]
    s_waitcnt lgkmcnt(6)
    v_mfma_f32_16x16x32_bf16 v[56:59], v[48:51], a[184:187], v[56:59]
    ds_read_b128 v[44:47], v11 offset:53248
    v_mfma_f32_16x16x32_bf16 v[64:67], v[48:51], a[188:191], v[64:67]
    s_waitcnt lgkmcnt(6)
    v_mfma_f32_16x16x32_bf16 v[52:55], v[20:23], a[192:195], v[52:55]
    ds_read_b128 v[48:51], v11 offset:55296
    v_mfma_f32_16x16x32_bf16 v[60:63], v[20:23], a[196:199], v[60:63]
    s_waitcnt lgkmcnt(6)
    v_mfma_f32_16x16x32_bf16 v[56:59], v[24:27], a[192:195], v[56:59]
    ds_read_b128 v[20:23], v10 offset:57344
    v_mfma_f32_16x16x32_bf16 v[64:67], v[24:27], a[196:199], v[64:67]
    s_waitcnt lgkmcnt(6)
    v_mfma_f32_16x16x32_bf16 v[52:55], v[28:31], a[200:203], v[52:55]
    ds_read_b128 v[24:27], v10 offset:59392
    v_mfma_f32_16x16x32_bf16 v[60:63], v[28:31], a[204:207], v[60:63]
    s_waitcnt lgkmcnt(6)
    v_mfma_f32_16x16x32_bf16 v[56:59], v[32:35], a[200:203], v[56:59]
    ds_read_b128 v[28:31], v11 offset:57344
    v_mfma_f32_16x16x32_bf16 v[64:67], v[32:35], a[204:207], v[64:67]
    s_waitcnt lgkmcnt(6)
    v_mfma_f32_16x16x32_bf16 v[52:55], v[36:39], a[208:211], v[52:55]
    ds_read_b128 v[32:35], v11 offset:59392
    v_mfma_f32_16x16x32_bf16 v[60:63], v[36:39], a[212:215], v[60:63]
    s_waitcnt lgkmcnt(6)
    v_mfma_f32_16x16x32_bf16 v[56:59], v[40:43], a[208:211], v[56:59]
    ds_read_b128 v[36:39], v10 offset:61440
    v_mfma_f32_16x16x32_bf16 v[64:67], v[40:43], a[212:215], v[64:67]
    s_waitcnt lgkmcnt(6)
    v_mfma_f32_16x16x32_bf16 v[52:55], v[44:47], a[216:219], v[52:55]
    ds_read_b128 v[40:43], v10 offset:63488
    v_mfma_f32_16x16x32_bf16 v[60:63], v[44:47], a[220:223], v[60:63]
    s_waitcnt lgkmcnt(6)
    v_mfma_f32_16x16x32_bf16 v[56:59], v[48:51], a[216:219], v[56:59]
    ds_read_b128 v[44:47], v11 offset:61440
    v_mfma_f32_16x16x32_bf16 v[64:67], v[48:51], a[220:223], v[64:67]
    s_waitcnt lgkmcnt(6)
    v_mfma_f32_16x16x32_bf16 v[52:55], v[20:23], a[224:227], v[52:55]
    ds_read_b128 v[48:51], v11 offset:63488
    v_mfma_f32_16x16x32_bf16 v[60:63], v[20:23], a[228:231], v[60:63]
    s_waitcnt lgkmcnt(6)
    v_mfma_f32_16x16x32_bf16 v[56:59], v[24:27], a[224:227], v[56:59]
    s_waitcnt vmcnt(8)
    s_barrier
    ds_read_b128 v[20:23], v12 offset:0
    v_mfma_f32_16x16x32_bf16 v[64:67], v[24:27], a[228:231], v[64:67]
    s_waitcnt lgkmcnt(6)
    v_mfma_f32_16x16x32_bf16 v[52:55], v[28:31], a[232:235], v[52:55]
    ds_read_b128 v[24:27], v12 offset:2048
    s_add_u32 m0, s19, 0
    v_mfma_f32_16x16x32_bf16 v[60:63], v[28:31], a[236:239], v[60:63]
    buffer_load_dwordx4 v2, s[8:11], s20 offen offset:0 lds
    s_waitcnt lgkmcnt(6)
    v_mfma_f32_16x16x32_bf16 v[56:59], v[32:35], a[232:235], v[56:59]
    ds_read_b128 v[28:31], v13 offset:0
    v_mfma_f32_16x16x32_bf16 v[64:67], v[32:35], a[236:239], v[64:67]
    v_mov_b32 v9, s23
    s_add_u32 s23, s23, 1
    buffer_store_dword v9, v4, s[4:7], 0 offen sc1
    s_waitcnt lgkmcnt(6)
    v_mfma_f32_16x16x32_bf16 v[52:55], v[36:39], a[240:243], v[52:55]
    ds_read_b128 v[32:35], v13 offset:2048
    s_add_u32 m0, s19, 3968
    v_mfma_f32_16x16x32_bf16 v[60:63], v[36:39], a[244:247], v[60:63]
    buffer_load_dwordx4 v2, s[8:11], s20 offen offset:128 lds
    s_waitcnt lgkmcnt(6)
    v_mfma_f32_16x16x32_bf16 v[56:59], v[40:43], a[240:243], v[56:59]
    ds_read_b128 v[36:39], v12 offset:4096
    v_mfma_f32_16x16x32_bf16 v[64:67], v[40:43], a[244:247], v[64:67]
    s_waitcnt lgkmcnt(6)
    v_mfma_f32_16x16x32_bf16 v[52:55], v[44:47], a[248:251], v[52:55]
    ds_read_b128 v[40:43], v12 offset:6144
    s_add_u32 m0, s19, 7936
    v_mfma_f32_16x16x32_bf16 v[60:63], v[44:47], a[252:255], v[60:63]
    buffer_load_dwordx4 v2, s[8:11], s20 offen offset:256 lds
    s_waitcnt lgkmcnt(6)
    v_mfma_f32_16x16x32_bf16 v[56:59], v[48:51], a[248:251], v[56:59]
    ds_read_b128 v[44:47], v13 offset:4096
    v_mfma_f32_16x16x32_bf16 v[64:67], v[48:51], a[252:255], v[64:67]
    s_waitcnt lgkmcnt(6)
    v_mfma_f32_16x16x32_bf16 v[68:71], v[20:23], a[0:3], 0
    ds_read_b128 v[48:51], v13 offset:6144
    v_mfma_f32_16x16x32_bf16 v[76:79], v[20:23], a[4:7], 0
    s_waitcnt lgkmcnt(6)
    v_mfma_f32_16x16x32_bf16 v[72:75], v[24:27], a[0:3], 0
    ds_read_b128 v[20:23], v12 offset:8192
    s_add_u32 m0, s19, 11904
    v_mfma_f32_16x16x32_bf16 v[80:83], v[24:27], a[4:7], 0
    buffer_load_dwordx4 v2, s[8:11], s20 offen offset:384 lds
    s_waitcnt lgkmcnt(6)
    v_mfma_f32_16x16x32_bf16 v[68:71], v[28:31], a[8:11], v[68:71]
    ds_read_b128 v[24:27], v12 offset:10240
    v_mfma_f32_16x16x32_bf16 v[76:79], v[28:31], a[12:15], v[76:79]
    s_waitcnt lgkmcnt(6)
    v_mfma_f32_16x16x32_bf16 v[72:75], v[32:35], a[8:11], v[72:75]
    ds_read_b128 v[28:31], v13 offset:8192
    s_add_u32 m0, s19, 15872
    v_mfma_f32_16x16x32_bf16 v[80:83], v[32:35], a[12:15], v[80:83]
    buffer_load_dwordx4 v2, s[8:11], s20 offen offset:512 lds
    s_waitcnt lgkmcnt(6)
    v_mfma_f32_16x16x32_bf16 v[68:71], v[36:39], a[16:19], v[68:71]
    ds_read_b128 v[32:35], v13 offset:10240
    v_mfma_f32_16x16x32_bf16 v[76:79], v[36:39], a[20:23], v[76:79]
    s_waitcnt lgkmcnt(6)
    v_mfma_f32_16x16x32_bf16 v[72:75], v[40:43], a[16:19], v[72:75]
    ds_read_b128 v[36:39], v12 offset:12288
    s_add_u32 m0, s19, 19840
    v_mfma_f32_16x16x32_bf16 v[80:83], v[40:43], a[20:23], v[80:83]
    buffer_load_dwordx4 v2, s[8:11], s20 offen offset:640 lds
    s_waitcnt lgkmcnt(6)
    v_mfma_f32_16x16x32_bf16 v[68:71], v[44:47], a[24:27], v[68:71]
    ds_read_b128 v[40:43], v12 offset:14336
    v_mfma_f32_16x16x32_bf16 v[76:79], v[44:47], a[28:31], v[76:79]
    s_waitcnt lgkmcnt(6)
    v_mfma_f32_16x16x32_bf16 v[72:75], v[48:51], a[24:27], v[72:75]
    ds_read_b128 v[44:47], v13 offset:12288
    s_add_u32 m0, s19, 23808
    v_mfma_f32_16x16x32_bf16 v[80:83], v[48:51], a[28:31], v[80:83]
    buffer_load_dwordx4 v2, s[8:11], s20 offen offset:768 lds
    s_waitcnt lgkmcnt(6)
    v_mfma_f32_16x16x32_bf16 v[68:71], v[20:23], a[32:35], v[68:71]
    ds_read_b128 v[48:51], v13 offset:14336
    v_mfma_f32_16x16x32_bf16 v[76:79], v[20:23], a[36:39], v[76:79]
    s_waitcnt lgkmcnt(6)
    v_mfma_f32_16x16x32_bf16 v[72:75], v[24:27], a[32:35], v[72:75]
    ds_read_b128 v[20:23], v12 offset:16384
    s_add_u32 m0, s19, 27776
    v_mfma_f32_16x16x32_bf16 v[80:83], v[24:27], a[36:39], v[80:83]
    buffer_load_dwordx4 v2, s[8:11], s20 offen offset:896 lds
    s_waitcnt lgkmcnt(6)
    v_mfma_f32_16x16x32_bf16 v[68:71], v[28:31], a[40:43], v[68:71]
    ds_read_b128 v[24:27], v12 offset:18432
    v_mfma_f32_16x16x32_bf16 v[76:79], v[28:31], a[44:47], v[76:79]
    v_cvt_pk_bf16_f32 v84, v52, v53
    s_waitcnt lgkmcnt(6)
    v_mfma_f32_16x16x32_bf16 v[72:75], v[32:35], a[40:43], v[72:75]
    ds_read_b128 v[28:31], v13 offset:16384
    v_mfma_f32_16x16x32_bf16 v[80:83], v[32:35], a[44:47], v[80:83]
    v_cvt_pk_bf16_f32 v85, v54, v55
    s_waitcnt lgkmcnt(6)
    v_mfma_f32_16x16x32_bf16 v[68:71], v[36:39], a[48:51], v[68:71]
    ds_read_b128 v[32:35], v13 offset:18432
    v_mfma_f32_16x16x32_bf16 v[76:79], v[36:39], a[52:55], v[76:79]
    v_cvt_pk_bf16_f32 v86, v56, v57
    s_waitcnt lgkmcnt(6)
    v_mfma_f32_16x16x32_bf16 v[72:75], v[40:43], a[48:51], v[72:75]
    ds_read_b128 v[36:39], v12 offset:20480
    v_mfma_f32_16x16x32_bf16 v[80:83], v[40:43], a[52:55], v[80:83]
    v_cvt_pk_bf16_f32 v87, v58, v59
    s_waitcnt lgkmcnt(6)
    v_mfma_f32_16x16x32_bf16 v[68:71], v[44:47], a[56:59], v[68:71]
    ds_read_b128 v[40:43], v12 offset:22528
    v_mfma_f32_16x16x32_bf16 v[76:79], v[44:47], a[60:63], v[76:79]
    v_cvt_pk_bf16_f32 v88, v60, v61
    s_waitcnt lgkmcnt(6)
    v_mfma_f32_16x16x32_bf16 v[72:75], v[48:51], a[56:59], v[72:75]
    ds_read_b128 v[44:47], v13 offset:20480
    v_mfma_f32_16x16x32_bf16 v[80:83], v[48:51], a[60:63], v[80:83]
    v_cvt_pk_bf16_f32 v89, v62, v63
    buffer_store_dwordx4 v[84:87], v3, s[4:7], s21 offen offset:0 sc1
    s_waitcnt lgkmcnt(6)
    v_mfma_f32_16x16x32_bf16 v[68:71], v[20:23], a[64:67], v[68:71]
    ds_read_b128 v[48:51], v13 offset:22528
    v_mfma_f32_16x16x32_bf16 v[76:79], v[20:23], a[68:71], v[76:79]
    v_cvt_pk_bf16_f32 v90, v64, v65
    s_waitcnt lgkmcnt(6)
    v_mfma_f32_16x16x32_bf16 v[72:75], v[24:27], a[64:67], v[72:75]
    ds_read_b128 v[20:23], v12 offset:24576
    v_mfma_f32_16x16x32_bf16 v[80:83], v[24:27], a[68:71], v[80:83]
    v_cvt_pk_bf16_f32 v91, v66, v67
    s_waitcnt lgkmcnt(6)
    v_mfma_f32_16x16x32_bf16 v[68:71], v[28:31], a[72:75], v[68:71]
    ds_read_b128 v[24:27], v12 offset:26624
    v_mfma_f32_16x16x32_bf16 v[76:79], v[28:31], a[76:79], v[76:79]
    s_waitcnt lgkmcnt(6)
    v_mfma_f32_16x16x32_bf16 v[72:75], v[32:35], a[72:75], v[72:75]
    ds_read_b128 v[28:31], v13 offset:24576
    v_mfma_f32_16x16x32_bf16 v[80:83], v[32:35], a[76:79], v[80:83]
    buffer_store_dwordx4 v[88:91], v3, s[4:7], s21 offen offset:256 sc1
    s_waitcnt lgkmcnt(6)
    v_mfma_f32_16x16x32_bf16 v[68:71], v[36:39], a[80:83], v[68:71]
    ds_read_b128 v[32:35], v13 offset:26624
    v_mfma_f32_16x16x32_bf16 v[76:79], v[36:39], a[84:87], v[76:79]
    s_add_u32 s21, s21, s25
    s_mov_b32 s25, s26
    s_waitcnt lgkmcnt(6)
    v_mfma_f32_16x16x32_bf16 v[72:75], v[40:43], a[80:83], v[72:75]
    ds_read_b128 v[36:39], v12 offset:28672
    v_mfma_f32_16x16x32_bf16 v[80:83], v[40:43], a[84:87], v[80:83]
    s_waitcnt lgkmcnt(6)
    v_mfma_f32_16x16x32_bf16 v[68:71], v[44:47], a[88:91], v[68:71]
    ds_read_b128 v[40:43], v12 offset:30720
    v_mfma_f32_16x16x32_bf16 v[76:79], v[44:47], a[92:95], v[76:79]
    s_waitcnt lgkmcnt(6)
    v_mfma_f32_16x16x32_bf16 v[72:75], v[48:51], a[88:91], v[72:75]
    ds_read_b128 v[44:47], v13 offset:28672
    v_mfma_f32_16x16x32_bf16 v[80:83], v[48:51], a[92:95], v[80:83]
    s_waitcnt lgkmcnt(6)
    v_mfma_f32_16x16x32_bf16 v[68:71], v[20:23], a[96:99], v[68:71]
    ds_read_b128 v[48:51], v13 offset:30720
    v_mfma_f32_16x16x32_bf16 v[76:79], v[20:23], a[100:103], v[76:79]
    s_waitcnt lgkmcnt(6)
    v_mfma_f32_16x16x32_bf16 v[72:75], v[24:27], a[96:99], v[72:75]
    s_waitcnt vmcnt(11)
    s_barrier
    ds_read_b128 v[20:23], v12 offset:32768
    v_mfma_f32_16x16x32_bf16 v[80:83], v[24:27], a[100:103], v[80:83]
    s_waitcnt lgkmcnt(6)
    v_mfma_f32_16x16x32_bf16 v[68:71], v[28:31], a[104:107], v[68:71]
    ds_read_b128 v[24:27], v12 offset:34816
    s_add_u32 m0, s19, 31744
    v_mfma_f32_16x16x32_bf16 v[76:79], v[28:31], a[108:111], v[76:79]
    buffer_load_dwordx4 v2, s[8:11], s20 offen offset:1024 lds
    s_waitcnt lgkmcnt(6)
    v_mfma_f32_16x16x32_bf16 v[72:75], v[32:35], a[104:107], v[72:75]
    ds_read_b128 v[28:31], v13 offset:32768
    v_mfma_f32_16x16x32_bf16 v[80:83], v[32:35], a[108:111], v[80:83]
    s_waitcnt lgkmcnt(6)
    v_mfma_f32_16x16x32_bf16 v[68:71], v[36:39], a[112:115], v[68:71]
    ds_read_b128 v[32:35], v13 offset:34816
    s_add_u32 m0, s19, 35712
    v_mfma_f32_16x16x32_bf16 v[76:79], v[36:39], a[116:119], v[76:79]
    buffer_load_dwordx4 v2, s[8:11], s20 offen offset:1152 lds
    s_waitcnt lgkmcnt(6)
    v_mfma_f32_16x16x32_bf16 v[72:75], v[40:43], a[112:115], v[72:75]
    ds_read_b128 v[36:39], v12 offset:36864
    v_mfma_f32_16x16x32_bf16 v[80:83], v[40:43], a[116:119], v[80:83]
    s_waitcnt lgkmcnt(6)
    v_mfma_f32_16x16x32_bf16 v[68:71], v[44:47], a[120:123], v[68:71]
    ds_read_b128 v[40:43], v12 offset:38912
    s_add_u32 m0, s19, 39680
    v_mfma_f32_16x16x32_bf16 v[76:79], v[44:47], a[124:127], v[76:79]
    buffer_load_dwordx4 v2, s[8:11], s20 offen offset:1280 lds
    s_waitcnt lgkmcnt(6)
    v_mfma_f32_16x16x32_bf16 v[72:75], v[48:51], a[120:123], v[72:75]
    ds_read_b128 v[44:47], v13 offset:36864
    v_mfma_f32_16x16x32_bf16 v[80:83], v[48:51], a[124:127], v[80:83]
    s_waitcnt lgkmcnt(6)
    v_mfma_f32_16x16x32_bf16 v[68:71], v[20:23], a[128:131], v[68:71]
    ds_read_b128 v[48:51], v13 offset:38912
    v_mfma_f32_16x16x32_bf16 v[76:79], v[20:23], a[132:135], v[76:79]
    s_waitcnt lgkmcnt(6)
    v_mfma_f32_16x16x32_bf16 v[72:75], v[24:27], a[128:131], v[72:75]
    ds_read_b128 v[20:23], v12 offset:40960
    s_add_u32 m0, s19, 43648
    v_mfma_f32_16x16x32_bf16 v[80:83], v[24:27], a[132:135], v[80:83]
    buffer_load_dwordx4 v2, s[8:11], s20 offen offset:1408 lds
    s_waitcnt lgkmcnt(6)
    v_mfma_f32_16x16x32_bf16 v[68:71], v[28:31], a[136:139], v[68:71]
    ds_read_b128 v[24:27], v12 offset:43008
    v_mfma_f32_16x16x32_bf16 v[76:79], v[28:31], a[140:143], v[76:79]
    s_waitcnt lgkmcnt(6)
    v_mfma_f32_16x16x32_bf16 v[72:75], v[32:35], a[136:139], v[72:75]
    ds_read_b128 v[28:31], v13 offset:40960
    s_add_u32 m0, s19, 47616
    v_mfma_f32_16x16x32_bf16 v[80:83], v[32:35], a[140:143], v[80:83]
    buffer_load_dwordx4 v2, s[8:11], s20 offen offset:1536 lds
    s_waitcnt lgkmcnt(6)
    v_mfma_f32_16x16x32_bf16 v[68:71], v[36:39], a[144:147], v[68:71]
    ds_read_b128 v[32:35], v13 offset:43008
    v_mfma_f32_16x16x32_bf16 v[76:79], v[36:39], a[148:151], v[76:79]
    s_waitcnt lgkmcnt(6)
    v_mfma_f32_16x16x32_bf16 v[72:75], v[40:43], a[144:147], v[72:75]
    ds_read_b128 v[36:39], v12 offset:45056
    s_add_u32 m0, s19, 51584
    v_mfma_f32_16x16x32_bf16 v[80:83], v[40:43], a[148:151], v[80:83]
    buffer_load_dwordx4 v2, s[8:11], s20 offen offset:1664 lds
    s_waitcnt lgkmcnt(6)
    v_mfma_f32_16x16x32_bf16 v[68:71], v[44:47], a[152:155], v[68:71]
    ds_read_b128 v[40:43], v12 offset:47104
    v_mfma_f32_16x16x32_bf16 v[76:79], v[44:47], a[156:159], v[76:79]
    s_waitcnt lgkmcnt(6)
    v_mfma_f32_16x16x32_bf16 v[72:75], v[48:51], a[152:155], v[72:75]
    ds_read_b128 v[44:47], v13 offset:45056
    s_add_u32 m0, s19, 55552
    v_mfma_f32_16x16x32_bf16 v[80:83], v[48:51], a[156:159], v[80:83]
    buffer_load_dwordx4 v2, s[8:11], s20 offen offset:1792 lds
    s_waitcnt lgkmcnt(6)
    v_mfma_f32_16x16x32_bf16 v[68:71], v[20:23], a[160:163], v[68:71]
    ds_read_b128 v[48:51], v13 offset:47104
    v_mfma_f32_16x16x32_bf16 v[76:79], v[20:23], a[164:167], v[76:79]
    s_waitcnt lgkmcnt(6)
    v_mfma_f32_16x16x32_bf16 v[72:75], v[24:27], a[160:163], v[72:75]
    ds_read_b128 v[20:23], v12 offset:49152
    s_add_u32 m0, s19, 59520
    v_mfma_f32_16x16x32_bf16 v[80:83], v[24:27], a[164:167], v[80:83]
    buffer_load_dwordx4 v2, s[8:11], s20 offen offset:1920 lds
    s_waitcnt lgkmcnt(6)
    v_mfma_f32_16x16x32_bf16 v[68:71], v[28:31], a[168:171], v[68:71]
    ds_read_b128 v[24:27], v12 offset:51200
    v_mfma_f32_16x16x32_bf16 v[76:79], v[28:31], a[172:175], v[76:79]
    s_add_u32 s20, s20, s24
    s_waitcnt lgkmcnt(6)
    v_mfma_f32_16x16x32_bf16 v[72:75], v[32:35], a[168:171], v[72:75]
    ds_read_b128 v[28:31], v13 offset:49152
    v_mfma_f32_16x16x32_bf16 v[80:83], v[32:35], a[172:175], v[80:83]
    s_waitcnt lgkmcnt(6)
    v_mfma_f32_16x16x32_bf16 v[68:71], v[36:39], a[176:179], v[68:71]
    ds_read_b128 v[32:35], v13 offset:51200
    v_mfma_f32_16x16x32_bf16 v[76:79], v[36:39], a[180:183], v[76:79]
    s_waitcnt lgkmcnt(6)
    v_mfma_f32_16x16x32_bf16 v[72:75], v[40:43], a[176:179], v[72:75]
    ds_read_b128 v[36:39], v12 offset:53248
    v_mfma_f32_16x16x32_bf16 v[80:83], v[40:43], a[180:183], v[80:83]
    s_waitcnt lgkmcnt(6)
    v_mfma_f32_16x16x32_bf16 v[68:71], v[44:47], a[184:187], v[68:71]
    ds_read_b128 v[40:43], v12 offset:55296
    v_mfma_f32_16x16x32_bf16 v[76:79], v[44:47], a[188:191], v[76:79]
    s_waitcnt lgkmcnt(6)
    v_mfma_f32_16x16x32_bf16 v[72:75], v[48:51], a[184:187], v[72:75]
    ds_read_b128 v[44:47], v13 offset:53248
    v_mfma_f32_16x16x32_bf16 v[80:83], v[48:51], a[188:191], v[80:83]
    s_waitcnt lgkmcnt(6)
    v_mfma_f32_16x16x32_bf16 v[68:71], v[20:23], a[192:195], v[68:71]
    ds_read_b128 v[48:51], v13 offset:55296
    v_mfma_f32_16x16x32_bf16 v[76:79], v[20:23], a[196:199], v[76:79]
    s_waitcnt lgkmcnt(6)
    v_mfma_f32_16x16x32_bf16 v[72:75], v[24:27], a[192:195], v[72:75]
    ds_read_b128 v[20:23], v12 offset:57344
    v_mfma_f32_16x16x32_bf16 v[80:83], v[24:27], a[196:199], v[80:83]
    s_waitcnt lgkmcnt(6)
    v_mfma_f32_16x16x32_bf16 v[68:71], v[28:31], a[200:203], v[68:71]
    ds_read_b128 v[24:27], v12 offset:59392
    v_mfma_f32_16x16x32_bf16 v[76:79], v[28:31], a[204:207], v[76:79]
    s_waitcnt lgkmcnt(6)
    v_mfma_f32_16x16x32_bf16 v[72:75], v[32:35], a[200:203], v[72:75]
    ds_read_b128 v[28:31], v13 offset:57344
    v_mfma_f32_16x16x32_bf16 v[80:83], v[32:35], a[204:207], v[80:83]
    s_waitcnt lgkmcnt(6)
    v_mfma_f32_16x16x32_bf16 v[68:71], v[36:39], a[208:211], v[68:71]
    ds_read_b128 v[32:35], v13 offset:59392
    v_mfma_f32_16x16x32_bf16 v[76:79], v[36:39], a[212:215], v[76:79]
    s_waitcnt lgkmcnt(6)
    v_mfma_f32_16x16x32_bf16 v[72:75], v[40:43], a[208:211], v[72:75]
    ds_read_b128 v[36:39], v12 offset:61440
    v_mfma_f32_16x16x32_bf16 v[80:83], v[40:43], a[212:215], v[80:83]
    s_waitcnt lgkmcnt(6)
    v_mfma_f32_16x16x32_bf16 v[68:71], v[44:47], a[216:219], v[68:71]
    ds_read_b128 v[40:43], v12 offset:63488
    v_mfma_f32_16x16x32_bf16 v[76:79], v[44:47], a[220:223], v[76:79]
    s_waitcnt lgkmcnt(6)
    v_mfma_f32_16x16x32_bf16 v[72:75], v[48:51], a[216:219], v[72:75]
    ds_read_b128 v[44:47], v13 offset:61440
    v_mfma_f32_16x16x32_bf16 v[80:83], v[48:51], a[220:223], v[80:83]
    s_waitcnt lgkmcnt(6)
    v_mfma_f32_16x16x32_bf16 v[68:71], v[20:23], a[224:227], v[68:71]
    ds_read_b128 v[48:51], v13 offset:63488
    v_mfma_f32_16x16x32_bf16 v[76:79], v[20:23], a[228:231], v[76:79]
    s_waitcnt lgkmcnt(6)
    v_mfma_f32_16x16x32_bf16 v[72:75], v[24:27], a[224:227], v[72:75]
    s_waitcnt vmcnt(8)
    s_barrier
    ds_read_b128 v[20:23], v10 offset:0
    v_mfma_f32_16x16x32_bf16 v[80:83], v[24:27], a[228:231], v[80:83]
    s_waitcnt lgkmcnt(6)
    v_mfma_f32_16x16x32_bf16 v[68:71], v[28:31], a[232:235], v[68:71]
    ds_read_b128 v[24:27], v10 offset:2048
    s_add_u32 m0, s19, 65536
    v_mfma_f32_16x16x32_bf16 v[76:79], v[28:31], a[236:239], v[76:79]
    buffer_load_dwordx4 v2, s[8:11], s20 offen offset:0 lds
    s_waitcnt lgkmcnt(6)
    v_mfma_f32_16x16x32_bf16 v[72:75], v[32:35], a[232:235], v[72:75]
    ds_read_b128 v[28:31], v11 offset:0
    v_mfma_f32_16x16x32_bf16 v[80:83], v[32:35], a[236:239], v[80:83]
    v_mov_b32 v9, s23
    s_add_u32 s23, s23, 1
    buffer_store_dword v9, v4, s[4:7], 0 offen sc1
    s_waitcnt lgkmcnt(6)
    v_mfma_f32_16x16x32_bf16 v[68:71], v[36:39], a[240:243], v[68:71]
    ds_read_b128 v[32:35], v11 offset:2048
    s_add_u32 m0, s19, 69504
    v_mfma_f32_16x16x32_bf16 v[76:79], v[36:39], a[244:247], v[76:79]
    buffer_load_dwordx4 v2, s[8:11], s20 offen offset:128 lds
    s_waitcnt lgkmcnt(6)
    v_mfma_f32_16x16x32_bf16 v[72:75], v[40:43], a[240:243], v[72:75]
    ds_read_b128 v[36:39], v10 offset:4096
    v_mfma_f32_16x16x32_bf16 v[80:83], v[40:43], a[244:247], v[80:83]
    s_waitcnt lgkmcnt(6)
    v_mfma_f32_16x16x32_bf16 v[68:71], v[44:47], a[248:251], v[68:71]
    ds_read_b128 v[40:43], v10 offset:6144
    s_add_u32 m0, s19, 73472
    v_mfma_f32_16x16x32_bf16 v[76:79], v[44:47], a[252:255], v[76:79]
    buffer_load_dwordx4 v2, s[8:11], s20 offen offset:256 lds
    s_waitcnt lgkmcnt(6)
    v_mfma_f32_16x16x32_bf16 v[72:75], v[48:51], a[248:251], v[72:75]
    ds_read_b128 v[44:47], v11 offset:4096
    v_mfma_f32_16x16x32_bf16 v[80:83], v[48:51], a[252:255], v[80:83]
    s_add_u32 s22, s22, 2
    s_cmp_lt_u32 s22, 64
    s_cbranch_scc1 P_v_top
    v_cvt_pk_bf16_f32 v84, v68, v69
    v_cvt_pk_bf16_f32 v85, v70, v71
    s_nop 0
    v_cvt_pk_bf16_f32 v86, v72, v73
    v_cvt_pk_bf16_f32 v87, v74, v75
    v_cvt_pk_bf16_f32 v88, v76, v77
    v_cvt_pk_bf16_f32 v89, v78, v79
    v_cvt_pk_bf16_f32 v90, v80, v81
    v_cvt_pk_bf16_f32 v91, v82, v83
    buffer_store_dwordx4 v[84:87], v3, s[4:7], s21 offen offset:0 sc1
    buffer_store_dwordx4 v[88:91], v3, s[4:7], s21 offen offset:256 sc1
    s_waitcnt vmcnt(0) lgkmcnt(0)
    v_mov_b32 v9, s23
    s_add_u32 s23, s23, 1
    buffer_store_dword v9, v4, s[4:7], 0 offen sc1
    s_branch W_U
W_U:
    v_mov_b32 v6, 0
    s_mov_b32 s18, 0
U_rdv:
    global_load_dwordx4 v[20:23], v6, s[94:95] sc1
    global_load_dwordx4 v[24:27], v6, s[94:95] offset:16 sc1
    global_load_dword v5, v6, s[94:95] offset:32 sc1
    s_waitcnt vmcnt(0)
    v_sad_u8 v5, v20, 0, v5
    v_sad_u8 v5, v21, 0, v5
    v_sad_u8 v5, v22, 0, v5
    v_sad_u8 v5, v23, 0, v5
    v_sad_u8 v5, v24, 0, v5
    v_sad_u8 v5, v25, 0, v5
    v_sad_u8 v5, v26, 0, v5
    v_sad_u8 v5, v27, 0, v5
    s_nop 0
    v_readfirstlane_b32 s17, v5
    s_nop 0
    s_cmp_ge_u32 s17, 256
    s_cbranch_scc1 U_rdv_ok
    s_sleep 8
    s_add_u32 s18, s18, 1
    s_cmp_lt_u32 s18, 1048576
    s_cbranch_scc1 U_rdv
    s_mov_b32 s92, 1048576
U_rdv_ok:
    s_load_dwordx2 s[8:9], s[0:1], 64
    s_load_dwordx2 s[12:13], s[0:1], 80
    s_mov_b32 s10, 8388608
    s_mov_b32 s11, 0x20000
    s_mov_b32 s14, 8388608
    s_mov_b32 s15, 0x20000
    s_lshl_b32 s20, s16, 21
    s_lshl_b32 s17, s91, 6
    s_add_u32 s20, s20, s17
    s_waitcnt lgkmcnt(0)
    s_barrier
    v_lshrrev_b32 v5, 2, v1
    v_and_b32 v6, 3, v1
    v_lshlrev_b32 v7, 4, v6
    v_lshl_add_u32 v7, v5, 11, v7
    v_lshlrev_b32 v8, 4, v6
    v_bfe_u32 v5, v1, 2, 2
    v_lshrrev_b32 v6, 4, v1
    v_lshl_add_u32 v5, v6, 3, v5
    v_lshl_add_u32 v8, v5, 6, v8
    s_lshl_b32 s18, s16, 15
    v_add_u32 v8, s18, v8
    s_add_u32 m0, s18, 0
    s_nop 0
    buffer_load_dwordx4 v7, s[8:11], s20 offen lds
    s_add_u32 s20, s20, 32768
    s_add_u32 m0, s18, 1024
    s_nop 0
    buffer_load_dwordx4 v7, s[8:11], s20 offen lds
    s_add_u32 s20, s20, 32768
    s_add_u32 m0, s18, 2048
    s_nop 0
    buffer_load_dwordx4 v7, s[8:11], s20 offen lds
    s_add_u32 s20, s20, 32768
    s_add_u32 m0, s18, 3072
    s_nop 0
    buffer_load_dwordx4 v7, s[8:11], s20 offen lds
    s_add_u32 s20, s20, 32768
    s_add_u32 m0, s18, 4096
    s_nop 0
    buffer_load_dwordx4 v7, s[8:11], s20 offen lds
    s_add_u32 s20, s20, 32768
    s_add_u32 m0, s18, 5120
    s_nop 0
    buffer_load_dwordx4 v7, s[8:11], s20 offen lds
    s_add_u32 s20, s20, 32768
    s_add_u32 m0, s18, 6144
    s_nop 0
    buffer_load_dwordx4 v7, s[8:11], s20 offen lds
    s_add_u32 s20, s20, 32768
    s_add_u32 m0, s18, 7168
    s_nop 0
    buffer_load_dwordx4 v7, s[8:11], s20 offen lds
    s_add_u32 s20, s20, 32768
    s_add_u32 m0, s18, 8192
    s_nop 0
    buffer_load_dwordx4 v7, s[8:11], s20 offen lds
    s_add_u32 s20, s20, 32768
    s_add_u32 m0, s18, 9216
    s_nop 0
    buffer_load_dwordx4 v7, s[8:11], s20 offen lds
    s_add_u32 s20, s20, 32768
    s_add_u32 m0, s18, 10240
    s_nop 0
    buffer_load_dwordx4 v7, s[8:11], s20 offen lds
    s_add_u32 s20, s20, 32768
    s_add_u32 m0, s18, 11264
    s_nop 0
    buffer_load_dwordx4 v7, s[8:11], s20 offen lds
    s_add_u32 s20, s20, 32768
    s_add_u32 m0, s18, 12288
    s_nop 0
    buffer_load_dwordx4 v7, s[8:11], s20 offen lds
    s_add_u32 s20, s20, 32768
    s_add_u32 m0, s18, 13312
    s_nop 0
    buffer_load_dwordx4 v7, s[8:11], s20 offen lds
    s_add_u32 s20, s20, 32768
    s_add_u32 m0, s18, 14336
    s_nop 0
    buffer_load_dwordx4 v7, s[8:11], s20 offen lds
    s_add_u32 s20, s20, 32768
    s_add_u32 m0, s18, 15360
    s_nop 0
    buffer_load_dwordx4 v7, s[8:11], s20 offen lds
    s_add_u32 s20, s20, 32768
    s_add_u32 m0, s18, 16384
    s_nop 0
    buffer_load_dwordx4 v7, s[8:11], s20 offen lds
    s_add_u32 s20, s20, 32768
    s_add_u32 m0, s18, 17408
    s_nop 0
    buffer_load_dwordx4 v7, s[8:11], s20 offen lds
    s_add_u32 s20, s20, 32768
    s_add_u32 m0, s18, 18432
    s_nop 0
    buffer_load_dwordx4 v7, s[8:11], s20 offen lds
    s_add_u32 s20, s20, 32768
    s_add_u32 m0, s18, 19456
    s_nop 0
    buffer_load_dwordx4 v7, s[8:11], s20 offen lds
    s_add_u32 s20, s20, 32768
    s_add_u32 m0, s18, 20480
    s_nop 0
    buffer_load_dwordx4 v7, s[8:11], s20 offen lds
    s_add_u32 s20, s20, 32768
    s_add_u32 m0, s18, 21504
    s_nop 0
    buffer_load_dwordx4 v7, s[8:11], s20 offen lds
    s_add_u32 s20, s20, 32768
    s_add_u32 m0, s18, 22528
    s_nop 0
    buffer_load_dwordx4 v7, s[8:11], s20 offen lds
    s_add_u32 s20, s20, 32768
    s_add_u32 m0, s18, 23552
    s_nop 0
    buffer_load_dwordx4 v7, s[8:11], s20 offen lds
    s_add_u32 s20, s20, 32768
    s_add_u32 m0, s18, 24576
    s_nop 0
    buffer_load_dwordx4 v7, s[8:11], s20 offen lds
    s_add_u32 s20, s20, 32768
    s_add_u32 m0, s18, 25600
    s_nop 0
    buffer_load_dwordx4 v7, s[8:11], s20 offen lds
    s_add_u32 s20, s20, 32768
    s_add_u32 m0, s18, 26624
    s_nop 0
    buffer_load_dwordx4 v7, s[8:11], s20 offen lds
    s_add_u32 s20, s20, 32768
    s_add_u32 m0, s18, 27648
    s_nop 0
    buffer_load_dwordx4 v7, s[8:11], s20 offen lds
    s_add_u32 s20, s20, 32768
    s_add_u32 m0, s18, 28672
    s_nop 0
    buffer_load_dwordx4 v7, s[8:11], s20 offen lds
    s_add_u32 s20, s20, 32768
    s_add_u32 m0, s18, 29696
    s_nop 0
    buffer_load_dwordx4 v7, s[8:11], s20 offen lds
    s_add_u32 s20, s20, 32768
    s_add_u32 m0, s18, 30720
    s_nop 0
    buffer_load_dwordx4 v7, s[8:11], s20 offen lds
    s_add_u32 s20, s20, 32768
    s_add_u32 m0, s18, 31744
    s_nop 0
    buffer_load_dwordx4 v7, s[8:11], s20 offen lds
    s_add_u32 s20, s20, 32768
    s_waitcnt vmcnt(24)
    ds_read_b64_tr_b16 a[0:1], v8 offset:0
    ds_read_b64_tr_b16 a[2:3], v8 offset:256
    ds_read_b64_tr_b16 a[4:5], v8 offset:8
    ds_read_b64_tr_b16 a[6:7], v8 offset:264
    ds_read_b64_tr_b16 a[8:9], v8 offset:2048
    ds_read_b64_tr_b16 a[10:11], v8 offset:2304
    ds_read_b64_tr_b16 a[12:13], v8 offset:2056
    ds_read_b64_tr_b16 a[14:15], v8 offset:2312
    s_waitcnt lgkmcnt(7)
    ds_read_b64_tr_b16 a[16:17], v8 offset:4096
    ds_read_b64_tr_b16 a[18:19], v8 offset:4352
    ds_read_b64_tr_b16 a[20:21], v8 offset:4104
    ds_read_b64_tr_b16 a[22:23], v8 offset:4360
    ds_read_b64_tr_b16 a[24:25], v8 offset:6144
    ds_read_b64_tr_b16 a[26:27], v8 offset:6400
    ds_read_b64_tr_b16 a[28:29], v8 offset:6152
    ds_read_b64_tr_b16 a[30:31], v8 offset:6408
    s_waitcnt lgkmcnt(7)
    s_waitcnt vmcnt(16)
    ds_read_b64_tr_b16 a[32:33], v8 offset:8192
    ds_read_b64_tr_b16 a[34:35], v8 offset:8448
    ds_read_b64_tr_b16 a[36:37], v8 offset:8200
    ds_read_b64_tr_b16 a[38:39], v8 offset:8456
    ds_read_b64_tr_b16 a[40:41], v8 offset:10240
    ds_read_b64_tr_b16 a[42:43], v8 offset:10496
    ds_read_b64_tr_b16 a[44:45], v8 offset:10248
    ds_read_b64_tr_b16 a[46:47], v8 offset:10504
    s_waitcnt lgkmcnt(7)
    ds_read_b64_tr_b16 a[48:49], v8 offset:12288
    ds_read_b64_tr_b16 a[50:51], v8 offset:12544
    ds_read_b64_tr_b16 a[52:53], v8 offset:12296
    ds_read_b64_tr_b16 a[54:55], v8 offset:12552
    ds_read_b64_tr_b16 a[56:57], v8 offset:14336
    ds_read_b64_tr_b16 a[58:59], v8 offset:14592
    ds_read_b64_tr_b16 a[60:61], v8 offset:14344
    ds_read_b64_tr_b16 a[62:63], v8 offset:14600
    s_waitcnt lgkmcnt(7)
    s_waitcnt vmcnt(8)
    ds_read_b64_tr_b16 a[64:65], v8 offset:16384
    ds_read_b64_tr_b16 a[66:67], v8 offset:16640
    ds_read_b64_tr_b16 a[68:69], v8 offset:16392
    ds_read_b64_tr_b16 a[70:71], v8 offset:16648
    ds_read_b64_tr_b16 a[72:73], v8 offset:18432
    ds_read_b64_tr_b16 a[74:75], v8 offset:18688
    ds_read_b64_tr_b16 a[76:77], v8 offset:18440
    ds_read_b64_tr_b16 a[78:79], v8 offset:18696
    s_waitcnt lgkmcnt(7)
    ds_read_b64_tr_b16 a[80:81], v8 offset:20480
    ds_read_b64_tr_b16 a[82:83], v8 offset:20736
    ds_read_b64_tr_b16 a[84:85], v8 offset:20488
    ds_read_b64_tr_b16 a[86:87], v8 offset:20744
    ds_read_b64_tr_b16 a[88:89], v8 offset:22528
    ds_read_b64_tr_b16 a[90:91], v8 offset:22784
    ds_read_b64_tr_b16 a[92:93], v8 offset:22536
    ds_read_b64_tr_b16 a[94:95], v8 offset:22792
    s_waitcnt lgkmcnt(7)
    s_waitcnt vmcnt(0)
    ds_read_b64_tr_b16 a[96:97], v8 offset:24576
    ds_read_b64_tr_b16 a[98:99], v8 offset:24832
    ds_read_b64_tr_b16 a[100:101], v8 offset:24584
    ds_read_b64_tr_b16 a[102:103], v8 offset:24840
    ds_read_b64_tr_b16 a[104:105], v8 offset:26624
    ds_read_b64_tr_b16 a[106:107], v8 offset:26880
    ds_read_b64_tr_b16 a[108:109], v8 offset:26632
    ds_read_b64_tr_b16 a[110:111], v8 offset:26888
    s_waitcnt lgkmcnt(7)
    ds_read_b64_tr_b16 a[112:113], v8 offset:28672
    ds_read_b64_tr_b16 a[114:115], v8 offset:28928
    ds_read_b64_tr_b16 a[116:117], v8 offset:28680
    ds_read_b64_tr_b16 a[118:119], v8 offset:28936
    ds_read_b64_tr_b16 a[120:121], v8 offset:30720
    ds_read_b64_tr_b16 a[122:123], v8 offset:30976
    ds_read_b64_tr_b16 a[124:125], v8 offset:30728
    ds_read_b64_tr_b16 a[126:127], v8 offset:30984
    s_waitcnt lgkmcnt(7)
    s_waitcnt lgkmcnt(0)
    s_add_u32 m0, s18, 0
    s_nop 0
    buffer_load_dwordx4 v7, s[8:11], s20 offen lds
    s_add_u32 s20, s20, 32768
    s_add_u32 m0, s18, 1024
    s_nop 0
    buffer_load_dwordx4 v7, s[8:11], s20 offen lds
    s_add_u32 s20, s20, 32768
    s_add_u32 m0, s18, 2048
    s_nop 0
    buffer_load_dwordx4 v7, s[8:11], s20 offen lds
    s_add_u32 s20, s20, 32768
    s_add_u32 m0, s18, 3072
    s_nop 0
    buffer_load_dwordx4 v7, s[8:11], s20 offen lds
    s_add_u32 s20, s20, 32768
    s_add_u32 m0, s18, 4096
    s_nop 0
    buffer_load_dwordx4 v7, s[8:11], s20 offen lds
    s_add_u32 s20, s20, 32768
    s_add_u32 m0, s18, 5120
    s_nop 0
    buffer_load_dwordx4 v7, s[8:11], s20 offen lds
    s_add_u32 s20, s20, 32768
    s_add_u32 m0, s18, 6144
    s_nop 0
    buffer_load_dwordx4 v7, s[8:11], s20 offen lds
    s_add_u32 s20, s20, 32768
    s_add_u32 m0, s18, 7168
    s_nop 0
    buffer_load_dwordx4 v7, s[8:11], s20 offen lds
    s_add_u32 s20, s20, 32768
    s_add_u32 m0, s18, 8192
    s_nop 0
    buffer_load_dwordx4 v7, s[8:11], s20 offen lds
    s_add_u32 s20, s20, 32768
    s_add_u32 m0, s18, 9216
    s_nop 0
    buffer_load_dwordx4 v7, s[8:11], s20 offen lds
    s_add_u32 s20, s20, 32768
    s_add_u32 m0, s18, 10240
    s_nop 0
    buffer_load_dwordx4 v7, s[8:11], s20 offen lds
    s_add_u32 s20, s20, 32768
    s_add_u32 m0, s18, 11264
    s_nop 0
    buffer_load_dwordx4 v7, s[8:11], s20 offen lds
    s_add_u32 s20, s20, 32768
    s_add_u32 m0, s18, 12288
    s_nop 0
    buffer_load_dwordx4 v7, s[8:11], s20 offen lds
    s_add_u32 s20, s20, 32768
    s_add_u32 m0, s18, 13312
    s_nop 0
    buffer_load_dwordx4 v7, s[8:11], s20 offen lds
    s_add_u32 s20, s20, 32768
    s_add_u32 m0, s18, 14336
    s_nop 0
    buffer_load_dwordx4 v7, s[8:11], s20 offen lds
    s_add_u32 s20, s20, 32768
    s_add_u32 m0, s18, 15360
    s_nop 0
    buffer_load_dwordx4 v7, s[8:11], s20 offen lds
    s_add_u32 s20, s20, 32768
    s_add_u32 m0, s18, 16384
    s_nop 0
    buffer_load_dwordx4 v7, s[8:11], s20 offen lds
    s_add_u32 s20, s20, 32768
    s_add_u32 m0, s18, 17408
    s_nop 0
    buffer_load_dwordx4 v7, s[8:11], s20 offen lds
    s_add_u32 s20, s20, 32768
    s_add_u32 m0, s18, 18432
    s_nop 0
    buffer_load_dwordx4 v7, s[8:11], s20 offen lds
    s_add_u32 s20, s20, 32768
    s_add_u32 m0, s18, 19456
    s_nop 0
    buffer_load_dwordx4 v7, s[8:11], s20 offen lds
    s_add_u32 s20, s20, 32768
    s_add_u32 m0, s18, 20480
    s_nop 0
    buffer_load_dwordx4 v7, s[8:11], s20 offen lds
    s_add_u32 s20, s20, 32768
    s_add_u32 m0, s18, 21504
    s_nop 0
    buffer_load_dwordx4 v7, s[8:11], s20 offen lds
    s_add_u32 s20, s20, 32768
    s_add_u32 m0, s18, 22528
    s_nop 0
    buffer_load_dwordx4 v7, s[8:11], s20 offen lds
    s_add_u32 s20, s20, 32768
    s_add_u32 m0, s18, 23552
    s_nop 0
    buffer_load_dwordx4 v7, s[8:11], s20 offen lds
    s_add_u32 s20, s20, 32768
    s_add_u32 m0, s18, 24576
    s_nop 0
    buffer_load_dwordx4 v7, s[8:11], s20 offen lds
    s_add_u32 s20, s20, 32768
    s_add_u32 m0, s18, 25600
    s_nop 0
    buffer_load_dwordx4 v7, s[8:11], s20 offen lds
    s_add_u32 s20, s20, 32768
    s_add_u32 m0, s18, 26624
    s_nop 0
    buffer_load_dwordx4 v7, s[8:11], s20 offen lds
    s_add_u32 s20, s20, 32768
    s_add_u32 m0, s18, 27648
    s_nop 0
    buffer_load_dwordx4 v7, s[8:11], s20 offen lds
    s_add_u32 s20, s20, 32768
    s_add_u32 m0, s18, 28672
    s_nop 0
    buffer_load_dwordx4 v7, s[8:11], s20 offen lds
    s_add_u32 s20, s20, 32768
    s_add_u32 m0, s18, 29696
    s_nop 0
    buffer_load_dwordx4 v7, s[8:11], s20 offen lds
    s_add_u32 s20, s20, 32768
    s_add_u32 m0, s18, 30720
    s_nop 0
    buffer_load_dwordx4 v7, s[8:11], s20 offen lds
    s_add_u32 s20, s20, 32768
    s_add_u32 m0, s18, 31744
    s_nop 0
    buffer_load_dwordx4 v7, s[8:11], s20 offen lds
    s_add_u32 s20, s20, 32768
    s_waitcnt vmcnt(24)
    ds_read_b64_tr_b16 a[128:129], v8 offset:0
    ds_read_b64_tr_b16 a[130:131], v8 offset:256
    ds_read_b64_tr_b16 a[132:133], v8 offset:8
    ds_read_b64_tr_b16 a[134:135], v8 offset:264
    ds_read_b64_tr_b16 a[136:137], v8 offset:2048
    ds_read_b64_tr_b16 a[138:139], v8 offset:2304
    ds_read_b64_tr_b16 a[140:141], v8 offset:2056
    ds_read_b64_tr_b16 a[142:143], v8 offset:2312
    s_waitcnt lgkmcnt(7)
    ds_read_b64_tr_b16 a[144:145], v8 offset:4096
    ds_read_b64_tr_b16 a[146:147], v8 offset:4352
    ds_read_b64_tr_b16 a[148:149], v8 offset:4104
    ds_read_b64_tr_b16 a[150:151], v8 offset:4360
    ds_read_b64_tr_b16 a[152:153], v8 offset:6144
    ds_read_b64_tr_b16 a[154:155], v8 offset:6400
    ds_read_b64_tr_b16 a[156:157], v8 offset:6152
    ds_read_b64_tr_b16 a[158:159], v8 offset:6408
    s_waitcnt lgkmcnt(7)
    s_waitcnt vmcnt(16)
    ds_read_b64_tr_b16 a[160:161], v8 offset:8192
    ds_read_b64_tr_b16 a[162:163], v8 offset:8448
    ds_read_b64_tr_b16 a[164:165], v8 offset:8200
    ds_read_b64_tr_b16 a[166:167], v8 offset:8456
    ds_read_b64_tr_b16 a[168:169], v8 offset:10240
    ds_read_b64_tr_b16 a[170:171], v8 offset:10496
    ds_read_b64_tr_b16 a[172:173], v8 offset:10248
    ds_read_b64_tr_b16 a[174:175], v8 offset:10504
    s_waitcnt lgkmcnt(7)
    ds_read_b64_tr_b16 a[176:177], v8 offset:12288
    ds_read_b64_tr_b16 a[178:179], v8 offset:12544
    ds_read_b64_tr_b16 a[180:181], v8 offset:12296
    ds_read_b64_tr_b16 a[182:183], v8 offset:12552
    ds_read_b64_tr_b16 a[184:185], v8 offset:14336
    ds_read_b64_tr_b16 a[186:187], v8 offset:14592
    ds_read_b64_tr_b16 a[188:189], v8 offset:14344
    ds_read_b64_tr_b16 a[190:191], v8 offset:14600
    s_waitcnt lgkmcnt(7)
    s_waitcnt vmcnt(8)
    ds_read_b64_tr_b16 a[192:193], v8 offset:16384
    ds_read_b64_tr_b16 a[194:195], v8 offset:16640
    ds_read_b64_tr_b16 a[196:197], v8 offset:16392
    ds_read_b64_tr_b16 a[198:199], v8 offset:16648
    ds_read_b64_tr_b16 a[200:201], v8 offset:18432
    ds_read_b64_tr_b16 a[202:203], v8 offset:18688
    ds_read_b64_tr_b16 a[204:205], v8 offset:18440
    ds_read_b64_tr_b16 a[206:207], v8 offset:18696
    s_waitcnt lgkmcnt(7)
    ds_read_b64_tr_b16 a[208:209], v8 offset:20480
    ds_read_b64_tr_b16 a[210:211], v8 offset:20736
    ds_read_b64_tr_b16 a[212:213], v8 offset:20488
    ds_read_b64_tr_b16 a[214:215], v8 offset:20744
    ds_read_b64_tr_b16 a[216:217], v8 offset:22528
    ds_read_b64_tr_b16 a[218:219], v8 offset:22784
    ds_read_b64_tr_b16 a[220:221], v8 offset:22536
    ds_read_b64_tr_b16 a[222:223], v8 offset:22792
    s_waitcnt lgkmcnt(7)
    s_waitcnt vmcnt(0)
    ds_read_b64_tr_b16 a[224:225], v8 offset:24576
    ds_read_b64_tr_b16 a[226:227], v8 offset:24832
    ds_read_b64_tr_b16 a[228:229], v8 offset:24584
    ds_read_b64_tr_b16 a[230:231], v8 offset:24840
    ds_read_b64_tr_b16 a[232:233], v8 offset:26624
    ds_read_b64_tr_b16 a[234:235], v8 offset:26880
    ds_read_b64_tr_b16 a[236:237], v8 offset:26632
    ds_read_b64_tr_b16 a[238:239], v8 offset:26888
    s_waitcnt lgkmcnt(7)
    ds_read_b64_tr_b16 a[240:241], v8 offset:28672
    ds_read_b64_tr_b16 a[242:243], v8 offset:28928
    ds_read_b64_tr_b16 a[244:245], v8 offset:28680
    ds_read_b64_tr_b16 a[246:247], v8 offset:28936
    ds_read_b64_tr_b16 a[248:249], v8 offset:30720
    ds_read_b64_tr_b16 a[250:251], v8 offset:30976
    ds_read_b64_tr_b16 a[252:253], v8 offset:30728
    ds_read_b64_tr_b16 a[254:255], v8 offset:30984
    s_waitcnt lgkmcnt(7)
    s_waitcnt lgkmcnt(0)
    v_lshlrev_b32 v15, 4, v1
    s_lshl_b32 s17, s16, 15
    v_add_u32 v10, s17, v15
    s_lshl_b32 s17, s16, 11
    v_add_u32 v14, s17, v15
    v_bfe_u32 v11, v1, 3, 2
    v_and_b32 v5, 7, v1
    v_lshlrev_b32 v5, 2, v5
    v_lshl_add_u32 v11, v11, 7, v5
    s_lshl_b32 s17, s16, 5
    s_add_u32 s17, s17, 100728832
    v_add_u32 v11, s17, v11
    v_mov_b32 v12, 0
    v_and_b32 v13, 15, v1
    v_and_b32 v5, 48, v1
    v_lshl_add_u32 v13, v13, 12, v5
    s_lshl_b32 s17, s91, 6
    s_add_u32 s17, s17, 2048
    v_add_u32 v13, s17, v13
    s_mov_b32 s28, s90
    s_mov_b32 s32, 0
    s_barrier
U_wait:
    s_mov_b32 s29, s92
U_fl:
    s_lshr_b32 s17, s28, 3
    v_cmp_ge_u32 vcc, s17, v12
    s_lshl_b32 s18, s28, 2
    s_and_b32 s18, s18, 24
    s_lshr_b32 s17, vcc_lo, s18
    s_and_b32 s17, s17, 0xff
    s_cbranch_scc0 U_go
    s_cmp_ge_u32 s29, 1048576
    s_cselect_b32 s92, 1048576, s92
    s_cbranch_scc1 U_go
    s_add_u32 s29, s29, 1
    s_mov_b64 exec, 0xffffffff
    buffer_load_dword v12, v11, s[4:7], 0 offen sc1
    s_mov_b64 exec, -1
    s_sleep 2
    s_waitcnt vmcnt(0)
    s_branch U_fl
U_go:
    s_lshl_b32 s30, s28, 17
    s_add_u32 s30, s30, 54525952
    buffer_load_dwordx4 v[64:67], v10, s[4:7], s30 offen offset:0 sc1
    buffer_load_dwordx4 v[68:71], v10, s[4:7], s30 offen offset:1024 sc1
    buffer_load_dwordx4 v[72:75], v10, s[4:7], s30 offen offset:2048 sc1
    buffer_load_dwordx4 v[76:79], v10, s[4:7], s30 offen offset:3072 sc1
    s_add_u32 s30, s30, 4096
    buffer_load_dwordx4 v[80:83], v10, s[4:7], s30 offen offset:0 sc1
    buffer_load_dwordx4 v[84:87], v10, s[4:7], s30 offen offset:1024 sc1
    buffer_load_dwordx4 v[88:91], v10, s[4:7], s30 offen offset:2048 sc1
    buffer_load_dwordx4 v[92:95], v10, s[4:7], s30 offen offset:3072 sc1
    s_add_u32 s30, s30, 4096
    buffer_load_dwordx4 v[96:99], v10, s[4:7], s30 offen offset:0 sc1
    buffer_load_dwordx4 v[100:103], v10, s[4:7], s30 offen offset:1024 sc1
    buffer_load_dwordx4 v[104:107], v10, s[4:7], s30 offen offset:2048 sc1
    buffer_load_dwordx4 v[108:111], v10, s[4:7], s30 offen offset:3072 sc1
    s_add_u32 s30, s30, 4096
    buffer_load_dwordx4 v[112:115], v10, s[4:7], s30 offen offset:0 sc1
    buffer_load_dwordx4 v[116:119], v10, s[4:7], s30 offen offset:1024 sc1
    buffer_load_dwordx4 v[120:123], v10, s[4:7], s30 offen offset:2048 sc1
    buffer_load_dwordx4 v[124:127], v10, s[4:7], s30 offen offset:3072 sc1
    s_add_u32 s30, s30, 4096
    buffer_load_dwordx4 v[128:131], v10, s[4:7], s30 offen offset:0 sc1
    buffer_load_dwordx4 v[132:135], v10, s[4:7], s30 offen offset:1024 sc1
    buffer_load_dwordx4 v[136:139], v10, s[4:7], s30 offen offset:2048 sc1
    buffer_load_dwordx4 v[140:143], v10, s[4:7], s30 offen offset:3072 sc1
    s_add_u32 s30, s30, 4096
    buffer_load_dwordx4 v[144:147], v10, s[4:7], s30 offen offset:0 sc1
    buffer_load_dwordx4 v[148:151], v10, s[4:7], s30 offen offset:1024 sc1
    buffer_load_dwordx4 v[152:155], v10, s[4:7], s30 offen offset:2048 sc1
    buffer_load_dwordx4 v[156:159], v10, s[4:7], s30 offen offset:3072 sc1
    s_add_u32 s30, s30, 4096
    buffer_load_dwordx4 v[160:163], v10, s[4:7], s30 offen offset:0 sc1
    buffer_load_dwordx4 v[164:167], v10, s[4:7], s30 offen offset:1024 sc1
    buffer_load_dwordx4 v[168:171], v10, s[4:7], s30 offen offset:2048 sc1
    buffer_load_dwordx4 v[172:175], v10, s[4:7], s30 offen offset:3072 sc1
    s_add_u32 s30, s30, 4096
    buffer_load_dwordx4 v[176:179], v10, s[4:7], s30 offen offset:0 sc1
    buffer_load_dwordx4 v[180:183], v10, s[4:7], s30 offen offset:1024 sc1
    buffer_load_dwordx4 v[184:187], v10, s[4:7], s30 offen offset:2048 sc1
    buffer_load_dwordx4 v[188:191], v10, s[4:7], s30 offen offset:3072 sc1
U_item:
    s_add_u32 s33, s28, 3
    s_lshr_b32 s17, s33, 3
    v_cmp_ge_u32 vcc, s17, v12
    s_lshl_b32 s18, s33, 2
    s_and_b32 s18, s18, 24
    s_lshr_b32 s17, vcc_lo, s18
    s_and_b32 s17, s17, 0xff
    s_cbranch_scc1 U_b
    s_lshl_b32 s30, s33, 17
    s_add_u32 s30, s30, 54525952
    s_waitcnt vmcnt(31)
    v_mfma_f32_16x16x32_bf16 v[16:19], a[0:3], v[64:67], 0
    v_mfma_f32_16x16x32_bf16 v[20:23], a[4:7], v[64:67], 0
    s_waitcnt vmcnt(30)
    v_mfma_f32_16x16x32_bf16 v[16:19], a[8:11], v[68:71], v[16:19]
    v_mfma_f32_16x16x32_bf16 v[20:23], a[12:15], v[68:71], v[20:23]
    buffer_load_dwordx4 v[64:67], v10, s[4:7], s30 offen offset:0 sc1
    s_waitcnt vmcnt(30)
    v_mfma_f32_16x16x32_bf16 v[16:19], a[16:19], v[72:75], v[16:19]
    v_mfma_f32_16x16x32_bf16 v[20:23], a[20:23], v[72:75], v[20:23]
    buffer_load_dwordx4 v[68:71], v10, s[4:7], s30 offen offset:1024 sc1
    s_waitcnt vmcnt(30)
    v_mfma_f32_16x16x32_bf16 v[16:19], a[24:27], v[76:79], v[16:19]
    v_mfma_f32_16x16x32_bf16 v[20:23], a[28:31], v[76:79], v[20:23]
    buffer_load_dwordx4 v[72:75], v10, s[4:7], s30 offen offset:2048 sc1
    s_waitcnt vmcnt(30)
    v_mfma_f32_16x16x32_bf16 v[16:19], a[32:35], v[80:83], v[16:19]
    v_mfma_f32_16x16x32_bf16 v[20:23], a[36:39], v[80:83], v[20:23]
    buffer_load_dwordx4 v[76:79], v10, s[4:7], s30 offen offset:3072 sc1
    s_waitcnt vmcnt(30)
    v_mfma_f32_16x16x32_bf16 v[16:19], a[40:43], v[84:87], v[16:19]
    v_mfma_f32_16x16x32_bf16 v[20:23], a[44:47], v[84:87], v[20:23]
    s_add_u32 s30, s30, 4096
    buffer_load_dwordx4 v[80:83], v10, s[4:7], s30 offen offset:0 sc1
    s_waitcnt vmcnt(30)
    v_mfma_f32_16x16x32_bf16 v[16:19], a[48:51], v[88:91], v[16:19]
    v_mfma_f32_16x16x32_bf16 v[20:23], a[52:55], v[88:91], v[20:23]
    buffer_load_dwordx4 v[84:87], v10, s[4:7], s30 offen offset:1024 sc1
    s_waitcnt vmcnt(30)
    v_mfma_f32_16x16x32_bf16 v[16:19], a[56:59], v[92:95], v[16:19]
    v_mfma_f32_16x16x32_bf16 v[20:23], a[60:63], v[92:95], v[20:23]
    buffer_load_dwordx4 v[88:91], v10, s[4:7], s30 offen offset:2048 sc1
    s_waitcnt vmcnt(30)
    v_mfma_f32_16x16x32_bf16 v[16:19], a[64:67], v[96:99], v[16:19]
    v_mfma_f32_16x16x32_bf16 v[20:23], a[68:71], v[96:99], v[20:23]
    buffer_load_dwordx4 v[92:95], v10, s[4:7], s30 offen offset:3072 sc1
    s_waitcnt vmcnt(30)
    v_mfma_f32_16x16x32_bf16 v[16:19], a[72:75], v[100:103], v[16:19]
    v_mfma_f32_16x16x32_bf16 v[20:23], a[76:79], v[100:103], v[20:23]
    s_add_u32 s30, s30, 4096
    buffer_load_dwordx4 v[96:99], v10, s[4:7], s30 offen offset:0 sc1
    s_waitcnt vmcnt(30)
    v_mfma_f32_16x16x32_bf16 v[16:19], a[80:83], v[104:107], v[16:19]
    v_mfma_f32_16x16x32_bf16 v[20:23], a[84:87], v[104:107], v[20:23]
    buffer_load_dwordx4 v[100:103], v10, s[4:7], s30 offen offset:1024 sc1
    s_waitcnt vmcnt(30)
    v_mfma_f32_16x16x32_bf16 v[16:19], a[88:91], v[108:111], v[16:19]
    v_mfma_f32_16x16x32_bf16 v[20:23], a[92:95], v[108:111], v[20:23]
    buffer_load_dwordx4 v[104:107], v10, s[4:7], s30 offen offset:2048 sc1
    s_waitcnt vmcnt(30)
    v_mfma_f32_16x16x32_bf16 v[16:19], a[96:99], v[112:115], v[16:19]
    v_mfma_f32_16x16x32_bf16 v[20:23], a[100:103], v[112:115], v[20:23]
    buffer_load_dwordx4 v[108:111], v10, s[4:7], s30 offen offset:3072 sc1
    s_waitcnt vmcnt(30)
    v_mfma_f32_16x16x32_bf16 v[16:19], a[104:107], v[116:119], v[16:19]
    v_mfma_f32_16x16x32_bf16 v[20:23], a[108:111], v[116:119], v[20:23]
    s_add_u32 s30, s30, 4096
    buffer_load_dwordx4 v[112:115], v10, s[4:7], s30 offen offset:0 sc1
    s_waitcnt vmcnt(30)
    v_mfma_f32_16x16x32_bf16 v[16:19], a[112:115], v[120:123], v[16:19]
    v_mfma_f32_16x16x32_bf16 v[20:23], a[116:119], v[120:123], v[20:23]
    buffer_load_dwordx4 v[116:119], v10, s[4:7], s30 offen offset:1024 sc1
    s_waitcnt vmcnt(30)
    v_mfma_f32_16x16x32_bf16 v[16:19], a[120:123], v[124:127], v[16:19]
    v_mfma_f32_16x16x32_bf16 v[20:23], a[124:127], v[124:127], v[20:23]
    buffer_load_dwordx4 v[120:123], v10, s[4:7], s30 offen offset:2048 sc1
    s_waitcnt vmcnt(30)
    v_mfma_f32_16x16x32_bf16 v[16:19], a[128:131], v[128:131], v[16:19]
    v_mfma_f32_16x16x32_bf16 v[20:23], a[132:135], v[128:131], v[20:23]
    buffer_load_dwordx4 v[124:127], v10, s[4:7], s30 offen offset:3072 sc1
    s_waitcnt vmcnt(30)
    v_mfma_f32_16x16x32_bf16 v[16:19], a[136:139], v[132:135], v[16:19]
    v_mfma_f32_16x16x32_bf16 v[20:23], a[140:143], v[132:135], v[20:23]
    s_add_u32 s30, s30, 4096
    buffer_load_dwordx4 v[128:131], v10, s[4:7], s30 offen offset:0 sc1
    s_waitcnt vmcnt(30)
    v_mfma_f32_16x16x32_bf16 v[16:19], a[144:147], v[136:139], v[16:19]
    v_mfma_f32_16x16x32_bf16 v[20:23], a[148:151], v[136:139], v[20:23]
    buffer_load_dwordx4 v[132:135], v10, s[4:7], s30 offen offset:1024 sc1
    s_waitcnt vmcnt(30)
    v_mfma_f32_16x16x32_bf16 v[16:19], a[152:155], v[140:143], v[16:19]
    v_mfma_f32_16x16x32_bf16 v[20:23], a[156:159], v[140:143], v[20:23]
    buffer_load_dwordx4 v[136:139], v10, s[4:7], s30 offen offset:2048 sc1
    s_waitcnt vmcnt(30)
    v_mfma_f32_16x16x32_bf16 v[16:19], a[160:163], v[144:147], v[16:19]
    v_mfma_f32_16x16x32_bf16 v[20:23], a[164:167], v[144:147], v[20:23]
    buffer_load_dwordx4 v[140:143], v10, s[4:7], s30 offen offset:3072 sc1
    s_waitcnt vmcnt(30)
    v_mfma_f32_16x16x32_bf16 v[16:19], a[168:171], v[148:151], v[16:19]
    v_mfma_f32_16x16x32_bf16 v[20:23], a[172:175], v[148:151], v[20:23]
    s_add_u32 s30, s30, 4096
    buffer_load_dwordx4 v[144:147], v10, s[4:7], s30 offen offset:0 sc1
    s_waitcnt vmcnt(30)
    v_mfma_f32_16x16x32_bf16 v[16:19], a[176:179], v[152:155], v[16:19]
    v_mfma_f32_16x16x32_bf16 v[20:23], a[180:183], v[152:155], v[20:23]
    buffer_load_dwordx4 v[148:151], v10, s[4:7], s30 offen offset:1024 sc1
    s_waitcnt vmcnt(30)
    v_mfma_f32_16x16x32_bf16 v[16:19], a[184:187], v[156:159], v[16:19]
    v_mfma_f32_16x16x32_bf16 v[20:23], a[188:191], v[156:159], v[20:23]
    buffer_load_dwordx4 v[152:155], v10, s[4:7], s30 offen offset:2048 sc1
    s_waitcnt vmcnt(30)
    v_mfma_f32_16x16x32_bf16 v[16:19], a[192:195], v[160:163], v[16:19]
    v_mfma_f32_16x16x32_bf16 v[20:23], a[196:199], v[160:163], v[20:23]
    buffer_load_dwordx4 v[156:159], v10, s[4:7], s30 offen offset:3072 sc1
    s_waitcnt vmcnt(30)
    v_mfma_f32_16x16x32_bf16 v[16:19], a[200:203], v[164:167], v[16:19]
    v_mfma_f32_16x16x32_bf16 v[20:23], a[204:207], v[164:167], v[20:23]
    s_add_u32 s30, s30, 4096
    buffer_load_dwordx4 v[160:163], v10, s[4:7], s30 offen offset:0 sc1
    s_waitcnt vmcnt(30)
    v_mfma_f32_16x16x32_bf16 v[16:19], a[208:211], v[168:171], v[16:19]
    v_mfma_f32_16x16x32_bf16 v[20:23], a[212:215], v[168:171], v[20:23]
    buffer_load_dwordx4 v[164:167], v10, s[4:7], s30 offen offset:1024 sc1
    s_waitcnt vmcnt(30)
    v_mfma_f32_16x16x32_bf16 v[16:19], a[216:219], v[172:175], v[16:19]
    v_mfma_f32_16x16x32_bf16 v[20:23], a[220:223], v[172:175], v[20:23]
    buffer_load_dwordx4 v[168:171], v10, s[4:7], s30 offen offset:2048 sc1
    s_waitcnt vmcnt(30)
    v_mfma_f32_16x16x32_bf16 v[16:19], a[224:227], v[176:179], v[16:19]
    v_mfma_f32_16x16x32_bf16 v[20:23], a[228:231], v[176:179], v[20:23]
    buffer_load_dwordx4 v[172:175], v10, s[4:7], s30 offen offset:3072 sc1
    s_waitcnt vmcnt(30)
    v_mfma_f32_16x16x32_bf16 v[16:19], a[232:235], v[180:183], v[16:19]
    v_mfma_f32_16x16x32_bf16 v[20:23], a[236:239], v[180:183], v[20:23]
    s_add_u32 s30, s30, 4096
    buffer_load_dwordx4 v[176:179], v10, s[4:7], s30 offen offset:0 sc1
    s_waitcnt vmcnt(30)
    v_mfma_f32_16x16x32_bf16 v[16:19], a[240:243], v[184:187], v[16:19]
    v_mfma_f32_16x16x32_bf16 v[20:23], a[244:247], v[184:187], v[20:23]
    buffer_load_dwordx4 v[180:183], v10, s[4:7], s30 offen offset:1024 sc1
    s_waitcnt vmcnt(30)
    v_mfma_f32_16x16x32_bf16 v[16:19], a[248:251], v[188:191], v[16:19]
    v_mfma_f32_16x16x32_bf16 v[20:23], a[252:255], v[188:191], v[20:23]
    buffer_load_dwordx4 v[184:187], v10, s[4:7], s30 offen offset:2048 sc1
    s_nop 7
    buffer_load_dwordx4 v[188:191], v10, s[4:7], s30 offen offset:3072 sc1
    s_lshl_b32 s31, s28, 16
    v_add_u32 v5, s32, v14
    v_add_u32 v6, s32, v15
    s_xor_b32 s32, s32, 8192
    s_mov_b32 s28, s33
    ds_write_b128 v5, v[16:19]
    ds_write_b128 v5, v[20:23] offset:1024
    s_waitcnt lgkmcnt(0)
    s_barrier
    s_cmp_lg_u32 s16, 0
    s_cbranch_scc1 Uf_1
    ds_read_b128 v[24:27], v6 offset:2048
    ds_read_b128 v[28:31], v6 offset:3072
    ds_read_b128 v[32:35], v6 offset:4096
    ds_read_b128 v[36:39], v6 offset:5120
    ds_read_b128 v[40:43], v6 offset:6144
    ds_read_b128 v[44:47], v6 offset:7168
    s_waitcnt lgkmcnt(4)
    v_add_f32 v24, v16, v24
    v_add_f32 v25, v17, v25
    v_add_f32 v26, v18, v26
    v_add_f32 v27, v19, v27
    v_add_f32 v28, v20, v28
    v_add_f32 v29, v21, v29
    v_add_f32 v30, v22, v30
    v_add_f32 v31, v23, v31
    s_waitcnt lgkmcnt(0)
    v_add_f32 v32, v32, v40
    v_add_f32 v33, v33, v41
    v_add_f32 v34, v34, v42
    v_add_f32 v35, v35, v43
    v_add_f32 v36, v36, v44
    v_add_f32 v37, v37, v45
    v_add_f32 v38, v38, v46
    v_add_f32 v39, v39, v47
    v_add_f32 v24, v24, v32
    v_add_f32 v25, v25, v33
    v_add_f32 v26, v26, v34
    v_add_f32 v27, v27, v35
    v_add_f32 v28, v28, v36
    v_add_f32 v29, v29, v37
    v_add_f32 v30, v30, v38
    v_add_f32 v31, v31, v39
    v_cvt_pk_bf16_f32 v48, v24, v25
    v_cvt_pk_bf16_f32 v49, v26, v27
    v_cvt_pk_bf16_f32 v50, v28, v29
    v_cvt_pk_bf16_f32 v51, v30, v31
    buffer_store_dwordx4 v[48:51], v13, s[12:15], s31 offen
Uf_1:
    s_cmp_lt_u32 s28, 128
    s_cbranch_scc1 U_item
    s_branch W_fin
U_b:
    s_waitcnt vmcnt(31)
    v_mfma_f32_16x16x32_bf16 v[16:19], a[0:3], v[64:67], 0
    v_mfma_f32_16x16x32_bf16 v[20:23], a[4:7], v[64:67], 0
    s_waitcnt vmcnt(30)
    v_mfma_f32_16x16x32_bf16 v[16:19], a[8:11], v[68:71], v[16:19]
    v_mfma_f32_16x16x32_bf16 v[20:23], a[12:15], v[68:71], v[20:23]
    s_waitcnt vmcnt(29)
    v_mfma_f32_16x16x32_bf16 v[16:19], a[16:19], v[72:75], v[16:19]
    v_mfma_f32_16x16x32_bf16 v[20:23], a[20:23], v[72:75], v[20:23]
    s_waitcnt vmcnt(28)
    v_mfma_f32_16x16x32_bf16 v[16:19], a[24:27], v[76:79], v[16:19]
    v_mfma_f32_16x16x32_bf16 v[20:23], a[28:31], v[76:79], v[20:23]
    s_waitcnt vmcnt(27)
    v_mfma_f32_16x16x32_bf16 v[16:19], a[32:35], v[80:83], v[16:19]
    v_mfma_f32_16x16x32_bf16 v[20:23], a[36:39], v[80:83], v[20:23]
    s_waitcnt vmcnt(26)
    v_mfma_f32_16x16x32_bf16 v[16:19], a[40:43], v[84:87], v[16:19]
    v_mfma_f32_16x16x32_bf16 v[20:23], a[44:47], v[84:87], v[20:23]
    s_waitcnt vmcnt(25)
    v_mfma_f32_16x16x32_bf16 v[16:19], a[48:51], v[88:91], v[16:19]
    v_mfma_f32_16x16x32_bf16 v[20:23], a[52:55], v[88:91], v[20:23]
    s_waitcnt vmcnt(24)
    v_mfma_f32_16x16x32_bf16 v[16:19], a[56:59], v[92:95], v[16:19]
    v_mfma_f32_16x16x32_bf16 v[20:23], a[60:63], v[92:95], v[20:23]
    s_waitcnt vmcnt(23)
    v_mfma_f32_16x16x32_bf16 v[16:19], a[64:67], v[96:99], v[16:19]
    v_mfma_f32_16x16x32_bf16 v[20:23], a[68:71], v[96:99], v[20:23]
    s_waitcnt vmcnt(22)
    v_mfma_f32_16x16x32_bf16 v[16:19], a[72:75], v[100:103], v[16:19]
    v_mfma_f32_16x16x32_bf16 v[20:23], a[76:79], v[100:103], v[20:23]
    s_waitcnt vmcnt(21)
    v_mfma_f32_16x16x32_bf16 v[16:19], a[80:83], v[104:107], v[16:19]
    v_mfma_f32_16x16x32_bf16 v[20:23], a[84:87], v[104:107], v[20:23]
    s_waitcnt vmcnt(20)
    v_mfma_f32_16x16x32_bf16 v[16:19], a[88:91], v[108:111], v[16:19]
    v_mfma_f32_16x16x32_bf16 v[20:23], a[92:95], v[108:111], v[20:23]
    s_waitcnt vmcnt(19)
    v_mfma_f32_16x16x32_bf16 v[16:19], a[96:99], v[112:115], v[16:19]
    v_mfma_f32_16x16x32_bf16 v[20:23], a[100:103], v[112:115], v[20:23]
    s_waitcnt vmcnt(18)
    v_mfma_f32_16x16x32_bf16 v[16:19], a[104:107], v[116:119], v[16:19]
    v_mfma_f32_16x16x32_bf16 v[20:23], a[108:111], v[116:119], v[20:23]
    s_waitcnt vmcnt(17)
    v_mfma_f32_16x16x32_bf16 v[16:19], a[112:115], v[120:123], v[16:19]
    v_mfma_f32_16x16x32_bf16 v[20:23], a[116:119], v[120:123], v[20:23]
    s_waitcnt vmcnt(16)
    v_mfma_f32_16x16x32_bf16 v[16:19], a[120:123], v[124:127], v[16:19]
    v_mfma_f32_16x16x32_bf16 v[20:23], a[124:127], v[124:127], v[20:23]
    s_waitcnt vmcnt(15)
    v_mfma_f32_16x16x32_bf16 v[16:19], a[128:131], v[128:131], v[16:19]
    v_mfma_f32_16x16x32_bf16 v[20:23], a[132:135], v[128:131], v[20:23]
    s_waitcnt vmcnt(14)
    v_mfma_f32_16x16x32_bf16 v[16:19], a[136:139], v[132:135], v[16:19]
    v_mfma_f32_16x16x32_bf16 v[20:23], a[140:143], v[132:135], v[20:23]
    s_waitcnt vmcnt(13)
    v_mfma_f32_16x16x32_bf16 v[16:19], a[144:147], v[136:139], v[16:19]
    v_mfma_f32_16x16x32_bf16 v[20:23], a[148:151], v[136:139], v[20:23]
    s_waitcnt vmcnt(12)
    v_mfma_f32_16x16x32_bf16 v[16:19], a[152:155], v[140:143], v[16:19]
    v_mfma_f32_16x16x32_bf16 v[20:23], a[156:159], v[140:143], v[20:23]
    s_waitcnt vmcnt(11)
    v_mfma_f32_16x16x32_bf16 v[16:19], a[160:163], v[144:147], v[16:19]
    v_mfma_f32_16x16x32_bf16 v[20:23], a[164:167], v[144:147], v[20:23]
    s_waitcnt vmcnt(10)
    v_mfma_f32_16x16x32_bf16 v[16:19], a[168:171], v[148:151], v[16:19]
    v_mfma_f32_16x16x32_bf16 v[20:23], a[172:175], v[148:151], v[20:23]
    s_waitcnt vmcnt(9)
    v_mfma_f32_16x16x32_bf16 v[16:19], a[176:179], v[152:155], v[16:19]
    v_mfma_f32_16x16x32_bf16 v[20:23], a[180:183], v[152:155], v[20:23]
    s_waitcnt vmcnt(8)
    v_mfma_f32_16x16x32_bf16 v[16:19], a[184:187], v[156:159], v[16:19]
    v_mfma_f32_16x16x32_bf16 v[20:23], a[188:191], v[156:159], v[20:23]
    s_waitcnt vmcnt(7)
    v_mfma_f32_16x16x32_bf16 v[16:19], a[192:195], v[160:163], v[16:19]
    v_mfma_f32_16x16x32_bf16 v[20:23], a[196:199], v[160:163], v[20:23]
    s_waitcnt vmcnt(6)
    v_mfma_f32_16x16x32_bf16 v[16:19], a[200:203], v[164:167], v[16:19]
    v_mfma_f32_16x16x32_bf16 v[20:23], a[204:207], v[164:167], v[20:23]
    s_waitcnt vmcnt(5)
    v_mfma_f32_16x16x32_bf16 v[16:19], a[208:211], v[168:171], v[16:19]
    v_mfma_f32_16x16x32_bf16 v[20:23], a[212:215], v[168:171], v[20:23]
    s_waitcnt vmcnt(4)
    v_mfma_f32_16x16x32_bf16 v[16:19], a[216:219], v[172:175], v[16:19]
    v_mfma_f32_16x16x32_bf16 v[20:23], a[220:223], v[172:175], v[20:23]
    s_waitcnt vmcnt(3)
    v_mfma_f32_16x16x32_bf16 v[16:19], a[224:227], v[176:179], v[16:19]
    v_mfma_f32_16x16x32_bf16 v[20:23], a[228:231], v[176:179], v[20:23]
    s_waitcnt vmcnt(2)
    v_mfma_f32_16x16x32_bf16 v[16:19], a[232:235], v[180:183], v[16:19]
    v_mfma_f32_16x16x32_bf16 v[20:23], a[236:239], v[180:183], v[20:23]
    s_waitcnt vmcnt(1)
    v_mfma_f32_16x16x32_bf16 v[16:19], a[240:243], v[184:187], v[16:19]
    v_mfma_f32_16x16x32_bf16 v[20:23], a[244:247], v[184:187], v[20:23]
    s_waitcnt vmcnt(0)
    v_mfma_f32_16x16x32_bf16 v[16:19], a[248:251], v[188:191], v[16:19]
    v_mfma_f32_16x16x32_bf16 v[20:23], a[252:255], v[188:191], v[20:23]
    s_lshl_b32 s31, s28, 16
    v_add_u32 v5, s32, v14
    v_add_u32 v6, s32, v15
    s_xor_b32 s32, s32, 8192
    s_mov_b32 s28, s33
    s_nop 1
    ds_write_b128 v5, v[16:19]
    ds_write_b128 v5, v[20:23] offset:1024
    s_waitcnt lgkmcnt(0)
    s_barrier
    s_cmp_lg_u32 s16, 0
    s_cbranch_scc1 Uf_2
    ds_read_b128 v[24:27], v6 offset:2048
    ds_read_b128 v[28:31], v6 offset:3072
    ds_read_b128 v[32:35], v6 offset:4096
    ds_read_b128 v[36:39], v6 offset:5120
    ds_read_b128 v[40:43], v6 offset:6144
    ds_read_b128 v[44:47], v6 offset:7168
    s_waitcnt lgkmcnt(4)
    v_add_f32 v24, v16, v24
    v_add_f32 v25, v17, v25
    v_add_f32 v26, v18, v26
    v_add_f32 v27, v19, v27
    v_add_f32 v28, v20, v28
    v_add_f32 v29, v21, v29
    v_add_f32 v30, v22, v30
    v_add_f32 v31, v23, v31
    s_waitcnt lgkmcnt(0)
    v_add_f32 v32, v32, v40
    v_add_f32 v33, v33, v41
    v_add_f32 v34, v34, v42
    v_add_f32 v35, v35, v43
    v_add_f32 v36, v36, v44
    v_add_f32 v37, v37, v45
    v_add_f32 v38, v38, v46
    v_add_f32 v39, v39, v47
    v_add_f32 v24, v24, v32
    v_add_f32 v25, v25, v33
    v_add_f32 v26, v26, v34
    v_add_f32 v27, v27, v35
    v_add_f32 v28, v28, v36
    v_add_f32 v29, v29, v37
    v_add_f32 v30, v30, v38
    v_add_f32 v31, v31, v39
    v_cvt_pk_bf16_f32 v48, v24, v25
    v_cvt_pk_bf16_f32 v49, v26, v27
    v_cvt_pk_bf16_f32 v50, v28, v29
    v_cvt_pk_bf16_f32 v51, v30, v31
    buffer_store_dwordx4 v[48:51], v13, s[12:15], s31 offen
Uf_2:
    s_cmp_lt_u32 s28, 128
    s_cbranch_scc1 U_wait
    s_branch W_fin
W_F:
    v_and_b32 v10, 19, v1
    v_bfe_u32 v5, v1, 2, 1
    v_bfe_u32 v6, v1, 3, 1
    v_lshl_add_u32 v10, v5, 3, v10
    v_lshl_add_u32 v10, v6, 2, v10
    s_load_dwordx2 s[8:9], s[0:1], 8
    s_load_dwordx2 s[12:13], s[0:1], 16
    s_mov_b32 s10, 2101248
    s_mov_b32 s11, 0x20000
    s_mov_b32 s14, 2101248
    s_mov_b32 s15, 0x20000
    v_lshrrev_b32 v11, 5, v1
    v_lshl_add_u32 v12, v11, 9, v10
    v_mul_u32_u24 v12, 1026, v12
    v_and_b32 v13, 1, v1
    v_lshlrev_b32 v13, 4, v13
    v_lshlrev_b32 v14, 4, v1
    s_lshr_b32 s17, s16, 1
    s_and_b32 s18, s16, 1
    s_lshl_b32 s17, s17, 5
    s_lshl_b32 s18, s18, 10
    s_add_u32 s17, s17, s18
    s_mul_i32 s20, s17, 1026
    s_lshl_b32 s17, s91, 5
    s_add_u32 s20, s20, s17
    s_lshl_b32 s21, s91, 17
    s_lshl_b32 s17, s16, 11
    s_add_u32 s21, s21, s17
    s_add_u32 s21, s21, 117440512
    v_and_b32 v7, -4, v12
    s_mov_b32 s28, 0x05040100
    s_mov_b32 s29, 0x07060302
    s_waitcnt lgkmcnt(0)
    buffer_load_dwordx4 v[20:23], v7, s[8:11], s20 offen
    buffer_load_dwordx4 v[24:27], v7, s[8:11], s20 offen offset:16
    buffer_load_dword v28, v7, s[8:11], s20 offen offset:32
    buffer_load_dwordx4 v[30:33], v7, s[12:15], s20 offen
    buffer_load_dwordx4 v[34:37], v7, s[12:15], s20 offen offset:16
    buffer_load_dword v38, v7, s[12:15], s20 offen offset:32
    s_add_u32 s20, s20, 65664
    buffer_load_dwordx4 v[40:43], v7, s[8:11], s20 offen
    buffer_load_dwordx4 v[44:47], v7, s[8:11], s20 offen offset:16
    buffer_load_dword v48, v7, s[8:11], s20 offen offset:32
    buffer_load_dwordx4 v[50:53], v7, s[12:15], s20 offen
    buffer_load_dwordx4 v[54:57], v7, s[12:15], s20 offen offset:16
    buffer_load_dword v58, v7, s[12:15], s20 offen offset:32
    s_add_u32 s20, s20, 65664
    buffer_load_dwordx4 v[60:63], v7, s[8:11], s20 offen
    buffer_load_dwordx4 v[64:67], v7, s[8:11], s20 offen offset:16
    buffer_load_dword v68, v7, s[8:11], s20 offen offset:32
    buffer_load_dwordx4 v[70:73], v7, s[12:15], s20 offen
    buffer_load_dwordx4 v[74:77], v7, s[12:15], s20 offen offset:16
    buffer_load_dword v78, v7, s[12:15], s20 offen offset:32
    s_add_u32 s20, s20, 65664
    buffer_load_dwordx4 v[80:83], v7, s[8:11], s20 offen
    buffer_load_dwordx4 v[84:87], v7, s[8:11], s20 offen offset:16
    buffer_load_dword v88, v7, s[8:11], s20 offen offset:32
    buffer_load_dwordx4 v[90:93], v7, s[12:15], s20 offen
    buffer_load_dwordx4 v[94:97], v7, s[12:15], s20 offen offset:16
    buffer_load_dword v98, v7, s[12:15], s20 offen offset:32
    s_add_u32 s20, s20, 65664
    s_waitcnt vmcnt(0)
    v_alignbit_b32 v20, v21, v20, v13
    v_alignbit_b32 v21, v22, v21, v13
    v_alignbit_b32 v22, v23, v22, v13
    v_alignbit_b32 v23, v24, v23, v13
    v_alignbit_b32 v24, v25, v24, v13
    v_alignbit_b32 v25, v26, v25, v13
    v_alignbit_b32 v26, v27, v26, v13
    v_alignbit_b32 v27, v28, v27, v13
    v_alignbit_b32 v30, v31, v30, v13
    v_alignbit_b32 v31, v32, v31, v13
    v_alignbit_b32 v32, v33, v32, v13
    v_alignbit_b32 v33, v34, v33, v13
    v_alignbit_b32 v34, v35, v34, v13
    v_alignbit_b32 v35, v36, v35, v13
    v_alignbit_b32 v36, v37, v36, v13
    v_alignbit_b32 v37, v38, v37, v13
    v_perm_b32 v100, v30, v20, s28
    v_perm_b32 v104, v30, v20, s29
    v_perm_b32 v108, v31, v21, s28
    v_perm_b32 v112, v31, v21, s29
    v_perm_b32 v116, v32, v22, s28
    v_perm_b32 v120, v32, v22, s29
    v_perm_b32 v124, v33, v23, s28
    v_perm_b32 v128, v33, v23, s29
    v_perm_b32 v132, v34, v24, s28
    v_perm_b32 v136, v34, v24, s29
    v_perm_b32 v140, v35, v25, s28
    v_perm_b32 v144, v35, v25, s29
    v_perm_b32 v148, v36, v26, s28
    v_perm_b32 v152, v36, v26, s29
    v_perm_b32 v156, v37, v27, s28
    v_perm_b32 v160, v37, v27, s29
    v_alignbit_b32 v40, v41, v40, v13
    v_alignbit_b32 v41, v42, v41, v13
    v_alignbit_b32 v42, v43, v42, v13
    v_alignbit_b32 v43, v44, v43, v13
    v_alignbit_b32 v44, v45, v44, v13
    v_alignbit_b32 v45, v46, v45, v13
    v_alignbit_b32 v46, v47, v46, v13
    v_alignbit_b32 v47, v48, v47, v13
    v_alignbit_b32 v50, v51, v50, v13
    v_alignbit_b32 v51, v52, v51, v13
    v_alignbit_b32 v52, v53, v52, v13
    v_alignbit_b32 v53, v54, v53, v13
    v_alignbit_b32 v54, v55, v54, v13
    v_alignbit_b32 v55, v56, v55, v13
    v_alignbit_b32 v56, v57, v56, v13
    v_alignbit_b32 v57, v58, v57, v13
    v_perm_b32 v101, v50, v40, s28
    v_perm_b32 v105, v50, v40, s29
    v_perm_b32 v109, v51, v41, s28
    v_perm_b32 v113, v51, v41, s29
    v_perm_b32 v117, v52, v42, s28
    v_perm_b32 v121, v52, v42, s29
    v_perm_b32 v125, v53, v43, s28
    v_perm_b32 v129, v53, v43, s29
    v_perm_b32 v133, v54, v44, s28
    v_perm_b32 v137, v54, v44, s29
    v_perm_b32 v141, v55, v45, s28
    v_perm_b32 v145, v55, v45, s29
    v_perm_b32 v149, v56, v46, s28
    v_perm_b32 v153, v56, v46, s29
    v_perm_b32 v157, v57, v47, s28
    v_perm_b32 v161, v57, v47, s29
    v_alignbit_b32 v60, v61, v60, v13
    v_alignbit_b32 v61, v62, v61, v13
    v_alignbit_b32 v62, v63, v62, v13
    v_alignbit_b32 v63, v64, v63, v13
    v_alignbit_b32 v64, v65, v64, v13
    v_alignbit_b32 v65, v66, v65, v13
    v_alignbit_b32 v66, v67, v66, v13
    v_alignbit_b32 v67, v68, v67, v13
    v_alignbit_b32 v70, v71, v70, v13
    v_alignbit_b32 v71, v72, v71, v13
    v_alignbit_b32 v72, v73, v72, v13
    v_alignbit_b32 v73, v74, v73, v13
    v_alignbit_b32 v74, v75, v74, v13
    v_alignbit_b32 v75, v76, v75, v13
    v_alignbit_b32 v76, v77, v76, v13
    v_alignbit_b32 v77, v78, v77, v13
    v_perm_b32 v102, v70, v60, s28
    v_perm_b32 v106, v70, v60, s29
    v_perm_b32 v110, v71, v61, s28
    v_perm_b32 v114, v71, v61, s29
    v_perm_b32 v118, v72, v62, s28
    v_perm_b32 v122, v72, v62, s29
    v_perm_b32 v126, v73, v63, s28
    v_perm_b32 v130, v73, v63, s29
    v_perm_b32 v134, v74, v64, s28
    v_perm_b32 v138, v74, v64, s29
    v_perm_b32 v142, v75, v65, s28
    v_perm_b32 v146, v75, v65, s29
    v_perm_b32 v150, v76, v66, s28
    v_perm_b32 v154, v76, v66, s29
    v_perm_b32 v158, v77, v67, s28
    v_perm_b32 v162, v77, v67, s29
    v_alignbit_b32 v80, v81, v80, v13
    v_alignbit_b32 v81, v82, v81, v13
    v_alignbit_b32 v82, v83, v82, v13
    v_alignbit_b32 v83, v84, v83, v13
    v_alignbit_b32 v84, v85, v84, v13
    v_alignbit_b32 v85, v86, v85, v13
    v_alignbit_b32 v86, v87, v86, v13
    v_alignbit_b32 v87, v88, v87, v13
    v_alignbit_b32 v90, v91, v90, v13
    v_alignbit_b32 v91, v92, v91, v13
    v_alignbit_b32 v92, v93, v92, v13
    v_alignbit_b32 v93, v94, v93, v13
    v_alignbit_b32 v94, v95, v94, v13
    v_alignbit_b32 v95, v96, v95, v13
    v_alignbit_b32 v96, v97, v96, v13
    v_alignbit_b32 v97, v98, v97, v13
    v_perm_b32 v103, v90, v80, s28
    v_perm_b32 v107, v90, v80, s29
    v_perm_b32 v111, v91, v81, s28
    v_perm_b32 v115, v91, v81, s29
    v_perm_b32 v119, v92, v82, s28
    v_perm_b32 v123, v92, v82, s29
    v_perm_b32 v127, v93, v83, s28
    v_perm_b32 v131, v93, v83, s29
    v_perm_b32 v135, v94, v84, s28
    v_perm_b32 v139, v94, v84, s29
    v_perm_b32 v143, v95, v85, s28
    v_perm_b32 v147, v95, v85, s29
    v_perm_b32 v151, v96, v86, s28
    v_perm_b32 v155, v96, v86, s29
    v_perm_b32 v159, v97, v87, s28
    v_perm_b32 v163, v97, v87, s29
    s_add_u32 s17, s21, 0
    buffer_store_dwordx4 v[100:103], v14, s[4:7], s17 offen
    s_add_u32 s17, s21, 8192
    buffer_store_dwordx4 v[104:107], v14, s[4:7], s17 offen
    s_add_u32 s17, s21, 16384
    buffer_store_dwordx4 v[108:111], v14, s[4:7], s17 offen
    s_add_u32 s17, s21, 24576
    buffer_store_dwordx4 v[112:115], v14, s[4:7], s17 offen
    s_add_u32 s17, s21, 32768
    buffer_store_dwordx4 v[116:119], v14, s[4:7], s17 offen
    s_add_u32 s17, s21, 40960
    buffer_store_dwordx4 v[120:123], v14, s[4:7], s17 offen
    s_add_u32 s17, s21, 49152
    buffer_store_dwordx4 v[124:127], v14, s[4:7], s17 offen
    s_add_u32 s17, s21, 57344
    buffer_store_dwordx4 v[128:131], v14, s[4:7], s17 offen
    s_add_u32 s17, s21, 65536
    buffer_store_dwordx4 v[132:135], v14, s[4:7], s17 offen
    s_add_u32 s17, s21, 73728
    buffer_store_dwordx4 v[136:139], v14, s[4:7], s17 offen
    s_add_u32 s17, s21, 81920
    buffer_store_dwordx4 v[140:143], v14, s[4:7], s17 offen
    s_add_u32 s17, s21, 90112
    buffer_store_dwordx4 v[144:147], v14, s[4:7], s17 offen
    s_add_u32 s17, s21, 98304
    buffer_store_dwordx4 v[148:151], v14, s[4:7], s17 offen
    s_add_u32 s17, s21, 106496
    buffer_store_dwordx4 v[152:155], v14, s[4:7], s17 offen
    s_add_u32 s17, s21, 114688
    buffer_store_dwordx4 v[156:159], v14, s[4:7], s17 offen
    s_add_u32 s17, s21, 122880
    buffer_store_dwordx4 v[160:163], v14, s[4:7], s17 offen
    buffer_load_dwordx4 v[20:23], v7, s[8:11], s20 offen
    buffer_load_dwordx4 v[24:27], v7, s[8:11], s20 offen offset:16
    buffer_load_dword v28, v7, s[8:11], s20 offen offset:32
    buffer_load_dwordx4 v[30:33], v7, s[12:15], s20 offen
    buffer_load_dwordx4 v[34:37], v7, s[12:15], s20 offen offset:16
    buffer_load_dword v38, v7, s[12:15], s20 offen offset:32
    s_add_u32 s20, s20, 65664
    buffer_load_dwordx4 v[40:43], v7, s[8:11], s20 offen
    buffer_load_dwordx4 v[44:47], v7, s[8:11], s20 offen offset:16
    buffer_load_dword v48, v7, s[8:11], s20 offen offset:32
    buffer_load_dwordx4 v[50:53], v7, s[12:15], s20 offen
    buffer_load_dwordx4 v[54:57], v7, s[12:15], s20 offen offset:16
    buffer_load_dword v58, v7, s[12:15], s20 offen offset:32
    s_add_u32 s20, s20, 65664
    buffer_load_dwordx4 v[60:63], v7, s[8:11], s20 offen
    buffer_load_dwordx4 v[64:67], v7, s[8:11], s20 offen offset:16
    buffer_load_dword v68, v7, s[8:11], s20 offen offset:32
    buffer_load_dwordx4 v[70:73], v7, s[12:15], s20 offen
    buffer_load_dwordx4 v[74:77], v7, s[12:15], s20 offen offset:16
    buffer_load_dword v78, v7, s[12:15], s20 offen offset:32
    s_add_u32 s20, s20, 65664
    buffer_load_dwordx4 v[80:83], v7, s[8:11], s20 offen
    buffer_load_dwordx4 v[84:87], v7, s[8:11], s20 offen offset:16
    buffer_load_dword v88, v7, s[8:11], s20 offen offset:32
    buffer_load_dwordx4 v[90:93], v7, s[12:15], s20 offen
    buffer_load_dwordx4 v[94:97], v7, s[12:15], s20 offen offset:16
    buffer_load_dword v98, v7, s[12:15], s20 offen offset:32
    s_add_u32 s20, s20, 65664
    s_waitcnt vmcnt(0)
    v_alignbit_b32 v20, v21, v20, v13
    v_alignbit_b32 v21, v22, v21, v13
    v_alignbit_b32 v22, v23, v22, v13
    v_alignbit_b32 v23, v24, v23, v13
    v_alignbit_b32 v24, v25, v24, v13
    v_alignbit_b32 v25, v26, v25, v13
    v_alignbit_b32 v26, v27, v26, v13
    v_alignbit_b32 v27, v28, v27, v13
    v_alignbit_b32 v30, v31, v30, v13
    v_alignbit_b32 v31, v32, v31, v13
    v_alignbit_b32 v32, v33, v32, v13
    v_alignbit_b32 v33, v34, v33, v13
    v_alignbit_b32 v34, v35, v34, v13
    v_alignbit_b32 v35, v36, v35, v13
    v_alignbit_b32 v36, v37, v36, v13
    v_alignbit_b32 v37, v38, v37, v13
    v_perm_b32 v100, v30, v20, s28
    v_perm_b32 v104, v30, v20, s29
    v_perm_b32 v108, v31, v21, s28
    v_perm_b32 v112, v31, v21, s29
    v_perm_b32 v116, v32, v22, s28
    v_perm_b32 v120, v32, v22, s29
    v_perm_b32 v124, v33, v23, s28
    v_perm_b32 v128, v33, v23, s29
    v_perm_b32 v132, v34, v24, s28
    v_perm_b32 v136, v34, v24, s29
    v_perm_b32 v140, v35, v25, s28
    v_perm_b32 v144, v35, v25, s29
    v_perm_b32 v148, v36, v26, s28
    v_perm_b32 v152, v36, v26, s29
    v_perm_b32 v156, v37, v27, s28
    v_perm_b32 v160, v37, v27, s29
    v_alignbit_b32 v40, v41, v40, v13
    v_alignbit_b32 v41, v42, v41, v13
    v_alignbit_b32 v42, v43, v42, v13
    v_alignbit_b32 v43, v44, v43, v13
    v_alignbit_b32 v44, v45, v44, v13
    v_alignbit_b32 v45, v46, v45, v13
    v_alignbit_b32 v46, v47, v46, v13
    v_alignbit_b32 v47, v48, v47, v13
    v_alignbit_b32 v50, v51, v50, v13
    v_alignbit_b32 v51, v52, v51, v13
    v_alignbit_b32 v52, v53, v52, v13
    v_alignbit_b32 v53, v54, v53, v13
    v_alignbit_b32 v54, v55, v54, v13
    v_alignbit_b32 v55, v56, v55, v13
    v_alignbit_b32 v56, v57, v56, v13
    v_alignbit_b32 v57, v58, v57, v13
    v_perm_b32 v101, v50, v40, s28
    v_perm_b32 v105, v50, v40, s29
    v_perm_b32 v109, v51, v41, s28
    v_perm_b32 v113, v51, v41, s29
    v_perm_b32 v117, v52, v42, s28
    v_perm_b32 v121, v52, v42, s29
    v_perm_b32 v125, v53, v43, s28
    v_perm_b32 v129, v53, v43, s29
    v_perm_b32 v133, v54, v44, s28
    v_perm_b32 v137, v54, v44, s29
    v_perm_b32 v141, v55, v45, s28
    v_perm_b32 v145, v55, v45, s29
    v_perm_b32 v149, v56, v46, s28
    v_perm_b32 v153, v56, v46, s29
    v_perm_b32 v157, v57, v47, s28
    v_perm_b32 v161, v57, v47, s29
    v_alignbit_b32 v60, v61, v60, v13
    v_alignbit_b32 v61, v62, v61, v13
    v_alignbit_b32 v62, v63, v62, v13
    v_alignbit_b32 v63, v64, v63, v13
    v_alignbit_b32 v64, v65, v64, v13
    v_alignbit_b32 v65, v66, v65, v13
    v_alignbit_b32 v66, v67, v66, v13
    v_alignbit_b32 v67, v68, v67, v13
    v_alignbit_b32 v70, v71, v70, v13
    v_alignbit_b32 v71, v72, v71, v13
    v_alignbit_b32 v72, v73, v72, v13
    v_alignbit_b32 v73, v74, v73, v13
    v_alignbit_b32 v74, v75, v74, v13
    v_alignbit_b32 v75, v76, v75, v13
    v_alignbit_b32 v76, v77, v76, v13
    v_alignbit_b32 v77, v78, v77, v13
    v_perm_b32 v102, v70, v60, s28
    v_perm_b32 v106, v70, v60, s29
    v_perm_b32 v110, v71, v61, s28
    v_perm_b32 v114, v71, v61, s29
    v_perm_b32 v118, v72, v62, s28
    v_perm_b32 v122, v72, v62, s29
    v_perm_b32 v126, v73, v63, s28
    v_perm_b32 v130, v73, v63, s29
    v_perm_b32 v134, v74, v64, s28
    v_perm_b32 v138, v74, v64, s29
    v_perm_b32 v142, v75, v65, s28
    v_perm_b32 v146, v75, v65, s29
    v_perm_b32 v150, v76, v66, s28
    v_perm_b32 v154, v76, v66, s29
    v_perm_b32 v158, v77, v67, s28
    v_perm_b32 v162, v77, v67, s29
    v_alignbit_b32 v80, v81, v80, v13
    v_alignbit_b32 v81, v82, v81, v13
    v_alignbit_b32 v82, v83, v82, v13
    v_alignbit_b32 v83, v84, v83, v13
    v_alignbit_b32 v84, v85, v84, v13
    v_alignbit_b32 v85, v86, v85, v13
    v_alignbit_b32 v86, v87, v86, v13
    v_alignbit_b32 v87, v88, v87, v13
    v_alignbit_b32 v90, v91, v90, v13
    v_alignbit_b32 v91, v92, v91, v13
    v_alignbit_b32 v92, v93, v92, v13
    v_alignbit_b32 v93, v94, v93, v13
    v_alignbit_b32 v94, v95, v94, v13
    v_alignbit_b32 v95, v96, v95, v13
    v_alignbit_b32 v96, v97, v96, v13
    v_alignbit_b32 v97, v98, v97, v13
    v_perm_b32 v103, v90, v80, s28
    v_perm_b32 v107, v90, v80, s29
    v_perm_b32 v111, v91, v81, s28
    v_perm_b32 v115, v91, v81, s29
    v_perm_b32 v119, v92, v82, s28
    v_perm_b32 v123, v92, v82, s29
    v_perm_b32 v127, v93, v83, s28
    v_perm_b32 v131, v93, v83, s29
    v_perm_b32 v135, v94, v84, s28
    v_perm_b32 v139, v94, v84, s29
    v_perm_b32 v143, v95, v85, s28
    v_perm_b32 v147, v95, v85, s29
    v_perm_b32 v151, v96, v86, s28
    v_perm_b32 v155, v96, v86, s29
    v_perm_b32 v159, v97, v87, s28
    v_perm_b32 v163, v97, v87, s29
    s_add_u32 s17, s21, 1024
    buffer_store_dwordx4 v[100:103], v14, s[4:7], s17 offen
    s_add_u32 s17, s21, 9216
    buffer_store_dwordx4 v[104:107], v14, s[4:7], s17 offen
    s_add_u32 s17, s21, 17408
    buffer_store_dwordx4 v[108:111], v14, s[4:7], s17 offen
    s_add_u32 s17, s21, 25600
    buffer_store_dwordx4 v[112:115], v14, s[4:7], s17 offen
    s_add_u32 s17, s21, 33792
    buffer_store_dwordx4 v[116:119], v14, s[4:7], s17 offen
    s_add_u32 s17, s21, 41984
    buffer_store_dwordx4 v[120:123], v14, s[4:7], s17 offen
    s_add_u32 s17, s21, 50176
    buffer_store_dwordx4 v[124:127], v14, s[4:7], s17 offen
    s_add_u32 s17, s21, 58368
    buffer_store_dwordx4 v[128:131], v14, s[4:7], s17 offen
    s_add_u32 s17, s21, 66560
    buffer_store_dwordx4 v[132:135], v14, s[4:7], s17 offen
    s_add_u32 s17, s21, 74752
    buffer_store_dwordx4 v[136:139], v14, s[4:7], s17 offen
    s_add_u32 s17, s21, 82944
    buffer_store_dwordx4 v[140:143], v14, s[4:7], s17 offen
    s_add_u32 s17, s21, 91136
    buffer_store_dwordx4 v[144:147], v14, s[4:7], s17 offen
    s_add_u32 s17, s21, 99328
    buffer_store_dwordx4 v[148:151], v14, s[4:7], s17 offen
    s_add_u32 s17, s21, 107520
    buffer_store_dwordx4 v[152:155], v14, s[4:7], s17 offen
    s_add_u32 s17, s21, 115712
    buffer_store_dwordx4 v[156:159], v14, s[4:7], s17 offen
    s_add_u32 s17, s21, 123904
    buffer_store_dwordx4 v[160:163], v14, s[4:7], s17 offen
    s_cmp_lg_u32 s91, 0
    s_cbranch_scc1 F_no512
    s_sub_u32 s20, s20, 524288
    buffer_load_ushort v20, v12, s[8:11], s20 offen
    buffer_load_ushort v28, v12, s[12:15], s20 offen
    s_add_u32 s20, s20, 65664
    buffer_load_ushort v21, v12, s[8:11], s20 offen
    buffer_load_ushort v29, v12, s[12:15], s20 offen
    s_add_u32 s20, s20, 65664
    buffer_load_ushort v22, v12, s[8:11], s20 offen
    buffer_load_ushort v30, v12, s[12:15], s20 offen
    s_add_u32 s20, s20, 65664
    buffer_load_ushort v23, v12, s[8:11], s20 offen
    buffer_load_ushort v31, v12, s[12:15], s20 offen
    s_add_u32 s20, s20, 65664
    buffer_load_ushort v24, v12, s[8:11], s20 offen
    buffer_load_ushort v32, v12, s[12:15], s20 offen
    s_add_u32 s20, s20, 65664
    buffer_load_ushort v25, v12, s[8:11], s20 offen
    buffer_load_ushort v33, v12, s[12:15], s20 offen
    s_add_u32 s20, s20, 65664
    buffer_load_ushort v26, v12, s[8:11], s20 offen
    buffer_load_ushort v34, v12, s[12:15], s20 offen
    s_add_u32 s20, s20, 65664
    buffer_load_ushort v27, v12, s[8:11], s20 offen
    buffer_load_ushort v35, v12, s[12:15], s20 offen
    s_add_u32 s20, s20, 65664
    s_waitcnt vmcnt(0)
    v_lshl_or_b32 v20, v28, 16, v20
    v_lshl_or_b32 v21, v29, 16, v21
    v_lshl_or_b32 v22, v30, 16, v22
    v_lshl_or_b32 v23, v31, 16, v23
    v_lshl_or_b32 v24, v32, 16, v24
    v_lshl_or_b32 v25, v33, 16, v25
    v_lshl_or_b32 v26, v34, 16, v26
    v_lshl_or_b32 v27, v35, 16, v27
    s_add_u32 s17, s21, 4194304
    buffer_store_dwordx4 v[20:23], v14, s[4:7], s17 offen
    buffer_store_dwordx4 v[24:27], v14, s[4:7], s17 offen offset:1024
F_no512:
    s_load_dwordx2 s[8:9], s[0:1], 0
    s_load_dwordx2 s[12:13], s[0:1], 80
    s_mov_b32 s10, 4194304
    s_mov_b32 s14, 8388608
    s_lshr_b32 s28, s91, 3
    s_and_b32 s29, s91, 7
    s_lshl_b32 s29, s29, 2
    s_add_u32 s29, s29, s16
    s_waitcnt vmcnt(0) lgkmcnt(0)
    v_bfe_u32 v5, v1, 2, 2
    v_and_b32 v7, 3, v1
    v_lshl_add_u32 v7, v5, 3, v7
    s_lshl_b32 s17, s29, 5
    v_add_u32 v7, s17, v7
    v_lshrrev_b32 v8, 4, v1
    v_cvt_f32_u32 v8, v8
    s_mov_b32 s31, 981467136
    v_add_u32 v5, 0, v7
    v_lshrrev_b32 v6, 1, v5
    v_and_b32 v30, 1, v5
    v_cmp_eq_u32 vcc, 1, v5
    v_mov_b32 v5, 512
    s_nop 0
    v_cndmask_b32 v6, v6, v5, vcc
    v_cndmask_b32 v30, v30, 0, vcc
    v_cvt_f32_u32 v6, v6
    v_cvt_f32_u32 v30, v30
    v_mul_f32 v32, s31, v6
    v_mul_f32 v30, 0x3e800000, v30
    v_mov_b32 v34, v32
    v_mul_f32 v36, 0x42000000, v32
    v_mul_f32 v5, 0x41000000, v32
    v_fma_f32 v30, v5, v8, v30
    v_add_u32 v5, 4, v7
    v_lshrrev_b32 v6, 1, v5
    v_and_b32 v31, 1, v5
    v_cmp_eq_u32 vcc, 1, v5
    v_mov_b32 v5, 512
    s_nop 0
    v_cndmask_b32 v6, v6, v5, vcc
    v_cndmask_b32 v31, v31, 0, vcc
    v_cvt_f32_u32 v6, v6
    v_cvt_f32_u32 v31, v31
    v_mul_f32 v33, s31, v6
    v_mul_f32 v31, 0x3e800000, v31
    v_mov_b32 v35, v33
    v_mul_f32 v37, 0x42000000, v33
    v_mul_f32 v5, 0x41000000, v33
    v_fma_f32 v31, v5, v8, v31
    v_lshlrev_b32 v8, 4, v1
    s_lshl_b32 s18, s16, 15
    v_add_u32 v8, s18, v8
    v_mov_b32 v7, v8
    s_mov_b32 s22, 0
F1_g0:
    v_fract_f32 v40, v30
    v_add_f32 v41, v40, v32
    v_add_f32 v42, v41, v34
    v_add_f32 v43, v42, v32
    v_add_f32 v44, v43, v34
    v_add_f32 v45, v44, v32
    v_add_f32 v46, v45, v34
    v_add_f32 v47, v46, v32
    v_add_f32 v30, v40, v36
    v_cos_f32 v48, v40
    v_cos_f32 v49, v41
    v_cos_f32 v50, v42
    v_cos_f32 v51, v43
    v_cos_f32 v52, v44
    v_cos_f32 v53, v45
    v_cos_f32 v54, v46
    v_cos_f32 v55, v47
    v_cvt_pk_bf16_f32 v56, v48, v49
    v_cvt_pk_bf16_f32 v57, v50, v51
    v_cvt_pk_bf16_f32 v58, v52, v53
    v_cvt_pk_bf16_f32 v59, v54, v55
    ds_write_b128 v7, v[56:59] offset:0
    v_fract_f32 v40, v31
    v_add_f32 v41, v40, v33
    v_add_f32 v42, v41, v35
    v_add_f32 v43, v42, v33
    v_add_f32 v44, v43, v35
    v_add_f32 v45, v44, v33
    v_add_f32 v46, v45, v35
    v_add_f32 v47, v46, v33
    v_add_f32 v31, v40, v37
    v_cos_f32 v48, v40
    v_cos_f32 v49, v41
    v_cos_f32 v50, v42
    v_cos_f32 v51, v43
    v_cos_f32 v52, v44
    v_cos_f32 v53, v45
    v_cos_f32 v54, v46
    v_cos_f32 v55, v47
    v_cvt_pk_bf16_f32 v60, v48, v49
    v_cvt_pk_bf16_f32 v61, v50, v51
    v_cvt_pk_bf16_f32 v62, v52, v53
    v_cvt_pk_bf16_f32 v63, v54, v55
    ds_write_b128 v7, v[60:63] offset:1024
    v_add_u32 v7, 2048, v7
    s_add_u32 s22, s22, 1
    s_cmp_lt_u32 s22, 16
    s_waitcnt lgkmcnt(0)
    s_cbranch_scc1 F1_g0
    ds_read_b128 a[0:3], v8 offset:0
    ds_read_b128 a[4:7], v8 offset:1024
    ds_read_b128 a[8:11], v8 offset:2048
    ds_read_b128 a[12:15], v8 offset:3072
    ds_read_b128 a[16:19], v8 offset:4096
    ds_read_b128 a[20:23], v8 offset:5120
    ds_read_b128 a[24:27], v8 offset:6144
    ds_read_b128 a[28:31], v8 offset:7168
    s_waitcnt lgkmcnt(7)
    ds_read_b128 a[32:35], v8 offset:8192
    ds_read_b128 a[36:39], v8 offset:9216
    ds_read_b128 a[40:43], v8 offset:10240
    ds_read_b128 a[44:47], v8 offset:11264
    ds_read_b128 a[48:51], v8 offset:12288
    ds_read_b128 a[52:55], v8 offset:13312
    ds_read_b128 a[56:59], v8 offset:14336
    ds_read_b128 a[60:63], v8 offset:15360
    s_waitcnt lgkmcnt(7)
    ds_read_b128 a[64:67], v8 offset:16384
    ds_read_b128 a[68:71], v8 offset:17408
    ds_read_b128 a[72:75], v8 offset:18432
    ds_read_b128 a[76:79], v8 offset:19456
    ds_read_b128 a[80:83], v8 offset:20480
    ds_read_b128 a[84:87], v8 offset:21504
    ds_read_b128 a[88:91], v8 offset:22528
    ds_read_b128 a[92:95], v8 offset:23552
    s_waitcnt lgkmcnt(7)
    ds_read_b128 a[96:99], v8 offset:24576
    ds_read_b128 a[100:103], v8 offset:25600
    ds_read_b128 a[104:107], v8 offset:26624
    ds_read_b128 a[108:111], v8 offset:27648
    ds_read_b128 a[112:115], v8 offset:28672
    ds_read_b128 a[116:119], v8 offset:29696
    ds_read_b128 a[120:123], v8 offset:30720
    ds_read_b128 a[124:127], v8 offset:31744
    s_waitcnt lgkmcnt(7)
    s_waitcnt lgkmcnt(0)
    v_mov_b32 v7, v8
    s_mov_b32 s22, 0
F1_g1:
    v_fract_f32 v40, v30
    v_add_f32 v41, v40, v32
    v_add_f32 v42, v41, v34
    v_add_f32 v43, v42, v32
    v_add_f32 v44, v43, v34
    v_add_f32 v45, v44, v32
    v_add_f32 v46, v45, v34
    v_add_f32 v47, v46, v32
    v_add_f32 v30, v40, v36
    v_cos_f32 v48, v40
    v_cos_f32 v49, v41
    v_cos_f32 v50, v42
    v_cos_f32 v51, v43
    v_cos_f32 v52, v44
    v_cos_f32 v53, v45
    v_cos_f32 v54, v46
    v_cos_f32 v55, v47
    v_cvt_pk_bf16_f32 v56, v48, v49
    v_cvt_pk_bf16_f32 v57, v50, v51
    v_cvt_pk_bf16_f32 v58, v52, v53
    v_cvt_pk_bf16_f32 v59, v54, v55
    ds_write_b128 v7, v[56:59] offset:0
    v_fract_f32 v40, v31
    v_add_f32 v41, v40, v33
    v_add_f32 v42, v41, v35
    v_add_f32 v43, v42, v33
    v_add_f32 v44, v43, v35
    v_add_f32 v45, v44, v33
    v_add_f32 v46, v45, v35
    v_add_f32 v47, v46, v33
    v_add_f32 v31, v40, v37
    v_cos_f32 v48, v40
    v_cos_f32 v49, v41
    v_cos_f32 v50, v42
    v_cos_f32 v51, v43
    v_cos_f32 v52, v44
    v_cos_f32 v53, v45
    v_cos_f32 v54, v46
    v_cos_f32 v55, v47
    v_cvt_pk_bf16_f32 v60, v48, v49
    v_cvt_pk_bf16_f32 v61, v50, v51
    v_cvt_pk_bf16_f32 v62, v52, v53
    v_cvt_pk_bf16_f32 v63, v54, v55
    ds_write_b128 v7, v[60:63] offset:1024
    v_add_u32 v7, 2048, v7
    s_add_u32 s22, s22, 1
    s_cmp_lt_u32 s22, 16
    s_waitcnt lgkmcnt(0)
    s_cbranch_scc1 F1_g1
    ds_read_b128 a[128:131], v8 offset:0
    ds_read_b128 a[132:135], v8 offset:1024
    ds_read_b128 a[136:139], v8 offset:2048
    ds_read_b128 a[140:143], v8 offset:3072
    ds_read_b128 a[144:147], v8 offset:4096
    ds_read_b128 a[148:151], v8 offset:5120
    ds_read_b128 a[152:155], v8 offset:6144
    ds_read_b128 a[156:159], v8 offset:7168
    s_waitcnt lgkmcnt(7)
    ds_read_b128 a[160:163], v8 offset:8192
    ds_read_b128 a[164:167], v8 offset:9216
    ds_read_b128 a[168:171], v8 offset:10240
    ds_read_b128 a[172:175], v8 offset:11264
    ds_read_b128 a[176:179], v8 offset:12288
    ds_read_b128 a[180:183], v8 offset:13312
    ds_read_b128 a[184:187], v8 offset:14336
    ds_read_b128 a[188:191], v8 offset:15360
    s_waitcnt lgkmcnt(7)
    ds_read_b128 a[192:195], v8 offset:16384
    ds_read_b128 a[196:199], v8 offset:17408
    ds_read_b128 a[200:203], v8 offset:18432
    ds_read_b128 a[204:207], v8 offset:19456
    ds_read_b128 a[208:211], v8 offset:20480
    ds_read_b128 a[212:215], v8 offset:21504
    ds_read_b128 a[216:219], v8 offset:22528
    ds_read_b128 a[220:223], v8 offset:23552
    s_waitcnt lgkmcnt(7)
    ds_read_b128 a[224:227], v8 offset:24576
    ds_read_b128 a[228:231], v8 offset:25600
    ds_read_b128 a[232:235], v8 offset:26624
    ds_read_b128 a[236:239], v8 offset:27648
    ds_read_b128 a[240:243], v8 offset:28672
    ds_read_b128 a[244:247], v8 offset:29696
    ds_read_b128 a[248:251], v8 offset:30720
    ds_read_b128 a[252:255], v8 offset:31744
    s_waitcnt lgkmcnt(7)
    s_waitcnt lgkmcnt(0)
    v_and_b32 v5, 15, v1
    v_bfe_u32 v6, v1, 1, 3
    v_lshrrev_b32 v7, 4, v1
    v_xor_b32 v6, v6, v7
    v_lshlrev_b32 v6, 4, v6
    v_lshl_add_u32 v10, v5, 7, v6
    s_lshl_b32 s19, s16, 10
    v_xor_b32 v11, 64, v10
    v_add_u32 v12, 0x10000, v10
    v_add_u32 v13, 0x10000, v11
    v_lshrrev_b32 v7, 3, v1
    s_lshl_b32 s17, s16, 3
    v_add_u32 v7, s17, v7
    v_bfe_u32 v8, v7, 1, 3
    v_xor_b32 v8, v8, v1
    v_and_b32 v8, 7, v8
    v_bfe_u32 v5, v7, 2, 2
    v_and_b32 v2, 3, v7
    v_lshl_add_u32 v2, v5, 3, v2
    v_bfe_u32 v5, v7, 4, 1
    v_lshl_add_u32 v2, v5, 2, v2
    v_bfe_u32 v5, v1, 2, 2
    v_and_b32 v3, 3, v1
    v_lshl_add_u32 v3, v5, 3, v3
    v_lshlrev_b32 v2, 16, v2
    v_lshl_add_u32 v2, v8, 4, v2
    v_and_b32 v5, 48, v1
    v_lshl_add_u32 v3, v3, 6, v5
    s_mul_i32 s21, s29, 133120
    s_lshl_b32 s17, s28, 15
    s_add_u32 s21, s21, s17
    s_add_u32 s21, s21, 104857600
    s_and_b32 s20, s28, 1
    s_lshl_b32 s20, s20, 15
    s_lshr_b32 s17, s28, 1
    s_lshl_b32 s17, s17, 21
    s_add_u32 s20, s20, s17
    s_mov_b32 s24, 2048
    s_mov_b32 s25, 2048
    s_barrier
    s_mov_b32 s26, s25
    s_sub_u32 s25, s21, 1073741824
    s_mov_b32 s21, 1073741824
    s_mov_b32 s23, 0
    s_mov_b32 s22, 0
    s_add_u32 m0, s19, 0
    s_nop 0
    buffer_load_dwordx4 v2, s[8:11], s20 offen offset:0 lds
    s_add_u32 m0, s19, 3968
    s_nop 0
    buffer_load_dwordx4 v2, s[8:11], s20 offen offset:128 lds
    s_add_u32 m0, s19, 7936
    s_nop 0
    buffer_load_dwordx4 v2, s[8:11], s20 offen offset:256 lds
    s_add_u32 m0, s19, 11904
    s_nop 0
    buffer_load_dwordx4 v2, s[8:11], s20 offen offset:384 lds
    s_add_u32 m0, s19, 15872
    s_nop 0
    buffer_load_dwordx4 v2, s[8:11], s20 offen offset:512 lds
    s_add_u32 m0, s19, 19840
    s_nop 0
    buffer_load_dwordx4 v2, s[8:11], s20 offen offset:640 lds
    s_add_u32 m0, s19, 23808
    s_nop 0
    buffer_load_dwordx4 v2, s[8:11], s20 offen offset:768 lds
    s_add_u32 m0, s19, 27776
    s_nop 0
    buffer_load_dwordx4 v2, s[8:11], s20 offen offset:896 lds
    s_add_u32 m0, s19, 31744
    s_nop 0
    buffer_load_dwordx4 v2, s[8:11], s20 offen offset:1024 lds
    s_add_u32 m0, s19, 35712
    s_nop 0
    buffer_load_dwordx4 v2, s[8:11], s20 offen offset:1152 lds
    s_add_u32 m0, s19, 39680
    s_nop 0
    buffer_load_dwordx4 v2, s[8:11], s20 offen offset:1280 lds
    s_add_u32 m0, s19, 43648
    s_nop 0
    buffer_load_dwordx4 v2, s[8:11], s20 offen offset:1408 lds
    s_add_u32 m0, s19, 47616
    s_nop 0
    buffer_load_dwordx4 v2, s[8:11], s20 offen offset:1536 lds
    s_add_u32 m0, s19, 51584
    s_nop 0
    buffer_load_dwordx4 v2, s[8:11], s20 offen offset:1664 lds
    s_add_u32 m0, s19, 55552
    s_nop 0
    buffer_load_dwordx4 v2, s[8:11], s20 offen offset:1792 lds
    s_add_u32 m0, s19, 59520
    s_nop 0
    buffer_load_dwordx4 v2, s[8:11], s20 offen offset:1920 lds
    s_add_u32 s20, s20, s24
    s_add_u32 m0, s19, 65536
    s_nop 0
    buffer_load_dwordx4 v2, s[8:11], s20 offen offset:0 lds
    s_add_u32 m0, s19, 69504
    s_nop 0
    buffer_load_dwordx4 v2, s[8:11], s20 offen offset:128 lds
    s_add_u32 m0, s19, 73472
    s_nop 0
    buffer_load_dwordx4 v2, s[8:11], s20 offen offset:256 lds
    s_waitcnt vmcnt(11)
    s_barrier
    ds_read_b128 v[20:23], v10 offset:0
    ds_read_b128 v[24:27], v10 offset:2048
    ds_read_b128 v[28:31], v11 offset:0
    ds_read_b128 v[32:35], v11 offset:2048
    ds_read_b128 v[36:39], v10 offset:4096
    ds_read_b128 v[40:43], v10 offset:6144
    ds_read_b128 v[44:47], v11 offset:4096
.p2align 6
F1_top:
    s_waitcnt lgkmcnt(6)
    v_mfma_f32_16x16x32_bf16 v[52:55], v[20:23], a[0:3], 0
    ds_read_b128 v[48:51], v11 offset:6144
    v_mfma_f32_16x16x32_bf16 v[60:63], v[20:23], a[4:7], 0
    s_waitcnt lgkmcnt(6)
    v_mfma_f32_16x16x32_bf16 v[56:59], v[24:27], a[0:3], 0
    ds_read_b128 v[20:23], v10 offset:8192
    s_add_u32 m0, s19, 77440
    v_mfma_f32_16x16x32_bf16 v[64:67], v[24:27], a[4:7], 0
    buffer_load_dwordx4 v2, s[8:11], s20 offen offset:384 lds
    s_waitcnt lgkmcnt(6)
    v_mfma_f32_16x16x32_bf16 v[52:55], v[28:31], a[8:11], v[52:55]
    ds_read_b128 v[24:27], v10 offset:10240
    v_mfma_f32_16x16x32_bf16 v[60:63], v[28:31], a[12:15], v[60:63]
    s_waitcnt lgkmcnt(6)
    v_mfma_f32_16x16x32_bf16 v[56:59], v[32:35], a[8:11], v[56:59]
    ds_read_b128 v[28:31], v11 offset:8192
    s_add_u32 m0, s19, 81408
    v_mfma_f32_16x16x32_bf16 v[64:67], v[32:35], a[12:15], v[64:67]
    buffer_load_dwordx4 v2, s[8:11], s20 offen offset:512 lds
    s_waitcnt lgkmcnt(6)
    v_mfma_f32_16x16x32_bf16 v[52:55], v[36:39], a[16:19], v[52:55]
    ds_read_b128 v[32:35], v11 offset:10240
    v_mfma_f32_16x16x32_bf16 v[60:63], v[36:39], a[20:23], v[60:63]
    s_waitcnt lgkmcnt(6)
    v_mfma_f32_16x16x32_bf16 v[56:59], v[40:43], a[16:19], v[56:59]
    ds_read_b128 v[36:39], v10 offset:12288
    s_add_u32 m0, s19, 85376
    v_mfma_f32_16x16x32_bf16 v[64:67], v[40:43], a[20:23], v[64:67]
    buffer_load_dwordx4 v2, s[8:11], s20 offen offset:640 lds
    s_waitcnt lgkmcnt(6)
    v_mfma_f32_16x16x32_bf16 v[52:55], v[44:47], a[24:27], v[52:55]
    ds_read_b128 v[40:43], v10 offset:14336
    v_mfma_f32_16x16x32_bf16 v[60:63], v[44:47], a[28:31], v[60:63]
    s_waitcnt lgkmcnt(6)
    v_mfma_f32_16x16x32_bf16 v[56:59], v[48:51], a[24:27], v[56:59]
    ds_read_b128 v[44:47], v11 offset:12288
    s_add_u32 m0, s19, 89344
    v_mfma_f32_16x16x32_bf16 v[64:67], v[48:51], a[28:31], v[64:67]
    buffer_load_dwordx4 v2, s[8:11], s20 offen offset:768 lds
    s_waitcnt lgkmcnt(6)
    v_mfma_f32_16x16x32_bf16 v[52:55], v[20:23], a[32:35], v[52:55]
    ds_read_b128 v[48:51], v11 offset:14336
    v_mfma_f32_16x16x32_bf16 v[60:63], v[20:23], a[36:39], v[60:63]
    s_waitcnt lgkmcnt(6)
    v_mfma_f32_16x16x32_bf16 v[56:59], v[24:27], a[32:35], v[56:59]
    ds_read_b128 v[20:23], v10 offset:16384
    s_add_u32 m0, s19, 93312
    v_mfma_f32_16x16x32_bf16 v[64:67], v[24:27], a[36:39], v[64:67]
    buffer_load_dwordx4 v2, s[8:11], s20 offen offset:896 lds
    s_waitcnt lgkmcnt(6)
    v_mfma_f32_16x16x32_bf16 v[52:55], v[28:31], a[40:43], v[52:55]
    ds_read_b128 v[24:27], v10 offset:18432
    v_mfma_f32_16x16x32_bf16 v[60:63], v[28:31], a[44:47], v[60:63]
    v_cvt_pk_bf16_f32 v84, v68, v69
    s_waitcnt lgkmcnt(6)
    v_mfma_f32_16x16x32_bf16 v[56:59], v[32:35], a[40:43], v[56:59]
    ds_read_b128 v[28:31], v11 offset:16384
    v_mfma_f32_16x16x32_bf16 v[64:67], v[32:35], a[44:47], v[64:67]
    v_cvt_pk_bf16_f32 v85, v70, v71
    s_waitcnt lgkmcnt(6)
    v_mfma_f32_16x16x32_bf16 v[52:55], v[36:39], a[48:51], v[52:55]
    ds_read_b128 v[32:35], v11 offset:18432
    v_mfma_f32_16x16x32_bf16 v[60:63], v[36:39], a[52:55], v[60:63]
    v_cvt_pk_bf16_f32 v86, v72, v73
    s_waitcnt lgkmcnt(6)
    v_mfma_f32_16x16x32_bf16 v[56:59], v[40:43], a[48:51], v[56:59]
    ds_read_b128 v[36:39], v10 offset:20480
    v_mfma_f32_16x16x32_bf16 v[64:67], v[40:43], a[52:55], v[64:67]
    v_cvt_pk_bf16_f32 v87, v74, v75
    s_waitcnt lgkmcnt(6)
    v_mfma_f32_16x16x32_bf16 v[52:55], v[44:47], a[56:59], v[52:55]
    ds_read_b128 v[40:43], v10 offset:22528
    v_mfma_f32_16x16x32_bf16 v[60:63], v[44:47], a[60:63], v[60:63]
    v_cvt_pk_bf16_f32 v88, v76, v77
    s_waitcnt lgkmcnt(6)
    v_mfma_f32_16x16x32_bf16 v[56:59], v[48:51], a[56:59], v[56:59]
    ds_read_b128 v[44:47], v11 offset:20480
    v_mfma_f32_16x16x32_bf16 v[64:67], v[48:51], a[60:63], v[64:67]
    v_cvt_pk_bf16_f32 v89, v78, v79
    buffer_store_dwordx4 v[84:87], v3, s[4:7], s21 offen offset:0 sc1
    s_waitcnt lgkmcnt(6)
    v_mfma_f32_16x16x32_bf16 v[52:55], v[20:23], a[64:67], v[52:55]
    ds_read_b128 v[48:51], v11 offset:22528
    v_mfma_f32_16x16x32_bf16 v[60:63], v[20:23], a[68:71], v[60:63]
    v_cvt_pk_bf16_f32 v90, v80, v81
    s_waitcnt lgkmcnt(6)
    v_mfma_f32_16x16x32_bf16 v[56:59], v[24:27], a[64:67], v[56:59]
    ds_read_b128 v[20:23], v10 offset:24576
    v_mfma_f32_16x16x32_bf16 v[64:67], v[24:27], a[68:71], v[64:67]
    v_cvt_pk_bf16_f32 v91, v82, v83
    s_waitcnt lgkmcnt(6)
    v_mfma_f32_16x16x32_bf16 v[52:55], v[28:31], a[72:75], v[52:55]
    ds_read_b128 v[24:27], v10 offset:26624
    v_mfma_f32_16x16x32_bf16 v[60:63], v[28:31], a[76:79], v[60:63]
    s_waitcnt lgkmcnt(6)
    v_mfma_f32_16x16x32_bf16 v[56:59], v[32:35], a[72:75], v[56:59]
    ds_read_b128 v[28:31], v11 offset:24576
    v_mfma_f32_16x16x32_bf16 v[64:67], v[32:35], a[76:79], v[64:67]
    buffer_store_dwordx4 v[88:91], v3, s[4:7], s21 offen offset:256 sc1
    s_waitcnt lgkmcnt(6)
    v_mfma_f32_16x16x32_bf16 v[52:55], v[36:39], a[80:83], v[52:55]
    ds_read_b128 v[32:35], v11 offset:26624
    v_mfma_f32_16x16x32_bf16 v[60:63], v[36:39], a[84:87], v[60:63]
    s_add_u32 s21, s21, s25
    s_mov_b32 s25, s26
    s_waitcnt lgkmcnt(6)
    v_mfma_f32_16x16x32_bf16 v[56:59], v[40:43], a[80:83], v[56:59]
    ds_read_b128 v[36:39], v10 offset:28672
    v_mfma_f32_16x16x32_bf16 v[64:67], v[40:43], a[84:87], v[64:67]
    s_waitcnt lgkmcnt(6)
    v_mfma_f32_16x16x32_bf16 v[52:55], v[44:47], a[88:91], v[52:55]
    ds_read_b128 v[40:43], v10 offset:30720
    v_mfma_f32_16x16x32_bf16 v[60:63], v[44:47], a[92:95], v[60:63]
    s_waitcnt lgkmcnt(6)
    v_mfma_f32_16x16x32_bf16 v[56:59], v[48:51], a[88:91], v[56:59]
    ds_read_b128 v[44:47], v11 offset:28672
    v_mfma_f32_16x16x32_bf16 v[64:67], v[48:51], a[92:95], v[64:67]
    s_waitcnt lgkmcnt(6)
    v_mfma_f32_16x16x32_bf16 v[52:55], v[20:23], a[96:99], v[52:55]
    ds_read_b128 v[48:51], v11 offset:30720
    v_mfma_f32_16x16x32_bf16 v[60:63], v[20:23], a[100:103], v[60:63]
    s_waitcnt lgkmcnt(6)
    v_mfma_f32_16x16x32_bf16 v[56:59], v[24:27], a[96:99], v[56:59]
    s_waitcnt vmcnt(10)
    s_barrier
    ds_read_b128 v[20:23], v10 offset:32768
    v_mfma_f32_16x16x32_bf16 v[64:67], v[24:27], a[100:103], v[64:67]
    s_waitcnt lgkmcnt(6)
    v_mfma_f32_16x16x32_bf16 v[52:55], v[28:31], a[104:107], v[52:55]
    ds_read_b128 v[24:27], v10 offset:34816
    s_add_u32 m0, s19, 97280
    v_mfma_f32_16x16x32_bf16 v[60:63], v[28:31], a[108:111], v[60:63]
    buffer_load_dwordx4 v2, s[8:11], s20 offen offset:1024 lds
    s_waitcnt lgkmcnt(6)
    v_mfma_f32_16x16x32_bf16 v[56:59], v[32:35], a[104:107], v[56:59]
    ds_read_b128 v[28:31], v11 offset:32768
    v_mfma_f32_16x16x32_bf16 v[64:67], v[32:35], a[108:111], v[64:67]
    s_waitcnt lgkmcnt(6)
    v_mfma_f32_16x16x32_bf16 v[52:55], v[36:39], a[112:115], v[52:55]
    ds_read_b128 v[32:35], v11 offset:34816
    s_add_u32 m0, s19, 101248
    v_mfma_f32_16x16x32_bf16 v[60:63], v[36:39], a[116:119], v[60:63]
    buffer_load_dwordx4 v2, s[8:11], s20 offen offset:1152 lds
    s_waitcnt lgkmcnt(6)
    v_mfma_f32_16x16x32_bf16 v[56:59], v[40:43], a[112:115], v[56:59]
    ds_read_b128 v[36:39], v10 offset:36864
    v_mfma_f32_16x16x32_bf16 v[64:67], v[40:43], a[116:119], v[64:67]
    s_waitcnt lgkmcnt(6)
    v_mfma_f32_16x16x32_bf16 v[52:55], v[44:47], a[120:123], v[52:55]
    ds_read_b128 v[40:43], v10 offset:38912
    s_add_u32 m0, s19, 105216
    v_mfma_f32_16x16x32_bf16 v[60:63], v[44:47], a[124:127], v[60:63]
    buffer_load_dwordx4 v2, s[8:11], s20 offen offset:1280 lds
    s_waitcnt lgkmcnt(6)
    v_mfma_f32_16x16x32_bf16 v[56:59], v[48:51], a[120:123], v[56:59]
    ds_read_b128 v[44:47], v11 offset:36864
    v_mfma_f32_16x16x32_bf16 v[64:67], v[48:51], a[124:127], v[64:67]
    s_waitcnt lgkmcnt(6)
    v_mfma_f32_16x16x32_bf16 v[52:55], v[20:23], a[128:131], v[52:55]
    ds_read_b128 v[48:51], v11 offset:38912
    v_mfma_f32_16x16x32_bf16 v[60:63], v[20:23], a[132:135], v[60:63]
    s_waitcnt lgkmcnt(6)
    v_mfma_f32_16x16x32_bf16 v[56:59], v[24:27], a[128:131], v[56:59]
    ds_read_b128 v[20:23], v10 offset:40960
    s_add_u32 m0, s19, 109184
    v_mfma_f32_16x16x32_bf16 v[64:67], v[24:27], a[132:135], v[64:67]
    buffer_load_dwordx4 v2, s[8:11], s20 offen offset:1408 lds
    s_waitcnt lgkmcnt(6)
    v_mfma_f32_16x16x32_bf16 v[52:55], v[28:31], a[136:139], v[52:55]
    ds_read_b128 v[24:27], v10 offset:43008
    v_mfma_f32_16x16x32_bf16 v[60:63], v[28:31], a[140:143], v[60:63]
    s_waitcnt lgkmcnt(6)
    v_mfma_f32_16x16x32_bf16 v[56:59], v[32:35], a[136:139], v[56:59]
    ds_read_b128 v[28:31], v11 offset:40960
    s_add_u32 m0, s19, 113152
    v_mfma_f32_16x16x32_bf16 v[64:67], v[32:35], a[140:143], v[64:67]
    buffer_load_dwordx4 v2, s[8:11], s20 offen offset:1536 lds
    s_waitcnt lgkmcnt(6)
    v_mfma_f32_16x16x32_bf16 v[52:55], v[36:39], a[144:147], v[52:55]
    ds_read_b128 v[32:35], v11 offset:43008
    v_mfma_f32_16x16x32_bf16 v[60:63], v[36:39], a[148:151], v[60:63]
    s_waitcnt lgkmcnt(6)
    v_mfma_f32_16x16x32_bf16 v[56:59], v[40:43], a[144:147], v[56:59]
    ds_read_b128 v[36:39], v10 offset:45056
    s_add_u32 m0, s19, 117120
    v_mfma_f32_16x16x32_bf16 v[64:67], v[40:43], a[148:151], v[64:67]
    buffer_load_dwordx4 v2, s[8:11], s20 offen offset:1664 lds
    s_waitcnt lgkmcnt(6)
    v_mfma_f32_16x16x32_bf16 v[52:55], v[44:47], a[152:155], v[52:55]
    ds_read_b128 v[40:43], v10 offset:47104
    v_mfma_f32_16x16x32_bf16 v[60:63], v[44:47], a[156:159], v[60:63]
    s_waitcnt lgkmcnt(6)
    v_mfma_f32_16x16x32_bf16 v[56:59], v[48:51], a[152:155], v[56:59]
    ds_read_b128 v[44:47], v11 offset:45056
    s_add_u32 m0, s19, 121088
    v_mfma_f32_16x16x32_bf16 v[64:67], v[48:51], a[156:159], v[64:67]
    buffer_load_dwordx4 v2, s[8:11], s20 offen offset:1792 lds
    s_waitcnt lgkmcnt(6)
    v_mfma_f32_16x16x32_bf16 v[52:55], v[20:23], a[160:163], v[52:55]
    ds_read_b128 v[48:51], v11 offset:47104
    v_mfma_f32_16x16x32_bf16 v[60:63], v[20:23], a[164:167], v[60:63]
    s_waitcnt lgkmcnt(6)
    v_mfma_f32_16x16x32_bf16 v[56:59], v[24:27], a[160:163], v[56:59]
    ds_read_b128 v[20:23], v10 offset:49152
    s_add_u32 m0, s19, 125056
    v_mfma_f32_16x16x32_bf16 v[64:67], v[24:27], a[164:167], v[64:67]
    buffer_load_dwordx4 v2, s[8:11], s20 offen offset:1920 lds
    s_waitcnt lgkmcnt(6)
    v_mfma_f32_16x16x32_bf16 v[52:55], v[28:31], a[168:171], v[52:55]
    ds_read_b128 v[24:27], v10 offset:51200
    v_mfma_f32_16x16x32_bf16 v[60:63], v[28:31], a[172:175], v[60:63]
    s_add_u32 s20, s20, s24
    s_waitcnt lgkmcnt(6)
    v_mfma_f32_16x16x32_bf16 v[56:59], v[32:35], a[168:171], v[56:59]
    ds_read_b128 v[28:31], v11 offset:49152
    v_mfma_f32_16x16x32_bf16 v[64:67], v[32:35], a[172:175], v[64:67]
    s_waitcnt lgkmcnt(6)
    v_mfma_f32_16x16x32_bf16 v[52:55], v[36:39], a[176:179], v[52:55]
    ds_read_b128 v[32:35], v11 offset:51200
    v_mfma_f32_16x16x32_bf16 v[60:63], v[36:39], a[180:183], v[60:63]
    s_waitcnt lgkmcnt(6)
    v_mfma_f32_16x16x32_bf16 v[56:59], v[40:43], a[176:179], v[56:59]
    ds_read_b128 v[36:39], v10 offset:53248
    v_mfma_f32_16x16x32_bf16 v[64:67], v[40:43], a[180:183], v[64:67]
    s_waitcnt lgkmcnt(6)
    v_mfma_f32_16x16x32_bf16 v[52:55], v[44:47], a[184:187], v[52:55]
    ds_read_b128 v[40:43], v10 offset:55296
    v_mfma_f32_16x16x32_bf16 v[60:63], v[44:47], a[188:191], v[60:63]
    s_waitcnt lgkmcnt(6)
    v_mfma_f32_16x16x32_bf16 v[56:59], v[48:51], a[184:187], v[56:59]
    ds_read_b128 v[44:47], v11 offset:53248
    v_mfma_f32_16x16x32_bf16 v[64:67], v[48:51], a[188:191], v[64:67]
    s_waitcnt lgkmcnt(6)
    v_mfma_f32_16x16x32_bf16 v[52:55], v[20:23], a[192:195], v[52:55]
    ds_read_b128 v[48:51], v11 offset:55296
    v_mfma_f32_16x16x32_bf16 v[60:63], v[20:23], a[196:199], v[60:63]
    s_waitcnt lgkmcnt(6)
    v_mfma_f32_16x16x32_bf16 v[56:59], v[24:27], a[192:195], v[56:59]
    ds_read_b128 v[20:23], v10 offset:57344
    v_mfma_f32_16x16x32_bf16 v[64:67], v[24:27], a[196:199], v[64:67]
    s_waitcnt lgkmcnt(6)
    v_mfma_f32_16x16x32_bf16 v[52:55], v[28:31], a[200:203], v[52:55]
    ds_read_b128 v[24:27], v10 offset:59392
    v_mfma_f32_16x16x32_bf16 v[60:63], v[28:31], a[204:207], v[60:63]
    s_waitcnt lgkmcnt(6)
    v_mfma_f32_16x16x32_bf16 v[56:59], v[32:35], a[200:203], v[56:59]
    ds_read_b128 v[28:31], v11 offset:57344
    v_mfma_f32_16x16x32_bf16 v[64:67], v[32:35], a[204:207], v[64:67]
    s_waitcnt lgkmcnt(6)
    v_mfma_f32_16x16x32_bf16 v[52:55], v[36:39], a[208:211], v[52:55]
    ds_read_b128 v[32:35], v11 offset:59392
    v_mfma_f32_16x16x32_bf16 v[60:63], v[36:39], a[212:215], v[60:63]
    s_waitcnt lgkmcnt(6)
    v_mfma_f32_16x16x32_bf16 v[56:59], v[40:43], a[208:211], v[56:59]
    ds_read_b128 v[36:39], v10 offset:61440
    v_mfma_f32_16x16x32_bf16 v[64:67], v[40:43], a[212:215], v[64:67]
    s_waitcnt lgkmcnt(6)
    v_mfma_f32_16x16x32_bf16 v[52:55], v[44:47], a[216:219], v[52:55]
    ds_read_b128 v[40:43], v10 offset:63488
    v_mfma_f32_16x16x32_bf16 v[60:63], v[44:47], a[220:223], v[60:63]
    s_waitcnt lgkmcnt(6)
    v_mfma_f32_16x16x32_bf16 v[56:59], v[48:51], a[216:219], v[56:59]
    ds_read_b128 v[44:47], v11 offset:61440
    v_mfma_f32_16x16x32_bf16 v[64:67], v[48:51], a[220:223], v[64:67]
    s_waitcnt lgkmcnt(6)
    v_mfma_f32_16x16x32_bf16 v[52:55], v[20:23], a[224:227], v[52:55]
    ds_read_b128 v[48:51], v11 offset:63488
    v_mfma_f32_16x16x32_bf16 v[60:63], v[20:23], a[228:231], v[60:63]
    s_waitcnt lgkmcnt(6)
    v_mfma_f32_16x16x32_bf16 v[56:59], v[24:27], a[224:227], v[56:59]
    s_waitcnt vmcnt(8)
    s_barrier
    ds_read_b128 v[20:23], v12 offset:0
    v_mfma_f32_16x16x32_bf16 v[64:67], v[24:27], a[228:231], v[64:67]
    s_waitcnt lgkmcnt(6)
    v_mfma_f32_16x16x32_bf16 v[52:55], v[28:31], a[232:235], v[52:55]
    ds_read_b128 v[24:27], v12 offset:2048
    s_add_u32 m0, s19, 0
    v_mfma_f32_16x16x32_bf16 v[60:63], v[28:31], a[236:239], v[60:63]
    buffer_load_dwordx4 v2, s[8:11], s20 offen offset:0 lds
    s_waitcnt lgkmcnt(6)
    v_mfma_f32_16x16x32_bf16 v[56:59], v[32:35], a[232:235], v[56:59]
    ds_read_b128 v[28:31], v13 offset:0
    v_mfma_f32_16x16x32_bf16 v[64:67], v[32:35], a[236:239], v[64:67]
    s_waitcnt lgkmcnt(6)
    v_mfma_f32_16x16x32_bf16 v[52:55], v[36:39], a[240:243], v[52:55]
    ds_read_b128 v[32:35], v13 offset:2048
    s_add_u32 m0, s19, 3968
    v_mfma_f32_16x16x32_bf16 v[60:63], v[36:39], a[244:247], v[60:63]
    buffer_load_dwordx4 v2, s[8:11], s20 offen offset:128 lds
    s_waitcnt lgkmcnt(6)
    v_mfma_f32_16x16x32_bf16 v[56:59], v[40:43], a[240:243], v[56:59]
    ds_read_b128 v[36:39], v12 offset:4096
    v_mfma_f32_16x16x32_bf16 v[64:67], v[40:43], a[244:247], v[64:67]
    s_waitcnt lgkmcnt(6)
    v_mfma_f32_16x16x32_bf16 v[52:55], v[44:47], a[248:251], v[52:55]
    ds_read_b128 v[40:43], v12 offset:6144
    s_add_u32 m0, s19, 7936
    v_mfma_f32_16x16x32_bf16 v[60:63], v[44:47], a[252:255], v[60:63]
    buffer_load_dwordx4 v2, s[8:11], s20 offen offset:256 lds
    s_waitcnt lgkmcnt(6)
    v_mfma_f32_16x16x32_bf16 v[56:59], v[48:51], a[248:251], v[56:59]
    ds_read_b128 v[44:47], v13 offset:4096
    v_mfma_f32_16x16x32_bf16 v[64:67], v[48:51], a[252:255], v[64:67]
    s_waitcnt lgkmcnt(6)
    v_mfma_f32_16x16x32_bf16 v[68:71], v[20:23], a[0:3], 0
    ds_read_b128 v[48:51], v13 offset:6144
    v_mfma_f32_16x16x32_bf16 v[76:79], v[20:23], a[4:7], 0
    s_waitcnt lgkmcnt(6)
    v_mfma_f32_16x16x32_bf16 v[72:75], v[24:27], a[0:3], 0
    ds_read_b128 v[20:23], v12 offset:8192
    s_add_u32 m0, s19, 11904
    v_mfma_f32_16x16x32_bf16 v[80:83], v[24:27], a[4:7], 0
    buffer_load_dwordx4 v2, s[8:11], s20 offen offset:384 lds
    s_waitcnt lgkmcnt(6)
    v_mfma_f32_16x16x32_bf16 v[68:71], v[28:31], a[8:11], v[68:71]
    ds_read_b128 v[24:27], v12 offset:10240
    v_mfma_f32_16x16x32_bf16 v[76:79], v[28:31], a[12:15], v[76:79]
    s_waitcnt lgkmcnt(6)
    v_mfma_f32_16x16x32_bf16 v[72:75], v[32:35], a[8:11], v[72:75]
    ds_read_b128 v[28:31], v13 offset:8192
    s_add_u32 m0, s19, 15872
    v_mfma_f32_16x16x32_bf16 v[80:83], v[32:35], a[12:15], v[80:83]
    buffer_load_dwordx4 v2, s[8:11], s20 offen offset:512 lds
    s_waitcnt lgkmcnt(6)
    v_mfma_f32_16x16x32_bf16 v[68:71], v[36:39], a[16:19], v[68:71]
    ds_read_b128 v[32:35], v13 offset:10240
    v_mfma_f32_16x16x32_bf16 v[76:79], v[36:39], a[20:23], v[76:79]
    s_waitcnt lgkmcnt(6)
    v_mfma_f32_16x16x32_bf16 v[72:75], v[40:43], a[16:19], v[72:75]
    ds_read_b128 v[36:39], v12 offset:12288
    s_add_u32 m0, s19, 19840
    v_mfma_f32_16x16x32_bf16 v[80:83], v[40:43], a[20:23], v[80:83]
    buffer_load_dwordx4 v2, s[8:11], s20 offen offset:640 lds
    s_waitcnt lgkmcnt(6)
    v_mfma_f32_16x16x32_bf16 v[68:71], v[44:47], a[24:27], v[68:71]
    ds_read_b128 v[40:43], v12 offset:14336
    v_mfma_f32_16x16x32_bf16 v[76:79], v[44:47], a[28:31], v[76:79]
    s_waitcnt lgkmcnt(6)
    v_mfma_f32_16x16x32_bf16 v[72:75], v[48:51], a[24:27], v[72:75]
    ds_read_b128 v[44:47], v13 offset:12288
    s_add_u32 m0, s19, 23808
    v_mfma_f32_16x16x32_bf16 v[80:83], v[48:51], a[28:31], v[80:83]
    buffer_load_dwordx4 v2, s[8:11], s20 offen offset:768 lds
    s_waitcnt lgkmcnt(6)
    v_mfma_f32_16x16x32_bf16 v[68:71], v[20:23], a[32:35], v[68:71]
    ds_read_b128 v[48:51], v13 offset:14336
    v_mfma_f32_16x16x32_bf16 v[76:79], v[20:23], a[36:39], v[76:79]
    s_waitcnt lgkmcnt(6)
    v_mfma_f32_16x16x32_bf16 v[72:75], v[24:27], a[32:35], v[72:75]
    ds_read_b128 v[20:23], v12 offset:16384
    s_add_u32 m0, s19, 27776
    v_mfma_f32_16x16x32_bf16 v[80:83], v[24:27], a[36:39], v[80:83]
    buffer_load_dwordx4 v2, s[8:11], s20 offen offset:896 lds
    s_waitcnt lgkmcnt(6)
    v_mfma_f32_16x16x32_bf16 v[68:71], v[28:31], a[40:43], v[68:71]
    ds_read_b128 v[24:27], v12 offset:18432
    v_mfma_f32_16x16x32_bf16 v[76:79], v[28:31], a[44:47], v[76:79]
    v_cvt_pk_bf16_f32 v84, v52, v53
    s_waitcnt lgkmcnt(6)
    v_mfma_f32_16x16x32_bf16 v[72:75], v[32:35], a[40:43], v[72:75]
    ds_read_b128 v[28:31], v13 offset:16384
    v_mfma_f32_16x16x32_bf16 v[80:83], v[32:35], a[44:47], v[80:83]
    v_cvt_pk_bf16_f32 v85, v54, v55
    s_waitcnt lgkmcnt(6)
    v_mfma_f32_16x16x32_bf16 v[68:71], v[36:39], a[48:51], v[68:71]
    ds_read_b128 v[32:35], v13 offset:18432
    v_mfma_f32_16x16x32_bf16 v[76:79], v[36:39], a[52:55], v[76:79]
    v_cvt_pk_bf16_f32 v86, v56, v57
    s_waitcnt lgkmcnt(6)
    v_mfma_f32_16x16x32_bf16 v[72:75], v[40:43], a[48:51], v[72:75]
    ds_read_b128 v[36:39], v12 offset:20480
    v_mfma_f32_16x16x32_bf16 v[80:83], v[40:43], a[52:55], v[80:83]
    v_cvt_pk_bf16_f32 v87, v58, v59
    s_waitcnt lgkmcnt(6)
    v_mfma_f32_16x16x32_bf16 v[68:71], v[44:47], a[56:59], v[68:71]
    ds_read_b128 v[40:43], v12 offset:22528
    v_mfma_f32_16x16x32_bf16 v[76:79], v[44:47], a[60:63], v[76:79]
    v_cvt_pk_bf16_f32 v88, v60, v61
    s_waitcnt lgkmcnt(6)
    v_mfma_f32_16x16x32_bf16 v[72:75], v[48:51], a[56:59], v[72:75]
    ds_read_b128 v[44:47], v13 offset:20480
    v_mfma_f32_16x16x32_bf16 v[80:83], v[48:51], a[60:63], v[80:83]
    v_cvt_pk_bf16_f32 v89, v62, v63
    buffer_store_dwordx4 v[84:87], v3, s[4:7], s21 offen offset:0 sc1
    s_waitcnt lgkmcnt(6)
    v_mfma_f32_16x16x32_bf16 v[68:71], v[20:23], a[64:67], v[68:71]
    ds_read_b128 v[48:51], v13 offset:22528
    v_mfma_f32_16x16x32_bf16 v[76:79], v[20:23], a[68:71], v[76:79]
    v_cvt_pk_bf16_f32 v90, v64, v65
    s_waitcnt lgkmcnt(6)
    v_mfma_f32_16x16x32_bf16 v[72:75], v[24:27], a[64:67], v[72:75]
    ds_read_b128 v[20:23], v12 offset:24576
    v_mfma_f32_16x16x32_bf16 v[80:83], v[24:27], a[68:71], v[80:83]
    v_cvt_pk_bf16_f32 v91, v66, v67
    s_waitcnt lgkmcnt(6)
    v_mfma_f32_16x16x32_bf16 v[68:71], v[28:31], a[72:75], v[68:71]
    ds_read_b128 v[24:27], v12 offset:26624
    v_mfma_f32_16x16x32_bf16 v[76:79], v[28:31], a[76:79], v[76:79]
    s_waitcnt lgkmcnt(6)
    v_mfma_f32_16x16x32_bf16 v[72:75], v[32:35], a[72:75], v[72:75]
    ds_read_b128 v[28:31], v13 offset:24576
    v_mfma_f32_16x16x32_bf16 v[80:83], v[32:35], a[76:79], v[80:83]
    buffer_store_dwordx4 v[88:91], v3, s[4:7], s21 offen offset:256 sc1
    s_waitcnt lgkmcnt(6)
    v_mfma_f32_16x16x32_bf16 v[68:71], v[36:39], a[80:83], v[68:71]
    ds_read_b128 v[32:35], v13 offset:26624
    v_mfma_f32_16x16x32_bf16 v[76:79], v[36:39], a[84:87], v[76:79]
    s_add_u32 s21, s21, s25
    s_mov_b32 s25, s26
    s_waitcnt lgkmcnt(6)
    v_mfma_f32_16x16x32_bf16 v[72:75], v[40:43], a[80:83], v[72:75]
    ds_read_b128 v[36:39], v12 offset:28672
    v_mfma_f32_16x16x32_bf16 v[80:83], v[40:43], a[84:87], v[80:83]
    s_waitcnt lgkmcnt(6)
    v_mfma_f32_16x16x32_bf16 v[68:71], v[44:47], a[88:91], v[68:71]
    ds_read_b128 v[40:43], v12 offset:30720
    v_mfma_f32_16x16x32_bf16 v[76:79], v[44:47], a[92:95], v[76:79]
    s_waitcnt lgkmcnt(6)
    v_mfma_f32_16x16x32_bf16 v[72:75], v[48:51], a[88:91], v[72:75]
    ds_read_b128 v[44:47], v13 offset:28672
    v_mfma_f32_16x16x32_bf16 v[80:83], v[48:51], a[92:95], v[80:83]
    s_waitcnt lgkmcnt(6)
    v_mfma_f32_16x16x32_bf16 v[68:71], v[20:23], a[96:99], v[68:71]
    ds_read_b128 v[48:51], v13 offset:30720
    v_mfma_f32_16x16x32_bf16 v[76:79], v[20:23], a[100:103], v[76:79]
    s_waitcnt lgkmcnt(6)
    v_mfma_f32_16x16x32_bf16 v[72:75], v[24:27], a[96:99], v[72:75]
    s_waitcnt vmcnt(10)
    s_barrier
    ds_read_b128 v[20:23], v12 offset:32768
    v_mfma_f32_16x16x32_bf16 v[80:83], v[24:27], a[100:103], v[80:83]
    s_waitcnt lgkmcnt(6)
    v_mfma_f32_16x16x32_bf16 v[68:71], v[28:31], a[104:107], v[68:71]
    ds_read_b128 v[24:27], v12 offset:34816
    s_add_u32 m0, s19, 31744
    v_mfma_f32_16x16x32_bf16 v[76:79], v[28:31], a[108:111], v[76:79]
    buffer_load_dwordx4 v2, s[8:11], s20 offen offset:1024 lds
    s_waitcnt lgkmcnt(6)
    v_mfma_f32_16x16x32_bf16 v[72:75], v[32:35], a[104:107], v[72:75]
    ds_read_b128 v[28:31], v13 offset:32768
    v_mfma_f32_16x16x32_bf16 v[80:83], v[32:35], a[108:111], v[80:83]
    s_waitcnt lgkmcnt(6)
    v_mfma_f32_16x16x32_bf16 v[68:71], v[36:39], a[112:115], v[68:71]
    ds_read_b128 v[32:35], v13 offset:34816
    s_add_u32 m0, s19, 35712
    v_mfma_f32_16x16x32_bf16 v[76:79], v[36:39], a[116:119], v[76:79]
    buffer_load_dwordx4 v2, s[8:11], s20 offen offset:1152 lds
    s_waitcnt lgkmcnt(6)
    v_mfma_f32_16x16x32_bf16 v[72:75], v[40:43], a[112:115], v[72:75]
    ds_read_b128 v[36:39], v12 offset:36864
    v_mfma_f32_16x16x32_bf16 v[80:83], v[40:43], a[116:119], v[80:83]
    s_waitcnt lgkmcnt(6)
    v_mfma_f32_16x16x32_bf16 v[68:71], v[44:47], a[120:123], v[68:71]
    ds_read_b128 v[40:43], v12 offset:38912
    s_add_u32 m0, s19, 39680
    v_mfma_f32_16x16x32_bf16 v[76:79], v[44:47], a[124:127], v[76:79]
    buffer_load_dwordx4 v2, s[8:11], s20 offen offset:1280 lds
    s_waitcnt lgkmcnt(6)
    v_mfma_f32_16x16x32_bf16 v[72:75], v[48:51], a[120:123], v[72:75]
    ds_read_b128 v[44:47], v13 offset:36864
    v_mfma_f32_16x16x32_bf16 v[80:83], v[48:51], a[124:127], v[80:83]
    s_waitcnt lgkmcnt(6)
    v_mfma_f32_16x16x32_bf16 v[68:71], v[20:23], a[128:131], v[68:71]
    ds_read_b128 v[48:51], v13 offset:38912
    v_mfma_f32_16x16x32_bf16 v[76:79], v[20:23], a[132:135], v[76:79]
    s_waitcnt lgkmcnt(6)
    v_mfma_f32_16x16x32_bf16 v[72:75], v[24:27], a[128:131], v[72:75]
    ds_read_b128 v[20:23], v12 offset:40960
    s_add_u32 m0, s19, 43648
    v_mfma_f32_16x16x32_bf16 v[80:83], v[24:27], a[132:135], v[80:83]
    buffer_load_dwordx4 v2, s[8:11], s20 offen offset:1408 lds
    s_waitcnt lgkmcnt(6)
    v_mfma_f32_16x16x32_bf16 v[68:71], v[28:31], a[136:139], v[68:71]
    ds_read_b128 v[24:27], v12 offset:43008
    v_mfma_f32_16x16x32_bf16 v[76:79], v[28:31], a[140:143], v[76:79]
    s_waitcnt lgkmcnt(6)
    v_mfma_f32_16x16x32_bf16 v[72:75], v[32:35], a[136:139], v[72:75]
    ds_read_b128 v[28:31], v13 offset:40960
    s_add_u32 m0, s19, 47616
    v_mfma_f32_16x16x32_bf16 v[80:83], v[32:35], a[140:143], v[80:83]
    buffer_load_dwordx4 v2, s[8:11], s20 offen offset:1536 lds
    s_waitcnt lgkmcnt(6)
    v_mfma_f32_16x16x32_bf16 v[68:71], v[36:39], a[144:147], v[68:71]
    ds_read_b128 v[32:35], v13 offset:43008
    v_mfma_f32_16x16x32_bf16 v[76:79], v[36:39], a[148:151], v[76:79]
    s_waitcnt lgkmcnt(6)
    v_mfma_f32_16x16x32_bf16 v[72:75], v[40:43], a[144:147], v[72:75]
    ds_read_b128 v[36:39], v12 offset:45056
    s_add_u32 m0, s19, 51584
    v_mfma_f32_16x16x32_bf16 v[80:83], v[40:43], a[148:151], v[80:83]
    buffer_load_dwordx4 v2, s[8:11], s20 offen offset:1664 lds
    s_waitcnt lgkmcnt(6)
    v_mfma_f32_16x16x32_bf16 v[68:71], v[44:47], a[152:155], v[68:71]
    ds_read_b128 v[40:43], v12 offset:47104
    v_mfma_f32_16x16x32_bf16 v[76:79], v[44:47], a[156:159], v[76:79]
    s_waitcnt lgkmcnt(6)
    v_mfma_f32_16x16x32_bf16 v[72:75], v[48:51], a[152:155], v[72:75]
    ds_read_b128 v[44:47], v13 offset:45056
    s_add_u32 m0, s19, 55552
    v_mfma_f32_16x16x32_bf16 v[80:83], v[48:51], a[156:159], v[80:83]
    buffer_load_dwordx4 v2, s[8:11], s20 offen offset:1792 lds
    s_waitcnt lgkmcnt(6)
    v_mfma_f32_16x16x32_bf16 v[68:71], v[20:23], a[160:163], v[68:71]
    ds_read_b128 v[48:51], v13 offset:47104
    v_mfma_f32_16x16x32_bf16 v[76:79], v[20:23], a[164:167], v[76:79]
    s_waitcnt lgkmcnt(6)
    v_mfma_f32_16x16x32_bf16 v[72:75], v[24:27], a[160:163], v[72:75]
    ds_read_b128 v[20:23], v12 offset:49152
    s_add_u32 m0, s19, 59520
    v_mfma_f32_16x16x32_bf16 v[80:83], v[24:27], a[164:167], v[80:83]
    buffer_load_dwordx4 v2, s[8:11], s20 offen offset:1920 lds
    s_waitcnt lgkmcnt(6)
    v_mfma_f32_16x16x32_bf16 v[68:71], v[28:31], a[168:171], v[68:71]
    ds_read_b128 v[24:27], v12 offset:51200
    v_mfma_f32_16x16x32_bf16 v[76:79], v[28:31], a[172:175], v[76:79]
    s_add_u32 s20, s20, s24
    s_waitcnt lgkmcnt(6)
    v_mfma_f32_16x16x32_bf16 v[72:75], v[32:35], a[168:171], v[72:75]
    ds_read_b128 v[28:31], v13 offset:49152
    v_mfma_f32_16x16x32_bf16 v[80:83], v[32:35], a[172:175], v[80:83]
    s_waitcnt lgkmcnt(6)
    v_mfma_f32_16x16x32_bf16 v[68:71], v[36:39], a[176:179], v[68:71]
    ds_read_b128 v[32:35], v13 offset:51200
    v_mfma_f32_16x16x32_bf16 v[76:79], v[36:39], a[180:183], v[76:79]
    s_waitcnt lgkmcnt(6)
    v_mfma_f32_16x16x32_bf16 v[72:75], v[40:43], a[176:179], v[72:75]
    ds_read_b128 v[36:39], v12 offset:53248
    v_mfma_f32_16x16x32_bf16 v[80:83], v[40:43], a[180:183], v[80:83]
    s_waitcnt lgkmcnt(6)
    v_mfma_f32_16x16x32_bf16 v[68:71], v[44:47], a[184:187], v[68:71]
    ds_read_b128 v[40:43], v12 offset:55296
    v_mfma_f32_16x16x32_bf16 v[76:79], v[44:47], a[188:191], v[76:79]
    s_waitcnt lgkmcnt(6)
    v_mfma_f32_16x16x32_bf16 v[72:75], v[48:51], a[184:187], v[72:75]
    ds_read_b128 v[44:47], v13 offset:53248
    v_mfma_f32_16x16x32_bf16 v[80:83], v[48:51], a[188:191], v[80:83]
    s_waitcnt lgkmcnt(6)
    v_mfma_f32_16x16x32_bf16 v[68:71], v[20:23], a[192:195], v[68:71]
    ds_read_b128 v[48:51], v13 offset:55296
    v_mfma_f32_16x16x32_bf16 v[76:79], v[20:23], a[196:199], v[76:79]
    s_waitcnt lgkmcnt(6)
    v_mfma_f32_16x16x32_bf16 v[72:75], v[24:27], a[192:195], v[72:75]
    ds_read_b128 v[20:23], v12 offset:57344
    v_mfma_f32_16x16x32_bf16 v[80:83], v[24:27], a[196:199], v[80:83]
    s_waitcnt lgkmcnt(6)
    v_mfma_f32_16x16x32_bf16 v[68:71], v[28:31], a[200:203], v[68:71]
    ds_read_b128 v[24:27], v12 offset:59392
    v_mfma_f32_16x16x32_bf16 v[76:79], v[28:31], a[204:207], v[76:79]
    s_waitcnt lgkmcnt(6)
    v_mfma_f32_16x16x32_bf16 v[72:75], v[32:35], a[200:203], v[72:75]
    ds_read_b128 v[28:31], v13 offset:57344
    v_mfma_f32_16x16x32_bf16 v[80:83], v[32:35], a[204:207], v[80:83]
    s_waitcnt lgkmcnt(6)
    v_mfma_f32_16x16x32_bf16 v[68:71], v[36:39], a[208:211], v[68:71]
    ds_read_b128 v[32:35], v13 offset:59392
    v_mfma_f32_16x16x32_bf16 v[76:79], v[36:39], a[212:215], v[76:79]
    s_waitcnt lgkmcnt(6)
    v_mfma_f32_16x16x32_bf16 v[72:75], v[40:43], a[208:211], v[72:75]
    ds_read_b128 v[36:39], v12 offset:61440
    v_mfma_f32_16x16x32_bf16 v[80:83], v[40:43], a[212:215], v[80:83]
    s_waitcnt lgkmcnt(6)
    v_mfma_f32_16x16x32_bf16 v[68:71], v[44:47], a[216:219], v[68:71]
    ds_read_b128 v[40:43], v12 offset:63488
    v_mfma_f32_16x16x32_bf16 v[76:79], v[44:47], a[220:223], v[76:79]
    s_waitcnt lgkmcnt(6)
    v_mfma_f32_16x16x32_bf16 v[72:75], v[48:51], a[216:219], v[72:75]
    ds_read_b128 v[44:47], v13 offset:61440
    v_mfma_f32_16x16x32_bf16 v[80:83], v[48:51], a[220:223], v[80:83]
    s_waitcnt lgkmcnt(6)
    v_mfma_f32_16x16x32_bf16 v[68:71], v[20:23], a[224:227], v[68:71]
    ds_read_b128 v[48:51], v13 offset:63488
    v_mfma_f32_16x16x32_bf16 v[76:79], v[20:23], a[228:231], v[76:79]
    s_waitcnt lgkmcnt(6)
    v_mfma_f32_16x16x32_bf16 v[72:75], v[24:27], a[224:227], v[72:75]
    s_waitcnt vmcnt(8)
    s_barrier
    ds_read_b128 v[20:23], v10 offset:0
    v_mfma_f32_16x16x32_bf16 v[80:83], v[24:27], a[228:231], v[80:83]
    s_waitcnt lgkmcnt(6)
    v_mfma_f32_16x16x32_bf16 v[68:71], v[28:31], a[232:235], v[68:71]
    ds_read_b128 v[24:27], v10 offset:2048
    s_add_u32 m0, s19, 65536
    v_mfma_f32_16x16x32_bf16 v[76:79], v[28:31], a[236:239], v[76:79]
    buffer_load_dwordx4 v2, s[8:11], s20 offen offset:0 lds
    s_waitcnt lgkmcnt(6)
    v_mfma_f32_16x16x32_bf16 v[72:75], v[32:35], a[232:235], v[72:75]
    ds_read_b128 v[28:31], v11 offset:0
    v_mfma_f32_16x16x32_bf16 v[80:83], v[32:35], a[236:239], v[80:83]
    s_waitcnt lgkmcnt(6)
    v_mfma_f32_16x16x32_bf16 v[68:71], v[36:39], a[240:243], v[68:71]
    ds_read_b128 v[32:35], v11 offset:2048
    s_add_u32 m0, s19, 69504
    v_mfma_f32_16x16x32_bf16 v[76:79], v[36:39], a[244:247], v[76:79]
    buffer_load_dwordx4 v2, s[8:11], s20 offen offset:128 lds
    s_waitcnt lgkmcnt(6)
    v_mfma_f32_16x16x32_bf16 v[72:75], v[40:43], a[240:243], v[72:75]
    ds_read_b128 v[36:39], v10 offset:4096
    v_mfma_f32_16x16x32_bf16 v[80:83], v[40:43], a[244:247], v[80:83]
    s_waitcnt lgkmcnt(6)
    v_mfma_f32_16x16x32_bf16 v[68:71], v[44:47], a[248:251], v[68:71]
    ds_read_b128 v[40:43], v10 offset:6144
    s_add_u32 m0, s19, 73472
    v_mfma_f32_16x16x32_bf16 v[76:79], v[44:47], a[252:255], v[76:79]
    buffer_load_dwordx4 v2, s[8:11], s20 offen offset:256 lds
    s_waitcnt lgkmcnt(6)
    v_mfma_f32_16x16x32_bf16 v[72:75], v[48:51], a[248:251], v[72:75]
    ds_read_b128 v[44:47], v11 offset:4096
    v_mfma_f32_16x16x32_bf16 v[80:83], v[48:51], a[252:255], v[80:83]
    s_add_u32 s22, s22, 2
    s_cmp_lt_u32 s22, 16
    s_cbranch_scc1 F1_top
    v_cvt_pk_bf16_f32 v84, v68, v69
    v_cvt_pk_bf16_f32 v85, v70, v71
    s_nop 0
    v_cvt_pk_bf16_f32 v86, v72, v73
    v_cvt_pk_bf16_f32 v87, v74, v75
    v_cvt_pk_bf16_f32 v88, v76, v77
    v_cvt_pk_bf16_f32 v89, v78, v79
    v_cvt_pk_bf16_f32 v90, v80, v81
    v_cvt_pk_bf16_f32 v91, v82, v83
    buffer_store_dwordx4 v[84:87], v3, s[4:7], s21 offen offset:0 sc1
    buffer_store_dwordx4 v[88:91], v3, s[4:7], s21 offen offset:256 sc1
    s_waitcnt vmcnt(0) lgkmcnt(0)
    s_barrier
    v_mov_b32 v6, 0
    s_mov_b32 s18, 0
F_rdv:
    global_load_dwordx4 v[20:23], v6, s[94:95] sc1
    global_load_dwordx4 v[24:27], v6, s[94:95] offset:16 sc1
    global_load_dword v5, v6, s[94:95] offset:32 sc1
    s_waitcnt vmcnt(0)
    v_sad_u8 v5, v20, 0, v5
    v_sad_u8 v5, v21, 0, v5
    v_sad_u8 v5, v22, 0, v5
    v_sad_u8 v5, v23, 0, v5
    v_sad_u8 v5, v24, 0, v5
    v_sad_u8 v5, v25, 0, v5
    v_sad_u8 v5, v26, 0, v5
    v_sad_u8 v5, v27, 0, v5
    s_nop 0
    v_readfirstlane_b32 s17, v5
    s_nop 0
    s_cmp_ge_u32 s17, 256
    s_cbranch_scc1 F_rdv_ok
    s_sleep 8
    s_add_u32 s18, s18, 1
    s_cmp_lt_u32 s18, 1048576
    s_cbranch_scc1 F_rdv
    s_mov_b32 s92, 1048576
F_rdv_ok:
    s_lshl_b32 s31, s29, 2
    s_add_u32 s31, s31, s28
    s_lshl_b32 s17, s31, 2
    s_add_u32 s17, s17, 100732928
    v_mov_b32 v5, s17
    v_mov_b32 v6, 1
    s_mov_b64 exec, 1
    buffer_store_dword v6, v5, s[4:7], 0 offen sc1
    s_mov_b64 exec, -1
    v_and_b32 v10, 19, v1
    v_bfe_u32 v5, v1, 2, 1
    v_bfe_u32 v6, v1, 3, 1
    v_lshl_add_u32 v10, v5, 3, v10
    v_lshl_add_u32 v10, v6, 2, v10
    v_lshrrev_b32 v11, 5, v1
    v_cvt_f32_u32 v16, v10
    v_lshlrev_b32 v17, 3, v11
    v_cvt_f32_u32 v17, v17
    v_lshlrev_b32 v14, 4, v1
    v_add_f32 v5, 0, v16
    v_mul_f32 v5, 1015021568, v5
    v_mul_f32 v6, v5, v17
    v_mul_f32 v7, 0x41800000, v5
    v_fract_f32 v32, v6
    v_add_f32 v33, v32, v5
    v_add_f32 v34, v33, v5
    v_add_f32 v35, v34, v5
    v_add_f32 v36, v35, v5
    v_add_f32 v37, v36, v5
    v_add_f32 v38, v37, v5
    v_add_f32 v39, v38, v5
    v_add_f32 v6, v32, v7
    v_cos_f32 v40, v32
    v_sin_f32 v48, v32
    v_cos_f32 v41, v33
    v_sin_f32 v49, v33
    v_cos_f32 v42, v34
    v_sin_f32 v50, v34
    v_cos_f32 v43, v35
    v_sin_f32 v51, v35
    v_cos_f32 v44, v36
    v_sin_f32 v52, v36
    v_cos_f32 v45, v37
    v_sin_f32 v53, v37
    v_cos_f32 v46, v38
    v_sin_f32 v54, v38
    v_cos_f32 v47, v39
    v_sin_f32 v55, v39
    v_cvt_pk_bf16_f32 v56, v40, v41
    v_cvt_pk_bf16_f32 v57, v48, v49
    v_accvgpr_write_b32 a0, v56
    v_xor_b32 v58, 0x80008000, v57
    v_accvgpr_write_b32 a32, v57
    v_accvgpr_write_b32 a64, v58
    v_cvt_pk_bf16_f32 v56, v42, v43
    v_cvt_pk_bf16_f32 v57, v50, v51
    v_accvgpr_write_b32 a1, v56
    v_xor_b32 v58, 0x80008000, v57
    v_accvgpr_write_b32 a33, v57
    v_accvgpr_write_b32 a65, v58
    v_cvt_pk_bf16_f32 v56, v44, v45
    v_cvt_pk_bf16_f32 v57, v52, v53
    v_accvgpr_write_b32 a2, v56
    v_xor_b32 v58, 0x80008000, v57
    v_accvgpr_write_b32 a34, v57
    v_accvgpr_write_b32 a66, v58
    v_cvt_pk_bf16_f32 v56, v46, v47
    v_cvt_pk_bf16_f32 v57, v54, v55
    v_accvgpr_write_b32 a3, v56
    v_xor_b32 v58, 0x80008000, v57
    v_accvgpr_write_b32 a35, v57
    v_accvgpr_write_b32 a67, v58
    v_fract_f32 v32, v6
    v_add_f32 v33, v32, v5
    v_add_f32 v34, v33, v5
    v_add_f32 v35, v34, v5
    v_add_f32 v36, v35, v5
    v_add_f32 v37, v36, v5
    v_add_f32 v38, v37, v5
    v_add_f32 v39, v38, v5
    v_add_f32 v6, v32, v7
    v_cos_f32 v40, v32
    v_sin_f32 v48, v32
    v_cos_f32 v41, v33
    v_sin_f32 v49, v33
    v_cos_f32 v42, v34
    v_sin_f32 v50, v34
    v_cos_f32 v43, v35
    v_sin_f32 v51, v35
    v_cos_f32 v44, v36
    v_sin_f32 v52, v36
    v_cos_f32 v45, v37
    v_sin_f32 v53, v37
    v_cos_f32 v46, v38
    v_sin_f32 v54, v38
    v_cos_f32 v47, v39
    v_sin_f32 v55, v39
    v_cvt_pk_bf16_f32 v56, v40, v41
    v_cvt_pk_bf16_f32 v57, v48, v49
    v_accvgpr_write_b32 a4, v56
    v_xor_b32 v58, 0x80008000, v57
    v_accvgpr_write_b32 a36, v57
    v_accvgpr_write_b32 a68, v58
    v_cvt_pk_bf16_f32 v56, v42, v43
    v_cvt_pk_bf16_f32 v57, v50, v51
    v_accvgpr_write_b32 a5, v56
    v_xor_b32 v58, 0x80008000, v57
    v_accvgpr_write_b32 a37, v57
    v_accvgpr_write_b32 a69, v58
    v_cvt_pk_bf16_f32 v56, v44, v45
    v_cvt_pk_bf16_f32 v57, v52, v53
    v_accvgpr_write_b32 a6, v56
    v_xor_b32 v58, 0x80008000, v57
    v_accvgpr_write_b32 a38, v57
    v_accvgpr_write_b32 a70, v58
    v_cvt_pk_bf16_f32 v56, v46, v47
    v_cvt_pk_bf16_f32 v57, v54, v55
    v_accvgpr_write_b32 a7, v56
    v_xor_b32 v58, 0x80008000, v57
    v_accvgpr_write_b32 a39, v57
    v_accvgpr_write_b32 a71, v58
    v_fract_f32 v32, v6
    v_add_f32 v33, v32, v5
    v_add_f32 v34, v33, v5
    v_add_f32 v35, v34, v5
    v_add_f32 v36, v35, v5
    v_add_f32 v37, v36, v5
    v_add_f32 v38, v37, v5
    v_add_f32 v39, v38, v5
    v_add_f32 v6, v32, v7
    v_cos_f32 v40, v32
    v_sin_f32 v48, v32
    v_cos_f32 v41, v33
    v_sin_f32 v49, v33
    v_cos_f32 v42, v34
    v_sin_f32 v50, v34
    v_cos_f32 v43, v35
    v_sin_f32 v51, v35
    v_cos_f32 v44, v36
    v_sin_f32 v52, v36
    v_cos_f32 v45, v37
    v_sin_f32 v53, v37
    v_cos_f32 v46, v38
    v_sin_f32 v54, v38
    v_cos_f32 v47, v39
    v_sin_f32 v55, v39
    v_cvt_pk_bf16_f32 v56, v40, v41
    v_cvt_pk_bf16_f32 v57, v48, v49
    v_accvgpr_write_b32 a8, v56
    v_xor_b32 v58, 0x80008000, v57
    v_accvgpr_write_b32 a40, v57
    v_accvgpr_write_b32 a72, v58
    v_cvt_pk_bf16_f32 v56, v42, v43
    v_cvt_pk_bf16_f32 v57, v50, v51
    v_accvgpr_write_b32 a9, v56
    v_xor_b32 v58, 0x80008000, v57
    v_accvgpr_write_b32 a41, v57
    v_accvgpr_write_b32 a73, v58
    v_cvt_pk_bf16_f32 v56, v44, v45
    v_cvt_pk_bf16_f32 v57, v52, v53
    v_accvgpr_write_b32 a10, v56
    v_xor_b32 v58, 0x80008000, v57
    v_accvgpr_write_b32 a42, v57
    v_accvgpr_write_b32 a74, v58
    v_cvt_pk_bf16_f32 v56, v46, v47
    v_cvt_pk_bf16_f32 v57, v54, v55
    v_accvgpr_write_b32 a11, v56
    v_xor_b32 v58, 0x80008000, v57
    v_accvgpr_write_b32 a43, v57
    v_accvgpr_write_b32 a75, v58
    v_fract_f32 v32, v6
    v_add_f32 v33, v32, v5
    v_add_f32 v34, v33, v5
    v_add_f32 v35, v34, v5
    v_add_f32 v36, v35, v5
    v_add_f32 v37, v36, v5
    v_add_f32 v38, v37, v5
    v_add_f32 v39, v38, v5
    v_add_f32 v6, v32, v7
    v_cos_f32 v40, v32
    v_sin_f32 v48, v32
    v_cos_f32 v41, v33
    v_sin_f32 v49, v33
    v_cos_f32 v42, v34
    v_sin_f32 v50, v34
    v_cos_f32 v43, v35
    v_sin_f32 v51, v35
    v_cos_f32 v44, v36
    v_sin_f32 v52, v36
    v_cos_f32 v45, v37
    v_sin_f32 v53, v37
    v_cos_f32 v46, v38
    v_sin_f32 v54, v38
    v_cos_f32 v47, v39
    v_sin_f32 v55, v39
    v_cvt_pk_bf16_f32 v56, v40, v41
    v_cvt_pk_bf16_f32 v57, v48, v49
    v_accvgpr_write_b32 a12, v56
    v_xor_b32 v58, 0x80008000, v57
    v_accvgpr_write_b32 a44, v57
    v_accvgpr_write_b32 a76, v58
    v_cvt_pk_bf16_f32 v56, v42, v43
    v_cvt_pk_bf16_f32 v57, v50, v51
    v_accvgpr_write_b32 a13, v56
    v_xor_b32 v58, 0x80008000, v57
    v_accvgpr_write_b32 a45, v57
    v_accvgpr_write_b32 a77, v58
    v_cvt_pk_bf16_f32 v56, v44, v45
    v_cvt_pk_bf16_f32 v57, v52, v53
    v_accvgpr_write_b32 a14, v56
    v_xor_b32 v58, 0x80008000, v57
    v_accvgpr_write_b32 a46, v57
    v_accvgpr_write_b32 a78, v58
    v_cvt_pk_bf16_f32 v56, v46, v47
    v_cvt_pk_bf16_f32 v57, v54, v55
    v_accvgpr_write_b32 a15, v56
    v_xor_b32 v58, 0x80008000, v57
    v_accvgpr_write_b32 a47, v57
    v_accvgpr_write_b32 a79, v58
    v_add_f32 v5, 1107296256, v16
    v_mul_f32 v5, 1015021568, v5
    v_mul_f32 v6, v5, v17
    v_mul_f32 v7, 0x41800000, v5
    v_fract_f32 v32, v6
    v_add_f32 v33, v32, v5
    v_add_f32 v34, v33, v5
    v_add_f32 v35, v34, v5
    v_add_f32 v36, v35, v5
    v_add_f32 v37, v36, v5
    v_add_f32 v38, v37, v5
    v_add_f32 v39, v38, v5
    v_add_f32 v6, v32, v7
    v_cos_f32 v40, v32
    v_sin_f32 v48, v32
    v_cos_f32 v41, v33
    v_sin_f32 v49, v33
    v_cos_f32 v42, v34
    v_sin_f32 v50, v34
    v_cos_f32 v43, v35
    v_sin_f32 v51, v35
    v_cos_f32 v44, v36
    v_sin_f32 v52, v36
    v_cos_f32 v45, v37
    v_sin_f32 v53, v37
    v_cos_f32 v46, v38
    v_sin_f32 v54, v38
    v_cos_f32 v47, v39
    v_sin_f32 v55, v39
    v_cvt_pk_bf16_f32 v56, v40, v41
    v_cvt_pk_bf16_f32 v57, v48, v49
    v_accvgpr_write_b32 a16, v56
    v_xor_b32 v58, 0x80008000, v57
    v_accvgpr_write_b32 a48, v57
    v_accvgpr_write_b32 a80, v58
    v_cvt_pk_bf16_f32 v56, v42, v43
    v_cvt_pk_bf16_f32 v57, v50, v51
    v_accvgpr_write_b32 a17, v56
    v_xor_b32 v58, 0x80008000, v57
    v_accvgpr_write_b32 a49, v57
    v_accvgpr_write_b32 a81, v58
    v_cvt_pk_bf16_f32 v56, v44, v45
    v_cvt_pk_bf16_f32 v57, v52, v53
    v_accvgpr_write_b32 a18, v56
    v_xor_b32 v58, 0x80008000, v57
    v_accvgpr_write_b32 a50, v57
    v_accvgpr_write_b32 a82, v58
    v_cvt_pk_bf16_f32 v56, v46, v47
    v_cvt_pk_bf16_f32 v57, v54, v55
    v_accvgpr_write_b32 a19, v56
    v_xor_b32 v58, 0x80008000, v57
    v_accvgpr_write_b32 a51, v57
    v_accvgpr_write_b32 a83, v58
    v_fract_f32 v32, v6
    v_add_f32 v33, v32, v5
    v_add_f32 v34, v33, v5
    v_add_f32 v35, v34, v5
    v_add_f32 v36, v35, v5
    v_add_f32 v37, v36, v5
    v_add_f32 v38, v37, v5
    v_add_f32 v39, v38, v5
    v_add_f32 v6, v32, v7
    v_cos_f32 v40, v32
    v_sin_f32 v48, v32
    v_cos_f32 v41, v33
    v_sin_f32 v49, v33
    v_cos_f32 v42, v34
    v_sin_f32 v50, v34
    v_cos_f32 v43, v35
    v_sin_f32 v51, v35
    v_cos_f32 v44, v36
    v_sin_f32 v52, v36
    v_cos_f32 v45, v37
    v_sin_f32 v53, v37
    v_cos_f32 v46, v38
    v_sin_f32 v54, v38
    v_cos_f32 v47, v39
    v_sin_f32 v55, v39
    v_cvt_pk_bf16_f32 v56, v40, v41
    v_cvt_pk_bf16_f32 v57, v48, v49
    v_accvgpr_write_b32 a20, v56
    v_xor_b32 v58, 0x80008000, v57
    v_accvgpr_write_b32 a52, v57
    v_accvgpr_write_b32 a84, v58
    v_cvt_pk_bf16_f32 v56, v42, v43
    v_cvt_pk_bf16_f32 v57, v50, v51
    v_accvgpr_write_b32 a21, v56
    v_xor_b32 v58, 0x80008000, v57
    v_accvgpr_write_b32 a53, v57
    v_accvgpr_write_b32 a85, v58
    v_cvt_pk_bf16_f32 v56, v44, v45
    v_cvt_pk_bf16_f32 v57, v52, v53
    v_accvgpr_write_b32 a22, v56
    v_xor_b32 v58, 0x80008000, v57
    v_accvgpr_write_b32 a54, v57
    v_accvgpr_write_b32 a86, v58
    v_cvt_pk_bf16_f32 v56, v46, v47
    v_cvt_pk_bf16_f32 v57, v54, v55
    v_accvgpr_write_b32 a23, v56
    v_xor_b32 v58, 0x80008000, v57
    v_accvgpr_write_b32 a55, v57
    v_accvgpr_write_b32 a87, v58
    v_fract_f32 v32, v6
    v_add_f32 v33, v32, v5
    v_add_f32 v34, v33, v5
    v_add_f32 v35, v34, v5
    v_add_f32 v36, v35, v5
    v_add_f32 v37, v36, v5
    v_add_f32 v38, v37, v5
    v_add_f32 v39, v38, v5
    v_add_f32 v6, v32, v7
    v_cos_f32 v40, v32
    v_sin_f32 v48, v32
    v_cos_f32 v41, v33
    v_sin_f32 v49, v33
    v_cos_f32 v42, v34
    v_sin_f32 v50, v34
    v_cos_f32 v43, v35
    v_sin_f32 v51, v35
    v_cos_f32 v44, v36
    v_sin_f32 v52, v36
    v_cos_f32 v45, v37
    v_sin_f32 v53, v37
    v_cos_f32 v46, v38
    v_sin_f32 v54, v38
    v_cos_f32 v47, v39
    v_sin_f32 v55, v39
    v_cvt_pk_bf16_f32 v56, v40, v41
    v_cvt_pk_bf16_f32 v57, v48, v49
    v_accvgpr_write_b32 a24, v56
    v_xor_b32 v58, 0x80008000, v57
    v_accvgpr_write_b32 a56, v57
    v_accvgpr_write_b32 a88, v58
    v_cvt_pk_bf16_f32 v56, v42, v43
    v_cvt_pk_bf16_f32 v57, v50, v51
    v_accvgpr_write_b32 a25, v56
    v_xor_b32 v58, 0x80008000, v57
    v_accvgpr_write_b32 a57, v57
    v_accvgpr_write_b32 a89, v58
    v_cvt_pk_bf16_f32 v56, v44, v45
    v_cvt_pk_bf16_f32 v57, v52, v53
    v_accvgpr_write_b32 a26, v56
    v_xor_b32 v58, 0x80008000, v57
    v_accvgpr_write_b32 a58, v57
    v_accvgpr_write_b32 a90, v58
    v_cvt_pk_bf16_f32 v56, v46, v47
    v_cvt_pk_bf16_f32 v57, v54, v55
    v_accvgpr_write_b32 a27, v56
    v_xor_b32 v58, 0x80008000, v57
    v_accvgpr_write_b32 a59, v57
    v_accvgpr_write_b32 a91, v58
    v_fract_f32 v32, v6
    v_add_f32 v33, v32, v5
    v_add_f32 v34, v33, v5
    v_add_f32 v35, v34, v5
    v_add_f32 v36, v35, v5
    v_add_f32 v37, v36, v5
    v_add_f32 v38, v37, v5
    v_add_f32 v39, v38, v5
    v_add_f32 v6, v32, v7
    v_cos_f32 v40, v32
    v_sin_f32 v48, v32
    v_cos_f32 v41, v33
    v_sin_f32 v49, v33
    v_cos_f32 v42, v34
    v_sin_f32 v50, v34
    v_cos_f32 v43, v35
    v_sin_f32 v51, v35
    v_cos_f32 v44, v36
    v_sin_f32 v52, v36
    v_cos_f32 v45, v37
    v_sin_f32 v53, v37
    v_cos_f32 v46, v38
    v_sin_f32 v54, v38
    v_cos_f32 v47, v39
    v_sin_f32 v55, v39
    v_cvt_pk_bf16_f32 v56, v40, v41
    v_cvt_pk_bf16_f32 v57, v48, v49
    v_accvgpr_write_b32 a28, v56
    v_xor_b32 v58, 0x80008000, v57
    v_accvgpr_write_b32 a60, v57
    v_accvgpr_write_b32 a92, v58
    v_cvt_pk_bf16_f32 v56, v42, v43
    v_cvt_pk_bf16_f32 v57, v50, v51
    v_accvgpr_write_b32 a29, v56
    v_xor_b32 v58, 0x80008000, v57
    v_accvgpr_write_b32 a61, v57
    v_accvgpr_write_b32 a93, v58
    v_cvt_pk_bf16_f32 v56, v44, v45
    v_cvt_pk_bf16_f32 v57, v52, v53
    v_accvgpr_write_b32 a30, v56
    v_xor_b32 v58, 0x80008000, v57
    v_accvgpr_write_b32 a62, v57
    v_accvgpr_write_b32 a94, v58
    v_cvt_pk_bf16_f32 v56, v46, v47
    v_cvt_pk_bf16_f32 v57, v54, v55
    v_accvgpr_write_b32 a31, v56
    v_xor_b32 v58, 0x80008000, v57
    v_accvgpr_write_b32 a63, v57
    v_accvgpr_write_b32 a95, v58
    v_add_f32 v5, 0, v16
    v_mul_f32 v5, 1023410176, v5
    v_mul_f32 v6, v5, v17
    v_mul_f32 v7, 0x41800000, v5
    v_fract_f32 v32, v6
    v_add_f32 v33, v32, v5
    v_add_f32 v34, v33, v5
    v_add_f32 v35, v34, v5
    v_add_f32 v36, v35, v5
    v_add_f32 v37, v36, v5
    v_add_f32 v38, v37, v5
    v_add_f32 v39, v38, v5
    v_add_f32 v6, v32, v7
    v_cos_f32 v40, v32
    v_sin_f32 v48, v32
    v_cos_f32 v41, v33
    v_sin_f32 v49, v33
    v_cos_f32 v42, v34
    v_sin_f32 v50, v34
    v_cos_f32 v43, v35
    v_sin_f32 v51, v35
    v_cos_f32 v44, v36
    v_sin_f32 v52, v36
    v_cos_f32 v45, v37
    v_sin_f32 v53, v37
    v_cos_f32 v46, v38
    v_sin_f32 v54, v38
    v_cos_f32 v47, v39
    v_sin_f32 v55, v39
    v_cvt_pk_bf16_f32 v56, v40, v41
    v_cvt_pk_bf16_f32 v57, v48, v49
    v_accvgpr_write_b32 a96, v56
    v_xor_b32 v58, 0x80008000, v57
    v_accvgpr_write_b32 a104, v57
    v_accvgpr_write_b32 a112, v58
    v_cvt_pk_bf16_f32 v56, v42, v43
    v_cvt_pk_bf16_f32 v57, v50, v51
    v_accvgpr_write_b32 a97, v56
    v_xor_b32 v58, 0x80008000, v57
    v_accvgpr_write_b32 a105, v57
    v_accvgpr_write_b32 a113, v58
    v_cvt_pk_bf16_f32 v56, v44, v45
    v_cvt_pk_bf16_f32 v57, v52, v53
    v_accvgpr_write_b32 a98, v56
    v_xor_b32 v58, 0x80008000, v57
    v_accvgpr_write_b32 a106, v57
    v_accvgpr_write_b32 a114, v58
    v_cvt_pk_bf16_f32 v56, v46, v47
    v_cvt_pk_bf16_f32 v57, v54, v55
    v_accvgpr_write_b32 a99, v56
    v_xor_b32 v58, 0x80008000, v57
    v_accvgpr_write_b32 a107, v57
    v_accvgpr_write_b32 a115, v58
    v_fract_f32 v32, v6
    v_add_f32 v33, v32, v5
    v_add_f32 v34, v33, v5
    v_add_f32 v35, v34, v5
    v_add_f32 v36, v35, v5
    v_add_f32 v37, v36, v5
    v_add_f32 v38, v37, v5
    v_add_f32 v39, v38, v5
    v_add_f32 v6, v32, v7
    v_cos_f32 v40, v32
    v_sin_f32 v48, v32
    v_cos_f32 v41, v33
    v_sin_f32 v49, v33
    v_cos_f32 v42, v34
    v_sin_f32 v50, v34
    v_cos_f32 v43, v35
    v_sin_f32 v51, v35
    v_cos_f32 v44, v36
    v_sin_f32 v52, v36
    v_cos_f32 v45, v37
    v_sin_f32 v53, v37
    v_cos_f32 v46, v38
    v_sin_f32 v54, v38
    v_cos_f32 v47, v39
    v_sin_f32 v55, v39
    v_cvt_pk_bf16_f32 v56, v40, v41
    v_cvt_pk_bf16_f32 v57, v48, v49
    v_accvgpr_write_b32 a100, v56
    v_xor_b32 v58, 0x80008000, v57
    v_accvgpr_write_b32 a108, v57
    v_accvgpr_write_b32 a116, v58
    v_cvt_pk_bf16_f32 v56, v42, v43
    v_cvt_pk_bf16_f32 v57, v50, v51
    v_accvgpr_write_b32 a101, v56
    v_xor_b32 v58, 0x80008000, v57
    v_accvgpr_write_b32 a109, v57
    v_accvgpr_write_b32 a117, v58
    v_cvt_pk_bf16_f32 v56, v44, v45
    v_cvt_pk_bf16_f32 v57, v52, v53
    v_accvgpr_write_b32 a102, v56
    v_xor_b32 v58, 0x80008000, v57
    v_accvgpr_write_b32 a110, v57
    v_accvgpr_write_b32 a118, v58
    v_cvt_pk_bf16_f32 v56, v46, v47
    v_cvt_pk_bf16_f32 v57, v54, v55
    v_accvgpr_write_b32 a103, v56
    v_xor_b32 v58, 0x80008000, v57
    v_accvgpr_write_b32 a111, v57
    v_accvgpr_write_b32 a119, v58
    v_add_f32 v5, 0, v16
    v_mul_f32 v5, 973078528, v5
    v_add_f32 v6, 0, v17
    v_mul_f32 v6, v6, v5
    v_cos_f32 v160, v6
    v_sin_f32 v176, v6
    v_add_f32 v6, 1065353216, v17
    v_mul_f32 v6, v6, v5
    v_cos_f32 v161, v6
    v_sin_f32 v177, v6
    v_add_f32 v6, 1073741824, v17
    v_mul_f32 v6, v6, v5
    v_cos_f32 v162, v6
    v_sin_f32 v178, v6
    v_add_f32 v6, 1077936128, v17
    v_mul_f32 v6, v6, v5
    v_cos_f32 v163, v6
    v_sin_f32 v179, v6
    v_add_f32 v6, 1082130432, v17
    v_mul_f32 v6, v6, v5
    v_cos_f32 v164, v6
    v_sin_f32 v180, v6
    v_add_f32 v6, 1084227584, v17
    v_mul_f32 v6, v6, v5
    v_cos_f32 v165, v6
    v_sin_f32 v181, v6
    v_add_f32 v6, 1086324736, v17
    v_mul_f32 v6, v6, v5
    v_cos_f32 v166, v6
    v_sin_f32 v182, v6
    v_add_f32 v6, 1088421888, v17
    v_mul_f32 v6, v6, v5
    v_cos_f32 v167, v6
    v_sin_f32 v183, v6
    v_add_f32 v6, 1098907648, v17
    v_mul_f32 v6, v6, v5
    v_cos_f32 v168, v6
    v_sin_f32 v184, v6
    v_add_f32 v6, 1099431936, v17
    v_mul_f32 v6, v6, v5
    v_cos_f32 v169, v6
    v_sin_f32 v185, v6
    v_add_f32 v6, 1099956224, v17
    v_mul_f32 v6, v6, v5
    v_cos_f32 v170, v6
    v_sin_f32 v186, v6
    v_add_f32 v6, 1100480512, v17
    v_mul_f32 v6, v6, v5
    v_cos_f32 v171, v6
    v_sin_f32 v187, v6
    v_add_f32 v6, 1101004800, v17
    v_mul_f32 v6, v6, v5
    v_cos_f32 v172, v6
    v_sin_f32 v188, v6
    v_add_f32 v6, 1101529088, v17
    v_mul_f32 v6, v6, v5
    v_cos_f32 v173, v6
    v_sin_f32 v189, v6
    v_add_f32 v6, 1102053376, v17
    v_mul_f32 v6, v6, v5
    v_cos_f32 v174, v6
    v_sin_f32 v190, v6
    v_add_f32 v6, 1102577664, v17
    v_mul_f32 v6, v6, v5
    v_cos_f32 v175, v6
    v_sin_f32 v191, v6
    v_add_f32 v5, 1107296256, v16
    v_mul_f32 v5, 973078528, v5
    v_add_f32 v6, 0, v17
    v_mul_f32 v6, v6, v5
    v_cos_f32 v192, v6
    v_sin_f32 v208, v6
    v_add_f32 v6, 1065353216, v17
    v_mul_f32 v6, v6, v5
    v_cos_f32 v193, v6
    v_sin_f32 v209, v6
    v_add_f32 v6, 1073741824, v17
    v_mul_f32 v6, v6, v5
    v_cos_f32 v194, v6
    v_sin_f32 v210, v6
    v_add_f32 v6, 1077936128, v17
    v_mul_f32 v6, v6, v5
    v_cos_f32 v195, v6
    v_sin_f32 v211, v6
    v_add_f32 v6, 1082130432, v17
    v_mul_f32 v6, v6, v5
    v_cos_f32 v196, v6
    v_sin_f32 v212, v6
    v_add_f32 v6, 1084227584, v17
    v_mul_f32 v6, v6, v5
    v_cos_f32 v197, v6
    v_sin_f32 v213, v6
    v_add_f32 v6, 1086324736, v17
    v_mul_f32 v6, v6, v5
    v_cos_f32 v198, v6
    v_sin_f32 v214, v6
    v_add_f32 v6, 1088421888, v17
    v_mul_f32 v6, v6, v5
    v_cos_f32 v199, v6
    v_sin_f32 v215, v6
    v_add_f32 v6, 1098907648, v17
    v_mul_f32 v6, v6, v5
    v_cos_f32 v200, v6
    v_sin_f32 v216, v6
    v_add_f32 v6, 1099431936, v17
    v_mul_f32 v6, v6, v5
    v_cos_f32 v201, v6
    v_sin_f32 v217, v6
    v_add_f32 v6, 1099956224, v17
    v_mul_f32 v6, v6, v5
    v_cos_f32 v202, v6
    v_sin_f32 v218, v6
    v_add_f32 v6, 1100480512, v17
    v_mul_f32 v6, v6, v5
    v_cos_f32 v203, v6
    v_sin_f32 v219, v6
    v_add_f32 v6, 1101004800, v17
    v_mul_f32 v6, v6, v5
    v_cos_f32 v204, v6
    v_sin_f32 v220, v6
    v_add_f32 v6, 1101529088, v17
    v_mul_f32 v6, v6, v5
    v_cos_f32 v205, v6
    v_sin_f32 v221, v6
    v_add_f32 v6, 1102053376, v17
    v_mul_f32 v6, v6, v5
    v_cos_f32 v206, v6
    v_sin_f32 v222, v6
    v_add_f32 v6, 1102577664, v17
    v_mul_f32 v6, v6, v5
    v_cos_f32 v207, v6
    v_sin_f32 v223, v6
    v_add_f32 v5, 0, v16
    v_mul_f32 v5, 973078528, v5
    v_add_f32 v6, 1107296256, v17
    v_mul_f32 v6, v6, v5
    v_cos_f32 v224, v6
    v_sin_f32 v240, v6
    v_add_f32 v6, 1107558400, v17
    v_mul_f32 v6, v6, v5
    v_cos_f32 v225, v6
    v_sin_f32 v241, v6
    v_add_f32 v6, 1107820544, v17
    v_mul_f32 v6, v6, v5
    v_cos_f32 v226, v6
    v_sin_f32 v242, v6
    v_add_f32 v6, 1108082688, v17
    v_mul_f32 v6, v6, v5
    v_cos_f32 v227, v6
    v_sin_f32 v243, v6
    v_add_f32 v6, 1108344832, v17
    v_mul_f32 v6, v6, v5
    v_cos_f32 v228, v6
    v_sin_f32 v244, v6
    v_add_f32 v6, 1108606976, v17
    v_mul_f32 v6, v6, v5
    v_cos_f32 v229, v6
    v_sin_f32 v245, v6
    v_add_f32 v6, 1108869120, v17
    v_mul_f32 v6, v6, v5
    v_cos_f32 v230, v6
    v_sin_f32 v246, v6
    v_add_f32 v6, 1109131264, v17
    v_mul_f32 v6, v6, v5
    v_cos_f32 v231, v6
    v_sin_f32 v247, v6
    v_add_f32 v6, 1111490560, v17
    v_mul_f32 v6, v6, v5
    v_cos_f32 v232, v6
    v_sin_f32 v248, v6
    v_add_f32 v6, 1111752704, v17
    v_mul_f32 v6, v6, v5
    v_cos_f32 v233, v6
    v_sin_f32 v249, v6
    v_add_f32 v6, 1112014848, v17
    v_mul_f32 v6, v6, v5
    v_cos_f32 v234, v6
    v_sin_f32 v250, v6
    v_add_f32 v6, 1112276992, v17
    v_mul_f32 v6, v6, v5
    v_cos_f32 v235, v6
    v_sin_f32 v251, v6
    v_add_f32 v6, 1112539136, v17
    v_mul_f32 v6, v6, v5
    v_cos_f32 v236, v6
    v_sin_f32 v252, v6
    v_add_f32 v6, 1112801280, v17
    v_mul_f32 v6, v6, v5
    v_cos_f32 v237, v6
    v_sin_f32 v253, v6
    v_add_f32 v6, 1113063424, v17
    v_mul_f32 v6, v6, v5
    v_cos_f32 v238, v6
    v_sin_f32 v254, v6
    v_add_f32 v6, 1113325568, v17
    v_mul_f32 v6, v6, v5
    v_cos_f32 v239, v6
    v_sin_f32 v255, v6
    v_lshlrev_b32 v15, 4, v11
    v_lshl_add_u32 v15, v10, 11, v15
    v_lshlrev_b32 v18, 12, v11
    v_lshl_add_u32 v18, v10, 4, v18
    s_mul_i32 s32, s91, 133120
    s_lshl_b32 s17, s16, 9
    s_add_u32 s32, s32, s17
    s_add_u32 s32, s32, 104857600
    s_add_u32 s33, s32, 64
    s_lshl_b32 s31, s91, 2
    s_add_u32 s31, s31, s16
    s_lshl_b32 s34, s31, 15
    s_add_u32 s34, s34, 117440512
    s_mov_b32 s38, 0xffff0000
    s_mov_b32 s36, 0
    s_cmp_eq_u32 s31, 0
    s_cselect_b32 s37, 5, 4
    s_cselect_b32 s33, 1073741824, s33
    s_mov_b32 s35, 897581056
    s_cselect_b32 s35, 889192448, s35
    v_and_b32 v7, 3, v1
    v_lshlrev_b32 v7, 2, v7
    s_lshl_b32 s17, s91, 4
    s_add_u32 s17, s17, 100732928
    v_add_u32 v7, s17, v7
    s_mov_b32 s30, s92
F2_w:
    buffer_load_dword v5, v7, s[4:7], 0 offen sc1
    s_waitcnt vmcnt(0)
    v_cmp_gt_u32 vcc, 1, v5
    s_nop 0
    s_and_b32 s17, vcc_lo, 15
    s_cbranch_scc0 F2_w_ok
    s_cmp_ge_u32 s30, 1048576
    s_cselect_b32 s92, 1048576, s92
    s_cbranch_scc1 F2_w_ok
    s_add_u32 s30, s30, 1
    s_sleep 8
    s_branch F2_w
F2_w_ok:
F2_top:
    s_add_u32 s17, s32, 65536
    buffer_load_dwordx4 v[96:99], v15, s[4:7], s32 offen offset:0 sc1
    buffer_load_dwordx4 v[100:103], v15, s[4:7], s32 offen offset:32 sc1
    buffer_load_dwordx4 v[104:107], v15, s[4:7], s17 offen offset:0 sc1
    buffer_load_dwordx4 v[108:111], v15, s[4:7], s17 offen offset:32 sc1
    s_add_u32 s17, s33, 65536
    buffer_load_dwordx4 v[112:115], v15, s[4:7], s33 offen offset:0 sc1
    buffer_load_dwordx4 v[116:119], v15, s[4:7], s33 offen offset:32 sc1
    buffer_load_dwordx4 v[120:123], v15, s[4:7], s17 offen offset:0 sc1
    buffer_load_dwordx4 v[124:127], v15, s[4:7], s17 offen offset:32 sc1
    s_add_u32 s17, s34, 4096
    buffer_load_dwordx4 v[128:131], v14, s[4:7], s34 offen offset:0 sc1
    buffer_load_dwordx4 v[132:135], v14, s[4:7], s34 offen offset:1024 sc1
    buffer_load_dwordx4 v[136:139], v14, s[4:7], s34 offen offset:2048 sc1
    buffer_load_dwordx4 v[140:143], v14, s[4:7], s34 offen offset:3072 sc1
    buffer_load_dwordx4 v[144:147], v14, s[4:7], s17 offen offset:0 sc1
    buffer_load_dwordx4 v[148:151], v14, s[4:7], s17 offen offset:1024 sc1
    buffer_load_dwordx4 v[152:155], v14, s[4:7], s17 offen offset:2048 sc1
    buffer_load_dwordx4 v[156:159], v14, s[4:7], s17 offen offset:3072 sc1
    s_waitcnt vmcnt(8)
    v_mfma_f32_32x32x16_bf16 v[32:47], v[96:99], a[0:3], 0
    v_mfma_f32_32x32x16_bf16 v[48:63], v[112:115], a[0:3], 0
    v_mfma_f32_32x32x16_bf16 v[32:47], v[112:115], a[32:35], v[32:47]
    v_mfma_f32_32x32x16_bf16 v[48:63], v[96:99], a[64:67], v[48:63]
    v_mfma_f32_32x32x16_bf16 v[32:47], v[100:103], a[4:7], v[32:47]
    v_mfma_f32_32x32x16_bf16 v[48:63], v[116:119], a[4:7], v[48:63]
    v_mfma_f32_32x32x16_bf16 v[32:47], v[116:119], a[36:39], v[32:47]
    v_mfma_f32_32x32x16_bf16 v[48:63], v[100:103], a[68:71], v[48:63]
    v_mfma_f32_32x32x16_bf16 v[32:47], v[104:107], a[8:11], v[32:47]
    v_mfma_f32_32x32x16_bf16 v[48:63], v[120:123], a[8:11], v[48:63]
    v_mfma_f32_32x32x16_bf16 v[32:47], v[120:123], a[40:43], v[32:47]
    v_mfma_f32_32x32x16_bf16 v[48:63], v[104:107], a[72:75], v[48:63]
    v_mfma_f32_32x32x16_bf16 v[32:47], v[108:111], a[12:15], v[32:47]
    v_mfma_f32_32x32x16_bf16 v[48:63], v[124:127], a[12:15], v[48:63]
    v_mfma_f32_32x32x16_bf16 v[32:47], v[124:127], a[44:47], v[32:47]
    v_mfma_f32_32x32x16_bf16 v[48:63], v[108:111], a[76:79], v[48:63]
    v_mfma_f32_32x32x16_bf16 v[64:79], v[96:99], a[16:19], 0
    v_mfma_f32_32x32x16_bf16 v[80:95], v[112:115], a[16:19], 0
    v_mfma_f32_32x32x16_bf16 v[64:79], v[112:115], a[48:51], v[64:79]
    v_mfma_f32_32x32x16_bf16 v[80:95], v[96:99], a[80:83], v[80:95]
    v_mfma_f32_32x32x16_bf16 v[64:79], v[100:103], a[20:23], v[64:79]
    v_mfma_f32_32x32x16_bf16 v[80:95], v[116:119], a[20:23], v[80:95]
    v_mfma_f32_32x32x16_bf16 v[64:79], v[116:119], a[52:55], v[64:79]
    v_mfma_f32_32x32x16_bf16 v[80:95], v[100:103], a[84:87], v[80:95]
    v_mfma_f32_32x32x16_bf16 v[64:79], v[104:107], a[24:27], v[64:79]
    v_mfma_f32_32x32x16_bf16 v[80:95], v[120:123], a[24:27], v[80:95]
    v_mfma_f32_32x32x16_bf16 v[64:79], v[120:123], a[56:59], v[64:79]
    v_mfma_f32_32x32x16_bf16 v[80:95], v[104:107], a[88:91], v[80:95]
    v_mfma_f32_32x32x16_bf16 v[64:79], v[108:111], a[28:31], v[64:79]
    v_mfma_f32_32x32x16_bf16 v[80:95], v[124:127], a[28:31], v[80:95]
    v_mfma_f32_32x32x16_bf16 v[64:79], v[124:127], a[60:63], v[64:79]
    v_mfma_f32_32x32x16_bf16 v[80:95], v[108:111], a[92:95], v[80:95]
    v_mul_f32 v5, v32, v160
    v_mul_f32 v7, v48, v160
    v_fma_f32 v5, v48, v176, v5
    v_fma_f32 v7, -v32, v176, v7
    v_mul_f32 v6, v33, v161
    v_mul_f32 v8, v49, v161
    v_fma_f32 v6, v49, v177, v6
    v_fma_f32 v8, -v33, v177, v8
    v_cvt_pk_bf16_f32 v96, v5, v6
    v_cvt_pk_bf16_f32 v112, v7, v8
    v_mul_f32 v5, v34, v162
    v_mul_f32 v7, v50, v162
    v_fma_f32 v5, v50, v178, v5
    v_fma_f32 v7, -v34, v178, v7
    v_mul_f32 v6, v35, v163
    v_mul_f32 v8, v51, v163
    v_fma_f32 v6, v51, v179, v6
    v_fma_f32 v8, -v35, v179, v8
    v_cvt_pk_bf16_f32 v97, v5, v6
    v_cvt_pk_bf16_f32 v113, v7, v8
    v_mul_f32 v5, v36, v164
    v_mul_f32 v7, v52, v164
    v_fma_f32 v5, v52, v180, v5
    v_fma_f32 v7, -v36, v180, v7
    v_mul_f32 v6, v37, v165
    v_mul_f32 v8, v53, v165
    v_fma_f32 v6, v53, v181, v6
    v_fma_f32 v8, -v37, v181, v8
    v_cvt_pk_bf16_f32 v98, v5, v6
    v_cvt_pk_bf16_f32 v114, v7, v8
    v_mul_f32 v5, v38, v166
    v_mul_f32 v7, v54, v166
    v_fma_f32 v5, v54, v182, v5
    v_fma_f32 v7, -v38, v182, v7
    v_mul_f32 v6, v39, v167
    v_mul_f32 v8, v55, v167
    v_fma_f32 v6, v55, v183, v6
    v_fma_f32 v8, -v39, v183, v8
    v_cvt_pk_bf16_f32 v99, v5, v6
    v_cvt_pk_bf16_f32 v115, v7, v8
    v_mul_f32 v5, v40, v168
    v_mul_f32 v7, v56, v168
    v_fma_f32 v5, v56, v184, v5
    v_fma_f32 v7, -v40, v184, v7
    v_mul_f32 v6, v41, v169
    v_mul_f32 v8, v57, v169
    v_fma_f32 v6, v57, v185, v6
    v_fma_f32 v8, -v41, v185, v8
    v_cvt_pk_bf16_f32 v100, v5, v6
    v_cvt_pk_bf16_f32 v116, v7, v8
    v_mul_f32 v5, v42, v170
    v_mul_f32 v7, v58, v170
    v_fma_f32 v5, v58, v186, v5
    v_fma_f32 v7, -v42, v186, v7
    v_mul_f32 v6, v43, v171
    v_mul_f32 v8, v59, v171
    v_fma_f32 v6, v59, v187, v6
    v_fma_f32 v8, -v43, v187, v8
    v_cvt_pk_bf16_f32 v101, v5, v6
    v_cvt_pk_bf16_f32 v117, v7, v8
    v_mul_f32 v5, v44, v172
    v_mul_f32 v7, v60, v172
    v_fma_f32 v5, v60, v188, v5
    v_fma_f32 v7, -v44, v188, v7
    v_mul_f32 v6, v45, v173
    v_mul_f32 v8, v61, v173
    v_fma_f32 v6, v61, v189, v6
    v_fma_f32 v8, -v45, v189, v8
    v_cvt_pk_bf16_f32 v102, v5, v6
    v_cvt_pk_bf16_f32 v118, v7, v8
    v_mul_f32 v5, v46, v174
    v_mul_f32 v7, v62, v174
    v_fma_f32 v5, v62, v190, v5
    v_fma_f32 v7, -v46, v190, v7
    v_mul_f32 v6, v47, v175
    v_mul_f32 v8, v63, v175
    v_fma_f32 v6, v63, v191, v6
    v_fma_f32 v8, -v47, v191, v8
    v_cvt_pk_bf16_f32 v103, v5, v6
    v_cvt_pk_bf16_f32 v119, v7, v8
    v_mul_f32 v5, v64, v192
    v_mul_f32 v7, v80, v192
    v_fma_f32 v5, v80, v208, v5
    v_fma_f32 v7, -v64, v208, v7
    v_mul_f32 v6, v65, v193
    v_mul_f32 v8, v81, v193
    v_fma_f32 v6, v81, v209, v6
    v_fma_f32 v8, -v65, v209, v8
    v_cvt_pk_bf16_f32 v104, v5, v6
    v_cvt_pk_bf16_f32 v120, v7, v8
    v_mul_f32 v5, v66, v194
    v_mul_f32 v7, v82, v194
    v_fma_f32 v5, v82, v210, v5
    v_fma_f32 v7, -v66, v210, v7
    v_mul_f32 v6, v67, v195
    v_mul_f32 v8, v83, v195
    v_fma_f32 v6, v83, v211, v6
    v_fma_f32 v8, -v67, v211, v8
    v_cvt_pk_bf16_f32 v105, v5, v6
    v_cvt_pk_bf16_f32 v121, v7, v8
    v_mul_f32 v5, v68, v196
    v_mul_f32 v7, v84, v196
    v_fma_f32 v5, v84, v212, v5
    v_fma_f32 v7, -v68, v212, v7
    v_mul_f32 v6, v69, v197
    v_mul_f32 v8, v85, v197
    v_fma_f32 v6, v85, v213, v6
    v_fma_f32 v8, -v69, v213, v8
    v_cvt_pk_bf16_f32 v106, v5, v6
    v_cvt_pk_bf16_f32 v122, v7, v8
    v_mul_f32 v5, v70, v198
    v_mul_f32 v7, v86, v198
    v_fma_f32 v5, v86, v214, v5
    v_fma_f32 v7, -v70, v214, v7
    v_mul_f32 v6, v71, v199
    v_mul_f32 v8, v87, v199
    v_fma_f32 v6, v87, v215, v6
    v_fma_f32 v8, -v71, v215, v8
    v_cvt_pk_bf16_f32 v107, v5, v6
    v_cvt_pk_bf16_f32 v123, v7, v8
    v_mul_f32 v5, v72, v200
    v_mul_f32 v7, v88, v200
    v_fma_f32 v5, v88, v216, v5
    v_fma_f32 v7, -v72, v216, v7
    v_mul_f32 v6, v73, v201
    v_mul_f32 v8, v89, v201
    v_fma_f32 v6, v89, v217, v6
    v_fma_f32 v8, -v73, v217, v8
    v_cvt_pk_bf16_f32 v108, v5, v6
    v_cvt_pk_bf16_f32 v124, v7, v8
    v_mul_f32 v5, v74, v202
    v_mul_f32 v7, v90, v202
    v_fma_f32 v5, v90, v218, v5
    v_fma_f32 v7, -v74, v218, v7
    v_mul_f32 v6, v75, v203
    v_mul_f32 v8, v91, v203
    v_fma_f32 v6, v91, v219, v6
    v_fma_f32 v8, -v75, v219, v8
    v_cvt_pk_bf16_f32 v109, v5, v6
    v_cvt_pk_bf16_f32 v125, v7, v8
    v_mul_f32 v5, v76, v204
    v_mul_f32 v7, v92, v204
    v_fma_f32 v5, v92, v220, v5
    v_fma_f32 v7, -v76, v220, v7
    v_mul_f32 v6, v77, v205
    v_mul_f32 v8, v93, v205
    v_fma_f32 v6, v93, v221, v6
    v_fma_f32 v8, -v77, v221, v8
    v_cvt_pk_bf16_f32 v110, v5, v6
    v_cvt_pk_bf16_f32 v126, v7, v8
    v_mul_f32 v5, v78, v206
    v_mul_f32 v7, v94, v206
    v_fma_f32 v5, v94, v222, v5
    v_fma_f32 v7, -v78, v222, v7
    v_mul_f32 v6, v79, v207
    v_mul_f32 v8, v95, v207
    v_fma_f32 v6, v95, v223, v6
    v_fma_f32 v8, -v79, v223, v8
    v_cvt_pk_bf16_f32 v111, v5, v6
    v_cvt_pk_bf16_f32 v127, v7, v8
    v_mfma_f32_32x32x16_bf16 v[32:47], a[96:99], v[96:99], 0
    v_mfma_f32_32x32x16_bf16 v[48:63], a[96:99], v[112:115], 0
    v_mfma_f32_32x32x16_bf16 v[32:47], a[104:107], v[112:115], v[32:47]
    v_mfma_f32_32x32x16_bf16 v[48:63], a[112:115], v[96:99], v[48:63]
    v_mfma_f32_32x32x16_bf16 v[32:47], a[100:103], v[100:103], v[32:47]
    v_mfma_f32_32x32x16_bf16 v[48:63], a[100:103], v[116:119], v[48:63]
    v_mfma_f32_32x32x16_bf16 v[32:47], a[108:111], v[116:119], v[32:47]
    v_mfma_f32_32x32x16_bf16 v[48:63], a[116:119], v[100:103], v[48:63]
    v_mfma_f32_32x32x16_bf16 v[64:79], a[96:99], v[104:107], 0
    v_mfma_f32_32x32x16_bf16 v[80:95], a[96:99], v[120:123], 0
    v_mfma_f32_32x32x16_bf16 v[64:79], a[104:107], v[120:123], v[64:79]
    v_mfma_f32_32x32x16_bf16 v[80:95], a[112:115], v[104:107], v[80:95]
    v_mfma_f32_32x32x16_bf16 v[64:79], a[100:103], v[108:111], v[64:79]
    v_mfma_f32_32x32x16_bf16 v[80:95], a[100:103], v[124:127], v[80:95]
    v_mfma_f32_32x32x16_bf16 v[64:79], a[108:111], v[124:127], v[64:79]
    v_mfma_f32_32x32x16_bf16 v[80:95], a[116:119], v[108:111], v[80:95]
    s_waitcnt vmcnt(0)
    v_lshlrev_b32 v20, 16, v128
    v_and_b32 v22, s38, v128
    v_mul_f32 v5, v32, v20
    v_mul_f32 v7, v48, v20
    v_fma_f32 v5, -v48, v22, v5
    v_fma_f32 v7, v32, v22, v7
    v_lshlrev_b32 v21, 16, v129
    v_and_b32 v23, s38, v129
    v_mul_f32 v6, v33, v21
    v_mul_f32 v8, v49, v21
    v_fma_f32 v6, -v49, v23, v6
    v_fma_f32 v8, v33, v23, v8
    v_cvt_pk_bf16_f32 v96, v5, v6
    v_cvt_pk_bf16_f32 v112, v7, v8
    v_lshlrev_b32 v20, 16, v130
    v_and_b32 v22, s38, v130
    v_mul_f32 v5, v34, v20
    v_mul_f32 v7, v50, v20
    v_fma_f32 v5, -v50, v22, v5
    v_fma_f32 v7, v34, v22, v7
    v_lshlrev_b32 v21, 16, v131
    v_and_b32 v23, s38, v131
    v_mul_f32 v6, v35, v21
    v_mul_f32 v8, v51, v21
    v_fma_f32 v6, -v51, v23, v6
    v_fma_f32 v8, v35, v23, v8
    v_cvt_pk_bf16_f32 v97, v5, v6
    v_cvt_pk_bf16_f32 v113, v7, v8
    v_lshlrev_b32 v20, 16, v132
    v_and_b32 v22, s38, v132
    v_mul_f32 v5, v36, v20
    v_mul_f32 v7, v52, v20
    v_fma_f32 v5, -v52, v22, v5
    v_fma_f32 v7, v36, v22, v7
    v_lshlrev_b32 v21, 16, v133
    v_and_b32 v23, s38, v133
    v_mul_f32 v6, v37, v21
    v_mul_f32 v8, v53, v21
    v_fma_f32 v6, -v53, v23, v6
    v_fma_f32 v8, v37, v23, v8
    v_cvt_pk_bf16_f32 v98, v5, v6
    v_cvt_pk_bf16_f32 v114, v7, v8
    v_lshlrev_b32 v20, 16, v134
    v_and_b32 v22, s38, v134
    v_mul_f32 v5, v38, v20
    v_mul_f32 v7, v54, v20
    v_fma_f32 v5, -v54, v22, v5
    v_fma_f32 v7, v38, v22, v7
    v_lshlrev_b32 v21, 16, v135
    v_and_b32 v23, s38, v135
    v_mul_f32 v6, v39, v21
    v_mul_f32 v8, v55, v21
    v_fma_f32 v6, -v55, v23, v6
    v_fma_f32 v8, v39, v23, v8
    v_cvt_pk_bf16_f32 v99, v5, v6
    v_cvt_pk_bf16_f32 v115, v7, v8
    v_lshlrev_b32 v20, 16, v136
    v_and_b32 v22, s38, v136
    v_mul_f32 v5, v40, v20
    v_mul_f32 v7, v56, v20
    v_fma_f32 v5, -v56, v22, v5
    v_fma_f32 v7, v40, v22, v7
    v_lshlrev_b32 v21, 16, v137
    v_and_b32 v23, s38, v137
    v_mul_f32 v6, v41, v21
    v_mul_f32 v8, v57, v21
    v_fma_f32 v6, -v57, v23, v6
    v_fma_f32 v8, v41, v23, v8
    v_cvt_pk_bf16_f32 v100, v5, v6
    v_cvt_pk_bf16_f32 v116, v7, v8
    v_lshlrev_b32 v20, 16, v138
    v_and_b32 v22, s38, v138
    v_mul_f32 v5, v42, v20
    v_mul_f32 v7, v58, v20
    v_fma_f32 v5, -v58, v22, v5
    v_fma_f32 v7, v42, v22, v7
    v_lshlrev_b32 v21, 16, v139
    v_and_b32 v23, s38, v139
    v_mul_f32 v6, v43, v21
    v_mul_f32 v8, v59, v21
    v_fma_f32 v6, -v59, v23, v6
    v_fma_f32 v8, v43, v23, v8
    v_cvt_pk_bf16_f32 v101, v5, v6
    v_cvt_pk_bf16_f32 v117, v7, v8
    v_lshlrev_b32 v20, 16, v140
    v_and_b32 v22, s38, v140
    v_mul_f32 v5, v44, v20
    v_mul_f32 v7, v60, v20
    v_fma_f32 v5, -v60, v22, v5
    v_fma_f32 v7, v44, v22, v7
    v_lshlrev_b32 v21, 16, v141
    v_and_b32 v23, s38, v141
    v_mul_f32 v6, v45, v21
    v_mul_f32 v8, v61, v21
    v_fma_f32 v6, -v61, v23, v6
    v_fma_f32 v8, v45, v23, v8
    v_cvt_pk_bf16_f32 v102, v5, v6
    v_cvt_pk_bf16_f32 v118, v7, v8
    v_lshlrev_b32 v20, 16, v142
    v_and_b32 v22, s38, v142
    v_mul_f32 v5, v46, v20
    v_mul_f32 v7, v62, v20
    v_fma_f32 v5, -v62, v22, v5
    v_fma_f32 v7, v46, v22, v7
    v_lshlrev_b32 v21, 16, v143
    v_and_b32 v23, s38, v143
    v_mul_f32 v6, v47, v21
    v_mul_f32 v8, v63, v21
    v_fma_f32 v6, -v63, v23, v6
    v_fma_f32 v8, v47, v23, v8
    v_cvt_pk_bf16_f32 v103, v5, v6
    v_cvt_pk_bf16_f32 v119, v7, v8
    v_lshlrev_b32 v20, 16, v144
    v_and_b32 v22, s38, v144
    v_mul_f32 v5, v64, v20
    v_mul_f32 v7, v80, v20
    v_fma_f32 v5, -v80, v22, v5
    v_fma_f32 v7, v64, v22, v7
    v_lshlrev_b32 v21, 16, v145
    v_and_b32 v23, s38, v145
    v_mul_f32 v6, v65, v21
    v_mul_f32 v8, v81, v21
    v_fma_f32 v6, -v81, v23, v6
    v_fma_f32 v8, v65, v23, v8
    v_cvt_pk_bf16_f32 v104, v5, v6
    v_cvt_pk_bf16_f32 v120, v7, v8
    v_lshlrev_b32 v20, 16, v146
    v_and_b32 v22, s38, v146
    v_mul_f32 v5, v66, v20
    v_mul_f32 v7, v82, v20
    v_fma_f32 v5, -v82, v22, v5
    v_fma_f32 v7, v66, v22, v7
    v_lshlrev_b32 v21, 16, v147
    v_and_b32 v23, s38, v147
    v_mul_f32 v6, v67, v21
    v_mul_f32 v8, v83, v21
    v_fma_f32 v6, -v83, v23, v6
    v_fma_f32 v8, v67, v23, v8
    v_cvt_pk_bf16_f32 v105, v5, v6
    v_cvt_pk_bf16_f32 v121, v7, v8
    v_lshlrev_b32 v20, 16, v148
    v_and_b32 v22, s38, v148
    v_mul_f32 v5, v68, v20
    v_mul_f32 v7, v84, v20
    v_fma_f32 v5, -v84, v22, v5
    v_fma_f32 v7, v68, v22, v7
    v_lshlrev_b32 v21, 16, v149
    v_and_b32 v23, s38, v149
    v_mul_f32 v6, v69, v21
    v_mul_f32 v8, v85, v21
    v_fma_f32 v6, -v85, v23, v6
    v_fma_f32 v8, v69, v23, v8
    v_cvt_pk_bf16_f32 v106, v5, v6
    v_cvt_pk_bf16_f32 v122, v7, v8
    v_lshlrev_b32 v20, 16, v150
    v_and_b32 v22, s38, v150
    v_mul_f32 v5, v70, v20
    v_mul_f32 v7, v86, v20
    v_fma_f32 v5, -v86, v22, v5
    v_fma_f32 v7, v70, v22, v7
    v_lshlrev_b32 v21, 16, v151
    v_and_b32 v23, s38, v151
    v_mul_f32 v6, v71, v21
    v_mul_f32 v8, v87, v21
    v_fma_f32 v6, -v87, v23, v6
    v_fma_f32 v8, v71, v23, v8
    v_cvt_pk_bf16_f32 v107, v5, v6
    v_cvt_pk_bf16_f32 v123, v7, v8
    v_lshlrev_b32 v20, 16, v152
    v_and_b32 v22, s38, v152
    v_mul_f32 v5, v72, v20
    v_mul_f32 v7, v88, v20
    v_fma_f32 v5, -v88, v22, v5
    v_fma_f32 v7, v72, v22, v7
    v_lshlrev_b32 v21, 16, v153
    v_and_b32 v23, s38, v153
    v_mul_f32 v6, v73, v21
    v_mul_f32 v8, v89, v21
    v_fma_f32 v6, -v89, v23, v6
    v_fma_f32 v8, v73, v23, v8
    v_cvt_pk_bf16_f32 v108, v5, v6
    v_cvt_pk_bf16_f32 v124, v7, v8
    v_lshlrev_b32 v20, 16, v154
    v_and_b32 v22, s38, v154
    v_mul_f32 v5, v74, v20
    v_mul_f32 v7, v90, v20
    v_fma_f32 v5, -v90, v22, v5
    v_fma_f32 v7, v74, v22, v7
    v_lshlrev_b32 v21, 16, v155
    v_and_b32 v23, s38, v155
    v_mul_f32 v6, v75, v21
    v_mul_f32 v8, v91, v21
    v_fma_f32 v6, -v91, v23, v6
    v_fma_f32 v8, v75, v23, v8
    v_cvt_pk_bf16_f32 v109, v5, v6
    v_cvt_pk_bf16_f32 v125, v7, v8
    v_lshlrev_b32 v20, 16, v156
    v_and_b32 v22, s38, v156
    v_mul_f32 v5, v76, v20
    v_mul_f32 v7, v92, v20
    v_fma_f32 v5, -v92, v22, v5
    v_fma_f32 v7, v76, v22, v7
    v_lshlrev_b32 v21, 16, v157
    v_and_b32 v23, s38, v157
    v_mul_f32 v6, v77, v21
    v_mul_f32 v8, v93, v21
    v_fma_f32 v6, -v93, v23, v6
    v_fma_f32 v8, v77, v23, v8
    v_cvt_pk_bf16_f32 v110, v5, v6
    v_cvt_pk_bf16_f32 v126, v7, v8
    v_lshlrev_b32 v20, 16, v158
    v_and_b32 v22, s38, v158
    v_mul_f32 v5, v78, v20
    v_mul_f32 v7, v94, v20
    v_fma_f32 v5, -v94, v22, v5
    v_fma_f32 v7, v78, v22, v7
    v_lshlrev_b32 v21, 16, v159
    v_and_b32 v23, s38, v159
    v_mul_f32 v6, v79, v21
    v_mul_f32 v8, v95, v21
    v_fma_f32 v6, -v95, v23, v6
    v_fma_f32 v8, v79, v23, v8
    v_cvt_pk_bf16_f32 v111, v5, v6
    v_cvt_pk_bf16_f32 v127, v7, v8
    v_mfma_f32_32x32x16_bf16 v[32:47], v[96:99], a[96:99], 0
    v_mfma_f32_32x32x16_bf16 v[48:63], v[112:115], a[96:99], 0
    v_mfma_f32_32x32x16_bf16 v[32:47], v[112:115], a[112:115], v[32:47]
    v_mfma_f32_32x32x16_bf16 v[48:63], v[96:99], a[104:107], v[48:63]
    v_mfma_f32_32x32x16_bf16 v[32:47], v[100:103], a[100:103], v[32:47]
    v_mfma_f32_32x32x16_bf16 v[48:63], v[116:119], a[100:103], v[48:63]
    v_mfma_f32_32x32x16_bf16 v[32:47], v[116:119], a[116:119], v[32:47]
    v_mfma_f32_32x32x16_bf16 v[48:63], v[100:103], a[108:111], v[48:63]
    v_mfma_f32_32x32x16_bf16 v[64:79], v[104:107], a[96:99], 0
    v_mfma_f32_32x32x16_bf16 v[80:95], v[120:123], a[96:99], 0
    v_mfma_f32_32x32x16_bf16 v[64:79], v[120:123], a[112:115], v[64:79]
    v_mfma_f32_32x32x16_bf16 v[80:95], v[104:107], a[104:107], v[80:95]
    v_mfma_f32_32x32x16_bf16 v[64:79], v[108:111], a[100:103], v[64:79]
    v_mfma_f32_32x32x16_bf16 v[80:95], v[124:127], a[100:103], v[80:95]
    v_mfma_f32_32x32x16_bf16 v[64:79], v[124:127], a[116:119], v[64:79]
    v_mfma_f32_32x32x16_bf16 v[80:95], v[108:111], a[108:111], v[80:95]
    s_nop 2
    v_mul_f32 v5, v32, v160
    v_mul_f32 v7, v48, v160
    v_fma_f32 v5, -v48, v176, v5
    v_fma_f32 v7, v32, v176, v7
    v_mul_f32 v6, v33, v161
    v_mul_f32 v8, v49, v161
    v_fma_f32 v6, -v49, v177, v6
    v_fma_f32 v8, v33, v177, v8
    v_cvt_pk_bf16_f32 v96, v5, v6
    v_cvt_pk_bf16_f32 v112, v7, v8
    v_mul_f32 v5, v34, v162
    v_mul_f32 v7, v50, v162
    v_fma_f32 v5, -v50, v178, v5
    v_fma_f32 v7, v34, v178, v7
    v_mul_f32 v6, v35, v163
    v_mul_f32 v8, v51, v163
    v_fma_f32 v6, -v51, v179, v6
    v_fma_f32 v8, v35, v179, v8
    v_cvt_pk_bf16_f32 v97, v5, v6
    v_cvt_pk_bf16_f32 v113, v7, v8
    v_mul_f32 v5, v36, v164
    v_mul_f32 v7, v52, v164
    v_fma_f32 v5, -v52, v180, v5
    v_fma_f32 v7, v36, v180, v7
    v_mul_f32 v6, v37, v165
    v_mul_f32 v8, v53, v165
    v_fma_f32 v6, -v53, v181, v6
    v_fma_f32 v8, v37, v181, v8
    v_cvt_pk_bf16_f32 v98, v5, v6
    v_cvt_pk_bf16_f32 v114, v7, v8
    v_mul_f32 v5, v38, v166
    v_mul_f32 v7, v54, v166
    v_fma_f32 v5, -v54, v182, v5
    v_fma_f32 v7, v38, v182, v7
    v_mul_f32 v6, v39, v167
    v_mul_f32 v8, v55, v167
    v_fma_f32 v6, -v55, v183, v6
    v_fma_f32 v8, v39, v183, v8
    v_cvt_pk_bf16_f32 v99, v5, v6
    v_cvt_pk_bf16_f32 v115, v7, v8
    v_mul_f32 v5, v40, v168
    v_mul_f32 v7, v56, v168
    v_fma_f32 v5, -v56, v184, v5
    v_fma_f32 v7, v40, v184, v7
    v_mul_f32 v6, v41, v169
    v_mul_f32 v8, v57, v169
    v_fma_f32 v6, -v57, v185, v6
    v_fma_f32 v8, v41, v185, v8
    v_cvt_pk_bf16_f32 v100, v5, v6
    v_cvt_pk_bf16_f32 v116, v7, v8
    v_mul_f32 v5, v42, v170
    v_mul_f32 v7, v58, v170
    v_fma_f32 v5, -v58, v186, v5
    v_fma_f32 v7, v42, v186, v7
    v_mul_f32 v6, v43, v171
    v_mul_f32 v8, v59, v171
    v_fma_f32 v6, -v59, v187, v6
    v_fma_f32 v8, v43, v187, v8
    v_cvt_pk_bf16_f32 v101, v5, v6
    v_cvt_pk_bf16_f32 v117, v7, v8
    v_mul_f32 v5, v44, v172
    v_mul_f32 v7, v60, v172
    v_fma_f32 v5, -v60, v188, v5
    v_fma_f32 v7, v44, v188, v7
    v_mul_f32 v6, v45, v173
    v_mul_f32 v8, v61, v173
    v_fma_f32 v6, -v61, v189, v6
    v_fma_f32 v8, v45, v189, v8
    v_cvt_pk_bf16_f32 v102, v5, v6
    v_cvt_pk_bf16_f32 v118, v7, v8
    v_mul_f32 v5, v46, v174
    v_mul_f32 v7, v62, v174
    v_fma_f32 v5, -v62, v190, v5
    v_fma_f32 v7, v46, v190, v7
    v_mul_f32 v6, v47, v175
    v_mul_f32 v8, v63, v175
    v_fma_f32 v6, -v63, v191, v6
    v_fma_f32 v8, v47, v191, v8
    v_cvt_pk_bf16_f32 v103, v5, v6
    v_cvt_pk_bf16_f32 v119, v7, v8
    v_mul_f32 v5, v64, v224
    v_mul_f32 v7, v80, v224
    v_fma_f32 v5, -v80, v240, v5
    v_fma_f32 v7, v64, v240, v7
    v_mul_f32 v6, v65, v225
    v_mul_f32 v8, v81, v225
    v_fma_f32 v6, -v81, v241, v6
    v_fma_f32 v8, v65, v241, v8
    v_cvt_pk_bf16_f32 v104, v5, v6
    v_cvt_pk_bf16_f32 v120, v7, v8
    v_mul_f32 v5, v66, v226
    v_mul_f32 v7, v82, v226
    v_fma_f32 v5, -v82, v242, v5
    v_fma_f32 v7, v66, v242, v7
    v_mul_f32 v6, v67, v227
    v_mul_f32 v8, v83, v227
    v_fma_f32 v6, -v83, v243, v6
    v_fma_f32 v8, v67, v243, v8
    v_cvt_pk_bf16_f32 v105, v5, v6
    v_cvt_pk_bf16_f32 v121, v7, v8
    v_mul_f32 v5, v68, v228
    v_mul_f32 v7, v84, v228
    v_fma_f32 v5, -v84, v244, v5
    v_fma_f32 v7, v68, v244, v7
    v_mul_f32 v6, v69, v229
    v_mul_f32 v8, v85, v229
    v_fma_f32 v6, -v85, v245, v6
    v_fma_f32 v8, v69, v245, v8
    v_cvt_pk_bf16_f32 v106, v5, v6
    v_cvt_pk_bf16_f32 v122, v7, v8
    v_mul_f32 v5, v70, v230
    v_mul_f32 v7, v86, v230
    v_fma_f32 v5, -v86, v246, v5
    v_fma_f32 v7, v70, v246, v7
    v_mul_f32 v6, v71, v231
    v_mul_f32 v8, v87, v231
    v_fma_f32 v6, -v87, v247, v6
    v_fma_f32 v8, v71, v247, v8
    v_cvt_pk_bf16_f32 v107, v5, v6
    v_cvt_pk_bf16_f32 v123, v7, v8
    v_mul_f32 v5, v72, v232
    v_mul_f32 v7, v88, v232
    v_fma_f32 v5, -v88, v248, v5
    v_fma_f32 v7, v72, v248, v7
    v_mul_f32 v6, v73, v233
    v_mul_f32 v8, v89, v233
    v_fma_f32 v6, -v89, v249, v6
    v_fma_f32 v8, v73, v249, v8
    v_cvt_pk_bf16_f32 v108, v5, v6
    v_cvt_pk_bf16_f32 v124, v7, v8
    v_mul_f32 v5, v74, v234
    v_mul_f32 v7, v90, v234
    v_fma_f32 v5, -v90, v250, v5
    v_fma_f32 v7, v74, v250, v7
    v_mul_f32 v6, v75, v235
    v_mul_f32 v8, v91, v235
    v_fma_f32 v6, -v91, v251, v6
    v_fma_f32 v8, v75, v251, v8
    v_cvt_pk_bf16_f32 v109, v5, v6
    v_cvt_pk_bf16_f32 v125, v7, v8
    v_mul_f32 v5, v76, v236
    v_mul_f32 v7, v92, v236
    v_fma_f32 v5, -v92, v252, v5
    v_fma_f32 v7, v76, v252, v7
    v_mul_f32 v6, v77, v237
    v_mul_f32 v8, v93, v237
    v_fma_f32 v6, -v93, v253, v6
    v_fma_f32 v8, v77, v253, v8
    v_cvt_pk_bf16_f32 v110, v5, v6
    v_cvt_pk_bf16_f32 v126, v7, v8
    v_mul_f32 v5, v78, v238
    v_mul_f32 v7, v94, v238
    v_fma_f32 v5, -v94, v254, v5
    v_fma_f32 v7, v78, v254, v7
    v_mul_f32 v6, v79, v239
    v_mul_f32 v8, v95, v239
    v_fma_f32 v6, -v95, v255, v6
    v_fma_f32 v8, v79, v255, v8
    v_cvt_pk_bf16_f32 v111, v5, v6
    v_cvt_pk_bf16_f32 v127, v7, v8
    v_mfma_f32_32x32x16_bf16 v[32:47], a[0:3], v[96:99], 0
    v_mfma_f32_32x32x16_bf16 v[48:63], a[0:3], v[112:115], 0
    v_mfma_f32_32x32x16_bf16 v[32:47], a[64:67], v[112:115], v[32:47]
    v_mfma_f32_32x32x16_bf16 v[48:63], a[32:35], v[96:99], v[48:63]
    v_mfma_f32_32x32x16_bf16 v[32:47], a[4:7], v[100:103], v[32:47]
    v_mfma_f32_32x32x16_bf16 v[48:63], a[4:7], v[116:119], v[48:63]
    v_mfma_f32_32x32x16_bf16 v[32:47], a[68:71], v[116:119], v[32:47]
    v_mfma_f32_32x32x16_bf16 v[48:63], a[36:39], v[100:103], v[48:63]
    v_mfma_f32_32x32x16_bf16 v[32:47], a[8:11], v[104:107], v[32:47]
    v_mfma_f32_32x32x16_bf16 v[48:63], a[8:11], v[120:123], v[48:63]
    v_mfma_f32_32x32x16_bf16 v[32:47], a[72:75], v[120:123], v[32:47]
    v_mfma_f32_32x32x16_bf16 v[48:63], a[40:43], v[104:107], v[48:63]
    v_mfma_f32_32x32x16_bf16 v[32:47], a[12:15], v[108:111], v[32:47]
    v_mfma_f32_32x32x16_bf16 v[48:63], a[12:15], v[124:127], v[48:63]
    v_mfma_f32_32x32x16_bf16 v[32:47], a[76:79], v[124:127], v[32:47]
    v_mfma_f32_32x32x16_bf16 v[48:63], a[44:47], v[108:111], v[48:63]
    v_mfma_f32_32x32x16_bf16 v[64:79], a[16:19], v[96:99], 0
    v_mfma_f32_32x32x16_bf16 v[80:95], a[16:19], v[112:115], 0
    v_mfma_f32_32x32x16_bf16 v[64:79], a[80:83], v[112:115], v[64:79]
    v_mfma_f32_32x32x16_bf16 v[80:95], a[48:51], v[96:99], v[80:95]
    v_mfma_f32_32x32x16_bf16 v[64:79], a[20:23], v[100:103], v[64:79]
    v_mfma_f32_32x32x16_bf16 v[80:95], a[20:23], v[116:119], v[80:95]
    v_mfma_f32_32x32x16_bf16 v[64:79], a[84:87], v[116:119], v[64:79]
    v_mfma_f32_32x32x16_bf16 v[80:95], a[52:55], v[100:103], v[80:95]
    v_mfma_f32_32x32x16_bf16 v[64:79], a[24:27], v[104:107], v[64:79]
    v_mfma_f32_32x32x16_bf16 v[80:95], a[24:27], v[120:123], v[80:95]
    v_mfma_f32_32x32x16_bf16 v[64:79], a[88:91], v[120:123], v[64:79]
    v_mfma_f32_32x32x16_bf16 v[80:95], a[56:59], v[104:107], v[80:95]
    v_mfma_f32_32x32x16_bf16 v[64:79], a[28:31], v[108:111], v[64:79]
    v_mfma_f32_32x32x16_bf16 v[80:95], a[28:31], v[124:127], v[80:95]
    v_mfma_f32_32x32x16_bf16 v[64:79], a[92:95], v[124:127], v[64:79]
    v_mfma_f32_32x32x16_bf16 v[80:95], a[60:63], v[108:111], v[80:95]
    v_mul_f32 v32, s35, v32
    v_mul_f32 v48, s35, v48
    v_cvt_pk_bf16_f32 v128, v32, v48
    v_mul_f32 v33, s35, v33
    v_mul_f32 v49, s35, v49
    v_cvt_pk_bf16_f32 v129, v33, v49
    v_mul_f32 v34, s35, v34
    v_mul_f32 v50, s35, v50
    v_cvt_pk_bf16_f32 v130, v34, v50
    v_mul_f32 v35, s35, v35
    v_mul_f32 v51, s35, v51
    v_cvt_pk_bf16_f32 v131, v35, v51
    v_mul_f32 v36, s35, v36
    v_mul_f32 v52, s35, v52
    v_cvt_pk_bf16_f32 v132, v36, v52
    v_mul_f32 v37, s35, v37
    v_mul_f32 v53, s35, v53
    v_cvt_pk_bf16_f32 v133, v37, v53
    v_mul_f32 v38, s35, v38
    v_mul_f32 v54, s35, v54
    v_cvt_pk_bf16_f32 v134, v38, v54
    v_mul_f32 v39, s35, v39
    v_mul_f32 v55, s35, v55
    v_cvt_pk_bf16_f32 v135, v39, v55
    v_mul_f32 v40, s35, v40
    v_mul_f32 v56, s35, v56
    v_cvt_pk_bf16_f32 v136, v40, v56
    v_mul_f32 v41, s35, v41
    v_mul_f32 v57, s35, v57
    v_cvt_pk_bf16_f32 v137, v41, v57
    v_mul_f32 v42, s35, v42
    v_mul_f32 v58, s35, v58
    v_cvt_pk_bf16_f32 v138, v42, v58
    v_mul_f32 v43, s35, v43
    v_mul_f32 v59, s35, v59
    v_cvt_pk_bf16_f32 v139, v43, v59
    v_mul_f32 v44, s35, v44
    v_mul_f32 v60, s35, v60
    v_cvt_pk_bf16_f32 v140, v44, v60
    v_mul_f32 v45, s35, v45
    v_mul_f32 v61, s35, v61
    v_cvt_pk_bf16_f32 v141, v45, v61
    v_mul_f32 v46, s35, v46
    v_mul_f32 v62, s35, v62
    v_cvt_pk_bf16_f32 v142, v46, v62
    v_mul_f32 v47, s35, v47
    v_mul_f32 v63, s35, v63
    v_cvt_pk_bf16_f32 v143, v47, v63
    v_mul_f32 v64, s35, v64
    v_mul_f32 v80, s35, v80
    v_cvt_pk_bf16_f32 v144, v64, v80
    v_mul_f32 v65, s35, v65
    v_mul_f32 v81, s35, v81
    v_cvt_pk_bf16_f32 v145, v65, v81
    v_mul_f32 v66, s35, v66
    v_mul_f32 v82, s35, v82
    v_cvt_pk_bf16_f32 v146, v66, v82
    v_mul_f32 v67, s35, v67
    v_mul_f32 v83, s35, v83
    v_cvt_pk_bf16_f32 v147, v67, v83
    v_mul_f32 v68, s35, v68
    v_mul_f32 v84, s35, v84
    v_cvt_pk_bf16_f32 v148, v68, v84
    v_mul_f32 v69, s35, v69
    v_mul_f32 v85, s35, v85
    v_cvt_pk_bf16_f32 v149, v69, v85
    v_mul_f32 v70, s35, v70
    v_mul_f32 v86, s35, v86
    v_cvt_pk_bf16_f32 v150, v70, v86
    v_mul_f32 v71, s35, v71
    v_mul_f32 v87, s35, v87
    v_cvt_pk_bf16_f32 v151, v71, v87
    v_mul_f32 v72, s35, v72
    v_mul_f32 v88, s35, v88
    v_cvt_pk_bf16_f32 v152, v72, v88
    v_mul_f32 v73, s35, v73
    v_mul_f32 v89, s35, v89
    v_cvt_pk_bf16_f32 v153, v73, v89
    v_mul_f32 v74, s35, v74
    v_mul_f32 v90, s35, v90
    v_cvt_pk_bf16_f32 v154, v74, v90
    v_mul_f32 v75, s35, v75
    v_mul_f32 v91, s35, v91
    v_cvt_pk_bf16_f32 v155, v75, v91
    v_mul_f32 v76, s35, v76
    v_mul_f32 v92, s35, v92
    v_cvt_pk_bf16_f32 v156, v76, v92
    v_mul_f32 v77, s35, v77
    v_mul_f32 v93, s35, v93
    v_cvt_pk_bf16_f32 v157, v77, v93
    v_mul_f32 v78, s35, v78
    v_mul_f32 v94, s35, v94
    v_cvt_pk_bf16_f32 v158, v78, v94
    v_mul_f32 v79, s35, v79
    v_mul_f32 v95, s35, v95
    v_cvt_pk_bf16_f32 v159, v79, v95
    s_cmp_eq_u32 s36, 1
    s_cbranch_scc1 F2_o1
    s_cmp_eq_u32 s36, 2
    s_cbranch_scc1 F2_o2
    s_cmp_eq_u32 s36, 3
    s_cbranch_scc1 F2_o3
    s_cmp_eq_u32 s36, 4
    s_cbranch_scc1 F2_o4
    v_accvgpr_write_b32 a120, v128
    v_accvgpr_write_b32 a124, v129
    v_accvgpr_write_b32 a128, v130
    v_accvgpr_write_b32 a132, v131
    v_accvgpr_write_b32 a136, v132
    v_accvgpr_write_b32 a140, v133
    v_accvgpr_write_b32 a144, v134
    v_accvgpr_write_b32 a148, v135
    v_accvgpr_write_b32 a152, v136
    v_accvgpr_write_b32 a156, v137
    v_accvgpr_write_b32 a160, v138
    v_accvgpr_write_b32 a164, v139
    v_accvgpr_write_b32 a168, v140
    v_accvgpr_write_b32 a172, v141
    v_accvgpr_write_b32 a176, v142
    v_accvgpr_write_b32 a180, v143
    v_accvgpr_write_b32 a184, v144
    v_accvgpr_write_b32 a188, v145
    v_accvgpr_write_b32 a192, v146
    v_accvgpr_write_b32 a196, v147
    v_accvgpr_write_b32 a200, v148
    v_accvgpr_write_b32 a204, v149
    v_accvgpr_write_b32 a208, v150
    v_accvgpr_write_b32 a212, v151
    v_accvgpr_write_b32 a216, v152
    v_accvgpr_write_b32 a220, v153
    v_accvgpr_write_b32 a224, v154
    v_accvgpr_write_b32 a228, v155
    v_accvgpr_write_b32 a232, v156
    v_accvgpr_write_b32 a236, v157
    v_accvgpr_write_b32 a240, v158
    v_accvgpr_write_b32 a244, v159
    s_branch F2_nx
F2_o1:
    v_accvgpr_write_b32 a121, v128
    v_accvgpr_write_b32 a125, v129
    v_accvgpr_write_b32 a129, v130
    v_accvgpr_write_b32 a133, v131
    v_accvgpr_write_b32 a137, v132
    v_accvgpr_write_b32 a141, v133
    v_accvgpr_write_b32 a145, v134
    v_accvgpr_write_b32 a149, v135
    v_accvgpr_write_b32 a153, v136
    v_accvgpr_write_b32 a157, v137
    v_accvgpr_write_b32 a161, v138
    v_accvgpr_write_b32 a165, v139
    v_accvgpr_write_b32 a169, v140
    v_accvgpr_write_b32 a173, v141
    v_accvgpr_write_b32 a177, v142
    v_accvgpr_write_b32 a181, v143
    v_accvgpr_write_b32 a185, v144
    v_accvgpr_write_b32 a189, v145
    v_accvgpr_write_b32 a193, v146
    v_accvgpr_write_b32 a197, v147
    v_accvgpr_write_b32 a201, v148
    v_accvgpr_write_b32 a205, v149
    v_accvgpr_write_b32 a209, v150
    v_accvgpr_write_b32 a213, v151
    v_accvgpr_write_b32 a217, v152
    v_accvgpr_write_b32 a221, v153
    v_accvgpr_write_b32 a225, v154
    v_accvgpr_write_b32 a229, v155
    v_accvgpr_write_b32 a233, v156
    v_accvgpr_write_b32 a237, v157
    v_accvgpr_write_b32 a241, v158
    v_accvgpr_write_b32 a245, v159
    s_branch F2_nx
F2_o2:
    v_accvgpr_write_b32 a122, v128
    v_accvgpr_write_b32 a126, v129
    v_accvgpr_write_b32 a130, v130
    v_accvgpr_write_b32 a134, v131
    v_accvgpr_write_b32 a138, v132
    v_accvgpr_write_b32 a142, v133
    v_accvgpr_write_b32 a146, v134
    v_accvgpr_write_b32 a150, v135
    v_accvgpr_write_b32 a154, v136
    v_accvgpr_write_b32 a158, v137
    v_accvgpr_write_b32 a162, v138
    v_accvgpr_write_b32 a166, v139
    v_accvgpr_write_b32 a170, v140
    v_accvgpr_write_b32 a174, v141
    v_accvgpr_write_b32 a178, v142
    v_accvgpr_write_b32 a182, v143
    v_accvgpr_write_b32 a186, v144
    v_accvgpr_write_b32 a190, v145
    v_accvgpr_write_b32 a194, v146
    v_accvgpr_write_b32 a198, v147
    v_accvgpr_write_b32 a202, v148
    v_accvgpr_write_b32 a206, v149
    v_accvgpr_write_b32 a210, v150
    v_accvgpr_write_b32 a214, v151
    v_accvgpr_write_b32 a218, v152
    v_accvgpr_write_b32 a222, v153
    v_accvgpr_write_b32 a226, v154
    v_accvgpr_write_b32 a230, v155
    v_accvgpr_write_b32 a234, v156
    v_accvgpr_write_b32 a238, v157
    v_accvgpr_write_b32 a242, v158
    v_accvgpr_write_b32 a246, v159
    s_branch F2_nx
F2_o3:
    v_accvgpr_write_b32 a123, v128
    v_accvgpr_write_b32 a127, v129
    v_accvgpr_write_b32 a131, v130
    v_accvgpr_write_b32 a135, v131
    v_accvgpr_write_b32 a139, v132
    v_accvgpr_write_b32 a143, v133
    v_accvgpr_write_b32 a147, v134
    v_accvgpr_write_b32 a151, v135
    v_accvgpr_write_b32 a155, v136
    v_accvgpr_write_b32 a159, v137
    v_accvgpr_write_b32 a163, v138
    v_accvgpr_write_b32 a167, v139
    v_accvgpr_write_b32 a171, v140
    v_accvgpr_write_b32 a175, v141
    v_accvgpr_write_b32 a179, v142
    v_accvgpr_write_b32 a183, v143
    v_accvgpr_write_b32 a187, v144
    v_accvgpr_write_b32 a191, v145
    v_accvgpr_write_b32 a195, v146
    v_accvgpr_write_b32 a199, v147
    v_accvgpr_write_b32 a203, v148
    v_accvgpr_write_b32 a207, v149
    v_accvgpr_write_b32 a211, v150
    v_accvgpr_write_b32 a215, v151
    v_accvgpr_write_b32 a219, v152
    v_accvgpr_write_b32 a223, v153
    v_accvgpr_write_b32 a227, v154
    v_accvgpr_write_b32 a231, v155
    v_accvgpr_write_b32 a235, v156
    v_accvgpr_write_b32 a239, v157
    v_accvgpr_write_b32 a243, v158
    v_accvgpr_write_b32 a247, v159
    s_branch F2_nx
F2_o4:
    v_accvgpr_read_b32 v5, a120
    v_lshlrev_b32 v6, 16, v128
    v_bfi_b32 v5, s38, v6, v5
    v_accvgpr_write_b32 a120, v5
    v_accvgpr_read_b32 v5, a124
    v_lshlrev_b32 v6, 16, v129
    v_bfi_b32 v5, s38, v6, v5
    v_accvgpr_write_b32 a124, v5
    v_accvgpr_read_b32 v5, a128
    v_lshlrev_b32 v6, 16, v130
    v_bfi_b32 v5, s38, v6, v5
    v_accvgpr_write_b32 a128, v5
    v_accvgpr_read_b32 v5, a132
    v_lshlrev_b32 v6, 16, v131
    v_bfi_b32 v5, s38, v6, v5
    v_accvgpr_write_b32 a132, v5
    v_accvgpr_read_b32 v5, a136
    v_lshlrev_b32 v6, 16, v132
    v_bfi_b32 v5, s38, v6, v5
    v_accvgpr_write_b32 a136, v5
    v_accvgpr_read_b32 v5, a140
    v_lshlrev_b32 v6, 16, v133
    v_bfi_b32 v5, s38, v6, v5
    v_accvgpr_write_b32 a140, v5
    v_accvgpr_read_b32 v5, a144
    v_lshlrev_b32 v6, 16, v134
    v_bfi_b32 v5, s38, v6, v5
    v_accvgpr_write_b32 a144, v5
    v_accvgpr_read_b32 v5, a148
    v_lshlrev_b32 v6, 16, v135
    v_bfi_b32 v5, s38, v6, v5
    v_accvgpr_write_b32 a148, v5
    v_accvgpr_read_b32 v5, a152
    v_lshlrev_b32 v6, 16, v136
    v_bfi_b32 v5, s38, v6, v5
    v_accvgpr_write_b32 a152, v5
    v_accvgpr_read_b32 v5, a156
    v_lshlrev_b32 v6, 16, v137
    v_bfi_b32 v5, s38, v6, v5
    v_accvgpr_write_b32 a156, v5
    v_accvgpr_read_b32 v5, a160
    v_lshlrev_b32 v6, 16, v138
    v_bfi_b32 v5, s38, v6, v5
    v_accvgpr_write_b32 a160, v5
    v_accvgpr_read_b32 v5, a164
    v_lshlrev_b32 v6, 16, v139
    v_bfi_b32 v5, s38, v6, v5
    v_accvgpr_write_b32 a164, v5
    v_accvgpr_read_b32 v5, a168
    v_lshlrev_b32 v6, 16, v140
    v_bfi_b32 v5, s38, v6, v5
    v_accvgpr_write_b32 a168, v5
    v_accvgpr_read_b32 v5, a172
    v_lshlrev_b32 v6, 16, v141
    v_bfi_b32 v5, s38, v6, v5
    v_accvgpr_write_b32 a172, v5
    v_accvgpr_read_b32 v5, a176
    v_lshlrev_b32 v6, 16, v142
    v_bfi_b32 v5, s38, v6, v5
    v_accvgpr_write_b32 a176, v5
    v_accvgpr_read_b32 v5, a180
    v_lshlrev_b32 v6, 16, v143
    v_bfi_b32 v5, s38, v6, v5
    v_accvgpr_write_b32 a180, v5
    v_accvgpr_read_b32 v5, a184
    v_lshlrev_b32 v6, 16, v144
    v_bfi_b32 v5, s38, v6, v5
    v_accvgpr_write_b32 a184, v5
    v_accvgpr_read_b32 v5, a188
    v_lshlrev_b32 v6, 16, v145
    v_bfi_b32 v5, s38, v6, v5
    v_accvgpr_write_b32 a188, v5
    v_accvgpr_read_b32 v5, a192
    v_lshlrev_b32 v6, 16, v146
    v_bfi_b32 v5, s38, v6, v5
    v_accvgpr_write_b32 a192, v5
    v_accvgpr_read_b32 v5, a196
    v_lshlrev_b32 v6, 16, v147
    v_bfi_b32 v5, s38, v6, v5
    v_accvgpr_write_b32 a196, v5
    v_accvgpr_read_b32 v5, a200
    v_lshlrev_b32 v6, 16, v148
    v_bfi_b32 v5, s38, v6, v5
    v_accvgpr_write_b32 a200, v5
    v_accvgpr_read_b32 v5, a204
    v_lshlrev_b32 v6, 16, v149
    v_bfi_b32 v5, s38, v6, v5
    v_accvgpr_write_b32 a204, v5
    v_accvgpr_read_b32 v5, a208
    v_lshlrev_b32 v6, 16, v150
    v_bfi_b32 v5, s38, v6, v5
    v_accvgpr_write_b32 a208, v5
    v_accvgpr_read_b32 v5, a212
    v_lshlrev_b32 v6, 16, v151
    v_bfi_b32 v5, s38, v6, v5
    v_accvgpr_write_b32 a212, v5
    v_accvgpr_read_b32 v5, a216
    v_lshlrev_b32 v6, 16, v152
    v_bfi_b32 v5, s38, v6, v5
    v_accvgpr_write_b32 a216, v5
    v_accvgpr_read_b32 v5, a220
    v_lshlrev_b32 v6, 16, v153
    v_bfi_b32 v5, s38, v6, v5
    v_accvgpr_write_b32 a220, v5
    v_accvgpr_read_b32 v5, a224
    v_lshlrev_b32 v6, 16, v154
    v_bfi_b32 v5, s38, v6, v5
    v_accvgpr_write_b32 a224, v5
    v_accvgpr_read_b32 v5, a228
    v_lshlrev_b32 v6, 16, v155
    v_bfi_b32 v5, s38, v6, v5
    v_accvgpr_write_b32 a228, v5
    v_accvgpr_read_b32 v5, a232
    v_lshlrev_b32 v6, 16, v156
    v_bfi_b32 v5, s38, v6, v5
    v_accvgpr_write_b32 a232, v5
    v_accvgpr_read_b32 v5, a236
    v_lshlrev_b32 v6, 16, v157
    v_bfi_b32 v5, s38, v6, v5
    v_accvgpr_write_b32 a236, v5
    v_accvgpr_read_b32 v5, a240
    v_lshlrev_b32 v6, 16, v158
    v_bfi_b32 v5, s38, v6, v5
    v_accvgpr_write_b32 a240, v5
    v_accvgpr_read_b32 v5, a244
    v_lshlrev_b32 v6, 16, v159
    v_bfi_b32 v5, s38, v6, v5
    v_accvgpr_write_b32 a244, v5
F2_nx:
    s_add_u32 s36, s36, 1
    s_add_u32 s32, s32, 128
    s_add_u32 s33, s32, 64
    s_add_u32 s34, s34, 8192
    s_mov_b32 s35, 897581056
    s_cmp_eq_u32 s36, 4
    s_cselect_b32 s32, 104857664, s32
    s_cselect_b32 s33, 1073741824, s33
    s_cselect_b32 s34, 121634816, s34
    s_cselect_b32 s35, 889192448, s35
    s_cmp_lt_u32 s36, s37
    s_cbranch_scc1 F2_top
    s_mul_i32 s21, s31, 33024
    s_add_u32 s21, s21, 111149056
    s_add_u32 s17, s21, 0
    buffer_store_dwordx4 a[120:123], v18, s[4:7], s17 offen offset:0 sc1
    buffer_store_dwordx4 a[124:127], v18, s[4:7], s17 offen offset:512 sc1
    buffer_store_dwordx4 a[128:131], v18, s[4:7], s17 offen offset:1024 sc1
    buffer_store_dwordx4 a[132:135], v18, s[4:7], s17 offen offset:1536 sc1
    buffer_store_dwordx4 a[136:139], v18, s[4:7], s17 offen offset:2048 sc1
    buffer_store_dwordx4 a[140:143], v18, s[4:7], s17 offen offset:2560 sc1
    buffer_store_dwordx4 a[144:147], v18, s[4:7], s17 offen offset:3072 sc1
    buffer_store_dwordx4 a[148:151], v18, s[4:7], s17 offen offset:3584 sc1
    s_add_u32 s17, s21, 8192
    buffer_store_dwordx4 a[152:155], v18, s[4:7], s17 offen offset:0 sc1
    buffer_store_dwordx4 a[156:159], v18, s[4:7], s17 offen offset:512 sc1
    buffer_store_dwordx4 a[160:163], v18, s[4:7], s17 offen offset:1024 sc1
    buffer_store_dwordx4 a[164:167], v18, s[4:7], s17 offen offset:1536 sc1
    buffer_store_dwordx4 a[168:171], v18, s[4:7], s17 offen offset:2048 sc1
    buffer_store_dwordx4 a[172:175], v18, s[4:7], s17 offen offset:2560 sc1
    buffer_store_dwordx4 a[176:179], v18, s[4:7], s17 offen offset:3072 sc1
    buffer_store_dwordx4 a[180:183], v18, s[4:7], s17 offen offset:3584 sc1
    s_add_u32 s17, s21, 16384
    buffer_store_dwordx4 a[184:187], v18, s[4:7], s17 offen offset:0 sc1
    buffer_store_dwordx4 a[188:191], v18, s[4:7], s17 offen offset:512 sc1
    buffer_store_dwordx4 a[192:195], v18, s[4:7], s17 offen offset:1024 sc1
    buffer_store_dwordx4 a[196:199], v18, s[4:7], s17 offen offset:1536 sc1
    buffer_store_dwordx4 a[200:203], v18, s[4:7], s17 offen offset:2048 sc1
    buffer_store_dwordx4 a[204:207], v18, s[4:7], s17 offen offset:2560 sc1
    buffer_store_dwordx4 a[208:211], v18, s[4:7], s17 offen offset:3072 sc1
    buffer_store_dwordx4 a[212:215], v18, s[4:7], s17 offen offset:3584 sc1
    s_add_u32 s17, s21, 24576
    buffer_store_dwordx4 a[216:219], v18, s[4:7], s17 offen offset:0 sc1
    buffer_store_dwordx4 a[220:223], v18, s[4:7], s17 offen offset:512 sc1
    buffer_store_dwordx4 a[224:227], v18, s[4:7], s17 offen offset:1024 sc1
    buffer_store_dwordx4 a[228:231], v18, s[4:7], s17 offen offset:1536 sc1
    buffer_store_dwordx4 a[232:235], v18, s[4:7], s17 offen offset:2048 sc1
    buffer_store_dwordx4 a[236:239], v18, s[4:7], s17 offen offset:2560 sc1
    buffer_store_dwordx4 a[240:243], v18, s[4:7], s17 offen offset:3072 sc1
    buffer_store_dwordx4 a[244:247], v18, s[4:7], s17 offen offset:3584 sc1
    s_waitcnt vmcnt(0)
    s_lshl_b32 s17, s31, 2
    s_add_u32 s17, s17, 100733440
    v_mov_b32 v5, s17
    v_mov_b32 v6, 1
    s_mov_b64 exec, 1
    buffer_store_dword v6, v5, s[4:7], 0 offen sc1
    s_mov_b64 exec, -1
    v_bfe_u32 v5, v1, 2, 2
    v_and_b32 v7, 3, v1
    v_lshl_add_u32 v7, v5, 3, v7
    s_lshl_b32 s17, s29, 5
    v_add_u32 v7, s17, v7
    v_lshrrev_b32 v8, 4, v1
    v_cvt_f32_u32 v8, v8
    s_mov_b32 s31, 981467136
    v_and_b32 v38, 1, v7
    v_add_u32 v5, 0, v7
    v_cvt_f32_u32 v6, v5
    v_mul_f32 v6, s31, v6
    v_mov_b32 v32, 0x3e800000
    v_sub_f32 v34, v6, v32
    v_mul_f32 v36, 0x41800000, v6
    v_mul_f32 v5, 4.0, v6
    v_mul_f32 v30, v5, v8
    v_add_u32 v5, 4, v7
    v_cvt_f32_u32 v6, v5
    v_mul_f32 v6, s31, v6
    v_mov_b32 v33, 0x3e800000
    v_sub_f32 v35, v6, v33
    v_mul_f32 v37, 0x41800000, v6
    v_mul_f32 v5, 4.0, v6
    v_mul_f32 v31, v5, v8
    v_lshlrev_b32 v8, 4, v1
    s_lshl_b32 s18, s16, 15
    v_add_u32 v8, s18, v8
    v_mov_b32 v7, v8
    s_mov_b32 s22, 0
F3_g0:
    v_fract_f32 v40, v30
    v_add_f32 v41, v40, v32
    v_add_f32 v42, v41, v34
    v_add_f32 v43, v42, v32
    v_add_f32 v44, v43, v34
    v_add_f32 v45, v44, v32
    v_add_f32 v46, v45, v34
    v_add_f32 v47, v46, v32
    v_add_f32 v30, v40, v36
    v_cos_f32 v48, v40
    v_cos_f32 v49, v41
    v_cos_f32 v50, v42
    v_cos_f32 v51, v43
    v_cos_f32 v52, v44
    v_cos_f32 v53, v45
    v_cos_f32 v54, v46
    v_cos_f32 v55, v47
    v_cvt_pk_bf16_f32 v56, v48, v49
    v_cvt_pk_bf16_f32 v57, v50, v51
    v_cvt_pk_bf16_f32 v58, v52, v53
    v_cvt_pk_bf16_f32 v59, v54, v55
    ds_write_b128 v7, v[56:59] offset:0
    v_fract_f32 v40, v31
    v_add_f32 v41, v40, v33
    v_add_f32 v42, v41, v35
    v_add_f32 v43, v42, v33
    v_add_f32 v44, v43, v35
    v_add_f32 v45, v44, v33
    v_add_f32 v46, v45, v35
    v_add_f32 v47, v46, v33
    v_add_f32 v31, v40, v37
    v_cos_f32 v48, v40
    v_cos_f32 v49, v41
    v_cos_f32 v50, v42
    v_cos_f32 v51, v43
    v_cos_f32 v52, v44
    v_cos_f32 v53, v45
    v_cos_f32 v54, v46
    v_cos_f32 v55, v47
    v_cvt_pk_bf16_f32 v60, v48, v49
    v_cvt_pk_bf16_f32 v61, v50, v51
    v_cvt_pk_bf16_f32 v62, v52, v53
    v_cvt_pk_bf16_f32 v63, v54, v55
    ds_write_b128 v7, v[60:63] offset:1024
    v_add_u32 v7, 2048, v7
    s_add_u32 s22, s22, 1
    s_cmp_lt_u32 s22, 16
    s_waitcnt lgkmcnt(0)
    s_cbranch_scc1 F3_g0
    ds_read_b128 a[0:3], v8 offset:0
    ds_read_b128 a[4:7], v8 offset:1024
    ds_read_b128 a[8:11], v8 offset:2048
    ds_read_b128 a[12:15], v8 offset:3072
    ds_read_b128 a[16:19], v8 offset:4096
    ds_read_b128 a[20:23], v8 offset:5120
    ds_read_b128 a[24:27], v8 offset:6144
    ds_read_b128 a[28:31], v8 offset:7168
    s_waitcnt lgkmcnt(7)
    ds_read_b128 a[32:35], v8 offset:8192
    ds_read_b128 a[36:39], v8 offset:9216
    ds_read_b128 a[40:43], v8 offset:10240
    ds_read_b128 a[44:47], v8 offset:11264
    ds_read_b128 a[48:51], v8 offset:12288
    ds_read_b128 a[52:55], v8 offset:13312
    ds_read_b128 a[56:59], v8 offset:14336
    ds_read_b128 a[60:63], v8 offset:15360
    s_waitcnt lgkmcnt(7)
    ds_read_b128 a[64:67], v8 offset:16384
    ds_read_b128 a[68:71], v8 offset:17408
    ds_read_b128 a[72:75], v8 offset:18432
    ds_read_b128 a[76:79], v8 offset:19456
    ds_read_b128 a[80:83], v8 offset:20480
    ds_read_b128 a[84:87], v8 offset:21504
    ds_read_b128 a[88:91], v8 offset:22528
    ds_read_b128 a[92:95], v8 offset:23552
    s_waitcnt lgkmcnt(7)
    ds_read_b128 a[96:99], v8 offset:24576
    ds_read_b128 a[100:103], v8 offset:25600
    ds_read_b128 a[104:107], v8 offset:26624
    ds_read_b128 a[108:111], v8 offset:27648
    ds_read_b128 a[112:115], v8 offset:28672
    ds_read_b128 a[116:119], v8 offset:29696
    ds_read_b128 a[120:123], v8 offset:30720
    ds_read_b128 a[124:127], v8 offset:31744
    s_waitcnt lgkmcnt(7)
    s_waitcnt lgkmcnt(0)
    v_mov_b32 v7, v8
    s_mov_b32 s22, 0
F3_g1:
    v_fract_f32 v40, v30
    v_add_f32 v41, v40, v32
    v_add_f32 v42, v41, v34
    v_add_f32 v43, v42, v32
    v_add_f32 v44, v43, v34
    v_add_f32 v45, v44, v32
    v_add_f32 v46, v45, v34
    v_add_f32 v47, v46, v32
    v_add_f32 v30, v40, v36
    v_cos_f32 v48, v40
    v_cos_f32 v49, v41
    v_cos_f32 v50, v42
    v_cos_f32 v51, v43
    v_cos_f32 v52, v44
    v_cos_f32 v53, v45
    v_cos_f32 v54, v46
    v_cos_f32 v55, v47
    v_cvt_pk_bf16_f32 v56, v48, v49
    v_cvt_pk_bf16_f32 v57, v50, v51
    v_cvt_pk_bf16_f32 v58, v52, v53
    v_cvt_pk_bf16_f32 v59, v54, v55
    ds_write_b128 v7, v[56:59] offset:0
    v_fract_f32 v40, v31
    v_add_f32 v41, v40, v33
    v_add_f32 v42, v41, v35
    v_add_f32 v43, v42, v33
    v_add_f32 v44, v43, v35
    v_add_f32 v45, v44, v33
    v_add_f32 v46, v45, v35
    v_add_f32 v47, v46, v33
    v_add_f32 v31, v40, v37
    v_cos_f32 v48, v40
    v_cos_f32 v49, v41
    v_cos_f32 v50, v42
    v_cos_f32 v51, v43
    v_cos_f32 v52, v44
    v_cos_f32 v53, v45
    v_cos_f32 v54, v46
    v_cos_f32 v55, v47
    v_cvt_pk_bf16_f32 v60, v48, v49
    v_cvt_pk_bf16_f32 v61, v50, v51
    v_cvt_pk_bf16_f32 v62, v52, v53
    v_cvt_pk_bf16_f32 v63, v54, v55
    ds_write_b128 v7, v[60:63] offset:1024
    v_add_u32 v7, 2048, v7
    s_add_u32 s22, s22, 1
    s_cmp_lt_u32 s22, 16
    s_waitcnt lgkmcnt(0)
    s_cbranch_scc1 F3_g1
    ds_read_b128 a[128:131], v8 offset:0
    ds_read_b128 a[132:135], v8 offset:1024
    ds_read_b128 a[136:139], v8 offset:2048
    ds_read_b128 a[140:143], v8 offset:3072
    ds_read_b128 a[144:147], v8 offset:4096
    ds_read_b128 a[148:151], v8 offset:5120
    ds_read_b128 a[152:155], v8 offset:6144
    ds_read_b128 a[156:159], v8 offset:7168
    s_waitcnt lgkmcnt(7)
    ds_read_b128 a[160:163], v8 offset:8192
    ds_read_b128 a[164:167], v8 offset:9216
    ds_read_b128 a[168:171], v8 offset:10240
    ds_read_b128 a[172:175], v8 offset:11264
    ds_read_b128 a[176:179], v8 offset:12288
    ds_read_b128 a[180:183], v8 offset:13312
    ds_read_b128 a[184:187], v8 offset:14336
    ds_read_b128 a[188:191], v8 offset:15360
    s_waitcnt lgkmcnt(7)
    ds_read_b128 a[192:195], v8 offset:16384
    ds_read_b128 a[196:199], v8 offset:17408
    ds_read_b128 a[200:203], v8 offset:18432
    ds_read_b128 a[204:207], v8 offset:19456
    ds_read_b128 a[208:211], v8 offset:20480
    ds_read_b128 a[212:215], v8 offset:21504
    ds_read_b128 a[216:219], v8 offset:22528
    ds_read_b128 a[220:223], v8 offset:23552
    s_waitcnt lgkmcnt(7)
    ds_read_b128 a[224:227], v8 offset:24576
    ds_read_b128 a[228:231], v8 offset:25600
    ds_read_b128 a[232:235], v8 offset:26624
    ds_read_b128 a[236:239], v8 offset:27648
    ds_read_b128 a[240:243], v8 offset:28672
    ds_read_b128 a[244:247], v8 offset:29696
    ds_read_b128 a[248:251], v8 offset:30720
    ds_read_b128 a[252:255], v8 offset:31744
    s_waitcnt lgkmcnt(7)
    s_waitcnt lgkmcnt(0)
    v_lshlrev_b32 v6, 31, v38
    v_or_b32 v6, 0x3f803f80, v6
    v_cmp_gt_u32 vcc, 16, v1
    v_accvgpr_read_b32 v5, a0
    s_nop 0
    v_cndmask_b32 v5, v5, v6, vcc
    v_accvgpr_write_b32 a0, v5
    v_accvgpr_read_b32 v5, a4
    v_cndmask_b32 v5, v5, v6, vcc
    v_accvgpr_write_b32 a4, v5
    v_and_b32 v5, 15, v1
    v_bfe_u32 v6, v1, 1, 3
    v_lshrrev_b32 v7, 4, v1
    v_xor_b32 v6, v6, v7
    v_lshlrev_b32 v6, 4, v6
    v_lshl_add_u32 v10, v5, 7, v6
    s_lshl_b32 s19, s16, 10
    v_xor_b32 v11, 64, v10
    v_add_u32 v12, 0x10000, v10
    v_add_u32 v13, 0x10000, v11
    v_lshrrev_b32 v7, 3, v1
    s_lshl_b32 s17, s16, 3
    v_add_u32 v7, s17, v7
    v_bfe_u32 v8, v7, 1, 3
    v_xor_b32 v8, v8, v1
    v_and_b32 v8, 7, v8
    v_mul_u32_u24 v2, 33024, v8
    v_lshl_add_u32 v2, v7, 4, v2
    v_and_b32 v3, 15, v1
    v_and_b32 v5, 48, v1
    v_lshl_add_u32 v3, v3, 12, v5
    v_add_u32 v4, 0x10000, v3
    s_lshl_b32 s21, s28, 21
    s_lshl_b32 s17, s29, 6
    s_add_u32 s21, s21, s17
    s_lshl_b32 s20, s28, 13
    s_add_u32 s20, s20, 111149056
    s_mov_b32 s24, 512
    s_mov_b32 s25, 131072
    v_lshlrev_b32 v7, 2, v1
    v_add_u32 v7, 100733440, v7
    v_add_u32 v8, 256, v7
    s_mov_b32 s30, s92
F3_w0:
    buffer_load_dword v5, v7, s[4:7], 0 offen sc1
    s_waitcnt vmcnt(0)
    v_cmp_gt_u32 vcc, 1, v5
    s_nop 0
    s_cmp_lg_u64 vcc, 0
    s_cbranch_scc0 F3_w0_ok
    s_cmp_ge_u32 s30, 1048576
    s_cselect_b32 s92, 1048576, s92
    s_cbranch_scc1 F3_w0_ok
    s_add_u32 s30, s30, 1
    s_sleep 8
    s_branch F3_w0
F3_w0_ok:
    s_mov_b32 s30, s92
F3_w1:
    buffer_load_dword v5, v8, s[4:7], 0 offen sc1
    s_waitcnt vmcnt(0)
    v_cmp_gt_u32 vcc, 1, v5
    s_nop 0
    s_cmp_lg_u64 vcc, 0
    s_cbranch_scc0 F3_w1_ok
    s_cmp_ge_u32 s30, 1048576
    s_cselect_b32 s92, 1048576, s92
    s_cbranch_scc1 F3_w1_ok
    s_add_u32 s30, s30, 1
    s_sleep 8
    s_branch F3_w1
F3_w1_ok:
    s_barrier
    s_mov_b32 s26, s25
    s_sub_u32 s25, s21, 1073741824
    s_mov_b32 s21, 1073741824
    s_mov_b32 s23, 0
    s_mov_b32 s22, 0
    s_add_u32 m0, s19, 0
    s_add_u32 s17, s20, 0
    buffer_load_dwordx4 v2, s[4:7], s17 offen sc1 lds
    s_add_u32 m0, s19, 4096
    s_add_u32 s17, s20, 264192
    buffer_load_dwordx4 v2, s[4:7], s17 offen sc1 lds
    s_add_u32 m0, s19, 8192
    s_add_u32 s17, s20, 528384
    buffer_load_dwordx4 v2, s[4:7], s17 offen sc1 lds
    s_add_u32 m0, s19, 12288
    s_add_u32 s17, s20, 792576
    buffer_load_dwordx4 v2, s[4:7], s17 offen sc1 lds
    s_add_u32 m0, s19, 16384
    s_add_u32 s17, s20, 1056768
    buffer_load_dwordx4 v2, s[4:7], s17 offen sc1 lds
    s_add_u32 m0, s19, 20480
    s_add_u32 s17, s20, 1320960
    buffer_load_dwordx4 v2, s[4:7], s17 offen sc1 lds
    s_add_u32 m0, s19, 24576
    s_add_u32 s17, s20, 1585152
    buffer_load_dwordx4 v2, s[4:7], s17 offen sc1 lds
    s_add_u32 m0, s19, 28672
    s_add_u32 s17, s20, 1849344
    buffer_load_dwordx4 v2, s[4:7], s17 offen sc1 lds
    s_add_u32 m0, s19, 32768
    s_add_u32 s17, s20, 2113536
    buffer_load_dwordx4 v2, s[4:7], s17 offen sc1 lds
    s_add_u32 m0, s19, 36864
    s_add_u32 s17, s20, 2377728
    buffer_load_dwordx4 v2, s[4:7], s17 offen sc1 lds
    s_add_u32 m0, s19, 40960
    s_add_u32 s17, s20, 2641920
    buffer_load_dwordx4 v2, s[4:7], s17 offen sc1 lds
    s_add_u32 m0, s19, 45056
    s_add_u32 s17, s20, 2906112
    buffer_load_dwordx4 v2, s[4:7], s17 offen sc1 lds
    s_add_u32 m0, s19, 49152
    s_add_u32 s17, s20, 3170304
    buffer_load_dwordx4 v2, s[4:7], s17 offen sc1 lds
    s_add_u32 m0, s19, 53248
    s_add_u32 s17, s20, 3434496
    buffer_load_dwordx4 v2, s[4:7], s17 offen sc1 lds
    s_add_u32 m0, s19, 57344
    s_add_u32 s17, s20, 3698688
    buffer_load_dwordx4 v2, s[4:7], s17 offen sc1 lds
    s_add_u32 m0, s19, 61440
    s_add_u32 s17, s20, 3962880
    buffer_load_dwordx4 v2, s[4:7], s17 offen sc1 lds
    s_add_u32 s20, s20, s24
    s_add_u32 m0, s19, 65536
    s_add_u32 s17, s20, 0
    buffer_load_dwordx4 v2, s[4:7], s17 offen sc1 lds
    s_add_u32 m0, s19, 69632
    s_add_u32 s17, s20, 264192
    buffer_load_dwordx4 v2, s[4:7], s17 offen sc1 lds
    s_add_u32 m0, s19, 73728
    s_add_u32 s17, s20, 528384
    buffer_load_dwordx4 v2, s[4:7], s17 offen sc1 lds
    s_waitcnt vmcnt(11)
    s_barrier
    ds_read_b128 v[20:23], v10 offset:0
    ds_read_b128 v[24:27], v10 offset:2048
    ds_read_b128 v[28:31], v11 offset:0
    ds_read_b128 v[32:35], v11 offset:2048
    ds_read_b128 v[36:39], v10 offset:4096
    ds_read_b128 v[40:43], v10 offset:6144
    ds_read_b128 v[44:47], v11 offset:4096
.p2align 6
F3_top:
    s_waitcnt lgkmcnt(6)
    v_mfma_f32_16x16x32_bf16 v[52:55], a[0:3], v[20:23], 0
    ds_read_b128 v[48:51], v11 offset:6144
    v_mfma_f32_16x16x32_bf16 v[56:59], a[4:7], v[20:23], 0
    s_waitcnt lgkmcnt(6)
    v_mfma_f32_16x16x32_bf16 v[60:63], a[0:3], v[24:27], 0
    ds_read_b128 v[20:23], v10 offset:8192
    s_add_u32 m0, s19, 77824
    v_mfma_f32_16x16x32_bf16 v[64:67], a[4:7], v[24:27], 0
    s_add_u32 s17, s20, 792576
    buffer_load_dwordx4 v2, s[4:7], s17 offen sc1 lds
    s_waitcnt lgkmcnt(6)
    v_mfma_f32_16x16x32_bf16 v[52:55], a[8:11], v[28:31], v[52:55]
    ds_read_b128 v[24:27], v10 offset:10240
    v_mfma_f32_16x16x32_bf16 v[56:59], a[12:15], v[28:31], v[56:59]
    s_waitcnt lgkmcnt(6)
    v_mfma_f32_16x16x32_bf16 v[60:63], a[8:11], v[32:35], v[60:63]
    ds_read_b128 v[28:31], v11 offset:8192
    s_add_u32 m0, s19, 81920
    v_mfma_f32_16x16x32_bf16 v[64:67], a[12:15], v[32:35], v[64:67]
    s_add_u32 s17, s20, 1056768
    buffer_load_dwordx4 v2, s[4:7], s17 offen sc1 lds
    s_waitcnt lgkmcnt(6)
    v_mfma_f32_16x16x32_bf16 v[52:55], a[16:19], v[36:39], v[52:55]
    ds_read_b128 v[32:35], v11 offset:10240
    v_mfma_f32_16x16x32_bf16 v[56:59], a[20:23], v[36:39], v[56:59]
    s_waitcnt lgkmcnt(6)
    v_mfma_f32_16x16x32_bf16 v[60:63], a[16:19], v[40:43], v[60:63]
    ds_read_b128 v[36:39], v10 offset:12288
    s_add_u32 m0, s19, 86016
    v_mfma_f32_16x16x32_bf16 v[64:67], a[20:23], v[40:43], v[64:67]
    s_add_u32 s17, s20, 1320960
    buffer_load_dwordx4 v2, s[4:7], s17 offen sc1 lds
    s_waitcnt lgkmcnt(6)
    v_mfma_f32_16x16x32_bf16 v[52:55], a[24:27], v[44:47], v[52:55]
    ds_read_b128 v[40:43], v10 offset:14336
    v_mfma_f32_16x16x32_bf16 v[56:59], a[28:31], v[44:47], v[56:59]
    s_waitcnt lgkmcnt(6)
    v_mfma_f32_16x16x32_bf16 v[60:63], a[24:27], v[48:51], v[60:63]
    ds_read_b128 v[44:47], v11 offset:12288
    s_add_u32 m0, s19, 90112
    v_mfma_f32_16x16x32_bf16 v[64:67], a[28:31], v[48:51], v[64:67]
    s_add_u32 s17, s20, 1585152
    buffer_load_dwordx4 v2, s[4:7], s17 offen sc1 lds
    s_waitcnt lgkmcnt(6)
    v_mfma_f32_16x16x32_bf16 v[52:55], a[32:35], v[20:23], v[52:55]
    ds_read_b128 v[48:51], v11 offset:14336
    v_mfma_f32_16x16x32_bf16 v[56:59], a[36:39], v[20:23], v[56:59]
    s_waitcnt lgkmcnt(6)
    v_mfma_f32_16x16x32_bf16 v[60:63], a[32:35], v[24:27], v[60:63]
    ds_read_b128 v[20:23], v10 offset:16384
    s_add_u32 m0, s19, 94208
    v_mfma_f32_16x16x32_bf16 v[64:67], a[36:39], v[24:27], v[64:67]
    s_add_u32 s17, s20, 1849344
    buffer_load_dwordx4 v2, s[4:7], s17 offen sc1 lds
    s_waitcnt lgkmcnt(6)
    v_mfma_f32_16x16x32_bf16 v[52:55], a[40:43], v[28:31], v[52:55]
    ds_read_b128 v[24:27], v10 offset:18432
    v_mfma_f32_16x16x32_bf16 v[56:59], a[44:47], v[28:31], v[56:59]
    v_cvt_pk_bf16_f32 v84, v68, v69
    s_waitcnt lgkmcnt(6)
    v_mfma_f32_16x16x32_bf16 v[60:63], a[40:43], v[32:35], v[60:63]
    ds_read_b128 v[28:31], v11 offset:16384
    v_mfma_f32_16x16x32_bf16 v[64:67], a[44:47], v[32:35], v[64:67]
    v_cvt_pk_bf16_f32 v85, v70, v71
    s_waitcnt lgkmcnt(6)
    v_mfma_f32_16x16x32_bf16 v[52:55], a[48:51], v[36:39], v[52:55]
    ds_read_b128 v[32:35], v11 offset:18432
    v_mfma_f32_16x16x32_bf16 v[56:59], a[52:55], v[36:39], v[56:59]
    v_cvt_pk_bf16_f32 v86, v72, v73
    s_waitcnt lgkmcnt(6)
    v_mfma_f32_16x16x32_bf16 v[60:63], a[48:51], v[40:43], v[60:63]
    ds_read_b128 v[36:39], v10 offset:20480
    v_mfma_f32_16x16x32_bf16 v[64:67], a[52:55], v[40:43], v[64:67]
    v_cvt_pk_bf16_f32 v87, v74, v75
    s_waitcnt lgkmcnt(6)
    v_mfma_f32_16x16x32_bf16 v[52:55], a[56:59], v[44:47], v[52:55]
    ds_read_b128 v[40:43], v10 offset:22528
    v_mfma_f32_16x16x32_bf16 v[56:59], a[60:63], v[44:47], v[56:59]
    v_cvt_pk_bf16_f32 v88, v76, v77
    s_waitcnt lgkmcnt(6)
    v_mfma_f32_16x16x32_bf16 v[60:63], a[56:59], v[48:51], v[60:63]
    ds_read_b128 v[44:47], v11 offset:20480
    v_mfma_f32_16x16x32_bf16 v[64:67], a[60:63], v[48:51], v[64:67]
    v_cvt_pk_bf16_f32 v89, v78, v79
    buffer_store_dwordx4 v[84:87], v3, s[12:15], s21 offen
    s_waitcnt lgkmcnt(6)
    v_mfma_f32_16x16x32_bf16 v[52:55], a[64:67], v[20:23], v[52:55]
    ds_read_b128 v[48:51], v11 offset:22528
    v_mfma_f32_16x16x32_bf16 v[56:59], a[68:71], v[20:23], v[56:59]
    v_cvt_pk_bf16_f32 v90, v80, v81
    s_waitcnt lgkmcnt(6)
    v_mfma_f32_16x16x32_bf16 v[60:63], a[64:67], v[24:27], v[60:63]
    ds_read_b128 v[20:23], v10 offset:24576
    v_mfma_f32_16x16x32_bf16 v[64:67], a[68:71], v[24:27], v[64:67]
    v_cvt_pk_bf16_f32 v91, v82, v83
    s_waitcnt lgkmcnt(6)
    v_mfma_f32_16x16x32_bf16 v[52:55], a[72:75], v[28:31], v[52:55]
    ds_read_b128 v[24:27], v10 offset:26624
    v_mfma_f32_16x16x32_bf16 v[56:59], a[76:79], v[28:31], v[56:59]
    s_waitcnt lgkmcnt(6)
    v_mfma_f32_16x16x32_bf16 v[60:63], a[72:75], v[32:35], v[60:63]
    ds_read_b128 v[28:31], v11 offset:24576
    v_mfma_f32_16x16x32_bf16 v[64:67], a[76:79], v[32:35], v[64:67]
    buffer_store_dwordx4 v[88:91], v4, s[12:15], s21 offen
    s_waitcnt lgkmcnt(6)
    v_mfma_f32_16x16x32_bf16 v[52:55], a[80:83], v[36:39], v[52:55]
    ds_read_b128 v[32:35], v11 offset:26624
    v_mfma_f32_16x16x32_bf16 v[56:59], a[84:87], v[36:39], v[56:59]
    s_add_u32 s21, s21, s25
    s_mov_b32 s25, s26
    s_waitcnt lgkmcnt(6)
    v_mfma_f32_16x16x32_bf16 v[60:63], a[80:83], v[40:43], v[60:63]
    ds_read_b128 v[36:39], v10 offset:28672
    v_mfma_f32_16x16x32_bf16 v[64:67], a[84:87], v[40:43], v[64:67]
    s_waitcnt lgkmcnt(6)
    v_mfma_f32_16x16x32_bf16 v[52:55], a[88:91], v[44:47], v[52:55]
    ds_read_b128 v[40:43], v10 offset:30720
    v_mfma_f32_16x16x32_bf16 v[56:59], a[92:95], v[44:47], v[56:59]
    s_waitcnt lgkmcnt(6)
    v_mfma_f32_16x16x32_bf16 v[60:63], a[88:91], v[48:51], v[60:63]
    ds_read_b128 v[44:47], v11 offset:28672
    v_mfma_f32_16x16x32_bf16 v[64:67], a[92:95], v[48:51], v[64:67]
    s_waitcnt lgkmcnt(6)
    v_mfma_f32_16x16x32_bf16 v[52:55], a[96:99], v[20:23], v[52:55]
    ds_read_b128 v[48:51], v11 offset:30720
    v_mfma_f32_16x16x32_bf16 v[56:59], a[100:103], v[20:23], v[56:59]
    s_waitcnt lgkmcnt(6)
    v_mfma_f32_16x16x32_bf16 v[60:63], a[96:99], v[24:27], v[60:63]
    s_waitcnt vmcnt(10)
    s_barrier
    ds_read_b128 v[20:23], v10 offset:32768
    v_mfma_f32_16x16x32_bf16 v[64:67], a[100:103], v[24:27], v[64:67]
    s_waitcnt lgkmcnt(6)
    v_mfma_f32_16x16x32_bf16 v[52:55], a[104:107], v[28:31], v[52:55]
    ds_read_b128 v[24:27], v10 offset:34816
    s_add_u32 m0, s19, 98304
    v_mfma_f32_16x16x32_bf16 v[56:59], a[108:111], v[28:31], v[56:59]
    s_add_u32 s17, s20, 2113536
    buffer_load_dwordx4 v2, s[4:7], s17 offen sc1 lds
    s_waitcnt lgkmcnt(6)
    v_mfma_f32_16x16x32_bf16 v[60:63], a[104:107], v[32:35], v[60:63]
    ds_read_b128 v[28:31], v11 offset:32768
    v_mfma_f32_16x16x32_bf16 v[64:67], a[108:111], v[32:35], v[64:67]
    s_waitcnt lgkmcnt(6)
    v_mfma_f32_16x16x32_bf16 v[52:55], a[112:115], v[36:39], v[52:55]
    ds_read_b128 v[32:35], v11 offset:34816
    s_add_u32 m0, s19, 102400
    v_mfma_f32_16x16x32_bf16 v[56:59], a[116:119], v[36:39], v[56:59]
    s_add_u32 s17, s20, 2377728
    buffer_load_dwordx4 v2, s[4:7], s17 offen sc1 lds
    s_waitcnt lgkmcnt(6)
    v_mfma_f32_16x16x32_bf16 v[60:63], a[112:115], v[40:43], v[60:63]
    ds_read_b128 v[36:39], v10 offset:36864
    v_mfma_f32_16x16x32_bf16 v[64:67], a[116:119], v[40:43], v[64:67]
    s_waitcnt lgkmcnt(6)
    v_mfma_f32_16x16x32_bf16 v[52:55], a[120:123], v[44:47], v[52:55]
    ds_read_b128 v[40:43], v10 offset:38912
    s_add_u32 m0, s19, 106496
    v_mfma_f32_16x16x32_bf16 v[56:59], a[124:127], v[44:47], v[56:59]
    s_add_u32 s17, s20, 2641920
    buffer_load_dwordx4 v2, s[4:7], s17 offen sc1 lds
    s_waitcnt lgkmcnt(6)
    v_mfma_f32_16x16x32_bf16 v[60:63], a[120:123], v[48:51], v[60:63]
    ds_read_b128 v[44:47], v11 offset:36864
    v_mfma_f32_16x16x32_bf16 v[64:67], a[124:127], v[48:51], v[64:67]
    s_waitcnt lgkmcnt(6)
    v_mfma_f32_16x16x32_bf16 v[52:55], a[128:131], v[20:23], v[52:55]
    ds_read_b128 v[48:51], v11 offset:38912
    v_mfma_f32_16x16x32_bf16 v[56:59], a[132:135], v[20:23], v[56:59]
    s_waitcnt lgkmcnt(6)
    v_mfma_f32_16x16x32_bf16 v[60:63], a[128:131], v[24:27], v[60:63]
    ds_read_b128 v[20:23], v10 offset:40960
    s_add_u32 m0, s19, 110592
    v_mfma_f32_16x16x32_bf16 v[64:67], a[132:135], v[24:27], v[64:67]
    s_add_u32 s17, s20, 2906112
    buffer_load_dwordx4 v2, s[4:7], s17 offen sc1 lds
    s_waitcnt lgkmcnt(6)
    v_mfma_f32_16x16x32_bf16 v[52:55], a[136:139], v[28:31], v[52:55]
    ds_read_b128 v[24:27], v10 offset:43008
    v_mfma_f32_16x16x32_bf16 v[56:59], a[140:143], v[28:31], v[56:59]
    s_waitcnt lgkmcnt(6)
    v_mfma_f32_16x16x32_bf16 v[60:63], a[136:139], v[32:35], v[60:63]
    ds_read_b128 v[28:31], v11 offset:40960
    s_add_u32 m0, s19, 114688
    v_mfma_f32_16x16x32_bf16 v[64:67], a[140:143], v[32:35], v[64:67]
    s_add_u32 s17, s20, 3170304
    buffer_load_dwordx4 v2, s[4:7], s17 offen sc1 lds
    s_waitcnt lgkmcnt(6)
    v_mfma_f32_16x16x32_bf16 v[52:55], a[144:147], v[36:39], v[52:55]
    ds_read_b128 v[32:35], v11 offset:43008
    v_mfma_f32_16x16x32_bf16 v[56:59], a[148:151], v[36:39], v[56:59]
    s_waitcnt lgkmcnt(6)
    v_mfma_f32_16x16x32_bf16 v[60:63], a[144:147], v[40:43], v[60:63]
    ds_read_b128 v[36:39], v10 offset:45056
    s_add_u32 m0, s19, 118784
    v_mfma_f32_16x16x32_bf16 v[64:67], a[148:151], v[40:43], v[64:67]
    s_add_u32 s17, s20, 3434496
    buffer_load_dwordx4 v2, s[4:7], s17 offen sc1 lds
    s_waitcnt lgkmcnt(6)
    v_mfma_f32_16x16x32_bf16 v[52:55], a[152:155], v[44:47], v[52:55]
    ds_read_b128 v[40:43], v10 offset:47104
    v_mfma_f32_16x16x32_bf16 v[56:59], a[156:159], v[44:47], v[56:59]
    s_waitcnt lgkmcnt(6)
    v_mfma_f32_16x16x32_bf16 v[60:63], a[152:155], v[48:51], v[60:63]
    ds_read_b128 v[44:47], v11 offset:45056
    s_add_u32 m0, s19, 122880
    v_mfma_f32_16x16x32_bf16 v[64:67], a[156:159], v[48:51], v[64:67]
    s_add_u32 s17, s20, 3698688
    buffer_load_dwordx4 v2, s[4:7], s17 offen sc1 lds
    s_waitcnt lgkmcnt(6)
    v_mfma_f32_16x16x32_bf16 v[52:55], a[160:163], v[20:23], v[52:55]
    ds_read_b128 v[48:51], v11 offset:47104
    v_mfma_f32_16x16x32_bf16 v[56:59], a[164:167], v[20:23], v[56:59]
    s_waitcnt lgkmcnt(6)
    v_mfma_f32_16x16x32_bf16 v[60:63], a[160:163], v[24:27], v[60:63]
    ds_read_b128 v[20:23], v10 offset:49152
    s_add_u32 m0, s19, 126976
    v_mfma_f32_16x16x32_bf16 v[64:67], a[164:167], v[24:27], v[64:67]
    s_add_u32 s17, s20, 3962880
    buffer_load_dwordx4 v2, s[4:7], s17 offen sc1 lds
    s_waitcnt lgkmcnt(6)
    v_mfma_f32_16x16x32_bf16 v[52:55], a[168:171], v[28:31], v[52:55]
    ds_read_b128 v[24:27], v10 offset:51200
    v_mfma_f32_16x16x32_bf16 v[56:59], a[172:175], v[28:31], v[56:59]
    s_add_u32 s20, s20, s24
    s_waitcnt lgkmcnt(6)
    v_mfma_f32_16x16x32_bf16 v[60:63], a[168:171], v[32:35], v[60:63]
    ds_read_b128 v[28:31], v11 offset:49152
    v_mfma_f32_16x16x32_bf16 v[64:67], a[172:175], v[32:35], v[64:67]
    s_waitcnt lgkmcnt(6)
    v_mfma_f32_16x16x32_bf16 v[52:55], a[176:179], v[36:39], v[52:55]
    ds_read_b128 v[32:35], v11 offset:51200
    v_mfma_f32_16x16x32_bf16 v[56:59], a[180:183], v[36:39], v[56:59]
    s_waitcnt lgkmcnt(6)
    v_mfma_f32_16x16x32_bf16 v[60:63], a[176:179], v[40:43], v[60:63]
    ds_read_b128 v[36:39], v10 offset:53248
    v_mfma_f32_16x16x32_bf16 v[64:67], a[180:183], v[40:43], v[64:67]
    s_waitcnt lgkmcnt(6)
    v_mfma_f32_16x16x32_bf16 v[52:55], a[184:187], v[44:47], v[52:55]
    ds_read_b128 v[40:43], v10 offset:55296
    v_mfma_f32_16x16x32_bf16 v[56:59], a[188:191], v[44:47], v[56:59]
    s_waitcnt lgkmcnt(6)
    v_mfma_f32_16x16x32_bf16 v[60:63], a[184:187], v[48:51], v[60:63]
    ds_read_b128 v[44:47], v11 offset:53248
    v_mfma_f32_16x16x32_bf16 v[64:67], a[188:191], v[48:51], v[64:67]
    s_waitcnt lgkmcnt(6)
    v_mfma_f32_16x16x32_bf16 v[52:55], a[192:195], v[20:23], v[52:55]
    ds_read_b128 v[48:51], v11 offset:55296
    v_mfma_f32_16x16x32_bf16 v[56:59], a[196:199], v[20:23], v[56:59]
    s_waitcnt lgkmcnt(6)
    v_mfma_f32_16x16x32_bf16 v[60:63], a[192:195], v[24:27], v[60:63]
    ds_read_b128 v[20:23], v10 offset:57344
    v_mfma_f32_16x16x32_bf16 v[64:67], a[196:199], v[24:27], v[64:67]
    s_waitcnt lgkmcnt(6)
    v_mfma_f32_16x16x32_bf16 v[52:55], a[200:203], v[28:31], v[52:55]
    ds_read_b128 v[24:27], v10 offset:59392
    v_mfma_f32_16x16x32_bf16 v[56:59], a[204:207], v[28:31], v[56:59]
    s_waitcnt lgkmcnt(6)
    v_mfma_f32_16x16x32_bf16 v[60:63], a[200:203], v[32:35], v[60:63]
    ds_read_b128 v[28:31], v11 offset:57344
    v_mfma_f32_16x16x32_bf16 v[64:67], a[204:207], v[32:35], v[64:67]
    s_waitcnt lgkmcnt(6)
    v_mfma_f32_16x16x32_bf16 v[52:55], a[208:211], v[36:39], v[52:55]
    ds_read_b128 v[32:35], v11 offset:59392
    v_mfma_f32_16x16x32_bf16 v[56:59], a[212:215], v[36:39], v[56:59]
    s_waitcnt lgkmcnt(6)
    v_mfma_f32_16x16x32_bf16 v[60:63], a[208:211], v[40:43], v[60:63]
    ds_read_b128 v[36:39], v10 offset:61440
    v_mfma_f32_16x16x32_bf16 v[64:67], a[212:215], v[40:43], v[64:67]
    s_waitcnt lgkmcnt(6)
    v_mfma_f32_16x16x32_bf16 v[52:55], a[216:219], v[44:47], v[52:55]
    ds_read_b128 v[40:43], v10 offset:63488
    v_mfma_f32_16x16x32_bf16 v[56:59], a[220:223], v[44:47], v[56:59]
    s_waitcnt lgkmcnt(6)
    v_mfma_f32_16x16x32_bf16 v[60:63], a[216:219], v[48:51], v[60:63]
    ds_read_b128 v[44:47], v11 offset:61440
    v_mfma_f32_16x16x32_bf16 v[64:67], a[220:223], v[48:51], v[64:67]
    s_waitcnt lgkmcnt(6)
    v_mfma_f32_16x16x32_bf16 v[52:55], a[224:227], v[20:23], v[52:55]
    ds_read_b128 v[48:51], v11 offset:63488
    v_mfma_f32_16x16x32_bf16 v[56:59], a[228:231], v[20:23], v[56:59]
    s_waitcnt lgkmcnt(6)
    v_mfma_f32_16x16x32_bf16 v[60:63], a[224:227], v[24:27], v[60:63]
    s_waitcnt vmcnt(8)
    s_barrier
    ds_read_b128 v[20:23], v12 offset:0
    v_mfma_f32_16x16x32_bf16 v[64:67], a[228:231], v[24:27], v[64:67]
    s_waitcnt lgkmcnt(6)
    v_mfma_f32_16x16x32_bf16 v[52:55], a[232:235], v[28:31], v[52:55]
    ds_read_b128 v[24:27], v12 offset:2048
    s_add_u32 m0, s19, 0
    v_mfma_f32_16x16x32_bf16 v[56:59], a[236:239], v[28:31], v[56:59]
    s_add_u32 s17, s20, 0
    buffer_load_dwordx4 v2, s[4:7], s17 offen sc1 lds
    s_waitcnt lgkmcnt(6)
    v_mfma_f32_16x16x32_bf16 v[60:63], a[232:235], v[32:35], v[60:63]
    ds_read_b128 v[28:31], v13 offset:0
    v_mfma_f32_16x16x32_bf16 v[64:67], a[236:239], v[32:35], v[64:67]
    s_waitcnt lgkmcnt(6)
    v_mfma_f32_16x16x32_bf16 v[52:55], a[240:243], v[36:39], v[52:55]
    ds_read_b128 v[32:35], v13 offset:2048
    s_add_u32 m0, s19, 4096
    v_mfma_f32_16x16x32_bf16 v[56:59], a[244:247], v[36:39], v[56:59]
    s_add_u32 s17, s20, 264192
    buffer_load_dwordx4 v2, s[4:7], s17 offen sc1 lds
    s_waitcnt lgkmcnt(6)
    v_mfma_f32_16x16x32_bf16 v[60:63], a[240:243], v[40:43], v[60:63]
    ds_read_b128 v[36:39], v12 offset:4096
    v_mfma_f32_16x16x32_bf16 v[64:67], a[244:247], v[40:43], v[64:67]
    s_waitcnt lgkmcnt(6)
    v_mfma_f32_16x16x32_bf16 v[52:55], a[248:251], v[44:47], v[52:55]
    ds_read_b128 v[40:43], v12 offset:6144
    s_add_u32 m0, s19, 8192
    v_mfma_f32_16x16x32_bf16 v[56:59], a[252:255], v[44:47], v[56:59]
    s_add_u32 s17, s20, 528384
    buffer_load_dwordx4 v2, s[4:7], s17 offen sc1 lds
    s_waitcnt lgkmcnt(6)
    v_mfma_f32_16x16x32_bf16 v[60:63], a[248:251], v[48:51], v[60:63]
    ds_read_b128 v[44:47], v13 offset:4096
    v_mfma_f32_16x16x32_bf16 v[64:67], a[252:255], v[48:51], v[64:67]
    s_waitcnt lgkmcnt(6)
    v_mfma_f32_16x16x32_bf16 v[68:71], a[0:3], v[20:23], 0
    ds_read_b128 v[48:51], v13 offset:6144
    v_mfma_f32_16x16x32_bf16 v[72:75], a[4:7], v[20:23], 0
    s_waitcnt lgkmcnt(6)
    v_mfma_f32_16x16x32_bf16 v[76:79], a[0:3], v[24:27], 0
    ds_read_b128 v[20:23], v12 offset:8192
    s_add_u32 m0, s19, 12288
    v_mfma_f32_16x16x32_bf16 v[80:83], a[4:7], v[24:27], 0
    s_add_u32 s17, s20, 792576
    buffer_load_dwordx4 v2, s[4:7], s17 offen sc1 lds
    s_waitcnt lgkmcnt(6)
    v_mfma_f32_16x16x32_bf16 v[68:71], a[8:11], v[28:31], v[68:71]
    ds_read_b128 v[24:27], v12 offset:10240
    v_mfma_f32_16x16x32_bf16 v[72:75], a[12:15], v[28:31], v[72:75]
    s_waitcnt lgkmcnt(6)
    v_mfma_f32_16x16x32_bf16 v[76:79], a[8:11], v[32:35], v[76:79]
    ds_read_b128 v[28:31], v13 offset:8192
    s_add_u32 m0, s19, 16384
    v_mfma_f32_16x16x32_bf16 v[80:83], a[12:15], v[32:35], v[80:83]
    s_add_u32 s17, s20, 1056768
    buffer_load_dwordx4 v2, s[4:7], s17 offen sc1 lds
    s_waitcnt lgkmcnt(6)
    v_mfma_f32_16x16x32_bf16 v[68:71], a[16:19], v[36:39], v[68:71]
    ds_read_b128 v[32:35], v13 offset:10240
    v_mfma_f32_16x16x32_bf16 v[72:75], a[20:23], v[36:39], v[72:75]
    s_waitcnt lgkmcnt(6)
    v_mfma_f32_16x16x32_bf16 v[76:79], a[16:19], v[40:43], v[76:79]
    ds_read_b128 v[36:39], v12 offset:12288
    s_add_u32 m0, s19, 20480
    v_mfma_f32_16x16x32_bf16 v[80:83], a[20:23], v[40:43], v[80:83]
    s_add_u32 s17, s20, 1320960
    buffer_load_dwordx4 v2, s[4:7], s17 offen sc1 lds
    s_waitcnt lgkmcnt(6)
    v_mfma_f32_16x16x32_bf16 v[68:71], a[24:27], v[44:47], v[68:71]
    ds_read_b128 v[40:43], v12 offset:14336
    v_mfma_f32_16x16x32_bf16 v[72:75], a[28:31], v[44:47], v[72:75]
    s_waitcnt lgkmcnt(6)
    v_mfma_f32_16x16x32_bf16 v[76:79], a[24:27], v[48:51], v[76:79]
    ds_read_b128 v[44:47], v13 offset:12288
    s_add_u32 m0, s19, 24576
    v_mfma_f32_16x16x32_bf16 v[80:83], a[28:31], v[48:51], v[80:83]
    s_add_u32 s17, s20, 1585152
    buffer_load_dwordx4 v2, s[4:7], s17 offen sc1 lds
    s_waitcnt lgkmcnt(6)
    v_mfma_f32_16x16x32_bf16 v[68:71], a[32:35], v[20:23], v[68:71]
    ds_read_b128 v[48:51], v13 offset:14336
    v_mfma_f32_16x16x32_bf16 v[72:75], a[36:39], v[20:23], v[72:75]
    s_waitcnt lgkmcnt(6)
    v_mfma_f32_16x16x32_bf16 v[76:79], a[32:35], v[24:27], v[76:79]
    ds_read_b128 v[20:23], v12 offset:16384
    s_add_u32 m0, s19, 28672
    v_mfma_f32_16x16x32_bf16 v[80:83], a[36:39], v[24:27], v[80:83]
    s_add_u32 s17, s20, 1849344
    buffer_load_dwordx4 v2, s[4:7], s17 offen sc1 lds
    s_waitcnt lgkmcnt(6)
    v_mfma_f32_16x16x32_bf16 v[68:71], a[40:43], v[28:31], v[68:71]
    ds_read_b128 v[24:27], v12 offset:18432
    v_mfma_f32_16x16x32_bf16 v[72:75], a[44:47], v[28:31], v[72:75]
    v_cvt_pk_bf16_f32 v84, v52, v53
    s_waitcnt lgkmcnt(6)
    v_mfma_f32_16x16x32_bf16 v[76:79], a[40:43], v[32:35], v[76:79]
    ds_read_b128 v[28:31], v13 offset:16384
    v_mfma_f32_16x16x32_bf16 v[80:83], a[44:47], v[32:35], v[80:83]
    v_cvt_pk_bf16_f32 v85, v54, v55
    s_waitcnt lgkmcnt(6)
    v_mfma_f32_16x16x32_bf16 v[68:71], a[48:51], v[36:39], v[68:71]
    ds_read_b128 v[32:35], v13 offset:18432
    v_mfma_f32_16x16x32_bf16 v[72:75], a[52:55], v[36:39], v[72:75]
    v_cvt_pk_bf16_f32 v86, v56, v57
    s_waitcnt lgkmcnt(6)
    v_mfma_f32_16x16x32_bf16 v[76:79], a[48:51], v[40:43], v[76:79]
    ds_read_b128 v[36:39], v12 offset:20480
    v_mfma_f32_16x16x32_bf16 v[80:83], a[52:55], v[40:43], v[80:83]
    v_cvt_pk_bf16_f32 v87, v58, v59
    s_waitcnt lgkmcnt(6)
    v_mfma_f32_16x16x32_bf16 v[68:71], a[56:59], v[44:47], v[68:71]
    ds_read_b128 v[40:43], v12 offset:22528
    v_mfma_f32_16x16x32_bf16 v[72:75], a[60:63], v[44:47], v[72:75]
    v_cvt_pk_bf16_f32 v88, v60, v61
    s_waitcnt lgkmcnt(6)
    v_mfma_f32_16x16x32_bf16 v[76:79], a[56:59], v[48:51], v[76:79]
    ds_read_b128 v[44:47], v13 offset:20480
    v_mfma_f32_16x16x32_bf16 v[80:83], a[60:63], v[48:51], v[80:83]
    v_cvt_pk_bf16_f32 v89, v62, v63
    buffer_store_dwordx4 v[84:87], v3, s[12:15], s21 offen
    s_waitcnt lgkmcnt(6)
    v_mfma_f32_16x16x32_bf16 v[68:71], a[64:67], v[20:23], v[68:71]
    ds_read_b128 v[48:51], v13 offset:22528
    v_mfma_f32_16x16x32_bf16 v[72:75], a[68:71], v[20:23], v[72:75]
    v_cvt_pk_bf16_f32 v90, v64, v65
    s_waitcnt lgkmcnt(6)
    v_mfma_f32_16x16x32_bf16 v[76:79], a[64:67], v[24:27], v[76:79]
    ds_read_b128 v[20:23], v12 offset:24576
    v_mfma_f32_16x16x32_bf16 v[80:83], a[68:71], v[24:27], v[80:83]
    v_cvt_pk_bf16_f32 v91, v66, v67
    s_waitcnt lgkmcnt(6)
    v_mfma_f32_16x16x32_bf16 v[68:71], a[72:75], v[28:31], v[68:71]
    ds_read_b128 v[24:27], v12 offset:26624
    v_mfma_f32_16x16x32_bf16 v[72:75], a[76:79], v[28:31], v[72:75]
    s_waitcnt lgkmcnt(6)
    v_mfma_f32_16x16x32_bf16 v[76:79], a[72:75], v[32:35], v[76:79]
    ds_read_b128 v[28:31], v13 offset:24576
    v_mfma_f32_16x16x32_bf16 v[80:83], a[76:79], v[32:35], v[80:83]
    buffer_store_dwordx4 v[88:91], v4, s[12:15], s21 offen
    s_waitcnt lgkmcnt(6)
    v_mfma_f32_16x16x32_bf16 v[68:71], a[80:83], v[36:39], v[68:71]
    ds_read_b128 v[32:35], v13 offset:26624
    v_mfma_f32_16x16x32_bf16 v[72:75], a[84:87], v[36:39], v[72:75]
    s_add_u32 s21, s21, s25
    s_mov_b32 s25, s26
    s_waitcnt lgkmcnt(6)
    v_mfma_f32_16x16x32_bf16 v[76:79], a[80:83], v[40:43], v[76:79]
    ds_read_b128 v[36:39], v12 offset:28672
    v_mfma_f32_16x16x32_bf16 v[80:83], a[84:87], v[40:43], v[80:83]
    s_waitcnt lgkmcnt(6)
    v_mfma_f32_16x16x32_bf16 v[68:71], a[88:91], v[44:47], v[68:71]
    ds_read_b128 v[40:43], v12 offset:30720
    v_mfma_f32_16x16x32_bf16 v[72:75], a[92:95], v[44:47], v[72:75]
    s_waitcnt lgkmcnt(6)
    v_mfma_f32_16x16x32_bf16 v[76:79], a[88:91], v[48:51], v[76:79]
    ds_read_b128 v[44:47], v13 offset:28672
    v_mfma_f32_16x16x32_bf16 v[80:83], a[92:95], v[48:51], v[80:83]
    s_waitcnt lgkmcnt(6)
    v_mfma_f32_16x16x32_bf16 v[68:71], a[96:99], v[20:23], v[68:71]
    ds_read_b128 v[48:51], v13 offset:30720
    v_mfma_f32_16x16x32_bf16 v[72:75], a[100:103], v[20:23], v[72:75]
    s_waitcnt lgkmcnt(6)
    v_mfma_f32_16x16x32_bf16 v[76:79], a[96:99], v[24:27], v[76:79]
    s_waitcnt vmcnt(10)
    s_barrier
    ds_read_b128 v[20:23], v12 offset:32768
    v_mfma_f32_16x16x32_bf16 v[80:83], a[100:103], v[24:27], v[80:83]
    s_waitcnt lgkmcnt(6)
    v_mfma_f32_16x16x32_bf16 v[68:71], a[104:107], v[28:31], v[68:71]
    ds_read_b128 v[24:27], v12 offset:34816
    s_add_u32 m0, s19, 32768
    v_mfma_f32_16x16x32_bf16 v[72:75], a[108:111], v[28:31], v[72:75]
    s_add_u32 s17, s20, 2113536
    buffer_load_dwordx4 v2, s[4:7], s17 offen sc1 lds
    s_waitcnt lgkmcnt(6)
    v_mfma_f32_16x16x32_bf16 v[76:79], a[104:107], v[32:35], v[76:79]
    ds_read_b128 v[28:31], v13 offset:32768
    v_mfma_f32_16x16x32_bf16 v[80:83], a[108:111], v[32:35], v[80:83]
    s_waitcnt lgkmcnt(6)
    v_mfma_f32_16x16x32_bf16 v[68:71], a[112:115], v[36:39], v[68:71]
    ds_read_b128 v[32:35], v13 offset:34816
    s_add_u32 m0, s19, 36864
    v_mfma_f32_16x16x32_bf16 v[72:75], a[116:119], v[36:39], v[72:75]
    s_add_u32 s17, s20, 2377728
    buffer_load_dwordx4 v2, s[4:7], s17 offen sc1 lds
    s_waitcnt lgkmcnt(6)
    v_mfma_f32_16x16x32_bf16 v[76:79], a[112:115], v[40:43], v[76:79]
    ds_read_b128 v[36:39], v12 offset:36864
    v_mfma_f32_16x16x32_bf16 v[80:83], a[116:119], v[40:43], v[80:83]
    s_waitcnt lgkmcnt(6)
    v_mfma_f32_16x16x32_bf16 v[68:71], a[120:123], v[44:47], v[68:71]
    ds_read_b128 v[40:43], v12 offset:38912
    s_add_u32 m0, s19, 40960
    v_mfma_f32_16x16x32_bf16 v[72:75], a[124:127], v[44:47], v[72:75]
    s_add_u32 s17, s20, 2641920
    buffer_load_dwordx4 v2, s[4:7], s17 offen sc1 lds
    s_waitcnt lgkmcnt(6)
    v_mfma_f32_16x16x32_bf16 v[76:79], a[120:123], v[48:51], v[76:79]
    ds_read_b128 v[44:47], v13 offset:36864
    v_mfma_f32_16x16x32_bf16 v[80:83], a[124:127], v[48:51], v[80:83]
    s_waitcnt lgkmcnt(6)
    v_mfma_f32_16x16x32_bf16 v[68:71], a[128:131], v[20:23], v[68:71]
    ds_read_b128 v[48:51], v13 offset:38912
    v_mfma_f32_16x16x32_bf16 v[72:75], a[132:135], v[20:23], v[72:75]
    s_waitcnt lgkmcnt(6)
    v_mfma_f32_16x16x32_bf16 v[76:79], a[128:131], v[24:27], v[76:79]
    ds_read_b128 v[20:23], v12 offset:40960
    s_add_u32 m0, s19, 45056
    v_mfma_f32_16x16x32_bf16 v[80:83], a[132:135], v[24:27], v[80:83]
    s_add_u32 s17, s20, 2906112
    buffer_load_dwordx4 v2, s[4:7], s17 offen sc1 lds
    s_waitcnt lgkmcnt(6)
    v_mfma_f32_16x16x32_bf16 v[68:71], a[136:139], v[28:31], v[68:71]
    ds_read_b128 v[24:27], v12 offset:43008
    v_mfma_f32_16x16x32_bf16 v[72:75], a[140:143], v[28:31], v[72:75]
    s_waitcnt lgkmcnt(6)
    v_mfma_f32_16x16x32_bf16 v[76:79], a[136:139], v[32:35], v[76:79]
    ds_read_b128 v[28:31], v13 offset:40960
    s_add_u32 m0, s19, 49152
    v_mfma_f32_16x16x32_bf16 v[80:83], a[140:143], v[32:35], v[80:83]
    s_add_u32 s17, s20, 3170304
    buffer_load_dwordx4 v2, s[4:7], s17 offen sc1 lds
    s_waitcnt lgkmcnt(6)
    v_mfma_f32_16x16x32_bf16 v[68:71], a[144:147], v[36:39], v[68:71]
    ds_read_b128 v[32:35], v13 offset:43008
    v_mfma_f32_16x16x32_bf16 v[72:75], a[148:151], v[36:39], v[72:75]
    s_waitcnt lgkmcnt(6)
    v_mfma_f32_16x16x32_bf16 v[76:79], a[144:147], v[40:43], v[76:79]
    ds_read_b128 v[36:39], v12 offset:45056
    s_add_u32 m0, s19, 53248
    v_mfma_f32_16x16x32_bf16 v[80:83], a[148:151], v[40:43], v[80:83]
    s_add_u32 s17, s20, 3434496
    buffer_load_dwordx4 v2, s[4:7], s17 offen sc1 lds
    s_waitcnt lgkmcnt(6)
    v_mfma_f32_16x16x32_bf16 v[68:71], a[152:155], v[44:47], v[68:71]
    ds_read_b128 v[40:43], v12 offset:47104
    v_mfma_f32_16x16x32_bf16 v[72:75], a[156:159], v[44:47], v[72:75]
    s_waitcnt lgkmcnt(6)
    v_mfma_f32_16x16x32_bf16 v[76:79], a[152:155], v[48:51], v[76:79]
    ds_read_b128 v[44:47], v13 offset:45056
    s_add_u32 m0, s19, 57344
    v_mfma_f32_16x16x32_bf16 v[80:83], a[156:159], v[48:51], v[80:83]
    s_add_u32 s17, s20, 3698688
    buffer_load_dwordx4 v2, s[4:7], s17 offen sc1 lds
    s_waitcnt lgkmcnt(6)
    v_mfma_f32_16x16x32_bf16 v[68:71], a[160:163], v[20:23], v[68:71]
    ds_read_b128 v[48:51], v13 offset:47104
    v_mfma_f32_16x16x32_bf16 v[72:75], a[164:167], v[20:23], v[72:75]
    s_waitcnt lgkmcnt(6)
    v_mfma_f32_16x16x32_bf16 v[76:79], a[160:163], v[24:27], v[76:79]
    ds_read_b128 v[20:23], v12 offset:49152
    s_add_u32 m0, s19, 61440
    v_mfma_f32_16x16x32_bf16 v[80:83], a[164:167], v[24:27], v[80:83]
    s_add_u32 s17, s20, 3962880
    buffer_load_dwordx4 v2, s[4:7], s17 offen sc1 lds
    s_waitcnt lgkmcnt(6)
    v_mfma_f32_16x16x32_bf16 v[68:71], a[168:171], v[28:31], v[68:71]
    ds_read_b128 v[24:27], v12 offset:51200
    v_mfma_f32_16x16x32_bf16 v[72:75], a[172:175], v[28:31], v[72:75]
    s_add_u32 s20, s20, s24
    s_waitcnt lgkmcnt(6)
    v_mfma_f32_16x16x32_bf16 v[76:79], a[168:171], v[32:35], v[76:79]
    ds_read_b128 v[28:31], v13 offset:49152
    v_mfma_f32_16x16x32_bf16 v[80:83], a[172:175], v[32:35], v[80:83]
    s_waitcnt lgkmcnt(6)
    v_mfma_f32_16x16x32_bf16 v[68:71], a[176:179], v[36:39], v[68:71]
    ds_read_b128 v[32:35], v13 offset:51200
    v_mfma_f32_16x16x32_bf16 v[72:75], a[180:183], v[36:39], v[72:75]
    s_waitcnt lgkmcnt(6)
    v_mfma_f32_16x16x32_bf16 v[76:79], a[176:179], v[40:43], v[76:79]
    ds_read_b128 v[36:39], v12 offset:53248
    v_mfma_f32_16x16x32_bf16 v[80:83], a[180:183], v[40:43], v[80:83]
    s_waitcnt lgkmcnt(6)
    v_mfma_f32_16x16x32_bf16 v[68:71], a[184:187], v[44:47], v[68:71]
    ds_read_b128 v[40:43], v12 offset:55296
    v_mfma_f32_16x16x32_bf16 v[72:75], a[188:191], v[44:47], v[72:75]
    s_waitcnt lgkmcnt(6)
    v_mfma_f32_16x16x32_bf16 v[76:79], a[184:187], v[48:51], v[76:79]
    ds_read_b128 v[44:47], v13 offset:53248
    v_mfma_f32_16x16x32_bf16 v[80:83], a[188:191], v[48:51], v[80:83]
    s_waitcnt lgkmcnt(6)
    v_mfma_f32_16x16x32_bf16 v[68:71], a[192:195], v[20:23], v[68:71]
    ds_read_b128 v[48:51], v13 offset:55296
    v_mfma_f32_16x16x32_bf16 v[72:75], a[196:199], v[20:23], v[72:75]
    s_waitcnt lgkmcnt(6)
    v_mfma_f32_16x16x32_bf16 v[76:79], a[192:195], v[24:27], v[76:79]
    ds_read_b128 v[20:23], v12 offset:57344
    v_mfma_f32_16x16x32_bf16 v[80:83], a[196:199], v[24:27], v[80:83]
    s_waitcnt lgkmcnt(6)
    v_mfma_f32_16x16x32_bf16 v[68:71], a[200:203], v[28:31], v[68:71]
    ds_read_b128 v[24:27], v12 offset:59392
    v_mfma_f32_16x16x32_bf16 v[72:75], a[204:207], v[28:31], v[72:75]
    s_waitcnt lgkmcnt(6)
    v_mfma_f32_16x16x32_bf16 v[76:79], a[200:203], v[32:35], v[76:79]
    ds_read_b128 v[28:31], v13 offset:57344
    v_mfma_f32_16x16x32_bf16 v[80:83], a[204:207], v[32:35], v[80:83]
    s_waitcnt lgkmcnt(6)
    v_mfma_f32_16x16x32_bf16 v[68:71], a[208:211], v[36:39], v[68:71]
    ds_read_b128 v[32:35], v13 offset:59392
    v_mfma_f32_16x16x32_bf16 v[72:75], a[212:215], v[36:39], v[72:75]
    s_waitcnt lgkmcnt(6)
    v_mfma_f32_16x16x32_bf16 v[76:79], a[208:211], v[40:43], v[76:79]
    ds_read_b128 v[36:39], v12 offset:61440
    v_mfma_f32_16x16x32_bf16 v[80:83], a[212:215], v[40:43], v[80:83]
    s_waitcnt lgkmcnt(6)
    v_mfma_f32_16x16x32_bf16 v[68:71], a[216:219], v[44:47], v[68:71]
    ds_read_b128 v[40:43], v12 offset:63488
    v_mfma_f32_16x16x32_bf16 v[72:75], a[220:223], v[44:47], v[72:75]
    s_waitcnt lgkmcnt(6)
    v_mfma_f32_16x16x32_bf16 v[76:79], a[216:219], v[48:51], v[76:79]
    ds_read_b128 v[44:47], v13 offset:61440
    v_mfma_f32_16x16x32_bf16 v[80:83], a[220:223], v[48:51], v[80:83]
    s_waitcnt lgkmcnt(6)
    v_mfma_f32_16x16x32_bf16 v[68:71], a[224:227], v[20:23], v[68:71]
    ds_read_b128 v[48:51], v13 offset:63488
    v_mfma_f32_16x16x32_bf16 v[72:75], a[228:231], v[20:23], v[72:75]
    s_waitcnt lgkmcnt(6)
    v_mfma_f32_16x16x32_bf16 v[76:79], a[224:227], v[24:27], v[76:79]
    s_waitcnt vmcnt(8)
    s_barrier
    ds_read_b128 v[20:23], v10 offset:0
    v_mfma_f32_16x16x32_bf16 v[80:83], a[228:231], v[24:27], v[80:83]
    s_waitcnt lgkmcnt(6)
    v_mfma_f32_16x16x32_bf16 v[68:71], a[232:235], v[28:31], v[68:71]
    ds_read_b128 v[24:27], v10 offset:2048
    s_add_u32 m0, s19, 65536
    v_mfma_f32_16x16x32_bf16 v[72:75], a[236:239], v[28:31], v[72:75]
    s_add_u32 s17, s20, 0
    buffer_load_dwordx4 v2, s[4:7], s17 offen sc1 lds
    s_waitcnt lgkmcnt(6)
    v_mfma_f32_16x16x32_bf16 v[76:79], a[232:235], v[32:35], v[76:79]
    ds_read_b128 v[28:31], v11 offset:0
    v_mfma_f32_16x16x32_bf16 v[80:83], a[236:239], v[32:35], v[80:83]
    s_waitcnt lgkmcnt(6)
    v_mfma_f32_16x16x32_bf16 v[68:71], a[240:243], v[36:39], v[68:71]
    ds_read_b128 v[32:35], v11 offset:2048
    s_add_u32 m0, s19, 69632
    v_mfma_f32_16x16x32_bf16 v[72:75], a[244:247], v[36:39], v[72:75]
    s_add_u32 s17, s20, 264192
    buffer_load_dwordx4 v2, s[4:7], s17 offen sc1 lds
    s_waitcnt lgkmcnt(6)
    v_mfma_f32_16x16x32_bf16 v[76:79], a[240:243], v[40:43], v[76:79]
    ds_read_b128 v[36:39], v10 offset:4096
    v_mfma_f32_16x16x32_bf16 v[80:83], a[244:247], v[40:43], v[80:83]
    s_waitcnt lgkmcnt(6)
    v_mfma_f32_16x16x32_bf16 v[68:71], a[248:251], v[44:47], v[68:71]
    ds_read_b128 v[40:43], v10 offset:6144
    s_add_u32 m0, s19, 73728
    v_mfma_f32_16x16x32_bf16 v[72:75], a[252:255], v[44:47], v[72:75]
    s_add_u32 s17, s20, 528384
    buffer_load_dwordx4 v2, s[4:7], s17 offen sc1 lds
    s_waitcnt lgkmcnt(6)
    v_mfma_f32_16x16x32_bf16 v[76:79], a[248:251], v[48:51], v[76:79]
    ds_read_b128 v[44:47], v11 offset:4096
    v_mfma_f32_16x16x32_bf16 v[80:83], a[252:255], v[48:51], v[80:83]
    s_add_u32 s22, s22, 2
    s_cmp_lt_u32 s22, 16
    s_cbranch_scc1 F3_top
    v_cvt_pk_bf16_f32 v84, v68, v69
    v_cvt_pk_bf16_f32 v85, v70, v71
    v_cvt_pk_bf16_f32 v86, v72, v73
    v_cvt_pk_bf16_f32 v87, v74, v75
    v_cvt_pk_bf16_f32 v88, v76, v77
    v_cvt_pk_bf16_f32 v89, v78, v79
    v_cvt_pk_bf16_f32 v90, v80, v81
    v_cvt_pk_bf16_f32 v91, v82, v83
    buffer_store_dwordx4 v[84:87], v3, s[12:15], s21 offen
    buffer_store_dwordx4 v[88:91], v4, s[12:15], s21 offen
    s_waitcnt vmcnt(0) lgkmcnt(0)
    s_branch W_T
W_T:
    v_and_b32 v7, 19, v1
    v_bfe_u32 v5, v1, 2, 1
    v_bfe_u32 v6, v1, 3, 1
    v_lshl_add_u32 v7, v5, 3, v7
    v_lshl_add_u32 v7, v6, 2, v7
    v_lshrrev_b32 v5, 5, v1
    v_and_b32 v6, 31, v1
    v_lshlrev_b32 v8, 4, v5
    v_lshl_add_u32 v10, v6, 6, v8
    v_lshl_add_u32 v11, v7, 6, v8
    v_mov_b32 v17, 1073741824
    v_cmp_gt_u32 vcc, 8, v6
    s_nop 1
    v_cndmask_b32 v12, v17, v10, vcc
    v_lshlrev_b32 v13, 3, v5
    v_lshl_add_u32 v13, v7, 4, v13
    v_and_b32 v14, 15, v1
    v_lshlrev_b32 v14, 4, v14
    v_lshl_add_u32 v14, v5, 8, v14
    v_bfe_u32 v8, v1, 4, 1
    v_lshl_add_u32 v14, v8, 17, v14
    v_lshrrev_b32 v15, 2, v1
    v_and_b32 v8, 3, v1
    v_lshl_add_u32 v15, v15, 7, v8
    s_lshl_b32 s17, s91, 2
    v_add_u32 v15, s17, v15
    v_lshlrev_b32 v15, 7, v15
    v_add_u32 v15, 100663296, v15
    v_mov_b32 v16, 0
    s_lshl_b32 s18, s16, 7
    s_add_u32 s18, s18, s17
    s_add_u32 s18, s18, 100728832
    v_mov_b32 v4, s18
    v_cmp_eq_u32 vcc, 0, v1
    s_nop 1
    v_cndmask_b32 v4, v17, v4, vcc
    v_lshlrev_b32 v5, 3, v5
    v_sub_u32 v6, v6, v5
    s_mov_b32 s29, 1040356334
    s_mov_b32 s28, s16
    s_mul_i32 s31, s17, 133120
    s_lshl_b32 s18, s28, 11
    s_add_u32 s31, s31, s18
    s_mul_i32 s32, s17, 33280
    s_lshl_b32 s18, s28, 9
    s_add_u32 s32, s32, s18
    s_add_u32 s32, s32, 71303168
    s_lshl_b32 s33, s28, 18
    s_lshl_b32 s18, s91, 12
    s_add_u32 s33, s33, s18
    s_add_u32 s33, s33, 54525952
    v_mov_b32 v17, 0xff800000
    v_cmp_le_i32 s[36:37], 0, v6
    v_cmp_le_i32 s[38:39], 1, v6
    v_cmp_le_i32 s[40:41], 2, v6
    v_cmp_le_i32 s[42:43], 3, v6
    v_cmp_le_i32 s[44:45], 4, v6
    v_cmp_le_i32 s[46:47], 5, v6
    v_cmp_le_i32 s[48:49], 6, v6
    v_cmp_le_i32 s[50:51], 7, v6
    v_cmp_le_i32 s[52:53], 16, v6
    v_cmp_le_i32 s[54:55], 17, v6
    v_cmp_le_i32 s[56:57], 18, v6
    v_cmp_le_i32 s[58:59], 19, v6
    v_cmp_le_i32 s[60:61], 20, v6
    v_cmp_le_i32 s[62:63], 21, v6
    v_cmp_le_i32 s[64:65], 22, v6
    v_cmp_le_i32 s[66:67], 23, v6
    v_mov_b32 v150, 0
    v_mov_b32 v151, 0
    v_mov_b32 v154, 0
    v_mov_b32 v155, 0
    v_mov_b32 v158, 0
    v_mov_b32 v159, 0
    v_mov_b32 v162, 0
    v_mov_b32 v163, 0
    v_mov_b32 v206, 0
    v_mov_b32 v207, 0
T_top:
    s_mov_b32 s30, s92
T_fl:
    v_cmp_ge_u32 vcc, s28, v16
    s_nop 0
    s_and_b32 s17, vcc_lo, 0xfff
    s_cbranch_scc0 T_go
    s_cmp_ge_u32 s30, 1048576
    s_cselect_b32 s92, 1048576, s92
    s_cbranch_scc1 T_go
    s_add_u32 s30, s30, 1
    s_mov_b64 exec, 0xfff
    buffer_load_dword v16, v15, s[4:7], 0 offen sc1
    s_mov_b64 exec, -1
    s_sleep 8
    s_waitcnt vmcnt(0)
    s_branch T_fl
T_go:
    s_add_u32 s17, s31, 0
    buffer_load_dwordx4 v[20:23], v10, s[4:7], s17 offen offset:0 sc1
    buffer_load_dwordx4 v[24:27], v10, s[4:7], s17 offen offset:32 sc1
    s_add_u32 s17, s31, 133120
    buffer_load_dwordx4 v[28:31], v10, s[4:7], s17 offen offset:0 sc1
    buffer_load_dwordx4 v[32:35], v10, s[4:7], s17 offen offset:32 sc1
    s_add_u32 s17, s31, 266240
    buffer_load_dwordx4 v[36:39], v10, s[4:7], s17 offen offset:0 sc1
    buffer_load_dwordx4 v[40:43], v10, s[4:7], s17 offen offset:32 sc1
    s_add_u32 s17, s31, 399360
    buffer_load_dwordx4 v[44:47], v10, s[4:7], s17 offen offset:0 sc1
    buffer_load_dwordx4 v[48:51], v10, s[4:7], s17 offen offset:32 sc1
    s_add_u32 s17, s31, 17825792
    buffer_load_dwordx4 v[52:55], v11, s[4:7], s17 offen offset:0 sc1
    buffer_load_dwordx4 v[56:59], v11, s[4:7], s17 offen offset:32 sc1
    s_add_u32 s17, s31, 17958912
    buffer_load_dwordx4 v[60:63], v11, s[4:7], s17 offen offset:0 sc1
    buffer_load_dwordx4 v[64:67], v11, s[4:7], s17 offen offset:32 sc1
    s_add_u32 s17, s31, 18092032
    buffer_load_dwordx4 v[68:71], v11, s[4:7], s17 offen offset:0 sc1
    buffer_load_dwordx4 v[72:75], v11, s[4:7], s17 offen offset:32 sc1
    s_add_u32 s17, s31, 18225152
    buffer_load_dwordx4 v[76:79], v11, s[4:7], s17 offen offset:0 sc1
    buffer_load_dwordx4 v[80:83], v11, s[4:7], s17 offen offset:32 sc1
    s_add_u32 s17, s31, 35651584
    buffer_load_dwordx4 v[84:87], v11, s[4:7], s17 offen offset:0 sc1
    buffer_load_dwordx4 v[88:91], v11, s[4:7], s17 offen offset:32 sc1
    s_add_u32 s17, s31, 35784704
    buffer_load_dwordx4 v[92:95], v11, s[4:7], s17 offen offset:0 sc1
    buffer_load_dwordx4 v[96:99], v11, s[4:7], s17 offen offset:32 sc1
    s_add_u32 s17, s31, 35917824
    buffer_load_dwordx4 v[100:103], v11, s[4:7], s17 offen offset:0 sc1
    buffer_load_dwordx4 v[104:107], v11, s[4:7], s17 offen offset:32 sc1
    s_add_u32 s17, s31, 36050944
    buffer_load_dwordx4 v[108:111], v11, s[4:7], s17 offen offset:0 sc1
    buffer_load_dwordx4 v[112:115], v11, s[4:7], s17 offen offset:32 sc1
    s_add_u32 s17, s32, 0
    s_add_u32 s18, s32, 5242880
    buffer_load_dwordx4 v[116:119], v12, s[4:7], s17 offen offset:0 sc1
    buffer_load_dwordx4 v[120:123], v12, s[4:7], s17 offen offset:32 sc1
    buffer_load_dwordx2 v[148:149], v13, s[4:7], s18 offen sc1
    s_add_u32 s17, s32, 33280
    s_add_u32 s18, s32, 5276160
    buffer_load_dwordx4 v[124:127], v12, s[4:7], s17 offen offset:0 sc1
    buffer_load_dwordx4 v[128:131], v12, s[4:7], s17 offen offset:32 sc1
    buffer_load_dwordx2 v[152:153], v13, s[4:7], s18 offen sc1
    s_add_u32 s17, s32, 66560
    s_add_u32 s18, s32, 5309440
    buffer_load_dwordx4 v[132:135], v12, s[4:7], s17 offen offset:0 sc1
    buffer_load_dwordx4 v[136:139], v12, s[4:7], s17 offen offset:32 sc1
    buffer_load_dwordx2 v[156:157], v13, s[4:7], s18 offen sc1
    s_add_u32 s17, s32, 99840
    s_add_u32 s18, s32, 5342720
    buffer_load_dwordx4 v[140:143], v12, s[4:7], s17 offen offset:0 sc1
    buffer_load_dwordx4 v[144:147], v12, s[4:7], s17 offen offset:32 sc1
    buffer_load_dwordx2 v[160:161], v13, s[4:7], s18 offen sc1
    s_waitcnt vmcnt(20)
    v_mfma_f32_32x32x16_bf16 v[164:179], v[52:55], v[20:23], 0
    v_mfma_f32_32x32x16_bf16 v[164:179], v[56:59], v[24:27], v[164:179]
    v_mfma_f32_32x32x16_bf16 v[164:179], v[60:63], v[28:31], v[164:179]
    v_mfma_f32_32x32x16_bf16 v[164:179], v[64:67], v[32:35], v[164:179]
    v_mfma_f32_32x32x16_bf16 v[164:179], v[68:71], v[36:39], v[164:179]
    v_mfma_f32_32x32x16_bf16 v[164:179], v[72:75], v[40:43], v[164:179]
    v_mfma_f32_32x32x16_bf16 v[164:179], v[76:79], v[44:47], v[164:179]
    v_mfma_f32_32x32x16_bf16 v[164:179], v[80:83], v[48:51], v[164:179]
    s_mov_b32 s30, s92
    s_nop 10
    v_cndmask_b32 v164, v17, v164, s[36:37]
    v_cndmask_b32 v165, v17, v165, s[38:39]
    v_cndmask_b32 v166, v17, v166, s[40:41]
    v_cndmask_b32 v167, v17, v167, s[42:43]
    v_cndmask_b32 v168, v17, v168, s[44:45]
    v_cndmask_b32 v169, v17, v169, s[46:47]
    v_cndmask_b32 v170, v17, v170, s[48:49]
    v_cndmask_b32 v171, v17, v171, s[50:51]
    v_cndmask_b32 v172, v17, v172, s[52:53]
    v_cndmask_b32 v173, v17, v173, s[54:55]
    v_cndmask_b32 v174, v17, v174, s[56:57]
    v_cndmask_b32 v175, v17, v175, s[58:59]
    v_cndmask_b32 v176, v17, v176, s[60:61]
    v_cndmask_b32 v177, v17, v177, s[62:63]
    v_cndmask_b32 v178, v17, v178, s[64:65]
    v_cndmask_b32 v179, v17, v179, s[66:67]
    v_max3_f32 v18, v164, v165, v166
    v_max3_f32 v18, v18, v167, v168
    v_max3_f32 v18, v18, v169, v170
    v_max3_f32 v18, v18, v171, v172
    v_max3_f32 v18, v18, v173, v174
    v_max3_f32 v18, v18, v175, v176
    v_max3_f32 v18, v18, v177, v178
    v_max_f32 v18, v18, v179
T_mw:
    s_waitcnt vmcnt(0)
    v_max_u32 v5, v116, v117
    v_max3_u32 v5, v5, v118, v119
    v_max3_u32 v5, v5, v120, v121
    v_max3_u32 v5, v5, v122, v123
    v_max3_u32 v5, v5, v124, v125
    v_max3_u32 v5, v5, v126, v127
    v_max3_u32 v5, v5, v128, v129
    v_max3_u32 v5, v5, v130, v131
    v_max3_u32 v5, v5, v132, v133
    v_max3_u32 v5, v5, v134, v135
    v_max3_u32 v5, v5, v136, v137
    v_max3_u32 v5, v5, v138, v139
    v_max3_u32 v5, v5, v140, v141
    v_max3_u32 v5, v5, v142, v143
    v_max3_u32 v5, v5, v144, v145
    v_max3_u32 v5, v5, v146, v147
    v_max3_u32 v5, v5, v148, v149
    v_max3_u32 v5, v5, v152, v153
    v_max3_u32 v5, v5, v156, v157
    v_max3_u32 v5, v5, v160, v161
    v_cmp_eq_u32 vcc, -1, v5
    s_nop 0
    s_cbranch_vccz T_mok
    s_cmp_ge_u32 s30, 1048576
    s_cselect_b32 s92, 1048576, s92
    s_cbranch_scc1 T_mok
    s_add_u32 s30, s30, 1
    s_sleep 4
    s_add_u32 s17, s32, 0
    s_add_u32 s18, s32, 5242880
    buffer_load_dwordx4 v[116:119], v12, s[4:7], s17 offen offset:0 sc1
    buffer_load_dwordx4 v[120:123], v12, s[4:7], s17 offen offset:32 sc1
    buffer_load_dwordx2 v[148:149], v13, s[4:7], s18 offen sc1
    s_add_u32 s17, s32, 33280
    s_add_u32 s18, s32, 5276160
    buffer_load_dwordx4 v[124:127], v12, s[4:7], s17 offen offset:0 sc1
    buffer_load_dwordx4 v[128:131], v12, s[4:7], s17 offen offset:32 sc1
    buffer_load_dwordx2 v[152:153], v13, s[4:7], s18 offen sc1
    s_add_u32 s17, s32, 66560
    s_add_u32 s18, s32, 5309440
    buffer_load_dwordx4 v[132:135], v12, s[4:7], s17 offen offset:0 sc1
    buffer_load_dwordx4 v[136:139], v12, s[4:7], s17 offen offset:32 sc1
    buffer_load_dwordx2 v[156:157], v13, s[4:7], s18 offen sc1
    s_add_u32 s17, s32, 99840
    s_add_u32 s18, s32, 5342720
    buffer_load_dwordx4 v[140:143], v12, s[4:7], s17 offen offset:0 sc1
    buffer_load_dwordx4 v[144:147], v12, s[4:7], s17 offen offset:32 sc1
    buffer_load_dwordx2 v[160:161], v13, s[4:7], s18 offen sc1
    s_branch T_mw
T_mok:
    v_mfma_f32_32x32x16_bf16 v[180:195], v[116:119], v[20:23], 0
    v_mfma_f32_32x32x16_bf16 v[180:195], v[120:123], v[24:27], v[180:195]
    v_mfma_f32_32x32x16_bf16 v[180:195], v[124:127], v[28:31], v[180:195]
    v_mfma_f32_32x32x16_bf16 v[180:195], v[128:131], v[32:35], v[180:195]
    v_mfma_f32_32x32x16_bf16 v[180:195], v[132:135], v[36:39], v[180:195]
    v_mfma_f32_32x32x16_bf16 v[180:195], v[136:139], v[40:43], v[180:195]
    v_mfma_f32_32x32x16_bf16 v[180:195], v[140:143], v[44:47], v[180:195]
    v_mfma_f32_32x32x16_bf16 v[180:195], v[144:147], v[48:51], v[180:195]
    s_nop 11
    v_max3_f32 v18, v18, v180, v181
    v_max3_f32 v18, v18, v182, v183
    v_mov_b32 v5, v18
    s_nop 1
    v_permlane32_swap_b32 v18, v5
    v_max_f32 v18, v18, v5
    v_mul_f32 v18, s29, v18
    v_fma_f32 v164, v164, s29, -v18
    v_fma_f32 v165, v165, s29, -v18
    v_fma_f32 v166, v166, s29, -v18
    v_fma_f32 v167, v167, s29, -v18
    v_fma_f32 v168, v168, s29, -v18
    v_fma_f32 v169, v169, s29, -v18
    v_fma_f32 v170, v170, s29, -v18
    v_fma_f32 v171, v171, s29, -v18
    v_fma_f32 v172, v172, s29, -v18
    v_fma_f32 v173, v173, s29, -v18
    v_fma_f32 v174, v174, s29, -v18
    v_fma_f32 v175, v175, s29, -v18
    v_fma_f32 v176, v176, s29, -v18
    v_fma_f32 v177, v177, s29, -v18
    v_fma_f32 v178, v178, s29, -v18
    v_fma_f32 v179, v179, s29, -v18
    v_fma_f32 v180, v180, s29, -v18
    v_fma_f32 v181, v181, s29, -v18
    v_fma_f32 v182, v182, s29, -v18
    v_fma_f32 v183, v183, s29, -v18
    v_exp_f32 v164, v164
    v_exp_f32 v165, v165
    v_exp_f32 v166, v166
    v_exp_f32 v167, v167
    v_exp_f32 v168, v168
    v_exp_f32 v169, v169
    v_exp_f32 v170, v170
    v_exp_f32 v171, v171
    v_exp_f32 v172, v172
    v_exp_f32 v173, v173
    v_exp_f32 v174, v174
    v_exp_f32 v175, v175
    v_exp_f32 v176, v176
    v_exp_f32 v177, v177
    v_exp_f32 v178, v178
    v_exp_f32 v179, v179
    v_exp_f32 v180, v180
    v_exp_f32 v181, v181
    v_exp_f32 v182, v182
    v_exp_f32 v183, v183
    v_add_f32 v19, v164, v165
    v_add_f32 v6, v166, v167
    v_add_f32 v19, v19, v168
    v_add_f32 v6, v6, v169
    v_add_f32 v19, v19, v170
    v_add_f32 v6, v6, v171
    v_add_f32 v19, v19, v172
    v_add_f32 v6, v6, v173
    v_add_f32 v19, v19, v174
    v_add_f32 v6, v6, v175
    v_add_f32 v19, v19, v176
    v_add_f32 v6, v6, v177
    v_add_f32 v19, v19, v178
    v_add_f32 v6, v6, v179
    v_add_f32 v19, v19, v180
    v_add_f32 v6, v6, v181
    v_add_f32 v19, v19, v182
    v_add_f32 v6, v6, v183
    v_add_f32 v19, v19, v6
    v_mov_b32 v5, v19
    s_nop 1
    v_permlane32_swap_b32 v19, v5
    v_add_f32 v19, v19, v5
    v_rcp_f32 v19, v19
    s_nop 0
    v_mul_f32 v164, v164, v19
    v_mul_f32 v165, v165, v19
    v_mul_f32 v166, v166, v19
    v_mul_f32 v167, v167, v19
    v_mul_f32 v168, v168, v19
    v_mul_f32 v169, v169, v19
    v_mul_f32 v170, v170, v19
    v_mul_f32 v171, v171, v19
    v_mul_f32 v172, v172, v19
    v_mul_f32 v173, v173, v19
    v_mul_f32 v174, v174, v19
    v_mul_f32 v175, v175, v19
    v_mul_f32 v176, v176, v19
    v_mul_f32 v177, v177, v19
    v_mul_f32 v178, v178, v19
    v_mul_f32 v179, v179, v19
    v_mul_f32 v180, v180, v19
    v_mul_f32 v181, v181, v19
    v_mul_f32 v182, v182, v19
    v_mul_f32 v183, v183, v19
    v_cvt_pk_bf16_f32 v196, v164, v165
    v_cvt_pk_bf16_f32 v197, v166, v167
    v_cvt_pk_bf16_f32 v198, v168, v169
    v_cvt_pk_bf16_f32 v199, v170, v171
    v_cvt_pk_bf16_f32 v200, v172, v173
    v_cvt_pk_bf16_f32 v201, v174, v175
    v_cvt_pk_bf16_f32 v202, v176, v177
    v_cvt_pk_bf16_f32 v203, v178, v179
    v_cvt_pk_bf16_f32 v204, v180, v181
    v_cvt_pk_bf16_f32 v205, v182, v183
    v_mfma_f32_32x32x16_bf16 v[20:35], v[84:87], v[196:199], 0
    v_mfma_f32_32x32x16_bf16 v[20:35], v[88:91], v[200:203], v[20:35]
    v_mfma_f32_32x32x16_bf16 v[20:35], v[148:151], v[204:207], v[20:35]
    v_mfma_f32_32x32x16_bf16 v[36:51], v[92:95], v[196:199], 0
    v_mfma_f32_32x32x16_bf16 v[36:51], v[96:99], v[200:203], v[36:51]
    v_mfma_f32_32x32x16_bf16 v[36:51], v[152:155], v[204:207], v[36:51]
    s_nop 8
    v_cvt_pk_bf16_f32 v208, v20, v21
    v_cvt_pk_bf16_f32 v209, v22, v23
    v_cvt_pk_bf16_f32 v210, v24, v25
    v_cvt_pk_bf16_f32 v211, v26, v27
    v_cvt_pk_bf16_f32 v212, v28, v29
    v_cvt_pk_bf16_f32 v213, v30, v31
    v_cvt_pk_bf16_f32 v214, v32, v33
    v_cvt_pk_bf16_f32 v215, v34, v35
    buffer_store_dwordx4 v[208:211], v14, s[4:7], s33 offen offset:0 sc1
    buffer_store_dwordx4 v[212:215], v14, s[4:7], s33 offen offset:512 sc1
    v_mfma_f32_32x32x16_bf16 v[52:67], v[100:103], v[196:199], 0
    v_mfma_f32_32x32x16_bf16 v[52:67], v[104:107], v[200:203], v[52:67]
    v_mfma_f32_32x32x16_bf16 v[52:67], v[156:159], v[204:207], v[52:67]
    v_cvt_pk_bf16_f32 v216, v36, v37
    v_cvt_pk_bf16_f32 v217, v38, v39
    v_cvt_pk_bf16_f32 v218, v40, v41
    v_cvt_pk_bf16_f32 v219, v42, v43
    v_cvt_pk_bf16_f32 v220, v44, v45
    v_cvt_pk_bf16_f32 v221, v46, v47
    v_cvt_pk_bf16_f32 v222, v48, v49
    v_cvt_pk_bf16_f32 v223, v50, v51
    buffer_store_dwordx4 v[216:219], v14, s[4:7], s33 offen offset:1024 sc1
    buffer_store_dwordx4 v[220:223], v14, s[4:7], s33 offen offset:1536 sc1
    v_mfma_f32_32x32x16_bf16 v[68:83], v[108:111], v[196:199], 0
    v_mfma_f32_32x32x16_bf16 v[68:83], v[112:115], v[200:203], v[68:83]
    v_mfma_f32_32x32x16_bf16 v[68:83], v[160:163], v[204:207], v[68:83]
    v_cvt_pk_bf16_f32 v224, v52, v53
    v_cvt_pk_bf16_f32 v225, v54, v55
    v_cvt_pk_bf16_f32 v226, v56, v57
    v_cvt_pk_bf16_f32 v227, v58, v59
    v_cvt_pk_bf16_f32 v228, v60, v61
    v_cvt_pk_bf16_f32 v229, v62, v63
    v_cvt_pk_bf16_f32 v230, v64, v65
    v_cvt_pk_bf16_f32 v231, v66, v67
    buffer_store_dwordx4 v[224:227], v14, s[4:7], s33 offen offset:2048 sc1
    buffer_store_dwordx4 v[228:231], v14, s[4:7], s33 offen offset:2560 sc1
    s_nop 1
    v_cvt_pk_bf16_f32 v232, v68, v69
    v_cvt_pk_bf16_f32 v233, v70, v71
    v_cvt_pk_bf16_f32 v234, v72, v73
    v_cvt_pk_bf16_f32 v235, v74, v75
    v_cvt_pk_bf16_f32 v236, v76, v77
    v_cvt_pk_bf16_f32 v237, v78, v79
    v_cvt_pk_bf16_f32 v238, v80, v81
    v_cvt_pk_bf16_f32 v239, v82, v83
    buffer_store_dwordx4 v[232:235], v14, s[4:7], s33 offen offset:3072 sc1
    buffer_store_dwordx4 v[236:239], v14, s[4:7], s33 offen offset:3584 sc1
    s_add_u32 s28, s28, 4
    s_lshr_b32 s17, s28, 2
    v_mov_b32 v9, s17
    s_add_u32 s31, s31, 8192
    s_add_u32 s32, s32, 2048
    s_add_u32 s33, s33, 1048576
    s_waitcnt vmcnt(0)
    buffer_store_dword v9, v4, s[4:7], 0 offen sc1
    s_cmp_lt_u32 s28, 64
    s_cbranch_scc1 T_top
    s_branch W_fin
W_fin:
W_end:
    s_endpgm
R_entry:
    s_and_b32 s12, s2, 7
    s_lshr_b32 s13, s2, 3
    s_load_dwordx2 s[4:5], s[0:1], 96
    s_load_dwordx2 s[28:29], s[0:1], 32
    s_load_dwordx2 s[30:31], s[0:1], 40
    s_load_dwordx2 s[32:33], s[0:1], 48
    s_load_dwordx2 s[34:35], s[0:1], 56
    s_load_dwordx2 s[36:37], s[0:1], 64
    s_load_dwordx2 s[38:39], s[0:1], 88
    v_lshrrev_b32 v19, 6, v0
    v_and_b32 v1, 63, v0
    v_readfirstlane_b32 s14, v19
    s_mov_b32 s6, 268435456
    s_mov_b32 s7, 0x20000
    s_mov_b32 s10, 8388608
    s_mov_b32 s11, 0x20000
    s_mov_b32 s25, 0
    s_mov_b32 s24, 1040356334
    s_waitcnt lgkmcnt(0)
    v_and_b32 v96, 7, v1
    v_bfe_u32 v97, v1, 3, 1
    v_lshrrev_b32 v98, 4, v1
    v_lshlrev_b32 v19, 4, v1
    s_lshl_b32 s21, s12, 14
    s_lshl_b32 s22, s14, 12
    s_add_u32 s21, s21, s22
    s_add_u32 s22, s21, 0
    v_add_u32 v2, s22, v19
    s_add_u32 s22, s21, 229376
    v_add_u32 v8, s22, v19
    s_lshr_b32 s21, s13, 1
    s_lshl_b32 s21, s21, 10
    s_and_b32 s22, s13, 1
    s_lshl_b32 s22, s22, 7
    s_add_u32 s21, s21, s22
    s_lshl_b32 s22, s12, 14
    s_add_u32 s21, s21, s22
    v_lshlrev_b32 v20, 8, v98
    v_lshl_add_u32 v20, v96, 4, v20
    v_lshl_add_u32 v20, v97, 3, v20
    s_add_u32 s22, s21, 229376
    v_add_u32 v7, s22, v20
    s_add_u32 s22, s21, 0
    v_add_u32 v11, s22, v20
    s_lshl_b32 s21, s13, 12
    s_lshl_b32 s22, s12, 10
    s_add_u32 s22, s21, s22
    v_add_u32 v9, s22, v19
    v_xor_b32 v10, 1024, v9
    v_xor_b32 v23, 2048, v9
    v_xor_b32 v244, 3072, v9
    s_mov_b32 s84, 83886080
    s_lshr_b32 s40, s13, 2
    s_lshl_b32 s21, s12, 3
    s_add_u32 s40, s40, s21
    s_and_b32 s41, s13, 3
    s_mul_i32 s21, s40, 5120
    s_add_u32 s21, s21, 65536
    v_add_u32 v5, s21, v19
    v_lshrrev_b32 v20, 3, v1
    v_lshlrev_b32 v20, 2, v20
    v_lshl_add_u32 v20, v96, 5, v20
    s_add_u32 s22, s21, 4096
    v_add_u32 v6, s22, v20
    s_lshl_b32 s22, s41, 10
    s_add_u32 s22, s22, s21
    v_add_u32 v3, s22, v19
    v_mov_b32 v21, 1073741824
    v_cmp_eq_u32 vcc, 0, v97
    s_nop 1
    v_cndmask_b32 v3, v21, v3, vcc
    s_lshl_b32 s22, s41, 8
    s_add_u32 s22, s22, s21
    s_add_u32 s22, s22, 4064
    v_lshlrev_b32 v20, 4, v98
    v_lshl_add_u32 v20, v96, 5, v20
    v_add_u32 v4, s22, v20
    v_cndmask_b32 v4, v21, v4, vcc
    v_cmp_le_u32 vcc, 2, v98
    s_nop 1
    v_cndmask_b32 v4, v21, v4, vcc
    s_lshl_b32 s27, s40, 7
    s_lshl_b32 s21, s41, 5
    s_add_u32 s27, s27, s21
    v_bfe_u32 v20, v1, 2, 2
    v_and_b32 v22, 3, v1
    v_lshl_add_u32 v20, v20, 3, v22
    v_lshlrev_b32 v12, 6, v20
    v_lshl_add_u32 v12, v98, 4, v12
    s_and_b32 s21, s14, 1
    s_lshl_b32 s21, s21, 14
    s_lshl_b32 s22, s27, 2
    s_add_u32 s21, s21, s22
    s_add_u32 s21, s21, 100679680
    v_mov_b32 v245, s21
    s_mov_b32 s85, 0
    s_mul_i32 s21, s27, 4160
    v_add_u32 v12, s21, v12
    v_mov_b32 v13, v12
    v_lshlrev_b32 v15, 4, v20
    v_lshl_add_u32 v15, v98, 2, v15
    s_mul_i32 s21, s27, 1040
    v_add_u32 v15, s21, v15
    v_lshlrev_b32 v14, 6, v96
    v_lshl_add_u32 v14, v98, 4, v14
    v_add_u32 v14, s21, v14
    v_cmp_eq_u32 vcc, 1, v97
    s_nop 1
    v_cndmask_b32 v14, v21, v14, vcc
    v_mov_b32 v16, v19
    s_lshl_b32 s21, s14, 11
    v_add_u32 v17, s21, v19
    v_and_b32 v18, 15, v1
    v_lshrrev_b32 v22, 1, v98
    v_lshl_add_u32 v18, v22, 4, v18
    v_lshlrev_b32 v18, 4, v18
    v_and_b32 v22, 1, v98
    v_lshl_add_u32 v18, v22, 3, v18
    s_mov_b32 s16, 81788928
    s_mov_b32 s42, 82083840
    s_mov_b32 s43, 82378752
    s_mov_b32 s44, 82673664
    s_mov_b32 s17, 17825792
    s_mov_b32 s18, 35651584
    s_mov_b32 s19, 71303168
    s_mov_b32 s20, 76546048
    s_mov_b32 s15, 0
    v_mov_b32 v204, -1
    v_mov_b32 v205, -1
    v_mov_b32 v206, -1
    v_mov_b32 v207, -1
    v_mov_b32 v236, 0x3f803f80
    v_mov_b32 v237, 0x3f803f80
    v_mov_b32 v238, 0x3f803f80
    v_mov_b32 v239, 0x3f803f80
    s_mul_i32 s22, s14, 294912
    s_add_u32 s22, s22, 81788928
    buffer_store_dwordx4 v[204:207], v3, s[4:7], s22 offen sc1
    buffer_store_dwordx4 v[204:207], v3, s[4:7], s22 offen offset:128 sc1
    buffer_store_dwordx4 v[204:207], v4, s[4:7], s22 offen sc1
    buffer_store_dwordx2 v[204:205], v7, s[4:7], s22 offen sc1
    buffer_store_dwordx2 v[204:205], v11, s[4:7], s22 offen sc1
    s_lshl_b32 s22, s14, 17
    s_add_u32 s22, s22, 83886080
    buffer_store_dwordx4 v[204:207], v9, s[4:7], s22 offen sc1
    s_add_u32 s22, s22, 524288
    buffer_store_dwordx4 v[204:207], v9, s[4:7], s22 offen sc1
    s_add_u32 s22, s22, 524288
    buffer_store_dwordx4 v[204:207], v9, s[4:7], s22 offen sc1
    s_add_u32 s22, s22, 524288
    buffer_store_dwordx4 v[204:207], v9, s[4:7], s22 offen sc1
    s_add_u32 s22, s22, 524288
    buffer_store_dwordx4 v[204:207], v9, s[4:7], s22 offen sc1
    s_add_u32 s22, s22, 524288
    buffer_store_dwordx4 v[204:207], v9, s[4:7], s22 offen sc1
    s_add_u32 s22, s22, 524288
    buffer_store_dwordx4 v[204:207], v9, s[4:7], s22 offen sc1
    s_add_u32 s22, s22, 524288
    buffer_store_dwordx4 v[204:207], v9, s[4:7], s22 offen sc1
    s_add_u32 s22, s22, 524288
    buffer_store_dwordx4 v[204:207], v9, s[4:7], s22 offen sc1
    s_add_u32 s22, s22, 524288
    buffer_store_dwordx4 v[204:207], v9, s[4:7], s22 offen sc1
    s_add_u32 s22, s22, 524288
    buffer_store_dwordx4 v[204:207], v9, s[4:7], s22 offen sc1
    s_add_u32 s22, s22, 524288
    buffer_store_dwordx4 v[204:207], v9, s[4:7], s22 offen sc1
    s_add_u32 s22, s22, 524288
    buffer_store_dwordx4 v[204:207], v9, s[4:7], s22 offen sc1
    s_add_u32 s22, s22, 524288
    buffer_store_dwordx4 v[204:207], v9, s[4:7], s22 offen sc1
    s_add_u32 s22, s22, 524288
    buffer_store_dwordx4 v[204:207], v9, s[4:7], s22 offen sc1
    s_add_u32 s22, s22, 524288
    buffer_store_dwordx4 v[204:207], v9, s[4:7], s22 offen sc1
    s_add_u32 s22, s22, 524288
    buffer_store_dwordx4 v[204:207], v9, s[4:7], s22 offen sc1
    s_add_u32 s22, s22, 524288
    buffer_store_dwordx4 v[204:207], v9, s[4:7], s22 offen sc1
    s_add_u32 s22, s22, 524288
    buffer_store_dwordx4 v[204:207], v9, s[4:7], s22 offen sc1
    s_add_u32 s22, s22, 524288
    buffer_store_dwordx4 v[204:207], v9, s[4:7], s22 offen sc1
    s_add_u32 s22, s22, 524288
    buffer_store_dwordx4 v[204:207], v9, s[4:7], s22 offen sc1
    s_add_u32 s22, s22, 524288
    buffer_store_dwordx4 v[204:207], v9, s[4:7], s22 offen sc1
    s_add_u32 s22, s22, 524288
    buffer_store_dwordx4 v[204:207], v9, s[4:7], s22 offen sc1
    s_add_u32 s22, s22, 524288
    buffer_store_dwordx4 v[204:207], v9, s[4:7], s22 offen sc1
    s_add_u32 s22, s22, 524288
    buffer_store_dwordx4 v[204:207], v9, s[4:7], s22 offen sc1
    s_add_u32 s22, s22, 524288
    buffer_store_dwordx4 v[204:207], v9, s[4:7], s22 offen sc1
    s_add_u32 s22, s22, 524288
    buffer_store_dwordx4 v[204:207], v9, s[4:7], s22 offen sc1
    s_add_u32 s22, s22, 524288
    buffer_store_dwordx4 v[204:207], v9, s[4:7], s22 offen sc1
    s_add_u32 s22, s22, 524288
    buffer_store_dwordx4 v[204:207], v9, s[4:7], s22 offen sc1
    s_add_u32 s22, s22, 524288
    buffer_store_dwordx4 v[204:207], v9, s[4:7], s22 offen sc1
    s_add_u32 s22, s22, 524288
    buffer_store_dwordx4 v[204:207], v9, s[4:7], s22 offen sc1
    s_add_u32 s22, s22, 524288
    buffer_store_dwordx4 v[204:207], v9, s[4:7], s22 offen sc1
    s_add_u32 s22, s22, 524288
    s_mul_i32 s22, s27, 1040
    s_lshl_b32 s21, s14, 13
    s_add_u32 s22, s22, s21
    s_add_u32 s21, s22, 71303168
    buffer_store_dwordx4 v[204:207], v16, s[4:7], s21 offen offset:0 sc1
    buffer_store_dwordx4 v[204:207], v16, s[4:7], s21 offen offset:1024 sc1
    buffer_store_dwordx4 v[204:207], v16, s[4:7], s21 offen offset:2048 sc1
    buffer_store_dwordx4 v[204:207], v16, s[4:7], s21 offen offset:3072 sc1
    s_add_u32 s21, s22, 71307264
    buffer_store_dwordx4 v[204:207], v16, s[4:7], s21 offen offset:0 sc1
    buffer_store_dwordx4 v[204:207], v16, s[4:7], s21 offen offset:1024 sc1
    buffer_store_dwordx4 v[204:207], v16, s[4:7], s21 offen offset:2048 sc1
    buffer_store_dwordx4 v[204:207], v16, s[4:7], s21 offen offset:3072 sc1
    s_add_u32 s21, s22, 76546048
    buffer_store_dwordx4 v[204:207], v16, s[4:7], s21 offen offset:0 sc1
    buffer_store_dwordx4 v[204:207], v16, s[4:7], s21 offen offset:1024 sc1
    buffer_store_dwordx4 v[204:207], v16, s[4:7], s21 offen offset:2048 sc1
    buffer_store_dwordx4 v[204:207], v16, s[4:7], s21 offen offset:3072 sc1
    s_add_u32 s21, s22, 76550144
    buffer_store_dwordx4 v[204:207], v16, s[4:7], s21 offen offset:0 sc1
    buffer_store_dwordx4 v[204:207], v16, s[4:7], s21 offen offset:1024 sc1
    buffer_store_dwordx4 v[204:207], v16, s[4:7], s21 offen offset:2048 sc1
    buffer_store_dwordx4 v[204:207], v16, s[4:7], s21 offen offset:3072 sc1
    s_waitcnt vmcnt(0)
    s_barrier
    s_cmp_lg_u32 s14, 0
    s_cbranch_scc1 L_3
    s_getreg_b32 s21, hwreg(HW_REG_XCC_ID, 0, 3)
    s_lshl_b32 s21, s21, 3
    s_lshl_b64 s[46:47], 1, s21
    v_mov_b32 v88, s46
    v_mov_b32 v89, s47
    s_lshl_b32 s21, s12, 3
    v_mov_b32 v20, s21
    s_mov_b64 exec, 1
    global_atomic_add_x2 v20, v[88:89], s[38:39] sc1
    s_mov_b64 exec, -1
L_3:
    v_lshrrev_b32 v19, 2, v1
    v_and_b32 v22, 3, v1
    v_lshlrev_b32 v22, 4, v22
    v_lshl_add_u32 v20, v19, 13, v22
    v_lshl_add_u32 v21, v19, 11, v22
    v_bfe_u32 v19, v1, 2, 2
    v_lshl_add_u32 v19, v98, 3, v19
    v_lshl_add_u32 v22, v19, 6, v22
    s_lshl_b32 s21, s14, 15
    v_add_u32 v22, s21, v22
    s_mov_b32 s8, s30
    s_mov_b32 s9, s31
    s_lshl_b32 s21, s14, 21
    s_lshl_b32 s22, s27, 1
    s_add_u32 s21, s21, s22
    s_lshl_b32 s22, s14, 15
    s_add_u32 s22, s22, 0
    s_mov_b32 m0, s22
    s_nop 0
    buffer_load_dwordx4 v20, s[8:11], s21 offen lds
    s_add_u32 s21, s21, 131072
    s_add_u32 s22, s22, 1024
    s_mov_b32 m0, s22
    s_nop 0
    buffer_load_dwordx4 v20, s[8:11], s21 offen lds
    s_add_u32 s21, s21, 131072
    s_add_u32 s22, s22, 1024
    s_mov_b32 m0, s22
    s_nop 0
    buffer_load_dwordx4 v20, s[8:11], s21 offen lds
    s_add_u32 s21, s21, 131072
    s_add_u32 s22, s22, 1024
    s_mov_b32 m0, s22
    s_nop 0
    buffer_load_dwordx4 v20, s[8:11], s21 offen lds
    s_add_u32 s21, s21, 131072
    s_add_u32 s22, s22, 1024
    s_mov_b32 m0, s22
    s_nop 0
    buffer_load_dwordx4 v20, s[8:11], s21 offen lds
    s_add_u32 s21, s21, 131072
    s_add_u32 s22, s22, 1024
    s_mov_b32 m0, s22
    s_nop 0
    buffer_load_dwordx4 v20, s[8:11], s21 offen lds
    s_add_u32 s21, s21, 131072
    s_add_u32 s22, s22, 1024
    s_mov_b32 m0, s22
    s_nop 0
    buffer_load_dwordx4 v20, s[8:11], s21 offen lds
    s_add_u32 s21, s21, 131072
    s_add_u32 s22, s22, 1024
    s_mov_b32 m0, s22
    s_nop 0
    buffer_load_dwordx4 v20, s[8:11], s21 offen lds
    s_add_u32 s21, s21, 131072
    s_add_u32 s22, s22, 1024
    s_mov_b32 m0, s22
    s_nop 0
    buffer_load_dwordx4 v20, s[8:11], s21 offen lds
    s_add_u32 s21, s21, 131072
    s_add_u32 s22, s22, 1024
    s_mov_b32 m0, s22
    s_nop 0
    buffer_load_dwordx4 v20, s[8:11], s21 offen lds
    s_add_u32 s21, s21, 131072
    s_add_u32 s22, s22, 1024
    s_mov_b32 m0, s22
    s_nop 0
    buffer_load_dwordx4 v20, s[8:11], s21 offen lds
    s_add_u32 s21, s21, 131072
    s_add_u32 s22, s22, 1024
    s_mov_b32 m0, s22
    s_nop 0
    buffer_load_dwordx4 v20, s[8:11], s21 offen lds
    s_add_u32 s21, s21, 131072
    s_add_u32 s22, s22, 1024
    s_mov_b32 m0, s22
    s_nop 0
    buffer_load_dwordx4 v20, s[8:11], s21 offen lds
    s_add_u32 s21, s21, 131072
    s_add_u32 s22, s22, 1024
    s_mov_b32 m0, s22
    s_nop 0
    buffer_load_dwordx4 v20, s[8:11], s21 offen lds
    s_add_u32 s21, s21, 131072
    s_add_u32 s22, s22, 1024
    s_mov_b32 m0, s22
    s_nop 0
    buffer_load_dwordx4 v20, s[8:11], s21 offen lds
    s_add_u32 s21, s21, 131072
    s_add_u32 s22, s22, 1024
    s_mov_b32 m0, s22
    s_nop 0
    buffer_load_dwordx4 v20, s[8:11], s21 offen lds
    s_add_u32 s21, s21, 131072
    s_add_u32 s22, s22, 1024
    s_mov_b32 s8, s32
    s_mov_b32 s9, s33
    s_lshl_b32 s21, s14, 21
    s_lshl_b32 s22, s27, 1
    s_add_u32 s21, s21, s22
    s_lshl_b32 s22, s14, 15
    s_add_u32 s22, s22, 16384
    s_mov_b32 m0, s22
    s_nop 0
    buffer_load_dwordx4 v20, s[8:11], s21 offen lds
    s_add_u32 s21, s21, 131072
    s_add_u32 s22, s22, 1024
    s_mov_b32 m0, s22
    s_nop 0
    buffer_load_dwordx4 v20, s[8:11], s21 offen lds
    s_add_u32 s21, s21, 131072
    s_add_u32 s22, s22, 1024
    s_mov_b32 m0, s22
    s_nop 0
    buffer_load_dwordx4 v20, s[8:11], s21 offen lds
    s_add_u32 s21, s21, 131072
    s_add_u32 s22, s22, 1024
    s_mov_b32 m0, s22
    s_nop 0
    buffer_load_dwordx4 v20, s[8:11], s21 offen lds
    s_add_u32 s21, s21, 131072
    s_add_u32 s22, s22, 1024
    s_mov_b32 m0, s22
    s_nop 0
    buffer_load_dwordx4 v20, s[8:11], s21 offen lds
    s_add_u32 s21, s21, 131072
    s_add_u32 s22, s22, 1024
    s_mov_b32 m0, s22
    s_nop 0
    buffer_load_dwordx4 v20, s[8:11], s21 offen lds
    s_add_u32 s21, s21, 131072
    s_add_u32 s22, s22, 1024
    s_mov_b32 m0, s22
    s_nop 0
    buffer_load_dwordx4 v20, s[8:11], s21 offen lds
    s_add_u32 s21, s21, 131072
    s_add_u32 s22, s22, 1024
    s_mov_b32 m0, s22
    s_nop 0
    buffer_load_dwordx4 v20, s[8:11], s21 offen lds
    s_add_u32 s21, s21, 131072
    s_add_u32 s22, s22, 1024
    s_mov_b32 m0, s22
    s_nop 0
    buffer_load_dwordx4 v20, s[8:11], s21 offen lds
    s_add_u32 s21, s21, 131072
    s_add_u32 s22, s22, 1024
    s_mov_b32 m0, s22
    s_nop 0
    buffer_load_dwordx4 v20, s[8:11], s21 offen lds
    s_add_u32 s21, s21, 131072
    s_add_u32 s22, s22, 1024
    s_mov_b32 m0, s22
    s_nop 0
    buffer_load_dwordx4 v20, s[8:11], s21 offen lds
    s_add_u32 s21, s21, 131072
    s_add_u32 s22, s22, 1024
    s_mov_b32 m0, s22
    s_nop 0
    buffer_load_dwordx4 v20, s[8:11], s21 offen lds
    s_add_u32 s21, s21, 131072
    s_add_u32 s22, s22, 1024
    s_mov_b32 m0, s22
    s_nop 0
    buffer_load_dwordx4 v20, s[8:11], s21 offen lds
    s_add_u32 s21, s21, 131072
    s_add_u32 s22, s22, 1024
    s_mov_b32 m0, s22
    s_nop 0
    buffer_load_dwordx4 v20, s[8:11], s21 offen lds
    s_add_u32 s21, s21, 131072
    s_add_u32 s22, s22, 1024
    s_mov_b32 m0, s22
    s_nop 0
    buffer_load_dwordx4 v20, s[8:11], s21 offen lds
    s_add_u32 s21, s21, 131072
    s_add_u32 s22, s22, 1024
    s_mov_b32 m0, s22
    s_nop 0
    buffer_load_dwordx4 v20, s[8:11], s21 offen lds
    s_add_u32 s21, s21, 131072
    s_add_u32 s22, s22, 1024
    s_waitcnt vmcnt(0)
    ds_read_b64_tr_b16 a[0:1], v22 offset:0
    ds_read_b64_tr_b16 a[2:3], v22 offset:256
    ds_read_b64_tr_b16 a[4:5], v22 offset:2048
    ds_read_b64_tr_b16 a[6:7], v22 offset:2304
    ds_read_b64_tr_b16 a[8:9], v22 offset:4096
    ds_read_b64_tr_b16 a[10:11], v22 offset:4352
    ds_read_b64_tr_b16 a[12:13], v22 offset:6144
    ds_read_b64_tr_b16 a[14:15], v22 offset:6400
    ds_read_b64_tr_b16 a[16:17], v22 offset:8192
    ds_read_b64_tr_b16 a[18:19], v22 offset:8448
    ds_read_b64_tr_b16 a[20:21], v22 offset:10240
    ds_read_b64_tr_b16 a[22:23], v22 offset:10496
    ds_read_b64_tr_b16 a[24:25], v22 offset:12288
    ds_read_b64_tr_b16 a[26:27], v22 offset:12544
    ds_read_b64_tr_b16 a[28:29], v22 offset:14336
    ds_read_b64_tr_b16 a[30:31], v22 offset:14592
    s_waitcnt lgkmcnt(0)
    ds_read_b64_tr_b16 a[32:33], v22 offset:8
    ds_read_b64_tr_b16 a[34:35], v22 offset:264
    ds_read_b64_tr_b16 a[36:37], v22 offset:2056
    ds_read_b64_tr_b16 a[38:39], v22 offset:2312
    ds_read_b64_tr_b16 a[40:41], v22 offset:4104
    ds_read_b64_tr_b16 a[42:43], v22 offset:4360
    ds_read_b64_tr_b16 a[44:45], v22 offset:6152
    ds_read_b64_tr_b16 a[46:47], v22 offset:6408
    ds_read_b64_tr_b16 a[48:49], v22 offset:8200
    ds_read_b64_tr_b16 a[50:51], v22 offset:8456
    ds_read_b64_tr_b16 a[52:53], v22 offset:10248
    ds_read_b64_tr_b16 a[54:55], v22 offset:10504
    ds_read_b64_tr_b16 a[56:57], v22 offset:12296
    ds_read_b64_tr_b16 a[58:59], v22 offset:12552
    ds_read_b64_tr_b16 a[60:61], v22 offset:14344
    ds_read_b64_tr_b16 a[62:63], v22 offset:14600
    s_waitcnt lgkmcnt(0)
    ds_read_b64_tr_b16 a[64:65], v22 offset:16384
    ds_read_b64_tr_b16 a[66:67], v22 offset:16640
    ds_read_b64_tr_b16 a[68:69], v22 offset:18432
    ds_read_b64_tr_b16 a[70:71], v22 offset:18688
    ds_read_b64_tr_b16 a[72:73], v22 offset:20480
    ds_read_b64_tr_b16 a[74:75], v22 offset:20736
    ds_read_b64_tr_b16 a[76:77], v22 offset:22528
    ds_read_b64_tr_b16 a[78:79], v22 offset:22784
    ds_read_b64_tr_b16 a[80:81], v22 offset:24576
    ds_read_b64_tr_b16 a[82:83], v22 offset:24832
    ds_read_b64_tr_b16 a[84:85], v22 offset:26624
    ds_read_b64_tr_b16 a[86:87], v22 offset:26880
    ds_read_b64_tr_b16 a[88:89], v22 offset:28672
    ds_read_b64_tr_b16 a[90:91], v22 offset:28928
    ds_read_b64_tr_b16 a[92:93], v22 offset:30720
    ds_read_b64_tr_b16 a[94:95], v22 offset:30976
    s_waitcnt lgkmcnt(0)
    ds_read_b64_tr_b16 a[96:97], v22 offset:16392
    ds_read_b64_tr_b16 a[98:99], v22 offset:16648
    ds_read_b64_tr_b16 a[100:101], v22 offset:18440
    ds_read_b64_tr_b16 a[102:103], v22 offset:18696
    ds_read_b64_tr_b16 a[104:105], v22 offset:20488
    ds_read_b64_tr_b16 a[106:107], v22 offset:20744
    ds_read_b64_tr_b16 a[108:109], v22 offset:22536
    ds_read_b64_tr_b16 a[110:111], v22 offset:22792
    ds_read_b64_tr_b16 a[112:113], v22 offset:24584
    ds_read_b64_tr_b16 a[114:115], v22 offset:24840
    ds_read_b64_tr_b16 a[116:117], v22 offset:26632
    ds_read_b64_tr_b16 a[118:119], v22 offset:26888
    ds_read_b64_tr_b16 a[120:121], v22 offset:28680
    ds_read_b64_tr_b16 a[122:123], v22 offset:28936
    ds_read_b64_tr_b16 a[124:125], v22 offset:30728
    ds_read_b64_tr_b16 a[126:127], v22 offset:30984
    s_waitcnt lgkmcnt(0)
    s_mov_b32 s8, s34
    s_mov_b32 s9, s35
    s_lshl_b32 s21, s14, 21
    s_lshl_b32 s22, s27, 1
    s_add_u32 s21, s21, s22
    s_lshl_b32 s22, s14, 15
    s_add_u32 s22, s22, 0
    s_mov_b32 m0, s22
    s_nop 0
    buffer_load_dwordx4 v20, s[8:11], s21 offen lds
    s_add_u32 s21, s21, 131072
    s_add_u32 s22, s22, 1024
    s_mov_b32 m0, s22
    s_nop 0
    buffer_load_dwordx4 v20, s[8:11], s21 offen lds
    s_add_u32 s21, s21, 131072
    s_add_u32 s22, s22, 1024
    s_mov_b32 m0, s22
    s_nop 0
    buffer_load_dwordx4 v20, s[8:11], s21 offen lds
    s_add_u32 s21, s21, 131072
    s_add_u32 s22, s22, 1024
    s_mov_b32 m0, s22
    s_nop 0
    buffer_load_dwordx4 v20, s[8:11], s21 offen lds
    s_add_u32 s21, s21, 131072
    s_add_u32 s22, s22, 1024
    s_mov_b32 m0, s22
    s_nop 0
    buffer_load_dwordx4 v20, s[8:11], s21 offen lds
    s_add_u32 s21, s21, 131072
    s_add_u32 s22, s22, 1024
    s_mov_b32 m0, s22
    s_nop 0
    buffer_load_dwordx4 v20, s[8:11], s21 offen lds
    s_add_u32 s21, s21, 131072
    s_add_u32 s22, s22, 1024
    s_mov_b32 m0, s22
    s_nop 0
    buffer_load_dwordx4 v20, s[8:11], s21 offen lds
    s_add_u32 s21, s21, 131072
    s_add_u32 s22, s22, 1024
    s_mov_b32 m0, s22
    s_nop 0
    buffer_load_dwordx4 v20, s[8:11], s21 offen lds
    s_add_u32 s21, s21, 131072
    s_add_u32 s22, s22, 1024
    s_mov_b32 m0, s22
    s_nop 0
    buffer_load_dwordx4 v20, s[8:11], s21 offen lds
    s_add_u32 s21, s21, 131072
    s_add_u32 s22, s22, 1024
    s_mov_b32 m0, s22
    s_nop 0
    buffer_load_dwordx4 v20, s[8:11], s21 offen lds
    s_add_u32 s21, s21, 131072
    s_add_u32 s22, s22, 1024
    s_mov_b32 m0, s22
    s_nop 0
    buffer_load_dwordx4 v20, s[8:11], s21 offen lds
    s_add_u32 s21, s21, 131072
    s_add_u32 s22, s22, 1024
    s_mov_b32 m0, s22
    s_nop 0
    buffer_load_dwordx4 v20, s[8:11], s21 offen lds
    s_add_u32 s21, s21, 131072
    s_add_u32 s22, s22, 1024
    s_mov_b32 m0, s22
    s_nop 0
    buffer_load_dwordx4 v20, s[8:11], s21 offen lds
    s_add_u32 s21, s21, 131072
    s_add_u32 s22, s22, 1024
    s_mov_b32 m0, s22
    s_nop 0
    buffer_load_dwordx4 v20, s[8:11], s21 offen lds
    s_add_u32 s21, s21, 131072
    s_add_u32 s22, s22, 1024
    s_mov_b32 m0, s22
    s_nop 0
    buffer_load_dwordx4 v20, s[8:11], s21 offen lds
    s_add_u32 s21, s21, 131072
    s_add_u32 s22, s22, 1024
    s_mov_b32 m0, s22
    s_nop 0
    buffer_load_dwordx4 v20, s[8:11], s21 offen lds
    s_add_u32 s21, s21, 131072
    s_add_u32 s22, s22, 1024
    s_mov_b32 s8, s36
    s_mov_b32 s9, s37
    s_lshl_b32 s21, s12, 21
    s_lshl_b32 s22, s14, 19
    s_add_u32 s21, s21, s22
    s_lshl_b32 s22, s13, 6
    s_add_u32 s21, s21, s22
    s_lshl_b32 s22, s14, 15
    s_add_u32 s22, s22, 16384
    s_mov_b32 m0, s22
    s_nop 0
    buffer_load_dwordx4 v21, s[8:11], s21 offen lds
    s_add_u32 s21, s21, 32768
    s_add_u32 s22, s22, 1024
    s_mov_b32 m0, s22
    s_nop 0
    buffer_load_dwordx4 v21, s[8:11], s21 offen lds
    s_add_u32 s21, s21, 32768
    s_add_u32 s22, s22, 1024
    s_mov_b32 m0, s22
    s_nop 0
    buffer_load_dwordx4 v21, s[8:11], s21 offen lds
    s_add_u32 s21, s21, 32768
    s_add_u32 s22, s22, 1024
    s_mov_b32 m0, s22
    s_nop 0
    buffer_load_dwordx4 v21, s[8:11], s21 offen lds
    s_add_u32 s21, s21, 32768
    s_add_u32 s22, s22, 1024
    s_mov_b32 m0, s22
    s_nop 0
    buffer_load_dwordx4 v21, s[8:11], s21 offen lds
    s_add_u32 s21, s21, 32768
    s_add_u32 s22, s22, 1024
    s_mov_b32 m0, s22
    s_nop 0
    buffer_load_dwordx4 v21, s[8:11], s21 offen lds
    s_add_u32 s21, s21, 32768
    s_add_u32 s22, s22, 1024
    s_mov_b32 m0, s22
    s_nop 0
    buffer_load_dwordx4 v21, s[8:11], s21 offen lds
    s_add_u32 s21, s21, 32768
    s_add_u32 s22, s22, 1024
    s_mov_b32 m0, s22
    s_nop 0
    buffer_load_dwordx4 v21, s[8:11], s21 offen lds
    s_add_u32 s21, s21, 32768
    s_add_u32 s22, s22, 1024
    s_mov_b32 m0, s22
    s_nop 0
    buffer_load_dwordx4 v21, s[8:11], s21 offen lds
    s_add_u32 s21, s21, 32768
    s_add_u32 s22, s22, 1024
    s_mov_b32 m0, s22
    s_nop 0
    buffer_load_dwordx4 v21, s[8:11], s21 offen lds
    s_add_u32 s21, s21, 32768
    s_add_u32 s22, s22, 1024
    s_mov_b32 m0, s22
    s_nop 0
    buffer_load_dwordx4 v21, s[8:11], s21 offen lds
    s_add_u32 s21, s21, 32768
    s_add_u32 s22, s22, 1024
    s_mov_b32 m0, s22
    s_nop 0
    buffer_load_dwordx4 v21, s[8:11], s21 offen lds
    s_add_u32 s21, s21, 32768
    s_add_u32 s22, s22, 1024
    s_mov_b32 m0, s22
    s_nop 0
    buffer_load_dwordx4 v21, s[8:11], s21 offen lds
    s_add_u32 s21, s21, 32768
    s_add_u32 s22, s22, 1024
    s_mov_b32 m0, s22
    s_nop 0
    buffer_load_dwordx4 v21, s[8:11], s21 offen lds
    s_add_u32 s21, s21, 32768
    s_add_u32 s22, s22, 1024
    s_mov_b32 m0, s22
    s_nop 0
    buffer_load_dwordx4 v21, s[8:11], s21 offen lds
    s_add_u32 s21, s21, 32768
    s_add_u32 s22, s22, 1024
    s_mov_b32 m0, s22
    s_nop 0
    buffer_load_dwordx4 v21, s[8:11], s21 offen lds
    s_add_u32 s21, s21, 32768
    s_add_u32 s22, s22, 1024
    s_waitcnt vmcnt(0)
    ds_read_b64_tr_b16 a[128:129], v22 offset:0
    ds_read_b64_tr_b16 a[130:131], v22 offset:256
    ds_read_b64_tr_b16 a[132:133], v22 offset:2048
    ds_read_b64_tr_b16 a[134:135], v22 offset:2304
    ds_read_b64_tr_b16 a[136:137], v22 offset:4096
    ds_read_b64_tr_b16 a[138:139], v22 offset:4352
    ds_read_b64_tr_b16 a[140:141], v22 offset:6144
    ds_read_b64_tr_b16 a[142:143], v22 offset:6400
    ds_read_b64_tr_b16 a[144:145], v22 offset:8192
    ds_read_b64_tr_b16 a[146:147], v22 offset:8448
    ds_read_b64_tr_b16 a[148:149], v22 offset:10240
    ds_read_b64_tr_b16 a[150:151], v22 offset:10496
    ds_read_b64_tr_b16 a[152:153], v22 offset:12288
    ds_read_b64_tr_b16 a[154:155], v22 offset:12544
    ds_read_b64_tr_b16 a[156:157], v22 offset:14336
    ds_read_b64_tr_b16 a[158:159], v22 offset:14592
    s_waitcnt lgkmcnt(0)
    ds_read_b64_tr_b16 a[160:161], v22 offset:8
    ds_read_b64_tr_b16 a[162:163], v22 offset:264
    ds_read_b64_tr_b16 a[164:165], v22 offset:2056
    ds_read_b64_tr_b16 a[166:167], v22 offset:2312
    ds_read_b64_tr_b16 a[168:169], v22 offset:4104
    ds_read_b64_tr_b16 a[170:171], v22 offset:4360
    ds_read_b64_tr_b16 a[172:173], v22 offset:6152
    ds_read_b64_tr_b16 a[174:175], v22 offset:6408
    ds_read_b64_tr_b16 a[176:177], v22 offset:8200
    ds_read_b64_tr_b16 a[178:179], v22 offset:8456
    ds_read_b64_tr_b16 a[180:181], v22 offset:10248
    ds_read_b64_tr_b16 a[182:183], v22 offset:10504
    ds_read_b64_tr_b16 a[184:185], v22 offset:12296
    ds_read_b64_tr_b16 a[186:187], v22 offset:12552
    ds_read_b64_tr_b16 a[188:189], v22 offset:14344
    ds_read_b64_tr_b16 a[190:191], v22 offset:14600
    s_waitcnt lgkmcnt(0)
    ds_read_b64_tr_b16 a[192:193], v22 offset:16384
    ds_read_b64_tr_b16 a[194:195], v22 offset:16640
    ds_read_b64_tr_b16 a[196:197], v22 offset:18432
    ds_read_b64_tr_b16 a[198:199], v22 offset:18688
    ds_read_b64_tr_b16 a[200:201], v22 offset:20480
    ds_read_b64_tr_b16 a[202:203], v22 offset:20736
    ds_read_b64_tr_b16 a[204:205], v22 offset:22528
    ds_read_b64_tr_b16 a[206:207], v22 offset:22784
    ds_read_b64_tr_b16 a[208:209], v22 offset:24576
    ds_read_b64_tr_b16 a[210:211], v22 offset:24832
    ds_read_b64_tr_b16 a[212:213], v22 offset:26624
    ds_read_b64_tr_b16 a[214:215], v22 offset:26880
    ds_read_b64_tr_b16 a[216:217], v22 offset:28672
    ds_read_b64_tr_b16 a[218:219], v22 offset:28928
    ds_read_b64_tr_b16 a[220:221], v22 offset:30720
    ds_read_b64_tr_b16 a[222:223], v22 offset:30976
    s_waitcnt lgkmcnt(0)
    ds_read_b64_tr_b16 a[224:225], v22 offset:16392
    ds_read_b64_tr_b16 a[226:227], v22 offset:16648
    ds_read_b64_tr_b16 a[228:229], v22 offset:18440
    ds_read_b64_tr_b16 a[230:231], v22 offset:18696
    ds_read_b64_tr_b16 a[232:233], v22 offset:20488
    ds_read_b64_tr_b16 a[234:235], v22 offset:20744
    ds_read_b64_tr_b16 a[236:237], v22 offset:22536
    ds_read_b64_tr_b16 a[238:239], v22 offset:22792
    ds_read_b64_tr_b16 a[240:241], v22 offset:24584
    ds_read_b64_tr_b16 a[242:243], v22 offset:24840
    ds_read_b64_tr_b16 a[244:245], v22 offset:26632
    ds_read_b64_tr_b16 a[246:247], v22 offset:26888
    ds_read_b64_tr_b16 a[248:249], v22 offset:28680
    ds_read_b64_tr_b16 a[250:251], v22 offset:28936
    ds_read_b64_tr_b16 a[252:253], v22 offset:30728
    ds_read_b64_tr_b16 a[254:255], v22 offset:30984
    s_waitcnt lgkmcnt(0)
    v_mov_b32 v155, 0
    v_mov_b32 v159, 0
    v_mov_b32 v163, 0
    v_mov_b32 v167, 0
    v_mov_b32 v179, 0
    s_mov_b32 s8, s28
    s_mov_b32 s9, s29
    s_mov_b32 s10, 16384
    v_lshlrev_b32 v20, 11, v96
    v_lshl_add_u32 v20, v98, 4, v20
    v_lshl_add_u32 v20, v97, 3, v20
    s_lshl_b32 s21, s13, 6
    buffer_load_dwordx2 v[88:89], v20, s[8:11], s21 offen
    v_mov_b32 v20, 0
    s_mov_b32 s23, 0
rdv_4:
    global_load_dwordx4 v[24:27], v20, s[38:39] sc1
    global_load_dwordx4 v[28:31], v20, s[38:39] offset:16 sc1
    global_load_dword v32, v20, s[38:39] offset:32 sc1
    s_waitcnt vmcnt(0)
    v_sad_u8 v19, v24, 0, v32
    v_sad_u8 v19, v25, 0, v19
    v_sad_u8 v19, v26, 0, v19
    v_sad_u8 v19, v27, 0, v19
    v_sad_u8 v19, v28, 0, v19
    v_sad_u8 v19, v29, 0, v19
    v_sad_u8 v19, v30, 0, v19
    v_sad_u8 v19, v31, 0, v19
    s_nop 0
    v_readfirstlane_b32 s21, v19
    s_nop 0
    s_cmp_ge_u32 s21, 256
    s_cbranch_scc1 rdvok_5
    s_sleep 4
    s_add_u32 s23, s23, 1
    s_cmp_lt_u32 s23, 200000
    s_cbranch_scc1 rdv_4
    s_mov_b32 s25, 200000
rdvok_5:
    v_or_b32 v24, v24, v25
    v_or_b32 v26, v26, v27
    v_or_b32 v28, v28, v29
    v_or_b32 v30, v30, v31
    v_and_b32 v24, 0x20202020, v24
    v_and_b32 v26, 0x20202020, v26
    v_and_b32 v28, 0x20202020, v28
    v_and_b32 v30, 0x20202020, v30
    v_min_u32 v24, v24, v26
    v_min_u32 v28, v28, v30
    v_min_u32 v24, v24, v28
    s_nop 0
    v_readfirstlane_b32 s45, v24
    v_min_u32 v88, -2, v88
    v_min_u32 v89, -2, v89
    buffer_store_dwordx2 v[88:89], v11, s[4:7], s16 offen sc1
    v_mov_b32 v40, 0
    v_mov_b32 v41, 0
    v_mov_b32 v42, 0
    v_mov_b32 v43, 0
    v_mov_b32 v44, 0
    v_mov_b32 v45, 0
    v_mov_b32 v46, 0
    v_mov_b32 v47, 0
    v_mov_b32 v48, 0
    v_mov_b32 v49, 0
    v_mov_b32 v50, 0
    v_mov_b32 v51, 0
    v_mov_b32 v52, 0
    v_mov_b32 v53, 0
    v_mov_b32 v54, 0
    v_mov_b32 v55, 0
    v_mov_b32 v56, 0
    v_mov_b32 v57, 0
    v_mov_b32 v58, 0
    v_mov_b32 v59, 0
    v_mov_b32 v60, 0
    v_mov_b32 v61, 0
    v_mov_b32 v62, 0
    v_mov_b32 v63, 0
    v_mov_b32 v64, 0
    v_mov_b32 v65, 0
    v_mov_b32 v66, 0
    v_mov_b32 v67, 0
    v_mov_b32 v68, 0
    v_mov_b32 v69, 0
    v_mov_b32 v70, 0
    v_mov_b32 v71, 0
    v_mov_b32 v24, -1
    v_mov_b32 v25, -1
    v_mov_b32 v26, -1
    v_mov_b32 v27, -1
    v_mov_b32 v28, -1
    v_mov_b32 v29, -1
    v_mov_b32 v30, -1
    v_mov_b32 v31, -1
    v_mov_b32 v32, -1
    v_mov_b32 v33, -1
    v_mov_b32 v34, -1
    v_mov_b32 v35, -1
    v_mov_b32 v36, -1
    v_mov_b32 v37, -1
    v_mov_b32 v38, -1
    v_mov_b32 v39, -1
    s_cmp_ge_u32 s14, 2
    s_cbranch_scc1 kv_6
    s_mov_b32 s94, 2
    s_mov_b32 s23, s25
fw_8:
    s_cmp_ge_u32 s85, s94
    s_cbranch_scc1 fo_9
    buffer_load_dword v19, v245, s[4:7], 0 offen sc1
    s_add_u32 s23, s23, 1
    s_waitcnt vmcnt(0)
    v_readfirstlane_b32 s85, v19
    s_cmp_lt_u32 s23, 200000
    s_cbranch_scc1 fw_8
    s_mov_b32 s25, 200000
fo_9:
    s_cmp_eq_u32 s14, 1
    s_cbranch_scc1 kv_7
    buffer_load_dwordx4 v[132:135], v12, s[4:7], s17 offen sc1
    buffer_load_dwordx4 v[136:139], v12, s[4:7], s17 offen offset:256 sc1
    s_add_u32 s17, s17, 2048
    s_min_u32 s17, s17, 17954816
    s_branch kv_6
kv_7:
    buffer_load_dwordx2 v[152:153], v13, s[4:7], s18 offen offset:0 sc1
    buffer_load_dwordx2 v[156:157], v13, s[4:7], s18 offen offset:8 sc1
    buffer_load_dwordx2 v[160:161], v13, s[4:7], s18 offen offset:256 sc1
    buffer_load_dwordx2 v[164:165], v13, s[4:7], s18 offen offset:264 sc1
    s_add_u32 s18, s18, 2048
    s_min_u32 s18, s18, 35780608
kv_6:
    s_mov_b32 s23, s25
    s_barrier
    s_cmp_eq_u32 s45, 0
    s_cbranch_scc1 recur_slow_disp
    s_cmp_eq_u32 s14, 1
    s_cbranch_scc1 recur_fast_w1
    s_cmp_eq_u32 s14, 2
    s_cbranch_scc1 recur_fast_w2
    s_cmp_eq_u32 s14, 3
    s_cbranch_scc1 recur_fast_w3
    s_branch recur_fast_w0
recur_slow_disp:
    s_cmp_eq_u32 s14, 1
    s_cbranch_scc1 recur_slow_w1
    s_cmp_eq_u32 s14, 2
    s_cbranch_scc1 recur_slow_w2
    s_cmp_eq_u32 s14, 3
    s_cbranch_scc1 recur_slow_w3
    s_branch recur_slow_w0
.p2align 6
recur_fast_w0:
    s_sleep 2
    s_mov_b32 s23, s25
    buffer_load_dwordx4 v[24:27], v2, s[4:7], s16 offen offset:0 sc1
    buffer_load_dwordx4 v[28:31], v2, s[4:7], s16 offen offset:1024 sc1
    buffer_load_dwordx4 v[32:35], v2, s[4:7], s16 offen offset:2048 sc1
    buffer_load_dwordx4 v[36:39], v2, s[4:7], s16 offen offset:3072 sc1
    s_waitcnt vmcnt(3)
    v_max3_u32 v19, v24, v25, v26
    v_max_u32 v19, v19, v27
    v_cmp_eq_u32 vcc, -1, v19
    s_nop 0
    s_cbranch_vccnz gs_11
    v_mfma_f32_16x16x32_bf16 v[40:43], a[0:3], v[24:27], v[40:43]
    v_mfma_f32_16x16x32_bf16 v[44:47], a[4:7], v[24:27], v[44:47]
    v_mfma_f32_16x16x32_bf16 v[56:59], a[64:67], v[24:27], v[56:59]
    v_mfma_f32_16x16x32_bf16 v[60:63], a[68:71], v[24:27], v[60:63]
    v_mfma_f32_16x16x32_bf16 v[48:51], a[32:35], v[24:27], v[48:51]
    s_waitcnt vmcnt(2)
    v_max3_u32 v19, v28, v29, v30
    v_mfma_f32_16x16x32_bf16 v[52:55], a[36:39], v[24:27], v[52:55]
    v_max_u32 v19, v19, v31
    v_mfma_f32_16x16x32_bf16 v[64:67], a[96:99], v[24:27], v[64:67]
    v_cmp_eq_u32 vcc, -1, v19
    v_mfma_f32_16x16x32_bf16 v[68:71], a[100:103], v[24:27], v[68:71]
    s_cbranch_vccnz gs_12
    v_mfma_f32_16x16x32_bf16 v[40:43], a[8:11], v[28:31], v[40:43]
    v_mfma_f32_16x16x32_bf16 v[44:47], a[12:15], v[28:31], v[44:47]
    v_mfma_f32_16x16x32_bf16 v[56:59], a[72:75], v[28:31], v[56:59]
    v_mfma_f32_16x16x32_bf16 v[60:63], a[76:79], v[28:31], v[60:63]
    v_mfma_f32_16x16x32_bf16 v[48:51], a[40:43], v[28:31], v[48:51]
    s_waitcnt vmcnt(1)
    v_max3_u32 v19, v32, v33, v34
    v_mfma_f32_16x16x32_bf16 v[52:55], a[44:47], v[28:31], v[52:55]
    v_max_u32 v19, v19, v35
    v_mfma_f32_16x16x32_bf16 v[64:67], a[104:107], v[28:31], v[64:67]
    v_cmp_eq_u32 vcc, -1, v19
    v_mfma_f32_16x16x32_bf16 v[68:71], a[108:111], v[28:31], v[68:71]
    s_cbranch_vccnz gs_13
    v_mfma_f32_16x16x32_bf16 v[40:43], a[16:19], v[32:35], v[40:43]
    v_mfma_f32_16x16x32_bf16 v[44:47], a[20:23], v[32:35], v[44:47]
    v_mfma_f32_16x16x32_bf16 v[56:59], a[80:83], v[32:35], v[56:59]
    v_mfma_f32_16x16x32_bf16 v[60:63], a[84:87], v[32:35], v[60:63]
    v_mfma_f32_16x16x32_bf16 v[48:51], a[48:51], v[32:35], v[48:51]
    s_waitcnt vmcnt(0)
    v_max3_u32 v19, v36, v37, v38
    v_mfma_f32_16x16x32_bf16 v[52:55], a[52:55], v[32:35], v[52:55]
    v_max_u32 v19, v19, v39
    v_mfma_f32_16x16x32_bf16 v[64:67], a[112:115], v[32:35], v[64:67]
    v_cmp_eq_u32 vcc, -1, v19
    v_mfma_f32_16x16x32_bf16 v[68:71], a[116:119], v[32:35], v[68:71]
    s_cbranch_vccnz gs_14
    v_mfma_f32_16x16x32_bf16 v[40:43], a[24:27], v[36:39], v[40:43]
    v_mfma_f32_16x16x32_bf16 v[44:47], a[28:31], v[36:39], v[44:47]
    v_mfma_f32_16x16x32_bf16 v[56:59], a[88:91], v[36:39], v[56:59]
    v_mfma_f32_16x16x32_bf16 v[60:63], a[92:95], v[36:39], v[60:63]
    v_mfma_f32_16x16x32_bf16 v[48:51], a[56:59], v[36:39], v[48:51]
    v_mfma_f32_16x16x32_bf16 v[52:55], a[60:63], v[36:39], v[52:55]
    v_mfma_f32_16x16x32_bf16 v[64:67], a[120:123], v[36:39], v[64:67]
    v_mfma_f32_16x16x32_bf16 v[68:71], a[124:127], v[36:39], v[68:71]
gc_10:
    s_nop 1
    v_add_f32_dpp v88, v44, v40 row_ror:8 row_mask:0xf bank_mask:0x3
    v_add_f32_dpp v89, v45, v41 row_ror:8 row_mask:0xf bank_mask:0x3
    v_add_f32_dpp v90, v46, v42 row_ror:8 row_mask:0xf bank_mask:0x3
    v_add_f32_dpp v91, v47, v43 row_ror:8 row_mask:0xf bank_mask:0x3
    v_add_f32_dpp v88, v56, v60 row_ror:8 row_mask:0xf bank_mask:0xc
    v_add_f32_dpp v89, v57, v61 row_ror:8 row_mask:0xf bank_mask:0xc
    v_add_f32_dpp v90, v58, v62 row_ror:8 row_mask:0xf bank_mask:0xc
    v_add_f32_dpp v91, v59, v63 row_ror:8 row_mask:0xf bank_mask:0xc
    v_add_f32_dpp v92, v52, v48 row_ror:8 row_mask:0xf bank_mask:0x3
    v_add_f32_dpp v93, v53, v49 row_ror:8 row_mask:0xf bank_mask:0x3
    v_add_f32_dpp v94, v54, v50 row_ror:8 row_mask:0xf bank_mask:0x3
    v_add_f32_dpp v95, v55, v51 row_ror:8 row_mask:0xf bank_mask:0x3
    v_mfma_f32_16x16x32_bf16 v[72:75], v[24:27], a[128:131], 0
    v_add_f32_dpp v92, v64, v68 row_ror:8 row_mask:0xf bank_mask:0xc
    v_add_f32_dpp v93, v65, v69 row_ror:8 row_mask:0xf bank_mask:0xc
    v_add_f32_dpp v94, v66, v70 row_ror:8 row_mask:0xf bank_mask:0xc
    v_add_f32_dpp v95, v67, v71 row_ror:8 row_mask:0xf bank_mask:0xc
    v_mfma_f32_16x16x32_bf16 v[80:83], v[24:27], a[160:163], 0
    v_mfma_f32_16x16x32_bf16 v[76:79], v[24:27], a[132:135], 0
    v_mfma_f32_16x16x32_bf16 v[84:87], v[24:27], a[164:167], 0
    s_waitcnt lgkmcnt(0)
    s_barrier
    ds_read_b128 v[104:107], v16 offset:2048
    ds_read_b128 v[108:111], v16 offset:3072
    ds_read_b128 v[112:115], v16 offset:4096
    ds_read_b128 v[116:119], v16 offset:5120
    ds_read_b128 v[120:123], v16 offset:6144
    ds_read_b128 v[124:127], v16 offset:7168
    buffer_load_dwordx4 v[228:231], v12, s[4:7], s17 offen sc1
    buffer_load_dwordx4 v[232:235], v12, s[4:7], s17 offen offset:256 sc1
    s_add_u32 s17, s17, 2048
    s_min_u32 s17, s17, 17954816
    v_mfma_f32_16x16x32_bf16 v[72:75], v[28:31], a[136:139], v[72:75]
    v_mfma_f32_16x16x32_bf16 v[80:83], v[28:31], a[168:171], v[80:83]
    v_mfma_f32_16x16x32_bf16 v[76:79], v[28:31], a[140:143], v[76:79]
    v_mfma_f32_16x16x32_bf16 v[84:87], v[28:31], a[172:175], v[84:87]
    s_waitcnt lgkmcnt(4)
    v_add_f32 v96, v88, v104
    v_add_f32 v97, v89, v105
    v_add_f32 v98, v90, v106
    v_add_f32 v99, v91, v107
    v_add_f32 v100, v92, v108
    v_add_f32 v101, v93, v109
    v_add_f32 v102, v94, v110
    v_add_f32 v103, v95, v111
    s_waitcnt lgkmcnt(0)
    v_add_f32 v112, v112, v120
    v_add_f32 v113, v113, v121
    v_add_f32 v114, v114, v122
    v_add_f32 v115, v115, v123
    v_add_f32 v116, v116, v124
    v_add_f32 v117, v117, v125
    v_add_f32 v118, v118, v126
    v_add_f32 v119, v119, v127
    v_add_f32 v96, v96, v112
    v_add_f32 v97, v97, v113
    v_add_f32 v98, v98, v114
    v_add_f32 v99, v99, v115
    v_add_f32 v100, v100, v116
    v_add_f32 v101, v101, v117
    v_add_f32 v102, v102, v118
    v_add_f32 v103, v103, v119
    v_cvt_pk_bf16_f32 v128, v96, v97
    v_cvt_pk_bf16_f32 v129, v98, v99
    v_cvt_pk_bf16_f32 v130, v100, v101
    v_cvt_pk_bf16_f32 v131, v102, v103
    s_nop 1
    v_mfma_f32_16x16x32_bf16 v[144:147], v[132:135], v[128:131], 0
    v_mfma_f32_16x16x32_bf16 v[148:151], v[136:139], v[128:131], 0
    v_mfma_f32_16x16x32_bf16 v[140:143], v[128:131], v[128:131], 0
    v_mfma_f32_16x16x32_bf16 v[72:75], v[32:35], a[144:147], v[72:75]
    v_mfma_f32_16x16x32_bf16 v[80:83], v[32:35], a[176:179], v[80:83]
    s_nop 3
    buffer_store_dwordx4 v[144:147], v3, s[4:7], s16 offen
    buffer_store_dwordx4 v[148:151], v3, s[4:7], s16 offen offset:128
    buffer_store_dwordx4 v[140:143], v4, s[4:7], s16 offen
    v_mfma_f32_16x16x32_bf16 v[76:79], v[32:35], a[148:151], v[76:79]
    v_mfma_f32_16x16x32_bf16 v[84:87], v[32:35], a[180:183], v[84:87]
    v_mfma_f32_16x16x32_bf16 v[72:75], v[36:39], a[152:155], v[72:75]
    v_mfma_f32_16x16x32_bf16 v[80:83], v[36:39], a[184:187], v[80:83]
    v_mfma_f32_16x16x32_bf16 v[76:79], v[36:39], a[156:159], v[76:79]
    v_mfma_f32_16x16x32_bf16 v[84:87], v[36:39], a[188:191], v[84:87]
    s_nop 6
    v_mov_b32_dpp v72, v76 quad_perm:[0,1,2,3] row_mask:0xc bank_mask:0xf
    v_mov_b32_dpp v73, v77 quad_perm:[0,1,2,3] row_mask:0xc bank_mask:0xf
    v_mov_b32_dpp v74, v78 quad_perm:[0,1,2,3] row_mask:0xc bank_mask:0xf
    v_mov_b32_dpp v75, v79 quad_perm:[0,1,2,3] row_mask:0xc bank_mask:0xf
    ds_write_b128 v17, v[72:75] offset:8192
    v_mov_b32_dpp v80, v84 quad_perm:[0,1,2,3] row_mask:0xc bank_mask:0xf
    v_mov_b32_dpp v81, v85 quad_perm:[0,1,2,3] row_mask:0xc bank_mask:0xf
    v_mov_b32_dpp v82, v86 quad_perm:[0,1,2,3] row_mask:0xc bank_mask:0xf
    v_mov_b32_dpp v83, v87 quad_perm:[0,1,2,3] row_mask:0xc bank_mask:0xf
    ds_write_b128 v17, v[80:83] offset:9216
    s_waitcnt lgkmcnt(0)
    s_barrier
    v_mov_b32 v40, 0
    v_mov_b32 v41, 0
    v_mov_b32 v42, 0
    v_mov_b32 v43, 0
    v_mov_b32 v44, 0
    v_mov_b32 v45, 0
    v_mov_b32 v46, 0
    v_mov_b32 v47, 0
    v_mov_b32 v48, 0
    v_mov_b32 v49, 0
    v_mov_b32 v50, 0
    v_mov_b32 v51, 0
    v_mov_b32 v52, 0
    v_mov_b32 v53, 0
    v_mov_b32 v54, 0
    v_mov_b32 v55, 0
    s_cmp_eq_u32 s15, 63
    s_cbranch_scc1 recur_fast_last0
    s_barrier
    s_sleep 7
    s_nop 12
    s_mov_b32 s23, s25
    buffer_load_dwordx4 v[24:27], v8, s[4:7], s16 offen offset:0 sc1
    buffer_load_dwordx4 v[28:31], v8, s[4:7], s16 offen offset:1024 sc1
    buffer_load_dwordx4 v[32:35], v8, s[4:7], s16 offen offset:2048 sc1
    buffer_load_dwordx4 v[36:39], v8, s[4:7], s16 offen offset:3072 sc1
    s_waitcnt vmcnt(3)
    v_max3_u32 v19, v24, v25, v26
    v_max_u32 v19, v19, v27
    v_cmp_eq_u32 vcc, -1, v19
    s_nop 0
    s_cbranch_vccnz gs_52
    v_mfma_f32_16x16x32_bf16 v[40:43], a[192:195], v[24:27], v[40:43]
    s_waitcnt vmcnt(2)
    v_max3_u32 v19, v28, v29, v30
    v_mfma_f32_16x16x32_bf16 v[44:47], a[196:199], v[24:27], v[44:47]
    v_max_u32 v19, v19, v31
    v_mfma_f32_16x16x32_bf16 v[48:51], a[224:227], v[24:27], v[48:51]
    v_cmp_eq_u32 vcc, -1, v19
    v_mfma_f32_16x16x32_bf16 v[52:55], a[228:231], v[24:27], v[52:55]
    s_cbranch_vccnz gs_53
    v_mfma_f32_16x16x32_bf16 v[40:43], a[200:203], v[28:31], v[40:43]
    s_waitcnt vmcnt(1)
    v_max3_u32 v19, v32, v33, v34
    v_mfma_f32_16x16x32_bf16 v[44:47], a[204:207], v[28:31], v[44:47]
    v_max_u32 v19, v19, v35
    v_mfma_f32_16x16x32_bf16 v[48:51], a[232:235], v[28:31], v[48:51]
    v_cmp_eq_u32 vcc, -1, v19
    v_mfma_f32_16x16x32_bf16 v[52:55], a[236:239], v[28:31], v[52:55]
    s_cbranch_vccnz gs_54
    v_mfma_f32_16x16x32_bf16 v[40:43], a[208:211], v[32:35], v[40:43]
    s_waitcnt vmcnt(0)
    v_max3_u32 v19, v36, v37, v38
    v_mfma_f32_16x16x32_bf16 v[44:47], a[212:215], v[32:35], v[44:47]
    v_max_u32 v19, v19, v39
    v_mfma_f32_16x16x32_bf16 v[48:51], a[240:243], v[32:35], v[48:51]
    v_cmp_eq_u32 vcc, -1, v19
    v_mfma_f32_16x16x32_bf16 v[52:55], a[244:247], v[32:35], v[52:55]
    s_cbranch_vccnz gs_55
    v_mfma_f32_16x16x32_bf16 v[40:43], a[216:219], v[36:39], v[40:43]
    v_mfma_f32_16x16x32_bf16 v[44:47], a[220:223], v[36:39], v[44:47]
    v_mfma_f32_16x16x32_bf16 v[48:51], a[248:251], v[36:39], v[48:51]
    v_mfma_f32_16x16x32_bf16 v[52:55], a[252:255], v[36:39], v[52:55]
gc_51:
    s_nop 5
    v_add_f32_dpp v88, v44, v40 row_ror:8 row_mask:0xf bank_mask:0x3
    v_add_f32_dpp v89, v45, v41 row_ror:8 row_mask:0xf bank_mask:0x3
    v_add_f32_dpp v90, v46, v42 row_ror:8 row_mask:0xf bank_mask:0x3
    v_add_f32_dpp v91, v47, v43 row_ror:8 row_mask:0xf bank_mask:0x3
    v_add_f32_dpp v88, v48, v52 row_ror:8 row_mask:0xf bank_mask:0xc
    v_add_f32_dpp v89, v49, v53 row_ror:8 row_mask:0xf bank_mask:0xc
    v_add_f32_dpp v90, v50, v54 row_ror:8 row_mask:0xf bank_mask:0xc
    v_add_f32_dpp v91, v51, v55 row_ror:8 row_mask:0xf bank_mask:0xc
    ds_write_b128 v17, v[88:91] offset:16384
    s_waitcnt lgkmcnt(0)
    s_barrier
    v_mov_b32 v132, v228
    v_mov_b32 v133, v229
    v_mov_b32 v134, v230
    v_mov_b32 v135, v231
    v_mov_b32 v136, v232
    v_mov_b32 v137, v233
    v_mov_b32 v138, v234
    v_mov_b32 v139, v235
    v_mov_b32 v40, 0
    v_mov_b32 v41, 0
    v_mov_b32 v42, 0
    v_mov_b32 v43, 0
    v_mov_b32 v44, 0
    v_mov_b32 v45, 0
    v_mov_b32 v46, 0
    v_mov_b32 v47, 0
    v_mov_b32 v48, 0
    v_mov_b32 v49, 0
    v_mov_b32 v50, 0
    v_mov_b32 v51, 0
    v_mov_b32 v52, 0
    v_mov_b32 v53, 0
    v_mov_b32 v54, 0
    v_mov_b32 v55, 0
    v_mov_b32 v56, 0
    v_mov_b32 v57, 0
    v_mov_b32 v58, 0
    v_mov_b32 v59, 0
    v_mov_b32 v60, 0
    v_mov_b32 v61, 0
    v_mov_b32 v62, 0
    v_mov_b32 v63, 0
    v_mov_b32 v64, 0
    v_mov_b32 v65, 0
    v_mov_b32 v66, 0
    v_mov_b32 v67, 0
    v_mov_b32 v68, 0
    v_mov_b32 v69, 0
    v_mov_b32 v70, 0
    v_mov_b32 v71, 0
    s_nop 7
    buffer_store_dwordx4 v[128:131], v14, s[4:7], s19 offen sc1
    s_add_u32 s19, s19, 512
    s_add_u32 s94, s15, 3
    s_min_u32 s94, s94, 64
    s_mov_b32 s23, s25
fw_92:
    s_cmp_ge_u32 s85, s94
    s_cbranch_scc1 fo_93
    buffer_load_dword v19, v245, s[4:7], 0 offen sc1
    s_add_u32 s23, s23, 1
    s_waitcnt vmcnt(0)
    v_readfirstlane_b32 s85, v19
    s_cmp_lt_u32 s23, 200000
    s_cbranch_scc1 fw_92
    s_mov_b32 s25, 200000
fo_93:
    s_mov_b32 s21, s16
    s_mov_b32 s16, s42
    s_mov_b32 s42, s43
    s_mov_b32 s43, s44
    s_mov_b32 s44, s21
    s_add_u32 s84, s84, 262144
    s_add_u32 s15, s15, 1
    s_barrier
    s_branch recur_fast_w0
gs_11:
    s_mov_b64 s[86:87], vcc
    s_mov_b64 exec, s[86:87]
    buffer_load_dwordx4 v[24:27], v2, s[4:7], s16 offen offset:0 sc1
    s_mov_b64 exec, -1
    s_waitcnt vmcnt(1)
    v_max3_u32 v19, v28, v29, v30
    v_max_u32 v19, v19, v31
    v_cmp_eq_u32 s[88:89], -1, v19
    v_max3_u32 v19, v32, v33, v34
    v_max_u32 v19, v19, v35
    v_cmp_eq_u32 s[90:91], -1, v19
    v_max3_u32 v19, v36, v37, v38
    v_max_u32 v19, v19, v39
    v_cmp_eq_u32 s[92:93], -1, v19
    s_mov_b64 exec, s[88:89]
    buffer_load_dwordx4 v[28:31], v2, s[4:7], s16 offen offset:1024 sc1
    s_mov_b64 exec, s[90:91]
    buffer_load_dwordx4 v[32:35], v2, s[4:7], s16 offen offset:2048 sc1
    s_mov_b64 exec, s[92:93]
    buffer_load_dwordx4 v[36:39], v2, s[4:7], s16 offen offset:3072 sc1
    s_mov_b64 exec, -1
    s_cmp_lg_u64 s[88:89], 0
    s_cbranch_scc1 gk_15
    v_mfma_f32_16x16x32_bf16 v[40:43], a[8:11], v[28:31], v[40:43]
    v_mfma_f32_16x16x32_bf16 v[44:47], a[12:15], v[28:31], v[44:47]
    v_mfma_f32_16x16x32_bf16 v[56:59], a[72:75], v[28:31], v[56:59]
    v_mfma_f32_16x16x32_bf16 v[60:63], a[76:79], v[28:31], v[60:63]
    v_mfma_f32_16x16x32_bf16 v[48:51], a[40:43], v[28:31], v[48:51]
    v_mfma_f32_16x16x32_bf16 v[52:55], a[44:47], v[28:31], v[52:55]
    v_mfma_f32_16x16x32_bf16 v[64:67], a[104:107], v[28:31], v[64:67]
    v_mfma_f32_16x16x32_bf16 v[68:71], a[108:111], v[28:31], v[68:71]
    s_mov_b64 exec, s[86:87]
    buffer_load_dwordx4 v[24:27], v2, s[4:7], s16 offen offset:0 sc1
    s_mov_b64 exec, s[90:91]
    buffer_load_dwordx4 v[32:35], v2, s[4:7], s16 offen offset:2048 sc1
    s_mov_b64 exec, s[92:93]
    buffer_load_dwordx4 v[36:39], v2, s[4:7], s16 offen offset:3072 sc1
    s_mov_b64 exec, -1
gk_15:
    s_cmp_lg_u64 s[90:91], 0
    s_cbranch_scc1 gk_16
    v_mfma_f32_16x16x32_bf16 v[40:43], a[16:19], v[32:35], v[40:43]
    v_mfma_f32_16x16x32_bf16 v[44:47], a[20:23], v[32:35], v[44:47]
    v_mfma_f32_16x16x32_bf16 v[56:59], a[80:83], v[32:35], v[56:59]
    v_mfma_f32_16x16x32_bf16 v[60:63], a[84:87], v[32:35], v[60:63]
    v_mfma_f32_16x16x32_bf16 v[48:51], a[48:51], v[32:35], v[48:51]
    v_mfma_f32_16x16x32_bf16 v[52:55], a[52:55], v[32:35], v[52:55]
    v_mfma_f32_16x16x32_bf16 v[64:67], a[112:115], v[32:35], v[64:67]
    v_mfma_f32_16x16x32_bf16 v[68:71], a[116:119], v[32:35], v[68:71]
    s_mov_b64 exec, s[86:87]
    buffer_load_dwordx4 v[24:27], v2, s[4:7], s16 offen offset:0 sc1
    s_mov_b64 exec, s[88:89]
    buffer_load_dwordx4 v[28:31], v2, s[4:7], s16 offen offset:1024 sc1
    s_mov_b64 exec, s[92:93]
    buffer_load_dwordx4 v[36:39], v2, s[4:7], s16 offen offset:3072 sc1
    s_mov_b64 exec, -1
gk_16:
    s_cmp_lg_u64 s[92:93], 0
    s_cbranch_scc1 gk_17
    v_mfma_f32_16x16x32_bf16 v[40:43], a[24:27], v[36:39], v[40:43]
    v_mfma_f32_16x16x32_bf16 v[44:47], a[28:31], v[36:39], v[44:47]
    v_mfma_f32_16x16x32_bf16 v[56:59], a[88:91], v[36:39], v[56:59]
    v_mfma_f32_16x16x32_bf16 v[60:63], a[92:95], v[36:39], v[60:63]
    v_mfma_f32_16x16x32_bf16 v[48:51], a[56:59], v[36:39], v[48:51]
    v_mfma_f32_16x16x32_bf16 v[52:55], a[60:63], v[36:39], v[52:55]
    v_mfma_f32_16x16x32_bf16 v[64:67], a[120:123], v[36:39], v[64:67]
    v_mfma_f32_16x16x32_bf16 v[68:71], a[124:127], v[36:39], v[68:71]
    s_mov_b64 exec, s[86:87]
    buffer_load_dwordx4 v[24:27], v2, s[4:7], s16 offen offset:0 sc1
    s_mov_b64 exec, s[88:89]
    buffer_load_dwordx4 v[28:31], v2, s[4:7], s16 offen offset:1024 sc1
    s_mov_b64 exec, s[90:91]
    buffer_load_dwordx4 v[32:35], v2, s[4:7], s16 offen offset:2048 sc1
    s_mov_b64 exec, -1
gk_17:
gl_19:
    v_max3_u32 v19, v24, v25, v26
    v_max_u32 v19, v19, v27
    v_cmp_eq_u32 vcc, -1, v19
    s_nop 0
    s_cbranch_vccz go_20
    s_mov_b64 s[86:87], vcc
    s_waitcnt vmcnt(8)
    s_mov_b64 exec, s[86:87]
    buffer_load_dwordx4 v[24:27], v2, s[4:7], s16 offen offset:0 sc1
    s_mov_b64 exec, s[88:89]
    buffer_load_dwordx4 v[28:31], v2, s[4:7], s16 offen offset:1024 sc1
    s_mov_b64 exec, s[90:91]
    buffer_load_dwordx4 v[32:35], v2, s[4:7], s16 offen offset:2048 sc1
    s_mov_b64 exec, s[92:93]
    buffer_load_dwordx4 v[36:39], v2, s[4:7], s16 offen offset:3072 sc1
    s_mov_b64 exec, -1
    s_add_u32 s23, s23, 1
    s_cmp_ge_u32 s23, 200000
    s_cselect_b32 s25, 200000, s25
    s_cbranch_scc1 go_20
    s_branch gl_19
go_20:
    v_mfma_f32_16x16x32_bf16 v[40:43], a[0:3], v[24:27], v[40:43]
    v_mfma_f32_16x16x32_bf16 v[44:47], a[4:7], v[24:27], v[44:47]
    v_mfma_f32_16x16x32_bf16 v[56:59], a[64:67], v[24:27], v[56:59]
    v_mfma_f32_16x16x32_bf16 v[60:63], a[68:71], v[24:27], v[60:63]
    v_mfma_f32_16x16x32_bf16 v[48:51], a[32:35], v[24:27], v[48:51]
    v_mfma_f32_16x16x32_bf16 v[52:55], a[36:39], v[24:27], v[52:55]
    v_mfma_f32_16x16x32_bf16 v[64:67], a[96:99], v[24:27], v[64:67]
    v_mfma_f32_16x16x32_bf16 v[68:71], a[100:103], v[24:27], v[68:71]
gd_18:
    s_cmp_eq_u64 s[88:89], 0
    s_cbranch_scc1 gd_21
gl_22:
    v_max3_u32 v19, v28, v29, v30
    v_max_u32 v19, v19, v31
    v_cmp_eq_u32 vcc, -1, v19
    s_nop 0
    s_cbranch_vccz go_23
    s_mov_b64 s[88:89], vcc
    s_waitcnt vmcnt(6)
    s_mov_b64 exec, s[88:89]
    buffer_load_dwordx4 v[28:31], v2, s[4:7], s16 offen offset:1024 sc1
    s_mov_b64 exec, s[90:91]
    buffer_load_dwordx4 v[32:35], v2, s[4:7], s16 offen offset:2048 sc1
    s_mov_b64 exec, s[92:93]
    buffer_load_dwordx4 v[36:39], v2, s[4:7], s16 offen offset:3072 sc1
    s_mov_b64 exec, -1
    s_add_u32 s23, s23, 1
    s_cmp_ge_u32 s23, 200000
    s_cselect_b32 s25, 200000, s25
    s_cbranch_scc1 go_23
    s_branch gl_22
go_23:
    v_mfma_f32_16x16x32_bf16 v[40:43], a[8:11], v[28:31], v[40:43]
    v_mfma_f32_16x16x32_bf16 v[44:47], a[12:15], v[28:31], v[44:47]
    v_mfma_f32_16x16x32_bf16 v[56:59], a[72:75], v[28:31], v[56:59]
    v_mfma_f32_16x16x32_bf16 v[60:63], a[76:79], v[28:31], v[60:63]
    v_mfma_f32_16x16x32_bf16 v[48:51], a[40:43], v[28:31], v[48:51]
    v_mfma_f32_16x16x32_bf16 v[52:55], a[44:47], v[28:31], v[52:55]
    v_mfma_f32_16x16x32_bf16 v[64:67], a[104:107], v[28:31], v[64:67]
    v_mfma_f32_16x16x32_bf16 v[68:71], a[108:111], v[28:31], v[68:71]
gd_21:
    s_cmp_eq_u64 s[90:91], 0
    s_cbranch_scc1 gd_24
gl_25:
    v_max3_u32 v19, v32, v33, v34
    v_max_u32 v19, v19, v35
    v_cmp_eq_u32 vcc, -1, v19
    s_nop 0
    s_cbranch_vccz go_26
    s_mov_b64 s[90:91], vcc
    s_waitcnt vmcnt(4)
    s_mov_b64 exec, s[90:91]
    buffer_load_dwordx4 v[32:35], v2, s[4:7], s16 offen offset:2048 sc1
    s_mov_b64 exec, s[92:93]
    buffer_load_dwordx4 v[36:39], v2, s[4:7], s16 offen offset:3072 sc1
    s_mov_b64 exec, -1
    s_add_u32 s23, s23, 1
    s_cmp_ge_u32 s23, 200000
    s_cselect_b32 s25, 200000, s25
    s_cbranch_scc1 go_26
    s_branch gl_25
go_26:
    v_mfma_f32_16x16x32_bf16 v[40:43], a[16:19], v[32:35], v[40:43]
    v_mfma_f32_16x16x32_bf16 v[44:47], a[20:23], v[32:35], v[44:47]
    v_mfma_f32_16x16x32_bf16 v[56:59], a[80:83], v[32:35], v[56:59]
    v_mfma_f32_16x16x32_bf16 v[60:63], a[84:87], v[32:35], v[60:63]
    v_mfma_f32_16x16x32_bf16 v[48:51], a[48:51], v[32:35], v[48:51]
    v_mfma_f32_16x16x32_bf16 v[52:55], a[52:55], v[32:35], v[52:55]
    v_mfma_f32_16x16x32_bf16 v[64:67], a[112:115], v[32:35], v[64:67]
    v_mfma_f32_16x16x32_bf16 v[68:71], a[116:119], v[32:35], v[68:71]
gd_24:
    s_cmp_eq_u64 s[92:93], 0
    s_cbranch_scc1 gd_27
gl_28:
    v_max3_u32 v19, v36, v37, v38
    v_max_u32 v19, v19, v39
    v_cmp_eq_u32 vcc, -1, v19
    s_nop 0
    s_cbranch_vccz go_29
    s_mov_b64 s[92:93], vcc
    s_waitcnt vmcnt(2)
    s_mov_b64 exec, s[92:93]
    buffer_load_dwordx4 v[36:39], v2, s[4:7], s16 offen offset:3072 sc1
    s_mov_b64 exec, -1
    s_add_u32 s23, s23, 1
    s_cmp_ge_u32 s23, 200000
    s_cselect_b32 s25, 200000, s25
    s_cbranch_scc1 go_29
    s_branch gl_28
go_29:
    v_mfma_f32_16x16x32_bf16 v[40:43], a[24:27], v[36:39], v[40:43]
    v_mfma_f32_16x16x32_bf16 v[44:47], a[28:31], v[36:39], v[44:47]
    v_mfma_f32_16x16x32_bf16 v[56:59], a[88:91], v[36:39], v[56:59]
    v_mfma_f32_16x16x32_bf16 v[60:63], a[92:95], v[36:39], v[60:63]
    v_mfma_f32_16x16x32_bf16 v[48:51], a[56:59], v[36:39], v[48:51]
    v_mfma_f32_16x16x32_bf16 v[52:55], a[60:63], v[36:39], v[52:55]
    v_mfma_f32_16x16x32_bf16 v[64:67], a[120:123], v[36:39], v[64:67]
    v_mfma_f32_16x16x32_bf16 v[68:71], a[124:127], v[36:39], v[68:71]
gd_27:
    s_branch gc_10
gs_12:
    s_mov_b64 s[88:89], vcc
    s_mov_b64 exec, s[88:89]
    buffer_load_dwordx4 v[28:31], v2, s[4:7], s16 offen offset:1024 sc1
    s_mov_b64 exec, -1
    s_waitcnt vmcnt(1)
    v_max3_u32 v19, v32, v33, v34
    v_max_u32 v19, v19, v35
    v_cmp_eq_u32 s[90:91], -1, v19
    v_max3_u32 v19, v36, v37, v38
    v_max_u32 v19, v19, v39
    v_cmp_eq_u32 s[92:93], -1, v19
    s_mov_b64 exec, s[90:91]
    buffer_load_dwordx4 v[32:35], v2, s[4:7], s16 offen offset:2048 sc1
    s_mov_b64 exec, s[92:93]
    buffer_load_dwordx4 v[36:39], v2, s[4:7], s16 offen offset:3072 sc1
    s_mov_b64 exec, -1
    s_cmp_lg_u64 s[90:91], 0
    s_cbranch_scc1 gk_30
    v_mfma_f32_16x16x32_bf16 v[40:43], a[16:19], v[32:35], v[40:43]
    v_mfma_f32_16x16x32_bf16 v[44:47], a[20:23], v[32:35], v[44:47]
    v_mfma_f32_16x16x32_bf16 v[56:59], a[80:83], v[32:35], v[56:59]
    v_mfma_f32_16x16x32_bf16 v[60:63], a[84:87], v[32:35], v[60:63]
    v_mfma_f32_16x16x32_bf16 v[48:51], a[48:51], v[32:35], v[48:51]
    v_mfma_f32_16x16x32_bf16 v[52:55], a[52:55], v[32:35], v[52:55]
    v_mfma_f32_16x16x32_bf16 v[64:67], a[112:115], v[32:35], v[64:67]
    v_mfma_f32_16x16x32_bf16 v[68:71], a[116:119], v[32:35], v[68:71]
    s_mov_b64 exec, s[88:89]
    buffer_load_dwordx4 v[28:31], v2, s[4:7], s16 offen offset:1024 sc1
    s_mov_b64 exec, s[92:93]
    buffer_load_dwordx4 v[36:39], v2, s[4:7], s16 offen offset:3072 sc1
    s_mov_b64 exec, -1
gk_30:
    s_cmp_lg_u64 s[92:93], 0
    s_cbranch_scc1 gk_31
    v_mfma_f32_16x16x32_bf16 v[40:43], a[24:27], v[36:39], v[40:43]
    v_mfma_f32_16x16x32_bf16 v[44:47], a[28:31], v[36:39], v[44:47]
    v_mfma_f32_16x16x32_bf16 v[56:59], a[88:91], v[36:39], v[56:59]
    v_mfma_f32_16x16x32_bf16 v[60:63], a[92:95], v[36:39], v[60:63]
    v_mfma_f32_16x16x32_bf16 v[48:51], a[56:59], v[36:39], v[48:51]
    v_mfma_f32_16x16x32_bf16 v[52:55], a[60:63], v[36:39], v[52:55]
    v_mfma_f32_16x16x32_bf16 v[64:67], a[120:123], v[36:39], v[64:67]
    v_mfma_f32_16x16x32_bf16 v[68:71], a[124:127], v[36:39], v[68:71]
    s_mov_b64 exec, s[88:89]
    buffer_load_dwordx4 v[28:31], v2, s[4:7], s16 offen offset:1024 sc1
    s_mov_b64 exec, s[90:91]
    buffer_load_dwordx4 v[32:35], v2, s[4:7], s16 offen offset:2048 sc1
    s_mov_b64 exec, -1
gk_31:
gl_33:
    v_max3_u32 v19, v28, v29, v30
    v_max_u32 v19, v19, v31
    v_cmp_eq_u32 vcc, -1, v19
    s_nop 0
    s_cbranch_vccz go_34
    s_mov_b64 s[88:89], vcc
    s_waitcnt vmcnt(6)
    s_mov_b64 exec, s[88:89]
    buffer_load_dwordx4 v[28:31], v2, s[4:7], s16 offen offset:1024 sc1
    s_mov_b64 exec, s[90:91]
    buffer_load_dwordx4 v[32:35], v2, s[4:7], s16 offen offset:2048 sc1
    s_mov_b64 exec, s[92:93]
    buffer_load_dwordx4 v[36:39], v2, s[4:7], s16 offen offset:3072 sc1
    s_mov_b64 exec, -1
    s_add_u32 s23, s23, 1
    s_cmp_ge_u32 s23, 200000
    s_cselect_b32 s25, 200000, s25
    s_cbranch_scc1 go_34
    s_branch gl_33
go_34:
    v_mfma_f32_16x16x32_bf16 v[40:43], a[8:11], v[28:31], v[40:43]
    v_mfma_f32_16x16x32_bf16 v[44:47], a[12:15], v[28:31], v[44:47]
    v_mfma_f32_16x16x32_bf16 v[56:59], a[72:75], v[28:31], v[56:59]
    v_mfma_f32_16x16x32_bf16 v[60:63], a[76:79], v[28:31], v[60:63]
    v_mfma_f32_16x16x32_bf16 v[48:51], a[40:43], v[28:31], v[48:51]
    v_mfma_f32_16x16x32_bf16 v[52:55], a[44:47], v[28:31], v[52:55]
    v_mfma_f32_16x16x32_bf16 v[64:67], a[104:107], v[28:31], v[64:67]
    v_mfma_f32_16x16x32_bf16 v[68:71], a[108:111], v[28:31], v[68:71]
gd_32:
    s_cmp_eq_u64 s[90:91], 0
    s_cbranch_scc1 gd_35
gl_36:
    v_max3_u32 v19, v32, v33, v34
    v_max_u32 v19, v19, v35
    v_cmp_eq_u32 vcc, -1, v19
    s_nop 0
    s_cbranch_vccz go_37
    s_mov_b64 s[90:91], vcc
    s_waitcnt vmcnt(4)
    s_mov_b64 exec, s[90:91]
    buffer_load_dwordx4 v[32:35], v2, s[4:7], s16 offen offset:2048 sc1
    s_mov_b64 exec, s[92:93]
    buffer_load_dwordx4 v[36:39], v2, s[4:7], s16 offen offset:3072 sc1
    s_mov_b64 exec, -1
    s_add_u32 s23, s23, 1
    s_cmp_ge_u32 s23, 200000
    s_cselect_b32 s25, 200000, s25
    s_cbranch_scc1 go_37
    s_branch gl_36
go_37:
    v_mfma_f32_16x16x32_bf16 v[40:43], a[16:19], v[32:35], v[40:43]
    v_mfma_f32_16x16x32_bf16 v[44:47], a[20:23], v[32:35], v[44:47]
    v_mfma_f32_16x16x32_bf16 v[56:59], a[80:83], v[32:35], v[56:59]
    v_mfma_f32_16x16x32_bf16 v[60:63], a[84:87], v[32:35], v[60:63]
    v_mfma_f32_16x16x32_bf16 v[48:51], a[48:51], v[32:35], v[48:51]
    v_mfma_f32_16x16x32_bf16 v[52:55], a[52:55], v[32:35], v[52:55]
    v_mfma_f32_16x16x32_bf16 v[64:67], a[112:115], v[32:35], v[64:67]
    v_mfma_f32_16x16x32_bf16 v[68:71], a[116:119], v[32:35], v[68:71]
gd_35:
    s_cmp_eq_u64 s[92:93], 0
    s_cbranch_scc1 gd_38
gl_39:
    v_max3_u32 v19, v36, v37, v38
    v_max_u32 v19, v19, v39
    v_cmp_eq_u32 vcc, -1, v19
    s_nop 0
    s_cbranch_vccz go_40
    s_mov_b64 s[92:93], vcc
    s_waitcnt vmcnt(2)
    s_mov_b64 exec, s[92:93]
    buffer_load_dwordx4 v[36:39], v2, s[4:7], s16 offen offset:3072 sc1
    s_mov_b64 exec, -1
    s_add_u32 s23, s23, 1
    s_cmp_ge_u32 s23, 200000
    s_cselect_b32 s25, 200000, s25
    s_cbranch_scc1 go_40
    s_branch gl_39
go_40:
    v_mfma_f32_16x16x32_bf16 v[40:43], a[24:27], v[36:39], v[40:43]
    v_mfma_f32_16x16x32_bf16 v[44:47], a[28:31], v[36:39], v[44:47]
    v_mfma_f32_16x16x32_bf16 v[56:59], a[88:91], v[36:39], v[56:59]
    v_mfma_f32_16x16x32_bf16 v[60:63], a[92:95], v[36:39], v[60:63]
    v_mfma_f32_16x16x32_bf16 v[48:51], a[56:59], v[36:39], v[48:51]
    v_mfma_f32_16x16x32_bf16 v[52:55], a[60:63], v[36:39], v[52:55]
    v_mfma_f32_16x16x32_bf16 v[64:67], a[120:123], v[36:39], v[64:67]
    v_mfma_f32_16x16x32_bf16 v[68:71], a[124:127], v[36:39], v[68:71]
gd_38:
    s_branch gc_10
gs_13:
    s_mov_b64 s[90:91], vcc
    s_mov_b64 exec, s[90:91]
    buffer_load_dwordx4 v[32:35], v2, s[4:7], s16 offen offset:2048 sc1
    s_mov_b64 exec, -1
    s_waitcnt vmcnt(1)
    v_max3_u32 v19, v36, v37, v38
    v_max_u32 v19, v19, v39
    v_cmp_eq_u32 s[92:93], -1, v19
    s_nop 0
    s_mov_b64 exec, s[92:93]
    buffer_load_dwordx4 v[36:39], v2, s[4:7], s16 offen offset:3072 sc1
    s_mov_b64 exec, -1
    s_cmp_lg_u64 s[92:93], 0
    s_cbranch_scc1 gk_41
    v_mfma_f32_16x16x32_bf16 v[40:43], a[24:27], v[36:39], v[40:43]
    v_mfma_f32_16x16x32_bf16 v[44:47], a[28:31], v[36:39], v[44:47]
    v_mfma_f32_16x16x32_bf16 v[56:59], a[88:91], v[36:39], v[56:59]
    v_mfma_f32_16x16x32_bf16 v[60:63], a[92:95], v[36:39], v[60:63]
    v_mfma_f32_16x16x32_bf16 v[48:51], a[56:59], v[36:39], v[48:51]
    v_mfma_f32_16x16x32_bf16 v[52:55], a[60:63], v[36:39], v[52:55]
    v_mfma_f32_16x16x32_bf16 v[64:67], a[120:123], v[36:39], v[64:67]
    v_mfma_f32_16x16x32_bf16 v[68:71], a[124:127], v[36:39], v[68:71]
    s_mov_b64 exec, s[90:91]
    buffer_load_dwordx4 v[32:35], v2, s[4:7], s16 offen offset:2048 sc1
    s_mov_b64 exec, -1
gk_41:
gl_43:
    v_max3_u32 v19, v32, v33, v34
    v_max_u32 v19, v19, v35
    v_cmp_eq_u32 vcc, -1, v19
    s_nop 0
    s_cbranch_vccz go_44
    s_mov_b64 s[90:91], vcc
    s_waitcnt vmcnt(4)
    s_mov_b64 exec, s[90:91]
    buffer_load_dwordx4 v[32:35], v2, s[4:7], s16 offen offset:2048 sc1
    s_mov_b64 exec, s[92:93]
    buffer_load_dwordx4 v[36:39], v2, s[4:7], s16 offen offset:3072 sc1
    s_mov_b64 exec, -1
    s_add_u32 s23, s23, 1
    s_cmp_ge_u32 s23, 200000
    s_cselect_b32 s25, 200000, s25
    s_cbranch_scc1 go_44
    s_branch gl_43
go_44:
    v_mfma_f32_16x16x32_bf16 v[40:43], a[16:19], v[32:35], v[40:43]
    v_mfma_f32_16x16x32_bf16 v[44:47], a[20:23], v[32:35], v[44:47]
    v_mfma_f32_16x16x32_bf16 v[56:59], a[80:83], v[32:35], v[56:59]
    v_mfma_f32_16x16x32_bf16 v[60:63], a[84:87], v[32:35], v[60:63]
    v_mfma_f32_16x16x32_bf16 v[48:51], a[48:51], v[32:35], v[48:51]
    v_mfma_f32_16x16x32_bf16 v[52:55], a[52:55], v[32:35], v[52:55]
    v_mfma_f32_16x16x32_bf16 v[64:67], a[112:115], v[32:35], v[64:67]
    v_mfma_f32_16x16x32_bf16 v[68:71], a[116:119], v[32:35], v[68:71]
gd_42:
    s_cmp_eq_u64 s[92:93], 0
    s_cbranch_scc1 gd_45
gl_46:
    v_max3_u32 v19, v36, v37, v38
    v_max_u32 v19, v19, v39
    v_cmp_eq_u32 vcc, -1, v19
    s_nop 0
    s_cbranch_vccz go_47
    s_mov_b64 s[92:93], vcc
    s_waitcnt vmcnt(2)
    s_mov_b64 exec, s[92:93]
    buffer_load_dwordx4 v[36:39], v2, s[4:7], s16 offen offset:3072 sc1
    s_mov_b64 exec, -1
    s_add_u32 s23, s23, 1
    s_cmp_ge_u32 s23, 200000
    s_cselect_b32 s25, 200000, s25
    s_cbranch_scc1 go_47
    s_branch gl_46
go_47:
    v_mfma_f32_16x16x32_bf16 v[40:43], a[24:27], v[36:39], v[40:43]
    v_mfma_f32_16x16x32_bf16 v[44:47], a[28:31], v[36:39], v[44:47]
    v_mfma_f32_16x16x32_bf16 v[56:59], a[88:91], v[36:39], v[56:59]
    v_mfma_f32_16x16x32_bf16 v[60:63], a[92:95], v[36:39], v[60:63]
    v_mfma_f32_16x16x32_bf16 v[48:51], a[56:59], v[36:39], v[48:51]
    v_mfma_f32_16x16x32_bf16 v[52:55], a[60:63], v[36:39], v[52:55]
    v_mfma_f32_16x16x32_bf16 v[64:67], a[120:123], v[36:39], v[64:67]
    v_mfma_f32_16x16x32_bf16 v[68:71], a[124:127], v[36:39], v[68:71]
gd_45:
    s_branch gc_10
gs_14:
    s_mov_b64 s[92:93], vcc
    s_mov_b64 exec, s[92:93]
    buffer_load_dwordx4 v[36:39], v2, s[4:7], s16 offen offset:3072 sc1
    s_mov_b64 exec, -1
gl_49:
    v_max3_u32 v19, v36, v37, v38
    v_max_u32 v19, v19, v39
    v_cmp_eq_u32 vcc, -1, v19
    s_nop 0
    s_cbranch_vccz go_50
    s_mov_b64 s[92:93], vcc
    s_waitcnt vmcnt(2)
    s_mov_b64 exec, s[92:93]
    buffer_load_dwordx4 v[36:39], v2, s[4:7], s16 offen offset:3072 sc1
    s_mov_b64 exec, -1
    s_add_u32 s23, s23, 1
    s_cmp_ge_u32 s23, 200000
    s_cselect_b32 s25, 200000, s25
    s_cbranch_scc1 go_50
    s_branch gl_49
go_50:
    v_mfma_f32_16x16x32_bf16 v[40:43], a[24:27], v[36:39], v[40:43]
    v_mfma_f32_16x16x32_bf16 v[44:47], a[28:31], v[36:39], v[44:47]
    v_mfma_f32_16x16x32_bf16 v[56:59], a[88:91], v[36:39], v[56:59]
    v_mfma_f32_16x16x32_bf16 v[60:63], a[92:95], v[36:39], v[60:63]
    v_mfma_f32_16x16x32_bf16 v[48:51], a[56:59], v[36:39], v[48:51]
    v_mfma_f32_16x16x32_bf16 v[52:55], a[60:63], v[36:39], v[52:55]
    v_mfma_f32_16x16x32_bf16 v[64:67], a[120:123], v[36:39], v[64:67]
    v_mfma_f32_16x16x32_bf16 v[68:71], a[124:127], v[36:39], v[68:71]
gd_48:
    s_branch gc_10
recur_fast_last0:
    buffer_store_dwordx4 v[128:131], v14, s[4:7], s19 offen sc1
    s_branch recur_end
gs_52:
    s_mov_b64 s[86:87], vcc
    s_mov_b64 exec, s[86:87]
    buffer_load_dwordx4 v[24:27], v8, s[4:7], s16 offen offset:0 sc1
    s_mov_b64 exec, -1
    s_waitcnt vmcnt(1)
    v_max3_u32 v19, v28, v29, v30
    v_max_u32 v19, v19, v31
    v_cmp_eq_u32 s[88:89], -1, v19
    v_max3_u32 v19, v32, v33, v34
    v_max_u32 v19, v19, v35
    v_cmp_eq_u32 s[90:91], -1, v19
    v_max3_u32 v19, v36, v37, v38
    v_max_u32 v19, v19, v39
    v_cmp_eq_u32 s[92:93], -1, v19
    s_mov_b64 exec, s[88:89]
    buffer_load_dwordx4 v[28:31], v8, s[4:7], s16 offen offset:1024 sc1
    s_mov_b64 exec, s[90:91]
    buffer_load_dwordx4 v[32:35], v8, s[4:7], s16 offen offset:2048 sc1
    s_mov_b64 exec, s[92:93]
    buffer_load_dwordx4 v[36:39], v8, s[4:7], s16 offen offset:3072 sc1
    s_mov_b64 exec, -1
    s_cmp_lg_u64 s[88:89], 0
    s_cbranch_scc1 gk_56
    v_mfma_f32_16x16x32_bf16 v[40:43], a[200:203], v[28:31], v[40:43]
    v_mfma_f32_16x16x32_bf16 v[44:47], a[204:207], v[28:31], v[44:47]
    v_mfma_f32_16x16x32_bf16 v[48:51], a[232:235], v[28:31], v[48:51]
    v_mfma_f32_16x16x32_bf16 v[52:55], a[236:239], v[28:31], v[52:55]
    s_mov_b64 exec, s[86:87]
    buffer_load_dwordx4 v[24:27], v8, s[4:7], s16 offen offset:0 sc1
    s_mov_b64 exec, s[90:91]
    buffer_load_dwordx4 v[32:35], v8, s[4:7], s16 offen offset:2048 sc1
    s_mov_b64 exec, s[92:93]
    buffer_load_dwordx4 v[36:39], v8, s[4:7], s16 offen offset:3072 sc1
    s_mov_b64 exec, -1
gk_56:
    s_cmp_lg_u64 s[90:91], 0
    s_cbranch_scc1 gk_57
    v_mfma_f32_16x16x32_bf16 v[40:43], a[208:211], v[32:35], v[40:43]
    v_mfma_f32_16x16x32_bf16 v[44:47], a[212:215], v[32:35], v[44:47]
    v_mfma_f32_16x16x32_bf16 v[48:51], a[240:243], v[32:35], v[48:51]
    v_mfma_f32_16x16x32_bf16 v[52:55], a[244:247], v[32:35], v[52:55]
    s_mov_b64 exec, s[86:87]
    buffer_load_dwordx4 v[24:27], v8, s[4:7], s16 offen offset:0 sc1
    s_mov_b64 exec, s[88:89]
    buffer_load_dwordx4 v[28:31], v8, s[4:7], s16 offen offset:1024 sc1
    s_mov_b64 exec, s[92:93]
    buffer_load_dwordx4 v[36:39], v8, s[4:7], s16 offen offset:3072 sc1
    s_mov_b64 exec, -1
gk_57:
    s_cmp_lg_u64 s[92:93], 0
    s_cbranch_scc1 gk_58
    v_mfma_f32_16x16x32_bf16 v[40:43], a[216:219], v[36:39], v[40:43]
    v_mfma_f32_16x16x32_bf16 v[44:47], a[220:223], v[36:39], v[44:47]
    v_mfma_f32_16x16x32_bf16 v[48:51], a[248:251], v[36:39], v[48:51]
    v_mfma_f32_16x16x32_bf16 v[52:55], a[252:255], v[36:39], v[52:55]
    s_mov_b64 exec, s[86:87]
    buffer_load_dwordx4 v[24:27], v8, s[4:7], s16 offen offset:0 sc1
    s_mov_b64 exec, s[88:89]
    buffer_load_dwordx4 v[28:31], v8, s[4:7], s16 offen offset:1024 sc1
    s_mov_b64 exec, s[90:91]
    buffer_load_dwordx4 v[32:35], v8, s[4:7], s16 offen offset:2048 sc1
    s_mov_b64 exec, -1
gk_58:
gl_60:
    v_max3_u32 v19, v24, v25, v26
    v_max_u32 v19, v19, v27
    v_cmp_eq_u32 vcc, -1, v19
    s_nop 0
    s_cbranch_vccz go_61
    s_mov_b64 s[86:87], vcc
    s_waitcnt vmcnt(8)
    s_mov_b64 exec, s[86:87]
    buffer_load_dwordx4 v[24:27], v8, s[4:7], s16 offen offset:0 sc1
    s_mov_b64 exec, s[88:89]
    buffer_load_dwordx4 v[28:31], v8, s[4:7], s16 offen offset:1024 sc1
    s_mov_b64 exec, s[90:91]
    buffer_load_dwordx4 v[32:35], v8, s[4:7], s16 offen offset:2048 sc1
    s_mov_b64 exec, s[92:93]
    buffer_load_dwordx4 v[36:39], v8, s[4:7], s16 offen offset:3072 sc1
    s_mov_b64 exec, -1
    s_add_u32 s23, s23, 1
    s_cmp_ge_u32 s23, 200000
    s_cselect_b32 s25, 200000, s25
    s_cbranch_scc1 go_61
    s_branch gl_60
go_61:
    v_mfma_f32_16x16x32_bf16 v[40:43], a[192:195], v[24:27], v[40:43]
    v_mfma_f32_16x16x32_bf16 v[44:47], a[196:199], v[24:27], v[44:47]
    v_mfma_f32_16x16x32_bf16 v[48:51], a[224:227], v[24:27], v[48:51]
    v_mfma_f32_16x16x32_bf16 v[52:55], a[228:231], v[24:27], v[52:55]
gd_59:
    s_cmp_eq_u64 s[88:89], 0
    s_cbranch_scc1 gd_62
gl_63:
    v_max3_u32 v19, v28, v29, v30
    v_max_u32 v19, v19, v31
    v_cmp_eq_u32 vcc, -1, v19
    s_nop 0
    s_cbranch_vccz go_64
    s_mov_b64 s[88:89], vcc
    s_waitcnt vmcnt(6)
    s_mov_b64 exec, s[88:89]
    buffer_load_dwordx4 v[28:31], v8, s[4:7], s16 offen offset:1024 sc1
    s_mov_b64 exec, s[90:91]
    buffer_load_dwordx4 v[32:35], v8, s[4:7], s16 offen offset:2048 sc1
    s_mov_b64 exec, s[92:93]
    buffer_load_dwordx4 v[36:39], v8, s[4:7], s16 offen offset:3072 sc1
    s_mov_b64 exec, -1
    s_add_u32 s23, s23, 1
    s_cmp_ge_u32 s23, 200000
    s_cselect_b32 s25, 200000, s25
    s_cbranch_scc1 go_64
    s_branch gl_63
go_64:
    v_mfma_f32_16x16x32_bf16 v[40:43], a[200:203], v[28:31], v[40:43]
    v_mfma_f32_16x16x32_bf16 v[44:47], a[204:207], v[28:31], v[44:47]
    v_mfma_f32_16x16x32_bf16 v[48:51], a[232:235], v[28:31], v[48:51]
    v_mfma_f32_16x16x32_bf16 v[52:55], a[236:239], v[28:31], v[52:55]
gd_62:
    s_cmp_eq_u64 s[90:91], 0
    s_cbranch_scc1 gd_65
gl_66:
    v_max3_u32 v19, v32, v33, v34
    v_max_u32 v19, v19, v35
    v_cmp_eq_u32 vcc, -1, v19
    s_nop 0
    s_cbranch_vccz go_67
    s_mov_b64 s[90:91], vcc
    s_waitcnt vmcnt(4)
    s_mov_b64 exec, s[90:91]
    buffer_load_dwordx4 v[32:35], v8, s[4:7], s16 offen offset:2048 sc1
    s_mov_b64 exec, s[92:93]
    buffer_load_dwordx4 v[36:39], v8, s[4:7], s16 offen offset:3072 sc1
    s_mov_b64 exec, -1
    s_add_u32 s23, s23, 1
    s_cmp_ge_u32 s23, 200000
    s_cselect_b32 s25, 200000, s25
    s_cbranch_scc1 go_67
    s_branch gl_66
go_67:
    v_mfma_f32_16x16x32_bf16 v[40:43], a[208:211], v[32:35], v[40:43]
    v_mfma_f32_16x16x32_bf16 v[44:47], a[212:215], v[32:35], v[44:47]
    v_mfma_f32_16x16x32_bf16 v[48:51], a[240:243], v[32:35], v[48:51]
    v_mfma_f32_16x16x32_bf16 v[52:55], a[244:247], v[32:35], v[52:55]
gd_65:
    s_cmp_eq_u64 s[92:93], 0
    s_cbranch_scc1 gd_68
gl_69:
    v_max3_u32 v19, v36, v37, v38
    v_max_u32 v19, v19, v39
    v_cmp_eq_u32 vcc, -1, v19
    s_nop 0
    s_cbranch_vccz go_70
    s_mov_b64 s[92:93], vcc
    s_waitcnt vmcnt(2)
    s_mov_b64 exec, s[92:93]
    buffer_load_dwordx4 v[36:39], v8, s[4:7], s16 offen offset:3072 sc1
    s_mov_b64 exec, -1
    s_add_u32 s23, s23, 1
    s_cmp_ge_u32 s23, 200000
    s_cselect_b32 s25, 200000, s25
    s_cbranch_scc1 go_70
    s_branch gl_69
go_70:
    v_mfma_f32_16x16x32_bf16 v[40:43], a[216:219], v[36:39], v[40:43]
    v_mfma_f32_16x16x32_bf16 v[44:47], a[220:223], v[36:39], v[44:47]
    v_mfma_f32_16x16x32_bf16 v[48:51], a[248:251], v[36:39], v[48:51]
    v_mfma_f32_16x16x32_bf16 v[52:55], a[252:255], v[36:39], v[52:55]
gd_68:
    s_branch gc_51
gs_53:
    s_mov_b64 s[88:89], vcc
    s_mov_b64 exec, s[88:89]
    buffer_load_dwordx4 v[28:31], v8, s[4:7], s16 offen offset:1024 sc1
    s_mov_b64 exec, -1
    s_waitcnt vmcnt(1)
    v_max3_u32 v19, v32, v33, v34
    v_max_u32 v19, v19, v35
    v_cmp_eq_u32 s[90:91], -1, v19
    v_max3_u32 v19, v36, v37, v38
    v_max_u32 v19, v19, v39
    v_cmp_eq_u32 s[92:93], -1, v19
    s_mov_b64 exec, s[90:91]
    buffer_load_dwordx4 v[32:35], v8, s[4:7], s16 offen offset:2048 sc1
    s_mov_b64 exec, s[92:93]
    buffer_load_dwordx4 v[36:39], v8, s[4:7], s16 offen offset:3072 sc1
    s_mov_b64 exec, -1
    s_cmp_lg_u64 s[90:91], 0
    s_cbranch_scc1 gk_71
    v_mfma_f32_16x16x32_bf16 v[40:43], a[208:211], v[32:35], v[40:43]
    v_mfma_f32_16x16x32_bf16 v[44:47], a[212:215], v[32:35], v[44:47]
    v_mfma_f32_16x16x32_bf16 v[48:51], a[240:243], v[32:35], v[48:51]
    v_mfma_f32_16x16x32_bf16 v[52:55], a[244:247], v[32:35], v[52:55]
    s_mov_b64 exec, s[88:89]
    buffer_load_dwordx4 v[28:31], v8, s[4:7], s16 offen offset:1024 sc1
    s_mov_b64 exec, s[92:93]
    buffer_load_dwordx4 v[36:39], v8, s[4:7], s16 offen offset:3072 sc1
    s_mov_b64 exec, -1
gk_71:
    s_cmp_lg_u64 s[92:93], 0
    s_cbranch_scc1 gk_72
    v_mfma_f32_16x16x32_bf16 v[40:43], a[216:219], v[36:39], v[40:43]
    v_mfma_f32_16x16x32_bf16 v[44:47], a[220:223], v[36:39], v[44:47]
    v_mfma_f32_16x16x32_bf16 v[48:51], a[248:251], v[36:39], v[48:51]
    v_mfma_f32_16x16x32_bf16 v[52:55], a[252:255], v[36:39], v[52:55]
    s_mov_b64 exec, s[88:89]
    buffer_load_dwordx4 v[28:31], v8, s[4:7], s16 offen offset:1024 sc1
    s_mov_b64 exec, s[90:91]
    buffer_load_dwordx4 v[32:35], v8, s[4:7], s16 offen offset:2048 sc1
    s_mov_b64 exec, -1
gk_72:
gl_74:
    v_max3_u32 v19, v28, v29, v30
    v_max_u32 v19, v19, v31
    v_cmp_eq_u32 vcc, -1, v19
    s_nop 0
    s_cbranch_vccz go_75
    s_mov_b64 s[88:89], vcc
    s_waitcnt vmcnt(6)
    s_mov_b64 exec, s[88:89]
    buffer_load_dwordx4 v[28:31], v8, s[4:7], s16 offen offset:1024 sc1
    s_mov_b64 exec, s[90:91]
    buffer_load_dwordx4 v[32:35], v8, s[4:7], s16 offen offset:2048 sc1
    s_mov_b64 exec, s[92:93]
    buffer_load_dwordx4 v[36:39], v8, s[4:7], s16 offen offset:3072 sc1
    s_mov_b64 exec, -1
    s_add_u32 s23, s23, 1
    s_cmp_ge_u32 s23, 200000
    s_cselect_b32 s25, 200000, s25
    s_cbranch_scc1 go_75
    s_branch gl_74
go_75:
    v_mfma_f32_16x16x32_bf16 v[40:43], a[200:203], v[28:31], v[40:43]
    v_mfma_f32_16x16x32_bf16 v[44:47], a[204:207], v[28:31], v[44:47]
    v_mfma_f32_16x16x32_bf16 v[48:51], a[232:235], v[28:31], v[48:51]
    v_mfma_f32_16x16x32_bf16 v[52:55], a[236:239], v[28:31], v[52:55]
gd_73:
    s_cmp_eq_u64 s[90:91], 0
    s_cbranch_scc1 gd_76
gl_77:
    v_max3_u32 v19, v32, v33, v34
    v_max_u32 v19, v19, v35
    v_cmp_eq_u32 vcc, -1, v19
    s_nop 0
    s_cbranch_vccz go_78
    s_mov_b64 s[90:91], vcc
    s_waitcnt vmcnt(4)
    s_mov_b64 exec, s[90:91]
    buffer_load_dwordx4 v[32:35], v8, s[4:7], s16 offen offset:2048 sc1
    s_mov_b64 exec, s[92:93]
    buffer_load_dwordx4 v[36:39], v8, s[4:7], s16 offen offset:3072 sc1
    s_mov_b64 exec, -1
    s_add_u32 s23, s23, 1
    s_cmp_ge_u32 s23, 200000
    s_cselect_b32 s25, 200000, s25
    s_cbranch_scc1 go_78
    s_branch gl_77
go_78:
    v_mfma_f32_16x16x32_bf16 v[40:43], a[208:211], v[32:35], v[40:43]
    v_mfma_f32_16x16x32_bf16 v[44:47], a[212:215], v[32:35], v[44:47]
    v_mfma_f32_16x16x32_bf16 v[48:51], a[240:243], v[32:35], v[48:51]
    v_mfma_f32_16x16x32_bf16 v[52:55], a[244:247], v[32:35], v[52:55]
gd_76:
    s_cmp_eq_u64 s[92:93], 0
    s_cbranch_scc1 gd_79
gl_80:
    v_max3_u32 v19, v36, v37, v38
    v_max_u32 v19, v19, v39
    v_cmp_eq_u32 vcc, -1, v19
    s_nop 0
    s_cbranch_vccz go_81
    s_mov_b64 s[92:93], vcc
    s_waitcnt vmcnt(2)
    s_mov_b64 exec, s[92:93]
    buffer_load_dwordx4 v[36:39], v8, s[4:7], s16 offen offset:3072 sc1
    s_mov_b64 exec, -1
    s_add_u32 s23, s23, 1
    s_cmp_ge_u32 s23, 200000
    s_cselect_b32 s25, 200000, s25
    s_cbranch_scc1 go_81
    s_branch gl_80
go_81:
    v_mfma_f32_16x16x32_bf16 v[40:43], a[216:219], v[36:39], v[40:43]
    v_mfma_f32_16x16x32_bf16 v[44:47], a[220:223], v[36:39], v[44:47]
    v_mfma_f32_16x16x32_bf16 v[48:51], a[248:251], v[36:39], v[48:51]
    v_mfma_f32_16x16x32_bf16 v[52:55], a[252:255], v[36:39], v[52:55]
gd_79:
    s_branch gc_51
gs_54:
    s_mov_b64 s[90:91], vcc
    s_mov_b64 exec, s[90:91]
    buffer_load_dwordx4 v[32:35], v8, s[4:7], s16 offen offset:2048 sc1
    s_mov_b64 exec, -1
    s_waitcnt vmcnt(1)
    v_max3_u32 v19, v36, v37, v38
    v_max_u32 v19, v19, v39
    v_cmp_eq_u32 s[92:93], -1, v19
    s_nop 0
    s_mov_b64 exec, s[92:93]
    buffer_load_dwordx4 v[36:39], v8, s[4:7], s16 offen offset:3072 sc1
    s_mov_b64 exec, -1
    s_cmp_lg_u64 s[92:93], 0
    s_cbranch_scc1 gk_82
    v_mfma_f32_16x16x32_bf16 v[40:43], a[216:219], v[36:39], v[40:43]
    v_mfma_f32_16x16x32_bf16 v[44:47], a[220:223], v[36:39], v[44:47]
    v_mfma_f32_16x16x32_bf16 v[48:51], a[248:251], v[36:39], v[48:51]
    v_mfma_f32_16x16x32_bf16 v[52:55], a[252:255], v[36:39], v[52:55]
    s_mov_b64 exec, s[90:91]
    buffer_load_dwordx4 v[32:35], v8, s[4:7], s16 offen offset:2048 sc1
    s_mov_b64 exec, -1
gk_82:
gl_84:
    v_max3_u32 v19, v32, v33, v34
    v_max_u32 v19, v19, v35
    v_cmp_eq_u32 vcc, -1, v19
    s_nop 0
    s_cbranch_vccz go_85
    s_mov_b64 s[90:91], vcc
    s_waitcnt vmcnt(4)
    s_mov_b64 exec, s[90:91]
    buffer_load_dwordx4 v[32:35], v8, s[4:7], s16 offen offset:2048 sc1
    s_mov_b64 exec, s[92:93]
    buffer_load_dwordx4 v[36:39], v8, s[4:7], s16 offen offset:3072 sc1
    s_mov_b64 exec, -1
    s_add_u32 s23, s23, 1
    s_cmp_ge_u32 s23, 200000
    s_cselect_b32 s25, 200000, s25
    s_cbranch_scc1 go_85
    s_branch gl_84
go_85:
    v_mfma_f32_16x16x32_bf16 v[40:43], a[208:211], v[32:35], v[40:43]
    v_mfma_f32_16x16x32_bf16 v[44:47], a[212:215], v[32:35], v[44:47]
    v_mfma_f32_16x16x32_bf16 v[48:51], a[240:243], v[32:35], v[48:51]
    v_mfma_f32_16x16x32_bf16 v[52:55], a[244:247], v[32:35], v[52:55]
gd_83:
    s_cmp_eq_u64 s[92:93], 0
    s_cbranch_scc1 gd_86
gl_87:
    v_max3_u32 v19, v36, v37, v38
    v_max_u32 v19, v19, v39
    v_cmp_eq_u32 vcc, -1, v19
    s_nop 0
    s_cbranch_vccz go_88
    s_mov_b64 s[92:93], vcc
    s_waitcnt vmcnt(2)
    s_mov_b64 exec, s[92:93]
    buffer_load_dwordx4 v[36:39], v8, s[4:7], s16 offen offset:3072 sc1
    s_mov_b64 exec, -1
    s_add_u32 s23, s23, 1
    s_cmp_ge_u32 s23, 200000
    s_cselect_b32 s25, 200000, s25
    s_cbranch_scc1 go_88
    s_branch gl_87
go_88:
    v_mfma_f32_16x16x32_bf16 v[40:43], a[216:219], v[36:39], v[40:43]
    v_mfma_f32_16x16x32_bf16 v[44:47], a[220:223], v[36:39], v[44:47]
    v_mfma_f32_16x16x32_bf16 v[48:51], a[248:251], v[36:39], v[48:51]
    v_mfma_f32_16x16x32_bf16 v[52:55], a[252:255], v[36:39], v[52:55]
gd_86:
    s_branch gc_51
gs_55:
    s_mov_b64 s[92:93], vcc
    s_mov_b64 exec, s[92:93]
    buffer_load_dwordx4 v[36:39], v8, s[4:7], s16 offen offset:3072 sc1
    s_mov_b64 exec, -1
gl_90:
    v_max3_u32 v19, v36, v37, v38
    v_max_u32 v19, v19, v39
    v_cmp_eq_u32 vcc, -1, v19
    s_nop 0
    s_cbranch_vccz go_91
    s_mov_b64 s[92:93], vcc
    s_waitcnt vmcnt(2)
    s_mov_b64 exec, s[92:93]
    buffer_load_dwordx4 v[36:39], v8, s[4:7], s16 offen offset:3072 sc1
    s_mov_b64 exec, -1
    s_add_u32 s23, s23, 1
    s_cmp_ge_u32 s23, 200000
    s_cselect_b32 s25, 200000, s25
    s_cbranch_scc1 go_91
    s_branch gl_90
go_91:
    v_mfma_f32_16x16x32_bf16 v[40:43], a[216:219], v[36:39], v[40:43]
    v_mfma_f32_16x16x32_bf16 v[44:47], a[220:223], v[36:39], v[44:47]
    v_mfma_f32_16x16x32_bf16 v[48:51], a[248:251], v[36:39], v[48:51]
    v_mfma_f32_16x16x32_bf16 v[52:55], a[252:255], v[36:39], v[52:55]
gd_89:
    s_branch gc_51
.p2align 6
recur_fast_w1:
    s_sleep 2
    s_mov_b32 s23, s25
    buffer_load_dwordx4 v[24:27], v2, s[4:7], s16 offen offset:0 sc1
    buffer_load_dwordx4 v[28:31], v2, s[4:7], s16 offen offset:1024 sc1
    buffer_load_dwordx4 v[32:35], v2, s[4:7], s16 offen offset:2048 sc1
    buffer_load_dwordx4 v[36:39], v2, s[4:7], s16 offen offset:3072 sc1
    s_waitcnt vmcnt(3)
    v_max3_u32 v19, v24, v25, v26
    v_max_u32 v19, v19, v27
    v_cmp_eq_u32 vcc, -1, v19
    s_nop 0
    s_cbranch_vccnz gs_95
    v_mfma_f32_16x16x32_bf16 v[40:43], a[0:3], v[24:27], v[40:43]
    v_mfma_f32_16x16x32_bf16 v[44:47], a[4:7], v[24:27], v[44:47]
    v_mfma_f32_16x16x32_bf16 v[56:59], a[64:67], v[24:27], v[56:59]
    v_mfma_f32_16x16x32_bf16 v[60:63], a[68:71], v[24:27], v[60:63]
    v_mfma_f32_16x16x32_bf16 v[48:51], a[32:35], v[24:27], v[48:51]
    s_waitcnt vmcnt(2)
    v_max3_u32 v19, v28, v29, v30
    v_mfma_f32_16x16x32_bf16 v[52:55], a[36:39], v[24:27], v[52:55]
    v_max_u32 v19, v19, v31
    v_mfma_f32_16x16x32_bf16 v[64:67], a[96:99], v[24:27], v[64:67]
    v_cmp_eq_u32 vcc, -1, v19
    v_mfma_f32_16x16x32_bf16 v[68:71], a[100:103], v[24:27], v[68:71]
    s_cbranch_vccnz gs_96
    v_mfma_f32_16x16x32_bf16 v[40:43], a[8:11], v[28:31], v[40:43]
    v_mfma_f32_16x16x32_bf16 v[44:47], a[12:15], v[28:31], v[44:47]
    v_mfma_f32_16x16x32_bf16 v[56:59], a[72:75], v[28:31], v[56:59]
    v_mfma_f32_16x16x32_bf16 v[60:63], a[76:79], v[28:31], v[60:63]
    v_mfma_f32_16x16x32_bf16 v[48:51], a[40:43], v[28:31], v[48:51]
    s_waitcnt vmcnt(1)
    v_max3_u32 v19, v32, v33, v34
    v_mfma_f32_16x16x32_bf16 v[52:55], a[44:47], v[28:31], v[52:55]
    v_max_u32 v19, v19, v35
    v_mfma_f32_16x16x32_bf16 v[64:67], a[104:107], v[28:31], v[64:67]
    v_cmp_eq_u32 vcc, -1, v19
    v_mfma_f32_16x16x32_bf16 v[68:71], a[108:111], v[28:31], v[68:71]
    s_cbranch_vccnz gs_97
    v_mfma_f32_16x16x32_bf16 v[40:43], a[16:19], v[32:35], v[40:43]
    v_mfma_f32_16x16x32_bf16 v[44:47], a[20:23], v[32:35], v[44:47]
    v_mfma_f32_16x16x32_bf16 v[56:59], a[80:83], v[32:35], v[56:59]
    v_mfma_f32_16x16x32_bf16 v[60:63], a[84:87], v[32:35], v[60:63]
    v_mfma_f32_16x16x32_bf16 v[48:51], a[48:51], v[32:35], v[48:51]
    s_waitcnt vmcnt(0)
    v_max3_u32 v19, v36, v37, v38
    v_mfma_f32_16x16x32_bf16 v[52:55], a[52:55], v[32:35], v[52:55]
    v_max_u32 v19, v19, v39
    v_mfma_f32_16x16x32_bf16 v[64:67], a[112:115], v[32:35], v[64:67]
    v_cmp_eq_u32 vcc, -1, v19
    v_mfma_f32_16x16x32_bf16 v[68:71], a[116:119], v[32:35], v[68:71]
    s_cbranch_vccnz gs_98
    v_mfma_f32_16x16x32_bf16 v[40:43], a[24:27], v[36:39], v[40:43]
    v_mfma_f32_16x16x32_bf16 v[44:47], a[28:31], v[36:39], v[44:47]
    v_mfma_f32_16x16x32_bf16 v[56:59], a[88:91], v[36:39], v[56:59]
    v_mfma_f32_16x16x32_bf16 v[60:63], a[92:95], v[36:39], v[60:63]
    v_mfma_f32_16x16x32_bf16 v[48:51], a[56:59], v[36:39], v[48:51]
    v_mfma_f32_16x16x32_bf16 v[52:55], a[60:63], v[36:39], v[52:55]
    v_mfma_f32_16x16x32_bf16 v[64:67], a[120:123], v[36:39], v[64:67]
    v_mfma_f32_16x16x32_bf16 v[68:71], a[124:127], v[36:39], v[68:71]
gc_94:
    s_nop 1
    v_add_f32_dpp v88, v44, v40 row_ror:8 row_mask:0xf bank_mask:0x3
    v_add_f32_dpp v89, v45, v41 row_ror:8 row_mask:0xf bank_mask:0x3
    v_add_f32_dpp v90, v46, v42 row_ror:8 row_mask:0xf bank_mask:0x3
    v_add_f32_dpp v91, v47, v43 row_ror:8 row_mask:0xf bank_mask:0x3
    v_add_f32_dpp v88, v56, v60 row_ror:8 row_mask:0xf bank_mask:0xc
    v_add_f32_dpp v89, v57, v61 row_ror:8 row_mask:0xf bank_mask:0xc
    v_add_f32_dpp v90, v58, v62 row_ror:8 row_mask:0xf bank_mask:0xc
    v_add_f32_dpp v91, v59, v63 row_ror:8 row_mask:0xf bank_mask:0xc
    ds_write_b128 v17, v[88:91] offset:0
    v_add_f32_dpp v92, v52, v48 row_ror:8 row_mask:0xf bank_mask:0x3
    v_add_f32_dpp v93, v53, v49 row_ror:8 row_mask:0xf bank_mask:0x3
    v_add_f32_dpp v94, v54, v50 row_ror:8 row_mask:0xf bank_mask:0x3
    v_add_f32_dpp v95, v55, v51 row_ror:8 row_mask:0xf bank_mask:0x3
    v_mfma_f32_16x16x32_bf16 v[72:75], v[24:27], a[128:131], 0
    v_add_f32_dpp v92, v64, v68 row_ror:8 row_mask:0xf bank_mask:0xc
    v_add_f32_dpp v93, v65, v69 row_ror:8 row_mask:0xf bank_mask:0xc
    v_add_f32_dpp v94, v66, v70 row_ror:8 row_mask:0xf bank_mask:0xc
    v_add_f32_dpp v95, v67, v71 row_ror:8 row_mask:0xf bank_mask:0xc
    v_mfma_f32_16x16x32_bf16 v[80:83], v[24:27], a[160:163], 0
    ds_write_b128 v17, v[92:95] offset:1024
    v_mfma_f32_16x16x32_bf16 v[76:79], v[24:27], a[132:135], 0
    v_mfma_f32_16x16x32_bf16 v[84:87], v[24:27], a[164:167], 0
    s_waitcnt lgkmcnt(0)
    s_barrier
    buffer_load_dwordx4 v[228:231], v13, s[4:7], s18 offen offset:0 sc1
    buffer_load_dwordx4 v[232:235], v13, s[4:7], s18 offen offset:256 sc1
    s_add_u32 s18, s18, 2048
    s_min_u32 s18, s18, 35780608
    v_mfma_f32_16x16x32_bf16 v[72:75], v[28:31], a[136:139], v[72:75]
    v_mfma_f32_16x16x32_bf16 v[80:83], v[28:31], a[168:171], v[80:83]
    v_mfma_f32_16x16x32_bf16 v[76:79], v[28:31], a[140:143], v[76:79]
    v_mfma_f32_16x16x32_bf16 v[84:87], v[28:31], a[172:175], v[84:87]
    v_mfma_f32_16x16x32_bf16 v[72:75], v[32:35], a[144:147], v[72:75]
    v_mfma_f32_16x16x32_bf16 v[80:83], v[32:35], a[176:179], v[80:83]
    v_mfma_f32_16x16x32_bf16 v[76:79], v[32:35], a[148:151], v[76:79]
    v_mfma_f32_16x16x32_bf16 v[84:87], v[32:35], a[180:183], v[84:87]
    v_mfma_f32_16x16x32_bf16 v[72:75], v[36:39], a[152:155], v[72:75]
    v_mfma_f32_16x16x32_bf16 v[80:83], v[36:39], a[184:187], v[80:83]
    v_mfma_f32_16x16x32_bf16 v[76:79], v[36:39], a[156:159], v[76:79]
    v_mfma_f32_16x16x32_bf16 v[84:87], v[36:39], a[188:191], v[84:87]
    s_nop 6
    v_mov_b32_dpp v72, v76 quad_perm:[0,1,2,3] row_mask:0xc bank_mask:0xf
    v_mov_b32_dpp v73, v77 quad_perm:[0,1,2,3] row_mask:0xc bank_mask:0xf
    v_mov_b32_dpp v74, v78 quad_perm:[0,1,2,3] row_mask:0xc bank_mask:0xf
    v_mov_b32_dpp v75, v79 quad_perm:[0,1,2,3] row_mask:0xc bank_mask:0xf
    ds_write_b128 v17, v[72:75] offset:8192
    v_mov_b32_dpp v80, v84 quad_perm:[0,1,2,3] row_mask:0xc bank_mask:0xf
    v_mov_b32_dpp v81, v85 quad_perm:[0,1,2,3] row_mask:0xc bank_mask:0xf
    v_mov_b32_dpp v82, v86 quad_perm:[0,1,2,3] row_mask:0xc bank_mask:0xf
    v_mov_b32_dpp v83, v87 quad_perm:[0,1,2,3] row_mask:0xc bank_mask:0xf
    ds_write_b128 v17, v[80:83] offset:9216
    v_mov_b32 v40, 0
    v_mov_b32 v41, 0
    v_mov_b32 v42, 0
    v_mov_b32 v43, 0
    v_mov_b32 v44, 0
    v_mov_b32 v45, 0
    v_mov_b32 v46, 0
    v_mov_b32 v47, 0
    v_mov_b32 v48, 0
    v_mov_b32 v49, 0
    v_mov_b32 v50, 0
    v_mov_b32 v51, 0
    v_mov_b32 v52, 0
    v_mov_b32 v53, 0
    v_mov_b32 v54, 0
    v_mov_b32 v55, 0
    s_waitcnt lgkmcnt(0)
    s_barrier
    s_cmp_eq_u32 s15, 63
    s_cbranch_scc1 recur_end
    s_mov_b32 s23, s25
    buffer_load_dwordx4 v[208:211], v5, s[4:7], s16 offen offset:0 sc1
    buffer_load_dword v224, v6, s[4:7], s16 offen offset:0 sc1
    buffer_load_dwordx4 v[212:215], v5, s[4:7], s16 offen offset:1024 sc1
    buffer_load_dword v225, v6, s[4:7], s16 offen offset:256 sc1
    buffer_load_dwordx4 v[216:219], v5, s[4:7], s16 offen offset:2048 sc1
    buffer_load_dword v226, v6, s[4:7], s16 offen offset:512 sc1
    buffer_load_dwordx4 v[220:223], v5, s[4:7], s16 offen offset:3072 sc1
    buffer_load_dword v227, v6, s[4:7], s16 offen offset:768 sc1
    s_waitcnt vmcnt(6)
    v_max3_u32 v19, v208, v209, v210
    v_max3_u32 v19, v19, v211, v224
    v_cmp_eq_u32 vcc, -1, v19
    s_nop 0
    s_cbranch_vccnz gs_136
    s_waitcnt vmcnt(4)
    v_max3_u32 v19, v212, v213, v214
    v_max3_u32 v19, v19, v215, v225
    v_cmp_eq_u32 vcc, -1, v19
    s_nop 0
    s_cbranch_vccnz gs_137
    s_waitcnt vmcnt(2)
    v_max3_u32 v19, v216, v217, v218
    v_max3_u32 v19, v19, v219, v226
    v_cmp_eq_u32 vcc, -1, v19
    s_nop 0
    s_cbranch_vccnz gs_138
    s_waitcnt vmcnt(0)
    v_max3_u32 v19, v220, v221, v222
    v_max3_u32 v19, v19, v223, v227
    v_cmp_eq_u32 vcc, -1, v19
    s_nop 0
    s_cbranch_vccnz gs_139
gc_135:
    s_barrier
    ds_read_b32 v154, v16 offset:24576
    ds_read_b32 v158, v16 offset:24580
    ds_read_b32 v162, v16 offset:24584
    ds_read_b32 v166, v16 offset:24588
    v_add_f32 v180, v208, v212
    v_add_f32 v181, v209, v213
    v_add_f32 v182, v210, v214
    v_add_f32 v183, v211, v215
    v_add_f32 v184, v224, v225
    v_add_f32 v96, v216, v220
    v_add_f32 v97, v217, v221
    v_add_f32 v98, v218, v222
    v_add_f32 v99, v219, v223
    v_add_f32 v100, v226, v227
    v_add_f32 v180, v180, v96
    v_add_f32 v181, v181, v97
    v_add_f32 v182, v182, v98
    v_add_f32 v183, v183, v99
    v_add_f32 v184, v184, v100
    v_max3_f32 v185, v180, v181, v182
    v_max3_f32 v185, v185, v183, v184
    s_nop 1
    v_max_f32_dpp v185, v185, v185 row_ror:8 row_mask:0xf bank_mask:0xf
    v_mov_b32 v186, v185
    s_nop 1
    v_permlane16_swap_b32 v185, v186
    v_max_f32 v185, v185, v186
    v_mov_b32 v186, v185
    s_nop 1
    v_permlane32_swap_b32 v185, v186
    v_max_f32 v185, v185, v186
    v_mul_f32 v185, s24, v185
    v_fma_f32 v180, v180, s24, -v185
    v_fma_f32 v181, v181, s24, -v185
    v_fma_f32 v182, v182, s24, -v185
    v_fma_f32 v183, v183, s24, -v185
    v_fma_f32 v184, v184, s24, -v185
    v_exp_f32 v180, v180
    v_exp_f32 v181, v181
    v_exp_f32 v182, v182
    v_exp_f32 v183, v183
    v_exp_f32 v184, v184
    v_cvt_pk_bf16_f32 v176, v180, v181
    v_cvt_pk_bf16_f32 v177, v182, v183
    v_cvt_pk_bf16_f32 v178, v184, v179
    s_waitcnt lgkmcnt(0)
    s_nop 0
    v_mfma_f32_16x16x32_bf16 v[240:243], v[236:239], v[176:179], 0
    v_mfma_f32_16x16x32_bf16 v[188:191], v[152:155], v[176:179], 0
    v_mfma_f32_16x16x32_bf16 v[192:195], v[156:159], v[176:179], 0
    v_mfma_f32_16x16x32_bf16 v[196:199], v[160:163], v[176:179], 0
    v_mfma_f32_16x16x32_bf16 v[200:203], v[164:167], v[176:179], 0
    s_nop 3
    v_add_f32_dpp v185, v240, v240 row_ror:8 row_mask:0xf bank_mask:0xf
    v_rcp_f32 v185, v185
    v_add_f32_dpp v88, v192, v188 row_ror:8 row_mask:0xf bank_mask:0x3
    v_add_f32_dpp v89, v193, v189 row_ror:8 row_mask:0xf bank_mask:0x3
    v_add_f32_dpp v90, v194, v190 row_ror:8 row_mask:0xf bank_mask:0x3
    v_add_f32_dpp v91, v195, v191 row_ror:8 row_mask:0xf bank_mask:0x3
    v_add_f32_dpp v88, v196, v200 row_ror:8 row_mask:0xf bank_mask:0xc
    v_add_f32_dpp v89, v197, v201 row_ror:8 row_mask:0xf bank_mask:0xc
    v_add_f32_dpp v90, v198, v202 row_ror:8 row_mask:0xf bank_mask:0xc
    v_add_f32_dpp v91, v199, v203 row_ror:8 row_mask:0xf bank_mask:0xc
    v_mul_f32 v88, v88, v185
    v_mul_f32 v89, v89, v185
    v_mul_f32 v90, v90, v185
    v_mul_f32 v91, v91, v185
    v_cvt_pk_bf16_f32 v88, v88, v89
    v_cvt_pk_bf16_f32 v89, v90, v91
    buffer_store_dwordx2 v[88:89], v7, s[4:7], s16 offen
    s_sleep 1
    s_mov_b32 s23, s25
    buffer_load_dwordx4 v[24:27], v8, s[4:7], s16 offen offset:0 sc1
    buffer_load_dwordx4 v[28:31], v8, s[4:7], s16 offen offset:1024 sc1
    buffer_load_dwordx4 v[32:35], v8, s[4:7], s16 offen offset:2048 sc1
    buffer_load_dwordx4 v[36:39], v8, s[4:7], s16 offen offset:3072 sc1
    s_waitcnt vmcnt(3)
    v_max3_u32 v19, v24, v25, v26
    v_max_u32 v19, v19, v27
    v_cmp_eq_u32 vcc, -1, v19
    s_nop 0
    s_cbranch_vccnz gs_171
    v_mfma_f32_16x16x32_bf16 v[40:43], a[192:195], v[24:27], v[40:43]
    s_waitcnt vmcnt(2)
    v_max3_u32 v19, v28, v29, v30
    v_mfma_f32_16x16x32_bf16 v[44:47], a[196:199], v[24:27], v[44:47]
    v_max_u32 v19, v19, v31
    v_mfma_f32_16x16x32_bf16 v[48:51], a[224:227], v[24:27], v[48:51]
    v_cmp_eq_u32 vcc, -1, v19
    v_mfma_f32_16x16x32_bf16 v[52:55], a[228:231], v[24:27], v[52:55]
    s_cbranch_vccnz gs_172
    v_mfma_f32_16x16x32_bf16 v[40:43], a[200:203], v[28:31], v[40:43]
    s_waitcnt vmcnt(1)
    v_max3_u32 v19, v32, v33, v34
    v_mfma_f32_16x16x32_bf16 v[44:47], a[204:207], v[28:31], v[44:47]
    v_max_u32 v19, v19, v35
    v_mfma_f32_16x16x32_bf16 v[48:51], a[232:235], v[28:31], v[48:51]
    v_cmp_eq_u32 vcc, -1, v19
    v_mfma_f32_16x16x32_bf16 v[52:55], a[236:239], v[28:31], v[52:55]
    s_cbranch_vccnz gs_173
    v_mfma_f32_16x16x32_bf16 v[40:43], a[208:211], v[32:35], v[40:43]
    s_waitcnt vmcnt(0)
    v_max3_u32 v19, v36, v37, v38
    v_mfma_f32_16x16x32_bf16 v[44:47], a[212:215], v[32:35], v[44:47]
    v_max_u32 v19, v19, v39
    v_mfma_f32_16x16x32_bf16 v[48:51], a[240:243], v[32:35], v[48:51]
    v_cmp_eq_u32 vcc, -1, v19
    v_mfma_f32_16x16x32_bf16 v[52:55], a[244:247], v[32:35], v[52:55]
    s_cbranch_vccnz gs_174
    v_mfma_f32_16x16x32_bf16 v[40:43], a[216:219], v[36:39], v[40:43]
    v_mfma_f32_16x16x32_bf16 v[44:47], a[220:223], v[36:39], v[44:47]
    v_mfma_f32_16x16x32_bf16 v[48:51], a[248:251], v[36:39], v[48:51]
    v_mfma_f32_16x16x32_bf16 v[52:55], a[252:255], v[36:39], v[52:55]
gc_170:
    s_nop 5
    v_add_f32_dpp v88, v44, v40 row_ror:8 row_mask:0xf bank_mask:0x3
    v_add_f32_dpp v89, v45, v41 row_ror:8 row_mask:0xf bank_mask:0x3
    v_add_f32_dpp v90, v46, v42 row_ror:8 row_mask:0xf bank_mask:0x3
    v_add_f32_dpp v91, v47, v43 row_ror:8 row_mask:0xf bank_mask:0x3
    v_add_f32_dpp v88, v48, v52 row_ror:8 row_mask:0xf bank_mask:0xc
    v_add_f32_dpp v89, v49, v53 row_ror:8 row_mask:0xf bank_mask:0xc
    v_add_f32_dpp v90, v50, v54 row_ror:8 row_mask:0xf bank_mask:0xc
    v_add_f32_dpp v91, v51, v55 row_ror:8 row_mask:0xf bank_mask:0xc
    ds_write_b128 v17, v[88:91] offset:16384
    s_waitcnt lgkmcnt(0)
    s_barrier
    v_mov_b32 v152, v228
    v_mov_b32 v153, v229
    v_mov_b32 v156, v230
    v_mov_b32 v157, v231
    v_mov_b32 v160, v232
    v_mov_b32 v161, v233
    v_mov_b32 v164, v234
    v_mov_b32 v165, v235
    v_mov_b32 v40, 0
    v_mov_b32 v41, 0
    v_mov_b32 v42, 0
    v_mov_b32 v43, 0
    v_mov_b32 v44, 0
    v_mov_b32 v45, 0
    v_mov_b32 v46, 0
    v_mov_b32 v47, 0
    v_mov_b32 v48, 0
    v_mov_b32 v49, 0
    v_mov_b32 v50, 0
    v_mov_b32 v51, 0
    v_mov_b32 v52, 0
    v_mov_b32 v53, 0
    v_mov_b32 v54, 0
    v_mov_b32 v55, 0
    v_mov_b32 v56, 0
    v_mov_b32 v57, 0
    v_mov_b32 v58, 0
    v_mov_b32 v59, 0
    v_mov_b32 v60, 0
    v_mov_b32 v61, 0
    v_mov_b32 v62, 0
    v_mov_b32 v63, 0
    v_mov_b32 v64, 0
    v_mov_b32 v65, 0
    v_mov_b32 v66, 0
    v_mov_b32 v67, 0
    v_mov_b32 v68, 0
    v_mov_b32 v69, 0
    v_mov_b32 v70, 0
    v_mov_b32 v71, 0
    s_add_u32 s94, s15, 3
    s_min_u32 s94, s94, 64
    s_mov_b32 s23, s25
fw_211:
    s_cmp_ge_u32 s85, s94
    s_cbranch_scc1 fo_212
    buffer_load_dword v19, v245, s[4:7], 0 offen sc1
    s_add_u32 s23, s23, 1
    s_waitcnt vmcnt(0)
    v_readfirstlane_b32 s85, v19
    s_cmp_lt_u32 s23, 200000
    s_cbranch_scc1 fw_211
    s_mov_b32 s25, 200000
fo_212:
    s_mov_b32 s21, s16
    s_mov_b32 s16, s42
    s_mov_b32 s42, s43
    s_mov_b32 s43, s44
    s_mov_b32 s44, s21
    s_add_u32 s84, s84, 262144
    s_add_u32 s15, s15, 1
    s_barrier
    s_branch recur_fast_w1
gs_95:
    s_mov_b64 s[86:87], vcc
    s_mov_b64 exec, s[86:87]
    buffer_load_dwordx4 v[24:27], v2, s[4:7], s16 offen offset:0 sc1
    s_mov_b64 exec, -1
    s_waitcnt vmcnt(1)
    v_max3_u32 v19, v28, v29, v30
    v_max_u32 v19, v19, v31
    v_cmp_eq_u32 s[88:89], -1, v19
    v_max3_u32 v19, v32, v33, v34
    v_max_u32 v19, v19, v35
    v_cmp_eq_u32 s[90:91], -1, v19
    v_max3_u32 v19, v36, v37, v38
    v_max_u32 v19, v19, v39
    v_cmp_eq_u32 s[92:93], -1, v19
    s_mov_b64 exec, s[88:89]
    buffer_load_dwordx4 v[28:31], v2, s[4:7], s16 offen offset:1024 sc1
    s_mov_b64 exec, s[90:91]
    buffer_load_dwordx4 v[32:35], v2, s[4:7], s16 offen offset:2048 sc1
    s_mov_b64 exec, s[92:93]
    buffer_load_dwordx4 v[36:39], v2, s[4:7], s16 offen offset:3072 sc1
    s_mov_b64 exec, -1
    s_cmp_lg_u64 s[88:89], 0
    s_cbranch_scc1 gk_99
    v_mfma_f32_16x16x32_bf16 v[40:43], a[8:11], v[28:31], v[40:43]
    v_mfma_f32_16x16x32_bf16 v[44:47], a[12:15], v[28:31], v[44:47]
    v_mfma_f32_16x16x32_bf16 v[56:59], a[72:75], v[28:31], v[56:59]
    v_mfma_f32_16x16x32_bf16 v[60:63], a[76:79], v[28:31], v[60:63]
    v_mfma_f32_16x16x32_bf16 v[48:51], a[40:43], v[28:31], v[48:51]
    v_mfma_f32_16x16x32_bf16 v[52:55], a[44:47], v[28:31], v[52:55]
    v_mfma_f32_16x16x32_bf16 v[64:67], a[104:107], v[28:31], v[64:67]
    v_mfma_f32_16x16x32_bf16 v[68:71], a[108:111], v[28:31], v[68:71]
    s_mov_b64 exec, s[86:87]
    buffer_load_dwordx4 v[24:27], v2, s[4:7], s16 offen offset:0 sc1
    s_mov_b64 exec, s[90:91]
    buffer_load_dwordx4 v[32:35], v2, s[4:7], s16 offen offset:2048 sc1
    s_mov_b64 exec, s[92:93]
    buffer_load_dwordx4 v[36:39], v2, s[4:7], s16 offen offset:3072 sc1
    s_mov_b64 exec, -1
gk_99:
    s_cmp_lg_u64 s[90:91], 0
    s_cbranch_scc1 gk_100
    v_mfma_f32_16x16x32_bf16 v[40:43], a[16:19], v[32:35], v[40:43]
    v_mfma_f32_16x16x32_bf16 v[44:47], a[20:23], v[32:35], v[44:47]
    v_mfma_f32_16x16x32_bf16 v[56:59], a[80:83], v[32:35], v[56:59]
    v_mfma_f32_16x16x32_bf16 v[60:63], a[84:87], v[32:35], v[60:63]
    v_mfma_f32_16x16x32_bf16 v[48:51], a[48:51], v[32:35], v[48:51]
    v_mfma_f32_16x16x32_bf16 v[52:55], a[52:55], v[32:35], v[52:55]
    v_mfma_f32_16x16x32_bf16 v[64:67], a[112:115], v[32:35], v[64:67]
    v_mfma_f32_16x16x32_bf16 v[68:71], a[116:119], v[32:35], v[68:71]
    s_mov_b64 exec, s[86:87]
    buffer_load_dwordx4 v[24:27], v2, s[4:7], s16 offen offset:0 sc1
    s_mov_b64 exec, s[88:89]
    buffer_load_dwordx4 v[28:31], v2, s[4:7], s16 offen offset:1024 sc1
    s_mov_b64 exec, s[92:93]
    buffer_load_dwordx4 v[36:39], v2, s[4:7], s16 offen offset:3072 sc1
    s_mov_b64 exec, -1
gk_100:
    s_cmp_lg_u64 s[92:93], 0
    s_cbranch_scc1 gk_101
    v_mfma_f32_16x16x32_bf16 v[40:43], a[24:27], v[36:39], v[40:43]
    v_mfma_f32_16x16x32_bf16 v[44:47], a[28:31], v[36:39], v[44:47]
    v_mfma_f32_16x16x32_bf16 v[56:59], a[88:91], v[36:39], v[56:59]
    v_mfma_f32_16x16x32_bf16 v[60:63], a[92:95], v[36:39], v[60:63]
    v_mfma_f32_16x16x32_bf16 v[48:51], a[56:59], v[36:39], v[48:51]
    v_mfma_f32_16x16x32_bf16 v[52:55], a[60:63], v[36:39], v[52:55]
    v_mfma_f32_16x16x32_bf16 v[64:67], a[120:123], v[36:39], v[64:67]
    v_mfma_f32_16x16x32_bf16 v[68:71], a[124:127], v[36:39], v[68:71]
    s_mov_b64 exec, s[86:87]
    buffer_load_dwordx4 v[24:27], v2, s[4:7], s16 offen offset:0 sc1
    s_mov_b64 exec, s[88:89]
    buffer_load_dwordx4 v[28:31], v2, s[4:7], s16 offen offset:1024 sc1
    s_mov_b64 exec, s[90:91]
    buffer_load_dwordx4 v[32:35], v2, s[4:7], s16 offen offset:2048 sc1
    s_mov_b64 exec, -1
gk_101:
gl_103:
    v_max3_u32 v19, v24, v25, v26
    v_max_u32 v19, v19, v27
    v_cmp_eq_u32 vcc, -1, v19
    s_nop 0
    s_cbranch_vccz go_104
    s_mov_b64 s[86:87], vcc
    s_waitcnt vmcnt(8)
    s_mov_b64 exec, s[86:87]
    buffer_load_dwordx4 v[24:27], v2, s[4:7], s16 offen offset:0 sc1
    s_mov_b64 exec, s[88:89]
    buffer_load_dwordx4 v[28:31], v2, s[4:7], s16 offen offset:1024 sc1
    s_mov_b64 exec, s[90:91]
    buffer_load_dwordx4 v[32:35], v2, s[4:7], s16 offen offset:2048 sc1
    s_mov_b64 exec, s[92:93]
    buffer_load_dwordx4 v[36:39], v2, s[4:7], s16 offen offset:3072 sc1
    s_mov_b64 exec, -1
    s_add_u32 s23, s23, 1
    s_cmp_ge_u32 s23, 200000
    s_cselect_b32 s25, 200000, s25
    s_cbranch_scc1 go_104
    s_branch gl_103
go_104:
    v_mfma_f32_16x16x32_bf16 v[40:43], a[0:3], v[24:27], v[40:43]
    v_mfma_f32_16x16x32_bf16 v[44:47], a[4:7], v[24:27], v[44:47]
    v_mfma_f32_16x16x32_bf16 v[56:59], a[64:67], v[24:27], v[56:59]
    v_mfma_f32_16x16x32_bf16 v[60:63], a[68:71], v[24:27], v[60:63]
    v_mfma_f32_16x16x32_bf16 v[48:51], a[32:35], v[24:27], v[48:51]
    v_mfma_f32_16x16x32_bf16 v[52:55], a[36:39], v[24:27], v[52:55]
    v_mfma_f32_16x16x32_bf16 v[64:67], a[96:99], v[24:27], v[64:67]
    v_mfma_f32_16x16x32_bf16 v[68:71], a[100:103], v[24:27], v[68:71]
gd_102:
    s_cmp_eq_u64 s[88:89], 0
    s_cbranch_scc1 gd_105
gl_106:
    v_max3_u32 v19, v28, v29, v30
    v_max_u32 v19, v19, v31
    v_cmp_eq_u32 vcc, -1, v19
    s_nop 0
    s_cbranch_vccz go_107
    s_mov_b64 s[88:89], vcc
    s_waitcnt vmcnt(6)
    s_mov_b64 exec, s[88:89]
    buffer_load_dwordx4 v[28:31], v2, s[4:7], s16 offen offset:1024 sc1
    s_mov_b64 exec, s[90:91]
    buffer_load_dwordx4 v[32:35], v2, s[4:7], s16 offen offset:2048 sc1
    s_mov_b64 exec, s[92:93]
    buffer_load_dwordx4 v[36:39], v2, s[4:7], s16 offen offset:3072 sc1
    s_mov_b64 exec, -1
    s_add_u32 s23, s23, 1
    s_cmp_ge_u32 s23, 200000
    s_cselect_b32 s25, 200000, s25
    s_cbranch_scc1 go_107
    s_branch gl_106
go_107:
    v_mfma_f32_16x16x32_bf16 v[40:43], a[8:11], v[28:31], v[40:43]
    v_mfma_f32_16x16x32_bf16 v[44:47], a[12:15], v[28:31], v[44:47]
    v_mfma_f32_16x16x32_bf16 v[56:59], a[72:75], v[28:31], v[56:59]
    v_mfma_f32_16x16x32_bf16 v[60:63], a[76:79], v[28:31], v[60:63]
    v_mfma_f32_16x16x32_bf16 v[48:51], a[40:43], v[28:31], v[48:51]
    v_mfma_f32_16x16x32_bf16 v[52:55], a[44:47], v[28:31], v[52:55]
    v_mfma_f32_16x16x32_bf16 v[64:67], a[104:107], v[28:31], v[64:67]
    v_mfma_f32_16x16x32_bf16 v[68:71], a[108:111], v[28:31], v[68:71]
gd_105:
    s_cmp_eq_u64 s[90:91], 0
    s_cbranch_scc1 gd_108
gl_109:
    v_max3_u32 v19, v32, v33, v34
    v_max_u32 v19, v19, v35
    v_cmp_eq_u32 vcc, -1, v19
    s_nop 0
    s_cbranch_vccz go_110
    s_mov_b64 s[90:91], vcc
    s_waitcnt vmcnt(4)
    s_mov_b64 exec, s[90:91]
    buffer_load_dwordx4 v[32:35], v2, s[4:7], s16 offen offset:2048 sc1
    s_mov_b64 exec, s[92:93]
    buffer_load_dwordx4 v[36:39], v2, s[4:7], s16 offen offset:3072 sc1
    s_mov_b64 exec, -1
    s_add_u32 s23, s23, 1
    s_cmp_ge_u32 s23, 200000
    s_cselect_b32 s25, 200000, s25
    s_cbranch_scc1 go_110
    s_branch gl_109
go_110:
    v_mfma_f32_16x16x32_bf16 v[40:43], a[16:19], v[32:35], v[40:43]
    v_mfma_f32_16x16x32_bf16 v[44:47], a[20:23], v[32:35], v[44:47]
    v_mfma_f32_16x16x32_bf16 v[56:59], a[80:83], v[32:35], v[56:59]
    v_mfma_f32_16x16x32_bf16 v[60:63], a[84:87], v[32:35], v[60:63]
    v_mfma_f32_16x16x32_bf16 v[48:51], a[48:51], v[32:35], v[48:51]
    v_mfma_f32_16x16x32_bf16 v[52:55], a[52:55], v[32:35], v[52:55]
    v_mfma_f32_16x16x32_bf16 v[64:67], a[112:115], v[32:35], v[64:67]
    v_mfma_f32_16x16x32_bf16 v[68:71], a[116:119], v[32:35], v[68:71]
gd_108:
    s_cmp_eq_u64 s[92:93], 0
    s_cbranch_scc1 gd_111
gl_112:
    v_max3_u32 v19, v36, v37, v38
    v_max_u32 v19, v19, v39
    v_cmp_eq_u32 vcc, -1, v19
    s_nop 0
    s_cbranch_vccz go_113
    s_mov_b64 s[92:93], vcc
    s_waitcnt vmcnt(2)
    s_mov_b64 exec, s[92:93]
    buffer_load_dwordx4 v[36:39], v2, s[4:7], s16 offen offset:3072 sc1
    s_mov_b64 exec, -1
    s_add_u32 s23, s23, 1
    s_cmp_ge_u32 s23, 200000
    s_cselect_b32 s25, 200000, s25
    s_cbranch_scc1 go_113
    s_branch gl_112
go_113:
    v_mfma_f32_16x16x32_bf16 v[40:43], a[24:27], v[36:39], v[40:43]
    v_mfma_f32_16x16x32_bf16 v[44:47], a[28:31], v[36:39], v[44:47]
    v_mfma_f32_16x16x32_bf16 v[56:59], a[88:91], v[36:39], v[56:59]
    v_mfma_f32_16x16x32_bf16 v[60:63], a[92:95], v[36:39], v[60:63]
    v_mfma_f32_16x16x32_bf16 v[48:51], a[56:59], v[36:39], v[48:51]
    v_mfma_f32_16x16x32_bf16 v[52:55], a[60:63], v[36:39], v[52:55]
    v_mfma_f32_16x16x32_bf16 v[64:67], a[120:123], v[36:39], v[64:67]
    v_mfma_f32_16x16x32_bf16 v[68:71], a[124:127], v[36:39], v[68:71]
gd_111:
    s_branch gc_94
gs_96:
    s_mov_b64 s[88:89], vcc
    s_mov_b64 exec, s[88:89]
    buffer_load_dwordx4 v[28:31], v2, s[4:7], s16 offen offset:1024 sc1
    s_mov_b64 exec, -1
    s_waitcnt vmcnt(1)
    v_max3_u32 v19, v32, v33, v34
    v_max_u32 v19, v19, v35
    v_cmp_eq_u32 s[90:91], -1, v19
    v_max3_u32 v19, v36, v37, v38
    v_max_u32 v19, v19, v39
    v_cmp_eq_u32 s[92:93], -1, v19
    s_mov_b64 exec, s[90:91]
    buffer_load_dwordx4 v[32:35], v2, s[4:7], s16 offen offset:2048 sc1
    s_mov_b64 exec, s[92:93]
    buffer_load_dwordx4 v[36:39], v2, s[4:7], s16 offen offset:3072 sc1
    s_mov_b64 exec, -1
    s_cmp_lg_u64 s[90:91], 0
    s_cbranch_scc1 gk_114
    v_mfma_f32_16x16x32_bf16 v[40:43], a[16:19], v[32:35], v[40:43]
    v_mfma_f32_16x16x32_bf16 v[44:47], a[20:23], v[32:35], v[44:47]
    v_mfma_f32_16x16x32_bf16 v[56:59], a[80:83], v[32:35], v[56:59]
    v_mfma_f32_16x16x32_bf16 v[60:63], a[84:87], v[32:35], v[60:63]
    v_mfma_f32_16x16x32_bf16 v[48:51], a[48:51], v[32:35], v[48:51]
    v_mfma_f32_16x16x32_bf16 v[52:55], a[52:55], v[32:35], v[52:55]
    v_mfma_f32_16x16x32_bf16 v[64:67], a[112:115], v[32:35], v[64:67]
    v_mfma_f32_16x16x32_bf16 v[68:71], a[116:119], v[32:35], v[68:71]
    s_mov_b64 exec, s[88:89]
    buffer_load_dwordx4 v[28:31], v2, s[4:7], s16 offen offset:1024 sc1
    s_mov_b64 exec, s[92:93]
    buffer_load_dwordx4 v[36:39], v2, s[4:7], s16 offen offset:3072 sc1
    s_mov_b64 exec, -1
gk_114:
    s_cmp_lg_u64 s[92:93], 0
    s_cbranch_scc1 gk_115
    v_mfma_f32_16x16x32_bf16 v[40:43], a[24:27], v[36:39], v[40:43]
    v_mfma_f32_16x16x32_bf16 v[44:47], a[28:31], v[36:39], v[44:47]
    v_mfma_f32_16x16x32_bf16 v[56:59], a[88:91], v[36:39], v[56:59]
    v_mfma_f32_16x16x32_bf16 v[60:63], a[92:95], v[36:39], v[60:63]
    v_mfma_f32_16x16x32_bf16 v[48:51], a[56:59], v[36:39], v[48:51]
    v_mfma_f32_16x16x32_bf16 v[52:55], a[60:63], v[36:39], v[52:55]
    v_mfma_f32_16x16x32_bf16 v[64:67], a[120:123], v[36:39], v[64:67]
    v_mfma_f32_16x16x32_bf16 v[68:71], a[124:127], v[36:39], v[68:71]
    s_mov_b64 exec, s[88:89]
    buffer_load_dwordx4 v[28:31], v2, s[4:7], s16 offen offset:1024 sc1
    s_mov_b64 exec, s[90:91]
    buffer_load_dwordx4 v[32:35], v2, s[4:7], s16 offen offset:2048 sc1
    s_mov_b64 exec, -1
gk_115:
gl_117:
    v_max3_u32 v19, v28, v29, v30
    v_max_u32 v19, v19, v31
    v_cmp_eq_u32 vcc, -1, v19
    s_nop 0
    s_cbranch_vccz go_118
    s_mov_b64 s[88:89], vcc
    s_waitcnt vmcnt(6)
    s_mov_b64 exec, s[88:89]
    buffer_load_dwordx4 v[28:31], v2, s[4:7], s16 offen offset:1024 sc1
    s_mov_b64 exec, s[90:91]
    buffer_load_dwordx4 v[32:35], v2, s[4:7], s16 offen offset:2048 sc1
    s_mov_b64 exec, s[92:93]
    buffer_load_dwordx4 v[36:39], v2, s[4:7], s16 offen offset:3072 sc1
    s_mov_b64 exec, -1
    s_add_u32 s23, s23, 1
    s_cmp_ge_u32 s23, 200000
    s_cselect_b32 s25, 200000, s25
    s_cbranch_scc1 go_118
    s_branch gl_117
go_118:
    v_mfma_f32_16x16x32_bf16 v[40:43], a[8:11], v[28:31], v[40:43]
    v_mfma_f32_16x16x32_bf16 v[44:47], a[12:15], v[28:31], v[44:47]
    v_mfma_f32_16x16x32_bf16 v[56:59], a[72:75], v[28:31], v[56:59]
    v_mfma_f32_16x16x32_bf16 v[60:63], a[76:79], v[28:31], v[60:63]
    v_mfma_f32_16x16x32_bf16 v[48:51], a[40:43], v[28:31], v[48:51]
    v_mfma_f32_16x16x32_bf16 v[52:55], a[44:47], v[28:31], v[52:55]
    v_mfma_f32_16x16x32_bf16 v[64:67], a[104:107], v[28:31], v[64:67]
    v_mfma_f32_16x16x32_bf16 v[68:71], a[108:111], v[28:31], v[68:71]
gd_116:
    s_cmp_eq_u64 s[90:91], 0
    s_cbranch_scc1 gd_119
gl_120:
    v_max3_u32 v19, v32, v33, v34
    v_max_u32 v19, v19, v35
    v_cmp_eq_u32 vcc, -1, v19
    s_nop 0
    s_cbranch_vccz go_121
    s_mov_b64 s[90:91], vcc
    s_waitcnt vmcnt(4)
    s_mov_b64 exec, s[90:91]
    buffer_load_dwordx4 v[32:35], v2, s[4:7], s16 offen offset:2048 sc1
    s_mov_b64 exec, s[92:93]
    buffer_load_dwordx4 v[36:39], v2, s[4:7], s16 offen offset:3072 sc1
    s_mov_b64 exec, -1
    s_add_u32 s23, s23, 1
    s_cmp_ge_u32 s23, 200000
    s_cselect_b32 s25, 200000, s25
    s_cbranch_scc1 go_121
    s_branch gl_120
go_121:
    v_mfma_f32_16x16x32_bf16 v[40:43], a[16:19], v[32:35], v[40:43]
    v_mfma_f32_16x16x32_bf16 v[44:47], a[20:23], v[32:35], v[44:47]
    v_mfma_f32_16x16x32_bf16 v[56:59], a[80:83], v[32:35], v[56:59]
    v_mfma_f32_16x16x32_bf16 v[60:63], a[84:87], v[32:35], v[60:63]
    v_mfma_f32_16x16x32_bf16 v[48:51], a[48:51], v[32:35], v[48:51]
    v_mfma_f32_16x16x32_bf16 v[52:55], a[52:55], v[32:35], v[52:55]
    v_mfma_f32_16x16x32_bf16 v[64:67], a[112:115], v[32:35], v[64:67]
    v_mfma_f32_16x16x32_bf16 v[68:71], a[116:119], v[32:35], v[68:71]
gd_119:
    s_cmp_eq_u64 s[92:93], 0
    s_cbranch_scc1 gd_122
gl_123:
    v_max3_u32 v19, v36, v37, v38
    v_max_u32 v19, v19, v39
    v_cmp_eq_u32 vcc, -1, v19
    s_nop 0
    s_cbranch_vccz go_124
    s_mov_b64 s[92:93], vcc
    s_waitcnt vmcnt(2)
    s_mov_b64 exec, s[92:93]
    buffer_load_dwordx4 v[36:39], v2, s[4:7], s16 offen offset:3072 sc1
    s_mov_b64 exec, -1
    s_add_u32 s23, s23, 1
    s_cmp_ge_u32 s23, 200000
    s_cselect_b32 s25, 200000, s25
    s_cbranch_scc1 go_124
    s_branch gl_123
go_124:
    v_mfma_f32_16x16x32_bf16 v[40:43], a[24:27], v[36:39], v[40:43]
    v_mfma_f32_16x16x32_bf16 v[44:47], a[28:31], v[36:39], v[44:47]
    v_mfma_f32_16x16x32_bf16 v[56:59], a[88:91], v[36:39], v[56:59]
    v_mfma_f32_16x16x32_bf16 v[60:63], a[92:95], v[36:39], v[60:63]
    v_mfma_f32_16x16x32_bf16 v[48:51], a[56:59], v[36:39], v[48:51]
    v_mfma_f32_16x16x32_bf16 v[52:55], a[60:63], v[36:39], v[52:55]
    v_mfma_f32_16x16x32_bf16 v[64:67], a[120:123], v[36:39], v[64:67]
    v_mfma_f32_16x16x32_bf16 v[68:71], a[124:127], v[36:39], v[68:71]
gd_122:
    s_branch gc_94
gs_97:
    s_mov_b64 s[90:91], vcc
    s_mov_b64 exec, s[90:91]
    buffer_load_dwordx4 v[32:35], v2, s[4:7], s16 offen offset:2048 sc1
    s_mov_b64 exec, -1
    s_waitcnt vmcnt(1)
    v_max3_u32 v19, v36, v37, v38
    v_max_u32 v19, v19, v39
    v_cmp_eq_u32 s[92:93], -1, v19
    s_nop 0
    s_mov_b64 exec, s[92:93]
    buffer_load_dwordx4 v[36:39], v2, s[4:7], s16 offen offset:3072 sc1
    s_mov_b64 exec, -1
    s_cmp_lg_u64 s[92:93], 0
    s_cbranch_scc1 gk_125
    v_mfma_f32_16x16x32_bf16 v[40:43], a[24:27], v[36:39], v[40:43]
    v_mfma_f32_16x16x32_bf16 v[44:47], a[28:31], v[36:39], v[44:47]
    v_mfma_f32_16x16x32_bf16 v[56:59], a[88:91], v[36:39], v[56:59]
    v_mfma_f32_16x16x32_bf16 v[60:63], a[92:95], v[36:39], v[60:63]
    v_mfma_f32_16x16x32_bf16 v[48:51], a[56:59], v[36:39], v[48:51]
    v_mfma_f32_16x16x32_bf16 v[52:55], a[60:63], v[36:39], v[52:55]
    v_mfma_f32_16x16x32_bf16 v[64:67], a[120:123], v[36:39], v[64:67]
    v_mfma_f32_16x16x32_bf16 v[68:71], a[124:127], v[36:39], v[68:71]
    s_mov_b64 exec, s[90:91]
    buffer_load_dwordx4 v[32:35], v2, s[4:7], s16 offen offset:2048 sc1
    s_mov_b64 exec, -1
gk_125:
gl_127:
    v_max3_u32 v19, v32, v33, v34
    v_max_u32 v19, v19, v35
    v_cmp_eq_u32 vcc, -1, v19
    s_nop 0
    s_cbranch_vccz go_128
    s_mov_b64 s[90:91], vcc
    s_waitcnt vmcnt(4)
    s_mov_b64 exec, s[90:91]
    buffer_load_dwordx4 v[32:35], v2, s[4:7], s16 offen offset:2048 sc1
    s_mov_b64 exec, s[92:93]
    buffer_load_dwordx4 v[36:39], v2, s[4:7], s16 offen offset:3072 sc1
    s_mov_b64 exec, -1
    s_add_u32 s23, s23, 1
    s_cmp_ge_u32 s23, 200000
    s_cselect_b32 s25, 200000, s25
    s_cbranch_scc1 go_128
    s_branch gl_127
go_128:
    v_mfma_f32_16x16x32_bf16 v[40:43], a[16:19], v[32:35], v[40:43]
    v_mfma_f32_16x16x32_bf16 v[44:47], a[20:23], v[32:35], v[44:47]
    v_mfma_f32_16x16x32_bf16 v[56:59], a[80:83], v[32:35], v[56:59]
    v_mfma_f32_16x16x32_bf16 v[60:63], a[84:87], v[32:35], v[60:63]
    v_mfma_f32_16x16x32_bf16 v[48:51], a[48:51], v[32:35], v[48:51]
    v_mfma_f32_16x16x32_bf16 v[52:55], a[52:55], v[32:35], v[52:55]
    v_mfma_f32_16x16x32_bf16 v[64:67], a[112:115], v[32:35], v[64:67]
    v_mfma_f32_16x16x32_bf16 v[68:71], a[116:119], v[32:35], v[68:71]
gd_126:
    s_cmp_eq_u64 s[92:93], 0
    s_cbranch_scc1 gd_129
gl_130:
    v_max3_u32 v19, v36, v37, v38
    v_max_u32 v19, v19, v39
    v_cmp_eq_u32 vcc, -1, v19
    s_nop 0
    s_cbranch_vccz go_131
    s_mov_b64 s[92:93], vcc
    s_waitcnt vmcnt(2)
    s_mov_b64 exec, s[92:93]
    buffer_load_dwordx4 v[36:39], v2, s[4:7], s16 offen offset:3072 sc1
    s_mov_b64 exec, -1
    s_add_u32 s23, s23, 1
    s_cmp_ge_u32 s23, 200000
    s_cselect_b32 s25, 200000, s25
    s_cbranch_scc1 go_131
    s_branch gl_130
go_131:
    v_mfma_f32_16x16x32_bf16 v[40:43], a[24:27], v[36:39], v[40:43]
    v_mfma_f32_16x16x32_bf16 v[44:47], a[28:31], v[36:39], v[44:47]
    v_mfma_f32_16x16x32_bf16 v[56:59], a[88:91], v[36:39], v[56:59]
    v_mfma_f32_16x16x32_bf16 v[60:63], a[92:95], v[36:39], v[60:63]
    v_mfma_f32_16x16x32_bf16 v[48:51], a[56:59], v[36:39], v[48:51]
    v_mfma_f32_16x16x32_bf16 v[52:55], a[60:63], v[36:39], v[52:55]
    v_mfma_f32_16x16x32_bf16 v[64:67], a[120:123], v[36:39], v[64:67]
    v_mfma_f32_16x16x32_bf16 v[68:71], a[124:127], v[36:39], v[68:71]
gd_129:
    s_branch gc_94
gs_98:
    s_mov_b64 s[92:93], vcc
    s_mov_b64 exec, s[92:93]
    buffer_load_dwordx4 v[36:39], v2, s[4:7], s16 offen offset:3072 sc1
    s_mov_b64 exec, -1
gl_133:
    v_max3_u32 v19, v36, v37, v38
    v_max_u32 v19, v19, v39
    v_cmp_eq_u32 vcc, -1, v19
    s_nop 0
    s_cbranch_vccz go_134
    s_mov_b64 s[92:93], vcc
    s_waitcnt vmcnt(2)
    s_mov_b64 exec, s[92:93]
    buffer_load_dwordx4 v[36:39], v2, s[4:7], s16 offen offset:3072 sc1
    s_mov_b64 exec, -1
    s_add_u32 s23, s23, 1
    s_cmp_ge_u32 s23, 200000
    s_cselect_b32 s25, 200000, s25
    s_cbranch_scc1 go_134
    s_branch gl_133
go_134:
    v_mfma_f32_16x16x32_bf16 v[40:43], a[24:27], v[36:39], v[40:43]
    v_mfma_f32_16x16x32_bf16 v[44:47], a[28:31], v[36:39], v[44:47]
    v_mfma_f32_16x16x32_bf16 v[56:59], a[88:91], v[36:39], v[56:59]
    v_mfma_f32_16x16x32_bf16 v[60:63], a[92:95], v[36:39], v[60:63]
    v_mfma_f32_16x16x32_bf16 v[48:51], a[56:59], v[36:39], v[48:51]
    v_mfma_f32_16x16x32_bf16 v[52:55], a[60:63], v[36:39], v[52:55]
    v_mfma_f32_16x16x32_bf16 v[64:67], a[120:123], v[36:39], v[64:67]
    v_mfma_f32_16x16x32_bf16 v[68:71], a[124:127], v[36:39], v[68:71]
gd_132:
    s_branch gc_94
gs_136:
    s_mov_b64 s[86:87], vcc
    s_mov_b64 exec, s[86:87]
    buffer_load_dwordx4 v[208:211], v5, s[4:7], s16 offen offset:0 sc1
    buffer_load_dword v224, v6, s[4:7], s16 offen offset:0 sc1
    s_mov_b64 exec, -1
    s_waitcnt vmcnt(2)
    v_max3_u32 v19, v212, v213, v214
    v_max3_u32 v19, v19, v215, v225
    v_cmp_eq_u32 s[88:89], -1, v19
    v_max3_u32 v19, v216, v217, v218
    v_max3_u32 v19, v19, v219, v226
    v_cmp_eq_u32 s[90:91], -1, v19
    v_max3_u32 v19, v220, v221, v222
    v_max3_u32 v19, v19, v223, v227
    v_cmp_eq_u32 s[92:93], -1, v19
    s_mov_b64 exec, s[88:89]
    buffer_load_dwordx4 v[212:215], v5, s[4:7], s16 offen offset:1024 sc1
    buffer_load_dword v225, v6, s[4:7], s16 offen offset:256 sc1
    s_mov_b64 exec, s[90:91]
    buffer_load_dwordx4 v[216:219], v5, s[4:7], s16 offen offset:2048 sc1
    buffer_load_dword v226, v6, s[4:7], s16 offen offset:512 sc1
    s_mov_b64 exec, s[92:93]
    buffer_load_dwordx4 v[220:223], v5, s[4:7], s16 offen offset:3072 sc1
    buffer_load_dword v227, v6, s[4:7], s16 offen offset:768 sc1
    s_mov_b64 exec, -1
gl_141:
    v_max3_u32 v19, v208, v209, v210
    v_max3_u32 v19, v19, v211, v224
    v_cmp_eq_u32 vcc, -1, v19
    s_nop 0
    s_cbranch_vccz go_142
    s_mov_b64 s[86:87], vcc
    s_waitcnt vmcnt(16)
    s_mov_b64 exec, s[86:87]
    buffer_load_dwordx4 v[208:211], v5, s[4:7], s16 offen offset:0 sc1
    buffer_load_dword v224, v6, s[4:7], s16 offen offset:0 sc1
    s_mov_b64 exec, s[88:89]
    buffer_load_dwordx4 v[212:215], v5, s[4:7], s16 offen offset:1024 sc1
    buffer_load_dword v225, v6, s[4:7], s16 offen offset:256 sc1
    s_mov_b64 exec, s[90:91]
    buffer_load_dwordx4 v[216:219], v5, s[4:7], s16 offen offset:2048 sc1
    buffer_load_dword v226, v6, s[4:7], s16 offen offset:512 sc1
    s_mov_b64 exec, s[92:93]
    buffer_load_dwordx4 v[220:223], v5, s[4:7], s16 offen offset:3072 sc1
    buffer_load_dword v227, v6, s[4:7], s16 offen offset:768 sc1
    s_mov_b64 exec, -1
    s_add_u32 s23, s23, 1
    s_cmp_ge_u32 s23, 200000
    s_cselect_b32 s25, 200000, s25
    s_cbranch_scc1 go_142
    s_branch gl_141
go_142:
gd_140:
    s_cmp_eq_u64 s[88:89], 0
    s_cbranch_scc1 gd_143
gl_144:
    v_max3_u32 v19, v212, v213, v214
    v_max3_u32 v19, v19, v215, v225
    v_cmp_eq_u32 vcc, -1, v19
    s_nop 0
    s_cbranch_vccz go_145
    s_mov_b64 s[88:89], vcc
    s_waitcnt vmcnt(12)
    s_mov_b64 exec, s[88:89]
    buffer_load_dwordx4 v[212:215], v5, s[4:7], s16 offen offset:1024 sc1
    buffer_load_dword v225, v6, s[4:7], s16 offen offset:256 sc1
    s_mov_b64 exec, s[90:91]
    buffer_load_dwordx4 v[216:219], v5, s[4:7], s16 offen offset:2048 sc1
    buffer_load_dword v226, v6, s[4:7], s16 offen offset:512 sc1
    s_mov_b64 exec, s[92:93]
    buffer_load_dwordx4 v[220:223], v5, s[4:7], s16 offen offset:3072 sc1
    buffer_load_dword v227, v6, s[4:7], s16 offen offset:768 sc1
    s_mov_b64 exec, -1
    s_add_u32 s23, s23, 1
    s_cmp_ge_u32 s23, 200000
    s_cselect_b32 s25, 200000, s25
    s_cbranch_scc1 go_145
    s_branch gl_144
go_145:
gd_143:
    s_cmp_eq_u64 s[90:91], 0
    s_cbranch_scc1 gd_146
gl_147:
    v_max3_u32 v19, v216, v217, v218
    v_max3_u32 v19, v19, v219, v226
    v_cmp_eq_u32 vcc, -1, v19
    s_nop 0
    s_cbranch_vccz go_148
    s_mov_b64 s[90:91], vcc
    s_waitcnt vmcnt(8)
    s_mov_b64 exec, s[90:91]
    buffer_load_dwordx4 v[216:219], v5, s[4:7], s16 offen offset:2048 sc1
    buffer_load_dword v226, v6, s[4:7], s16 offen offset:512 sc1
    s_mov_b64 exec, s[92:93]
    buffer_load_dwordx4 v[220:223], v5, s[4:7], s16 offen offset:3072 sc1
    buffer_load_dword v227, v6, s[4:7], s16 offen offset:768 sc1
    s_mov_b64 exec, -1
    s_add_u32 s23, s23, 1
    s_cmp_ge_u32 s23, 200000
    s_cselect_b32 s25, 200000, s25
    s_cbranch_scc1 go_148
    s_branch gl_147
go_148:
gd_146:
    s_cmp_eq_u64 s[92:93], 0
    s_cbranch_scc1 gd_149
gl_150:
    v_max3_u32 v19, v220, v221, v222
    v_max3_u32 v19, v19, v223, v227
    v_cmp_eq_u32 vcc, -1, v19
    s_nop 0
    s_cbranch_vccz go_151
    s_mov_b64 s[92:93], vcc
    s_waitcnt vmcnt(4)
    s_mov_b64 exec, s[92:93]
    buffer_load_dwordx4 v[220:223], v5, s[4:7], s16 offen offset:3072 sc1
    buffer_load_dword v227, v6, s[4:7], s16 offen offset:768 sc1
    s_mov_b64 exec, -1
    s_add_u32 s23, s23, 1
    s_cmp_ge_u32 s23, 200000
    s_cselect_b32 s25, 200000, s25
    s_cbranch_scc1 go_151
    s_branch gl_150
go_151:
gd_149:
    s_branch gc_135
gs_137:
    s_mov_b64 s[88:89], vcc
    s_mov_b64 exec, s[88:89]
    buffer_load_dwordx4 v[212:215], v5, s[4:7], s16 offen offset:1024 sc1
    buffer_load_dword v225, v6, s[4:7], s16 offen offset:256 sc1
    s_mov_b64 exec, -1
    s_waitcnt vmcnt(2)
    v_max3_u32 v19, v216, v217, v218
    v_max3_u32 v19, v19, v219, v226
    v_cmp_eq_u32 s[90:91], -1, v19
    v_max3_u32 v19, v220, v221, v222
    v_max3_u32 v19, v19, v223, v227
    v_cmp_eq_u32 s[92:93], -1, v19
    s_mov_b64 exec, s[90:91]
    buffer_load_dwordx4 v[216:219], v5, s[4:7], s16 offen offset:2048 sc1
    buffer_load_dword v226, v6, s[4:7], s16 offen offset:512 sc1
    s_mov_b64 exec, s[92:93]
    buffer_load_dwordx4 v[220:223], v5, s[4:7], s16 offen offset:3072 sc1
    buffer_load_dword v227, v6, s[4:7], s16 offen offset:768 sc1
    s_mov_b64 exec, -1
gl_153:
    v_max3_u32 v19, v212, v213, v214
    v_max3_u32 v19, v19, v215, v225
    v_cmp_eq_u32 vcc, -1, v19
    s_nop 0
    s_cbranch_vccz go_154
    s_mov_b64 s[88:89], vcc
    s_waitcnt vmcnt(12)
    s_mov_b64 exec, s[88:89]
    buffer_load_dwordx4 v[212:215], v5, s[4:7], s16 offen offset:1024 sc1
    buffer_load_dword v225, v6, s[4:7], s16 offen offset:256 sc1
    s_mov_b64 exec, s[90:91]
    buffer_load_dwordx4 v[216:219], v5, s[4:7], s16 offen offset:2048 sc1
    buffer_load_dword v226, v6, s[4:7], s16 offen offset:512 sc1
    s_mov_b64 exec, s[92:93]
    buffer_load_dwordx4 v[220:223], v5, s[4:7], s16 offen offset:3072 sc1
    buffer_load_dword v227, v6, s[4:7], s16 offen offset:768 sc1
    s_mov_b64 exec, -1
    s_add_u32 s23, s23, 1
    s_cmp_ge_u32 s23, 200000
    s_cselect_b32 s25, 200000, s25
    s_cbranch_scc1 go_154
    s_branch gl_153
go_154:
gd_152:
    s_cmp_eq_u64 s[90:91], 0
    s_cbranch_scc1 gd_155
gl_156:
    v_max3_u32 v19, v216, v217, v218
    v_max3_u32 v19, v19, v219, v226
    v_cmp_eq_u32 vcc, -1, v19
    s_nop 0
    s_cbranch_vccz go_157
    s_mov_b64 s[90:91], vcc
    s_waitcnt vmcnt(8)
    s_mov_b64 exec, s[90:91]
    buffer_load_dwordx4 v[216:219], v5, s[4:7], s16 offen offset:2048 sc1
    buffer_load_dword v226, v6, s[4:7], s16 offen offset:512 sc1
    s_mov_b64 exec, s[92:93]
    buffer_load_dwordx4 v[220:223], v5, s[4:7], s16 offen offset:3072 sc1
    buffer_load_dword v227, v6, s[4:7], s16 offen offset:768 sc1
    s_mov_b64 exec, -1
    s_add_u32 s23, s23, 1
    s_cmp_ge_u32 s23, 200000
    s_cselect_b32 s25, 200000, s25
    s_cbranch_scc1 go_157
    s_branch gl_156
go_157:
gd_155:
    s_cmp_eq_u64 s[92:93], 0
    s_cbranch_scc1 gd_158
gl_159:
    v_max3_u32 v19, v220, v221, v222
    v_max3_u32 v19, v19, v223, v227
    v_cmp_eq_u32 vcc, -1, v19
    s_nop 0
    s_cbranch_vccz go_160
    s_mov_b64 s[92:93], vcc
    s_waitcnt vmcnt(4)
    s_mov_b64 exec, s[92:93]
    buffer_load_dwordx4 v[220:223], v5, s[4:7], s16 offen offset:3072 sc1
    buffer_load_dword v227, v6, s[4:7], s16 offen offset:768 sc1
    s_mov_b64 exec, -1
    s_add_u32 s23, s23, 1
    s_cmp_ge_u32 s23, 200000
    s_cselect_b32 s25, 200000, s25
    s_cbranch_scc1 go_160
    s_branch gl_159
go_160:
gd_158:
    s_branch gc_135
gs_138:
    s_mov_b64 s[90:91], vcc
    s_mov_b64 exec, s[90:91]
    buffer_load_dwordx4 v[216:219], v5, s[4:7], s16 offen offset:2048 sc1
    buffer_load_dword v226, v6, s[4:7], s16 offen offset:512 sc1
    s_mov_b64 exec, -1
    s_waitcnt vmcnt(2)
    v_max3_u32 v19, v220, v221, v222
    v_max3_u32 v19, v19, v223, v227
    v_cmp_eq_u32 s[92:93], -1, v19
    s_nop 0
    s_mov_b64 exec, s[92:93]
    buffer_load_dwordx4 v[220:223], v5, s[4:7], s16 offen offset:3072 sc1
    buffer_load_dword v227, v6, s[4:7], s16 offen offset:768 sc1
    s_mov_b64 exec, -1
gl_162:
    v_max3_u32 v19, v216, v217, v218
    v_max3_u32 v19, v19, v219, v226
    v_cmp_eq_u32 vcc, -1, v19
    s_nop 0
    s_cbranch_vccz go_163
    s_mov_b64 s[90:91], vcc
    s_waitcnt vmcnt(8)
    s_mov_b64 exec, s[90:91]
    buffer_load_dwordx4 v[216:219], v5, s[4:7], s16 offen offset:2048 sc1
    buffer_load_dword v226, v6, s[4:7], s16 offen offset:512 sc1
    s_mov_b64 exec, s[92:93]
    buffer_load_dwordx4 v[220:223], v5, s[4:7], s16 offen offset:3072 sc1
    buffer_load_dword v227, v6, s[4:7], s16 offen offset:768 sc1
    s_mov_b64 exec, -1
    s_add_u32 s23, s23, 1
    s_cmp_ge_u32 s23, 200000
    s_cselect_b32 s25, 200000, s25
    s_cbranch_scc1 go_163
    s_branch gl_162
go_163:
gd_161:
    s_cmp_eq_u64 s[92:93], 0
    s_cbranch_scc1 gd_164
gl_165:
    v_max3_u32 v19, v220, v221, v222
    v_max3_u32 v19, v19, v223, v227
    v_cmp_eq_u32 vcc, -1, v19
    s_nop 0
    s_cbranch_vccz go_166
    s_mov_b64 s[92:93], vcc
    s_waitcnt vmcnt(4)
    s_mov_b64 exec, s[92:93]
    buffer_load_dwordx4 v[220:223], v5, s[4:7], s16 offen offset:3072 sc1
    buffer_load_dword v227, v6, s[4:7], s16 offen offset:768 sc1
    s_mov_b64 exec, -1
    s_add_u32 s23, s23, 1
    s_cmp_ge_u32 s23, 200000
    s_cselect_b32 s25, 200000, s25
    s_cbranch_scc1 go_166
    s_branch gl_165
go_166:
gd_164:
    s_branch gc_135
gs_139:
    s_mov_b64 s[92:93], vcc
    s_mov_b64 exec, s[92:93]
    buffer_load_dwordx4 v[220:223], v5, s[4:7], s16 offen offset:3072 sc1
    buffer_load_dword v227, v6, s[4:7], s16 offen offset:768 sc1
    s_mov_b64 exec, -1
gl_168:
    v_max3_u32 v19, v220, v221, v222
    v_max3_u32 v19, v19, v223, v227
    v_cmp_eq_u32 vcc, -1, v19
    s_nop 0
    s_cbranch_vccz go_169
    s_mov_b64 s[92:93], vcc
    s_waitcnt vmcnt(4)
    s_mov_b64 exec, s[92:93]
    buffer_load_dwordx4 v[220:223], v5, s[4:7], s16 offen offset:3072 sc1
    buffer_load_dword v227, v6, s[4:7], s16 offen offset:768 sc1
    s_mov_b64 exec, -1
    s_add_u32 s23, s23, 1
    s_cmp_ge_u32 s23, 200000
    s_cselect_b32 s25, 200000, s25
    s_cbranch_scc1 go_169
    s_branch gl_168
go_169:
gd_167:
    s_branch gc_135
gs_171:
    s_mov_b64 s[86:87], vcc
    s_mov_b64 exec, s[86:87]
    buffer_load_dwordx4 v[24:27], v8, s[4:7], s16 offen offset:0 sc1
    s_mov_b64 exec, -1
    s_waitcnt vmcnt(1)
    v_max3_u32 v19, v28, v29, v30
    v_max_u32 v19, v19, v31
    v_cmp_eq_u32 s[88:89], -1, v19
    v_max3_u32 v19, v32, v33, v34
    v_max_u32 v19, v19, v35
    v_cmp_eq_u32 s[90:91], -1, v19
    v_max3_u32 v19, v36, v37, v38
    v_max_u32 v19, v19, v39
    v_cmp_eq_u32 s[92:93], -1, v19
    s_mov_b64 exec, s[88:89]
    buffer_load_dwordx4 v[28:31], v8, s[4:7], s16 offen offset:1024 sc1
    s_mov_b64 exec, s[90:91]
    buffer_load_dwordx4 v[32:35], v8, s[4:7], s16 offen offset:2048 sc1
    s_mov_b64 exec, s[92:93]
    buffer_load_dwordx4 v[36:39], v8, s[4:7], s16 offen offset:3072 sc1
    s_mov_b64 exec, -1
    s_cmp_lg_u64 s[88:89], 0
    s_cbranch_scc1 gk_175
    v_mfma_f32_16x16x32_bf16 v[40:43], a[200:203], v[28:31], v[40:43]
    v_mfma_f32_16x16x32_bf16 v[44:47], a[204:207], v[28:31], v[44:47]
    v_mfma_f32_16x16x32_bf16 v[48:51], a[232:235], v[28:31], v[48:51]
    v_mfma_f32_16x16x32_bf16 v[52:55], a[236:239], v[28:31], v[52:55]
    s_mov_b64 exec, s[86:87]
    buffer_load_dwordx4 v[24:27], v8, s[4:7], s16 offen offset:0 sc1
    s_mov_b64 exec, s[90:91]
    buffer_load_dwordx4 v[32:35], v8, s[4:7], s16 offen offset:2048 sc1
    s_mov_b64 exec, s[92:93]
    buffer_load_dwordx4 v[36:39], v8, s[4:7], s16 offen offset:3072 sc1
    s_mov_b64 exec, -1
gk_175:
    s_cmp_lg_u64 s[90:91], 0
    s_cbranch_scc1 gk_176
    v_mfma_f32_16x16x32_bf16 v[40:43], a[208:211], v[32:35], v[40:43]
    v_mfma_f32_16x16x32_bf16 v[44:47], a[212:215], v[32:35], v[44:47]
    v_mfma_f32_16x16x32_bf16 v[48:51], a[240:243], v[32:35], v[48:51]
    v_mfma_f32_16x16x32_bf16 v[52:55], a[244:247], v[32:35], v[52:55]
    s_mov_b64 exec, s[86:87]
    buffer_load_dwordx4 v[24:27], v8, s[4:7], s16 offen offset:0 sc1
    s_mov_b64 exec, s[88:89]
    buffer_load_dwordx4 v[28:31], v8, s[4:7], s16 offen offset:1024 sc1
    s_mov_b64 exec, s[92:93]
    buffer_load_dwordx4 v[36:39], v8, s[4:7], s16 offen offset:3072 sc1
    s_mov_b64 exec, -1
gk_176:
    s_cmp_lg_u64 s[92:93], 0
    s_cbranch_scc1 gk_177
    v_mfma_f32_16x16x32_bf16 v[40:43], a[216:219], v[36:39], v[40:43]
    v_mfma_f32_16x16x32_bf16 v[44:47], a[220:223], v[36:39], v[44:47]
    v_mfma_f32_16x16x32_bf16 v[48:51], a[248:251], v[36:39], v[48:51]
    v_mfma_f32_16x16x32_bf16 v[52:55], a[252:255], v[36:39], v[52:55]
    s_mov_b64 exec, s[86:87]
    buffer_load_dwordx4 v[24:27], v8, s[4:7], s16 offen offset:0 sc1
    s_mov_b64 exec, s[88:89]
    buffer_load_dwordx4 v[28:31], v8, s[4:7], s16 offen offset:1024 sc1
    s_mov_b64 exec, s[90:91]
    buffer_load_dwordx4 v[32:35], v8, s[4:7], s16 offen offset:2048 sc1
    s_mov_b64 exec, -1
gk_177:
gl_179:
    v_max3_u32 v19, v24, v25, v26
    v_max_u32 v19, v19, v27
    v_cmp_eq_u32 vcc, -1, v19
    s_nop 0
    s_cbranch_vccz go_180
    s_mov_b64 s[86:87], vcc
    s_waitcnt vmcnt(8)
    s_mov_b64 exec, s[86:87]
    buffer_load_dwordx4 v[24:27], v8, s[4:7], s16 offen offset:0 sc1
    s_mov_b64 exec, s[88:89]
    buffer_load_dwordx4 v[28:31], v8, s[4:7], s16 offen offset:1024 sc1
    s_mov_b64 exec, s[90:91]
    buffer_load_dwordx4 v[32:35], v8, s[4:7], s16 offen offset:2048 sc1
    s_mov_b64 exec, s[92:93]
    buffer_load_dwordx4 v[36:39], v8, s[4:7], s16 offen offset:3072 sc1
    s_mov_b64 exec, -1
    s_add_u32 s23, s23, 1
    s_cmp_ge_u32 s23, 200000
    s_cselect_b32 s25, 200000, s25
    s_cbranch_scc1 go_180
    s_branch gl_179
go_180:
    v_mfma_f32_16x16x32_bf16 v[40:43], a[192:195], v[24:27], v[40:43]
    v_mfma_f32_16x16x32_bf16 v[44:47], a[196:199], v[24:27], v[44:47]
    v_mfma_f32_16x16x32_bf16 v[48:51], a[224:227], v[24:27], v[48:51]
    v_mfma_f32_16x16x32_bf16 v[52:55], a[228:231], v[24:27], v[52:55]
gd_178:
    s_cmp_eq_u64 s[88:89], 0
    s_cbranch_scc1 gd_181
gl_182:
    v_max3_u32 v19, v28, v29, v30
    v_max_u32 v19, v19, v31
    v_cmp_eq_u32 vcc, -1, v19
    s_nop 0
    s_cbranch_vccz go_183
    s_mov_b64 s[88:89], vcc
    s_waitcnt vmcnt(6)
    s_mov_b64 exec, s[88:89]
    buffer_load_dwordx4 v[28:31], v8, s[4:7], s16 offen offset:1024 sc1
    s_mov_b64 exec, s[90:91]
    buffer_load_dwordx4 v[32:35], v8, s[4:7], s16 offen offset:2048 sc1
    s_mov_b64 exec, s[92:93]
    buffer_load_dwordx4 v[36:39], v8, s[4:7], s16 offen offset:3072 sc1
    s_mov_b64 exec, -1
    s_add_u32 s23, s23, 1
    s_cmp_ge_u32 s23, 200000
    s_cselect_b32 s25, 200000, s25
    s_cbranch_scc1 go_183
    s_branch gl_182
go_183:
    v_mfma_f32_16x16x32_bf16 v[40:43], a[200:203], v[28:31], v[40:43]
    v_mfma_f32_16x16x32_bf16 v[44:47], a[204:207], v[28:31], v[44:47]
    v_mfma_f32_16x16x32_bf16 v[48:51], a[232:235], v[28:31], v[48:51]
    v_mfma_f32_16x16x32_bf16 v[52:55], a[236:239], v[28:31], v[52:55]
gd_181:
    s_cmp_eq_u64 s[90:91], 0
    s_cbranch_scc1 gd_184
gl_185:
    v_max3_u32 v19, v32, v33, v34
    v_max_u32 v19, v19, v35
    v_cmp_eq_u32 vcc, -1, v19
    s_nop 0
    s_cbranch_vccz go_186
    s_mov_b64 s[90:91], vcc
    s_waitcnt vmcnt(4)
    s_mov_b64 exec, s[90:91]
    buffer_load_dwordx4 v[32:35], v8, s[4:7], s16 offen offset:2048 sc1
    s_mov_b64 exec, s[92:93]
    buffer_load_dwordx4 v[36:39], v8, s[4:7], s16 offen offset:3072 sc1
    s_mov_b64 exec, -1
    s_add_u32 s23, s23, 1
    s_cmp_ge_u32 s23, 200000
    s_cselect_b32 s25, 200000, s25
    s_cbranch_scc1 go_186
    s_branch gl_185
go_186:
    v_mfma_f32_16x16x32_bf16 v[40:43], a[208:211], v[32:35], v[40:43]
    v_mfma_f32_16x16x32_bf16 v[44:47], a[212:215], v[32:35], v[44:47]
    v_mfma_f32_16x16x32_bf16 v[48:51], a[240:243], v[32:35], v[48:51]
    v_mfma_f32_16x16x32_bf16 v[52:55], a[244:247], v[32:35], v[52:55]
gd_184:
    s_cmp_eq_u64 s[92:93], 0
    s_cbranch_scc1 gd_187
gl_188:
    v_max3_u32 v19, v36, v37, v38
    v_max_u32 v19, v19, v39
    v_cmp_eq_u32 vcc, -1, v19
    s_nop 0
    s_cbranch_vccz go_189
    s_mov_b64 s[92:93], vcc
    s_waitcnt vmcnt(2)
    s_mov_b64 exec, s[92:93]
    buffer_load_dwordx4 v[36:39], v8, s[4:7], s16 offen offset:3072 sc1
    s_mov_b64 exec, -1
    s_add_u32 s23, s23, 1
    s_cmp_ge_u32 s23, 200000
    s_cselect_b32 s25, 200000, s25
    s_cbranch_scc1 go_189
    s_branch gl_188
go_189:
    v_mfma_f32_16x16x32_bf16 v[40:43], a[216:219], v[36:39], v[40:43]
    v_mfma_f32_16x16x32_bf16 v[44:47], a[220:223], v[36:39], v[44:47]
    v_mfma_f32_16x16x32_bf16 v[48:51], a[248:251], v[36:39], v[48:51]
    v_mfma_f32_16x16x32_bf16 v[52:55], a[252:255], v[36:39], v[52:55]
gd_187:
    s_branch gc_170
gs_172:
    s_mov_b64 s[88:89], vcc
    s_mov_b64 exec, s[88:89]
    buffer_load_dwordx4 v[28:31], v8, s[4:7], s16 offen offset:1024 sc1
    s_mov_b64 exec, -1
    s_waitcnt vmcnt(1)
    v_max3_u32 v19, v32, v33, v34
    v_max_u32 v19, v19, v35
    v_cmp_eq_u32 s[90:91], -1, v19
    v_max3_u32 v19, v36, v37, v38
    v_max_u32 v19, v19, v39
    v_cmp_eq_u32 s[92:93], -1, v19
    s_mov_b64 exec, s[90:91]
    buffer_load_dwordx4 v[32:35], v8, s[4:7], s16 offen offset:2048 sc1
    s_mov_b64 exec, s[92:93]
    buffer_load_dwordx4 v[36:39], v8, s[4:7], s16 offen offset:3072 sc1
    s_mov_b64 exec, -1
    s_cmp_lg_u64 s[90:91], 0
    s_cbranch_scc1 gk_190
    v_mfma_f32_16x16x32_bf16 v[40:43], a[208:211], v[32:35], v[40:43]
    v_mfma_f32_16x16x32_bf16 v[44:47], a[212:215], v[32:35], v[44:47]
    v_mfma_f32_16x16x32_bf16 v[48:51], a[240:243], v[32:35], v[48:51]
    v_mfma_f32_16x16x32_bf16 v[52:55], a[244:247], v[32:35], v[52:55]
    s_mov_b64 exec, s[88:89]
    buffer_load_dwordx4 v[28:31], v8, s[4:7], s16 offen offset:1024 sc1
    s_mov_b64 exec, s[92:93]
    buffer_load_dwordx4 v[36:39], v8, s[4:7], s16 offen offset:3072 sc1
    s_mov_b64 exec, -1
gk_190:
    s_cmp_lg_u64 s[92:93], 0
    s_cbranch_scc1 gk_191
    v_mfma_f32_16x16x32_bf16 v[40:43], a[216:219], v[36:39], v[40:43]
    v_mfma_f32_16x16x32_bf16 v[44:47], a[220:223], v[36:39], v[44:47]
    v_mfma_f32_16x16x32_bf16 v[48:51], a[248:251], v[36:39], v[48:51]
    v_mfma_f32_16x16x32_bf16 v[52:55], a[252:255], v[36:39], v[52:55]
    s_mov_b64 exec, s[88:89]
    buffer_load_dwordx4 v[28:31], v8, s[4:7], s16 offen offset:1024 sc1
    s_mov_b64 exec, s[90:91]
    buffer_load_dwordx4 v[32:35], v8, s[4:7], s16 offen offset:2048 sc1
    s_mov_b64 exec, -1
gk_191:
gl_193:
    v_max3_u32 v19, v28, v29, v30
    v_max_u32 v19, v19, v31
    v_cmp_eq_u32 vcc, -1, v19
    s_nop 0
    s_cbranch_vccz go_194
    s_mov_b64 s[88:89], vcc
    s_waitcnt vmcnt(6)
    s_mov_b64 exec, s[88:89]
    buffer_load_dwordx4 v[28:31], v8, s[4:7], s16 offen offset:1024 sc1
    s_mov_b64 exec, s[90:91]
    buffer_load_dwordx4 v[32:35], v8, s[4:7], s16 offen offset:2048 sc1
    s_mov_b64 exec, s[92:93]
    buffer_load_dwordx4 v[36:39], v8, s[4:7], s16 offen offset:3072 sc1
    s_mov_b64 exec, -1
    s_add_u32 s23, s23, 1
    s_cmp_ge_u32 s23, 200000
    s_cselect_b32 s25, 200000, s25
    s_cbranch_scc1 go_194
    s_branch gl_193
go_194:
    v_mfma_f32_16x16x32_bf16 v[40:43], a[200:203], v[28:31], v[40:43]
    v_mfma_f32_16x16x32_bf16 v[44:47], a[204:207], v[28:31], v[44:47]
    v_mfma_f32_16x16x32_bf16 v[48:51], a[232:235], v[28:31], v[48:51]
    v_mfma_f32_16x16x32_bf16 v[52:55], a[236:239], v[28:31], v[52:55]
gd_192:
    s_cmp_eq_u64 s[90:91], 0
    s_cbranch_scc1 gd_195
gl_196:
    v_max3_u32 v19, v32, v33, v34
    v_max_u32 v19, v19, v35
    v_cmp_eq_u32 vcc, -1, v19
    s_nop 0
    s_cbranch_vccz go_197
    s_mov_b64 s[90:91], vcc
    s_waitcnt vmcnt(4)
    s_mov_b64 exec, s[90:91]
    buffer_load_dwordx4 v[32:35], v8, s[4:7], s16 offen offset:2048 sc1
    s_mov_b64 exec, s[92:93]
    buffer_load_dwordx4 v[36:39], v8, s[4:7], s16 offen offset:3072 sc1
    s_mov_b64 exec, -1
    s_add_u32 s23, s23, 1
    s_cmp_ge_u32 s23, 200000
    s_cselect_b32 s25, 200000, s25
    s_cbranch_scc1 go_197
    s_branch gl_196
go_197:
    v_mfma_f32_16x16x32_bf16 v[40:43], a[208:211], v[32:35], v[40:43]
    v_mfma_f32_16x16x32_bf16 v[44:47], a[212:215], v[32:35], v[44:47]
    v_mfma_f32_16x16x32_bf16 v[48:51], a[240:243], v[32:35], v[48:51]
    v_mfma_f32_16x16x32_bf16 v[52:55], a[244:247], v[32:35], v[52:55]
gd_195:
    s_cmp_eq_u64 s[92:93], 0
    s_cbranch_scc1 gd_198
gl_199:
    v_max3_u32 v19, v36, v37, v38
    v_max_u32 v19, v19, v39
    v_cmp_eq_u32 vcc, -1, v19
    s_nop 0
    s_cbranch_vccz go_200
    s_mov_b64 s[92:93], vcc
    s_waitcnt vmcnt(2)
    s_mov_b64 exec, s[92:93]
    buffer_load_dwordx4 v[36:39], v8, s[4:7], s16 offen offset:3072 sc1
    s_mov_b64 exec, -1
    s_add_u32 s23, s23, 1
    s_cmp_ge_u32 s23, 200000
    s_cselect_b32 s25, 200000, s25
    s_cbranch_scc1 go_200
    s_branch gl_199
go_200:
    v_mfma_f32_16x16x32_bf16 v[40:43], a[216:219], v[36:39], v[40:43]
    v_mfma_f32_16x16x32_bf16 v[44:47], a[220:223], v[36:39], v[44:47]
    v_mfma_f32_16x16x32_bf16 v[48:51], a[248:251], v[36:39], v[48:51]
    v_mfma_f32_16x16x32_bf16 v[52:55], a[252:255], v[36:39], v[52:55]
gd_198:
    s_branch gc_170
gs_173:
    s_mov_b64 s[90:91], vcc
    s_mov_b64 exec, s[90:91]
    buffer_load_dwordx4 v[32:35], v8, s[4:7], s16 offen offset:2048 sc1
    s_mov_b64 exec, -1
    s_waitcnt vmcnt(1)
    v_max3_u32 v19, v36, v37, v38
    v_max_u32 v19, v19, v39
    v_cmp_eq_u32 s[92:93], -1, v19
    s_nop 0
    s_mov_b64 exec, s[92:93]
    buffer_load_dwordx4 v[36:39], v8, s[4:7], s16 offen offset:3072 sc1
    s_mov_b64 exec, -1
    s_cmp_lg_u64 s[92:93], 0
    s_cbranch_scc1 gk_201
    v_mfma_f32_16x16x32_bf16 v[40:43], a[216:219], v[36:39], v[40:43]
    v_mfma_f32_16x16x32_bf16 v[44:47], a[220:223], v[36:39], v[44:47]
    v_mfma_f32_16x16x32_bf16 v[48:51], a[248:251], v[36:39], v[48:51]
    v_mfma_f32_16x16x32_bf16 v[52:55], a[252:255], v[36:39], v[52:55]
    s_mov_b64 exec, s[90:91]
    buffer_load_dwordx4 v[32:35], v8, s[4:7], s16 offen offset:2048 sc1
    s_mov_b64 exec, -1
gk_201:
gl_203:
    v_max3_u32 v19, v32, v33, v34
    v_max_u32 v19, v19, v35
    v_cmp_eq_u32 vcc, -1, v19
    s_nop 0
    s_cbranch_vccz go_204
    s_mov_b64 s[90:91], vcc
    s_waitcnt vmcnt(4)
    s_mov_b64 exec, s[90:91]
    buffer_load_dwordx4 v[32:35], v8, s[4:7], s16 offen offset:2048 sc1
    s_mov_b64 exec, s[92:93]
    buffer_load_dwordx4 v[36:39], v8, s[4:7], s16 offen offset:3072 sc1
    s_mov_b64 exec, -1
    s_add_u32 s23, s23, 1
    s_cmp_ge_u32 s23, 200000
    s_cselect_b32 s25, 200000, s25
    s_cbranch_scc1 go_204
    s_branch gl_203
go_204:
    v_mfma_f32_16x16x32_bf16 v[40:43], a[208:211], v[32:35], v[40:43]
    v_mfma_f32_16x16x32_bf16 v[44:47], a[212:215], v[32:35], v[44:47]
    v_mfma_f32_16x16x32_bf16 v[48:51], a[240:243], v[32:35], v[48:51]
    v_mfma_f32_16x16x32_bf16 v[52:55], a[244:247], v[32:35], v[52:55]
gd_202:
    s_cmp_eq_u64 s[92:93], 0
    s_cbranch_scc1 gd_205
gl_206:
    v_max3_u32 v19, v36, v37, v38
    v_max_u32 v19, v19, v39
    v_cmp_eq_u32 vcc, -1, v19
    s_nop 0
    s_cbranch_vccz go_207
    s_mov_b64 s[92:93], vcc
    s_waitcnt vmcnt(2)
    s_mov_b64 exec, s[92:93]
    buffer_load_dwordx4 v[36:39], v8, s[4:7], s16 offen offset:3072 sc1
    s_mov_b64 exec, -1
    s_add_u32 s23, s23, 1
    s_cmp_ge_u32 s23, 200000
    s_cselect_b32 s25, 200000, s25
    s_cbranch_scc1 go_207
    s_branch gl_206
go_207:
    v_mfma_f32_16x16x32_bf16 v[40:43], a[216:219], v[36:39], v[40:43]
    v_mfma_f32_16x16x32_bf16 v[44:47], a[220:223], v[36:39], v[44:47]
    v_mfma_f32_16x16x32_bf16 v[48:51], a[248:251], v[36:39], v[48:51]
    v_mfma_f32_16x16x32_bf16 v[52:55], a[252:255], v[36:39], v[52:55]
gd_205:
    s_branch gc_170
gs_174:
    s_mov_b64 s[92:93], vcc
    s_mov_b64 exec, s[92:93]
    buffer_load_dwordx4 v[36:39], v8, s[4:7], s16 offen offset:3072 sc1
    s_mov_b64 exec, -1
gl_209:
    v_max3_u32 v19, v36, v37, v38
    v_max_u32 v19, v19, v39
    v_cmp_eq_u32 vcc, -1, v19
    s_nop 0
    s_cbranch_vccz go_210
    s_mov_b64 s[92:93], vcc
    s_waitcnt vmcnt(2)
    s_mov_b64 exec, s[92:93]
    buffer_load_dwordx4 v[36:39], v8, s[4:7], s16 offen offset:3072 sc1
    s_mov_b64 exec, -1
    s_add_u32 s23, s23, 1
    s_cmp_ge_u32 s23, 200000
    s_cselect_b32 s25, 200000, s25
    s_cbranch_scc1 go_210
    s_branch gl_209
go_210:
    v_mfma_f32_16x16x32_bf16 v[40:43], a[216:219], v[36:39], v[40:43]
    v_mfma_f32_16x16x32_bf16 v[44:47], a[220:223], v[36:39], v[44:47]
    v_mfma_f32_16x16x32_bf16 v[48:51], a[248:251], v[36:39], v[48:51]
    v_mfma_f32_16x16x32_bf16 v[52:55], a[252:255], v[36:39], v[52:55]
gd_208:
    s_branch gc_170
.p2align 6
recur_fast_w2:
    s_sleep 2
    s_mov_b32 s23, s25
    buffer_load_dwordx4 v[24:27], v2, s[4:7], s16 offen offset:0 sc1
    buffer_load_dwordx4 v[28:31], v2, s[4:7], s16 offen offset:1024 sc1
    buffer_load_dwordx4 v[32:35], v2, s[4:7], s16 offen offset:2048 sc1
    buffer_load_dwordx4 v[36:39], v2, s[4:7], s16 offen offset:3072 sc1
    s_waitcnt vmcnt(3)
    v_max3_u32 v19, v24, v25, v26
    v_max_u32 v19, v19, v27
    v_cmp_eq_u32 vcc, -1, v19
    s_nop 0
    s_cbranch_vccnz gs_214
    v_mfma_f32_16x16x32_bf16 v[40:43], a[0:3], v[24:27], v[40:43]
    v_mfma_f32_16x16x32_bf16 v[44:47], a[4:7], v[24:27], v[44:47]
    v_mfma_f32_16x16x32_bf16 v[56:59], a[64:67], v[24:27], v[56:59]
    v_mfma_f32_16x16x32_bf16 v[60:63], a[68:71], v[24:27], v[60:63]
    v_mfma_f32_16x16x32_bf16 v[48:51], a[32:35], v[24:27], v[48:51]
    s_waitcnt vmcnt(2)
    v_max3_u32 v19, v28, v29, v30
    v_mfma_f32_16x16x32_bf16 v[52:55], a[36:39], v[24:27], v[52:55]
    v_max_u32 v19, v19, v31
    v_mfma_f32_16x16x32_bf16 v[64:67], a[96:99], v[24:27], v[64:67]
    v_cmp_eq_u32 vcc, -1, v19
    v_mfma_f32_16x16x32_bf16 v[68:71], a[100:103], v[24:27], v[68:71]
    s_cbranch_vccnz gs_215
    v_mfma_f32_16x16x32_bf16 v[40:43], a[8:11], v[28:31], v[40:43]
    v_mfma_f32_16x16x32_bf16 v[44:47], a[12:15], v[28:31], v[44:47]
    v_mfma_f32_16x16x32_bf16 v[56:59], a[72:75], v[28:31], v[56:59]
    v_mfma_f32_16x16x32_bf16 v[60:63], a[76:79], v[28:31], v[60:63]
    v_mfma_f32_16x16x32_bf16 v[48:51], a[40:43], v[28:31], v[48:51]
    s_waitcnt vmcnt(1)
    v_max3_u32 v19, v32, v33, v34
    v_mfma_f32_16x16x32_bf16 v[52:55], a[44:47], v[28:31], v[52:55]
    v_max_u32 v19, v19, v35
    v_mfma_f32_16x16x32_bf16 v[64:67], a[104:107], v[28:31], v[64:67]
    v_cmp_eq_u32 vcc, -1, v19
    v_mfma_f32_16x16x32_bf16 v[68:71], a[108:111], v[28:31], v[68:71]
    s_cbranch_vccnz gs_216
    v_mfma_f32_16x16x32_bf16 v[40:43], a[16:19], v[32:35], v[40:43]
    v_mfma_f32_16x16x32_bf16 v[44:47], a[20:23], v[32:35], v[44:47]
    v_mfma_f32_16x16x32_bf16 v[56:59], a[80:83], v[32:35], v[56:59]
    v_mfma_f32_16x16x32_bf16 v[60:63], a[84:87], v[32:35], v[60:63]
    v_mfma_f32_16x16x32_bf16 v[48:51], a[48:51], v[32:35], v[48:51]
    s_waitcnt vmcnt(0)
    v_max3_u32 v19, v36, v37, v38
    v_mfma_f32_16x16x32_bf16 v[52:55], a[52:55], v[32:35], v[52:55]
    v_max_u32 v19, v19, v39
    v_mfma_f32_16x16x32_bf16 v[64:67], a[112:115], v[32:35], v[64:67]
    v_cmp_eq_u32 vcc, -1, v19
    v_mfma_f32_16x16x32_bf16 v[68:71], a[116:119], v[32:35], v[68:71]
    s_cbranch_vccnz gs_217
    v_mfma_f32_16x16x32_bf16 v[40:43], a[24:27], v[36:39], v[40:43]
    v_mfma_f32_16x16x32_bf16 v[44:47], a[28:31], v[36:39], v[44:47]
    v_mfma_f32_16x16x32_bf16 v[56:59], a[88:91], v[36:39], v[56:59]
    v_mfma_f32_16x16x32_bf16 v[60:63], a[92:95], v[36:39], v[60:63]
    v_mfma_f32_16x16x32_bf16 v[48:51], a[56:59], v[36:39], v[48:51]
    v_mfma_f32_16x16x32_bf16 v[52:55], a[60:63], v[36:39], v[52:55]
    v_mfma_f32_16x16x32_bf16 v[64:67], a[120:123], v[36:39], v[64:67]
    v_mfma_f32_16x16x32_bf16 v[68:71], a[124:127], v[36:39], v[68:71]
gc_213:
    s_nop 1
    v_add_f32_dpp v88, v44, v40 row_ror:8 row_mask:0xf bank_mask:0x3
    v_add_f32_dpp v89, v45, v41 row_ror:8 row_mask:0xf bank_mask:0x3
    v_add_f32_dpp v90, v46, v42 row_ror:8 row_mask:0xf bank_mask:0x3
    v_add_f32_dpp v91, v47, v43 row_ror:8 row_mask:0xf bank_mask:0x3
    v_add_f32_dpp v88, v56, v60 row_ror:8 row_mask:0xf bank_mask:0xc
    v_add_f32_dpp v89, v57, v61 row_ror:8 row_mask:0xf bank_mask:0xc
    v_add_f32_dpp v90, v58, v62 row_ror:8 row_mask:0xf bank_mask:0xc
    v_add_f32_dpp v91, v59, v63 row_ror:8 row_mask:0xf bank_mask:0xc
    ds_write_b128 v17, v[88:91] offset:0
    v_add_f32_dpp v92, v52, v48 row_ror:8 row_mask:0xf bank_mask:0x3
    v_add_f32_dpp v93, v53, v49 row_ror:8 row_mask:0xf bank_mask:0x3
    v_add_f32_dpp v94, v54, v50 row_ror:8 row_mask:0xf bank_mask:0x3
    v_add_f32_dpp v95, v55, v51 row_ror:8 row_mask:0xf bank_mask:0x3
    v_mfma_f32_16x16x32_bf16 v[72:75], v[24:27], a[128:131], 0
    v_add_f32_dpp v92, v64, v68 row_ror:8 row_mask:0xf bank_mask:0xc
    v_add_f32_dpp v93, v65, v69 row_ror:8 row_mask:0xf bank_mask:0xc
    v_add_f32_dpp v94, v66, v70 row_ror:8 row_mask:0xf bank_mask:0xc
    v_add_f32_dpp v95, v67, v71 row_ror:8 row_mask:0xf bank_mask:0xc
    v_mfma_f32_16x16x32_bf16 v[80:83], v[24:27], a[160:163], 0
    ds_write_b128 v17, v[92:95] offset:1024
    v_mfma_f32_16x16x32_bf16 v[76:79], v[24:27], a[132:135], 0
    v_mfma_f32_16x16x32_bf16 v[84:87], v[24:27], a[164:167], 0
    s_waitcnt lgkmcnt(0)
    s_barrier
    v_mfma_f32_16x16x32_bf16 v[72:75], v[28:31], a[136:139], v[72:75]
    v_mfma_f32_16x16x32_bf16 v[80:83], v[28:31], a[168:171], v[80:83]
    v_mfma_f32_16x16x32_bf16 v[76:79], v[28:31], a[140:143], v[76:79]
    v_mfma_f32_16x16x32_bf16 v[84:87], v[28:31], a[172:175], v[84:87]
    v_mfma_f32_16x16x32_bf16 v[72:75], v[32:35], a[144:147], v[72:75]
    v_mfma_f32_16x16x32_bf16 v[80:83], v[32:35], a[176:179], v[80:83]
    v_mfma_f32_16x16x32_bf16 v[76:79], v[32:35], a[148:151], v[76:79]
    v_mfma_f32_16x16x32_bf16 v[84:87], v[32:35], a[180:183], v[84:87]
    v_mfma_f32_16x16x32_bf16 v[72:75], v[36:39], a[152:155], v[72:75]
    v_mfma_f32_16x16x32_bf16 v[80:83], v[36:39], a[184:187], v[80:83]
    v_mfma_f32_16x16x32_bf16 v[76:79], v[36:39], a[156:159], v[76:79]
    v_mfma_f32_16x16x32_bf16 v[84:87], v[36:39], a[188:191], v[84:87]
    s_nop 6
    v_mov_b32_dpp v72, v76 quad_perm:[0,1,2,3] row_mask:0xc bank_mask:0xf
    v_mov_b32_dpp v73, v77 quad_perm:[0,1,2,3] row_mask:0xc bank_mask:0xf
    v_mov_b32_dpp v74, v78 quad_perm:[0,1,2,3] row_mask:0xc bank_mask:0xf
    v_mov_b32_dpp v75, v79 quad_perm:[0,1,2,3] row_mask:0xc bank_mask:0xf
    ds_write_b128 v17, v[72:75] offset:8192
    v_mov_b32_dpp v80, v84 quad_perm:[0,1,2,3] row_mask:0xc bank_mask:0xf
    v_mov_b32_dpp v81, v85 quad_perm:[0,1,2,3] row_mask:0xc bank_mask:0xf
    v_mov_b32_dpp v82, v86 quad_perm:[0,1,2,3] row_mask:0xc bank_mask:0xf
    v_mov_b32_dpp v83, v87 quad_perm:[0,1,2,3] row_mask:0xc bank_mask:0xf
    ds_write_b128 v17, v[80:83] offset:9216
    v_mov_b32 v40, 0
    v_mov_b32 v41, 0
    v_mov_b32 v42, 0
    v_mov_b32 v43, 0
    v_mov_b32 v44, 0
    v_mov_b32 v45, 0
    v_mov_b32 v46, 0
    v_mov_b32 v47, 0
    v_mov_b32 v48, 0
    v_mov_b32 v49, 0
    v_mov_b32 v50, 0
    v_mov_b32 v51, 0
    v_mov_b32 v52, 0
    v_mov_b32 v53, 0
    v_mov_b32 v54, 0
    v_mov_b32 v55, 0
    s_waitcnt lgkmcnt(0)
    s_barrier
    ds_read_b64 v[96:97], v18 offset:8192
    ds_read_b64 v[98:99], v18 offset:8704
    ds_read_b64 v[100:101], v18 offset:10240
    ds_read_b64 v[102:103], v18 offset:10752
    ds_read_b64 v[104:105], v18 offset:12288
    ds_read_b64 v[106:107], v18 offset:12800
    ds_read_b64 v[108:109], v18 offset:14336
    ds_read_b64 v[110:111], v18 offset:14848
    s_waitcnt lgkmcnt(7)
    ds_read_b64 v[112:113], v18 offset:9216
    ds_read_b64 v[114:115], v18 offset:9728
    ds_read_b64 v[116:117], v18 offset:11264
    ds_read_b64 v[118:119], v18 offset:11776
    ds_read_b64 v[120:121], v18 offset:13312
    ds_read_b64 v[122:123], v18 offset:13824
    ds_read_b64 v[124:125], v18 offset:15360
    ds_read_b64 v[126:127], v18 offset:15872
    s_waitcnt lgkmcnt(8)
    v_add_f32 v96, v96, v104
    v_add_f32 v97, v97, v105
    v_add_f32 v98, v98, v106
    v_add_f32 v99, v99, v107
    v_add_f32 v100, v100, v108
    v_add_f32 v101, v101, v109
    v_add_f32 v102, v102, v110
    v_add_f32 v103, v103, v111
    v_add_f32 v96, v96, v100
    v_add_f32 v97, v97, v101
    v_add_f32 v98, v98, v102
    v_add_f32 v99, v99, v103
    v_add_f32 v96, v96, v98
    v_add_f32 v97, v97, v99
    v_cvt_pk_bf16_f32 v168, v96, v97
    v_and_b32 v140, 0xffff, v168
    v_lshrrev_b32 v141, 16, v168
    s_waitcnt lgkmcnt(0)
    v_add_f32 v112, v112, v120
    v_add_f32 v113, v113, v121
    v_add_f32 v114, v114, v122
    v_add_f32 v115, v115, v123
    v_add_f32 v116, v116, v124
    v_add_f32 v117, v117, v125
    v_add_f32 v118, v118, v126
    v_add_f32 v119, v119, v127
    v_add_f32 v112, v112, v116
    v_add_f32 v113, v113, v117
    v_add_f32 v114, v114, v118
    v_add_f32 v115, v115, v119
    v_add_f32 v112, v112, v114
    v_add_f32 v113, v113, v115
    v_cvt_pk_bf16_f32 v169, v112, v113
    v_and_b32 v142, 0xffff, v169
    v_lshrrev_b32 v143, 16, v169
    ds_write_b128 v16, v[140:143] offset:24576
    s_cmp_eq_u32 s15, 63
    s_cbranch_scc1 recur_fast_last2
    s_waitcnt lgkmcnt(0)
    s_barrier
    s_sleep 7
    s_nop 12
    s_mov_b32 s23, s25
    buffer_load_dwordx4 v[24:27], v8, s[4:7], s16 offen offset:0 sc1
    buffer_load_dwordx4 v[28:31], v8, s[4:7], s16 offen offset:1024 sc1
    buffer_load_dwordx4 v[32:35], v8, s[4:7], s16 offen offset:2048 sc1
    buffer_load_dwordx4 v[36:39], v8, s[4:7], s16 offen offset:3072 sc1
    s_waitcnt vmcnt(3)
    v_max3_u32 v19, v24, v25, v26
    v_max_u32 v19, v19, v27
    v_cmp_eq_u32 vcc, -1, v19
    s_nop 0
    s_cbranch_vccnz gs_255
    v_mfma_f32_16x16x32_bf16 v[40:43], a[192:195], v[24:27], v[40:43]
    s_waitcnt vmcnt(2)
    v_max3_u32 v19, v28, v29, v30
    v_mfma_f32_16x16x32_bf16 v[44:47], a[196:199], v[24:27], v[44:47]
    v_max_u32 v19, v19, v31
    v_mfma_f32_16x16x32_bf16 v[48:51], a[224:227], v[24:27], v[48:51]
    v_cmp_eq_u32 vcc, -1, v19
    v_mfma_f32_16x16x32_bf16 v[52:55], a[228:231], v[24:27], v[52:55]
    s_cbranch_vccnz gs_256
    v_mfma_f32_16x16x32_bf16 v[40:43], a[200:203], v[28:31], v[40:43]
    s_waitcnt vmcnt(1)
    v_max3_u32 v19, v32, v33, v34
    v_mfma_f32_16x16x32_bf16 v[44:47], a[204:207], v[28:31], v[44:47]
    v_max_u32 v19, v19, v35
    v_mfma_f32_16x16x32_bf16 v[48:51], a[232:235], v[28:31], v[48:51]
    v_cmp_eq_u32 vcc, -1, v19
    v_mfma_f32_16x16x32_bf16 v[52:55], a[236:239], v[28:31], v[52:55]
    s_cbranch_vccnz gs_257
    v_mfma_f32_16x16x32_bf16 v[40:43], a[208:211], v[32:35], v[40:43]
    s_waitcnt vmcnt(0)
    v_max3_u32 v19, v36, v37, v38
    v_mfma_f32_16x16x32_bf16 v[44:47], a[212:215], v[32:35], v[44:47]
    v_max_u32 v19, v19, v39
    v_mfma_f32_16x16x32_bf16 v[48:51], a[240:243], v[32:35], v[48:51]
    v_cmp_eq_u32 vcc, -1, v19
    v_mfma_f32_16x16x32_bf16 v[52:55], a[244:247], v[32:35], v[52:55]
    s_cbranch_vccnz gs_258
    v_mfma_f32_16x16x32_bf16 v[40:43], a[216:219], v[36:39], v[40:43]
    v_mfma_f32_16x16x32_bf16 v[44:47], a[220:223], v[36:39], v[44:47]
    v_mfma_f32_16x16x32_bf16 v[48:51], a[248:251], v[36:39], v[48:51]
    v_mfma_f32_16x16x32_bf16 v[52:55], a[252:255], v[36:39], v[52:55]
gc_254:
    s_nop 5
    v_add_f32_dpp v88, v44, v40 row_ror:8 row_mask:0xf bank_mask:0x3
    v_add_f32_dpp v89, v45, v41 row_ror:8 row_mask:0xf bank_mask:0x3
    v_add_f32_dpp v90, v46, v42 row_ror:8 row_mask:0xf bank_mask:0x3
    v_add_f32_dpp v91, v47, v43 row_ror:8 row_mask:0xf bank_mask:0x3
    v_add_f32_dpp v88, v48, v52 row_ror:8 row_mask:0xf bank_mask:0xc
    v_add_f32_dpp v89, v49, v53 row_ror:8 row_mask:0xf bank_mask:0xc
    v_add_f32_dpp v90, v50, v54 row_ror:8 row_mask:0xf bank_mask:0xc
    v_add_f32_dpp v91, v51, v55 row_ror:8 row_mask:0xf bank_mask:0xc
    ds_write_b128 v17, v[88:91] offset:16384
    s_waitcnt lgkmcnt(0)
    s_barrier
    v_mov_b32 v40, 0
    v_mov_b32 v41, 0
    v_mov_b32 v42, 0
    v_mov_b32 v43, 0
    v_mov_b32 v44, 0
    v_mov_b32 v45, 0
    v_mov_b32 v46, 0
    v_mov_b32 v47, 0
    v_mov_b32 v48, 0
    v_mov_b32 v49, 0
    v_mov_b32 v50, 0
    v_mov_b32 v51, 0
    v_mov_b32 v52, 0
    v_mov_b32 v53, 0
    v_mov_b32 v54, 0
    v_mov_b32 v55, 0
    v_mov_b32 v56, 0
    v_mov_b32 v57, 0
    v_mov_b32 v58, 0
    v_mov_b32 v59, 0
    v_mov_b32 v60, 0
    v_mov_b32 v61, 0
    v_mov_b32 v62, 0
    v_mov_b32 v63, 0
    v_mov_b32 v64, 0
    v_mov_b32 v65, 0
    v_mov_b32 v66, 0
    v_mov_b32 v67, 0
    v_mov_b32 v68, 0
    v_mov_b32 v69, 0
    v_mov_b32 v70, 0
    v_mov_b32 v71, 0
    s_sleep 1
    buffer_store_dword v168, v15, s[4:7], s20 offen offset:0 sc1
    buffer_store_dword v169, v15, s[4:7], s20 offen offset:64 sc1
    s_add_u32 s20, s20, 512
    s_mov_b32 s21, s16
    s_mov_b32 s16, s42
    s_mov_b32 s42, s43
    s_mov_b32 s43, s44
    s_mov_b32 s44, s21
    s_add_u32 s84, s84, 262144
    s_add_u32 s15, s15, 1
    s_barrier
    s_branch recur_fast_w2
gs_214:
    s_mov_b64 s[86:87], vcc
    s_mov_b64 exec, s[86:87]
    buffer_load_dwordx4 v[24:27], v2, s[4:7], s16 offen offset:0 sc1
    s_mov_b64 exec, -1
    s_waitcnt vmcnt(1)
    v_max3_u32 v19, v28, v29, v30
    v_max_u32 v19, v19, v31
    v_cmp_eq_u32 s[88:89], -1, v19
    v_max3_u32 v19, v32, v33, v34
    v_max_u32 v19, v19, v35
    v_cmp_eq_u32 s[90:91], -1, v19
    v_max3_u32 v19, v36, v37, v38
    v_max_u32 v19, v19, v39
    v_cmp_eq_u32 s[92:93], -1, v19
    s_mov_b64 exec, s[88:89]
    buffer_load_dwordx4 v[28:31], v2, s[4:7], s16 offen offset:1024 sc1
    s_mov_b64 exec, s[90:91]
    buffer_load_dwordx4 v[32:35], v2, s[4:7], s16 offen offset:2048 sc1
    s_mov_b64 exec, s[92:93]
    buffer_load_dwordx4 v[36:39], v2, s[4:7], s16 offen offset:3072 sc1
    s_mov_b64 exec, -1
    s_cmp_lg_u64 s[88:89], 0
    s_cbranch_scc1 gk_218
    v_mfma_f32_16x16x32_bf16 v[40:43], a[8:11], v[28:31], v[40:43]
    v_mfma_f32_16x16x32_bf16 v[44:47], a[12:15], v[28:31], v[44:47]
    v_mfma_f32_16x16x32_bf16 v[56:59], a[72:75], v[28:31], v[56:59]
    v_mfma_f32_16x16x32_bf16 v[60:63], a[76:79], v[28:31], v[60:63]
    v_mfma_f32_16x16x32_bf16 v[48:51], a[40:43], v[28:31], v[48:51]
    v_mfma_f32_16x16x32_bf16 v[52:55], a[44:47], v[28:31], v[52:55]
    v_mfma_f32_16x16x32_bf16 v[64:67], a[104:107], v[28:31], v[64:67]
    v_mfma_f32_16x16x32_bf16 v[68:71], a[108:111], v[28:31], v[68:71]
    s_mov_b64 exec, s[86:87]
    buffer_load_dwordx4 v[24:27], v2, s[4:7], s16 offen offset:0 sc1
    s_mov_b64 exec, s[90:91]
    buffer_load_dwordx4 v[32:35], v2, s[4:7], s16 offen offset:2048 sc1
    s_mov_b64 exec, s[92:93]
    buffer_load_dwordx4 v[36:39], v2, s[4:7], s16 offen offset:3072 sc1
    s_mov_b64 exec, -1
gk_218:
    s_cmp_lg_u64 s[90:91], 0
    s_cbranch_scc1 gk_219
    v_mfma_f32_16x16x32_bf16 v[40:43], a[16:19], v[32:35], v[40:43]
    v_mfma_f32_16x16x32_bf16 v[44:47], a[20:23], v[32:35], v[44:47]
    v_mfma_f32_16x16x32_bf16 v[56:59], a[80:83], v[32:35], v[56:59]
    v_mfma_f32_16x16x32_bf16 v[60:63], a[84:87], v[32:35], v[60:63]
    v_mfma_f32_16x16x32_bf16 v[48:51], a[48:51], v[32:35], v[48:51]
    v_mfma_f32_16x16x32_bf16 v[52:55], a[52:55], v[32:35], v[52:55]
    v_mfma_f32_16x16x32_bf16 v[64:67], a[112:115], v[32:35], v[64:67]
    v_mfma_f32_16x16x32_bf16 v[68:71], a[116:119], v[32:35], v[68:71]
    s_mov_b64 exec, s[86:87]
    buffer_load_dwordx4 v[24:27], v2, s[4:7], s16 offen offset:0 sc1
    s_mov_b64 exec, s[88:89]
    buffer_load_dwordx4 v[28:31], v2, s[4:7], s16 offen offset:1024 sc1
    s_mov_b64 exec, s[92:93]
    buffer_load_dwordx4 v[36:39], v2, s[4:7], s16 offen offset:3072 sc1
    s_mov_b64 exec, -1
gk_219:
    s_cmp_lg_u64 s[92:93], 0
    s_cbranch_scc1 gk_220
    v_mfma_f32_16x16x32_bf16 v[40:43], a[24:27], v[36:39], v[40:43]
    v_mfma_f32_16x16x32_bf16 v[44:47], a[28:31], v[36:39], v[44:47]
    v_mfma_f32_16x16x32_bf16 v[56:59], a[88:91], v[36:39], v[56:59]
    v_mfma_f32_16x16x32_bf16 v[60:63], a[92:95], v[36:39], v[60:63]
    v_mfma_f32_16x16x32_bf16 v[48:51], a[56:59], v[36:39], v[48:51]
    v_mfma_f32_16x16x32_bf16 v[52:55], a[60:63], v[36:39], v[52:55]
    v_mfma_f32_16x16x32_bf16 v[64:67], a[120:123], v[36:39], v[64:67]
    v_mfma_f32_16x16x32_bf16 v[68:71], a[124:127], v[36:39], v[68:71]
    s_mov_b64 exec, s[86:87]
    buffer_load_dwordx4 v[24:27], v2, s[4:7], s16 offen offset:0 sc1
    s_mov_b64 exec, s[88:89]
    buffer_load_dwordx4 v[28:31], v2, s[4:7], s16 offen offset:1024 sc1
    s_mov_b64 exec, s[90:91]
    buffer_load_dwordx4 v[32:35], v2, s[4:7], s16 offen offset:2048 sc1
    s_mov_b64 exec, -1
gk_220:
gl_222:
    v_max3_u32 v19, v24, v25, v26
    v_max_u32 v19, v19, v27
    v_cmp_eq_u32 vcc, -1, v19
    s_nop 0
    s_cbranch_vccz go_223
    s_mov_b64 s[86:87], vcc
    s_waitcnt vmcnt(8)
    s_mov_b64 exec, s[86:87]
    buffer_load_dwordx4 v[24:27], v2, s[4:7], s16 offen offset:0 sc1
    s_mov_b64 exec, s[88:89]
    buffer_load_dwordx4 v[28:31], v2, s[4:7], s16 offen offset:1024 sc1
    s_mov_b64 exec, s[90:91]
    buffer_load_dwordx4 v[32:35], v2, s[4:7], s16 offen offset:2048 sc1
    s_mov_b64 exec, s[92:93]
    buffer_load_dwordx4 v[36:39], v2, s[4:7], s16 offen offset:3072 sc1
    s_mov_b64 exec, -1
    s_add_u32 s23, s23, 1
    s_cmp_ge_u32 s23, 200000
    s_cselect_b32 s25, 200000, s25
    s_cbranch_scc1 go_223
    s_branch gl_222
go_223:
    v_mfma_f32_16x16x32_bf16 v[40:43], a[0:3], v[24:27], v[40:43]
    v_mfma_f32_16x16x32_bf16 v[44:47], a[4:7], v[24:27], v[44:47]
    v_mfma_f32_16x16x32_bf16 v[56:59], a[64:67], v[24:27], v[56:59]
    v_mfma_f32_16x16x32_bf16 v[60:63], a[68:71], v[24:27], v[60:63]
    v_mfma_f32_16x16x32_bf16 v[48:51], a[32:35], v[24:27], v[48:51]
    v_mfma_f32_16x16x32_bf16 v[52:55], a[36:39], v[24:27], v[52:55]
    v_mfma_f32_16x16x32_bf16 v[64:67], a[96:99], v[24:27], v[64:67]
    v_mfma_f32_16x16x32_bf16 v[68:71], a[100:103], v[24:27], v[68:71]
gd_221:
    s_cmp_eq_u64 s[88:89], 0
    s_cbranch_scc1 gd_224
gl_225:
    v_max3_u32 v19, v28, v29, v30
    v_max_u32 v19, v19, v31
    v_cmp_eq_u32 vcc, -1, v19
    s_nop 0
    s_cbranch_vccz go_226
    s_mov_b64 s[88:89], vcc
    s_waitcnt vmcnt(6)
    s_mov_b64 exec, s[88:89]
    buffer_load_dwordx4 v[28:31], v2, s[4:7], s16 offen offset:1024 sc1
    s_mov_b64 exec, s[90:91]
    buffer_load_dwordx4 v[32:35], v2, s[4:7], s16 offen offset:2048 sc1
    s_mov_b64 exec, s[92:93]
    buffer_load_dwordx4 v[36:39], v2, s[4:7], s16 offen offset:3072 sc1
    s_mov_b64 exec, -1
    s_add_u32 s23, s23, 1
    s_cmp_ge_u32 s23, 200000
    s_cselect_b32 s25, 200000, s25
    s_cbranch_scc1 go_226
    s_branch gl_225
go_226:
    v_mfma_f32_16x16x32_bf16 v[40:43], a[8:11], v[28:31], v[40:43]
    v_mfma_f32_16x16x32_bf16 v[44:47], a[12:15], v[28:31], v[44:47]
    v_mfma_f32_16x16x32_bf16 v[56:59], a[72:75], v[28:31], v[56:59]
    v_mfma_f32_16x16x32_bf16 v[60:63], a[76:79], v[28:31], v[60:63]
    v_mfma_f32_16x16x32_bf16 v[48:51], a[40:43], v[28:31], v[48:51]
    v_mfma_f32_16x16x32_bf16 v[52:55], a[44:47], v[28:31], v[52:55]
    v_mfma_f32_16x16x32_bf16 v[64:67], a[104:107], v[28:31], v[64:67]
    v_mfma_f32_16x16x32_bf16 v[68:71], a[108:111], v[28:31], v[68:71]
gd_224:
    s_cmp_eq_u64 s[90:91], 0
    s_cbranch_scc1 gd_227
gl_228:
    v_max3_u32 v19, v32, v33, v34
    v_max_u32 v19, v19, v35
    v_cmp_eq_u32 vcc, -1, v19
    s_nop 0
    s_cbranch_vccz go_229
    s_mov_b64 s[90:91], vcc
    s_waitcnt vmcnt(4)
    s_mov_b64 exec, s[90:91]
    buffer_load_dwordx4 v[32:35], v2, s[4:7], s16 offen offset:2048 sc1
    s_mov_b64 exec, s[92:93]
    buffer_load_dwordx4 v[36:39], v2, s[4:7], s16 offen offset:3072 sc1
    s_mov_b64 exec, -1
    s_add_u32 s23, s23, 1
    s_cmp_ge_u32 s23, 200000
    s_cselect_b32 s25, 200000, s25
    s_cbranch_scc1 go_229
    s_branch gl_228
go_229:
    v_mfma_f32_16x16x32_bf16 v[40:43], a[16:19], v[32:35], v[40:43]
    v_mfma_f32_16x16x32_bf16 v[44:47], a[20:23], v[32:35], v[44:47]
    v_mfma_f32_16x16x32_bf16 v[56:59], a[80:83], v[32:35], v[56:59]
    v_mfma_f32_16x16x32_bf16 v[60:63], a[84:87], v[32:35], v[60:63]
    v_mfma_f32_16x16x32_bf16 v[48:51], a[48:51], v[32:35], v[48:51]
    v_mfma_f32_16x16x32_bf16 v[52:55], a[52:55], v[32:35], v[52:55]
    v_mfma_f32_16x16x32_bf16 v[64:67], a[112:115], v[32:35], v[64:67]
    v_mfma_f32_16x16x32_bf16 v[68:71], a[116:119], v[32:35], v[68:71]
gd_227:
    s_cmp_eq_u64 s[92:93], 0
    s_cbranch_scc1 gd_230
gl_231:
    v_max3_u32 v19, v36, v37, v38
    v_max_u32 v19, v19, v39
    v_cmp_eq_u32 vcc, -1, v19
    s_nop 0
    s_cbranch_vccz go_232
    s_mov_b64 s[92:93], vcc
    s_waitcnt vmcnt(2)
    s_mov_b64 exec, s[92:93]
    buffer_load_dwordx4 v[36:39], v2, s[4:7], s16 offen offset:3072 sc1
    s_mov_b64 exec, -1
    s_add_u32 s23, s23, 1
    s_cmp_ge_u32 s23, 200000
    s_cselect_b32 s25, 200000, s25
    s_cbranch_scc1 go_232
    s_branch gl_231
go_232:
    v_mfma_f32_16x16x32_bf16 v[40:43], a[24:27], v[36:39], v[40:43]
    v_mfma_f32_16x16x32_bf16 v[44:47], a[28:31], v[36:39], v[44:47]
    v_mfma_f32_16x16x32_bf16 v[56:59], a[88:91], v[36:39], v[56:59]
    v_mfma_f32_16x16x32_bf16 v[60:63], a[92:95], v[36:39], v[60:63]
    v_mfma_f32_16x16x32_bf16 v[48:51], a[56:59], v[36:39], v[48:51]
    v_mfma_f32_16x16x32_bf16 v[52:55], a[60:63], v[36:39], v[52:55]
    v_mfma_f32_16x16x32_bf16 v[64:67], a[120:123], v[36:39], v[64:67]
    v_mfma_f32_16x16x32_bf16 v[68:71], a[124:127], v[36:39], v[68:71]
gd_230:
    s_branch gc_213
gs_215:
    s_mov_b64 s[88:89], vcc
    s_mov_b64 exec, s[88:89]
    buffer_load_dwordx4 v[28:31], v2, s[4:7], s16 offen offset:1024 sc1
    s_mov_b64 exec, -1
    s_waitcnt vmcnt(1)
    v_max3_u32 v19, v32, v33, v34
    v_max_u32 v19, v19, v35
    v_cmp_eq_u32 s[90:91], -1, v19
    v_max3_u32 v19, v36, v37, v38
    v_max_u32 v19, v19, v39
    v_cmp_eq_u32 s[92:93], -1, v19
    s_mov_b64 exec, s[90:91]
    buffer_load_dwordx4 v[32:35], v2, s[4:7], s16 offen offset:2048 sc1
    s_mov_b64 exec, s[92:93]
    buffer_load_dwordx4 v[36:39], v2, s[4:7], s16 offen offset:3072 sc1
    s_mov_b64 exec, -1
    s_cmp_lg_u64 s[90:91], 0
    s_cbranch_scc1 gk_233
    v_mfma_f32_16x16x32_bf16 v[40:43], a[16:19], v[32:35], v[40:43]
    v_mfma_f32_16x16x32_bf16 v[44:47], a[20:23], v[32:35], v[44:47]
    v_mfma_f32_16x16x32_bf16 v[56:59], a[80:83], v[32:35], v[56:59]
    v_mfma_f32_16x16x32_bf16 v[60:63], a[84:87], v[32:35], v[60:63]
    v_mfma_f32_16x16x32_bf16 v[48:51], a[48:51], v[32:35], v[48:51]
    v_mfma_f32_16x16x32_bf16 v[52:55], a[52:55], v[32:35], v[52:55]
    v_mfma_f32_16x16x32_bf16 v[64:67], a[112:115], v[32:35], v[64:67]
    v_mfma_f32_16x16x32_bf16 v[68:71], a[116:119], v[32:35], v[68:71]
    s_mov_b64 exec, s[88:89]
    buffer_load_dwordx4 v[28:31], v2, s[4:7], s16 offen offset:1024 sc1
    s_mov_b64 exec, s[92:93]
    buffer_load_dwordx4 v[36:39], v2, s[4:7], s16 offen offset:3072 sc1
    s_mov_b64 exec, -1
gk_233:
    s_cmp_lg_u64 s[92:93], 0
    s_cbranch_scc1 gk_234
    v_mfma_f32_16x16x32_bf16 v[40:43], a[24:27], v[36:39], v[40:43]
    v_mfma_f32_16x16x32_bf16 v[44:47], a[28:31], v[36:39], v[44:47]
    v_mfma_f32_16x16x32_bf16 v[56:59], a[88:91], v[36:39], v[56:59]
    v_mfma_f32_16x16x32_bf16 v[60:63], a[92:95], v[36:39], v[60:63]
    v_mfma_f32_16x16x32_bf16 v[48:51], a[56:59], v[36:39], v[48:51]
    v_mfma_f32_16x16x32_bf16 v[52:55], a[60:63], v[36:39], v[52:55]
    v_mfma_f32_16x16x32_bf16 v[64:67], a[120:123], v[36:39], v[64:67]
    v_mfma_f32_16x16x32_bf16 v[68:71], a[124:127], v[36:39], v[68:71]
    s_mov_b64 exec, s[88:89]
    buffer_load_dwordx4 v[28:31], v2, s[4:7], s16 offen offset:1024 sc1
    s_mov_b64 exec, s[90:91]
    buffer_load_dwordx4 v[32:35], v2, s[4:7], s16 offen offset:2048 sc1
    s_mov_b64 exec, -1
gk_234:
gl_236:
    v_max3_u32 v19, v28, v29, v30
    v_max_u32 v19, v19, v31
    v_cmp_eq_u32 vcc, -1, v19
    s_nop 0
    s_cbranch_vccz go_237
    s_mov_b64 s[88:89], vcc
    s_waitcnt vmcnt(6)
    s_mov_b64 exec, s[88:89]
    buffer_load_dwordx4 v[28:31], v2, s[4:7], s16 offen offset:1024 sc1
    s_mov_b64 exec, s[90:91]
    buffer_load_dwordx4 v[32:35], v2, s[4:7], s16 offen offset:2048 sc1
    s_mov_b64 exec, s[92:93]
    buffer_load_dwordx4 v[36:39], v2, s[4:7], s16 offen offset:3072 sc1
    s_mov_b64 exec, -1
    s_add_u32 s23, s23, 1
    s_cmp_ge_u32 s23, 200000
    s_cselect_b32 s25, 200000, s25
    s_cbranch_scc1 go_237
    s_branch gl_236
go_237:
    v_mfma_f32_16x16x32_bf16 v[40:43], a[8:11], v[28:31], v[40:43]
    v_mfma_f32_16x16x32_bf16 v[44:47], a[12:15], v[28:31], v[44:47]
    v_mfma_f32_16x16x32_bf16 v[56:59], a[72:75], v[28:31], v[56:59]
    v_mfma_f32_16x16x32_bf16 v[60:63], a[76:79], v[28:31], v[60:63]
    v_mfma_f32_16x16x32_bf16 v[48:51], a[40:43], v[28:31], v[48:51]
    v_mfma_f32_16x16x32_bf16 v[52:55], a[44:47], v[28:31], v[52:55]
    v_mfma_f32_16x16x32_bf16 v[64:67], a[104:107], v[28:31], v[64:67]
    v_mfma_f32_16x16x32_bf16 v[68:71], a[108:111], v[28:31], v[68:71]
gd_235:
    s_cmp_eq_u64 s[90:91], 0
    s_cbranch_scc1 gd_238
gl_239:
    v_max3_u32 v19, v32, v33, v34
    v_max_u32 v19, v19, v35
    v_cmp_eq_u32 vcc, -1, v19
    s_nop 0
    s_cbranch_vccz go_240
    s_mov_b64 s[90:91], vcc
    s_waitcnt vmcnt(4)
    s_mov_b64 exec, s[90:91]
    buffer_load_dwordx4 v[32:35], v2, s[4:7], s16 offen offset:2048 sc1
    s_mov_b64 exec, s[92:93]
    buffer_load_dwordx4 v[36:39], v2, s[4:7], s16 offen offset:3072 sc1
    s_mov_b64 exec, -1
    s_add_u32 s23, s23, 1
    s_cmp_ge_u32 s23, 200000
    s_cselect_b32 s25, 200000, s25
    s_cbranch_scc1 go_240
    s_branch gl_239
go_240:
    v_mfma_f32_16x16x32_bf16 v[40:43], a[16:19], v[32:35], v[40:43]
    v_mfma_f32_16x16x32_bf16 v[44:47], a[20:23], v[32:35], v[44:47]
    v_mfma_f32_16x16x32_bf16 v[56:59], a[80:83], v[32:35], v[56:59]
    v_mfma_f32_16x16x32_bf16 v[60:63], a[84:87], v[32:35], v[60:63]
    v_mfma_f32_16x16x32_bf16 v[48:51], a[48:51], v[32:35], v[48:51]
    v_mfma_f32_16x16x32_bf16 v[52:55], a[52:55], v[32:35], v[52:55]
    v_mfma_f32_16x16x32_bf16 v[64:67], a[112:115], v[32:35], v[64:67]
    v_mfma_f32_16x16x32_bf16 v[68:71], a[116:119], v[32:35], v[68:71]
gd_238:
    s_cmp_eq_u64 s[92:93], 0
    s_cbranch_scc1 gd_241
gl_242:
    v_max3_u32 v19, v36, v37, v38
    v_max_u32 v19, v19, v39
    v_cmp_eq_u32 vcc, -1, v19
    s_nop 0
    s_cbranch_vccz go_243
    s_mov_b64 s[92:93], vcc
    s_waitcnt vmcnt(2)
    s_mov_b64 exec, s[92:93]
    buffer_load_dwordx4 v[36:39], v2, s[4:7], s16 offen offset:3072 sc1
    s_mov_b64 exec, -1
    s_add_u32 s23, s23, 1
    s_cmp_ge_u32 s23, 200000
    s_cselect_b32 s25, 200000, s25
    s_cbranch_scc1 go_243
    s_branch gl_242
go_243:
    v_mfma_f32_16x16x32_bf16 v[40:43], a[24:27], v[36:39], v[40:43]
    v_mfma_f32_16x16x32_bf16 v[44:47], a[28:31], v[36:39], v[44:47]
    v_mfma_f32_16x16x32_bf16 v[56:59], a[88:91], v[36:39], v[56:59]
    v_mfma_f32_16x16x32_bf16 v[60:63], a[92:95], v[36:39], v[60:63]
    v_mfma_f32_16x16x32_bf16 v[48:51], a[56:59], v[36:39], v[48:51]
    v_mfma_f32_16x16x32_bf16 v[52:55], a[60:63], v[36:39], v[52:55]
    v_mfma_f32_16x16x32_bf16 v[64:67], a[120:123], v[36:39], v[64:67]
    v_mfma_f32_16x16x32_bf16 v[68:71], a[124:127], v[36:39], v[68:71]
gd_241:
    s_branch gc_213
gs_216:
    s_mov_b64 s[90:91], vcc
    s_mov_b64 exec, s[90:91]
    buffer_load_dwordx4 v[32:35], v2, s[4:7], s16 offen offset:2048 sc1
    s_mov_b64 exec, -1
    s_waitcnt vmcnt(1)
    v_max3_u32 v19, v36, v37, v38
    v_max_u32 v19, v19, v39
    v_cmp_eq_u32 s[92:93], -1, v19
    s_nop 0
    s_mov_b64 exec, s[92:93]
    buffer_load_dwordx4 v[36:39], v2, s[4:7], s16 offen offset:3072 sc1
    s_mov_b64 exec, -1
    s_cmp_lg_u64 s[92:93], 0
    s_cbranch_scc1 gk_244
    v_mfma_f32_16x16x32_bf16 v[40:43], a[24:27], v[36:39], v[40:43]
    v_mfma_f32_16x16x32_bf16 v[44:47], a[28:31], v[36:39], v[44:47]
    v_mfma_f32_16x16x32_bf16 v[56:59], a[88:91], v[36:39], v[56:59]
    v_mfma_f32_16x16x32_bf16 v[60:63], a[92:95], v[36:39], v[60:63]
    v_mfma_f32_16x16x32_bf16 v[48:51], a[56:59], v[36:39], v[48:51]
    v_mfma_f32_16x16x32_bf16 v[52:55], a[60:63], v[36:39], v[52:55]
    v_mfma_f32_16x16x32_bf16 v[64:67], a[120:123], v[36:39], v[64:67]
    v_mfma_f32_16x16x32_bf16 v[68:71], a[124:127], v[36:39], v[68:71]
    s_mov_b64 exec, s[90:91]
    buffer_load_dwordx4 v[32:35], v2, s[4:7], s16 offen offset:2048 sc1
    s_mov_b64 exec, -1
gk_244:
gl_246:
    v_max3_u32 v19, v32, v33, v34
    v_max_u32 v19, v19, v35
    v_cmp_eq_u32 vcc, -1, v19
    s_nop 0
    s_cbranch_vccz go_247
    s_mov_b64 s[90:91], vcc
    s_waitcnt vmcnt(4)
    s_mov_b64 exec, s[90:91]
    buffer_load_dwordx4 v[32:35], v2, s[4:7], s16 offen offset:2048 sc1
    s_mov_b64 exec, s[92:93]
    buffer_load_dwordx4 v[36:39], v2, s[4:7], s16 offen offset:3072 sc1
    s_mov_b64 exec, -1
    s_add_u32 s23, s23, 1
    s_cmp_ge_u32 s23, 200000
    s_cselect_b32 s25, 200000, s25
    s_cbranch_scc1 go_247
    s_branch gl_246
go_247:
    v_mfma_f32_16x16x32_bf16 v[40:43], a[16:19], v[32:35], v[40:43]
    v_mfma_f32_16x16x32_bf16 v[44:47], a[20:23], v[32:35], v[44:47]
    v_mfma_f32_16x16x32_bf16 v[56:59], a[80:83], v[32:35], v[56:59]
    v_mfma_f32_16x16x32_bf16 v[60:63], a[84:87], v[32:35], v[60:63]
    v_mfma_f32_16x16x32_bf16 v[48:51], a[48:51], v[32:35], v[48:51]
    v_mfma_f32_16x16x32_bf16 v[52:55], a[52:55], v[32:35], v[52:55]
    v_mfma_f32_16x16x32_bf16 v[64:67], a[112:115], v[32:35], v[64:67]
    v_mfma_f32_16x16x32_bf16 v[68:71], a[116:119], v[32:35], v[68:71]
gd_245:
    s_cmp_eq_u64 s[92:93], 0
    s_cbranch_scc1 gd_248
gl_249:
    v_max3_u32 v19, v36, v37, v38
    v_max_u32 v19, v19, v39
    v_cmp_eq_u32 vcc, -1, v19
    s_nop 0
    s_cbranch_vccz go_250
    s_mov_b64 s[92:93], vcc
    s_waitcnt vmcnt(2)
    s_mov_b64 exec, s[92:93]
    buffer_load_dwordx4 v[36:39], v2, s[4:7], s16 offen offset:3072 sc1
    s_mov_b64 exec, -1
    s_add_u32 s23, s23, 1
    s_cmp_ge_u32 s23, 200000
    s_cselect_b32 s25, 200000, s25
    s_cbranch_scc1 go_250
    s_branch gl_249
go_250:
    v_mfma_f32_16x16x32_bf16 v[40:43], a[24:27], v[36:39], v[40:43]
    v_mfma_f32_16x16x32_bf16 v[44:47], a[28:31], v[36:39], v[44:47]
    v_mfma_f32_16x16x32_bf16 v[56:59], a[88:91], v[36:39], v[56:59]
    v_mfma_f32_16x16x32_bf16 v[60:63], a[92:95], v[36:39], v[60:63]
    v_mfma_f32_16x16x32_bf16 v[48:51], a[56:59], v[36:39], v[48:51]
    v_mfma_f32_16x16x32_bf16 v[52:55], a[60:63], v[36:39], v[52:55]
    v_mfma_f32_16x16x32_bf16 v[64:67], a[120:123], v[36:39], v[64:67]
    v_mfma_f32_16x16x32_bf16 v[68:71], a[124:127], v[36:39], v[68:71]
gd_248:
    s_branch gc_213
gs_217:
    s_mov_b64 s[92:93], vcc
    s_mov_b64 exec, s[92:93]
    buffer_load_dwordx4 v[36:39], v2, s[4:7], s16 offen offset:3072 sc1
    s_mov_b64 exec, -1
gl_252:
    v_max3_u32 v19, v36, v37, v38
    v_max_u32 v19, v19, v39
    v_cmp_eq_u32 vcc, -1, v19
    s_nop 0
    s_cbranch_vccz go_253
    s_mov_b64 s[92:93], vcc
    s_waitcnt vmcnt(2)
    s_mov_b64 exec, s[92:93]
    buffer_load_dwordx4 v[36:39], v2, s[4:7], s16 offen offset:3072 sc1
    s_mov_b64 exec, -1
    s_add_u32 s23, s23, 1
    s_cmp_ge_u32 s23, 200000
    s_cselect_b32 s25, 200000, s25
    s_cbranch_scc1 go_253
    s_branch gl_252
go_253:
    v_mfma_f32_16x16x32_bf16 v[40:43], a[24:27], v[36:39], v[40:43]
    v_mfma_f32_16x16x32_bf16 v[44:47], a[28:31], v[36:39], v[44:47]
    v_mfma_f32_16x16x32_bf16 v[56:59], a[88:91], v[36:39], v[56:59]
    v_mfma_f32_16x16x32_bf16 v[60:63], a[92:95], v[36:39], v[60:63]
    v_mfma_f32_16x16x32_bf16 v[48:51], a[56:59], v[36:39], v[48:51]
    v_mfma_f32_16x16x32_bf16 v[52:55], a[60:63], v[36:39], v[52:55]
    v_mfma_f32_16x16x32_bf16 v[64:67], a[120:123], v[36:39], v[64:67]
    v_mfma_f32_16x16x32_bf16 v[68:71], a[124:127], v[36:39], v[68:71]
gd_251:
    s_branch gc_213
recur_fast_last2:
    buffer_store_dword v168, v15, s[4:7], s20 offen offset:0 sc1
    buffer_store_dword v169, v15, s[4:7], s20 offen offset:64 sc1
    s_branch recur_end
gs_255:
    s_mov_b64 s[86:87], vcc
    s_mov_b64 exec, s[86:87]
    buffer_load_dwordx4 v[24:27], v8, s[4:7], s16 offen offset:0 sc1
    s_mov_b64 exec, -1
    s_waitcnt vmcnt(1)
    v_max3_u32 v19, v28, v29, v30
    v_max_u32 v19, v19, v31
    v_cmp_eq_u32 s[88:89], -1, v19
    v_max3_u32 v19, v32, v33, v34
    v_max_u32 v19, v19, v35
    v_cmp_eq_u32 s[90:91], -1, v19
    v_max3_u32 v19, v36, v37, v38
    v_max_u32 v19, v19, v39
    v_cmp_eq_u32 s[92:93], -1, v19
    s_mov_b64 exec, s[88:89]
    buffer_load_dwordx4 v[28:31], v8, s[4:7], s16 offen offset:1024 sc1
    s_mov_b64 exec, s[90:91]
    buffer_load_dwordx4 v[32:35], v8, s[4:7], s16 offen offset:2048 sc1
    s_mov_b64 exec, s[92:93]
    buffer_load_dwordx4 v[36:39], v8, s[4:7], s16 offen offset:3072 sc1
    s_mov_b64 exec, -1
    s_cmp_lg_u64 s[88:89], 0
    s_cbranch_scc1 gk_259
    v_mfma_f32_16x16x32_bf16 v[40:43], a[200:203], v[28:31], v[40:43]
    v_mfma_f32_16x16x32_bf16 v[44:47], a[204:207], v[28:31], v[44:47]
    v_mfma_f32_16x16x32_bf16 v[48:51], a[232:235], v[28:31], v[48:51]
    v_mfma_f32_16x16x32_bf16 v[52:55], a[236:239], v[28:31], v[52:55]
    s_mov_b64 exec, s[86:87]
    buffer_load_dwordx4 v[24:27], v8, s[4:7], s16 offen offset:0 sc1
    s_mov_b64 exec, s[90:91]
    buffer_load_dwordx4 v[32:35], v8, s[4:7], s16 offen offset:2048 sc1
    s_mov_b64 exec, s[92:93]
    buffer_load_dwordx4 v[36:39], v8, s[4:7], s16 offen offset:3072 sc1
    s_mov_b64 exec, -1
gk_259:
    s_cmp_lg_u64 s[90:91], 0
    s_cbranch_scc1 gk_260
    v_mfma_f32_16x16x32_bf16 v[40:43], a[208:211], v[32:35], v[40:43]
    v_mfma_f32_16x16x32_bf16 v[44:47], a[212:215], v[32:35], v[44:47]
    v_mfma_f32_16x16x32_bf16 v[48:51], a[240:243], v[32:35], v[48:51]
    v_mfma_f32_16x16x32_bf16 v[52:55], a[244:247], v[32:35], v[52:55]
    s_mov_b64 exec, s[86:87]
    buffer_load_dwordx4 v[24:27], v8, s[4:7], s16 offen offset:0 sc1
    s_mov_b64 exec, s[88:89]
    buffer_load_dwordx4 v[28:31], v8, s[4:7], s16 offen offset:1024 sc1
    s_mov_b64 exec, s[92:93]
    buffer_load_dwordx4 v[36:39], v8, s[4:7], s16 offen offset:3072 sc1
    s_mov_b64 exec, -1
gk_260:
    s_cmp_lg_u64 s[92:93], 0
    s_cbranch_scc1 gk_261
    v_mfma_f32_16x16x32_bf16 v[40:43], a[216:219], v[36:39], v[40:43]
    v_mfma_f32_16x16x32_bf16 v[44:47], a[220:223], v[36:39], v[44:47]
    v_mfma_f32_16x16x32_bf16 v[48:51], a[248:251], v[36:39], v[48:51]
    v_mfma_f32_16x16x32_bf16 v[52:55], a[252:255], v[36:39], v[52:55]
    s_mov_b64 exec, s[86:87]
    buffer_load_dwordx4 v[24:27], v8, s[4:7], s16 offen offset:0 sc1
    s_mov_b64 exec, s[88:89]
    buffer_load_dwordx4 v[28:31], v8, s[4:7], s16 offen offset:1024 sc1
    s_mov_b64 exec, s[90:91]
    buffer_load_dwordx4 v[32:35], v8, s[4:7], s16 offen offset:2048 sc1
    s_mov_b64 exec, -1
gk_261:
gl_263:
    v_max3_u32 v19, v24, v25, v26
    v_max_u32 v19, v19, v27
    v_cmp_eq_u32 vcc, -1, v19
    s_nop 0
    s_cbranch_vccz go_264
    s_mov_b64 s[86:87], vcc
    s_waitcnt vmcnt(8)
    s_mov_b64 exec, s[86:87]
    buffer_load_dwordx4 v[24:27], v8, s[4:7], s16 offen offset:0 sc1
    s_mov_b64 exec, s[88:89]
    buffer_load_dwordx4 v[28:31], v8, s[4:7], s16 offen offset:1024 sc1
    s_mov_b64 exec, s[90:91]
    buffer_load_dwordx4 v[32:35], v8, s[4:7], s16 offen offset:2048 sc1
    s_mov_b64 exec, s[92:93]
    buffer_load_dwordx4 v[36:39], v8, s[4:7], s16 offen offset:3072 sc1
    s_mov_b64 exec, -1
    s_add_u32 s23, s23, 1
    s_cmp_ge_u32 s23, 200000
    s_cselect_b32 s25, 200000, s25
    s_cbranch_scc1 go_264
    s_branch gl_263
go_264:
    v_mfma_f32_16x16x32_bf16 v[40:43], a[192:195], v[24:27], v[40:43]
    v_mfma_f32_16x16x32_bf16 v[44:47], a[196:199], v[24:27], v[44:47]
    v_mfma_f32_16x16x32_bf16 v[48:51], a[224:227], v[24:27], v[48:51]
    v_mfma_f32_16x16x32_bf16 v[52:55], a[228:231], v[24:27], v[52:55]
gd_262:
    s_cmp_eq_u64 s[88:89], 0
    s_cbranch_scc1 gd_265
gl_266:
    v_max3_u32 v19, v28, v29, v30
    v_max_u32 v19, v19, v31
    v_cmp_eq_u32 vcc, -1, v19
    s_nop 0
    s_cbranch_vccz go_267
    s_mov_b64 s[88:89], vcc
    s_waitcnt vmcnt(6)
    s_mov_b64 exec, s[88:89]
    buffer_load_dwordx4 v[28:31], v8, s[4:7], s16 offen offset:1024 sc1
    s_mov_b64 exec, s[90:91]
    buffer_load_dwordx4 v[32:35], v8, s[4:7], s16 offen offset:2048 sc1
    s_mov_b64 exec, s[92:93]
    buffer_load_dwordx4 v[36:39], v8, s[4:7], s16 offen offset:3072 sc1
    s_mov_b64 exec, -1
    s_add_u32 s23, s23, 1
    s_cmp_ge_u32 s23, 200000
    s_cselect_b32 s25, 200000, s25
    s_cbranch_scc1 go_267
    s_branch gl_266
go_267:
    v_mfma_f32_16x16x32_bf16 v[40:43], a[200:203], v[28:31], v[40:43]
    v_mfma_f32_16x16x32_bf16 v[44:47], a[204:207], v[28:31], v[44:47]
    v_mfma_f32_16x16x32_bf16 v[48:51], a[232:235], v[28:31], v[48:51]
    v_mfma_f32_16x16x32_bf16 v[52:55], a[236:239], v[28:31], v[52:55]
gd_265:
    s_cmp_eq_u64 s[90:91], 0
    s_cbranch_scc1 gd_268
gl_269:
    v_max3_u32 v19, v32, v33, v34
    v_max_u32 v19, v19, v35
    v_cmp_eq_u32 vcc, -1, v19
    s_nop 0
    s_cbranch_vccz go_270
    s_mov_b64 s[90:91], vcc
    s_waitcnt vmcnt(4)
    s_mov_b64 exec, s[90:91]
    buffer_load_dwordx4 v[32:35], v8, s[4:7], s16 offen offset:2048 sc1
    s_mov_b64 exec, s[92:93]
    buffer_load_dwordx4 v[36:39], v8, s[4:7], s16 offen offset:3072 sc1
    s_mov_b64 exec, -1
    s_add_u32 s23, s23, 1
    s_cmp_ge_u32 s23, 200000
    s_cselect_b32 s25, 200000, s25
    s_cbranch_scc1 go_270
    s_branch gl_269
go_270:
    v_mfma_f32_16x16x32_bf16 v[40:43], a[208:211], v[32:35], v[40:43]
    v_mfma_f32_16x16x32_bf16 v[44:47], a[212:215], v[32:35], v[44:47]
    v_mfma_f32_16x16x32_bf16 v[48:51], a[240:243], v[32:35], v[48:51]
    v_mfma_f32_16x16x32_bf16 v[52:55], a[244:247], v[32:35], v[52:55]
gd_268:
    s_cmp_eq_u64 s[92:93], 0
    s_cbranch_scc1 gd_271
gl_272:
    v_max3_u32 v19, v36, v37, v38
    v_max_u32 v19, v19, v39
    v_cmp_eq_u32 vcc, -1, v19
    s_nop 0
    s_cbranch_vccz go_273
    s_mov_b64 s[92:93], vcc
    s_waitcnt vmcnt(2)
    s_mov_b64 exec, s[92:93]
    buffer_load_dwordx4 v[36:39], v8, s[4:7], s16 offen offset:3072 sc1
    s_mov_b64 exec, -1
    s_add_u32 s23, s23, 1
    s_cmp_ge_u32 s23, 200000
    s_cselect_b32 s25, 200000, s25
    s_cbranch_scc1 go_273
    s_branch gl_272
go_273:
    v_mfma_f32_16x16x32_bf16 v[40:43], a[216:219], v[36:39], v[40:43]
    v_mfma_f32_16x16x32_bf16 v[44:47], a[220:223], v[36:39], v[44:47]
    v_mfma_f32_16x16x32_bf16 v[48:51], a[248:251], v[36:39], v[48:51]
    v_mfma_f32_16x16x32_bf16 v[52:55], a[252:255], v[36:39], v[52:55]
gd_271:
    s_branch gc_254
gs_256:
    s_mov_b64 s[88:89], vcc
    s_mov_b64 exec, s[88:89]
    buffer_load_dwordx4 v[28:31], v8, s[4:7], s16 offen offset:1024 sc1
    s_mov_b64 exec, -1
    s_waitcnt vmcnt(1)
    v_max3_u32 v19, v32, v33, v34
    v_max_u32 v19, v19, v35
    v_cmp_eq_u32 s[90:91], -1, v19
    v_max3_u32 v19, v36, v37, v38
    v_max_u32 v19, v19, v39
    v_cmp_eq_u32 s[92:93], -1, v19
    s_mov_b64 exec, s[90:91]
    buffer_load_dwordx4 v[32:35], v8, s[4:7], s16 offen offset:2048 sc1
    s_mov_b64 exec, s[92:93]
    buffer_load_dwordx4 v[36:39], v8, s[4:7], s16 offen offset:3072 sc1
    s_mov_b64 exec, -1
    s_cmp_lg_u64 s[90:91], 0
    s_cbranch_scc1 gk_274
    v_mfma_f32_16x16x32_bf16 v[40:43], a[208:211], v[32:35], v[40:43]
    v_mfma_f32_16x16x32_bf16 v[44:47], a[212:215], v[32:35], v[44:47]
    v_mfma_f32_16x16x32_bf16 v[48:51], a[240:243], v[32:35], v[48:51]
    v_mfma_f32_16x16x32_bf16 v[52:55], a[244:247], v[32:35], v[52:55]
    s_mov_b64 exec, s[88:89]
    buffer_load_dwordx4 v[28:31], v8, s[4:7], s16 offen offset:1024 sc1
    s_mov_b64 exec, s[92:93]
    buffer_load_dwordx4 v[36:39], v8, s[4:7], s16 offen offset:3072 sc1
    s_mov_b64 exec, -1
gk_274:
    s_cmp_lg_u64 s[92:93], 0
    s_cbranch_scc1 gk_275
    v_mfma_f32_16x16x32_bf16 v[40:43], a[216:219], v[36:39], v[40:43]
    v_mfma_f32_16x16x32_bf16 v[44:47], a[220:223], v[36:39], v[44:47]
    v_mfma_f32_16x16x32_bf16 v[48:51], a[248:251], v[36:39], v[48:51]
    v_mfma_f32_16x16x32_bf16 v[52:55], a[252:255], v[36:39], v[52:55]
    s_mov_b64 exec, s[88:89]
    buffer_load_dwordx4 v[28:31], v8, s[4:7], s16 offen offset:1024 sc1
    s_mov_b64 exec, s[90:91]
    buffer_load_dwordx4 v[32:35], v8, s[4:7], s16 offen offset:2048 sc1
    s_mov_b64 exec, -1
gk_275:
gl_277:
    v_max3_u32 v19, v28, v29, v30
    v_max_u32 v19, v19, v31
    v_cmp_eq_u32 vcc, -1, v19
    s_nop 0
    s_cbranch_vccz go_278
    s_mov_b64 s[88:89], vcc
    s_waitcnt vmcnt(6)
    s_mov_b64 exec, s[88:89]
    buffer_load_dwordx4 v[28:31], v8, s[4:7], s16 offen offset:1024 sc1
    s_mov_b64 exec, s[90:91]
    buffer_load_dwordx4 v[32:35], v8, s[4:7], s16 offen offset:2048 sc1
    s_mov_b64 exec, s[92:93]
    buffer_load_dwordx4 v[36:39], v8, s[4:7], s16 offen offset:3072 sc1
    s_mov_b64 exec, -1
    s_add_u32 s23, s23, 1
    s_cmp_ge_u32 s23, 200000
    s_cselect_b32 s25, 200000, s25
    s_cbranch_scc1 go_278
    s_branch gl_277
go_278:
    v_mfma_f32_16x16x32_bf16 v[40:43], a[200:203], v[28:31], v[40:43]
    v_mfma_f32_16x16x32_bf16 v[44:47], a[204:207], v[28:31], v[44:47]
    v_mfma_f32_16x16x32_bf16 v[48:51], a[232:235], v[28:31], v[48:51]
    v_mfma_f32_16x16x32_bf16 v[52:55], a[236:239], v[28:31], v[52:55]
gd_276:
    s_cmp_eq_u64 s[90:91], 0
    s_cbranch_scc1 gd_279
gl_280:
    v_max3_u32 v19, v32, v33, v34
    v_max_u32 v19, v19, v35
    v_cmp_eq_u32 vcc, -1, v19
    s_nop 0
    s_cbranch_vccz go_281
    s_mov_b64 s[90:91], vcc
    s_waitcnt vmcnt(4)
    s_mov_b64 exec, s[90:91]
    buffer_load_dwordx4 v[32:35], v8, s[4:7], s16 offen offset:2048 sc1
    s_mov_b64 exec, s[92:93]
    buffer_load_dwordx4 v[36:39], v8, s[4:7], s16 offen offset:3072 sc1
    s_mov_b64 exec, -1
    s_add_u32 s23, s23, 1
    s_cmp_ge_u32 s23, 200000
    s_cselect_b32 s25, 200000, s25
    s_cbranch_scc1 go_281
    s_branch gl_280
go_281:
    v_mfma_f32_16x16x32_bf16 v[40:43], a[208:211], v[32:35], v[40:43]
    v_mfma_f32_16x16x32_bf16 v[44:47], a[212:215], v[32:35], v[44:47]
    v_mfma_f32_16x16x32_bf16 v[48:51], a[240:243], v[32:35], v[48:51]
    v_mfma_f32_16x16x32_bf16 v[52:55], a[244:247], v[32:35], v[52:55]
gd_279:
    s_cmp_eq_u64 s[92:93], 0
    s_cbranch_scc1 gd_282
gl_283:
    v_max3_u32 v19, v36, v37, v38
    v_max_u32 v19, v19, v39
    v_cmp_eq_u32 vcc, -1, v19
    s_nop 0
    s_cbranch_vccz go_284
    s_mov_b64 s[92:93], vcc
    s_waitcnt vmcnt(2)
    s_mov_b64 exec, s[92:93]
    buffer_load_dwordx4 v[36:39], v8, s[4:7], s16 offen offset:3072 sc1
    s_mov_b64 exec, -1
    s_add_u32 s23, s23, 1
    s_cmp_ge_u32 s23, 200000
    s_cselect_b32 s25, 200000, s25
    s_cbranch_scc1 go_284
    s_branch gl_283
go_284:
    v_mfma_f32_16x16x32_bf16 v[40:43], a[216:219], v[36:39], v[40:43]
    v_mfma_f32_16x16x32_bf16 v[44:47], a[220:223], v[36:39], v[44:47]
    v_mfma_f32_16x16x32_bf16 v[48:51], a[248:251], v[36:39], v[48:51]
    v_mfma_f32_16x16x32_bf16 v[52:55], a[252:255], v[36:39], v[52:55]
gd_282:
    s_branch gc_254
gs_257:
    s_mov_b64 s[90:91], vcc
    s_mov_b64 exec, s[90:91]
    buffer_load_dwordx4 v[32:35], v8, s[4:7], s16 offen offset:2048 sc1
    s_mov_b64 exec, -1
    s_waitcnt vmcnt(1)
    v_max3_u32 v19, v36, v37, v38
    v_max_u32 v19, v19, v39
    v_cmp_eq_u32 s[92:93], -1, v19
    s_nop 0
    s_mov_b64 exec, s[92:93]
    buffer_load_dwordx4 v[36:39], v8, s[4:7], s16 offen offset:3072 sc1
    s_mov_b64 exec, -1
    s_cmp_lg_u64 s[92:93], 0
    s_cbranch_scc1 gk_285
    v_mfma_f32_16x16x32_bf16 v[40:43], a[216:219], v[36:39], v[40:43]
    v_mfma_f32_16x16x32_bf16 v[44:47], a[220:223], v[36:39], v[44:47]
    v_mfma_f32_16x16x32_bf16 v[48:51], a[248:251], v[36:39], v[48:51]
    v_mfma_f32_16x16x32_bf16 v[52:55], a[252:255], v[36:39], v[52:55]
    s_mov_b64 exec, s[90:91]
    buffer_load_dwordx4 v[32:35], v8, s[4:7], s16 offen offset:2048 sc1
    s_mov_b64 exec, -1
gk_285:
gl_287:
    v_max3_u32 v19, v32, v33, v34
    v_max_u32 v19, v19, v35
    v_cmp_eq_u32 vcc, -1, v19
    s_nop 0
    s_cbranch_vccz go_288
    s_mov_b64 s[90:91], vcc
    s_waitcnt vmcnt(4)
    s_mov_b64 exec, s[90:91]
    buffer_load_dwordx4 v[32:35], v8, s[4:7], s16 offen offset:2048 sc1
    s_mov_b64 exec, s[92:93]
    buffer_load_dwordx4 v[36:39], v8, s[4:7], s16 offen offset:3072 sc1
    s_mov_b64 exec, -1
    s_add_u32 s23, s23, 1
    s_cmp_ge_u32 s23, 200000
    s_cselect_b32 s25, 200000, s25
    s_cbranch_scc1 go_288
    s_branch gl_287
go_288:
    v_mfma_f32_16x16x32_bf16 v[40:43], a[208:211], v[32:35], v[40:43]
    v_mfma_f32_16x16x32_bf16 v[44:47], a[212:215], v[32:35], v[44:47]
    v_mfma_f32_16x16x32_bf16 v[48:51], a[240:243], v[32:35], v[48:51]
    v_mfma_f32_16x16x32_bf16 v[52:55], a[244:247], v[32:35], v[52:55]
gd_286:
    s_cmp_eq_u64 s[92:93], 0
    s_cbranch_scc1 gd_289
gl_290:
    v_max3_u32 v19, v36, v37, v38
    v_max_u32 v19, v19, v39
    v_cmp_eq_u32 vcc, -1, v19
    s_nop 0
    s_cbranch_vccz go_291
    s_mov_b64 s[92:93], vcc
    s_waitcnt vmcnt(2)
    s_mov_b64 exec, s[92:93]
    buffer_load_dwordx4 v[36:39], v8, s[4:7], s16 offen offset:3072 sc1
    s_mov_b64 exec, -1
    s_add_u32 s23, s23, 1
    s_cmp_ge_u32 s23, 200000
    s_cselect_b32 s25, 200000, s25
    s_cbranch_scc1 go_291
    s_branch gl_290
go_291:
    v_mfma_f32_16x16x32_bf16 v[40:43], a[216:219], v[36:39], v[40:43]
    v_mfma_f32_16x16x32_bf16 v[44:47], a[220:223], v[36:39], v[44:47]
    v_mfma_f32_16x16x32_bf16 v[48:51], a[248:251], v[36:39], v[48:51]
    v_mfma_f32_16x16x32_bf16 v[52:55], a[252:255], v[36:39], v[52:55]
gd_289:
    s_branch gc_254
gs_258:
    s_mov_b64 s[92:93], vcc
    s_mov_b64 exec, s[92:93]
    buffer_load_dwordx4 v[36:39], v8, s[4:7], s16 offen offset:3072 sc1
    s_mov_b64 exec, -1
gl_293:
    v_max3_u32 v19, v36, v37, v38
    v_max_u32 v19, v19, v39
    v_cmp_eq_u32 vcc, -1, v19
    s_nop 0
    s_cbranch_vccz go_294
    s_mov_b64 s[92:93], vcc
    s_waitcnt vmcnt(2)
    s_mov_b64 exec, s[92:93]
    buffer_load_dwordx4 v[36:39], v8, s[4:7], s16 offen offset:3072 sc1
    s_mov_b64 exec, -1
    s_add_u32 s23, s23, 1
    s_cmp_ge_u32 s23, 200000
    s_cselect_b32 s25, 200000, s25
    s_cbranch_scc1 go_294
    s_branch gl_293
go_294:
    v_mfma_f32_16x16x32_bf16 v[40:43], a[216:219], v[36:39], v[40:43]
    v_mfma_f32_16x16x32_bf16 v[44:47], a[220:223], v[36:39], v[44:47]
    v_mfma_f32_16x16x32_bf16 v[48:51], a[248:251], v[36:39], v[48:51]
    v_mfma_f32_16x16x32_bf16 v[52:55], a[252:255], v[36:39], v[52:55]
gd_292:
    s_branch gc_254
.p2align 6
recur_fast_w3:
    s_nop 11
    s_mov_b32 s23, s25
    buffer_load_dwordx4 v[24:27], v2, s[4:7], s16 offen offset:0 sc1
    buffer_load_dwordx4 v[28:31], v2, s[4:7], s16 offen offset:1024 sc1
    buffer_load_dwordx4 v[32:35], v2, s[4:7], s16 offen offset:2048 sc1
    buffer_load_dwordx4 v[36:39], v2, s[4:7], s16 offen offset:3072 sc1
    s_waitcnt vmcnt(3)
    v_max3_u32 v19, v24, v25, v26
    v_max_u32 v19, v19, v27
    v_cmp_eq_u32 vcc, -1, v19
    s_nop 0
    s_cbranch_vccnz gs_296
    v_mfma_f32_16x16x32_bf16 v[40:43], a[0:3], v[24:27], v[40:43]
    v_mfma_f32_16x16x32_bf16 v[44:47], a[4:7], v[24:27], v[44:47]
    v_mfma_f32_16x16x32_bf16 v[56:59], a[64:67], v[24:27], v[56:59]
    v_mfma_f32_16x16x32_bf16 v[60:63], a[68:71], v[24:27], v[60:63]
    v_mfma_f32_16x16x32_bf16 v[48:51], a[32:35], v[24:27], v[48:51]
    s_waitcnt vmcnt(2)
    v_max3_u32 v19, v28, v29, v30
    v_mfma_f32_16x16x32_bf16 v[52:55], a[36:39], v[24:27], v[52:55]
    v_max_u32 v19, v19, v31
    v_mfma_f32_16x16x32_bf16 v[64:67], a[96:99], v[24:27], v[64:67]
    v_cmp_eq_u32 vcc, -1, v19
    v_mfma_f32_16x16x32_bf16 v[68:71], a[100:103], v[24:27], v[68:71]
    s_cbranch_vccnz gs_297
    v_mfma_f32_16x16x32_bf16 v[40:43], a[8:11], v[28:31], v[40:43]
    v_mfma_f32_16x16x32_bf16 v[44:47], a[12:15], v[28:31], v[44:47]
    v_mfma_f32_16x16x32_bf16 v[56:59], a[72:75], v[28:31], v[56:59]
    v_mfma_f32_16x16x32_bf16 v[60:63], a[76:79], v[28:31], v[60:63]
    v_mfma_f32_16x16x32_bf16 v[48:51], a[40:43], v[28:31], v[48:51]
    s_waitcnt vmcnt(1)
    v_max3_u32 v19, v32, v33, v34
    v_mfma_f32_16x16x32_bf16 v[52:55], a[44:47], v[28:31], v[52:55]
    v_max_u32 v19, v19, v35
    v_mfma_f32_16x16x32_bf16 v[64:67], a[104:107], v[28:31], v[64:67]
    v_cmp_eq_u32 vcc, -1, v19
    v_mfma_f32_16x16x32_bf16 v[68:71], a[108:111], v[28:31], v[68:71]
    s_cbranch_vccnz gs_298
    v_mfma_f32_16x16x32_bf16 v[40:43], a[16:19], v[32:35], v[40:43]
    v_mfma_f32_16x16x32_bf16 v[44:47], a[20:23], v[32:35], v[44:47]
    v_mfma_f32_16x16x32_bf16 v[56:59], a[80:83], v[32:35], v[56:59]
    v_mfma_f32_16x16x32_bf16 v[60:63], a[84:87], v[32:35], v[60:63]
    v_mfma_f32_16x16x32_bf16 v[48:51], a[48:51], v[32:35], v[48:51]
    s_waitcnt vmcnt(0)
    v_max3_u32 v19, v36, v37, v38
    v_mfma_f32_16x16x32_bf16 v[52:55], a[52:55], v[32:35], v[52:55]
    v_max_u32 v19, v19, v39
    v_mfma_f32_16x16x32_bf16 v[64:67], a[112:115], v[32:35], v[64:67]
    v_cmp_eq_u32 vcc, -1, v19
    v_mfma_f32_16x16x32_bf16 v[68:71], a[116:119], v[32:35], v[68:71]
    s_cbranch_vccnz gs_299
    v_mfma_f32_16x16x32_bf16 v[40:43], a[24:27], v[36:39], v[40:43]
    v_mfma_f32_16x16x32_bf16 v[44:47], a[28:31], v[36:39], v[44:47]
    v_mfma_f32_16x16x32_bf16 v[56:59], a[88:91], v[36:39], v[56:59]
    v_mfma_f32_16x16x32_bf16 v[60:63], a[92:95], v[36:39], v[60:63]
    v_mfma_f32_16x16x32_bf16 v[48:51], a[56:59], v[36:39], v[48:51]
    v_mfma_f32_16x16x32_bf16 v[52:55], a[60:63], v[36:39], v[52:55]
    v_mfma_f32_16x16x32_bf16 v[64:67], a[120:123], v[36:39], v[64:67]
    v_mfma_f32_16x16x32_bf16 v[68:71], a[124:127], v[36:39], v[68:71]
gc_295:
    s_nop 1
    v_add_f32_dpp v88, v44, v40 row_ror:8 row_mask:0xf bank_mask:0x3
    v_add_f32_dpp v89, v45, v41 row_ror:8 row_mask:0xf bank_mask:0x3
    v_add_f32_dpp v90, v46, v42 row_ror:8 row_mask:0xf bank_mask:0x3
    v_add_f32_dpp v91, v47, v43 row_ror:8 row_mask:0xf bank_mask:0x3
    v_add_f32_dpp v88, v56, v60 row_ror:8 row_mask:0xf bank_mask:0xc
    v_add_f32_dpp v89, v57, v61 row_ror:8 row_mask:0xf bank_mask:0xc
    v_add_f32_dpp v90, v58, v62 row_ror:8 row_mask:0xf bank_mask:0xc
    v_add_f32_dpp v91, v59, v63 row_ror:8 row_mask:0xf bank_mask:0xc
    ds_write_b128 v17, v[88:91] offset:0
    v_add_f32_dpp v92, v52, v48 row_ror:8 row_mask:0xf bank_mask:0x3
    v_add_f32_dpp v93, v53, v49 row_ror:8 row_mask:0xf bank_mask:0x3
    v_add_f32_dpp v94, v54, v50 row_ror:8 row_mask:0xf bank_mask:0x3
    v_add_f32_dpp v95, v55, v51 row_ror:8 row_mask:0xf bank_mask:0x3
    v_mfma_f32_16x16x32_bf16 v[72:75], v[24:27], a[128:131], 0
    v_add_f32_dpp v92, v64, v68 row_ror:8 row_mask:0xf bank_mask:0xc
    v_add_f32_dpp v93, v65, v69 row_ror:8 row_mask:0xf bank_mask:0xc
    v_add_f32_dpp v94, v66, v70 row_ror:8 row_mask:0xf bank_mask:0xc
    v_add_f32_dpp v95, v67, v71 row_ror:8 row_mask:0xf bank_mask:0xc
    v_mfma_f32_16x16x32_bf16 v[80:83], v[24:27], a[160:163], 0
    ds_write_b128 v17, v[92:95] offset:1024
    v_mfma_f32_16x16x32_bf16 v[76:79], v[24:27], a[132:135], 0
    v_mfma_f32_16x16x32_bf16 v[84:87], v[24:27], a[164:167], 0
    s_waitcnt lgkmcnt(0)
    s_barrier
    v_mfma_f32_16x16x32_bf16 v[72:75], v[28:31], a[136:139], v[72:75]
    v_mfma_f32_16x16x32_bf16 v[80:83], v[28:31], a[168:171], v[80:83]
    v_mfma_f32_16x16x32_bf16 v[76:79], v[28:31], a[140:143], v[76:79]
    v_mfma_f32_16x16x32_bf16 v[84:87], v[28:31], a[172:175], v[84:87]
    v_mfma_f32_16x16x32_bf16 v[72:75], v[32:35], a[144:147], v[72:75]
    v_mfma_f32_16x16x32_bf16 v[80:83], v[32:35], a[176:179], v[80:83]
    v_mfma_f32_16x16x32_bf16 v[76:79], v[32:35], a[148:151], v[76:79]
    v_mfma_f32_16x16x32_bf16 v[84:87], v[32:35], a[180:183], v[84:87]
    v_mfma_f32_16x16x32_bf16 v[72:75], v[36:39], a[152:155], v[72:75]
    v_mfma_f32_16x16x32_bf16 v[80:83], v[36:39], a[184:187], v[80:83]
    v_mfma_f32_16x16x32_bf16 v[76:79], v[36:39], a[156:159], v[76:79]
    v_mfma_f32_16x16x32_bf16 v[84:87], v[36:39], a[188:191], v[84:87]
    s_nop 6
    v_mov_b32_dpp v72, v76 quad_perm:[0,1,2,3] row_mask:0xc bank_mask:0xf
    v_mov_b32_dpp v73, v77 quad_perm:[0,1,2,3] row_mask:0xc bank_mask:0xf
    v_mov_b32_dpp v74, v78 quad_perm:[0,1,2,3] row_mask:0xc bank_mask:0xf
    v_mov_b32_dpp v75, v79 quad_perm:[0,1,2,3] row_mask:0xc bank_mask:0xf
    ds_write_b128 v17, v[72:75] offset:8192
    v_mov_b32_dpp v80, v84 quad_perm:[0,1,2,3] row_mask:0xc bank_mask:0xf
    v_mov_b32_dpp v81, v85 quad_perm:[0,1,2,3] row_mask:0xc bank_mask:0xf
    v_mov_b32_dpp v82, v86 quad_perm:[0,1,2,3] row_mask:0xc bank_mask:0xf
    v_mov_b32_dpp v83, v87 quad_perm:[0,1,2,3] row_mask:0xc bank_mask:0xf
    ds_write_b128 v17, v[80:83] offset:9216
    v_mov_b32 v40, 0
    v_mov_b32 v41, 0
    v_mov_b32 v42, 0
    v_mov_b32 v43, 0
    v_mov_b32 v44, 0
    v_mov_b32 v45, 0
    v_mov_b32 v46, 0
    v_mov_b32 v47, 0
    v_mov_b32 v48, 0
    v_mov_b32 v49, 0
    v_mov_b32 v50, 0
    v_mov_b32 v51, 0
    v_mov_b32 v52, 0
    v_mov_b32 v53, 0
    v_mov_b32 v54, 0
    v_mov_b32 v55, 0
    s_waitcnt lgkmcnt(0)
    s_barrier
    s_cmp_eq_u32 s15, 63
    s_cbranch_scc1 recur_end
    s_sleep 2
    buffer_store_dwordx4 v[204:207], v3, s[4:7], s43 offen
    buffer_store_dwordx4 v[204:207], v3, s[4:7], s43 offen offset:128
    buffer_store_dwordx4 v[204:207], v4, s[4:7], s43 offen
    buffer_store_dwordx2 v[204:205], v7, s[4:7], s43 offen
    buffer_store_dwordx2 v[204:205], v11, s[4:7], s43 offen
    s_barrier
    s_sleep 7
    s_nop 12
    s_mov_b32 s23, s25
    buffer_load_dwordx4 v[24:27], v8, s[4:7], s16 offen offset:0 sc1
    buffer_load_dwordx4 v[28:31], v8, s[4:7], s16 offen offset:1024 sc1
    buffer_load_dwordx4 v[32:35], v8, s[4:7], s16 offen offset:2048 sc1
    buffer_load_dwordx4 v[36:39], v8, s[4:7], s16 offen offset:3072 sc1
    s_waitcnt vmcnt(3)
    v_max3_u32 v19, v24, v25, v26
    v_max_u32 v19, v19, v27
    v_cmp_eq_u32 vcc, -1, v19
    s_nop 0
    s_cbranch_vccnz gs_337
    v_mfma_f32_16x16x32_bf16 v[40:43], a[192:195], v[24:27], v[40:43]
    s_waitcnt vmcnt(2)
    v_max3_u32 v19, v28, v29, v30
    v_mfma_f32_16x16x32_bf16 v[44:47], a[196:199], v[24:27], v[44:47]
    v_max_u32 v19, v19, v31
    v_mfma_f32_16x16x32_bf16 v[48:51], a[224:227], v[24:27], v[48:51]
    v_cmp_eq_u32 vcc, -1, v19
    v_mfma_f32_16x16x32_bf16 v[52:55], a[228:231], v[24:27], v[52:55]
    s_cbranch_vccnz gs_338
    v_mfma_f32_16x16x32_bf16 v[40:43], a[200:203], v[28:31], v[40:43]
    s_waitcnt vmcnt(1)
    v_max3_u32 v19, v32, v33, v34
    v_mfma_f32_16x16x32_bf16 v[44:47], a[204:207], v[28:31], v[44:47]
    v_max_u32 v19, v19, v35
    v_mfma_f32_16x16x32_bf16 v[48:51], a[232:235], v[28:31], v[48:51]
    v_cmp_eq_u32 vcc, -1, v19
    v_mfma_f32_16x16x32_bf16 v[52:55], a[236:239], v[28:31], v[52:55]
    s_cbranch_vccnz gs_339
    v_mfma_f32_16x16x32_bf16 v[40:43], a[208:211], v[32:35], v[40:43]
    s_waitcnt vmcnt(0)
    v_max3_u32 v19, v36, v37, v38
    v_mfma_f32_16x16x32_bf16 v[44:47], a[212:215], v[32:35], v[44:47]
    v_max_u32 v19, v19, v39
    v_mfma_f32_16x16x32_bf16 v[48:51], a[240:243], v[32:35], v[48:51]
    v_cmp_eq_u32 vcc, -1, v19
    v_mfma_f32_16x16x32_bf16 v[52:55], a[244:247], v[32:35], v[52:55]
    s_cbranch_vccnz gs_340
    v_mfma_f32_16x16x32_bf16 v[40:43], a[216:219], v[36:39], v[40:43]
    v_mfma_f32_16x16x32_bf16 v[44:47], a[220:223], v[36:39], v[44:47]
    v_mfma_f32_16x16x32_bf16 v[48:51], a[248:251], v[36:39], v[48:51]
    v_mfma_f32_16x16x32_bf16 v[52:55], a[252:255], v[36:39], v[52:55]
gc_336:
    s_nop 5
    v_add_f32_dpp v88, v44, v40 row_ror:8 row_mask:0xf bank_mask:0x3
    v_add_f32_dpp v89, v45, v41 row_ror:8 row_mask:0xf bank_mask:0x3
    v_add_f32_dpp v90, v46, v42 row_ror:8 row_mask:0xf bank_mask:0x3
    v_add_f32_dpp v91, v47, v43 row_ror:8 row_mask:0xf bank_mask:0x3
    v_add_f32_dpp v88, v48, v52 row_ror:8 row_mask:0xf bank_mask:0xc
    v_add_f32_dpp v89, v49, v53 row_ror:8 row_mask:0xf bank_mask:0xc
    v_add_f32_dpp v90, v50, v54 row_ror:8 row_mask:0xf bank_mask:0xc
    v_add_f32_dpp v91, v51, v55 row_ror:8 row_mask:0xf bank_mask:0xc
    s_barrier
    ds_read_b128 v[96:99], v16 offset:16384
    ds_read_b128 v[100:103], v16 offset:18432
    ds_read_b128 v[104:107], v16 offset:20480
    s_waitcnt lgkmcnt(1)
    v_add_f32 v96, v96, v100
    v_add_f32 v97, v97, v101
    v_add_f32 v98, v98, v102
    v_add_f32 v99, v99, v103
    s_waitcnt lgkmcnt(0)
    v_add_f32 v104, v104, v88
    v_add_f32 v105, v105, v89
    v_add_f32 v106, v106, v90
    v_add_f32 v107, v107, v91
    v_add_f32 v88, v96, v104
    v_add_f32 v89, v97, v105
    v_add_f32 v90, v98, v106
    v_add_f32 v91, v99, v107
    buffer_store_dwordx4 v[88:91], v9, s[4:7], s84 offen sc1
    s_add_u32 s22, s84, 131072
    buffer_store_dwordx4 v[88:91], v9, s[4:7], s22 offen sc1
    v_mov_b32 v40, 0
    v_mov_b32 v41, 0
    v_mov_b32 v42, 0
    v_mov_b32 v43, 0
    v_mov_b32 v44, 0
    v_mov_b32 v45, 0
    v_mov_b32 v46, 0
    v_mov_b32 v47, 0
    v_mov_b32 v48, 0
    v_mov_b32 v49, 0
    v_mov_b32 v50, 0
    v_mov_b32 v51, 0
    v_mov_b32 v52, 0
    v_mov_b32 v53, 0
    v_mov_b32 v54, 0
    v_mov_b32 v55, 0
    v_mov_b32 v56, 0
    v_mov_b32 v57, 0
    v_mov_b32 v58, 0
    v_mov_b32 v59, 0
    v_mov_b32 v60, 0
    v_mov_b32 v61, 0
    v_mov_b32 v62, 0
    v_mov_b32 v63, 0
    v_mov_b32 v64, 0
    v_mov_b32 v65, 0
    v_mov_b32 v66, 0
    v_mov_b32 v67, 0
    v_mov_b32 v68, 0
    v_mov_b32 v69, 0
    v_mov_b32 v70, 0
    v_mov_b32 v71, 0
    s_sleep 5
    s_mov_b32 s23, s25
    buffer_load_dwordx4 v[96:99], v10, s[4:7], s84 offen sc1
    buffer_load_dwordx4 v[100:103], v23, s[4:7], s84 offen sc1
    buffer_load_dwordx4 v[104:107], v244, s[4:7], s84 offen sc1
    s_sleep 3
    buffer_load_dwordx4 v[108:111], v10, s[4:7], s22 offen sc1
    buffer_load_dwordx4 v[112:115], v23, s[4:7], s22 offen sc1
    buffer_load_dwordx4 v[116:119], v244, s[4:7], s22 offen sc1
    s_waitcnt vmcnt(3)
    v_max3_u32 v19, v96, v97, v98
    v_max3_u32 v19, v19, v99, v100
    v_max3_u32 v19, v19, v101, v102
    v_max3_u32 v19, v19, v103, v104
    v_max3_u32 v19, v19, v105, v106
    v_max_u32 v19, v19, v107
    v_cmp_eq_u32 vcc, -1, v19
    v_add_f32 v124, v88, v96
    v_add_f32 v125, v89, v97
    v_add_f32 v126, v90, v98
    v_add_f32 v127, v91, v99
    s_cbranch_vccnz pr_377
    s_barrier
    v_add_f32 v120, v100, v104
    v_add_f32 v121, v101, v105
    v_add_f32 v122, v102, v106
    v_add_f32 v123, v103, v107
    v_add_f32 v120, v124, v120
    v_add_f32 v121, v125, v121
    v_add_f32 v122, v126, v122
    v_add_f32 v123, v127, v123
    v_cvt_pk_bf16_f32 v180, v120, v121
    v_cvt_pk_bf16_f32 v181, v122, v123
    buffer_store_dwordx2 v[180:181], v11, s[4:7], s42 offen
pf_379:
    s_mov_b32 s23, s25
    s_mov_b32 s21, s16
    s_mov_b32 s16, s42
    s_mov_b32 s42, s43
    s_mov_b32 s43, s44
    s_mov_b32 s44, s21
    s_add_u32 s84, s84, 262144
    s_add_u32 s15, s15, 1
    s_branch recur_fast_w3
gs_296:
    s_mov_b64 s[86:87], vcc
    s_mov_b64 exec, s[86:87]
    buffer_load_dwordx4 v[24:27], v2, s[4:7], s16 offen offset:0 sc1
    s_mov_b64 exec, -1
    s_waitcnt vmcnt(1)
    v_max3_u32 v19, v28, v29, v30
    v_max_u32 v19, v19, v31
    v_cmp_eq_u32 s[88:89], -1, v19
    v_max3_u32 v19, v32, v33, v34
    v_max_u32 v19, v19, v35
    v_cmp_eq_u32 s[90:91], -1, v19
    v_max3_u32 v19, v36, v37, v38
    v_max_u32 v19, v19, v39
    v_cmp_eq_u32 s[92:93], -1, v19
    s_mov_b64 exec, s[88:89]
    buffer_load_dwordx4 v[28:31], v2, s[4:7], s16 offen offset:1024 sc1
    s_mov_b64 exec, s[90:91]
    buffer_load_dwordx4 v[32:35], v2, s[4:7], s16 offen offset:2048 sc1
    s_mov_b64 exec, s[92:93]
    buffer_load_dwordx4 v[36:39], v2, s[4:7], s16 offen offset:3072 sc1
    s_mov_b64 exec, -1
    s_cmp_lg_u64 s[88:89], 0
    s_cbranch_scc1 gk_300
    v_mfma_f32_16x16x32_bf16 v[40:43], a[8:11], v[28:31], v[40:43]
    v_mfma_f32_16x16x32_bf16 v[44:47], a[12:15], v[28:31], v[44:47]
    v_mfma_f32_16x16x32_bf16 v[56:59], a[72:75], v[28:31], v[56:59]
    v_mfma_f32_16x16x32_bf16 v[60:63], a[76:79], v[28:31], v[60:63]
    v_mfma_f32_16x16x32_bf16 v[48:51], a[40:43], v[28:31], v[48:51]
    v_mfma_f32_16x16x32_bf16 v[52:55], a[44:47], v[28:31], v[52:55]
    v_mfma_f32_16x16x32_bf16 v[64:67], a[104:107], v[28:31], v[64:67]
    v_mfma_f32_16x16x32_bf16 v[68:71], a[108:111], v[28:31], v[68:71]
    s_mov_b64 exec, s[86:87]
    buffer_load_dwordx4 v[24:27], v2, s[4:7], s16 offen offset:0 sc1
    s_mov_b64 exec, s[90:91]
    buffer_load_dwordx4 v[32:35], v2, s[4:7], s16 offen offset:2048 sc1
    s_mov_b64 exec, s[92:93]
    buffer_load_dwordx4 v[36:39], v2, s[4:7], s16 offen offset:3072 sc1
    s_mov_b64 exec, -1
gk_300:
    s_cmp_lg_u64 s[90:91], 0
    s_cbranch_scc1 gk_301
    v_mfma_f32_16x16x32_bf16 v[40:43], a[16:19], v[32:35], v[40:43]
    v_mfma_f32_16x16x32_bf16 v[44:47], a[20:23], v[32:35], v[44:47]
    v_mfma_f32_16x16x32_bf16 v[56:59], a[80:83], v[32:35], v[56:59]
    v_mfma_f32_16x16x32_bf16 v[60:63], a[84:87], v[32:35], v[60:63]
    v_mfma_f32_16x16x32_bf16 v[48:51], a[48:51], v[32:35], v[48:51]
    v_mfma_f32_16x16x32_bf16 v[52:55], a[52:55], v[32:35], v[52:55]
    v_mfma_f32_16x16x32_bf16 v[64:67], a[112:115], v[32:35], v[64:67]
    v_mfma_f32_16x16x32_bf16 v[68:71], a[116:119], v[32:35], v[68:71]
    s_mov_b64 exec, s[86:87]
    buffer_load_dwordx4 v[24:27], v2, s[4:7], s16 offen offset:0 sc1
    s_mov_b64 exec, s[88:89]
    buffer_load_dwordx4 v[28:31], v2, s[4:7], s16 offen offset:1024 sc1
    s_mov_b64 exec, s[92:93]
    buffer_load_dwordx4 v[36:39], v2, s[4:7], s16 offen offset:3072 sc1
    s_mov_b64 exec, -1
gk_301:
    s_cmp_lg_u64 s[92:93], 0
    s_cbranch_scc1 gk_302
    v_mfma_f32_16x16x32_bf16 v[40:43], a[24:27], v[36:39], v[40:43]
    v_mfma_f32_16x16x32_bf16 v[44:47], a[28:31], v[36:39], v[44:47]
    v_mfma_f32_16x16x32_bf16 v[56:59], a[88:91], v[36:39], v[56:59]
    v_mfma_f32_16x16x32_bf16 v[60:63], a[92:95], v[36:39], v[60:63]
    v_mfma_f32_16x16x32_bf16 v[48:51], a[56:59], v[36:39], v[48:51]
    v_mfma_f32_16x16x32_bf16 v[52:55], a[60:63], v[36:39], v[52:55]
    v_mfma_f32_16x16x32_bf16 v[64:67], a[120:123], v[36:39], v[64:67]
    v_mfma_f32_16x16x32_bf16 v[68:71], a[124:127], v[36:39], v[68:71]
    s_mov_b64 exec, s[86:87]
    buffer_load_dwordx4 v[24:27], v2, s[4:7], s16 offen offset:0 sc1
    s_mov_b64 exec, s[88:89]
    buffer_load_dwordx4 v[28:31], v2, s[4:7], s16 offen offset:1024 sc1
    s_mov_b64 exec, s[90:91]
    buffer_load_dwordx4 v[32:35], v2, s[4:7], s16 offen offset:2048 sc1
    s_mov_b64 exec, -1
gk_302:
gl_304:
    v_max3_u32 v19, v24, v25, v26
    v_max_u32 v19, v19, v27
    v_cmp_eq_u32 vcc, -1, v19
    s_nop 0
    s_cbranch_vccz go_305
    s_mov_b64 s[86:87], vcc
    s_waitcnt vmcnt(8)
    s_mov_b64 exec, s[86:87]
    buffer_load_dwordx4 v[24:27], v2, s[4:7], s16 offen offset:0 sc1
    s_mov_b64 exec, s[88:89]
    buffer_load_dwordx4 v[28:31], v2, s[4:7], s16 offen offset:1024 sc1
    s_mov_b64 exec, s[90:91]
    buffer_load_dwordx4 v[32:35], v2, s[4:7], s16 offen offset:2048 sc1
    s_mov_b64 exec, s[92:93]
    buffer_load_dwordx4 v[36:39], v2, s[4:7], s16 offen offset:3072 sc1
    s_mov_b64 exec, -1
    s_add_u32 s23, s23, 1
    s_cmp_ge_u32 s23, 200000
    s_cselect_b32 s25, 200000, s25
    s_cbranch_scc1 go_305
    s_branch gl_304
go_305:
    v_mfma_f32_16x16x32_bf16 v[40:43], a[0:3], v[24:27], v[40:43]
    v_mfma_f32_16x16x32_bf16 v[44:47], a[4:7], v[24:27], v[44:47]
    v_mfma_f32_16x16x32_bf16 v[56:59], a[64:67], v[24:27], v[56:59]
    v_mfma_f32_16x16x32_bf16 v[60:63], a[68:71], v[24:27], v[60:63]
    v_mfma_f32_16x16x32_bf16 v[48:51], a[32:35], v[24:27], v[48:51]
    v_mfma_f32_16x16x32_bf16 v[52:55], a[36:39], v[24:27], v[52:55]
    v_mfma_f32_16x16x32_bf16 v[64:67], a[96:99], v[24:27], v[64:67]
    v_mfma_f32_16x16x32_bf16 v[68:71], a[100:103], v[24:27], v[68:71]
gd_303:
    s_cmp_eq_u64 s[88:89], 0
    s_cbranch_scc1 gd_306
gl_307:
    v_max3_u32 v19, v28, v29, v30
    v_max_u32 v19, v19, v31
    v_cmp_eq_u32 vcc, -1, v19
    s_nop 0
    s_cbranch_vccz go_308
    s_mov_b64 s[88:89], vcc
    s_waitcnt vmcnt(6)
    s_mov_b64 exec, s[88:89]
    buffer_load_dwordx4 v[28:31], v2, s[4:7], s16 offen offset:1024 sc1
    s_mov_b64 exec, s[90:91]
    buffer_load_dwordx4 v[32:35], v2, s[4:7], s16 offen offset:2048 sc1
    s_mov_b64 exec, s[92:93]
    buffer_load_dwordx4 v[36:39], v2, s[4:7], s16 offen offset:3072 sc1
    s_mov_b64 exec, -1
    s_add_u32 s23, s23, 1
    s_cmp_ge_u32 s23, 200000
    s_cselect_b32 s25, 200000, s25
    s_cbranch_scc1 go_308
    s_branch gl_307
go_308:
    v_mfma_f32_16x16x32_bf16 v[40:43], a[8:11], v[28:31], v[40:43]
    v_mfma_f32_16x16x32_bf16 v[44:47], a[12:15], v[28:31], v[44:47]
    v_mfma_f32_16x16x32_bf16 v[56:59], a[72:75], v[28:31], v[56:59]
    v_mfma_f32_16x16x32_bf16 v[60:63], a[76:79], v[28:31], v[60:63]
    v_mfma_f32_16x16x32_bf16 v[48:51], a[40:43], v[28:31], v[48:51]
    v_mfma_f32_16x16x32_bf16 v[52:55], a[44:47], v[28:31], v[52:55]
    v_mfma_f32_16x16x32_bf16 v[64:67], a[104:107], v[28:31], v[64:67]
    v_mfma_f32_16x16x32_bf16 v[68:71], a[108:111], v[28:31], v[68:71]
gd_306:
    s_cmp_eq_u64 s[90:91], 0
    s_cbranch_scc1 gd_309
gl_310:
    v_max3_u32 v19, v32, v33, v34
    v_max_u32 v19, v19, v35
    v_cmp_eq_u32 vcc, -1, v19
    s_nop 0
    s_cbranch_vccz go_311
    s_mov_b64 s[90:91], vcc
    s_waitcnt vmcnt(4)
    s_mov_b64 exec, s[90:91]
    buffer_load_dwordx4 v[32:35], v2, s[4:7], s16 offen offset:2048 sc1
    s_mov_b64 exec, s[92:93]
    buffer_load_dwordx4 v[36:39], v2, s[4:7], s16 offen offset:3072 sc1
    s_mov_b64 exec, -1
    s_add_u32 s23, s23, 1
    s_cmp_ge_u32 s23, 200000
    s_cselect_b32 s25, 200000, s25
    s_cbranch_scc1 go_311
    s_branch gl_310
go_311:
    v_mfma_f32_16x16x32_bf16 v[40:43], a[16:19], v[32:35], v[40:43]
    v_mfma_f32_16x16x32_bf16 v[44:47], a[20:23], v[32:35], v[44:47]
    v_mfma_f32_16x16x32_bf16 v[56:59], a[80:83], v[32:35], v[56:59]
    v_mfma_f32_16x16x32_bf16 v[60:63], a[84:87], v[32:35], v[60:63]
    v_mfma_f32_16x16x32_bf16 v[48:51], a[48:51], v[32:35], v[48:51]
    v_mfma_f32_16x16x32_bf16 v[52:55], a[52:55], v[32:35], v[52:55]
    v_mfma_f32_16x16x32_bf16 v[64:67], a[112:115], v[32:35], v[64:67]
    v_mfma_f32_16x16x32_bf16 v[68:71], a[116:119], v[32:35], v[68:71]
gd_309:
    s_cmp_eq_u64 s[92:93], 0
    s_cbranch_scc1 gd_312
gl_313:
    v_max3_u32 v19, v36, v37, v38
    v_max_u32 v19, v19, v39
    v_cmp_eq_u32 vcc, -1, v19
    s_nop 0
    s_cbranch_vccz go_314
    s_mov_b64 s[92:93], vcc
    s_waitcnt vmcnt(2)
    s_mov_b64 exec, s[92:93]
    buffer_load_dwordx4 v[36:39], v2, s[4:7], s16 offen offset:3072 sc1
    s_mov_b64 exec, -1
    s_add_u32 s23, s23, 1
    s_cmp_ge_u32 s23, 200000
    s_cselect_b32 s25, 200000, s25
    s_cbranch_scc1 go_314
    s_branch gl_313
go_314:
    v_mfma_f32_16x16x32_bf16 v[40:43], a[24:27], v[36:39], v[40:43]
    v_mfma_f32_16x16x32_bf16 v[44:47], a[28:31], v[36:39], v[44:47]
    v_mfma_f32_16x16x32_bf16 v[56:59], a[88:91], v[36:39], v[56:59]
    v_mfma_f32_16x16x32_bf16 v[60:63], a[92:95], v[36:39], v[60:63]
    v_mfma_f32_16x16x32_bf16 v[48:51], a[56:59], v[36:39], v[48:51]
    v_mfma_f32_16x16x32_bf16 v[52:55], a[60:63], v[36:39], v[52:55]
    v_mfma_f32_16x16x32_bf16 v[64:67], a[120:123], v[36:39], v[64:67]
    v_mfma_f32_16x16x32_bf16 v[68:71], a[124:127], v[36:39], v[68:71]
gd_312:
    s_branch gc_295
gs_297:
    s_mov_b64 s[88:89], vcc
    s_mov_b64 exec, s[88:89]
    buffer_load_dwordx4 v[28:31], v2, s[4:7], s16 offen offset:1024 sc1
    s_mov_b64 exec, -1
    s_waitcnt vmcnt(1)
    v_max3_u32 v19, v32, v33, v34
    v_max_u32 v19, v19, v35
    v_cmp_eq_u32 s[90:91], -1, v19
    v_max3_u32 v19, v36, v37, v38
    v_max_u32 v19, v19, v39
    v_cmp_eq_u32 s[92:93], -1, v19
    s_mov_b64 exec, s[90:91]
    buffer_load_dwordx4 v[32:35], v2, s[4:7], s16 offen offset:2048 sc1
    s_mov_b64 exec, s[92:93]
    buffer_load_dwordx4 v[36:39], v2, s[4:7], s16 offen offset:3072 sc1
    s_mov_b64 exec, -1
    s_cmp_lg_u64 s[90:91], 0
    s_cbranch_scc1 gk_315
    v_mfma_f32_16x16x32_bf16 v[40:43], a[16:19], v[32:35], v[40:43]
    v_mfma_f32_16x16x32_bf16 v[44:47], a[20:23], v[32:35], v[44:47]
    v_mfma_f32_16x16x32_bf16 v[56:59], a[80:83], v[32:35], v[56:59]
    v_mfma_f32_16x16x32_bf16 v[60:63], a[84:87], v[32:35], v[60:63]
    v_mfma_f32_16x16x32_bf16 v[48:51], a[48:51], v[32:35], v[48:51]
    v_mfma_f32_16x16x32_bf16 v[52:55], a[52:55], v[32:35], v[52:55]
    v_mfma_f32_16x16x32_bf16 v[64:67], a[112:115], v[32:35], v[64:67]
    v_mfma_f32_16x16x32_bf16 v[68:71], a[116:119], v[32:35], v[68:71]
    s_mov_b64 exec, s[88:89]
    buffer_load_dwordx4 v[28:31], v2, s[4:7], s16 offen offset:1024 sc1
    s_mov_b64 exec, s[92:93]
    buffer_load_dwordx4 v[36:39], v2, s[4:7], s16 offen offset:3072 sc1
    s_mov_b64 exec, -1
gk_315:
    s_cmp_lg_u64 s[92:93], 0
    s_cbranch_scc1 gk_316
    v_mfma_f32_16x16x32_bf16 v[40:43], a[24:27], v[36:39], v[40:43]
    v_mfma_f32_16x16x32_bf16 v[44:47], a[28:31], v[36:39], v[44:47]
    v_mfma_f32_16x16x32_bf16 v[56:59], a[88:91], v[36:39], v[56:59]
    v_mfma_f32_16x16x32_bf16 v[60:63], a[92:95], v[36:39], v[60:63]
    v_mfma_f32_16x16x32_bf16 v[48:51], a[56:59], v[36:39], v[48:51]
    v_mfma_f32_16x16x32_bf16 v[52:55], a[60:63], v[36:39], v[52:55]
    v_mfma_f32_16x16x32_bf16 v[64:67], a[120:123], v[36:39], v[64:67]
    v_mfma_f32_16x16x32_bf16 v[68:71], a[124:127], v[36:39], v[68:71]
    s_mov_b64 exec, s[88:89]
    buffer_load_dwordx4 v[28:31], v2, s[4:7], s16 offen offset:1024 sc1
    s_mov_b64 exec, s[90:91]
    buffer_load_dwordx4 v[32:35], v2, s[4:7], s16 offen offset:2048 sc1
    s_mov_b64 exec, -1
gk_316:
gl_318:
    v_max3_u32 v19, v28, v29, v30
    v_max_u32 v19, v19, v31
    v_cmp_eq_u32 vcc, -1, v19
    s_nop 0
    s_cbranch_vccz go_319
    s_mov_b64 s[88:89], vcc
    s_waitcnt vmcnt(6)
    s_mov_b64 exec, s[88:89]
    buffer_load_dwordx4 v[28:31], v2, s[4:7], s16 offen offset:1024 sc1
    s_mov_b64 exec, s[90:91]
    buffer_load_dwordx4 v[32:35], v2, s[4:7], s16 offen offset:2048 sc1
    s_mov_b64 exec, s[92:93]
    buffer_load_dwordx4 v[36:39], v2, s[4:7], s16 offen offset:3072 sc1
    s_mov_b64 exec, -1
    s_add_u32 s23, s23, 1
    s_cmp_ge_u32 s23, 200000
    s_cselect_b32 s25, 200000, s25
    s_cbranch_scc1 go_319
    s_branch gl_318
go_319:
    v_mfma_f32_16x16x32_bf16 v[40:43], a[8:11], v[28:31], v[40:43]
    v_mfma_f32_16x16x32_bf16 v[44:47], a[12:15], v[28:31], v[44:47]
    v_mfma_f32_16x16x32_bf16 v[56:59], a[72:75], v[28:31], v[56:59]
    v_mfma_f32_16x16x32_bf16 v[60:63], a[76:79], v[28:31], v[60:63]
    v_mfma_f32_16x16x32_bf16 v[48:51], a[40:43], v[28:31], v[48:51]
    v_mfma_f32_16x16x32_bf16 v[52:55], a[44:47], v[28:31], v[52:55]
    v_mfma_f32_16x16x32_bf16 v[64:67], a[104:107], v[28:31], v[64:67]
    v_mfma_f32_16x16x32_bf16 v[68:71], a[108:111], v[28:31], v[68:71]
gd_317:
    s_cmp_eq_u64 s[90:91], 0
    s_cbranch_scc1 gd_320
gl_321:
    v_max3_u32 v19, v32, v33, v34
    v_max_u32 v19, v19, v35
    v_cmp_eq_u32 vcc, -1, v19
    s_nop 0
    s_cbranch_vccz go_322
    s_mov_b64 s[90:91], vcc
    s_waitcnt vmcnt(4)
    s_mov_b64 exec, s[90:91]
    buffer_load_dwordx4 v[32:35], v2, s[4:7], s16 offen offset:2048 sc1
    s_mov_b64 exec, s[92:93]
    buffer_load_dwordx4 v[36:39], v2, s[4:7], s16 offen offset:3072 sc1
    s_mov_b64 exec, -1
    s_add_u32 s23, s23, 1
    s_cmp_ge_u32 s23, 200000
    s_cselect_b32 s25, 200000, s25
    s_cbranch_scc1 go_322
    s_branch gl_321
go_322:
    v_mfma_f32_16x16x32_bf16 v[40:43], a[16:19], v[32:35], v[40:43]
    v_mfma_f32_16x16x32_bf16 v[44:47], a[20:23], v[32:35], v[44:47]
    v_mfma_f32_16x16x32_bf16 v[56:59], a[80:83], v[32:35], v[56:59]
    v_mfma_f32_16x16x32_bf16 v[60:63], a[84:87], v[32:35], v[60:63]
    v_mfma_f32_16x16x32_bf16 v[48:51], a[48:51], v[32:35], v[48:51]
    v_mfma_f32_16x16x32_bf16 v[52:55], a[52:55], v[32:35], v[52:55]
    v_mfma_f32_16x16x32_bf16 v[64:67], a[112:115], v[32:35], v[64:67]
    v_mfma_f32_16x16x32_bf16 v[68:71], a[116:119], v[32:35], v[68:71]
gd_320:
    s_cmp_eq_u64 s[92:93], 0
    s_cbranch_scc1 gd_323
gl_324:
    v_max3_u32 v19, v36, v37, v38
    v_max_u32 v19, v19, v39
    v_cmp_eq_u32 vcc, -1, v19
    s_nop 0
    s_cbranch_vccz go_325
    s_mov_b64 s[92:93], vcc
    s_waitcnt vmcnt(2)
    s_mov_b64 exec, s[92:93]
    buffer_load_dwordx4 v[36:39], v2, s[4:7], s16 offen offset:3072 sc1
    s_mov_b64 exec, -1
    s_add_u32 s23, s23, 1
    s_cmp_ge_u32 s23, 200000
    s_cselect_b32 s25, 200000, s25
    s_cbranch_scc1 go_325
    s_branch gl_324
go_325:
    v_mfma_f32_16x16x32_bf16 v[40:43], a[24:27], v[36:39], v[40:43]
    v_mfma_f32_16x16x32_bf16 v[44:47], a[28:31], v[36:39], v[44:47]
    v_mfma_f32_16x16x32_bf16 v[56:59], a[88:91], v[36:39], v[56:59]
    v_mfma_f32_16x16x32_bf16 v[60:63], a[92:95], v[36:39], v[60:63]
    v_mfma_f32_16x16x32_bf16 v[48:51], a[56:59], v[36:39], v[48:51]
    v_mfma_f32_16x16x32_bf16 v[52:55], a[60:63], v[36:39], v[52:55]
    v_mfma_f32_16x16x32_bf16 v[64:67], a[120:123], v[36:39], v[64:67]
    v_mfma_f32_16x16x32_bf16 v[68:71], a[124:127], v[36:39], v[68:71]
gd_323:
    s_branch gc_295
gs_298:
    s_mov_b64 s[90:91], vcc
    s_mov_b64 exec, s[90:91]
    buffer_load_dwordx4 v[32:35], v2, s[4:7], s16 offen offset:2048 sc1
    s_mov_b64 exec, -1
    s_waitcnt vmcnt(1)
    v_max3_u32 v19, v36, v37, v38
    v_max_u32 v19, v19, v39
    v_cmp_eq_u32 s[92:93], -1, v19
    s_nop 0
    s_mov_b64 exec, s[92:93]
    buffer_load_dwordx4 v[36:39], v2, s[4:7], s16 offen offset:3072 sc1
    s_mov_b64 exec, -1
    s_cmp_lg_u64 s[92:93], 0
    s_cbranch_scc1 gk_326
    v_mfma_f32_16x16x32_bf16 v[40:43], a[24:27], v[36:39], v[40:43]
    v_mfma_f32_16x16x32_bf16 v[44:47], a[28:31], v[36:39], v[44:47]
    v_mfma_f32_16x16x32_bf16 v[56:59], a[88:91], v[36:39], v[56:59]
    v_mfma_f32_16x16x32_bf16 v[60:63], a[92:95], v[36:39], v[60:63]
    v_mfma_f32_16x16x32_bf16 v[48:51], a[56:59], v[36:39], v[48:51]
    v_mfma_f32_16x16x32_bf16 v[52:55], a[60:63], v[36:39], v[52:55]
    v_mfma_f32_16x16x32_bf16 v[64:67], a[120:123], v[36:39], v[64:67]
    v_mfma_f32_16x16x32_bf16 v[68:71], a[124:127], v[36:39], v[68:71]
    s_mov_b64 exec, s[90:91]
    buffer_load_dwordx4 v[32:35], v2, s[4:7], s16 offen offset:2048 sc1
    s_mov_b64 exec, -1
gk_326:
gl_328:
    v_max3_u32 v19, v32, v33, v34
    v_max_u32 v19, v19, v35
    v_cmp_eq_u32 vcc, -1, v19
    s_nop 0
    s_cbranch_vccz go_329
    s_mov_b64 s[90:91], vcc
    s_waitcnt vmcnt(4)
    s_mov_b64 exec, s[90:91]
    buffer_load_dwordx4 v[32:35], v2, s[4:7], s16 offen offset:2048 sc1
    s_mov_b64 exec, s[92:93]
    buffer_load_dwordx4 v[36:39], v2, s[4:7], s16 offen offset:3072 sc1
    s_mov_b64 exec, -1
    s_add_u32 s23, s23, 1
    s_cmp_ge_u32 s23, 200000
    s_cselect_b32 s25, 200000, s25
    s_cbranch_scc1 go_329
    s_branch gl_328
go_329:
    v_mfma_f32_16x16x32_bf16 v[40:43], a[16:19], v[32:35], v[40:43]
    v_mfma_f32_16x16x32_bf16 v[44:47], a[20:23], v[32:35], v[44:47]
    v_mfma_f32_16x16x32_bf16 v[56:59], a[80:83], v[32:35], v[56:59]
    v_mfma_f32_16x16x32_bf16 v[60:63], a[84:87], v[32:35], v[60:63]
    v_mfma_f32_16x16x32_bf16 v[48:51], a[48:51], v[32:35], v[48:51]
    v_mfma_f32_16x16x32_bf16 v[52:55], a[52:55], v[32:35], v[52:55]
    v_mfma_f32_16x16x32_bf16 v[64:67], a[112:115], v[32:35], v[64:67]
    v_mfma_f32_16x16x32_bf16 v[68:71], a[116:119], v[32:35], v[68:71]
gd_327:
    s_cmp_eq_u64 s[92:93], 0
    s_cbranch_scc1 gd_330
gl_331:
    v_max3_u32 v19, v36, v37, v38
    v_max_u32 v19, v19, v39
    v_cmp_eq_u32 vcc, -1, v19
    s_nop 0
    s_cbranch_vccz go_332
    s_mov_b64 s[92:93], vcc
    s_waitcnt vmcnt(2)
    s_mov_b64 exec, s[92:93]
    buffer_load_dwordx4 v[36:39], v2, s[4:7], s16 offen offset:3072 sc1
    s_mov_b64 exec, -1
    s_add_u32 s23, s23, 1
    s_cmp_ge_u32 s23, 200000
    s_cselect_b32 s25, 200000, s25
    s_cbranch_scc1 go_332
    s_branch gl_331
go_332:
    v_mfma_f32_16x16x32_bf16 v[40:43], a[24:27], v[36:39], v[40:43]
    v_mfma_f32_16x16x32_bf16 v[44:47], a[28:31], v[36:39], v[44:47]
    v_mfma_f32_16x16x32_bf16 v[56:59], a[88:91], v[36:39], v[56:59]
    v_mfma_f32_16x16x32_bf16 v[60:63], a[92:95], v[36:39], v[60:63]
    v_mfma_f32_16x16x32_bf16 v[48:51], a[56:59], v[36:39], v[48:51]
    v_mfma_f32_16x16x32_bf16 v[52:55], a[60:63], v[36:39], v[52:55]
    v_mfma_f32_16x16x32_bf16 v[64:67], a[120:123], v[36:39], v[64:67]
    v_mfma_f32_16x16x32_bf16 v[68:71], a[124:127], v[36:39], v[68:71]
gd_330:
    s_branch gc_295
gs_299:
    s_mov_b64 s[92:93], vcc
    s_mov_b64 exec, s[92:93]
    buffer_load_dwordx4 v[36:39], v2, s[4:7], s16 offen offset:3072 sc1
    s_mov_b64 exec, -1
gl_334:
    v_max3_u32 v19, v36, v37, v38
    v_max_u32 v19, v19, v39
    v_cmp_eq_u32 vcc, -1, v19
    s_nop 0
    s_cbranch_vccz go_335
    s_mov_b64 s[92:93], vcc
    s_waitcnt vmcnt(2)
    s_mov_b64 exec, s[92:93]
    buffer_load_dwordx4 v[36:39], v2, s[4:7], s16 offen offset:3072 sc1
    s_mov_b64 exec, -1
    s_add_u32 s23, s23, 1
    s_cmp_ge_u32 s23, 200000
    s_cselect_b32 s25, 200000, s25
    s_cbranch_scc1 go_335
    s_branch gl_334
go_335:
    v_mfma_f32_16x16x32_bf16 v[40:43], a[24:27], v[36:39], v[40:43]
    v_mfma_f32_16x16x32_bf16 v[44:47], a[28:31], v[36:39], v[44:47]
    v_mfma_f32_16x16x32_bf16 v[56:59], a[88:91], v[36:39], v[56:59]
    v_mfma_f32_16x16x32_bf16 v[60:63], a[92:95], v[36:39], v[60:63]
    v_mfma_f32_16x16x32_bf16 v[48:51], a[56:59], v[36:39], v[48:51]
    v_mfma_f32_16x16x32_bf16 v[52:55], a[60:63], v[36:39], v[52:55]
    v_mfma_f32_16x16x32_bf16 v[64:67], a[120:123], v[36:39], v[64:67]
    v_mfma_f32_16x16x32_bf16 v[68:71], a[124:127], v[36:39], v[68:71]
gd_333:
    s_branch gc_295
gs_337:
    s_mov_b64 s[86:87], vcc
    s_mov_b64 exec, s[86:87]
    buffer_load_dwordx4 v[24:27], v8, s[4:7], s16 offen offset:0 sc1
    s_mov_b64 exec, -1
    s_waitcnt vmcnt(1)
    v_max3_u32 v19, v28, v29, v30
    v_max_u32 v19, v19, v31
    v_cmp_eq_u32 s[88:89], -1, v19
    v_max3_u32 v19, v32, v33, v34
    v_max_u32 v19, v19, v35
    v_cmp_eq_u32 s[90:91], -1, v19
    v_max3_u32 v19, v36, v37, v38
    v_max_u32 v19, v19, v39
    v_cmp_eq_u32 s[92:93], -1, v19
    s_mov_b64 exec, s[88:89]
    buffer_load_dwordx4 v[28:31], v8, s[4:7], s16 offen offset:1024 sc1
    s_mov_b64 exec, s[90:91]
    buffer_load_dwordx4 v[32:35], v8, s[4:7], s16 offen offset:2048 sc1
    s_mov_b64 exec, s[92:93]
    buffer_load_dwordx4 v[36:39], v8, s[4:7], s16 offen offset:3072 sc1
    s_mov_b64 exec, -1
    s_cmp_lg_u64 s[88:89], 0
    s_cbranch_scc1 gk_341
    v_mfma_f32_16x16x32_bf16 v[40:43], a[200:203], v[28:31], v[40:43]
    v_mfma_f32_16x16x32_bf16 v[44:47], a[204:207], v[28:31], v[44:47]
    v_mfma_f32_16x16x32_bf16 v[48:51], a[232:235], v[28:31], v[48:51]
    v_mfma_f32_16x16x32_bf16 v[52:55], a[236:239], v[28:31], v[52:55]
    s_mov_b64 exec, s[86:87]
    buffer_load_dwordx4 v[24:27], v8, s[4:7], s16 offen offset:0 sc1
    s_mov_b64 exec, s[90:91]
    buffer_load_dwordx4 v[32:35], v8, s[4:7], s16 offen offset:2048 sc1
    s_mov_b64 exec, s[92:93]
    buffer_load_dwordx4 v[36:39], v8, s[4:7], s16 offen offset:3072 sc1
    s_mov_b64 exec, -1
gk_341:
    s_cmp_lg_u64 s[90:91], 0
    s_cbranch_scc1 gk_342
    v_mfma_f32_16x16x32_bf16 v[40:43], a[208:211], v[32:35], v[40:43]
    v_mfma_f32_16x16x32_bf16 v[44:47], a[212:215], v[32:35], v[44:47]
    v_mfma_f32_16x16x32_bf16 v[48:51], a[240:243], v[32:35], v[48:51]
    v_mfma_f32_16x16x32_bf16 v[52:55], a[244:247], v[32:35], v[52:55]
    s_mov_b64 exec, s[86:87]
    buffer_load_dwordx4 v[24:27], v8, s[4:7], s16 offen offset:0 sc1
    s_mov_b64 exec, s[88:89]
    buffer_load_dwordx4 v[28:31], v8, s[4:7], s16 offen offset:1024 sc1
    s_mov_b64 exec, s[92:93]
    buffer_load_dwordx4 v[36:39], v8, s[4:7], s16 offen offset:3072 sc1
    s_mov_b64 exec, -1
gk_342:
    s_cmp_lg_u64 s[92:93], 0
    s_cbranch_scc1 gk_343
    v_mfma_f32_16x16x32_bf16 v[40:43], a[216:219], v[36:39], v[40:43]
    v_mfma_f32_16x16x32_bf16 v[44:47], a[220:223], v[36:39], v[44:47]
    v_mfma_f32_16x16x32_bf16 v[48:51], a[248:251], v[36:39], v[48:51]
    v_mfma_f32_16x16x32_bf16 v[52:55], a[252:255], v[36:39], v[52:55]
    s_mov_b64 exec, s[86:87]
    buffer_load_dwordx4 v[24:27], v8, s[4:7], s16 offen offset:0 sc1
    s_mov_b64 exec, s[88:89]
    buffer_load_dwordx4 v[28:31], v8, s[4:7], s16 offen offset:1024 sc1
    s_mov_b64 exec, s[90:91]
    buffer_load_dwordx4 v[32:35], v8, s[4:7], s16 offen offset:2048 sc1
    s_mov_b64 exec, -1
gk_343:
gl_345:
    v_max3_u32 v19, v24, v25, v26
    v_max_u32 v19, v19, v27
    v_cmp_eq_u32 vcc, -1, v19
    s_nop 0
    s_cbranch_vccz go_346
    s_mov_b64 s[86:87], vcc
    s_waitcnt vmcnt(8)
    s_mov_b64 exec, s[86:87]
    buffer_load_dwordx4 v[24:27], v8, s[4:7], s16 offen offset:0 sc1
    s_mov_b64 exec, s[88:89]
    buffer_load_dwordx4 v[28:31], v8, s[4:7], s16 offen offset:1024 sc1
    s_mov_b64 exec, s[90:91]
    buffer_load_dwordx4 v[32:35], v8, s[4:7], s16 offen offset:2048 sc1
    s_mov_b64 exec, s[92:93]
    buffer_load_dwordx4 v[36:39], v8, s[4:7], s16 offen offset:3072 sc1
    s_mov_b64 exec, -1
    s_add_u32 s23, s23, 1
    s_cmp_ge_u32 s23, 200000
    s_cselect_b32 s25, 200000, s25
    s_cbranch_scc1 go_346
    s_branch gl_345
go_346:
    v_mfma_f32_16x16x32_bf16 v[40:43], a[192:195], v[24:27], v[40:43]
    v_mfma_f32_16x16x32_bf16 v[44:47], a[196:199], v[24:27], v[44:47]
    v_mfma_f32_16x16x32_bf16 v[48:51], a[224:227], v[24:27], v[48:51]
    v_mfma_f32_16x16x32_bf16 v[52:55], a[228:231], v[24:27], v[52:55]
gd_344:
    s_cmp_eq_u64 s[88:89], 0
    s_cbranch_scc1 gd_347
gl_348:
    v_max3_u32 v19, v28, v29, v30
    v_max_u32 v19, v19, v31
    v_cmp_eq_u32 vcc, -1, v19
    s_nop 0
    s_cbranch_vccz go_349
    s_mov_b64 s[88:89], vcc
    s_waitcnt vmcnt(6)
    s_mov_b64 exec, s[88:89]
    buffer_load_dwordx4 v[28:31], v8, s[4:7], s16 offen offset:1024 sc1
    s_mov_b64 exec, s[90:91]
    buffer_load_dwordx4 v[32:35], v8, s[4:7], s16 offen offset:2048 sc1
    s_mov_b64 exec, s[92:93]
    buffer_load_dwordx4 v[36:39], v8, s[4:7], s16 offen offset:3072 sc1
    s_mov_b64 exec, -1
    s_add_u32 s23, s23, 1
    s_cmp_ge_u32 s23, 200000
    s_cselect_b32 s25, 200000, s25
    s_cbranch_scc1 go_349
    s_branch gl_348
go_349:
    v_mfma_f32_16x16x32_bf16 v[40:43], a[200:203], v[28:31], v[40:43]
    v_mfma_f32_16x16x32_bf16 v[44:47], a[204:207], v[28:31], v[44:47]
    v_mfma_f32_16x16x32_bf16 v[48:51], a[232:235], v[28:31], v[48:51]
    v_mfma_f32_16x16x32_bf16 v[52:55], a[236:239], v[28:31], v[52:55]
gd_347:
    s_cmp_eq_u64 s[90:91], 0
    s_cbranch_scc1 gd_350
gl_351:
    v_max3_u32 v19, v32, v33, v34
    v_max_u32 v19, v19, v35
    v_cmp_eq_u32 vcc, -1, v19
    s_nop 0
    s_cbranch_vccz go_352
    s_mov_b64 s[90:91], vcc
    s_waitcnt vmcnt(4)
    s_mov_b64 exec, s[90:91]
    buffer_load_dwordx4 v[32:35], v8, s[4:7], s16 offen offset:2048 sc1
    s_mov_b64 exec, s[92:93]
    buffer_load_dwordx4 v[36:39], v8, s[4:7], s16 offen offset:3072 sc1
    s_mov_b64 exec, -1
    s_add_u32 s23, s23, 1
    s_cmp_ge_u32 s23, 200000
    s_cselect_b32 s25, 200000, s25
    s_cbranch_scc1 go_352
    s_branch gl_351
go_352:
    v_mfma_f32_16x16x32_bf16 v[40:43], a[208:211], v[32:35], v[40:43]
    v_mfma_f32_16x16x32_bf16 v[44:47], a[212:215], v[32:35], v[44:47]
    v_mfma_f32_16x16x32_bf16 v[48:51], a[240:243], v[32:35], v[48:51]
    v_mfma_f32_16x16x32_bf16 v[52:55], a[244:247], v[32:35], v[52:55]
gd_350:
    s_cmp_eq_u64 s[92:93], 0
    s_cbranch_scc1 gd_353
gl_354:
    v_max3_u32 v19, v36, v37, v38
    v_max_u32 v19, v19, v39
    v_cmp_eq_u32 vcc, -1, v19
    s_nop 0
    s_cbranch_vccz go_355
    s_mov_b64 s[92:93], vcc
    s_waitcnt vmcnt(2)
    s_mov_b64 exec, s[92:93]
    buffer_load_dwordx4 v[36:39], v8, s[4:7], s16 offen offset:3072 sc1
    s_mov_b64 exec, -1
    s_add_u32 s23, s23, 1
    s_cmp_ge_u32 s23, 200000
    s_cselect_b32 s25, 200000, s25
    s_cbranch_scc1 go_355
    s_branch gl_354
go_355:
    v_mfma_f32_16x16x32_bf16 v[40:43], a[216:219], v[36:39], v[40:43]
    v_mfma_f32_16x16x32_bf16 v[44:47], a[220:223], v[36:39], v[44:47]
    v_mfma_f32_16x16x32_bf16 v[48:51], a[248:251], v[36:39], v[48:51]
    v_mfma_f32_16x16x32_bf16 v[52:55], a[252:255], v[36:39], v[52:55]
gd_353:
    s_branch gc_336
gs_338:
    s_mov_b64 s[88:89], vcc
    s_mov_b64 exec, s[88:89]
    buffer_load_dwordx4 v[28:31], v8, s[4:7], s16 offen offset:1024 sc1
    s_mov_b64 exec, -1
    s_waitcnt vmcnt(1)
    v_max3_u32 v19, v32, v33, v34
    v_max_u32 v19, v19, v35
    v_cmp_eq_u32 s[90:91], -1, v19
    v_max3_u32 v19, v36, v37, v38
    v_max_u32 v19, v19, v39
    v_cmp_eq_u32 s[92:93], -1, v19
    s_mov_b64 exec, s[90:91]
    buffer_load_dwordx4 v[32:35], v8, s[4:7], s16 offen offset:2048 sc1
    s_mov_b64 exec, s[92:93]
    buffer_load_dwordx4 v[36:39], v8, s[4:7], s16 offen offset:3072 sc1
    s_mov_b64 exec, -1
    s_cmp_lg_u64 s[90:91], 0
    s_cbranch_scc1 gk_356
    v_mfma_f32_16x16x32_bf16 v[40:43], a[208:211], v[32:35], v[40:43]
    v_mfma_f32_16x16x32_bf16 v[44:47], a[212:215], v[32:35], v[44:47]
    v_mfma_f32_16x16x32_bf16 v[48:51], a[240:243], v[32:35], v[48:51]
    v_mfma_f32_16x16x32_bf16 v[52:55], a[244:247], v[32:35], v[52:55]
    s_mov_b64 exec, s[88:89]
    buffer_load_dwordx4 v[28:31], v8, s[4:7], s16 offen offset:1024 sc1
    s_mov_b64 exec, s[92:93]
    buffer_load_dwordx4 v[36:39], v8, s[4:7], s16 offen offset:3072 sc1
    s_mov_b64 exec, -1
gk_356:
    s_cmp_lg_u64 s[92:93], 0
    s_cbranch_scc1 gk_357
    v_mfma_f32_16x16x32_bf16 v[40:43], a[216:219], v[36:39], v[40:43]
    v_mfma_f32_16x16x32_bf16 v[44:47], a[220:223], v[36:39], v[44:47]
    v_mfma_f32_16x16x32_bf16 v[48:51], a[248:251], v[36:39], v[48:51]
    v_mfma_f32_16x16x32_bf16 v[52:55], a[252:255], v[36:39], v[52:55]
    s_mov_b64 exec, s[88:89]
    buffer_load_dwordx4 v[28:31], v8, s[4:7], s16 offen offset:1024 sc1
    s_mov_b64 exec, s[90:91]
    buffer_load_dwordx4 v[32:35], v8, s[4:7], s16 offen offset:2048 sc1
    s_mov_b64 exec, -1
gk_357:
gl_359:
    v_max3_u32 v19, v28, v29, v30
    v_max_u32 v19, v19, v31
    v_cmp_eq_u32 vcc, -1, v19
    s_nop 0
    s_cbranch_vccz go_360
    s_mov_b64 s[88:89], vcc
    s_waitcnt vmcnt(6)
    s_mov_b64 exec, s[88:89]
    buffer_load_dwordx4 v[28:31], v8, s[4:7], s16 offen offset:1024 sc1
    s_mov_b64 exec, s[90:91]
    buffer_load_dwordx4 v[32:35], v8, s[4:7], s16 offen offset:2048 sc1
    s_mov_b64 exec, s[92:93]
    buffer_load_dwordx4 v[36:39], v8, s[4:7], s16 offen offset:3072 sc1
    s_mov_b64 exec, -1
    s_add_u32 s23, s23, 1
    s_cmp_ge_u32 s23, 200000
    s_cselect_b32 s25, 200000, s25
    s_cbranch_scc1 go_360
    s_branch gl_359
go_360:
    v_mfma_f32_16x16x32_bf16 v[40:43], a[200:203], v[28:31], v[40:43]
    v_mfma_f32_16x16x32_bf16 v[44:47], a[204:207], v[28:31], v[44:47]
    v_mfma_f32_16x16x32_bf16 v[48:51], a[232:235], v[28:31], v[48:51]
    v_mfma_f32_16x16x32_bf16 v[52:55], a[236:239], v[28:31], v[52:55]
gd_358:
    s_cmp_eq_u64 s[90:91], 0
    s_cbranch_scc1 gd_361
gl_362:
    v_max3_u32 v19, v32, v33, v34
    v_max_u32 v19, v19, v35
    v_cmp_eq_u32 vcc, -1, v19
    s_nop 0
    s_cbranch_vccz go_363
    s_mov_b64 s[90:91], vcc
    s_waitcnt vmcnt(4)
    s_mov_b64 exec, s[90:91]
    buffer_load_dwordx4 v[32:35], v8, s[4:7], s16 offen offset:2048 sc1
    s_mov_b64 exec, s[92:93]
    buffer_load_dwordx4 v[36:39], v8, s[4:7], s16 offen offset:3072 sc1
    s_mov_b64 exec, -1
    s_add_u32 s23, s23, 1
    s_cmp_ge_u32 s23, 200000
    s_cselect_b32 s25, 200000, s25
    s_cbranch_scc1 go_363
    s_branch gl_362
go_363:
    v_mfma_f32_16x16x32_bf16 v[40:43], a[208:211], v[32:35], v[40:43]
    v_mfma_f32_16x16x32_bf16 v[44:47], a[212:215], v[32:35], v[44:47]
    v_mfma_f32_16x16x32_bf16 v[48:51], a[240:243], v[32:35], v[48:51]
    v_mfma_f32_16x16x32_bf16 v[52:55], a[244:247], v[32:35], v[52:55]
gd_361:
    s_cmp_eq_u64 s[92:93], 0
    s_cbranch_scc1 gd_364
gl_365:
    v_max3_u32 v19, v36, v37, v38
    v_max_u32 v19, v19, v39
    v_cmp_eq_u32 vcc, -1, v19
    s_nop 0
    s_cbranch_vccz go_366
    s_mov_b64 s[92:93], vcc
    s_waitcnt vmcnt(2)
    s_mov_b64 exec, s[92:93]
    buffer_load_dwordx4 v[36:39], v8, s[4:7], s16 offen offset:3072 sc1
    s_mov_b64 exec, -1
    s_add_u32 s23, s23, 1
    s_cmp_ge_u32 s23, 200000
    s_cselect_b32 s25, 200000, s25
    s_cbranch_scc1 go_366
    s_branch gl_365
go_366:
    v_mfma_f32_16x16x32_bf16 v[40:43], a[216:219], v[36:39], v[40:43]
    v_mfma_f32_16x16x32_bf16 v[44:47], a[220:223], v[36:39], v[44:47]
    v_mfma_f32_16x16x32_bf16 v[48:51], a[248:251], v[36:39], v[48:51]
    v_mfma_f32_16x16x32_bf16 v[52:55], a[252:255], v[36:39], v[52:55]
gd_364:
    s_branch gc_336
gs_339:
    s_mov_b64 s[90:91], vcc
    s_mov_b64 exec, s[90:91]
    buffer_load_dwordx4 v[32:35], v8, s[4:7], s16 offen offset:2048 sc1
    s_mov_b64 exec, -1
    s_waitcnt vmcnt(1)
    v_max3_u32 v19, v36, v37, v38
    v_max_u32 v19, v19, v39
    v_cmp_eq_u32 s[92:93], -1, v19
    s_nop 0
    s_mov_b64 exec, s[92:93]
    buffer_load_dwordx4 v[36:39], v8, s[4:7], s16 offen offset:3072 sc1
    s_mov_b64 exec, -1
    s_cmp_lg_u64 s[92:93], 0
    s_cbranch_scc1 gk_367
    v_mfma_f32_16x16x32_bf16 v[40:43], a[216:219], v[36:39], v[40:43]
    v_mfma_f32_16x16x32_bf16 v[44:47], a[220:223], v[36:39], v[44:47]
    v_mfma_f32_16x16x32_bf16 v[48:51], a[248:251], v[36:39], v[48:51]
    v_mfma_f32_16x16x32_bf16 v[52:55], a[252:255], v[36:39], v[52:55]
    s_mov_b64 exec, s[90:91]
    buffer_load_dwordx4 v[32:35], v8, s[4:7], s16 offen offset:2048 sc1
    s_mov_b64 exec, -1
gk_367:
gl_369:
    v_max3_u32 v19, v32, v33, v34
    v_max_u32 v19, v19, v35
    v_cmp_eq_u32 vcc, -1, v19
    s_nop 0
    s_cbranch_vccz go_370
    s_mov_b64 s[90:91], vcc
    s_waitcnt vmcnt(4)
    s_mov_b64 exec, s[90:91]
    buffer_load_dwordx4 v[32:35], v8, s[4:7], s16 offen offset:2048 sc1
    s_mov_b64 exec, s[92:93]
    buffer_load_dwordx4 v[36:39], v8, s[4:7], s16 offen offset:3072 sc1
    s_mov_b64 exec, -1
    s_add_u32 s23, s23, 1
    s_cmp_ge_u32 s23, 200000
    s_cselect_b32 s25, 200000, s25
    s_cbranch_scc1 go_370
    s_branch gl_369
go_370:
    v_mfma_f32_16x16x32_bf16 v[40:43], a[208:211], v[32:35], v[40:43]
    v_mfma_f32_16x16x32_bf16 v[44:47], a[212:215], v[32:35], v[44:47]
    v_mfma_f32_16x16x32_bf16 v[48:51], a[240:243], v[32:35], v[48:51]
    v_mfma_f32_16x16x32_bf16 v[52:55], a[244:247], v[32:35], v[52:55]
gd_368:
    s_cmp_eq_u64 s[92:93], 0
    s_cbranch_scc1 gd_371
gl_372:
    v_max3_u32 v19, v36, v37, v38
    v_max_u32 v19, v19, v39
    v_cmp_eq_u32 vcc, -1, v19
    s_nop 0
    s_cbranch_vccz go_373
    s_mov_b64 s[92:93], vcc
    s_waitcnt vmcnt(2)
    s_mov_b64 exec, s[92:93]
    buffer_load_dwordx4 v[36:39], v8, s[4:7], s16 offen offset:3072 sc1
    s_mov_b64 exec, -1
    s_add_u32 s23, s23, 1
    s_cmp_ge_u32 s23, 200000
    s_cselect_b32 s25, 200000, s25
    s_cbranch_scc1 go_373
    s_branch gl_372
go_373:
    v_mfma_f32_16x16x32_bf16 v[40:43], a[216:219], v[36:39], v[40:43]
    v_mfma_f32_16x16x32_bf16 v[44:47], a[220:223], v[36:39], v[44:47]
    v_mfma_f32_16x16x32_bf16 v[48:51], a[248:251], v[36:39], v[48:51]
    v_mfma_f32_16x16x32_bf16 v[52:55], a[252:255], v[36:39], v[52:55]
gd_371:
    s_branch gc_336
gs_340:
    s_mov_b64 s[92:93], vcc
    s_mov_b64 exec, s[92:93]
    buffer_load_dwordx4 v[36:39], v8, s[4:7], s16 offen offset:3072 sc1
    s_mov_b64 exec, -1
gl_375:
    v_max3_u32 v19, v36, v37, v38
    v_max_u32 v19, v19, v39
    v_cmp_eq_u32 vcc, -1, v19
    s_nop 0
    s_cbranch_vccz go_376
    s_mov_b64 s[92:93], vcc
    s_waitcnt vmcnt(2)
    s_mov_b64 exec, s[92:93]
    buffer_load_dwordx4 v[36:39], v8, s[4:7], s16 offen offset:3072 sc1
    s_mov_b64 exec, -1
    s_add_u32 s23, s23, 1
    s_cmp_ge_u32 s23, 200000
    s_cselect_b32 s25, 200000, s25
    s_cbranch_scc1 go_376
    s_branch gl_375
go_376:
    v_mfma_f32_16x16x32_bf16 v[40:43], a[216:219], v[36:39], v[40:43]
    v_mfma_f32_16x16x32_bf16 v[44:47], a[220:223], v[36:39], v[44:47]
    v_mfma_f32_16x16x32_bf16 v[48:51], a[248:251], v[36:39], v[48:51]
    v_mfma_f32_16x16x32_bf16 v[52:55], a[252:255], v[36:39], v[52:55]
gd_374:
    s_branch gc_336
pr_377:
pb_380:
    s_waitcnt vmcnt(0)
    v_max3_u32 v19, v108, v109, v110
    v_max3_u32 v19, v19, v111, v112
    v_max3_u32 v19, v19, v113, v114
    v_max3_u32 v19, v19, v115, v116
    v_max3_u32 v19, v19, v117, v118
    v_max_u32 v19, v19, v119
    v_cmp_eq_u32 vcc, -1, v19
    v_add_f32 v124, v88, v108
    v_add_f32 v125, v89, v109
    v_add_f32 v126, v90, v110
    v_add_f32 v127, v91, v111
    s_add_u32 s23, s23, 1
    s_cbranch_vccz pg_378
    buffer_load_dwordx4 v[108:111], v10, s[4:7], s22 offen sc1
    buffer_load_dwordx4 v[112:115], v23, s[4:7], s22 offen sc1
    buffer_load_dwordx4 v[116:119], v244, s[4:7], s22 offen sc1
    s_add_u32 s23, s23, 1
    s_cmp_ge_u32 s23, 200000
    s_cselect_b32 s25, 200000, s25
    s_cbranch_scc1 pg_378
    s_branch pb_380
pg_378:
    s_barrier
    v_add_f32 v120, v112, v116
    v_add_f32 v121, v113, v117
    v_add_f32 v122, v114, v118
    v_add_f32 v123, v115, v119
    v_add_f32 v120, v124, v120
    v_add_f32 v121, v125, v121
    v_add_f32 v122, v126, v122
    v_add_f32 v123, v127, v123
    v_cvt_pk_bf16_f32 v180, v120, v121
    v_cvt_pk_bf16_f32 v181, v122, v123
    buffer_store_dwordx2 v[180:181], v11, s[4:7], s42 offen
    s_branch pf_379
.p2align 6
recur_slow_w0:
    s_sleep 2
    s_mov_b32 s23, s25
    buffer_load_dwordx4 v[24:27], v2, s[4:7], s16 offen offset:0 sc1
    buffer_load_dwordx4 v[28:31], v2, s[4:7], s16 offen offset:1024 sc1
    buffer_load_dwordx4 v[32:35], v2, s[4:7], s16 offen offset:2048 sc1
    buffer_load_dwordx4 v[36:39], v2, s[4:7], s16 offen offset:3072 sc1
    s_waitcnt vmcnt(3)
    v_max3_u32 v19, v24, v25, v26
    v_max_u32 v19, v19, v27
    v_cmp_eq_u32 vcc, -1, v19
    s_nop 0
    s_cbranch_vccnz gs_382
    v_mfma_f32_16x16x32_bf16 v[40:43], a[0:3], v[24:27], v[40:43]
    v_mfma_f32_16x16x32_bf16 v[44:47], a[4:7], v[24:27], v[44:47]
    v_mfma_f32_16x16x32_bf16 v[56:59], a[64:67], v[24:27], v[56:59]
    v_mfma_f32_16x16x32_bf16 v[60:63], a[68:71], v[24:27], v[60:63]
    v_mfma_f32_16x16x32_bf16 v[48:51], a[32:35], v[24:27], v[48:51]
    s_waitcnt vmcnt(2)
    v_max3_u32 v19, v28, v29, v30
    v_mfma_f32_16x16x32_bf16 v[52:55], a[36:39], v[24:27], v[52:55]
    v_max_u32 v19, v19, v31
    v_mfma_f32_16x16x32_bf16 v[64:67], a[96:99], v[24:27], v[64:67]
    v_cmp_eq_u32 vcc, -1, v19
    v_mfma_f32_16x16x32_bf16 v[68:71], a[100:103], v[24:27], v[68:71]
    s_cbranch_vccnz gs_383
    v_mfma_f32_16x16x32_bf16 v[40:43], a[8:11], v[28:31], v[40:43]
    v_mfma_f32_16x16x32_bf16 v[44:47], a[12:15], v[28:31], v[44:47]
    v_mfma_f32_16x16x32_bf16 v[56:59], a[72:75], v[28:31], v[56:59]
    v_mfma_f32_16x16x32_bf16 v[60:63], a[76:79], v[28:31], v[60:63]
    v_mfma_f32_16x16x32_bf16 v[48:51], a[40:43], v[28:31], v[48:51]
    s_waitcnt vmcnt(1)
    v_max3_u32 v19, v32, v33, v34
    v_mfma_f32_16x16x32_bf16 v[52:55], a[44:47], v[28:31], v[52:55]
    v_max_u32 v19, v19, v35
    v_mfma_f32_16x16x32_bf16 v[64:67], a[104:107], v[28:31], v[64:67]
    v_cmp_eq_u32 vcc, -1, v19
    v_mfma_f32_16x16x32_bf16 v[68:71], a[108:111], v[28:31], v[68:71]
    s_cbranch_vccnz gs_384
    v_mfma_f32_16x16x32_bf16 v[40:43], a[16:19], v[32:35], v[40:43]
    v_mfma_f32_16x16x32_bf16 v[44:47], a[20:23], v[32:35], v[44:47]
    v_mfma_f32_16x16x32_bf16 v[56:59], a[80:83], v[32:35], v[56:59]
    v_mfma_f32_16x16x32_bf16 v[60:63], a[84:87], v[32:35], v[60:63]
    v_mfma_f32_16x16x32_bf16 v[48:51], a[48:51], v[32:35], v[48:51]
    s_waitcnt vmcnt(0)
    v_max3_u32 v19, v36, v37, v38
    v_mfma_f32_16x16x32_bf16 v[52:55], a[52:55], v[32:35], v[52:55]
    v_max_u32 v19, v19, v39
    v_mfma_f32_16x16x32_bf16 v[64:67], a[112:115], v[32:35], v[64:67]
    v_cmp_eq_u32 vcc, -1, v19
    v_mfma_f32_16x16x32_bf16 v[68:71], a[116:119], v[32:35], v[68:71]
    s_cbranch_vccnz gs_385
    v_mfma_f32_16x16x32_bf16 v[40:43], a[24:27], v[36:39], v[40:43]
    v_mfma_f32_16x16x32_bf16 v[44:47], a[28:31], v[36:39], v[44:47]
    v_mfma_f32_16x16x32_bf16 v[56:59], a[88:91], v[36:39], v[56:59]
    v_mfma_f32_16x16x32_bf16 v[60:63], a[92:95], v[36:39], v[60:63]
    v_mfma_f32_16x16x32_bf16 v[48:51], a[56:59], v[36:39], v[48:51]
    v_mfma_f32_16x16x32_bf16 v[52:55], a[60:63], v[36:39], v[52:55]
    v_mfma_f32_16x16x32_bf16 v[64:67], a[120:123], v[36:39], v[64:67]
    v_mfma_f32_16x16x32_bf16 v[68:71], a[124:127], v[36:39], v[68:71]
gc_381:
    s_nop 1
    v_add_f32_dpp v88, v44, v40 row_ror:8 row_mask:0xf bank_mask:0x3
    v_add_f32_dpp v89, v45, v41 row_ror:8 row_mask:0xf bank_mask:0x3
    v_add_f32_dpp v90, v46, v42 row_ror:8 row_mask:0xf bank_mask:0x3
    v_add_f32_dpp v91, v47, v43 row_ror:8 row_mask:0xf bank_mask:0x3
    v_add_f32_dpp v88, v56, v60 row_ror:8 row_mask:0xf bank_mask:0xc
    v_add_f32_dpp v89, v57, v61 row_ror:8 row_mask:0xf bank_mask:0xc
    v_add_f32_dpp v90, v58, v62 row_ror:8 row_mask:0xf bank_mask:0xc
    v_add_f32_dpp v91, v59, v63 row_ror:8 row_mask:0xf bank_mask:0xc
    v_add_f32_dpp v92, v52, v48 row_ror:8 row_mask:0xf bank_mask:0x3
    v_add_f32_dpp v93, v53, v49 row_ror:8 row_mask:0xf bank_mask:0x3
    v_add_f32_dpp v94, v54, v50 row_ror:8 row_mask:0xf bank_mask:0x3
    v_add_f32_dpp v95, v55, v51 row_ror:8 row_mask:0xf bank_mask:0x3
    v_mfma_f32_16x16x32_bf16 v[72:75], v[24:27], a[128:131], 0
    v_add_f32_dpp v92, v64, v68 row_ror:8 row_mask:0xf bank_mask:0xc
    v_add_f32_dpp v93, v65, v69 row_ror:8 row_mask:0xf bank_mask:0xc
    v_add_f32_dpp v94, v66, v70 row_ror:8 row_mask:0xf bank_mask:0xc
    v_add_f32_dpp v95, v67, v71 row_ror:8 row_mask:0xf bank_mask:0xc
    v_mfma_f32_16x16x32_bf16 v[80:83], v[24:27], a[160:163], 0
    v_mfma_f32_16x16x32_bf16 v[76:79], v[24:27], a[132:135], 0
    v_mfma_f32_16x16x32_bf16 v[84:87], v[24:27], a[164:167], 0
    s_waitcnt lgkmcnt(0)
    s_barrier
    ds_read_b128 v[104:107], v16 offset:2048
    ds_read_b128 v[108:111], v16 offset:3072
    ds_read_b128 v[112:115], v16 offset:4096
    ds_read_b128 v[116:119], v16 offset:5120
    ds_read_b128 v[120:123], v16 offset:6144
    ds_read_b128 v[124:127], v16 offset:7168
    buffer_load_dwordx4 v[228:231], v12, s[4:7], s17 offen sc1
    buffer_load_dwordx4 v[232:235], v12, s[4:7], s17 offen offset:256 sc1
    s_add_u32 s17, s17, 2048
    s_min_u32 s17, s17, 17954816
    v_mfma_f32_16x16x32_bf16 v[72:75], v[28:31], a[136:139], v[72:75]
    v_mfma_f32_16x16x32_bf16 v[80:83], v[28:31], a[168:171], v[80:83]
    v_mfma_f32_16x16x32_bf16 v[76:79], v[28:31], a[140:143], v[76:79]
    v_mfma_f32_16x16x32_bf16 v[84:87], v[28:31], a[172:175], v[84:87]
    s_waitcnt lgkmcnt(4)
    v_add_f32 v96, v88, v104
    v_add_f32 v97, v89, v105
    v_add_f32 v98, v90, v106
    v_add_f32 v99, v91, v107
    v_add_f32 v100, v92, v108
    v_add_f32 v101, v93, v109
    v_add_f32 v102, v94, v110
    v_add_f32 v103, v95, v111
    s_waitcnt lgkmcnt(0)
    v_add_f32 v112, v112, v120
    v_add_f32 v113, v113, v121
    v_add_f32 v114, v114, v122
    v_add_f32 v115, v115, v123
    v_add_f32 v116, v116, v124
    v_add_f32 v117, v117, v125
    v_add_f32 v118, v118, v126
    v_add_f32 v119, v119, v127
    v_add_f32 v96, v96, v112
    v_add_f32 v97, v97, v113
    v_add_f32 v98, v98, v114
    v_add_f32 v99, v99, v115
    v_add_f32 v100, v100, v116
    v_add_f32 v101, v101, v117
    v_add_f32 v102, v102, v118
    v_add_f32 v103, v103, v119
    v_cvt_pk_bf16_f32 v128, v96, v97
    v_cvt_pk_bf16_f32 v129, v98, v99
    v_cvt_pk_bf16_f32 v130, v100, v101
    v_cvt_pk_bf16_f32 v131, v102, v103
    s_nop 1
    v_mfma_f32_16x16x32_bf16 v[144:147], v[132:135], v[128:131], 0
    v_mfma_f32_16x16x32_bf16 v[148:151], v[136:139], v[128:131], 0
    v_mfma_f32_16x16x32_bf16 v[140:143], v[128:131], v[128:131], 0
    v_mfma_f32_16x16x32_bf16 v[72:75], v[32:35], a[144:147], v[72:75]
    v_mfma_f32_16x16x32_bf16 v[80:83], v[32:35], a[176:179], v[80:83]
    s_nop 3
    buffer_store_dwordx4 v[144:147], v3, s[4:7], s16 offen sc1
    buffer_store_dwordx4 v[148:151], v3, s[4:7], s16 offen offset:128 sc1
    buffer_store_dwordx4 v[140:143], v4, s[4:7], s16 offen sc1
    v_mfma_f32_16x16x32_bf16 v[76:79], v[32:35], a[148:151], v[76:79]
    v_mfma_f32_16x16x32_bf16 v[84:87], v[32:35], a[180:183], v[84:87]
    v_mfma_f32_16x16x32_bf16 v[72:75], v[36:39], a[152:155], v[72:75]
    v_mfma_f32_16x16x32_bf16 v[80:83], v[36:39], a[184:187], v[80:83]
    v_mfma_f32_16x16x32_bf16 v[76:79], v[36:39], a[156:159], v[76:79]
    v_mfma_f32_16x16x32_bf16 v[84:87], v[36:39], a[188:191], v[84:87]
    s_nop 6
    v_mov_b32_dpp v72, v76 quad_perm:[0,1,2,3] row_mask:0xc bank_mask:0xf
    v_mov_b32_dpp v73, v77 quad_perm:[0,1,2,3] row_mask:0xc bank_mask:0xf
    v_mov_b32_dpp v74, v78 quad_perm:[0,1,2,3] row_mask:0xc bank_mask:0xf
    v_mov_b32_dpp v75, v79 quad_perm:[0,1,2,3] row_mask:0xc bank_mask:0xf
    ds_write_b128 v17, v[72:75] offset:8192
    v_mov_b32_dpp v80, v84 quad_perm:[0,1,2,3] row_mask:0xc bank_mask:0xf
    v_mov_b32_dpp v81, v85 quad_perm:[0,1,2,3] row_mask:0xc bank_mask:0xf
    v_mov_b32_dpp v82, v86 quad_perm:[0,1,2,3] row_mask:0xc bank_mask:0xf
    v_mov_b32_dpp v83, v87 quad_perm:[0,1,2,3] row_mask:0xc bank_mask:0xf
    ds_write_b128 v17, v[80:83] offset:9216
    s_waitcnt lgkmcnt(0)
    s_barrier
    v_mov_b32 v40, 0
    v_mov_b32 v41, 0
    v_mov_b32 v42, 0
    v_mov_b32 v43, 0
    v_mov_b32 v44, 0
    v_mov_b32 v45, 0
    v_mov_b32 v46, 0
    v_mov_b32 v47, 0
    v_mov_b32 v48, 0
    v_mov_b32 v49, 0
    v_mov_b32 v50, 0
    v_mov_b32 v51, 0
    v_mov_b32 v52, 0
    v_mov_b32 v53, 0
    v_mov_b32 v54, 0
    v_mov_b32 v55, 0
    s_cmp_eq_u32 s15, 63
    s_cbranch_scc1 recur_slow_last0
    s_barrier
    s_sleep 7
    s_nop 12
    s_mov_b32 s23, s25
    buffer_load_dwordx4 v[24:27], v8, s[4:7], s16 offen offset:0 sc1
    buffer_load_dwordx4 v[28:31], v8, s[4:7], s16 offen offset:1024 sc1
    buffer_load_dwordx4 v[32:35], v8, s[4:7], s16 offen offset:2048 sc1
    buffer_load_dwordx4 v[36:39], v8, s[4:7], s16 offen offset:3072 sc1
    s_waitcnt vmcnt(3)
    v_max3_u32 v19, v24, v25, v26
    v_max_u32 v19, v19, v27
    v_cmp_eq_u32 vcc, -1, v19
    s_nop 0
    s_cbranch_vccnz gs_423
    v_mfma_f32_16x16x32_bf16 v[40:43], a[192:195], v[24:27], v[40:43]
    s_waitcnt vmcnt(2)
    v_max3_u32 v19, v28, v29, v30
    v_mfma_f32_16x16x32_bf16 v[44:47], a[196:199], v[24:27], v[44:47]
    v_max_u32 v19, v19, v31
    v_mfma_f32_16x16x32_bf16 v[48:51], a[224:227], v[24:27], v[48:51]
    v_cmp_eq_u32 vcc, -1, v19
    v_mfma_f32_16x16x32_bf16 v[52:55], a[228:231], v[24:27], v[52:55]
    s_cbranch_vccnz gs_424
    v_mfma_f32_16x16x32_bf16 v[40:43], a[200:203], v[28:31], v[40:43]
    s_waitcnt vmcnt(1)
    v_max3_u32 v19, v32, v33, v34
    v_mfma_f32_16x16x32_bf16 v[44:47], a[204:207], v[28:31], v[44:47]
    v_max_u32 v19, v19, v35
    v_mfma_f32_16x16x32_bf16 v[48:51], a[232:235], v[28:31], v[48:51]
    v_cmp_eq_u32 vcc, -1, v19
    v_mfma_f32_16x16x32_bf16 v[52:55], a[236:239], v[28:31], v[52:55]
    s_cbranch_vccnz gs_425
    v_mfma_f32_16x16x32_bf16 v[40:43], a[208:211], v[32:35], v[40:43]
    s_waitcnt vmcnt(0)
    v_max3_u32 v19, v36, v37, v38
    v_mfma_f32_16x16x32_bf16 v[44:47], a[212:215], v[32:35], v[44:47]
    v_max_u32 v19, v19, v39
    v_mfma_f32_16x16x32_bf16 v[48:51], a[240:243], v[32:35], v[48:51]
    v_cmp_eq_u32 vcc, -1, v19
    v_mfma_f32_16x16x32_bf16 v[52:55], a[244:247], v[32:35], v[52:55]
    s_cbranch_vccnz gs_426
    v_mfma_f32_16x16x32_bf16 v[40:43], a[216:219], v[36:39], v[40:43]
    v_mfma_f32_16x16x32_bf16 v[44:47], a[220:223], v[36:39], v[44:47]
    v_mfma_f32_16x16x32_bf16 v[48:51], a[248:251], v[36:39], v[48:51]
    v_mfma_f32_16x16x32_bf16 v[52:55], a[252:255], v[36:39], v[52:55]
gc_422:
    s_nop 5
    v_add_f32_dpp v88, v44, v40 row_ror:8 row_mask:0xf bank_mask:0x3
    v_add_f32_dpp v89, v45, v41 row_ror:8 row_mask:0xf bank_mask:0x3
    v_add_f32_dpp v90, v46, v42 row_ror:8 row_mask:0xf bank_mask:0x3
    v_add_f32_dpp v91, v47, v43 row_ror:8 row_mask:0xf bank_mask:0x3
    v_add_f32_dpp v88, v48, v52 row_ror:8 row_mask:0xf bank_mask:0xc
    v_add_f32_dpp v89, v49, v53 row_ror:8 row_mask:0xf bank_mask:0xc
    v_add_f32_dpp v90, v50, v54 row_ror:8 row_mask:0xf bank_mask:0xc
    v_add_f32_dpp v91, v51, v55 row_ror:8 row_mask:0xf bank_mask:0xc
    ds_write_b128 v17, v[88:91] offset:16384
    s_waitcnt lgkmcnt(0)
    s_barrier
    v_mov_b32 v132, v228
    v_mov_b32 v133, v229
    v_mov_b32 v134, v230
    v_mov_b32 v135, v231
    v_mov_b32 v136, v232
    v_mov_b32 v137, v233
    v_mov_b32 v138, v234
    v_mov_b32 v139, v235
    v_mov_b32 v40, 0
    v_mov_b32 v41, 0
    v_mov_b32 v42, 0
    v_mov_b32 v43, 0
    v_mov_b32 v44, 0
    v_mov_b32 v45, 0
    v_mov_b32 v46, 0
    v_mov_b32 v47, 0
    v_mov_b32 v48, 0
    v_mov_b32 v49, 0
    v_mov_b32 v50, 0
    v_mov_b32 v51, 0
    v_mov_b32 v52, 0
    v_mov_b32 v53, 0
    v_mov_b32 v54, 0
    v_mov_b32 v55, 0
    v_mov_b32 v56, 0
    v_mov_b32 v57, 0
    v_mov_b32 v58, 0
    v_mov_b32 v59, 0
    v_mov_b32 v60, 0
    v_mov_b32 v61, 0
    v_mov_b32 v62, 0
    v_mov_b32 v63, 0
    v_mov_b32 v64, 0
    v_mov_b32 v65, 0
    v_mov_b32 v66, 0
    v_mov_b32 v67, 0
    v_mov_b32 v68, 0
    v_mov_b32 v69, 0
    v_mov_b32 v70, 0
    v_mov_b32 v71, 0
    s_nop 7
    buffer_store_dwordx4 v[128:131], v14, s[4:7], s19 offen sc1
    s_add_u32 s19, s19, 512
    s_add_u32 s94, s15, 3
    s_min_u32 s94, s94, 64
    s_mov_b32 s23, s25
fw_463:
    s_cmp_ge_u32 s85, s94
    s_cbranch_scc1 fo_464
    buffer_load_dword v19, v245, s[4:7], 0 offen sc1
    s_add_u32 s23, s23, 1
    s_waitcnt vmcnt(0)
    v_readfirstlane_b32 s85, v19
    s_cmp_lt_u32 s23, 200000
    s_cbranch_scc1 fw_463
    s_mov_b32 s25, 200000
fo_464:
    s_mov_b32 s21, s16
    s_mov_b32 s16, s42
    s_mov_b32 s42, s43
    s_mov_b32 s43, s44
    s_mov_b32 s44, s21
    s_add_u32 s84, s84, 262144
    s_add_u32 s15, s15, 1
    s_barrier
    s_branch recur_slow_w0
gs_382:
    s_mov_b64 s[86:87], vcc
    s_mov_b64 exec, s[86:87]
    buffer_load_dwordx4 v[24:27], v2, s[4:7], s16 offen offset:0 sc1
    s_mov_b64 exec, -1
    s_waitcnt vmcnt(1)
    v_max3_u32 v19, v28, v29, v30
    v_max_u32 v19, v19, v31
    v_cmp_eq_u32 s[88:89], -1, v19
    v_max3_u32 v19, v32, v33, v34
    v_max_u32 v19, v19, v35
    v_cmp_eq_u32 s[90:91], -1, v19
    v_max3_u32 v19, v36, v37, v38
    v_max_u32 v19, v19, v39
    v_cmp_eq_u32 s[92:93], -1, v19
    s_mov_b64 exec, s[88:89]
    buffer_load_dwordx4 v[28:31], v2, s[4:7], s16 offen offset:1024 sc1
    s_mov_b64 exec, s[90:91]
    buffer_load_dwordx4 v[32:35], v2, s[4:7], s16 offen offset:2048 sc1
    s_mov_b64 exec, s[92:93]
    buffer_load_dwordx4 v[36:39], v2, s[4:7], s16 offen offset:3072 sc1
    s_mov_b64 exec, -1
    s_cmp_lg_u64 s[88:89], 0
    s_cbranch_scc1 gk_386
    v_mfma_f32_16x16x32_bf16 v[40:43], a[8:11], v[28:31], v[40:43]
    v_mfma_f32_16x16x32_bf16 v[44:47], a[12:15], v[28:31], v[44:47]
    v_mfma_f32_16x16x32_bf16 v[56:59], a[72:75], v[28:31], v[56:59]
    v_mfma_f32_16x16x32_bf16 v[60:63], a[76:79], v[28:31], v[60:63]
    v_mfma_f32_16x16x32_bf16 v[48:51], a[40:43], v[28:31], v[48:51]
    v_mfma_f32_16x16x32_bf16 v[52:55], a[44:47], v[28:31], v[52:55]
    v_mfma_f32_16x16x32_bf16 v[64:67], a[104:107], v[28:31], v[64:67]
    v_mfma_f32_16x16x32_bf16 v[68:71], a[108:111], v[28:31], v[68:71]
    s_mov_b64 exec, s[86:87]
    buffer_load_dwordx4 v[24:27], v2, s[4:7], s16 offen offset:0 sc1
    s_mov_b64 exec, s[90:91]
    buffer_load_dwordx4 v[32:35], v2, s[4:7], s16 offen offset:2048 sc1
    s_mov_b64 exec, s[92:93]
    buffer_load_dwordx4 v[36:39], v2, s[4:7], s16 offen offset:3072 sc1
    s_mov_b64 exec, -1
gk_386:
    s_cmp_lg_u64 s[90:91], 0
    s_cbranch_scc1 gk_387
    v_mfma_f32_16x16x32_bf16 v[40:43], a[16:19], v[32:35], v[40:43]
    v_mfma_f32_16x16x32_bf16 v[44:47], a[20:23], v[32:35], v[44:47]
    v_mfma_f32_16x16x32_bf16 v[56:59], a[80:83], v[32:35], v[56:59]
    v_mfma_f32_16x16x32_bf16 v[60:63], a[84:87], v[32:35], v[60:63]
    v_mfma_f32_16x16x32_bf16 v[48:51], a[48:51], v[32:35], v[48:51]
    v_mfma_f32_16x16x32_bf16 v[52:55], a[52:55], v[32:35], v[52:55]
    v_mfma_f32_16x16x32_bf16 v[64:67], a[112:115], v[32:35], v[64:67]
    v_mfma_f32_16x16x32_bf16 v[68:71], a[116:119], v[32:35], v[68:71]
    s_mov_b64 exec, s[86:87]
    buffer_load_dwordx4 v[24:27], v2, s[4:7], s16 offen offset:0 sc1
    s_mov_b64 exec, s[88:89]
    buffer_load_dwordx4 v[28:31], v2, s[4:7], s16 offen offset:1024 sc1
    s_mov_b64 exec, s[92:93]
    buffer_load_dwordx4 v[36:39], v2, s[4:7], s16 offen offset:3072 sc1
    s_mov_b64 exec, -1
gk_387:
    s_cmp_lg_u64 s[92:93], 0
    s_cbranch_scc1 gk_388
    v_mfma_f32_16x16x32_bf16 v[40:43], a[24:27], v[36:39], v[40:43]
    v_mfma_f32_16x16x32_bf16 v[44:47], a[28:31], v[36:39], v[44:47]
    v_mfma_f32_16x16x32_bf16 v[56:59], a[88:91], v[36:39], v[56:59]
    v_mfma_f32_16x16x32_bf16 v[60:63], a[92:95], v[36:39], v[60:63]
    v_mfma_f32_16x16x32_bf16 v[48:51], a[56:59], v[36:39], v[48:51]
    v_mfma_f32_16x16x32_bf16 v[52:55], a[60:63], v[36:39], v[52:55]
    v_mfma_f32_16x16x32_bf16 v[64:67], a[120:123], v[36:39], v[64:67]
    v_mfma_f32_16x16x32_bf16 v[68:71], a[124:127], v[36:39], v[68:71]
    s_mov_b64 exec, s[86:87]
    buffer_load_dwordx4 v[24:27], v2, s[4:7], s16 offen offset:0 sc1
    s_mov_b64 exec, s[88:89]
    buffer_load_dwordx4 v[28:31], v2, s[4:7], s16 offen offset:1024 sc1
    s_mov_b64 exec, s[90:91]
    buffer_load_dwordx4 v[32:35], v2, s[4:7], s16 offen offset:2048 sc1
    s_mov_b64 exec, -1
gk_388:
gl_390:
    v_max3_u32 v19, v24, v25, v26
    v_max_u32 v19, v19, v27
    v_cmp_eq_u32 vcc, -1, v19
    s_nop 0
    s_cbranch_vccz go_391
    s_mov_b64 s[86:87], vcc
    s_waitcnt vmcnt(8)
    s_mov_b64 exec, s[86:87]
    buffer_load_dwordx4 v[24:27], v2, s[4:7], s16 offen offset:0 sc1
    s_mov_b64 exec, s[88:89]
    buffer_load_dwordx4 v[28:31], v2, s[4:7], s16 offen offset:1024 sc1
    s_mov_b64 exec, s[90:91]
    buffer_load_dwordx4 v[32:35], v2, s[4:7], s16 offen offset:2048 sc1
    s_mov_b64 exec, s[92:93]
    buffer_load_dwordx4 v[36:39], v2, s[4:7], s16 offen offset:3072 sc1
    s_mov_b64 exec, -1
    s_add_u32 s23, s23, 1
    s_cmp_ge_u32 s23, 200000
    s_cselect_b32 s25, 200000, s25
    s_cbranch_scc1 go_391
    s_branch gl_390
go_391:
    v_mfma_f32_16x16x32_bf16 v[40:43], a[0:3], v[24:27], v[40:43]
    v_mfma_f32_16x16x32_bf16 v[44:47], a[4:7], v[24:27], v[44:47]
    v_mfma_f32_16x16x32_bf16 v[56:59], a[64:67], v[24:27], v[56:59]
    v_mfma_f32_16x16x32_bf16 v[60:63], a[68:71], v[24:27], v[60:63]
    v_mfma_f32_16x16x32_bf16 v[48:51], a[32:35], v[24:27], v[48:51]
    v_mfma_f32_16x16x32_bf16 v[52:55], a[36:39], v[24:27], v[52:55]
    v_mfma_f32_16x16x32_bf16 v[64:67], a[96:99], v[24:27], v[64:67]
    v_mfma_f32_16x16x32_bf16 v[68:71], a[100:103], v[24:27], v[68:71]
gd_389:
    s_cmp_eq_u64 s[88:89], 0
    s_cbranch_scc1 gd_392
gl_393:
    v_max3_u32 v19, v28, v29, v30
    v_max_u32 v19, v19, v31
    v_cmp_eq_u32 vcc, -1, v19
    s_nop 0
    s_cbranch_vccz go_394
    s_mov_b64 s[88:89], vcc
    s_waitcnt vmcnt(6)
    s_mov_b64 exec, s[88:89]
    buffer_load_dwordx4 v[28:31], v2, s[4:7], s16 offen offset:1024 sc1
    s_mov_b64 exec, s[90:91]
    buffer_load_dwordx4 v[32:35], v2, s[4:7], s16 offen offset:2048 sc1
    s_mov_b64 exec, s[92:93]
    buffer_load_dwordx4 v[36:39], v2, s[4:7], s16 offen offset:3072 sc1
    s_mov_b64 exec, -1
    s_add_u32 s23, s23, 1
    s_cmp_ge_u32 s23, 200000
    s_cselect_b32 s25, 200000, s25
    s_cbranch_scc1 go_394
    s_branch gl_393
go_394:
    v_mfma_f32_16x16x32_bf16 v[40:43], a[8:11], v[28:31], v[40:43]
    v_mfma_f32_16x16x32_bf16 v[44:47], a[12:15], v[28:31], v[44:47]
    v_mfma_f32_16x16x32_bf16 v[56:59], a[72:75], v[28:31], v[56:59]
    v_mfma_f32_16x16x32_bf16 v[60:63], a[76:79], v[28:31], v[60:63]
    v_mfma_f32_16x16x32_bf16 v[48:51], a[40:43], v[28:31], v[48:51]
    v_mfma_f32_16x16x32_bf16 v[52:55], a[44:47], v[28:31], v[52:55]
    v_mfma_f32_16x16x32_bf16 v[64:67], a[104:107], v[28:31], v[64:67]
    v_mfma_f32_16x16x32_bf16 v[68:71], a[108:111], v[28:31], v[68:71]
gd_392:
    s_cmp_eq_u64 s[90:91], 0
    s_cbranch_scc1 gd_395
gl_396:
    v_max3_u32 v19, v32, v33, v34
    v_max_u32 v19, v19, v35
    v_cmp_eq_u32 vcc, -1, v19
    s_nop 0
    s_cbranch_vccz go_397
    s_mov_b64 s[90:91], vcc
    s_waitcnt vmcnt(4)
    s_mov_b64 exec, s[90:91]
    buffer_load_dwordx4 v[32:35], v2, s[4:7], s16 offen offset:2048 sc1
    s_mov_b64 exec, s[92:93]
    buffer_load_dwordx4 v[36:39], v2, s[4:7], s16 offen offset:3072 sc1
    s_mov_b64 exec, -1
    s_add_u32 s23, s23, 1
    s_cmp_ge_u32 s23, 200000
    s_cselect_b32 s25, 200000, s25
    s_cbranch_scc1 go_397
    s_branch gl_396
go_397:
    v_mfma_f32_16x16x32_bf16 v[40:43], a[16:19], v[32:35], v[40:43]
    v_mfma_f32_16x16x32_bf16 v[44:47], a[20:23], v[32:35], v[44:47]
    v_mfma_f32_16x16x32_bf16 v[56:59], a[80:83], v[32:35], v[56:59]
    v_mfma_f32_16x16x32_bf16 v[60:63], a[84:87], v[32:35], v[60:63]
    v_mfma_f32_16x16x32_bf16 v[48:51], a[48:51], v[32:35], v[48:51]
    v_mfma_f32_16x16x32_bf16 v[52:55], a[52:55], v[32:35], v[52:55]
    v_mfma_f32_16x16x32_bf16 v[64:67], a[112:115], v[32:35], v[64:67]
    v_mfma_f32_16x16x32_bf16 v[68:71], a[116:119], v[32:35], v[68:71]
gd_395:
    s_cmp_eq_u64 s[92:93], 0
    s_cbranch_scc1 gd_398
gl_399:
    v_max3_u32 v19, v36, v37, v38
    v_max_u32 v19, v19, v39
    v_cmp_eq_u32 vcc, -1, v19
    s_nop 0
    s_cbranch_vccz go_400
    s_mov_b64 s[92:93], vcc
    s_waitcnt vmcnt(2)
    s_mov_b64 exec, s[92:93]
    buffer_load_dwordx4 v[36:39], v2, s[4:7], s16 offen offset:3072 sc1
    s_mov_b64 exec, -1
    s_add_u32 s23, s23, 1
    s_cmp_ge_u32 s23, 200000
    s_cselect_b32 s25, 200000, s25
    s_cbranch_scc1 go_400
    s_branch gl_399
go_400:
    v_mfma_f32_16x16x32_bf16 v[40:43], a[24:27], v[36:39], v[40:43]
    v_mfma_f32_16x16x32_bf16 v[44:47], a[28:31], v[36:39], v[44:47]
    v_mfma_f32_16x16x32_bf16 v[56:59], a[88:91], v[36:39], v[56:59]
    v_mfma_f32_16x16x32_bf16 v[60:63], a[92:95], v[36:39], v[60:63]
    v_mfma_f32_16x16x32_bf16 v[48:51], a[56:59], v[36:39], v[48:51]
    v_mfma_f32_16x16x32_bf16 v[52:55], a[60:63], v[36:39], v[52:55]
    v_mfma_f32_16x16x32_bf16 v[64:67], a[120:123], v[36:39], v[64:67]
    v_mfma_f32_16x16x32_bf16 v[68:71], a[124:127], v[36:39], v[68:71]
gd_398:
    s_branch gc_381
gs_383:
    s_mov_b64 s[88:89], vcc
    s_mov_b64 exec, s[88:89]
    buffer_load_dwordx4 v[28:31], v2, s[4:7], s16 offen offset:1024 sc1
    s_mov_b64 exec, -1
    s_waitcnt vmcnt(1)
    v_max3_u32 v19, v32, v33, v34
    v_max_u32 v19, v19, v35
    v_cmp_eq_u32 s[90:91], -1, v19
    v_max3_u32 v19, v36, v37, v38
    v_max_u32 v19, v19, v39
    v_cmp_eq_u32 s[92:93], -1, v19
    s_mov_b64 exec, s[90:91]
    buffer_load_dwordx4 v[32:35], v2, s[4:7], s16 offen offset:2048 sc1
    s_mov_b64 exec, s[92:93]
    buffer_load_dwordx4 v[36:39], v2, s[4:7], s16 offen offset:3072 sc1
    s_mov_b64 exec, -1
    s_cmp_lg_u64 s[90:91], 0
    s_cbranch_scc1 gk_401
    v_mfma_f32_16x16x32_bf16 v[40:43], a[16:19], v[32:35], v[40:43]
    v_mfma_f32_16x16x32_bf16 v[44:47], a[20:23], v[32:35], v[44:47]
    v_mfma_f32_16x16x32_bf16 v[56:59], a[80:83], v[32:35], v[56:59]
    v_mfma_f32_16x16x32_bf16 v[60:63], a[84:87], v[32:35], v[60:63]
    v_mfma_f32_16x16x32_bf16 v[48:51], a[48:51], v[32:35], v[48:51]
    v_mfma_f32_16x16x32_bf16 v[52:55], a[52:55], v[32:35], v[52:55]
    v_mfma_f32_16x16x32_bf16 v[64:67], a[112:115], v[32:35], v[64:67]
    v_mfma_f32_16x16x32_bf16 v[68:71], a[116:119], v[32:35], v[68:71]
    s_mov_b64 exec, s[88:89]
    buffer_load_dwordx4 v[28:31], v2, s[4:7], s16 offen offset:1024 sc1
    s_mov_b64 exec, s[92:93]
    buffer_load_dwordx4 v[36:39], v2, s[4:7], s16 offen offset:3072 sc1
    s_mov_b64 exec, -1
gk_401:
    s_cmp_lg_u64 s[92:93], 0
    s_cbranch_scc1 gk_402
    v_mfma_f32_16x16x32_bf16 v[40:43], a[24:27], v[36:39], v[40:43]
    v_mfma_f32_16x16x32_bf16 v[44:47], a[28:31], v[36:39], v[44:47]
    v_mfma_f32_16x16x32_bf16 v[56:59], a[88:91], v[36:39], v[56:59]
    v_mfma_f32_16x16x32_bf16 v[60:63], a[92:95], v[36:39], v[60:63]
    v_mfma_f32_16x16x32_bf16 v[48:51], a[56:59], v[36:39], v[48:51]
    v_mfma_f32_16x16x32_bf16 v[52:55], a[60:63], v[36:39], v[52:55]
    v_mfma_f32_16x16x32_bf16 v[64:67], a[120:123], v[36:39], v[64:67]
    v_mfma_f32_16x16x32_bf16 v[68:71], a[124:127], v[36:39], v[68:71]
    s_mov_b64 exec, s[88:89]
    buffer_load_dwordx4 v[28:31], v2, s[4:7], s16 offen offset:1024 sc1
    s_mov_b64 exec, s[90:91]
    buffer_load_dwordx4 v[32:35], v2, s[4:7], s16 offen offset:2048 sc1
    s_mov_b64 exec, -1
gk_402:
gl_404:
    v_max3_u32 v19, v28, v29, v30
    v_max_u32 v19, v19, v31
    v_cmp_eq_u32 vcc, -1, v19
    s_nop 0
    s_cbranch_vccz go_405
    s_mov_b64 s[88:89], vcc
    s_waitcnt vmcnt(6)
    s_mov_b64 exec, s[88:89]
    buffer_load_dwordx4 v[28:31], v2, s[4:7], s16 offen offset:1024 sc1
    s_mov_b64 exec, s[90:91]
    buffer_load_dwordx4 v[32:35], v2, s[4:7], s16 offen offset:2048 sc1
    s_mov_b64 exec, s[92:93]
    buffer_load_dwordx4 v[36:39], v2, s[4:7], s16 offen offset:3072 sc1
    s_mov_b64 exec, -1
    s_add_u32 s23, s23, 1
    s_cmp_ge_u32 s23, 200000
    s_cselect_b32 s25, 200000, s25
    s_cbranch_scc1 go_405
    s_branch gl_404
go_405:
    v_mfma_f32_16x16x32_bf16 v[40:43], a[8:11], v[28:31], v[40:43]
    v_mfma_f32_16x16x32_bf16 v[44:47], a[12:15], v[28:31], v[44:47]
    v_mfma_f32_16x16x32_bf16 v[56:59], a[72:75], v[28:31], v[56:59]
    v_mfma_f32_16x16x32_bf16 v[60:63], a[76:79], v[28:31], v[60:63]
    v_mfma_f32_16x16x32_bf16 v[48:51], a[40:43], v[28:31], v[48:51]
    v_mfma_f32_16x16x32_bf16 v[52:55], a[44:47], v[28:31], v[52:55]
    v_mfma_f32_16x16x32_bf16 v[64:67], a[104:107], v[28:31], v[64:67]
    v_mfma_f32_16x16x32_bf16 v[68:71], a[108:111], v[28:31], v[68:71]
gd_403:
    s_cmp_eq_u64 s[90:91], 0
    s_cbranch_scc1 gd_406
gl_407:
    v_max3_u32 v19, v32, v33, v34
    v_max_u32 v19, v19, v35
    v_cmp_eq_u32 vcc, -1, v19
    s_nop 0
    s_cbranch_vccz go_408
    s_mov_b64 s[90:91], vcc
    s_waitcnt vmcnt(4)
    s_mov_b64 exec, s[90:91]
    buffer_load_dwordx4 v[32:35], v2, s[4:7], s16 offen offset:2048 sc1
    s_mov_b64 exec, s[92:93]
    buffer_load_dwordx4 v[36:39], v2, s[4:7], s16 offen offset:3072 sc1
    s_mov_b64 exec, -1
    s_add_u32 s23, s23, 1
    s_cmp_ge_u32 s23, 200000
    s_cselect_b32 s25, 200000, s25
    s_cbranch_scc1 go_408
    s_branch gl_407
go_408:
    v_mfma_f32_16x16x32_bf16 v[40:43], a[16:19], v[32:35], v[40:43]
    v_mfma_f32_16x16x32_bf16 v[44:47], a[20:23], v[32:35], v[44:47]
    v_mfma_f32_16x16x32_bf16 v[56:59], a[80:83], v[32:35], v[56:59]
    v_mfma_f32_16x16x32_bf16 v[60:63], a[84:87], v[32:35], v[60:63]
    v_mfma_f32_16x16x32_bf16 v[48:51], a[48:51], v[32:35], v[48:51]
    v_mfma_f32_16x16x32_bf16 v[52:55], a[52:55], v[32:35], v[52:55]
    v_mfma_f32_16x16x32_bf16 v[64:67], a[112:115], v[32:35], v[64:67]
    v_mfma_f32_16x16x32_bf16 v[68:71], a[116:119], v[32:35], v[68:71]
gd_406:
    s_cmp_eq_u64 s[92:93], 0
    s_cbranch_scc1 gd_409
gl_410:
    v_max3_u32 v19, v36, v37, v38
    v_max_u32 v19, v19, v39
    v_cmp_eq_u32 vcc, -1, v19
    s_nop 0
    s_cbranch_vccz go_411
    s_mov_b64 s[92:93], vcc
    s_waitcnt vmcnt(2)
    s_mov_b64 exec, s[92:93]
    buffer_load_dwordx4 v[36:39], v2, s[4:7], s16 offen offset:3072 sc1
    s_mov_b64 exec, -1
    s_add_u32 s23, s23, 1
    s_cmp_ge_u32 s23, 200000
    s_cselect_b32 s25, 200000, s25
    s_cbranch_scc1 go_411
    s_branch gl_410
go_411:
    v_mfma_f32_16x16x32_bf16 v[40:43], a[24:27], v[36:39], v[40:43]
    v_mfma_f32_16x16x32_bf16 v[44:47], a[28:31], v[36:39], v[44:47]
    v_mfma_f32_16x16x32_bf16 v[56:59], a[88:91], v[36:39], v[56:59]
    v_mfma_f32_16x16x32_bf16 v[60:63], a[92:95], v[36:39], v[60:63]
    v_mfma_f32_16x16x32_bf16 v[48:51], a[56:59], v[36:39], v[48:51]
    v_mfma_f32_16x16x32_bf16 v[52:55], a[60:63], v[36:39], v[52:55]
    v_mfma_f32_16x16x32_bf16 v[64:67], a[120:123], v[36:39], v[64:67]
    v_mfma_f32_16x16x32_bf16 v[68:71], a[124:127], v[36:39], v[68:71]
gd_409:
    s_branch gc_381
gs_384:
    s_mov_b64 s[90:91], vcc
    s_mov_b64 exec, s[90:91]
    buffer_load_dwordx4 v[32:35], v2, s[4:7], s16 offen offset:2048 sc1
    s_mov_b64 exec, -1
    s_waitcnt vmcnt(1)
    v_max3_u32 v19, v36, v37, v38
    v_max_u32 v19, v19, v39
    v_cmp_eq_u32 s[92:93], -1, v19
    s_nop 0
    s_mov_b64 exec, s[92:93]
    buffer_load_dwordx4 v[36:39], v2, s[4:7], s16 offen offset:3072 sc1
    s_mov_b64 exec, -1
    s_cmp_lg_u64 s[92:93], 0
    s_cbranch_scc1 gk_412
    v_mfma_f32_16x16x32_bf16 v[40:43], a[24:27], v[36:39], v[40:43]
    v_mfma_f32_16x16x32_bf16 v[44:47], a[28:31], v[36:39], v[44:47]
    v_mfma_f32_16x16x32_bf16 v[56:59], a[88:91], v[36:39], v[56:59]
    v_mfma_f32_16x16x32_bf16 v[60:63], a[92:95], v[36:39], v[60:63]
    v_mfma_f32_16x16x32_bf16 v[48:51], a[56:59], v[36:39], v[48:51]
    v_mfma_f32_16x16x32_bf16 v[52:55], a[60:63], v[36:39], v[52:55]
    v_mfma_f32_16x16x32_bf16 v[64:67], a[120:123], v[36:39], v[64:67]
    v_mfma_f32_16x16x32_bf16 v[68:71], a[124:127], v[36:39], v[68:71]
    s_mov_b64 exec, s[90:91]
    buffer_load_dwordx4 v[32:35], v2, s[4:7], s16 offen offset:2048 sc1
    s_mov_b64 exec, -1
gk_412:
gl_414:
    v_max3_u32 v19, v32, v33, v34
    v_max_u32 v19, v19, v35
    v_cmp_eq_u32 vcc, -1, v19
    s_nop 0
    s_cbranch_vccz go_415
    s_mov_b64 s[90:91], vcc
    s_waitcnt vmcnt(4)
    s_mov_b64 exec, s[90:91]
    buffer_load_dwordx4 v[32:35], v2, s[4:7], s16 offen offset:2048 sc1
    s_mov_b64 exec, s[92:93]
    buffer_load_dwordx4 v[36:39], v2, s[4:7], s16 offen offset:3072 sc1
    s_mov_b64 exec, -1
    s_add_u32 s23, s23, 1
    s_cmp_ge_u32 s23, 200000
    s_cselect_b32 s25, 200000, s25
    s_cbranch_scc1 go_415
    s_branch gl_414
go_415:
    v_mfma_f32_16x16x32_bf16 v[40:43], a[16:19], v[32:35], v[40:43]
    v_mfma_f32_16x16x32_bf16 v[44:47], a[20:23], v[32:35], v[44:47]
    v_mfma_f32_16x16x32_bf16 v[56:59], a[80:83], v[32:35], v[56:59]
    v_mfma_f32_16x16x32_bf16 v[60:63], a[84:87], v[32:35], v[60:63]
    v_mfma_f32_16x16x32_bf16 v[48:51], a[48:51], v[32:35], v[48:51]
    v_mfma_f32_16x16x32_bf16 v[52:55], a[52:55], v[32:35], v[52:55]
    v_mfma_f32_16x16x32_bf16 v[64:67], a[112:115], v[32:35], v[64:67]
    v_mfma_f32_16x16x32_bf16 v[68:71], a[116:119], v[32:35], v[68:71]
gd_413:
    s_cmp_eq_u64 s[92:93], 0
    s_cbranch_scc1 gd_416
gl_417:
    v_max3_u32 v19, v36, v37, v38
    v_max_u32 v19, v19, v39
    v_cmp_eq_u32 vcc, -1, v19
    s_nop 0
    s_cbranch_vccz go_418
    s_mov_b64 s[92:93], vcc
    s_waitcnt vmcnt(2)
    s_mov_b64 exec, s[92:93]
    buffer_load_dwordx4 v[36:39], v2, s[4:7], s16 offen offset:3072 sc1
    s_mov_b64 exec, -1
    s_add_u32 s23, s23, 1
    s_cmp_ge_u32 s23, 200000
    s_cselect_b32 s25, 200000, s25
    s_cbranch_scc1 go_418
    s_branch gl_417
go_418:
    v_mfma_f32_16x16x32_bf16 v[40:43], a[24:27], v[36:39], v[40:43]
    v_mfma_f32_16x16x32_bf16 v[44:47], a[28:31], v[36:39], v[44:47]
    v_mfma_f32_16x16x32_bf16 v[56:59], a[88:91], v[36:39], v[56:59]
    v_mfma_f32_16x16x32_bf16 v[60:63], a[92:95], v[36:39], v[60:63]
    v_mfma_f32_16x16x32_bf16 v[48:51], a[56:59], v[36:39], v[48:51]
    v_mfma_f32_16x16x32_bf16 v[52:55], a[60:63], v[36:39], v[52:55]
    v_mfma_f32_16x16x32_bf16 v[64:67], a[120:123], v[36:39], v[64:67]
    v_mfma_f32_16x16x32_bf16 v[68:71], a[124:127], v[36:39], v[68:71]
gd_416:
    s_branch gc_381
gs_385:
    s_mov_b64 s[92:93], vcc
    s_mov_b64 exec, s[92:93]
    buffer_load_dwordx4 v[36:39], v2, s[4:7], s16 offen offset:3072 sc1
    s_mov_b64 exec, -1
gl_420:
    v_max3_u32 v19, v36, v37, v38
    v_max_u32 v19, v19, v39
    v_cmp_eq_u32 vcc, -1, v19
    s_nop 0
    s_cbranch_vccz go_421
    s_mov_b64 s[92:93], vcc
    s_waitcnt vmcnt(2)
    s_mov_b64 exec, s[92:93]
    buffer_load_dwordx4 v[36:39], v2, s[4:7], s16 offen offset:3072 sc1
    s_mov_b64 exec, -1
    s_add_u32 s23, s23, 1
    s_cmp_ge_u32 s23, 200000
    s_cselect_b32 s25, 200000, s25
    s_cbranch_scc1 go_421
    s_branch gl_420
go_421:
    v_mfma_f32_16x16x32_bf16 v[40:43], a[24:27], v[36:39], v[40:43]
    v_mfma_f32_16x16x32_bf16 v[44:47], a[28:31], v[36:39], v[44:47]
    v_mfma_f32_16x16x32_bf16 v[56:59], a[88:91], v[36:39], v[56:59]
    v_mfma_f32_16x16x32_bf16 v[60:63], a[92:95], v[36:39], v[60:63]
    v_mfma_f32_16x16x32_bf16 v[48:51], a[56:59], v[36:39], v[48:51]
    v_mfma_f32_16x16x32_bf16 v[52:55], a[60:63], v[36:39], v[52:55]
    v_mfma_f32_16x16x32_bf16 v[64:67], a[120:123], v[36:39], v[64:67]
    v_mfma_f32_16x16x32_bf16 v[68:71], a[124:127], v[36:39], v[68:71]
gd_419:
    s_branch gc_381
recur_slow_last0:
    buffer_store_dwordx4 v[128:131], v14, s[4:7], s19 offen sc1
    s_branch recur_end
gs_423:
    s_mov_b64 s[86:87], vcc
    s_mov_b64 exec, s[86:87]
    buffer_load_dwordx4 v[24:27], v8, s[4:7], s16 offen offset:0 sc1
    s_mov_b64 exec, -1
    s_waitcnt vmcnt(1)
    v_max3_u32 v19, v28, v29, v30
    v_max_u32 v19, v19, v31
    v_cmp_eq_u32 s[88:89], -1, v19
    v_max3_u32 v19, v32, v33, v34
    v_max_u32 v19, v19, v35
    v_cmp_eq_u32 s[90:91], -1, v19
    v_max3_u32 v19, v36, v37, v38
    v_max_u32 v19, v19, v39
    v_cmp_eq_u32 s[92:93], -1, v19
    s_mov_b64 exec, s[88:89]
    buffer_load_dwordx4 v[28:31], v8, s[4:7], s16 offen offset:1024 sc1
    s_mov_b64 exec, s[90:91]
    buffer_load_dwordx4 v[32:35], v8, s[4:7], s16 offen offset:2048 sc1
    s_mov_b64 exec, s[92:93]
    buffer_load_dwordx4 v[36:39], v8, s[4:7], s16 offen offset:3072 sc1
    s_mov_b64 exec, -1
    s_cmp_lg_u64 s[88:89], 0
    s_cbranch_scc1 gk_427
    v_mfma_f32_16x16x32_bf16 v[40:43], a[200:203], v[28:31], v[40:43]
    v_mfma_f32_16x16x32_bf16 v[44:47], a[204:207], v[28:31], v[44:47]
    v_mfma_f32_16x16x32_bf16 v[48:51], a[232:235], v[28:31], v[48:51]
    v_mfma_f32_16x16x32_bf16 v[52:55], a[236:239], v[28:31], v[52:55]
    s_mov_b64 exec, s[86:87]
    buffer_load_dwordx4 v[24:27], v8, s[4:7], s16 offen offset:0 sc1
    s_mov_b64 exec, s[90:91]
    buffer_load_dwordx4 v[32:35], v8, s[4:7], s16 offen offset:2048 sc1
    s_mov_b64 exec, s[92:93]
    buffer_load_dwordx4 v[36:39], v8, s[4:7], s16 offen offset:3072 sc1
    s_mov_b64 exec, -1
gk_427:
    s_cmp_lg_u64 s[90:91], 0
    s_cbranch_scc1 gk_428
    v_mfma_f32_16x16x32_bf16 v[40:43], a[208:211], v[32:35], v[40:43]
    v_mfma_f32_16x16x32_bf16 v[44:47], a[212:215], v[32:35], v[44:47]
    v_mfma_f32_16x16x32_bf16 v[48:51], a[240:243], v[32:35], v[48:51]
    v_mfma_f32_16x16x32_bf16 v[52:55], a[244:247], v[32:35], v[52:55]
    s_mov_b64 exec, s[86:87]
    buffer_load_dwordx4 v[24:27], v8, s[4:7], s16 offen offset:0 sc1
    s_mov_b64 exec, s[88:89]
    buffer_load_dwordx4 v[28:31], v8, s[4:7], s16 offen offset:1024 sc1
    s_mov_b64 exec, s[92:93]
    buffer_load_dwordx4 v[36:39], v8, s[4:7], s16 offen offset:3072 sc1
    s_mov_b64 exec, -1
gk_428:
    s_cmp_lg_u64 s[92:93], 0
    s_cbranch_scc1 gk_429
    v_mfma_f32_16x16x32_bf16 v[40:43], a[216:219], v[36:39], v[40:43]
    v_mfma_f32_16x16x32_bf16 v[44:47], a[220:223], v[36:39], v[44:47]
    v_mfma_f32_16x16x32_bf16 v[48:51], a[248:251], v[36:39], v[48:51]
    v_mfma_f32_16x16x32_bf16 v[52:55], a[252:255], v[36:39], v[52:55]
    s_mov_b64 exec, s[86:87]
    buffer_load_dwordx4 v[24:27], v8, s[4:7], s16 offen offset:0 sc1
    s_mov_b64 exec, s[88:89]
    buffer_load_dwordx4 v[28:31], v8, s[4:7], s16 offen offset:1024 sc1
    s_mov_b64 exec, s[90:91]
    buffer_load_dwordx4 v[32:35], v8, s[4:7], s16 offen offset:2048 sc1
    s_mov_b64 exec, -1
gk_429:
gl_431:
    v_max3_u32 v19, v24, v25, v26
    v_max_u32 v19, v19, v27
    v_cmp_eq_u32 vcc, -1, v19
    s_nop 0
    s_cbranch_vccz go_432
    s_mov_b64 s[86:87], vcc
    s_waitcnt vmcnt(8)
    s_mov_b64 exec, s[86:87]
    buffer_load_dwordx4 v[24:27], v8, s[4:7], s16 offen offset:0 sc1
    s_mov_b64 exec, s[88:89]
    buffer_load_dwordx4 v[28:31], v8, s[4:7], s16 offen offset:1024 sc1
    s_mov_b64 exec, s[90:91]
    buffer_load_dwordx4 v[32:35], v8, s[4:7], s16 offen offset:2048 sc1
    s_mov_b64 exec, s[92:93]
    buffer_load_dwordx4 v[36:39], v8, s[4:7], s16 offen offset:3072 sc1
    s_mov_b64 exec, -1
    s_add_u32 s23, s23, 1
    s_cmp_ge_u32 s23, 200000
    s_cselect_b32 s25, 200000, s25
    s_cbranch_scc1 go_432
    s_branch gl_431
go_432:
    v_mfma_f32_16x16x32_bf16 v[40:43], a[192:195], v[24:27], v[40:43]
    v_mfma_f32_16x16x32_bf16 v[44:47], a[196:199], v[24:27], v[44:47]
    v_mfma_f32_16x16x32_bf16 v[48:51], a[224:227], v[24:27], v[48:51]
    v_mfma_f32_16x16x32_bf16 v[52:55], a[228:231], v[24:27], v[52:55]
gd_430:
    s_cmp_eq_u64 s[88:89], 0
    s_cbranch_scc1 gd_433
gl_434:
    v_max3_u32 v19, v28, v29, v30
    v_max_u32 v19, v19, v31
    v_cmp_eq_u32 vcc, -1, v19
    s_nop 0
    s_cbranch_vccz go_435
    s_mov_b64 s[88:89], vcc
    s_waitcnt vmcnt(6)
    s_mov_b64 exec, s[88:89]
    buffer_load_dwordx4 v[28:31], v8, s[4:7], s16 offen offset:1024 sc1
    s_mov_b64 exec, s[90:91]
    buffer_load_dwordx4 v[32:35], v8, s[4:7], s16 offen offset:2048 sc1
    s_mov_b64 exec, s[92:93]
    buffer_load_dwordx4 v[36:39], v8, s[4:7], s16 offen offset:3072 sc1
    s_mov_b64 exec, -1
    s_add_u32 s23, s23, 1
    s_cmp_ge_u32 s23, 200000
    s_cselect_b32 s25, 200000, s25
    s_cbranch_scc1 go_435
    s_branch gl_434
go_435:
    v_mfma_f32_16x16x32_bf16 v[40:43], a[200:203], v[28:31], v[40:43]
    v_mfma_f32_16x16x32_bf16 v[44:47], a[204:207], v[28:31], v[44:47]
    v_mfma_f32_16x16x32_bf16 v[48:51], a[232:235], v[28:31], v[48:51]
    v_mfma_f32_16x16x32_bf16 v[52:55], a[236:239], v[28:31], v[52:55]
gd_433:
    s_cmp_eq_u64 s[90:91], 0
    s_cbranch_scc1 gd_436
gl_437:
    v_max3_u32 v19, v32, v33, v34
    v_max_u32 v19, v19, v35
    v_cmp_eq_u32 vcc, -1, v19
    s_nop 0
    s_cbranch_vccz go_438
    s_mov_b64 s[90:91], vcc
    s_waitcnt vmcnt(4)
    s_mov_b64 exec, s[90:91]
    buffer_load_dwordx4 v[32:35], v8, s[4:7], s16 offen offset:2048 sc1
    s_mov_b64 exec, s[92:93]
    buffer_load_dwordx4 v[36:39], v8, s[4:7], s16 offen offset:3072 sc1
    s_mov_b64 exec, -1
    s_add_u32 s23, s23, 1
    s_cmp_ge_u32 s23, 200000
    s_cselect_b32 s25, 200000, s25
    s_cbranch_scc1 go_438
    s_branch gl_437
go_438:
    v_mfma_f32_16x16x32_bf16 v[40:43], a[208:211], v[32:35], v[40:43]
    v_mfma_f32_16x16x32_bf16 v[44:47], a[212:215], v[32:35], v[44:47]
    v_mfma_f32_16x16x32_bf16 v[48:51], a[240:243], v[32:35], v[48:51]
    v_mfma_f32_16x16x32_bf16 v[52:55], a[244:247], v[32:35], v[52:55]
gd_436:
    s_cmp_eq_u64 s[92:93], 0
    s_cbranch_scc1 gd_439
gl_440:
    v_max3_u32 v19, v36, v37, v38
    v_max_u32 v19, v19, v39
    v_cmp_eq_u32 vcc, -1, v19
    s_nop 0
    s_cbranch_vccz go_441
    s_mov_b64 s[92:93], vcc
    s_waitcnt vmcnt(2)
    s_mov_b64 exec, s[92:93]
    buffer_load_dwordx4 v[36:39], v8, s[4:7], s16 offen offset:3072 sc1
    s_mov_b64 exec, -1
    s_add_u32 s23, s23, 1
    s_cmp_ge_u32 s23, 200000
    s_cselect_b32 s25, 200000, s25
    s_cbranch_scc1 go_441
    s_branch gl_440
go_441:
    v_mfma_f32_16x16x32_bf16 v[40:43], a[216:219], v[36:39], v[40:43]
    v_mfma_f32_16x16x32_bf16 v[44:47], a[220:223], v[36:39], v[44:47]
    v_mfma_f32_16x16x32_bf16 v[48:51], a[248:251], v[36:39], v[48:51]
    v_mfma_f32_16x16x32_bf16 v[52:55], a[252:255], v[36:39], v[52:55]
gd_439:
    s_branch gc_422
gs_424:
    s_mov_b64 s[88:89], vcc
    s_mov_b64 exec, s[88:89]
    buffer_load_dwordx4 v[28:31], v8, s[4:7], s16 offen offset:1024 sc1
    s_mov_b64 exec, -1
    s_waitcnt vmcnt(1)
    v_max3_u32 v19, v32, v33, v34
    v_max_u32 v19, v19, v35
    v_cmp_eq_u32 s[90:91], -1, v19
    v_max3_u32 v19, v36, v37, v38
    v_max_u32 v19, v19, v39
    v_cmp_eq_u32 s[92:93], -1, v19
    s_mov_b64 exec, s[90:91]
    buffer_load_dwordx4 v[32:35], v8, s[4:7], s16 offen offset:2048 sc1
    s_mov_b64 exec, s[92:93]
    buffer_load_dwordx4 v[36:39], v8, s[4:7], s16 offen offset:3072 sc1
    s_mov_b64 exec, -1
    s_cmp_lg_u64 s[90:91], 0
    s_cbranch_scc1 gk_442
    v_mfma_f32_16x16x32_bf16 v[40:43], a[208:211], v[32:35], v[40:43]
    v_mfma_f32_16x16x32_bf16 v[44:47], a[212:215], v[32:35], v[44:47]
    v_mfma_f32_16x16x32_bf16 v[48:51], a[240:243], v[32:35], v[48:51]
    v_mfma_f32_16x16x32_bf16 v[52:55], a[244:247], v[32:35], v[52:55]
    s_mov_b64 exec, s[88:89]
    buffer_load_dwordx4 v[28:31], v8, s[4:7], s16 offen offset:1024 sc1
    s_mov_b64 exec, s[92:93]
    buffer_load_dwordx4 v[36:39], v8, s[4:7], s16 offen offset:3072 sc1
    s_mov_b64 exec, -1
gk_442:
    s_cmp_lg_u64 s[92:93], 0
    s_cbranch_scc1 gk_443
    v_mfma_f32_16x16x32_bf16 v[40:43], a[216:219], v[36:39], v[40:43]
    v_mfma_f32_16x16x32_bf16 v[44:47], a[220:223], v[36:39], v[44:47]
    v_mfma_f32_16x16x32_bf16 v[48:51], a[248:251], v[36:39], v[48:51]
    v_mfma_f32_16x16x32_bf16 v[52:55], a[252:255], v[36:39], v[52:55]
    s_mov_b64 exec, s[88:89]
    buffer_load_dwordx4 v[28:31], v8, s[4:7], s16 offen offset:1024 sc1
    s_mov_b64 exec, s[90:91]
    buffer_load_dwordx4 v[32:35], v8, s[4:7], s16 offen offset:2048 sc1
    s_mov_b64 exec, -1
gk_443:
gl_445:
    v_max3_u32 v19, v28, v29, v30
    v_max_u32 v19, v19, v31
    v_cmp_eq_u32 vcc, -1, v19
    s_nop 0
    s_cbranch_vccz go_446
    s_mov_b64 s[88:89], vcc
    s_waitcnt vmcnt(6)
    s_mov_b64 exec, s[88:89]
    buffer_load_dwordx4 v[28:31], v8, s[4:7], s16 offen offset:1024 sc1
    s_mov_b64 exec, s[90:91]
    buffer_load_dwordx4 v[32:35], v8, s[4:7], s16 offen offset:2048 sc1
    s_mov_b64 exec, s[92:93]
    buffer_load_dwordx4 v[36:39], v8, s[4:7], s16 offen offset:3072 sc1
    s_mov_b64 exec, -1
    s_add_u32 s23, s23, 1
    s_cmp_ge_u32 s23, 200000
    s_cselect_b32 s25, 200000, s25
    s_cbranch_scc1 go_446
    s_branch gl_445
go_446:
    v_mfma_f32_16x16x32_bf16 v[40:43], a[200:203], v[28:31], v[40:43]
    v_mfma_f32_16x16x32_bf16 v[44:47], a[204:207], v[28:31], v[44:47]
    v_mfma_f32_16x16x32_bf16 v[48:51], a[232:235], v[28:31], v[48:51]
    v_mfma_f32_16x16x32_bf16 v[52:55], a[236:239], v[28:31], v[52:55]
gd_444:
    s_cmp_eq_u64 s[90:91], 0
    s_cbranch_scc1 gd_447
gl_448:
    v_max3_u32 v19, v32, v33, v34
    v_max_u32 v19, v19, v35
    v_cmp_eq_u32 vcc, -1, v19
    s_nop 0
    s_cbranch_vccz go_449
    s_mov_b64 s[90:91], vcc
    s_waitcnt vmcnt(4)
    s_mov_b64 exec, s[90:91]
    buffer_load_dwordx4 v[32:35], v8, s[4:7], s16 offen offset:2048 sc1
    s_mov_b64 exec, s[92:93]
    buffer_load_dwordx4 v[36:39], v8, s[4:7], s16 offen offset:3072 sc1
    s_mov_b64 exec, -1
    s_add_u32 s23, s23, 1
    s_cmp_ge_u32 s23, 200000
    s_cselect_b32 s25, 200000, s25
    s_cbranch_scc1 go_449
    s_branch gl_448
go_449:
    v_mfma_f32_16x16x32_bf16 v[40:43], a[208:211], v[32:35], v[40:43]
    v_mfma_f32_16x16x32_bf16 v[44:47], a[212:215], v[32:35], v[44:47]
    v_mfma_f32_16x16x32_bf16 v[48:51], a[240:243], v[32:35], v[48:51]
    v_mfma_f32_16x16x32_bf16 v[52:55], a[244:247], v[32:35], v[52:55]
gd_447:
    s_cmp_eq_u64 s[92:93], 0
    s_cbranch_scc1 gd_450
gl_451:
    v_max3_u32 v19, v36, v37, v38
    v_max_u32 v19, v19, v39
    v_cmp_eq_u32 vcc, -1, v19
    s_nop 0
    s_cbranch_vccz go_452
    s_mov_b64 s[92:93], vcc
    s_waitcnt vmcnt(2)
    s_mov_b64 exec, s[92:93]
    buffer_load_dwordx4 v[36:39], v8, s[4:7], s16 offen offset:3072 sc1
    s_mov_b64 exec, -1
    s_add_u32 s23, s23, 1
    s_cmp_ge_u32 s23, 200000
    s_cselect_b32 s25, 200000, s25
    s_cbranch_scc1 go_452
    s_branch gl_451
go_452:
    v_mfma_f32_16x16x32_bf16 v[40:43], a[216:219], v[36:39], v[40:43]
    v_mfma_f32_16x16x32_bf16 v[44:47], a[220:223], v[36:39], v[44:47]
    v_mfma_f32_16x16x32_bf16 v[48:51], a[248:251], v[36:39], v[48:51]
    v_mfma_f32_16x16x32_bf16 v[52:55], a[252:255], v[36:39], v[52:55]
gd_450:
    s_branch gc_422
gs_425:
    s_mov_b64 s[90:91], vcc
    s_mov_b64 exec, s[90:91]
    buffer_load_dwordx4 v[32:35], v8, s[4:7], s16 offen offset:2048 sc1
    s_mov_b64 exec, -1
    s_waitcnt vmcnt(1)
    v_max3_u32 v19, v36, v37, v38
    v_max_u32 v19, v19, v39
    v_cmp_eq_u32 s[92:93], -1, v19
    s_nop 0
    s_mov_b64 exec, s[92:93]
    buffer_load_dwordx4 v[36:39], v8, s[4:7], s16 offen offset:3072 sc1
    s_mov_b64 exec, -1
    s_cmp_lg_u64 s[92:93], 0
    s_cbranch_scc1 gk_453
    v_mfma_f32_16x16x32_bf16 v[40:43], a[216:219], v[36:39], v[40:43]
    v_mfma_f32_16x16x32_bf16 v[44:47], a[220:223], v[36:39], v[44:47]
    v_mfma_f32_16x16x32_bf16 v[48:51], a[248:251], v[36:39], v[48:51]
    v_mfma_f32_16x16x32_bf16 v[52:55], a[252:255], v[36:39], v[52:55]
    s_mov_b64 exec, s[90:91]
    buffer_load_dwordx4 v[32:35], v8, s[4:7], s16 offen offset:2048 sc1
    s_mov_b64 exec, -1
gk_453:
gl_455:
    v_max3_u32 v19, v32, v33, v34
    v_max_u32 v19, v19, v35
    v_cmp_eq_u32 vcc, -1, v19
    s_nop 0
    s_cbranch_vccz go_456
    s_mov_b64 s[90:91], vcc
    s_waitcnt vmcnt(4)
    s_mov_b64 exec, s[90:91]
    buffer_load_dwordx4 v[32:35], v8, s[4:7], s16 offen offset:2048 sc1
    s_mov_b64 exec, s[92:93]
    buffer_load_dwordx4 v[36:39], v8, s[4:7], s16 offen offset:3072 sc1
    s_mov_b64 exec, -1
    s_add_u32 s23, s23, 1
    s_cmp_ge_u32 s23, 200000
    s_cselect_b32 s25, 200000, s25
    s_cbranch_scc1 go_456
    s_branch gl_455
go_456:
    v_mfma_f32_16x16x32_bf16 v[40:43], a[208:211], v[32:35], v[40:43]
    v_mfma_f32_16x16x32_bf16 v[44:47], a[212:215], v[32:35], v[44:47]
    v_mfma_f32_16x16x32_bf16 v[48:51], a[240:243], v[32:35], v[48:51]
    v_mfma_f32_16x16x32_bf16 v[52:55], a[244:247], v[32:35], v[52:55]
gd_454:
    s_cmp_eq_u64 s[92:93], 0
    s_cbranch_scc1 gd_457
gl_458:
    v_max3_u32 v19, v36, v37, v38
    v_max_u32 v19, v19, v39
    v_cmp_eq_u32 vcc, -1, v19
    s_nop 0
    s_cbranch_vccz go_459
    s_mov_b64 s[92:93], vcc
    s_waitcnt vmcnt(2)
    s_mov_b64 exec, s[92:93]
    buffer_load_dwordx4 v[36:39], v8, s[4:7], s16 offen offset:3072 sc1
    s_mov_b64 exec, -1
    s_add_u32 s23, s23, 1
    s_cmp_ge_u32 s23, 200000
    s_cselect_b32 s25, 200000, s25
    s_cbranch_scc1 go_459
    s_branch gl_458
go_459:
    v_mfma_f32_16x16x32_bf16 v[40:43], a[216:219], v[36:39], v[40:43]
    v_mfma_f32_16x16x32_bf16 v[44:47], a[220:223], v[36:39], v[44:47]
    v_mfma_f32_16x16x32_bf16 v[48:51], a[248:251], v[36:39], v[48:51]
    v_mfma_f32_16x16x32_bf16 v[52:55], a[252:255], v[36:39], v[52:55]
gd_457:
    s_branch gc_422
gs_426:
    s_mov_b64 s[92:93], vcc
    s_mov_b64 exec, s[92:93]
    buffer_load_dwordx4 v[36:39], v8, s[4:7], s16 offen offset:3072 sc1
    s_mov_b64 exec, -1
gl_461:
    v_max3_u32 v19, v36, v37, v38
    v_max_u32 v19, v19, v39
    v_cmp_eq_u32 vcc, -1, v19
    s_nop 0
    s_cbranch_vccz go_462
    s_mov_b64 s[92:93], vcc
    s_waitcnt vmcnt(2)
    s_mov_b64 exec, s[92:93]
    buffer_load_dwordx4 v[36:39], v8, s[4:7], s16 offen offset:3072 sc1
    s_mov_b64 exec, -1
    s_add_u32 s23, s23, 1
    s_cmp_ge_u32 s23, 200000
    s_cselect_b32 s25, 200000, s25
    s_cbranch_scc1 go_462
    s_branch gl_461
go_462:
    v_mfma_f32_16x16x32_bf16 v[40:43], a[216:219], v[36:39], v[40:43]
    v_mfma_f32_16x16x32_bf16 v[44:47], a[220:223], v[36:39], v[44:47]
    v_mfma_f32_16x16x32_bf16 v[48:51], a[248:251], v[36:39], v[48:51]
    v_mfma_f32_16x16x32_bf16 v[52:55], a[252:255], v[36:39], v[52:55]
gd_460:
    s_branch gc_422
.p2align 6
recur_slow_w1:
    s_sleep 2
    s_mov_b32 s23, s25
    buffer_load_dwordx4 v[24:27], v2, s[4:7], s16 offen offset:0 sc1
    buffer_load_dwordx4 v[28:31], v2, s[4:7], s16 offen offset:1024 sc1
    buffer_load_dwordx4 v[32:35], v2, s[4:7], s16 offen offset:2048 sc1
    buffer_load_dwordx4 v[36:39], v2, s[4:7], s16 offen offset:3072 sc1
    s_waitcnt vmcnt(3)
    v_max3_u32 v19, v24, v25, v26
    v_max_u32 v19, v19, v27
    v_cmp_eq_u32 vcc, -1, v19
    s_nop 0
    s_cbranch_vccnz gs_466
    v_mfma_f32_16x16x32_bf16 v[40:43], a[0:3], v[24:27], v[40:43]
    v_mfma_f32_16x16x32_bf16 v[44:47], a[4:7], v[24:27], v[44:47]
    v_mfma_f32_16x16x32_bf16 v[56:59], a[64:67], v[24:27], v[56:59]
    v_mfma_f32_16x16x32_bf16 v[60:63], a[68:71], v[24:27], v[60:63]
    v_mfma_f32_16x16x32_bf16 v[48:51], a[32:35], v[24:27], v[48:51]
    s_waitcnt vmcnt(2)
    v_max3_u32 v19, v28, v29, v30
    v_mfma_f32_16x16x32_bf16 v[52:55], a[36:39], v[24:27], v[52:55]
    v_max_u32 v19, v19, v31
    v_mfma_f32_16x16x32_bf16 v[64:67], a[96:99], v[24:27], v[64:67]
    v_cmp_eq_u32 vcc, -1, v19
    v_mfma_f32_16x16x32_bf16 v[68:71], a[100:103], v[24:27], v[68:71]
    s_cbranch_vccnz gs_467
    v_mfma_f32_16x16x32_bf16 v[40:43], a[8:11], v[28:31], v[40:43]
    v_mfma_f32_16x16x32_bf16 v[44:47], a[12:15], v[28:31], v[44:47]
    v_mfma_f32_16x16x32_bf16 v[56:59], a[72:75], v[28:31], v[56:59]
    v_mfma_f32_16x16x32_bf16 v[60:63], a[76:79], v[28:31], v[60:63]
    v_mfma_f32_16x16x32_bf16 v[48:51], a[40:43], v[28:31], v[48:51]
    s_waitcnt vmcnt(1)
    v_max3_u32 v19, v32, v33, v34
    v_mfma_f32_16x16x32_bf16 v[52:55], a[44:47], v[28:31], v[52:55]
    v_max_u32 v19, v19, v35
    v_mfma_f32_16x16x32_bf16 v[64:67], a[104:107], v[28:31], v[64:67]
    v_cmp_eq_u32 vcc, -1, v19
    v_mfma_f32_16x16x32_bf16 v[68:71], a[108:111], v[28:31], v[68:71]
    s_cbranch_vccnz gs_468
    v_mfma_f32_16x16x32_bf16 v[40:43], a[16:19], v[32:35], v[40:43]
    v_mfma_f32_16x16x32_bf16 v[44:47], a[20:23], v[32:35], v[44:47]
    v_mfma_f32_16x16x32_bf16 v[56:59], a[80:83], v[32:35], v[56:59]
    v_mfma_f32_16x16x32_bf16 v[60:63], a[84:87], v[32:35], v[60:63]
    v_mfma_f32_16x16x32_bf16 v[48:51], a[48:51], v[32:35], v[48:51]
    s_waitcnt vmcnt(0)
    v_max3_u32 v19, v36, v37, v38
    v_mfma_f32_16x16x32_bf16 v[52:55], a[52:55], v[32:35], v[52:55]
    v_max_u32 v19, v19, v39
    v_mfma_f32_16x16x32_bf16 v[64:67], a[112:115], v[32:35], v[64:67]
    v_cmp_eq_u32 vcc, -1, v19
    v_mfma_f32_16x16x32_bf16 v[68:71], a[116:119], v[32:35], v[68:71]
    s_cbranch_vccnz gs_469
    v_mfma_f32_16x16x32_bf16 v[40:43], a[24:27], v[36:39], v[40:43]
    v_mfma_f32_16x16x32_bf16 v[44:47], a[28:31], v[36:39], v[44:47]
    v_mfma_f32_16x16x32_bf16 v[56:59], a[88:91], v[36:39], v[56:59]
    v_mfma_f32_16x16x32_bf16 v[60:63], a[92:95], v[36:39], v[60:63]
    v_mfma_f32_16x16x32_bf16 v[48:51], a[56:59], v[36:39], v[48:51]
    v_mfma_f32_16x16x32_bf16 v[52:55], a[60:63], v[36:39], v[52:55]
    v_mfma_f32_16x16x32_bf16 v[64:67], a[120:123], v[36:39], v[64:67]
    v_mfma_f32_16x16x32_bf16 v[68:71], a[124:127], v[36:39], v[68:71]
gc_465:
    s_nop 1
    v_add_f32_dpp v88, v44, v40 row_ror:8 row_mask:0xf bank_mask:0x3
    v_add_f32_dpp v89, v45, v41 row_ror:8 row_mask:0xf bank_mask:0x3
    v_add_f32_dpp v90, v46, v42 row_ror:8 row_mask:0xf bank_mask:0x3
    v_add_f32_dpp v91, v47, v43 row_ror:8 row_mask:0xf bank_mask:0x3
    v_add_f32_dpp v88, v56, v60 row_ror:8 row_mask:0xf bank_mask:0xc
    v_add_f32_dpp v89, v57, v61 row_ror:8 row_mask:0xf bank_mask:0xc
    v_add_f32_dpp v90, v58, v62 row_ror:8 row_mask:0xf bank_mask:0xc
    v_add_f32_dpp v91, v59, v63 row_ror:8 row_mask:0xf bank_mask:0xc
    ds_write_b128 v17, v[88:91] offset:0
    v_add_f32_dpp v92, v52, v48 row_ror:8 row_mask:0xf bank_mask:0x3
    v_add_f32_dpp v93, v53, v49 row_ror:8 row_mask:0xf bank_mask:0x3
    v_add_f32_dpp v94, v54, v50 row_ror:8 row_mask:0xf bank_mask:0x3
    v_add_f32_dpp v95, v55, v51 row_ror:8 row_mask:0xf bank_mask:0x3
    v_mfma_f32_16x16x32_bf16 v[72:75], v[24:27], a[128:131], 0
    v_add_f32_dpp v92, v64, v68 row_ror:8 row_mask:0xf bank_mask:0xc
    v_add_f32_dpp v93, v65, v69 row_ror:8 row_mask:0xf bank_mask:0xc
    v_add_f32_dpp v94, v66, v70 row_ror:8 row_mask:0xf bank_mask:0xc
    v_add_f32_dpp v95, v67, v71 row_ror:8 row_mask:0xf bank_mask:0xc
    v_mfma_f32_16x16x32_bf16 v[80:83], v[24:27], a[160:163], 0
    ds_write_b128 v17, v[92:95] offset:1024
    v_mfma_f32_16x16x32_bf16 v[76:79], v[24:27], a[132:135], 0
    v_mfma_f32_16x16x32_bf16 v[84:87], v[24:27], a[164:167], 0
    s_waitcnt lgkmcnt(0)
    s_barrier
    buffer_load_dwordx4 v[228:231], v13, s[4:7], s18 offen offset:0 sc1
    buffer_load_dwordx4 v[232:235], v13, s[4:7], s18 offen offset:256 sc1
    s_add_u32 s18, s18, 2048
    s_min_u32 s18, s18, 35780608
    v_mfma_f32_16x16x32_bf16 v[72:75], v[28:31], a[136:139], v[72:75]
    v_mfma_f32_16x16x32_bf16 v[80:83], v[28:31], a[168:171], v[80:83]
    v_mfma_f32_16x16x32_bf16 v[76:79], v[28:31], a[140:143], v[76:79]
    v_mfma_f32_16x16x32_bf16 v[84:87], v[28:31], a[172:175], v[84:87]
    v_mfma_f32_16x16x32_bf16 v[72:75], v[32:35], a[144:147], v[72:75]
    v_mfma_f32_16x16x32_bf16 v[80:83], v[32:35], a[176:179], v[80:83]
    v_mfma_f32_16x16x32_bf16 v[76:79], v[32:35], a[148:151], v[76:79]
    v_mfma_f32_16x16x32_bf16 v[84:87], v[32:35], a[180:183], v[84:87]
    v_mfma_f32_16x16x32_bf16 v[72:75], v[36:39], a[152:155], v[72:75]
    v_mfma_f32_16x16x32_bf16 v[80:83], v[36:39], a[184:187], v[80:83]
    v_mfma_f32_16x16x32_bf16 v[76:79], v[36:39], a[156:159], v[76:79]
    v_mfma_f32_16x16x32_bf16 v[84:87], v[36:39], a[188:191], v[84:87]
    s_nop 6
    v_mov_b32_dpp v72, v76 quad_perm:[0,1,2,3] row_mask:0xc bank_mask:0xf
    v_mov_b32_dpp v73, v77 quad_perm:[0,1,2,3] row_mask:0xc bank_mask:0xf
    v_mov_b32_dpp v74, v78 quad_perm:[0,1,2,3] row_mask:0xc bank_mask:0xf
    v_mov_b32_dpp v75, v79 quad_perm:[0,1,2,3] row_mask:0xc bank_mask:0xf
    ds_write_b128 v17, v[72:75] offset:8192
    v_mov_b32_dpp v80, v84 quad_perm:[0,1,2,3] row_mask:0xc bank_mask:0xf
    v_mov_b32_dpp v81, v85 quad_perm:[0,1,2,3] row_mask:0xc bank_mask:0xf
    v_mov_b32_dpp v82, v86 quad_perm:[0,1,2,3] row_mask:0xc bank_mask:0xf
    v_mov_b32_dpp v83, v87 quad_perm:[0,1,2,3] row_mask:0xc bank_mask:0xf
    ds_write_b128 v17, v[80:83] offset:9216
    v_mov_b32 v40, 0
    v_mov_b32 v41, 0
    v_mov_b32 v42, 0
    v_mov_b32 v43, 0
    v_mov_b32 v44, 0
    v_mov_b32 v45, 0
    v_mov_b32 v46, 0
    v_mov_b32 v47, 0
    v_mov_b32 v48, 0
    v_mov_b32 v49, 0
    v_mov_b32 v50, 0
    v_mov_b32 v51, 0
    v_mov_b32 v52, 0
    v_mov_b32 v53, 0
    v_mov_b32 v54, 0
    v_mov_b32 v55, 0
    s_waitcnt lgkmcnt(0)
    s_barrier
    s_cmp_eq_u32 s15, 63
    s_cbranch_scc1 recur_end
    s_mov_b32 s23, s25
    buffer_load_dwordx4 v[208:211], v5, s[4:7], s16 offen offset:0 sc1
    buffer_load_dword v224, v6, s[4:7], s16 offen offset:0 sc1
    buffer_load_dwordx4 v[212:215], v5, s[4:7], s16 offen offset:1024 sc1
    buffer_load_dword v225, v6, s[4:7], s16 offen offset:256 sc1
    buffer_load_dwordx4 v[216:219], v5, s[4:7], s16 offen offset:2048 sc1
    buffer_load_dword v226, v6, s[4:7], s16 offen offset:512 sc1
    buffer_load_dwordx4 v[220:223], v5, s[4:7], s16 offen offset:3072 sc1
    buffer_load_dword v227, v6, s[4:7], s16 offen offset:768 sc1
    s_waitcnt vmcnt(6)
    v_max3_u32 v19, v208, v209, v210
    v_max3_u32 v19, v19, v211, v224
    v_cmp_eq_u32 vcc, -1, v19
    s_nop 0
    s_cbranch_vccnz gs_507
    s_waitcnt vmcnt(4)
    v_max3_u32 v19, v212, v213, v214
    v_max3_u32 v19, v19, v215, v225
    v_cmp_eq_u32 vcc, -1, v19
    s_nop 0
    s_cbranch_vccnz gs_508
    s_waitcnt vmcnt(2)
    v_max3_u32 v19, v216, v217, v218
    v_max3_u32 v19, v19, v219, v226
    v_cmp_eq_u32 vcc, -1, v19
    s_nop 0
    s_cbranch_vccnz gs_509
    s_waitcnt vmcnt(0)
    v_max3_u32 v19, v220, v221, v222
    v_max3_u32 v19, v19, v223, v227
    v_cmp_eq_u32 vcc, -1, v19
    s_nop 0
    s_cbranch_vccnz gs_510
gc_506:
    s_barrier
    ds_read_b32 v154, v16 offset:24576
    ds_read_b32 v158, v16 offset:24580
    ds_read_b32 v162, v16 offset:24584
    ds_read_b32 v166, v16 offset:24588
    v_add_f32 v180, v208, v212
    v_add_f32 v181, v209, v213
    v_add_f32 v182, v210, v214
    v_add_f32 v183, v211, v215
    v_add_f32 v184, v224, v225
    v_add_f32 v96, v216, v220
    v_add_f32 v97, v217, v221
    v_add_f32 v98, v218, v222
    v_add_f32 v99, v219, v223
    v_add_f32 v100, v226, v227
    v_add_f32 v180, v180, v96
    v_add_f32 v181, v181, v97
    v_add_f32 v182, v182, v98
    v_add_f32 v183, v183, v99
    v_add_f32 v184, v184, v100
    v_max3_f32 v185, v180, v181, v182
    v_max3_f32 v185, v185, v183, v184
    s_nop 1
    v_max_f32_dpp v185, v185, v185 row_ror:8 row_mask:0xf bank_mask:0xf
    v_mov_b32 v186, v185
    s_nop 1
    v_permlane16_swap_b32 v185, v186
    v_max_f32 v185, v185, v186
    v_mov_b32 v186, v185
    s_nop 1
    v_permlane32_swap_b32 v185, v186
    v_max_f32 v185, v185, v186
    v_mul_f32 v185, s24, v185
    v_fma_f32 v180, v180, s24, -v185
    v_fma_f32 v181, v181, s24, -v185
    v_fma_f32 v182, v182, s24, -v185
    v_fma_f32 v183, v183, s24, -v185
    v_fma_f32 v184, v184, s24, -v185
    v_exp_f32 v180, v180
    v_exp_f32 v181, v181
    v_exp_f32 v182, v182
    v_exp_f32 v183, v183
    v_exp_f32 v184, v184
    v_cvt_pk_bf16_f32 v176, v180, v181
    v_cvt_pk_bf16_f32 v177, v182, v183
    v_cvt_pk_bf16_f32 v178, v184, v179
    s_waitcnt lgkmcnt(0)
    s_nop 0
    v_mfma_f32_16x16x32_bf16 v[240:243], v[236:239], v[176:179], 0
    v_mfma_f32_16x16x32_bf16 v[188:191], v[152:155], v[176:179], 0
    v_mfma_f32_16x16x32_bf16 v[192:195], v[156:159], v[176:179], 0
    v_mfma_f32_16x16x32_bf16 v[196:199], v[160:163], v[176:179], 0
    v_mfma_f32_16x16x32_bf16 v[200:203], v[164:167], v[176:179], 0
    s_nop 3
    v_add_f32_dpp v185, v240, v240 row_ror:8 row_mask:0xf bank_mask:0xf
    v_rcp_f32 v185, v185
    v_add_f32_dpp v88, v192, v188 row_ror:8 row_mask:0xf bank_mask:0x3
    v_add_f32_dpp v89, v193, v189 row_ror:8 row_mask:0xf bank_mask:0x3
    v_add_f32_dpp v90, v194, v190 row_ror:8 row_mask:0xf bank_mask:0x3
    v_add_f32_dpp v91, v195, v191 row_ror:8 row_mask:0xf bank_mask:0x3
    v_add_f32_dpp v88, v196, v200 row_ror:8 row_mask:0xf bank_mask:0xc
    v_add_f32_dpp v89, v197, v201 row_ror:8 row_mask:0xf bank_mask:0xc
    v_add_f32_dpp v90, v198, v202 row_ror:8 row_mask:0xf bank_mask:0xc
    v_add_f32_dpp v91, v199, v203 row_ror:8 row_mask:0xf bank_mask:0xc
    v_mul_f32 v88, v88, v185
    v_mul_f32 v89, v89, v185
    v_mul_f32 v90, v90, v185
    v_mul_f32 v91, v91, v185
    v_cvt_pk_bf16_f32 v88, v88, v89
    v_cvt_pk_bf16_f32 v89, v90, v91
    buffer_store_dwordx2 v[88:89], v7, s[4:7], s16 offen sc1
    s_sleep 1
    s_mov_b32 s23, s25
    buffer_load_dwordx4 v[24:27], v8, s[4:7], s16 offen offset:0 sc1
    buffer_load_dwordx4 v[28:31], v8, s[4:7], s16 offen offset:1024 sc1
    buffer_load_dwordx4 v[32:35], v8, s[4:7], s16 offen offset:2048 sc1
    buffer_load_dwordx4 v[36:39], v8, s[4:7], s16 offen offset:3072 sc1
    s_waitcnt vmcnt(3)
    v_max3_u32 v19, v24, v25, v26
    v_max_u32 v19, v19, v27
    v_cmp_eq_u32 vcc, -1, v19
    s_nop 0
    s_cbranch_vccnz gs_542
    v_mfma_f32_16x16x32_bf16 v[40:43], a[192:195], v[24:27], v[40:43]
    s_waitcnt vmcnt(2)
    v_max3_u32 v19, v28, v29, v30
    v_mfma_f32_16x16x32_bf16 v[44:47], a[196:199], v[24:27], v[44:47]
    v_max_u32 v19, v19, v31
    v_mfma_f32_16x16x32_bf16 v[48:51], a[224:227], v[24:27], v[48:51]
    v_cmp_eq_u32 vcc, -1, v19
    v_mfma_f32_16x16x32_bf16 v[52:55], a[228:231], v[24:27], v[52:55]
    s_cbranch_vccnz gs_543
    v_mfma_f32_16x16x32_bf16 v[40:43], a[200:203], v[28:31], v[40:43]
    s_waitcnt vmcnt(1)
    v_max3_u32 v19, v32, v33, v34
    v_mfma_f32_16x16x32_bf16 v[44:47], a[204:207], v[28:31], v[44:47]
    v_max_u32 v19, v19, v35
    v_mfma_f32_16x16x32_bf16 v[48:51], a[232:235], v[28:31], v[48:51]
    v_cmp_eq_u32 vcc, -1, v19
    v_mfma_f32_16x16x32_bf16 v[52:55], a[236:239], v[28:31], v[52:55]
    s_cbranch_vccnz gs_544
    v_mfma_f32_16x16x32_bf16 v[40:43], a[208:211], v[32:35], v[40:43]
    s_waitcnt vmcnt(0)
    v_max3_u32 v19, v36, v37, v38
    v_mfma_f32_16x16x32_bf16 v[44:47], a[212:215], v[32:35], v[44:47]
    v_max_u32 v19, v19, v39
    v_mfma_f32_16x16x32_bf16 v[48:51], a[240:243], v[32:35], v[48:51]
    v_cmp_eq_u32 vcc, -1, v19
    v_mfma_f32_16x16x32_bf16 v[52:55], a[244:247], v[32:35], v[52:55]
    s_cbranch_vccnz gs_545
    v_mfma_f32_16x16x32_bf16 v[40:43], a[216:219], v[36:39], v[40:43]
    v_mfma_f32_16x16x32_bf16 v[44:47], a[220:223], v[36:39], v[44:47]
    v_mfma_f32_16x16x32_bf16 v[48:51], a[248:251], v[36:39], v[48:51]
    v_mfma_f32_16x16x32_bf16 v[52:55], a[252:255], v[36:39], v[52:55]
gc_541:
    s_nop 5
    v_add_f32_dpp v88, v44, v40 row_ror:8 row_mask:0xf bank_mask:0x3
    v_add_f32_dpp v89, v45, v41 row_ror:8 row_mask:0xf bank_mask:0x3
    v_add_f32_dpp v90, v46, v42 row_ror:8 row_mask:0xf bank_mask:0x3
    v_add_f32_dpp v91, v47, v43 row_ror:8 row_mask:0xf bank_mask:0x3
    v_add_f32_dpp v88, v48, v52 row_ror:8 row_mask:0xf bank_mask:0xc
    v_add_f32_dpp v89, v49, v53 row_ror:8 row_mask:0xf bank_mask:0xc
    v_add_f32_dpp v90, v50, v54 row_ror:8 row_mask:0xf bank_mask:0xc
    v_add_f32_dpp v91, v51, v55 row_ror:8 row_mask:0xf bank_mask:0xc
    ds_write_b128 v17, v[88:91] offset:16384
    s_waitcnt lgkmcnt(0)
    s_barrier
    v_mov_b32 v152, v228
    v_mov_b32 v153, v229
    v_mov_b32 v156, v230
    v_mov_b32 v157, v231
    v_mov_b32 v160, v232
    v_mov_b32 v161, v233
    v_mov_b32 v164, v234
    v_mov_b32 v165, v235
    v_mov_b32 v40, 0
    v_mov_b32 v41, 0
    v_mov_b32 v42, 0
    v_mov_b32 v43, 0
    v_mov_b32 v44, 0
    v_mov_b32 v45, 0
    v_mov_b32 v46, 0
    v_mov_b32 v47, 0
    v_mov_b32 v48, 0
    v_mov_b32 v49, 0
    v_mov_b32 v50, 0
    v_mov_b32 v51, 0
    v_mov_b32 v52, 0
    v_mov_b32 v53, 0
    v_mov_b32 v54, 0
    v_mov_b32 v55, 0
    v_mov_b32 v56, 0
    v_mov_b32 v57, 0
    v_mov_b32 v58, 0
    v_mov_b32 v59, 0
    v_mov_b32 v60, 0
    v_mov_b32 v61, 0
    v_mov_b32 v62, 0
    v_mov_b32 v63, 0
    v_mov_b32 v64, 0
    v_mov_b32 v65, 0
    v_mov_b32 v66, 0
    v_mov_b32 v67, 0
    v_mov_b32 v68, 0
    v_mov_b32 v69, 0
    v_mov_b32 v70, 0
    v_mov_b32 v71, 0
    s_add_u32 s94, s15, 3
    s_min_u32 s94, s94, 64
    s_mov_b32 s23, s25
fw_582:
    s_cmp_ge_u32 s85, s94
    s_cbranch_scc1 fo_583
    buffer_load_dword v19, v245, s[4:7], 0 offen sc1
    s_add_u32 s23, s23, 1
    s_waitcnt vmcnt(0)
    v_readfirstlane_b32 s85, v19
    s_cmp_lt_u32 s23, 200000
    s_cbranch_scc1 fw_582
    s_mov_b32 s25, 200000
fo_583:
    s_mov_b32 s21, s16
    s_mov_b32 s16, s42
    s_mov_b32 s42, s43
    s_mov_b32 s43, s44
    s_mov_b32 s44, s21
    s_add_u32 s84, s84, 262144
    s_add_u32 s15, s15, 1
    s_barrier
    s_branch recur_slow_w1
gs_466:
    s_mov_b64 s[86:87], vcc
    s_mov_b64 exec, s[86:87]
    buffer_load_dwordx4 v[24:27], v2, s[4:7], s16 offen offset:0 sc1
    s_mov_b64 exec, -1
    s_waitcnt vmcnt(1)
    v_max3_u32 v19, v28, v29, v30
    v_max_u32 v19, v19, v31
    v_cmp_eq_u32 s[88:89], -1, v19
    v_max3_u32 v19, v32, v33, v34
    v_max_u32 v19, v19, v35
    v_cmp_eq_u32 s[90:91], -1, v19
    v_max3_u32 v19, v36, v37, v38
    v_max_u32 v19, v19, v39
    v_cmp_eq_u32 s[92:93], -1, v19
    s_mov_b64 exec, s[88:89]
    buffer_load_dwordx4 v[28:31], v2, s[4:7], s16 offen offset:1024 sc1
    s_mov_b64 exec, s[90:91]
    buffer_load_dwordx4 v[32:35], v2, s[4:7], s16 offen offset:2048 sc1
    s_mov_b64 exec, s[92:93]
    buffer_load_dwordx4 v[36:39], v2, s[4:7], s16 offen offset:3072 sc1
    s_mov_b64 exec, -1
    s_cmp_lg_u64 s[88:89], 0
    s_cbranch_scc1 gk_470
    v_mfma_f32_16x16x32_bf16 v[40:43], a[8:11], v[28:31], v[40:43]
    v_mfma_f32_16x16x32_bf16 v[44:47], a[12:15], v[28:31], v[44:47]
    v_mfma_f32_16x16x32_bf16 v[56:59], a[72:75], v[28:31], v[56:59]
    v_mfma_f32_16x16x32_bf16 v[60:63], a[76:79], v[28:31], v[60:63]
    v_mfma_f32_16x16x32_bf16 v[48:51], a[40:43], v[28:31], v[48:51]
    v_mfma_f32_16x16x32_bf16 v[52:55], a[44:47], v[28:31], v[52:55]
    v_mfma_f32_16x16x32_bf16 v[64:67], a[104:107], v[28:31], v[64:67]
    v_mfma_f32_16x16x32_bf16 v[68:71], a[108:111], v[28:31], v[68:71]
    s_mov_b64 exec, s[86:87]
    buffer_load_dwordx4 v[24:27], v2, s[4:7], s16 offen offset:0 sc1
    s_mov_b64 exec, s[90:91]
    buffer_load_dwordx4 v[32:35], v2, s[4:7], s16 offen offset:2048 sc1
    s_mov_b64 exec, s[92:93]
    buffer_load_dwordx4 v[36:39], v2, s[4:7], s16 offen offset:3072 sc1
    s_mov_b64 exec, -1
gk_470:
    s_cmp_lg_u64 s[90:91], 0
    s_cbranch_scc1 gk_471
    v_mfma_f32_16x16x32_bf16 v[40:43], a[16:19], v[32:35], v[40:43]
    v_mfma_f32_16x16x32_bf16 v[44:47], a[20:23], v[32:35], v[44:47]
    v_mfma_f32_16x16x32_bf16 v[56:59], a[80:83], v[32:35], v[56:59]
    v_mfma_f32_16x16x32_bf16 v[60:63], a[84:87], v[32:35], v[60:63]
    v_mfma_f32_16x16x32_bf16 v[48:51], a[48:51], v[32:35], v[48:51]
    v_mfma_f32_16x16x32_bf16 v[52:55], a[52:55], v[32:35], v[52:55]
    v_mfma_f32_16x16x32_bf16 v[64:67], a[112:115], v[32:35], v[64:67]
    v_mfma_f32_16x16x32_bf16 v[68:71], a[116:119], v[32:35], v[68:71]
    s_mov_b64 exec, s[86:87]
    buffer_load_dwordx4 v[24:27], v2, s[4:7], s16 offen offset:0 sc1
    s_mov_b64 exec, s[88:89]
    buffer_load_dwordx4 v[28:31], v2, s[4:7], s16 offen offset:1024 sc1
    s_mov_b64 exec, s[92:93]
    buffer_load_dwordx4 v[36:39], v2, s[4:7], s16 offen offset:3072 sc1
    s_mov_b64 exec, -1
gk_471:
    s_cmp_lg_u64 s[92:93], 0
    s_cbranch_scc1 gk_472
    v_mfma_f32_16x16x32_bf16 v[40:43], a[24:27], v[36:39], v[40:43]
    v_mfma_f32_16x16x32_bf16 v[44:47], a[28:31], v[36:39], v[44:47]
    v_mfma_f32_16x16x32_bf16 v[56:59], a[88:91], v[36:39], v[56:59]
    v_mfma_f32_16x16x32_bf16 v[60:63], a[92:95], v[36:39], v[60:63]
    v_mfma_f32_16x16x32_bf16 v[48:51], a[56:59], v[36:39], v[48:51]
    v_mfma_f32_16x16x32_bf16 v[52:55], a[60:63], v[36:39], v[52:55]
    v_mfma_f32_16x16x32_bf16 v[64:67], a[120:123], v[36:39], v[64:67]
    v_mfma_f32_16x16x32_bf16 v[68:71], a[124:127], v[36:39], v[68:71]
    s_mov_b64 exec, s[86:87]
    buffer_load_dwordx4 v[24:27], v2, s[4:7], s16 offen offset:0 sc1
    s_mov_b64 exec, s[88:89]
    buffer_load_dwordx4 v[28:31], v2, s[4:7], s16 offen offset:1024 sc1
    s_mov_b64 exec, s[90:91]
    buffer_load_dwordx4 v[32:35], v2, s[4:7], s16 offen offset:2048 sc1
    s_mov_b64 exec, -1
gk_472:
gl_474:
    v_max3_u32 v19, v24, v25, v26
    v_max_u32 v19, v19, v27
    v_cmp_eq_u32 vcc, -1, v19
    s_nop 0
    s_cbranch_vccz go_475
    s_mov_b64 s[86:87], vcc
    s_waitcnt vmcnt(8)
    s_mov_b64 exec, s[86:87]
    buffer_load_dwordx4 v[24:27], v2, s[4:7], s16 offen offset:0 sc1
    s_mov_b64 exec, s[88:89]
    buffer_load_dwordx4 v[28:31], v2, s[4:7], s16 offen offset:1024 sc1
    s_mov_b64 exec, s[90:91]
    buffer_load_dwordx4 v[32:35], v2, s[4:7], s16 offen offset:2048 sc1
    s_mov_b64 exec, s[92:93]
    buffer_load_dwordx4 v[36:39], v2, s[4:7], s16 offen offset:3072 sc1
    s_mov_b64 exec, -1
    s_add_u32 s23, s23, 1
    s_cmp_ge_u32 s23, 200000
    s_cselect_b32 s25, 200000, s25
    s_cbranch_scc1 go_475
    s_branch gl_474
go_475:
    v_mfma_f32_16x16x32_bf16 v[40:43], a[0:3], v[24:27], v[40:43]
    v_mfma_f32_16x16x32_bf16 v[44:47], a[4:7], v[24:27], v[44:47]
    v_mfma_f32_16x16x32_bf16 v[56:59], a[64:67], v[24:27], v[56:59]
    v_mfma_f32_16x16x32_bf16 v[60:63], a[68:71], v[24:27], v[60:63]
    v_mfma_f32_16x16x32_bf16 v[48:51], a[32:35], v[24:27], v[48:51]
    v_mfma_f32_16x16x32_bf16 v[52:55], a[36:39], v[24:27], v[52:55]
    v_mfma_f32_16x16x32_bf16 v[64:67], a[96:99], v[24:27], v[64:67]
    v_mfma_f32_16x16x32_bf16 v[68:71], a[100:103], v[24:27], v[68:71]
gd_473:
    s_cmp_eq_u64 s[88:89], 0
    s_cbranch_scc1 gd_476
gl_477:
    v_max3_u32 v19, v28, v29, v30
    v_max_u32 v19, v19, v31
    v_cmp_eq_u32 vcc, -1, v19
    s_nop 0
    s_cbranch_vccz go_478
    s_mov_b64 s[88:89], vcc
    s_waitcnt vmcnt(6)
    s_mov_b64 exec, s[88:89]
    buffer_load_dwordx4 v[28:31], v2, s[4:7], s16 offen offset:1024 sc1
    s_mov_b64 exec, s[90:91]
    buffer_load_dwordx4 v[32:35], v2, s[4:7], s16 offen offset:2048 sc1
    s_mov_b64 exec, s[92:93]
    buffer_load_dwordx4 v[36:39], v2, s[4:7], s16 offen offset:3072 sc1
    s_mov_b64 exec, -1
    s_add_u32 s23, s23, 1
    s_cmp_ge_u32 s23, 200000
    s_cselect_b32 s25, 200000, s25
    s_cbranch_scc1 go_478
    s_branch gl_477
go_478:
    v_mfma_f32_16x16x32_bf16 v[40:43], a[8:11], v[28:31], v[40:43]
    v_mfma_f32_16x16x32_bf16 v[44:47], a[12:15], v[28:31], v[44:47]
    v_mfma_f32_16x16x32_bf16 v[56:59], a[72:75], v[28:31], v[56:59]
    v_mfma_f32_16x16x32_bf16 v[60:63], a[76:79], v[28:31], v[60:63]
    v_mfma_f32_16x16x32_bf16 v[48:51], a[40:43], v[28:31], v[48:51]
    v_mfma_f32_16x16x32_bf16 v[52:55], a[44:47], v[28:31], v[52:55]
    v_mfma_f32_16x16x32_bf16 v[64:67], a[104:107], v[28:31], v[64:67]
    v_mfma_f32_16x16x32_bf16 v[68:71], a[108:111], v[28:31], v[68:71]
gd_476:
    s_cmp_eq_u64 s[90:91], 0
    s_cbranch_scc1 gd_479
gl_480:
    v_max3_u32 v19, v32, v33, v34
    v_max_u32 v19, v19, v35
    v_cmp_eq_u32 vcc, -1, v19
    s_nop 0
    s_cbranch_vccz go_481
    s_mov_b64 s[90:91], vcc
    s_waitcnt vmcnt(4)
    s_mov_b64 exec, s[90:91]
    buffer_load_dwordx4 v[32:35], v2, s[4:7], s16 offen offset:2048 sc1
    s_mov_b64 exec, s[92:93]
    buffer_load_dwordx4 v[36:39], v2, s[4:7], s16 offen offset:3072 sc1
    s_mov_b64 exec, -1
    s_add_u32 s23, s23, 1
    s_cmp_ge_u32 s23, 200000
    s_cselect_b32 s25, 200000, s25
    s_cbranch_scc1 go_481
    s_branch gl_480
go_481:
    v_mfma_f32_16x16x32_bf16 v[40:43], a[16:19], v[32:35], v[40:43]
    v_mfma_f32_16x16x32_bf16 v[44:47], a[20:23], v[32:35], v[44:47]
    v_mfma_f32_16x16x32_bf16 v[56:59], a[80:83], v[32:35], v[56:59]
    v_mfma_f32_16x16x32_bf16 v[60:63], a[84:87], v[32:35], v[60:63]
    v_mfma_f32_16x16x32_bf16 v[48:51], a[48:51], v[32:35], v[48:51]
    v_mfma_f32_16x16x32_bf16 v[52:55], a[52:55], v[32:35], v[52:55]
    v_mfma_f32_16x16x32_bf16 v[64:67], a[112:115], v[32:35], v[64:67]
    v_mfma_f32_16x16x32_bf16 v[68:71], a[116:119], v[32:35], v[68:71]
gd_479:
    s_cmp_eq_u64 s[92:93], 0
    s_cbranch_scc1 gd_482
gl_483:
    v_max3_u32 v19, v36, v37, v38
    v_max_u32 v19, v19, v39
    v_cmp_eq_u32 vcc, -1, v19
    s_nop 0
    s_cbranch_vccz go_484
    s_mov_b64 s[92:93], vcc
    s_waitcnt vmcnt(2)
    s_mov_b64 exec, s[92:93]
    buffer_load_dwordx4 v[36:39], v2, s[4:7], s16 offen offset:3072 sc1
    s_mov_b64 exec, -1
    s_add_u32 s23, s23, 1
    s_cmp_ge_u32 s23, 200000
    s_cselect_b32 s25, 200000, s25
    s_cbranch_scc1 go_484
    s_branch gl_483
go_484:
    v_mfma_f32_16x16x32_bf16 v[40:43], a[24:27], v[36:39], v[40:43]
    v_mfma_f32_16x16x32_bf16 v[44:47], a[28:31], v[36:39], v[44:47]
    v_mfma_f32_16x16x32_bf16 v[56:59], a[88:91], v[36:39], v[56:59]
    v_mfma_f32_16x16x32_bf16 v[60:63], a[92:95], v[36:39], v[60:63]
    v_mfma_f32_16x16x32_bf16 v[48:51], a[56:59], v[36:39], v[48:51]
    v_mfma_f32_16x16x32_bf16 v[52:55], a[60:63], v[36:39], v[52:55]
    v_mfma_f32_16x16x32_bf16 v[64:67], a[120:123], v[36:39], v[64:67]
    v_mfma_f32_16x16x32_bf16 v[68:71], a[124:127], v[36:39], v[68:71]
gd_482:
    s_branch gc_465
gs_467:
    s_mov_b64 s[88:89], vcc
    s_mov_b64 exec, s[88:89]
    buffer_load_dwordx4 v[28:31], v2, s[4:7], s16 offen offset:1024 sc1
    s_mov_b64 exec, -1
    s_waitcnt vmcnt(1)
    v_max3_u32 v19, v32, v33, v34
    v_max_u32 v19, v19, v35
    v_cmp_eq_u32 s[90:91], -1, v19
    v_max3_u32 v19, v36, v37, v38
    v_max_u32 v19, v19, v39
    v_cmp_eq_u32 s[92:93], -1, v19
    s_mov_b64 exec, s[90:91]
    buffer_load_dwordx4 v[32:35], v2, s[4:7], s16 offen offset:2048 sc1
    s_mov_b64 exec, s[92:93]
    buffer_load_dwordx4 v[36:39], v2, s[4:7], s16 offen offset:3072 sc1
    s_mov_b64 exec, -1
    s_cmp_lg_u64 s[90:91], 0
    s_cbranch_scc1 gk_485
    v_mfma_f32_16x16x32_bf16 v[40:43], a[16:19], v[32:35], v[40:43]
    v_mfma_f32_16x16x32_bf16 v[44:47], a[20:23], v[32:35], v[44:47]
    v_mfma_f32_16x16x32_bf16 v[56:59], a[80:83], v[32:35], v[56:59]
    v_mfma_f32_16x16x32_bf16 v[60:63], a[84:87], v[32:35], v[60:63]
    v_mfma_f32_16x16x32_bf16 v[48:51], a[48:51], v[32:35], v[48:51]
    v_mfma_f32_16x16x32_bf16 v[52:55], a[52:55], v[32:35], v[52:55]
    v_mfma_f32_16x16x32_bf16 v[64:67], a[112:115], v[32:35], v[64:67]
    v_mfma_f32_16x16x32_bf16 v[68:71], a[116:119], v[32:35], v[68:71]
    s_mov_b64 exec, s[88:89]
    buffer_load_dwordx4 v[28:31], v2, s[4:7], s16 offen offset:1024 sc1
    s_mov_b64 exec, s[92:93]
    buffer_load_dwordx4 v[36:39], v2, s[4:7], s16 offen offset:3072 sc1
    s_mov_b64 exec, -1
gk_485:
    s_cmp_lg_u64 s[92:93], 0
    s_cbranch_scc1 gk_486
    v_mfma_f32_16x16x32_bf16 v[40:43], a[24:27], v[36:39], v[40:43]
    v_mfma_f32_16x16x32_bf16 v[44:47], a[28:31], v[36:39], v[44:47]
    v_mfma_f32_16x16x32_bf16 v[56:59], a[88:91], v[36:39], v[56:59]
    v_mfma_f32_16x16x32_bf16 v[60:63], a[92:95], v[36:39], v[60:63]
    v_mfma_f32_16x16x32_bf16 v[48:51], a[56:59], v[36:39], v[48:51]
    v_mfma_f32_16x16x32_bf16 v[52:55], a[60:63], v[36:39], v[52:55]
    v_mfma_f32_16x16x32_bf16 v[64:67], a[120:123], v[36:39], v[64:67]
    v_mfma_f32_16x16x32_bf16 v[68:71], a[124:127], v[36:39], v[68:71]
    s_mov_b64 exec, s[88:89]
    buffer_load_dwordx4 v[28:31], v2, s[4:7], s16 offen offset:1024 sc1
    s_mov_b64 exec, s[90:91]
    buffer_load_dwordx4 v[32:35], v2, s[4:7], s16 offen offset:2048 sc1
    s_mov_b64 exec, -1
gk_486:
gl_488:
    v_max3_u32 v19, v28, v29, v30
    v_max_u32 v19, v19, v31
    v_cmp_eq_u32 vcc, -1, v19
    s_nop 0
    s_cbranch_vccz go_489
    s_mov_b64 s[88:89], vcc
    s_waitcnt vmcnt(6)
    s_mov_b64 exec, s[88:89]
    buffer_load_dwordx4 v[28:31], v2, s[4:7], s16 offen offset:1024 sc1
    s_mov_b64 exec, s[90:91]
    buffer_load_dwordx4 v[32:35], v2, s[4:7], s16 offen offset:2048 sc1
    s_mov_b64 exec, s[92:93]
    buffer_load_dwordx4 v[36:39], v2, s[4:7], s16 offen offset:3072 sc1
    s_mov_b64 exec, -1
    s_add_u32 s23, s23, 1
    s_cmp_ge_u32 s23, 200000
    s_cselect_b32 s25, 200000, s25
    s_cbranch_scc1 go_489
    s_branch gl_488
go_489:
    v_mfma_f32_16x16x32_bf16 v[40:43], a[8:11], v[28:31], v[40:43]
    v_mfma_f32_16x16x32_bf16 v[44:47], a[12:15], v[28:31], v[44:47]
    v_mfma_f32_16x16x32_bf16 v[56:59], a[72:75], v[28:31], v[56:59]
    v_mfma_f32_16x16x32_bf16 v[60:63], a[76:79], v[28:31], v[60:63]
    v_mfma_f32_16x16x32_bf16 v[48:51], a[40:43], v[28:31], v[48:51]
    v_mfma_f32_16x16x32_bf16 v[52:55], a[44:47], v[28:31], v[52:55]
    v_mfma_f32_16x16x32_bf16 v[64:67], a[104:107], v[28:31], v[64:67]
    v_mfma_f32_16x16x32_bf16 v[68:71], a[108:111], v[28:31], v[68:71]
gd_487:
    s_cmp_eq_u64 s[90:91], 0
    s_cbranch_scc1 gd_490
gl_491:
    v_max3_u32 v19, v32, v33, v34
    v_max_u32 v19, v19, v35
    v_cmp_eq_u32 vcc, -1, v19
    s_nop 0
    s_cbranch_vccz go_492
    s_mov_b64 s[90:91], vcc
    s_waitcnt vmcnt(4)
    s_mov_b64 exec, s[90:91]
    buffer_load_dwordx4 v[32:35], v2, s[4:7], s16 offen offset:2048 sc1
    s_mov_b64 exec, s[92:93]
    buffer_load_dwordx4 v[36:39], v2, s[4:7], s16 offen offset:3072 sc1
    s_mov_b64 exec, -1
    s_add_u32 s23, s23, 1
    s_cmp_ge_u32 s23, 200000
    s_cselect_b32 s25, 200000, s25
    s_cbranch_scc1 go_492
    s_branch gl_491
go_492:
    v_mfma_f32_16x16x32_bf16 v[40:43], a[16:19], v[32:35], v[40:43]
    v_mfma_f32_16x16x32_bf16 v[44:47], a[20:23], v[32:35], v[44:47]
    v_mfma_f32_16x16x32_bf16 v[56:59], a[80:83], v[32:35], v[56:59]
    v_mfma_f32_16x16x32_bf16 v[60:63], a[84:87], v[32:35], v[60:63]
    v_mfma_f32_16x16x32_bf16 v[48:51], a[48:51], v[32:35], v[48:51]
    v_mfma_f32_16x16x32_bf16 v[52:55], a[52:55], v[32:35], v[52:55]
    v_mfma_f32_16x16x32_bf16 v[64:67], a[112:115], v[32:35], v[64:67]
    v_mfma_f32_16x16x32_bf16 v[68:71], a[116:119], v[32:35], v[68:71]
gd_490:
    s_cmp_eq_u64 s[92:93], 0
    s_cbranch_scc1 gd_493
gl_494:
    v_max3_u32 v19, v36, v37, v38
    v_max_u32 v19, v19, v39
    v_cmp_eq_u32 vcc, -1, v19
    s_nop 0
    s_cbranch_vccz go_495
    s_mov_b64 s[92:93], vcc
    s_waitcnt vmcnt(2)
    s_mov_b64 exec, s[92:93]
    buffer_load_dwordx4 v[36:39], v2, s[4:7], s16 offen offset:3072 sc1
    s_mov_b64 exec, -1
    s_add_u32 s23, s23, 1
    s_cmp_ge_u32 s23, 200000
    s_cselect_b32 s25, 200000, s25
    s_cbranch_scc1 go_495
    s_branch gl_494
go_495:
    v_mfma_f32_16x16x32_bf16 v[40:43], a[24:27], v[36:39], v[40:43]
    v_mfma_f32_16x16x32_bf16 v[44:47], a[28:31], v[36:39], v[44:47]
    v_mfma_f32_16x16x32_bf16 v[56:59], a[88:91], v[36:39], v[56:59]
    v_mfma_f32_16x16x32_bf16 v[60:63], a[92:95], v[36:39], v[60:63]
    v_mfma_f32_16x16x32_bf16 v[48:51], a[56:59], v[36:39], v[48:51]
    v_mfma_f32_16x16x32_bf16 v[52:55], a[60:63], v[36:39], v[52:55]
    v_mfma_f32_16x16x32_bf16 v[64:67], a[120:123], v[36:39], v[64:67]
    v_mfma_f32_16x16x32_bf16 v[68:71], a[124:127], v[36:39], v[68:71]
gd_493:
    s_branch gc_465
gs_468:
    s_mov_b64 s[90:91], vcc
    s_mov_b64 exec, s[90:91]
    buffer_load_dwordx4 v[32:35], v2, s[4:7], s16 offen offset:2048 sc1
    s_mov_b64 exec, -1
    s_waitcnt vmcnt(1)
    v_max3_u32 v19, v36, v37, v38
    v_max_u32 v19, v19, v39
    v_cmp_eq_u32 s[92:93], -1, v19
    s_nop 0
    s_mov_b64 exec, s[92:93]
    buffer_load_dwordx4 v[36:39], v2, s[4:7], s16 offen offset:3072 sc1
    s_mov_b64 exec, -1
    s_cmp_lg_u64 s[92:93], 0
    s_cbranch_scc1 gk_496
    v_mfma_f32_16x16x32_bf16 v[40:43], a[24:27], v[36:39], v[40:43]
    v_mfma_f32_16x16x32_bf16 v[44:47], a[28:31], v[36:39], v[44:47]
    v_mfma_f32_16x16x32_bf16 v[56:59], a[88:91], v[36:39], v[56:59]
    v_mfma_f32_16x16x32_bf16 v[60:63], a[92:95], v[36:39], v[60:63]
    v_mfma_f32_16x16x32_bf16 v[48:51], a[56:59], v[36:39], v[48:51]
    v_mfma_f32_16x16x32_bf16 v[52:55], a[60:63], v[36:39], v[52:55]
    v_mfma_f32_16x16x32_bf16 v[64:67], a[120:123], v[36:39], v[64:67]
    v_mfma_f32_16x16x32_bf16 v[68:71], a[124:127], v[36:39], v[68:71]
    s_mov_b64 exec, s[90:91]
    buffer_load_dwordx4 v[32:35], v2, s[4:7], s16 offen offset:2048 sc1
    s_mov_b64 exec, -1
gk_496:
gl_498:
    v_max3_u32 v19, v32, v33, v34
    v_max_u32 v19, v19, v35
    v_cmp_eq_u32 vcc, -1, v19
    s_nop 0
    s_cbranch_vccz go_499
    s_mov_b64 s[90:91], vcc
    s_waitcnt vmcnt(4)
    s_mov_b64 exec, s[90:91]
    buffer_load_dwordx4 v[32:35], v2, s[4:7], s16 offen offset:2048 sc1
    s_mov_b64 exec, s[92:93]
    buffer_load_dwordx4 v[36:39], v2, s[4:7], s16 offen offset:3072 sc1
    s_mov_b64 exec, -1
    s_add_u32 s23, s23, 1
    s_cmp_ge_u32 s23, 200000
    s_cselect_b32 s25, 200000, s25
    s_cbranch_scc1 go_499
    s_branch gl_498
go_499:
    v_mfma_f32_16x16x32_bf16 v[40:43], a[16:19], v[32:35], v[40:43]
    v_mfma_f32_16x16x32_bf16 v[44:47], a[20:23], v[32:35], v[44:47]
    v_mfma_f32_16x16x32_bf16 v[56:59], a[80:83], v[32:35], v[56:59]
    v_mfma_f32_16x16x32_bf16 v[60:63], a[84:87], v[32:35], v[60:63]
    v_mfma_f32_16x16x32_bf16 v[48:51], a[48:51], v[32:35], v[48:51]
    v_mfma_f32_16x16x32_bf16 v[52:55], a[52:55], v[32:35], v[52:55]
    v_mfma_f32_16x16x32_bf16 v[64:67], a[112:115], v[32:35], v[64:67]
    v_mfma_f32_16x16x32_bf16 v[68:71], a[116:119], v[32:35], v[68:71]
gd_497:
    s_cmp_eq_u64 s[92:93], 0
    s_cbranch_scc1 gd_500
gl_501:
    v_max3_u32 v19, v36, v37, v38
    v_max_u32 v19, v19, v39
    v_cmp_eq_u32 vcc, -1, v19
    s_nop 0
    s_cbranch_vccz go_502
    s_mov_b64 s[92:93], vcc
    s_waitcnt vmcnt(2)
    s_mov_b64 exec, s[92:93]
    buffer_load_dwordx4 v[36:39], v2, s[4:7], s16 offen offset:3072 sc1
    s_mov_b64 exec, -1
    s_add_u32 s23, s23, 1
    s_cmp_ge_u32 s23, 200000
    s_cselect_b32 s25, 200000, s25
    s_cbranch_scc1 go_502
    s_branch gl_501
go_502:
    v_mfma_f32_16x16x32_bf16 v[40:43], a[24:27], v[36:39], v[40:43]
    v_mfma_f32_16x16x32_bf16 v[44:47], a[28:31], v[36:39], v[44:47]
    v_mfma_f32_16x16x32_bf16 v[56:59], a[88:91], v[36:39], v[56:59]
    v_mfma_f32_16x16x32_bf16 v[60:63], a[92:95], v[36:39], v[60:63]
    v_mfma_f32_16x16x32_bf16 v[48:51], a[56:59], v[36:39], v[48:51]
    v_mfma_f32_16x16x32_bf16 v[52:55], a[60:63], v[36:39], v[52:55]
    v_mfma_f32_16x16x32_bf16 v[64:67], a[120:123], v[36:39], v[64:67]
    v_mfma_f32_16x16x32_bf16 v[68:71], a[124:127], v[36:39], v[68:71]
gd_500:
    s_branch gc_465
gs_469:
    s_mov_b64 s[92:93], vcc
    s_mov_b64 exec, s[92:93]
    buffer_load_dwordx4 v[36:39], v2, s[4:7], s16 offen offset:3072 sc1
    s_mov_b64 exec, -1
gl_504:
    v_max3_u32 v19, v36, v37, v38
    v_max_u32 v19, v19, v39
    v_cmp_eq_u32 vcc, -1, v19
    s_nop 0
    s_cbranch_vccz go_505
    s_mov_b64 s[92:93], vcc
    s_waitcnt vmcnt(2)
    s_mov_b64 exec, s[92:93]
    buffer_load_dwordx4 v[36:39], v2, s[4:7], s16 offen offset:3072 sc1
    s_mov_b64 exec, -1
    s_add_u32 s23, s23, 1
    s_cmp_ge_u32 s23, 200000
    s_cselect_b32 s25, 200000, s25
    s_cbranch_scc1 go_505
    s_branch gl_504
go_505:
    v_mfma_f32_16x16x32_bf16 v[40:43], a[24:27], v[36:39], v[40:43]
    v_mfma_f32_16x16x32_bf16 v[44:47], a[28:31], v[36:39], v[44:47]
    v_mfma_f32_16x16x32_bf16 v[56:59], a[88:91], v[36:39], v[56:59]
    v_mfma_f32_16x16x32_bf16 v[60:63], a[92:95], v[36:39], v[60:63]
    v_mfma_f32_16x16x32_bf16 v[48:51], a[56:59], v[36:39], v[48:51]
    v_mfma_f32_16x16x32_bf16 v[52:55], a[60:63], v[36:39], v[52:55]
    v_mfma_f32_16x16x32_bf16 v[64:67], a[120:123], v[36:39], v[64:67]
    v_mfma_f32_16x16x32_bf16 v[68:71], a[124:127], v[36:39], v[68:71]
gd_503:
    s_branch gc_465
gs_507:
    s_mov_b64 s[86:87], vcc
    s_mov_b64 exec, s[86:87]
    buffer_load_dwordx4 v[208:211], v5, s[4:7], s16 offen offset:0 sc1
    buffer_load_dword v224, v6, s[4:7], s16 offen offset:0 sc1
    s_mov_b64 exec, -1
    s_waitcnt vmcnt(2)
    v_max3_u32 v19, v212, v213, v214
    v_max3_u32 v19, v19, v215, v225
    v_cmp_eq_u32 s[88:89], -1, v19
    v_max3_u32 v19, v216, v217, v218
    v_max3_u32 v19, v19, v219, v226
    v_cmp_eq_u32 s[90:91], -1, v19
    v_max3_u32 v19, v220, v221, v222
    v_max3_u32 v19, v19, v223, v227
    v_cmp_eq_u32 s[92:93], -1, v19
    s_mov_b64 exec, s[88:89]
    buffer_load_dwordx4 v[212:215], v5, s[4:7], s16 offen offset:1024 sc1
    buffer_load_dword v225, v6, s[4:7], s16 offen offset:256 sc1
    s_mov_b64 exec, s[90:91]
    buffer_load_dwordx4 v[216:219], v5, s[4:7], s16 offen offset:2048 sc1
    buffer_load_dword v226, v6, s[4:7], s16 offen offset:512 sc1
    s_mov_b64 exec, s[92:93]
    buffer_load_dwordx4 v[220:223], v5, s[4:7], s16 offen offset:3072 sc1
    buffer_load_dword v227, v6, s[4:7], s16 offen offset:768 sc1
    s_mov_b64 exec, -1
gl_512:
    v_max3_u32 v19, v208, v209, v210
    v_max3_u32 v19, v19, v211, v224
    v_cmp_eq_u32 vcc, -1, v19
    s_nop 0
    s_cbranch_vccz go_513
    s_mov_b64 s[86:87], vcc
    s_waitcnt vmcnt(16)
    s_mov_b64 exec, s[86:87]
    buffer_load_dwordx4 v[208:211], v5, s[4:7], s16 offen offset:0 sc1
    buffer_load_dword v224, v6, s[4:7], s16 offen offset:0 sc1
    s_mov_b64 exec, s[88:89]
    buffer_load_dwordx4 v[212:215], v5, s[4:7], s16 offen offset:1024 sc1
    buffer_load_dword v225, v6, s[4:7], s16 offen offset:256 sc1
    s_mov_b64 exec, s[90:91]
    buffer_load_dwordx4 v[216:219], v5, s[4:7], s16 offen offset:2048 sc1
    buffer_load_dword v226, v6, s[4:7], s16 offen offset:512 sc1
    s_mov_b64 exec, s[92:93]
    buffer_load_dwordx4 v[220:223], v5, s[4:7], s16 offen offset:3072 sc1
    buffer_load_dword v227, v6, s[4:7], s16 offen offset:768 sc1
    s_mov_b64 exec, -1
    s_add_u32 s23, s23, 1
    s_cmp_ge_u32 s23, 200000
    s_cselect_b32 s25, 200000, s25
    s_cbranch_scc1 go_513
    s_branch gl_512
go_513:
gd_511:
    s_cmp_eq_u64 s[88:89], 0
    s_cbranch_scc1 gd_514
gl_515:
    v_max3_u32 v19, v212, v213, v214
    v_max3_u32 v19, v19, v215, v225
    v_cmp_eq_u32 vcc, -1, v19
    s_nop 0
    s_cbranch_vccz go_516
    s_mov_b64 s[88:89], vcc
    s_waitcnt vmcnt(12)
    s_mov_b64 exec, s[88:89]
    buffer_load_dwordx4 v[212:215], v5, s[4:7], s16 offen offset:1024 sc1
    buffer_load_dword v225, v6, s[4:7], s16 offen offset:256 sc1
    s_mov_b64 exec, s[90:91]
    buffer_load_dwordx4 v[216:219], v5, s[4:7], s16 offen offset:2048 sc1
    buffer_load_dword v226, v6, s[4:7], s16 offen offset:512 sc1
    s_mov_b64 exec, s[92:93]
    buffer_load_dwordx4 v[220:223], v5, s[4:7], s16 offen offset:3072 sc1
    buffer_load_dword v227, v6, s[4:7], s16 offen offset:768 sc1
    s_mov_b64 exec, -1
    s_add_u32 s23, s23, 1
    s_cmp_ge_u32 s23, 200000
    s_cselect_b32 s25, 200000, s25
    s_cbranch_scc1 go_516
    s_branch gl_515
go_516:
gd_514:
    s_cmp_eq_u64 s[90:91], 0
    s_cbranch_scc1 gd_517
gl_518:
    v_max3_u32 v19, v216, v217, v218
    v_max3_u32 v19, v19, v219, v226
    v_cmp_eq_u32 vcc, -1, v19
    s_nop 0
    s_cbranch_vccz go_519
    s_mov_b64 s[90:91], vcc
    s_waitcnt vmcnt(8)
    s_mov_b64 exec, s[90:91]
    buffer_load_dwordx4 v[216:219], v5, s[4:7], s16 offen offset:2048 sc1
    buffer_load_dword v226, v6, s[4:7], s16 offen offset:512 sc1
    s_mov_b64 exec, s[92:93]
    buffer_load_dwordx4 v[220:223], v5, s[4:7], s16 offen offset:3072 sc1
    buffer_load_dword v227, v6, s[4:7], s16 offen offset:768 sc1
    s_mov_b64 exec, -1
    s_add_u32 s23, s23, 1
    s_cmp_ge_u32 s23, 200000
    s_cselect_b32 s25, 200000, s25
    s_cbranch_scc1 go_519
    s_branch gl_518
go_519:
gd_517:
    s_cmp_eq_u64 s[92:93], 0
    s_cbranch_scc1 gd_520
gl_521:
    v_max3_u32 v19, v220, v221, v222
    v_max3_u32 v19, v19, v223, v227
    v_cmp_eq_u32 vcc, -1, v19
    s_nop 0
    s_cbranch_vccz go_522
    s_mov_b64 s[92:93], vcc
    s_waitcnt vmcnt(4)
    s_mov_b64 exec, s[92:93]
    buffer_load_dwordx4 v[220:223], v5, s[4:7], s16 offen offset:3072 sc1
    buffer_load_dword v227, v6, s[4:7], s16 offen offset:768 sc1
    s_mov_b64 exec, -1
    s_add_u32 s23, s23, 1
    s_cmp_ge_u32 s23, 200000
    s_cselect_b32 s25, 200000, s25
    s_cbranch_scc1 go_522
    s_branch gl_521
go_522:
gd_520:
    s_branch gc_506
gs_508:
    s_mov_b64 s[88:89], vcc
    s_mov_b64 exec, s[88:89]
    buffer_load_dwordx4 v[212:215], v5, s[4:7], s16 offen offset:1024 sc1
    buffer_load_dword v225, v6, s[4:7], s16 offen offset:256 sc1
    s_mov_b64 exec, -1
    s_waitcnt vmcnt(2)
    v_max3_u32 v19, v216, v217, v218
    v_max3_u32 v19, v19, v219, v226
    v_cmp_eq_u32 s[90:91], -1, v19
    v_max3_u32 v19, v220, v221, v222
    v_max3_u32 v19, v19, v223, v227
    v_cmp_eq_u32 s[92:93], -1, v19
    s_mov_b64 exec, s[90:91]
    buffer_load_dwordx4 v[216:219], v5, s[4:7], s16 offen offset:2048 sc1
    buffer_load_dword v226, v6, s[4:7], s16 offen offset:512 sc1
    s_mov_b64 exec, s[92:93]
    buffer_load_dwordx4 v[220:223], v5, s[4:7], s16 offen offset:3072 sc1
    buffer_load_dword v227, v6, s[4:7], s16 offen offset:768 sc1
    s_mov_b64 exec, -1
gl_524:
    v_max3_u32 v19, v212, v213, v214
    v_max3_u32 v19, v19, v215, v225
    v_cmp_eq_u32 vcc, -1, v19
    s_nop 0
    s_cbranch_vccz go_525
    s_mov_b64 s[88:89], vcc
    s_waitcnt vmcnt(12)
    s_mov_b64 exec, s[88:89]
    buffer_load_dwordx4 v[212:215], v5, s[4:7], s16 offen offset:1024 sc1
    buffer_load_dword v225, v6, s[4:7], s16 offen offset:256 sc1
    s_mov_b64 exec, s[90:91]
    buffer_load_dwordx4 v[216:219], v5, s[4:7], s16 offen offset:2048 sc1
    buffer_load_dword v226, v6, s[4:7], s16 offen offset:512 sc1
    s_mov_b64 exec, s[92:93]
    buffer_load_dwordx4 v[220:223], v5, s[4:7], s16 offen offset:3072 sc1
    buffer_load_dword v227, v6, s[4:7], s16 offen offset:768 sc1
    s_mov_b64 exec, -1
    s_add_u32 s23, s23, 1
    s_cmp_ge_u32 s23, 200000
    s_cselect_b32 s25, 200000, s25
    s_cbranch_scc1 go_525
    s_branch gl_524
go_525:
gd_523:
    s_cmp_eq_u64 s[90:91], 0
    s_cbranch_scc1 gd_526
gl_527:
    v_max3_u32 v19, v216, v217, v218
    v_max3_u32 v19, v19, v219, v226
    v_cmp_eq_u32 vcc, -1, v19
    s_nop 0
    s_cbranch_vccz go_528
    s_mov_b64 s[90:91], vcc
    s_waitcnt vmcnt(8)
    s_mov_b64 exec, s[90:91]
    buffer_load_dwordx4 v[216:219], v5, s[4:7], s16 offen offset:2048 sc1
    buffer_load_dword v226, v6, s[4:7], s16 offen offset:512 sc1
    s_mov_b64 exec, s[92:93]
    buffer_load_dwordx4 v[220:223], v5, s[4:7], s16 offen offset:3072 sc1
    buffer_load_dword v227, v6, s[4:7], s16 offen offset:768 sc1
    s_mov_b64 exec, -1
    s_add_u32 s23, s23, 1
    s_cmp_ge_u32 s23, 200000
    s_cselect_b32 s25, 200000, s25
    s_cbranch_scc1 go_528
    s_branch gl_527
go_528:
gd_526:
    s_cmp_eq_u64 s[92:93], 0
    s_cbranch_scc1 gd_529
gl_530:
    v_max3_u32 v19, v220, v221, v222
    v_max3_u32 v19, v19, v223, v227
    v_cmp_eq_u32 vcc, -1, v19
    s_nop 0
    s_cbranch_vccz go_531
    s_mov_b64 s[92:93], vcc
    s_waitcnt vmcnt(4)
    s_mov_b64 exec, s[92:93]
    buffer_load_dwordx4 v[220:223], v5, s[4:7], s16 offen offset:3072 sc1
    buffer_load_dword v227, v6, s[4:7], s16 offen offset:768 sc1
    s_mov_b64 exec, -1
    s_add_u32 s23, s23, 1
    s_cmp_ge_u32 s23, 200000
    s_cselect_b32 s25, 200000, s25
    s_cbranch_scc1 go_531
    s_branch gl_530
go_531:
gd_529:
    s_branch gc_506
gs_509:
    s_mov_b64 s[90:91], vcc
    s_mov_b64 exec, s[90:91]
    buffer_load_dwordx4 v[216:219], v5, s[4:7], s16 offen offset:2048 sc1
    buffer_load_dword v226, v6, s[4:7], s16 offen offset:512 sc1
    s_mov_b64 exec, -1
    s_waitcnt vmcnt(2)
    v_max3_u32 v19, v220, v221, v222
    v_max3_u32 v19, v19, v223, v227
    v_cmp_eq_u32 s[92:93], -1, v19
    s_nop 0
    s_mov_b64 exec, s[92:93]
    buffer_load_dwordx4 v[220:223], v5, s[4:7], s16 offen offset:3072 sc1
    buffer_load_dword v227, v6, s[4:7], s16 offen offset:768 sc1
    s_mov_b64 exec, -1
gl_533:
    v_max3_u32 v19, v216, v217, v218
    v_max3_u32 v19, v19, v219, v226
    v_cmp_eq_u32 vcc, -1, v19
    s_nop 0
    s_cbranch_vccz go_534
    s_mov_b64 s[90:91], vcc
    s_waitcnt vmcnt(8)
    s_mov_b64 exec, s[90:91]
    buffer_load_dwordx4 v[216:219], v5, s[4:7], s16 offen offset:2048 sc1
    buffer_load_dword v226, v6, s[4:7], s16 offen offset:512 sc1
    s_mov_b64 exec, s[92:93]
    buffer_load_dwordx4 v[220:223], v5, s[4:7], s16 offen offset:3072 sc1
    buffer_load_dword v227, v6, s[4:7], s16 offen offset:768 sc1
    s_mov_b64 exec, -1
    s_add_u32 s23, s23, 1
    s_cmp_ge_u32 s23, 200000
    s_cselect_b32 s25, 200000, s25
    s_cbranch_scc1 go_534
    s_branch gl_533
go_534:
gd_532:
    s_cmp_eq_u64 s[92:93], 0
    s_cbranch_scc1 gd_535
gl_536:
    v_max3_u32 v19, v220, v221, v222
    v_max3_u32 v19, v19, v223, v227
    v_cmp_eq_u32 vcc, -1, v19
    s_nop 0
    s_cbranch_vccz go_537
    s_mov_b64 s[92:93], vcc
    s_waitcnt vmcnt(4)
    s_mov_b64 exec, s[92:93]
    buffer_load_dwordx4 v[220:223], v5, s[4:7], s16 offen offset:3072 sc1
    buffer_load_dword v227, v6, s[4:7], s16 offen offset:768 sc1
    s_mov_b64 exec, -1
    s_add_u32 s23, s23, 1
    s_cmp_ge_u32 s23, 200000
    s_cselect_b32 s25, 200000, s25
    s_cbranch_scc1 go_537
    s_branch gl_536
go_537:
gd_535:
    s_branch gc_506
gs_510:
    s_mov_b64 s[92:93], vcc
    s_mov_b64 exec, s[92:93]
    buffer_load_dwordx4 v[220:223], v5, s[4:7], s16 offen offset:3072 sc1
    buffer_load_dword v227, v6, s[4:7], s16 offen offset:768 sc1
    s_mov_b64 exec, -1
gl_539:
    v_max3_u32 v19, v220, v221, v222
    v_max3_u32 v19, v19, v223, v227
    v_cmp_eq_u32 vcc, -1, v19
    s_nop 0
    s_cbranch_vccz go_540
    s_mov_b64 s[92:93], vcc
    s_waitcnt vmcnt(4)
    s_mov_b64 exec, s[92:93]
    buffer_load_dwordx4 v[220:223], v5, s[4:7], s16 offen offset:3072 sc1
    buffer_load_dword v227, v6, s[4:7], s16 offen offset:768 sc1
    s_mov_b64 exec, -1
    s_add_u32 s23, s23, 1
    s_cmp_ge_u32 s23, 200000
    s_cselect_b32 s25, 200000, s25
    s_cbranch_scc1 go_540
    s_branch gl_539
go_540:
gd_538:
    s_branch gc_506
gs_542:
    s_mov_b64 s[86:87], vcc
    s_mov_b64 exec, s[86:87]
    buffer_load_dwordx4 v[24:27], v8, s[4:7], s16 offen offset:0 sc1
    s_mov_b64 exec, -1
    s_waitcnt vmcnt(1)
    v_max3_u32 v19, v28, v29, v30
    v_max_u32 v19, v19, v31
    v_cmp_eq_u32 s[88:89], -1, v19
    v_max3_u32 v19, v32, v33, v34
    v_max_u32 v19, v19, v35
    v_cmp_eq_u32 s[90:91], -1, v19
    v_max3_u32 v19, v36, v37, v38
    v_max_u32 v19, v19, v39
    v_cmp_eq_u32 s[92:93], -1, v19
    s_mov_b64 exec, s[88:89]
    buffer_load_dwordx4 v[28:31], v8, s[4:7], s16 offen offset:1024 sc1
    s_mov_b64 exec, s[90:91]
    buffer_load_dwordx4 v[32:35], v8, s[4:7], s16 offen offset:2048 sc1
    s_mov_b64 exec, s[92:93]
    buffer_load_dwordx4 v[36:39], v8, s[4:7], s16 offen offset:3072 sc1
    s_mov_b64 exec, -1
    s_cmp_lg_u64 s[88:89], 0
    s_cbranch_scc1 gk_546
    v_mfma_f32_16x16x32_bf16 v[40:43], a[200:203], v[28:31], v[40:43]
    v_mfma_f32_16x16x32_bf16 v[44:47], a[204:207], v[28:31], v[44:47]
    v_mfma_f32_16x16x32_bf16 v[48:51], a[232:235], v[28:31], v[48:51]
    v_mfma_f32_16x16x32_bf16 v[52:55], a[236:239], v[28:31], v[52:55]
    s_mov_b64 exec, s[86:87]
    buffer_load_dwordx4 v[24:27], v8, s[4:7], s16 offen offset:0 sc1
    s_mov_b64 exec, s[90:91]
    buffer_load_dwordx4 v[32:35], v8, s[4:7], s16 offen offset:2048 sc1
    s_mov_b64 exec, s[92:93]
    buffer_load_dwordx4 v[36:39], v8, s[4:7], s16 offen offset:3072 sc1
    s_mov_b64 exec, -1
gk_546:
    s_cmp_lg_u64 s[90:91], 0
    s_cbranch_scc1 gk_547
    v_mfma_f32_16x16x32_bf16 v[40:43], a[208:211], v[32:35], v[40:43]
    v_mfma_f32_16x16x32_bf16 v[44:47], a[212:215], v[32:35], v[44:47]
    v_mfma_f32_16x16x32_bf16 v[48:51], a[240:243], v[32:35], v[48:51]
    v_mfma_f32_16x16x32_bf16 v[52:55], a[244:247], v[32:35], v[52:55]
    s_mov_b64 exec, s[86:87]
    buffer_load_dwordx4 v[24:27], v8, s[4:7], s16 offen offset:0 sc1
    s_mov_b64 exec, s[88:89]
    buffer_load_dwordx4 v[28:31], v8, s[4:7], s16 offen offset:1024 sc1
    s_mov_b64 exec, s[92:93]
    buffer_load_dwordx4 v[36:39], v8, s[4:7], s16 offen offset:3072 sc1
    s_mov_b64 exec, -1
gk_547:
    s_cmp_lg_u64 s[92:93], 0
    s_cbranch_scc1 gk_548
    v_mfma_f32_16x16x32_bf16 v[40:43], a[216:219], v[36:39], v[40:43]
    v_mfma_f32_16x16x32_bf16 v[44:47], a[220:223], v[36:39], v[44:47]
    v_mfma_f32_16x16x32_bf16 v[48:51], a[248:251], v[36:39], v[48:51]
    v_mfma_f32_16x16x32_bf16 v[52:55], a[252:255], v[36:39], v[52:55]
    s_mov_b64 exec, s[86:87]
    buffer_load_dwordx4 v[24:27], v8, s[4:7], s16 offen offset:0 sc1
    s_mov_b64 exec, s[88:89]
    buffer_load_dwordx4 v[28:31], v8, s[4:7], s16 offen offset:1024 sc1
    s_mov_b64 exec, s[90:91]
    buffer_load_dwordx4 v[32:35], v8, s[4:7], s16 offen offset:2048 sc1
    s_mov_b64 exec, -1
gk_548:
gl_550:
    v_max3_u32 v19, v24, v25, v26
    v_max_u32 v19, v19, v27
    v_cmp_eq_u32 vcc, -1, v19
    s_nop 0
    s_cbranch_vccz go_551
    s_mov_b64 s[86:87], vcc
    s_waitcnt vmcnt(8)
    s_mov_b64 exec, s[86:87]
    buffer_load_dwordx4 v[24:27], v8, s[4:7], s16 offen offset:0 sc1
    s_mov_b64 exec, s[88:89]
    buffer_load_dwordx4 v[28:31], v8, s[4:7], s16 offen offset:1024 sc1
    s_mov_b64 exec, s[90:91]
    buffer_load_dwordx4 v[32:35], v8, s[4:7], s16 offen offset:2048 sc1
    s_mov_b64 exec, s[92:93]
    buffer_load_dwordx4 v[36:39], v8, s[4:7], s16 offen offset:3072 sc1
    s_mov_b64 exec, -1
    s_add_u32 s23, s23, 1
    s_cmp_ge_u32 s23, 200000
    s_cselect_b32 s25, 200000, s25
    s_cbranch_scc1 go_551
    s_branch gl_550
go_551:
    v_mfma_f32_16x16x32_bf16 v[40:43], a[192:195], v[24:27], v[40:43]
    v_mfma_f32_16x16x32_bf16 v[44:47], a[196:199], v[24:27], v[44:47]
    v_mfma_f32_16x16x32_bf16 v[48:51], a[224:227], v[24:27], v[48:51]
    v_mfma_f32_16x16x32_bf16 v[52:55], a[228:231], v[24:27], v[52:55]
gd_549:
    s_cmp_eq_u64 s[88:89], 0
    s_cbranch_scc1 gd_552
gl_553:
    v_max3_u32 v19, v28, v29, v30
    v_max_u32 v19, v19, v31
    v_cmp_eq_u32 vcc, -1, v19
    s_nop 0
    s_cbranch_vccz go_554
    s_mov_b64 s[88:89], vcc
    s_waitcnt vmcnt(6)
    s_mov_b64 exec, s[88:89]
    buffer_load_dwordx4 v[28:31], v8, s[4:7], s16 offen offset:1024 sc1
    s_mov_b64 exec, s[90:91]
    buffer_load_dwordx4 v[32:35], v8, s[4:7], s16 offen offset:2048 sc1
    s_mov_b64 exec, s[92:93]
    buffer_load_dwordx4 v[36:39], v8, s[4:7], s16 offen offset:3072 sc1
    s_mov_b64 exec, -1
    s_add_u32 s23, s23, 1
    s_cmp_ge_u32 s23, 200000
    s_cselect_b32 s25, 200000, s25
    s_cbranch_scc1 go_554
    s_branch gl_553
go_554:
    v_mfma_f32_16x16x32_bf16 v[40:43], a[200:203], v[28:31], v[40:43]
    v_mfma_f32_16x16x32_bf16 v[44:47], a[204:207], v[28:31], v[44:47]
    v_mfma_f32_16x16x32_bf16 v[48:51], a[232:235], v[28:31], v[48:51]
    v_mfma_f32_16x16x32_bf16 v[52:55], a[236:239], v[28:31], v[52:55]
gd_552:
    s_cmp_eq_u64 s[90:91], 0
    s_cbranch_scc1 gd_555
gl_556:
    v_max3_u32 v19, v32, v33, v34
    v_max_u32 v19, v19, v35
    v_cmp_eq_u32 vcc, -1, v19
    s_nop 0
    s_cbranch_vccz go_557
    s_mov_b64 s[90:91], vcc
    s_waitcnt vmcnt(4)
    s_mov_b64 exec, s[90:91]
    buffer_load_dwordx4 v[32:35], v8, s[4:7], s16 offen offset:2048 sc1
    s_mov_b64 exec, s[92:93]
    buffer_load_dwordx4 v[36:39], v8, s[4:7], s16 offen offset:3072 sc1
    s_mov_b64 exec, -1
    s_add_u32 s23, s23, 1
    s_cmp_ge_u32 s23, 200000
    s_cselect_b32 s25, 200000, s25
    s_cbranch_scc1 go_557
    s_branch gl_556
go_557:
    v_mfma_f32_16x16x32_bf16 v[40:43], a[208:211], v[32:35], v[40:43]
    v_mfma_f32_16x16x32_bf16 v[44:47], a[212:215], v[32:35], v[44:47]
    v_mfma_f32_16x16x32_bf16 v[48:51], a[240:243], v[32:35], v[48:51]
    v_mfma_f32_16x16x32_bf16 v[52:55], a[244:247], v[32:35], v[52:55]
gd_555:
    s_cmp_eq_u64 s[92:93], 0
    s_cbranch_scc1 gd_558
gl_559:
    v_max3_u32 v19, v36, v37, v38
    v_max_u32 v19, v19, v39
    v_cmp_eq_u32 vcc, -1, v19
    s_nop 0
    s_cbranch_vccz go_560
    s_mov_b64 s[92:93], vcc
    s_waitcnt vmcnt(2)
    s_mov_b64 exec, s[92:93]
    buffer_load_dwordx4 v[36:39], v8, s[4:7], s16 offen offset:3072 sc1
    s_mov_b64 exec, -1
    s_add_u32 s23, s23, 1
    s_cmp_ge_u32 s23, 200000
    s_cselect_b32 s25, 200000, s25
    s_cbranch_scc1 go_560
    s_branch gl_559
go_560:
    v_mfma_f32_16x16x32_bf16 v[40:43], a[216:219], v[36:39], v[40:43]
    v_mfma_f32_16x16x32_bf16 v[44:47], a[220:223], v[36:39], v[44:47]
    v_mfma_f32_16x16x32_bf16 v[48:51], a[248:251], v[36:39], v[48:51]
    v_mfma_f32_16x16x32_bf16 v[52:55], a[252:255], v[36:39], v[52:55]
gd_558:
    s_branch gc_541
gs_543:
    s_mov_b64 s[88:89], vcc
    s_mov_b64 exec, s[88:89]
    buffer_load_dwordx4 v[28:31], v8, s[4:7], s16 offen offset:1024 sc1
    s_mov_b64 exec, -1
    s_waitcnt vmcnt(1)
    v_max3_u32 v19, v32, v33, v34
    v_max_u32 v19, v19, v35
    v_cmp_eq_u32 s[90:91], -1, v19
    v_max3_u32 v19, v36, v37, v38
    v_max_u32 v19, v19, v39
    v_cmp_eq_u32 s[92:93], -1, v19
    s_mov_b64 exec, s[90:91]
    buffer_load_dwordx4 v[32:35], v8, s[4:7], s16 offen offset:2048 sc1
    s_mov_b64 exec, s[92:93]
    buffer_load_dwordx4 v[36:39], v8, s[4:7], s16 offen offset:3072 sc1
    s_mov_b64 exec, -1
    s_cmp_lg_u64 s[90:91], 0
    s_cbranch_scc1 gk_561
    v_mfma_f32_16x16x32_bf16 v[40:43], a[208:211], v[32:35], v[40:43]
    v_mfma_f32_16x16x32_bf16 v[44:47], a[212:215], v[32:35], v[44:47]
    v_mfma_f32_16x16x32_bf16 v[48:51], a[240:243], v[32:35], v[48:51]
    v_mfma_f32_16x16x32_bf16 v[52:55], a[244:247], v[32:35], v[52:55]
    s_mov_b64 exec, s[88:89]
    buffer_load_dwordx4 v[28:31], v8, s[4:7], s16 offen offset:1024 sc1
    s_mov_b64 exec, s[92:93]
    buffer_load_dwordx4 v[36:39], v8, s[4:7], s16 offen offset:3072 sc1
    s_mov_b64 exec, -1
gk_561:
    s_cmp_lg_u64 s[92:93], 0
    s_cbranch_scc1 gk_562
    v_mfma_f32_16x16x32_bf16 v[40:43], a[216:219], v[36:39], v[40:43]
    v_mfma_f32_16x16x32_bf16 v[44:47], a[220:223], v[36:39], v[44:47]
    v_mfma_f32_16x16x32_bf16 v[48:51], a[248:251], v[36:39], v[48:51]
    v_mfma_f32_16x16x32_bf16 v[52:55], a[252:255], v[36:39], v[52:55]
    s_mov_b64 exec, s[88:89]
    buffer_load_dwordx4 v[28:31], v8, s[4:7], s16 offen offset:1024 sc1
    s_mov_b64 exec, s[90:91]
    buffer_load_dwordx4 v[32:35], v8, s[4:7], s16 offen offset:2048 sc1
    s_mov_b64 exec, -1
gk_562:
gl_564:
    v_max3_u32 v19, v28, v29, v30
    v_max_u32 v19, v19, v31
    v_cmp_eq_u32 vcc, -1, v19
    s_nop 0
    s_cbranch_vccz go_565
    s_mov_b64 s[88:89], vcc
    s_waitcnt vmcnt(6)
    s_mov_b64 exec, s[88:89]
    buffer_load_dwordx4 v[28:31], v8, s[4:7], s16 offen offset:1024 sc1
    s_mov_b64 exec, s[90:91]
    buffer_load_dwordx4 v[32:35], v8, s[4:7], s16 offen offset:2048 sc1
    s_mov_b64 exec, s[92:93]
    buffer_load_dwordx4 v[36:39], v8, s[4:7], s16 offen offset:3072 sc1
    s_mov_b64 exec, -1
    s_add_u32 s23, s23, 1
    s_cmp_ge_u32 s23, 200000
    s_cselect_b32 s25, 200000, s25
    s_cbranch_scc1 go_565
    s_branch gl_564
go_565:
    v_mfma_f32_16x16x32_bf16 v[40:43], a[200:203], v[28:31], v[40:43]
    v_mfma_f32_16x16x32_bf16 v[44:47], a[204:207], v[28:31], v[44:47]
    v_mfma_f32_16x16x32_bf16 v[48:51], a[232:235], v[28:31], v[48:51]
    v_mfma_f32_16x16x32_bf16 v[52:55], a[236:239], v[28:31], v[52:55]
gd_563:
    s_cmp_eq_u64 s[90:91], 0
    s_cbranch_scc1 gd_566
gl_567:
    v_max3_u32 v19, v32, v33, v34
    v_max_u32 v19, v19, v35
    v_cmp_eq_u32 vcc, -1, v19
    s_nop 0
    s_cbranch_vccz go_568
    s_mov_b64 s[90:91], vcc
    s_waitcnt vmcnt(4)
    s_mov_b64 exec, s[90:91]
    buffer_load_dwordx4 v[32:35], v8, s[4:7], s16 offen offset:2048 sc1
    s_mov_b64 exec, s[92:93]
    buffer_load_dwordx4 v[36:39], v8, s[4:7], s16 offen offset:3072 sc1
    s_mov_b64 exec, -1
    s_add_u32 s23, s23, 1
    s_cmp_ge_u32 s23, 200000
    s_cselect_b32 s25, 200000, s25
    s_cbranch_scc1 go_568
    s_branch gl_567
go_568:
    v_mfma_f32_16x16x32_bf16 v[40:43], a[208:211], v[32:35], v[40:43]
    v_mfma_f32_16x16x32_bf16 v[44:47], a[212:215], v[32:35], v[44:47]
    v_mfma_f32_16x16x32_bf16 v[48:51], a[240:243], v[32:35], v[48:51]
    v_mfma_f32_16x16x32_bf16 v[52:55], a[244:247], v[32:35], v[52:55]
gd_566:
    s_cmp_eq_u64 s[92:93], 0
    s_cbranch_scc1 gd_569
gl_570:
    v_max3_u32 v19, v36, v37, v38
    v_max_u32 v19, v19, v39
    v_cmp_eq_u32 vcc, -1, v19
    s_nop 0
    s_cbranch_vccz go_571
    s_mov_b64 s[92:93], vcc
    s_waitcnt vmcnt(2)
    s_mov_b64 exec, s[92:93]
    buffer_load_dwordx4 v[36:39], v8, s[4:7], s16 offen offset:3072 sc1
    s_mov_b64 exec, -1
    s_add_u32 s23, s23, 1
    s_cmp_ge_u32 s23, 200000
    s_cselect_b32 s25, 200000, s25
    s_cbranch_scc1 go_571
    s_branch gl_570
go_571:
    v_mfma_f32_16x16x32_bf16 v[40:43], a[216:219], v[36:39], v[40:43]
    v_mfma_f32_16x16x32_bf16 v[44:47], a[220:223], v[36:39], v[44:47]
    v_mfma_f32_16x16x32_bf16 v[48:51], a[248:251], v[36:39], v[48:51]
    v_mfma_f32_16x16x32_bf16 v[52:55], a[252:255], v[36:39], v[52:55]
gd_569:
    s_branch gc_541
gs_544:
    s_mov_b64 s[90:91], vcc
    s_mov_b64 exec, s[90:91]
    buffer_load_dwordx4 v[32:35], v8, s[4:7], s16 offen offset:2048 sc1
    s_mov_b64 exec, -1
    s_waitcnt vmcnt(1)
    v_max3_u32 v19, v36, v37, v38
    v_max_u32 v19, v19, v39
    v_cmp_eq_u32 s[92:93], -1, v19
    s_nop 0
    s_mov_b64 exec, s[92:93]
    buffer_load_dwordx4 v[36:39], v8, s[4:7], s16 offen offset:3072 sc1
    s_mov_b64 exec, -1
    s_cmp_lg_u64 s[92:93], 0
    s_cbranch_scc1 gk_572
    v_mfma_f32_16x16x32_bf16 v[40:43], a[216:219], v[36:39], v[40:43]
    v_mfma_f32_16x16x32_bf16 v[44:47], a[220:223], v[36:39], v[44:47]
    v_mfma_f32_16x16x32_bf16 v[48:51], a[248:251], v[36:39], v[48:51]
    v_mfma_f32_16x16x32_bf16 v[52:55], a[252:255], v[36:39], v[52:55]
    s_mov_b64 exec, s[90:91]
    buffer_load_dwordx4 v[32:35], v8, s[4:7], s16 offen offset:2048 sc1
    s_mov_b64 exec, -1
gk_572:
gl_574:
    v_max3_u32 v19, v32, v33, v34
    v_max_u32 v19, v19, v35
    v_cmp_eq_u32 vcc, -1, v19
    s_nop 0
    s_cbranch_vccz go_575
    s_mov_b64 s[90:91], vcc
    s_waitcnt vmcnt(4)
    s_mov_b64 exec, s[90:91]
    buffer_load_dwordx4 v[32:35], v8, s[4:7], s16 offen offset:2048 sc1
    s_mov_b64 exec, s[92:93]
    buffer_load_dwordx4 v[36:39], v8, s[4:7], s16 offen offset:3072 sc1
    s_mov_b64 exec, -1
    s_add_u32 s23, s23, 1
    s_cmp_ge_u32 s23, 200000
    s_cselect_b32 s25, 200000, s25
    s_cbranch_scc1 go_575
    s_branch gl_574
go_575:
    v_mfma_f32_16x16x32_bf16 v[40:43], a[208:211], v[32:35], v[40:43]
    v_mfma_f32_16x16x32_bf16 v[44:47], a[212:215], v[32:35], v[44:47]
    v_mfma_f32_16x16x32_bf16 v[48:51], a[240:243], v[32:35], v[48:51]
    v_mfma_f32_16x16x32_bf16 v[52:55], a[244:247], v[32:35], v[52:55]
gd_573:
    s_cmp_eq_u64 s[92:93], 0
    s_cbranch_scc1 gd_576
gl_577:
    v_max3_u32 v19, v36, v37, v38
    v_max_u32 v19, v19, v39
    v_cmp_eq_u32 vcc, -1, v19
    s_nop 0
    s_cbranch_vccz go_578
    s_mov_b64 s[92:93], vcc
    s_waitcnt vmcnt(2)
    s_mov_b64 exec, s[92:93]
    buffer_load_dwordx4 v[36:39], v8, s[4:7], s16 offen offset:3072 sc1
    s_mov_b64 exec, -1
    s_add_u32 s23, s23, 1
    s_cmp_ge_u32 s23, 200000
    s_cselect_b32 s25, 200000, s25
    s_cbranch_scc1 go_578
    s_branch gl_577
go_578:
    v_mfma_f32_16x16x32_bf16 v[40:43], a[216:219], v[36:39], v[40:43]
    v_mfma_f32_16x16x32_bf16 v[44:47], a[220:223], v[36:39], v[44:47]
    v_mfma_f32_16x16x32_bf16 v[48:51], a[248:251], v[36:39], v[48:51]
    v_mfma_f32_16x16x32_bf16 v[52:55], a[252:255], v[36:39], v[52:55]
gd_576:
    s_branch gc_541
gs_545:
    s_mov_b64 s[92:93], vcc
    s_mov_b64 exec, s[92:93]
    buffer_load_dwordx4 v[36:39], v8, s[4:7], s16 offen offset:3072 sc1
    s_mov_b64 exec, -1
gl_580:
    v_max3_u32 v19, v36, v37, v38
    v_max_u32 v19, v19, v39
    v_cmp_eq_u32 vcc, -1, v19
    s_nop 0
    s_cbranch_vccz go_581
    s_mov_b64 s[92:93], vcc
    s_waitcnt vmcnt(2)
    s_mov_b64 exec, s[92:93]
    buffer_load_dwordx4 v[36:39], v8, s[4:7], s16 offen offset:3072 sc1
    s_mov_b64 exec, -1
    s_add_u32 s23, s23, 1
    s_cmp_ge_u32 s23, 200000
    s_cselect_b32 s25, 200000, s25
    s_cbranch_scc1 go_581
    s_branch gl_580
go_581:
    v_mfma_f32_16x16x32_bf16 v[40:43], a[216:219], v[36:39], v[40:43]
    v_mfma_f32_16x16x32_bf16 v[44:47], a[220:223], v[36:39], v[44:47]
    v_mfma_f32_16x16x32_bf16 v[48:51], a[248:251], v[36:39], v[48:51]
    v_mfma_f32_16x16x32_bf16 v[52:55], a[252:255], v[36:39], v[52:55]
gd_579:
    s_branch gc_541
.p2align 6
recur_slow_w2:
    s_sleep 2
    s_mov_b32 s23, s25
    buffer_load_dwordx4 v[24:27], v2, s[4:7], s16 offen offset:0 sc1
    buffer_load_dwordx4 v[28:31], v2, s[4:7], s16 offen offset:1024 sc1
    buffer_load_dwordx4 v[32:35], v2, s[4:7], s16 offen offset:2048 sc1
    buffer_load_dwordx4 v[36:39], v2, s[4:7], s16 offen offset:3072 sc1
    s_waitcnt vmcnt(3)
    v_max3_u32 v19, v24, v25, v26
    v_max_u32 v19, v19, v27
    v_cmp_eq_u32 vcc, -1, v19
    s_nop 0
    s_cbranch_vccnz gs_585
    v_mfma_f32_16x16x32_bf16 v[40:43], a[0:3], v[24:27], v[40:43]
    v_mfma_f32_16x16x32_bf16 v[44:47], a[4:7], v[24:27], v[44:47]
    v_mfma_f32_16x16x32_bf16 v[56:59], a[64:67], v[24:27], v[56:59]
    v_mfma_f32_16x16x32_bf16 v[60:63], a[68:71], v[24:27], v[60:63]
    v_mfma_f32_16x16x32_bf16 v[48:51], a[32:35], v[24:27], v[48:51]
    s_waitcnt vmcnt(2)
    v_max3_u32 v19, v28, v29, v30
    v_mfma_f32_16x16x32_bf16 v[52:55], a[36:39], v[24:27], v[52:55]
    v_max_u32 v19, v19, v31
    v_mfma_f32_16x16x32_bf16 v[64:67], a[96:99], v[24:27], v[64:67]
    v_cmp_eq_u32 vcc, -1, v19
    v_mfma_f32_16x16x32_bf16 v[68:71], a[100:103], v[24:27], v[68:71]
    s_cbranch_vccnz gs_586
    v_mfma_f32_16x16x32_bf16 v[40:43], a[8:11], v[28:31], v[40:43]
    v_mfma_f32_16x16x32_bf16 v[44:47], a[12:15], v[28:31], v[44:47]
    v_mfma_f32_16x16x32_bf16 v[56:59], a[72:75], v[28:31], v[56:59]
    v_mfma_f32_16x16x32_bf16 v[60:63], a[76:79], v[28:31], v[60:63]
    v_mfma_f32_16x16x32_bf16 v[48:51], a[40:43], v[28:31], v[48:51]
    s_waitcnt vmcnt(1)
    v_max3_u32 v19, v32, v33, v34
    v_mfma_f32_16x16x32_bf16 v[52:55], a[44:47], v[28:31], v[52:55]
    v_max_u32 v19, v19, v35
    v_mfma_f32_16x16x32_bf16 v[64:67], a[104:107], v[28:31], v[64:67]
    v_cmp_eq_u32 vcc, -1, v19
    v_mfma_f32_16x16x32_bf16 v[68:71], a[108:111], v[28:31], v[68:71]
    s_cbranch_vccnz gs_587
    v_mfma_f32_16x16x32_bf16 v[40:43], a[16:19], v[32:35], v[40:43]
    v_mfma_f32_16x16x32_bf16 v[44:47], a[20:23], v[32:35], v[44:47]
    v_mfma_f32_16x16x32_bf16 v[56:59], a[80:83], v[32:35], v[56:59]
    v_mfma_f32_16x16x32_bf16 v[60:63], a[84:87], v[32:35], v[60:63]
    v_mfma_f32_16x16x32_bf16 v[48:51], a[48:51], v[32:35], v[48:51]
    s_waitcnt vmcnt(0)
    v_max3_u32 v19, v36, v37, v38
    v_mfma_f32_16x16x32_bf16 v[52:55], a[52:55], v[32:35], v[52:55]
    v_max_u32 v19, v19, v39
    v_mfma_f32_16x16x32_bf16 v[64:67], a[112:115], v[32:35], v[64:67]
    v_cmp_eq_u32 vcc, -1, v19
    v_mfma_f32_16x16x32_bf16 v[68:71], a[116:119], v[32:35], v[68:71]
    s_cbranch_vccnz gs_588
    v_mfma_f32_16x16x32_bf16 v[40:43], a[24:27], v[36:39], v[40:43]
    v_mfma_f32_16x16x32_bf16 v[44:47], a[28:31], v[36:39], v[44:47]
    v_mfma_f32_16x16x32_bf16 v[56:59], a[88:91], v[36:39], v[56:59]
    v_mfma_f32_16x16x32_bf16 v[60:63], a[92:95], v[36:39], v[60:63]
    v_mfma_f32_16x16x32_bf16 v[48:51], a[56:59], v[36:39], v[48:51]
    v_mfma_f32_16x16x32_bf16 v[52:55], a[60:63], v[36:39], v[52:55]
    v_mfma_f32_16x16x32_bf16 v[64:67], a[120:123], v[36:39], v[64:67]
    v_mfma_f32_16x16x32_bf16 v[68:71], a[124:127], v[36:39], v[68:71]
gc_584:
    s_nop 1
    v_add_f32_dpp v88, v44, v40 row_ror:8 row_mask:0xf bank_mask:0x3
    v_add_f32_dpp v89, v45, v41 row_ror:8 row_mask:0xf bank_mask:0x3
    v_add_f32_dpp v90, v46, v42 row_ror:8 row_mask:0xf bank_mask:0x3
    v_add_f32_dpp v91, v47, v43 row_ror:8 row_mask:0xf bank_mask:0x3
    v_add_f32_dpp v88, v56, v60 row_ror:8 row_mask:0xf bank_mask:0xc
    v_add_f32_dpp v89, v57, v61 row_ror:8 row_mask:0xf bank_mask:0xc
    v_add_f32_dpp v90, v58, v62 row_ror:8 row_mask:0xf bank_mask:0xc
    v_add_f32_dpp v91, v59, v63 row_ror:8 row_mask:0xf bank_mask:0xc
    ds_write_b128 v17, v[88:91] offset:0
    v_add_f32_dpp v92, v52, v48 row_ror:8 row_mask:0xf bank_mask:0x3
    v_add_f32_dpp v93, v53, v49 row_ror:8 row_mask:0xf bank_mask:0x3
    v_add_f32_dpp v94, v54, v50 row_ror:8 row_mask:0xf bank_mask:0x3
    v_add_f32_dpp v95, v55, v51 row_ror:8 row_mask:0xf bank_mask:0x3
    v_mfma_f32_16x16x32_bf16 v[72:75], v[24:27], a[128:131], 0
    v_add_f32_dpp v92, v64, v68 row_ror:8 row_mask:0xf bank_mask:0xc
    v_add_f32_dpp v93, v65, v69 row_ror:8 row_mask:0xf bank_mask:0xc
    v_add_f32_dpp v94, v66, v70 row_ror:8 row_mask:0xf bank_mask:0xc
    v_add_f32_dpp v95, v67, v71 row_ror:8 row_mask:0xf bank_mask:0xc
    v_mfma_f32_16x16x32_bf16 v[80:83], v[24:27], a[160:163], 0
    ds_write_b128 v17, v[92:95] offset:1024
    v_mfma_f32_16x16x32_bf16 v[76:79], v[24:27], a[132:135], 0
    v_mfma_f32_16x16x32_bf16 v[84:87], v[24:27], a[164:167], 0
    s_waitcnt lgkmcnt(0)
    s_barrier
    v_mfma_f32_16x16x32_bf16 v[72:75], v[28:31], a[136:139], v[72:75]
    v_mfma_f32_16x16x32_bf16 v[80:83], v[28:31], a[168:171], v[80:83]
    v_mfma_f32_16x16x32_bf16 v[76:79], v[28:31], a[140:143], v[76:79]
    v_mfma_f32_16x16x32_bf16 v[84:87], v[28:31], a[172:175], v[84:87]
    v_mfma_f32_16x16x32_bf16 v[72:75], v[32:35], a[144:147], v[72:75]
    v_mfma_f32_16x16x32_bf16 v[80:83], v[32:35], a[176:179], v[80:83]
    v_mfma_f32_16x16x32_bf16 v[76:79], v[32:35], a[148:151], v[76:79]
    v_mfma_f32_16x16x32_bf16 v[84:87], v[32:35], a[180:183], v[84:87]
    v_mfma_f32_16x16x32_bf16 v[72:75], v[36:39], a[152:155], v[72:75]
    v_mfma_f32_16x16x32_bf16 v[80:83], v[36:39], a[184:187], v[80:83]
    v_mfma_f32_16x16x32_bf16 v[76:79], v[36:39], a[156:159], v[76:79]
    v_mfma_f32_16x16x32_bf16 v[84:87], v[36:39], a[188:191], v[84:87]
    s_nop 6
    v_mov_b32_dpp v72, v76 quad_perm:[0,1,2,3] row_mask:0xc bank_mask:0xf
    v_mov_b32_dpp v73, v77 quad_perm:[0,1,2,3] row_mask:0xc bank_mask:0xf
    v_mov_b32_dpp v74, v78 quad_perm:[0,1,2,3] row_mask:0xc bank_mask:0xf
    v_mov_b32_dpp v75, v79 quad_perm:[0,1,2,3] row_mask:0xc bank_mask:0xf
    ds_write_b128 v17, v[72:75] offset:8192
    v_mov_b32_dpp v80, v84 quad_perm:[0,1,2,3] row_mask:0xc bank_mask:0xf
    v_mov_b32_dpp v81, v85 quad_perm:[0,1,2,3] row_mask:0xc bank_mask:0xf
    v_mov_b32_dpp v82, v86 quad_perm:[0,1,2,3] row_mask:0xc bank_mask:0xf
    v_mov_b32_dpp v83, v87 quad_perm:[0,1,2,3] row_mask:0xc bank_mask:0xf
    ds_write_b128 v17, v[80:83] offset:9216
    v_mov_b32 v40, 0
    v_mov_b32 v41, 0
    v_mov_b32 v42, 0
    v_mov_b32 v43, 0
    v_mov_b32 v44, 0
    v_mov_b32 v45, 0
    v_mov_b32 v46, 0
    v_mov_b32 v47, 0
    v_mov_b32 v48, 0
    v_mov_b32 v49, 0
    v_mov_b32 v50, 0
    v_mov_b32 v51, 0
    v_mov_b32 v52, 0
    v_mov_b32 v53, 0
    v_mov_b32 v54, 0
    v_mov_b32 v55, 0
    s_waitcnt lgkmcnt(0)
    s_barrier
    ds_read_b64 v[96:97], v18 offset:8192
    ds_read_b64 v[98:99], v18 offset:8704
    ds_read_b64 v[100:101], v18 offset:10240
    ds_read_b64 v[102:103], v18 offset:10752
    ds_read_b64 v[104:105], v18 offset:12288
    ds_read_b64 v[106:107], v18 offset:12800
    ds_read_b64 v[108:109], v18 offset:14336
    ds_read_b64 v[110:111], v18 offset:14848
    s_waitcnt lgkmcnt(7)
    ds_read_b64 v[112:113], v18 offset:9216
    ds_read_b64 v[114:115], v18 offset:9728
    ds_read_b64 v[116:117], v18 offset:11264
    ds_read_b64 v[118:119], v18 offset:11776
    ds_read_b64 v[120:121], v18 offset:13312
    ds_read_b64 v[122:123], v18 offset:13824
    ds_read_b64 v[124:125], v18 offset:15360
    ds_read_b64 v[126:127], v18 offset:15872
    s_waitcnt lgkmcnt(8)
    v_add_f32 v96, v96, v104
    v_add_f32 v97, v97, v105
    v_add_f32 v98, v98, v106
    v_add_f32 v99, v99, v107
    v_add_f32 v100, v100, v108
    v_add_f32 v101, v101, v109
    v_add_f32 v102, v102, v110
    v_add_f32 v103, v103, v111
    v_add_f32 v96, v96, v100
    v_add_f32 v97, v97, v101
    v_add_f32 v98, v98, v102
    v_add_f32 v99, v99, v103
    v_add_f32 v96, v96, v98
    v_add_f32 v97, v97, v99
    v_cvt_pk_bf16_f32 v168, v96, v97
    v_and_b32 v140, 0xffff, v168
    v_lshrrev_b32 v141, 16, v168
    s_waitcnt lgkmcnt(0)
    v_add_f32 v112, v112, v120
    v_add_f32 v113, v113, v121
    v_add_f32 v114, v114, v122
    v_add_f32 v115, v115, v123
    v_add_f32 v116, v116, v124
    v_add_f32 v117, v117, v125
    v_add_f32 v118, v118, v126
    v_add_f32 v119, v119, v127
    v_add_f32 v112, v112, v116
    v_add_f32 v113, v113, v117
    v_add_f32 v114, v114, v118
    v_add_f32 v115, v115, v119
    v_add_f32 v112, v112, v114
    v_add_f32 v113, v113, v115
    v_cvt_pk_bf16_f32 v169, v112, v113
    v_and_b32 v142, 0xffff, v169
    v_lshrrev_b32 v143, 16, v169
    ds_write_b128 v16, v[140:143] offset:24576
    s_cmp_eq_u32 s15, 63
    s_cbranch_scc1 recur_slow_last2
    s_waitcnt lgkmcnt(0)
    s_barrier
    s_sleep 7
    s_nop 12
    s_mov_b32 s23, s25
    buffer_load_dwordx4 v[24:27], v8, s[4:7], s16 offen offset:0 sc1
    buffer_load_dwordx4 v[28:31], v8, s[4:7], s16 offen offset:1024 sc1
    buffer_load_dwordx4 v[32:35], v8, s[4:7], s16 offen offset:2048 sc1
    buffer_load_dwordx4 v[36:39], v8, s[4:7], s16 offen offset:3072 sc1
    s_waitcnt vmcnt(3)
    v_max3_u32 v19, v24, v25, v26
    v_max_u32 v19, v19, v27
    v_cmp_eq_u32 vcc, -1, v19
    s_nop 0
    s_cbranch_vccnz gs_626
    v_mfma_f32_16x16x32_bf16 v[40:43], a[192:195], v[24:27], v[40:43]
    s_waitcnt vmcnt(2)
    v_max3_u32 v19, v28, v29, v30
    v_mfma_f32_16x16x32_bf16 v[44:47], a[196:199], v[24:27], v[44:47]
    v_max_u32 v19, v19, v31
    v_mfma_f32_16x16x32_bf16 v[48:51], a[224:227], v[24:27], v[48:51]
    v_cmp_eq_u32 vcc, -1, v19
    v_mfma_f32_16x16x32_bf16 v[52:55], a[228:231], v[24:27], v[52:55]
    s_cbranch_vccnz gs_627
    v_mfma_f32_16x16x32_bf16 v[40:43], a[200:203], v[28:31], v[40:43]
    s_waitcnt vmcnt(1)
    v_max3_u32 v19, v32, v33, v34
    v_mfma_f32_16x16x32_bf16 v[44:47], a[204:207], v[28:31], v[44:47]
    v_max_u32 v19, v19, v35
    v_mfma_f32_16x16x32_bf16 v[48:51], a[232:235], v[28:31], v[48:51]
    v_cmp_eq_u32 vcc, -1, v19
    v_mfma_f32_16x16x32_bf16 v[52:55], a[236:239], v[28:31], v[52:55]
    s_cbranch_vccnz gs_628
    v_mfma_f32_16x16x32_bf16 v[40:43], a[208:211], v[32:35], v[40:43]
    s_waitcnt vmcnt(0)
    v_max3_u32 v19, v36, v37, v38
    v_mfma_f32_16x16x32_bf16 v[44:47], a[212:215], v[32:35], v[44:47]
    v_max_u32 v19, v19, v39
    v_mfma_f32_16x16x32_bf16 v[48:51], a[240:243], v[32:35], v[48:51]
    v_cmp_eq_u32 vcc, -1, v19
    v_mfma_f32_16x16x32_bf16 v[52:55], a[244:247], v[32:35], v[52:55]
    s_cbranch_vccnz gs_629
    v_mfma_f32_16x16x32_bf16 v[40:43], a[216:219], v[36:39], v[40:43]
    v_mfma_f32_16x16x32_bf16 v[44:47], a[220:223], v[36:39], v[44:47]
    v_mfma_f32_16x16x32_bf16 v[48:51], a[248:251], v[36:39], v[48:51]
    v_mfma_f32_16x16x32_bf16 v[52:55], a[252:255], v[36:39], v[52:55]
gc_625:
    s_nop 5
    v_add_f32_dpp v88, v44, v40 row_ror:8 row_mask:0xf bank_mask:0x3
    v_add_f32_dpp v89, v45, v41 row_ror:8 row_mask:0xf bank_mask:0x3
    v_add_f32_dpp v90, v46, v42 row_ror:8 row_mask:0xf bank_mask:0x3
    v_add_f32_dpp v91, v47, v43 row_ror:8 row_mask:0xf bank_mask:0x3
    v_add_f32_dpp v88, v48, v52 row_ror:8 row_mask:0xf bank_mask:0xc
    v_add_f32_dpp v89, v49, v53 row_ror:8 row_mask:0xf bank_mask:0xc
    v_add_f32_dpp v90, v50, v54 row_ror:8 row_mask:0xf bank_mask:0xc
    v_add_f32_dpp v91, v51, v55 row_ror:8 row_mask:0xf bank_mask:0xc
    ds_write_b128 v17, v[88:91] offset:16384
    s_waitcnt lgkmcnt(0)
    s_barrier
    v_mov_b32 v40, 0
    v_mov_b32 v41, 0
    v_mov_b32 v42, 0
    v_mov_b32 v43, 0
    v_mov_b32 v44, 0
    v_mov_b32 v45, 0
    v_mov_b32 v46, 0
    v_mov_b32 v47, 0
    v_mov_b32 v48, 0
    v_mov_b32 v49, 0
    v_mov_b32 v50, 0
    v_mov_b32 v51, 0
    v_mov_b32 v52, 0
    v_mov_b32 v53, 0
    v_mov_b32 v54, 0
    v_mov_b32 v55, 0
    v_mov_b32 v56, 0
    v_mov_b32 v57, 0
    v_mov_b32 v58, 0
    v_mov_b32 v59, 0
    v_mov_b32 v60, 0
    v_mov_b32 v61, 0
    v_mov_b32 v62, 0
    v_mov_b32 v63, 0
    v_mov_b32 v64, 0
    v_mov_b32 v65, 0
    v_mov_b32 v66, 0
    v_mov_b32 v67, 0
    v_mov_b32 v68, 0
    v_mov_b32 v69, 0
    v_mov_b32 v70, 0
    v_mov_b32 v71, 0
    s_sleep 1
    buffer_store_dword v168, v15, s[4:7], s20 offen offset:0 sc1
    buffer_store_dword v169, v15, s[4:7], s20 offen offset:64 sc1
    s_add_u32 s20, s20, 512
    s_mov_b32 s21, s16
    s_mov_b32 s16, s42
    s_mov_b32 s42, s43
    s_mov_b32 s43, s44
    s_mov_b32 s44, s21
    s_add_u32 s84, s84, 262144
    s_add_u32 s15, s15, 1
    s_barrier
    s_branch recur_slow_w2
gs_585:
    s_mov_b64 s[86:87], vcc
    s_mov_b64 exec, s[86:87]
    buffer_load_dwordx4 v[24:27], v2, s[4:7], s16 offen offset:0 sc1
    s_mov_b64 exec, -1
    s_waitcnt vmcnt(1)
    v_max3_u32 v19, v28, v29, v30
    v_max_u32 v19, v19, v31
    v_cmp_eq_u32 s[88:89], -1, v19
    v_max3_u32 v19, v32, v33, v34
    v_max_u32 v19, v19, v35
    v_cmp_eq_u32 s[90:91], -1, v19
    v_max3_u32 v19, v36, v37, v38
    v_max_u32 v19, v19, v39
    v_cmp_eq_u32 s[92:93], -1, v19
    s_mov_b64 exec, s[88:89]
    buffer_load_dwordx4 v[28:31], v2, s[4:7], s16 offen offset:1024 sc1
    s_mov_b64 exec, s[90:91]
    buffer_load_dwordx4 v[32:35], v2, s[4:7], s16 offen offset:2048 sc1
    s_mov_b64 exec, s[92:93]
    buffer_load_dwordx4 v[36:39], v2, s[4:7], s16 offen offset:3072 sc1
    s_mov_b64 exec, -1
    s_cmp_lg_u64 s[88:89], 0
    s_cbranch_scc1 gk_589
    v_mfma_f32_16x16x32_bf16 v[40:43], a[8:11], v[28:31], v[40:43]
    v_mfma_f32_16x16x32_bf16 v[44:47], a[12:15], v[28:31], v[44:47]
    v_mfma_f32_16x16x32_bf16 v[56:59], a[72:75], v[28:31], v[56:59]
    v_mfma_f32_16x16x32_bf16 v[60:63], a[76:79], v[28:31], v[60:63]
    v_mfma_f32_16x16x32_bf16 v[48:51], a[40:43], v[28:31], v[48:51]
    v_mfma_f32_16x16x32_bf16 v[52:55], a[44:47], v[28:31], v[52:55]
    v_mfma_f32_16x16x32_bf16 v[64:67], a[104:107], v[28:31], v[64:67]
    v_mfma_f32_16x16x32_bf16 v[68:71], a[108:111], v[28:31], v[68:71]
    s_mov_b64 exec, s[86:87]
    buffer_load_dwordx4 v[24:27], v2, s[4:7], s16 offen offset:0 sc1
    s_mov_b64 exec, s[90:91]
    buffer_load_dwordx4 v[32:35], v2, s[4:7], s16 offen offset:2048 sc1
    s_mov_b64 exec, s[92:93]
    buffer_load_dwordx4 v[36:39], v2, s[4:7], s16 offen offset:3072 sc1
    s_mov_b64 exec, -1
gk_589:
    s_cmp_lg_u64 s[90:91], 0
    s_cbranch_scc1 gk_590
    v_mfma_f32_16x16x32_bf16 v[40:43], a[16:19], v[32:35], v[40:43]
    v_mfma_f32_16x16x32_bf16 v[44:47], a[20:23], v[32:35], v[44:47]
    v_mfma_f32_16x16x32_bf16 v[56:59], a[80:83], v[32:35], v[56:59]
    v_mfma_f32_16x16x32_bf16 v[60:63], a[84:87], v[32:35], v[60:63]
    v_mfma_f32_16x16x32_bf16 v[48:51], a[48:51], v[32:35], v[48:51]
    v_mfma_f32_16x16x32_bf16 v[52:55], a[52:55], v[32:35], v[52:55]
    v_mfma_f32_16x16x32_bf16 v[64:67], a[112:115], v[32:35], v[64:67]
    v_mfma_f32_16x16x32_bf16 v[68:71], a[116:119], v[32:35], v[68:71]
    s_mov_b64 exec, s[86:87]
    buffer_load_dwordx4 v[24:27], v2, s[4:7], s16 offen offset:0 sc1
    s_mov_b64 exec, s[88:89]
    buffer_load_dwordx4 v[28:31], v2, s[4:7], s16 offen offset:1024 sc1
    s_mov_b64 exec, s[92:93]
    buffer_load_dwordx4 v[36:39], v2, s[4:7], s16 offen offset:3072 sc1
    s_mov_b64 exec, -1
gk_590:
    s_cmp_lg_u64 s[92:93], 0
    s_cbranch_scc1 gk_591
    v_mfma_f32_16x16x32_bf16 v[40:43], a[24:27], v[36:39], v[40:43]
    v_mfma_f32_16x16x32_bf16 v[44:47], a[28:31], v[36:39], v[44:47]
    v_mfma_f32_16x16x32_bf16 v[56:59], a[88:91], v[36:39], v[56:59]
    v_mfma_f32_16x16x32_bf16 v[60:63], a[92:95], v[36:39], v[60:63]
    v_mfma_f32_16x16x32_bf16 v[48:51], a[56:59], v[36:39], v[48:51]
    v_mfma_f32_16x16x32_bf16 v[52:55], a[60:63], v[36:39], v[52:55]
    v_mfma_f32_16x16x32_bf16 v[64:67], a[120:123], v[36:39], v[64:67]
    v_mfma_f32_16x16x32_bf16 v[68:71], a[124:127], v[36:39], v[68:71]
    s_mov_b64 exec, s[86:87]
    buffer_load_dwordx4 v[24:27], v2, s[4:7], s16 offen offset:0 sc1
    s_mov_b64 exec, s[88:89]
    buffer_load_dwordx4 v[28:31], v2, s[4:7], s16 offen offset:1024 sc1
    s_mov_b64 exec, s[90:91]
    buffer_load_dwordx4 v[32:35], v2, s[4:7], s16 offen offset:2048 sc1
    s_mov_b64 exec, -1
gk_591:
gl_593:
    v_max3_u32 v19, v24, v25, v26
    v_max_u32 v19, v19, v27
    v_cmp_eq_u32 vcc, -1, v19
    s_nop 0
    s_cbranch_vccz go_594
    s_mov_b64 s[86:87], vcc
    s_waitcnt vmcnt(8)
    s_mov_b64 exec, s[86:87]
    buffer_load_dwordx4 v[24:27], v2, s[4:7], s16 offen offset:0 sc1
    s_mov_b64 exec, s[88:89]
    buffer_load_dwordx4 v[28:31], v2, s[4:7], s16 offen offset:1024 sc1
    s_mov_b64 exec, s[90:91]
    buffer_load_dwordx4 v[32:35], v2, s[4:7], s16 offen offset:2048 sc1
    s_mov_b64 exec, s[92:93]
    buffer_load_dwordx4 v[36:39], v2, s[4:7], s16 offen offset:3072 sc1
    s_mov_b64 exec, -1
    s_add_u32 s23, s23, 1
    s_cmp_ge_u32 s23, 200000
    s_cselect_b32 s25, 200000, s25
    s_cbranch_scc1 go_594
    s_branch gl_593
go_594:
    v_mfma_f32_16x16x32_bf16 v[40:43], a[0:3], v[24:27], v[40:43]
    v_mfma_f32_16x16x32_bf16 v[44:47], a[4:7], v[24:27], v[44:47]
    v_mfma_f32_16x16x32_bf16 v[56:59], a[64:67], v[24:27], v[56:59]
    v_mfma_f32_16x16x32_bf16 v[60:63], a[68:71], v[24:27], v[60:63]
    v_mfma_f32_16x16x32_bf16 v[48:51], a[32:35], v[24:27], v[48:51]
    v_mfma_f32_16x16x32_bf16 v[52:55], a[36:39], v[24:27], v[52:55]
    v_mfma_f32_16x16x32_bf16 v[64:67], a[96:99], v[24:27], v[64:67]
    v_mfma_f32_16x16x32_bf16 v[68:71], a[100:103], v[24:27], v[68:71]
gd_592:
    s_cmp_eq_u64 s[88:89], 0
    s_cbranch_scc1 gd_595
gl_596:
    v_max3_u32 v19, v28, v29, v30
    v_max_u32 v19, v19, v31
    v_cmp_eq_u32 vcc, -1, v19
    s_nop 0
    s_cbranch_vccz go_597
    s_mov_b64 s[88:89], vcc
    s_waitcnt vmcnt(6)
    s_mov_b64 exec, s[88:89]
    buffer_load_dwordx4 v[28:31], v2, s[4:7], s16 offen offset:1024 sc1
    s_mov_b64 exec, s[90:91]
    buffer_load_dwordx4 v[32:35], v2, s[4:7], s16 offen offset:2048 sc1
    s_mov_b64 exec, s[92:93]
    buffer_load_dwordx4 v[36:39], v2, s[4:7], s16 offen offset:3072 sc1
    s_mov_b64 exec, -1
    s_add_u32 s23, s23, 1
    s_cmp_ge_u32 s23, 200000
    s_cselect_b32 s25, 200000, s25
    s_cbranch_scc1 go_597
    s_branch gl_596
go_597:
    v_mfma_f32_16x16x32_bf16 v[40:43], a[8:11], v[28:31], v[40:43]
    v_mfma_f32_16x16x32_bf16 v[44:47], a[12:15], v[28:31], v[44:47]
    v_mfma_f32_16x16x32_bf16 v[56:59], a[72:75], v[28:31], v[56:59]
    v_mfma_f32_16x16x32_bf16 v[60:63], a[76:79], v[28:31], v[60:63]
    v_mfma_f32_16x16x32_bf16 v[48:51], a[40:43], v[28:31], v[48:51]
    v_mfma_f32_16x16x32_bf16 v[52:55], a[44:47], v[28:31], v[52:55]
    v_mfma_f32_16x16x32_bf16 v[64:67], a[104:107], v[28:31], v[64:67]
    v_mfma_f32_16x16x32_bf16 v[68:71], a[108:111], v[28:31], v[68:71]
gd_595:
    s_cmp_eq_u64 s[90:91], 0
    s_cbranch_scc1 gd_598
gl_599:
    v_max3_u32 v19, v32, v33, v34
    v_max_u32 v19, v19, v35
    v_cmp_eq_u32 vcc, -1, v19
    s_nop 0
    s_cbranch_vccz go_600
    s_mov_b64 s[90:91], vcc
    s_waitcnt vmcnt(4)
    s_mov_b64 exec, s[90:91]
    buffer_load_dwordx4 v[32:35], v2, s[4:7], s16 offen offset:2048 sc1
    s_mov_b64 exec, s[92:93]
    buffer_load_dwordx4 v[36:39], v2, s[4:7], s16 offen offset:3072 sc1
    s_mov_b64 exec, -1
    s_add_u32 s23, s23, 1
    s_cmp_ge_u32 s23, 200000
    s_cselect_b32 s25, 200000, s25
    s_cbranch_scc1 go_600
    s_branch gl_599
go_600:
    v_mfma_f32_16x16x32_bf16 v[40:43], a[16:19], v[32:35], v[40:43]
    v_mfma_f32_16x16x32_bf16 v[44:47], a[20:23], v[32:35], v[44:47]
    v_mfma_f32_16x16x32_bf16 v[56:59], a[80:83], v[32:35], v[56:59]
    v_mfma_f32_16x16x32_bf16 v[60:63], a[84:87], v[32:35], v[60:63]
    v_mfma_f32_16x16x32_bf16 v[48:51], a[48:51], v[32:35], v[48:51]
    v_mfma_f32_16x16x32_bf16 v[52:55], a[52:55], v[32:35], v[52:55]
    v_mfma_f32_16x16x32_bf16 v[64:67], a[112:115], v[32:35], v[64:67]
    v_mfma_f32_16x16x32_bf16 v[68:71], a[116:119], v[32:35], v[68:71]
gd_598:
    s_cmp_eq_u64 s[92:93], 0
    s_cbranch_scc1 gd_601
gl_602:
    v_max3_u32 v19, v36, v37, v38
    v_max_u32 v19, v19, v39
    v_cmp_eq_u32 vcc, -1, v19
    s_nop 0
    s_cbranch_vccz go_603
    s_mov_b64 s[92:93], vcc
    s_waitcnt vmcnt(2)
    s_mov_b64 exec, s[92:93]
    buffer_load_dwordx4 v[36:39], v2, s[4:7], s16 offen offset:3072 sc1
    s_mov_b64 exec, -1
    s_add_u32 s23, s23, 1
    s_cmp_ge_u32 s23, 200000
    s_cselect_b32 s25, 200000, s25
    s_cbranch_scc1 go_603
    s_branch gl_602
go_603:
    v_mfma_f32_16x16x32_bf16 v[40:43], a[24:27], v[36:39], v[40:43]
    v_mfma_f32_16x16x32_bf16 v[44:47], a[28:31], v[36:39], v[44:47]
    v_mfma_f32_16x16x32_bf16 v[56:59], a[88:91], v[36:39], v[56:59]
    v_mfma_f32_16x16x32_bf16 v[60:63], a[92:95], v[36:39], v[60:63]
    v_mfma_f32_16x16x32_bf16 v[48:51], a[56:59], v[36:39], v[48:51]
    v_mfma_f32_16x16x32_bf16 v[52:55], a[60:63], v[36:39], v[52:55]
    v_mfma_f32_16x16x32_bf16 v[64:67], a[120:123], v[36:39], v[64:67]
    v_mfma_f32_16x16x32_bf16 v[68:71], a[124:127], v[36:39], v[68:71]
gd_601:
    s_branch gc_584
gs_586:
    s_mov_b64 s[88:89], vcc
    s_mov_b64 exec, s[88:89]
    buffer_load_dwordx4 v[28:31], v2, s[4:7], s16 offen offset:1024 sc1
    s_mov_b64 exec, -1
    s_waitcnt vmcnt(1)
    v_max3_u32 v19, v32, v33, v34
    v_max_u32 v19, v19, v35
    v_cmp_eq_u32 s[90:91], -1, v19
    v_max3_u32 v19, v36, v37, v38
    v_max_u32 v19, v19, v39
    v_cmp_eq_u32 s[92:93], -1, v19
    s_mov_b64 exec, s[90:91]
    buffer_load_dwordx4 v[32:35], v2, s[4:7], s16 offen offset:2048 sc1
    s_mov_b64 exec, s[92:93]
    buffer_load_dwordx4 v[36:39], v2, s[4:7], s16 offen offset:3072 sc1
    s_mov_b64 exec, -1
    s_cmp_lg_u64 s[90:91], 0
    s_cbranch_scc1 gk_604
    v_mfma_f32_16x16x32_bf16 v[40:43], a[16:19], v[32:35], v[40:43]
    v_mfma_f32_16x16x32_bf16 v[44:47], a[20:23], v[32:35], v[44:47]
    v_mfma_f32_16x16x32_bf16 v[56:59], a[80:83], v[32:35], v[56:59]
    v_mfma_f32_16x16x32_bf16 v[60:63], a[84:87], v[32:35], v[60:63]
    v_mfma_f32_16x16x32_bf16 v[48:51], a[48:51], v[32:35], v[48:51]
    v_mfma_f32_16x16x32_bf16 v[52:55], a[52:55], v[32:35], v[52:55]
    v_mfma_f32_16x16x32_bf16 v[64:67], a[112:115], v[32:35], v[64:67]
    v_mfma_f32_16x16x32_bf16 v[68:71], a[116:119], v[32:35], v[68:71]
    s_mov_b64 exec, s[88:89]
    buffer_load_dwordx4 v[28:31], v2, s[4:7], s16 offen offset:1024 sc1
    s_mov_b64 exec, s[92:93]
    buffer_load_dwordx4 v[36:39], v2, s[4:7], s16 offen offset:3072 sc1
    s_mov_b64 exec, -1
gk_604:
    s_cmp_lg_u64 s[92:93], 0
    s_cbranch_scc1 gk_605
    v_mfma_f32_16x16x32_bf16 v[40:43], a[24:27], v[36:39], v[40:43]
    v_mfma_f32_16x16x32_bf16 v[44:47], a[28:31], v[36:39], v[44:47]
    v_mfma_f32_16x16x32_bf16 v[56:59], a[88:91], v[36:39], v[56:59]
    v_mfma_f32_16x16x32_bf16 v[60:63], a[92:95], v[36:39], v[60:63]
    v_mfma_f32_16x16x32_bf16 v[48:51], a[56:59], v[36:39], v[48:51]
    v_mfma_f32_16x16x32_bf16 v[52:55], a[60:63], v[36:39], v[52:55]
    v_mfma_f32_16x16x32_bf16 v[64:67], a[120:123], v[36:39], v[64:67]
    v_mfma_f32_16x16x32_bf16 v[68:71], a[124:127], v[36:39], v[68:71]
    s_mov_b64 exec, s[88:89]
    buffer_load_dwordx4 v[28:31], v2, s[4:7], s16 offen offset:1024 sc1
    s_mov_b64 exec, s[90:91]
    buffer_load_dwordx4 v[32:35], v2, s[4:7], s16 offen offset:2048 sc1
    s_mov_b64 exec, -1
gk_605:
gl_607:
    v_max3_u32 v19, v28, v29, v30
    v_max_u32 v19, v19, v31
    v_cmp_eq_u32 vcc, -1, v19
    s_nop 0
    s_cbranch_vccz go_608
    s_mov_b64 s[88:89], vcc
    s_waitcnt vmcnt(6)
    s_mov_b64 exec, s[88:89]
    buffer_load_dwordx4 v[28:31], v2, s[4:7], s16 offen offset:1024 sc1
    s_mov_b64 exec, s[90:91]
    buffer_load_dwordx4 v[32:35], v2, s[4:7], s16 offen offset:2048 sc1
    s_mov_b64 exec, s[92:93]
    buffer_load_dwordx4 v[36:39], v2, s[4:7], s16 offen offset:3072 sc1
    s_mov_b64 exec, -1
    s_add_u32 s23, s23, 1
    s_cmp_ge_u32 s23, 200000
    s_cselect_b32 s25, 200000, s25
    s_cbranch_scc1 go_608
    s_branch gl_607
go_608:
    v_mfma_f32_16x16x32_bf16 v[40:43], a[8:11], v[28:31], v[40:43]
    v_mfma_f32_16x16x32_bf16 v[44:47], a[12:15], v[28:31], v[44:47]
    v_mfma_f32_16x16x32_bf16 v[56:59], a[72:75], v[28:31], v[56:59]
    v_mfma_f32_16x16x32_bf16 v[60:63], a[76:79], v[28:31], v[60:63]
    v_mfma_f32_16x16x32_bf16 v[48:51], a[40:43], v[28:31], v[48:51]
    v_mfma_f32_16x16x32_bf16 v[52:55], a[44:47], v[28:31], v[52:55]
    v_mfma_f32_16x16x32_bf16 v[64:67], a[104:107], v[28:31], v[64:67]
    v_mfma_f32_16x16x32_bf16 v[68:71], a[108:111], v[28:31], v[68:71]
gd_606:
    s_cmp_eq_u64 s[90:91], 0
    s_cbranch_scc1 gd_609
gl_610:
    v_max3_u32 v19, v32, v33, v34
    v_max_u32 v19, v19, v35
    v_cmp_eq_u32 vcc, -1, v19
    s_nop 0
    s_cbranch_vccz go_611
    s_mov_b64 s[90:91], vcc
    s_waitcnt vmcnt(4)
    s_mov_b64 exec, s[90:91]
    buffer_load_dwordx4 v[32:35], v2, s[4:7], s16 offen offset:2048 sc1
    s_mov_b64 exec, s[92:93]
    buffer_load_dwordx4 v[36:39], v2, s[4:7], s16 offen offset:3072 sc1
    s_mov_b64 exec, -1
    s_add_u32 s23, s23, 1
    s_cmp_ge_u32 s23, 200000
    s_cselect_b32 s25, 200000, s25
    s_cbranch_scc1 go_611
    s_branch gl_610
go_611:
    v_mfma_f32_16x16x32_bf16 v[40:43], a[16:19], v[32:35], v[40:43]
    v_mfma_f32_16x16x32_bf16 v[44:47], a[20:23], v[32:35], v[44:47]
    v_mfma_f32_16x16x32_bf16 v[56:59], a[80:83], v[32:35], v[56:59]
    v_mfma_f32_16x16x32_bf16 v[60:63], a[84:87], v[32:35], v[60:63]
    v_mfma_f32_16x16x32_bf16 v[48:51], a[48:51], v[32:35], v[48:51]
    v_mfma_f32_16x16x32_bf16 v[52:55], a[52:55], v[32:35], v[52:55]
    v_mfma_f32_16x16x32_bf16 v[64:67], a[112:115], v[32:35], v[64:67]
    v_mfma_f32_16x16x32_bf16 v[68:71], a[116:119], v[32:35], v[68:71]
gd_609:
    s_cmp_eq_u64 s[92:93], 0
    s_cbranch_scc1 gd_612
gl_613:
    v_max3_u32 v19, v36, v37, v38
    v_max_u32 v19, v19, v39
    v_cmp_eq_u32 vcc, -1, v19
    s_nop 0
    s_cbranch_vccz go_614
    s_mov_b64 s[92:93], vcc
    s_waitcnt vmcnt(2)
    s_mov_b64 exec, s[92:93]
    buffer_load_dwordx4 v[36:39], v2, s[4:7], s16 offen offset:3072 sc1
    s_mov_b64 exec, -1
    s_add_u32 s23, s23, 1
    s_cmp_ge_u32 s23, 200000
    s_cselect_b32 s25, 200000, s25
    s_cbranch_scc1 go_614
    s_branch gl_613
go_614:
    v_mfma_f32_16x16x32_bf16 v[40:43], a[24:27], v[36:39], v[40:43]
    v_mfma_f32_16x16x32_bf16 v[44:47], a[28:31], v[36:39], v[44:47]
    v_mfma_f32_16x16x32_bf16 v[56:59], a[88:91], v[36:39], v[56:59]
    v_mfma_f32_16x16x32_bf16 v[60:63], a[92:95], v[36:39], v[60:63]
    v_mfma_f32_16x16x32_bf16 v[48:51], a[56:59], v[36:39], v[48:51]
    v_mfma_f32_16x16x32_bf16 v[52:55], a[60:63], v[36:39], v[52:55]
    v_mfma_f32_16x16x32_bf16 v[64:67], a[120:123], v[36:39], v[64:67]
    v_mfma_f32_16x16x32_bf16 v[68:71], a[124:127], v[36:39], v[68:71]
gd_612:
    s_branch gc_584
gs_587:
    s_mov_b64 s[90:91], vcc
    s_mov_b64 exec, s[90:91]
    buffer_load_dwordx4 v[32:35], v2, s[4:7], s16 offen offset:2048 sc1
    s_mov_b64 exec, -1
    s_waitcnt vmcnt(1)
    v_max3_u32 v19, v36, v37, v38
    v_max_u32 v19, v19, v39
    v_cmp_eq_u32 s[92:93], -1, v19
    s_nop 0
    s_mov_b64 exec, s[92:93]
    buffer_load_dwordx4 v[36:39], v2, s[4:7], s16 offen offset:3072 sc1
    s_mov_b64 exec, -1
    s_cmp_lg_u64 s[92:93], 0
    s_cbranch_scc1 gk_615
    v_mfma_f32_16x16x32_bf16 v[40:43], a[24:27], v[36:39], v[40:43]
    v_mfma_f32_16x16x32_bf16 v[44:47], a[28:31], v[36:39], v[44:47]
    v_mfma_f32_16x16x32_bf16 v[56:59], a[88:91], v[36:39], v[56:59]
    v_mfma_f32_16x16x32_bf16 v[60:63], a[92:95], v[36:39], v[60:63]
    v_mfma_f32_16x16x32_bf16 v[48:51], a[56:59], v[36:39], v[48:51]
    v_mfma_f32_16x16x32_bf16 v[52:55], a[60:63], v[36:39], v[52:55]
    v_mfma_f32_16x16x32_bf16 v[64:67], a[120:123], v[36:39], v[64:67]
    v_mfma_f32_16x16x32_bf16 v[68:71], a[124:127], v[36:39], v[68:71]
    s_mov_b64 exec, s[90:91]
    buffer_load_dwordx4 v[32:35], v2, s[4:7], s16 offen offset:2048 sc1
    s_mov_b64 exec, -1
gk_615:
gl_617:
    v_max3_u32 v19, v32, v33, v34
    v_max_u32 v19, v19, v35
    v_cmp_eq_u32 vcc, -1, v19
    s_nop 0
    s_cbranch_vccz go_618
    s_mov_b64 s[90:91], vcc
    s_waitcnt vmcnt(4)
    s_mov_b64 exec, s[90:91]
    buffer_load_dwordx4 v[32:35], v2, s[4:7], s16 offen offset:2048 sc1
    s_mov_b64 exec, s[92:93]
    buffer_load_dwordx4 v[36:39], v2, s[4:7], s16 offen offset:3072 sc1
    s_mov_b64 exec, -1
    s_add_u32 s23, s23, 1
    s_cmp_ge_u32 s23, 200000
    s_cselect_b32 s25, 200000, s25
    s_cbranch_scc1 go_618
    s_branch gl_617
go_618:
    v_mfma_f32_16x16x32_bf16 v[40:43], a[16:19], v[32:35], v[40:43]
    v_mfma_f32_16x16x32_bf16 v[44:47], a[20:23], v[32:35], v[44:47]
    v_mfma_f32_16x16x32_bf16 v[56:59], a[80:83], v[32:35], v[56:59]
    v_mfma_f32_16x16x32_bf16 v[60:63], a[84:87], v[32:35], v[60:63]
    v_mfma_f32_16x16x32_bf16 v[48:51], a[48:51], v[32:35], v[48:51]
    v_mfma_f32_16x16x32_bf16 v[52:55], a[52:55], v[32:35], v[52:55]
    v_mfma_f32_16x16x32_bf16 v[64:67], a[112:115], v[32:35], v[64:67]
    v_mfma_f32_16x16x32_bf16 v[68:71], a[116:119], v[32:35], v[68:71]
gd_616:
    s_cmp_eq_u64 s[92:93], 0
    s_cbranch_scc1 gd_619
gl_620:
    v_max3_u32 v19, v36, v37, v38
    v_max_u32 v19, v19, v39
    v_cmp_eq_u32 vcc, -1, v19
    s_nop 0
    s_cbranch_vccz go_621
    s_mov_b64 s[92:93], vcc
    s_waitcnt vmcnt(2)
    s_mov_b64 exec, s[92:93]
    buffer_load_dwordx4 v[36:39], v2, s[4:7], s16 offen offset:3072 sc1
    s_mov_b64 exec, -1
    s_add_u32 s23, s23, 1
    s_cmp_ge_u32 s23, 200000
    s_cselect_b32 s25, 200000, s25
    s_cbranch_scc1 go_621
    s_branch gl_620
go_621:
    v_mfma_f32_16x16x32_bf16 v[40:43], a[24:27], v[36:39], v[40:43]
    v_mfma_f32_16x16x32_bf16 v[44:47], a[28:31], v[36:39], v[44:47]
    v_mfma_f32_16x16x32_bf16 v[56:59], a[88:91], v[36:39], v[56:59]
    v_mfma_f32_16x16x32_bf16 v[60:63], a[92:95], v[36:39], v[60:63]
    v_mfma_f32_16x16x32_bf16 v[48:51], a[56:59], v[36:39], v[48:51]
    v_mfma_f32_16x16x32_bf16 v[52:55], a[60:63], v[36:39], v[52:55]
    v_mfma_f32_16x16x32_bf16 v[64:67], a[120:123], v[36:39], v[64:67]
    v_mfma_f32_16x16x32_bf16 v[68:71], a[124:127], v[36:39], v[68:71]
gd_619:
    s_branch gc_584
gs_588:
    s_mov_b64 s[92:93], vcc
    s_mov_b64 exec, s[92:93]
    buffer_load_dwordx4 v[36:39], v2, s[4:7], s16 offen offset:3072 sc1
    s_mov_b64 exec, -1
gl_623:
    v_max3_u32 v19, v36, v37, v38
    v_max_u32 v19, v19, v39
    v_cmp_eq_u32 vcc, -1, v19
    s_nop 0
    s_cbranch_vccz go_624
    s_mov_b64 s[92:93], vcc
    s_waitcnt vmcnt(2)
    s_mov_b64 exec, s[92:93]
    buffer_load_dwordx4 v[36:39], v2, s[4:7], s16 offen offset:3072 sc1
    s_mov_b64 exec, -1
    s_add_u32 s23, s23, 1
    s_cmp_ge_u32 s23, 200000
    s_cselect_b32 s25, 200000, s25
    s_cbranch_scc1 go_624
    s_branch gl_623
go_624:
    v_mfma_f32_16x16x32_bf16 v[40:43], a[24:27], v[36:39], v[40:43]
    v_mfma_f32_16x16x32_bf16 v[44:47], a[28:31], v[36:39], v[44:47]
    v_mfma_f32_16x16x32_bf16 v[56:59], a[88:91], v[36:39], v[56:59]
    v_mfma_f32_16x16x32_bf16 v[60:63], a[92:95], v[36:39], v[60:63]
    v_mfma_f32_16x16x32_bf16 v[48:51], a[56:59], v[36:39], v[48:51]
    v_mfma_f32_16x16x32_bf16 v[52:55], a[60:63], v[36:39], v[52:55]
    v_mfma_f32_16x16x32_bf16 v[64:67], a[120:123], v[36:39], v[64:67]
    v_mfma_f32_16x16x32_bf16 v[68:71], a[124:127], v[36:39], v[68:71]
gd_622:
    s_branch gc_584
recur_slow_last2:
    buffer_store_dword v168, v15, s[4:7], s20 offen offset:0 sc1
    buffer_store_dword v169, v15, s[4:7], s20 offen offset:64 sc1
    s_branch recur_end
gs_626:
    s_mov_b64 s[86:87], vcc
    s_mov_b64 exec, s[86:87]
    buffer_load_dwordx4 v[24:27], v8, s[4:7], s16 offen offset:0 sc1
    s_mov_b64 exec, -1
    s_waitcnt vmcnt(1)
    v_max3_u32 v19, v28, v29, v30
    v_max_u32 v19, v19, v31
    v_cmp_eq_u32 s[88:89], -1, v19
    v_max3_u32 v19, v32, v33, v34
    v_max_u32 v19, v19, v35
    v_cmp_eq_u32 s[90:91], -1, v19
    v_max3_u32 v19, v36, v37, v38
    v_max_u32 v19, v19, v39
    v_cmp_eq_u32 s[92:93], -1, v19
    s_mov_b64 exec, s[88:89]
    buffer_load_dwordx4 v[28:31], v8, s[4:7], s16 offen offset:1024 sc1
    s_mov_b64 exec, s[90:91]
    buffer_load_dwordx4 v[32:35], v8, s[4:7], s16 offen offset:2048 sc1
    s_mov_b64 exec, s[92:93]
    buffer_load_dwordx4 v[36:39], v8, s[4:7], s16 offen offset:3072 sc1
    s_mov_b64 exec, -1
    s_cmp_lg_u64 s[88:89], 0
    s_cbranch_scc1 gk_630
    v_mfma_f32_16x16x32_bf16 v[40:43], a[200:203], v[28:31], v[40:43]
    v_mfma_f32_16x16x32_bf16 v[44:47], a[204:207], v[28:31], v[44:47]
    v_mfma_f32_16x16x32_bf16 v[48:51], a[232:235], v[28:31], v[48:51]
    v_mfma_f32_16x16x32_bf16 v[52:55], a[236:239], v[28:31], v[52:55]
    s_mov_b64 exec, s[86:87]
    buffer_load_dwordx4 v[24:27], v8, s[4:7], s16 offen offset:0 sc1
    s_mov_b64 exec, s[90:91]
    buffer_load_dwordx4 v[32:35], v8, s[4:7], s16 offen offset:2048 sc1
    s_mov_b64 exec, s[92:93]
    buffer_load_dwordx4 v[36:39], v8, s[4:7], s16 offen offset:3072 sc1
    s_mov_b64 exec, -1
gk_630:
    s_cmp_lg_u64 s[90:91], 0
    s_cbranch_scc1 gk_631
    v_mfma_f32_16x16x32_bf16 v[40:43], a[208:211], v[32:35], v[40:43]
    v_mfma_f32_16x16x32_bf16 v[44:47], a[212:215], v[32:35], v[44:47]
    v_mfma_f32_16x16x32_bf16 v[48:51], a[240:243], v[32:35], v[48:51]
    v_mfma_f32_16x16x32_bf16 v[52:55], a[244:247], v[32:35], v[52:55]
    s_mov_b64 exec, s[86:87]
    buffer_load_dwordx4 v[24:27], v8, s[4:7], s16 offen offset:0 sc1
    s_mov_b64 exec, s[88:89]
    buffer_load_dwordx4 v[28:31], v8, s[4:7], s16 offen offset:1024 sc1
    s_mov_b64 exec, s[92:93]
    buffer_load_dwordx4 v[36:39], v8, s[4:7], s16 offen offset:3072 sc1
    s_mov_b64 exec, -1
gk_631:
    s_cmp_lg_u64 s[92:93], 0
    s_cbranch_scc1 gk_632
    v_mfma_f32_16x16x32_bf16 v[40:43], a[216:219], v[36:39], v[40:43]
    v_mfma_f32_16x16x32_bf16 v[44:47], a[220:223], v[36:39], v[44:47]
    v_mfma_f32_16x16x32_bf16 v[48:51], a[248:251], v[36:39], v[48:51]
    v_mfma_f32_16x16x32_bf16 v[52:55], a[252:255], v[36:39], v[52:55]
    s_mov_b64 exec, s[86:87]
    buffer_load_dwordx4 v[24:27], v8, s[4:7], s16 offen offset:0 sc1
    s_mov_b64 exec, s[88:89]
    buffer_load_dwordx4 v[28:31], v8, s[4:7], s16 offen offset:1024 sc1
    s_mov_b64 exec, s[90:91]
    buffer_load_dwordx4 v[32:35], v8, s[4:7], s16 offen offset:2048 sc1
    s_mov_b64 exec, -1
gk_632:
gl_634:
    v_max3_u32 v19, v24, v25, v26
    v_max_u32 v19, v19, v27
    v_cmp_eq_u32 vcc, -1, v19
    s_nop 0
    s_cbranch_vccz go_635
    s_mov_b64 s[86:87], vcc
    s_waitcnt vmcnt(8)
    s_mov_b64 exec, s[86:87]
    buffer_load_dwordx4 v[24:27], v8, s[4:7], s16 offen offset:0 sc1
    s_mov_b64 exec, s[88:89]
    buffer_load_dwordx4 v[28:31], v8, s[4:7], s16 offen offset:1024 sc1
    s_mov_b64 exec, s[90:91]
    buffer_load_dwordx4 v[32:35], v8, s[4:7], s16 offen offset:2048 sc1
    s_mov_b64 exec, s[92:93]
    buffer_load_dwordx4 v[36:39], v8, s[4:7], s16 offen offset:3072 sc1
    s_mov_b64 exec, -1
    s_add_u32 s23, s23, 1
    s_cmp_ge_u32 s23, 200000
    s_cselect_b32 s25, 200000, s25
    s_cbranch_scc1 go_635
    s_branch gl_634
go_635:
    v_mfma_f32_16x16x32_bf16 v[40:43], a[192:195], v[24:27], v[40:43]
    v_mfma_f32_16x16x32_bf16 v[44:47], a[196:199], v[24:27], v[44:47]
    v_mfma_f32_16x16x32_bf16 v[48:51], a[224:227], v[24:27], v[48:51]
    v_mfma_f32_16x16x32_bf16 v[52:55], a[228:231], v[24:27], v[52:55]
gd_633:
    s_cmp_eq_u64 s[88:89], 0
    s_cbranch_scc1 gd_636
gl_637:
    v_max3_u32 v19, v28, v29, v30
    v_max_u32 v19, v19, v31
    v_cmp_eq_u32 vcc, -1, v19
    s_nop 0
    s_cbranch_vccz go_638
    s_mov_b64 s[88:89], vcc
    s_waitcnt vmcnt(6)
    s_mov_b64 exec, s[88:89]
    buffer_load_dwordx4 v[28:31], v8, s[4:7], s16 offen offset:1024 sc1
    s_mov_b64 exec, s[90:91]
    buffer_load_dwordx4 v[32:35], v8, s[4:7], s16 offen offset:2048 sc1
    s_mov_b64 exec, s[92:93]
    buffer_load_dwordx4 v[36:39], v8, s[4:7], s16 offen offset:3072 sc1
    s_mov_b64 exec, -1
    s_add_u32 s23, s23, 1
    s_cmp_ge_u32 s23, 200000
    s_cselect_b32 s25, 200000, s25
    s_cbranch_scc1 go_638
    s_branch gl_637
go_638:
    v_mfma_f32_16x16x32_bf16 v[40:43], a[200:203], v[28:31], v[40:43]
    v_mfma_f32_16x16x32_bf16 v[44:47], a[204:207], v[28:31], v[44:47]
    v_mfma_f32_16x16x32_bf16 v[48:51], a[232:235], v[28:31], v[48:51]
    v_mfma_f32_16x16x32_bf16 v[52:55], a[236:239], v[28:31], v[52:55]
gd_636:
    s_cmp_eq_u64 s[90:91], 0
    s_cbranch_scc1 gd_639
gl_640:
    v_max3_u32 v19, v32, v33, v34
    v_max_u32 v19, v19, v35
    v_cmp_eq_u32 vcc, -1, v19
    s_nop 0
    s_cbranch_vccz go_641
    s_mov_b64 s[90:91], vcc
    s_waitcnt vmcnt(4)
    s_mov_b64 exec, s[90:91]
    buffer_load_dwordx4 v[32:35], v8, s[4:7], s16 offen offset:2048 sc1
    s_mov_b64 exec, s[92:93]
    buffer_load_dwordx4 v[36:39], v8, s[4:7], s16 offen offset:3072 sc1
    s_mov_b64 exec, -1
    s_add_u32 s23, s23, 1
    s_cmp_ge_u32 s23, 200000
    s_cselect_b32 s25, 200000, s25
    s_cbranch_scc1 go_641
    s_branch gl_640
go_641:
    v_mfma_f32_16x16x32_bf16 v[40:43], a[208:211], v[32:35], v[40:43]
    v_mfma_f32_16x16x32_bf16 v[44:47], a[212:215], v[32:35], v[44:47]
    v_mfma_f32_16x16x32_bf16 v[48:51], a[240:243], v[32:35], v[48:51]
    v_mfma_f32_16x16x32_bf16 v[52:55], a[244:247], v[32:35], v[52:55]
gd_639:
    s_cmp_eq_u64 s[92:93], 0
    s_cbranch_scc1 gd_642
gl_643:
    v_max3_u32 v19, v36, v37, v38
    v_max_u32 v19, v19, v39
    v_cmp_eq_u32 vcc, -1, v19
    s_nop 0
    s_cbranch_vccz go_644
    s_mov_b64 s[92:93], vcc
    s_waitcnt vmcnt(2)
    s_mov_b64 exec, s[92:93]
    buffer_load_dwordx4 v[36:39], v8, s[4:7], s16 offen offset:3072 sc1
    s_mov_b64 exec, -1
    s_add_u32 s23, s23, 1
    s_cmp_ge_u32 s23, 200000
    s_cselect_b32 s25, 200000, s25
    s_cbranch_scc1 go_644
    s_branch gl_643
go_644:
    v_mfma_f32_16x16x32_bf16 v[40:43], a[216:219], v[36:39], v[40:43]
    v_mfma_f32_16x16x32_bf16 v[44:47], a[220:223], v[36:39], v[44:47]
    v_mfma_f32_16x16x32_bf16 v[48:51], a[248:251], v[36:39], v[48:51]
    v_mfma_f32_16x16x32_bf16 v[52:55], a[252:255], v[36:39], v[52:55]
gd_642:
    s_branch gc_625
gs_627:
    s_mov_b64 s[88:89], vcc
    s_mov_b64 exec, s[88:89]
    buffer_load_dwordx4 v[28:31], v8, s[4:7], s16 offen offset:1024 sc1
    s_mov_b64 exec, -1
    s_waitcnt vmcnt(1)
    v_max3_u32 v19, v32, v33, v34
    v_max_u32 v19, v19, v35
    v_cmp_eq_u32 s[90:91], -1, v19
    v_max3_u32 v19, v36, v37, v38
    v_max_u32 v19, v19, v39
    v_cmp_eq_u32 s[92:93], -1, v19
    s_mov_b64 exec, s[90:91]
    buffer_load_dwordx4 v[32:35], v8, s[4:7], s16 offen offset:2048 sc1
    s_mov_b64 exec, s[92:93]
    buffer_load_dwordx4 v[36:39], v8, s[4:7], s16 offen offset:3072 sc1
    s_mov_b64 exec, -1
    s_cmp_lg_u64 s[90:91], 0
    s_cbranch_scc1 gk_645
    v_mfma_f32_16x16x32_bf16 v[40:43], a[208:211], v[32:35], v[40:43]
    v_mfma_f32_16x16x32_bf16 v[44:47], a[212:215], v[32:35], v[44:47]
    v_mfma_f32_16x16x32_bf16 v[48:51], a[240:243], v[32:35], v[48:51]
    v_mfma_f32_16x16x32_bf16 v[52:55], a[244:247], v[32:35], v[52:55]
    s_mov_b64 exec, s[88:89]
    buffer_load_dwordx4 v[28:31], v8, s[4:7], s16 offen offset:1024 sc1
    s_mov_b64 exec, s[92:93]
    buffer_load_dwordx4 v[36:39], v8, s[4:7], s16 offen offset:3072 sc1
    s_mov_b64 exec, -1
gk_645:
    s_cmp_lg_u64 s[92:93], 0
    s_cbranch_scc1 gk_646
    v_mfma_f32_16x16x32_bf16 v[40:43], a[216:219], v[36:39], v[40:43]
    v_mfma_f32_16x16x32_bf16 v[44:47], a[220:223], v[36:39], v[44:47]
    v_mfma_f32_16x16x32_bf16 v[48:51], a[248:251], v[36:39], v[48:51]
    v_mfma_f32_16x16x32_bf16 v[52:55], a[252:255], v[36:39], v[52:55]
    s_mov_b64 exec, s[88:89]
    buffer_load_dwordx4 v[28:31], v8, s[4:7], s16 offen offset:1024 sc1
    s_mov_b64 exec, s[90:91]
    buffer_load_dwordx4 v[32:35], v8, s[4:7], s16 offen offset:2048 sc1
    s_mov_b64 exec, -1
gk_646:
gl_648:
    v_max3_u32 v19, v28, v29, v30
    v_max_u32 v19, v19, v31
    v_cmp_eq_u32 vcc, -1, v19
    s_nop 0
    s_cbranch_vccz go_649
    s_mov_b64 s[88:89], vcc
    s_waitcnt vmcnt(6)
    s_mov_b64 exec, s[88:89]
    buffer_load_dwordx4 v[28:31], v8, s[4:7], s16 offen offset:1024 sc1
    s_mov_b64 exec, s[90:91]
    buffer_load_dwordx4 v[32:35], v8, s[4:7], s16 offen offset:2048 sc1
    s_mov_b64 exec, s[92:93]
    buffer_load_dwordx4 v[36:39], v8, s[4:7], s16 offen offset:3072 sc1
    s_mov_b64 exec, -1
    s_add_u32 s23, s23, 1
    s_cmp_ge_u32 s23, 200000
    s_cselect_b32 s25, 200000, s25
    s_cbranch_scc1 go_649
    s_branch gl_648
go_649:
    v_mfma_f32_16x16x32_bf16 v[40:43], a[200:203], v[28:31], v[40:43]
    v_mfma_f32_16x16x32_bf16 v[44:47], a[204:207], v[28:31], v[44:47]
    v_mfma_f32_16x16x32_bf16 v[48:51], a[232:235], v[28:31], v[48:51]
    v_mfma_f32_16x16x32_bf16 v[52:55], a[236:239], v[28:31], v[52:55]
gd_647:
    s_cmp_eq_u64 s[90:91], 0
    s_cbranch_scc1 gd_650
gl_651:
    v_max3_u32 v19, v32, v33, v34
    v_max_u32 v19, v19, v35
    v_cmp_eq_u32 vcc, -1, v19
    s_nop 0
    s_cbranch_vccz go_652
    s_mov_b64 s[90:91], vcc
    s_waitcnt vmcnt(4)
    s_mov_b64 exec, s[90:91]
    buffer_load_dwordx4 v[32:35], v8, s[4:7], s16 offen offset:2048 sc1
    s_mov_b64 exec, s[92:93]
    buffer_load_dwordx4 v[36:39], v8, s[4:7], s16 offen offset:3072 sc1
    s_mov_b64 exec, -1
    s_add_u32 s23, s23, 1
    s_cmp_ge_u32 s23, 200000
    s_cselect_b32 s25, 200000, s25
    s_cbranch_scc1 go_652
    s_branch gl_651
go_652:
    v_mfma_f32_16x16x32_bf16 v[40:43], a[208:211], v[32:35], v[40:43]
    v_mfma_f32_16x16x32_bf16 v[44:47], a[212:215], v[32:35], v[44:47]
    v_mfma_f32_16x16x32_bf16 v[48:51], a[240:243], v[32:35], v[48:51]
    v_mfma_f32_16x16x32_bf16 v[52:55], a[244:247], v[32:35], v[52:55]
gd_650:
    s_cmp_eq_u64 s[92:93], 0
    s_cbranch_scc1 gd_653
gl_654:
    v_max3_u32 v19, v36, v37, v38
    v_max_u32 v19, v19, v39
    v_cmp_eq_u32 vcc, -1, v19
    s_nop 0
    s_cbranch_vccz go_655
    s_mov_b64 s[92:93], vcc
    s_waitcnt vmcnt(2)
    s_mov_b64 exec, s[92:93]
    buffer_load_dwordx4 v[36:39], v8, s[4:7], s16 offen offset:3072 sc1
    s_mov_b64 exec, -1
    s_add_u32 s23, s23, 1
    s_cmp_ge_u32 s23, 200000
    s_cselect_b32 s25, 200000, s25
    s_cbranch_scc1 go_655
    s_branch gl_654
go_655:
    v_mfma_f32_16x16x32_bf16 v[40:43], a[216:219], v[36:39], v[40:43]
    v_mfma_f32_16x16x32_bf16 v[44:47], a[220:223], v[36:39], v[44:47]
    v_mfma_f32_16x16x32_bf16 v[48:51], a[248:251], v[36:39], v[48:51]
    v_mfma_f32_16x16x32_bf16 v[52:55], a[252:255], v[36:39], v[52:55]
gd_653:
    s_branch gc_625
gs_628:
    s_mov_b64 s[90:91], vcc
    s_mov_b64 exec, s[90:91]
    buffer_load_dwordx4 v[32:35], v8, s[4:7], s16 offen offset:2048 sc1
    s_mov_b64 exec, -1
    s_waitcnt vmcnt(1)
    v_max3_u32 v19, v36, v37, v38
    v_max_u32 v19, v19, v39
    v_cmp_eq_u32 s[92:93], -1, v19
    s_nop 0
    s_mov_b64 exec, s[92:93]
    buffer_load_dwordx4 v[36:39], v8, s[4:7], s16 offen offset:3072 sc1
    s_mov_b64 exec, -1
    s_cmp_lg_u64 s[92:93], 0
    s_cbranch_scc1 gk_656
    v_mfma_f32_16x16x32_bf16 v[40:43], a[216:219], v[36:39], v[40:43]
    v_mfma_f32_16x16x32_bf16 v[44:47], a[220:223], v[36:39], v[44:47]
    v_mfma_f32_16x16x32_bf16 v[48:51], a[248:251], v[36:39], v[48:51]
    v_mfma_f32_16x16x32_bf16 v[52:55], a[252:255], v[36:39], v[52:55]
    s_mov_b64 exec, s[90:91]
    buffer_load_dwordx4 v[32:35], v8, s[4:7], s16 offen offset:2048 sc1
    s_mov_b64 exec, -1
gk_656:
gl_658:
    v_max3_u32 v19, v32, v33, v34
    v_max_u32 v19, v19, v35
    v_cmp_eq_u32 vcc, -1, v19
    s_nop 0
    s_cbranch_vccz go_659
    s_mov_b64 s[90:91], vcc
    s_waitcnt vmcnt(4)
    s_mov_b64 exec, s[90:91]
    buffer_load_dwordx4 v[32:35], v8, s[4:7], s16 offen offset:2048 sc1
    s_mov_b64 exec, s[92:93]
    buffer_load_dwordx4 v[36:39], v8, s[4:7], s16 offen offset:3072 sc1
    s_mov_b64 exec, -1
    s_add_u32 s23, s23, 1
    s_cmp_ge_u32 s23, 200000
    s_cselect_b32 s25, 200000, s25
    s_cbranch_scc1 go_659
    s_branch gl_658
go_659:
    v_mfma_f32_16x16x32_bf16 v[40:43], a[208:211], v[32:35], v[40:43]
    v_mfma_f32_16x16x32_bf16 v[44:47], a[212:215], v[32:35], v[44:47]
    v_mfma_f32_16x16x32_bf16 v[48:51], a[240:243], v[32:35], v[48:51]
    v_mfma_f32_16x16x32_bf16 v[52:55], a[244:247], v[32:35], v[52:55]
gd_657:
    s_cmp_eq_u64 s[92:93], 0
    s_cbranch_scc1 gd_660
gl_661:
    v_max3_u32 v19, v36, v37, v38
    v_max_u32 v19, v19, v39
    v_cmp_eq_u32 vcc, -1, v19
    s_nop 0
    s_cbranch_vccz go_662
    s_mov_b64 s[92:93], vcc
    s_waitcnt vmcnt(2)
    s_mov_b64 exec, s[92:93]
    buffer_load_dwordx4 v[36:39], v8, s[4:7], s16 offen offset:3072 sc1
    s_mov_b64 exec, -1
    s_add_u32 s23, s23, 1
    s_cmp_ge_u32 s23, 200000
    s_cselect_b32 s25, 200000, s25
    s_cbranch_scc1 go_662
    s_branch gl_661
go_662:
    v_mfma_f32_16x16x32_bf16 v[40:43], a[216:219], v[36:39], v[40:43]
    v_mfma_f32_16x16x32_bf16 v[44:47], a[220:223], v[36:39], v[44:47]
    v_mfma_f32_16x16x32_bf16 v[48:51], a[248:251], v[36:39], v[48:51]
    v_mfma_f32_16x16x32_bf16 v[52:55], a[252:255], v[36:39], v[52:55]
gd_660:
    s_branch gc_625
gs_629:
    s_mov_b64 s[92:93], vcc
    s_mov_b64 exec, s[92:93]
    buffer_load_dwordx4 v[36:39], v8, s[4:7], s16 offen offset:3072 sc1
    s_mov_b64 exec, -1
gl_664:
    v_max3_u32 v19, v36, v37, v38
    v_max_u32 v19, v19, v39
    v_cmp_eq_u32 vcc, -1, v19
    s_nop 0
    s_cbranch_vccz go_665
    s_mov_b64 s[92:93], vcc
    s_waitcnt vmcnt(2)
    s_mov_b64 exec, s[92:93]
    buffer_load_dwordx4 v[36:39], v8, s[4:7], s16 offen offset:3072 sc1
    s_mov_b64 exec, -1
    s_add_u32 s23, s23, 1
    s_cmp_ge_u32 s23, 200000
    s_cselect_b32 s25, 200000, s25
    s_cbranch_scc1 go_665
    s_branch gl_664
go_665:
    v_mfma_f32_16x16x32_bf16 v[40:43], a[216:219], v[36:39], v[40:43]
    v_mfma_f32_16x16x32_bf16 v[44:47], a[220:223], v[36:39], v[44:47]
    v_mfma_f32_16x16x32_bf16 v[48:51], a[248:251], v[36:39], v[48:51]
    v_mfma_f32_16x16x32_bf16 v[52:55], a[252:255], v[36:39], v[52:55]
gd_663:
    s_branch gc_625
.p2align 6
recur_slow_w3:
    s_nop 11
    s_mov_b32 s23, s25
    buffer_load_dwordx4 v[24:27], v2, s[4:7], s16 offen offset:0 sc1
    buffer_load_dwordx4 v[28:31], v2, s[4:7], s16 offen offset:1024 sc1
    buffer_load_dwordx4 v[32:35], v2, s[4:7], s16 offen offset:2048 sc1
    buffer_load_dwordx4 v[36:39], v2, s[4:7], s16 offen offset:3072 sc1
    s_waitcnt vmcnt(3)
    v_max3_u32 v19, v24, v25, v26
    v_max_u32 v19, v19, v27
    v_cmp_eq_u32 vcc, -1, v19
    s_nop 0
    s_cbranch_vccnz gs_667
    v_mfma_f32_16x16x32_bf16 v[40:43], a[0:3], v[24:27], v[40:43]
    v_mfma_f32_16x16x32_bf16 v[44:47], a[4:7], v[24:27], v[44:47]
    v_mfma_f32_16x16x32_bf16 v[56:59], a[64:67], v[24:27], v[56:59]
    v_mfma_f32_16x16x32_bf16 v[60:63], a[68:71], v[24:27], v[60:63]
    v_mfma_f32_16x16x32_bf16 v[48:51], a[32:35], v[24:27], v[48:51]
    s_waitcnt vmcnt(2)
    v_max3_u32 v19, v28, v29, v30
    v_mfma_f32_16x16x32_bf16 v[52:55], a[36:39], v[24:27], v[52:55]
    v_max_u32 v19, v19, v31
    v_mfma_f32_16x16x32_bf16 v[64:67], a[96:99], v[24:27], v[64:67]
    v_cmp_eq_u32 vcc, -1, v19
    v_mfma_f32_16x16x32_bf16 v[68:71], a[100:103], v[24:27], v[68:71]
    s_cbranch_vccnz gs_668
    v_mfma_f32_16x16x32_bf16 v[40:43], a[8:11], v[28:31], v[40:43]
    v_mfma_f32_16x16x32_bf16 v[44:47], a[12:15], v[28:31], v[44:47]
    v_mfma_f32_16x16x32_bf16 v[56:59], a[72:75], v[28:31], v[56:59]
    v_mfma_f32_16x16x32_bf16 v[60:63], a[76:79], v[28:31], v[60:63]
    v_mfma_f32_16x16x32_bf16 v[48:51], a[40:43], v[28:31], v[48:51]
    s_waitcnt vmcnt(1)
    v_max3_u32 v19, v32, v33, v34
    v_mfma_f32_16x16x32_bf16 v[52:55], a[44:47], v[28:31], v[52:55]
    v_max_u32 v19, v19, v35
    v_mfma_f32_16x16x32_bf16 v[64:67], a[104:107], v[28:31], v[64:67]
    v_cmp_eq_u32 vcc, -1, v19
    v_mfma_f32_16x16x32_bf16 v[68:71], a[108:111], v[28:31], v[68:71]
    s_cbranch_vccnz gs_669
    v_mfma_f32_16x16x32_bf16 v[40:43], a[16:19], v[32:35], v[40:43]
    v_mfma_f32_16x16x32_bf16 v[44:47], a[20:23], v[32:35], v[44:47]
    v_mfma_f32_16x16x32_bf16 v[56:59], a[80:83], v[32:35], v[56:59]
    v_mfma_f32_16x16x32_bf16 v[60:63], a[84:87], v[32:35], v[60:63]
    v_mfma_f32_16x16x32_bf16 v[48:51], a[48:51], v[32:35], v[48:51]
    s_waitcnt vmcnt(0)
    v_max3_u32 v19, v36, v37, v38
    v_mfma_f32_16x16x32_bf16 v[52:55], a[52:55], v[32:35], v[52:55]
    v_max_u32 v19, v19, v39
    v_mfma_f32_16x16x32_bf16 v[64:67], a[112:115], v[32:35], v[64:67]
    v_cmp_eq_u32 vcc, -1, v19
    v_mfma_f32_16x16x32_bf16 v[68:71], a[116:119], v[32:35], v[68:71]
    s_cbranch_vccnz gs_670
    v_mfma_f32_16x16x32_bf16 v[40:43], a[24:27], v[36:39], v[40:43]
    v_mfma_f32_16x16x32_bf16 v[44:47], a[28:31], v[36:39], v[44:47]
    v_mfma_f32_16x16x32_bf16 v[56:59], a[88:91], v[36:39], v[56:59]
    v_mfma_f32_16x16x32_bf16 v[60:63], a[92:95], v[36:39], v[60:63]
    v_mfma_f32_16x16x32_bf16 v[48:51], a[56:59], v[36:39], v[48:51]
    v_mfma_f32_16x16x32_bf16 v[52:55], a[60:63], v[36:39], v[52:55]
    v_mfma_f32_16x16x32_bf16 v[64:67], a[120:123], v[36:39], v[64:67]
    v_mfma_f32_16x16x32_bf16 v[68:71], a[124:127], v[36:39], v[68:71]
gc_666:
    s_nop 1
    v_add_f32_dpp v88, v44, v40 row_ror:8 row_mask:0xf bank_mask:0x3
    v_add_f32_dpp v89, v45, v41 row_ror:8 row_mask:0xf bank_mask:0x3
    v_add_f32_dpp v90, v46, v42 row_ror:8 row_mask:0xf bank_mask:0x3
    v_add_f32_dpp v91, v47, v43 row_ror:8 row_mask:0xf bank_mask:0x3
    v_add_f32_dpp v88, v56, v60 row_ror:8 row_mask:0xf bank_mask:0xc
    v_add_f32_dpp v89, v57, v61 row_ror:8 row_mask:0xf bank_mask:0xc
    v_add_f32_dpp v90, v58, v62 row_ror:8 row_mask:0xf bank_mask:0xc
    v_add_f32_dpp v91, v59, v63 row_ror:8 row_mask:0xf bank_mask:0xc
    ds_write_b128 v17, v[88:91] offset:0
    v_add_f32_dpp v92, v52, v48 row_ror:8 row_mask:0xf bank_mask:0x3
    v_add_f32_dpp v93, v53, v49 row_ror:8 row_mask:0xf bank_mask:0x3
    v_add_f32_dpp v94, v54, v50 row_ror:8 row_mask:0xf bank_mask:0x3
    v_add_f32_dpp v95, v55, v51 row_ror:8 row_mask:0xf bank_mask:0x3
    v_mfma_f32_16x16x32_bf16 v[72:75], v[24:27], a[128:131], 0
    v_add_f32_dpp v92, v64, v68 row_ror:8 row_mask:0xf bank_mask:0xc
    v_add_f32_dpp v93, v65, v69 row_ror:8 row_mask:0xf bank_mask:0xc
    v_add_f32_dpp v94, v66, v70 row_ror:8 row_mask:0xf bank_mask:0xc
    v_add_f32_dpp v95, v67, v71 row_ror:8 row_mask:0xf bank_mask:0xc
    v_mfma_f32_16x16x32_bf16 v[80:83], v[24:27], a[160:163], 0
    ds_write_b128 v17, v[92:95] offset:1024
    v_mfma_f32_16x16x32_bf16 v[76:79], v[24:27], a[132:135], 0
    v_mfma_f32_16x16x32_bf16 v[84:87], v[24:27], a[164:167], 0
    s_waitcnt lgkmcnt(0)
    s_barrier
    v_mfma_f32_16x16x32_bf16 v[72:75], v[28:31], a[136:139], v[72:75]
    v_mfma_f32_16x16x32_bf16 v[80:83], v[28:31], a[168:171], v[80:83]
    v_mfma_f32_16x16x32_bf16 v[76:79], v[28:31], a[140:143], v[76:79]
    v_mfma_f32_16x16x32_bf16 v[84:87], v[28:31], a[172:175], v[84:87]
    v_mfma_f32_16x16x32_bf16 v[72:75], v[32:35], a[144:147], v[72:75]
    v_mfma_f32_16x16x32_bf16 v[80:83], v[32:35], a[176:179], v[80:83]
    v_mfma_f32_16x16x32_bf16 v[76:79], v[32:35], a[148:151], v[76:79]
    v_mfma_f32_16x16x32_bf16 v[84:87], v[32:35], a[180:183], v[84:87]
    v_mfma_f32_16x16x32_bf16 v[72:75], v[36:39], a[152:155], v[72:75]
    v_mfma_f32_16x16x32_bf16 v[80:83], v[36:39], a[184:187], v[80:83]
    v_mfma_f32_16x16x32_bf16 v[76:79], v[36:39], a[156:159], v[76:79]
    v_mfma_f32_16x16x32_bf16 v[84:87], v[36:39], a[188:191], v[84:87]
    s_nop 6
    v_mov_b32_dpp v72, v76 quad_perm:[0,1,2,3] row_mask:0xc bank_mask:0xf
    v_mov_b32_dpp v73, v77 quad_perm:[0,1,2,3] row_mask:0xc bank_mask:0xf
    v_mov_b32_dpp v74, v78 quad_perm:[0,1,2,3] row_mask:0xc bank_mask:0xf
    v_mov_b32_dpp v75, v79 quad_perm:[0,1,2,3] row_mask:0xc bank_mask:0xf
    ds_write_b128 v17, v[72:75] offset:8192
    v_mov_b32_dpp v80, v84 quad_perm:[0,1,2,3] row_mask:0xc bank_mask:0xf
    v_mov_b32_dpp v81, v85 quad_perm:[0,1,2,3] row_mask:0xc bank_mask:0xf
    v_mov_b32_dpp v82, v86 quad_perm:[0,1,2,3] row_mask:0xc bank_mask:0xf
    v_mov_b32_dpp v83, v87 quad_perm:[0,1,2,3] row_mask:0xc bank_mask:0xf
    ds_write_b128 v17, v[80:83] offset:9216
    v_mov_b32 v40, 0
    v_mov_b32 v41, 0
    v_mov_b32 v42, 0
    v_mov_b32 v43, 0
    v_mov_b32 v44, 0
    v_mov_b32 v45, 0
    v_mov_b32 v46, 0
    v_mov_b32 v47, 0
    v_mov_b32 v48, 0
    v_mov_b32 v49, 0
    v_mov_b32 v50, 0
    v_mov_b32 v51, 0
    v_mov_b32 v52, 0
    v_mov_b32 v53, 0
    v_mov_b32 v54, 0
    v_mov_b32 v55, 0
    s_waitcnt lgkmcnt(0)
    s_barrier
    s_cmp_eq_u32 s15, 63
    s_cbranch_scc1 recur_end
    s_sleep 2
    buffer_store_dwordx4 v[204:207], v3, s[4:7], s43 offen sc1
    buffer_store_dwordx4 v[204:207], v3, s[4:7], s43 offen offset:128 sc1
    buffer_store_dwordx4 v[204:207], v4, s[4:7], s43 offen sc1
    buffer_store_dwordx2 v[204:205], v7, s[4:7], s43 offen sc1
    buffer_store_dwordx2 v[204:205], v11, s[4:7], s43 offen sc1
    s_barrier
    s_sleep 7
    s_nop 12
    s_mov_b32 s23, s25
    buffer_load_dwordx4 v[24:27], v8, s[4:7], s16 offen offset:0 sc1
    buffer_load_dwordx4 v[28:31], v8, s[4:7], s16 offen offset:1024 sc1
    buffer_load_dwordx4 v[32:35], v8, s[4:7], s16 offen offset:2048 sc1
    buffer_load_dwordx4 v[36:39], v8, s[4:7], s16 offen offset:3072 sc1
    s_waitcnt vmcnt(3)
    v_max3_u32 v19, v24, v25, v26
    v_max_u32 v19, v19, v27
    v_cmp_eq_u32 vcc, -1, v19
    s_nop 0
    s_cbranch_vccnz gs_708
    v_mfma_f32_16x16x32_bf16 v[40:43], a[192:195], v[24:27], v[40:43]
    s_waitcnt vmcnt(2)
    v_max3_u32 v19, v28, v29, v30
    v_mfma_f32_16x16x32_bf16 v[44:47], a[196:199], v[24:27], v[44:47]
    v_max_u32 v19, v19, v31
    v_mfma_f32_16x16x32_bf16 v[48:51], a[224:227], v[24:27], v[48:51]
    v_cmp_eq_u32 vcc, -1, v19
    v_mfma_f32_16x16x32_bf16 v[52:55], a[228:231], v[24:27], v[52:55]
    s_cbranch_vccnz gs_709
    v_mfma_f32_16x16x32_bf16 v[40:43], a[200:203], v[28:31], v[40:43]
    s_waitcnt vmcnt(1)
    v_max3_u32 v19, v32, v33, v34
    v_mfma_f32_16x16x32_bf16 v[44:47], a[204:207], v[28:31], v[44:47]
    v_max_u32 v19, v19, v35
    v_mfma_f32_16x16x32_bf16 v[48:51], a[232:235], v[28:31], v[48:51]
    v_cmp_eq_u32 vcc, -1, v19
    v_mfma_f32_16x16x32_bf16 v[52:55], a[236:239], v[28:31], v[52:55]
    s_cbranch_vccnz gs_710
    v_mfma_f32_16x16x32_bf16 v[40:43], a[208:211], v[32:35], v[40:43]
    s_waitcnt vmcnt(0)
    v_max3_u32 v19, v36, v37, v38
    v_mfma_f32_16x16x32_bf16 v[44:47], a[212:215], v[32:35], v[44:47]
    v_max_u32 v19, v19, v39
    v_mfma_f32_16x16x32_bf16 v[48:51], a[240:243], v[32:35], v[48:51]
    v_cmp_eq_u32 vcc, -1, v19
    v_mfma_f32_16x16x32_bf16 v[52:55], a[244:247], v[32:35], v[52:55]
    s_cbranch_vccnz gs_711
    v_mfma_f32_16x16x32_bf16 v[40:43], a[216:219], v[36:39], v[40:43]
    v_mfma_f32_16x16x32_bf16 v[44:47], a[220:223], v[36:39], v[44:47]
    v_mfma_f32_16x16x32_bf16 v[48:51], a[248:251], v[36:39], v[48:51]
    v_mfma_f32_16x16x32_bf16 v[52:55], a[252:255], v[36:39], v[52:55]
gc_707:
    s_nop 5
    v_add_f32_dpp v88, v44, v40 row_ror:8 row_mask:0xf bank_mask:0x3
    v_add_f32_dpp v89, v45, v41 row_ror:8 row_mask:0xf bank_mask:0x3
    v_add_f32_dpp v90, v46, v42 row_ror:8 row_mask:0xf bank_mask:0x3
    v_add_f32_dpp v91, v47, v43 row_ror:8 row_mask:0xf bank_mask:0x3
    v_add_f32_dpp v88, v48, v52 row_ror:8 row_mask:0xf bank_mask:0xc
    v_add_f32_dpp v89, v49, v53 row_ror:8 row_mask:0xf bank_mask:0xc
    v_add_f32_dpp v90, v50, v54 row_ror:8 row_mask:0xf bank_mask:0xc
    v_add_f32_dpp v91, v51, v55 row_ror:8 row_mask:0xf bank_mask:0xc
    s_barrier
    ds_read_b128 v[96:99], v16 offset:16384
    ds_read_b128 v[100:103], v16 offset:18432
    ds_read_b128 v[104:107], v16 offset:20480
    s_waitcnt lgkmcnt(1)
    v_add_f32 v96, v96, v100
    v_add_f32 v97, v97, v101
    v_add_f32 v98, v98, v102
    v_add_f32 v99, v99, v103
    s_waitcnt lgkmcnt(0)
    v_add_f32 v104, v104, v88
    v_add_f32 v105, v105, v89
    v_add_f32 v106, v106, v90
    v_add_f32 v107, v107, v91
    v_add_f32 v88, v96, v104
    v_add_f32 v89, v97, v105
    v_add_f32 v90, v98, v106
    v_add_f32 v91, v99, v107
    buffer_store_dwordx4 v[88:91], v9, s[4:7], s84 offen sc1
    s_add_u32 s22, s84, 131072
    buffer_store_dwordx4 v[88:91], v9, s[4:7], s22 offen sc1
    v_mov_b32 v40, 0
    v_mov_b32 v41, 0
    v_mov_b32 v42, 0
    v_mov_b32 v43, 0
    v_mov_b32 v44, 0
    v_mov_b32 v45, 0
    v_mov_b32 v46, 0
    v_mov_b32 v47, 0
    v_mov_b32 v48, 0
    v_mov_b32 v49, 0
    v_mov_b32 v50, 0
    v_mov_b32 v51, 0
    v_mov_b32 v52, 0
    v_mov_b32 v53, 0
    v_mov_b32 v54, 0
    v_mov_b32 v55, 0
    v_mov_b32 v56, 0
    v_mov_b32 v57, 0
    v_mov_b32 v58, 0
    v_mov_b32 v59, 0
    v_mov_b32 v60, 0
    v_mov_b32 v61, 0
    v_mov_b32 v62, 0
    v_mov_b32 v63, 0
    v_mov_b32 v64, 0
    v_mov_b32 v65, 0
    v_mov_b32 v66, 0
    v_mov_b32 v67, 0
    v_mov_b32 v68, 0
    v_mov_b32 v69, 0
    v_mov_b32 v70, 0
    v_mov_b32 v71, 0
    s_sleep 5
    s_mov_b32 s23, s25
    buffer_load_dwordx4 v[96:99], v10, s[4:7], s84 offen sc1
    buffer_load_dwordx4 v[100:103], v23, s[4:7], s84 offen sc1
    buffer_load_dwordx4 v[104:107], v244, s[4:7], s84 offen sc1
    s_sleep 3
    buffer_load_dwordx4 v[108:111], v10, s[4:7], s22 offen sc1
    buffer_load_dwordx4 v[112:115], v23, s[4:7], s22 offen sc1
    buffer_load_dwordx4 v[116:119], v244, s[4:7], s22 offen sc1
    s_waitcnt vmcnt(3)
    v_max3_u32 v19, v96, v97, v98
    v_max3_u32 v19, v19, v99, v100
    v_max3_u32 v19, v19, v101, v102
    v_max3_u32 v19, v19, v103, v104
    v_max3_u32 v19, v19, v105, v106
    v_max_u32 v19, v19, v107
    v_cmp_eq_u32 vcc, -1, v19
    v_add_f32 v124, v88, v96
    v_add_f32 v125, v89, v97
    v_add_f32 v126, v90, v98
    v_add_f32 v127, v91, v99
    s_cbranch_vccnz pr_748
    s_barrier
    v_add_f32 v120, v100, v104
    v_add_f32 v121, v101, v105
    v_add_f32 v122, v102, v106
    v_add_f32 v123, v103, v107
    v_add_f32 v120, v124, v120
    v_add_f32 v121, v125, v121
    v_add_f32 v122, v126, v122
    v_add_f32 v123, v127, v123
    v_cvt_pk_bf16_f32 v180, v120, v121
    v_cvt_pk_bf16_f32 v181, v122, v123
    buffer_store_dwordx2 v[180:181], v11, s[4:7], s42 offen sc1
pf_750:
    s_mov_b32 s23, s25
    s_mov_b32 s21, s16
    s_mov_b32 s16, s42
    s_mov_b32 s42, s43
    s_mov_b32 s43, s44
    s_mov_b32 s44, s21
    s_add_u32 s84, s84, 262144
    s_add_u32 s15, s15, 1
    s_branch recur_slow_w3
gs_667:
    s_mov_b64 s[86:87], vcc
    s_mov_b64 exec, s[86:87]
    buffer_load_dwordx4 v[24:27], v2, s[4:7], s16 offen offset:0 sc1
    s_mov_b64 exec, -1
    s_waitcnt vmcnt(1)
    v_max3_u32 v19, v28, v29, v30
    v_max_u32 v19, v19, v31
    v_cmp_eq_u32 s[88:89], -1, v19
    v_max3_u32 v19, v32, v33, v34
    v_max_u32 v19, v19, v35
    v_cmp_eq_u32 s[90:91], -1, v19
    v_max3_u32 v19, v36, v37, v38
    v_max_u32 v19, v19, v39
    v_cmp_eq_u32 s[92:93], -1, v19
    s_mov_b64 exec, s[88:89]
    buffer_load_dwordx4 v[28:31], v2, s[4:7], s16 offen offset:1024 sc1
    s_mov_b64 exec, s[90:91]
    buffer_load_dwordx4 v[32:35], v2, s[4:7], s16 offen offset:2048 sc1
    s_mov_b64 exec, s[92:93]
    buffer_load_dwordx4 v[36:39], v2, s[4:7], s16 offen offset:3072 sc1
    s_mov_b64 exec, -1
    s_cmp_lg_u64 s[88:89], 0
    s_cbranch_scc1 gk_671
    v_mfma_f32_16x16x32_bf16 v[40:43], a[8:11], v[28:31], v[40:43]
    v_mfma_f32_16x16x32_bf16 v[44:47], a[12:15], v[28:31], v[44:47]
    v_mfma_f32_16x16x32_bf16 v[56:59], a[72:75], v[28:31], v[56:59]
    v_mfma_f32_16x16x32_bf16 v[60:63], a[76:79], v[28:31], v[60:63]
    v_mfma_f32_16x16x32_bf16 v[48:51], a[40:43], v[28:31], v[48:51]
    v_mfma_f32_16x16x32_bf16 v[52:55], a[44:47], v[28:31], v[52:55]
    v_mfma_f32_16x16x32_bf16 v[64:67], a[104:107], v[28:31], v[64:67]
    v_mfma_f32_16x16x32_bf16 v[68:71], a[108:111], v[28:31], v[68:71]
    s_mov_b64 exec, s[86:87]
    buffer_load_dwordx4 v[24:27], v2, s[4:7], s16 offen offset:0 sc1
    s_mov_b64 exec, s[90:91]
    buffer_load_dwordx4 v[32:35], v2, s[4:7], s16 offen offset:2048 sc1
    s_mov_b64 exec, s[92:93]
    buffer_load_dwordx4 v[36:39], v2, s[4:7], s16 offen offset:3072 sc1
    s_mov_b64 exec, -1
gk_671:
    s_cmp_lg_u64 s[90:91], 0
    s_cbranch_scc1 gk_672
    v_mfma_f32_16x16x32_bf16 v[40:43], a[16:19], v[32:35], v[40:43]
    v_mfma_f32_16x16x32_bf16 v[44:47], a[20:23], v[32:35], v[44:47]
    v_mfma_f32_16x16x32_bf16 v[56:59], a[80:83], v[32:35], v[56:59]
    v_mfma_f32_16x16x32_bf16 v[60:63], a[84:87], v[32:35], v[60:63]
    v_mfma_f32_16x16x32_bf16 v[48:51], a[48:51], v[32:35], v[48:51]
    v_mfma_f32_16x16x32_bf16 v[52:55], a[52:55], v[32:35], v[52:55]
    v_mfma_f32_16x16x32_bf16 v[64:67], a[112:115], v[32:35], v[64:67]
    v_mfma_f32_16x16x32_bf16 v[68:71], a[116:119], v[32:35], v[68:71]
    s_mov_b64 exec, s[86:87]
    buffer_load_dwordx4 v[24:27], v2, s[4:7], s16 offen offset:0 sc1
    s_mov_b64 exec, s[88:89]
    buffer_load_dwordx4 v[28:31], v2, s[4:7], s16 offen offset:1024 sc1
    s_mov_b64 exec, s[92:93]
    buffer_load_dwordx4 v[36:39], v2, s[4:7], s16 offen offset:3072 sc1
    s_mov_b64 exec, -1
gk_672:
    s_cmp_lg_u64 s[92:93], 0
    s_cbranch_scc1 gk_673
    v_mfma_f32_16x16x32_bf16 v[40:43], a[24:27], v[36:39], v[40:43]
    v_mfma_f32_16x16x32_bf16 v[44:47], a[28:31], v[36:39], v[44:47]
    v_mfma_f32_16x16x32_bf16 v[56:59], a[88:91], v[36:39], v[56:59]
    v_mfma_f32_16x16x32_bf16 v[60:63], a[92:95], v[36:39], v[60:63]
    v_mfma_f32_16x16x32_bf16 v[48:51], a[56:59], v[36:39], v[48:51]
    v_mfma_f32_16x16x32_bf16 v[52:55], a[60:63], v[36:39], v[52:55]
    v_mfma_f32_16x16x32_bf16 v[64:67], a[120:123], v[36:39], v[64:67]
    v_mfma_f32_16x16x32_bf16 v[68:71], a[124:127], v[36:39], v[68:71]
    s_mov_b64 exec, s[86:87]
    buffer_load_dwordx4 v[24:27], v2, s[4:7], s16 offen offset:0 sc1
    s_mov_b64 exec, s[88:89]
    buffer_load_dwordx4 v[28:31], v2, s[4:7], s16 offen offset:1024 sc1
    s_mov_b64 exec, s[90:91]
    buffer_load_dwordx4 v[32:35], v2, s[4:7], s16 offen offset:2048 sc1
    s_mov_b64 exec, -1
gk_673:
gl_675:
    v_max3_u32 v19, v24, v25, v26
    v_max_u32 v19, v19, v27
    v_cmp_eq_u32 vcc, -1, v19
    s_nop 0
    s_cbranch_vccz go_676
    s_mov_b64 s[86:87], vcc
    s_waitcnt vmcnt(8)
    s_mov_b64 exec, s[86:87]
    buffer_load_dwordx4 v[24:27], v2, s[4:7], s16 offen offset:0 sc1
    s_mov_b64 exec, s[88:89]
    buffer_load_dwordx4 v[28:31], v2, s[4:7], s16 offen offset:1024 sc1
    s_mov_b64 exec, s[90:91]
    buffer_load_dwordx4 v[32:35], v2, s[4:7], s16 offen offset:2048 sc1
    s_mov_b64 exec, s[92:93]
    buffer_load_dwordx4 v[36:39], v2, s[4:7], s16 offen offset:3072 sc1
    s_mov_b64 exec, -1
    s_add_u32 s23, s23, 1
    s_cmp_ge_u32 s23, 200000
    s_cselect_b32 s25, 200000, s25
    s_cbranch_scc1 go_676
    s_branch gl_675
go_676:
    v_mfma_f32_16x16x32_bf16 v[40:43], a[0:3], v[24:27], v[40:43]
    v_mfma_f32_16x16x32_bf16 v[44:47], a[4:7], v[24:27], v[44:47]
    v_mfma_f32_16x16x32_bf16 v[56:59], a[64:67], v[24:27], v[56:59]
    v_mfma_f32_16x16x32_bf16 v[60:63], a[68:71], v[24:27], v[60:63]
    v_mfma_f32_16x16x32_bf16 v[48:51], a[32:35], v[24:27], v[48:51]
    v_mfma_f32_16x16x32_bf16 v[52:55], a[36:39], v[24:27], v[52:55]
    v_mfma_f32_16x16x32_bf16 v[64:67], a[96:99], v[24:27], v[64:67]
    v_mfma_f32_16x16x32_bf16 v[68:71], a[100:103], v[24:27], v[68:71]
gd_674:
    s_cmp_eq_u64 s[88:89], 0
    s_cbranch_scc1 gd_677
gl_678:
    v_max3_u32 v19, v28, v29, v30
    v_max_u32 v19, v19, v31
    v_cmp_eq_u32 vcc, -1, v19
    s_nop 0
    s_cbranch_vccz go_679
    s_mov_b64 s[88:89], vcc
    s_waitcnt vmcnt(6)
    s_mov_b64 exec, s[88:89]
    buffer_load_dwordx4 v[28:31], v2, s[4:7], s16 offen offset:1024 sc1
    s_mov_b64 exec, s[90:91]
    buffer_load_dwordx4 v[32:35], v2, s[4:7], s16 offen offset:2048 sc1
    s_mov_b64 exec, s[92:93]
    buffer_load_dwordx4 v[36:39], v2, s[4:7], s16 offen offset:3072 sc1
    s_mov_b64 exec, -1
    s_add_u32 s23, s23, 1
    s_cmp_ge_u32 s23, 200000
    s_cselect_b32 s25, 200000, s25
    s_cbranch_scc1 go_679
    s_branch gl_678
go_679:
    v_mfma_f32_16x16x32_bf16 v[40:43], a[8:11], v[28:31], v[40:43]
    v_mfma_f32_16x16x32_bf16 v[44:47], a[12:15], v[28:31], v[44:47]
    v_mfma_f32_16x16x32_bf16 v[56:59], a[72:75], v[28:31], v[56:59]
    v_mfma_f32_16x16x32_bf16 v[60:63], a[76:79], v[28:31], v[60:63]
    v_mfma_f32_16x16x32_bf16 v[48:51], a[40:43], v[28:31], v[48:51]
    v_mfma_f32_16x16x32_bf16 v[52:55], a[44:47], v[28:31], v[52:55]
    v_mfma_f32_16x16x32_bf16 v[64:67], a[104:107], v[28:31], v[64:67]
    v_mfma_f32_16x16x32_bf16 v[68:71], a[108:111], v[28:31], v[68:71]
gd_677:
    s_cmp_eq_u64 s[90:91], 0
    s_cbranch_scc1 gd_680
gl_681:
    v_max3_u32 v19, v32, v33, v34
    v_max_u32 v19, v19, v35
    v_cmp_eq_u32 vcc, -1, v19
    s_nop 0
    s_cbranch_vccz go_682
    s_mov_b64 s[90:91], vcc
    s_waitcnt vmcnt(4)
    s_mov_b64 exec, s[90:91]
    buffer_load_dwordx4 v[32:35], v2, s[4:7], s16 offen offset:2048 sc1
    s_mov_b64 exec, s[92:93]
    buffer_load_dwordx4 v[36:39], v2, s[4:7], s16 offen offset:3072 sc1
    s_mov_b64 exec, -1
    s_add_u32 s23, s23, 1
    s_cmp_ge_u32 s23, 200000
    s_cselect_b32 s25, 200000, s25
    s_cbranch_scc1 go_682
    s_branch gl_681
go_682:
    v_mfma_f32_16x16x32_bf16 v[40:43], a[16:19], v[32:35], v[40:43]
    v_mfma_f32_16x16x32_bf16 v[44:47], a[20:23], v[32:35], v[44:47]
    v_mfma_f32_16x16x32_bf16 v[56:59], a[80:83], v[32:35], v[56:59]
    v_mfma_f32_16x16x32_bf16 v[60:63], a[84:87], v[32:35], v[60:63]
    v_mfma_f32_16x16x32_bf16 v[48:51], a[48:51], v[32:35], v[48:51]
    v_mfma_f32_16x16x32_bf16 v[52:55], a[52:55], v[32:35], v[52:55]
    v_mfma_f32_16x16x32_bf16 v[64:67], a[112:115], v[32:35], v[64:67]
    v_mfma_f32_16x16x32_bf16 v[68:71], a[116:119], v[32:35], v[68:71]
gd_680:
    s_cmp_eq_u64 s[92:93], 0
    s_cbranch_scc1 gd_683
gl_684:
    v_max3_u32 v19, v36, v37, v38
    v_max_u32 v19, v19, v39
    v_cmp_eq_u32 vcc, -1, v19
    s_nop 0
    s_cbranch_vccz go_685
    s_mov_b64 s[92:93], vcc
    s_waitcnt vmcnt(2)
    s_mov_b64 exec, s[92:93]
    buffer_load_dwordx4 v[36:39], v2, s[4:7], s16 offen offset:3072 sc1
    s_mov_b64 exec, -1
    s_add_u32 s23, s23, 1
    s_cmp_ge_u32 s23, 200000
    s_cselect_b32 s25, 200000, s25
    s_cbranch_scc1 go_685
    s_branch gl_684
go_685:
    v_mfma_f32_16x16x32_bf16 v[40:43], a[24:27], v[36:39], v[40:43]
    v_mfma_f32_16x16x32_bf16 v[44:47], a[28:31], v[36:39], v[44:47]
    v_mfma_f32_16x16x32_bf16 v[56:59], a[88:91], v[36:39], v[56:59]
    v_mfma_f32_16x16x32_bf16 v[60:63], a[92:95], v[36:39], v[60:63]
    v_mfma_f32_16x16x32_bf16 v[48:51], a[56:59], v[36:39], v[48:51]
    v_mfma_f32_16x16x32_bf16 v[52:55], a[60:63], v[36:39], v[52:55]
    v_mfma_f32_16x16x32_bf16 v[64:67], a[120:123], v[36:39], v[64:67]
    v_mfma_f32_16x16x32_bf16 v[68:71], a[124:127], v[36:39], v[68:71]
gd_683:
    s_branch gc_666
gs_668:
    s_mov_b64 s[88:89], vcc
    s_mov_b64 exec, s[88:89]
    buffer_load_dwordx4 v[28:31], v2, s[4:7], s16 offen offset:1024 sc1
    s_mov_b64 exec, -1
    s_waitcnt vmcnt(1)
    v_max3_u32 v19, v32, v33, v34
    v_max_u32 v19, v19, v35
    v_cmp_eq_u32 s[90:91], -1, v19
    v_max3_u32 v19, v36, v37, v38
    v_max_u32 v19, v19, v39
    v_cmp_eq_u32 s[92:93], -1, v19
    s_mov_b64 exec, s[90:91]
    buffer_load_dwordx4 v[32:35], v2, s[4:7], s16 offen offset:2048 sc1
    s_mov_b64 exec, s[92:93]
    buffer_load_dwordx4 v[36:39], v2, s[4:7], s16 offen offset:3072 sc1
    s_mov_b64 exec, -1
    s_cmp_lg_u64 s[90:91], 0
    s_cbranch_scc1 gk_686
    v_mfma_f32_16x16x32_bf16 v[40:43], a[16:19], v[32:35], v[40:43]
    v_mfma_f32_16x16x32_bf16 v[44:47], a[20:23], v[32:35], v[44:47]
    v_mfma_f32_16x16x32_bf16 v[56:59], a[80:83], v[32:35], v[56:59]
    v_mfma_f32_16x16x32_bf16 v[60:63], a[84:87], v[32:35], v[60:63]
    v_mfma_f32_16x16x32_bf16 v[48:51], a[48:51], v[32:35], v[48:51]
    v_mfma_f32_16x16x32_bf16 v[52:55], a[52:55], v[32:35], v[52:55]
    v_mfma_f32_16x16x32_bf16 v[64:67], a[112:115], v[32:35], v[64:67]
    v_mfma_f32_16x16x32_bf16 v[68:71], a[116:119], v[32:35], v[68:71]
    s_mov_b64 exec, s[88:89]
    buffer_load_dwordx4 v[28:31], v2, s[4:7], s16 offen offset:1024 sc1
    s_mov_b64 exec, s[92:93]
    buffer_load_dwordx4 v[36:39], v2, s[4:7], s16 offen offset:3072 sc1
    s_mov_b64 exec, -1
gk_686:
    s_cmp_lg_u64 s[92:93], 0
    s_cbranch_scc1 gk_687
    v_mfma_f32_16x16x32_bf16 v[40:43], a[24:27], v[36:39], v[40:43]
    v_mfma_f32_16x16x32_bf16 v[44:47], a[28:31], v[36:39], v[44:47]
    v_mfma_f32_16x16x32_bf16 v[56:59], a[88:91], v[36:39], v[56:59]
    v_mfma_f32_16x16x32_bf16 v[60:63], a[92:95], v[36:39], v[60:63]
    v_mfma_f32_16x16x32_bf16 v[48:51], a[56:59], v[36:39], v[48:51]
    v_mfma_f32_16x16x32_bf16 v[52:55], a[60:63], v[36:39], v[52:55]
    v_mfma_f32_16x16x32_bf16 v[64:67], a[120:123], v[36:39], v[64:67]
    v_mfma_f32_16x16x32_bf16 v[68:71], a[124:127], v[36:39], v[68:71]
    s_mov_b64 exec, s[88:89]
    buffer_load_dwordx4 v[28:31], v2, s[4:7], s16 offen offset:1024 sc1
    s_mov_b64 exec, s[90:91]
    buffer_load_dwordx4 v[32:35], v2, s[4:7], s16 offen offset:2048 sc1
    s_mov_b64 exec, -1
gk_687:
gl_689:
    v_max3_u32 v19, v28, v29, v30
    v_max_u32 v19, v19, v31
    v_cmp_eq_u32 vcc, -1, v19
    s_nop 0
    s_cbranch_vccz go_690
    s_mov_b64 s[88:89], vcc
    s_waitcnt vmcnt(6)
    s_mov_b64 exec, s[88:89]
    buffer_load_dwordx4 v[28:31], v2, s[4:7], s16 offen offset:1024 sc1
    s_mov_b64 exec, s[90:91]
    buffer_load_dwordx4 v[32:35], v2, s[4:7], s16 offen offset:2048 sc1
    s_mov_b64 exec, s[92:93]
    buffer_load_dwordx4 v[36:39], v2, s[4:7], s16 offen offset:3072 sc1
    s_mov_b64 exec, -1
    s_add_u32 s23, s23, 1
    s_cmp_ge_u32 s23, 200000
    s_cselect_b32 s25, 200000, s25
    s_cbranch_scc1 go_690
    s_branch gl_689
go_690:
    v_mfma_f32_16x16x32_bf16 v[40:43], a[8:11], v[28:31], v[40:43]
    v_mfma_f32_16x16x32_bf16 v[44:47], a[12:15], v[28:31], v[44:47]
    v_mfma_f32_16x16x32_bf16 v[56:59], a[72:75], v[28:31], v[56:59]
    v_mfma_f32_16x16x32_bf16 v[60:63], a[76:79], v[28:31], v[60:63]
    v_mfma_f32_16x16x32_bf16 v[48:51], a[40:43], v[28:31], v[48:51]
    v_mfma_f32_16x16x32_bf16 v[52:55], a[44:47], v[28:31], v[52:55]
    v_mfma_f32_16x16x32_bf16 v[64:67], a[104:107], v[28:31], v[64:67]
    v_mfma_f32_16x16x32_bf16 v[68:71], a[108:111], v[28:31], v[68:71]
gd_688:
    s_cmp_eq_u64 s[90:91], 0
    s_cbranch_scc1 gd_691
gl_692:
    v_max3_u32 v19, v32, v33, v34
    v_max_u32 v19, v19, v35
    v_cmp_eq_u32 vcc, -1, v19
    s_nop 0
    s_cbranch_vccz go_693
    s_mov_b64 s[90:91], vcc
    s_waitcnt vmcnt(4)
    s_mov_b64 exec, s[90:91]
    buffer_load_dwordx4 v[32:35], v2, s[4:7], s16 offen offset:2048 sc1
    s_mov_b64 exec, s[92:93]
    buffer_load_dwordx4 v[36:39], v2, s[4:7], s16 offen offset:3072 sc1
    s_mov_b64 exec, -1
    s_add_u32 s23, s23, 1
    s_cmp_ge_u32 s23, 200000
    s_cselect_b32 s25, 200000, s25
    s_cbranch_scc1 go_693
    s_branch gl_692
go_693:
    v_mfma_f32_16x16x32_bf16 v[40:43], a[16:19], v[32:35], v[40:43]
    v_mfma_f32_16x16x32_bf16 v[44:47], a[20:23], v[32:35], v[44:47]
    v_mfma_f32_16x16x32_bf16 v[56:59], a[80:83], v[32:35], v[56:59]
    v_mfma_f32_16x16x32_bf16 v[60:63], a[84:87], v[32:35], v[60:63]
    v_mfma_f32_16x16x32_bf16 v[48:51], a[48:51], v[32:35], v[48:51]
    v_mfma_f32_16x16x32_bf16 v[52:55], a[52:55], v[32:35], v[52:55]
    v_mfma_f32_16x16x32_bf16 v[64:67], a[112:115], v[32:35], v[64:67]
    v_mfma_f32_16x16x32_bf16 v[68:71], a[116:119], v[32:35], v[68:71]
gd_691:
    s_cmp_eq_u64 s[92:93], 0
    s_cbranch_scc1 gd_694
gl_695:
    v_max3_u32 v19, v36, v37, v38
    v_max_u32 v19, v19, v39
    v_cmp_eq_u32 vcc, -1, v19
    s_nop 0
    s_cbranch_vccz go_696
    s_mov_b64 s[92:93], vcc
    s_waitcnt vmcnt(2)
    s_mov_b64 exec, s[92:93]
    buffer_load_dwordx4 v[36:39], v2, s[4:7], s16 offen offset:3072 sc1
    s_mov_b64 exec, -1
    s_add_u32 s23, s23, 1
    s_cmp_ge_u32 s23, 200000
    s_cselect_b32 s25, 200000, s25
    s_cbranch_scc1 go_696
    s_branch gl_695
go_696:
    v_mfma_f32_16x16x32_bf16 v[40:43], a[24:27], v[36:39], v[40:43]
    v_mfma_f32_16x16x32_bf16 v[44:47], a[28:31], v[36:39], v[44:47]
    v_mfma_f32_16x16x32_bf16 v[56:59], a[88:91], v[36:39], v[56:59]
    v_mfma_f32_16x16x32_bf16 v[60:63], a[92:95], v[36:39], v[60:63]
    v_mfma_f32_16x16x32_bf16 v[48:51], a[56:59], v[36:39], v[48:51]
    v_mfma_f32_16x16x32_bf16 v[52:55], a[60:63], v[36:39], v[52:55]
    v_mfma_f32_16x16x32_bf16 v[64:67], a[120:123], v[36:39], v[64:67]
    v_mfma_f32_16x16x32_bf16 v[68:71], a[124:127], v[36:39], v[68:71]
gd_694:
    s_branch gc_666
gs_669:
    s_mov_b64 s[90:91], vcc
    s_mov_b64 exec, s[90:91]
    buffer_load_dwordx4 v[32:35], v2, s[4:7], s16 offen offset:2048 sc1
    s_mov_b64 exec, -1
    s_waitcnt vmcnt(1)
    v_max3_u32 v19, v36, v37, v38
    v_max_u32 v19, v19, v39
    v_cmp_eq_u32 s[92:93], -1, v19
    s_nop 0
    s_mov_b64 exec, s[92:93]
    buffer_load_dwordx4 v[36:39], v2, s[4:7], s16 offen offset:3072 sc1
    s_mov_b64 exec, -1
    s_cmp_lg_u64 s[92:93], 0
    s_cbranch_scc1 gk_697
    v_mfma_f32_16x16x32_bf16 v[40:43], a[24:27], v[36:39], v[40:43]
    v_mfma_f32_16x16x32_bf16 v[44:47], a[28:31], v[36:39], v[44:47]
    v_mfma_f32_16x16x32_bf16 v[56:59], a[88:91], v[36:39], v[56:59]
    v_mfma_f32_16x16x32_bf16 v[60:63], a[92:95], v[36:39], v[60:63]
    v_mfma_f32_16x16x32_bf16 v[48:51], a[56:59], v[36:39], v[48:51]
    v_mfma_f32_16x16x32_bf16 v[52:55], a[60:63], v[36:39], v[52:55]
    v_mfma_f32_16x16x32_bf16 v[64:67], a[120:123], v[36:39], v[64:67]
    v_mfma_f32_16x16x32_bf16 v[68:71], a[124:127], v[36:39], v[68:71]
    s_mov_b64 exec, s[90:91]
    buffer_load_dwordx4 v[32:35], v2, s[4:7], s16 offen offset:2048 sc1
    s_mov_b64 exec, -1
gk_697:
gl_699:
    v_max3_u32 v19, v32, v33, v34
    v_max_u32 v19, v19, v35
    v_cmp_eq_u32 vcc, -1, v19
    s_nop 0
    s_cbranch_vccz go_700
    s_mov_b64 s[90:91], vcc
    s_waitcnt vmcnt(4)
    s_mov_b64 exec, s[90:91]
    buffer_load_dwordx4 v[32:35], v2, s[4:7], s16 offen offset:2048 sc1
    s_mov_b64 exec, s[92:93]
    buffer_load_dwordx4 v[36:39], v2, s[4:7], s16 offen offset:3072 sc1
    s_mov_b64 exec, -1
    s_add_u32 s23, s23, 1
    s_cmp_ge_u32 s23, 200000
    s_cselect_b32 s25, 200000, s25
    s_cbranch_scc1 go_700
    s_branch gl_699
go_700:
    v_mfma_f32_16x16x32_bf16 v[40:43], a[16:19], v[32:35], v[40:43]
    v_mfma_f32_16x16x32_bf16 v[44:47], a[20:23], v[32:35], v[44:47]
    v_mfma_f32_16x16x32_bf16 v[56:59], a[80:83], v[32:35], v[56:59]
    v_mfma_f32_16x16x32_bf16 v[60:63], a[84:87], v[32:35], v[60:63]
    v_mfma_f32_16x16x32_bf16 v[48:51], a[48:51], v[32:35], v[48:51]
    v_mfma_f32_16x16x32_bf16 v[52:55], a[52:55], v[32:35], v[52:55]
    v_mfma_f32_16x16x32_bf16 v[64:67], a[112:115], v[32:35], v[64:67]
    v_mfma_f32_16x16x32_bf16 v[68:71], a[116:119], v[32:35], v[68:71]
gd_698:
    s_cmp_eq_u64 s[92:93], 0
    s_cbranch_scc1 gd_701
gl_702:
    v_max3_u32 v19, v36, v37, v38
    v_max_u32 v19, v19, v39
    v_cmp_eq_u32 vcc, -1, v19
    s_nop 0
    s_cbranch_vccz go_703
    s_mov_b64 s[92:93], vcc
    s_waitcnt vmcnt(2)
    s_mov_b64 exec, s[92:93]
    buffer_load_dwordx4 v[36:39], v2, s[4:7], s16 offen offset:3072 sc1
    s_mov_b64 exec, -1
    s_add_u32 s23, s23, 1
    s_cmp_ge_u32 s23, 200000
    s_cselect_b32 s25, 200000, s25
    s_cbranch_scc1 go_703
    s_branch gl_702
go_703:
    v_mfma_f32_16x16x32_bf16 v[40:43], a[24:27], v[36:39], v[40:43]
    v_mfma_f32_16x16x32_bf16 v[44:47], a[28:31], v[36:39], v[44:47]
    v_mfma_f32_16x16x32_bf16 v[56:59], a[88:91], v[36:39], v[56:59]
    v_mfma_f32_16x16x32_bf16 v[60:63], a[92:95], v[36:39], v[60:63]
    v_mfma_f32_16x16x32_bf16 v[48:51], a[56:59], v[36:39], v[48:51]
    v_mfma_f32_16x16x32_bf16 v[52:55], a[60:63], v[36:39], v[52:55]
    v_mfma_f32_16x16x32_bf16 v[64:67], a[120:123], v[36:39], v[64:67]
    v_mfma_f32_16x16x32_bf16 v[68:71], a[124:127], v[36:39], v[68:71]
gd_701:
    s_branch gc_666
gs_670:
    s_mov_b64 s[92:93], vcc
    s_mov_b64 exec, s[92:93]
    buffer_load_dwordx4 v[36:39], v2, s[4:7], s16 offen offset:3072 sc1
    s_mov_b64 exec, -1
gl_705:
    v_max3_u32 v19, v36, v37, v38
    v_max_u32 v19, v19, v39
    v_cmp_eq_u32 vcc, -1, v19
    s_nop 0
    s_cbranch_vccz go_706
    s_mov_b64 s[92:93], vcc
    s_waitcnt vmcnt(2)
    s_mov_b64 exec, s[92:93]
    buffer_load_dwordx4 v[36:39], v2, s[4:7], s16 offen offset:3072 sc1
    s_mov_b64 exec, -1
    s_add_u32 s23, s23, 1
    s_cmp_ge_u32 s23, 200000
    s_cselect_b32 s25, 200000, s25
    s_cbranch_scc1 go_706
    s_branch gl_705
go_706:
    v_mfma_f32_16x16x32_bf16 v[40:43], a[24:27], v[36:39], v[40:43]
    v_mfma_f32_16x16x32_bf16 v[44:47], a[28:31], v[36:39], v[44:47]
    v_mfma_f32_16x16x32_bf16 v[56:59], a[88:91], v[36:39], v[56:59]
    v_mfma_f32_16x16x32_bf16 v[60:63], a[92:95], v[36:39], v[60:63]
    v_mfma_f32_16x16x32_bf16 v[48:51], a[56:59], v[36:39], v[48:51]
    v_mfma_f32_16x16x32_bf16 v[52:55], a[60:63], v[36:39], v[52:55]
    v_mfma_f32_16x16x32_bf16 v[64:67], a[120:123], v[36:39], v[64:67]
    v_mfma_f32_16x16x32_bf16 v[68:71], a[124:127], v[36:39], v[68:71]
gd_704:
    s_branch gc_666
gs_708:
    s_mov_b64 s[86:87], vcc
    s_mov_b64 exec, s[86:87]
    buffer_load_dwordx4 v[24:27], v8, s[4:7], s16 offen offset:0 sc1
    s_mov_b64 exec, -1
    s_waitcnt vmcnt(1)
    v_max3_u32 v19, v28, v29, v30
    v_max_u32 v19, v19, v31
    v_cmp_eq_u32 s[88:89], -1, v19
    v_max3_u32 v19, v32, v33, v34
    v_max_u32 v19, v19, v35
    v_cmp_eq_u32 s[90:91], -1, v19
    v_max3_u32 v19, v36, v37, v38
    v_max_u32 v19, v19, v39
    v_cmp_eq_u32 s[92:93], -1, v19
    s_mov_b64 exec, s[88:89]
    buffer_load_dwordx4 v[28:31], v8, s[4:7], s16 offen offset:1024 sc1
    s_mov_b64 exec, s[90:91]
    buffer_load_dwordx4 v[32:35], v8, s[4:7], s16 offen offset:2048 sc1
    s_mov_b64 exec, s[92:93]
    buffer_load_dwordx4 v[36:39], v8, s[4:7], s16 offen offset:3072 sc1
    s_mov_b64 exec, -1
    s_cmp_lg_u64 s[88:89], 0
    s_cbranch_scc1 gk_712
    v_mfma_f32_16x16x32_bf16 v[40:43], a[200:203], v[28:31], v[40:43]
    v_mfma_f32_16x16x32_bf16 v[44:47], a[204:207], v[28:31], v[44:47]
    v_mfma_f32_16x16x32_bf16 v[48:51], a[232:235], v[28:31], v[48:51]
    v_mfma_f32_16x16x32_bf16 v[52:55], a[236:239], v[28:31], v[52:55]
    s_mov_b64 exec, s[86:87]
    buffer_load_dwordx4 v[24:27], v8, s[4:7], s16 offen offset:0 sc1
    s_mov_b64 exec, s[90:91]
    buffer_load_dwordx4 v[32:35], v8, s[4:7], s16 offen offset:2048 sc1
    s_mov_b64 exec, s[92:93]
    buffer_load_dwordx4 v[36:39], v8, s[4:7], s16 offen offset:3072 sc1
    s_mov_b64 exec, -1
gk_712:
    s_cmp_lg_u64 s[90:91], 0
    s_cbranch_scc1 gk_713
    v_mfma_f32_16x16x32_bf16 v[40:43], a[208:211], v[32:35], v[40:43]
    v_mfma_f32_16x16x32_bf16 v[44:47], a[212:215], v[32:35], v[44:47]
    v_mfma_f32_16x16x32_bf16 v[48:51], a[240:243], v[32:35], v[48:51]
    v_mfma_f32_16x16x32_bf16 v[52:55], a[244:247], v[32:35], v[52:55]
    s_mov_b64 exec, s[86:87]
    buffer_load_dwordx4 v[24:27], v8, s[4:7], s16 offen offset:0 sc1
    s_mov_b64 exec, s[88:89]
    buffer_load_dwordx4 v[28:31], v8, s[4:7], s16 offen offset:1024 sc1
    s_mov_b64 exec, s[92:93]
    buffer_load_dwordx4 v[36:39], v8, s[4:7], s16 offen offset:3072 sc1
    s_mov_b64 exec, -1
gk_713:
    s_cmp_lg_u64 s[92:93], 0
    s_cbranch_scc1 gk_714
    v_mfma_f32_16x16x32_bf16 v[40:43], a[216:219], v[36:39], v[40:43]
    v_mfma_f32_16x16x32_bf16 v[44:47], a[220:223], v[36:39], v[44:47]
    v_mfma_f32_16x16x32_bf16 v[48:51], a[248:251], v[36:39], v[48:51]
    v_mfma_f32_16x16x32_bf16 v[52:55], a[252:255], v[36:39], v[52:55]
    s_mov_b64 exec, s[86:87]
    buffer_load_dwordx4 v[24:27], v8, s[4:7], s16 offen offset:0 sc1
    s_mov_b64 exec, s[88:89]
    buffer_load_dwordx4 v[28:31], v8, s[4:7], s16 offen offset:1024 sc1
    s_mov_b64 exec, s[90:91]
    buffer_load_dwordx4 v[32:35], v8, s[4:7], s16 offen offset:2048 sc1
    s_mov_b64 exec, -1
gk_714:
gl_716:
    v_max3_u32 v19, v24, v25, v26
    v_max_u32 v19, v19, v27
    v_cmp_eq_u32 vcc, -1, v19
    s_nop 0
    s_cbranch_vccz go_717
    s_mov_b64 s[86:87], vcc
    s_waitcnt vmcnt(8)
    s_mov_b64 exec, s[86:87]
    buffer_load_dwordx4 v[24:27], v8, s[4:7], s16 offen offset:0 sc1
    s_mov_b64 exec, s[88:89]
    buffer_load_dwordx4 v[28:31], v8, s[4:7], s16 offen offset:1024 sc1
    s_mov_b64 exec, s[90:91]
    buffer_load_dwordx4 v[32:35], v8, s[4:7], s16 offen offset:2048 sc1
    s_mov_b64 exec, s[92:93]
    buffer_load_dwordx4 v[36:39], v8, s[4:7], s16 offen offset:3072 sc1
    s_mov_b64 exec, -1
    s_add_u32 s23, s23, 1
    s_cmp_ge_u32 s23, 200000
    s_cselect_b32 s25, 200000, s25
    s_cbranch_scc1 go_717
    s_branch gl_716
go_717:
    v_mfma_f32_16x16x32_bf16 v[40:43], a[192:195], v[24:27], v[40:43]
    v_mfma_f32_16x16x32_bf16 v[44:47], a[196:199], v[24:27], v[44:47]
    v_mfma_f32_16x16x32_bf16 v[48:51], a[224:227], v[24:27], v[48:51]
    v_mfma_f32_16x16x32_bf16 v[52:55], a[228:231], v[24:27], v[52:55]
gd_715:
    s_cmp_eq_u64 s[88:89], 0
    s_cbranch_scc1 gd_718
gl_719:
    v_max3_u32 v19, v28, v29, v30
    v_max_u32 v19, v19, v31
    v_cmp_eq_u32 vcc, -1, v19
    s_nop 0
    s_cbranch_vccz go_720
    s_mov_b64 s[88:89], vcc
    s_waitcnt vmcnt(6)
    s_mov_b64 exec, s[88:89]
    buffer_load_dwordx4 v[28:31], v8, s[4:7], s16 offen offset:1024 sc1
    s_mov_b64 exec, s[90:91]
    buffer_load_dwordx4 v[32:35], v8, s[4:7], s16 offen offset:2048 sc1
    s_mov_b64 exec, s[92:93]
    buffer_load_dwordx4 v[36:39], v8, s[4:7], s16 offen offset:3072 sc1
    s_mov_b64 exec, -1
    s_add_u32 s23, s23, 1
    s_cmp_ge_u32 s23, 200000
    s_cselect_b32 s25, 200000, s25
    s_cbranch_scc1 go_720
    s_branch gl_719
go_720:
    v_mfma_f32_16x16x32_bf16 v[40:43], a[200:203], v[28:31], v[40:43]
    v_mfma_f32_16x16x32_bf16 v[44:47], a[204:207], v[28:31], v[44:47]
    v_mfma_f32_16x16x32_bf16 v[48:51], a[232:235], v[28:31], v[48:51]
    v_mfma_f32_16x16x32_bf16 v[52:55], a[236:239], v[28:31], v[52:55]
gd_718:
    s_cmp_eq_u64 s[90:91], 0
    s_cbranch_scc1 gd_721
gl_722:
    v_max3_u32 v19, v32, v33, v34
    v_max_u32 v19, v19, v35
    v_cmp_eq_u32 vcc, -1, v19
    s_nop 0
    s_cbranch_vccz go_723
    s_mov_b64 s[90:91], vcc
    s_waitcnt vmcnt(4)
    s_mov_b64 exec, s[90:91]
    buffer_load_dwordx4 v[32:35], v8, s[4:7], s16 offen offset:2048 sc1
    s_mov_b64 exec, s[92:93]
    buffer_load_dwordx4 v[36:39], v8, s[4:7], s16 offen offset:3072 sc1
    s_mov_b64 exec, -1
    s_add_u32 s23, s23, 1
    s_cmp_ge_u32 s23, 200000
    s_cselect_b32 s25, 200000, s25
    s_cbranch_scc1 go_723
    s_branch gl_722
go_723:
    v_mfma_f32_16x16x32_bf16 v[40:43], a[208:211], v[32:35], v[40:43]
    v_mfma_f32_16x16x32_bf16 v[44:47], a[212:215], v[32:35], v[44:47]
    v_mfma_f32_16x16x32_bf16 v[48:51], a[240:243], v[32:35], v[48:51]
    v_mfma_f32_16x16x32_bf16 v[52:55], a[244:247], v[32:35], v[52:55]
gd_721:
    s_cmp_eq_u64 s[92:93], 0
    s_cbranch_scc1 gd_724
gl_725:
    v_max3_u32 v19, v36, v37, v38
    v_max_u32 v19, v19, v39
    v_cmp_eq_u32 vcc, -1, v19
    s_nop 0
    s_cbranch_vccz go_726
    s_mov_b64 s[92:93], vcc
    s_waitcnt vmcnt(2)
    s_mov_b64 exec, s[92:93]
    buffer_load_dwordx4 v[36:39], v8, s[4:7], s16 offen offset:3072 sc1
    s_mov_b64 exec, -1
    s_add_u32 s23, s23, 1
    s_cmp_ge_u32 s23, 200000
    s_cselect_b32 s25, 200000, s25
    s_cbranch_scc1 go_726
    s_branch gl_725
go_726:
    v_mfma_f32_16x16x32_bf16 v[40:43], a[216:219], v[36:39], v[40:43]
    v_mfma_f32_16x16x32_bf16 v[44:47], a[220:223], v[36:39], v[44:47]
    v_mfma_f32_16x16x32_bf16 v[48:51], a[248:251], v[36:39], v[48:51]
    v_mfma_f32_16x16x32_bf16 v[52:55], a[252:255], v[36:39], v[52:55]
gd_724:
    s_branch gc_707
gs_709:
    s_mov_b64 s[88:89], vcc
    s_mov_b64 exec, s[88:89]
    buffer_load_dwordx4 v[28:31], v8, s[4:7], s16 offen offset:1024 sc1
    s_mov_b64 exec, -1
    s_waitcnt vmcnt(1)
    v_max3_u32 v19, v32, v33, v34
    v_max_u32 v19, v19, v35
    v_cmp_eq_u32 s[90:91], -1, v19
    v_max3_u32 v19, v36, v37, v38
    v_max_u32 v19, v19, v39
    v_cmp_eq_u32 s[92:93], -1, v19
    s_mov_b64 exec, s[90:91]
    buffer_load_dwordx4 v[32:35], v8, s[4:7], s16 offen offset:2048 sc1
    s_mov_b64 exec, s[92:93]
    buffer_load_dwordx4 v[36:39], v8, s[4:7], s16 offen offset:3072 sc1
    s_mov_b64 exec, -1
    s_cmp_lg_u64 s[90:91], 0
    s_cbranch_scc1 gk_727
    v_mfma_f32_16x16x32_bf16 v[40:43], a[208:211], v[32:35], v[40:43]
    v_mfma_f32_16x16x32_bf16 v[44:47], a[212:215], v[32:35], v[44:47]
    v_mfma_f32_16x16x32_bf16 v[48:51], a[240:243], v[32:35], v[48:51]
    v_mfma_f32_16x16x32_bf16 v[52:55], a[244:247], v[32:35], v[52:55]
    s_mov_b64 exec, s[88:89]
    buffer_load_dwordx4 v[28:31], v8, s[4:7], s16 offen offset:1024 sc1
    s_mov_b64 exec, s[92:93]
    buffer_load_dwordx4 v[36:39], v8, s[4:7], s16 offen offset:3072 sc1
    s_mov_b64 exec, -1
gk_727:
    s_cmp_lg_u64 s[92:93], 0
    s_cbranch_scc1 gk_728
    v_mfma_f32_16x16x32_bf16 v[40:43], a[216:219], v[36:39], v[40:43]
    v_mfma_f32_16x16x32_bf16 v[44:47], a[220:223], v[36:39], v[44:47]
    v_mfma_f32_16x16x32_bf16 v[48:51], a[248:251], v[36:39], v[48:51]
    v_mfma_f32_16x16x32_bf16 v[52:55], a[252:255], v[36:39], v[52:55]
    s_mov_b64 exec, s[88:89]
    buffer_load_dwordx4 v[28:31], v8, s[4:7], s16 offen offset:1024 sc1
    s_mov_b64 exec, s[90:91]
    buffer_load_dwordx4 v[32:35], v8, s[4:7], s16 offen offset:2048 sc1
    s_mov_b64 exec, -1
gk_728:
gl_730:
    v_max3_u32 v19, v28, v29, v30
    v_max_u32 v19, v19, v31
    v_cmp_eq_u32 vcc, -1, v19
    s_nop 0
    s_cbranch_vccz go_731
    s_mov_b64 s[88:89], vcc
    s_waitcnt vmcnt(6)
    s_mov_b64 exec, s[88:89]
    buffer_load_dwordx4 v[28:31], v8, s[4:7], s16 offen offset:1024 sc1
    s_mov_b64 exec, s[90:91]
    buffer_load_dwordx4 v[32:35], v8, s[4:7], s16 offen offset:2048 sc1
    s_mov_b64 exec, s[92:93]
    buffer_load_dwordx4 v[36:39], v8, s[4:7], s16 offen offset:3072 sc1
    s_mov_b64 exec, -1
    s_add_u32 s23, s23, 1
    s_cmp_ge_u32 s23, 200000
    s_cselect_b32 s25, 200000, s25
    s_cbranch_scc1 go_731
    s_branch gl_730
go_731:
    v_mfma_f32_16x16x32_bf16 v[40:43], a[200:203], v[28:31], v[40:43]
    v_mfma_f32_16x16x32_bf16 v[44:47], a[204:207], v[28:31], v[44:47]
    v_mfma_f32_16x16x32_bf16 v[48:51], a[232:235], v[28:31], v[48:51]
    v_mfma_f32_16x16x32_bf16 v[52:55], a[236:239], v[28:31], v[52:55]
gd_729:
    s_cmp_eq_u64 s[90:91], 0
    s_cbranch_scc1 gd_732
gl_733:
    v_max3_u32 v19, v32, v33, v34
    v_max_u32 v19, v19, v35
    v_cmp_eq_u32 vcc, -1, v19
    s_nop 0
    s_cbranch_vccz go_734
    s_mov_b64 s[90:91], vcc
    s_waitcnt vmcnt(4)
    s_mov_b64 exec, s[90:91]
    buffer_load_dwordx4 v[32:35], v8, s[4:7], s16 offen offset:2048 sc1
    s_mov_b64 exec, s[92:93]
    buffer_load_dwordx4 v[36:39], v8, s[4:7], s16 offen offset:3072 sc1
    s_mov_b64 exec, -1
    s_add_u32 s23, s23, 1
    s_cmp_ge_u32 s23, 200000
    s_cselect_b32 s25, 200000, s25
    s_cbranch_scc1 go_734
    s_branch gl_733
go_734:
    v_mfma_f32_16x16x32_bf16 v[40:43], a[208:211], v[32:35], v[40:43]
    v_mfma_f32_16x16x32_bf16 v[44:47], a[212:215], v[32:35], v[44:47]
    v_mfma_f32_16x16x32_bf16 v[48:51], a[240:243], v[32:35], v[48:51]
    v_mfma_f32_16x16x32_bf16 v[52:55], a[244:247], v[32:35], v[52:55]
gd_732:
    s_cmp_eq_u64 s[92:93], 0
    s_cbranch_scc1 gd_735
gl_736:
    v_max3_u32 v19, v36, v37, v38
    v_max_u32 v19, v19, v39
    v_cmp_eq_u32 vcc, -1, v19
    s_nop 0
    s_cbranch_vccz go_737
    s_mov_b64 s[92:93], vcc
    s_waitcnt vmcnt(2)
    s_mov_b64 exec, s[92:93]
    buffer_load_dwordx4 v[36:39], v8, s[4:7], s16 offen offset:3072 sc1
    s_mov_b64 exec, -1
    s_add_u32 s23, s23, 1
    s_cmp_ge_u32 s23, 200000
    s_cselect_b32 s25, 200000, s25
    s_cbranch_scc1 go_737
    s_branch gl_736
go_737:
    v_mfma_f32_16x16x32_bf16 v[40:43], a[216:219], v[36:39], v[40:43]
    v_mfma_f32_16x16x32_bf16 v[44:47], a[220:223], v[36:39], v[44:47]
    v_mfma_f32_16x16x32_bf16 v[48:51], a[248:251], v[36:39], v[48:51]
    v_mfma_f32_16x16x32_bf16 v[52:55], a[252:255], v[36:39], v[52:55]
gd_735:
    s_branch gc_707
gs_710:
    s_mov_b64 s[90:91], vcc
    s_mov_b64 exec, s[90:91]
    buffer_load_dwordx4 v[32:35], v8, s[4:7], s16 offen offset:2048 sc1
    s_mov_b64 exec, -1
    s_waitcnt vmcnt(1)
    v_max3_u32 v19, v36, v37, v38
    v_max_u32 v19, v19, v39
    v_cmp_eq_u32 s[92:93], -1, v19
    s_nop 0
    s_mov_b64 exec, s[92:93]
    buffer_load_dwordx4 v[36:39], v8, s[4:7], s16 offen offset:3072 sc1
    s_mov_b64 exec, -1
    s_cmp_lg_u64 s[92:93], 0
    s_cbranch_scc1 gk_738
    v_mfma_f32_16x16x32_bf16 v[40:43], a[216:219], v[36:39], v[40:43]
    v_mfma_f32_16x16x32_bf16 v[44:47], a[220:223], v[36:39], v[44:47]
    v_mfma_f32_16x16x32_bf16 v[48:51], a[248:251], v[36:39], v[48:51]
    v_mfma_f32_16x16x32_bf16 v[52:55], a[252:255], v[36:39], v[52:55]
    s_mov_b64 exec, s[90:91]
    buffer_load_dwordx4 v[32:35], v8, s[4:7], s16 offen offset:2048 sc1
    s_mov_b64 exec, -1
gk_738:
gl_740:
    v_max3_u32 v19, v32, v33, v34
    v_max_u32 v19, v19, v35
    v_cmp_eq_u32 vcc, -1, v19
    s_nop 0
    s_cbranch_vccz go_741
    s_mov_b64 s[90:91], vcc
    s_waitcnt vmcnt(4)
    s_mov_b64 exec, s[90:91]
    buffer_load_dwordx4 v[32:35], v8, s[4:7], s16 offen offset:2048 sc1
    s_mov_b64 exec, s[92:93]
    buffer_load_dwordx4 v[36:39], v8, s[4:7], s16 offen offset:3072 sc1
    s_mov_b64 exec, -1
    s_add_u32 s23, s23, 1
    s_cmp_ge_u32 s23, 200000
    s_cselect_b32 s25, 200000, s25
    s_cbranch_scc1 go_741
    s_branch gl_740
go_741:
    v_mfma_f32_16x16x32_bf16 v[40:43], a[208:211], v[32:35], v[40:43]
    v_mfma_f32_16x16x32_bf16 v[44:47], a[212:215], v[32:35], v[44:47]
    v_mfma_f32_16x16x32_bf16 v[48:51], a[240:243], v[32:35], v[48:51]
    v_mfma_f32_16x16x32_bf16 v[52:55], a[244:247], v[32:35], v[52:55]
gd_739:
    s_cmp_eq_u64 s[92:93], 0
    s_cbranch_scc1 gd_742
gl_743:
    v_max3_u32 v19, v36, v37, v38
    v_max_u32 v19, v19, v39
    v_cmp_eq_u32 vcc, -1, v19
    s_nop 0
    s_cbranch_vccz go_744
    s_mov_b64 s[92:93], vcc
    s_waitcnt vmcnt(2)
    s_mov_b64 exec, s[92:93]
    buffer_load_dwordx4 v[36:39], v8, s[4:7], s16 offen offset:3072 sc1
    s_mov_b64 exec, -1
    s_add_u32 s23, s23, 1
    s_cmp_ge_u32 s23, 200000
    s_cselect_b32 s25, 200000, s25
    s_cbranch_scc1 go_744
    s_branch gl_743
go_744:
    v_mfma_f32_16x16x32_bf16 v[40:43], a[216:219], v[36:39], v[40:43]
    v_mfma_f32_16x16x32_bf16 v[44:47], a[220:223], v[36:39], v[44:47]
    v_mfma_f32_16x16x32_bf16 v[48:51], a[248:251], v[36:39], v[48:51]
    v_mfma_f32_16x16x32_bf16 v[52:55], a[252:255], v[36:39], v[52:55]
gd_742:
    s_branch gc_707
gs_711:
    s_mov_b64 s[92:93], vcc
    s_mov_b64 exec, s[92:93]
    buffer_load_dwordx4 v[36:39], v8, s[4:7], s16 offen offset:3072 sc1
    s_mov_b64 exec, -1
gl_746:
    v_max3_u32 v19, v36, v37, v38
    v_max_u32 v19, v19, v39
    v_cmp_eq_u32 vcc, -1, v19
    s_nop 0
    s_cbranch_vccz go_747
    s_mov_b64 s[92:93], vcc
    s_waitcnt vmcnt(2)
    s_mov_b64 exec, s[92:93]
    buffer_load_dwordx4 v[36:39], v8, s[4:7], s16 offen offset:3072 sc1
    s_mov_b64 exec, -1
    s_add_u32 s23, s23, 1
    s_cmp_ge_u32 s23, 200000
    s_cselect_b32 s25, 200000, s25
    s_cbranch_scc1 go_747
    s_branch gl_746
go_747:
    v_mfma_f32_16x16x32_bf16 v[40:43], a[216:219], v[36:39], v[40:43]
    v_mfma_f32_16x16x32_bf16 v[44:47], a[220:223], v[36:39], v[44:47]
    v_mfma_f32_16x16x32_bf16 v[48:51], a[248:251], v[36:39], v[48:51]
    v_mfma_f32_16x16x32_bf16 v[52:55], a[252:255], v[36:39], v[52:55]
gd_745:
    s_branch gc_707
pr_748:
pb_751:
    s_waitcnt vmcnt(0)
    v_max3_u32 v19, v108, v109, v110
    v_max3_u32 v19, v19, v111, v112
    v_max3_u32 v19, v19, v113, v114
    v_max3_u32 v19, v19, v115, v116
    v_max3_u32 v19, v19, v117, v118
    v_max_u32 v19, v19, v119
    v_cmp_eq_u32 vcc, -1, v19
    v_add_f32 v124, v88, v108
    v_add_f32 v125, v89, v109
    v_add_f32 v126, v90, v110
    v_add_f32 v127, v91, v111
    s_add_u32 s23, s23, 1
    s_cbranch_vccz pg_749
    buffer_load_dwordx4 v[108:111], v10, s[4:7], s22 offen sc1
    buffer_load_dwordx4 v[112:115], v23, s[4:7], s22 offen sc1
    buffer_load_dwordx4 v[116:119], v244, s[4:7], s22 offen sc1
    s_add_u32 s23, s23, 1
    s_cmp_ge_u32 s23, 200000
    s_cselect_b32 s25, 200000, s25
    s_cbranch_scc1 pg_749
    s_branch pb_751
pg_749:
    s_barrier
    v_add_f32 v120, v112, v116
    v_add_f32 v121, v113, v117
    v_add_f32 v122, v114, v118
    v_add_f32 v123, v115, v119
    v_add_f32 v120, v124, v120
    v_add_f32 v121, v125, v121
    v_add_f32 v122, v126, v122
    v_add_f32 v123, v127, v123
    v_cvt_pk_bf16_f32 v180, v120, v121
    v_cvt_pk_bf16_f32 v181, v122, v123
    buffer_store_dwordx2 v[180:181], v11, s[4:7], s42 offen sc1
    s_branch pf_750
recur_end:
    s_endpgm
.section .rodata,"a"
.p2align 6
.amdhsa_kernel concat_heads__spectral_gfnet__memory_aug_recurrent_mem_tr__prompt_kernel
  .amdhsa_next_free_vgpr 512
  .amdhsa_next_free_sgpr 102
  .amdhsa_accum_offset 256
  .amdhsa_group_segment_fixed_size 0
  .amdhsa_kernarg_size 104
  .amdhsa_user_sgpr_count 2
  .amdhsa_user_sgpr_kernarg_segment_ptr 1
  .amdhsa_system_sgpr_workgroup_id_x 1
  .amdhsa_float_denorm_mode_32 3
.end_amdhsa_kernel
```

```asm
; @launch kernel=concat_heads__spectral_gfnet__memory_aug_recurrent_mem_tr__prompt_kernel grid=(256,1,1) block=(256,1,1) lds=131072
.amdgcn_target "amdgcn-amd-amdhsa--gfx950"
.text
.globl concat_heads__spectral_gfnet__memory_aug_recurrent_mem_tr__prompt_kernel
.p2align 8
.type concat_heads__spectral_gfnet__memory_aug_recurrent_mem_tr__prompt_kernel,@function
concat_heads__spectral_gfnet__memory_aug_recurrent_mem_tr__prompt_kernel:
    s_cmp_ge_u32 s2, 256
    s_cbranch_scc1 W_end
    s_load_dwordx2 s[100:101], s[0:1], 88
    s_mov_b32 s97, s2
    s_mov_b32 s98, 0
    s_getreg_b32 s3, hwreg(HW_REG_XCC_ID, 0, 3)
role_start:
    s_andn2_b32 s2, s97, 7
    s_or_b32 s2, s2, s3
    s_bitcmp1_b32 s3, 2
    s_cbranch_scc0 R_entry
    s_cmp_ge_u32 s2, 256
    s_cbranch_scc1 W_end
    s_load_dwordx2 s[4:5], s[0:1], 96
    v_lshrrev_b32 v5, 6, v0
    v_and_b32 v1, 63, v0
    v_readfirstlane_b32 s16, v5
    s_mov_b32 s6, 268435456
    s_mov_b32 s7, 0x20000
    s_waitcnt lgkmcnt(0)
    s_lshr_b32 s90, s2, 6
    s_bfe_u32 s91, s2, 0x30003
    s_lshl_b32 s91, s91, 2
    s_and_b32 s17, s3, 3
    s_add_u32 s91, s91, s17
    s_mov_b32 s92, 0
    s_lshl_b32 s17, s91, 2
    s_add_u32 s17, s17, s16
    s_lshl_b32 s18, s90, 7
    s_add_u32 s18, s18, s17
    s_lshl_b32 s18, s18, 7
    s_add_u32 s18, s18, 100663296
    s_lshl_b32 s20, s16, 5
    s_add_u32 s20, s20, s91
    s_lshl_b32 s20, s20, 2
    s_add_u32 s20, s20, 100728832
    s_cmp_eq_u32 s90, 3
    s_cselect_b32 s18, s20, s18
    s_cselect_b64 exec, 7, 1
    v_mov_b32 v5, s18
    s_and_b32 s18, s17, 31
    s_lshl_b32 s18, s18, 2
    s_lshr_b32 s20, s91, 3
    s_add_u32 s18, s18, s20
    s_lshl_b32 s18, s18, 2
    s_add_u32 s18, s18, 100732928
    v_writelane_b32 v5, s18, 1
    s_lshl_b32 s18, s17, 2
    s_add_u32 s18, s18, 100733440
    v_writelane_b32 v5, s18, 2
    v_mov_b32 v6, 0
    buffer_store_dword v6, v5, s[4:7], 0 offen sc1
    s_mov_b64 exec, -1
    s_waitcnt vmcnt(0) lgkmcnt(0)
    s_barrier
    s_cmp_lg_u32 s90, 3
    s_cbranch_scc1 W_novote
    s_or_b32 s17, s16, s98
    s_cmp_lg_u32 s17, 0
    s_cbranch_scc1 vote_1
    s_lshl_b32 s17, s91, 14
    s_add_u32 s17, s17, 205520896
    v_lshlrev_b32 v5, 2, v1
    v_add_u32 v5, s17, v5
    v_add_u32 v6, 8192, v5
    s_mov_b32 s20, -1
    s_mov_b32 s21, -1
    s_mov_b64 exec, 1
    buffer_store_dword v1, v5, s[4:7], 0 offen sc1
    s_mov_b32 s22, 0
vp_2:
    s_add_u32 s22, s22, 1
    s_getreg_b32 s18, hwreg(HW_REG_IB_STS, 0, 4)
    s_cmp_lt_u32 s22, 2048
    s_cselect_b32 s18, s18, 0
    s_cmp_lg_u32 s18, 0
    s_cbranch_scc1 vp_2
    s_min_u32 s20, s20, s22
    buffer_store_dword v1, v6, s[4:7], 0 offen sc1
    s_mov_b32 s22, 0
vp_3:
    s_add_u32 s22, s22, 1
    s_getreg_b32 s18, hwreg(HW_REG_IB_STS, 0, 4)
    s_cmp_lt_u32 s22, 2048
    s_cselect_b32 s18, s18, 0
    s_cmp_lg_u32 s18, 0
    s_cbranch_scc1 vp_3
    s_min_u32 s21, s21, s22
    buffer_store_dword v1, v5, s[4:7], 0 offen sc1
    s_mov_b32 s22, 0
vp_4:
    s_add_u32 s22, s22, 1
    s_getreg_b32 s18, hwreg(HW_REG_IB_STS, 0, 4)
    s_cmp_lt_u32 s22, 2048
    s_cselect_b32 s18, s18, 0
    s_cmp_lg_u32 s18, 0
    s_cbranch_scc1 vp_4
    s_min_u32 s20, s20, s22
    buffer_store_dword v1, v6, s[4:7], 0 offen sc1
    s_mov_b32 s22, 0
vp_5:
    s_add_u32 s22, s22, 1
    s_getreg_b32 s18, hwreg(HW_REG_IB_STS, 0, 4)
    s_cmp_lt_u32 s22, 2048
    s_cselect_b32 s18, s18, 0
    s_cmp_lg_u32 s18, 0
    s_cbranch_scc1 vp_5
    s_min_u32 s21, s21, s22
    buffer_store_dword v1, v5, s[4:7], 0 offen sc1
    s_mov_b32 s22, 0
vp_6:
    s_add_u32 s22, s22, 1
    s_getreg_b32 s18, hwreg(HW_REG_IB_STS, 0, 4)
    s_cmp_lt_u32 s22, 2048
    s_cselect_b32 s18, s18, 0
    s_cmp_lg_u32 s18, 0
    s_cbranch_scc1 vp_6
    s_min_u32 s20, s20, s22
    buffer_store_dword v1, v6, s[4:7], 0 offen sc1
    s_mov_b32 s22, 0
vp_7:
    s_add_u32 s22, s22, 1
    s_getreg_b32 s18, hwreg(HW_REG_IB_STS, 0, 4)
    s_cmp_lt_u32 s22, 2048
    s_cselect_b32 s18, s18, 0
    s_cmp_lg_u32 s18, 0
    s_cbranch_scc1 vp_7
    s_min_u32 s21, s21, s22
    buffer_store_dword v1, v5, s[4:7], 0 offen sc1
    s_mov_b32 s22, 0
vp_8:
    s_add_u32 s22, s22, 1
    s_getreg_b32 s18, hwreg(HW_REG_IB_STS, 0, 4)
    s_cmp_lt_u32 s22, 2048
    s_cselect_b32 s18, s18, 0
    s_cmp_lg_u32 s18, 0
    s_cbranch_scc1 vp_8
    s_min_u32 s20, s20, s22
    buffer_store_dword v1, v6, s[4:7], 0 offen sc1
    s_mov_b32 s22, 0
vp_9:
    s_add_u32 s22, s22, 1
    s_getreg_b32 s18, hwreg(HW_REG_IB_STS, 0, 4)
    s_cmp_lt_u32 s22, 2048
    s_cselect_b32 s18, s18, 0
    s_cmp_lg_u32 s18, 0
    s_cbranch_scc1 vp_9
    s_min_u32 s21, s21, s22
    s_and_b32 s17, s97, 3
    s_lshl_b32 s17, s17, 3
    s_lshl_b32 s17, 0x40, s17
    s_cmp_lt_u32 s20, s21
    s_cselect_b32 s17, s17, 0
    s_andn2_b32 s18, s97, 3
    v_mov_b32 v5, s18
    v_mov_b32 v6, s17
    global_atomic_add v5, v6, s[100:101] sc1
    s_mov_b64 exec, -1
    s_waitcnt vmcnt(0)
vote_1:
    s_barrier
W_novote:
    s_cmp_lg_u32 s16, 0
    s_cbranch_scc1 reg_10
    s_and_b32 s17, s2, 3
    s_lshl_b32 s17, s17, 3
    s_lshl_b32 s18, s98, 2
    s_add_u32 s17, s17, s18
    s_lshl_b32 s17, 1, s17
    s_andn2_b32 s18, s2, 3
    v_mov_b32 v5, s18
    v_mov_b32 v6, s17
    s_mov_b64 exec, 1
    global_atomic_add v5, v6, s[100:101] sc1
    s_mov_b64 exec, -1
reg_10:
    s_cmp_eq_u32 s90, 3
    s_cbranch_scc1 W_F
    s_load_dwordx2 s[12:13], s[0:1], 40
    s_load_dwordx2 s[28:29], s[0:1], 48
    s_load_dwordx2 s[30:31], s[0:1], 56
    s_load_dwordx2 s[8:9], s[0:1], 24
    s_mov_b32 s10, 4194304
    s_mov_b32 s11, 0x20000
    s_mov_b32 s14, 8388608
    s_mov_b32 s15, 0x20000
    s_waitcnt lgkmcnt(0)
    s_cmp_eq_u32 s90, 1
    s_cselect_b64 s[12:13], s[28:29], s[12:13]
    s_cmp_eq_u32 s90, 2
    s_cselect_b64 s[12:13], s[30:31], s[12:13]
    s_lshl_b32 s28, s91, 2
    s_add_u32 s28, s28, s16
    s_lshl_b32 s20, s28, 6
    v_lshrrev_b32 v5, 2, v1
    v_and_b32 v6, 3, v1
    v_lshlrev_b32 v7, 4, v6
    v_lshl_add_u32 v7, v5, 13, v7
    v_lshlrev_b32 v8, 4, v6
    v_bfe_u32 v5, v1, 2, 2
    v_lshrrev_b32 v6, 4, v1
    v_lshl_add_u32 v5, v6, 3, v5
    v_lshl_add_u32 v8, v5, 6, v8
    s_lshl_b32 s18, s16, 15
    v_add_u32 v8, s18, v8
    s_add_u32 m0, s18, 0
    s_nop 0
    buffer_load_dwordx4 v7, s[12:15], s20 offen lds
    s_add_u32 s20, s20, 131072
    s_add_u32 m0, s18, 1024
    s_nop 0
    buffer_load_dwordx4 v7, s[12:15], s20 offen lds
    s_add_u32 s20, s20, 131072
    s_add_u32 m0, s18, 2048
    s_nop 0
    buffer_load_dwordx4 v7, s[12:15], s20 offen lds
    s_add_u32 s20, s20, 131072
    s_add_u32 m0, s18, 3072
    s_nop 0
    buffer_load_dwordx4 v7, s[12:15], s20 offen lds
    s_add_u32 s20, s20, 131072
    s_add_u32 m0, s18, 4096
    s_nop 0
    buffer_load_dwordx4 v7, s[12:15], s20 offen lds
    s_add_u32 s20, s20, 131072
    s_add_u32 m0, s18, 5120
    s_nop 0
    buffer_load_dwordx4 v7, s[12:15], s20 offen lds
    s_add_u32 s20, s20, 131072
    s_add_u32 m0, s18, 6144
    s_nop 0
    buffer_load_dwordx4 v7, s[12:15], s20 offen lds
    s_add_u32 s20, s20, 131072
    s_add_u32 m0, s18, 7168
    s_nop 0
    buffer_load_dwordx4 v7, s[12:15], s20 offen lds
    s_add_u32 s20, s20, 131072
    s_add_u32 m0, s18, 8192
    s_nop 0
    buffer_load_dwordx4 v7, s[12:15], s20 offen lds
    s_add_u32 s20, s20, 131072
    s_add_u32 m0, s18, 9216
    s_nop 0
    buffer_load_dwordx4 v7, s[12:15], s20 offen lds
    s_add_u32 s20, s20, 131072
    s_add_u32 m0, s18, 10240
    s_nop 0
    buffer_load_dwordx4 v7, s[12:15], s20 offen lds
    s_add_u32 s20, s20, 131072
    s_add_u32 m0, s18, 11264
    s_nop 0
    buffer_load_dwordx4 v7, s[12:15], s20 offen lds
    s_add_u32 s20, s20, 131072
    s_add_u32 m0, s18, 12288
    s_nop 0
    buffer_load_dwordx4 v7, s[12:15], s20 offen lds
    s_add_u32 s20, s20, 131072
    s_add_u32 m0, s18, 13312
    s_nop 0
    buffer_load_dwordx4 v7, s[12:15], s20 offen lds
    s_add_u32 s20, s20, 131072
    s_add_u32 m0, s18, 14336
    s_nop 0
    buffer_load_dwordx4 v7, s[12:15], s20 offen lds
    s_add_u32 s20, s20, 131072
    s_add_u32 m0, s18, 15360
    s_nop 0
    buffer_load_dwordx4 v7, s[12:15], s20 offen lds
    s_add_u32 s20, s20, 131072
    s_add_u32 m0, s18, 16384
    s_nop 0
    buffer_load_dwordx4 v7, s[12:15], s20 offen lds
    s_add_u32 s20, s20, 131072
    s_add_u32 m0, s18, 17408
    s_nop 0
    buffer_load_dwordx4 v7, s[12:15], s20 offen lds
    s_add_u32 s20, s20, 131072
    s_add_u32 m0, s18, 18432
    s_nop 0
    buffer_load_dwordx4 v7, s[12:15], s20 offen lds
    s_add_u32 s20, s20, 131072
    s_add_u32 m0, s18, 19456
    s_nop 0
    buffer_load_dwordx4 v7, s[12:15], s20 offen lds
    s_add_u32 s20, s20, 131072
    s_add_u32 m0, s18, 20480
    s_nop 0
    buffer_load_dwordx4 v7, s[12:15], s20 offen lds
    s_add_u32 s20, s20, 131072
    s_add_u32 m0, s18, 21504
    s_nop 0
    buffer_load_dwordx4 v7, s[12:15], s20 offen lds
    s_add_u32 s20, s20, 131072
    s_add_u32 m0, s18, 22528
    s_nop 0
    buffer_load_dwordx4 v7, s[12:15], s20 offen lds
    s_add_u32 s20, s20, 131072
    s_add_u32 m0, s18, 23552
    s_nop 0
    buffer_load_dwordx4 v7, s[12:15], s20 offen lds
    s_add_u32 s20, s20, 131072
    s_add_u32 m0, s18, 24576
    s_nop 0
    buffer_load_dwordx4 v7, s[12:15], s20 offen lds
    s_add_u32 s20, s20, 131072
    s_add_u32 m0, s18, 25600
    s_nop 0
    buffer_load_dwordx4 v7, s[12:15], s20 offen lds
    s_add_u32 s20, s20, 131072
    s_add_u32 m0, s18, 26624
    s_nop 0
    buffer_load_dwordx4 v7, s[12:15], s20 offen lds
    s_add_u32 s20, s20, 131072
    s_add_u32 m0, s18, 27648
    s_nop 0
    buffer_load_dwordx4 v7, s[12:15], s20 offen lds
    s_add_u32 s20, s20, 131072
    s_add_u32 m0, s18, 28672
    s_nop 0
    buffer_load_dwordx4 v7, s[12:15], s20 offen lds
    s_add_u32 s20, s20, 131072
    s_add_u32 m0, s18, 29696
    s_nop 0
    buffer_load_dwordx4 v7, s[12:15], s20 offen lds
    s_add_u32 s20, s20, 131072
    s_add_u32 m0, s18, 30720
    s_nop 0
    buffer_load_dwordx4 v7, s[12:15], s20 offen lds
    s_add_u32 s20, s20, 131072
    s_add_u32 m0, s18, 31744
    s_nop 0
    buffer_load_dwordx4 v7, s[12:15], s20 offen lds
    s_add_u32 s20, s20, 131072
    s_waitcnt vmcnt(24)
    ds_read_b64_tr_b16 a[0:1], v8 offset:0
    ds_read_b64_tr_b16 a[2:3], v8 offset:256
    ds_read_b64_tr_b16 a[4:5], v8 offset:8
    ds_read_b64_tr_b16 a[6:7], v8 offset:264
    ds_read_b64_tr_b16 a[8:9], v8 offset:2048
    ds_read_b64_tr_b16 a[10:11], v8 offset:2304
    ds_read_b64_tr_b16 a[12:13], v8 offset:2056
    ds_read_b64_tr_b16 a[14:15], v8 offset:2312
    s_waitcnt lgkmcnt(7)
    ds_read_b64_tr_b16 a[16:17], v8 offset:4096
    ds_read_b64_tr_b16 a[18:19], v8 offset:4352
    ds_read_b64_tr_b16 a[20:21], v8 offset:4104
    ds_read_b64_tr_b16 a[22:23], v8 offset:4360
    ds_read_b64_tr_b16 a[24:25], v8 offset:6144
    ds_read_b64_tr_b16 a[26:27], v8 offset:6400
    ds_read_b64_tr_b16 a[28:29], v8 offset:6152
    ds_read_b64_tr_b16 a[30:31], v8 offset:6408
    s_waitcnt lgkmcnt(7)
    s_waitcnt vmcnt(16)
    ds_read_b64_tr_b16 a[32:33], v8 offset:8192
    ds_read_b64_tr_b16 a[34:35], v8 offset:8448
    ds_read_b64_tr_b16 a[36:37], v8 offset:8200
    ds_read_b64_tr_b16 a[38:39], v8 offset:8456
    ds_read_b64_tr_b16 a[40:41], v8 offset:10240
    ds_read_b64_tr_b16 a[42:43], v8 offset:10496
    ds_read_b64_tr_b16 a[44:45], v8 offset:10248
    ds_read_b64_tr_b16 a[46:47], v8 offset:10504
    s_waitcnt lgkmcnt(7)
    ds_read_b64_tr_b16 a[48:49], v8 offset:12288
    ds_read_b64_tr_b16 a[50:51], v8 offset:12544
    ds_read_b64_tr_b16 a[52:53], v8 offset:12296
    ds_read_b64_tr_b16 a[54:55], v8 offset:12552
    ds_read_b64_tr_b16 a[56:57], v8 offset:14336
    ds_read_b64_tr_b16 a[58:59], v8 offset:14592
    ds_read_b64_tr_b16 a[60:61], v8 offset:14344
    ds_read_b64_tr_b16 a[62:63], v8 offset:14600
    s_waitcnt lgkmcnt(7)
    s_waitcnt vmcnt(8)
    ds_read_b64_tr_b16 a[64:65], v8 offset:16384
    ds_read_b64_tr_b16 a[66:67], v8 offset:16640
    ds_read_b64_tr_b16 a[68:69], v8 offset:16392
    ds_read_b64_tr_b16 a[70:71], v8 offset:16648
    ds_read_b64_tr_b16 a[72:73], v8 offset:18432
    ds_read_b64_tr_b16 a[74:75], v8 offset:18688
    ds_read_b64_tr_b16 a[76:77], v8 offset:18440
    ds_read_b64_tr_b16 a[78:79], v8 offset:18696
    s_waitcnt lgkmcnt(7)
    ds_read_b64_tr_b16 a[80:81], v8 offset:20480
    ds_read_b64_tr_b16 a[82:83], v8 offset:20736
    ds_read_b64_tr_b16 a[84:85], v8 offset:20488
    ds_read_b64_tr_b16 a[86:87], v8 offset:20744
    ds_read_b64_tr_b16 a[88:89], v8 offset:22528
    ds_read_b64_tr_b16 a[90:91], v8 offset:22784
    ds_read_b64_tr_b16 a[92:93], v8 offset:22536
    ds_read_b64_tr_b16 a[94:95], v8 offset:22792
    s_waitcnt lgkmcnt(7)
    s_waitcnt vmcnt(0)
    ds_read_b64_tr_b16 a[96:97], v8 offset:24576
    ds_read_b64_tr_b16 a[98:99], v8 offset:24832
    ds_read_b64_tr_b16 a[100:101], v8 offset:24584
    ds_read_b64_tr_b16 a[102:103], v8 offset:24840
    ds_read_b64_tr_b16 a[104:105], v8 offset:26624
    ds_read_b64_tr_b16 a[106:107], v8 offset:26880
    ds_read_b64_tr_b16 a[108:109], v8 offset:26632
    ds_read_b64_tr_b16 a[110:111], v8 offset:26888
    s_waitcnt lgkmcnt(7)
    ds_read_b64_tr_b16 a[112:113], v8 offset:28672
    ds_read_b64_tr_b16 a[114:115], v8 offset:28928
    ds_read_b64_tr_b16 a[116:117], v8 offset:28680
    ds_read_b64_tr_b16 a[118:119], v8 offset:28936
    ds_read_b64_tr_b16 a[120:121], v8 offset:30720
    ds_read_b64_tr_b16 a[122:123], v8 offset:30976
    ds_read_b64_tr_b16 a[124:125], v8 offset:30728
    ds_read_b64_tr_b16 a[126:127], v8 offset:30984
    s_waitcnt lgkmcnt(7)
    s_waitcnt lgkmcnt(0)
    s_add_u32 m0, s18, 0
    s_nop 0
    buffer_load_dwordx4 v7, s[12:15], s20 offen lds
    s_add_u32 s20, s20, 131072
    s_add_u32 m0, s18, 1024
    s_nop 0
    buffer_load_dwordx4 v7, s[12:15], s20 offen lds
    s_add_u32 s20, s20, 131072
    s_add_u32 m0, s18, 2048
    s_nop 0
    buffer_load_dwordx4 v7, s[12:15], s20 offen lds
    s_add_u32 s20, s20, 131072
    s_add_u32 m0, s18, 3072
    s_nop 0
    buffer_load_dwordx4 v7, s[12:15], s20 offen lds
    s_add_u32 s20, s20, 131072
    s_add_u32 m0, s18, 4096
    s_nop 0
    buffer_load_dwordx4 v7, s[12:15], s20 offen lds
    s_add_u32 s20, s20, 131072
    s_add_u32 m0, s18, 5120
    s_nop 0
    buffer_load_dwordx4 v7, s[12:15], s20 offen lds
    s_add_u32 s20, s20, 131072
    s_add_u32 m0, s18, 6144
    s_nop 0
    buffer_load_dwordx4 v7, s[12:15], s20 offen lds
    s_add_u32 s20, s20, 131072
    s_add_u32 m0, s18, 7168
    s_nop 0
    buffer_load_dwordx4 v7, s[12:15], s20 offen lds
    s_add_u32 s20, s20, 131072
    s_add_u32 m0, s18, 8192
    s_nop 0
    buffer_load_dwordx4 v7, s[12:15], s20 offen lds
    s_add_u32 s20, s20, 131072
    s_add_u32 m0, s18, 9216
    s_nop 0
    buffer_load_dwordx4 v7, s[12:15], s20 offen lds
    s_add_u32 s20, s20, 131072
    s_add_u32 m0, s18, 10240
    s_nop 0
    buffer_load_dwordx4 v7, s[12:15], s20 offen lds
    s_add_u32 s20, s20, 131072
    s_add_u32 m0, s18, 11264
    s_nop 0
    buffer_load_dwordx4 v7, s[12:15], s20 offen lds
    s_add_u32 s20, s20, 131072
    s_add_u32 m0, s18, 12288
    s_nop 0
    buffer_load_dwordx4 v7, s[12:15], s20 offen lds
    s_add_u32 s20, s20, 131072
    s_add_u32 m0, s18, 13312
    s_nop 0
    buffer_load_dwordx4 v7, s[12:15], s20 offen lds
    s_add_u32 s20, s20, 131072
    s_add_u32 m0, s18, 14336
    s_nop 0
    buffer_load_dwordx4 v7, s[12:15], s20 offen lds
    s_add_u32 s20, s20, 131072
    s_add_u32 m0, s18, 15360
    s_nop 0
    buffer_load_dwordx4 v7, s[12:15], s20 offen lds
    s_add_u32 s20, s20, 131072
    s_add_u32 m0, s18, 16384
    s_nop 0
    buffer_load_dwordx4 v7, s[12:15], s20 offen lds
    s_add_u32 s20, s20, 131072
    s_add_u32 m0, s18, 17408
    s_nop 0
    buffer_load_dwordx4 v7, s[12:15], s20 offen lds
    s_add_u32 s20, s20, 131072
    s_add_u32 m0, s18, 18432
    s_nop 0
    buffer_load_dwordx4 v7, s[12:15], s20 offen lds
    s_add_u32 s20, s20, 131072
    s_add_u32 m0, s18, 19456
    s_nop 0
    buffer_load_dwordx4 v7, s[12:15], s20 offen lds
    s_add_u32 s20, s20, 131072
    s_add_u32 m0, s18, 20480
    s_nop 0
    buffer_load_dwordx4 v7, s[12:15], s20 offen lds
    s_add_u32 s20, s20, 131072
    s_add_u32 m0, s18, 21504
    s_nop 0
    buffer_load_dwordx4 v7, s[12:15], s20 offen lds
    s_add_u32 s20, s20, 131072
    s_add_u32 m0, s18, 22528
    s_nop 0
    buffer_load_dwordx4 v7, s[12:15], s20 offen lds
    s_add_u32 s20, s20, 131072
    s_add_u32 m0, s18, 23552
    s_nop 0
    buffer_load_dwordx4 v7, s[12:15], s20 offen lds
    s_add_u32 s20, s20, 131072
    s_add_u32 m0, s18, 24576
    s_nop 0
    buffer_load_dwordx4 v7, s[12:15], s20 offen lds
    s_add_u32 s20, s20, 131072
    s_add_u32 m0, s18, 25600
    s_nop 0
    buffer_load_dwordx4 v7, s[12:15], s20 offen lds
    s_add_u32 s20, s20, 131072
    s_add_u32 m0, s18, 26624
    s_nop 0
    buffer_load_dwordx4 v7, s[12:15], s20 offen lds
    s_add_u32 s20, s20, 131072
    s_add_u32 m0, s18, 27648
    s_nop 0
    buffer_load_dwordx4 v7, s[12:15], s20 offen lds
    s_add_u32 s20, s20, 131072
    s_add_u32 m0, s18, 28672
    s_nop 0
    buffer_load_dwordx4 v7, s[12:15], s20 offen lds
    s_add_u32 s20, s20, 131072
    s_add_u32 m0, s18, 29696
    s_nop 0
    buffer_load_dwordx4 v7, s[12:15], s20 offen lds
    s_add_u32 s20, s20, 131072
    s_add_u32 m0, s18, 30720
    s_nop 0
    buffer_load_dwordx4 v7, s[12:15], s20 offen lds
    s_add_u32 s20, s20, 131072
    s_add_u32 m0, s18, 31744
    s_nop 0
    buffer_load_dwordx4 v7, s[12:15], s20 offen lds
    s_add_u32 s20, s20, 131072
    s_waitcnt vmcnt(24)
    ds_read_b64_tr_b16 a[128:129], v8 offset:0
    ds_read_b64_tr_b16 a[130:131], v8 offset:256
    ds_read_b64_tr_b16 a[132:133], v8 offset:8
    ds_read_b64_tr_b16 a[134:135], v8 offset:264
    ds_read_b64_tr_b16 a[136:137], v8 offset:2048
    ds_read_b64_tr_b16 a[138:139], v8 offset:2304
    ds_read_b64_tr_b16 a[140:141], v8 offset:2056
    ds_read_b64_tr_b16 a[142:143], v8 offset:2312
    s_waitcnt lgkmcnt(7)
    ds_read_b64_tr_b16 a[144:145], v8 offset:4096
    ds_read_b64_tr_b16 a[146:147], v8 offset:4352
    ds_read_b64_tr_b16 a[148:149], v8 offset:4104
    ds_read_b64_tr_b16 a[150:151], v8 offset:4360
    ds_read_b64_tr_b16 a[152:153], v8 offset:6144
    ds_read_b64_tr_b16 a[154:155], v8 offset:6400
    ds_read_b64_tr_b16 a[156:157], v8 offset:6152
    ds_read_b64_tr_b16 a[158:159], v8 offset:6408
    s_waitcnt lgkmcnt(7)
    s_waitcnt vmcnt(16)
    ds_read_b64_tr_b16 a[160:161], v8 offset:8192
    ds_read_b64_tr_b16 a[162:163], v8 offset:8448
    ds_read_b64_tr_b16 a[164:165], v8 offset:8200
    ds_read_b64_tr_b16 a[166:167], v8 offset:8456
    ds_read_b64_tr_b16 a[168:169], v8 offset:10240
    ds_read_b64_tr_b16 a[170:171], v8 offset:10496
    ds_read_b64_tr_b16 a[172:173], v8 offset:10248
    ds_read_b64_tr_b16 a[174:175], v8 offset:10504
    s_waitcnt lgkmcnt(7)
    ds_read_b64_tr_b16 a[176:177], v8 offset:12288
    ds_read_b64_tr_b16 a[178:179], v8 offset:12544
    ds_read_b64_tr_b16 a[180:181], v8 offset:12296
    ds_read_b64_tr_b16 a[182:183], v8 offset:12552
    ds_read_b64_tr_b16 a[184:185], v8 offset:14336
    ds_read_b64_tr_b16 a[186:187], v8 offset:14592
    ds_read_b64_tr_b16 a[188:189], v8 offset:14344
    ds_read_b64_tr_b16 a[190:191], v8 offset:14600
    s_waitcnt lgkmcnt(7)
    s_waitcnt vmcnt(8)
    ds_read_b64_tr_b16 a[192:193], v8 offset:16384
    ds_read_b64_tr_b16 a[194:195], v8 offset:16640
    ds_read_b64_tr_b16 a[196:197], v8 offset:16392
    ds_read_b64_tr_b16 a[198:199], v8 offset:16648
    ds_read_b64_tr_b16 a[200:201], v8 offset:18432
    ds_read_b64_tr_b16 a[202:203], v8 offset:18688
    ds_read_b64_tr_b16 a[204:205], v8 offset:18440
    ds_read_b64_tr_b16 a[206:207], v8 offset:18696
    s_waitcnt lgkmcnt(7)
    ds_read_b64_tr_b16 a[208:209], v8 offset:20480
    ds_read_b64_tr_b16 a[210:211], v8 offset:20736
    ds_read_b64_tr_b16 a[212:213], v8 offset:20488
    ds_read_b64_tr_b16 a[214:215], v8 offset:20744
    ds_read_b64_tr_b16 a[216:217], v8 offset:22528
    ds_read_b64_tr_b16 a[218:219], v8 offset:22784
    ds_read_b64_tr_b16 a[220:221], v8 offset:22536
    ds_read_b64_tr_b16 a[222:223], v8 offset:22792
    s_waitcnt lgkmcnt(7)
    s_waitcnt vmcnt(0)
    ds_read_b64_tr_b16 a[224:225], v8 offset:24576
    ds_read_b64_tr_b16 a[226:227], v8 offset:24832
    ds_read_b64_tr_b16 a[228:229], v8 offset:24584
    ds_read_b64_tr_b16 a[230:231], v8 offset:24840
    ds_read_b64_tr_b16 a[232:233], v8 offset:26624
    ds_read_b64_tr_b16 a[234:235], v8 offset:26880
    ds_read_b64_tr_b16 a[236:237], v8 offset:26632
    ds_read_b64_tr_b16 a[238:239], v8 offset:26888
    s_waitcnt lgkmcnt(7)
    ds_read_b64_tr_b16 a[240:241], v8 offset:28672
    ds_read_b64_tr_b16 a[242:243], v8 offset:28928
    ds_read_b64_tr_b16 a[244:245], v8 offset:28680
    ds_read_b64_tr_b16 a[246:247], v8 offset:28936
    ds_read_b64_tr_b16 a[248:249], v8 offset:30720
    ds_read_b64_tr_b16 a[250:251], v8 offset:30976
    ds_read_b64_tr_b16 a[252:253], v8 offset:30728
    ds_read_b64_tr_b16 a[254:255], v8 offset:30984
    s_waitcnt lgkmcnt(7)
    s_waitcnt lgkmcnt(0)
    v_lshlrev_b32 v5, 2, v1
    s_mov_b32 s18, 0
rdv_11:
    global_load_dword v6, v5, s[100:101] sc1
    s_lshl_b32 s17, s98, 2
    s_waitcnt vmcnt(0)
    v_lshrrev_b32 v7, s17, v6
    s_cmp_eq_u32 s98, 0
    s_cselect_b32 s17, 0x0f0f0f0f, s17
    s_cselect_b32 s17, s17, 0x01010101
    v_and_b32 v7, s17, v7
    v_cmp_ne_u32 vcc, 0x01010101, v7
    s_nop 0
    s_cbranch_vccz rdvok_12
    v_sad_u8 v7, v7, 0, 0
    s_nop 1
    v_add_u32_dpp v7, v7, v7 quad_perm:[1,0,3,2] row_mask:0xf bank_mask:0xf
    v_cmp_ne_u32 vcc, 8, v7
    s_nop 0
    s_cbranch_vccnz rdvw_13
    s_mov_b32 s98, 1
    s_and_b32 s3, s97, 7
    s_barrier
    s_branch role_start
rdvw_13:
    s_sleep 4
    s_add_u32 s18, s18, 1
    s_cmp_lt_u32 s18, 262144
    s_cbranch_scc1 rdv_11
    s_mov_b32 s92, 1048576
rdvok_12:
    v_and_b32 v5, 15, v1
    v_bfe_u32 v6, v1, 1, 3
    v_lshrrev_b32 v7, 4, v1
    v_xor_b32 v6, v6, v7
    v_lshlrev_b32 v6, 4, v6
    v_lshl_add_u32 v10, v5, 7, v6
    s_lshl_b32 s19, s16, 10
    v_xor_b32 v11, 64, v10
    v_add_u32 v12, 0x10000, v10
    v_add_u32 v13, 0x10000, v11
    v_lshrrev_b32 v7, 3, v1
    s_lshl_b32 s17, s16, 3
    v_add_u32 v7, s17, v7
    v_bfe_u32 v8, v7, 1, 3
    v_xor_b32 v8, v8, v1
    v_and_b32 v8, 7, v8
    v_bfe_u32 v5, v7, 2, 2
    v_and_b32 v2, 3, v7
    v_lshl_add_u32 v2, v5, 3, v2
    v_bfe_u32 v5, v7, 4, 1
    v_lshl_add_u32 v2, v5, 2, v2
    v_bfe_u32 v5, v1, 2, 2
    v_and_b32 v3, 3, v1
    v_lshl_add_u32 v3, v5, 3, v3
    v_lshlrev_b32 v2, 11, v2
    v_lshl_add_u32 v2, v8, 4, v2
    v_and_b32 v5, 48, v1
    v_lshl_add_u32 v3, v3, 6, v5
    s_mul_i32 s21, s28, 133120
    s_mul_i32 s18, s90, 17825792
    s_add_u32 s21, s21, s18
    s_lshl_b32 s18, s90, 7
    s_add_u32 s17, s28, s18
    s_lshl_b32 s17, s17, 7
    s_add_u32 s17, s17, 100663296
    v_mov_b32 v4, s17
    v_mov_b32 v5, 1073741824
    v_cmp_eq_u32 vcc, 0, v1
    s_nop 1
    v_cndmask_b32 v4, v5, v4, vcc
    s_mov_b32 s20, 0
    s_mov_b32 s24, 65536
    s_mov_b32 s25, 2048
    s_barrier
    s_cmp_eq_u32 s90, 2
    s_cbranch_scc1 P_v
    s_mov_b32 s26, s25
    s_sub_u32 s25, s21, 1073741824
    s_mov_b32 s21, 1073741824
    s_mov_b32 s23, 0
    s_mov_b32 s22, 0
    s_add_u32 m0, s19, 0
    s_nop 0
    buffer_load_dwordx4 v2, s[8:11], s20 offen offset:0 lds
    s_add_u32 m0, s19, 3968
    s_nop 0
    buffer_load_dwordx4 v2, s[8:11], s20 offen offset:128 lds
    s_add_u32 m0, s19, 7936
    s_nop 0
    buffer_load_dwordx4 v2, s[8:11], s20 offen offset:256 lds
    s_add_u32 m0, s19, 11904
    s_nop 0
    buffer_load_dwordx4 v2, s[8:11], s20 offen offset:384 lds
    s_add_u32 m0, s19, 15872
    s_nop 0
    buffer_load_dwordx4 v2, s[8:11], s20 offen offset:512 lds
    s_add_u32 m0, s19, 19840
    s_nop 0
    buffer_load_dwordx4 v2, s[8:11], s20 offen offset:640 lds
    s_add_u32 m0, s19, 23808
    s_nop 0
    buffer_load_dwordx4 v2, s[8:11], s20 offen offset:768 lds
    s_add_u32 m0, s19, 27776
    s_nop 0
    buffer_load_dwordx4 v2, s[8:11], s20 offen offset:896 lds
    s_add_u32 m0, s19, 31744
    s_nop 0
    buffer_load_dwordx4 v2, s[8:11], s20 offen offset:1024 lds
    s_add_u32 m0, s19, 35712
    s_nop 0
    buffer_load_dwordx4 v2, s[8:11], s20 offen offset:1152 lds
    s_add_u32 m0, s19, 39680
    s_nop 0
    buffer_load_dwordx4 v2, s[8:11], s20 offen offset:1280 lds
    s_add_u32 m0, s19, 43648
    s_nop 0
    buffer_load_dwordx4 v2, s[8:11], s20 offen offset:1408 lds
    s_add_u32 m0, s19, 47616
    s_nop 0
    buffer_load_dwordx4 v2, s[8:11], s20 offen offset:1536 lds
    s_add_u32 m0, s19, 51584
    s_nop 0
    buffer_load_dwordx4 v2, s[8:11], s20 offen offset:1664 lds
    s_add_u32 m0, s19, 55552
    s_nop 0
    buffer_load_dwordx4 v2, s[8:11], s20 offen offset:1792 lds
    s_add_u32 m0, s19, 59520
    s_nop 0
    buffer_load_dwordx4 v2, s[8:11], s20 offen offset:1920 lds
    s_add_u32 s20, s20, s24
    s_add_u32 m0, s19, 65536
    s_nop 0
    buffer_load_dwordx4 v2, s[8:11], s20 offen offset:0 lds
    s_add_u32 m0, s19, 69504
    s_nop 0
    buffer_load_dwordx4 v2, s[8:11], s20 offen offset:128 lds
    s_add_u32 m0, s19, 73472
    s_nop 0
    buffer_load_dwordx4 v2, s[8:11], s20 offen offset:256 lds
    v_mov_b32 v9, s23
    s_add_u32 s23, s23, 1
    buffer_store_dword v9, v4, s[4:7], 0 offen sc1
    s_mov_b32 s23, 0
    s_waitcnt vmcnt(12)
    s_barrier
    ds_read_b128 v[20:23], v10 offset:0
    ds_read_b128 v[24:27], v10 offset:2048
    ds_read_b128 v[28:31], v11 offset:0
    ds_read_b128 v[32:35], v11 offset:2048
    ds_read_b128 v[36:39], v10 offset:4096
    ds_read_b128 v[40:43], v10 offset:6144
    ds_read_b128 v[44:47], v11 offset:4096
.p2align 6
P_qk_top:
    s_waitcnt lgkmcnt(6)
    v_mfma_f32_16x16x32_bf16 v[52:55], a[0:3], v[20:23], 0
    ds_read_b128 v[48:51], v11 offset:6144
    v_mfma_f32_16x16x32_bf16 v[56:59], a[4:7], v[20:23], 0
    s_waitcnt lgkmcnt(6)
    v_mfma_f32_16x16x32_bf16 v[60:63], a[0:3], v[24:27], 0
    ds_read_b128 v[20:23], v10 offset:8192
    s_add_u32 m0, s19, 77440
    v_mfma_f32_16x16x32_bf16 v[64:67], a[4:7], v[24:27], 0
    buffer_load_dwordx4 v2, s[8:11], s20 offen offset:384 lds
    s_waitcnt lgkmcnt(6)
    v_mfma_f32_16x16x32_bf16 v[52:55], a[8:11], v[28:31], v[52:55]
    ds_read_b128 v[24:27], v10 offset:10240
    v_mfma_f32_16x16x32_bf16 v[56:59], a[12:15], v[28:31], v[56:59]
    s_waitcnt lgkmcnt(6)
    v_mfma_f32_16x16x32_bf16 v[60:63], a[8:11], v[32:35], v[60:63]
    ds_read_b128 v[28:31], v11 offset:8192
    s_add_u32 m0, s19, 81408
    v_mfma_f32_16x16x32_bf16 v[64:67], a[12:15], v[32:35], v[64:67]
    buffer_load_dwordx4 v2, s[8:11], s20 offen offset:512 lds
    s_waitcnt lgkmcnt(6)
    v_mfma_f32_16x16x32_bf16 v[52:55], a[16:19], v[36:39], v[52:55]
    ds_read_b128 v[32:35], v11 offset:10240
    v_mfma_f32_16x16x32_bf16 v[56:59], a[20:23], v[36:39], v[56:59]
    s_waitcnt lgkmcnt(6)
    v_mfma_f32_16x16x32_bf16 v[60:63], a[16:19], v[40:43], v[60:63]
    ds_read_b128 v[36:39], v10 offset:12288
    s_add_u32 m0, s19, 85376
    v_mfma_f32_16x16x32_bf16 v[64:67], a[20:23], v[40:43], v[64:67]
    buffer_load_dwordx4 v2, s[8:11], s20 offen offset:640 lds
    s_waitcnt lgkmcnt(6)
    v_mfma_f32_16x16x32_bf16 v[52:55], a[24:27], v[44:47], v[52:55]
    ds_read_b128 v[40:43], v10 offset:14336
    v_mfma_f32_16x16x32_bf16 v[56:59], a[28:31], v[44:47], v[56:59]
    s_waitcnt lgkmcnt(6)
    v_mfma_f32_16x16x32_bf16 v[60:63], a[24:27], v[48:51], v[60:63]
    ds_read_b128 v[44:47], v11 offset:12288
    s_add_u32 m0, s19, 89344
    v_mfma_f32_16x16x32_bf16 v[64:67], a[28:31], v[48:51], v[64:67]
    buffer_load_dwordx4 v2, s[8:11], s20 offen offset:768 lds
    s_waitcnt lgkmcnt(6)
    v_mfma_f32_16x16x32_bf16 v[52:55], a[32:35], v[20:23], v[52:55]
    ds_read_b128 v[48:51], v11 offset:14336
    v_mfma_f32_16x16x32_bf16 v[56:59], a[36:39], v[20:23], v[56:59]
    s_waitcnt lgkmcnt(6)
    v_mfma_f32_16x16x32_bf16 v[60:63], a[32:35], v[24:27], v[60:63]
    ds_read_b128 v[20:23], v10 offset:16384
    s_add_u32 m0, s19, 93312
    v_mfma_f32_16x16x32_bf16 v[64:67], a[36:39], v[24:27], v[64:67]
    buffer_load_dwordx4 v2, s[8:11], s20 offen offset:896 lds
    s_waitcnt lgkmcnt(6)
    v_mfma_f32_16x16x32_bf16 v[52:55], a[40:43], v[28:31], v[52:55]
    ds_read_b128 v[24:27], v10 offset:18432
    v_mfma_f32_16x16x32_bf16 v[56:59], a[44:47], v[28:31], v[56:59]
    v_cvt_pk_bf16_f32 v84, v68, v69
    s_waitcnt lgkmcnt(6)
    v_mfma_f32_16x16x32_bf16 v[60:63], a[40:43], v[32:35], v[60:63]
    ds_read_b128 v[28:31], v11 offset:16384
    v_mfma_f32_16x16x32_bf16 v[64:67], a[44:47], v[32:35], v[64:67]
    v_cvt_pk_bf16_f32 v85, v70, v71
    s_waitcnt lgkmcnt(6)
    v_mfma_f32_16x16x32_bf16 v[52:55], a[48:51], v[36:39], v[52:55]
    ds_read_b128 v[32:35], v11 offset:18432
    v_mfma_f32_16x16x32_bf16 v[56:59], a[52:55], v[36:39], v[56:59]
    v_cvt_pk_bf16_f32 v86, v72, v73
    s_waitcnt lgkmcnt(6)
    v_mfma_f32_16x16x32_bf16 v[60:63], a[48:51], v[40:43], v[60:63]
    ds_read_b128 v[36:39], v10 offset:20480
    v_mfma_f32_16x16x32_bf16 v[64:67], a[52:55], v[40:43], v[64:67]
    v_cvt_pk_bf16_f32 v87, v74, v75
    s_waitcnt lgkmcnt(6)
    v_mfma_f32_16x16x32_bf16 v[52:55], a[56:59], v[44:47], v[52:55]
    ds_read_b128 v[40:43], v10 offset:22528
    v_mfma_f32_16x16x32_bf16 v[56:59], a[60:63], v[44:47], v[56:59]
    v_cvt_pk_bf16_f32 v88, v76, v77
    s_waitcnt lgkmcnt(6)
    v_mfma_f32_16x16x32_bf16 v[60:63], a[56:59], v[48:51], v[60:63]
    ds_read_b128 v[44:47], v11 offset:20480
    v_mfma_f32_16x16x32_bf16 v[64:67], a[60:63], v[48:51], v[64:67]
    v_cvt_pk_bf16_f32 v89, v78, v79
    buffer_store_dwordx4 v[84:87], v3, s[4:7], s21 offen offset:0 sc1
    s_waitcnt lgkmcnt(6)
    v_mfma_f32_16x16x32_bf16 v[52:55], a[64:67], v[20:23], v[52:55]
    ds_read_b128 v[48:51], v11 offset:22528
    v_mfma_f32_16x16x32_bf16 v[56:59], a[68:71], v[20:23], v[56:59]
    v_cvt_pk_bf16_f32 v90, v80, v81
    s_waitcnt lgkmcnt(6)
    v_mfma_f32_16x16x32_bf16 v[60:63], a[64:67], v[24:27], v[60:63]
    ds_read_b128 v[20:23], v10 offset:24576
    v_mfma_f32_16x16x32_bf16 v[64:67], a[68:71], v[24:27], v[64:67]
    v_cvt_pk_bf16_f32 v91, v82, v83
    s_waitcnt lgkmcnt(6)
    v_mfma_f32_16x16x32_bf16 v[52:55], a[72:75], v[28:31], v[52:55]
    ds_read_b128 v[24:27], v10 offset:26624
    v_mfma_f32_16x16x32_bf16 v[56:59], a[76:79], v[28:31], v[56:59]
    s_waitcnt lgkmcnt(6)
    v_mfma_f32_16x16x32_bf16 v[60:63], a[72:75], v[32:35], v[60:63]
    ds_read_b128 v[28:31], v11 offset:24576
    v_mfma_f32_16x16x32_bf16 v[64:67], a[76:79], v[32:35], v[64:67]
    buffer_store_dwordx4 v[88:91], v3, s[4:7], s21 offen offset:256 sc1
    s_waitcnt lgkmcnt(6)
    v_mfma_f32_16x16x32_bf16 v[52:55], a[80:83], v[36:39], v[52:55]
    ds_read_b128 v[32:35], v11 offset:26624
    v_mfma_f32_16x16x32_bf16 v[56:59], a[84:87], v[36:39], v[56:59]
    s_add_u32 s21, s21, s25
    s_mov_b32 s25, s26
    s_waitcnt lgkmcnt(6)
    v_mfma_f32_16x16x32_bf16 v[60:63], a[80:83], v[40:43], v[60:63]
    ds_read_b128 v[36:39], v10 offset:28672
    v_mfma_f32_16x16x32_bf16 v[64:67], a[84:87], v[40:43], v[64:67]
    s_waitcnt lgkmcnt(6)
    v_mfma_f32_16x16x32_bf16 v[52:55], a[88:91], v[44:47], v[52:55]
    ds_read_b128 v[40:43], v10 offset:30720
    v_mfma_f32_16x16x32_bf16 v[56:59], a[92:95], v[44:47], v[56:59]
    s_waitcnt lgkmcnt(6)
    v_mfma_f32_16x16x32_bf16 v[60:63], a[88:91], v[48:51], v[60:63]
    ds_read_b128 v[44:47], v11 offset:28672
    v_mfma_f32_16x16x32_bf16 v[64:67], a[92:95], v[48:51], v[64:67]
    s_waitcnt lgkmcnt(6)
    v_mfma_f32_16x16x32_bf16 v[52:55], a[96:99], v[20:23], v[52:55]
    ds_read_b128 v[48:51], v11 offset:30720
    v_mfma_f32_16x16x32_bf16 v[56:59], a[100:103], v[20:23], v[56:59]
    s_waitcnt lgkmcnt(6)
    v_mfma_f32_16x16x32_bf16 v[60:63], a[96:99], v[24:27], v[60:63]
    s_waitcnt vmcnt(11)
    s_barrier
    ds_read_b128 v[20:23], v10 offset:32768
    v_mfma_f32_16x16x32_bf16 v[64:67], a[100:103], v[24:27], v[64:67]
    s_waitcnt lgkmcnt(6)
    v_mfma_f32_16x16x32_bf16 v[52:55], a[104:107], v[28:31], v[52:55]
    ds_read_b128 v[24:27], v10 offset:34816
    s_add_u32 m0, s19, 97280
    v_mfma_f32_16x16x32_bf16 v[56:59], a[108:111], v[28:31], v[56:59]
    buffer_load_dwordx4 v2, s[8:11], s20 offen offset:1024 lds
    s_waitcnt lgkmcnt(6)
    v_mfma_f32_16x16x32_bf16 v[60:63], a[104:107], v[32:35], v[60:63]
    ds_read_b128 v[28:31], v11 offset:32768
    v_mfma_f32_16x16x32_bf16 v[64:67], a[108:111], v[32:35], v[64:67]
    s_waitcnt lgkmcnt(6)
    v_mfma_f32_16x16x32_bf16 v[52:55], a[112:115], v[36:39], v[52:55]
    ds_read_b128 v[32:35], v11 offset:34816
    s_add_u32 m0, s19, 101248
    v_mfma_f32_16x16x32_bf16 v[56:59], a[116:119], v[36:39], v[56:59]
    buffer_load_dwordx4 v2, s[8:11], s20 offen offset:1152 lds
    s_waitcnt lgkmcnt(6)
    v_mfma_f32_16x16x32_bf16 v[60:63], a[112:115], v[40:43], v[60:63]
    ds_read_b128 v[36:39], v10 offset:36864
    v_mfma_f32_16x16x32_bf16 v[64:67], a[116:119], v[40:43], v[64:67]
    s_waitcnt lgkmcnt(6)
    v_mfma_f32_16x16x32_bf16 v[52:55], a[120:123], v[44:47], v[52:55]
    ds_read_b128 v[40:43], v10 offset:38912
    s_add_u32 m0, s19, 105216
    v_mfma_f32_16x16x32_bf16 v[56:59], a[124:127], v[44:47], v[56:59]
    buffer_load_dwordx4 v2, s[8:11], s20 offen offset:1280 lds
    s_waitcnt lgkmcnt(6)
    v_mfma_f32_16x16x32_bf16 v[60:63], a[120:123], v[48:51], v[60:63]
    ds_read_b128 v[44:47], v11 offset:36864
    v_mfma_f32_16x16x32_bf16 v[64:67], a[124:127], v[48:51], v[64:67]
    s_waitcnt lgkmcnt(6)
    v_mfma_f32_16x16x32_bf16 v[52:55], a[128:131], v[20:23], v[52:55]
    ds_read_b128 v[48:51], v11 offset:38912
    v_mfma_f32_16x16x32_bf16 v[56:59], a[132:135], v[20:23], v[56:59]
    s_waitcnt lgkmcnt(6)
    v_mfma_f32_16x16x32_bf16 v[60:63], a[128:131], v[24:27], v[60:63]
    ds_read_b128 v[20:23], v10 offset:40960
    s_add_u32 m0, s19, 109184
    v_mfma_f32_16x16x32_bf16 v[64:67], a[132:135], v[24:27], v[64:67]
    buffer_load_dwordx4 v2, s[8:11], s20 offen offset:1408 lds
    s_waitcnt lgkmcnt(6)
    v_mfma_f32_16x16x32_bf16 v[52:55], a[136:139], v[28:31], v[52:55]
    ds_read_b128 v[24:27], v10 offset:43008
    v_mfma_f32_16x16x32_bf16 v[56:59], a[140:143], v[28:31], v[56:59]
    s_waitcnt lgkmcnt(6)
    v_mfma_f32_16x16x32_bf16 v[60:63], a[136:139], v[32:35], v[60:63]
    ds_read_b128 v[28:31], v11 offset:40960
    s_add_u32 m0, s19, 113152
    v_mfma_f32_16x16x32_bf16 v[64:67], a[140:143], v[32:35], v[64:67]
    buffer_load_dwordx4 v2, s[8:11], s20 offen offset:1536 lds
    s_waitcnt lgkmcnt(6)
    v_mfma_f32_16x16x32_bf16 v[52:55], a[144:147], v[36:39], v[52:55]
    ds_read_b128 v[32:35], v11 offset:43008
    v_mfma_f32_16x16x32_bf16 v[56:59], a[148:151], v[36:39], v[56:59]
    s_waitcnt lgkmcnt(6)
    v_mfma_f32_16x16x32_bf16 v[60:63], a[144:147], v[40:43], v[60:63]
    ds_read_b128 v[36:39], v10 offset:45056
    s_add_u32 m0, s19, 117120
    v_mfma_f32_16x16x32_bf16 v[64:67], a[148:151], v[40:43], v[64:67]
    buffer_load_dwordx4 v2, s[8:11], s20 offen offset:1664 lds
    s_waitcnt lgkmcnt(6)
    v_mfma_f32_16x16x32_bf16 v[52:55], a[152:155], v[44:47], v[52:55]
    ds_read_b128 v[40:43], v10 offset:47104
    v_mfma_f32_16x16x32_bf16 v[56:59], a[156:159], v[44:47], v[56:59]
    s_waitcnt lgkmcnt(6)
    v_mfma_f32_16x16x32_bf16 v[60:63], a[152:155], v[48:51], v[60:63]
    ds_read_b128 v[44:47], v11 offset:45056
    s_add_u32 m0, s19, 121088
    v_mfma_f32_16x16x32_bf16 v[64:67], a[156:159], v[48:51], v[64:67]
    buffer_load_dwordx4 v2, s[8:11], s20 offen offset:1792 lds
    s_waitcnt lgkmcnt(6)
    v_mfma_f32_16x16x32_bf16 v[52:55], a[160:163], v[20:23], v[52:55]
    ds_read_b128 v[48:51], v11 offset:47104
    v_mfma_f32_16x16x32_bf16 v[56:59], a[164:167], v[20:23], v[56:59]
    s_waitcnt lgkmcnt(6)
    v_mfma_f32_16x16x32_bf16 v[60:63], a[160:163], v[24:27], v[60:63]
    ds_read_b128 v[20:23], v10 offset:49152
    s_add_u32 m0, s19, 125056
    v_mfma_f32_16x16x32_bf16 v[64:67], a[164:167], v[24:27], v[64:67]
    buffer_load_dwordx4 v2, s[8:11], s20 offen offset:1920 lds
    s_waitcnt lgkmcnt(6)
    v_mfma_f32_16x16x32_bf16 v[52:55], a[168:171], v[28:31], v[52:55]
    ds_read_b128 v[24:27], v10 offset:51200
    v_mfma_f32_16x16x32_bf16 v[56:59], a[172:175], v[28:31], v[56:59]
    s_add_u32 s20, s20, s24
    s_waitcnt lgkmcnt(6)
    v_mfma_f32_16x16x32_bf16 v[60:63], a[168:171], v[32:35], v[60:63]
    ds_read_b128 v[28:31], v11 offset:49152
    v_mfma_f32_16x16x32_bf16 v[64:67], a[172:175], v[32:35], v[64:67]
    s_waitcnt lgkmcnt(6)
    v_mfma_f32_16x16x32_bf16 v[52:55], a[176:179], v[36:39], v[52:55]
    ds_read_b128 v[32:35], v11 offset:51200
    v_mfma_f32_16x16x32_bf16 v[56:59], a[180:183], v[36:39], v[56:59]
    s_waitcnt lgkmcnt(6)
    v_mfma_f32_16x16x32_bf16 v[60:63], a[176:179], v[40:43], v[60:63]
    ds_read_b128 v[36:39], v10 offset:53248
    v_mfma_f32_16x16x32_bf16 v[64:67], a[180:183], v[40:43], v[64:67]
    s_waitcnt lgkmcnt(6)
    v_mfma_f32_16x16x32_bf16 v[52:55], a[184:187], v[44:47], v[52:55]
    ds_read_b128 v[40:43], v10 offset:55296
    v_mfma_f32_16x16x32_bf16 v[56:59], a[188:191], v[44:47], v[56:59]
    s_waitcnt lgkmcnt(6)
    v_mfma_f32_16x16x32_bf16 v[60:63], a[184:187], v[48:51], v[60:63]
    ds_read_b128 v[44:47], v11 offset:53248
    v_mfma_f32_16x16x32_bf16 v[64:67], a[188:191], v[48:51], v[64:67]
    s_waitcnt lgkmcnt(6)
    v_mfma_f32_16x16x32_bf16 v[52:55], a[192:195], v[20:23], v[52:55]
    ds_read_b128 v[48:51], v11 offset:55296
    v_mfma_f32_16x16x32_bf16 v[56:59], a[196:199], v[20:23], v[56:59]
    s_waitcnt lgkmcnt(6)
    v_mfma_f32_16x16x32_bf16 v[60:63], a[192:195], v[24:27], v[60:63]
    ds_read_b128 v[20:23], v10 offset:57344
    v_mfma_f32_16x16x32_bf16 v[64:67], a[196:199], v[24:27], v[64:67]
    s_waitcnt lgkmcnt(6)
    v_mfma_f32_16x16x32_bf16 v[52:55], a[200:203], v[28:31], v[52:55]
    ds_read_b128 v[24:27], v10 offset:59392
    v_mfma_f32_16x16x32_bf16 v[56:59], a[204:207], v[28:31], v[56:59]
    s_waitcnt lgkmcnt(6)
    v_mfma_f32_16x16x32_bf16 v[60:63], a[200:203], v[32:35], v[60:63]
    ds_read_b128 v[28:31], v11 offset:57344
    v_mfma_f32_16x16x32_bf16 v[64:67], a[204:207], v[32:35], v[64:67]
    s_waitcnt lgkmcnt(6)
    v_mfma_f32_16x16x32_bf16 v[52:55], a[208:211], v[36:39], v[52:55]
    ds_read_b128 v[32:35], v11 offset:59392
    v_mfma_f32_16x16x32_bf16 v[56:59], a[212:215], v[36:39], v[56:59]
    s_waitcnt lgkmcnt(6)
    v_mfma_f32_16x16x32_bf16 v[60:63], a[208:211], v[40:43], v[60:63]
    ds_read_b128 v[36:39], v10 offset:61440
    v_mfma_f32_16x16x32_bf16 v[64:67], a[212:215], v[40:43], v[64:67]
    s_waitcnt lgkmcnt(6)
    v_mfma_f32_16x16x32_bf16 v[52:55], a[216:219], v[44:47], v[52:55]
    ds_read_b128 v[40:43], v10 offset:63488
    v_mfma_f32_16x16x32_bf16 v[56:59], a[220:223], v[44:47], v[56:59]
    s_waitcnt lgkmcnt(6)
    v_mfma_f32_16x16x32_bf16 v[60:63], a[216:219], v[48:51], v[60:63]
    ds_read_b128 v[44:47], v11 offset:61440
    v_mfma_f32_16x16x32_bf16 v[64:67], a[220:223], v[48:51], v[64:67]
    s_waitcnt lgkmcnt(6)
    v_mfma_f32_16x16x32_bf16 v[52:55], a[224:227], v[20:23], v[52:55]
    ds_read_b128 v[48:51], v11 offset:63488
    v_mfma_f32_16x16x32_bf16 v[56:59], a[228:231], v[20:23], v[56:59]
    s_waitcnt lgkmcnt(6)
    v_mfma_f32_16x16x32_bf16 v[60:63], a[224:227], v[24:27], v[60:63]
    s_waitcnt vmcnt(8)
    s_barrier
    ds_read_b128 v[20:23], v12 offset:0
    v_mfma_f32_16x16x32_bf16 v[64:67], a[228:231], v[24:27], v[64:67]
    s_waitcnt lgkmcnt(6)
    v_mfma_f32_16x16x32_bf16 v[52:55], a[232:235], v[28:31], v[52:55]
    ds_read_b128 v[24:27], v12 offset:2048
    s_add_u32 m0, s19, 0
    v_mfma_f32_16x16x32_bf16 v[56:59], a[236:239], v[28:31], v[56:59]
    buffer_load_dwordx4 v2, s[8:11], s20 offen offset:0 lds
    s_waitcnt lgkmcnt(6)
    v_mfma_f32_16x16x32_bf16 v[60:63], a[232:235], v[32:35], v[60:63]
    ds_read_b128 v[28:31], v13 offset:0
    v_mfma_f32_16x16x32_bf16 v[64:67], a[236:239], v[32:35], v[64:67]
    v_mov_b32 v9, s23
    s_add_u32 s23, s23, 1
    buffer_store_dword v9, v4, s[4:7], 0 offen sc1
    s_waitcnt lgkmcnt(6)
    v_mfma_f32_16x16x32_bf16 v[52:55], a[240:243], v[36:39], v[52:55]
    ds_read_b128 v[32:35], v13 offset:2048
    s_add_u32 m0, s19, 3968
    v_mfma_f32_16x16x32_bf16 v[56:59], a[244:247], v[36:39], v[56:59]
    buffer_load_dwordx4 v2, s[8:11], s20 offen offset:128 lds
    s_waitcnt lgkmcnt(6)
    v_mfma_f32_16x16x32_bf16 v[60:63], a[240:243], v[40:43], v[60:63]
    ds_read_b128 v[36:39], v12 offset:4096
    v_mfma_f32_16x16x32_bf16 v[64:67], a[244:247], v[40:43], v[64:67]
    s_waitcnt lgkmcnt(6)
    v_mfma_f32_16x16x32_bf16 v[52:55], a[248:251], v[44:47], v[52:55]
    ds_read_b128 v[40:43], v12 offset:6144
    s_add_u32 m0, s19, 7936
    v_mfma_f32_16x16x32_bf16 v[56:59], a[252:255], v[44:47], v[56:59]
    buffer_load_dwordx4 v2, s[8:11], s20 offen offset:256 lds
    s_waitcnt lgkmcnt(6)
    v_mfma_f32_16x16x32_bf16 v[60:63], a[248:251], v[48:51], v[60:63]
    ds_read_b128 v[44:47], v13 offset:4096
    v_mfma_f32_16x16x32_bf16 v[64:67], a[252:255], v[48:51], v[64:67]
    s_waitcnt lgkmcnt(6)
    v_mfma_f32_16x16x32_bf16 v[68:71], a[0:3], v[20:23], 0
    ds_read_b128 v[48:51], v13 offset:6144
    v_mfma_f32_16x16x32_bf16 v[72:75], a[4:7], v[20:23], 0
    s_waitcnt lgkmcnt(6)
    v_mfma_f32_16x16x32_bf16 v[76:79], a[0:3], v[24:27], 0
    ds_read_b128 v[20:23], v12 offset:8192
    s_add_u32 m0, s19, 11904
    v_mfma_f32_16x16x32_bf16 v[80:83], a[4:7], v[24:27], 0
    buffer_load_dwordx4 v2, s[8:11], s20 offen offset:384 lds
    s_waitcnt lgkmcnt(6)
    v_mfma_f32_16x16x32_bf16 v[68:71], a[8:11], v[28:31], v[68:71]
    ds_read_b128 v[24:27], v12 offset:10240
    v_mfma_f32_16x16x32_bf16 v[72:75], a[12:15], v[28:31], v[72:75]
    s_waitcnt lgkmcnt(6)
    v_mfma_f32_16x16x32_bf16 v[76:79], a[8:11], v[32:35], v[76:79]
    ds_read_b128 v[28:31], v13 offset:8192
    s_add_u32 m0, s19, 15872
    v_mfma_f32_16x16x32_bf16 v[80:83], a[12:15], v[32:35], v[80:83]
    buffer_load_dwordx4 v2, s[8:11], s20 offen offset:512 lds
    s_waitcnt lgkmcnt(6)
    v_mfma_f32_16x16x32_bf16 v[68:71], a[16:19], v[36:39], v[68:71]
    ds_read_b128 v[32:35], v13 offset:10240
    v_mfma_f32_16x16x32_bf16 v[72:75], a[20:23], v[36:39], v[72:75]
    s_waitcnt lgkmcnt(6)
    v_mfma_f32_16x16x32_bf16 v[76:79], a[16:19], v[40:43], v[76:79]
    ds_read_b128 v[36:39], v12 offset:12288
    s_add_u32 m0, s19, 19840
    v_mfma_f32_16x16x32_bf16 v[80:83], a[20:23], v[40:43], v[80:83]
    buffer_load_dwordx4 v2, s[8:11], s20 offen offset:640 lds
    s_waitcnt lgkmcnt(6)
    v_mfma_f32_16x16x32_bf16 v[68:71], a[24:27], v[44:47], v[68:71]
    ds_read_b128 v[40:43], v12 offset:14336
    v_mfma_f32_16x16x32_bf16 v[72:75], a[28:31], v[44:47], v[72:75]
    s_waitcnt lgkmcnt(6)
    v_mfma_f32_16x16x32_bf16 v[76:79], a[24:27], v[48:51], v[76:79]
    ds_read_b128 v[44:47], v13 offset:12288
    s_add_u32 m0, s19, 23808
    v_mfma_f32_16x16x32_bf16 v[80:83], a[28:31], v[48:51], v[80:83]
    buffer_load_dwordx4 v2, s[8:11], s20 offen offset:768 lds
    s_waitcnt lgkmcnt(6)
    v_mfma_f32_16x16x32_bf16 v[68:71], a[32:35], v[20:23], v[68:71]
    ds_read_b128 v[48:51], v13 offset:14336
    v_mfma_f32_16x16x32_bf16 v[72:75], a[36:39], v[20:23], v[72:75]
    s_waitcnt lgkmcnt(6)
    v_mfma_f32_16x16x32_bf16 v[76:79], a[32:35], v[24:27], v[76:79]
    ds_read_b128 v[20:23], v12 offset:16384
    s_add_u32 m0, s19, 27776
    v_mfma_f32_16x16x32_bf16 v[80:83], a[36:39], v[24:27], v[80:83]
    buffer_load_dwordx4 v2, s[8:11], s20 offen offset:896 lds
    s_waitcnt lgkmcnt(6)
    v_mfma_f32_16x16x32_bf16 v[68:71], a[40:43], v[28:31], v[68:71]
    ds_read_b128 v[24:27], v12 offset:18432
    v_mfma_f32_16x16x32_bf16 v[72:75], a[44:47], v[28:31], v[72:75]
    v_cvt_pk_bf16_f32 v84, v52, v53
    s_waitcnt lgkmcnt(6)
    v_mfma_f32_16x16x32_bf16 v[76:79], a[40:43], v[32:35], v[76:79]
    ds_read_b128 v[28:31], v13 offset:16384
    v_mfma_f32_16x16x32_bf16 v[80:83], a[44:47], v[32:35], v[80:83]
    v_cvt_pk_bf16_f32 v85, v54, v55
    s_waitcnt lgkmcnt(6)
    v_mfma_f32_16x16x32_bf16 v[68:71], a[48:51], v[36:39], v[68:71]
    ds_read_b128 v[32:35], v13 offset:18432
    v_mfma_f32_16x16x32_bf16 v[72:75], a[52:55], v[36:39], v[72:75]
    v_cvt_pk_bf16_f32 v86, v56, v57
    s_waitcnt lgkmcnt(6)
    v_mfma_f32_16x16x32_bf16 v[76:79], a[48:51], v[40:43], v[76:79]
    ds_read_b128 v[36:39], v12 offset:20480
    v_mfma_f32_16x16x32_bf16 v[80:83], a[52:55], v[40:43], v[80:83]
    v_cvt_pk_bf16_f32 v87, v58, v59
    s_waitcnt lgkmcnt(6)
    v_mfma_f32_16x16x32_bf16 v[68:71], a[56:59], v[44:47], v[68:71]
    ds_read_b128 v[40:43], v12 offset:22528
    v_mfma_f32_16x16x32_bf16 v[72:75], a[60:63], v[44:47], v[72:75]
    v_cvt_pk_bf16_f32 v88, v60, v61
    s_waitcnt lgkmcnt(6)
    v_mfma_f32_16x16x32_bf16 v[76:79], a[56:59], v[48:51], v[76:79]
    ds_read_b128 v[44:47], v13 offset:20480
    v_mfma_f32_16x16x32_bf16 v[80:83], a[60:63], v[48:51], v[80:83]
    v_cvt_pk_bf16_f32 v89, v62, v63
    buffer_store_dwordx4 v[84:87], v3, s[4:7], s21 offen offset:0 sc1
    s_waitcnt lgkmcnt(6)
    v_mfma_f32_16x16x32_bf16 v[68:71], a[64:67], v[20:23], v[68:71]
    ds_read_b128 v[48:51], v13 offset:22528
    v_mfma_f32_16x16x32_bf16 v[72:75], a[68:71], v[20:23], v[72:75]
    v_cvt_pk_bf16_f32 v90, v64, v65
    s_waitcnt lgkmcnt(6)
    v_mfma_f32_16x16x32_bf16 v[76:79], a[64:67], v[24:27], v[76:79]
    ds_read_b128 v[20:23], v12 offset:24576
    v_mfma_f32_16x16x32_bf16 v[80:83], a[68:71], v[24:27], v[80:83]
    v_cvt_pk_bf16_f32 v91, v66, v67
    s_waitcnt lgkmcnt(6)
    v_mfma_f32_16x16x32_bf16 v[68:71], a[72:75], v[28:31], v[68:71]
    ds_read_b128 v[24:27], v12 offset:26624
    v_mfma_f32_16x16x32_bf16 v[72:75], a[76:79], v[28:31], v[72:75]
    s_waitcnt lgkmcnt(6)
    v_mfma_f32_16x16x32_bf16 v[76:79], a[72:75], v[32:35], v[76:79]
    ds_read_b128 v[28:31], v13 offset:24576
    v_mfma_f32_16x16x32_bf16 v[80:83], a[76:79], v[32:35], v[80:83]
    buffer_store_dwordx4 v[88:91], v3, s[4:7], s21 offen offset:256 sc1
    s_waitcnt lgkmcnt(6)
    v_mfma_f32_16x16x32_bf16 v[68:71], a[80:83], v[36:39], v[68:71]
    ds_read_b128 v[32:35], v13 offset:26624
    v_mfma_f32_16x16x32_bf16 v[72:75], a[84:87], v[36:39], v[72:75]
    s_add_u32 s21, s21, s25
    s_mov_b32 s25, s26
    s_waitcnt lgkmcnt(6)
    v_mfma_f32_16x16x32_bf16 v[76:79], a[80:83], v[40:43], v[76:79]
    ds_read_b128 v[36:39], v12 offset:28672
    v_mfma_f32_16x16x32_bf16 v[80:83], a[84:87], v[40:43], v[80:83]
    s_waitcnt lgkmcnt(6)
    v_mfma_f32_16x16x32_bf16 v[68:71], a[88:91], v[44:47], v[68:71]
    ds_read_b128 v[40:43], v12 offset:30720
    v_mfma_f32_16x16x32_bf16 v[72:75], a[92:95], v[44:47], v[72:75]
    s_waitcnt lgkmcnt(6)
    v_mfma_f32_16x16x32_bf16 v[76:79], a[88:91], v[48:51], v[76:79]
    ds_read_b128 v[44:47], v13 offset:28672
    v_mfma_f32_16x16x32_bf16 v[80:83], a[92:95], v[48:51], v[80:83]
    s_waitcnt lgkmcnt(6)
    v_mfma_f32_16x16x32_bf16 v[68:71], a[96:99], v[20:23], v[68:71]
    ds_read_b128 v[48:51], v13 offset:30720
    v_mfma_f32_16x16x32_bf16 v[72:75], a[100:103], v[20:23], v[72:75]
    s_waitcnt lgkmcnt(6)
    v_mfma_f32_16x16x32_bf16 v[76:79], a[96:99], v[24:27], v[76:79]
    s_waitcnt vmcnt(11)
    s_barrier
    ds_read_b128 v[20:23], v12 offset:32768
    v_mfma_f32_16x16x32_bf16 v[80:83], a[100:103], v[24:27], v[80:83]
    s_waitcnt lgkmcnt(6)
    v_mfma_f32_16x16x32_bf16 v[68:71], a[104:107], v[28:31], v[68:71]
    ds_read_b128 v[24:27], v12 offset:34816
    s_add_u32 m0, s19, 31744
    v_mfma_f32_16x16x32_bf16 v[72:75], a[108:111], v[28:31], v[72:75]
    buffer_load_dwordx4 v2, s[8:11], s20 offen offset:1024 lds
    s_waitcnt lgkmcnt(6)
    v_mfma_f32_16x16x32_bf16 v[76:79], a[104:107], v[32:35], v[76:79]
    ds_read_b128 v[28:31], v13 offset:32768
    v_mfma_f32_16x16x32_bf16 v[80:83], a[108:111], v[32:35], v[80:83]
    s_waitcnt lgkmcnt(6)
    v_mfma_f32_16x16x32_bf16 v[68:71], a[112:115], v[36:39], v[68:71]
    ds_read_b128 v[32:35], v13 offset:34816
    s_add_u32 m0, s19, 35712
    v_mfma_f32_16x16x32_bf16 v[72:75], a[116:119], v[36:39], v[72:75]
    buffer_load_dwordx4 v2, s[8:11], s20 offen offset:1152 lds
    s_waitcnt lgkmcnt(6)
    v_mfma_f32_16x16x32_bf16 v[76:79], a[112:115], v[40:43], v[76:79]
    ds_read_b128 v[36:39], v12 offset:36864
    v_mfma_f32_16x16x32_bf16 v[80:83], a[116:119], v[40:43], v[80:83]
    s_waitcnt lgkmcnt(6)
    v_mfma_f32_16x16x32_bf16 v[68:71], a[120:123], v[44:47], v[68:71]
    ds_read_b128 v[40:43], v12 offset:38912
    s_add_u32 m0, s19, 39680
    v_mfma_f32_16x16x32_bf16 v[72:75], a[124:127], v[44:47], v[72:75]
    buffer_load_dwordx4 v2, s[8:11], s20 offen offset:1280 lds
    s_waitcnt lgkmcnt(6)
    v_mfma_f32_16x16x32_bf16 v[76:79], a[120:123], v[48:51], v[76:79]
    ds_read_b128 v[44:47], v13 offset:36864
    v_mfma_f32_16x16x32_bf16 v[80:83], a[124:127], v[48:51], v[80:83]
    s_waitcnt lgkmcnt(6)
    v_mfma_f32_16x16x32_bf16 v[68:71], a[128:131], v[20:23], v[68:71]
    ds_read_b128 v[48:51], v13 offset:38912
    v_mfma_f32_16x16x32_bf16 v[72:75], a[132:135], v[20:23], v[72:75]
    s_waitcnt lgkmcnt(6)
    v_mfma_f32_16x16x32_bf16 v[76:79], a[128:131], v[24:27], v[76:79]
    ds_read_b128 v[20:23], v12 offset:40960
    s_add_u32 m0, s19, 43648
    v_mfma_f32_16x16x32_bf16 v[80:83], a[132:135], v[24:27], v[80:83]
    buffer_load_dwordx4 v2, s[8:11], s20 offen offset:1408 lds
    s_waitcnt lgkmcnt(6)
    v_mfma_f32_16x16x32_bf16 v[68:71], a[136:139], v[28:31], v[68:71]
    ds_read_b128 v[24:27], v12 offset:43008
    v_mfma_f32_16x16x32_bf16 v[72:75], a[140:143], v[28:31], v[72:75]
    s_waitcnt lgkmcnt(6)
    v_mfma_f32_16x16x32_bf16 v[76:79], a[136:139], v[32:35], v[76:79]
    ds_read_b128 v[28:31], v13 offset:40960
    s_add_u32 m0, s19, 47616
    v_mfma_f32_16x16x32_bf16 v[80:83], a[140:143], v[32:35], v[80:83]
    buffer_load_dwordx4 v2, s[8:11], s20 offen offset:1536 lds
    s_waitcnt lgkmcnt(6)
    v_mfma_f32_16x16x32_bf16 v[68:71], a[144:147], v[36:39], v[68:71]
    ds_read_b128 v[32:35], v13 offset:43008
    v_mfma_f32_16x16x32_bf16 v[72:75], a[148:151], v[36:39], v[72:75]
    s_waitcnt lgkmcnt(6)
    v_mfma_f32_16x16x32_bf16 v[76:79], a[144:147], v[40:43], v[76:79]
    ds_read_b128 v[36:39], v12 offset:45056
    s_add_u32 m0, s19, 51584
    v_mfma_f32_16x16x32_bf16 v[80:83], a[148:151], v[40:43], v[80:83]
    buffer_load_dwordx4 v2, s[8:11], s20 offen offset:1664 lds
    s_waitcnt lgkmcnt(6)
    v_mfma_f32_16x16x32_bf16 v[68:71], a[152:155], v[44:47], v[68:71]
    ds_read_b128 v[40:43], v12 offset:47104
    v_mfma_f32_16x16x32_bf16 v[72:75], a[156:159], v[44:47], v[72:75]
    s_waitcnt lgkmcnt(6)
    v_mfma_f32_16x16x32_bf16 v[76:79], a[152:155], v[48:51], v[76:79]
    ds_read_b128 v[44:47], v13 offset:45056
    s_add_u32 m0, s19, 55552
    v_mfma_f32_16x16x32_bf16 v[80:83], a[156:159], v[48:51], v[80:83]
    buffer_load_dwordx4 v2, s[8:11], s20 offen offset:1792 lds
    s_waitcnt lgkmcnt(6)
    v_mfma_f32_16x16x32_bf16 v[68:71], a[160:163], v[20:23], v[68:71]
    ds_read_b128 v[48:51], v13 offset:47104
    v_mfma_f32_16x16x32_bf16 v[72:75], a[164:167], v[20:23], v[72:75]
    s_waitcnt lgkmcnt(6)
    v_mfma_f32_16x16x32_bf16 v[76:79], a[160:163], v[24:27], v[76:79]
    ds_read_b128 v[20:23], v12 offset:49152
    s_add_u32 m0, s19, 59520
    v_mfma_f32_16x16x32_bf16 v[80:83], a[164:167], v[24:27], v[80:83]
    buffer_load_dwordx4 v2, s[8:11], s20 offen offset:1920 lds
    s_waitcnt lgkmcnt(6)
    v_mfma_f32_16x16x32_bf16 v[68:71], a[168:171], v[28:31], v[68:71]
    ds_read_b128 v[24:27], v12 offset:51200
    v_mfma_f32_16x16x32_bf16 v[72:75], a[172:175], v[28:31], v[72:75]
    s_add_u32 s20, s20, s24
    s_waitcnt lgkmcnt(6)
    v_mfma_f32_16x16x32_bf16 v[76:79], a[168:171], v[32:35], v[76:79]
    ds_read_b128 v[28:31], v13 offset:49152
    v_mfma_f32_16x16x32_bf16 v[80:83], a[172:175], v[32:35], v[80:83]
    s_waitcnt lgkmcnt(6)
    v_mfma_f32_16x16x32_bf16 v[68:71], a[176:179], v[36:39], v[68:71]
    ds_read_b128 v[32:35], v13 offset:51200
    v_mfma_f32_16x16x32_bf16 v[72:75], a[180:183], v[36:39], v[72:75]
    s_waitcnt lgkmcnt(6)
    v_mfma_f32_16x16x32_bf16 v[76:79], a[176:179], v[40:43], v[76:79]
    ds_read_b128 v[36:39], v12 offset:53248
    v_mfma_f32_16x16x32_bf16 v[80:83], a[180:183], v[40:43], v[80:83]
    s_waitcnt lgkmcnt(6)
    v_mfma_f32_16x16x32_bf16 v[68:71], a[184:187], v[44:47], v[68:71]
    ds_read_b128 v[40:43], v12 offset:55296
    v_mfma_f32_16x16x32_bf16 v[72:75], a[188:191], v[44:47], v[72:75]
    s_waitcnt lgkmcnt(6)
    v_mfma_f32_16x16x32_bf16 v[76:79], a[184:187], v[48:51], v[76:79]
    ds_read_b128 v[44:47], v13 offset:53248
    v_mfma_f32_16x16x32_bf16 v[80:83], a[188:191], v[48:51], v[80:83]
    s_waitcnt lgkmcnt(6)
    v_mfma_f32_16x16x32_bf16 v[68:71], a[192:195], v[20:23], v[68:71]
    ds_read_b128 v[48:51], v13 offset:55296
    v_mfma_f32_16x16x32_bf16 v[72:75], a[196:199], v[20:23], v[72:75]
    s_waitcnt lgkmcnt(6)
    v_mfma_f32_16x16x32_bf16 v[76:79], a[192:195], v[24:27], v[76:79]
    ds_read_b128 v[20:23], v12 offset:57344
    v_mfma_f32_16x16x32_bf16 v[80:83], a[196:199], v[24:27], v[80:83]
    s_waitcnt lgkmcnt(6)
    v_mfma_f32_16x16x32_bf16 v[68:71], a[200:203], v[28:31], v[68:71]
    ds_read_b128 v[24:27], v12 offset:59392
    v_mfma_f32_16x16x32_bf16 v[72:75], a[204:207], v[28:31], v[72:75]
    s_waitcnt lgkmcnt(6)
    v_mfma_f32_16x16x32_bf16 v[76:79], a[200:203], v[32:35], v[76:79]
    ds_read_b128 v[28:31], v13 offset:57344
    v_mfma_f32_16x16x32_bf16 v[80:83], a[204:207], v[32:35], v[80:83]
    s_waitcnt lgkmcnt(6)
    v_mfma_f32_16x16x32_bf16 v[68:71], a[208:211], v[36:39], v[68:71]
    ds_read_b128 v[32:35], v13 offset:59392
    v_mfma_f32_16x16x32_bf16 v[72:75], a[212:215], v[36:39], v[72:75]
    s_waitcnt lgkmcnt(6)
    v_mfma_f32_16x16x32_bf16 v[76:79], a[208:211], v[40:43], v[76:79]
    ds_read_b128 v[36:39], v12 offset:61440
    v_mfma_f32_16x16x32_bf16 v[80:83], a[212:215], v[40:43], v[80:83]
    s_waitcnt lgkmcnt(6)
    v_mfma_f32_16x16x32_bf16 v[68:71], a[216:219], v[44:47], v[68:71]
    ds_read_b128 v[40:43], v12 offset:63488
    v_mfma_f32_16x16x32_bf16 v[72:75], a[220:223], v[44:47], v[72:75]
    s_waitcnt lgkmcnt(6)
    v_mfma_f32_16x16x32_bf16 v[76:79], a[216:219], v[48:51], v[76:79]
    ds_read_b128 v[44:47], v13 offset:61440
    v_mfma_f32_16x16x32_bf16 v[80:83], a[220:223], v[48:51], v[80:83]
    s_waitcnt lgkmcnt(6)
    v_mfma_f32_16x16x32_bf16 v[68:71], a[224:227], v[20:23], v[68:71]
    ds_read_b128 v[48:51], v13 offset:63488
    v_mfma_f32_16x16x32_bf16 v[72:75], a[228:231], v[20:23], v[72:75]
    s_waitcnt lgkmcnt(6)
    v_mfma_f32_16x16x32_bf16 v[76:79], a[224:227], v[24:27], v[76:79]
    s_waitcnt vmcnt(8)
    s_barrier
    ds_read_b128 v[20:23], v10 offset:0
    v_mfma_f32_16x16x32_bf16 v[80:83], a[228:231], v[24:27], v[80:83]
    s_waitcnt lgkmcnt(6)
    v_mfma_f32_16x16x32_bf16 v[68:71], a[232:235], v[28:31], v[68:71]
    ds_read_b128 v[24:27], v10 offset:2048
    s_add_u32 m0, s19, 65536
    v_mfma_f32_16x16x32_bf16 v[72:75], a[236:239], v[28:31], v[72:75]
    buffer_load_dwordx4 v2, s[8:11], s20 offen offset:0 lds
    s_waitcnt lgkmcnt(6)
    v_mfma_f32_16x16x32_bf16 v[76:79], a[232:235], v[32:35], v[76:79]
    ds_read_b128 v[28:31], v11 offset:0
    v_mfma_f32_16x16x32_bf16 v[80:83], a[236:239], v[32:35], v[80:83]
    v_mov_b32 v9, s23
    s_add_u32 s23, s23, 1
    buffer_store_dword v9, v4, s[4:7], 0 offen sc1
    s_waitcnt lgkmcnt(6)
    v_mfma_f32_16x16x32_bf16 v[68:71], a[240:243], v[36:39], v[68:71]
    ds_read_b128 v[32:35], v11 offset:2048
    s_add_u32 m0, s19, 69504
    v_mfma_f32_16x16x32_bf16 v[72:75], a[244:247], v[36:39], v[72:75]
    buffer_load_dwordx4 v2, s[8:11], s20 offen offset:128 lds
    s_waitcnt lgkmcnt(6)
    v_mfma_f32_16x16x32_bf16 v[76:79], a[240:243], v[40:43], v[76:79]
    ds_read_b128 v[36:39], v10 offset:4096
    v_mfma_f32_16x16x32_bf16 v[80:83], a[244:247], v[40:43], v[80:83]
    s_waitcnt lgkmcnt(6)
    v_mfma_f32_16x16x32_bf16 v[68:71], a[248:251], v[44:47], v[68:71]
    ds_read_b128 v[40:43], v10 offset:6144
    s_add_u32 m0, s19, 73472
    v_mfma_f32_16x16x32_bf16 v[72:75], a[252:255], v[44:47], v[72:75]
    buffer_load_dwordx4 v2, s[8:11], s20 offen offset:256 lds
    s_waitcnt lgkmcnt(6)
    v_mfma_f32_16x16x32_bf16 v[76:79], a[248:251], v[48:51], v[76:79]
    ds_read_b128 v[44:47], v11 offset:4096
    v_mfma_f32_16x16x32_bf16 v[80:83], a[252:255], v[48:51], v[80:83]
    s_add_u32 s22, s22, 2
    s_cmp_lt_u32 s22, 64
    s_cbranch_scc1 P_qk_top
    v_cvt_pk_bf16_f32 v84, v68, v69
    v_cvt_pk_bf16_f32 v85, v70, v71
    v_cvt_pk_bf16_f32 v86, v72, v73
    v_cvt_pk_bf16_f32 v87, v74, v75
    v_cvt_pk_bf16_f32 v88, v76, v77
    v_cvt_pk_bf16_f32 v89, v78, v79
    v_cvt_pk_bf16_f32 v90, v80, v81
    v_cvt_pk_bf16_f32 v91, v82, v83
    buffer_store_dwordx4 v[84:87], v3, s[4:7], s21 offen offset:0 sc1
    buffer_store_dwordx4 v[88:91], v3, s[4:7], s21 offen offset:256 sc1
    s_waitcnt vmcnt(0) lgkmcnt(0)
    v_mov_b32 v9, s23
    s_add_u32 s23, s23, 1
    buffer_store_dword v9, v4, s[4:7], 0 offen sc1
    s_branch W_U
P_v:
    s_mov_b32 s26, s25
    s_sub_u32 s25, s21, 1073741824
    s_mov_b32 s21, 1073741824
    s_mov_b32 s23, 0
    s_mov_b32 s22, 0
    s_add_u32 m0, s19, 0
    s_nop 0
    buffer_load_dwordx4 v2, s[8:11], s20 offen offset:0 lds
    s_add_u32 m0, s19, 3968
    s_nop 0
    buffer_load_dwordx4 v2, s[8:11], s20 offen offset:128 lds
    s_add_u32 m0, s19, 7936
    s_nop 0
    buffer_load_dwordx4 v2, s[8:11], s20 offen offset:256 lds
    s_add_u32 m0, s19, 11904
    s_nop 0
    buffer_load_dwordx4 v2, s[8:11], s20 offen offset:384 lds
    s_add_u32 m0, s19, 15872
    s_nop 0
    buffer_load_dwordx4 v2, s[8:11], s20 offen offset:512 lds
    s_add_u32 m0, s19, 19840
    s_nop 0
    buffer_load_dwordx4 v2, s[8:11], s20 offen offset:640 lds
    s_add_u32 m0, s19, 23808
    s_nop 0
    buffer_load_dwordx4 v2, s[8:11], s20 offen offset:768 lds
    s_add_u32 m0, s19, 27776
    s_nop 0
    buffer_load_dwordx4 v2, s[8:11], s20 offen offset:896 lds
    s_add_u32 m0, s19, 31744
    s_nop 0
    buffer_load_dwordx4 v2, s[8:11], s20 offen offset:1024 lds
    s_add_u32 m0, s19, 35712
    s_nop 0
    buffer_load_dwordx4 v2, s[8:11], s20 offen offset:1152 lds
    s_add_u32 m0, s19, 39680
    s_nop 0
    buffer_load_dwordx4 v2, s[8:11], s20 offen offset:1280 lds
    s_add_u32 m0, s19, 43648
    s_nop 0
    buffer_load_dwordx4 v2, s[8:11], s20 offen offset:1408 lds
    s_add_u32 m0, s19, 47616
    s_nop 0
    buffer_load_dwordx4 v2, s[8:11], s20 offen offset:1536 lds
    s_add_u32 m0, s19, 51584
    s_nop 0
    buffer_load_dwordx4 v2, s[8:11], s20 offen offset:1664 lds
    s_add_u32 m0, s19, 55552
    s_nop 0
    buffer_load_dwordx4 v2, s[8:11], s20 offen offset:1792 lds
    s_add_u32 m0, s19, 59520
    s_nop 0
    buffer_load_dwordx4 v2, s[8:11], s20 offen offset:1920 lds
    s_add_u32 s20, s20, s24
    s_add_u32 m0, s19, 65536
    s_nop 0
    buffer_load_dwordx4 v2, s[8:11], s20 offen offset:0 lds
    s_add_u32 m0, s19, 69504
    s_nop 0
    buffer_load_dwordx4 v2, s[8:11], s20 offen offset:128 lds
    s_add_u32 m0, s19, 73472
    s_nop 0
    buffer_load_dwordx4 v2, s[8:11], s20 offen offset:256 lds
    v_mov_b32 v9, s23
    s_add_u32 s23, s23, 1
    buffer_store_dword v9, v4, s[4:7], 0 offen sc1
    s_mov_b32 s23, 0
    s_waitcnt vmcnt(12)
    s_barrier
    ds_read_b128 v[20:23], v10 offset:0
    ds_read_b128 v[24:27], v10 offset:2048
    ds_read_b128 v[28:31], v11 offset:0
    ds_read_b128 v[32:35], v11 offset:2048
    ds_read_b128 v[36:39], v10 offset:4096
    ds_read_b128 v[40:43], v10 offset:6144
    ds_read_b128 v[44:47], v11 offset:4096
.p2align 6
P_v_top:
    s_waitcnt lgkmcnt(6)
    v_mfma_f32_16x16x32_bf16 v[52:55], v[20:23], a[0:3], 0
    ds_read_b128 v[48:51], v11 offset:6144
    v_mfma_f32_16x16x32_bf16 v[60:63], v[20:23], a[4:7], 0
    s_waitcnt lgkmcnt(6)
    v_mfma_f32_16x16x32_bf16 v[56:59], v[24:27], a[0:3], 0
    ds_read_b128 v[20:23], v10 offset:8192
    s_add_u32 m0, s19, 77440
    v_mfma_f32_16x16x32_bf16 v[64:67], v[24:27], a[4:7], 0
    buffer_load_dwordx4 v2, s[8:11], s20 offen offset:384 lds
    s_waitcnt lgkmcnt(6)
    v_mfma_f32_16x16x32_bf16 v[52:55], v[28:31], a[8:11], v[52:55]
    ds_read_b128 v[24:27], v10 offset:10240
    v_mfma_f32_16x16x32_bf16 v[60:63], v[28:31], a[12:15], v[60:63]
    s_waitcnt lgkmcnt(6)
    v_mfma_f32_16x16x32_bf16 v[56:59], v[32:35], a[8:11], v[56:59]
    ds_read_b128 v[28:31], v11 offset:8192
    s_add_u32 m0, s19, 81408
    v_mfma_f32_16x16x32_bf16 v[64:67], v[32:35], a[12:15], v[64:67]
    buffer_load_dwordx4 v2, s[8:11], s20 offen offset:512 lds
    s_waitcnt lgkmcnt(6)
    v_mfma_f32_16x16x32_bf16 v[52:55], v[36:39], a[16:19], v[52:55]
    ds_read_b128 v[32:35], v11 offset:10240
    v_mfma_f32_16x16x32_bf16 v[60:63], v[36:39], a[20:23], v[60:63]
    s_waitcnt lgkmcnt(6)
    v_mfma_f32_16x16x32_bf16 v[56:59], v[40:43], a[16:19], v[56:59]
    ds_read_b128 v[36:39], v10 offset:12288
    s_add_u32 m0, s19, 85376
    v_mfma_f32_16x16x32_bf16 v[64:67], v[40:43], a[20:23], v[64:67]
    buffer_load_dwordx4 v2, s[8:11], s20 offen offset:640 lds
    s_waitcnt lgkmcnt(6)
    v_mfma_f32_16x16x32_bf16 v[52:55], v[44:47], a[24:27], v[52:55]
    ds_read_b128 v[40:43], v10 offset:14336
    v_mfma_f32_16x16x32_bf16 v[60:63], v[44:47], a[28:31], v[60:63]
    s_waitcnt lgkmcnt(6)
    v_mfma_f32_16x16x32_bf16 v[56:59], v[48:51], a[24:27], v[56:59]
    ds_read_b128 v[44:47], v11 offset:12288
    s_add_u32 m0, s19, 89344
    v_mfma_f32_16x16x32_bf16 v[64:67], v[48:51], a[28:31], v[64:67]
    buffer_load_dwordx4 v2, s[8:11], s20 offen offset:768 lds
    s_waitcnt lgkmcnt(6)
    v_mfma_f32_16x16x32_bf16 v[52:55], v[20:23], a[32:35], v[52:55]
    ds_read_b128 v[48:51], v11 offset:14336
    v_mfma_f32_16x16x32_bf16 v[60:63], v[20:23], a[36:39], v[60:63]
    s_waitcnt lgkmcnt(6)
    v_mfma_f32_16x16x32_bf16 v[56:59], v[24:27], a[32:35], v[56:59]
    ds_read_b128 v[20:23], v10 offset:16384
    s_add_u32 m0, s19, 93312
    v_mfma_f32_16x16x32_bf16 v[64:67], v[24:27], a[36:39], v[64:67]
    buffer_load_dwordx4 v2, s[8:11], s20 offen offset:896 lds
    s_waitcnt lgkmcnt(6)
    v_mfma_f32_16x16x32_bf16 v[52:55], v[28:31], a[40:43], v[52:55]
    ds_read_b128 v[24:27], v10 offset:18432
    v_mfma_f32_16x16x32_bf16 v[60:63], v[28:31], a[44:47], v[60:63]
    v_cvt_pk_bf16_f32 v84, v68, v69
    s_waitcnt lgkmcnt(6)
    v_mfma_f32_16x16x32_bf16 v[56:59], v[32:35], a[40:43], v[56:59]
    ds_read_b128 v[28:31], v11 offset:16384
    v_mfma_f32_16x16x32_bf16 v[64:67], v[32:35], a[44:47], v[64:67]
    v_cvt_pk_bf16_f32 v85, v70, v71
    s_waitcnt lgkmcnt(6)
    v_mfma_f32_16x16x32_bf16 v[52:55], v[36:39], a[48:51], v[52:55]
    ds_read_b128 v[32:35], v11 offset:18432
    v_mfma_f32_16x16x32_bf16 v[60:63], v[36:39], a[52:55], v[60:63]
    v_cvt_pk_bf16_f32 v86, v72, v73
    s_waitcnt lgkmcnt(6)
    v_mfma_f32_16x16x32_bf16 v[56:59], v[40:43], a[48:51], v[56:59]
    ds_read_b128 v[36:39], v10 offset:20480
    v_mfma_f32_16x16x32_bf16 v[64:67], v[40:43], a[52:55], v[64:67]
    v_cvt_pk_bf16_f32 v87, v74, v75
    s_waitcnt lgkmcnt(6)
    v_mfma_f32_16x16x32_bf16 v[52:55], v[44:47], a[56:59], v[52:55]
    ds_read_b128 v[40:43], v10 offset:22528
    v_mfma_f32_16x16x32_bf16 v[60:63], v[44:47], a[60:63], v[60:63]
    v_cvt_pk_bf16_f32 v88, v76, v77
    s_waitcnt lgkmcnt(6)
    v_mfma_f32_16x16x32_bf16 v[56:59], v[48:51], a[56:59], v[56:59]
    ds_read_b128 v[44:47], v11 offset:20480
    v_mfma_f32_16x16x32_bf16 v[64:67], v[48:51], a[60:63], v[64:67]
    v_cvt_pk_bf16_f32 v89, v78, v79
    buffer_store_dwordx4 v[84:87], v3, s[4:7], s21 offen offset:0 sc1
    s_waitcnt lgkmcnt(6)
    v_mfma_f32_16x16x32_bf16 v[52:55], v[20:23], a[64:67], v[52:55]
    ds_read_b128 v[48:51], v11 offset:22528
    v_mfma_f32_16x16x32_bf16 v[60:63], v[20:23], a[68:71], v[60:63]
    v_cvt_pk_bf16_f32 v90, v80, v81
    s_waitcnt lgkmcnt(6)
    v_mfma_f32_16x16x32_bf16 v[56:59], v[24:27], a[64:67], v[56:59]
    ds_read_b128 v[20:23], v10 offset:24576
    v_mfma_f32_16x16x32_bf16 v[64:67], v[24:27], a[68:71], v[64:67]
    v_cvt_pk_bf16_f32 v91, v82, v83
    s_waitcnt lgkmcnt(6)
    v_mfma_f32_16x16x32_bf16 v[52:55], v[28:31], a[72:75], v[52:55]
    ds_read_b128 v[24:27], v10 offset:26624
    v_mfma_f32_16x16x32_bf16 v[60:63], v[28:31], a[76:79], v[60:63]
    s_waitcnt lgkmcnt(6)
    v_mfma_f32_16x16x32_bf16 v[56:59], v[32:35], a[72:75], v[56:59]
    ds_read_b128 v[28:31], v11 offset:24576
    v_mfma_f32_16x16x32_bf16 v[64:67], v[32:35], a[76:79], v[64:67]
    buffer_store_dwordx4 v[88:91], v3, s[4:7], s21 offen offset:256 sc1
    s_waitcnt lgkmcnt(6)
    v_mfma_f32_16x16x32_bf16 v[52:55], v[36:39], a[80:83], v[52:55]
    ds_read_b128 v[32:35], v11 offset:26624
    v_mfma_f32_16x16x32_bf16 v[60:63], v[36:39], a[84:87], v[60:63]
    s_add_u32 s21, s21, s25
    s_mov_b32 s25, s26
    s_waitcnt lgkmcnt(6)
    v_mfma_f32_16x16x32_bf16 v[56:59], v[40:43], a[80:83], v[56:59]
    ds_read_b128 v[36:39], v10 offset:28672
    v_mfma_f32_16x16x32_bf16 v[64:67], v[40:43], a[84:87], v[64:67]
    s_waitcnt lgkmcnt(6)
    v_mfma_f32_16x16x32_bf16 v[52:55], v[44:47], a[88:91], v[52:55]
    ds_read_b128 v[40:43], v10 offset:30720
    v_mfma_f32_16x16x32_bf16 v[60:63], v[44:47], a[92:95], v[60:63]
    s_waitcnt lgkmcnt(6)
    v_mfma_f32_16x16x32_bf16 v[56:59], v[48:51], a[88:91], v[56:59]
    ds_read_b128 v[44:47], v11 offset:28672
    v_mfma_f32_16x16x32_bf16 v[64:67], v[48:51], a[92:95], v[64:67]
    s_waitcnt lgkmcnt(6)
    v_mfma_f32_16x16x32_bf16 v[52:55], v[20:23], a[96:99], v[52:55]
    ds_read_b128 v[48:51], v11 offset:30720
    v_mfma_f32_16x16x32_bf16 v[60:63], v[20:23], a[100:103], v[60:63]
    s_waitcnt lgkmcnt(6)
    v_mfma_f32_16x16x32_bf16 v[56:59], v[24:27], a[96:99], v[56:59]
    s_waitcnt vmcnt(11)
    s_barrier
    ds_read_b128 v[20:23], v10 offset:32768
    v_mfma_f32_16x16x32_bf16 v[64:67], v[24:27], a[100:103], v[64:67]
    s_waitcnt lgkmcnt(6)
    v_mfma_f32_16x16x32_bf16 v[52:55], v[28:31], a[104:107], v[52:55]
    ds_read_b128 v[24:27], v10 offset:34816
    s_add_u32 m0, s19, 97280
    v_mfma_f32_16x16x32_bf16 v[60:63], v[28:31], a[108:111], v[60:63]
    buffer_load_dwordx4 v2, s[8:11], s20 offen offset:1024 lds
    s_waitcnt lgkmcnt(6)
    v_mfma_f32_16x16x32_bf16 v[56:59], v[32:35], a[104:107], v[56:59]
    ds_read_b128 v[28:31], v11 offset:32768
    v_mfma_f32_16x16x32_bf16 v[64:67], v[32:35], a[108:111], v[64:67]
    s_waitcnt lgkmcnt(6)
    v_mfma_f32_16x16x32_bf16 v[52:55], v[36:39], a[112:115], v[52:55]
    ds_read_b128 v[32:35], v11 offset:34816
    s_add_u32 m0, s19, 101248
    v_mfma_f32_16x16x32_bf16 v[60:63], v[36:39], a[116:119], v[60:63]
    buffer_load_dwordx4 v2, s[8:11], s20 offen offset:1152 lds
    s_waitcnt lgkmcnt(6)
    v_mfma_f32_16x16x32_bf16 v[56:59], v[40:43], a[112:115], v[56:59]
    ds_read_b128 v[36:39], v10 offset:36864
    v_mfma_f32_16x16x32_bf16 v[64:67], v[40:43], a[116:119], v[64:67]
    s_waitcnt lgkmcnt(6)
    v_mfma_f32_16x16x32_bf16 v[52:55], v[44:47], a[120:123], v[52:55]
    ds_read_b128 v[40:43], v10 offset:38912
    s_add_u32 m0, s19, 105216
    v_mfma_f32_16x16x32_bf16 v[60:63], v[44:47], a[124:127], v[60:63]
    buffer_load_dwordx4 v2, s[8:11], s20 offen offset:1280 lds
    s_waitcnt lgkmcnt(6)
    v_mfma_f32_16x16x32_bf16 v[56:59], v[48:51], a[120:123], v[56:59]
    ds_read_b128 v[44:47], v11 offset:36864
    v_mfma_f32_16x16x32_bf16 v[64:67], v[48:51], a[124:127], v[64:67]
    s_waitcnt lgkmcnt(6)
    v_mfma_f32_16x16x32_bf16 v[52:55], v[20:23], a[128:131], v[52:55]
    ds_read_b128 v[48:51], v11 offset:38912
    v_mfma_f32_16x16x32_bf16 v[60:63], v[20:23], a[132:135], v[60:63]
    s_waitcnt lgkmcnt(6)
    v_mfma_f32_16x16x32_bf16 v[56:59], v[24:27], a[128:131], v[56:59]
    ds_read_b128 v[20:23], v10 offset:40960
    s_add_u32 m0, s19, 109184
    v_mfma_f32_16x16x32_bf16 v[64:67], v[24:27], a[132:135], v[64:67]
    buffer_load_dwordx4 v2, s[8:11], s20 offen offset:1408 lds
    s_waitcnt lgkmcnt(6)
    v_mfma_f32_16x16x32_bf16 v[52:55], v[28:31], a[136:139], v[52:55]
    ds_read_b128 v[24:27], v10 offset:43008
    v_mfma_f32_16x16x32_bf16 v[60:63], v[28:31], a[140:143], v[60:63]
    s_waitcnt lgkmcnt(6)
    v_mfma_f32_16x16x32_bf16 v[56:59], v[32:35], a[136:139], v[56:59]
    ds_read_b128 v[28:31], v11 offset:40960
    s_add_u32 m0, s19, 113152
    v_mfma_f32_16x16x32_bf16 v[64:67], v[32:35], a[140:143], v[64:67]
    buffer_load_dwordx4 v2, s[8:11], s20 offen offset:1536 lds
    s_waitcnt lgkmcnt(6)
    v_mfma_f32_16x16x32_bf16 v[52:55], v[36:39], a[144:147], v[52:55]
    ds_read_b128 v[32:35], v11 offset:43008
    v_mfma_f32_16x16x32_bf16 v[60:63], v[36:39], a[148:151], v[60:63]
    s_waitcnt lgkmcnt(6)
    v_mfma_f32_16x16x32_bf16 v[56:59], v[40:43], a[144:147], v[56:59]
    ds_read_b128 v[36:39], v10 offset:45056
    s_add_u32 m0, s19, 117120
    v_mfma_f32_16x16x32_bf16 v[64:67], v[40:43], a[148:151], v[64:67]
    buffer_load_dwordx4 v2, s[8:11], s20 offen offset:1664 lds
    s_waitcnt lgkmcnt(6)
    v_mfma_f32_16x16x32_bf16 v[52:55], v[44:47], a[152:155], v[52:55]
    ds_read_b128 v[40:43], v10 offset:47104
    v_mfma_f32_16x16x32_bf16 v[60:63], v[44:47], a[156:159], v[60:63]
    s_waitcnt lgkmcnt(6)
    v_mfma_f32_16x16x32_bf16 v[56:59], v[48:51], a[152:155], v[56:59]
    ds_read_b128 v[44:47], v11 offset:45056
    s_add_u32 m0, s19, 121088
    v_mfma_f32_16x16x32_bf16 v[64:67], v[48:51], a[156:159], v[64:67]
    buffer_load_dwordx4 v2, s[8:11], s20 offen offset:1792 lds
    s_waitcnt lgkmcnt(6)
    v_mfma_f32_16x16x32_bf16 v[52:55], v[20:23], a[160:163], v[52:55]
    ds_read_b128 v[48:51], v11 offset:47104
    v_mfma_f32_16x16x32_bf16 v[60:63], v[20:23], a[164:167], v[60:63]
    s_waitcnt lgkmcnt(6)
    v_mfma_f32_16x16x32_bf16 v[56:59], v[24:27], a[160:163], v[56:59]
    ds_read_b128 v[20:23], v10 offset:49152
    s_add_u32 m0, s19, 125056
    v_mfma_f32_16x16x32_bf16 v[64:67], v[24:27], a[164:167], v[64:67]
    buffer_load_dwordx4 v2, s[8:11], s20 offen offset:1920 lds
    s_waitcnt lgkmcnt(6)
    v_mfma_f32_16x16x32_bf16 v[52:55], v[28:31], a[168:171], v[52:55]
    ds_read_b128 v[24:27], v10 offset:51200
    v_mfma_f32_16x16x32_bf16 v[60:63], v[28:31], a[172:175], v[60:63]
    s_add_u32 s20, s20, s24
    s_waitcnt lgkmcnt(6)
    v_mfma_f32_16x16x32_bf16 v[56:59], v[32:35], a[168:171], v[56:59]
    ds_read_b128 v[28:31], v11 offset:49152
    v_mfma_f32_16x16x32_bf16 v[64:67], v[32:35], a[172:175], v[64:67]
    s_waitcnt lgkmcnt(6)
    v_mfma_f32_16x16x32_bf16 v[52:55], v[36:39], a[176:179], v[52:55]
    ds_read_b128 v[32:35], v11 offset:51200
    v_mfma_f32_16x16x32_bf16 v[60:63], v[36:39], a[180:183], v[60:63]
    s_waitcnt lgkmcnt(6)
    v_mfma_f32_16x16x32_bf16 v[56:59], v[40:43], a[176:179], v[56:59]
    ds_read_b128 v[36:39], v10 offset:53248
    v_mfma_f32_16x16x32_bf16 v[64:67], v[40:43], a[180:183], v[64:67]
    s_waitcnt lgkmcnt(6)
    v_mfma_f32_16x16x32_bf16 v[52:55], v[44:47], a[184:187], v[52:55]
    ds_read_b128 v[40:43], v10 offset:55296
    v_mfma_f32_16x16x32_bf16 v[60:63], v[44:47], a[188:191], v[60:63]
    s_waitcnt lgkmcnt(6)
    v_mfma_f32_16x16x32_bf16 v[56:59], v[48:51], a[184:187], v[56:59]
    ds_read_b128 v[44:47], v11 offset:53248
    v_mfma_f32_16x16x32_bf16 v[64:67], v[48:51], a[188:191], v[64:67]
    s_waitcnt lgkmcnt(6)
    v_mfma_f32_16x16x32_bf16 v[52:55], v[20:23], a[192:195], v[52:55]
    ds_read_b128 v[48:51], v11 offset:55296
    v_mfma_f32_16x16x32_bf16 v[60:63], v[20:23], a[196:199], v[60:63]
    s_waitcnt lgkmcnt(6)
    v_mfma_f32_16x16x32_bf16 v[56:59], v[24:27], a[192:195], v[56:59]
    ds_read_b128 v[20:23], v10 offset:57344
    v_mfma_f32_16x16x32_bf16 v[64:67], v[24:27], a[196:199], v[64:67]
    s_waitcnt lgkmcnt(6)
    v_mfma_f32_16x16x32_bf16 v[52:55], v[28:31], a[200:203], v[52:55]
    ds_read_b128 v[24:27], v10 offset:59392
    v_mfma_f32_16x16x32_bf16 v[60:63], v[28:31], a[204:207], v[60:63]
    s_waitcnt lgkmcnt(6)
    v_mfma_f32_16x16x32_bf16 v[56:59], v[32:35], a[200:203], v[56:59]
    ds_read_b128 v[28:31], v11 offset:57344
    v_mfma_f32_16x16x32_bf16 v[64:67], v[32:35], a[204:207], v[64:67]
    s_waitcnt lgkmcnt(6)
    v_mfma_f32_16x16x32_bf16 v[52:55], v[36:39], a[208:211], v[52:55]
    ds_read_b128 v[32:35], v11 offset:59392
    v_mfma_f32_16x16x32_bf16 v[60:63], v[36:39], a[212:215], v[60:63]
    s_waitcnt lgkmcnt(6)
    v_mfma_f32_16x16x32_bf16 v[56:59], v[40:43], a[208:211], v[56:59]
    ds_read_b128 v[36:39], v10 offset:61440
    v_mfma_f32_16x16x32_bf16 v[64:67], v[40:43], a[212:215], v[64:67]
    s_waitcnt lgkmcnt(6)
    v_mfma_f32_16x16x32_bf16 v[52:55], v[44:47], a[216:219], v[52:55]
    ds_read_b128 v[40:43], v10 offset:63488
    v_mfma_f32_16x16x32_bf16 v[60:63], v[44:47], a[220:223], v[60:63]
    s_waitcnt lgkmcnt(6)
    v_mfma_f32_16x16x32_bf16 v[56:59], v[48:51], a[216:219], v[56:59]
    ds_read_b128 v[44:47], v11 offset:61440
    v_mfma_f32_16x16x32_bf16 v[64:67], v[48:51], a[220:223], v[64:67]
    s_waitcnt lgkmcnt(6)
    v_mfma_f32_16x16x32_bf16 v[52:55], v[20:23], a[224:227], v[52:55]
    ds_read_b128 v[48:51], v11 offset:63488
    v_mfma_f32_16x16x32_bf16 v[60:63], v[20:23], a[228:231], v[60:63]
    s_waitcnt lgkmcnt(6)
    v_mfma_f32_16x16x32_bf16 v[56:59], v[24:27], a[224:227], v[56:59]
    s_waitcnt vmcnt(8)
    s_barrier
    ds_read_b128 v[20:23], v12 offset:0
    v_mfma_f32_16x16x32_bf16 v[64:67], v[24:27], a[228:231], v[64:67]
    s_waitcnt lgkmcnt(6)
    v_mfma_f32_16x16x32_bf16 v[52:55], v[28:31], a[232:235], v[52:55]
    ds_read_b128 v[24:27], v12 offset:2048
    s_add_u32 m0, s19, 0
    v_mfma_f32_16x16x32_bf16 v[60:63], v[28:31], a[236:239], v[60:63]
    buffer_load_dwordx4 v2, s[8:11], s20 offen offset:0 lds
    s_waitcnt lgkmcnt(6)
    v_mfma_f32_16x16x32_bf16 v[56:59], v[32:35], a[232:235], v[56:59]
    ds_read_b128 v[28:31], v13 offset:0
    v_mfma_f32_16x16x32_bf16 v[64:67], v[32:35], a[236:239], v[64:67]
    v_mov_b32 v9, s23
    s_add_u32 s23, s23, 1
    buffer_store_dword v9, v4, s[4:7], 0 offen sc1
    s_waitcnt lgkmcnt(6)
    v_mfma_f32_16x16x32_bf16 v[52:55], v[36:39], a[240:243], v[52:55]
    ds_read_b128 v[32:35], v13 offset:2048
    s_add_u32 m0, s19, 3968
    v_mfma_f32_16x16x32_bf16 v[60:63], v[36:39], a[244:247], v[60:63]
    buffer_load_dwordx4 v2, s[8:11], s20 offen offset:128 lds
    s_waitcnt lgkmcnt(6)
    v_mfma_f32_16x16x32_bf16 v[56:59], v[40:43], a[240:243], v[56:59]
    ds_read_b128 v[36:39], v12 offset:4096
    v_mfma_f32_16x16x32_bf16 v[64:67], v[40:43], a[244:247], v[64:67]
    s_waitcnt lgkmcnt(6)
    v_mfma_f32_16x16x32_bf16 v[52:55], v[44:47], a[248:251], v[52:55]
    ds_read_b128 v[40:43], v12 offset:6144
    s_add_u32 m0, s19, 7936
    v_mfma_f32_16x16x32_bf16 v[60:63], v[44:47], a[252:255], v[60:63]
    buffer_load_dwordx4 v2, s[8:11], s20 offen offset:256 lds
    s_waitcnt lgkmcnt(6)
    v_mfma_f32_16x16x32_bf16 v[56:59], v[48:51], a[248:251], v[56:59]
    ds_read_b128 v[44:47], v13 offset:4096
    v_mfma_f32_16x16x32_bf16 v[64:67], v[48:51], a[252:255], v[64:67]
    s_waitcnt lgkmcnt(6)
    v_mfma_f32_16x16x32_bf16 v[68:71], v[20:23], a[0:3], 0
    ds_read_b128 v[48:51], v13 offset:6144
    v_mfma_f32_16x16x32_bf16 v[76:79], v[20:23], a[4:7], 0
    s_waitcnt lgkmcnt(6)
    v_mfma_f32_16x16x32_bf16 v[72:75], v[24:27], a[0:3], 0
    ds_read_b128 v[20:23], v12 offset:8192
    s_add_u32 m0, s19, 11904
    v_mfma_f32_16x16x32_bf16 v[80:83], v[24:27], a[4:7], 0
    buffer_load_dwordx4 v2, s[8:11], s20 offen offset:384 lds
    s_waitcnt lgkmcnt(6)
    v_mfma_f32_16x16x32_bf16 v[68:71], v[28:31], a[8:11], v[68:71]
    ds_read_b128 v[24:27], v12 offset:10240
    v_mfma_f32_16x16x32_bf16 v[76:79], v[28:31], a[12:15], v[76:79]
    s_waitcnt lgkmcnt(6)
    v_mfma_f32_16x16x32_bf16 v[72:75], v[32:35], a[8:11], v[72:75]
    ds_read_b128 v[28:31], v13 offset:8192
    s_add_u32 m0, s19, 15872
    v_mfma_f32_16x16x32_bf16 v[80:83], v[32:35], a[12:15], v[80:83]
    buffer_load_dwordx4 v2, s[8:11], s20 offen offset:512 lds
    s_waitcnt lgkmcnt(6)
    v_mfma_f32_16x16x32_bf16 v[68:71], v[36:39], a[16:19], v[68:71]
    ds_read_b128 v[32:35], v13 offset:10240
    v_mfma_f32_16x16x32_bf16 v[76:79], v[36:39], a[20:23], v[76:79]
    s_waitcnt lgkmcnt(6)
    v_mfma_f32_16x16x32_bf16 v[72:75], v[40:43], a[16:19], v[72:75]
    ds_read_b128 v[36:39], v12 offset:12288
    s_add_u32 m0, s19, 19840
    v_mfma_f32_16x16x32_bf16 v[80:83], v[40:43], a[20:23], v[80:83]
    buffer_load_dwordx4 v2, s[8:11], s20 offen offset:640 lds
    s_waitcnt lgkmcnt(6)
    v_mfma_f32_16x16x32_bf16 v[68:71], v[44:47], a[24:27], v[68:71]
    ds_read_b128 v[40:43], v12 offset:14336
    v_mfma_f32_16x16x32_bf16 v[76:79], v[44:47], a[28:31], v[76:79]
    s_waitcnt lgkmcnt(6)
    v_mfma_f32_16x16x32_bf16 v[72:75], v[48:51], a[24:27], v[72:75]
    ds_read_b128 v[44:47], v13 offset:12288
    s_add_u32 m0, s19, 23808
    v_mfma_f32_16x16x32_bf16 v[80:83], v[48:51], a[28:31], v[80:83]
    buffer_load_dwordx4 v2, s[8:11], s20 offen offset:768 lds
    s_waitcnt lgkmcnt(6)
    v_mfma_f32_16x16x32_bf16 v[68:71], v[20:23], a[32:35], v[68:71]
    ds_read_b128 v[48:51], v13 offset:14336
    v_mfma_f32_16x16x32_bf16 v[76:79], v[20:23], a[36:39], v[76:79]
    s_waitcnt lgkmcnt(6)
    v_mfma_f32_16x16x32_bf16 v[72:75], v[24:27], a[32:35], v[72:75]
    ds_read_b128 v[20:23], v12 offset:16384
    s_add_u32 m0, s19, 27776
    v_mfma_f32_16x16x32_bf16 v[80:83], v[24:27], a[36:39], v[80:83]
    buffer_load_dwordx4 v2, s[8:11], s20 offen offset:896 lds
    s_waitcnt lgkmcnt(6)
    v_mfma_f32_16x16x32_bf16 v[68:71], v[28:31], a[40:43], v[68:71]
    ds_read_b128 v[24:27], v12 offset:18432
    v_mfma_f32_16x16x32_bf16 v[76:79], v[28:31], a[44:47], v[76:79]
    v_cvt_pk_bf16_f32 v84, v52, v53
    s_waitcnt lgkmcnt(6)
    v_mfma_f32_16x16x32_bf16 v[72:75], v[32:35], a[40:43], v[72:75]
    ds_read_b128 v[28:31], v13 offset:16384
    v_mfma_f32_16x16x32_bf16 v[80:83], v[32:35], a[44:47], v[80:83]
    v_cvt_pk_bf16_f32 v85, v54, v55
    s_waitcnt lgkmcnt(6)
    v_mfma_f32_16x16x32_bf16 v[68:71], v[36:39], a[48:51], v[68:71]
    ds_read_b128 v[32:35], v13 offset:18432
    v_mfma_f32_16x16x32_bf16 v[76:79], v[36:39], a[52:55], v[76:79]
    v_cvt_pk_bf16_f32 v86, v56, v57
    s_waitcnt lgkmcnt(6)
    v_mfma_f32_16x16x32_bf16 v[72:75], v[40:43], a[48:51], v[72:75]
    ds_read_b128 v[36:39], v12 offset:20480
    v_mfma_f32_16x16x32_bf16 v[80:83], v[40:43], a[52:55], v[80:83]
    v_cvt_pk_bf16_f32 v87, v58, v59
    s_waitcnt lgkmcnt(6)
    v_mfma_f32_16x16x32_bf16 v[68:71], v[44:47], a[56:59], v[68:71]
    ds_read_b128 v[40:43], v12 offset:22528
    v_mfma_f32_16x16x32_bf16 v[76:79], v[44:47], a[60:63], v[76:79]
    v_cvt_pk_bf16_f32 v88, v60, v61
    s_waitcnt lgkmcnt(6)
    v_mfma_f32_16x16x32_bf16 v[72:75], v[48:51], a[56:59], v[72:75]
    ds_read_b128 v[44:47], v13 offset:20480
    v_mfma_f32_16x16x32_bf16 v[80:83], v[48:51], a[60:63], v[80:83]
    v_cvt_pk_bf16_f32 v89, v62, v63
    buffer_store_dwordx4 v[84:87], v3, s[4:7], s21 offen offset:0 sc1
    s_waitcnt lgkmcnt(6)
    v_mfma_f32_16x16x32_bf16 v[68:71], v[20:23], a[64:67], v[68:71]
    ds_read_b128 v[48:51], v13 offset:22528
    v_mfma_f32_16x16x32_bf16 v[76:79], v[20:23], a[68:71], v[76:79]
    v_cvt_pk_bf16_f32 v90, v64, v65
    s_waitcnt lgkmcnt(6)
    v_mfma_f32_16x16x32_bf16 v[72:75], v[24:27], a[64:67], v[72:75]
    ds_read_b128 v[20:23], v12 offset:24576
    v_mfma_f32_16x16x32_bf16 v[80:83], v[24:27], a[68:71], v[80:83]
    v_cvt_pk_bf16_f32 v91, v66, v67
    s_waitcnt lgkmcnt(6)
    v_mfma_f32_16x16x32_bf16 v[68:71], v[28:31], a[72:75], v[68:71]
    ds_read_b128 v[24:27], v12 offset:26624
    v_mfma_f32_16x16x32_bf16 v[76:79], v[28:31], a[76:79], v[76:79]
    s_waitcnt lgkmcnt(6)
    v_mfma_f32_16x16x32_bf16 v[72:75], v[32:35], a[72:75], v[72:75]
    ds_read_b128 v[28:31], v13 offset:24576
    v_mfma_f32_16x16x32_bf16 v[80:83], v[32:35], a[76:79], v[80:83]
    buffer_store_dwordx4 v[88:91], v3, s[4:7], s21 offen offset:256 sc1
    s_waitcnt lgkmcnt(6)
    v_mfma_f32_16x16x32_bf16 v[68:71], v[36:39], a[80:83], v[68:71]
    ds_read_b128 v[32:35], v13 offset:26624
    v_mfma_f32_16x16x32_bf16 v[76:79], v[36:39], a[84:87], v[76:79]
    s_add_u32 s21, s21, s25
    s_mov_b32 s25, s26
    s_waitcnt lgkmcnt(6)
    v_mfma_f32_16x16x32_bf16 v[72:75], v[40:43], a[80:83], v[72:75]
    ds_read_b128 v[36:39], v12 offset:28672
    v_mfma_f32_16x16x32_bf16 v[80:83], v[40:43], a[84:87], v[80:83]
    s_waitcnt lgkmcnt(6)
    v_mfma_f32_16x16x32_bf16 v[68:71], v[44:47], a[88:91], v[68:71]
    ds_read_b128 v[40:43], v12 offset:30720
    v_mfma_f32_16x16x32_bf16 v[76:79], v[44:47], a[92:95], v[76:79]
    s_waitcnt lgkmcnt(6)
    v_mfma_f32_16x16x32_bf16 v[72:75], v[48:51], a[88:91], v[72:75]
    ds_read_b128 v[44:47], v13 offset:28672
    v_mfma_f32_16x16x32_bf16 v[80:83], v[48:51], a[92:95], v[80:83]
    s_waitcnt lgkmcnt(6)
    v_mfma_f32_16x16x32_bf16 v[68:71], v[20:23], a[96:99], v[68:71]
    ds_read_b128 v[48:51], v13 offset:30720
    v_mfma_f32_16x16x32_bf16 v[76:79], v[20:23], a[100:103], v[76:79]
    s_waitcnt lgkmcnt(6)
    v_mfma_f32_16x16x32_bf16 v[72:75], v[24:27], a[96:99], v[72:75]
    s_waitcnt vmcnt(11)
    s_barrier
    ds_read_b128 v[20:23], v12 offset:32768
    v_mfma_f32_16x16x32_bf16 v[80:83], v[24:27], a[100:103], v[80:83]
    s_waitcnt lgkmcnt(6)
    v_mfma_f32_16x16x32_bf16 v[68:71], v[28:31], a[104:107], v[68:71]
    ds_read_b128 v[24:27], v12 offset:34816
    s_add_u32 m0, s19, 31744
    v_mfma_f32_16x16x32_bf16 v[76:79], v[28:31], a[108:111], v[76:79]
    buffer_load_dwordx4 v2, s[8:11], s20 offen offset:1024 lds
    s_waitcnt lgkmcnt(6)
    v_mfma_f32_16x16x32_bf16 v[72:75], v[32:35], a[104:107], v[72:75]
    ds_read_b128 v[28:31], v13 offset:32768
    v_mfma_f32_16x16x32_bf16 v[80:83], v[32:35], a[108:111], v[80:83]
    s_waitcnt lgkmcnt(6)
    v_mfma_f32_16x16x32_bf16 v[68:71], v[36:39], a[112:115], v[68:71]
    ds_read_b128 v[32:35], v13 offset:34816
    s_add_u32 m0, s19, 35712
    v_mfma_f32_16x16x32_bf16 v[76:79], v[36:39], a[116:119], v[76:79]
    buffer_load_dwordx4 v2, s[8:11], s20 offen offset:1152 lds
    s_waitcnt lgkmcnt(6)
    v_mfma_f32_16x16x32_bf16 v[72:75], v[40:43], a[112:115], v[72:75]
    ds_read_b128 v[36:39], v12 offset:36864
    v_mfma_f32_16x16x32_bf16 v[80:83], v[40:43], a[116:119], v[80:83]
    s_waitcnt lgkmcnt(6)
    v_mfma_f32_16x16x32_bf16 v[68:71], v[44:47], a[120:123], v[68:71]
    ds_read_b128 v[40:43], v12 offset:38912
    s_add_u32 m0, s19, 39680
    v_mfma_f32_16x16x32_bf16 v[76:79], v[44:47], a[124:127], v[76:79]
    buffer_load_dwordx4 v2, s[8:11], s20 offen offset:1280 lds
    s_waitcnt lgkmcnt(6)
    v_mfma_f32_16x16x32_bf16 v[72:75], v[48:51], a[120:123], v[72:75]
    ds_read_b128 v[44:47], v13 offset:36864
    v_mfma_f32_16x16x32_bf16 v[80:83], v[48:51], a[124:127], v[80:83]
    s_waitcnt lgkmcnt(6)
    v_mfma_f32_16x16x32_bf16 v[68:71], v[20:23], a[128:131], v[68:71]
    ds_read_b128 v[48:51], v13 offset:38912
    v_mfma_f32_16x16x32_bf16 v[76:79], v[20:23], a[132:135], v[76:79]
    s_waitcnt lgkmcnt(6)
    v_mfma_f32_16x16x32_bf16 v[72:75], v[24:27], a[128:131], v[72:75]
    ds_read_b128 v[20:23], v12 offset:40960
    s_add_u32 m0, s19, 43648
    v_mfma_f32_16x16x32_bf16 v[80:83], v[24:27], a[132:135], v[80:83]
    buffer_load_dwordx4 v2, s[8:11], s20 offen offset:1408 lds
    s_waitcnt lgkmcnt(6)
    v_mfma_f32_16x16x32_bf16 v[68:71], v[28:31], a[136:139], v[68:71]
    ds_read_b128 v[24:27], v12 offset:43008
    v_mfma_f32_16x16x32_bf16 v[76:79], v[28:31], a[140:143], v[76:79]
    s_waitcnt lgkmcnt(6)
    v_mfma_f32_16x16x32_bf16 v[72:75], v[32:35], a[136:139], v[72:75]
    ds_read_b128 v[28:31], v13 offset:40960
    s_add_u32 m0, s19, 47616
    v_mfma_f32_16x16x32_bf16 v[80:83], v[32:35], a[140:143], v[80:83]
    buffer_load_dwordx4 v2, s[8:11], s20 offen offset:1536 lds
    s_waitcnt lgkmcnt(6)
    v_mfma_f32_16x16x32_bf16 v[68:71], v[36:39], a[144:147], v[68:71]
    ds_read_b128 v[32:35], v13 offset:43008
    v_mfma_f32_16x16x32_bf16 v[76:79], v[36:39], a[148:151], v[76:79]
    s_waitcnt lgkmcnt(6)
    v_mfma_f32_16x16x32_bf16 v[72:75], v[40:43], a[144:147], v[72:75]
    ds_read_b128 v[36:39], v12 offset:45056
    s_add_u32 m0, s19, 51584
    v_mfma_f32_16x16x32_bf16 v[80:83], v[40:43], a[148:151], v[80:83]
    buffer_load_dwordx4 v2, s[8:11], s20 offen offset:1664 lds
    s_waitcnt lgkmcnt(6)
    v_mfma_f32_16x16x32_bf16 v[68:71], v[44:47], a[152:155], v[68:71]
    ds_read_b128 v[40:43], v12 offset:47104
    v_mfma_f32_16x16x32_bf16 v[76:79], v[44:47], a[156:159], v[76:79]
    s_waitcnt lgkmcnt(6)
    v_mfma_f32_16x16x32_bf16 v[72:75], v[48:51], a[152:155], v[72:75]
    ds_read_b128 v[44:47], v13 offset:45056
    s_add_u32 m0, s19, 55552
    v_mfma_f32_16x16x32_bf16 v[80:83], v[48:51], a[156:159], v[80:83]
    buffer_load_dwordx4 v2, s[8:11], s20 offen offset:1792 lds
    s_waitcnt lgkmcnt(6)
    v_mfma_f32_16x16x32_bf16 v[68:71], v[20:23], a[160:163], v[68:71]
    ds_read_b128 v[48:51], v13 offset:47104
    v_mfma_f32_16x16x32_bf16 v[76:79], v[20:23], a[164:167], v[76:79]
    s_waitcnt lgkmcnt(6)
    v_mfma_f32_16x16x32_bf16 v[72:75], v[24:27], a[160:163], v[72:75]
    ds_read_b128 v[20:23], v12 offset:49152
    s_add_u32 m0, s19, 59520
    v_mfma_f32_16x16x32_bf16 v[80:83], v[24:27], a[164:167], v[80:83]
    buffer_load_dwordx4 v2, s[8:11], s20 offen offset:1920 lds
    s_waitcnt lgkmcnt(6)
    v_mfma_f32_16x16x32_bf16 v[68:71], v[28:31], a[168:171], v[68:71]
    ds_read_b128 v[24:27], v12 offset:51200
    v_mfma_f32_16x16x32_bf16 v[76:79], v[28:31], a[172:175], v[76:79]
    s_add_u32 s20, s20, s24
    s_waitcnt lgkmcnt(6)
    v_mfma_f32_16x16x32_bf16 v[72:75], v[32:35], a[168:171], v[72:75]
    ds_read_b128 v[28:31], v13 offset:49152
    v_mfma_f32_16x16x32_bf16 v[80:83], v[32:35], a[172:175], v[80:83]
    s_waitcnt lgkmcnt(6)
    v_mfma_f32_16x16x32_bf16 v[68:71], v[36:39], a[176:179], v[68:71]
    ds_read_b128 v[32:35], v13 offset:51200
    v_mfma_f32_16x16x32_bf16 v[76:79], v[36:39], a[180:183], v[76:79]
    s_waitcnt lgkmcnt(6)
    v_mfma_f32_16x16x32_bf16 v[72:75], v[40:43], a[176:179], v[72:75]
    ds_read_b128 v[36:39], v12 offset:53248
    v_mfma_f32_16x16x32_bf16 v[80:83], v[40:43], a[180:183], v[80:83]
    s_waitcnt lgkmcnt(6)
    v_mfma_f32_16x16x32_bf16 v[68:71], v[44:47], a[184:187], v[68:71]
    ds_read_b128 v[40:43], v12 offset:55296
    v_mfma_f32_16x16x32_bf16 v[76:79], v[44:47], a[188:191], v[76:79]
    s_waitcnt lgkmcnt(6)
    v_mfma_f32_16x16x32_bf16 v[72:75], v[48:51], a[184:187], v[72:75]
    ds_read_b128 v[44:47], v13 offset:53248
    v_mfma_f32_16x16x32_bf16 v[80:83], v[48:51], a[188:191], v[80:83]
    s_waitcnt lgkmcnt(6)
    v_mfma_f32_16x16x32_bf16 v[68:71], v[20:23], a[192:195], v[68:71]
    ds_read_b128 v[48:51], v13 offset:55296
    v_mfma_f32_16x16x32_bf16 v[76:79], v[20:23], a[196:199], v[76:79]
    s_waitcnt lgkmcnt(6)
    v_mfma_f32_16x16x32_bf16 v[72:75], v[24:27], a[192:195], v[72:75]
    ds_read_b128 v[20:23], v12 offset:57344
    v_mfma_f32_16x16x32_bf16 v[80:83], v[24:27], a[196:199], v[80:83]
    s_waitcnt lgkmcnt(6)
    v_mfma_f32_16x16x32_bf16 v[68:71], v[28:31], a[200:203], v[68:71]
    ds_read_b128 v[24:27], v12 offset:59392
    v_mfma_f32_16x16x32_bf16 v[76:79], v[28:31], a[204:207], v[76:79]
    s_waitcnt lgkmcnt(6)
    v_mfma_f32_16x16x32_bf16 v[72:75], v[32:35], a[200:203], v[72:75]
    ds_read_b128 v[28:31], v13 offset:57344
    v_mfma_f32_16x16x32_bf16 v[80:83], v[32:35], a[204:207], v[80:83]
    s_waitcnt lgkmcnt(6)
    v_mfma_f32_16x16x32_bf16 v[68:71], v[36:39], a[208:211], v[68:71]
    ds_read_b128 v[32:35], v13 offset:59392
    v_mfma_f32_16x16x32_bf16 v[76:79], v[36:39], a[212:215], v[76:79]
    s_waitcnt lgkmcnt(6)
    v_mfma_f32_16x16x32_bf16 v[72:75], v[40:43], a[208:211], v[72:75]
    ds_read_b128 v[36:39], v12 offset:61440
    v_mfma_f32_16x16x32_bf16 v[80:83], v[40:43], a[212:215], v[80:83]
    s_waitcnt lgkmcnt(6)
    v_mfma_f32_16x16x32_bf16 v[68:71], v[44:47], a[216:219], v[68:71]
    ds_read_b128 v[40:43], v12 offset:63488
    v_mfma_f32_16x16x32_bf16 v[76:79], v[44:47], a[220:223], v[76:79]
    s_waitcnt lgkmcnt(6)
    v_mfma_f32_16x16x32_bf16 v[72:75], v[48:51], a[216:219], v[72:75]
    ds_read_b128 v[44:47], v13 offset:61440
    v_mfma_f32_16x16x32_bf16 v[80:83], v[48:51], a[220:223], v[80:83]
    s_waitcnt lgkmcnt(6)
    v_mfma_f32_16x16x32_bf16 v[68:71], v[20:23], a[224:227], v[68:71]
    ds_read_b128 v[48:51], v13 offset:63488
    v_mfma_f32_16x16x32_bf16 v[76:79], v[20:23], a[228:231], v[76:79]
    s_waitcnt lgkmcnt(6)
    v_mfma_f32_16x16x32_bf16 v[72:75], v[24:27], a[224:227], v[72:75]
    s_waitcnt vmcnt(8)
    s_barrier
    ds_read_b128 v[20:23], v10 offset:0
    v_mfma_f32_16x16x32_bf16 v[80:83], v[24:27], a[228:231], v[80:83]
    s_waitcnt lgkmcnt(6)
    v_mfma_f32_16x16x32_bf16 v[68:71], v[28:31], a[232:235], v[68:71]
    ds_read_b128 v[24:27], v10 offset:2048
    s_add_u32 m0, s19, 65536
    v_mfma_f32_16x16x32_bf16 v[76:79], v[28:31], a[236:239], v[76:79]
    buffer_load_dwordx4 v2, s[8:11], s20 offen offset:0 lds
    s_waitcnt lgkmcnt(6)
    v_mfma_f32_16x16x32_bf16 v[72:75], v[32:35], a[232:235], v[72:75]
    ds_read_b128 v[28:31], v11 offset:0
    v_mfma_f32_16x16x32_bf16 v[80:83], v[32:35], a[236:239], v[80:83]
    v_mov_b32 v9, s23
    s_add_u32 s23, s23, 1
    buffer_store_dword v9, v4, s[4:7], 0 offen sc1
    s_waitcnt lgkmcnt(6)
    v_mfma_f32_16x16x32_bf16 v[68:71], v[36:39], a[240:243], v[68:71]
    ds_read_b128 v[32:35], v11 offset:2048
    s_add_u32 m0, s19, 69504
    v_mfma_f32_16x16x32_bf16 v[76:79], v[36:39], a[244:247], v[76:79]
    buffer_load_dwordx4 v2, s[8:11], s20 offen offset:128 lds
    s_waitcnt lgkmcnt(6)
    v_mfma_f32_16x16x32_bf16 v[72:75], v[40:43], a[240:243], v[72:75]
    ds_read_b128 v[36:39], v10 offset:4096
    v_mfma_f32_16x16x32_bf16 v[80:83], v[40:43], a[244:247], v[80:83]
    s_waitcnt lgkmcnt(6)
    v_mfma_f32_16x16x32_bf16 v[68:71], v[44:47], a[248:251], v[68:71]
    ds_read_b128 v[40:43], v10 offset:6144
    s_add_u32 m0, s19, 73472
    v_mfma_f32_16x16x32_bf16 v[76:79], v[44:47], a[252:255], v[76:79]
    buffer_load_dwordx4 v2, s[8:11], s20 offen offset:256 lds
    s_waitcnt lgkmcnt(6)
    v_mfma_f32_16x16x32_bf16 v[72:75], v[48:51], a[248:251], v[72:75]
    ds_read_b128 v[44:47], v11 offset:4096
    v_mfma_f32_16x16x32_bf16 v[80:83], v[48:51], a[252:255], v[80:83]
    s_add_u32 s22, s22, 2
    s_cmp_lt_u32 s22, 64
    s_cbranch_scc1 P_v_top
    v_cvt_pk_bf16_f32 v84, v68, v69
    v_cvt_pk_bf16_f32 v85, v70, v71
    s_nop 0
    v_cvt_pk_bf16_f32 v86, v72, v73
    v_cvt_pk_bf16_f32 v87, v74, v75
    v_cvt_pk_bf16_f32 v88, v76, v77
    v_cvt_pk_bf16_f32 v89, v78, v79
    v_cvt_pk_bf16_f32 v90, v80, v81
    v_cvt_pk_bf16_f32 v91, v82, v83
    buffer_store_dwordx4 v[84:87], v3, s[4:7], s21 offen offset:0 sc1
    buffer_store_dwordx4 v[88:91], v3, s[4:7], s21 offen offset:256 sc1
    s_waitcnt vmcnt(0) lgkmcnt(0)
    v_mov_b32 v9, s23
    s_add_u32 s23, s23, 1
    buffer_store_dword v9, v4, s[4:7], 0 offen sc1
    s_branch W_U
W_U:
    s_load_dwordx2 s[8:9], s[0:1], 64
    s_load_dwordx2 s[12:13], s[0:1], 80
    s_mov_b32 s10, 8388608
    s_mov_b32 s11, 0x20000
    s_mov_b32 s14, 8388608
    s_mov_b32 s15, 0x20000
    s_lshl_b32 s20, s16, 21
    s_lshl_b32 s17, s91, 6
    s_add_u32 s20, s20, s17
    s_waitcnt lgkmcnt(0)
    s_barrier
    v_lshrrev_b32 v5, 2, v1
    v_and_b32 v6, 3, v1
    v_lshlrev_b32 v7, 4, v6
    v_lshl_add_u32 v7, v5, 11, v7
    v_lshlrev_b32 v8, 4, v6
    v_bfe_u32 v5, v1, 2, 2
    v_lshrrev_b32 v6, 4, v1
    v_lshl_add_u32 v5, v6, 3, v5
    v_lshl_add_u32 v8, v5, 6, v8
    s_lshl_b32 s18, s16, 15
    v_add_u32 v8, s18, v8
    s_add_u32 m0, s18, 0
    s_nop 0
    buffer_load_dwordx4 v7, s[8:11], s20 offen lds
    s_add_u32 s20, s20, 32768
    s_add_u32 m0, s18, 1024
    s_nop 0
    buffer_load_dwordx4 v7, s[8:11], s20 offen lds
    s_add_u32 s20, s20, 32768
    s_add_u32 m0, s18, 2048
    s_nop 0
    buffer_load_dwordx4 v7, s[8:11], s20 offen lds
    s_add_u32 s20, s20, 32768
    s_add_u32 m0, s18, 3072
    s_nop 0
    buffer_load_dwordx4 v7, s[8:11], s20 offen lds
    s_add_u32 s20, s20, 32768
    s_add_u32 m0, s18, 4096
    s_nop 0
    buffer_load_dwordx4 v7, s[8:11], s20 offen lds
    s_add_u32 s20, s20, 32768
    s_add_u32 m0, s18, 5120
    s_nop 0
    buffer_load_dwordx4 v7, s[8:11], s20 offen lds
    s_add_u32 s20, s20, 32768
    s_add_u32 m0, s18, 6144
    s_nop 0
    buffer_load_dwordx4 v7, s[8:11], s20 offen lds
    s_add_u32 s20, s20, 32768
    s_add_u32 m0, s18, 7168
    s_nop 0
    buffer_load_dwordx4 v7, s[8:11], s20 offen lds
    s_add_u32 s20, s20, 32768
    s_add_u32 m0, s18, 8192
    s_nop 0
    buffer_load_dwordx4 v7, s[8:11], s20 offen lds
    s_add_u32 s20, s20, 32768
    s_add_u32 m0, s18, 9216
    s_nop 0
    buffer_load_dwordx4 v7, s[8:11], s20 offen lds
    s_add_u32 s20, s20, 32768
    s_add_u32 m0, s18, 10240
    s_nop 0
    buffer_load_dwordx4 v7, s[8:11], s20 offen lds
    s_add_u32 s20, s20, 32768
    s_add_u32 m0, s18, 11264
    s_nop 0
    buffer_load_dwordx4 v7, s[8:11], s20 offen lds
    s_add_u32 s20, s20, 32768
    s_add_u32 m0, s18, 12288
    s_nop 0
    buffer_load_dwordx4 v7, s[8:11], s20 offen lds
    s_add_u32 s20, s20, 32768
    s_add_u32 m0, s18, 13312
    s_nop 0
    buffer_load_dwordx4 v7, s[8:11], s20 offen lds
    s_add_u32 s20, s20, 32768
    s_add_u32 m0, s18, 14336
    s_nop 0
    buffer_load_dwordx4 v7, s[8:11], s20 offen lds
    s_add_u32 s20, s20, 32768
    s_add_u32 m0, s18, 15360
    s_nop 0
    buffer_load_dwordx4 v7, s[8:11], s20 offen lds
    s_add_u32 s20, s20, 32768
    s_add_u32 m0, s18, 16384
    s_nop 0
    buffer_load_dwordx4 v7, s[8:11], s20 offen lds
    s_add_u32 s20, s20, 32768
    s_add_u32 m0, s18, 17408
    s_nop 0
    buffer_load_dwordx4 v7, s[8:11], s20 offen lds
    s_add_u32 s20, s20, 32768
    s_add_u32 m0, s18, 18432
    s_nop 0
    buffer_load_dwordx4 v7, s[8:11], s20 offen lds
    s_add_u32 s20, s20, 32768
    s_add_u32 m0, s18, 19456
    s_nop 0
    buffer_load_dwordx4 v7, s[8:11], s20 offen lds
    s_add_u32 s20, s20, 32768
    s_add_u32 m0, s18, 20480
    s_nop 0
    buffer_load_dwordx4 v7, s[8:11], s20 offen lds
    s_add_u32 s20, s20, 32768
    s_add_u32 m0, s18, 21504
    s_nop 0
    buffer_load_dwordx4 v7, s[8:11], s20 offen lds
    s_add_u32 s20, s20, 32768
    s_add_u32 m0, s18, 22528
    s_nop 0
    buffer_load_dwordx4 v7, s[8:11], s20 offen lds
    s_add_u32 s20, s20, 32768
    s_add_u32 m0, s18, 23552
    s_nop 0
    buffer_load_dwordx4 v7, s[8:11], s20 offen lds
    s_add_u32 s20, s20, 32768
    s_add_u32 m0, s18, 24576
    s_nop 0
    buffer_load_dwordx4 v7, s[8:11], s20 offen lds
    s_add_u32 s20, s20, 32768
    s_add_u32 m0, s18, 25600
    s_nop 0
    buffer_load_dwordx4 v7, s[8:11], s20 offen lds
    s_add_u32 s20, s20, 32768
    s_add_u32 m0, s18, 26624
    s_nop 0
    buffer_load_dwordx4 v7, s[8:11], s20 offen lds
    s_add_u32 s20, s20, 32768
    s_add_u32 m0, s18, 27648
    s_nop 0
    buffer_load_dwordx4 v7, s[8:11], s20 offen lds
    s_add_u32 s20, s20, 32768
    s_add_u32 m0, s18, 28672
    s_nop 0
    buffer_load_dwordx4 v7, s[8:11], s20 offen lds
    s_add_u32 s20, s20, 32768
    s_add_u32 m0, s18, 29696
    s_nop 0
    buffer_load_dwordx4 v7, s[8:11], s20 offen lds
    s_add_u32 s20, s20, 32768
    s_add_u32 m0, s18, 30720
    s_nop 0
    buffer_load_dwordx4 v7, s[8:11], s20 offen lds
    s_add_u32 s20, s20, 32768
    s_add_u32 m0, s18, 31744
    s_nop 0
    buffer_load_dwordx4 v7, s[8:11], s20 offen lds
    s_add_u32 s20, s20, 32768
    s_waitcnt vmcnt(24)
    ds_read_b64_tr_b16 a[0:1], v8 offset:0
    ds_read_b64_tr_b16 a[2:3], v8 offset:256
    ds_read_b64_tr_b16 a[4:5], v8 offset:8
    ds_read_b64_tr_b16 a[6:7], v8 offset:264
    ds_read_b64_tr_b16 a[8:9], v8 offset:2048
    ds_read_b64_tr_b16 a[10:11], v8 offset:2304
    ds_read_b64_tr_b16 a[12:13], v8 offset:2056
    ds_read_b64_tr_b16 a[14:15], v8 offset:2312
    s_waitcnt lgkmcnt(7)
    ds_read_b64_tr_b16 a[16:17], v8 offset:4096
    ds_read_b64_tr_b16 a[18:19], v8 offset:4352
    ds_read_b64_tr_b16 a[20:21], v8 offset:4104
    ds_read_b64_tr_b16 a[22:23], v8 offset:4360
    ds_read_b64_tr_b16 a[24:25], v8 offset:6144
    ds_read_b64_tr_b16 a[26:27], v8 offset:6400
    ds_read_b64_tr_b16 a[28:29], v8 offset:6152
    ds_read_b64_tr_b16 a[30:31], v8 offset:6408
    s_waitcnt lgkmcnt(7)
    s_waitcnt vmcnt(16)
    ds_read_b64_tr_b16 a[32:33], v8 offset:8192
    ds_read_b64_tr_b16 a[34:35], v8 offset:8448
    ds_read_b64_tr_b16 a[36:37], v8 offset:8200
    ds_read_b64_tr_b16 a[38:39], v8 offset:8456
    ds_read_b64_tr_b16 a[40:41], v8 offset:10240
    ds_read_b64_tr_b16 a[42:43], v8 offset:10496
    ds_read_b64_tr_b16 a[44:45], v8 offset:10248
    ds_read_b64_tr_b16 a[46:47], v8 offset:10504
    s_waitcnt lgkmcnt(7)
    ds_read_b64_tr_b16 a[48:49], v8 offset:12288
    ds_read_b64_tr_b16 a[50:51], v8 offset:12544
    ds_read_b64_tr_b16 a[52:53], v8 offset:12296
    ds_read_b64_tr_b16 a[54:55], v8 offset:12552
    ds_read_b64_tr_b16 a[56:57], v8 offset:14336
    ds_read_b64_tr_b16 a[58:59], v8 offset:14592
    ds_read_b64_tr_b16 a[60:61], v8 offset:14344
    ds_read_b64_tr_b16 a[62:63], v8 offset:14600
    s_waitcnt lgkmcnt(7)
    s_waitcnt vmcnt(8)
    ds_read_b64_tr_b16 a[64:65], v8 offset:16384
    ds_read_b64_tr_b16 a[66:67], v8 offset:16640
    ds_read_b64_tr_b16 a[68:69], v8 offset:16392
    ds_read_b64_tr_b16 a[70:71], v8 offset:16648
    ds_read_b64_tr_b16 a[72:73], v8 offset:18432
    ds_read_b64_tr_b16 a[74:75], v8 offset:18688
    ds_read_b64_tr_b16 a[76:77], v8 offset:18440
    ds_read_b64_tr_b16 a[78:79], v8 offset:18696
    s_waitcnt lgkmcnt(7)
    ds_read_b64_tr_b16 a[80:81], v8 offset:20480
    ds_read_b64_tr_b16 a[82:83], v8 offset:20736
    ds_read_b64_tr_b16 a[84:85], v8 offset:20488
    ds_read_b64_tr_b16 a[86:87], v8 offset:20744
    ds_read_b64_tr_b16 a[88:89], v8 offset:22528
    ds_read_b64_tr_b16 a[90:91], v8 offset:22784
    ds_read_b64_tr_b16 a[92:93], v8 offset:22536
    ds_read_b64_tr_b16 a[94:95], v8 offset:22792
    s_waitcnt lgkmcnt(7)
    s_waitcnt vmcnt(0)
    ds_read_b64_tr_b16 a[96:97], v8 offset:24576
    ds_read_b64_tr_b16 a[98:99], v8 offset:24832
    ds_read_b64_tr_b16 a[100:101], v8 offset:24584
    ds_read_b64_tr_b16 a[102:103], v8 offset:24840
    ds_read_b64_tr_b16 a[104:105], v8 offset:26624
    ds_read_b64_tr_b16 a[106:107], v8 offset:26880
    ds_read_b64_tr_b16 a[108:109], v8 offset:26632
    ds_read_b64_tr_b16 a[110:111], v8 offset:26888
    s_waitcnt lgkmcnt(7)
    ds_read_b64_tr_b16 a[112:113], v8 offset:28672
    ds_read_b64_tr_b16 a[114:115], v8 offset:28928
    ds_read_b64_tr_b16 a[116:117], v8 offset:28680
    ds_read_b64_tr_b16 a[118:119], v8 offset:28936
    ds_read_b64_tr_b16 a[120:121], v8 offset:30720
    ds_read_b64_tr_b16 a[122:123], v8 offset:30976
    ds_read_b64_tr_b16 a[124:125], v8 offset:30728
    ds_read_b64_tr_b16 a[126:127], v8 offset:30984
    s_waitcnt lgkmcnt(7)
    s_waitcnt lgkmcnt(0)
    s_add_u32 m0, s18, 0
    s_nop 0
    buffer_load_dwordx4 v7, s[8:11], s20 offen lds
    s_add_u32 s20, s20, 32768
    s_add_u32 m0, s18, 1024
    s_nop 0
    buffer_load_dwordx4 v7, s[8:11], s20 offen lds
    s_add_u32 s20, s20, 32768
    s_add_u32 m0, s18, 2048
    s_nop 0
    buffer_load_dwordx4 v7, s[8:11], s20 offen lds
    s_add_u32 s20, s20, 32768
    s_add_u32 m0, s18, 3072
    s_nop 0
    buffer_load_dwordx4 v7, s[8:11], s20 offen lds
    s_add_u32 s20, s20, 32768
    s_add_u32 m0, s18, 4096
    s_nop 0
    buffer_load_dwordx4 v7, s[8:11], s20 offen lds
    s_add_u32 s20, s20, 32768
    s_add_u32 m0, s18, 5120
    s_nop 0
    buffer_load_dwordx4 v7, s[8:11], s20 offen lds
    s_add_u32 s20, s20, 32768
    s_add_u32 m0, s18, 6144
    s_nop 0
    buffer_load_dwordx4 v7, s[8:11], s20 offen lds
    s_add_u32 s20, s20, 32768
    s_add_u32 m0, s18, 7168
    s_nop 0
    buffer_load_dwordx4 v7, s[8:11], s20 offen lds
    s_add_u32 s20, s20, 32768
    s_add_u32 m0, s18, 8192
    s_nop 0
    buffer_load_dwordx4 v7, s[8:11], s20 offen lds
    s_add_u32 s20, s20, 32768
    s_add_u32 m0, s18, 9216
    s_nop 0
    buffer_load_dwordx4 v7, s[8:11], s20 offen lds
    s_add_u32 s20, s20, 32768
    s_add_u32 m0, s18, 10240
    s_nop 0
    buffer_load_dwordx4 v7, s[8:11], s20 offen lds
    s_add_u32 s20, s20, 32768
    s_add_u32 m0, s18, 11264
    s_nop 0
    buffer_load_dwordx4 v7, s[8:11], s20 offen lds
    s_add_u32 s20, s20, 32768
    s_add_u32 m0, s18, 12288
    s_nop 0
    buffer_load_dwordx4 v7, s[8:11], s20 offen lds
    s_add_u32 s20, s20, 32768
    s_add_u32 m0, s18, 13312
    s_nop 0
    buffer_load_dwordx4 v7, s[8:11], s20 offen lds
    s_add_u32 s20, s20, 32768
    s_add_u32 m0, s18, 14336
    s_nop 0
    buffer_load_dwordx4 v7, s[8:11], s20 offen lds
    s_add_u32 s20, s20, 32768
    s_add_u32 m0, s18, 15360
    s_nop 0
    buffer_load_dwordx4 v7, s[8:11], s20 offen lds
    s_add_u32 s20, s20, 32768
    s_add_u32 m0, s18, 16384
    s_nop 0
    buffer_load_dwordx4 v7, s[8:11], s20 offen lds
    s_add_u32 s20, s20, 32768
    s_add_u32 m0, s18, 17408
    s_nop 0
    buffer_load_dwordx4 v7, s[8:11], s20 offen lds
    s_add_u32 s20, s20, 32768
    s_add_u32 m0, s18, 18432
    s_nop 0
    buffer_load_dwordx4 v7, s[8:11], s20 offen lds
    s_add_u32 s20, s20, 32768
    s_add_u32 m0, s18, 19456
    s_nop 0
    buffer_load_dwordx4 v7, s[8:11], s20 offen lds
    s_add_u32 s20, s20, 32768
    s_add_u32 m0, s18, 20480
    s_nop 0
    buffer_load_dwordx4 v7, s[8:11], s20 offen lds
    s_add_u32 s20, s20, 32768
    s_add_u32 m0, s18, 21504
    s_nop 0
    buffer_load_dwordx4 v7, s[8:11], s20 offen lds
    s_add_u32 s20, s20, 32768
    s_add_u32 m0, s18, 22528
    s_nop 0
    buffer_load_dwordx4 v7, s[8:11], s20 offen lds
    s_add_u32 s20, s20, 32768
    s_add_u32 m0, s18, 23552
    s_nop 0
    buffer_load_dwordx4 v7, s[8:11], s20 offen lds
    s_add_u32 s20, s20, 32768
    s_add_u32 m0, s18, 24576
    s_nop 0
    buffer_load_dwordx4 v7, s[8:11], s20 offen lds
    s_add_u32 s20, s20, 32768
    s_add_u32 m0, s18, 25600
    s_nop 0
    buffer_load_dwordx4 v7, s[8:11], s20 offen lds
    s_add_u32 s20, s20, 32768
    s_add_u32 m0, s18, 26624
    s_nop 0
    buffer_load_dwordx4 v7, s[8:11], s20 offen lds
    s_add_u32 s20, s20, 32768
    s_add_u32 m0, s18, 27648
    s_nop 0
    buffer_load_dwordx4 v7, s[8:11], s20 offen lds
    s_add_u32 s20, s20, 32768
    s_add_u32 m0, s18, 28672
    s_nop 0
    buffer_load_dwordx4 v7, s[8:11], s20 offen lds
    s_add_u32 s20, s20, 32768
    s_add_u32 m0, s18, 29696
    s_nop 0
    buffer_load_dwordx4 v7, s[8:11], s20 offen lds
    s_add_u32 s20, s20, 32768
    s_add_u32 m0, s18, 30720
    s_nop 0
    buffer_load_dwordx4 v7, s[8:11], s20 offen lds
    s_add_u32 s20, s20, 32768
    s_add_u32 m0, s18, 31744
    s_nop 0
    buffer_load_dwordx4 v7, s[8:11], s20 offen lds
    s_add_u32 s20, s20, 32768
    s_waitcnt vmcnt(24)
    ds_read_b64_tr_b16 a[128:129], v8 offset:0
    ds_read_b64_tr_b16 a[130:131], v8 offset:256
    ds_read_b64_tr_b16 a[132:133], v8 offset:8
    ds_read_b64_tr_b16 a[134:135], v8 offset:264
    ds_read_b64_tr_b16 a[136:137], v8 offset:2048
    ds_read_b64_tr_b16 a[138:139], v8 offset:2304
    ds_read_b64_tr_b16 a[140:141], v8 offset:2056
    ds_read_b64_tr_b16 a[142:143], v8 offset:2312
    s_waitcnt lgkmcnt(7)
    ds_read_b64_tr_b16 a[144:145], v8 offset:4096
    ds_read_b64_tr_b16 a[146:147], v8 offset:4352
    ds_read_b64_tr_b16 a[148:149], v8 offset:4104
    ds_read_b64_tr_b16 a[150:151], v8 offset:4360
    ds_read_b64_tr_b16 a[152:153], v8 offset:6144
    ds_read_b64_tr_b16 a[154:155], v8 offset:6400
    ds_read_b64_tr_b16 a[156:157], v8 offset:6152
    ds_read_b64_tr_b16 a[158:159], v8 offset:6408
    s_waitcnt lgkmcnt(7)
    s_waitcnt vmcnt(16)
    ds_read_b64_tr_b16 a[160:161], v8 offset:8192
    ds_read_b64_tr_b16 a[162:163], v8 offset:8448
    ds_read_b64_tr_b16 a[164:165], v8 offset:8200
    ds_read_b64_tr_b16 a[166:167], v8 offset:8456
    ds_read_b64_tr_b16 a[168:169], v8 offset:10240
    ds_read_b64_tr_b16 a[170:171], v8 offset:10496
    ds_read_b64_tr_b16 a[172:173], v8 offset:10248
    ds_read_b64_tr_b16 a[174:175], v8 offset:10504
    s_waitcnt lgkmcnt(7)
    ds_read_b64_tr_b16 a[176:177], v8 offset:12288
    ds_read_b64_tr_b16 a[178:179], v8 offset:12544
    ds_read_b64_tr_b16 a[180:181], v8 offset:12296
    ds_read_b64_tr_b16 a[182:183], v8 offset:12552
    ds_read_b64_tr_b16 a[184:185], v8 offset:14336
    ds_read_b64_tr_b16 a[186:187], v8 offset:14592
    ds_read_b64_tr_b16 a[188:189], v8 offset:14344
    ds_read_b64_tr_b16 a[190:191], v8 offset:14600
    s_waitcnt lgkmcnt(7)
    s_waitcnt vmcnt(8)
    ds_read_b64_tr_b16 a[192:193], v8 offset:16384
    ds_read_b64_tr_b16 a[194:195], v8 offset:16640
    ds_read_b64_tr_b16 a[196:197], v8 offset:16392
    ds_read_b64_tr_b16 a[198:199], v8 offset:16648
    ds_read_b64_tr_b16 a[200:201], v8 offset:18432
    ds_read_b64_tr_b16 a[202:203], v8 offset:18688
    ds_read_b64_tr_b16 a[204:205], v8 offset:18440
    ds_read_b64_tr_b16 a[206:207], v8 offset:18696
    s_waitcnt lgkmcnt(7)
    ds_read_b64_tr_b16 a[208:209], v8 offset:20480
    ds_read_b64_tr_b16 a[210:211], v8 offset:20736
    ds_read_b64_tr_b16 a[212:213], v8 offset:20488
    ds_read_b64_tr_b16 a[214:215], v8 offset:20744
    ds_read_b64_tr_b16 a[216:217], v8 offset:22528
    ds_read_b64_tr_b16 a[218:219], v8 offset:22784
    ds_read_b64_tr_b16 a[220:221], v8 offset:22536
    ds_read_b64_tr_b16 a[222:223], v8 offset:22792
    s_waitcnt lgkmcnt(7)
    s_waitcnt vmcnt(0)
    ds_read_b64_tr_b16 a[224:225], v8 offset:24576
    ds_read_b64_tr_b16 a[226:227], v8 offset:24832
    ds_read_b64_tr_b16 a[228:229], v8 offset:24584
    ds_read_b64_tr_b16 a[230:231], v8 offset:24840
    ds_read_b64_tr_b16 a[232:233], v8 offset:26624
    ds_read_b64_tr_b16 a[234:235], v8 offset:26880
    ds_read_b64_tr_b16 a[236:237], v8 offset:26632
    ds_read_b64_tr_b16 a[238:239], v8 offset:26888
    s_waitcnt lgkmcnt(7)
    ds_read_b64_tr_b16 a[240:241], v8 offset:28672
    ds_read_b64_tr_b16 a[242:243], v8 offset:28928
    ds_read_b64_tr_b16 a[244:245], v8 offset:28680
    ds_read_b64_tr_b16 a[246:247], v8 offset:28936
    ds_read_b64_tr_b16 a[248:249], v8 offset:30720
    ds_read_b64_tr_b16 a[250:251], v8 offset:30976
    ds_read_b64_tr_b16 a[252:253], v8 offset:30728
    ds_read_b64_tr_b16 a[254:255], v8 offset:30984
    s_waitcnt lgkmcnt(7)
    s_waitcnt lgkmcnt(0)
    v_lshlrev_b32 v15, 4, v1
    s_lshl_b32 s17, s16, 15
    v_add_u32 v10, s17, v15
    s_lshl_b32 s17, s16, 11
    v_add_u32 v14, s17, v15
    v_bfe_u32 v11, v1, 3, 2
    v_and_b32 v5, 7, v1
    v_lshlrev_b32 v5, 2, v5
    v_lshl_add_u32 v11, v11, 7, v5
    s_lshl_b32 s17, s16, 5
    s_add_u32 s17, s17, 100728832
    v_add_u32 v11, s17, v11
    v_mov_b32 v12, 0
    v_and_b32 v13, 15, v1
    v_and_b32 v5, 48, v1
    v_lshl_add_u32 v13, v13, 12, v5
    s_lshl_b32 s17, s91, 6
    s_add_u32 s17, s17, 2048
    v_add_u32 v13, s17, v13
    s_mov_b32 s28, s90
    s_mov_b32 s32, 0
    s_barrier
U_wait:
    s_mov_b32 s29, s92
U_fl:
    s_lshr_b32 s17, s28, 3
    v_cmp_ge_u32 vcc, s17, v12
    s_lshl_b32 s18, s28, 2
    s_and_b32 s18, s18, 24
    s_lshr_b32 s17, vcc_lo, s18
    s_and_b32 s17, s17, 0xff
    s_cbranch_scc0 U_go
    s_cmp_ge_u32 s29, 1048576
    s_cselect_b32 s92, 1048576, s92
    s_cbranch_scc1 U_go
    s_add_u32 s29, s29, 1
    s_mov_b64 exec, 0xffffffff
    buffer_load_dword v12, v11, s[4:7], 0 offen sc1
    s_mov_b64 exec, -1
    s_sleep 2
    s_waitcnt vmcnt(0)
    s_branch U_fl
U_go:
    s_lshl_b32 s30, s28, 17
    s_add_u32 s30, s30, 54525952
    buffer_load_dwordx4 v[64:67], v10, s[4:7], s30 offen offset:0 sc1
    buffer_load_dwordx4 v[68:71], v10, s[4:7], s30 offen offset:1024 sc1
    buffer_load_dwordx4 v[72:75], v10, s[4:7], s30 offen offset:2048 sc1
    buffer_load_dwordx4 v[76:79], v10, s[4:7], s30 offen offset:3072 sc1
    s_add_u32 s30, s30, 4096
    buffer_load_dwordx4 v[80:83], v10, s[4:7], s30 offen offset:0 sc1
    buffer_load_dwordx4 v[84:87], v10, s[4:7], s30 offen offset:1024 sc1
    buffer_load_dwordx4 v[88:91], v10, s[4:7], s30 offen offset:2048 sc1
    buffer_load_dwordx4 v[92:95], v10, s[4:7], s30 offen offset:3072 sc1
    s_add_u32 s30, s30, 4096
    buffer_load_dwordx4 v[96:99], v10, s[4:7], s30 offen offset:0 sc1
    buffer_load_dwordx4 v[100:103], v10, s[4:7], s30 offen offset:1024 sc1
    buffer_load_dwordx4 v[104:107], v10, s[4:7], s30 offen offset:2048 sc1
    buffer_load_dwordx4 v[108:111], v10, s[4:7], s30 offen offset:3072 sc1
    s_add_u32 s30, s30, 4096
    buffer_load_dwordx4 v[112:115], v10, s[4:7], s30 offen offset:0 sc1
    buffer_load_dwordx4 v[116:119], v10, s[4:7], s30 offen offset:1024 sc1
    buffer_load_dwordx4 v[120:123], v10, s[4:7], s30 offen offset:2048 sc1
    buffer_load_dwordx4 v[124:127], v10, s[4:7], s30 offen offset:3072 sc1
    s_add_u32 s30, s30, 4096
    buffer_load_dwordx4 v[128:131], v10, s[4:7], s30 offen offset:0 sc1
    buffer_load_dwordx4 v[132:135], v10, s[4:7], s30 offen offset:1024 sc1
    buffer_load_dwordx4 v[136:139], v10, s[4:7], s30 offen offset:2048 sc1
    buffer_load_dwordx4 v[140:143], v10, s[4:7], s30 offen offset:3072 sc1
    s_add_u32 s30, s30, 4096
    buffer_load_dwordx4 v[144:147], v10, s[4:7], s30 offen offset:0 sc1
    buffer_load_dwordx4 v[148:151], v10, s[4:7], s30 offen offset:1024 sc1
    buffer_load_dwordx4 v[152:155], v10, s[4:7], s30 offen offset:2048 sc1
    buffer_load_dwordx4 v[156:159], v10, s[4:7], s30 offen offset:3072 sc1
    s_add_u32 s30, s30, 4096
    buffer_load_dwordx4 v[160:163], v10, s[4:7], s30 offen offset:0 sc1
    buffer_load_dwordx4 v[164:167], v10, s[4:7], s30 offen offset:1024 sc1
    buffer_load_dwordx4 v[168:171], v10, s[4:7], s30 offen offset:2048 sc1
    buffer_load_dwordx4 v[172:175], v10, s[4:7], s30 offen offset:3072 sc1
    s_add_u32 s30, s30, 4096
    buffer_load_dwordx4 v[176:179], v10, s[4:7], s30 offen offset:0 sc1
    buffer_load_dwordx4 v[180:183], v10, s[4:7], s30 offen offset:1024 sc1
    buffer_load_dwordx4 v[184:187], v10, s[4:7], s30 offen offset:2048 sc1
    buffer_load_dwordx4 v[188:191], v10, s[4:7], s30 offen offset:3072 sc1
U_item:
    s_add_u32 s33, s28, 3
    s_lshr_b32 s17, s33, 3
    v_cmp_ge_u32 vcc, s17, v12
    s_lshl_b32 s18, s33, 2
    s_and_b32 s18, s18, 24
    s_lshr_b32 s17, vcc_lo, s18
    s_and_b32 s17, s17, 0xff
    s_cbranch_scc1 U_b
    s_lshl_b32 s30, s33, 17
    s_add_u32 s30, s30, 54525952
    s_waitcnt vmcnt(31)
    v_mfma_f32_16x16x32_bf16 v[16:19], a[0:3], v[64:67], 0
    v_mfma_f32_16x16x32_bf16 v[20:23], a[4:7], v[64:67], 0
    s_waitcnt vmcnt(30)
    v_mfma_f32_16x16x32_bf16 v[16:19], a[8:11], v[68:71], v[16:19]
    v_mfma_f32_16x16x32_bf16 v[20:23], a[12:15], v[68:71], v[20:23]
    buffer_load_dwordx4 v[64:67], v10, s[4:7], s30 offen offset:0 sc1
    s_waitcnt vmcnt(30)
    v_mfma_f32_16x16x32_bf16 v[16:19], a[16:19], v[72:75], v[16:19]
    v_mfma_f32_16x16x32_bf16 v[20:23], a[20:23], v[72:75], v[20:23]
    buffer_load_dwordx4 v[68:71], v10, s[4:7], s30 offen offset:1024 sc1
    s_waitcnt vmcnt(30)
    v_mfma_f32_16x16x32_bf16 v[16:19], a[24:27], v[76:79], v[16:19]
    v_mfma_f32_16x16x32_bf16 v[20:23], a[28:31], v[76:79], v[20:23]
    buffer_load_dwordx4 v[72:75], v10, s[4:7], s30 offen offset:2048 sc1
    s_waitcnt vmcnt(30)
    v_mfma_f32_16x16x32_bf16 v[16:19], a[32:35], v[80:83], v[16:19]
    v_mfma_f32_16x16x32_bf16 v[20:23], a[36:39], v[80:83], v[20:23]
    buffer_load_dwordx4 v[76:79], v10, s[4:7], s30 offen offset:3072 sc1
    s_waitcnt vmcnt(30)
    v_mfma_f32_16x16x32_bf16 v[16:19], a[40:43], v[84:87], v[16:19]
    v_mfma_f32_16x16x32_bf16 v[20:23], a[44:47], v[84:87], v[20:23]
    s_add_u32 s30, s30, 4096
    buffer_load_dwordx4 v[80:83], v10, s[4:7], s30 offen offset:0 sc1
    s_waitcnt vmcnt(30)
    v_mfma_f32_16x16x32_bf16 v[16:19], a[48:51], v[88:91], v[16:19]
    v_mfma_f32_16x16x32_bf16 v[20:23], a[52:55], v[88:91], v[20:23]
    buffer_load_dwordx4 v[84:87], v10, s[4:7], s30 offen offset:1024 sc1
    s_waitcnt vmcnt(30)
    v_mfma_f32_16x16x32_bf16 v[16:19], a[56:59], v[92:95], v[16:19]
    v_mfma_f32_16x16x32_bf16 v[20:23], a[60:63], v[92:95], v[20:23]
    buffer_load_dwordx4 v[88:91], v10, s[4:7], s30 offen offset:2048 sc1
    s_waitcnt vmcnt(30)
    v_mfma_f32_16x16x32_bf16 v[16:19], a[64:67], v[96:99], v[16:19]
    v_mfma_f32_16x16x32_bf16 v[20:23], a[68:71], v[96:99], v[20:23]
    buffer_load_dwordx4 v[92:95], v10, s[4:7], s30 offen offset:3072 sc1
    s_waitcnt vmcnt(30)
    v_mfma_f32_16x16x32_bf16 v[16:19], a[72:75], v[100:103], v[16:19]
    v_mfma_f32_16x16x32_bf16 v[20:23], a[76:79], v[100:103], v[20:23]
    s_add_u32 s30, s30, 4096
    buffer_load_dwordx4 v[96:99], v10, s[4:7], s30 offen offset:0 sc1
    s_waitcnt vmcnt(30)
    v_mfma_f32_16x16x32_bf16 v[16:19], a[80:83], v[104:107], v[16:19]
    v_mfma_f32_16x16x32_bf16 v[20:23], a[84:87], v[104:107], v[20:23]
    buffer_load_dwordx4 v[100:103], v10, s[4:7], s30 offen offset:1024 sc1
    s_waitcnt vmcnt(30)
    v_mfma_f32_16x16x32_bf16 v[16:19], a[88:91], v[108:111], v[16:19]
    v_mfma_f32_16x16x32_bf16 v[20:23], a[92:95], v[108:111], v[20:23]
    buffer_load_dwordx4 v[104:107], v10, s[4:7], s30 offen offset:2048 sc1
    s_waitcnt vmcnt(30)
    v_mfma_f32_16x16x32_bf16 v[16:19], a[96:99], v[112:115], v[16:19]
    v_mfma_f32_16x16x32_bf16 v[20:23], a[100:103], v[112:115], v[20:23]
    buffer_load_dwordx4 v[108:111], v10, s[4:7], s30 offen offset:3072 sc1
    s_waitcnt vmcnt(30)
    v_mfma_f32_16x16x32_bf16 v[16:19], a[104:107], v[116:119], v[16:19]
    v_mfma_f32_16x16x32_bf16 v[20:23], a[108:111], v[116:119], v[20:23]
    s_add_u32 s30, s30, 4096
    buffer_load_dwordx4 v[112:115], v10, s[4:7], s30 offen offset:0 sc1
    s_waitcnt vmcnt(30)
    v_mfma_f32_16x16x32_bf16 v[16:19], a[112:115], v[120:123], v[16:19]
    v_mfma_f32_16x16x32_bf16 v[20:23], a[116:119], v[120:123], v[20:23]
    buffer_load_dwordx4 v[116:119], v10, s[4:7], s30 offen offset:1024 sc1
    s_waitcnt vmcnt(30)
    v_mfma_f32_16x16x32_bf16 v[16:19], a[120:123], v[124:127], v[16:19]
    v_mfma_f32_16x16x32_bf16 v[20:23], a[124:127], v[124:127], v[20:23]
    buffer_load_dwordx4 v[120:123], v10, s[4:7], s30 offen offset:2048 sc1
    s_waitcnt vmcnt(30)
    v_mfma_f32_16x16x32_bf16 v[16:19], a[128:131], v[128:131], v[16:19]
    v_mfma_f32_16x16x32_bf16 v[20:23], a[132:135], v[128:131], v[20:23]
    buffer_load_dwordx4 v[124:127], v10, s[4:7], s30 offen offset:3072 sc1
    s_waitcnt vmcnt(30)
    v_mfma_f32_16x16x32_bf16 v[16:19], a[136:139], v[132:135], v[16:19]
    v_mfma_f32_16x16x32_bf16 v[20:23], a[140:143], v[132:135], v[20:23]
    s_add_u32 s30, s30, 4096
    buffer_load_dwordx4 v[128:131], v10, s[4:7], s30 offen offset:0 sc1
    s_waitcnt vmcnt(30)
    v_mfma_f32_16x16x32_bf16 v[16:19], a[144:147], v[136:139], v[16:19]
    v_mfma_f32_16x16x32_bf16 v[20:23], a[148:151], v[136:139], v[20:23]
    buffer_load_dwordx4 v[132:135], v10, s[4:7], s30 offen offset:1024 sc1
    s_waitcnt vmcnt(30)
    v_mfma_f32_16x16x32_bf16 v[16:19], a[152:155], v[140:143], v[16:19]
    v_mfma_f32_16x16x32_bf16 v[20:23], a[156:159], v[140:143], v[20:23]
    buffer_load_dwordx4 v[136:139], v10, s[4:7], s30 offen offset:2048 sc1
    s_waitcnt vmcnt(30)
    v_mfma_f32_16x16x32_bf16 v[16:19], a[160:163], v[144:147], v[16:19]
    v_mfma_f32_16x16x32_bf16 v[20:23], a[164:167], v[144:147], v[20:23]
    buffer_load_dwordx4 v[140:143], v10, s[4:7], s30 offen offset:3072 sc1
    s_waitcnt vmcnt(30)
    v_mfma_f32_16x16x32_bf16 v[16:19], a[168:171], v[148:151], v[16:19]
    v_mfma_f32_16x16x32_bf16 v[20:23], a[172:175], v[148:151], v[20:23]
    s_add_u32 s30, s30, 4096
    buffer_load_dwordx4 v[144:147], v10, s[4:7], s30 offen offset:0 sc1
    s_waitcnt vmcnt(30)
    v_mfma_f32_16x16x32_bf16 v[16:19], a[176:179], v[152:155], v[16:19]
    v_mfma_f32_16x16x32_bf16 v[20:23], a[180:183], v[152:155], v[20:23]
    buffer_load_dwordx4 v[148:151], v10, s[4:7], s30 offen offset:1024 sc1
    s_waitcnt vmcnt(30)
    v_mfma_f32_16x16x32_bf16 v[16:19], a[184:187], v[156:159], v[16:19]
    v_mfma_f32_16x16x32_bf16 v[20:23], a[188:191], v[156:159], v[20:23]
    buffer_load_dwordx4 v[152:155], v10, s[4:7], s30 offen offset:2048 sc1
    s_waitcnt vmcnt(30)
    v_mfma_f32_16x16x32_bf16 v[16:19], a[192:195], v[160:163], v[16:19]
    v_mfma_f32_16x16x32_bf16 v[20:23], a[196:199], v[160:163], v[20:23]
    buffer_load_dwordx4 v[156:159], v10, s[4:7], s30 offen offset:3072 sc1
    s_waitcnt vmcnt(30)
    v_mfma_f32_16x16x32_bf16 v[16:19], a[200:203], v[164:167], v[16:19]
    v_mfma_f32_16x16x32_bf16 v[20:23], a[204:207], v[164:167], v[20:23]
    s_add_u32 s30, s30, 4096
    buffer_load_dwordx4 v[160:163], v10, s[4:7], s30 offen offset:0 sc1
    s_waitcnt vmcnt(30)
    v_mfma_f32_16x16x32_bf16 v[16:19], a[208:211], v[168:171], v[16:19]
    v_mfma_f32_16x16x32_bf16 v[20:23], a[212:215], v[168:171], v[20:23]
    buffer_load_dwordx4 v[164:167], v10, s[4:7], s30 offen offset:1024 sc1
    s_waitcnt vmcnt(30)
    v_mfma_f32_16x16x32_bf16 v[16:19], a[216:219], v[172:175], v[16:19]
    v_mfma_f32_16x16x32_bf16 v[20:23], a[220:223], v[172:175], v[20:23]
    buffer_load_dwordx4 v[168:171], v10, s[4:7], s30 offen offset:2048 sc1
    s_waitcnt vmcnt(30)
    v_mfma_f32_16x16x32_bf16 v[16:19], a[224:227], v[176:179], v[16:19]
    v_mfma_f32_16x16x32_bf16 v[20:23], a[228:231], v[176:179], v[20:23]
    buffer_load_dwordx4 v[172:175], v10, s[4:7], s30 offen offset:3072 sc1
    s_waitcnt vmcnt(30)
    v_mfma_f32_16x16x32_bf16 v[16:19], a[232:235], v[180:183], v[16:19]
    v_mfma_f32_16x16x32_bf16 v[20:23], a[236:239], v[180:183], v[20:23]
    s_add_u32 s30, s30, 4096
    buffer_load_dwordx4 v[176:179], v10, s[4:7], s30 offen offset:0 sc1
    s_waitcnt vmcnt(30)
    v_mfma_f32_16x16x32_bf16 v[16:19], a[240:243], v[184:187], v[16:19]
    v_mfma_f32_16x16x32_bf16 v[20:23], a[244:247], v[184:187], v[20:23]
    buffer_load_dwordx4 v[180:183], v10, s[4:7], s30 offen offset:1024 sc1
    s_waitcnt vmcnt(30)
    v_mfma_f32_16x16x32_bf16 v[16:19], a[248:251], v[188:191], v[16:19]
    v_mfma_f32_16x16x32_bf16 v[20:23], a[252:255], v[188:191], v[20:23]
    buffer_load_dwordx4 v[184:187], v10, s[4:7], s30 offen offset:2048 sc1
    s_nop 7
    buffer_load_dwordx4 v[188:191], v10, s[4:7], s30 offen offset:3072 sc1
    s_lshl_b32 s31, s28, 16
    v_add_u32 v5, s32, v14
    v_add_u32 v6, s32, v15
    s_xor_b32 s32, s32, 8192
    s_mov_b32 s28, s33
    ds_write_b128 v5, v[16:19]
    ds_write_b128 v5, v[20:23] offset:1024
    s_waitcnt lgkmcnt(0)
    s_barrier
    s_cmp_lg_u32 s16, 0
    s_cbranch_scc1 Uf_14
    ds_read_b128 v[24:27], v6 offset:2048
    ds_read_b128 v[28:31], v6 offset:3072
    ds_read_b128 v[32:35], v6 offset:4096
    ds_read_b128 v[36:39], v6 offset:5120
    ds_read_b128 v[40:43], v6 offset:6144
    ds_read_b128 v[44:47], v6 offset:7168
    s_waitcnt lgkmcnt(4)
    v_add_f32 v24, v16, v24
    v_add_f32 v25, v17, v25
    v_add_f32 v26, v18, v26
    v_add_f32 v27, v19, v27
    v_add_f32 v28, v20, v28
    v_add_f32 v29, v21, v29
    v_add_f32 v30, v22, v30
    v_add_f32 v31, v23, v31
    s_waitcnt lgkmcnt(0)
    v_add_f32 v32, v32, v40
    v_add_f32 v33, v33, v41
    v_add_f32 v34, v34, v42
    v_add_f32 v35, v35, v43
    v_add_f32 v36, v36, v44
    v_add_f32 v37, v37, v45
    v_add_f32 v38, v38, v46
    v_add_f32 v39, v39, v47
    v_add_f32 v24, v24, v32
    v_add_f32 v25, v25, v33
    v_add_f32 v26, v26, v34
    v_add_f32 v27, v27, v35
    v_add_f32 v28, v28, v36
    v_add_f32 v29, v29, v37
    v_add_f32 v30, v30, v38
    v_add_f32 v31, v31, v39
    v_cvt_pk_bf16_f32 v48, v24, v25
    v_cvt_pk_bf16_f32 v49, v26, v27
    v_cvt_pk_bf16_f32 v50, v28, v29
    v_cvt_pk_bf16_f32 v51, v30, v31
    buffer_store_dwordx4 v[48:51], v13, s[12:15], s31 offen
Uf_14:
    s_cmp_lt_u32 s28, 128
    s_cbranch_scc1 U_item
    s_branch W_fin
U_b:
    s_waitcnt vmcnt(31)
    v_mfma_f32_16x16x32_bf16 v[16:19], a[0:3], v[64:67], 0
    v_mfma_f32_16x16x32_bf16 v[20:23], a[4:7], v[64:67], 0
    s_waitcnt vmcnt(30)
    v_mfma_f32_16x16x32_bf16 v[16:19], a[8:11], v[68:71], v[16:19]
    v_mfma_f32_16x16x32_bf16 v[20:23], a[12:15], v[68:71], v[20:23]
    s_waitcnt vmcnt(29)
    v_mfma_f32_16x16x32_bf16 v[16:19], a[16:19], v[72:75], v[16:19]
    v_mfma_f32_16x16x32_bf16 v[20:23], a[20:23], v[72:75], v[20:23]
    s_waitcnt vmcnt(28)
    v_mfma_f32_16x16x32_bf16 v[16:19], a[24:27], v[76:79], v[16:19]
    v_mfma_f32_16x16x32_bf16 v[20:23], a[28:31], v[76:79], v[20:23]
    s_waitcnt vmcnt(27)
    v_mfma_f32_16x16x32_bf16 v[16:19], a[32:35], v[80:83], v[16:19]
    v_mfma_f32_16x16x32_bf16 v[20:23], a[36:39], v[80:83], v[20:23]
    s_waitcnt vmcnt(26)
    v_mfma_f32_16x16x32_bf16 v[16:19], a[40:43], v[84:87], v[16:19]
    v_mfma_f32_16x16x32_bf16 v[20:23], a[44:47], v[84:87], v[20:23]
    s_waitcnt vmcnt(25)
    v_mfma_f32_16x16x32_bf16 v[16:19], a[48:51], v[88:91], v[16:19]
    v_mfma_f32_16x16x32_bf16 v[20:23], a[52:55], v[88:91], v[20:23]
    s_waitcnt vmcnt(24)
    v_mfma_f32_16x16x32_bf16 v[16:19], a[56:59], v[92:95], v[16:19]
    v_mfma_f32_16x16x32_bf16 v[20:23], a[60:63], v[92:95], v[20:23]
    s_waitcnt vmcnt(23)
    v_mfma_f32_16x16x32_bf16 v[16:19], a[64:67], v[96:99], v[16:19]
    v_mfma_f32_16x16x32_bf16 v[20:23], a[68:71], v[96:99], v[20:23]
    s_waitcnt vmcnt(22)
    v_mfma_f32_16x16x32_bf16 v[16:19], a[72:75], v[100:103], v[16:19]
    v_mfma_f32_16x16x32_bf16 v[20:23], a[76:79], v[100:103], v[20:23]
    s_waitcnt vmcnt(21)
    v_mfma_f32_16x16x32_bf16 v[16:19], a[80:83], v[104:107], v[16:19]
    v_mfma_f32_16x16x32_bf16 v[20:23], a[84:87], v[104:107], v[20:23]
    s_waitcnt vmcnt(20)
    v_mfma_f32_16x16x32_bf16 v[16:19], a[88:91], v[108:111], v[16:19]
    v_mfma_f32_16x16x32_bf16 v[20:23], a[92:95], v[108:111], v[20:23]
    s_waitcnt vmcnt(19)
    v_mfma_f32_16x16x32_bf16 v[16:19], a[96:99], v[112:115], v[16:19]
    v_mfma_f32_16x16x32_bf16 v[20:23], a[100:103], v[112:115], v[20:23]
    s_waitcnt vmcnt(18)
    v_mfma_f32_16x16x32_bf16 v[16:19], a[104:107], v[116:119], v[16:19]
    v_mfma_f32_16x16x32_bf16 v[20:23], a[108:111], v[116:119], v[20:23]
    s_waitcnt vmcnt(17)
    v_mfma_f32_16x16x32_bf16 v[16:19], a[112:115], v[120:123], v[16:19]
    v_mfma_f32_16x16x32_bf16 v[20:23], a[116:119], v[120:123], v[20:23]
    s_waitcnt vmcnt(16)
    v_mfma_f32_16x16x32_bf16 v[16:19], a[120:123], v[124:127], v[16:19]
    v_mfma_f32_16x16x32_bf16 v[20:23], a[124:127], v[124:127], v[20:23]
    s_waitcnt vmcnt(15)
    v_mfma_f32_16x16x32_bf16 v[16:19], a[128:131], v[128:131], v[16:19]
    v_mfma_f32_16x16x32_bf16 v[20:23], a[132:135], v[128:131], v[20:23]
    s_waitcnt vmcnt(14)
    v_mfma_f32_16x16x32_bf16 v[16:19], a[136:139], v[132:135], v[16:19]
    v_mfma_f32_16x16x32_bf16 v[20:23], a[140:143], v[132:135], v[20:23]
    s_waitcnt vmcnt(13)
    v_mfma_f32_16x16x32_bf16 v[16:19], a[144:147], v[136:139], v[16:19]
    v_mfma_f32_16x16x32_bf16 v[20:23], a[148:151], v[136:139], v[20:23]
    s_waitcnt vmcnt(12)
    v_mfma_f32_16x16x32_bf16 v[16:19], a[152:155], v[140:143], v[16:19]
    v_mfma_f32_16x16x32_bf16 v[20:23], a[156:159], v[140:143], v[20:23]
    s_waitcnt vmcnt(11)
    v_mfma_f32_16x16x32_bf16 v[16:19], a[160:163], v[144:147], v[16:19]
    v_mfma_f32_16x16x32_bf16 v[20:23], a[164:167], v[144:147], v[20:23]
    s_waitcnt vmcnt(10)
    v_mfma_f32_16x16x32_bf16 v[16:19], a[168:171], v[148:151], v[16:19]
    v_mfma_f32_16x16x32_bf16 v[20:23], a[172:175], v[148:151], v[20:23]
    s_waitcnt vmcnt(9)
    v_mfma_f32_16x16x32_bf16 v[16:19], a[176:179], v[152:155], v[16:19]
    v_mfma_f32_16x16x32_bf16 v[20:23], a[180:183], v[152:155], v[20:23]
    s_waitcnt vmcnt(8)
    v_mfma_f32_16x16x32_bf16 v[16:19], a[184:187], v[156:159], v[16:19]
    v_mfma_f32_16x16x32_bf16 v[20:23], a[188:191], v[156:159], v[20:23]
    s_waitcnt vmcnt(7)
    v_mfma_f32_16x16x32_bf16 v[16:19], a[192:195], v[160:163], v[16:19]
    v_mfma_f32_16x16x32_bf16 v[20:23], a[196:199], v[160:163], v[20:23]
    s_waitcnt vmcnt(6)
    v_mfma_f32_16x16x32_bf16 v[16:19], a[200:203], v[164:167], v[16:19]
    v_mfma_f32_16x16x32_bf16 v[20:23], a[204:207], v[164:167], v[20:23]
    s_waitcnt vmcnt(5)
    v_mfma_f32_16x16x32_bf16 v[16:19], a[208:211], v[168:171], v[16:19]
    v_mfma_f32_16x16x32_bf16 v[20:23], a[212:215], v[168:171], v[20:23]
    s_waitcnt vmcnt(4)
    v_mfma_f32_16x16x32_bf16 v[16:19], a[216:219], v[172:175], v[16:19]
    v_mfma_f32_16x16x32_bf16 v[20:23], a[220:223], v[172:175], v[20:23]
    s_waitcnt vmcnt(3)
    v_mfma_f32_16x16x32_bf16 v[16:19], a[224:227], v[176:179], v[16:19]
    v_mfma_f32_16x16x32_bf16 v[20:23], a[228:231], v[176:179], v[20:23]
    s_waitcnt vmcnt(2)
    v_mfma_f32_16x16x32_bf16 v[16:19], a[232:235], v[180:183], v[16:19]
    v_mfma_f32_16x16x32_bf16 v[20:23], a[236:239], v[180:183], v[20:23]
    s_waitcnt vmcnt(1)
    v_mfma_f32_16x16x32_bf16 v[16:19], a[240:243], v[184:187], v[16:19]
    v_mfma_f32_16x16x32_bf16 v[20:23], a[244:247], v[184:187], v[20:23]
    s_waitcnt vmcnt(0)
    v_mfma_f32_16x16x32_bf16 v[16:19], a[248:251], v[188:191], v[16:19]
    v_mfma_f32_16x16x32_bf16 v[20:23], a[252:255], v[188:191], v[20:23]
    s_lshl_b32 s31, s28, 16
    v_add_u32 v5, s32, v14
    v_add_u32 v6, s32, v15
    s_xor_b32 s32, s32, 8192
    s_mov_b32 s28, s33
    ds_write_b128 v5, v[16:19]
    s_nop 1
    ds_write_b128 v5, v[20:23] offset:1024
    s_waitcnt lgkmcnt(0)
    s_barrier
    s_cmp_lg_u32 s16, 0
    s_cbranch_scc1 Uf_15
    ds_read_b128 v[24:27], v6 offset:2048
    ds_read_b128 v[28:31], v6 offset:3072
    ds_read_b128 v[32:35], v6 offset:4096
    ds_read_b128 v[36:39], v6 offset:5120
    ds_read_b128 v[40:43], v6 offset:6144
    ds_read_b128 v[44:47], v6 offset:7168
    s_waitcnt lgkmcnt(4)
    v_add_f32 v24, v16, v24
    v_add_f32 v25, v17, v25
    v_add_f32 v26, v18, v26
    v_add_f32 v27, v19, v27
    v_add_f32 v28, v20, v28
    v_add_f32 v29, v21, v29
    v_add_f32 v30, v22, v30
    v_add_f32 v31, v23, v31
    s_waitcnt lgkmcnt(0)
    v_add_f32 v32, v32, v40
    v_add_f32 v33, v33, v41
    v_add_f32 v34, v34, v42
    v_add_f32 v35, v35, v43
    v_add_f32 v36, v36, v44
    v_add_f32 v37, v37, v45
    v_add_f32 v38, v38, v46
    v_add_f32 v39, v39, v47
    v_add_f32 v24, v24, v32
    v_add_f32 v25, v25, v33
    v_add_f32 v26, v26, v34
    v_add_f32 v27, v27, v35
    v_add_f32 v28, v28, v36
    v_add_f32 v29, v29, v37
    v_add_f32 v30, v30, v38
    v_add_f32 v31, v31, v39
    v_cvt_pk_bf16_f32 v48, v24, v25
    v_cvt_pk_bf16_f32 v49, v26, v27
    v_cvt_pk_bf16_f32 v50, v28, v29
    v_cvt_pk_bf16_f32 v51, v30, v31
    buffer_store_dwordx4 v[48:51], v13, s[12:15], s31 offen
Uf_15:
    s_cmp_lt_u32 s28, 128
    s_cbranch_scc1 U_wait
    s_branch W_fin
W_F:
    v_and_b32 v10, 19, v1
    v_bfe_u32 v5, v1, 2, 1
    v_bfe_u32 v6, v1, 3, 1
    v_lshl_add_u32 v10, v5, 3, v10
    v_lshl_add_u32 v10, v6, 2, v10
    s_load_dwordx2 s[8:9], s[0:1], 8
    s_load_dwordx2 s[12:13], s[0:1], 16
    s_mov_b32 s10, 2101248
    s_mov_b32 s11, 0x20000
    s_mov_b32 s14, 2101248
    s_mov_b32 s15, 0x20000
    v_lshrrev_b32 v11, 5, v1
    v_lshl_add_u32 v12, v11, 9, v10
    v_mul_u32_u24 v12, 1026, v12
    v_and_b32 v13, 1, v1
    v_lshlrev_b32 v13, 4, v13
    v_lshlrev_b32 v14, 4, v1
    s_lshr_b32 s17, s16, 1
    s_and_b32 s18, s16, 1
    s_lshl_b32 s17, s17, 5
    s_lshl_b32 s18, s18, 10
    s_add_u32 s17, s17, s18
    s_mul_i32 s20, s17, 1026
    s_lshl_b32 s17, s91, 5
    s_add_u32 s20, s20, s17
    s_lshl_b32 s21, s91, 17
    s_lshl_b32 s17, s16, 11
    s_add_u32 s21, s21, s17
    s_add_u32 s21, s21, 117440512
    v_and_b32 v7, -4, v12
    s_mov_b32 s28, 0x05040100
    s_mov_b32 s29, 0x07060302
    s_waitcnt lgkmcnt(0)
    buffer_load_dwordx4 v[20:23], v7, s[8:11], s20 offen
    buffer_load_dwordx4 v[24:27], v7, s[8:11], s20 offen offset:16
    buffer_load_dword v28, v7, s[8:11], s20 offen offset:32
    buffer_load_dwordx4 v[30:33], v7, s[12:15], s20 offen
    buffer_load_dwordx4 v[34:37], v7, s[12:15], s20 offen offset:16
    buffer_load_dword v38, v7, s[12:15], s20 offen offset:32
    s_add_u32 s20, s20, 65664
    buffer_load_dwordx4 v[40:43], v7, s[8:11], s20 offen
    buffer_load_dwordx4 v[44:47], v7, s[8:11], s20 offen offset:16
    buffer_load_dword v48, v7, s[8:11], s20 offen offset:32
    buffer_load_dwordx4 v[50:53], v7, s[12:15], s20 offen
    buffer_load_dwordx4 v[54:57], v7, s[12:15], s20 offen offset:16
    buffer_load_dword v58, v7, s[12:15], s20 offen offset:32
    s_add_u32 s20, s20, 65664
    buffer_load_dwordx4 v[60:63], v7, s[8:11], s20 offen
    buffer_load_dwordx4 v[64:67], v7, s[8:11], s20 offen offset:16
    buffer_load_dword v68, v7, s[8:11], s20 offen offset:32
    buffer_load_dwordx4 v[70:73], v7, s[12:15], s20 offen
    buffer_load_dwordx4 v[74:77], v7, s[12:15], s20 offen offset:16
    buffer_load_dword v78, v7, s[12:15], s20 offen offset:32
    s_add_u32 s20, s20, 65664
    buffer_load_dwordx4 v[80:83], v7, s[8:11], s20 offen
    buffer_load_dwordx4 v[84:87], v7, s[8:11], s20 offen offset:16
    buffer_load_dword v88, v7, s[8:11], s20 offen offset:32
    buffer_load_dwordx4 v[90:93], v7, s[12:15], s20 offen
    buffer_load_dwordx4 v[94:97], v7, s[12:15], s20 offen offset:16
    buffer_load_dword v98, v7, s[12:15], s20 offen offset:32
    s_add_u32 s20, s20, 65664
    s_waitcnt vmcnt(0)
    v_alignbit_b32 v20, v21, v20, v13
    v_alignbit_b32 v21, v22, v21, v13
    v_alignbit_b32 v22, v23, v22, v13
    v_alignbit_b32 v23, v24, v23, v13
    v_alignbit_b32 v24, v25, v24, v13
    v_alignbit_b32 v25, v26, v25, v13
    v_alignbit_b32 v26, v27, v26, v13
    v_alignbit_b32 v27, v28, v27, v13
    v_alignbit_b32 v30, v31, v30, v13
    v_alignbit_b32 v31, v32, v31, v13
    v_alignbit_b32 v32, v33, v32, v13
    v_alignbit_b32 v33, v34, v33, v13
    v_alignbit_b32 v34, v35, v34, v13
    v_alignbit_b32 v35, v36, v35, v13
    v_alignbit_b32 v36, v37, v36, v13
    v_alignbit_b32 v37, v38, v37, v13
    v_perm_b32 v100, v30, v20, s28
    v_perm_b32 v104, v30, v20, s29
    v_perm_b32 v108, v31, v21, s28
    v_perm_b32 v112, v31, v21, s29
    v_perm_b32 v116, v32, v22, s28
    v_perm_b32 v120, v32, v22, s29
    v_perm_b32 v124, v33, v23, s28
    v_perm_b32 v128, v33, v23, s29
    v_perm_b32 v132, v34, v24, s28
    v_perm_b32 v136, v34, v24, s29
    v_perm_b32 v140, v35, v25, s28
    v_perm_b32 v144, v35, v25, s29
    v_perm_b32 v148, v36, v26, s28
    v_perm_b32 v152, v36, v26, s29
    v_perm_b32 v156, v37, v27, s28
    v_perm_b32 v160, v37, v27, s29
    v_alignbit_b32 v40, v41, v40, v13
    v_alignbit_b32 v41, v42, v41, v13
    v_alignbit_b32 v42, v43, v42, v13
    v_alignbit_b32 v43, v44, v43, v13
    v_alignbit_b32 v44, v45, v44, v13
    v_alignbit_b32 v45, v46, v45, v13
    v_alignbit_b32 v46, v47, v46, v13
    v_alignbit_b32 v47, v48, v47, v13
    v_alignbit_b32 v50, v51, v50, v13
    v_alignbit_b32 v51, v52, v51, v13
    v_alignbit_b32 v52, v53, v52, v13
    v_alignbit_b32 v53, v54, v53, v13
    v_alignbit_b32 v54, v55, v54, v13
    v_alignbit_b32 v55, v56, v55, v13
    v_alignbit_b32 v56, v57, v56, v13
    v_alignbit_b32 v57, v58, v57, v13
    v_perm_b32 v101, v50, v40, s28
    v_perm_b32 v105, v50, v40, s29
    v_perm_b32 v109, v51, v41, s28
    v_perm_b32 v113, v51, v41, s29
    v_perm_b32 v117, v52, v42, s28
    v_perm_b32 v121, v52, v42, s29
    v_perm_b32 v125, v53, v43, s28
    v_perm_b32 v129, v53, v43, s29
    v_perm_b32 v133, v54, v44, s28
    v_perm_b32 v137, v54, v44, s29
    v_perm_b32 v141, v55, v45, s28
    v_perm_b32 v145, v55, v45, s29
    v_perm_b32 v149, v56, v46, s28
    v_perm_b32 v153, v56, v46, s29
    v_perm_b32 v157, v57, v47, s28
    v_perm_b32 v161, v57, v47, s29
    v_alignbit_b32 v60, v61, v60, v13
    v_alignbit_b32 v61, v62, v61, v13
    v_alignbit_b32 v62, v63, v62, v13
    v_alignbit_b32 v63, v64, v63, v13
    v_alignbit_b32 v64, v65, v64, v13
    v_alignbit_b32 v65, v66, v65, v13
    v_alignbit_b32 v66, v67, v66, v13
    v_alignbit_b32 v67, v68, v67, v13
    v_alignbit_b32 v70, v71, v70, v13
    v_alignbit_b32 v71, v72, v71, v13
    v_alignbit_b32 v72, v73, v72, v13
    v_alignbit_b32 v73, v74, v73, v13
    v_alignbit_b32 v74, v75, v74, v13
    v_alignbit_b32 v75, v76, v75, v13
    v_alignbit_b32 v76, v77, v76, v13
    v_alignbit_b32 v77, v78, v77, v13
    v_perm_b32 v102, v70, v60, s28
    v_perm_b32 v106, v70, v60, s29
    v_perm_b32 v110, v71, v61, s28
    v_perm_b32 v114, v71, v61, s29
    v_perm_b32 v118, v72, v62, s28
    v_perm_b32 v122, v72, v62, s29
    v_perm_b32 v126, v73, v63, s28
    v_perm_b32 v130, v73, v63, s29
    v_perm_b32 v134, v74, v64, s28
    v_perm_b32 v138, v74, v64, s29
    v_perm_b32 v142, v75, v65, s28
    v_perm_b32 v146, v75, v65, s29
    v_perm_b32 v150, v76, v66, s28
    v_perm_b32 v154, v76, v66, s29
    v_perm_b32 v158, v77, v67, s28
    v_perm_b32 v162, v77, v67, s29
    v_alignbit_b32 v80, v81, v80, v13
    v_alignbit_b32 v81, v82, v81, v13
    v_alignbit_b32 v82, v83, v82, v13
    v_alignbit_b32 v83, v84, v83, v13
    v_alignbit_b32 v84, v85, v84, v13
    v_alignbit_b32 v85, v86, v85, v13
    v_alignbit_b32 v86, v87, v86, v13
    v_alignbit_b32 v87, v88, v87, v13
    v_alignbit_b32 v90, v91, v90, v13
    v_alignbit_b32 v91, v92, v91, v13
    v_alignbit_b32 v92, v93, v92, v13
    v_alignbit_b32 v93, v94, v93, v13
    v_alignbit_b32 v94, v95, v94, v13
    v_alignbit_b32 v95, v96, v95, v13
    v_alignbit_b32 v96, v97, v96, v13
    v_alignbit_b32 v97, v98, v97, v13
    v_perm_b32 v103, v90, v80, s28
    v_perm_b32 v107, v90, v80, s29
    v_perm_b32 v111, v91, v81, s28
    v_perm_b32 v115, v91, v81, s29
    v_perm_b32 v119, v92, v82, s28
    v_perm_b32 v123, v92, v82, s29
    v_perm_b32 v127, v93, v83, s28
    v_perm_b32 v131, v93, v83, s29
    v_perm_b32 v135, v94, v84, s28
    v_perm_b32 v139, v94, v84, s29
    v_perm_b32 v143, v95, v85, s28
    v_perm_b32 v147, v95, v85, s29
    v_perm_b32 v151, v96, v86, s28
    v_perm_b32 v155, v96, v86, s29
    v_perm_b32 v159, v97, v87, s28
    v_perm_b32 v163, v97, v87, s29
    s_add_u32 s17, s21, 0
    buffer_store_dwordx4 v[100:103], v14, s[4:7], s17 offen
    s_add_u32 s17, s21, 8192
    buffer_store_dwordx4 v[104:107], v14, s[4:7], s17 offen
    s_add_u32 s17, s21, 16384
    buffer_store_dwordx4 v[108:111], v14, s[4:7], s17 offen
    s_add_u32 s17, s21, 24576
    buffer_store_dwordx4 v[112:115], v14, s[4:7], s17 offen
    s_add_u32 s17, s21, 32768
    buffer_store_dwordx4 v[116:119], v14, s[4:7], s17 offen
    s_add_u32 s17, s21, 40960
    buffer_store_dwordx4 v[120:123], v14, s[4:7], s17 offen
    s_add_u32 s17, s21, 49152
    buffer_store_dwordx4 v[124:127], v14, s[4:7], s17 offen
    s_add_u32 s17, s21, 57344
    buffer_store_dwordx4 v[128:131], v14, s[4:7], s17 offen
    s_add_u32 s17, s21, 65536
    buffer_store_dwordx4 v[132:135], v14, s[4:7], s17 offen
    s_add_u32 s17, s21, 73728
    buffer_store_dwordx4 v[136:139], v14, s[4:7], s17 offen
    s_add_u32 s17, s21, 81920
    buffer_store_dwordx4 v[140:143], v14, s[4:7], s17 offen
    s_add_u32 s17, s21, 90112
    buffer_store_dwordx4 v[144:147], v14, s[4:7], s17 offen
    s_add_u32 s17, s21, 98304
    buffer_store_dwordx4 v[148:151], v14, s[4:7], s17 offen
    s_add_u32 s17, s21, 106496
    buffer_store_dwordx4 v[152:155], v14, s[4:7], s17 offen
    s_add_u32 s17, s21, 114688
    buffer_store_dwordx4 v[156:159], v14, s[4:7], s17 offen
    s_add_u32 s17, s21, 122880
    buffer_store_dwordx4 v[160:163], v14, s[4:7], s17 offen
    buffer_load_dwordx4 v[20:23], v7, s[8:11], s20 offen
    buffer_load_dwordx4 v[24:27], v7, s[8:11], s20 offen offset:16
    buffer_load_dword v28, v7, s[8:11], s20 offen offset:32
    buffer_load_dwordx4 v[30:33], v7, s[12:15], s20 offen
    buffer_load_dwordx4 v[34:37], v7, s[12:15], s20 offen offset:16
    buffer_load_dword v38, v7, s[12:15], s20 offen offset:32
    s_add_u32 s20, s20, 65664
    buffer_load_dwordx4 v[40:43], v7, s[8:11], s20 offen
    buffer_load_dwordx4 v[44:47], v7, s[8:11], s20 offen offset:16
    buffer_load_dword v48, v7, s[8:11], s20 offen offset:32
    buffer_load_dwordx4 v[50:53], v7, s[12:15], s20 offen
    buffer_load_dwordx4 v[54:57], v7, s[12:15], s20 offen offset:16
    buffer_load_dword v58, v7, s[12:15], s20 offen offset:32
    s_add_u32 s20, s20, 65664
    buffer_load_dwordx4 v[60:63], v7, s[8:11], s20 offen
    buffer_load_dwordx4 v[64:67], v7, s[8:11], s20 offen offset:16
    buffer_load_dword v68, v7, s[8:11], s20 offen offset:32
    buffer_load_dwordx4 v[70:73], v7, s[12:15], s20 offen
    buffer_load_dwordx4 v[74:77], v7, s[12:15], s20 offen offset:16
    buffer_load_dword v78, v7, s[12:15], s20 offen offset:32
    s_add_u32 s20, s20, 65664
    buffer_load_dwordx4 v[80:83], v7, s[8:11], s20 offen
    buffer_load_dwordx4 v[84:87], v7, s[8:11], s20 offen offset:16
    buffer_load_dword v88, v7, s[8:11], s20 offen offset:32
    buffer_load_dwordx4 v[90:93], v7, s[12:15], s20 offen
    buffer_load_dwordx4 v[94:97], v7, s[12:15], s20 offen offset:16
    buffer_load_dword v98, v7, s[12:15], s20 offen offset:32
    s_add_u32 s20, s20, 65664
    s_waitcnt vmcnt(0)
    v_alignbit_b32 v20, v21, v20, v13
    v_alignbit_b32 v21, v22, v21, v13
    v_alignbit_b32 v22, v23, v22, v13
    v_alignbit_b32 v23, v24, v23, v13
    v_alignbit_b32 v24, v25, v24, v13
    v_alignbit_b32 v25, v26, v25, v13
    v_alignbit_b32 v26, v27, v26, v13
    v_alignbit_b32 v27, v28, v27, v13
    v_alignbit_b32 v30, v31, v30, v13
    v_alignbit_b32 v31, v32, v31, v13
    v_alignbit_b32 v32, v33, v32, v13
    v_alignbit_b32 v33, v34, v33, v13
    v_alignbit_b32 v34, v35, v34, v13
    v_alignbit_b32 v35, v36, v35, v13
    v_alignbit_b32 v36, v37, v36, v13
    v_alignbit_b32 v37, v38, v37, v13
    v_perm_b32 v100, v30, v20, s28
    v_perm_b32 v104, v30, v20, s29
    v_perm_b32 v108, v31, v21, s28
    v_perm_b32 v112, v31, v21, s29
    v_perm_b32 v116, v32, v22, s28
    v_perm_b32 v120, v32, v22, s29
    v_perm_b32 v124, v33, v23, s28
    v_perm_b32 v128, v33, v23, s29
    v_perm_b32 v132, v34, v24, s28
    v_perm_b32 v136, v34, v24, s29
    v_perm_b32 v140, v35, v25, s28
    v_perm_b32 v144, v35, v25, s29
    v_perm_b32 v148, v36, v26, s28
    v_perm_b32 v152, v36, v26, s29
    v_perm_b32 v156, v37, v27, s28
    v_perm_b32 v160, v37, v27, s29
    v_alignbit_b32 v40, v41, v40, v13
    v_alignbit_b32 v41, v42, v41, v13
    v_alignbit_b32 v42, v43, v42, v13
    v_alignbit_b32 v43, v44, v43, v13
    v_alignbit_b32 v44, v45, v44, v13
    v_alignbit_b32 v45, v46, v45, v13
    v_alignbit_b32 v46, v47, v46, v13
    v_alignbit_b32 v47, v48, v47, v13
    v_alignbit_b32 v50, v51, v50, v13
    v_alignbit_b32 v51, v52, v51, v13
    v_alignbit_b32 v52, v53, v52, v13
    v_alignbit_b32 v53, v54, v53, v13
    v_alignbit_b32 v54, v55, v54, v13
    v_alignbit_b32 v55, v56, v55, v13
    v_alignbit_b32 v56, v57, v56, v13
    v_alignbit_b32 v57, v58, v57, v13
    v_perm_b32 v101, v50, v40, s28
    v_perm_b32 v105, v50, v40, s29
    v_perm_b32 v109, v51, v41, s28
    v_perm_b32 v113, v51, v41, s29
    v_perm_b32 v117, v52, v42, s28
    v_perm_b32 v121, v52, v42, s29
    v_perm_b32 v125, v53, v43, s28
    v_perm_b32 v129, v53, v43, s29
    v_perm_b32 v133, v54, v44, s28
    v_perm_b32 v137, v54, v44, s29
    v_perm_b32 v141, v55, v45, s28
    v_perm_b32 v145, v55, v45, s29
    v_perm_b32 v149, v56, v46, s28
    v_perm_b32 v153, v56, v46, s29
    v_perm_b32 v157, v57, v47, s28
    v_perm_b32 v161, v57, v47, s29
    v_alignbit_b32 v60, v61, v60, v13
    v_alignbit_b32 v61, v62, v61, v13
    v_alignbit_b32 v62, v63, v62, v13
    v_alignbit_b32 v63, v64, v63, v13
    v_alignbit_b32 v64, v65, v64, v13
    v_alignbit_b32 v65, v66, v65, v13
    v_alignbit_b32 v66, v67, v66, v13
    v_alignbit_b32 v67, v68, v67, v13
    v_alignbit_b32 v70, v71, v70, v13
    v_alignbit_b32 v71, v72, v71, v13
    v_alignbit_b32 v72, v73, v72, v13
    v_alignbit_b32 v73, v74, v73, v13
    v_alignbit_b32 v74, v75, v74, v13
    v_alignbit_b32 v75, v76, v75, v13
    v_alignbit_b32 v76, v77, v76, v13
    v_alignbit_b32 v77, v78, v77, v13
    v_perm_b32 v102, v70, v60, s28
    v_perm_b32 v106, v70, v60, s29
    v_perm_b32 v110, v71, v61, s28
    v_perm_b32 v114, v71, v61, s29
    v_perm_b32 v118, v72, v62, s28
    v_perm_b32 v122, v72, v62, s29
    v_perm_b32 v126, v73, v63, s28
    v_perm_b32 v130, v73, v63, s29
    v_perm_b32 v134, v74, v64, s28
    v_perm_b32 v138, v74, v64, s29
    v_perm_b32 v142, v75, v65, s28
    v_perm_b32 v146, v75, v65, s29
    v_perm_b32 v150, v76, v66, s28
    v_perm_b32 v154, v76, v66, s29
    v_perm_b32 v158, v77, v67, s28
    v_perm_b32 v162, v77, v67, s29
    v_alignbit_b32 v80, v81, v80, v13
    v_alignbit_b32 v81, v82, v81, v13
    v_alignbit_b32 v82, v83, v82, v13
    v_alignbit_b32 v83, v84, v83, v13
    v_alignbit_b32 v84, v85, v84, v13
    v_alignbit_b32 v85, v86, v85, v13
    v_alignbit_b32 v86, v87, v86, v13
    v_alignbit_b32 v87, v88, v87, v13
    v_alignbit_b32 v90, v91, v90, v13
    v_alignbit_b32 v91, v92, v91, v13
    v_alignbit_b32 v92, v93, v92, v13
    v_alignbit_b32 v93, v94, v93, v13
    v_alignbit_b32 v94, v95, v94, v13
    v_alignbit_b32 v95, v96, v95, v13
    v_alignbit_b32 v96, v97, v96, v13
    v_alignbit_b32 v97, v98, v97, v13
    v_perm_b32 v103, v90, v80, s28
    v_perm_b32 v107, v90, v80, s29
    v_perm_b32 v111, v91, v81, s28
    v_perm_b32 v115, v91, v81, s29
    v_perm_b32 v119, v92, v82, s28
    v_perm_b32 v123, v92, v82, s29
    v_perm_b32 v127, v93, v83, s28
    v_perm_b32 v131, v93, v83, s29
    v_perm_b32 v135, v94, v84, s28
    v_perm_b32 v139, v94, v84, s29
    v_perm_b32 v143, v95, v85, s28
    v_perm_b32 v147, v95, v85, s29
    v_perm_b32 v151, v96, v86, s28
    v_perm_b32 v155, v96, v86, s29
    v_perm_b32 v159, v97, v87, s28
    v_perm_b32 v163, v97, v87, s29
    s_add_u32 s17, s21, 1024
    buffer_store_dwordx4 v[100:103], v14, s[4:7], s17 offen
    s_add_u32 s17, s21, 9216
    buffer_store_dwordx4 v[104:107], v14, s[4:7], s17 offen
    s_add_u32 s17, s21, 17408
    buffer_store_dwordx4 v[108:111], v14, s[4:7], s17 offen
    s_add_u32 s17, s21, 25600
    buffer_store_dwordx4 v[112:115], v14, s[4:7], s17 offen
    s_add_u32 s17, s21, 33792
    buffer_store_dwordx4 v[116:119], v14, s[4:7], s17 offen
    s_add_u32 s17, s21, 41984
    buffer_store_dwordx4 v[120:123], v14, s[4:7], s17 offen
    s_add_u32 s17, s21, 50176
    buffer_store_dwordx4 v[124:127], v14, s[4:7], s17 offen
    s_add_u32 s17, s21, 58368
    buffer_store_dwordx4 v[128:131], v14, s[4:7], s17 offen
    s_add_u32 s17, s21, 66560
    buffer_store_dwordx4 v[132:135], v14, s[4:7], s17 offen
    s_add_u32 s17, s21, 74752
    buffer_store_dwordx4 v[136:139], v14, s[4:7], s17 offen
    s_add_u32 s17, s21, 82944
    buffer_store_dwordx4 v[140:143], v14, s[4:7], s17 offen
    s_add_u32 s17, s21, 91136
    buffer_store_dwordx4 v[144:147], v14, s[4:7], s17 offen
    s_add_u32 s17, s21, 99328
    buffer_store_dwordx4 v[148:151], v14, s[4:7], s17 offen
    s_add_u32 s17, s21, 107520
    buffer_store_dwordx4 v[152:155], v14, s[4:7], s17 offen
    s_add_u32 s17, s21, 115712
    buffer_store_dwordx4 v[156:159], v14, s[4:7], s17 offen
    s_add_u32 s17, s21, 123904
    buffer_store_dwordx4 v[160:163], v14, s[4:7], s17 offen
    s_cmp_lg_u32 s91, 0
    s_cbranch_scc1 F_no512
    s_sub_u32 s20, s20, 524288
    buffer_load_ushort v20, v12, s[8:11], s20 offen
    buffer_load_ushort v28, v12, s[12:15], s20 offen
    s_add_u32 s20, s20, 65664
    buffer_load_ushort v21, v12, s[8:11], s20 offen
    buffer_load_ushort v29, v12, s[12:15], s20 offen
    s_add_u32 s20, s20, 65664
    buffer_load_ushort v22, v12, s[8:11], s20 offen
    buffer_load_ushort v30, v12, s[12:15], s20 offen
    s_add_u32 s20, s20, 65664
    buffer_load_ushort v23, v12, s[8:11], s20 offen
    buffer_load_ushort v31, v12, s[12:15], s20 offen
    s_add_u32 s20, s20, 65664
    buffer_load_ushort v24, v12, s[8:11], s20 offen
    buffer_load_ushort v32, v12, s[12:15], s20 offen
    s_add_u32 s20, s20, 65664
    buffer_load_ushort v25, v12, s[8:11], s20 offen
    buffer_load_ushort v33, v12, s[12:15], s20 offen
    s_add_u32 s20, s20, 65664
    buffer_load_ushort v26, v12, s[8:11], s20 offen
    buffer_load_ushort v34, v12, s[12:15], s20 offen
    s_add_u32 s20, s20, 65664
    buffer_load_ushort v27, v12, s[8:11], s20 offen
    buffer_load_ushort v35, v12, s[12:15], s20 offen
    s_add_u32 s20, s20, 65664
    s_waitcnt vmcnt(0)
    v_lshl_or_b32 v20, v28, 16, v20
    v_lshl_or_b32 v21, v29, 16, v21
    v_lshl_or_b32 v22, v30, 16, v22
    v_lshl_or_b32 v23, v31, 16, v23
    v_lshl_or_b32 v24, v32, 16, v24
    v_lshl_or_b32 v25, v33, 16, v25
    v_lshl_or_b32 v26, v34, 16, v26
    v_lshl_or_b32 v27, v35, 16, v27
    s_add_u32 s17, s21, 4194304
    buffer_store_dwordx4 v[20:23], v14, s[4:7], s17 offen
    buffer_store_dwordx4 v[24:27], v14, s[4:7], s17 offen offset:1024
F_no512:
    s_load_dwordx2 s[8:9], s[0:1], 0
    s_load_dwordx2 s[12:13], s[0:1], 80
    s_mov_b32 s10, 4194304
    s_mov_b32 s14, 8388608
    s_lshr_b32 s28, s91, 3
    s_and_b32 s29, s91, 7
    s_lshl_b32 s29, s29, 2
    s_add_u32 s29, s29, s16
    s_waitcnt vmcnt(0) lgkmcnt(0)
    v_bfe_u32 v5, v1, 2, 2
    v_and_b32 v7, 3, v1
    v_lshl_add_u32 v7, v5, 3, v7
    s_lshl_b32 s17, s29, 5
    v_add_u32 v7, s17, v7
    v_lshrrev_b32 v8, 4, v1
    v_cvt_f32_u32 v8, v8
    s_mov_b32 s31, 981467136
    v_add_u32 v5, 0, v7
    v_lshrrev_b32 v6, 1, v5
    v_and_b32 v30, 1, v5
    v_cmp_eq_u32 vcc, 1, v5
    v_mov_b32 v5, 512
    s_nop 0
    v_cndmask_b32 v6, v6, v5, vcc
    v_cndmask_b32 v30, v30, 0, vcc
    v_cvt_f32_u32 v6, v6
    v_cvt_f32_u32 v30, v30
    v_mul_f32 v32, s31, v6
    v_mul_f32 v30, 0x3e800000, v30
    v_mov_b32 v34, v32
    v_mul_f32 v36, 0x42000000, v32
    v_mul_f32 v5, 0x41000000, v32
    v_fma_f32 v30, v5, v8, v30
    v_add_u32 v5, 4, v7
    v_lshrrev_b32 v6, 1, v5
    v_and_b32 v31, 1, v5
    v_cmp_eq_u32 vcc, 1, v5
    v_mov_b32 v5, 512
    s_nop 0
    v_cndmask_b32 v6, v6, v5, vcc
    v_cndmask_b32 v31, v31, 0, vcc
    v_cvt_f32_u32 v6, v6
    v_cvt_f32_u32 v31, v31
    v_mul_f32 v33, s31, v6
    v_mul_f32 v31, 0x3e800000, v31
    v_mov_b32 v35, v33
    v_mul_f32 v37, 0x42000000, v33
    v_mul_f32 v5, 0x41000000, v33
    v_fma_f32 v31, v5, v8, v31
    v_lshlrev_b32 v8, 4, v1
    s_lshl_b32 s18, s16, 15
    v_add_u32 v8, s18, v8
    v_mov_b32 v7, v8
    s_mov_b32 s22, 0
F1_g0:
    v_fract_f32 v40, v30
    v_add_f32 v41, v40, v32
    v_add_f32 v42, v41, v34
    v_add_f32 v43, v42, v32
    v_add_f32 v44, v43, v34
    v_add_f32 v45, v44, v32
    v_add_f32 v46, v45, v34
    v_add_f32 v47, v46, v32
    v_add_f32 v30, v40, v36
    v_cos_f32 v48, v40
    v_cos_f32 v49, v41
    v_cos_f32 v50, v42
    v_cos_f32 v51, v43
    v_cos_f32 v52, v44
    v_cos_f32 v53, v45
    v_cos_f32 v54, v46
    v_cos_f32 v55, v47
    v_cvt_pk_bf16_f32 v56, v48, v49
    v_cvt_pk_bf16_f32 v57, v50, v51
    v_cvt_pk_bf16_f32 v58, v52, v53
    v_cvt_pk_bf16_f32 v59, v54, v55
    ds_write_b128 v7, v[56:59] offset:0
    v_fract_f32 v40, v31
    v_add_f32 v41, v40, v33
    v_add_f32 v42, v41, v35
    v_add_f32 v43, v42, v33
    v_add_f32 v44, v43, v35
    v_add_f32 v45, v44, v33
    v_add_f32 v46, v45, v35
    v_add_f32 v47, v46, v33
    v_add_f32 v31, v40, v37
    v_cos_f32 v48, v40
    v_cos_f32 v49, v41
    v_cos_f32 v50, v42
    v_cos_f32 v51, v43
    v_cos_f32 v52, v44
    v_cos_f32 v53, v45
    v_cos_f32 v54, v46
    v_cos_f32 v55, v47
    v_cvt_pk_bf16_f32 v60, v48, v49
    v_cvt_pk_bf16_f32 v61, v50, v51
    v_cvt_pk_bf16_f32 v62, v52, v53
    v_cvt_pk_bf16_f32 v63, v54, v55
    ds_write_b128 v7, v[60:63] offset:1024
    v_add_u32 v7, 2048, v7
    s_add_u32 s22, s22, 1
    s_cmp_lt_u32 s22, 16
    s_waitcnt lgkmcnt(0)
    s_cbranch_scc1 F1_g0
    ds_read_b128 a[0:3], v8 offset:0
    ds_read_b128 a[4:7], v8 offset:1024
    ds_read_b128 a[8:11], v8 offset:2048
    ds_read_b128 a[12:15], v8 offset:3072
    ds_read_b128 a[16:19], v8 offset:4096
    ds_read_b128 a[20:23], v8 offset:5120
    ds_read_b128 a[24:27], v8 offset:6144
    ds_read_b128 a[28:31], v8 offset:7168
    s_waitcnt lgkmcnt(7)
    ds_read_b128 a[32:35], v8 offset:8192
    ds_read_b128 a[36:39], v8 offset:9216
    ds_read_b128 a[40:43], v8 offset:10240
    ds_read_b128 a[44:47], v8 offset:11264
    ds_read_b128 a[48:51], v8 offset:12288
    ds_read_b128 a[52:55], v8 offset:13312
    ds_read_b128 a[56:59], v8 offset:14336
    ds_read_b128 a[60:63], v8 offset:15360
    s_waitcnt lgkmcnt(7)
    ds_read_b128 a[64:67], v8 offset:16384
    ds_read_b128 a[68:71], v8 offset:17408
    ds_read_b128 a[72:75], v8 offset:18432
    ds_read_b128 a[76:79], v8 offset:19456
    ds_read_b128 a[80:83], v8 offset:20480
    ds_read_b128 a[84:87], v8 offset:21504
    ds_read_b128 a[88:91], v8 offset:22528
    ds_read_b128 a[92:95], v8 offset:23552
    s_waitcnt lgkmcnt(7)
    ds_read_b128 a[96:99], v8 offset:24576
    ds_read_b128 a[100:103], v8 offset:25600
    ds_read_b128 a[104:107], v8 offset:26624
    ds_read_b128 a[108:111], v8 offset:27648
    ds_read_b128 a[112:115], v8 offset:28672
    ds_read_b128 a[116:119], v8 offset:29696
    ds_read_b128 a[120:123], v8 offset:30720
    ds_read_b128 a[124:127], v8 offset:31744
    s_waitcnt lgkmcnt(7)
    s_waitcnt lgkmcnt(0)
    v_mov_b32 v7, v8
    s_mov_b32 s22, 0
F1_g1:
    v_fract_f32 v40, v30
    v_add_f32 v41, v40, v32
    v_add_f32 v42, v41, v34
    v_add_f32 v43, v42, v32
    v_add_f32 v44, v43, v34
    v_add_f32 v45, v44, v32
    v_add_f32 v46, v45, v34
    v_add_f32 v47, v46, v32
    v_add_f32 v30, v40, v36
    v_cos_f32 v48, v40
    v_cos_f32 v49, v41
    v_cos_f32 v50, v42
    v_cos_f32 v51, v43
    v_cos_f32 v52, v44
    v_cos_f32 v53, v45
    v_cos_f32 v54, v46
    v_cos_f32 v55, v47
    v_cvt_pk_bf16_f32 v56, v48, v49
    v_cvt_pk_bf16_f32 v57, v50, v51
    v_cvt_pk_bf16_f32 v58, v52, v53
    v_cvt_pk_bf16_f32 v59, v54, v55
    ds_write_b128 v7, v[56:59] offset:0
    v_fract_f32 v40, v31
    v_add_f32 v41, v40, v33
    v_add_f32 v42, v41, v35
    v_add_f32 v43, v42, v33
    v_add_f32 v44, v43, v35
    v_add_f32 v45, v44, v33
    v_add_f32 v46, v45, v35
    v_add_f32 v47, v46, v33
    v_add_f32 v31, v40, v37
    v_cos_f32 v48, v40
    v_cos_f32 v49, v41
    v_cos_f32 v50, v42
    v_cos_f32 v51, v43
    v_cos_f32 v52, v44
    v_cos_f32 v53, v45
    v_cos_f32 v54, v46
    v_cos_f32 v55, v47
    v_cvt_pk_bf16_f32 v60, v48, v49
    v_cvt_pk_bf16_f32 v61, v50, v51
    v_cvt_pk_bf16_f32 v62, v52, v53
    v_cvt_pk_bf16_f32 v63, v54, v55
    ds_write_b128 v7, v[60:63] offset:1024
    v_add_u32 v7, 2048, v7
    s_add_u32 s22, s22, 1
    s_cmp_lt_u32 s22, 16
    s_waitcnt lgkmcnt(0)
    s_cbranch_scc1 F1_g1
    ds_read_b128 a[128:131], v8 offset:0
    ds_read_b128 a[132:135], v8 offset:1024
    ds_read_b128 a[136:139], v8 offset:2048
    ds_read_b128 a[140:143], v8 offset:3072
    ds_read_b128 a[144:147], v8 offset:4096
    ds_read_b128 a[148:151], v8 offset:5120
    ds_read_b128 a[152:155], v8 offset:6144
    ds_read_b128 a[156:159], v8 offset:7168
    s_waitcnt lgkmcnt(7)
    ds_read_b128 a[160:163], v8 offset:8192
    ds_read_b128 a[164:167], v8 offset:9216
    ds_read_b128 a[168:171], v8 offset:10240
    ds_read_b128 a[172:175], v8 offset:11264
    ds_read_b128 a[176:179], v8 offset:12288
    ds_read_b128 a[180:183], v8 offset:13312
    ds_read_b128 a[184:187], v8 offset:14336
    ds_read_b128 a[188:191], v8 offset:15360
    s_waitcnt lgkmcnt(7)
    ds_read_b128 a[192:195], v8 offset:16384
    ds_read_b128 a[196:199], v8 offset:17408
    ds_read_b128 a[200:203], v8 offset:18432
    ds_read_b128 a[204:207], v8 offset:19456
    ds_read_b128 a[208:211], v8 offset:20480
    ds_read_b128 a[212:215], v8 offset:21504
    ds_read_b128 a[216:219], v8 offset:22528
    ds_read_b128 a[220:223], v8 offset:23552
    s_waitcnt lgkmcnt(7)
    ds_read_b128 a[224:227], v8 offset:24576
    ds_read_b128 a[228:231], v8 offset:25600
    ds_read_b128 a[232:235], v8 offset:26624
    ds_read_b128 a[236:239], v8 offset:27648
    ds_read_b128 a[240:243], v8 offset:28672
    ds_read_b128 a[244:247], v8 offset:29696
    ds_read_b128 a[248:251], v8 offset:30720
    ds_read_b128 a[252:255], v8 offset:31744
    s_waitcnt lgkmcnt(7)
    s_waitcnt lgkmcnt(0)
    v_lshlrev_b32 v5, 2, v1
    s_mov_b32 s18, 0
rdv_16:
    global_load_dword v6, v5, s[100:101] sc1
    s_lshl_b32 s17, s98, 2
    s_waitcnt vmcnt(0)
    v_lshrrev_b32 v7, s17, v6
    s_cmp_eq_u32 s98, 0
    s_cselect_b32 s17, 0x0f0f0f0f, s17
    s_cselect_b32 s17, s17, 0x01010101
    v_and_b32 v7, s17, v7
    v_cmp_ne_u32 vcc, 0x01010101, v7
    s_nop 0
    s_cbranch_vccz rdvok_17
    v_sad_u8 v7, v7, 0, 0
    s_nop 1
    v_add_u32_dpp v7, v7, v7 quad_perm:[1,0,3,2] row_mask:0xf bank_mask:0xf
    v_cmp_ne_u32 vcc, 8, v7
    s_nop 0
    s_cbranch_vccnz rdvw_18
    s_mov_b32 s98, 1
    s_and_b32 s3, s97, 7
    s_barrier
    s_branch role_start
rdvw_18:
    s_sleep 4
    s_add_u32 s18, s18, 1
    s_cmp_lt_u32 s18, 262144
    s_cbranch_scc1 rdv_16
    s_mov_b32 s92, 1048576
rdvok_17:
    v_and_b32 v5, 15, v1
    v_bfe_u32 v6, v1, 1, 3
    v_lshrrev_b32 v7, 4, v1
    v_xor_b32 v6, v6, v7
    v_lshlrev_b32 v6, 4, v6
    v_lshl_add_u32 v10, v5, 7, v6
    s_lshl_b32 s19, s16, 10
    v_xor_b32 v11, 64, v10
    v_add_u32 v12, 0x10000, v10
    v_add_u32 v13, 0x10000, v11
    v_lshrrev_b32 v7, 3, v1
    s_lshl_b32 s17, s16, 3
    v_add_u32 v7, s17, v7
    v_bfe_u32 v8, v7, 1, 3
    v_xor_b32 v8, v8, v1
    v_and_b32 v8, 7, v8
    v_bfe_u32 v5, v7, 2, 2
    v_and_b32 v2, 3, v7
    v_lshl_add_u32 v2, v5, 3, v2
    v_bfe_u32 v5, v7, 4, 1
    v_lshl_add_u32 v2, v5, 2, v2
    v_bfe_u32 v5, v1, 2, 2
    v_and_b32 v3, 3, v1
    v_lshl_add_u32 v3, v5, 3, v3
    v_lshlrev_b32 v2, 16, v2
    v_lshl_add_u32 v2, v8, 4, v2
    v_and_b32 v5, 48, v1
    v_lshl_add_u32 v3, v3, 6, v5
    s_mul_i32 s21, s29, 133120
    s_lshl_b32 s17, s28, 15
    s_add_u32 s21, s21, s17
    s_add_u32 s21, s21, 104857600
    s_and_b32 s20, s28, 1
    s_lshl_b32 s20, s20, 15
    s_lshr_b32 s17, s28, 1
    s_lshl_b32 s17, s17, 21
    s_add_u32 s20, s20, s17
    s_mov_b32 s24, 2048
    s_mov_b32 s25, 2048
    s_barrier
    s_mov_b32 s26, s25
    s_sub_u32 s25, s21, 1073741824
    s_mov_b32 s21, 1073741824
    s_mov_b32 s23, 0
    s_mov_b32 s22, 0
    s_add_u32 m0, s19, 0
    s_nop 0
    buffer_load_dwordx4 v2, s[8:11], s20 offen offset:0 lds
    s_add_u32 m0, s19, 3968
    s_nop 0
    buffer_load_dwordx4 v2, s[8:11], s20 offen offset:128 lds
    s_add_u32 m0, s19, 7936
    s_nop 0
    buffer_load_dwordx4 v2, s[8:11], s20 offen offset:256 lds
    s_add_u32 m0, s19, 11904
    s_nop 0
    buffer_load_dwordx4 v2, s[8:11], s20 offen offset:384 lds
    s_add_u32 m0, s19, 15872
    s_nop 0
    buffer_load_dwordx4 v2, s[8:11], s20 offen offset:512 lds
    s_add_u32 m0, s19, 19840
    s_nop 0
    buffer_load_dwordx4 v2, s[8:11], s20 offen offset:640 lds
    s_add_u32 m0, s19, 23808
    s_nop 0
    buffer_load_dwordx4 v2, s[8:11], s20 offen offset:768 lds
    s_add_u32 m0, s19, 27776
    s_nop 0
    buffer_load_dwordx4 v2, s[8:11], s20 offen offset:896 lds
    s_add_u32 m0, s19, 31744
    s_nop 0
    buffer_load_dwordx4 v2, s[8:11], s20 offen offset:1024 lds
    s_add_u32 m0, s19, 35712
    s_nop 0
    buffer_load_dwordx4 v2, s[8:11], s20 offen offset:1152 lds
    s_add_u32 m0, s19, 39680
    s_nop 0
    buffer_load_dwordx4 v2, s[8:11], s20 offen offset:1280 lds
    s_add_u32 m0, s19, 43648
    s_nop 0
    buffer_load_dwordx4 v2, s[8:11], s20 offen offset:1408 lds
    s_add_u32 m0, s19, 47616
    s_nop 0
    buffer_load_dwordx4 v2, s[8:11], s20 offen offset:1536 lds
    s_add_u32 m0, s19, 51584
    s_nop 0
    buffer_load_dwordx4 v2, s[8:11], s20 offen offset:1664 lds
    s_add_u32 m0, s19, 55552
    s_nop 0
    buffer_load_dwordx4 v2, s[8:11], s20 offen offset:1792 lds
    s_add_u32 m0, s19, 59520
    s_nop 0
    buffer_load_dwordx4 v2, s[8:11], s20 offen offset:1920 lds
    s_add_u32 s20, s20, s24
    s_add_u32 m0, s19, 65536
    s_nop 0
    buffer_load_dwordx4 v2, s[8:11], s20 offen offset:0 lds
    s_add_u32 m0, s19, 69504
    s_nop 0
    buffer_load_dwordx4 v2, s[8:11], s20 offen offset:128 lds
    s_add_u32 m0, s19, 73472
    s_nop 0
    buffer_load_dwordx4 v2, s[8:11], s20 offen offset:256 lds
    s_waitcnt vmcnt(11)
    s_barrier
    ds_read_b128 v[20:23], v10 offset:0
    ds_read_b128 v[24:27], v10 offset:2048
    ds_read_b128 v[28:31], v11 offset:0
    ds_read_b128 v[32:35], v11 offset:2048
    ds_read_b128 v[36:39], v10 offset:4096
    ds_read_b128 v[40:43], v10 offset:6144
    ds_read_b128 v[44:47], v11 offset:4096
.p2align 6
F1_top:
    s_waitcnt lgkmcnt(6)
    v_mfma_f32_16x16x32_bf16 v[52:55], v[20:23], a[0:3], 0
    ds_read_b128 v[48:51], v11 offset:6144
    v_mfma_f32_16x16x32_bf16 v[60:63], v[20:23], a[4:7], 0
    s_waitcnt lgkmcnt(6)
    v_mfma_f32_16x16x32_bf16 v[56:59], v[24:27], a[0:3], 0
    ds_read_b128 v[20:23], v10 offset:8192
    s_add_u32 m0, s19, 77440
    v_mfma_f32_16x16x32_bf16 v[64:67], v[24:27], a[4:7], 0
    buffer_load_dwordx4 v2, s[8:11], s20 offen offset:384 lds
    s_waitcnt lgkmcnt(6)
    v_mfma_f32_16x16x32_bf16 v[52:55], v[28:31], a[8:11], v[52:55]
    ds_read_b128 v[24:27], v10 offset:10240
    v_mfma_f32_16x16x32_bf16 v[60:63], v[28:31], a[12:15], v[60:63]
    s_waitcnt lgkmcnt(6)
    v_mfma_f32_16x16x32_bf16 v[56:59], v[32:35], a[8:11], v[56:59]
    ds_read_b128 v[28:31], v11 offset:8192
    s_add_u32 m0, s19, 81408
    v_mfma_f32_16x16x32_bf16 v[64:67], v[32:35], a[12:15], v[64:67]
    buffer_load_dwordx4 v2, s[8:11], s20 offen offset:512 lds
    s_waitcnt lgkmcnt(6)
    v_mfma_f32_16x16x32_bf16 v[52:55], v[36:39], a[16:19], v[52:55]
    ds_read_b128 v[32:35], v11 offset:10240
    v_mfma_f32_16x16x32_bf16 v[60:63], v[36:39], a[20:23], v[60:63]
    s_waitcnt lgkmcnt(6)
    v_mfma_f32_16x16x32_bf16 v[56:59], v[40:43], a[16:19], v[56:59]
    ds_read_b128 v[36:39], v10 offset:12288
    s_add_u32 m0, s19, 85376
    v_mfma_f32_16x16x32_bf16 v[64:67], v[40:43], a[20:23], v[64:67]
    buffer_load_dwordx4 v2, s[8:11], s20 offen offset:640 lds
    s_waitcnt lgkmcnt(6)
    v_mfma_f32_16x16x32_bf16 v[52:55], v[44:47], a[24:27], v[52:55]
    ds_read_b128 v[40:43], v10 offset:14336
    v_mfma_f32_16x16x32_bf16 v[60:63], v[44:47], a[28:31], v[60:63]
    s_waitcnt lgkmcnt(6)
    v_mfma_f32_16x16x32_bf16 v[56:59], v[48:51], a[24:27], v[56:59]
    ds_read_b128 v[44:47], v11 offset:12288
    s_add_u32 m0, s19, 89344
    v_mfma_f32_16x16x32_bf16 v[64:67], v[48:51], a[28:31], v[64:67]
    buffer_load_dwordx4 v2, s[8:11], s20 offen offset:768 lds
    s_waitcnt lgkmcnt(6)
    v_mfma_f32_16x16x32_bf16 v[52:55], v[20:23], a[32:35], v[52:55]
    ds_read_b128 v[48:51], v11 offset:14336
    v_mfma_f32_16x16x32_bf16 v[60:63], v[20:23], a[36:39], v[60:63]
    s_waitcnt lgkmcnt(6)
    v_mfma_f32_16x16x32_bf16 v[56:59], v[24:27], a[32:35], v[56:59]
    ds_read_b128 v[20:23], v10 offset:16384
    s_add_u32 m0, s19, 93312
    v_mfma_f32_16x16x32_bf16 v[64:67], v[24:27], a[36:39], v[64:67]
    buffer_load_dwordx4 v2, s[8:11], s20 offen offset:896 lds
    s_waitcnt lgkmcnt(6)
    v_mfma_f32_16x16x32_bf16 v[52:55], v[28:31], a[40:43], v[52:55]
    ds_read_b128 v[24:27], v10 offset:18432
    v_mfma_f32_16x16x32_bf16 v[60:63], v[28:31], a[44:47], v[60:63]
    v_cvt_pk_bf16_f32 v84, v68, v69
    s_waitcnt lgkmcnt(6)
    v_mfma_f32_16x16x32_bf16 v[56:59], v[32:35], a[40:43], v[56:59]
    ds_read_b128 v[28:31], v11 offset:16384
    v_mfma_f32_16x16x32_bf16 v[64:67], v[32:35], a[44:47], v[64:67]
    v_cvt_pk_bf16_f32 v85, v70, v71
    s_waitcnt lgkmcnt(6)
    v_mfma_f32_16x16x32_bf16 v[52:55], v[36:39], a[48:51], v[52:55]
    ds_read_b128 v[32:35], v11 offset:18432
    v_mfma_f32_16x16x32_bf16 v[60:63], v[36:39], a[52:55], v[60:63]
    v_cvt_pk_bf16_f32 v86, v72, v73
    s_waitcnt lgkmcnt(6)
    v_mfma_f32_16x16x32_bf16 v[56:59], v[40:43], a[48:51], v[56:59]
    ds_read_b128 v[36:39], v10 offset:20480
    v_mfma_f32_16x16x32_bf16 v[64:67], v[40:43], a[52:55], v[64:67]
    v_cvt_pk_bf16_f32 v87, v74, v75
    s_waitcnt lgkmcnt(6)
    v_mfma_f32_16x16x32_bf16 v[52:55], v[44:47], a[56:59], v[52:55]
    ds_read_b128 v[40:43], v10 offset:22528
    v_mfma_f32_16x16x32_bf16 v[60:63], v[44:47], a[60:63], v[60:63]
    v_cvt_pk_bf16_f32 v88, v76, v77
    s_waitcnt lgkmcnt(6)
    v_mfma_f32_16x16x32_bf16 v[56:59], v[48:51], a[56:59], v[56:59]
    ds_read_b128 v[44:47], v11 offset:20480
    v_mfma_f32_16x16x32_bf16 v[64:67], v[48:51], a[60:63], v[64:67]
    v_cvt_pk_bf16_f32 v89, v78, v79
    buffer_store_dwordx4 v[84:87], v3, s[4:7], s21 offen offset:0 sc1
    s_waitcnt lgkmcnt(6)
    v_mfma_f32_16x16x32_bf16 v[52:55], v[20:23], a[64:67], v[52:55]
    ds_read_b128 v[48:51], v11 offset:22528
    v_mfma_f32_16x16x32_bf16 v[60:63], v[20:23], a[68:71], v[60:63]
    v_cvt_pk_bf16_f32 v90, v80, v81
    s_waitcnt lgkmcnt(6)
    v_mfma_f32_16x16x32_bf16 v[56:59], v[24:27], a[64:67], v[56:59]
    ds_read_b128 v[20:23], v10 offset:24576
    v_mfma_f32_16x16x32_bf16 v[64:67], v[24:27], a[68:71], v[64:67]
    v_cvt_pk_bf16_f32 v91, v82, v83
    s_waitcnt lgkmcnt(6)
    v_mfma_f32_16x16x32_bf16 v[52:55], v[28:31], a[72:75], v[52:55]
    ds_read_b128 v[24:27], v10 offset:26624
    v_mfma_f32_16x16x32_bf16 v[60:63], v[28:31], a[76:79], v[60:63]
    s_waitcnt lgkmcnt(6)
    v_mfma_f32_16x16x32_bf16 v[56:59], v[32:35], a[72:75], v[56:59]
    ds_read_b128 v[28:31], v11 offset:24576
    v_mfma_f32_16x16x32_bf16 v[64:67], v[32:35], a[76:79], v[64:67]
    buffer_store_dwordx4 v[88:91], v3, s[4:7], s21 offen offset:256 sc1
    s_waitcnt lgkmcnt(6)
    v_mfma_f32_16x16x32_bf16 v[52:55], v[36:39], a[80:83], v[52:55]
    ds_read_b128 v[32:35], v11 offset:26624
    v_mfma_f32_16x16x32_bf16 v[60:63], v[36:39], a[84:87], v[60:63]
    s_add_u32 s21, s21, s25
    s_mov_b32 s25, s26
    s_waitcnt lgkmcnt(6)
    v_mfma_f32_16x16x32_bf16 v[56:59], v[40:43], a[80:83], v[56:59]
    ds_read_b128 v[36:39], v10 offset:28672
    v_mfma_f32_16x16x32_bf16 v[64:67], v[40:43], a[84:87], v[64:67]
    s_waitcnt lgkmcnt(6)
    v_mfma_f32_16x16x32_bf16 v[52:55], v[44:47], a[88:91], v[52:55]
    ds_read_b128 v[40:43], v10 offset:30720
    v_mfma_f32_16x16x32_bf16 v[60:63], v[44:47], a[92:95], v[60:63]
    s_waitcnt lgkmcnt(6)
    v_mfma_f32_16x16x32_bf16 v[56:59], v[48:51], a[88:91], v[56:59]
    ds_read_b128 v[44:47], v11 offset:28672
    v_mfma_f32_16x16x32_bf16 v[64:67], v[48:51], a[92:95], v[64:67]
    s_waitcnt lgkmcnt(6)
    v_mfma_f32_16x16x32_bf16 v[52:55], v[20:23], a[96:99], v[52:55]
    ds_read_b128 v[48:51], v11 offset:30720
    v_mfma_f32_16x16x32_bf16 v[60:63], v[20:23], a[100:103], v[60:63]
    s_waitcnt lgkmcnt(6)
    v_mfma_f32_16x16x32_bf16 v[56:59], v[24:27], a[96:99], v[56:59]
    s_waitcnt vmcnt(10)
    s_barrier
    ds_read_b128 v[20:23], v10 offset:32768
    v_mfma_f32_16x16x32_bf16 v[64:67], v[24:27], a[100:103], v[64:67]
    s_waitcnt lgkmcnt(6)
    v_mfma_f32_16x16x32_bf16 v[52:55], v[28:31], a[104:107], v[52:55]
    ds_read_b128 v[24:27], v10 offset:34816
    s_add_u32 m0, s19, 97280
    v_mfma_f32_16x16x32_bf16 v[60:63], v[28:31], a[108:111], v[60:63]
    buffer_load_dwordx4 v2, s[8:11], s20 offen offset:1024 lds
    s_waitcnt lgkmcnt(6)
    v_mfma_f32_16x16x32_bf16 v[56:59], v[32:35], a[104:107], v[56:59]
    ds_read_b128 v[28:31], v11 offset:32768
    v_mfma_f32_16x16x32_bf16 v[64:67], v[32:35], a[108:111], v[64:67]
    s_waitcnt lgkmcnt(6)
    v_mfma_f32_16x16x32_bf16 v[52:55], v[36:39], a[112:115], v[52:55]
    ds_read_b128 v[32:35], v11 offset:34816
    s_add_u32 m0, s19, 101248
    v_mfma_f32_16x16x32_bf16 v[60:63], v[36:39], a[116:119], v[60:63]
    buffer_load_dwordx4 v2, s[8:11], s20 offen offset:1152 lds
    s_waitcnt lgkmcnt(6)
    v_mfma_f32_16x16x32_bf16 v[56:59], v[40:43], a[112:115], v[56:59]
    ds_read_b128 v[36:39], v10 offset:36864
    v_mfma_f32_16x16x32_bf16 v[64:67], v[40:43], a[116:119], v[64:67]
    s_waitcnt lgkmcnt(6)
    v_mfma_f32_16x16x32_bf16 v[52:55], v[44:47], a[120:123], v[52:55]
    ds_read_b128 v[40:43], v10 offset:38912
    s_add_u32 m0, s19, 105216
    v_mfma_f32_16x16x32_bf16 v[60:63], v[44:47], a[124:127], v[60:63]
    buffer_load_dwordx4 v2, s[8:11], s20 offen offset:1280 lds
    s_waitcnt lgkmcnt(6)
    v_mfma_f32_16x16x32_bf16 v[56:59], v[48:51], a[120:123], v[56:59]
    ds_read_b128 v[44:47], v11 offset:36864
    v_mfma_f32_16x16x32_bf16 v[64:67], v[48:51], a[124:127], v[64:67]
    s_waitcnt lgkmcnt(6)
    v_mfma_f32_16x16x32_bf16 v[52:55], v[20:23], a[128:131], v[52:55]
    ds_read_b128 v[48:51], v11 offset:38912
    v_mfma_f32_16x16x32_bf16 v[60:63], v[20:23], a[132:135], v[60:63]
    s_waitcnt lgkmcnt(6)
    v_mfma_f32_16x16x32_bf16 v[56:59], v[24:27], a[128:131], v[56:59]
    ds_read_b128 v[20:23], v10 offset:40960
    s_add_u32 m0, s19, 109184
    v_mfma_f32_16x16x32_bf16 v[64:67], v[24:27], a[132:135], v[64:67]
    buffer_load_dwordx4 v2, s[8:11], s20 offen offset:1408 lds
    s_waitcnt lgkmcnt(6)
    v_mfma_f32_16x16x32_bf16 v[52:55], v[28:31], a[136:139], v[52:55]
    ds_read_b128 v[24:27], v10 offset:43008
    v_mfma_f32_16x16x32_bf16 v[60:63], v[28:31], a[140:143], v[60:63]
    s_waitcnt lgkmcnt(6)
    v_mfma_f32_16x16x32_bf16 v[56:59], v[32:35], a[136:139], v[56:59]
    ds_read_b128 v[28:31], v11 offset:40960
    s_add_u32 m0, s19, 113152
    v_mfma_f32_16x16x32_bf16 v[64:67], v[32:35], a[140:143], v[64:67]
    buffer_load_dwordx4 v2, s[8:11], s20 offen offset:1536 lds
    s_waitcnt lgkmcnt(6)
    v_mfma_f32_16x16x32_bf16 v[52:55], v[36:39], a[144:147], v[52:55]
    ds_read_b128 v[32:35], v11 offset:43008
    v_mfma_f32_16x16x32_bf16 v[60:63], v[36:39], a[148:151], v[60:63]
    s_waitcnt lgkmcnt(6)
    v_mfma_f32_16x16x32_bf16 v[56:59], v[40:43], a[144:147], v[56:59]
    ds_read_b128 v[36:39], v10 offset:45056
    s_add_u32 m0, s19, 117120
    v_mfma_f32_16x16x32_bf16 v[64:67], v[40:43], a[148:151], v[64:67]
    buffer_load_dwordx4 v2, s[8:11], s20 offen offset:1664 lds
    s_waitcnt lgkmcnt(6)
    v_mfma_f32_16x16x32_bf16 v[52:55], v[44:47], a[152:155], v[52:55]
    ds_read_b128 v[40:43], v10 offset:47104
    v_mfma_f32_16x16x32_bf16 v[60:63], v[44:47], a[156:159], v[60:63]
    s_waitcnt lgkmcnt(6)
    v_mfma_f32_16x16x32_bf16 v[56:59], v[48:51], a[152:155], v[56:59]
    ds_read_b128 v[44:47], v11 offset:45056
    s_add_u32 m0, s19, 121088
    v_mfma_f32_16x16x32_bf16 v[64:67], v[48:51], a[156:159], v[64:67]
    buffer_load_dwordx4 v2, s[8:11], s20 offen offset:1792 lds
    s_waitcnt lgkmcnt(6)
    v_mfma_f32_16x16x32_bf16 v[52:55], v[20:23], a[160:163], v[52:55]
    ds_read_b128 v[48:51], v11 offset:47104
    v_mfma_f32_16x16x32_bf16 v[60:63], v[20:23], a[164:167], v[60:63]
    s_waitcnt lgkmcnt(6)
    v_mfma_f32_16x16x32_bf16 v[56:59], v[24:27], a[160:163], v[56:59]
    ds_read_b128 v[20:23], v10 offset:49152
    s_add_u32 m0, s19, 125056
    v_mfma_f32_16x16x32_bf16 v[64:67], v[24:27], a[164:167], v[64:67]
    buffer_load_dwordx4 v2, s[8:11], s20 offen offset:1920 lds
    s_waitcnt lgkmcnt(6)
    v_mfma_f32_16x16x32_bf16 v[52:55], v[28:31], a[168:171], v[52:55]
    ds_read_b128 v[24:27], v10 offset:51200
    v_mfma_f32_16x16x32_bf16 v[60:63], v[28:31], a[172:175], v[60:63]
    s_add_u32 s20, s20, s24
    s_waitcnt lgkmcnt(6)
    v_mfma_f32_16x16x32_bf16 v[56:59], v[32:35], a[168:171], v[56:59]
    ds_read_b128 v[28:31], v11 offset:49152
    v_mfma_f32_16x16x32_bf16 v[64:67], v[32:35], a[172:175], v[64:67]
    s_waitcnt lgkmcnt(6)
    v_mfma_f32_16x16x32_bf16 v[52:55], v[36:39], a[176:179], v[52:55]
    ds_read_b128 v[32:35], v11 offset:51200
    v_mfma_f32_16x16x32_bf16 v[60:63], v[36:39], a[180:183], v[60:63]
    s_waitcnt lgkmcnt(6)
    v_mfma_f32_16x16x32_bf16 v[56:59], v[40:43], a[176:179], v[56:59]
    ds_read_b128 v[36:39], v10 offset:53248
    v_mfma_f32_16x16x32_bf16 v[64:67], v[40:43], a[180:183], v[64:67]
    s_waitcnt lgkmcnt(6)
    v_mfma_f32_16x16x32_bf16 v[52:55], v[44:47], a[184:187], v[52:55]
    ds_read_b128 v[40:43], v10 offset:55296
    v_mfma_f32_16x16x32_bf16 v[60:63], v[44:47], a[188:191], v[60:63]
    s_waitcnt lgkmcnt(6)
    v_mfma_f32_16x16x32_bf16 v[56:59], v[48:51], a[184:187], v[56:59]
    ds_read_b128 v[44:47], v11 offset:53248
    v_mfma_f32_16x16x32_bf16 v[64:67], v[48:51], a[188:191], v[64:67]
    s_waitcnt lgkmcnt(6)
    v_mfma_f32_16x16x32_bf16 v[52:55], v[20:23], a[192:195], v[52:55]
    ds_read_b128 v[48:51], v11 offset:55296
    v_mfma_f32_16x16x32_bf16 v[60:63], v[20:23], a[196:199], v[60:63]
    s_waitcnt lgkmcnt(6)
    v_mfma_f32_16x16x32_bf16 v[56:59], v[24:27], a[192:195], v[56:59]
    ds_read_b128 v[20:23], v10 offset:57344
    v_mfma_f32_16x16x32_bf16 v[64:67], v[24:27], a[196:199], v[64:67]
    s_waitcnt lgkmcnt(6)
    v_mfma_f32_16x16x32_bf16 v[52:55], v[28:31], a[200:203], v[52:55]
    ds_read_b128 v[24:27], v10 offset:59392
    v_mfma_f32_16x16x32_bf16 v[60:63], v[28:31], a[204:207], v[60:63]
    s_waitcnt lgkmcnt(6)
    v_mfma_f32_16x16x32_bf16 v[56:59], v[32:35], a[200:203], v[56:59]
    ds_read_b128 v[28:31], v11 offset:57344
    v_mfma_f32_16x16x32_bf16 v[64:67], v[32:35], a[204:207], v[64:67]
    s_waitcnt lgkmcnt(6)
    v_mfma_f32_16x16x32_bf16 v[52:55], v[36:39], a[208:211], v[52:55]
    ds_read_b128 v[32:35], v11 offset:59392
    v_mfma_f32_16x16x32_bf16 v[60:63], v[36:39], a[212:215], v[60:63]
    s_waitcnt lgkmcnt(6)
    v_mfma_f32_16x16x32_bf16 v[56:59], v[40:43], a[208:211], v[56:59]
    ds_read_b128 v[36:39], v10 offset:61440
    v_mfma_f32_16x16x32_bf16 v[64:67], v[40:43], a[212:215], v[64:67]
    s_waitcnt lgkmcnt(6)
    v_mfma_f32_16x16x32_bf16 v[52:55], v[44:47], a[216:219], v[52:55]
    ds_read_b128 v[40:43], v10 offset:63488
    v_mfma_f32_16x16x32_bf16 v[60:63], v[44:47], a[220:223], v[60:63]
    s_waitcnt lgkmcnt(6)
    v_mfma_f32_16x16x32_bf16 v[56:59], v[48:51], a[216:219], v[56:59]
    ds_read_b128 v[44:47], v11 offset:61440
    v_mfma_f32_16x16x32_bf16 v[64:67], v[48:51], a[220:223], v[64:67]
    s_waitcnt lgkmcnt(6)
    v_mfma_f32_16x16x32_bf16 v[52:55], v[20:23], a[224:227], v[52:55]
    ds_read_b128 v[48:51], v11 offset:63488
    v_mfma_f32_16x16x32_bf16 v[60:63], v[20:23], a[228:231], v[60:63]
    s_waitcnt lgkmcnt(6)
    v_mfma_f32_16x16x32_bf16 v[56:59], v[24:27], a[224:227], v[56:59]
    s_waitcnt vmcnt(8)
    s_barrier
    ds_read_b128 v[20:23], v12 offset:0
    v_mfma_f32_16x16x32_bf16 v[64:67], v[24:27], a[228:231], v[64:67]
    s_waitcnt lgkmcnt(6)
    v_mfma_f32_16x16x32_bf16 v[52:55], v[28:31], a[232:235], v[52:55]
    ds_read_b128 v[24:27], v12 offset:2048
    s_add_u32 m0, s19, 0
    v_mfma_f32_16x16x32_bf16 v[60:63], v[28:31], a[236:239], v[60:63]
    buffer_load_dwordx4 v2, s[8:11], s20 offen offset:0 lds
    s_waitcnt lgkmcnt(6)
    v_mfma_f32_16x16x32_bf16 v[56:59], v[32:35], a[232:235], v[56:59]
    ds_read_b128 v[28:31], v13 offset:0
    v_mfma_f32_16x16x32_bf16 v[64:67], v[32:35], a[236:239], v[64:67]
    s_waitcnt lgkmcnt(6)
    v_mfma_f32_16x16x32_bf16 v[52:55], v[36:39], a[240:243], v[52:55]
    ds_read_b128 v[32:35], v13 offset:2048
    s_add_u32 m0, s19, 3968
    v_mfma_f32_16x16x32_bf16 v[60:63], v[36:39], a[244:247], v[60:63]
    buffer_load_dwordx4 v2, s[8:11], s20 offen offset:128 lds
    s_waitcnt lgkmcnt(6)
    v_mfma_f32_16x16x32_bf16 v[56:59], v[40:43], a[240:243], v[56:59]
    ds_read_b128 v[36:39], v12 offset:4096
    v_mfma_f32_16x16x32_bf16 v[64:67], v[40:43], a[244:247], v[64:67]
    s_waitcnt lgkmcnt(6)
    v_mfma_f32_16x16x32_bf16 v[52:55], v[44:47], a[248:251], v[52:55]
    ds_read_b128 v[40:43], v12 offset:6144
    s_add_u32 m0, s19, 7936
    v_mfma_f32_16x16x32_bf16 v[60:63], v[44:47], a[252:255], v[60:63]
    buffer_load_dwordx4 v2, s[8:11], s20 offen offset:256 lds
    s_waitcnt lgkmcnt(6)
    v_mfma_f32_16x16x32_bf16 v[56:59], v[48:51], a[248:251], v[56:59]
    ds_read_b128 v[44:47], v13 offset:4096
    v_mfma_f32_16x16x32_bf16 v[64:67], v[48:51], a[252:255], v[64:67]
    s_waitcnt lgkmcnt(6)
    v_mfma_f32_16x16x32_bf16 v[68:71], v[20:23], a[0:3], 0
    ds_read_b128 v[48:51], v13 offset:6144
    v_mfma_f32_16x16x32_bf16 v[76:79], v[20:23], a[4:7], 0
    s_waitcnt lgkmcnt(6)
    v_mfma_f32_16x16x32_bf16 v[72:75], v[24:27], a[0:3], 0
    ds_read_b128 v[20:23], v12 offset:8192
    s_add_u32 m0, s19, 11904
    v_mfma_f32_16x16x32_bf16 v[80:83], v[24:27], a[4:7], 0
    buffer_load_dwordx4 v2, s[8:11], s20 offen offset:384 lds
    s_waitcnt lgkmcnt(6)
    v_mfma_f32_16x16x32_bf16 v[68:71], v[28:31], a[8:11], v[68:71]
    ds_read_b128 v[24:27], v12 offset:10240
    v_mfma_f32_16x16x32_bf16 v[76:79], v[28:31], a[12:15], v[76:79]
    s_waitcnt lgkmcnt(6)
    v_mfma_f32_16x16x32_bf16 v[72:75], v[32:35], a[8:11], v[72:75]
    ds_read_b128 v[28:31], v13 offset:8192
    s_add_u32 m0, s19, 15872
    v_mfma_f32_16x16x32_bf16 v[80:83], v[32:35], a[12:15], v[80:83]
    buffer_load_dwordx4 v2, s[8:11], s20 offen offset:512 lds
    s_waitcnt lgkmcnt(6)
    v_mfma_f32_16x16x32_bf16 v[68:71], v[36:39], a[16:19], v[68:71]
    ds_read_b128 v[32:35], v13 offset:10240
    v_mfma_f32_16x16x32_bf16 v[76:79], v[36:39], a[20:23], v[76:79]
    s_waitcnt lgkmcnt(6)
    v_mfma_f32_16x16x32_bf16 v[72:75], v[40:43], a[16:19], v[72:75]
    ds_read_b128 v[36:39], v12 offset:12288
    s_add_u32 m0, s19, 19840
    v_mfma_f32_16x16x32_bf16 v[80:83], v[40:43], a[20:23], v[80:83]
    buffer_load_dwordx4 v2, s[8:11], s20 offen offset:640 lds
    s_waitcnt lgkmcnt(6)
    v_mfma_f32_16x16x32_bf16 v[68:71], v[44:47], a[24:27], v[68:71]
    ds_read_b128 v[40:43], v12 offset:14336
    v_mfma_f32_16x16x32_bf16 v[76:79], v[44:47], a[28:31], v[76:79]
    s_waitcnt lgkmcnt(6)
    v_mfma_f32_16x16x32_bf16 v[72:75], v[48:51], a[24:27], v[72:75]
    ds_read_b128 v[44:47], v13 offset:12288
    s_add_u32 m0, s19, 23808
    v_mfma_f32_16x16x32_bf16 v[80:83], v[48:51], a[28:31], v[80:83]
    buffer_load_dwordx4 v2, s[8:11], s20 offen offset:768 lds
    s_waitcnt lgkmcnt(6)
    v_mfma_f32_16x16x32_bf16 v[68:71], v[20:23], a[32:35], v[68:71]
    ds_read_b128 v[48:51], v13 offset:14336
    v_mfma_f32_16x16x32_bf16 v[76:79], v[20:23], a[36:39], v[76:79]
    s_waitcnt lgkmcnt(6)
    v_mfma_f32_16x16x32_bf16 v[72:75], v[24:27], a[32:35], v[72:75]
    ds_read_b128 v[20:23], v12 offset:16384
    s_add_u32 m0, s19, 27776
    v_mfma_f32_16x16x32_bf16 v[80:83], v[24:27], a[36:39], v[80:83]
    buffer_load_dwordx4 v2, s[8:11], s20 offen offset:896 lds
    s_waitcnt lgkmcnt(6)
    v_mfma_f32_16x16x32_bf16 v[68:71], v[28:31], a[40:43], v[68:71]
    ds_read_b128 v[24:27], v12 offset:18432
    v_mfma_f32_16x16x32_bf16 v[76:79], v[28:31], a[44:47], v[76:79]
    v_cvt_pk_bf16_f32 v84, v52, v53
    s_waitcnt lgkmcnt(6)
    v_mfma_f32_16x16x32_bf16 v[72:75], v[32:35], a[40:43], v[72:75]
    ds_read_b128 v[28:31], v13 offset:16384
    v_mfma_f32_16x16x32_bf16 v[80:83], v[32:35], a[44:47], v[80:83]
    v_cvt_pk_bf16_f32 v85, v54, v55
    s_waitcnt lgkmcnt(6)
    v_mfma_f32_16x16x32_bf16 v[68:71], v[36:39], a[48:51], v[68:71]
    ds_read_b128 v[32:35], v13 offset:18432
    v_mfma_f32_16x16x32_bf16 v[76:79], v[36:39], a[52:55], v[76:79]
    v_cvt_pk_bf16_f32 v86, v56, v57
    s_waitcnt lgkmcnt(6)
    v_mfma_f32_16x16x32_bf16 v[72:75], v[40:43], a[48:51], v[72:75]
    ds_read_b128 v[36:39], v12 offset:20480
    v_mfma_f32_16x16x32_bf16 v[80:83], v[40:43], a[52:55], v[80:83]
    v_cvt_pk_bf16_f32 v87, v58, v59
    s_waitcnt lgkmcnt(6)
    v_mfma_f32_16x16x32_bf16 v[68:71], v[44:47], a[56:59], v[68:71]
    ds_read_b128 v[40:43], v12 offset:22528
    v_mfma_f32_16x16x32_bf16 v[76:79], v[44:47], a[60:63], v[76:79]
    v_cvt_pk_bf16_f32 v88, v60, v61
    s_waitcnt lgkmcnt(6)
    v_mfma_f32_16x16x32_bf16 v[72:75], v[48:51], a[56:59], v[72:75]
    ds_read_b128 v[44:47], v13 offset:20480
    v_mfma_f32_16x16x32_bf16 v[80:83], v[48:51], a[60:63], v[80:83]
    v_cvt_pk_bf16_f32 v89, v62, v63
    buffer_store_dwordx4 v[84:87], v3, s[4:7], s21 offen offset:0 sc1
    s_waitcnt lgkmcnt(6)
    v_mfma_f32_16x16x32_bf16 v[68:71], v[20:23], a[64:67], v[68:71]
    ds_read_b128 v[48:51], v13 offset:22528
    v_mfma_f32_16x16x32_bf16 v[76:79], v[20:23], a[68:71], v[76:79]
    v_cvt_pk_bf16_f32 v90, v64, v65
    s_waitcnt lgkmcnt(6)
    v_mfma_f32_16x16x32_bf16 v[72:75], v[24:27], a[64:67], v[72:75]
    ds_read_b128 v[20:23], v12 offset:24576
    v_mfma_f32_16x16x32_bf16 v[80:83], v[24:27], a[68:71], v[80:83]
    v_cvt_pk_bf16_f32 v91, v66, v67
    s_waitcnt lgkmcnt(6)
    v_mfma_f32_16x16x32_bf16 v[68:71], v[28:31], a[72:75], v[68:71]
    ds_read_b128 v[24:27], v12 offset:26624
    v_mfma_f32_16x16x32_bf16 v[76:79], v[28:31], a[76:79], v[76:79]
    s_waitcnt lgkmcnt(6)
    v_mfma_f32_16x16x32_bf16 v[72:75], v[32:35], a[72:75], v[72:75]
    ds_read_b128 v[28:31], v13 offset:24576
    v_mfma_f32_16x16x32_bf16 v[80:83], v[32:35], a[76:79], v[80:83]
    buffer_store_dwordx4 v[88:91], v3, s[4:7], s21 offen offset:256 sc1
    s_waitcnt lgkmcnt(6)
    v_mfma_f32_16x16x32_bf16 v[68:71], v[36:39], a[80:83], v[68:71]
    ds_read_b128 v[32:35], v13 offset:26624
    v_mfma_f32_16x16x32_bf16 v[76:79], v[36:39], a[84:87], v[76:79]
    s_add_u32 s21, s21, s25
    s_mov_b32 s25, s26
    s_waitcnt lgkmcnt(6)
    v_mfma_f32_16x16x32_bf16 v[72:75], v[40:43], a[80:83], v[72:75]
    ds_read_b128 v[36:39], v12 offset:28672
    v_mfma_f32_16x16x32_bf16 v[80:83], v[40:43], a[84:87], v[80:83]
    s_waitcnt lgkmcnt(6)
    v_mfma_f32_16x16x32_bf16 v[68:71], v[44:47], a[88:91], v[68:71]
    ds_read_b128 v[40:43], v12 offset:30720
    v_mfma_f32_16x16x32_bf16 v[76:79], v[44:47], a[92:95], v[76:79]
    s_waitcnt lgkmcnt(6)
    v_mfma_f32_16x16x32_bf16 v[72:75], v[48:51], a[88:91], v[72:75]
    ds_read_b128 v[44:47], v13 offset:28672
    v_mfma_f32_16x16x32_bf16 v[80:83], v[48:51], a[92:95], v[80:83]
    s_waitcnt lgkmcnt(6)
    v_mfma_f32_16x16x32_bf16 v[68:71], v[20:23], a[96:99], v[68:71]
    ds_read_b128 v[48:51], v13 offset:30720
    v_mfma_f32_16x16x32_bf16 v[76:79], v[20:23], a[100:103], v[76:79]
    s_waitcnt lgkmcnt(6)
    v_mfma_f32_16x16x32_bf16 v[72:75], v[24:27], a[96:99], v[72:75]
    s_waitcnt vmcnt(10)
    s_barrier
    ds_read_b128 v[20:23], v12 offset:32768
    v_mfma_f32_16x16x32_bf16 v[80:83], v[24:27], a[100:103], v[80:83]
    s_waitcnt lgkmcnt(6)
    v_mfma_f32_16x16x32_bf16 v[68:71], v[28:31], a[104:107], v[68:71]
    ds_read_b128 v[24:27], v12 offset:34816
    s_add_u32 m0, s19, 31744
    v_mfma_f32_16x16x32_bf16 v[76:79], v[28:31], a[108:111], v[76:79]
    buffer_load_dwordx4 v2, s[8:11], s20 offen offset:1024 lds
    s_waitcnt lgkmcnt(6)
    v_mfma_f32_16x16x32_bf16 v[72:75], v[32:35], a[104:107], v[72:75]
    ds_read_b128 v[28:31], v13 offset:32768
    v_mfma_f32_16x16x32_bf16 v[80:83], v[32:35], a[108:111], v[80:83]
    s_waitcnt lgkmcnt(6)
    v_mfma_f32_16x16x32_bf16 v[68:71], v[36:39], a[112:115], v[68:71]
    ds_read_b128 v[32:35], v13 offset:34816
    s_add_u32 m0, s19, 35712
    v_mfma_f32_16x16x32_bf16 v[76:79], v[36:39], a[116:119], v[76:79]
    buffer_load_dwordx4 v2, s[8:11], s20 offen offset:1152 lds
    s_waitcnt lgkmcnt(6)
    v_mfma_f32_16x16x32_bf16 v[72:75], v[40:43], a[112:115], v[72:75]
    ds_read_b128 v[36:39], v12 offset:36864
    v_mfma_f32_16x16x32_bf16 v[80:83], v[40:43], a[116:119], v[80:83]
    s_waitcnt lgkmcnt(6)
    v_mfma_f32_16x16x32_bf16 v[68:71], v[44:47], a[120:123], v[68:71]
    ds_read_b128 v[40:43], v12 offset:38912
    s_add_u32 m0, s19, 39680
    v_mfma_f32_16x16x32_bf16 v[76:79], v[44:47], a[124:127], v[76:79]
    buffer_load_dwordx4 v2, s[8:11], s20 offen offset:1280 lds
    s_waitcnt lgkmcnt(6)
    v_mfma_f32_16x16x32_bf16 v[72:75], v[48:51], a[120:123], v[72:75]
    ds_read_b128 v[44:47], v13 offset:36864
    v_mfma_f32_16x16x32_bf16 v[80:83], v[48:51], a[124:127], v[80:83]
    s_waitcnt lgkmcnt(6)
    v_mfma_f32_16x16x32_bf16 v[68:71], v[20:23], a[128:131], v[68:71]
    ds_read_b128 v[48:51], v13 offset:38912
    v_mfma_f32_16x16x32_bf16 v[76:79], v[20:23], a[132:135], v[76:79]
    s_waitcnt lgkmcnt(6)
    v_mfma_f32_16x16x32_bf16 v[72:75], v[24:27], a[128:131], v[72:75]
    ds_read_b128 v[20:23], v12 offset:40960
    s_add_u32 m0, s19, 43648
    v_mfma_f32_16x16x32_bf16 v[80:83], v[24:27], a[132:135], v[80:83]
    buffer_load_dwordx4 v2, s[8:11], s20 offen offset:1408 lds
    s_waitcnt lgkmcnt(6)
    v_mfma_f32_16x16x32_bf16 v[68:71], v[28:31], a[136:139], v[68:71]
    ds_read_b128 v[24:27], v12 offset:43008
    v_mfma_f32_16x16x32_bf16 v[76:79], v[28:31], a[140:143], v[76:79]
    s_waitcnt lgkmcnt(6)
    v_mfma_f32_16x16x32_bf16 v[72:75], v[32:35], a[136:139], v[72:75]
    ds_read_b128 v[28:31], v13 offset:40960
    s_add_u32 m0, s19, 47616
    v_mfma_f32_16x16x32_bf16 v[80:83], v[32:35], a[140:143], v[80:83]
    buffer_load_dwordx4 v2, s[8:11], s20 offen offset:1536 lds
    s_waitcnt lgkmcnt(6)
    v_mfma_f32_16x16x32_bf16 v[68:71], v[36:39], a[144:147], v[68:71]
    ds_read_b128 v[32:35], v13 offset:43008
    v_mfma_f32_16x16x32_bf16 v[76:79], v[36:39], a[148:151], v[76:79]
    s_waitcnt lgkmcnt(6)
    v_mfma_f32_16x16x32_bf16 v[72:75], v[40:43], a[144:147], v[72:75]
    ds_read_b128 v[36:39], v12 offset:45056
    s_add_u32 m0, s19, 51584
    v_mfma_f32_16x16x32_bf16 v[80:83], v[40:43], a[148:151], v[80:83]
    buffer_load_dwordx4 v2, s[8:11], s20 offen offset:1664 lds
    s_waitcnt lgkmcnt(6)
    v_mfma_f32_16x16x32_bf16 v[68:71], v[44:47], a[152:155], v[68:71]
    ds_read_b128 v[40:43], v12 offset:47104
    v_mfma_f32_16x16x32_bf16 v[76:79], v[44:47], a[156:159], v[76:79]
    s_waitcnt lgkmcnt(6)
    v_mfma_f32_16x16x32_bf16 v[72:75], v[48:51], a[152:155], v[72:75]
    ds_read_b128 v[44:47], v13 offset:45056
    s_add_u32 m0, s19, 55552
    v_mfma_f32_16x16x32_bf16 v[80:83], v[48:51], a[156:159], v[80:83]
    buffer_load_dwordx4 v2, s[8:11], s20 offen offset:1792 lds
    s_waitcnt lgkmcnt(6)
    v_mfma_f32_16x16x32_bf16 v[68:71], v[20:23], a[160:163], v[68:71]
    ds_read_b128 v[48:51], v13 offset:47104
    v_mfma_f32_16x16x32_bf16 v[76:79], v[20:23], a[164:167], v[76:79]
    s_waitcnt lgkmcnt(6)
    v_mfma_f32_16x16x32_bf16 v[72:75], v[24:27], a[160:163], v[72:75]
    ds_read_b128 v[20:23], v12 offset:49152
    s_add_u32 m0, s19, 59520
    v_mfma_f32_16x16x32_bf16 v[80:83], v[24:27], a[164:167], v[80:83]
    buffer_load_dwordx4 v2, s[8:11], s20 offen offset:1920 lds
    s_waitcnt lgkmcnt(6)
    v_mfma_f32_16x16x32_bf16 v[68:71], v[28:31], a[168:171], v[68:71]
    ds_read_b128 v[24:27], v12 offset:51200
    v_mfma_f32_16x16x32_bf16 v[76:79], v[28:31], a[172:175], v[76:79]
    s_add_u32 s20, s20, s24
    s_waitcnt lgkmcnt(6)
    v_mfma_f32_16x16x32_bf16 v[72:75], v[32:35], a[168:171], v[72:75]
    ds_read_b128 v[28:31], v13 offset:49152
    v_mfma_f32_16x16x32_bf16 v[80:83], v[32:35], a[172:175], v[80:83]
    s_waitcnt lgkmcnt(6)
    v_mfma_f32_16x16x32_bf16 v[68:71], v[36:39], a[176:179], v[68:71]
    ds_read_b128 v[32:35], v13 offset:51200
    v_mfma_f32_16x16x32_bf16 v[76:79], v[36:39], a[180:183], v[76:79]
    s_waitcnt lgkmcnt(6)
    v_mfma_f32_16x16x32_bf16 v[72:75], v[40:43], a[176:179], v[72:75]
    ds_read_b128 v[36:39], v12 offset:53248
    v_mfma_f32_16x16x32_bf16 v[80:83], v[40:43], a[180:183], v[80:83]
    s_waitcnt lgkmcnt(6)
    v_mfma_f32_16x16x32_bf16 v[68:71], v[44:47], a[184:187], v[68:71]
    ds_read_b128 v[40:43], v12 offset:55296
    v_mfma_f32_16x16x32_bf16 v[76:79], v[44:47], a[188:191], v[76:79]
    s_waitcnt lgkmcnt(6)
    v_mfma_f32_16x16x32_bf16 v[72:75], v[48:51], a[184:187], v[72:75]
    ds_read_b128 v[44:47], v13 offset:53248
    v_mfma_f32_16x16x32_bf16 v[80:83], v[48:51], a[188:191], v[80:83]
    s_waitcnt lgkmcnt(6)
    v_mfma_f32_16x16x32_bf16 v[68:71], v[20:23], a[192:195], v[68:71]
    ds_read_b128 v[48:51], v13 offset:55296
    v_mfma_f32_16x16x32_bf16 v[76:79], v[20:23], a[196:199], v[76:79]
    s_waitcnt lgkmcnt(6)
    v_mfma_f32_16x16x32_bf16 v[72:75], v[24:27], a[192:195], v[72:75]
    ds_read_b128 v[20:23], v12 offset:57344
    v_mfma_f32_16x16x32_bf16 v[80:83], v[24:27], a[196:199], v[80:83]
    s_waitcnt lgkmcnt(6)
    v_mfma_f32_16x16x32_bf16 v[68:71], v[28:31], a[200:203], v[68:71]
    ds_read_b128 v[24:27], v12 offset:59392
    v_mfma_f32_16x16x32_bf16 v[76:79], v[28:31], a[204:207], v[76:79]
    s_waitcnt lgkmcnt(6)
    v_mfma_f32_16x16x32_bf16 v[72:75], v[32:35], a[200:203], v[72:75]
    ds_read_b128 v[28:31], v13 offset:57344
    v_mfma_f32_16x16x32_bf16 v[80:83], v[32:35], a[204:207], v[80:83]
    s_waitcnt lgkmcnt(6)
    v_mfma_f32_16x16x32_bf16 v[68:71], v[36:39], a[208:211], v[68:71]
    ds_read_b128 v[32:35], v13 offset:59392
    v_mfma_f32_16x16x32_bf16 v[76:79], v[36:39], a[212:215], v[76:79]
    s_waitcnt lgkmcnt(6)
    v_mfma_f32_16x16x32_bf16 v[72:75], v[40:43], a[208:211], v[72:75]
    ds_read_b128 v[36:39], v12 offset:61440
    v_mfma_f32_16x16x32_bf16 v[80:83], v[40:43], a[212:215], v[80:83]
    s_waitcnt lgkmcnt(6)
    v_mfma_f32_16x16x32_bf16 v[68:71], v[44:47], a[216:219], v[68:71]
    ds_read_b128 v[40:43], v12 offset:63488
    v_mfma_f32_16x16x32_bf16 v[76:79], v[44:47], a[220:223], v[76:79]
    s_waitcnt lgkmcnt(6)
    v_mfma_f32_16x16x32_bf16 v[72:75], v[48:51], a[216:219], v[72:75]
    ds_read_b128 v[44:47], v13 offset:61440
    v_mfma_f32_16x16x32_bf16 v[80:83], v[48:51], a[220:223], v[80:83]
    s_waitcnt lgkmcnt(6)
    v_mfma_f32_16x16x32_bf16 v[68:71], v[20:23], a[224:227], v[68:71]
    ds_read_b128 v[48:51], v13 offset:63488
    v_mfma_f32_16x16x32_bf16 v[76:79], v[20:23], a[228:231], v[76:79]
    s_waitcnt lgkmcnt(6)
    v_mfma_f32_16x16x32_bf16 v[72:75], v[24:27], a[224:227], v[72:75]
    s_waitcnt vmcnt(8)
    s_barrier
    ds_read_b128 v[20:23], v10 offset:0
    v_mfma_f32_16x16x32_bf16 v[80:83], v[24:27], a[228:231], v[80:83]
    s_waitcnt lgkmcnt(6)
    v_mfma_f32_16x16x32_bf16 v[68:71], v[28:31], a[232:235], v[68:71]
    ds_read_b128 v[24:27], v10 offset:2048
    s_add_u32 m0, s19, 65536
    v_mfma_f32_16x16x32_bf16 v[76:79], v[28:31], a[236:239], v[76:79]
    buffer_load_dwordx4 v2, s[8:11], s20 offen offset:0 lds
    s_waitcnt lgkmcnt(6)
    v_mfma_f32_16x16x32_bf16 v[72:75], v[32:35], a[232:235], v[72:75]
    ds_read_b128 v[28:31], v11 offset:0
    v_mfma_f32_16x16x32_bf16 v[80:83], v[32:35], a[236:239], v[80:83]
    s_waitcnt lgkmcnt(6)
    v_mfma_f32_16x16x32_bf16 v[68:71], v[36:39], a[240:243], v[68:71]
    ds_read_b128 v[32:35], v11 offset:2048
    s_add_u32 m0, s19, 69504
    v_mfma_f32_16x16x32_bf16 v[76:79], v[36:39], a[244:247], v[76:79]
    buffer_load_dwordx4 v2, s[8:11], s20 offen offset:128 lds
    s_waitcnt lgkmcnt(6)
    v_mfma_f32_16x16x32_bf16 v[72:75], v[40:43], a[240:243], v[72:75]
    ds_read_b128 v[36:39], v10 offset:4096
    v_mfma_f32_16x16x32_bf16 v[80:83], v[40:43], a[244:247], v[80:83]
    s_waitcnt lgkmcnt(6)
    v_mfma_f32_16x16x32_bf16 v[68:71], v[44:47], a[248:251], v[68:71]
    ds_read_b128 v[40:43], v10 offset:6144
    s_add_u32 m0, s19, 73472
    v_mfma_f32_16x16x32_bf16 v[76:79], v[44:47], a[252:255], v[76:79]
    buffer_load_dwordx4 v2, s[8:11], s20 offen offset:256 lds
    s_waitcnt lgkmcnt(6)
    v_mfma_f32_16x16x32_bf16 v[72:75], v[48:51], a[248:251], v[72:75]
    ds_read_b128 v[44:47], v11 offset:4096
    v_mfma_f32_16x16x32_bf16 v[80:83], v[48:51], a[252:255], v[80:83]
    s_add_u32 s22, s22, 2
    s_cmp_lt_u32 s22, 16
    s_cbranch_scc1 F1_top
    v_cvt_pk_bf16_f32 v84, v68, v69
    v_cvt_pk_bf16_f32 v85, v70, v71
    s_nop 0
    v_cvt_pk_bf16_f32 v86, v72, v73
    v_cvt_pk_bf16_f32 v87, v74, v75
    v_cvt_pk_bf16_f32 v88, v76, v77
    v_cvt_pk_bf16_f32 v89, v78, v79
    v_cvt_pk_bf16_f32 v90, v80, v81
    v_cvt_pk_bf16_f32 v91, v82, v83
    buffer_store_dwordx4 v[84:87], v3, s[4:7], s21 offen offset:0 sc1
    buffer_store_dwordx4 v[88:91], v3, s[4:7], s21 offen offset:256 sc1
    s_waitcnt vmcnt(0) lgkmcnt(0)
    s_barrier
    s_lshl_b32 s31, s29, 2
    s_add_u32 s31, s31, s28
    s_lshl_b32 s17, s31, 2
    s_add_u32 s17, s17, 100732928
    v_mov_b32 v5, s17
    v_mov_b32 v6, 1
    s_mov_b64 exec, 1
    buffer_store_dword v6, v5, s[4:7], 0 offen sc1
    s_mov_b64 exec, -1
    v_and_b32 v10, 19, v1
    v_bfe_u32 v5, v1, 2, 1
    v_bfe_u32 v6, v1, 3, 1
    v_lshl_add_u32 v10, v5, 3, v10
    v_lshl_add_u32 v10, v6, 2, v10
    v_lshrrev_b32 v11, 5, v1
    v_cvt_f32_u32 v16, v10
    v_lshlrev_b32 v17, 3, v11
    v_cvt_f32_u32 v17, v17
    v_lshlrev_b32 v14, 4, v1
    v_add_f32 v5, 0, v16
    v_mul_f32 v5, 1015021568, v5
    v_mul_f32 v6, v5, v17
    v_mul_f32 v7, 0x41800000, v5
    v_fract_f32 v32, v6
    v_add_f32 v33, v32, v5
    v_add_f32 v34, v33, v5
    v_add_f32 v35, v34, v5
    v_add_f32 v36, v35, v5
    v_add_f32 v37, v36, v5
    v_add_f32 v38, v37, v5
    v_add_f32 v39, v38, v5
    v_add_f32 v6, v32, v7
    v_cos_f32 v40, v32
    v_sin_f32 v48, v32
    v_cos_f32 v41, v33
    v_sin_f32 v49, v33
    v_cos_f32 v42, v34
    v_sin_f32 v50, v34
    v_cos_f32 v43, v35
    v_sin_f32 v51, v35
    v_cos_f32 v44, v36
    v_sin_f32 v52, v36
    v_cos_f32 v45, v37
    v_sin_f32 v53, v37
    v_cos_f32 v46, v38
    v_sin_f32 v54, v38
    v_cos_f32 v47, v39
    v_sin_f32 v55, v39
    v_cvt_pk_bf16_f32 v56, v40, v41
    v_cvt_pk_bf16_f32 v57, v48, v49
    v_accvgpr_write_b32 a0, v56
    v_xor_b32 v58, 0x80008000, v57
    v_accvgpr_write_b32 a32, v57
    v_accvgpr_write_b32 a64, v58
    v_cvt_pk_bf16_f32 v56, v42, v43
    v_cvt_pk_bf16_f32 v57, v50, v51
    v_accvgpr_write_b32 a1, v56
    v_xor_b32 v58, 0x80008000, v57
    v_accvgpr_write_b32 a33, v57
    v_accvgpr_write_b32 a65, v58
    v_cvt_pk_bf16_f32 v56, v44, v45
    v_cvt_pk_bf16_f32 v57, v52, v53
    v_accvgpr_write_b32 a2, v56
    v_xor_b32 v58, 0x80008000, v57
    v_accvgpr_write_b32 a34, v57
    v_accvgpr_write_b32 a66, v58
    v_cvt_pk_bf16_f32 v56, v46, v47
    v_cvt_pk_bf16_f32 v57, v54, v55
    v_accvgpr_write_b32 a3, v56
    v_xor_b32 v58, 0x80008000, v57
    v_accvgpr_write_b32 a35, v57
    v_accvgpr_write_b32 a67, v58
    v_fract_f32 v32, v6
    v_add_f32 v33, v32, v5
    v_add_f32 v34, v33, v5
    v_add_f32 v35, v34, v5
    v_add_f32 v36, v35, v5
    v_add_f32 v37, v36, v5
    v_add_f32 v38, v37, v5
    v_add_f32 v39, v38, v5
    v_add_f32 v6, v32, v7
    v_cos_f32 v40, v32
    v_sin_f32 v48, v32
    v_cos_f32 v41, v33
    v_sin_f32 v49, v33
    v_cos_f32 v42, v34
    v_sin_f32 v50, v34
    v_cos_f32 v43, v35
    v_sin_f32 v51, v35
    v_cos_f32 v44, v36
    v_sin_f32 v52, v36
    v_cos_f32 v45, v37
    v_sin_f32 v53, v37
    v_cos_f32 v46, v38
    v_sin_f32 v54, v38
    v_cos_f32 v47, v39
    v_sin_f32 v55, v39
    v_cvt_pk_bf16_f32 v56, v40, v41
    v_cvt_pk_bf16_f32 v57, v48, v49
    v_accvgpr_write_b32 a4, v56
    v_xor_b32 v58, 0x80008000, v57
    v_accvgpr_write_b32 a36, v57
    v_accvgpr_write_b32 a68, v58
    v_cvt_pk_bf16_f32 v56, v42, v43
    v_cvt_pk_bf16_f32 v57, v50, v51
    v_accvgpr_write_b32 a5, v56
    v_xor_b32 v58, 0x80008000, v57
    v_accvgpr_write_b32 a37, v57
    v_accvgpr_write_b32 a69, v58
    v_cvt_pk_bf16_f32 v56, v44, v45
    v_cvt_pk_bf16_f32 v57, v52, v53
    v_accvgpr_write_b32 a6, v56
    v_xor_b32 v58, 0x80008000, v57
    v_accvgpr_write_b32 a38, v57
    v_accvgpr_write_b32 a70, v58
    v_cvt_pk_bf16_f32 v56, v46, v47
    v_cvt_pk_bf16_f32 v57, v54, v55
    v_accvgpr_write_b32 a7, v56
    v_xor_b32 v58, 0x80008000, v57
    v_accvgpr_write_b32 a39, v57
    v_accvgpr_write_b32 a71, v58
    v_fract_f32 v32, v6
    v_add_f32 v33, v32, v5
    v_add_f32 v34, v33, v5
    v_add_f32 v35, v34, v5
    v_add_f32 v36, v35, v5
    v_add_f32 v37, v36, v5
    v_add_f32 v38, v37, v5
    v_add_f32 v39, v38, v5
    v_add_f32 v6, v32, v7
    v_cos_f32 v40, v32
    v_sin_f32 v48, v32
    v_cos_f32 v41, v33
    v_sin_f32 v49, v33
    v_cos_f32 v42, v34
    v_sin_f32 v50, v34
    v_cos_f32 v43, v35
    v_sin_f32 v51, v35
    v_cos_f32 v44, v36
    v_sin_f32 v52, v36
    v_cos_f32 v45, v37
    v_sin_f32 v53, v37
    v_cos_f32 v46, v38
    v_sin_f32 v54, v38
    v_cos_f32 v47, v39
    v_sin_f32 v55, v39
    v_cvt_pk_bf16_f32 v56, v40, v41
    v_cvt_pk_bf16_f32 v57, v48, v49
    v_accvgpr_write_b32 a8, v56
    v_xor_b32 v58, 0x80008000, v57
    v_accvgpr_write_b32 a40, v57
    v_accvgpr_write_b32 a72, v58
    v_cvt_pk_bf16_f32 v56, v42, v43
    v_cvt_pk_bf16_f32 v57, v50, v51
    v_accvgpr_write_b32 a9, v56
    v_xor_b32 v58, 0x80008000, v57
    v_accvgpr_write_b32 a41, v57
    v_accvgpr_write_b32 a73, v58
    v_cvt_pk_bf16_f32 v56, v44, v45
    v_cvt_pk_bf16_f32 v57, v52, v53
    v_accvgpr_write_b32 a10, v56
    v_xor_b32 v58, 0x80008000, v57
    v_accvgpr_write_b32 a42, v57
    v_accvgpr_write_b32 a74, v58
    v_cvt_pk_bf16_f32 v56, v46, v47
    v_cvt_pk_bf16_f32 v57, v54, v55
    v_accvgpr_write_b32 a11, v56
    v_xor_b32 v58, 0x80008000, v57
    v_accvgpr_write_b32 a43, v57
    v_accvgpr_write_b32 a75, v58
    v_fract_f32 v32, v6
    v_add_f32 v33, v32, v5
    v_add_f32 v34, v33, v5
    v_add_f32 v35, v34, v5
    v_add_f32 v36, v35, v5
    v_add_f32 v37, v36, v5
    v_add_f32 v38, v37, v5
    v_add_f32 v39, v38, v5
    v_add_f32 v6, v32, v7
    v_cos_f32 v40, v32
    v_sin_f32 v48, v32
    v_cos_f32 v41, v33
    v_sin_f32 v49, v33
    v_cos_f32 v42, v34
    v_sin_f32 v50, v34
    v_cos_f32 v43, v35
    v_sin_f32 v51, v35
    v_cos_f32 v44, v36
    v_sin_f32 v52, v36
    v_cos_f32 v45, v37
    v_sin_f32 v53, v37
    v_cos_f32 v46, v38
    v_sin_f32 v54, v38
    v_cos_f32 v47, v39
    v_sin_f32 v55, v39
    v_cvt_pk_bf16_f32 v56, v40, v41
    v_cvt_pk_bf16_f32 v57, v48, v49
    v_accvgpr_write_b32 a12, v56
    v_xor_b32 v58, 0x80008000, v57
    v_accvgpr_write_b32 a44, v57
    v_accvgpr_write_b32 a76, v58
    v_cvt_pk_bf16_f32 v56, v42, v43
    v_cvt_pk_bf16_f32 v57, v50, v51
    v_accvgpr_write_b32 a13, v56
    v_xor_b32 v58, 0x80008000, v57
    v_accvgpr_write_b32 a45, v57
    v_accvgpr_write_b32 a77, v58
    v_cvt_pk_bf16_f32 v56, v44, v45
    v_cvt_pk_bf16_f32 v57, v52, v53
    v_accvgpr_write_b32 a14, v56
    v_xor_b32 v58, 0x80008000, v57
    v_accvgpr_write_b32 a46, v57
    v_accvgpr_write_b32 a78, v58
    v_cvt_pk_bf16_f32 v56, v46, v47
    v_cvt_pk_bf16_f32 v57, v54, v55
    v_accvgpr_write_b32 a15, v56
    v_xor_b32 v58, 0x80008000, v57
    v_accvgpr_write_b32 a47, v57
    v_accvgpr_write_b32 a79, v58
    v_add_f32 v5, 1107296256, v16
    v_mul_f32 v5, 1015021568, v5
    v_mul_f32 v6, v5, v17
    v_mul_f32 v7, 0x41800000, v5
    v_fract_f32 v32, v6
    v_add_f32 v33, v32, v5
    v_add_f32 v34, v33, v5
    v_add_f32 v35, v34, v5
    v_add_f32 v36, v35, v5
    v_add_f32 v37, v36, v5
    v_add_f32 v38, v37, v5
    v_add_f32 v39, v38, v5
    v_add_f32 v6, v32, v7
    v_cos_f32 v40, v32
    v_sin_f32 v48, v32
    v_cos_f32 v41, v33
    v_sin_f32 v49, v33
    v_cos_f32 v42, v34
    v_sin_f32 v50, v34
    v_cos_f32 v43, v35
    v_sin_f32 v51, v35
    v_cos_f32 v44, v36
    v_sin_f32 v52, v36
    v_cos_f32 v45, v37
    v_sin_f32 v53, v37
    v_cos_f32 v46, v38
    v_sin_f32 v54, v38
    v_cos_f32 v47, v39
    v_sin_f32 v55, v39
    v_cvt_pk_bf16_f32 v56, v40, v41
    v_cvt_pk_bf16_f32 v57, v48, v49
    v_accvgpr_write_b32 a16, v56
    v_xor_b32 v58, 0x80008000, v57
    v_accvgpr_write_b32 a48, v57
    v_accvgpr_write_b32 a80, v58
    v_cvt_pk_bf16_f32 v56, v42, v43
    v_cvt_pk_bf16_f32 v57, v50, v51
    v_accvgpr_write_b32 a17, v56
    v_xor_b32 v58, 0x80008000, v57
    v_accvgpr_write_b32 a49, v57
    v_accvgpr_write_b32 a81, v58
    v_cvt_pk_bf16_f32 v56, v44, v45
    v_cvt_pk_bf16_f32 v57, v52, v53
    v_accvgpr_write_b32 a18, v56
    v_xor_b32 v58, 0x80008000, v57
    v_accvgpr_write_b32 a50, v57
    v_accvgpr_write_b32 a82, v58
    v_cvt_pk_bf16_f32 v56, v46, v47
    v_cvt_pk_bf16_f32 v57, v54, v55
    v_accvgpr_write_b32 a19, v56
    v_xor_b32 v58, 0x80008000, v57
    v_accvgpr_write_b32 a51, v57
    v_accvgpr_write_b32 a83, v58
    v_fract_f32 v32, v6
    v_add_f32 v33, v32, v5
    v_add_f32 v34, v33, v5
    v_add_f32 v35, v34, v5
    v_add_f32 v36, v35, v5
    v_add_f32 v37, v36, v5
    v_add_f32 v38, v37, v5
    v_add_f32 v39, v38, v5
    v_add_f32 v6, v32, v7
    v_cos_f32 v40, v32
    v_sin_f32 v48, v32
    v_cos_f32 v41, v33
    v_sin_f32 v49, v33
    v_cos_f32 v42, v34
    v_sin_f32 v50, v34
    v_cos_f32 v43, v35
    v_sin_f32 v51, v35
    v_cos_f32 v44, v36
    v_sin_f32 v52, v36
    v_cos_f32 v45, v37
    v_sin_f32 v53, v37
    v_cos_f32 v46, v38
    v_sin_f32 v54, v38
    v_cos_f32 v47, v39
    v_sin_f32 v55, v39
    v_cvt_pk_bf16_f32 v56, v40, v41
    v_cvt_pk_bf16_f32 v57, v48, v49
    v_accvgpr_write_b32 a20, v56
    v_xor_b32 v58, 0x80008000, v57
    v_accvgpr_write_b32 a52, v57
    v_accvgpr_write_b32 a84, v58
    v_cvt_pk_bf16_f32 v56, v42, v43
    v_cvt_pk_bf16_f32 v57, v50, v51
    v_accvgpr_write_b32 a21, v56
    v_xor_b32 v58, 0x80008000, v57
    v_accvgpr_write_b32 a53, v57
    v_accvgpr_write_b32 a85, v58
    v_cvt_pk_bf16_f32 v56, v44, v45
    v_cvt_pk_bf16_f32 v57, v52, v53
    v_accvgpr_write_b32 a22, v56
    v_xor_b32 v58, 0x80008000, v57
    v_accvgpr_write_b32 a54, v57
    v_accvgpr_write_b32 a86, v58
    v_cvt_pk_bf16_f32 v56, v46, v47
    v_cvt_pk_bf16_f32 v57, v54, v55
    v_accvgpr_write_b32 a23, v56
    v_xor_b32 v58, 0x80008000, v57
    v_accvgpr_write_b32 a55, v57
    v_accvgpr_write_b32 a87, v58
    v_fract_f32 v32, v6
    v_add_f32 v33, v32, v5
    v_add_f32 v34, v33, v5
    v_add_f32 v35, v34, v5
    v_add_f32 v36, v35, v5
    v_add_f32 v37, v36, v5
    v_add_f32 v38, v37, v5
    v_add_f32 v39, v38, v5
    v_add_f32 v6, v32, v7
    v_cos_f32 v40, v32
    v_sin_f32 v48, v32
    v_cos_f32 v41, v33
    v_sin_f32 v49, v33
    v_cos_f32 v42, v34
    v_sin_f32 v50, v34
    v_cos_f32 v43, v35
    v_sin_f32 v51, v35
    v_cos_f32 v44, v36
    v_sin_f32 v52, v36
    v_cos_f32 v45, v37
    v_sin_f32 v53, v37
    v_cos_f32 v46, v38
    v_sin_f32 v54, v38
    v_cos_f32 v47, v39
    v_sin_f32 v55, v39
    v_cvt_pk_bf16_f32 v56, v40, v41
    v_cvt_pk_bf16_f32 v57, v48, v49
    v_accvgpr_write_b32 a24, v56
    v_xor_b32 v58, 0x80008000, v57
    v_accvgpr_write_b32 a56, v57
    v_accvgpr_write_b32 a88, v58
    v_cvt_pk_bf16_f32 v56, v42, v43
    v_cvt_pk_bf16_f32 v57, v50, v51
    v_accvgpr_write_b32 a25, v56
    v_xor_b32 v58, 0x80008000, v57
    v_accvgpr_write_b32 a57, v57
    v_accvgpr_write_b32 a89, v58
    v_cvt_pk_bf16_f32 v56, v44, v45
    v_cvt_pk_bf16_f32 v57, v52, v53
    v_accvgpr_write_b32 a26, v56
    v_xor_b32 v58, 0x80008000, v57
    v_accvgpr_write_b32 a58, v57
    v_accvgpr_write_b32 a90, v58
    v_cvt_pk_bf16_f32 v56, v46, v47
    v_cvt_pk_bf16_f32 v57, v54, v55
    v_accvgpr_write_b32 a27, v56
    v_xor_b32 v58, 0x80008000, v57
    v_accvgpr_write_b32 a59, v57
    v_accvgpr_write_b32 a91, v58
    v_fract_f32 v32, v6
    v_add_f32 v33, v32, v5
    v_add_f32 v34, v33, v5
    v_add_f32 v35, v34, v5
    v_add_f32 v36, v35, v5
    v_add_f32 v37, v36, v5
    v_add_f32 v38, v37, v5
    v_add_f32 v39, v38, v5
    v_add_f32 v6, v32, v7
    v_cos_f32 v40, v32
    v_sin_f32 v48, v32
    v_cos_f32 v41, v33
    v_sin_f32 v49, v33
    v_cos_f32 v42, v34
    v_sin_f32 v50, v34
    v_cos_f32 v43, v35
    v_sin_f32 v51, v35
    v_cos_f32 v44, v36
    v_sin_f32 v52, v36
    v_cos_f32 v45, v37
    v_sin_f32 v53, v37
    v_cos_f32 v46, v38
    v_sin_f32 v54, v38
    v_cos_f32 v47, v39
    v_sin_f32 v55, v39
    v_cvt_pk_bf16_f32 v56, v40, v41
    v_cvt_pk_bf16_f32 v57, v48, v49
    v_accvgpr_write_b32 a28, v56
    v_xor_b32 v58, 0x80008000, v57
    v_accvgpr_write_b32 a60, v57
    v_accvgpr_write_b32 a92, v58
    v_cvt_pk_bf16_f32 v56, v42, v43
    v_cvt_pk_bf16_f32 v57, v50, v51
    v_accvgpr_write_b32 a29, v56
    v_xor_b32 v58, 0x80008000, v57
    v_accvgpr_write_b32 a61, v57
    v_accvgpr_write_b32 a93, v58
    v_cvt_pk_bf16_f32 v56, v44, v45
    v_cvt_pk_bf16_f32 v57, v52, v53
    v_accvgpr_write_b32 a30, v56
    v_xor_b32 v58, 0x80008000, v57
    v_accvgpr_write_b32 a62, v57
    v_accvgpr_write_b32 a94, v58
    v_cvt_pk_bf16_f32 v56, v46, v47
    v_cvt_pk_bf16_f32 v57, v54, v55
    v_accvgpr_write_b32 a31, v56
    v_xor_b32 v58, 0x80008000, v57
    v_accvgpr_write_b32 a63, v57
    v_accvgpr_write_b32 a95, v58
    v_add_f32 v5, 0, v16
    v_mul_f32 v5, 1023410176, v5
    v_mul_f32 v6, v5, v17
    v_mul_f32 v7, 0x41800000, v5
    v_fract_f32 v32, v6
    v_add_f32 v33, v32, v5
    v_add_f32 v34, v33, v5
    v_add_f32 v35, v34, v5
    v_add_f32 v36, v35, v5
    v_add_f32 v37, v36, v5
    v_add_f32 v38, v37, v5
    v_add_f32 v39, v38, v5
    v_add_f32 v6, v32, v7
    v_cos_f32 v40, v32
    v_sin_f32 v48, v32
    v_cos_f32 v41, v33
    v_sin_f32 v49, v33
    v_cos_f32 v42, v34
    v_sin_f32 v50, v34
    v_cos_f32 v43, v35
    v_sin_f32 v51, v35
    v_cos_f32 v44, v36
    v_sin_f32 v52, v36
    v_cos_f32 v45, v37
    v_sin_f32 v53, v37
    v_cos_f32 v46, v38
    v_sin_f32 v54, v38
    v_cos_f32 v47, v39
    v_sin_f32 v55, v39
    v_cvt_pk_bf16_f32 v56, v40, v41
    v_cvt_pk_bf16_f32 v57, v48, v49
    v_accvgpr_write_b32 a96, v56
    v_xor_b32 v58, 0x80008000, v57
    v_accvgpr_write_b32 a104, v57
    v_accvgpr_write_b32 a112, v58
    v_cvt_pk_bf16_f32 v56, v42, v43
    v_cvt_pk_bf16_f32 v57, v50, v51
    v_accvgpr_write_b32 a97, v56
    v_xor_b32 v58, 0x80008000, v57
    v_accvgpr_write_b32 a105, v57
    v_accvgpr_write_b32 a113, v58
    v_cvt_pk_bf16_f32 v56, v44, v45
    v_cvt_pk_bf16_f32 v57, v52, v53
    v_accvgpr_write_b32 a98, v56
    v_xor_b32 v58, 0x80008000, v57
    v_accvgpr_write_b32 a106, v57
    v_accvgpr_write_b32 a114, v58
    v_cvt_pk_bf16_f32 v56, v46, v47
    v_cvt_pk_bf16_f32 v57, v54, v55
    v_accvgpr_write_b32 a99, v56
    v_xor_b32 v58, 0x80008000, v57
    v_accvgpr_write_b32 a107, v57
    v_accvgpr_write_b32 a115, v58
    v_fract_f32 v32, v6
    v_add_f32 v33, v32, v5
    v_add_f32 v34, v33, v5
    v_add_f32 v35, v34, v5
    v_add_f32 v36, v35, v5
    v_add_f32 v37, v36, v5
    v_add_f32 v38, v37, v5
    v_add_f32 v39, v38, v5
    v_add_f32 v6, v32, v7
    v_cos_f32 v40, v32
    v_sin_f32 v48, v32
    v_cos_f32 v41, v33
    v_sin_f32 v49, v33
    v_cos_f32 v42, v34
    v_sin_f32 v50, v34
    v_cos_f32 v43, v35
    v_sin_f32 v51, v35
    v_cos_f32 v44, v36
    v_sin_f32 v52, v36
    v_cos_f32 v45, v37
    v_sin_f32 v53, v37
    v_cos_f32 v46, v38
    v_sin_f32 v54, v38
    v_cos_f32 v47, v39
    v_sin_f32 v55, v39
    v_cvt_pk_bf16_f32 v56, v40, v41
    v_cvt_pk_bf16_f32 v57, v48, v49
    v_accvgpr_write_b32 a100, v56
    v_xor_b32 v58, 0x80008000, v57
    v_accvgpr_write_b32 a108, v57
    v_accvgpr_write_b32 a116, v58
    v_cvt_pk_bf16_f32 v56, v42, v43
    v_cvt_pk_bf16_f32 v57, v50, v51
    v_accvgpr_write_b32 a101, v56
    v_xor_b32 v58, 0x80008000, v57
    v_accvgpr_write_b32 a109, v57
    v_accvgpr_write_b32 a117, v58
    v_cvt_pk_bf16_f32 v56, v44, v45
    v_cvt_pk_bf16_f32 v57, v52, v53
    v_accvgpr_write_b32 a102, v56
    v_xor_b32 v58, 0x80008000, v57
    v_accvgpr_write_b32 a110, v57
    v_accvgpr_write_b32 a118, v58
    v_cvt_pk_bf16_f32 v56, v46, v47
    v_cvt_pk_bf16_f32 v57, v54, v55
    v_accvgpr_write_b32 a103, v56
    v_xor_b32 v58, 0x80008000, v57
    v_accvgpr_write_b32 a111, v57
    v_accvgpr_write_b32 a119, v58
    v_add_f32 v5, 0, v16
    v_mul_f32 v5, 973078528, v5
    v_add_f32 v6, 0, v17
    v_mul_f32 v6, v6, v5
    v_cos_f32 v160, v6
    v_sin_f32 v176, v6
    v_add_f32 v6, 1065353216, v17
    v_mul_f32 v6, v6, v5
    v_cos_f32 v161, v6
    v_sin_f32 v177, v6
    v_add_f32 v6, 1073741824, v17
    v_mul_f32 v6, v6, v5
    v_cos_f32 v162, v6
    v_sin_f32 v178, v6
    v_add_f32 v6, 1077936128, v17
    v_mul_f32 v6, v6, v5
    v_cos_f32 v163, v6
    v_sin_f32 v179, v6
    v_add_f32 v6, 1082130432, v17
    v_mul_f32 v6, v6, v5
    v_cos_f32 v164, v6
    v_sin_f32 v180, v6
    v_add_f32 v6, 1084227584, v17
    v_mul_f32 v6, v6, v5
    v_cos_f32 v165, v6
    v_sin_f32 v181, v6
    v_add_f32 v6, 1086324736, v17
    v_mul_f32 v6, v6, v5
    v_cos_f32 v166, v6
    v_sin_f32 v182, v6
    v_add_f32 v6, 1088421888, v17
    v_mul_f32 v6, v6, v5
    v_cos_f32 v167, v6
    v_sin_f32 v183, v6
    v_add_f32 v6, 1098907648, v17
    v_mul_f32 v6, v6, v5
    v_cos_f32 v168, v6
    v_sin_f32 v184, v6
    v_add_f32 v6, 1099431936, v17
    v_mul_f32 v6, v6, v5
    v_cos_f32 v169, v6
    v_sin_f32 v185, v6
    v_add_f32 v6, 1099956224, v17
    v_mul_f32 v6, v6, v5
    v_cos_f32 v170, v6
    v_sin_f32 v186, v6
    v_add_f32 v6, 1100480512, v17
    v_mul_f32 v6, v6, v5
    v_cos_f32 v171, v6
    v_sin_f32 v187, v6
    v_add_f32 v6, 1101004800, v17
    v_mul_f32 v6, v6, v5
    v_cos_f32 v172, v6
    v_sin_f32 v188, v6
    v_add_f32 v6, 1101529088, v17
    v_mul_f32 v6, v6, v5
    v_cos_f32 v173, v6
    v_sin_f32 v189, v6
    v_add_f32 v6, 1102053376, v17
    v_mul_f32 v6, v6, v5
    v_cos_f32 v174, v6
    v_sin_f32 v190, v6
    v_add_f32 v6, 1102577664, v17
    v_mul_f32 v6, v6, v5
    v_cos_f32 v175, v6
    v_sin_f32 v191, v6
    v_add_f32 v5, 1107296256, v16
    v_mul_f32 v5, 973078528, v5
    v_add_f32 v6, 0, v17
    v_mul_f32 v6, v6, v5
    v_cos_f32 v192, v6
    v_sin_f32 v208, v6
    v_add_f32 v6, 1065353216, v17
    v_mul_f32 v6, v6, v5
    v_cos_f32 v193, v6
    v_sin_f32 v209, v6
    v_add_f32 v6, 1073741824, v17
    v_mul_f32 v6, v6, v5
    v_cos_f32 v194, v6
    v_sin_f32 v210, v6
    v_add_f32 v6, 1077936128, v17
    v_mul_f32 v6, v6, v5
    v_cos_f32 v195, v6
    v_sin_f32 v211, v6
    v_add_f32 v6, 1082130432, v17
    v_mul_f32 v6, v6, v5
    v_cos_f32 v196, v6
    v_sin_f32 v212, v6
    v_add_f32 v6, 1084227584, v17
    v_mul_f32 v6, v6, v5
    v_cos_f32 v197, v6
    v_sin_f32 v213, v6
    v_add_f32 v6, 1086324736, v17
    v_mul_f32 v6, v6, v5
    v_cos_f32 v198, v6
    v_sin_f32 v214, v6
    v_add_f32 v6, 1088421888, v17
    v_mul_f32 v6, v6, v5
    v_cos_f32 v199, v6
    v_sin_f32 v215, v6
    v_add_f32 v6, 1098907648, v17
    v_mul_f32 v6, v6, v5
    v_cos_f32 v200, v6
    v_sin_f32 v216, v6
    v_add_f32 v6, 1099431936, v17
    v_mul_f32 v6, v6, v5
    v_cos_f32 v201, v6
    v_sin_f32 v217, v6
    v_add_f32 v6, 1099956224, v17
    v_mul_f32 v6, v6, v5
    v_cos_f32 v202, v6
    v_sin_f32 v218, v6
    v_add_f32 v6, 1100480512, v17
    v_mul_f32 v6, v6, v5
    v_cos_f32 v203, v6
    v_sin_f32 v219, v6
    v_add_f32 v6, 1101004800, v17
    v_mul_f32 v6, v6, v5
    v_cos_f32 v204, v6
    v_sin_f32 v220, v6
    v_add_f32 v6, 1101529088, v17
    v_mul_f32 v6, v6, v5
    v_cos_f32 v205, v6
    v_sin_f32 v221, v6
    v_add_f32 v6, 1102053376, v17
    v_mul_f32 v6, v6, v5
    v_cos_f32 v206, v6
    v_sin_f32 v222, v6
    v_add_f32 v6, 1102577664, v17
    v_mul_f32 v6, v6, v5
    v_cos_f32 v207, v6
    v_sin_f32 v223, v6
    v_add_f32 v5, 0, v16
    v_mul_f32 v5, 973078528, v5
    v_add_f32 v6, 1107296256, v17
    v_mul_f32 v6, v6, v5
    v_cos_f32 v224, v6
    v_sin_f32 v240, v6
    v_add_f32 v6, 1107558400, v17
    v_mul_f32 v6, v6, v5
    v_cos_f32 v225, v6
    v_sin_f32 v241, v6
    v_add_f32 v6, 1107820544, v17
    v_mul_f32 v6, v6, v5
    v_cos_f32 v226, v6
    v_sin_f32 v242, v6
    v_add_f32 v6, 1108082688, v17
    v_mul_f32 v6, v6, v5
    v_cos_f32 v227, v6
    v_sin_f32 v243, v6
    v_add_f32 v6, 1108344832, v17
    v_mul_f32 v6, v6, v5
    v_cos_f32 v228, v6
    v_sin_f32 v244, v6
    v_add_f32 v6, 1108606976, v17
    v_mul_f32 v6, v6, v5
    v_cos_f32 v229, v6
    v_sin_f32 v245, v6
    v_add_f32 v6, 1108869120, v17
    v_mul_f32 v6, v6, v5
    v_cos_f32 v230, v6
    v_sin_f32 v246, v6
    v_add_f32 v6, 1109131264, v17
    v_mul_f32 v6, v6, v5
    v_cos_f32 v231, v6
    v_sin_f32 v247, v6
    v_add_f32 v6, 1111490560, v17
    v_mul_f32 v6, v6, v5
    v_cos_f32 v232, v6
    v_sin_f32 v248, v6
    v_add_f32 v6, 1111752704, v17
    v_mul_f32 v6, v6, v5
    v_cos_f32 v233, v6
    v_sin_f32 v249, v6
    v_add_f32 v6, 1112014848, v17
    v_mul_f32 v6, v6, v5
    v_cos_f32 v234, v6
    v_sin_f32 v250, v6
    v_add_f32 v6, 1112276992, v17
    v_mul_f32 v6, v6, v5
    v_cos_f32 v235, v6
    v_sin_f32 v251, v6
    v_add_f32 v6, 1112539136, v17
    v_mul_f32 v6, v6, v5
    v_cos_f32 v236, v6
    v_sin_f32 v252, v6
    v_add_f32 v6, 1112801280, v17
    v_mul_f32 v6, v6, v5
    v_cos_f32 v237, v6
    v_sin_f32 v253, v6
    v_add_f32 v6, 1113063424, v17
    v_mul_f32 v6, v6, v5
    v_cos_f32 v238, v6
    v_sin_f32 v254, v6
    v_add_f32 v6, 1113325568, v17
    v_mul_f32 v6, v6, v5
    v_cos_f32 v239, v6
    v_sin_f32 v255, v6
    v_lshlrev_b32 v15, 4, v11
    v_lshl_add_u32 v15, v10, 11, v15
    v_lshlrev_b32 v18, 12, v11
    v_lshl_add_u32 v18, v10, 4, v18
    s_mul_i32 s32, s91, 133120
    s_lshl_b32 s17, s16, 9
    s_add_u32 s32, s32, s17
    s_add_u32 s32, s32, 104857600
    s_add_u32 s33, s32, 64
    s_lshl_b32 s31, s91, 2
    s_add_u32 s31, s31, s16
    s_lshl_b32 s34, s31, 15
    s_add_u32 s34, s34, 117440512
    s_mov_b32 s38, 0xffff0000
    s_mov_b32 s36, 0
    s_cmp_eq_u32 s31, 0
    s_cselect_b32 s37, 5, 4
    s_cselect_b32 s33, 1073741824, s33
    s_mov_b32 s35, 897581056
    s_cselect_b32 s35, 889192448, s35
    v_and_b32 v7, 3, v1
    v_lshlrev_b32 v7, 2, v7
    s_lshl_b32 s17, s91, 4
    s_add_u32 s17, s17, 100732928
    v_add_u32 v7, s17, v7
    s_mov_b32 s30, s92
F2_w:
    buffer_load_dword v5, v7, s[4:7], 0 offen sc1
    s_waitcnt vmcnt(0)
    v_cmp_gt_u32 vcc, 1, v5
    s_nop 0
    s_and_b32 s17, vcc_lo, 15
    s_cbranch_scc0 F2_w_ok
    s_cmp_ge_u32 s30, 1048576
    s_cselect_b32 s92, 1048576, s92
    s_cbranch_scc1 F2_w_ok
    s_add_u32 s30, s30, 1
    s_sleep 8
    s_branch F2_w
F2_w_ok:
F2_top:
    s_add_u32 s17, s32, 65536
    buffer_load_dwordx4 v[96:99], v15, s[4:7], s32 offen offset:0 sc1
    buffer_load_dwordx4 v[100:103], v15, s[4:7], s32 offen offset:32 sc1
    buffer_load_dwordx4 v[104:107], v15, s[4:7], s17 offen offset:0 sc1
    buffer_load_dwordx4 v[108:111], v15, s[4:7], s17 offen offset:32 sc1
    s_add_u32 s17, s33, 65536
    buffer_load_dwordx4 v[112:115], v15, s[4:7], s33 offen offset:0 sc1
    buffer_load_dwordx4 v[116:119], v15, s[4:7], s33 offen offset:32 sc1
    buffer_load_dwordx4 v[120:123], v15, s[4:7], s17 offen offset:0 sc1
    buffer_load_dwordx4 v[124:127], v15, s[4:7], s17 offen offset:32 sc1
    s_add_u32 s17, s34, 4096
    buffer_load_dwordx4 v[128:131], v14, s[4:7], s34 offen offset:0 sc1
    buffer_load_dwordx4 v[132:135], v14, s[4:7], s34 offen offset:1024 sc1
    buffer_load_dwordx4 v[136:139], v14, s[4:7], s34 offen offset:2048 sc1
    buffer_load_dwordx4 v[140:143], v14, s[4:7], s34 offen offset:3072 sc1
    buffer_load_dwordx4 v[144:147], v14, s[4:7], s17 offen offset:0 sc1
    buffer_load_dwordx4 v[148:151], v14, s[4:7], s17 offen offset:1024 sc1
    buffer_load_dwordx4 v[152:155], v14, s[4:7], s17 offen offset:2048 sc1
    buffer_load_dwordx4 v[156:159], v14, s[4:7], s17 offen offset:3072 sc1
    s_waitcnt vmcnt(8)
    v_mfma_f32_32x32x16_bf16 v[32:47], v[96:99], a[0:3], 0
    v_mfma_f32_32x32x16_bf16 v[48:63], v[112:115], a[0:3], 0
    v_mfma_f32_32x32x16_bf16 v[32:47], v[112:115], a[32:35], v[32:47]
    v_mfma_f32_32x32x16_bf16 v[48:63], v[96:99], a[64:67], v[48:63]
    v_mfma_f32_32x32x16_bf16 v[32:47], v[100:103], a[4:7], v[32:47]
    v_mfma_f32_32x32x16_bf16 v[48:63], v[116:119], a[4:7], v[48:63]
    v_mfma_f32_32x32x16_bf16 v[32:47], v[116:119], a[36:39], v[32:47]
    v_mfma_f32_32x32x16_bf16 v[48:63], v[100:103], a[68:71], v[48:63]
    v_mfma_f32_32x32x16_bf16 v[32:47], v[104:107], a[8:11], v[32:47]
    v_mfma_f32_32x32x16_bf16 v[48:63], v[120:123], a[8:11], v[48:63]
    v_mfma_f32_32x32x16_bf16 v[32:47], v[120:123], a[40:43], v[32:47]
    v_mfma_f32_32x32x16_bf16 v[48:63], v[104:107], a[72:75], v[48:63]
    v_mfma_f32_32x32x16_bf16 v[32:47], v[108:111], a[12:15], v[32:47]
    v_mfma_f32_32x32x16_bf16 v[48:63], v[124:127], a[12:15], v[48:63]
    v_mfma_f32_32x32x16_bf16 v[32:47], v[124:127], a[44:47], v[32:47]
    v_mfma_f32_32x32x16_bf16 v[48:63], v[108:111], a[76:79], v[48:63]
    v_mfma_f32_32x32x16_bf16 v[64:79], v[96:99], a[16:19], 0
    v_mfma_f32_32x32x16_bf16 v[80:95], v[112:115], a[16:19], 0
    v_mfma_f32_32x32x16_bf16 v[64:79], v[112:115], a[48:51], v[64:79]
    v_mfma_f32_32x32x16_bf16 v[80:95], v[96:99], a[80:83], v[80:95]
    v_mfma_f32_32x32x16_bf16 v[64:79], v[100:103], a[20:23], v[64:79]
    v_mfma_f32_32x32x16_bf16 v[80:95], v[116:119], a[20:23], v[80:95]
    v_mfma_f32_32x32x16_bf16 v[64:79], v[116:119], a[52:55], v[64:79]
    v_mfma_f32_32x32x16_bf16 v[80:95], v[100:103], a[84:87], v[80:95]
    v_mfma_f32_32x32x16_bf16 v[64:79], v[104:107], a[24:27], v[64:79]
    v_mfma_f32_32x32x16_bf16 v[80:95], v[120:123], a[24:27], v[80:95]
    v_mfma_f32_32x32x16_bf16 v[64:79], v[120:123], a[56:59], v[64:79]
    v_mfma_f32_32x32x16_bf16 v[80:95], v[104:107], a[88:91], v[80:95]
    v_mfma_f32_32x32x16_bf16 v[64:79], v[108:111], a[28:31], v[64:79]
    v_mfma_f32_32x32x16_bf16 v[80:95], v[124:127], a[28:31], v[80:95]
    v_mfma_f32_32x32x16_bf16 v[64:79], v[124:127], a[60:63], v[64:79]
    v_mfma_f32_32x32x16_bf16 v[80:95], v[108:111], a[92:95], v[80:95]
    v_mul_f32 v5, v32, v160
    v_mul_f32 v7, v48, v160
    v_fma_f32 v5, v48, v176, v5
    v_fma_f32 v7, -v32, v176, v7
    v_mul_f32 v6, v33, v161
    v_mul_f32 v8, v49, v161
    v_fma_f32 v6, v49, v177, v6
    v_fma_f32 v8, -v33, v177, v8
    v_cvt_pk_bf16_f32 v96, v5, v6
    v_cvt_pk_bf16_f32 v112, v7, v8
    v_mul_f32 v5, v34, v162
    v_mul_f32 v7, v50, v162
    v_fma_f32 v5, v50, v178, v5
    v_fma_f32 v7, -v34, v178, v7
    v_mul_f32 v6, v35, v163
    v_mul_f32 v8, v51, v163
    v_fma_f32 v6, v51, v179, v6
    v_fma_f32 v8, -v35, v179, v8
    v_cvt_pk_bf16_f32 v97, v5, v6
    v_cvt_pk_bf16_f32 v113, v7, v8
    v_mul_f32 v5, v36, v164
    v_mul_f32 v7, v52, v164
    v_fma_f32 v5, v52, v180, v5
    v_fma_f32 v7, -v36, v180, v7
    v_mul_f32 v6, v37, v165
    v_mul_f32 v8, v53, v165
    v_fma_f32 v6, v53, v181, v6
    v_fma_f32 v8, -v37, v181, v8
    v_cvt_pk_bf16_f32 v98, v5, v6
    v_cvt_pk_bf16_f32 v114, v7, v8
    v_mul_f32 v5, v38, v166
    v_mul_f32 v7, v54, v166
    v_fma_f32 v5, v54, v182, v5
    v_fma_f32 v7, -v38, v182, v7
    v_mul_f32 v6, v39, v167
    v_mul_f32 v8, v55, v167
    v_fma_f32 v6, v55, v183, v6
    v_fma_f32 v8, -v39, v183, v8
    v_cvt_pk_bf16_f32 v99, v5, v6
    v_cvt_pk_bf16_f32 v115, v7, v8
    v_mul_f32 v5, v40, v168
    v_mul_f32 v7, v56, v168
    v_fma_f32 v5, v56, v184, v5
    v_fma_f32 v7, -v40, v184, v7
    v_mul_f32 v6, v41, v169
    v_mul_f32 v8, v57, v169
    v_fma_f32 v6, v57, v185, v6
    v_fma_f32 v8, -v41, v185, v8
    v_cvt_pk_bf16_f32 v100, v5, v6
    v_cvt_pk_bf16_f32 v116, v7, v8
    v_mul_f32 v5, v42, v170
    v_mul_f32 v7, v58, v170
    v_fma_f32 v5, v58, v186, v5
    v_fma_f32 v7, -v42, v186, v7
    v_mul_f32 v6, v43, v171
    v_mul_f32 v8, v59, v171
    v_fma_f32 v6, v59, v187, v6
    v_fma_f32 v8, -v43, v187, v8
    v_cvt_pk_bf16_f32 v101, v5, v6
    v_cvt_pk_bf16_f32 v117, v7, v8
    v_mul_f32 v5, v44, v172
    v_mul_f32 v7, v60, v172
    v_fma_f32 v5, v60, v188, v5
    v_fma_f32 v7, -v44, v188, v7
    v_mul_f32 v6, v45, v173
    v_mul_f32 v8, v61, v173
    v_fma_f32 v6, v61, v189, v6
    v_fma_f32 v8, -v45, v189, v8
    v_cvt_pk_bf16_f32 v102, v5, v6
    v_cvt_pk_bf16_f32 v118, v7, v8
    v_mul_f32 v5, v46, v174
    v_mul_f32 v7, v62, v174
    v_fma_f32 v5, v62, v190, v5
    v_fma_f32 v7, -v46, v190, v7
    v_mul_f32 v6, v47, v175
    v_mul_f32 v8, v63, v175
    v_fma_f32 v6, v63, v191, v6
    v_fma_f32 v8, -v47, v191, v8
    v_cvt_pk_bf16_f32 v103, v5, v6
    v_cvt_pk_bf16_f32 v119, v7, v8
    v_mul_f32 v5, v64, v192
    v_mul_f32 v7, v80, v192
    v_fma_f32 v5, v80, v208, v5
    v_fma_f32 v7, -v64, v208, v7
    v_mul_f32 v6, v65, v193
    v_mul_f32 v8, v81, v193
    v_fma_f32 v6, v81, v209, v6
    v_fma_f32 v8, -v65, v209, v8
    v_cvt_pk_bf16_f32 v104, v5, v6
    v_cvt_pk_bf16_f32 v120, v7, v8
    v_mul_f32 v5, v66, v194
    v_mul_f32 v7, v82, v194
    v_fma_f32 v5, v82, v210, v5
    v_fma_f32 v7, -v66, v210, v7
    v_mul_f32 v6, v67, v195
    v_mul_f32 v8, v83, v195
    v_fma_f32 v6, v83, v211, v6
    v_fma_f32 v8, -v67, v211, v8
    v_cvt_pk_bf16_f32 v105, v5, v6
    v_cvt_pk_bf16_f32 v121, v7, v8
    v_mul_f32 v5, v68, v196
    v_mul_f32 v7, v84, v196
    v_fma_f32 v5, v84, v212, v5
    v_fma_f32 v7, -v68, v212, v7
    v_mul_f32 v6, v69, v197
    v_mul_f32 v8, v85, v197
    v_fma_f32 v6, v85, v213, v6
    v_fma_f32 v8, -v69, v213, v8
    v_cvt_pk_bf16_f32 v106, v5, v6
    v_cvt_pk_bf16_f32 v122, v7, v8
    v_mul_f32 v5, v70, v198
    v_mul_f32 v7, v86, v198
    v_fma_f32 v5, v86, v214, v5
    v_fma_f32 v7, -v70, v214, v7
    v_mul_f32 v6, v71, v199
    v_mul_f32 v8, v87, v199
    v_fma_f32 v6, v87, v215, v6
    v_fma_f32 v8, -v71, v215, v8
    v_cvt_pk_bf16_f32 v107, v5, v6
    v_cvt_pk_bf16_f32 v123, v7, v8
    v_mul_f32 v5, v72, v200
    v_mul_f32 v7, v88, v200
    v_fma_f32 v5, v88, v216, v5
    v_fma_f32 v7, -v72, v216, v7
    v_mul_f32 v6, v73, v201
    v_mul_f32 v8, v89, v201
    v_fma_f32 v6, v89, v217, v6
    v_fma_f32 v8, -v73, v217, v8
    v_cvt_pk_bf16_f32 v108, v5, v6
    v_cvt_pk_bf16_f32 v124, v7, v8
    v_mul_f32 v5, v74, v202
    v_mul_f32 v7, v90, v202
    v_fma_f32 v5, v90, v218, v5
    v_fma_f32 v7, -v74, v218, v7
    v_mul_f32 v6, v75, v203
    v_mul_f32 v8, v91, v203
    v_fma_f32 v6, v91, v219, v6
    v_fma_f32 v8, -v75, v219, v8
    v_cvt_pk_bf16_f32 v109, v5, v6
    v_cvt_pk_bf16_f32 v125, v7, v8
    v_mul_f32 v5, v76, v204
    v_mul_f32 v7, v92, v204
    v_fma_f32 v5, v92, v220, v5
    v_fma_f32 v7, -v76, v220, v7
    v_mul_f32 v6, v77, v205
    v_mul_f32 v8, v93, v205
    v_fma_f32 v6, v93, v221, v6
    v_fma_f32 v8, -v77, v221, v8
    v_cvt_pk_bf16_f32 v110, v5, v6
    v_cvt_pk_bf16_f32 v126, v7, v8
    v_mul_f32 v5, v78, v206
    v_mul_f32 v7, v94, v206
    v_fma_f32 v5, v94, v222, v5
    v_fma_f32 v7, -v78, v222, v7
    v_mul_f32 v6, v79, v207
    v_mul_f32 v8, v95, v207
    v_fma_f32 v6, v95, v223, v6
    v_fma_f32 v8, -v79, v223, v8
    v_cvt_pk_bf16_f32 v111, v5, v6
    v_cvt_pk_bf16_f32 v127, v7, v8
    v_mfma_f32_32x32x16_bf16 v[32:47], a[96:99], v[96:99], 0
    v_mfma_f32_32x32x16_bf16 v[48:63], a[96:99], v[112:115], 0
    v_mfma_f32_32x32x16_bf16 v[32:47], a[104:107], v[112:115], v[32:47]
    v_mfma_f32_32x32x16_bf16 v[48:63], a[112:115], v[96:99], v[48:63]
    v_mfma_f32_32x32x16_bf16 v[32:47], a[100:103], v[100:103], v[32:47]
    v_mfma_f32_32x32x16_bf16 v[48:63], a[100:103], v[116:119], v[48:63]
    v_mfma_f32_32x32x16_bf16 v[32:47], a[108:111], v[116:119], v[32:47]
    v_mfma_f32_32x32x16_bf16 v[48:63], a[116:119], v[100:103], v[48:63]
    v_mfma_f32_32x32x16_bf16 v[64:79], a[96:99], v[104:107], 0
    v_mfma_f32_32x32x16_bf16 v[80:95], a[96:99], v[120:123], 0
    v_mfma_f32_32x32x16_bf16 v[64:79], a[104:107], v[120:123], v[64:79]
    v_mfma_f32_32x32x16_bf16 v[80:95], a[112:115], v[104:107], v[80:95]
    v_mfma_f32_32x32x16_bf16 v[64:79], a[100:103], v[108:111], v[64:79]
    v_mfma_f32_32x32x16_bf16 v[80:95], a[100:103], v[124:127], v[80:95]
    v_mfma_f32_32x32x16_bf16 v[64:79], a[108:111], v[124:127], v[64:79]
    v_mfma_f32_32x32x16_bf16 v[80:95], a[116:119], v[108:111], v[80:95]
    s_waitcnt vmcnt(0)
    v_lshlrev_b32 v20, 16, v128
    v_and_b32 v22, s38, v128
    v_mul_f32 v5, v32, v20
    v_mul_f32 v7, v48, v20
    v_fma_f32 v5, -v48, v22, v5
    v_fma_f32 v7, v32, v22, v7
    v_lshlrev_b32 v21, 16, v129
    v_and_b32 v23, s38, v129
    v_mul_f32 v6, v33, v21
    v_mul_f32 v8, v49, v21
    v_fma_f32 v6, -v49, v23, v6
    v_fma_f32 v8, v33, v23, v8
    v_cvt_pk_bf16_f32 v96, v5, v6
    v_cvt_pk_bf16_f32 v112, v7, v8
    v_lshlrev_b32 v20, 16, v130
    v_and_b32 v22, s38, v130
    v_mul_f32 v5, v34, v20
    v_mul_f32 v7, v50, v20
    v_fma_f32 v5, -v50, v22, v5
    v_fma_f32 v7, v34, v22, v7
    v_lshlrev_b32 v21, 16, v131
    v_and_b32 v23, s38, v131
    v_mul_f32 v6, v35, v21
    v_mul_f32 v8, v51, v21
    v_fma_f32 v6, -v51, v23, v6
    v_fma_f32 v8, v35, v23, v8
    v_cvt_pk_bf16_f32 v97, v5, v6
    v_cvt_pk_bf16_f32 v113, v7, v8
    v_lshlrev_b32 v20, 16, v132
    v_and_b32 v22, s38, v132
    v_mul_f32 v5, v36, v20
    v_mul_f32 v7, v52, v20
    v_fma_f32 v5, -v52, v22, v5
    v_fma_f32 v7, v36, v22, v7
    v_lshlrev_b32 v21, 16, v133
    v_and_b32 v23, s38, v133
    v_mul_f32 v6, v37, v21
    v_mul_f32 v8, v53, v21
    v_fma_f32 v6, -v53, v23, v6
    v_fma_f32 v8, v37, v23, v8
    v_cvt_pk_bf16_f32 v98, v5, v6
    v_cvt_pk_bf16_f32 v114, v7, v8
    v_lshlrev_b32 v20, 16, v134
    v_and_b32 v22, s38, v134
    v_mul_f32 v5, v38, v20
    v_mul_f32 v7, v54, v20
    v_fma_f32 v5, -v54, v22, v5
    v_fma_f32 v7, v38, v22, v7
    v_lshlrev_b32 v21, 16, v135
    v_and_b32 v23, s38, v135
    v_mul_f32 v6, v39, v21
    v_mul_f32 v8, v55, v21
    v_fma_f32 v6, -v55, v23, v6
    v_fma_f32 v8, v39, v23, v8
    v_cvt_pk_bf16_f32 v99, v5, v6
    v_cvt_pk_bf16_f32 v115, v7, v8
    v_lshlrev_b32 v20, 16, v136
    v_and_b32 v22, s38, v136
    v_mul_f32 v5, v40, v20
    v_mul_f32 v7, v56, v20
    v_fma_f32 v5, -v56, v22, v5
    v_fma_f32 v7, v40, v22, v7
    v_lshlrev_b32 v21, 16, v137
    v_and_b32 v23, s38, v137
    v_mul_f32 v6, v41, v21
    v_mul_f32 v8, v57, v21
    v_fma_f32 v6, -v57, v23, v6
    v_fma_f32 v8, v41, v23, v8
    v_cvt_pk_bf16_f32 v100, v5, v6
    v_cvt_pk_bf16_f32 v116, v7, v8
    v_lshlrev_b32 v20, 16, v138
    v_and_b32 v22, s38, v138
    v_mul_f32 v5, v42, v20
    v_mul_f32 v7, v58, v20
    v_fma_f32 v5, -v58, v22, v5
    v_fma_f32 v7, v42, v22, v7
    v_lshlrev_b32 v21, 16, v139
    v_and_b32 v23, s38, v139
    v_mul_f32 v6, v43, v21
    v_mul_f32 v8, v59, v21
    v_fma_f32 v6, -v59, v23, v6
    v_fma_f32 v8, v43, v23, v8
    v_cvt_pk_bf16_f32 v101, v5, v6
    v_cvt_pk_bf16_f32 v117, v7, v8
    v_lshlrev_b32 v20, 16, v140
    v_and_b32 v22, s38, v140
    v_mul_f32 v5, v44, v20
    v_mul_f32 v7, v60, v20
    v_fma_f32 v5, -v60, v22, v5
    v_fma_f32 v7, v44, v22, v7
    v_lshlrev_b32 v21, 16, v141
    v_and_b32 v23, s38, v141
    v_mul_f32 v6, v45, v21
    v_mul_f32 v8, v61, v21
    v_fma_f32 v6, -v61, v23, v6
    v_fma_f32 v8, v45, v23, v8
    v_cvt_pk_bf16_f32 v102, v5, v6
    v_cvt_pk_bf16_f32 v118, v7, v8
    v_lshlrev_b32 v20, 16, v142
    v_and_b32 v22, s38, v142
    v_mul_f32 v5, v46, v20
    v_mul_f32 v7, v62, v20
    v_fma_f32 v5, -v62, v22, v5
    v_fma_f32 v7, v46, v22, v7
    v_lshlrev_b32 v21, 16, v143
    v_and_b32 v23, s38, v143
    v_mul_f32 v6, v47, v21
    v_mul_f32 v8, v63, v21
    v_fma_f32 v6, -v63, v23, v6
    v_fma_f32 v8, v47, v23, v8
    v_cvt_pk_bf16_f32 v103, v5, v6
    v_cvt_pk_bf16_f32 v119, v7, v8
    v_lshlrev_b32 v20, 16, v144
    v_and_b32 v22, s38, v144
    v_mul_f32 v5, v64, v20
    v_mul_f32 v7, v80, v20
    v_fma_f32 v5, -v80, v22, v5
    v_fma_f32 v7, v64, v22, v7
    v_lshlrev_b32 v21, 16, v145
    v_and_b32 v23, s38, v145
    v_mul_f32 v6, v65, v21
    v_mul_f32 v8, v81, v21
    v_fma_f32 v6, -v81, v23, v6
    v_fma_f32 v8, v65, v23, v8
    v_cvt_pk_bf16_f32 v104, v5, v6
    v_cvt_pk_bf16_f32 v120, v7, v8
    v_lshlrev_b32 v20, 16, v146
    v_and_b32 v22, s38, v146
    v_mul_f32 v5, v66, v20
    v_mul_f32 v7, v82, v20
    v_fma_f32 v5, -v82, v22, v5
    v_fma_f32 v7, v66, v22, v7
    v_lshlrev_b32 v21, 16, v147
    v_and_b32 v23, s38, v147
    v_mul_f32 v6, v67, v21
    v_mul_f32 v8, v83, v21
    v_fma_f32 v6, -v83, v23, v6
    v_fma_f32 v8, v67, v23, v8
    v_cvt_pk_bf16_f32 v105, v5, v6
    v_cvt_pk_bf16_f32 v121, v7, v8
    v_lshlrev_b32 v20, 16, v148
    v_and_b32 v22, s38, v148
    v_mul_f32 v5, v68, v20
    v_mul_f32 v7, v84, v20
    v_fma_f32 v5, -v84, v22, v5
    v_fma_f32 v7, v68, v22, v7
    v_lshlrev_b32 v21, 16, v149
    v_and_b32 v23, s38, v149
    v_mul_f32 v6, v69, v21
    v_mul_f32 v8, v85, v21
    v_fma_f32 v6, -v85, v23, v6
    v_fma_f32 v8, v69, v23, v8
    v_cvt_pk_bf16_f32 v106, v5, v6
    v_cvt_pk_bf16_f32 v122, v7, v8
    v_lshlrev_b32 v20, 16, v150
    v_and_b32 v22, s38, v150
    v_mul_f32 v5, v70, v20
    v_mul_f32 v7, v86, v20
    v_fma_f32 v5, -v86, v22, v5
    v_fma_f32 v7, v70, v22, v7
    v_lshlrev_b32 v21, 16, v151
    v_and_b32 v23, s38, v151
    v_mul_f32 v6, v71, v21
    v_mul_f32 v8, v87, v21
    v_fma_f32 v6, -v87, v23, v6
    v_fma_f32 v8, v71, v23, v8
    v_cvt_pk_bf16_f32 v107, v5, v6
    v_cvt_pk_bf16_f32 v123, v7, v8
    v_lshlrev_b32 v20, 16, v152
    v_and_b32 v22, s38, v152
    v_mul_f32 v5, v72, v20
    v_mul_f32 v7, v88, v20
    v_fma_f32 v5, -v88, v22, v5
    v_fma_f32 v7, v72, v22, v7
    v_lshlrev_b32 v21, 16, v153
    v_and_b32 v23, s38, v153
    v_mul_f32 v6, v73, v21
    v_mul_f32 v8, v89, v21
    v_fma_f32 v6, -v89, v23, v6
    v_fma_f32 v8, v73, v23, v8
    v_cvt_pk_bf16_f32 v108, v5, v6
    v_cvt_pk_bf16_f32 v124, v7, v8
    v_lshlrev_b32 v20, 16, v154
    v_and_b32 v22, s38, v154
    v_mul_f32 v5, v74, v20
    v_mul_f32 v7, v90, v20
    v_fma_f32 v5, -v90, v22, v5
    v_fma_f32 v7, v74, v22, v7
    v_lshlrev_b32 v21, 16, v155
    v_and_b32 v23, s38, v155
    v_mul_f32 v6, v75, v21
    v_mul_f32 v8, v91, v21
    v_fma_f32 v6, -v91, v23, v6
    v_fma_f32 v8, v75, v23, v8
    v_cvt_pk_bf16_f32 v109, v5, v6
    v_cvt_pk_bf16_f32 v125, v7, v8
    v_lshlrev_b32 v20, 16, v156
    v_and_b32 v22, s38, v156
    v_mul_f32 v5, v76, v20
    v_mul_f32 v7, v92, v20
    v_fma_f32 v5, -v92, v22, v5
    v_fma_f32 v7, v76, v22, v7
    v_lshlrev_b32 v21, 16, v157
    v_and_b32 v23, s38, v157
    v_mul_f32 v6, v77, v21
    v_mul_f32 v8, v93, v21
    v_fma_f32 v6, -v93, v23, v6
    v_fma_f32 v8, v77, v23, v8
    v_cvt_pk_bf16_f32 v110, v5, v6
    v_cvt_pk_bf16_f32 v126, v7, v8
    v_lshlrev_b32 v20, 16, v158
    v_and_b32 v22, s38, v158
    v_mul_f32 v5, v78, v20
    v_mul_f32 v7, v94, v20
    v_fma_f32 v5, -v94, v22, v5
    v_fma_f32 v7, v78, v22, v7
    v_lshlrev_b32 v21, 16, v159
    v_and_b32 v23, s38, v159
    v_mul_f32 v6, v79, v21
    v_mul_f32 v8, v95, v21
    v_fma_f32 v6, -v95, v23, v6
    v_fma_f32 v8, v79, v23, v8
    v_cvt_pk_bf16_f32 v111, v5, v6
    v_cvt_pk_bf16_f32 v127, v7, v8
    v_mfma_f32_32x32x16_bf16 v[32:47], v[96:99], a[96:99], 0
    v_mfma_f32_32x32x16_bf16 v[48:63], v[112:115], a[96:99], 0
    v_mfma_f32_32x32x16_bf16 v[32:47], v[112:115], a[112:115], v[32:47]
    v_mfma_f32_32x32x16_bf16 v[48:63], v[96:99], a[104:107], v[48:63]
    v_mfma_f32_32x32x16_bf16 v[32:47], v[100:103], a[100:103], v[32:47]
    v_mfma_f32_32x32x16_bf16 v[48:63], v[116:119], a[100:103], v[48:63]
    v_mfma_f32_32x32x16_bf16 v[32:47], v[116:119], a[116:119], v[32:47]
    v_mfma_f32_32x32x16_bf16 v[48:63], v[100:103], a[108:111], v[48:63]
    v_mfma_f32_32x32x16_bf16 v[64:79], v[104:107], a[96:99], 0
    v_mfma_f32_32x32x16_bf16 v[80:95], v[120:123], a[96:99], 0
    v_mfma_f32_32x32x16_bf16 v[64:79], v[120:123], a[112:115], v[64:79]
    v_mfma_f32_32x32x16_bf16 v[80:95], v[104:107], a[104:107], v[80:95]
    v_mfma_f32_32x32x16_bf16 v[64:79], v[108:111], a[100:103], v[64:79]
    v_mfma_f32_32x32x16_bf16 v[80:95], v[124:127], a[100:103], v[80:95]
    v_mfma_f32_32x32x16_bf16 v[64:79], v[124:127], a[116:119], v[64:79]
    v_mfma_f32_32x32x16_bf16 v[80:95], v[108:111], a[108:111], v[80:95]
    v_mul_f32 v5, v32, v160
    v_mul_f32 v7, v48, v160
    v_fma_f32 v5, -v48, v176, v5
    v_fma_f32 v7, v32, v176, v7
    v_mul_f32 v6, v33, v161
    v_mul_f32 v8, v49, v161
    v_fma_f32 v6, -v49, v177, v6
    v_fma_f32 v8, v33, v177, v8
    v_cvt_pk_bf16_f32 v96, v5, v6
    v_cvt_pk_bf16_f32 v112, v7, v8
    v_mul_f32 v5, v34, v162
    v_mul_f32 v7, v50, v162
    v_fma_f32 v5, -v50, v178, v5
    v_fma_f32 v7, v34, v178, v7
    v_mul_f32 v6, v35, v163
    v_mul_f32 v8, v51, v163
    v_fma_f32 v6, -v51, v179, v6
    v_fma_f32 v8, v35, v179, v8
    v_cvt_pk_bf16_f32 v97, v5, v6
    v_cvt_pk_bf16_f32 v113, v7, v8
    v_mul_f32 v5, v36, v164
    v_mul_f32 v7, v52, v164
    v_fma_f32 v5, -v52, v180, v5
    v_fma_f32 v7, v36, v180, v7
    v_mul_f32 v6, v37, v165
    v_mul_f32 v8, v53, v165
    v_fma_f32 v6, -v53, v181, v6
    v_fma_f32 v8, v37, v181, v8
    v_cvt_pk_bf16_f32 v98, v5, v6
    v_cvt_pk_bf16_f32 v114, v7, v8
    v_mul_f32 v5, v38, v166
    v_mul_f32 v7, v54, v166
    v_fma_f32 v5, -v54, v182, v5
    v_fma_f32 v7, v38, v182, v7
    v_mul_f32 v6, v39, v167
    v_mul_f32 v8, v55, v167
    v_fma_f32 v6, -v55, v183, v6
    v_fma_f32 v8, v39, v183, v8
    v_cvt_pk_bf16_f32 v99, v5, v6
    v_cvt_pk_bf16_f32 v115, v7, v8
    v_mul_f32 v5, v40, v168
    v_mul_f32 v7, v56, v168
    v_fma_f32 v5, -v56, v184, v5
    v_fma_f32 v7, v40, v184, v7
    v_mul_f32 v6, v41, v169
    v_mul_f32 v8, v57, v169
    v_fma_f32 v6, -v57, v185, v6
    v_fma_f32 v8, v41, v185, v8
    v_cvt_pk_bf16_f32 v100, v5, v6
    v_cvt_pk_bf16_f32 v116, v7, v8
    v_mul_f32 v5, v42, v170
    v_mul_f32 v7, v58, v170
    v_fma_f32 v5, -v58, v186, v5
    v_fma_f32 v7, v42, v186, v7
    v_mul_f32 v6, v43, v171
    v_mul_f32 v8, v59, v171
    v_fma_f32 v6, -v59, v187, v6
    v_fma_f32 v8, v43, v187, v8
    v_cvt_pk_bf16_f32 v101, v5, v6
    v_cvt_pk_bf16_f32 v117, v7, v8
    v_mul_f32 v5, v44, v172
    v_mul_f32 v7, v60, v172
    v_fma_f32 v5, -v60, v188, v5
    v_fma_f32 v7, v44, v188, v7
    v_mul_f32 v6, v45, v173
    v_mul_f32 v8, v61, v173
    v_fma_f32 v6, -v61, v189, v6
    v_fma_f32 v8, v45, v189, v8
    v_cvt_pk_bf16_f32 v102, v5, v6
    v_cvt_pk_bf16_f32 v118, v7, v8
    v_mul_f32 v5, v46, v174
    v_mul_f32 v7, v62, v174
    v_fma_f32 v5, -v62, v190, v5
    v_fma_f32 v7, v46, v190, v7
    v_mul_f32 v6, v47, v175
    v_mul_f32 v8, v63, v175
    v_fma_f32 v6, -v63, v191, v6
    v_fma_f32 v8, v47, v191, v8
    v_cvt_pk_bf16_f32 v103, v5, v6
    v_cvt_pk_bf16_f32 v119, v7, v8
    v_mul_f32 v5, v64, v224
    v_mul_f32 v7, v80, v224
    v_fma_f32 v5, -v80, v240, v5
    v_fma_f32 v7, v64, v240, v7
    v_mul_f32 v6, v65, v225
    v_mul_f32 v8, v81, v225
    v_fma_f32 v6, -v81, v241, v6
    v_fma_f32 v8, v65, v241, v8
    v_cvt_pk_bf16_f32 v104, v5, v6
    v_cvt_pk_bf16_f32 v120, v7, v8
    v_mul_f32 v5, v66, v226
    v_mul_f32 v7, v82, v226
    v_fma_f32 v5, -v82, v242, v5
    v_fma_f32 v7, v66, v242, v7
    v_mul_f32 v6, v67, v227
    v_mul_f32 v8, v83, v227
    v_fma_f32 v6, -v83, v243, v6
    v_fma_f32 v8, v67, v243, v8
    v_cvt_pk_bf16_f32 v105, v5, v6
    v_cvt_pk_bf16_f32 v121, v7, v8
    v_mul_f32 v5, v68, v228
    v_mul_f32 v7, v84, v228
    v_fma_f32 v5, -v84, v244, v5
    v_fma_f32 v7, v68, v244, v7
    v_mul_f32 v6, v69, v229
    v_mul_f32 v8, v85, v229
    v_fma_f32 v6, -v85, v245, v6
    v_fma_f32 v8, v69, v245, v8
    v_cvt_pk_bf16_f32 v106, v5, v6
    v_cvt_pk_bf16_f32 v122, v7, v8
    v_mul_f32 v5, v70, v230
    v_mul_f32 v7, v86, v230
    v_fma_f32 v5, -v86, v246, v5
    v_fma_f32 v7, v70, v246, v7
    v_mul_f32 v6, v71, v231
    v_mul_f32 v8, v87, v231
    v_fma_f32 v6, -v87, v247, v6
    v_fma_f32 v8, v71, v247, v8
    v_cvt_pk_bf16_f32 v107, v5, v6
    v_cvt_pk_bf16_f32 v123, v7, v8
    v_mul_f32 v5, v72, v232
    v_mul_f32 v7, v88, v232
    v_fma_f32 v5, -v88, v248, v5
    v_fma_f32 v7, v72, v248, v7
    v_mul_f32 v6, v73, v233
    v_mul_f32 v8, v89, v233
    v_fma_f32 v6, -v89, v249, v6
    v_fma_f32 v8, v73, v249, v8
    v_cvt_pk_bf16_f32 v108, v5, v6
    v_cvt_pk_bf16_f32 v124, v7, v8
    v_mul_f32 v5, v74, v234
    v_mul_f32 v7, v90, v234
    v_fma_f32 v5, -v90, v250, v5
    v_fma_f32 v7, v74, v250, v7
    v_mul_f32 v6, v75, v235
    v_mul_f32 v8, v91, v235
    v_fma_f32 v6, -v91, v251, v6
    v_fma_f32 v8, v75, v251, v8
    v_cvt_pk_bf16_f32 v109, v5, v6
    v_cvt_pk_bf16_f32 v125, v7, v8
    v_mul_f32 v5, v76, v236
    v_mul_f32 v7, v92, v236
    v_fma_f32 v5, -v92, v252, v5
    v_fma_f32 v7, v76, v252, v7
    v_mul_f32 v6, v77, v237
    v_mul_f32 v8, v93, v237
    v_fma_f32 v6, -v93, v253, v6
    v_fma_f32 v8, v77, v253, v8
    v_cvt_pk_bf16_f32 v110, v5, v6
    v_cvt_pk_bf16_f32 v126, v7, v8
    v_mul_f32 v5, v78, v238
    v_mul_f32 v7, v94, v238
    v_fma_f32 v5, -v94, v254, v5
    v_fma_f32 v7, v78, v254, v7
    v_mul_f32 v6, v79, v239
    v_mul_f32 v8, v95, v239
    v_fma_f32 v6, -v95, v255, v6
    v_fma_f32 v8, v79, v255, v8
    v_cvt_pk_bf16_f32 v111, v5, v6
    v_cvt_pk_bf16_f32 v127, v7, v8
    v_mfma_f32_32x32x16_bf16 v[32:47], a[0:3], v[96:99], 0
    v_mfma_f32_32x32x16_bf16 v[48:63], a[0:3], v[112:115], 0
    v_mfma_f32_32x32x16_bf16 v[32:47], a[64:67], v[112:115], v[32:47]
    v_mfma_f32_32x32x16_bf16 v[48:63], a[32:35], v[96:99], v[48:63]
    v_mfma_f32_32x32x16_bf16 v[32:47], a[4:7], v[100:103], v[32:47]
    v_mfma_f32_32x32x16_bf16 v[48:63], a[4:7], v[116:119], v[48:63]
    v_mfma_f32_32x32x16_bf16 v[32:47], a[68:71], v[116:119], v[32:47]
    v_mfma_f32_32x32x16_bf16 v[48:63], a[36:39], v[100:103], v[48:63]
    v_mfma_f32_32x32x16_bf16 v[32:47], a[8:11], v[104:107], v[32:47]
    v_mfma_f32_32x32x16_bf16 v[48:63], a[8:11], v[120:123], v[48:63]
    v_mfma_f32_32x32x16_bf16 v[32:47], a[72:75], v[120:123], v[32:47]
    v_mfma_f32_32x32x16_bf16 v[48:63], a[40:43], v[104:107], v[48:63]
    v_mfma_f32_32x32x16_bf16 v[32:47], a[12:15], v[108:111], v[32:47]
    v_mfma_f32_32x32x16_bf16 v[48:63], a[12:15], v[124:127], v[48:63]
    v_mfma_f32_32x32x16_bf16 v[32:47], a[76:79], v[124:127], v[32:47]
    v_mfma_f32_32x32x16_bf16 v[48:63], a[44:47], v[108:111], v[48:63]
    v_mfma_f32_32x32x16_bf16 v[64:79], a[16:19], v[96:99], 0
    v_mfma_f32_32x32x16_bf16 v[80:95], a[16:19], v[112:115], 0
    v_mfma_f32_32x32x16_bf16 v[64:79], a[80:83], v[112:115], v[64:79]
    v_mfma_f32_32x32x16_bf16 v[80:95], a[48:51], v[96:99], v[80:95]
    v_mfma_f32_32x32x16_bf16 v[64:79], a[20:23], v[100:103], v[64:79]
    v_mfma_f32_32x32x16_bf16 v[80:95], a[20:23], v[116:119], v[80:95]
    v_mfma_f32_32x32x16_bf16 v[64:79], a[84:87], v[116:119], v[64:79]
    v_mfma_f32_32x32x16_bf16 v[80:95], a[52:55], v[100:103], v[80:95]
    v_mfma_f32_32x32x16_bf16 v[64:79], a[24:27], v[104:107], v[64:79]
    v_mfma_f32_32x32x16_bf16 v[80:95], a[24:27], v[120:123], v[80:95]
    v_mfma_f32_32x32x16_bf16 v[64:79], a[88:91], v[120:123], v[64:79]
    v_mfma_f32_32x32x16_bf16 v[80:95], a[56:59], v[104:107], v[80:95]
    v_mfma_f32_32x32x16_bf16 v[64:79], a[28:31], v[108:111], v[64:79]
    v_mfma_f32_32x32x16_bf16 v[80:95], a[28:31], v[124:127], v[80:95]
    v_mfma_f32_32x32x16_bf16 v[64:79], a[92:95], v[124:127], v[64:79]
    v_mfma_f32_32x32x16_bf16 v[80:95], a[60:63], v[108:111], v[80:95]
    v_mul_f32 v32, s35, v32
    v_mul_f32 v48, s35, v48
    v_cvt_pk_bf16_f32 v128, v32, v48
    v_mul_f32 v33, s35, v33
    v_mul_f32 v49, s35, v49
    v_cvt_pk_bf16_f32 v129, v33, v49
    v_mul_f32 v34, s35, v34
    v_mul_f32 v50, s35, v50
    v_cvt_pk_bf16_f32 v130, v34, v50
    v_mul_f32 v35, s35, v35
    v_mul_f32 v51, s35, v51
    v_cvt_pk_bf16_f32 v131, v35, v51
    v_mul_f32 v36, s35, v36
    v_mul_f32 v52, s35, v52
    v_cvt_pk_bf16_f32 v132, v36, v52
    v_mul_f32 v37, s35, v37
    v_mul_f32 v53, s35, v53
    v_cvt_pk_bf16_f32 v133, v37, v53
    v_mul_f32 v38, s35, v38
    v_mul_f32 v54, s35, v54
    v_cvt_pk_bf16_f32 v134, v38, v54
    v_mul_f32 v39, s35, v39
    v_mul_f32 v55, s35, v55
    v_cvt_pk_bf16_f32 v135, v39, v55
    v_mul_f32 v40, s35, v40
    v_mul_f32 v56, s35, v56
    v_cvt_pk_bf16_f32 v136, v40, v56
    v_mul_f32 v41, s35, v41
    v_mul_f32 v57, s35, v57
    v_cvt_pk_bf16_f32 v137, v41, v57
    v_mul_f32 v42, s35, v42
    v_mul_f32 v58, s35, v58
    v_cvt_pk_bf16_f32 v138, v42, v58
    v_mul_f32 v43, s35, v43
    v_mul_f32 v59, s35, v59
    v_cvt_pk_bf16_f32 v139, v43, v59
    v_mul_f32 v44, s35, v44
    v_mul_f32 v60, s35, v60
    v_cvt_pk_bf16_f32 v140, v44, v60
    v_mul_f32 v45, s35, v45
    v_mul_f32 v61, s35, v61
    v_cvt_pk_bf16_f32 v141, v45, v61
    v_mul_f32 v46, s35, v46
    v_mul_f32 v62, s35, v62
    v_cvt_pk_bf16_f32 v142, v46, v62
    v_mul_f32 v47, s35, v47
    v_mul_f32 v63, s35, v63
    v_cvt_pk_bf16_f32 v143, v47, v63
    v_mul_f32 v64, s35, v64
    v_mul_f32 v80, s35, v80
    v_cvt_pk_bf16_f32 v144, v64, v80
    v_mul_f32 v65, s35, v65
    v_mul_f32 v81, s35, v81
    v_cvt_pk_bf16_f32 v145, v65, v81
    v_mul_f32 v66, s35, v66
    v_mul_f32 v82, s35, v82
    v_cvt_pk_bf16_f32 v146, v66, v82
    v_mul_f32 v67, s35, v67
    v_mul_f32 v83, s35, v83
    v_cvt_pk_bf16_f32 v147, v67, v83
    v_mul_f32 v68, s35, v68
    v_mul_f32 v84, s35, v84
    v_cvt_pk_bf16_f32 v148, v68, v84
    v_mul_f32 v69, s35, v69
    v_mul_f32 v85, s35, v85
    v_cvt_pk_bf16_f32 v149, v69, v85
    v_mul_f32 v70, s35, v70
    v_mul_f32 v86, s35, v86
    v_cvt_pk_bf16_f32 v150, v70, v86
    v_mul_f32 v71, s35, v71
    v_mul_f32 v87, s35, v87
    v_cvt_pk_bf16_f32 v151, v71, v87
    v_mul_f32 v72, s35, v72
    v_mul_f32 v88, s35, v88
    v_cvt_pk_bf16_f32 v152, v72, v88
    v_mul_f32 v73, s35, v73
    v_mul_f32 v89, s35, v89
    v_cvt_pk_bf16_f32 v153, v73, v89
    v_mul_f32 v74, s35, v74
    v_mul_f32 v90, s35, v90
    v_cvt_pk_bf16_f32 v154, v74, v90
    v_mul_f32 v75, s35, v75
    v_mul_f32 v91, s35, v91
    v_cvt_pk_bf16_f32 v155, v75, v91
    v_mul_f32 v76, s35, v76
    v_mul_f32 v92, s35, v92
    v_cvt_pk_bf16_f32 v156, v76, v92
    v_mul_f32 v77, s35, v77
    v_mul_f32 v93, s35, v93
    v_cvt_pk_bf16_f32 v157, v77, v93
    v_mul_f32 v78, s35, v78
    v_mul_f32 v94, s35, v94
    v_cvt_pk_bf16_f32 v158, v78, v94
    v_mul_f32 v79, s35, v79
    v_mul_f32 v95, s35, v95
    v_cvt_pk_bf16_f32 v159, v79, v95
    s_cmp_eq_u32 s36, 1
    s_cbranch_scc1 F2_o1
    s_cmp_eq_u32 s36, 2
    s_cbranch_scc1 F2_o2
    s_cmp_eq_u32 s36, 3
    s_cbranch_scc1 F2_o3
    s_cmp_eq_u32 s36, 4
    s_cbranch_scc1 F2_o4
    v_accvgpr_write_b32 a120, v128
    v_accvgpr_write_b32 a124, v129
    v_accvgpr_write_b32 a128, v130
    v_accvgpr_write_b32 a132, v131
    v_accvgpr_write_b32 a136, v132
    v_accvgpr_write_b32 a140, v133
    v_accvgpr_write_b32 a144, v134
    v_accvgpr_write_b32 a148, v135
    v_accvgpr_write_b32 a152, v136
    v_accvgpr_write_b32 a156, v137
    v_accvgpr_write_b32 a160, v138
    v_accvgpr_write_b32 a164, v139
    v_accvgpr_write_b32 a168, v140
    v_accvgpr_write_b32 a172, v141
    v_accvgpr_write_b32 a176, v142
    v_accvgpr_write_b32 a180, v143
    v_accvgpr_write_b32 a184, v144
    v_accvgpr_write_b32 a188, v145
    v_accvgpr_write_b32 a192, v146
    v_accvgpr_write_b32 a196, v147
    v_accvgpr_write_b32 a200, v148
    v_accvgpr_write_b32 a204, v149
    v_accvgpr_write_b32 a208, v150
    v_accvgpr_write_b32 a212, v151
    v_accvgpr_write_b32 a216, v152
    v_accvgpr_write_b32 a220, v153
    v_accvgpr_write_b32 a224, v154
    v_accvgpr_write_b32 a228, v155
    v_accvgpr_write_b32 a232, v156
    v_accvgpr_write_b32 a236, v157
    v_accvgpr_write_b32 a240, v158
    v_accvgpr_write_b32 a244, v159
    s_branch F2_nx
F2_o1:
    v_accvgpr_write_b32 a121, v128
    v_accvgpr_write_b32 a125, v129
    v_accvgpr_write_b32 a129, v130
    v_accvgpr_write_b32 a133, v131
    v_accvgpr_write_b32 a137, v132
    v_accvgpr_write_b32 a141, v133
    v_accvgpr_write_b32 a145, v134
    v_accvgpr_write_b32 a149, v135
    v_accvgpr_write_b32 a153, v136
    v_accvgpr_write_b32 a157, v137
    v_accvgpr_write_b32 a161, v138
    v_accvgpr_write_b32 a165, v139
    v_accvgpr_write_b32 a169, v140
    v_accvgpr_write_b32 a173, v141
    v_accvgpr_write_b32 a177, v142
    v_accvgpr_write_b32 a181, v143
    v_accvgpr_write_b32 a185, v144
    v_accvgpr_write_b32 a189, v145
    v_accvgpr_write_b32 a193, v146
    v_accvgpr_write_b32 a197, v147
    v_accvgpr_write_b32 a201, v148
    v_accvgpr_write_b32 a205, v149
    v_accvgpr_write_b32 a209, v150
    v_accvgpr_write_b32 a213, v151
    v_accvgpr_write_b32 a217, v152
    v_accvgpr_write_b32 a221, v153
    v_accvgpr_write_b32 a225, v154
    v_accvgpr_write_b32 a229, v155
    v_accvgpr_write_b32 a233, v156
    v_accvgpr_write_b32 a237, v157
    v_accvgpr_write_b32 a241, v158
    v_accvgpr_write_b32 a245, v159
    s_branch F2_nx
F2_o2:
    v_accvgpr_write_b32 a122, v128
    v_accvgpr_write_b32 a126, v129
    v_accvgpr_write_b32 a130, v130
    v_accvgpr_write_b32 a134, v131
    v_accvgpr_write_b32 a138, v132
    v_accvgpr_write_b32 a142, v133
    v_accvgpr_write_b32 a146, v134
    v_accvgpr_write_b32 a150, v135
    v_accvgpr_write_b32 a154, v136
    v_accvgpr_write_b32 a158, v137
    v_accvgpr_write_b32 a162, v138
    v_accvgpr_write_b32 a166, v139
    v_accvgpr_write_b32 a170, v140
    v_accvgpr_write_b32 a174, v141
    v_accvgpr_write_b32 a178, v142
    v_accvgpr_write_b32 a182, v143
    v_accvgpr_write_b32 a186, v144
    v_accvgpr_write_b32 a190, v145
    v_accvgpr_write_b32 a194, v146
    v_accvgpr_write_b32 a198, v147
    v_accvgpr_write_b32 a202, v148
    v_accvgpr_write_b32 a206, v149
    v_accvgpr_write_b32 a210, v150
    v_accvgpr_write_b32 a214, v151
    v_accvgpr_write_b32 a218, v152
    v_accvgpr_write_b32 a222, v153
    v_accvgpr_write_b32 a226, v154
    v_accvgpr_write_b32 a230, v155
    v_accvgpr_write_b32 a234, v156
    v_accvgpr_write_b32 a238, v157
    v_accvgpr_write_b32 a242, v158
    v_accvgpr_write_b32 a246, v159
    s_branch F2_nx
F2_o3:
    v_accvgpr_write_b32 a123, v128
    v_accvgpr_write_b32 a127, v129
    v_accvgpr_write_b32 a131, v130
    v_accvgpr_write_b32 a135, v131
    v_accvgpr_write_b32 a139, v132
    v_accvgpr_write_b32 a143, v133
    v_accvgpr_write_b32 a147, v134
    v_accvgpr_write_b32 a151, v135
    v_accvgpr_write_b32 a155, v136
    v_accvgpr_write_b32 a159, v137
    v_accvgpr_write_b32 a163, v138
    v_accvgpr_write_b32 a167, v139
    v_accvgpr_write_b32 a171, v140
    v_accvgpr_write_b32 a175, v141
    v_accvgpr_write_b32 a179, v142
    v_accvgpr_write_b32 a183, v143
    v_accvgpr_write_b32 a187, v144
    v_accvgpr_write_b32 a191, v145
    v_accvgpr_write_b32 a195, v146
    v_accvgpr_write_b32 a199, v147
    v_accvgpr_write_b32 a203, v148
    v_accvgpr_write_b32 a207, v149
    v_accvgpr_write_b32 a211, v150
    v_accvgpr_write_b32 a215, v151
    v_accvgpr_write_b32 a219, v152
    v_accvgpr_write_b32 a223, v153
    v_accvgpr_write_b32 a227, v154
    v_accvgpr_write_b32 a231, v155
    v_accvgpr_write_b32 a235, v156
    v_accvgpr_write_b32 a239, v157
    v_accvgpr_write_b32 a243, v158
    v_accvgpr_write_b32 a247, v159
    s_branch F2_nx
F2_o4:
    v_accvgpr_read_b32 v5, a120
    v_lshlrev_b32 v6, 16, v128
    v_bfi_b32 v5, s38, v6, v5
    v_accvgpr_write_b32 a120, v5
    v_accvgpr_read_b32 v5, a124
    v_lshlrev_b32 v6, 16, v129
    v_bfi_b32 v5, s38, v6, v5
    v_accvgpr_write_b32 a124, v5
    v_accvgpr_read_b32 v5, a128
    v_lshlrev_b32 v6, 16, v130
    v_bfi_b32 v5, s38, v6, v5
    v_accvgpr_write_b32 a128, v5
    v_accvgpr_read_b32 v5, a132
    v_lshlrev_b32 v6, 16, v131
    v_bfi_b32 v5, s38, v6, v5
    v_accvgpr_write_b32 a132, v5
    v_accvgpr_read_b32 v5, a136
    v_lshlrev_b32 v6, 16, v132
    v_bfi_b32 v5, s38, v6, v5
    v_accvgpr_write_b32 a136, v5
    v_accvgpr_read_b32 v5, a140
    v_lshlrev_b32 v6, 16, v133
    v_bfi_b32 v5, s38, v6, v5
    v_accvgpr_write_b32 a140, v5
    v_accvgpr_read_b32 v5, a144
    v_lshlrev_b32 v6, 16, v134
    v_bfi_b32 v5, s38, v6, v5
    v_accvgpr_write_b32 a144, v5
    v_accvgpr_read_b32 v5, a148
    v_lshlrev_b32 v6, 16, v135
    v_bfi_b32 v5, s38, v6, v5
    v_accvgpr_write_b32 a148, v5
    v_accvgpr_read_b32 v5, a152
    v_lshlrev_b32 v6, 16, v136
    v_bfi_b32 v5, s38, v6, v5
    v_accvgpr_write_b32 a152, v5
    v_accvgpr_read_b32 v5, a156
    v_lshlrev_b32 v6, 16, v137
    v_bfi_b32 v5, s38, v6, v5
    v_accvgpr_write_b32 a156, v5
    v_accvgpr_read_b32 v5, a160
    v_lshlrev_b32 v6, 16, v138
    v_bfi_b32 v5, s38, v6, v5
    v_accvgpr_write_b32 a160, v5
    v_accvgpr_read_b32 v5, a164
    v_lshlrev_b32 v6, 16, v139
    v_bfi_b32 v5, s38, v6, v5
    v_accvgpr_write_b32 a164, v5
    v_accvgpr_read_b32 v5, a168
    v_lshlrev_b32 v6, 16, v140
    v_bfi_b32 v5, s38, v6, v5
    v_accvgpr_write_b32 a168, v5
    v_accvgpr_read_b32 v5, a172
    v_lshlrev_b32 v6, 16, v141
    v_bfi_b32 v5, s38, v6, v5
    v_accvgpr_write_b32 a172, v5
    v_accvgpr_read_b32 v5, a176
    v_lshlrev_b32 v6, 16, v142
    v_bfi_b32 v5, s38, v6, v5
    v_accvgpr_write_b32 a176, v5
    v_accvgpr_read_b32 v5, a180
    v_lshlrev_b32 v6, 16, v143
    v_bfi_b32 v5, s38, v6, v5
    v_accvgpr_write_b32 a180, v5
    v_accvgpr_read_b32 v5, a184
    v_lshlrev_b32 v6, 16, v144
    v_bfi_b32 v5, s38, v6, v5
    v_accvgpr_write_b32 a184, v5
    v_accvgpr_read_b32 v5, a188
    v_lshlrev_b32 v6, 16, v145
    v_bfi_b32 v5, s38, v6, v5
    v_accvgpr_write_b32 a188, v5
    v_accvgpr_read_b32 v5, a192
    v_lshlrev_b32 v6, 16, v146
    v_bfi_b32 v5, s38, v6, v5
    v_accvgpr_write_b32 a192, v5
    v_accvgpr_read_b32 v5, a196
    v_lshlrev_b32 v6, 16, v147
    v_bfi_b32 v5, s38, v6, v5
    v_accvgpr_write_b32 a196, v5
    v_accvgpr_read_b32 v5, a200
    v_lshlrev_b32 v6, 16, v148
    v_bfi_b32 v5, s38, v6, v5
    v_accvgpr_write_b32 a200, v5
    v_accvgpr_read_b32 v5, a204
    v_lshlrev_b32 v6, 16, v149
    v_bfi_b32 v5, s38, v6, v5
    v_accvgpr_write_b32 a204, v5
    v_accvgpr_read_b32 v5, a208
    v_lshlrev_b32 v6, 16, v150
    v_bfi_b32 v5, s38, v6, v5
    v_accvgpr_write_b32 a208, v5
    v_accvgpr_read_b32 v5, a212
    v_lshlrev_b32 v6, 16, v151
    v_bfi_b32 v5, s38, v6, v5
    v_accvgpr_write_b32 a212, v5
    v_accvgpr_read_b32 v5, a216
    v_lshlrev_b32 v6, 16, v152
    v_bfi_b32 v5, s38, v6, v5
    v_accvgpr_write_b32 a216, v5
    v_accvgpr_read_b32 v5, a220
    v_lshlrev_b32 v6, 16, v153
    v_bfi_b32 v5, s38, v6, v5
    v_accvgpr_write_b32 a220, v5
    v_accvgpr_read_b32 v5, a224
    v_lshlrev_b32 v6, 16, v154
    v_bfi_b32 v5, s38, v6, v5
    v_accvgpr_write_b32 a224, v5
    v_accvgpr_read_b32 v5, a228
    v_lshlrev_b32 v6, 16, v155
    v_bfi_b32 v5, s38, v6, v5
    v_accvgpr_write_b32 a228, v5
    v_accvgpr_read_b32 v5, a232
    v_lshlrev_b32 v6, 16, v156
    v_bfi_b32 v5, s38, v6, v5
    v_accvgpr_write_b32 a232, v5
    v_accvgpr_read_b32 v5, a236
    v_lshlrev_b32 v6, 16, v157
    v_bfi_b32 v5, s38, v6, v5
    v_accvgpr_write_b32 a236, v5
    v_accvgpr_read_b32 v5, a240
    v_lshlrev_b32 v6, 16, v158
    v_bfi_b32 v5, s38, v6, v5
    v_accvgpr_write_b32 a240, v5
    v_accvgpr_read_b32 v5, a244
    v_lshlrev_b32 v6, 16, v159
    v_bfi_b32 v5, s38, v6, v5
    v_accvgpr_write_b32 a244, v5
F2_nx:
    s_add_u32 s36, s36, 1
    s_add_u32 s32, s32, 128
    s_add_u32 s33, s32, 64
    s_add_u32 s34, s34, 8192
    s_mov_b32 s35, 897581056
    s_cmp_eq_u32 s36, 4
    s_cselect_b32 s32, 104857664, s32
    s_cselect_b32 s33, 1073741824, s33
    s_cselect_b32 s34, 121634816, s34
    s_cselect_b32 s35, 889192448, s35
    s_cmp_lt_u32 s36, s37
    s_cbranch_scc1 F2_top
    s_mul_i32 s21, s31, 33024
    s_add_u32 s21, s21, 111149056
    s_add_u32 s17, s21, 0
    buffer_store_dwordx4 a[120:123], v18, s[4:7], s17 offen offset:0 sc1
    buffer_store_dwordx4 a[124:127], v18, s[4:7], s17 offen offset:512 sc1
    buffer_store_dwordx4 a[128:131], v18, s[4:7], s17 offen offset:1024 sc1
    buffer_store_dwordx4 a[132:135], v18, s[4:7], s17 offen offset:1536 sc1
    buffer_store_dwordx4 a[136:139], v18, s[4:7], s17 offen offset:2048 sc1
    buffer_store_dwordx4 a[140:143], v18, s[4:7], s17 offen offset:2560 sc1
    buffer_store_dwordx4 a[144:147], v18, s[4:7], s17 offen offset:3072 sc1
    buffer_store_dwordx4 a[148:151], v18, s[4:7], s17 offen offset:3584 sc1
    s_add_u32 s17, s21, 8192
    buffer_store_dwordx4 a[152:155], v18, s[4:7], s17 offen offset:0 sc1
    buffer_store_dwordx4 a[156:159], v18, s[4:7], s17 offen offset:512 sc1
    buffer_store_dwordx4 a[160:163], v18, s[4:7], s17 offen offset:1024 sc1
    buffer_store_dwordx4 a[164:167], v18, s[4:7], s17 offen offset:1536 sc1
    buffer_store_dwordx4 a[168:171], v18, s[4:7], s17 offen offset:2048 sc1
    buffer_store_dwordx4 a[172:175], v18, s[4:7], s17 offen offset:2560 sc1
    buffer_store_dwordx4 a[176:179], v18, s[4:7], s17 offen offset:3072 sc1
    buffer_store_dwordx4 a[180:183], v18, s[4:7], s17 offen offset:3584 sc1
    s_add_u32 s17, s21, 16384
    buffer_store_dwordx4 a[184:187], v18, s[4:7], s17 offen offset:0 sc1
    buffer_store_dwordx4 a[188:191], v18, s[4:7], s17 offen offset:512 sc1
    buffer_store_dwordx4 a[192:195], v18, s[4:7], s17 offen offset:1024 sc1
    buffer_store_dwordx4 a[196:199], v18, s[4:7], s17 offen offset:1536 sc1
    buffer_store_dwordx4 a[200:203], v18, s[4:7], s17 offen offset:2048 sc1
    buffer_store_dwordx4 a[204:207], v18, s[4:7], s17 offen offset:2560 sc1
    buffer_store_dwordx4 a[208:211], v18, s[4:7], s17 offen offset:3072 sc1
    buffer_store_dwordx4 a[212:215], v18, s[4:7], s17 offen offset:3584 sc1
    s_add_u32 s17, s21, 24576
    buffer_store_dwordx4 a[216:219], v18, s[4:7], s17 offen offset:0 sc1
    buffer_store_dwordx4 a[220:223], v18, s[4:7], s17 offen offset:512 sc1
    buffer_store_dwordx4 a[224:227], v18, s[4:7], s17 offen offset:1024 sc1
    buffer_store_dwordx4 a[228:231], v18, s[4:7], s17 offen offset:1536 sc1
    buffer_store_dwordx4 a[232:235], v18, s[4:7], s17 offen offset:2048 sc1
    buffer_store_dwordx4 a[236:239], v18, s[4:7], s17 offen offset:2560 sc1
    buffer_store_dwordx4 a[240:243], v18, s[4:7], s17 offen offset:3072 sc1
    buffer_store_dwordx4 a[244:247], v18, s[4:7], s17 offen offset:3584 sc1
    s_waitcnt vmcnt(0)
    s_lshl_b32 s17, s31, 2
    s_add_u32 s17, s17, 100733440
    v_mov_b32 v5, s17
    v_mov_b32 v6, 1
    s_mov_b64 exec, 1
    buffer_store_dword v6, v5, s[4:7], 0 offen sc1
    s_mov_b64 exec, -1
    v_bfe_u32 v5, v1, 2, 2
    v_and_b32 v7, 3, v1
    v_lshl_add_u32 v7, v5, 3, v7
    s_lshl_b32 s17, s29, 5
    v_add_u32 v7, s17, v7
    v_lshrrev_b32 v8, 4, v1
    v_cvt_f32_u32 v8, v8
    s_mov_b32 s31, 981467136
    v_and_b32 v38, 1, v7
    v_add_u32 v5, 0, v7
    v_cvt_f32_u32 v6, v5
    v_mul_f32 v6, s31, v6
    v_mov_b32 v32, 0x3e800000
    v_sub_f32 v34, v6, v32
    v_mul_f32 v36, 0x41800000, v6
    v_mul_f32 v5, 4.0, v6
    v_mul_f32 v30, v5, v8
    v_add_u32 v5, 4, v7
    v_cvt_f32_u32 v6, v5
    v_mul_f32 v6, s31, v6
    v_mov_b32 v33, 0x3e800000
    v_sub_f32 v35, v6, v33
    v_mul_f32 v37, 0x41800000, v6
    v_mul_f32 v5, 4.0, v6
    v_mul_f32 v31, v5, v8
    v_lshlrev_b32 v8, 4, v1
    s_lshl_b32 s18, s16, 15
    v_add_u32 v8, s18, v8
    v_mov_b32 v7, v8
    s_mov_b32 s22, 0
F3_g0:
    v_fract_f32 v40, v30
    v_add_f32 v41, v40, v32
    v_add_f32 v42, v41, v34
    v_add_f32 v43, v42, v32
    v_add_f32 v44, v43, v34
    v_add_f32 v45, v44, v32
    v_add_f32 v46, v45, v34
    v_add_f32 v47, v46, v32
    v_add_f32 v30, v40, v36
    v_cos_f32 v48, v40
    v_cos_f32 v49, v41
    v_cos_f32 v50, v42
    v_cos_f32 v51, v43
    v_cos_f32 v52, v44
    v_cos_f32 v53, v45
    v_cos_f32 v54, v46
    v_cos_f32 v55, v47
    v_cvt_pk_bf16_f32 v56, v48, v49
    v_cvt_pk_bf16_f32 v57, v50, v51
    v_cvt_pk_bf16_f32 v58, v52, v53
    v_cvt_pk_bf16_f32 v59, v54, v55
    ds_write_b128 v7, v[56:59] offset:0
    v_fract_f32 v40, v31
    v_add_f32 v41, v40, v33
    v_add_f32 v42, v41, v35
    v_add_f32 v43, v42, v33
    v_add_f32 v44, v43, v35
    v_add_f32 v45, v44, v33
    v_add_f32 v46, v45, v35
    v_add_f32 v47, v46, v33
    v_add_f32 v31, v40, v37
    v_cos_f32 v48, v40
    v_cos_f32 v49, v41
    v_cos_f32 v50, v42
    v_cos_f32 v51, v43
    v_cos_f32 v52, v44
    v_cos_f32 v53, v45
    v_cos_f32 v54, v46
    v_cos_f32 v55, v47
    v_cvt_pk_bf16_f32 v60, v48, v49
    v_cvt_pk_bf16_f32 v61, v50, v51
    v_cvt_pk_bf16_f32 v62, v52, v53
    v_cvt_pk_bf16_f32 v63, v54, v55
    ds_write_b128 v7, v[60:63] offset:1024
    v_add_u32 v7, 2048, v7
    s_add_u32 s22, s22, 1
    s_cmp_lt_u32 s22, 16
    s_waitcnt lgkmcnt(0)
    s_cbranch_scc1 F3_g0
    ds_read_b128 a[0:3], v8 offset:0
    ds_read_b128 a[4:7], v8 offset:1024
    ds_read_b128 a[8:11], v8 offset:2048
    ds_read_b128 a[12:15], v8 offset:3072
    ds_read_b128 a[16:19], v8 offset:4096
    ds_read_b128 a[20:23], v8 offset:5120
    ds_read_b128 a[24:27], v8 offset:6144
    ds_read_b128 a[28:31], v8 offset:7168
    s_waitcnt lgkmcnt(7)
    ds_read_b128 a[32:35], v8 offset:8192
    ds_read_b128 a[36:39], v8 offset:9216
    ds_read_b128 a[40:43], v8 offset:10240
    ds_read_b128 a[44:47], v8 offset:11264
    ds_read_b128 a[48:51], v8 offset:12288
    ds_read_b128 a[52:55], v8 offset:13312
    ds_read_b128 a[56:59], v8 offset:14336
    ds_read_b128 a[60:63], v8 offset:15360
    s_waitcnt lgkmcnt(7)
    ds_read_b128 a[64:67], v8 offset:16384
    ds_read_b128 a[68:71], v8 offset:17408
    ds_read_b128 a[72:75], v8 offset:18432
    ds_read_b128 a[76:79], v8 offset:19456
    ds_read_b128 a[80:83], v8 offset:20480
    ds_read_b128 a[84:87], v8 offset:21504
    ds_read_b128 a[88:91], v8 offset:22528
    ds_read_b128 a[92:95], v8 offset:23552
    s_waitcnt lgkmcnt(7)
    ds_read_b128 a[96:99], v8 offset:24576
    ds_read_b128 a[100:103], v8 offset:25600
    ds_read_b128 a[104:107], v8 offset:26624
    ds_read_b128 a[108:111], v8 offset:27648
    ds_read_b128 a[112:115], v8 offset:28672
    ds_read_b128 a[116:119], v8 offset:29696
    ds_read_b128 a[120:123], v8 offset:30720
    ds_read_b128 a[124:127], v8 offset:31744
    s_waitcnt lgkmcnt(7)
    s_waitcnt lgkmcnt(0)
    v_mov_b32 v7, v8
    s_mov_b32 s22, 0
F3_g1:
    v_fract_f32 v40, v30
    v_add_f32 v41, v40, v32
    v_add_f32 v42, v41, v34
    v_add_f32 v43, v42, v32
    v_add_f32 v44, v43, v34
    v_add_f32 v45, v44, v32
    v_add_f32 v46, v45, v34
    v_add_f32 v47, v46, v32
    v_add_f32 v30, v40, v36
    v_cos_f32 v48, v40
    v_cos_f32 v49, v41
    v_cos_f32 v50, v42
    v_cos_f32 v51, v43
    v_cos_f32 v52, v44
    v_cos_f32 v53, v45
    v_cos_f32 v54, v46
    v_cos_f32 v55, v47
    v_cvt_pk_bf16_f32 v56, v48, v49
    v_cvt_pk_bf16_f32 v57, v50, v51
    v_cvt_pk_bf16_f32 v58, v52, v53
    v_cvt_pk_bf16_f32 v59, v54, v55
    ds_write_b128 v7, v[56:59] offset:0
    v_fract_f32 v40, v31
    v_add_f32 v41, v40, v33
    v_add_f32 v42, v41, v35
    v_add_f32 v43, v42, v33
    v_add_f32 v44, v43, v35
    v_add_f32 v45, v44, v33
    v_add_f32 v46, v45, v35
    v_add_f32 v47, v46, v33
    v_add_f32 v31, v40, v37
    v_cos_f32 v48, v40
    v_cos_f32 v49, v41
    v_cos_f32 v50, v42
    v_cos_f32 v51, v43
    v_cos_f32 v52, v44
    v_cos_f32 v53, v45
    v_cos_f32 v54, v46
    v_cos_f32 v55, v47
    v_cvt_pk_bf16_f32 v60, v48, v49
    v_cvt_pk_bf16_f32 v61, v50, v51
    v_cvt_pk_bf16_f32 v62, v52, v53
    v_cvt_pk_bf16_f32 v63, v54, v55
    ds_write_b128 v7, v[60:63] offset:1024
    v_add_u32 v7, 2048, v7
    s_add_u32 s22, s22, 1
    s_cmp_lt_u32 s22, 16
    s_waitcnt lgkmcnt(0)
    s_cbranch_scc1 F3_g1
    ds_read_b128 a[128:131], v8 offset:0
    ds_read_b128 a[132:135], v8 offset:1024
    ds_read_b128 a[136:139], v8 offset:2048
    ds_read_b128 a[140:143], v8 offset:3072
    ds_read_b128 a[144:147], v8 offset:4096
    ds_read_b128 a[148:151], v8 offset:5120
    ds_read_b128 a[152:155], v8 offset:6144
    ds_read_b128 a[156:159], v8 offset:7168
    s_waitcnt lgkmcnt(7)
    ds_read_b128 a[160:163], v8 offset:8192
    ds_read_b128 a[164:167], v8 offset:9216
    ds_read_b128 a[168:171], v8 offset:10240
    ds_read_b128 a[172:175], v8 offset:11264
    ds_read_b128 a[176:179], v8 offset:12288
    ds_read_b128 a[180:183], v8 offset:13312
    ds_read_b128 a[184:187], v8 offset:14336
    ds_read_b128 a[188:191], v8 offset:15360
    s_waitcnt lgkmcnt(7)
    ds_read_b128 a[192:195], v8 offset:16384
    ds_read_b128 a[196:199], v8 offset:17408
    ds_read_b128 a[200:203], v8 offset:18432
    ds_read_b128 a[204:207], v8 offset:19456
    ds_read_b128 a[208:211], v8 offset:20480
    ds_read_b128 a[212:215], v8 offset:21504
    ds_read_b128 a[216:219], v8 offset:22528
    ds_read_b128 a[220:223], v8 offset:23552
    s_waitcnt lgkmcnt(7)
    ds_read_b128 a[224:227], v8 offset:24576
    ds_read_b128 a[228:231], v8 offset:25600
    ds_read_b128 a[232:235], v8 offset:26624
    ds_read_b128 a[236:239], v8 offset:27648
    ds_read_b128 a[240:243], v8 offset:28672
    ds_read_b128 a[244:247], v8 offset:29696
    ds_read_b128 a[248:251], v8 offset:30720
    ds_read_b128 a[252:255], v8 offset:31744
    s_waitcnt lgkmcnt(7)
    s_waitcnt lgkmcnt(0)
    v_lshlrev_b32 v6, 31, v38
    v_or_b32 v6, 0x3f803f80, v6
    v_cmp_gt_u32 vcc, 16, v1
    v_accvgpr_read_b32 v5, a0
    s_nop 0
    v_cndmask_b32 v5, v5, v6, vcc
    v_accvgpr_write_b32 a0, v5
    v_accvgpr_read_b32 v5, a4
    v_cndmask_b32 v5, v5, v6, vcc
    v_accvgpr_write_b32 a4, v5
    v_and_b32 v5, 15, v1
    v_bfe_u32 v6, v1, 1, 3
    v_lshrrev_b32 v7, 4, v1
    v_xor_b32 v6, v6, v7
    v_lshlrev_b32 v6, 4, v6
    v_lshl_add_u32 v10, v5, 7, v6
    s_lshl_b32 s19, s16, 10
    v_xor_b32 v11, 64, v10
    v_add_u32 v12, 0x10000, v10
    v_add_u32 v13, 0x10000, v11
    v_lshrrev_b32 v7, 3, v1
    s_lshl_b32 s17, s16, 3
    v_add_u32 v7, s17, v7
    v_bfe_u32 v8, v7, 1, 3
    v_xor_b32 v8, v8, v1
    v_and_b32 v8, 7, v8
    v_mul_u32_u24 v2, 33024, v8
    v_lshl_add_u32 v2, v7, 4, v2
    v_and_b32 v3, 15, v1
    v_and_b32 v5, 48, v1
    v_lshl_add_u32 v3, v3, 12, v5
    v_add_u32 v4, 0x10000, v3
    s_lshl_b32 s21, s28, 21
    s_lshl_b32 s17, s29, 6
    s_add_u32 s21, s21, s17
    s_lshl_b32 s20, s28, 13
    s_add_u32 s20, s20, 111149056
    s_mov_b32 s24, 512
    s_mov_b32 s25, 131072
    v_lshlrev_b32 v7, 2, v1
    v_add_u32 v7, 100733440, v7
    v_add_u32 v8, 256, v7
    s_mov_b32 s30, s92
F3_w0:
    buffer_load_dword v5, v7, s[4:7], 0 offen sc1
    s_waitcnt vmcnt(0)
    v_cmp_gt_u32 vcc, 1, v5
    s_nop 0
    s_cmp_lg_u64 vcc, 0
    s_cbranch_scc0 F3_w0_ok
    s_cmp_ge_u32 s30, 1048576
    s_cselect_b32 s92, 1048576, s92
    s_cbranch_scc1 F3_w0_ok
    s_add_u32 s30, s30, 1
    s_sleep 8
    s_branch F3_w0
F3_w0_ok:
    s_mov_b32 s30, s92
F3_w1:
    buffer_load_dword v5, v8, s[4:7], 0 offen sc1
    s_waitcnt vmcnt(0)
    v_cmp_gt_u32 vcc, 1, v5
    s_nop 0
    s_cmp_lg_u64 vcc, 0
    s_cbranch_scc0 F3_w1_ok
    s_cmp_ge_u32 s30, 1048576
    s_cselect_b32 s92, 1048576, s92
    s_cbranch_scc1 F3_w1_ok
    s_add_u32 s30, s30, 1
    s_sleep 8
    s_branch F3_w1
F3_w1_ok:
    s_barrier
    s_mov_b32 s26, s25
    s_sub_u32 s25, s21, 1073741824
    s_mov_b32 s21, 1073741824
    s_mov_b32 s23, 0
    s_mov_b32 s22, 0
    s_add_u32 m0, s19, 0
    s_add_u32 s17, s20, 0
    buffer_load_dwordx4 v2, s[4:7], s17 offen sc1 lds
    s_add_u32 m0, s19, 4096
    s_add_u32 s17, s20, 264192
    buffer_load_dwordx4 v2, s[4:7], s17 offen sc1 lds
    s_add_u32 m0, s19, 8192
    s_add_u32 s17, s20, 528384
    buffer_load_dwordx4 v2, s[4:7], s17 offen sc1 lds
    s_add_u32 m0, s19, 12288
    s_add_u32 s17, s20, 792576
    buffer_load_dwordx4 v2, s[4:7], s17 offen sc1 lds
    s_add_u32 m0, s19, 16384
    s_add_u32 s17, s20, 1056768
    buffer_load_dwordx4 v2, s[4:7], s17 offen sc1 lds
    s_add_u32 m0, s19, 20480
    s_add_u32 s17, s20, 1320960
    buffer_load_dwordx4 v2, s[4:7], s17 offen sc1 lds
    s_add_u32 m0, s19, 24576
    s_add_u32 s17, s20, 1585152
    buffer_load_dwordx4 v2, s[4:7], s17 offen sc1 lds
    s_add_u32 m0, s19, 28672
    s_add_u32 s17, s20, 1849344
    buffer_load_dwordx4 v2, s[4:7], s17 offen sc1 lds
    s_add_u32 m0, s19, 32768
    s_add_u32 s17, s20, 2113536
    buffer_load_dwordx4 v2, s[4:7], s17 offen sc1 lds
    s_add_u32 m0, s19, 36864
    s_add_u32 s17, s20, 2377728
    buffer_load_dwordx4 v2, s[4:7], s17 offen sc1 lds
    s_add_u32 m0, s19, 40960
    s_add_u32 s17, s20, 2641920
    buffer_load_dwordx4 v2, s[4:7], s17 offen sc1 lds
    s_add_u32 m0, s19, 45056
    s_add_u32 s17, s20, 2906112
    buffer_load_dwordx4 v2, s[4:7], s17 offen sc1 lds
    s_add_u32 m0, s19, 49152
    s_add_u32 s17, s20, 3170304
    buffer_load_dwordx4 v2, s[4:7], s17 offen sc1 lds
    s_add_u32 m0, s19, 53248
    s_add_u32 s17, s20, 3434496
    buffer_load_dwordx4 v2, s[4:7], s17 offen sc1 lds
    s_add_u32 m0, s19, 57344
    s_add_u32 s17, s20, 3698688
    buffer_load_dwordx4 v2, s[4:7], s17 offen sc1 lds
    s_add_u32 m0, s19, 61440
    s_add_u32 s17, s20, 3962880
    buffer_load_dwordx4 v2, s[4:7], s17 offen sc1 lds
    s_add_u32 s20, s20, s24
    s_add_u32 m0, s19, 65536
    s_add_u32 s17, s20, 0
    buffer_load_dwordx4 v2, s[4:7], s17 offen sc1 lds
    s_add_u32 m0, s19, 69632
    s_add_u32 s17, s20, 264192
    buffer_load_dwordx4 v2, s[4:7], s17 offen sc1 lds
    s_add_u32 m0, s19, 73728
    s_add_u32 s17, s20, 528384
    buffer_load_dwordx4 v2, s[4:7], s17 offen sc1 lds
    s_waitcnt vmcnt(11)
    s_barrier
    ds_read_b128 v[20:23], v10 offset:0
    ds_read_b128 v[24:27], v10 offset:2048
    ds_read_b128 v[28:31], v11 offset:0
    ds_read_b128 v[32:35], v11 offset:2048
    ds_read_b128 v[36:39], v10 offset:4096
    ds_read_b128 v[40:43], v10 offset:6144
    ds_read_b128 v[44:47], v11 offset:4096
.p2align 6
F3_top:
    s_waitcnt lgkmcnt(6)
    v_mfma_f32_16x16x32_bf16 v[52:55], a[0:3], v[20:23], 0
    ds_read_b128 v[48:51], v11 offset:6144
    v_mfma_f32_16x16x32_bf16 v[56:59], a[4:7], v[20:23], 0
    s_waitcnt lgkmcnt(6)
    v_mfma_f32_16x16x32_bf16 v[60:63], a[0:3], v[24:27], 0
    ds_read_b128 v[20:23], v10 offset:8192
    s_add_u32 m0, s19, 77824
    v_mfma_f32_16x16x32_bf16 v[64:67], a[4:7], v[24:27], 0
    s_add_u32 s17, s20, 792576
    buffer_load_dwordx4 v2, s[4:7], s17 offen sc1 lds
    s_waitcnt lgkmcnt(6)
    v_mfma_f32_16x16x32_bf16 v[52:55], a[8:11], v[28:31], v[52:55]
    ds_read_b128 v[24:27], v10 offset:10240
    v_mfma_f32_16x16x32_bf16 v[56:59], a[12:15], v[28:31], v[56:59]
    s_waitcnt lgkmcnt(6)
    v_mfma_f32_16x16x32_bf16 v[60:63], a[8:11], v[32:35], v[60:63]
    ds_read_b128 v[28:31], v11 offset:8192
    s_add_u32 m0, s19, 81920
    v_mfma_f32_16x16x32_bf16 v[64:67], a[12:15], v[32:35], v[64:67]
    s_add_u32 s17, s20, 1056768
    buffer_load_dwordx4 v2, s[4:7], s17 offen sc1 lds
    s_waitcnt lgkmcnt(6)
    v_mfma_f32_16x16x32_bf16 v[52:55], a[16:19], v[36:39], v[52:55]
    ds_read_b128 v[32:35], v11 offset:10240
    v_mfma_f32_16x16x32_bf16 v[56:59], a[20:23], v[36:39], v[56:59]
    s_waitcnt lgkmcnt(6)
    v_mfma_f32_16x16x32_bf16 v[60:63], a[16:19], v[40:43], v[60:63]
    ds_read_b128 v[36:39], v10 offset:12288
    s_add_u32 m0, s19, 86016
    v_mfma_f32_16x16x32_bf16 v[64:67], a[20:23], v[40:43], v[64:67]
    s_add_u32 s17, s20, 1320960
    buffer_load_dwordx4 v2, s[4:7], s17 offen sc1 lds
    s_waitcnt lgkmcnt(6)
    v_mfma_f32_16x16x32_bf16 v[52:55], a[24:27], v[44:47], v[52:55]
    ds_read_b128 v[40:43], v10 offset:14336
    v_mfma_f32_16x16x32_bf16 v[56:59], a[28:31], v[44:47], v[56:59]
    s_waitcnt lgkmcnt(6)
    v_mfma_f32_16x16x32_bf16 v[60:63], a[24:27], v[48:51], v[60:63]
    ds_read_b128 v[44:47], v11 offset:12288
    s_add_u32 m0, s19, 90112
    v_mfma_f32_16x16x32_bf16 v[64:67], a[28:31], v[48:51], v[64:67]
    s_add_u32 s17, s20, 1585152
    buffer_load_dwordx4 v2, s[4:7], s17 offen sc1 lds
    s_waitcnt lgkmcnt(6)
    v_mfma_f32_16x16x32_bf16 v[52:55], a[32:35], v[20:23], v[52:55]
    ds_read_b128 v[48:51], v11 offset:14336
    v_mfma_f32_16x16x32_bf16 v[56:59], a[36:39], v[20:23], v[56:59]
    s_waitcnt lgkmcnt(6)
    v_mfma_f32_16x16x32_bf16 v[60:63], a[32:35], v[24:27], v[60:63]
    ds_read_b128 v[20:23], v10 offset:16384
    s_add_u32 m0, s19, 94208
    v_mfma_f32_16x16x32_bf16 v[64:67], a[36:39], v[24:27], v[64:67]
    s_add_u32 s17, s20, 1849344
    buffer_load_dwordx4 v2, s[4:7], s17 offen sc1 lds
    s_waitcnt lgkmcnt(6)
    v_mfma_f32_16x16x32_bf16 v[52:55], a[40:43], v[28:31], v[52:55]
    ds_read_b128 v[24:27], v10 offset:18432
    v_mfma_f32_16x16x32_bf16 v[56:59], a[44:47], v[28:31], v[56:59]
    v_cvt_pk_bf16_f32 v84, v68, v69
    s_waitcnt lgkmcnt(6)
    v_mfma_f32_16x16x32_bf16 v[60:63], a[40:43], v[32:35], v[60:63]
    ds_read_b128 v[28:31], v11 offset:16384
    v_mfma_f32_16x16x32_bf16 v[64:67], a[44:47], v[32:35], v[64:67]
    v_cvt_pk_bf16_f32 v85, v70, v71
    s_waitcnt lgkmcnt(6)
    v_mfma_f32_16x16x32_bf16 v[52:55], a[48:51], v[36:39], v[52:55]
    ds_read_b128 v[32:35], v11 offset:18432
    v_mfma_f32_16x16x32_bf16 v[56:59], a[52:55], v[36:39], v[56:59]
    v_cvt_pk_bf16_f32 v86, v72, v73
    s_waitcnt lgkmcnt(6)
    v_mfma_f32_16x16x32_bf16 v[60:63], a[48:51], v[40:43], v[60:63]
    ds_read_b128 v[36:39], v10 offset:20480
    v_mfma_f32_16x16x32_bf16 v[64:67], a[52:55], v[40:43], v[64:67]
    v_cvt_pk_bf16_f32 v87, v74, v75
    s_waitcnt lgkmcnt(6)
    v_mfma_f32_16x16x32_bf16 v[52:55], a[56:59], v[44:47], v[52:55]
    ds_read_b128 v[40:43], v10 offset:22528
    v_mfma_f32_16x16x32_bf16 v[56:59], a[60:63], v[44:47], v[56:59]
    v_cvt_pk_bf16_f32 v88, v76, v77
    s_waitcnt lgkmcnt(6)
    v_mfma_f32_16x16x32_bf16 v[60:63], a[56:59], v[48:51], v[60:63]
    ds_read_b128 v[44:47], v11 offset:20480
    v_mfma_f32_16x16x32_bf16 v[64:67], a[60:63], v[48:51], v[64:67]
    v_cvt_pk_bf16_f32 v89, v78, v79
    buffer_store_dwordx4 v[84:87], v3, s[12:15], s21 offen
    s_waitcnt lgkmcnt(6)
    v_mfma_f32_16x16x32_bf16 v[52:55], a[64:67], v[20:23], v[52:55]
    ds_read_b128 v[48:51], v11 offset:22528
    v_mfma_f32_16x16x32_bf16 v[56:59], a[68:71], v[20:23], v[56:59]
    v_cvt_pk_bf16_f32 v90, v80, v81
    s_waitcnt lgkmcnt(6)
    v_mfma_f32_16x16x32_bf16 v[60:63], a[64:67], v[24:27], v[60:63]
    ds_read_b128 v[20:23], v10 offset:24576
    v_mfma_f32_16x16x32_bf16 v[64:67], a[68:71], v[24:27], v[64:67]
    v_cvt_pk_bf16_f32 v91, v82, v83
    s_waitcnt lgkmcnt(6)
    v_mfma_f32_16x16x32_bf16 v[52:55], a[72:75], v[28:31], v[52:55]
    ds_read_b128 v[24:27], v10 offset:26624
    v_mfma_f32_16x16x32_bf16 v[56:59], a[76:79], v[28:31], v[56:59]
    s_waitcnt lgkmcnt(6)
    v_mfma_f32_16x16x32_bf16 v[60:63], a[72:75], v[32:35], v[60:63]
    ds_read_b128 v[28:31], v11 offset:24576
    v_mfma_f32_16x16x32_bf16 v[64:67], a[76:79], v[32:35], v[64:67]
    buffer_store_dwordx4 v[88:91], v4, s[12:15], s21 offen
    s_waitcnt lgkmcnt(6)
    v_mfma_f32_16x16x32_bf16 v[52:55], a[80:83], v[36:39], v[52:55]
    ds_read_b128 v[32:35], v11 offset:26624
    v_mfma_f32_16x16x32_bf16 v[56:59], a[84:87], v[36:39], v[56:59]
    s_add_u32 s21, s21, s25
    s_mov_b32 s25, s26
    s_waitcnt lgkmcnt(6)
    v_mfma_f32_16x16x32_bf16 v[60:63], a[80:83], v[40:43], v[60:63]
    ds_read_b128 v[36:39], v10 offset:28672
    v_mfma_f32_16x16x32_bf16 v[64:67], a[84:87], v[40:43], v[64:67]
    s_waitcnt lgkmcnt(6)
    v_mfma_f32_16x16x32_bf16 v[52:55], a[88:91], v[44:47], v[52:55]
    ds_read_b128 v[40:43], v10 offset:30720
    v_mfma_f32_16x16x32_bf16 v[56:59], a[92:95], v[44:47], v[56:59]
    s_waitcnt lgkmcnt(6)
    v_mfma_f32_16x16x32_bf16 v[60:63], a[88:91], v[48:51], v[60:63]
    ds_read_b128 v[44:47], v11 offset:28672
    v_mfma_f32_16x16x32_bf16 v[64:67], a[92:95], v[48:51], v[64:67]
    s_waitcnt lgkmcnt(6)
    v_mfma_f32_16x16x32_bf16 v[52:55], a[96:99], v[20:23], v[52:55]
    ds_read_b128 v[48:51], v11 offset:30720
    v_mfma_f32_16x16x32_bf16 v[56:59], a[100:103], v[20:23], v[56:59]
    s_waitcnt lgkmcnt(6)
    v_mfma_f32_16x16x32_bf16 v[60:63], a[96:99], v[24:27], v[60:63]
    s_waitcnt vmcnt(10)
    s_barrier
    ds_read_b128 v[20:23], v10 offset:32768
    v_mfma_f32_16x16x32_bf16 v[64:67], a[100:103], v[24:27], v[64:67]
    s_waitcnt lgkmcnt(6)
    v_mfma_f32_16x16x32_bf16 v[52:55], a[104:107], v[28:31], v[52:55]
    ds_read_b128 v[24:27], v10 offset:34816
    s_add_u32 m0, s19, 98304
    v_mfma_f32_16x16x32_bf16 v[56:59], a[108:111], v[28:31], v[56:59]
    s_add_u32 s17, s20, 2113536
    buffer_load_dwordx4 v2, s[4:7], s17 offen sc1 lds
    s_waitcnt lgkmcnt(6)
    v_mfma_f32_16x16x32_bf16 v[60:63], a[104:107], v[32:35], v[60:63]
    ds_read_b128 v[28:31], v11 offset:32768
    v_mfma_f32_16x16x32_bf16 v[64:67], a[108:111], v[32:35], v[64:67]
    s_waitcnt lgkmcnt(6)
    v_mfma_f32_16x16x32_bf16 v[52:55], a[112:115], v[36:39], v[52:55]
    ds_read_b128 v[32:35], v11 offset:34816
    s_add_u32 m0, s19, 102400
    v_mfma_f32_16x16x32_bf16 v[56:59], a[116:119], v[36:39], v[56:59]
    s_add_u32 s17, s20, 2377728
    buffer_load_dwordx4 v2, s[4:7], s17 offen sc1 lds
    s_waitcnt lgkmcnt(6)
    v_mfma_f32_16x16x32_bf16 v[60:63], a[112:115], v[40:43], v[60:63]
    ds_read_b128 v[36:39], v10 offset:36864
    v_mfma_f32_16x16x32_bf16 v[64:67], a[116:119], v[40:43], v[64:67]
    s_waitcnt lgkmcnt(6)
    v_mfma_f32_16x16x32_bf16 v[52:55], a[120:123], v[44:47], v[52:55]
    ds_read_b128 v[40:43], v10 offset:38912
    s_add_u32 m0, s19, 106496
    v_mfma_f32_16x16x32_bf16 v[56:59], a[124:127], v[44:47], v[56:59]
    s_add_u32 s17, s20, 2641920
    buffer_load_dwordx4 v2, s[4:7], s17 offen sc1 lds
    s_waitcnt lgkmcnt(6)
    v_mfma_f32_16x16x32_bf16 v[60:63], a[120:123], v[48:51], v[60:63]
    ds_read_b128 v[44:47], v11 offset:36864
    v_mfma_f32_16x16x32_bf16 v[64:67], a[124:127], v[48:51], v[64:67]
    s_waitcnt lgkmcnt(6)
    v_mfma_f32_16x16x32_bf16 v[52:55], a[128:131], v[20:23], v[52:55]
    ds_read_b128 v[48:51], v11 offset:38912
    v_mfma_f32_16x16x32_bf16 v[56:59], a[132:135], v[20:23], v[56:59]
    s_waitcnt lgkmcnt(6)
    v_mfma_f32_16x16x32_bf16 v[60:63], a[128:131], v[24:27], v[60:63]
    ds_read_b128 v[20:23], v10 offset:40960
    s_add_u32 m0, s19, 110592
    v_mfma_f32_16x16x32_bf16 v[64:67], a[132:135], v[24:27], v[64:67]
    s_add_u32 s17, s20, 2906112
    buffer_load_dwordx4 v2, s[4:7], s17 offen sc1 lds
    s_waitcnt lgkmcnt(6)
    v_mfma_f32_16x16x32_bf16 v[52:55], a[136:139], v[28:31], v[52:55]
    ds_read_b128 v[24:27], v10 offset:43008
    v_mfma_f32_16x16x32_bf16 v[56:59], a[140:143], v[28:31], v[56:59]
    s_waitcnt lgkmcnt(6)
    v_mfma_f32_16x16x32_bf16 v[60:63], a[136:139], v[32:35], v[60:63]
    ds_read_b128 v[28:31], v11 offset:40960
    s_add_u32 m0, s19, 114688
    v_mfma_f32_16x16x32_bf16 v[64:67], a[140:143], v[32:35], v[64:67]
    s_add_u32 s17, s20, 3170304
    buffer_load_dwordx4 v2, s[4:7], s17 offen sc1 lds
    s_waitcnt lgkmcnt(6)
    v_mfma_f32_16x16x32_bf16 v[52:55], a[144:147], v[36:39], v[52:55]
    ds_read_b128 v[32:35], v11 offset:43008
    v_mfma_f32_16x16x32_bf16 v[56:59], a[148:151], v[36:39], v[56:59]
    s_waitcnt lgkmcnt(6)
    v_mfma_f32_16x16x32_bf16 v[60:63], a[144:147], v[40:43], v[60:63]
    ds_read_b128 v[36:39], v10 offset:45056
    s_add_u32 m0, s19, 118784
    v_mfma_f32_16x16x32_bf16 v[64:67], a[148:151], v[40:43], v[64:67]
    s_add_u32 s17, s20, 3434496
    buffer_load_dwordx4 v2, s[4:7], s17 offen sc1 lds
    s_waitcnt lgkmcnt(6)
    v_mfma_f32_16x16x32_bf16 v[52:55], a[152:155], v[44:47], v[52:55]
    ds_read_b128 v[40:43], v10 offset:47104
    v_mfma_f32_16x16x32_bf16 v[56:59], a[156:159], v[44:47], v[56:59]
    s_waitcnt lgkmcnt(6)
    v_mfma_f32_16x16x32_bf16 v[60:63], a[152:155], v[48:51], v[60:63]
    ds_read_b128 v[44:47], v11 offset:45056
    s_add_u32 m0, s19, 122880
    v_mfma_f32_16x16x32_bf16 v[64:67], a[156:159], v[48:51], v[64:67]
    s_add_u32 s17, s20, 3698688
    buffer_load_dwordx4 v2, s[4:7], s17 offen sc1 lds
    s_waitcnt lgkmcnt(6)
    v_mfma_f32_16x16x32_bf16 v[52:55], a[160:163], v[20:23], v[52:55]
    ds_read_b128 v[48:51], v11 offset:47104
    v_mfma_f32_16x16x32_bf16 v[56:59], a[164:167], v[20:23], v[56:59]
    s_waitcnt lgkmcnt(6)
    v_mfma_f32_16x16x32_bf16 v[60:63], a[160:163], v[24:27], v[60:63]
    ds_read_b128 v[20:23], v10 offset:49152
    s_add_u32 m0, s19, 126976
    v_mfma_f32_16x16x32_bf16 v[64:67], a[164:167], v[24:27], v[64:67]
    s_add_u32 s17, s20, 3962880
    buffer_load_dwordx4 v2, s[4:7], s17 offen sc1 lds
    s_waitcnt lgkmcnt(6)
    v_mfma_f32_16x16x32_bf16 v[52:55], a[168:171], v[28:31], v[52:55]
    ds_read_b128 v[24:27], v10 offset:51200
    v_mfma_f32_16x16x32_bf16 v[56:59], a[172:175], v[28:31], v[56:59]
    s_add_u32 s20, s20, s24
    s_waitcnt lgkmcnt(6)
    v_mfma_f32_16x16x32_bf16 v[60:63], a[168:171], v[32:35], v[60:63]
    ds_read_b128 v[28:31], v11 offset:49152
    v_mfma_f32_16x16x32_bf16 v[64:67], a[172:175], v[32:35], v[64:67]
    s_waitcnt lgkmcnt(6)
    v_mfma_f32_16x16x32_bf16 v[52:55], a[176:179], v[36:39], v[52:55]
    ds_read_b128 v[32:35], v11 offset:51200
    v_mfma_f32_16x16x32_bf16 v[56:59], a[180:183], v[36:39], v[56:59]
    s_waitcnt lgkmcnt(6)
    v_mfma_f32_16x16x32_bf16 v[60:63], a[176:179], v[40:43], v[60:63]
    ds_read_b128 v[36:39], v10 offset:53248
    v_mfma_f32_16x16x32_bf16 v[64:67], a[180:183], v[40:43], v[64:67]
    s_waitcnt lgkmcnt(6)
    v_mfma_f32_16x16x32_bf16 v[52:55], a[184:187], v[44:47], v[52:55]
    ds_read_b128 v[40:43], v10 offset:55296
    v_mfma_f32_16x16x32_bf16 v[56:59], a[188:191], v[44:47], v[56:59]
    s_waitcnt lgkmcnt(6)
    v_mfma_f32_16x16x32_bf16 v[60:63], a[184:187], v[48:51], v[60:63]
    ds_read_b128 v[44:47], v11 offset:53248
    v_mfma_f32_16x16x32_bf16 v[64:67], a[188:191], v[48:51], v[64:67]
    s_waitcnt lgkmcnt(6)
    v_mfma_f32_16x16x32_bf16 v[52:55], a[192:195], v[20:23], v[52:55]
    ds_read_b128 v[48:51], v11 offset:55296
    v_mfma_f32_16x16x32_bf16 v[56:59], a[196:199], v[20:23], v[56:59]
    s_waitcnt lgkmcnt(6)
    v_mfma_f32_16x16x32_bf16 v[60:63], a[192:195], v[24:27], v[60:63]
    ds_read_b128 v[20:23], v10 offset:57344
    v_mfma_f32_16x16x32_bf16 v[64:67], a[196:199], v[24:27], v[64:67]
    s_waitcnt lgkmcnt(6)
    v_mfma_f32_16x16x32_bf16 v[52:55], a[200:203], v[28:31], v[52:55]
    ds_read_b128 v[24:27], v10 offset:59392
    v_mfma_f32_16x16x32_bf16 v[56:59], a[204:207], v[28:31], v[56:59]
    s_waitcnt lgkmcnt(6)
    v_mfma_f32_16x16x32_bf16 v[60:63], a[200:203], v[32:35], v[60:63]
    ds_read_b128 v[28:31], v11 offset:57344
    v_mfma_f32_16x16x32_bf16 v[64:67], a[204:207], v[32:35], v[64:67]
    s_waitcnt lgkmcnt(6)
    v_mfma_f32_16x16x32_bf16 v[52:55], a[208:211], v[36:39], v[52:55]
    ds_read_b128 v[32:35], v11 offset:59392
    v_mfma_f32_16x16x32_bf16 v[56:59], a[212:215], v[36:39], v[56:59]
    s_waitcnt lgkmcnt(6)
    v_mfma_f32_16x16x32_bf16 v[60:63], a[208:211], v[40:43], v[60:63]
    ds_read_b128 v[36:39], v10 offset:61440
    v_mfma_f32_16x16x32_bf16 v[64:67], a[212:215], v[40:43], v[64:67]
    s_waitcnt lgkmcnt(6)
    v_mfma_f32_16x16x32_bf16 v[52:55], a[216:219], v[44:47], v[52:55]
    ds_read_b128 v[40:43], v10 offset:63488
    v_mfma_f32_16x16x32_bf16 v[56:59], a[220:223], v[44:47], v[56:59]
    s_waitcnt lgkmcnt(6)
    v_mfma_f32_16x16x32_bf16 v[60:63], a[216:219], v[48:51], v[60:63]
    ds_read_b128 v[44:47], v11 offset:61440
    v_mfma_f32_16x16x32_bf16 v[64:67], a[220:223], v[48:51], v[64:67]
    s_waitcnt lgkmcnt(6)
    v_mfma_f32_16x16x32_bf16 v[52:55], a[224:227], v[20:23], v[52:55]
    ds_read_b128 v[48:51], v11 offset:63488
    v_mfma_f32_16x16x32_bf16 v[56:59], a[228:231], v[20:23], v[56:59]
    s_waitcnt lgkmcnt(6)
    v_mfma_f32_16x16x32_bf16 v[60:63], a[224:227], v[24:27], v[60:63]
    s_waitcnt vmcnt(8)
    s_barrier
    ds_read_b128 v[20:23], v12 offset:0
    v_mfma_f32_16x16x32_bf16 v[64:67], a[228:231], v[24:27], v[64:67]
    s_waitcnt lgkmcnt(6)
    v_mfma_f32_16x16x32_bf16 v[52:55], a[232:235], v[28:31], v[52:55]
    ds_read_b128 v[24:27], v12 offset:2048
    s_add_u32 m0, s19, 0
    v_mfma_f32_16x16x32_bf16 v[56:59], a[236:239], v[28:31], v[56:59]
    s_add_u32 s17, s20, 0
    buffer_load_dwordx4 v2, s[4:7], s17 offen sc1 lds
    s_waitcnt lgkmcnt(6)
    v_mfma_f32_16x16x32_bf16 v[60:63], a[232:235], v[32:35], v[60:63]
    ds_read_b128 v[28:31], v13 offset:0
    v_mfma_f32_16x16x32_bf16 v[64:67], a[236:239], v[32:35], v[64:67]
    s_waitcnt lgkmcnt(6)
    v_mfma_f32_16x16x32_bf16 v[52:55], a[240:243], v[36:39], v[52:55]
    ds_read_b128 v[32:35], v13 offset:2048
    s_add_u32 m0, s19, 4096
    v_mfma_f32_16x16x32_bf16 v[56:59], a[244:247], v[36:39], v[56:59]
    s_add_u32 s17, s20, 264192
    buffer_load_dwordx4 v2, s[4:7], s17 offen sc1 lds
    s_waitcnt lgkmcnt(6)
    v_mfma_f32_16x16x32_bf16 v[60:63], a[240:243], v[40:43], v[60:63]
    ds_read_b128 v[36:39], v12 offset:4096
    v_mfma_f32_16x16x32_bf16 v[64:67], a[244:247], v[40:43], v[64:67]
    s_waitcnt lgkmcnt(6)
    v_mfma_f32_16x16x32_bf16 v[52:55], a[248:251], v[44:47], v[52:55]
    ds_read_b128 v[40:43], v12 offset:6144
    s_add_u32 m0, s19, 8192
    v_mfma_f32_16x16x32_bf16 v[56:59], a[252:255], v[44:47], v[56:59]
    s_add_u32 s17, s20, 528384
    buffer_load_dwordx4 v2, s[4:7], s17 offen sc1 lds
    s_waitcnt lgkmcnt(6)
    v_mfma_f32_16x16x32_bf16 v[60:63], a[248:251], v[48:51], v[60:63]
    ds_read_b128 v[44:47], v13 offset:4096
    v_mfma_f32_16x16x32_bf16 v[64:67], a[252:255], v[48:51], v[64:67]
    s_waitcnt lgkmcnt(6)
    v_mfma_f32_16x16x32_bf16 v[68:71], a[0:3], v[20:23], 0
    ds_read_b128 v[48:51], v13 offset:6144
    v_mfma_f32_16x16x32_bf16 v[72:75], a[4:7], v[20:23], 0
    s_waitcnt lgkmcnt(6)
    v_mfma_f32_16x16x32_bf16 v[76:79], a[0:3], v[24:27], 0
    ds_read_b128 v[20:23], v12 offset:8192
    s_add_u32 m0, s19, 12288
    v_mfma_f32_16x16x32_bf16 v[80:83], a[4:7], v[24:27], 0
    s_add_u32 s17, s20, 792576
    buffer_load_dwordx4 v2, s[4:7], s17 offen sc1 lds
    s_waitcnt lgkmcnt(6)
    v_mfma_f32_16x16x32_bf16 v[68:71], a[8:11], v[28:31], v[68:71]
    ds_read_b128 v[24:27], v12 offset:10240
    v_mfma_f32_16x16x32_bf16 v[72:75], a[12:15], v[28:31], v[72:75]
    s_waitcnt lgkmcnt(6)
    v_mfma_f32_16x16x32_bf16 v[76:79], a[8:11], v[32:35], v[76:79]
    ds_read_b128 v[28:31], v13 offset:8192
    s_add_u32 m0, s19, 16384
    v_mfma_f32_16x16x32_bf16 v[80:83], a[12:15], v[32:35], v[80:83]
    s_add_u32 s17, s20, 1056768
    buffer_load_dwordx4 v2, s[4:7], s17 offen sc1 lds
    s_waitcnt lgkmcnt(6)
    v_mfma_f32_16x16x32_bf16 v[68:71], a[16:19], v[36:39], v[68:71]
    ds_read_b128 v[32:35], v13 offset:10240
    v_mfma_f32_16x16x32_bf16 v[72:75], a[20:23], v[36:39], v[72:75]
    s_waitcnt lgkmcnt(6)
    v_mfma_f32_16x16x32_bf16 v[76:79], a[16:19], v[40:43], v[76:79]
    ds_read_b128 v[36:39], v12 offset:12288
    s_add_u32 m0, s19, 20480
    v_mfma_f32_16x16x32_bf16 v[80:83], a[20:23], v[40:43], v[80:83]
    s_add_u32 s17, s20, 1320960
    buffer_load_dwordx4 v2, s[4:7], s17 offen sc1 lds
    s_waitcnt lgkmcnt(6)
    v_mfma_f32_16x16x32_bf16 v[68:71], a[24:27], v[44:47], v[68:71]
    ds_read_b128 v[40:43], v12 offset:14336
    v_mfma_f32_16x16x32_bf16 v[72:75], a[28:31], v[44:47], v[72:75]
    s_waitcnt lgkmcnt(6)
    v_mfma_f32_16x16x32_bf16 v[76:79], a[24:27], v[48:51], v[76:79]
    ds_read_b128 v[44:47], v13 offset:12288
    s_add_u32 m0, s19, 24576
    v_mfma_f32_16x16x32_bf16 v[80:83], a[28:31], v[48:51], v[80:83]
    s_add_u32 s17, s20, 1585152
    buffer_load_dwordx4 v2, s[4:7], s17 offen sc1 lds
    s_waitcnt lgkmcnt(6)
    v_mfma_f32_16x16x32_bf16 v[68:71], a[32:35], v[20:23], v[68:71]
    ds_read_b128 v[48:51], v13 offset:14336
    v_mfma_f32_16x16x32_bf16 v[72:75], a[36:39], v[20:23], v[72:75]
    s_waitcnt lgkmcnt(6)
    v_mfma_f32_16x16x32_bf16 v[76:79], a[32:35], v[24:27], v[76:79]
    ds_read_b128 v[20:23], v12 offset:16384
    s_add_u32 m0, s19, 28672
    v_mfma_f32_16x16x32_bf16 v[80:83], a[36:39], v[24:27], v[80:83]
    s_add_u32 s17, s20, 1849344
    buffer_load_dwordx4 v2, s[4:7], s17 offen sc1 lds
    s_waitcnt lgkmcnt(6)
    v_mfma_f32_16x16x32_bf16 v[68:71], a[40:43], v[28:31], v[68:71]
    ds_read_b128 v[24:27], v12 offset:18432
    v_mfma_f32_16x16x32_bf16 v[72:75], a[44:47], v[28:31], v[72:75]
    v_cvt_pk_bf16_f32 v84, v52, v53
    s_waitcnt lgkmcnt(6)
    v_mfma_f32_16x16x32_bf16 v[76:79], a[40:43], v[32:35], v[76:79]
    ds_read_b128 v[28:31], v13 offset:16384
    v_mfma_f32_16x16x32_bf16 v[80:83], a[44:47], v[32:35], v[80:83]
    v_cvt_pk_bf16_f32 v85, v54, v55
    s_waitcnt lgkmcnt(6)
    v_mfma_f32_16x16x32_bf16 v[68:71], a[48:51], v[36:39], v[68:71]
    ds_read_b128 v[32:35], v13 offset:18432
    v_mfma_f32_16x16x32_bf16 v[72:75], a[52:55], v[36:39], v[72:75]
    v_cvt_pk_bf16_f32 v86, v56, v57
    s_waitcnt lgkmcnt(6)
    v_mfma_f32_16x16x32_bf16 v[76:79], a[48:51], v[40:43], v[76:79]
    ds_read_b128 v[36:39], v12 offset:20480
    v_mfma_f32_16x16x32_bf16 v[80:83], a[52:55], v[40:43], v[80:83]
    v_cvt_pk_bf16_f32 v87, v58, v59
    s_waitcnt lgkmcnt(6)
    v_mfma_f32_16x16x32_bf16 v[68:71], a[56:59], v[44:47], v[68:71]
    ds_read_b128 v[40:43], v12 offset:22528
    v_mfma_f32_16x16x32_bf16 v[72:75], a[60:63], v[44:47], v[72:75]
    v_cvt_pk_bf16_f32 v88, v60, v61
    s_waitcnt lgkmcnt(6)
    v_mfma_f32_16x16x32_bf16 v[76:79], a[56:59], v[48:51], v[76:79]
    ds_read_b128 v[44:47], v13 offset:20480
    v_mfma_f32_16x16x32_bf16 v[80:83], a[60:63], v[48:51], v[80:83]
    v_cvt_pk_bf16_f32 v89, v62, v63
    buffer_store_dwordx4 v[84:87], v3, s[12:15], s21 offen
    s_waitcnt lgkmcnt(6)
    v_mfma_f32_16x16x32_bf16 v[68:71], a[64:67], v[20:23], v[68:71]
    ds_read_b128 v[48:51], v13 offset:22528
    v_mfma_f32_16x16x32_bf16 v[72:75], a[68:71], v[20:23], v[72:75]
    v_cvt_pk_bf16_f32 v90, v64, v65
    s_waitcnt lgkmcnt(6)
    v_mfma_f32_16x16x32_bf16 v[76:79], a[64:67], v[24:27], v[76:79]
    ds_read_b128 v[20:23], v12 offset:24576
    v_mfma_f32_16x16x32_bf16 v[80:83], a[68:71], v[24:27], v[80:83]
    v_cvt_pk_bf16_f32 v91, v66, v67
    s_waitcnt lgkmcnt(6)
    v_mfma_f32_16x16x32_bf16 v[68:71], a[72:75], v[28:31], v[68:71]
    ds_read_b128 v[24:27], v12 offset:26624
    v_mfma_f32_16x16x32_bf16 v[72:75], a[76:79], v[28:31], v[72:75]
    s_waitcnt lgkmcnt(6)
    v_mfma_f32_16x16x32_bf16 v[76:79], a[72:75], v[32:35], v[76:79]
    ds_read_b128 v[28:31], v13 offset:24576
    v_mfma_f32_16x16x32_bf16 v[80:83], a[76:79], v[32:35], v[80:83]
    buffer_store_dwordx4 v[88:91], v4, s[12:15], s21 offen
    s_waitcnt lgkmcnt(6)
    v_mfma_f32_16x16x32_bf16 v[68:71], a[80:83], v[36:39], v[68:71]
    ds_read_b128 v[32:35], v13 offset:26624
    v_mfma_f32_16x16x32_bf16 v[72:75], a[84:87], v[36:39], v[72:75]
    s_add_u32 s21, s21, s25
    s_mov_b32 s25, s26
    s_waitcnt lgkmcnt(6)
    v_mfma_f32_16x16x32_bf16 v[76:79], a[80:83], v[40:43], v[76:79]
    ds_read_b128 v[36:39], v12 offset:28672
    v_mfma_f32_16x16x32_bf16 v[80:83], a[84:87], v[40:43], v[80:83]
    s_waitcnt lgkmcnt(6)
    v_mfma_f32_16x16x32_bf16 v[68:71], a[88:91], v[44:47], v[68:71]
    ds_read_b128 v[40:43], v12 offset:30720
    v_mfma_f32_16x16x32_bf16 v[72:75], a[92:95], v[44:47], v[72:75]
    s_waitcnt lgkmcnt(6)
    v_mfma_f32_16x16x32_bf16 v[76:79], a[88:91], v[48:51], v[76:79]
    ds_read_b128 v[44:47], v13 offset:28672
    v_mfma_f32_16x16x32_bf16 v[80:83], a[92:95], v[48:51], v[80:83]
    s_waitcnt lgkmcnt(6)
    v_mfma_f32_16x16x32_bf16 v[68:71], a[96:99], v[20:23], v[68:71]
    ds_read_b128 v[48:51], v13 offset:30720
    v_mfma_f32_16x16x32_bf16 v[72:75], a[100:103], v[20:23], v[72:75]
    s_waitcnt lgkmcnt(6)
    v_mfma_f32_16x16x32_bf16 v[76:79], a[96:99], v[24:27], v[76:79]
    s_waitcnt vmcnt(10)
    s_barrier
    ds_read_b128 v[20:23], v12 offset:32768
    v_mfma_f32_16x16x32_bf16 v[80:83], a[100:103], v[24:27], v[80:83]
    s_waitcnt lgkmcnt(6)
    v_mfma_f32_16x16x32_bf16 v[68:71], a[104:107], v[28:31], v[68:71]
    ds_read_b128 v[24:27], v12 offset:34816
    s_add_u32 m0, s19, 32768
    v_mfma_f32_16x16x32_bf16 v[72:75], a[108:111], v[28:31], v[72:75]
    s_add_u32 s17, s20, 2113536
    buffer_load_dwordx4 v2, s[4:7], s17 offen sc1 lds
    s_waitcnt lgkmcnt(6)
    v_mfma_f32_16x16x32_bf16 v[76:79], a[104:107], v[32:35], v[76:79]
    ds_read_b128 v[28:31], v13 offset:32768
    v_mfma_f32_16x16x32_bf16 v[80:83], a[108:111], v[32:35], v[80:83]
    s_waitcnt lgkmcnt(6)
    v_mfma_f32_16x16x32_bf16 v[68:71], a[112:115], v[36:39], v[68:71]
    ds_read_b128 v[32:35], v13 offset:34816
    s_add_u32 m0, s19, 36864
    v_mfma_f32_16x16x32_bf16 v[72:75], a[116:119], v[36:39], v[72:75]
    s_add_u32 s17, s20, 2377728
    buffer_load_dwordx4 v2, s[4:7], s17 offen sc1 lds
    s_waitcnt lgkmcnt(6)
    v_mfma_f32_16x16x32_bf16 v[76:79], a[112:115], v[40:43], v[76:79]
    ds_read_b128 v[36:39], v12 offset:36864
    v_mfma_f32_16x16x32_bf16 v[80:83], a[116:119], v[40:43], v[80:83]
    s_waitcnt lgkmcnt(6)
    v_mfma_f32_16x16x32_bf16 v[68:71], a[120:123], v[44:47], v[68:71]
    ds_read_b128 v[40:43], v12 offset:38912
    s_add_u32 m0, s19, 40960
    v_mfma_f32_16x16x32_bf16 v[72:75], a[124:127], v[44:47], v[72:75]
    s_add_u32 s17, s20, 2641920
    buffer_load_dwordx4 v2, s[4:7], s17 offen sc1 lds
    s_waitcnt lgkmcnt(6)
    v_mfma_f32_16x16x32_bf16 v[76:79], a[120:123], v[48:51], v[76:79]
    ds_read_b128 v[44:47], v13 offset:36864
    v_mfma_f32_16x16x32_bf16 v[80:83], a[124:127], v[48:51], v[80:83]
    s_waitcnt lgkmcnt(6)
    v_mfma_f32_16x16x32_bf16 v[68:71], a[128:131], v[20:23], v[68:71]
    ds_read_b128 v[48:51], v13 offset:38912
    v_mfma_f32_16x16x32_bf16 v[72:75], a[132:135], v[20:23], v[72:75]
    s_waitcnt lgkmcnt(6)
    v_mfma_f32_16x16x32_bf16 v[76:79], a[128:131], v[24:27], v[76:79]
    ds_read_b128 v[20:23], v12 offset:40960
    s_add_u32 m0, s19, 45056
    v_mfma_f32_16x16x32_bf16 v[80:83], a[132:135], v[24:27], v[80:83]
    s_add_u32 s17, s20, 2906112
    buffer_load_dwordx4 v2, s[4:7], s17 offen sc1 lds
    s_waitcnt lgkmcnt(6)
    v_mfma_f32_16x16x32_bf16 v[68:71], a[136:139], v[28:31], v[68:71]
    ds_read_b128 v[24:27], v12 offset:43008
    v_mfma_f32_16x16x32_bf16 v[72:75], a[140:143], v[28:31], v[72:75]
    s_waitcnt lgkmcnt(6)
    v_mfma_f32_16x16x32_bf16 v[76:79], a[136:139], v[32:35], v[76:79]
    ds_read_b128 v[28:31], v13 offset:40960
    s_add_u32 m0, s19, 49152
    v_mfma_f32_16x16x32_bf16 v[80:83], a[140:143], v[32:35], v[80:83]
    s_add_u32 s17, s20, 3170304
    buffer_load_dwordx4 v2, s[4:7], s17 offen sc1 lds
    s_waitcnt lgkmcnt(6)
    v_mfma_f32_16x16x32_bf16 v[68:71], a[144:147], v[36:39], v[68:71]
    ds_read_b128 v[32:35], v13 offset:43008
    v_mfma_f32_16x16x32_bf16 v[72:75], a[148:151], v[36:39], v[72:75]
    s_waitcnt lgkmcnt(6)
    v_mfma_f32_16x16x32_bf16 v[76:79], a[144:147], v[40:43], v[76:79]
    ds_read_b128 v[36:39], v12 offset:45056
    s_add_u32 m0, s19, 53248
    v_mfma_f32_16x16x32_bf16 v[80:83], a[148:151], v[40:43], v[80:83]
    s_add_u32 s17, s20, 3434496
    buffer_load_dwordx4 v2, s[4:7], s17 offen sc1 lds
    s_waitcnt lgkmcnt(6)
    v_mfma_f32_16x16x32_bf16 v[68:71], a[152:155], v[44:47], v[68:71]
    ds_read_b128 v[40:43], v12 offset:47104
    v_mfma_f32_16x16x32_bf16 v[72:75], a[156:159], v[44:47], v[72:75]
    s_waitcnt lgkmcnt(6)
    v_mfma_f32_16x16x32_bf16 v[76:79], a[152:155], v[48:51], v[76:79]
    ds_read_b128 v[44:47], v13 offset:45056
    s_add_u32 m0, s19, 57344
    v_mfma_f32_16x16x32_bf16 v[80:83], a[156:159], v[48:51], v[80:83]
    s_add_u32 s17, s20, 3698688
    buffer_load_dwordx4 v2, s[4:7], s17 offen sc1 lds
    s_waitcnt lgkmcnt(6)
    v_mfma_f32_16x16x32_bf16 v[68:71], a[160:163], v[20:23], v[68:71]
    ds_read_b128 v[48:51], v13 offset:47104
    v_mfma_f32_16x16x32_bf16 v[72:75], a[164:167], v[20:23], v[72:75]
    s_waitcnt lgkmcnt(6)
    v_mfma_f32_16x16x32_bf16 v[76:79], a[160:163], v[24:27], v[76:79]
    ds_read_b128 v[20:23], v12 offset:49152
    s_add_u32 m0, s19, 61440
    v_mfma_f32_16x16x32_bf16 v[80:83], a[164:167], v[24:27], v[80:83]
    s_add_u32 s17, s20, 3962880
    buffer_load_dwordx4 v2, s[4:7], s17 offen sc1 lds
    s_waitcnt lgkmcnt(6)
    v_mfma_f32_16x16x32_bf16 v[68:71], a[168:171], v[28:31], v[68:71]
    ds_read_b128 v[24:27], v12 offset:51200
    v_mfma_f32_16x16x32_bf16 v[72:75], a[172:175], v[28:31], v[72:75]
    s_add_u32 s20, s20, s24
    s_waitcnt lgkmcnt(6)
    v_mfma_f32_16x16x32_bf16 v[76:79], a[168:171], v[32:35], v[76:79]
    ds_read_b128 v[28:31], v13 offset:49152
    v_mfma_f32_16x16x32_bf16 v[80:83], a[172:175], v[32:35], v[80:83]
    s_waitcnt lgkmcnt(6)
    v_mfma_f32_16x16x32_bf16 v[68:71], a[176:179], v[36:39], v[68:71]
    ds_read_b128 v[32:35], v13 offset:51200
    v_mfma_f32_16x16x32_bf16 v[72:75], a[180:183], v[36:39], v[72:75]
    s_waitcnt lgkmcnt(6)
    v_mfma_f32_16x16x32_bf16 v[76:79], a[176:179], v[40:43], v[76:79]
    ds_read_b128 v[36:39], v12 offset:53248
    v_mfma_f32_16x16x32_bf16 v[80:83], a[180:183], v[40:43], v[80:83]
    s_waitcnt lgkmcnt(6)
    v_mfma_f32_16x16x32_bf16 v[68:71], a[184:187], v[44:47], v[68:71]
    ds_read_b128 v[40:43], v12 offset:55296
    v_mfma_f32_16x16x32_bf16 v[72:75], a[188:191], v[44:47], v[72:75]
    s_waitcnt lgkmcnt(6)
    v_mfma_f32_16x16x32_bf16 v[76:79], a[184:187], v[48:51], v[76:79]
    ds_read_b128 v[44:47], v13 offset:53248
    v_mfma_f32_16x16x32_bf16 v[80:83], a[188:191], v[48:51], v[80:83]
    s_waitcnt lgkmcnt(6)
    v_mfma_f32_16x16x32_bf16 v[68:71], a[192:195], v[20:23], v[68:71]
    ds_read_b128 v[48:51], v13 offset:55296
    v_mfma_f32_16x16x32_bf16 v[72:75], a[196:199], v[20:23], v[72:75]
    s_waitcnt lgkmcnt(6)
    v_mfma_f32_16x16x32_bf16 v[76:79], a[192:195], v[24:27], v[76:79]
    ds_read_b128 v[20:23], v12 offset:57344
    v_mfma_f32_16x16x32_bf16 v[80:83], a[196:199], v[24:27], v[80:83]
    s_waitcnt lgkmcnt(6)
    v_mfma_f32_16x16x32_bf16 v[68:71], a[200:203], v[28:31], v[68:71]
    ds_read_b128 v[24:27], v12 offset:59392
    v_mfma_f32_16x16x32_bf16 v[72:75], a[204:207], v[28:31], v[72:75]
    s_waitcnt lgkmcnt(6)
    v_mfma_f32_16x16x32_bf16 v[76:79], a[200:203], v[32:35], v[76:79]
    ds_read_b128 v[28:31], v13 offset:57344
    v_mfma_f32_16x16x32_bf16 v[80:83], a[204:207], v[32:35], v[80:83]
    s_waitcnt lgkmcnt(6)
    v_mfma_f32_16x16x32_bf16 v[68:71], a[208:211], v[36:39], v[68:71]
    ds_read_b128 v[32:35], v13 offset:59392
    v_mfma_f32_16x16x32_bf16 v[72:75], a[212:215], v[36:39], v[72:75]
    s_waitcnt lgkmcnt(6)
    v_mfma_f32_16x16x32_bf16 v[76:79], a[208:211], v[40:43], v[76:79]
    ds_read_b128 v[36:39], v12 offset:61440
    v_mfma_f32_16x16x32_bf16 v[80:83], a[212:215], v[40:43], v[80:83]
    s_waitcnt lgkmcnt(6)
    v_mfma_f32_16x16x32_bf16 v[68:71], a[216:219], v[44:47], v[68:71]
    ds_read_b128 v[40:43], v12 offset:63488
    v_mfma_f32_16x16x32_bf16 v[72:75], a[220:223], v[44:47], v[72:75]
    s_waitcnt lgkmcnt(6)
    v_mfma_f32_16x16x32_bf16 v[76:79], a[216:219], v[48:51], v[76:79]
    ds_read_b128 v[44:47], v13 offset:61440
    v_mfma_f32_16x16x32_bf16 v[80:83], a[220:223], v[48:51], v[80:83]
    s_waitcnt lgkmcnt(6)
    v_mfma_f32_16x16x32_bf16 v[68:71], a[224:227], v[20:23], v[68:71]
    ds_read_b128 v[48:51], v13 offset:63488
    v_mfma_f32_16x16x32_bf16 v[72:75], a[228:231], v[20:23], v[72:75]
    s_waitcnt lgkmcnt(6)
    v_mfma_f32_16x16x32_bf16 v[76:79], a[224:227], v[24:27], v[76:79]
    s_waitcnt vmcnt(8)
    s_barrier
    ds_read_b128 v[20:23], v10 offset:0
    v_mfma_f32_16x16x32_bf16 v[80:83], a[228:231], v[24:27], v[80:83]
    s_waitcnt lgkmcnt(6)
    v_mfma_f32_16x16x32_bf16 v[68:71], a[232:235], v[28:31], v[68:71]
    ds_read_b128 v[24:27], v10 offset:2048
    s_add_u32 m0, s19, 65536
    v_mfma_f32_16x16x32_bf16 v[72:75], a[236:239], v[28:31], v[72:75]
    s_add_u32 s17, s20, 0
    buffer_load_dwordx4 v2, s[4:7], s17 offen sc1 lds
    s_waitcnt lgkmcnt(6)
    v_mfma_f32_16x16x32_bf16 v[76:79], a[232:235], v[32:35], v[76:79]
    ds_read_b128 v[28:31], v11 offset:0
    v_mfma_f32_16x16x32_bf16 v[80:83], a[236:239], v[32:35], v[80:83]
    s_waitcnt lgkmcnt(6)
    v_mfma_f32_16x16x32_bf16 v[68:71], a[240:243], v[36:39], v[68:71]
    ds_read_b128 v[32:35], v11 offset:2048
    s_add_u32 m0, s19, 69632
    v_mfma_f32_16x16x32_bf16 v[72:75], a[244:247], v[36:39], v[72:75]
    s_add_u32 s17, s20, 264192
    buffer_load_dwordx4 v2, s[4:7], s17 offen sc1 lds
    s_waitcnt lgkmcnt(6)
    v_mfma_f32_16x16x32_bf16 v[76:79], a[240:243], v[40:43], v[76:79]
    ds_read_b128 v[36:39], v10 offset:4096
    v_mfma_f32_16x16x32_bf16 v[80:83], a[244:247], v[40:43], v[80:83]
    s_waitcnt lgkmcnt(6)
    v_mfma_f32_16x16x32_bf16 v[68:71], a[248:251], v[44:47], v[68:71]
    ds_read_b128 v[40:43], v10 offset:6144
    s_add_u32 m0, s19, 73728
    v_mfma_f32_16x16x32_bf16 v[72:75], a[252:255], v[44:47], v[72:75]
    s_add_u32 s17, s20, 528384
    buffer_load_dwordx4 v2, s[4:7], s17 offen sc1 lds
    s_waitcnt lgkmcnt(6)
    v_mfma_f32_16x16x32_bf16 v[76:79], a[248:251], v[48:51], v[76:79]
    ds_read_b128 v[44:47], v11 offset:4096
    v_mfma_f32_16x16x32_bf16 v[80:83], a[252:255], v[48:51], v[80:83]
    s_add_u32 s22, s22, 2
    s_cmp_lt_u32 s22, 16
    s_cbranch_scc1 F3_top
    v_cvt_pk_bf16_f32 v84, v68, v69
    v_cvt_pk_bf16_f32 v85, v70, v71
    v_cvt_pk_bf16_f32 v86, v72, v73
    v_cvt_pk_bf16_f32 v87, v74, v75
    v_cvt_pk_bf16_f32 v88, v76, v77
    v_cvt_pk_bf16_f32 v89, v78, v79
    v_cvt_pk_bf16_f32 v90, v80, v81
    v_cvt_pk_bf16_f32 v91, v82, v83
    buffer_store_dwordx4 v[84:87], v3, s[12:15], s21 offen
    buffer_store_dwordx4 v[88:91], v4, s[12:15], s21 offen
    s_waitcnt vmcnt(0) lgkmcnt(0)
    s_branch W_T
W_T:
    v_and_b32 v7, 19, v1
    v_bfe_u32 v5, v1, 2, 1
    v_bfe_u32 v6, v1, 3, 1
    v_lshl_add_u32 v7, v5, 3, v7
    v_lshl_add_u32 v7, v6, 2, v7
    v_lshrrev_b32 v5, 5, v1
    v_and_b32 v6, 31, v1
    v_lshlrev_b32 v8, 4, v5
    v_lshl_add_u32 v10, v6, 6, v8
    v_lshl_add_u32 v11, v7, 6, v8
    v_mov_b32 v17, 1073741824
    v_cmp_gt_u32 vcc, 8, v6
    s_nop 1
    v_cndmask_b32 v12, v17, v10, vcc
    v_lshlrev_b32 v13, 3, v5
    v_lshl_add_u32 v13, v7, 4, v13
    v_and_b32 v14, 15, v1
    v_lshlrev_b32 v14, 4, v14
    v_lshl_add_u32 v14, v5, 8, v14
    v_bfe_u32 v8, v1, 4, 1
    v_lshl_add_u32 v14, v8, 17, v14
    v_lshrrev_b32 v15, 2, v1
    v_and_b32 v8, 3, v1
    v_lshl_add_u32 v15, v15, 7, v8
    s_lshl_b32 s17, s91, 2
    v_add_u32 v15, s17, v15
    v_lshlrev_b32 v15, 7, v15
    v_add_u32 v15, 100663296, v15
    v_mov_b32 v16, 0
    s_lshl_b32 s18, s16, 7
    s_add_u32 s18, s18, s17
    s_add_u32 s18, s18, 100728832
    v_mov_b32 v4, s18
    v_cmp_eq_u32 vcc, 0, v1
    s_nop 1
    v_cndmask_b32 v4, v17, v4, vcc
    v_lshlrev_b32 v5, 3, v5
    v_sub_u32 v6, v6, v5
    s_mov_b32 s29, 1040356334
    s_mov_b32 s28, s16
    s_mul_i32 s31, s17, 133120
    s_lshl_b32 s18, s28, 11
    s_add_u32 s31, s31, s18
    s_mul_i32 s32, s17, 33280
    s_lshl_b32 s18, s28, 9
    s_add_u32 s32, s32, s18
    s_add_u32 s32, s32, 71303168
    s_lshl_b32 s33, s28, 18
    s_lshl_b32 s18, s91, 12
    s_add_u32 s33, s33, s18
    s_add_u32 s33, s33, 54525952
    v_mov_b32 v17, 0xff800000
    v_cmp_le_i32 s[36:37], 0, v6
    v_cmp_le_i32 s[38:39], 1, v6
    v_cmp_le_i32 s[40:41], 2, v6
    v_cmp_le_i32 s[42:43], 3, v6
    v_cmp_le_i32 s[44:45], 4, v6
    v_cmp_le_i32 s[46:47], 5, v6
    v_cmp_le_i32 s[48:49], 6, v6
    v_cmp_le_i32 s[50:51], 7, v6
    v_cmp_le_i32 s[52:53], 16, v6
    v_cmp_le_i32 s[54:55], 17, v6
    v_cmp_le_i32 s[56:57], 18, v6
    v_cmp_le_i32 s[58:59], 19, v6
    v_cmp_le_i32 s[60:61], 20, v6
    v_cmp_le_i32 s[62:63], 21, v6
    v_cmp_le_i32 s[64:65], 22, v6
    v_cmp_le_i32 s[66:67], 23, v6
    v_mov_b32 v150, 0
    v_mov_b32 v151, 0
    v_mov_b32 v154, 0
    v_mov_b32 v155, 0
    v_mov_b32 v158, 0
    v_mov_b32 v159, 0
    v_mov_b32 v162, 0
    v_mov_b32 v163, 0
    v_mov_b32 v206, 0
    v_mov_b32 v207, 0
T_top:
    s_mov_b32 s30, s92
T_fl:
    v_cmp_ge_u32 vcc, s28, v16
    s_nop 0
    s_and_b32 s17, vcc_lo, 0xfff
    s_cbranch_scc0 T_go
    s_cmp_ge_u32 s30, 1048576
    s_cselect_b32 s92, 1048576, s92
    s_cbranch_scc1 T_go
    s_add_u32 s30, s30, 1
    s_mov_b64 exec, 0xfff
    buffer_load_dword v16, v15, s[4:7], 0 offen sc1
    s_mov_b64 exec, -1
    s_sleep 8
    s_waitcnt vmcnt(0)
    s_branch T_fl
T_go:
    s_add_u32 s17, s31, 0
    buffer_load_dwordx4 v[20:23], v10, s[4:7], s17 offen offset:0 sc1
    buffer_load_dwordx4 v[24:27], v10, s[4:7], s17 offen offset:32 sc1
    s_add_u32 s17, s31, 133120
    buffer_load_dwordx4 v[28:31], v10, s[4:7], s17 offen offset:0 sc1
    buffer_load_dwordx4 v[32:35], v10, s[4:7], s17 offen offset:32 sc1
    s_add_u32 s17, s31, 266240
    buffer_load_dwordx4 v[36:39], v10, s[4:7], s17 offen offset:0 sc1
    buffer_load_dwordx4 v[40:43], v10, s[4:7], s17 offen offset:32 sc1
    s_add_u32 s17, s31, 399360
    buffer_load_dwordx4 v[44:47], v10, s[4:7], s17 offen offset:0 sc1
    buffer_load_dwordx4 v[48:51], v10, s[4:7], s17 offen offset:32 sc1
    s_add_u32 s17, s31, 17825792
    buffer_load_dwordx4 v[52:55], v11, s[4:7], s17 offen offset:0 sc1
    buffer_load_dwordx4 v[56:59], v11, s[4:7], s17 offen offset:32 sc1
    s_add_u32 s17, s31, 17958912
    buffer_load_dwordx4 v[60:63], v11, s[4:7], s17 offen offset:0 sc1
    buffer_load_dwordx4 v[64:67], v11, s[4:7], s17 offen offset:32 sc1
    s_add_u32 s17, s31, 18092032
    buffer_load_dwordx4 v[68:71], v11, s[4:7], s17 offen offset:0 sc1
    buffer_load_dwordx4 v[72:75], v11, s[4:7], s17 offen offset:32 sc1
    s_add_u32 s17, s31, 18225152
    buffer_load_dwordx4 v[76:79], v11, s[4:7], s17 offen offset:0 sc1
    buffer_load_dwordx4 v[80:83], v11, s[4:7], s17 offen offset:32 sc1
    s_add_u32 s17, s31, 35651584
    buffer_load_dwordx4 v[84:87], v11, s[4:7], s17 offen offset:0 sc1
    buffer_load_dwordx4 v[88:91], v11, s[4:7], s17 offen offset:32 sc1
    s_add_u32 s17, s31, 35784704
    buffer_load_dwordx4 v[92:95], v11, s[4:7], s17 offen offset:0 sc1
    buffer_load_dwordx4 v[96:99], v11, s[4:7], s17 offen offset:32 sc1
    s_add_u32 s17, s31, 35917824
    buffer_load_dwordx4 v[100:103], v11, s[4:7], s17 offen offset:0 sc1
    buffer_load_dwordx4 v[104:107], v11, s[4:7], s17 offen offset:32 sc1
    s_add_u32 s17, s31, 36050944
    buffer_load_dwordx4 v[108:111], v11, s[4:7], s17 offen offset:0 sc1
    buffer_load_dwordx4 v[112:115], v11, s[4:7], s17 offen offset:32 sc1
    s_add_u32 s17, s32, 0
    s_add_u32 s18, s32, 5242880
    buffer_load_dwordx4 v[116:119], v12, s[4:7], s17 offen offset:0 sc1
    buffer_load_dwordx4 v[120:123], v12, s[4:7], s17 offen offset:32 sc1
    buffer_load_dwordx2 v[148:149], v13, s[4:7], s18 offen sc1
    s_add_u32 s17, s32, 33280
    s_add_u32 s18, s32, 5276160
    buffer_load_dwordx4 v[124:127], v12, s[4:7], s17 offen offset:0 sc1
    buffer_load_dwordx4 v[128:131], v12, s[4:7], s17 offen offset:32 sc1
    buffer_load_dwordx2 v[152:153], v13, s[4:7], s18 offen sc1
    s_add_u32 s17, s32, 66560
    s_add_u32 s18, s32, 5309440
    buffer_load_dwordx4 v[132:135], v12, s[4:7], s17 offen offset:0 sc1
    buffer_load_dwordx4 v[136:139], v12, s[4:7], s17 offen offset:32 sc1
    buffer_load_dwordx2 v[156:157], v13, s[4:7], s18 offen sc1
    s_add_u32 s17, s32, 99840
    s_add_u32 s18, s32, 5342720
    buffer_load_dwordx4 v[140:143], v12, s[4:7], s17 offen offset:0 sc1
    buffer_load_dwordx4 v[144:147], v12, s[4:7], s17 offen offset:32 sc1
    buffer_load_dwordx2 v[160:161], v13, s[4:7], s18 offen sc1
    s_waitcnt vmcnt(20)
    v_mfma_f32_32x32x16_bf16 v[164:179], v[52:55], v[20:23], 0
    v_mfma_f32_32x32x16_bf16 v[164:179], v[56:59], v[24:27], v[164:179]
    v_mfma_f32_32x32x16_bf16 v[164:179], v[60:63], v[28:31], v[164:179]
    v_mfma_f32_32x32x16_bf16 v[164:179], v[64:67], v[32:35], v[164:179]
    v_mfma_f32_32x32x16_bf16 v[164:179], v[68:71], v[36:39], v[164:179]
    v_mfma_f32_32x32x16_bf16 v[164:179], v[72:75], v[40:43], v[164:179]
    v_mfma_f32_32x32x16_bf16 v[164:179], v[76:79], v[44:47], v[164:179]
    v_mfma_f32_32x32x16_bf16 v[164:179], v[80:83], v[48:51], v[164:179]
    s_mov_b32 s30, s92
    s_nop 10
    v_cndmask_b32 v164, v17, v164, s[36:37]
    v_cndmask_b32 v165, v17, v165, s[38:39]
    v_cndmask_b32 v166, v17, v166, s[40:41]
    v_cndmask_b32 v167, v17, v167, s[42:43]
    v_cndmask_b32 v168, v17, v168, s[44:45]
    v_cndmask_b32 v169, v17, v169, s[46:47]
    v_cndmask_b32 v170, v17, v170, s[48:49]
    v_cndmask_b32 v171, v17, v171, s[50:51]
    v_cndmask_b32 v172, v17, v172, s[52:53]
    v_cndmask_b32 v173, v17, v173, s[54:55]
    v_cndmask_b32 v174, v17, v174, s[56:57]
    v_cndmask_b32 v175, v17, v175, s[58:59]
    v_cndmask_b32 v176, v17, v176, s[60:61]
    v_cndmask_b32 v177, v17, v177, s[62:63]
    v_cndmask_b32 v178, v17, v178, s[64:65]
    v_cndmask_b32 v179, v17, v179, s[66:67]
    v_max3_f32 v18, v164, v165, v166
    v_max3_f32 v18, v18, v167, v168
    v_max3_f32 v18, v18, v169, v170
    v_max3_f32 v18, v18, v171, v172
    v_max3_f32 v18, v18, v173, v174
    v_max3_f32 v18, v18, v175, v176
    v_max3_f32 v18, v18, v177, v178
    v_max_f32 v18, v18, v179
T_mw:
    s_waitcnt vmcnt(0)
    v_max_u32 v5, v116, v117
    v_max3_u32 v5, v5, v118, v119
    v_max3_u32 v5, v5, v120, v121
    v_max3_u32 v5, v5, v122, v123
    v_max3_u32 v5, v5, v124, v125
    v_max3_u32 v5, v5, v126, v127
    v_max3_u32 v5, v5, v128, v129
    v_max3_u32 v5, v5, v130, v131
    v_max3_u32 v5, v5, v132, v133
    v_max3_u32 v5, v5, v134, v135
    v_max3_u32 v5, v5, v136, v137
    v_max3_u32 v5, v5, v138, v139
    v_max3_u32 v5, v5, v140, v141
    v_max3_u32 v5, v5, v142, v143
    v_max3_u32 v5, v5, v144, v145
    v_max3_u32 v5, v5, v146, v147
    v_max3_u32 v5, v5, v148, v149
    v_max3_u32 v5, v5, v152, v153
    v_max3_u32 v5, v5, v156, v157
    v_max3_u32 v5, v5, v160, v161
    v_cmp_eq_u32 vcc, -1, v5
    s_nop 0
    s_cbranch_vccz T_mok
    s_cmp_ge_u32 s30, 1048576
    s_cselect_b32 s92, 1048576, s92
    s_cbranch_scc1 T_mok
    s_add_u32 s30, s30, 1
    s_sleep 4
    s_add_u32 s17, s32, 0
    s_add_u32 s18, s32, 5242880
    buffer_load_dwordx4 v[116:119], v12, s[4:7], s17 offen offset:0 sc1
    buffer_load_dwordx4 v[120:123], v12, s[4:7], s17 offen offset:32 sc1
    buffer_load_dwordx2 v[148:149], v13, s[4:7], s18 offen sc1
    s_add_u32 s17, s32, 33280
    s_add_u32 s18, s32, 5276160
    buffer_load_dwordx4 v[124:127], v12, s[4:7], s17 offen offset:0 sc1
    buffer_load_dwordx4 v[128:131], v12, s[4:7], s17 offen offset:32 sc1
    buffer_load_dwordx2 v[152:153], v13, s[4:7], s18 offen sc1
    s_add_u32 s17, s32, 66560
    s_add_u32 s18, s32, 5309440
    buffer_load_dwordx4 v[132:135], v12, s[4:7], s17 offen offset:0 sc1
    buffer_load_dwordx4 v[136:139], v12, s[4:7], s17 offen offset:32 sc1
    buffer_load_dwordx2 v[156:157], v13, s[4:7], s18 offen sc1
    s_add_u32 s17, s32, 99840
    s_add_u32 s18, s32, 5342720
    buffer_load_dwordx4 v[140:143], v12, s[4:7], s17 offen offset:0 sc1
    buffer_load_dwordx4 v[144:147], v12, s[4:7], s17 offen offset:32 sc1
    buffer_load_dwordx2 v[160:161], v13, s[4:7], s18 offen sc1
    s_branch T_mw
T_mok:
    v_mfma_f32_32x32x16_bf16 v[180:195], v[116:119], v[20:23], 0
    v_mfma_f32_32x32x16_bf16 v[180:195], v[120:123], v[24:27], v[180:195]
    v_mfma_f32_32x32x16_bf16 v[180:195], v[124:127], v[28:31], v[180:195]
    v_mfma_f32_32x32x16_bf16 v[180:195], v[128:131], v[32:35], v[180:195]
    v_mfma_f32_32x32x16_bf16 v[180:195], v[132:135], v[36:39], v[180:195]
    v_mfma_f32_32x32x16_bf16 v[180:195], v[136:139], v[40:43], v[180:195]
    v_mfma_f32_32x32x16_bf16 v[180:195], v[140:143], v[44:47], v[180:195]
    v_mfma_f32_32x32x16_bf16 v[180:195], v[144:147], v[48:51], v[180:195]
    s_nop 11
    v_max3_f32 v18, v18, v180, v181
    v_max3_f32 v18, v18, v182, v183
    v_mov_b32 v5, v18
    s_nop 1
    v_permlane32_swap_b32 v18, v5
    v_max_f32 v18, v18, v5
    v_mul_f32 v18, s29, v18
    v_fma_f32 v164, v164, s29, -v18
    v_fma_f32 v165, v165, s29, -v18
    v_fma_f32 v166, v166, s29, -v18
    v_fma_f32 v167, v167, s29, -v18
    v_fma_f32 v168, v168, s29, -v18
    v_fma_f32 v169, v169, s29, -v18
    v_fma_f32 v170, v170, s29, -v18
    v_fma_f32 v171, v171, s29, -v18
    v_fma_f32 v172, v172, s29, -v18
    v_fma_f32 v173, v173, s29, -v18
    v_fma_f32 v174, v174, s29, -v18
    v_fma_f32 v175, v175, s29, -v18
    v_fma_f32 v176, v176, s29, -v18
    v_fma_f32 v177, v177, s29, -v18
    v_fma_f32 v178, v178, s29, -v18
    v_fma_f32 v179, v179, s29, -v18
    v_fma_f32 v180, v180, s29, -v18
    v_fma_f32 v181, v181, s29, -v18
    v_fma_f32 v182, v182, s29, -v18
    v_fma_f32 v183, v183, s29, -v18
    v_exp_f32 v164, v164
    v_exp_f32 v165, v165
    v_exp_f32 v166, v166
    v_exp_f32 v167, v167
    v_exp_f32 v168, v168
    v_exp_f32 v169, v169
    v_exp_f32 v170, v170
    v_exp_f32 v171, v171
    v_exp_f32 v172, v172
    v_exp_f32 v173, v173
    v_exp_f32 v174, v174
    v_exp_f32 v175, v175
    v_exp_f32 v176, v176
    v_exp_f32 v177, v177
    v_exp_f32 v178, v178
    v_exp_f32 v179, v179
    v_exp_f32 v180, v180
    v_exp_f32 v181, v181
    v_exp_f32 v182, v182
    v_exp_f32 v183, v183
    v_add_f32 v19, v164, v165
    v_add_f32 v6, v166, v167
    v_add_f32 v19, v19, v168
    v_add_f32 v6, v6, v169
    v_add_f32 v19, v19, v170
    v_add_f32 v6, v6, v171
    v_add_f32 v19, v19, v172
    v_add_f32 v6, v6, v173
    v_add_f32 v19, v19, v174
    v_add_f32 v6, v6, v175
    v_add_f32 v19, v19, v176
    v_add_f32 v6, v6, v177
    v_add_f32 v19, v19, v178
    v_add_f32 v6, v6, v179
    v_add_f32 v19, v19, v180
    v_add_f32 v6, v6, v181
    v_add_f32 v19, v19, v182
    v_add_f32 v6, v6, v183
    v_add_f32 v19, v19, v6
    v_mov_b32 v5, v19
    s_nop 1
    v_permlane32_swap_b32 v19, v5
    v_add_f32 v19, v19, v5
    v_rcp_f32 v19, v19
    s_nop 0
    v_mul_f32 v164, v164, v19
    v_mul_f32 v165, v165, v19
    v_mul_f32 v166, v166, v19
    v_mul_f32 v167, v167, v19
    v_mul_f32 v168, v168, v19
    v_mul_f32 v169, v169, v19
    v_mul_f32 v170, v170, v19
    v_mul_f32 v171, v171, v19
    v_mul_f32 v172, v172, v19
    v_mul_f32 v173, v173, v19
    v_mul_f32 v174, v174, v19
    v_mul_f32 v175, v175, v19
    v_mul_f32 v176, v176, v19
    v_mul_f32 v177, v177, v19
    v_mul_f32 v178, v178, v19
    v_mul_f32 v179, v179, v19
    v_mul_f32 v180, v180, v19
    v_mul_f32 v181, v181, v19
    v_mul_f32 v182, v182, v19
    v_mul_f32 v183, v183, v19
    v_cvt_pk_bf16_f32 v196, v164, v165
    v_cvt_pk_bf16_f32 v197, v166, v167
    v_cvt_pk_bf16_f32 v198, v168, v169
    v_cvt_pk_bf16_f32 v199, v170, v171
    v_cvt_pk_bf16_f32 v200, v172, v173
    v_cvt_pk_bf16_f32 v201, v174, v175
    v_cvt_pk_bf16_f32 v202, v176, v177
    v_cvt_pk_bf16_f32 v203, v178, v179
    v_cvt_pk_bf16_f32 v204, v180, v181
    v_cvt_pk_bf16_f32 v205, v182, v183
    v_mfma_f32_32x32x16_bf16 v[20:35], v[84:87], v[196:199], 0
    v_mfma_f32_32x32x16_bf16 v[20:35], v[88:91], v[200:203], v[20:35]
    v_mfma_f32_32x32x16_bf16 v[20:35], v[148:151], v[204:207], v[20:35]
    v_mfma_f32_32x32x16_bf16 v[36:51], v[92:95], v[196:199], 0
    v_mfma_f32_32x32x16_bf16 v[36:51], v[96:99], v[200:203], v[36:51]
    v_mfma_f32_32x32x16_bf16 v[36:51], v[152:155], v[204:207], v[36:51]
    s_nop 2
    v_cvt_pk_bf16_f32 v208, v20, v21
    v_cvt_pk_bf16_f32 v209, v22, v23
    v_cvt_pk_bf16_f32 v210, v24, v25
    v_cvt_pk_bf16_f32 v211, v26, v27
    v_cvt_pk_bf16_f32 v212, v28, v29
    v_cvt_pk_bf16_f32 v213, v30, v31
    v_cvt_pk_bf16_f32 v214, v32, v33
    v_cvt_pk_bf16_f32 v215, v34, v35
    buffer_store_dwordx4 v[208:211], v14, s[4:7], s33 offen offset:0 sc1
    buffer_store_dwordx4 v[212:215], v14, s[4:7], s33 offen offset:512 sc1
    v_mfma_f32_32x32x16_bf16 v[52:67], v[100:103], v[196:199], 0
    v_mfma_f32_32x32x16_bf16 v[52:67], v[104:107], v[200:203], v[52:67]
    v_mfma_f32_32x32x16_bf16 v[52:67], v[156:159], v[204:207], v[52:67]
    v_cvt_pk_bf16_f32 v216, v36, v37
    v_cvt_pk_bf16_f32 v217, v38, v39
    v_cvt_pk_bf16_f32 v218, v40, v41
    v_cvt_pk_bf16_f32 v219, v42, v43
    v_cvt_pk_bf16_f32 v220, v44, v45
    v_cvt_pk_bf16_f32 v221, v46, v47
    v_cvt_pk_bf16_f32 v222, v48, v49
    v_cvt_pk_bf16_f32 v223, v50, v51
    buffer_store_dwordx4 v[216:219], v14, s[4:7], s33 offen offset:1024 sc1
    buffer_store_dwordx4 v[220:223], v14, s[4:7], s33 offen offset:1536 sc1
    v_mfma_f32_32x32x16_bf16 v[68:83], v[108:111], v[196:199], 0
    v_mfma_f32_32x32x16_bf16 v[68:83], v[112:115], v[200:203], v[68:83]
    v_mfma_f32_32x32x16_bf16 v[68:83], v[160:163], v[204:207], v[68:83]
    v_cvt_pk_bf16_f32 v224, v52, v53
    v_cvt_pk_bf16_f32 v225, v54, v55
    v_cvt_pk_bf16_f32 v226, v56, v57
    v_cvt_pk_bf16_f32 v227, v58, v59
    v_cvt_pk_bf16_f32 v228, v60, v61
    v_cvt_pk_bf16_f32 v229, v62, v63
    v_cvt_pk_bf16_f32 v230, v64, v65
    v_cvt_pk_bf16_f32 v231, v66, v67
    buffer_store_dwordx4 v[224:227], v14, s[4:7], s33 offen offset:2048 sc1
    buffer_store_dwordx4 v[228:231], v14, s[4:7], s33 offen offset:2560 sc1
    s_nop 1
    v_cvt_pk_bf16_f32 v232, v68, v69
    v_cvt_pk_bf16_f32 v233, v70, v71
    v_cvt_pk_bf16_f32 v234, v72, v73
    v_cvt_pk_bf16_f32 v235, v74, v75
    v_cvt_pk_bf16_f32 v236, v76, v77
    v_cvt_pk_bf16_f32 v237, v78, v79
    v_cvt_pk_bf16_f32 v238, v80, v81
    v_cvt_pk_bf16_f32 v239, v82, v83
    buffer_store_dwordx4 v[232:235], v14, s[4:7], s33 offen offset:3072 sc1
    buffer_store_dwordx4 v[236:239], v14, s[4:7], s33 offen offset:3584 sc1
    s_add_u32 s28, s28, 4
    s_lshr_b32 s17, s28, 2
    v_mov_b32 v9, s17
    s_add_u32 s31, s31, 8192
    s_add_u32 s32, s32, 2048
    s_add_u32 s33, s33, 1048576
    s_waitcnt vmcnt(0)
    buffer_store_dword v9, v4, s[4:7], 0 offen sc1
    s_cmp_lt_u32 s28, 64
    s_cbranch_scc1 T_top
    s_branch W_fin
W_fin:
W_end:
    s_endpgm
R_entry:
    s_mov_b32 s12, s3
    s_lshr_b32 s13, s2, 3
    s_load_dwordx2 s[4:5], s[0:1], 96
    s_load_dwordx2 s[28:29], s[0:1], 32
    s_load_dwordx2 s[30:31], s[0:1], 40
    s_load_dwordx2 s[32:33], s[0:1], 48
    s_load_dwordx2 s[34:35], s[0:1], 56
    s_load_dwordx2 s[36:37], s[0:1], 64
    v_lshrrev_b32 v19, 6, v0
    v_and_b32 v1, 63, v0
    v_readfirstlane_b32 s14, v19
    s_mov_b32 s6, 268435456
    s_mov_b32 s7, 0x20000
    s_mov_b32 s10, 8388608
    s_mov_b32 s11, 0x20000
    s_mov_b32 s25, 0
    s_mov_b32 s24, 1040356334
    s_waitcnt lgkmcnt(0)
    v_and_b32 v96, 7, v1
    v_bfe_u32 v97, v1, 3, 1
    v_lshrrev_b32 v98, 4, v1
    v_lshlrev_b32 v19, 4, v1
    s_lshl_b32 s21, s12, 14
    s_lshl_b32 s22, s14, 12
    s_add_u32 s21, s21, s22
    s_add_u32 s22, s21, 0
    v_add_u32 v2, s22, v19
    s_add_u32 s22, s21, 229376
    v_add_u32 v8, s22, v19
    s_lshr_b32 s21, s13, 1
    s_lshl_b32 s21, s21, 10
    s_and_b32 s22, s13, 1
    s_lshl_b32 s22, s22, 7
    s_add_u32 s21, s21, s22
    s_lshl_b32 s22, s12, 14
    s_add_u32 s21, s21, s22
    v_lshlrev_b32 v20, 8, v98
    v_lshl_add_u32 v20, v96, 4, v20
    v_lshl_add_u32 v20, v97, 3, v20
    s_add_u32 s22, s21, 229376
    v_add_u32 v7, s22, v20
    s_add_u32 s22, s21, 0
    v_add_u32 v11, s22, v20
    s_lshr_b32 s21, s13, 1
    s_lshl_b32 s21, s21, 14
    s_and_b32 s22, s13, 1
    s_lshl_b32 s22, s22, 12
    s_add_u32 s21, s21, s22
    s_lshl_b32 s22, s12, 10
    s_add_u32 s22, s21, s22
    v_add_u32 v9, s22, v19
    v_xor_b32 v10, 1024, v9
    v_xor_b32 v23, 2048, v9
    v_xor_b32 v244, 3072, v9
    s_mov_b32 s95, 167772160
    s_lshr_b32 s40, s13, 2
    s_lshl_b32 s21, s12, 3
    s_add_u32 s40, s40, s21
    s_and_b32 s41, s13, 3
    s_mul_i32 s21, s40, 5120
    s_add_u32 s21, s21, 65536
    v_add_u32 v5, s21, v19
    v_lshrrev_b32 v20, 3, v1
    v_lshlrev_b32 v20, 2, v20
    v_lshl_add_u32 v20, v96, 5, v20
    s_add_u32 s22, s21, 4096
    v_add_u32 v6, s22, v20
    s_lshl_b32 s22, s41, 10
    s_add_u32 s22, s22, s21
    v_add_u32 v3, s22, v19
    v_mov_b32 v21, 1073741824
    v_cmp_eq_u32 vcc, 0, v97
    s_nop 1
    v_cndmask_b32 v3, v21, v3, vcc
    s_lshl_b32 s22, s41, 8
    s_add_u32 s22, s22, s21
    s_add_u32 s22, s22, 4064
    v_lshlrev_b32 v20, 4, v98
    v_lshl_add_u32 v20, v96, 5, v20
    v_add_u32 v4, s22, v20
    v_cndmask_b32 v4, v21, v4, vcc
    v_cmp_le_u32 vcc, 2, v98
    s_nop 1
    v_cndmask_b32 v4, v21, v4, vcc
    s_lshl_b32 s27, s40, 7
    s_lshl_b32 s21, s41, 5
    s_add_u32 s27, s27, s21
    v_bfe_u32 v20, v1, 2, 2
    v_and_b32 v22, 3, v1
    v_lshl_add_u32 v20, v20, 3, v22
    v_lshlrev_b32 v12, 6, v20
    v_lshl_add_u32 v12, v98, 4, v12
    s_and_b32 s21, s14, 1
    s_lshl_b32 s21, s21, 14
    s_lshl_b32 s22, s27, 2
    s_add_u32 s21, s21, s22
    s_add_u32 s21, s21, 100679680
    v_mov_b32 v245, s21
    s_mov_b32 s85, 0
    s_mul_i32 s21, s27, 4160
    v_add_u32 v12, s21, v12
    v_mov_b32 v13, v12
    v_lshlrev_b32 v15, 4, v20
    v_lshl_add_u32 v15, v98, 5, v15
    s_mul_i32 s21, s27, 1040
    v_add_u32 v15, s21, v15
    v_and_b32 v22, 1, v98
    v_cmp_eq_u32 vcc, 0, v22
    s_nop 1
    v_cndmask_b32 v15, v21, v15, vcc
    v_lshlrev_b32 v14, 6, v96
    v_lshl_add_u32 v14, v98, 4, v14
    v_add_u32 v14, s21, v14
    v_cmp_eq_u32 vcc, 1, v97
    s_nop 1
    v_cndmask_b32 v14, v21, v14, vcc
    v_mov_b32 v16, v19
    s_lshl_b32 s21, s14, 11
    v_add_u32 v17, s21, v19
    v_and_b32 v20, 15, v1
    v_bfe_u32 v22, v1, 2, 2
    v_and_b32 v18, 1, v1
    v_lshl_add_u32 v18, v22, 1, v18
    v_bfe_u32 v22, v1, 1, 1
    v_lshl_add_u32 v18, v22, 3, v18
    s_cmp_eq_u32 s14, 1
    s_cselect_b64 vcc, -1, 0
    v_cndmask_b32 v20, v20, v18, vcc
    v_and_b32 v22, 1, v98
    v_lshlrev_b32 v22, 2, v22
    v_sub_u32 v20, v20, v22
    v_mov_b32 v22, 0x3f80
    v_mov_b32 v18, 0x3f800000
    v_mov_b32 v172, 0x4444
    v_mov_b32 v84, 0xeeee
    v_cmp_eq_u32 vcc, 1, v97
    s_nop 1
    v_cndmask_b32 v172, v172, v84, vcc
    v_cmp_eq_u32 vcc, 0, v20
    s_nop 1
    v_cndmask_b32 v84, 0, v22, vcc
    v_cmp_eq_u32 vcc, 1, v20
    s_nop 1
    v_cndmask_b32 v84, v84, v18, vcc
    v_cmp_eq_u32 vcc, 2, v20
    s_nop 1
    v_cndmask_b32 v85, 0, v22, vcc
    v_cmp_eq_u32 vcc, 3, v20
    s_nop 1
    v_cndmask_b32 v85, v85, v18, vcc
    v_cmp_eq_u32 vcc, 8, v20
    s_nop 1
    v_cndmask_b32 v86, 0, v22, vcc
    v_cmp_eq_u32 vcc, 9, v20
    s_nop 1
    v_cndmask_b32 v86, v86, v18, vcc
    v_cmp_eq_u32 vcc, 10, v20
    s_nop 1
    v_cndmask_b32 v87, 0, v22, vcc
    v_cmp_eq_u32 vcc, 11, v20
    s_nop 1
    v_cndmask_b32 v87, v87, v18, vcc
    s_mov_b32 s16, 81788928
    s_mov_b32 s42, 82083840
    s_mov_b32 s43, 82378752
    s_mov_b32 s44, 82673664
    s_mov_b32 s17, 17825792
    s_mov_b32 s18, 35651584
    s_mov_b32 s19, 71303168
    s_mov_b32 s20, 76546048
    s_mov_b32 s15, 0
    v_mov_b32 v204, -1
    v_mov_b32 v205, -1
    v_mov_b32 v206, -1
    v_mov_b32 v207, -1
    v_mov_b32 v236, 0x3f803f80
    v_mov_b32 v237, 0x3f803f80
    v_mov_b32 v238, 0x3f803f80
    v_mov_b32 v239, 0x3f803f80
    s_mul_i32 s22, s14, 294912
    s_add_u32 s22, s22, 81788928
    buffer_store_dwordx4 v[204:207], v3, s[4:7], s22 offen sc1
    buffer_store_dwordx4 v[204:207], v3, s[4:7], s22 offen offset:128 sc1
    buffer_store_dwordx4 v[204:207], v4, s[4:7], s22 offen sc1
    buffer_store_dwordx2 v[204:205], v7, s[4:7], s22 offen sc1
    buffer_store_dwordx2 v[204:205], v11, s[4:7], s22 offen sc1
    s_lshl_b32 s22, s14, 18
    s_add_u32 s22, s22, 167772160
    buffer_store_dwordx4 v[204:207], v9, s[4:7], s22 offen sc1
    s_add_u32 s22, s22, 8192
    buffer_store_dwordx4 v[204:207], v9, s[4:7], s22 offen sc1
    s_mul_i32 s22, s27, 1040
    v_add_u32 v246, s22, v16
    s_lshl_b32 s21, s14, 10
    s_add_u32 s22, s21, 71303168
    buffer_store_dwordx4 v[204:207], v246, s[4:7], s22 offen sc1
    s_add_u32 s22, s21, 76546048
    buffer_store_dwordx4 v[204:207], v246, s[4:7], s22 offen sc1
    v_add_u32 v20, 5242368, v246
    v_cmp_gt_u32 vcc, 32, v1
    s_nop 1
    v_cndmask_b32 v246, v20, v246, vcc
    s_waitcnt vmcnt(0)
    s_barrier
    s_cmp_lg_u32 s14, 0
    s_cbranch_scc1 reg_19
    s_and_b32 s21, s2, 3
    s_lshl_b32 s21, s21, 3
    s_lshl_b32 s22, s98, 2
    s_add_u32 s21, s21, s22
    s_lshl_b32 s21, 1, s21
    s_andn2_b32 s22, s2, 3
    v_mov_b32 v20, s22
    v_mov_b32 v21, s21
    s_mov_b64 exec, 1
    global_atomic_add v20, v21, s[100:101] sc1
    s_mov_b64 exec, -1
reg_19:
    v_lshrrev_b32 v19, 2, v1
    v_and_b32 v22, 3, v1
    v_lshlrev_b32 v22, 4, v22
    v_lshl_add_u32 v20, v19, 13, v22
    v_lshl_add_u32 v21, v19, 11, v22
    v_bfe_u32 v19, v1, 2, 1
    v_lshl_add_u32 v19, v98, 2, v19
    v_lshl_add_u32 v19, v97, 5, v19
    v_lshl_add_u32 v22, v19, 6, v22
    s_lshl_b32 s21, s14, 15
    v_add_u32 v22, s21, v22
    s_mov_b32 s8, s30
    s_mov_b32 s9, s31
    s_lshl_b32 s21, s14, 21
    s_lshl_b32 s22, s27, 1
    s_add_u32 s21, s21, s22
    s_lshl_b32 s22, s14, 15
    s_add_u32 s22, s22, 0
    s_mov_b32 m0, s22
    s_nop 0
    buffer_load_dwordx4 v20, s[8:11], s21 offen lds
    s_add_u32 s21, s21, 131072
    s_add_u32 s22, s22, 1024
    s_mov_b32 m0, s22
    s_nop 0
    buffer_load_dwordx4 v20, s[8:11], s21 offen lds
    s_add_u32 s21, s21, 131072
    s_add_u32 s22, s22, 1024
    s_mov_b32 m0, s22
    s_nop 0
    buffer_load_dwordx4 v20, s[8:11], s21 offen lds
    s_add_u32 s21, s21, 131072
    s_add_u32 s22, s22, 1024
    s_mov_b32 m0, s22
    s_nop 0
    buffer_load_dwordx4 v20, s[8:11], s21 offen lds
    s_add_u32 s21, s21, 131072
    s_add_u32 s22, s22, 1024
    s_mov_b32 m0, s22
    s_nop 0
    buffer_load_dwordx4 v20, s[8:11], s21 offen lds
    s_add_u32 s21, s21, 131072
    s_add_u32 s22, s22, 1024
    s_mov_b32 m0, s22
    s_nop 0
    buffer_load_dwordx4 v20, s[8:11], s21 offen lds
    s_add_u32 s21, s21, 131072
    s_add_u32 s22, s22, 1024
    s_mov_b32 m0, s22
    s_nop 0
    buffer_load_dwordx4 v20, s[8:11], s21 offen lds
    s_add_u32 s21, s21, 131072
    s_add_u32 s22, s22, 1024
    s_mov_b32 m0, s22
    s_nop 0
    buffer_load_dwordx4 v20, s[8:11], s21 offen lds
    s_add_u32 s21, s21, 131072
    s_add_u32 s22, s22, 1024
    s_mov_b32 m0, s22
    s_nop 0
    buffer_load_dwordx4 v20, s[8:11], s21 offen lds
    s_add_u32 s21, s21, 131072
    s_add_u32 s22, s22, 1024
    s_mov_b32 m0, s22
    s_nop 0
    buffer_load_dwordx4 v20, s[8:11], s21 offen lds
    s_add_u32 s21, s21, 131072
    s_add_u32 s22, s22, 1024
    s_mov_b32 m0, s22
    s_nop 0
    buffer_load_dwordx4 v20, s[8:11], s21 offen lds
    s_add_u32 s21, s21, 131072
    s_add_u32 s22, s22, 1024
    s_mov_b32 m0, s22
    s_nop 0
    buffer_load_dwordx4 v20, s[8:11], s21 offen lds
    s_add_u32 s21, s21, 131072
    s_add_u32 s22, s22, 1024
    s_mov_b32 m0, s22
    s_nop 0
    buffer_load_dwordx4 v20, s[8:11], s21 offen lds
    s_add_u32 s21, s21, 131072
    s_add_u32 s22, s22, 1024
    s_mov_b32 m0, s22
    s_nop 0
    buffer_load_dwordx4 v20, s[8:11], s21 offen lds
    s_add_u32 s21, s21, 131072
    s_add_u32 s22, s22, 1024
    s_mov_b32 m0, s22
    s_nop 0
    buffer_load_dwordx4 v20, s[8:11], s21 offen lds
    s_add_u32 s21, s21, 131072
    s_add_u32 s22, s22, 1024
    s_mov_b32 m0, s22
    s_nop 0
    buffer_load_dwordx4 v20, s[8:11], s21 offen lds
    s_add_u32 s21, s21, 131072
    s_add_u32 s22, s22, 1024
    s_mov_b32 s8, s32
    s_mov_b32 s9, s33
    s_lshl_b32 s21, s14, 21
    s_lshl_b32 s22, s27, 1
    s_add_u32 s21, s21, s22
    s_lshl_b32 s22, s14, 15
    s_add_u32 s22, s22, 16384
    s_mov_b32 m0, s22
    s_nop 0
    buffer_load_dwordx4 v20, s[8:11], s21 offen lds
    s_add_u32 s21, s21, 131072
    s_add_u32 s22, s22, 1024
    s_mov_b32 m0, s22
    s_nop 0
    buffer_load_dwordx4 v20, s[8:11], s21 offen lds
    s_add_u32 s21, s21, 131072
    s_add_u32 s22, s22, 1024
    s_mov_b32 m0, s22
    s_nop 0
    buffer_load_dwordx4 v20, s[8:11], s21 offen lds
    s_add_u32 s21, s21, 131072
    s_add_u32 s22, s22, 1024
    s_mov_b32 m0, s22
    s_nop 0
    buffer_load_dwordx4 v20, s[8:11], s21 offen lds
    s_add_u32 s21, s21, 131072
    s_add_u32 s22, s22, 1024
    s_mov_b32 m0, s22
    s_nop 0
    buffer_load_dwordx4 v20, s[8:11], s21 offen lds
    s_add_u32 s21, s21, 131072
    s_add_u32 s22, s22, 1024
    s_mov_b32 m0, s22
    s_nop 0
    buffer_load_dwordx4 v20, s[8:11], s21 offen lds
    s_add_u32 s21, s21, 131072
    s_add_u32 s22, s22, 1024
    s_mov_b32 m0, s22
    s_nop 0
    buffer_load_dwordx4 v20, s[8:11], s21 offen lds
    s_add_u32 s21, s21, 131072
    s_add_u32 s22, s22, 1024
    s_mov_b32 m0, s22
    s_nop 0
    buffer_load_dwordx4 v20, s[8:11], s21 offen lds
    s_add_u32 s21, s21, 131072
    s_add_u32 s22, s22, 1024
    s_mov_b32 m0, s22
    s_nop 0
    buffer_load_dwordx4 v20, s[8:11], s21 offen lds
    s_add_u32 s21, s21, 131072
    s_add_u32 s22, s22, 1024
    s_mov_b32 m0, s22
    s_nop 0
    buffer_load_dwordx4 v20, s[8:11], s21 offen lds
    s_add_u32 s21, s21, 131072
    s_add_u32 s22, s22, 1024
    s_mov_b32 m0, s22
    s_nop 0
    buffer_load_dwordx4 v20, s[8:11], s21 offen lds
    s_add_u32 s21, s21, 131072
    s_add_u32 s22, s22, 1024
    s_mov_b32 m0, s22
    s_nop 0
    buffer_load_dwordx4 v20, s[8:11], s21 offen lds
    s_add_u32 s21, s21, 131072
    s_add_u32 s22, s22, 1024
    s_mov_b32 m0, s22
    s_nop 0
    buffer_load_dwordx4 v20, s[8:11], s21 offen lds
    s_add_u32 s21, s21, 131072
    s_add_u32 s22, s22, 1024
    s_mov_b32 m0, s22
    s_nop 0
    buffer_load_dwordx4 v20, s[8:11], s21 offen lds
    s_add_u32 s21, s21, 131072
    s_add_u32 s22, s22, 1024
    s_mov_b32 m0, s22
    s_nop 0
    buffer_load_dwordx4 v20, s[8:11], s21 offen lds
    s_add_u32 s21, s21, 131072
    s_add_u32 s22, s22, 1024
    s_mov_b32 m0, s22
    s_nop 0
    buffer_load_dwordx4 v20, s[8:11], s21 offen lds
    s_add_u32 s21, s21, 131072
    s_add_u32 s22, s22, 1024
    s_waitcnt vmcnt(0)
    ds_read_b64_tr_b16 a[0:1], v22 offset:0
    ds_read_b64_tr_b16 a[2:3], v22 offset:128
    ds_read_b64_tr_b16 a[4:5], v22 offset:1024
    ds_read_b64_tr_b16 a[6:7], v22 offset:1152
    ds_read_b64_tr_b16 a[8:9], v22 offset:4096
    ds_read_b64_tr_b16 a[10:11], v22 offset:4224
    ds_read_b64_tr_b16 a[12:13], v22 offset:5120
    ds_read_b64_tr_b16 a[14:15], v22 offset:5248
    ds_read_b64_tr_b16 a[16:17], v22 offset:8192
    ds_read_b64_tr_b16 a[18:19], v22 offset:8320
    ds_read_b64_tr_b16 a[20:21], v22 offset:9216
    ds_read_b64_tr_b16 a[22:23], v22 offset:9344
    ds_read_b64_tr_b16 a[24:25], v22 offset:12288
    ds_read_b64_tr_b16 a[26:27], v22 offset:12416
    ds_read_b64_tr_b16 a[28:29], v22 offset:13312
    ds_read_b64_tr_b16 a[30:31], v22 offset:13440
    s_waitcnt lgkmcnt(0)
    ds_read_b64_tr_b16 a[32:33], v22 offset:8
    ds_read_b64_tr_b16 a[34:35], v22 offset:136
    ds_read_b64_tr_b16 a[36:37], v22 offset:1032
    ds_read_b64_tr_b16 a[38:39], v22 offset:1160
    ds_read_b64_tr_b16 a[40:41], v22 offset:4104
    ds_read_b64_tr_b16 a[42:43], v22 offset:4232
    ds_read_b64_tr_b16 a[44:45], v22 offset:5128
    ds_read_b64_tr_b16 a[46:47], v22 offset:5256
    ds_read_b64_tr_b16 a[48:49], v22 offset:8200
    ds_read_b64_tr_b16 a[50:51], v22 offset:8328
    ds_read_b64_tr_b16 a[52:53], v22 offset:9224
    ds_read_b64_tr_b16 a[54:55], v22 offset:9352
    ds_read_b64_tr_b16 a[56:57], v22 offset:12296
    ds_read_b64_tr_b16 a[58:59], v22 offset:12424
    ds_read_b64_tr_b16 a[60:61], v22 offset:13320
    ds_read_b64_tr_b16 a[62:63], v22 offset:13448
    s_waitcnt lgkmcnt(0)
    ds_read_b64_tr_b16 a[64:65], v22 offset:16384
    ds_read_b64_tr_b16 a[66:67], v22 offset:16512
    ds_read_b64_tr_b16 a[68:69], v22 offset:17408
    ds_read_b64_tr_b16 a[70:71], v22 offset:17536
    ds_read_b64_tr_b16 a[72:73], v22 offset:20480
    ds_read_b64_tr_b16 a[74:75], v22 offset:20608
    ds_read_b64_tr_b16 a[76:77], v22 offset:21504
    ds_read_b64_tr_b16 a[78:79], v22 offset:21632
    ds_read_b64_tr_b16 a[80:81], v22 offset:24576
    ds_read_b64_tr_b16 a[82:83], v22 offset:24704
    ds_read_b64_tr_b16 a[84:85], v22 offset:25600
    ds_read_b64_tr_b16 a[86:87], v22 offset:25728
    ds_read_b64_tr_b16 a[88:89], v22 offset:28672
    ds_read_b64_tr_b16 a[90:91], v22 offset:28800
    ds_read_b64_tr_b16 a[92:93], v22 offset:29696
    ds_read_b64_tr_b16 a[94:95], v22 offset:29824
    s_waitcnt lgkmcnt(0)
    ds_read_b64_tr_b16 a[96:97], v22 offset:16392
    ds_read_b64_tr_b16 a[98:99], v22 offset:16520
    ds_read_b64_tr_b16 a[100:101], v22 offset:17416
    ds_read_b64_tr_b16 a[102:103], v22 offset:17544
    ds_read_b64_tr_b16 a[104:105], v22 offset:20488
    ds_read_b64_tr_b16 a[106:107], v22 offset:20616
    ds_read_b64_tr_b16 a[108:109], v22 offset:21512
    ds_read_b64_tr_b16 a[110:111], v22 offset:21640
    ds_read_b64_tr_b16 a[112:113], v22 offset:24584
    ds_read_b64_tr_b16 a[114:115], v22 offset:24712
    ds_read_b64_tr_b16 a[116:117], v22 offset:25608
    ds_read_b64_tr_b16 a[118:119], v22 offset:25736
    ds_read_b64_tr_b16 a[120:121], v22 offset:28680
    ds_read_b64_tr_b16 a[122:123], v22 offset:28808
    ds_read_b64_tr_b16 a[124:125], v22 offset:29704
    ds_read_b64_tr_b16 a[126:127], v22 offset:29832
    s_waitcnt lgkmcnt(0)
    s_mov_b32 s8, s34
    s_mov_b32 s9, s35
    s_lshl_b32 s21, s14, 21
    s_lshl_b32 s22, s27, 1
    s_add_u32 s21, s21, s22
    s_lshl_b32 s22, s14, 15
    s_add_u32 s22, s22, 0
    s_mov_b32 m0, s22
    s_nop 0
    buffer_load_dwordx4 v20, s[8:11], s21 offen lds
    s_add_u32 s21, s21, 131072
    s_add_u32 s22, s22, 1024
    s_mov_b32 m0, s22
    s_nop 0
    buffer_load_dwordx4 v20, s[8:11], s21 offen lds
    s_add_u32 s21, s21, 131072
    s_add_u32 s22, s22, 1024
    s_mov_b32 m0, s22
    s_nop 0
    buffer_load_dwordx4 v20, s[8:11], s21 offen lds
    s_add_u32 s21, s21, 131072
    s_add_u32 s22, s22, 1024
    s_mov_b32 m0, s22
    s_nop 0
    buffer_load_dwordx4 v20, s[8:11], s21 offen lds
    s_add_u32 s21, s21, 131072
    s_add_u32 s22, s22, 1024
    s_mov_b32 m0, s22
    s_nop 0
    buffer_load_dwordx4 v20, s[8:11], s21 offen lds
    s_add_u32 s21, s21, 131072
    s_add_u32 s22, s22, 1024
    s_mov_b32 m0, s22
    s_nop 0
    buffer_load_dwordx4 v20, s[8:11], s21 offen lds
    s_add_u32 s21, s21, 131072
    s_add_u32 s22, s22, 1024
    s_mov_b32 m0, s22
    s_nop 0
    buffer_load_dwordx4 v20, s[8:11], s21 offen lds
    s_add_u32 s21, s21, 131072
    s_add_u32 s22, s22, 1024
    s_mov_b32 m0, s22
    s_nop 0
    buffer_load_dwordx4 v20, s[8:11], s21 offen lds
    s_add_u32 s21, s21, 131072
    s_add_u32 s22, s22, 1024
    s_mov_b32 m0, s22
    s_nop 0
    buffer_load_dwordx4 v20, s[8:11], s21 offen lds
    s_add_u32 s21, s21, 131072
    s_add_u32 s22, s22, 1024
    s_mov_b32 m0, s22
    s_nop 0
    buffer_load_dwordx4 v20, s[8:11], s21 offen lds
    s_add_u32 s21, s21, 131072
    s_add_u32 s22, s22, 1024
    s_mov_b32 m0, s22
    s_nop 0
    buffer_load_dwordx4 v20, s[8:11], s21 offen lds
    s_add_u32 s21, s21, 131072
    s_add_u32 s22, s22, 1024
    s_mov_b32 m0, s22
    s_nop 0
    buffer_load_dwordx4 v20, s[8:11], s21 offen lds
    s_add_u32 s21, s21, 131072
    s_add_u32 s22, s22, 1024
    s_mov_b32 m0, s22
    s_nop 0
    buffer_load_dwordx4 v20, s[8:11], s21 offen lds
    s_add_u32 s21, s21, 131072
    s_add_u32 s22, s22, 1024
    s_mov_b32 m0, s22
    s_nop 0
    buffer_load_dwordx4 v20, s[8:11], s21 offen lds
    s_add_u32 s21, s21, 131072
    s_add_u32 s22, s22, 1024
    s_mov_b32 m0, s22
    s_nop 0
    buffer_load_dwordx4 v20, s[8:11], s21 offen lds
    s_add_u32 s21, s21, 131072
    s_add_u32 s22, s22, 1024
    s_mov_b32 m0, s22
    s_nop 0
    buffer_load_dwordx4 v20, s[8:11], s21 offen lds
    s_add_u32 s21, s21, 131072
    s_add_u32 s22, s22, 1024
    s_mov_b32 s8, s36
    s_mov_b32 s9, s37
    s_lshl_b32 s21, s12, 21
    s_lshl_b32 s22, s14, 19
    s_add_u32 s21, s21, s22
    s_lshl_b32 s22, s13, 6
    s_add_u32 s21, s21, s22
    s_lshl_b32 s22, s14, 15
    s_add_u32 s22, s22, 16384
    s_mov_b32 m0, s22
    s_nop 0
    buffer_load_dwordx4 v21, s[8:11], s21 offen lds
    s_add_u32 s21, s21, 32768
    s_add_u32 s22, s22, 1024
    s_mov_b32 m0, s22
    s_nop 0
    buffer_load_dwordx4 v21, s[8:11], s21 offen lds
    s_add_u32 s21, s21, 32768
    s_add_u32 s22, s22, 1024
    s_mov_b32 m0, s22
    s_nop 0
    buffer_load_dwordx4 v21, s[8:11], s21 offen lds
    s_add_u32 s21, s21, 32768
    s_add_u32 s22, s22, 1024
    s_mov_b32 m0, s22
    s_nop 0
    buffer_load_dwordx4 v21, s[8:11], s21 offen lds
    s_add_u32 s21, s21, 32768
    s_add_u32 s22, s22, 1024
    s_mov_b32 m0, s22
    s_nop 0
    buffer_load_dwordx4 v21, s[8:11], s21 offen lds
    s_add_u32 s21, s21, 32768
    s_add_u32 s22, s22, 1024
    s_mov_b32 m0, s22
    s_nop 0
    buffer_load_dwordx4 v21, s[8:11], s21 offen lds
    s_add_u32 s21, s21, 32768
    s_add_u32 s22, s22, 1024
    s_mov_b32 m0, s22
    s_nop 0
    buffer_load_dwordx4 v21, s[8:11], s21 offen lds
    s_add_u32 s21, s21, 32768
    s_add_u32 s22, s22, 1024
    s_mov_b32 m0, s22
    s_nop 0
    buffer_load_dwordx4 v21, s[8:11], s21 offen lds
    s_add_u32 s21, s21, 32768
    s_add_u32 s22, s22, 1024
    s_mov_b32 m0, s22
    s_nop 0
    buffer_load_dwordx4 v21, s[8:11], s21 offen lds
    s_add_u32 s21, s21, 32768
    s_add_u32 s22, s22, 1024
    s_mov_b32 m0, s22
    s_nop 0
    buffer_load_dwordx4 v21, s[8:11], s21 offen lds
    s_add_u32 s21, s21, 32768
    s_add_u32 s22, s22, 1024
    s_mov_b32 m0, s22
    s_nop 0
    buffer_load_dwordx4 v21, s[8:11], s21 offen lds
    s_add_u32 s21, s21, 32768
    s_add_u32 s22, s22, 1024
    s_mov_b32 m0, s22
    s_nop 0
    buffer_load_dwordx4 v21, s[8:11], s21 offen lds
    s_add_u32 s21, s21, 32768
    s_add_u32 s22, s22, 1024
    s_mov_b32 m0, s22
    s_nop 0
    buffer_load_dwordx4 v21, s[8:11], s21 offen lds
    s_add_u32 s21, s21, 32768
    s_add_u32 s22, s22, 1024
    s_mov_b32 m0, s22
    s_nop 0
    buffer_load_dwordx4 v21, s[8:11], s21 offen lds
    s_add_u32 s21, s21, 32768
    s_add_u32 s22, s22, 1024
    s_mov_b32 m0, s22
    s_nop 0
    buffer_load_dwordx4 v21, s[8:11], s21 offen lds
    s_add_u32 s21, s21, 32768
    s_add_u32 s22, s22, 1024
    s_mov_b32 m0, s22
    s_nop 0
    buffer_load_dwordx4 v21, s[8:11], s21 offen lds
    s_add_u32 s21, s21, 32768
    s_add_u32 s22, s22, 1024
    s_waitcnt vmcnt(0)
    ds_read_b64_tr_b16 a[128:129], v22 offset:0
    ds_read_b64_tr_b16 a[130:131], v22 offset:128
    ds_read_b64_tr_b16 a[132:133], v22 offset:1024
    ds_read_b64_tr_b16 a[134:135], v22 offset:1152
    ds_read_b64_tr_b16 a[136:137], v22 offset:4096
    ds_read_b64_tr_b16 a[138:139], v22 offset:4224
    ds_read_b64_tr_b16 a[140:141], v22 offset:5120
    ds_read_b64_tr_b16 a[142:143], v22 offset:5248
    ds_read_b64_tr_b16 a[144:145], v22 offset:8192
    ds_read_b64_tr_b16 a[146:147], v22 offset:8320
    ds_read_b64_tr_b16 a[148:149], v22 offset:9216
    ds_read_b64_tr_b16 a[150:151], v22 offset:9344
    ds_read_b64_tr_b16 a[152:153], v22 offset:12288
    ds_read_b64_tr_b16 a[154:155], v22 offset:12416
    ds_read_b64_tr_b16 a[156:157], v22 offset:13312
    ds_read_b64_tr_b16 a[158:159], v22 offset:13440
    s_waitcnt lgkmcnt(0)
    ds_read_b64_tr_b16 a[160:161], v22 offset:8
    ds_read_b64_tr_b16 a[162:163], v22 offset:136
    ds_read_b64_tr_b16 a[164:165], v22 offset:1032
    ds_read_b64_tr_b16 a[166:167], v22 offset:1160
    ds_read_b64_tr_b16 a[168:169], v22 offset:4104
    ds_read_b64_tr_b16 a[170:171], v22 offset:4232
    ds_read_b64_tr_b16 a[172:173], v22 offset:5128
    ds_read_b64_tr_b16 a[174:175], v22 offset:5256
    ds_read_b64_tr_b16 a[176:177], v22 offset:8200
    ds_read_b64_tr_b16 a[178:179], v22 offset:8328
    ds_read_b64_tr_b16 a[180:181], v22 offset:9224
    ds_read_b64_tr_b16 a[182:183], v22 offset:9352
    ds_read_b64_tr_b16 a[184:185], v22 offset:12296
    ds_read_b64_tr_b16 a[186:187], v22 offset:12424
    ds_read_b64_tr_b16 a[188:189], v22 offset:13320
    ds_read_b64_tr_b16 a[190:191], v22 offset:13448
    s_waitcnt lgkmcnt(0)
    ds_read_b64_tr_b16 a[192:193], v22 offset:16384
    ds_read_b64_tr_b16 a[194:195], v22 offset:16512
    ds_read_b64_tr_b16 a[196:197], v22 offset:17408
    ds_read_b64_tr_b16 a[198:199], v22 offset:17536
    ds_read_b64_tr_b16 a[200:201], v22 offset:20480
    ds_read_b64_tr_b16 a[202:203], v22 offset:20608
    ds_read_b64_tr_b16 a[204:205], v22 offset:21504
    ds_read_b64_tr_b16 a[206:207], v22 offset:21632
    ds_read_b64_tr_b16 a[208:209], v22 offset:24576
    ds_read_b64_tr_b16 a[210:211], v22 offset:24704
    ds_read_b64_tr_b16 a[212:213], v22 offset:25600
    ds_read_b64_tr_b16 a[214:215], v22 offset:25728
    ds_read_b64_tr_b16 a[216:217], v22 offset:28672
    ds_read_b64_tr_b16 a[218:219], v22 offset:28800
    ds_read_b64_tr_b16 a[220:221], v22 offset:29696
    ds_read_b64_tr_b16 a[222:223], v22 offset:29824
    s_waitcnt lgkmcnt(0)
    ds_read_b64_tr_b16 a[224:225], v22 offset:16392
    ds_read_b64_tr_b16 a[226:227], v22 offset:16520
    ds_read_b64_tr_b16 a[228:229], v22 offset:17416
    ds_read_b64_tr_b16 a[230:231], v22 offset:17544
    ds_read_b64_tr_b16 a[232:233], v22 offset:20488
    ds_read_b64_tr_b16 a[234:235], v22 offset:20616
    ds_read_b64_tr_b16 a[236:237], v22 offset:21512
    ds_read_b64_tr_b16 a[238:239], v22 offset:21640
    ds_read_b64_tr_b16 a[240:241], v22 offset:24584
    ds_read_b64_tr_b16 a[242:243], v22 offset:24712
    ds_read_b64_tr_b16 a[244:245], v22 offset:25608
    ds_read_b64_tr_b16 a[246:247], v22 offset:25736
    ds_read_b64_tr_b16 a[248:249], v22 offset:28680
    ds_read_b64_tr_b16 a[250:251], v22 offset:28808
    ds_read_b64_tr_b16 a[252:253], v22 offset:29704
    ds_read_b64_tr_b16 a[254:255], v22 offset:29832
    s_waitcnt lgkmcnt(0)
    v_mov_b32 v155, 0
    v_mov_b32 v159, 0
    v_mov_b32 v163, 0
    v_mov_b32 v167, 0
    v_mov_b32 v179, 0
    s_mov_b32 s8, s28
    s_mov_b32 s9, s29
    s_mov_b32 s10, 16384
    v_lshlrev_b32 v20, 11, v96
    v_lshl_add_u32 v20, v98, 4, v20
    v_lshl_add_u32 v20, v97, 3, v20
    s_lshl_b32 s21, s13, 6
    buffer_load_dwordx2 v[88:89], v20, s[8:11], s21 offen
    v_lshlrev_b32 v20, 2, v1
    s_mov_b32 s22, 0
rdv_20:
    global_load_dword v21, v20, s[100:101] sc1
    s_lshl_b32 s21, s98, 2
    s_waitcnt vmcnt(0)
    v_lshrrev_b32 v22, s21, v21
    s_cmp_eq_u32 s98, 0
    s_cselect_b32 s21, 0x0f0f0f0f, s21
    s_cselect_b32 s21, s21, 0x01010101
    v_and_b32 v22, s21, v22
    v_cmp_ne_u32 vcc, 0x01010101, v22
    s_nop 0
    s_cbranch_vccz rdvok_21
    v_sad_u8 v22, v22, 0, 0
    s_nop 1
    v_add_u32_dpp v22, v22, v22 quad_perm:[1,0,3,2] row_mask:0xf bank_mask:0xf
    v_cmp_ne_u32 vcc, 8, v22
    s_nop 0
    s_cbranch_vccnz rdvw_22
    s_mov_b32 s98, 1
    s_and_b32 s3, s97, 7
    s_barrier
    s_branch role_start
rdvw_22:
    s_sleep 4
    s_add_u32 s22, s22, 1
    s_cmp_lt_u32 s22, 262144
    s_cbranch_scc1 rdv_20
    s_mov_b32 s25, 200000
rdvok_21:
    v_and_b32 v22, 0x40404040, v21
    v_bcnt_u32_b32 v22, v22, 0
    s_mov_b32 s46, 0
    v_cmp_le_u32 vcc, 1, v22
    s_nop 0
    s_bcnt1_i32_b64 s21, vcc
    s_add_u32 s46, s46, s21
    v_cmp_le_u32 vcc, 2, v22
    s_nop 0
    s_bcnt1_i32_b64 s21, vcc
    s_add_u32 s46, s46, s21
    v_cmp_le_u32 vcc, 3, v22
    s_nop 0
    s_bcnt1_i32_b64 s21, vcc
    s_add_u32 s46, s46, s21
    v_cmp_le_u32 vcc, 4, v22
    s_nop 0
    s_bcnt1_i32_b64 s21, vcc
    s_add_u32 s46, s46, s21
    s_cmp_gt_u32 s46, 16
    s_cselect_b32 s46, 8192, 0
    s_add_u32 s84, s95, s46
    s_xor_b32 s45, s98, 1
    v_min_u32 v88, -2, v88
    v_min_u32 v89, -2, v89
    buffer_store_dwordx2 v[88:89], v11, s[4:7], s16 offen sc1
    v_mov_b32 v40, 0
    v_mov_b32 v41, 0
    v_mov_b32 v42, 0
    v_mov_b32 v43, 0
    v_mov_b32 v44, 0
    v_mov_b32 v45, 0
    v_mov_b32 v46, 0
    v_mov_b32 v47, 0
    v_mov_b32 v48, 0
    v_mov_b32 v49, 0
    v_mov_b32 v50, 0
    v_mov_b32 v51, 0
    v_mov_b32 v52, 0
    v_mov_b32 v53, 0
    v_mov_b32 v54, 0
    v_mov_b32 v55, 0
    v_mov_b32 v56, 0
    v_mov_b32 v57, 0
    v_mov_b32 v58, 0
    v_mov_b32 v59, 0
    v_mov_b32 v60, 0
    v_mov_b32 v61, 0
    v_mov_b32 v62, 0
    v_mov_b32 v63, 0
    v_mov_b32 v64, 0
    v_mov_b32 v65, 0
    v_mov_b32 v66, 0
    v_mov_b32 v67, 0
    v_mov_b32 v68, 0
    v_mov_b32 v69, 0
    v_mov_b32 v70, 0
    v_mov_b32 v71, 0
    s_cmp_ge_u32 s14, 2
    s_cbranch_scc1 kv_23
    s_mov_b32 s94, 2
    s_mov_b32 s23, s25
fw_25:
    s_cmp_ge_u32 s85, s94
    s_cbranch_scc1 fo_26
    buffer_load_dword v19, v245, s[4:7], 0 offen sc1
    s_add_u32 s23, s23, 1
    s_waitcnt vmcnt(0)
    v_readfirstlane_b32 s85, v19
    s_cmp_lt_u32 s23, 200000
    s_cbranch_scc1 fw_25
    s_mov_b32 s25, 200000
fo_26:
    s_cmp_eq_u32 s14, 1
    s_cbranch_scc1 kv_24
    buffer_load_dwordx4 v[132:135], v12, s[4:7], s17 offen sc1
    buffer_load_dwordx4 v[136:139], v12, s[4:7], s17 offen offset:256 sc1
    s_add_u32 s17, s17, 2048
    s_min_u32 s17, s17, 17954816
    s_branch kv_23
kv_24:
    buffer_load_dwordx2 v[152:153], v13, s[4:7], s18 offen offset:0 sc1
    buffer_load_dwordx2 v[156:157], v13, s[4:7], s18 offen offset:8 sc1
    buffer_load_dwordx2 v[160:161], v13, s[4:7], s18 offen offset:256 sc1
    buffer_load_dwordx2 v[164:165], v13, s[4:7], s18 offen offset:264 sc1
    s_add_u32 s18, s18, 2048
    s_min_u32 s18, s18, 35780608
kv_23:
    s_mov_b32 s23, s25
    s_barrier
    s_cmp_eq_u32 s45, 0
    s_cbranch_scc1 recur_slow_disp
    s_cmp_eq_u32 s14, 1
    s_cbranch_scc1 recur_fast_w1
    s_cmp_eq_u32 s14, 2
    s_cbranch_scc1 recur_fast_w2
    s_cmp_eq_u32 s14, 3
    s_cbranch_scc1 recur_fast_w3
    s_branch recur_fast_w0
recur_slow_disp:
    s_cmp_eq_u32 s14, 1
    s_cbranch_scc1 recur_slow_w1
    s_cmp_eq_u32 s14, 2
    s_cbranch_scc1 recur_slow_w2
    s_cmp_eq_u32 s14, 3
    s_cbranch_scc1 recur_slow_w3
    s_branch recur_slow_w0
.p2align 6
recur_fast_w0:
    s_nop 15
    s_mov_b32 s23, s25
    buffer_load_dwordx4 v[24:27], v2, s[4:7], s16 offen offset:0 sc1
    s_nop 11
    buffer_load_dwordx4 v[28:31], v2, s[4:7], s16 offen offset:1024 sc1
    s_nop 11
    buffer_load_dwordx4 v[32:35], v2, s[4:7], s16 offen offset:2048 sc1
    s_nop 11
    buffer_load_dwordx4 v[36:39], v2, s[4:7], s16 offen offset:3072 sc1
    s_waitcnt vmcnt(3)
    v_max3_u32 v19, v24, v25, v26
    v_max_u32 v19, v19, v27
    v_cmp_eq_u32 vcc, -1, v19
    s_nop 0
    s_cbranch_vccnz g_27F15_0
    v_smfmac_f32_16x16x64_bf16 v[40:43], v[24:27], a[0:7], v172
    v_smfmac_f32_16x16x64_bf16 v[44:47], v[24:27], a[64:71], v172
    s_waitcnt vmcnt(2)
    v_max3_u32 v19, v28, v29, v30
    v_max_u32 v19, v19, v31
    v_smfmac_f32_16x16x64_bf16 v[48:51], v[24:27], a[32:39], v172
    v_cmp_eq_u32 vcc, -1, v19
    v_smfmac_f32_16x16x64_bf16 v[52:55], v[24:27], a[96:103], v172
    s_cbranch_vccnz g_27F14_1
    v_smfmac_f32_16x16x64_bf16 v[40:43], v[28:31], a[8:15], v172
    v_smfmac_f32_16x16x64_bf16 v[44:47], v[28:31], a[72:79], v172
    s_waitcnt vmcnt(1)
    v_max3_u32 v19, v32, v33, v34
    v_max_u32 v19, v19, v35
    v_smfmac_f32_16x16x64_bf16 v[48:51], v[28:31], a[40:47], v172
    v_cmp_eq_u32 vcc, -1, v19
    v_smfmac_f32_16x16x64_bf16 v[52:55], v[28:31], a[104:111], v172
    s_cbranch_vccnz g_27F12_2
    v_smfmac_f32_16x16x64_bf16 v[40:43], v[32:35], a[16:23], v172
    v_smfmac_f32_16x16x64_bf16 v[44:47], v[32:35], a[80:87], v172
    s_waitcnt vmcnt(0)
    v_max3_u32 v19, v36, v37, v38
    v_max_u32 v19, v19, v39
    v_smfmac_f32_16x16x64_bf16 v[48:51], v[32:35], a[48:55], v172
    v_cmp_eq_u32 vcc, -1, v19
    v_smfmac_f32_16x16x64_bf16 v[52:55], v[32:35], a[112:119], v172
    s_cbranch_vccnz g_27F8_3
    v_smfmac_f32_16x16x64_bf16 v[40:43], v[36:39], a[24:31], v172
    v_smfmac_f32_16x16x64_bf16 v[44:47], v[36:39], a[88:95], v172
    v_smfmac_f32_16x16x64_bf16 v[48:51], v[36:39], a[56:63], v172
    v_smfmac_f32_16x16x64_bf16 v[52:55], v[36:39], a[120:127], v172
gc_28:
    v_cvt_pk_bf16_f32 v72, v40, v41
    v_cvt_pk_bf16_f32 v73, v42, v43
    v_cvt_pk_bf16_f32 v74, v44, v45
    v_cvt_pk_bf16_f32 v75, v46, v47
    v_smfmac_f32_16x16x64_bf16 v[56:59], v[24:27], a[128:135], v172
    v_cvt_pk_bf16_f32 v76, v48, v49
    v_cvt_pk_bf16_f32 v77, v50, v51
    s_nop 0
    v_cvt_pk_bf16_f32 v78, v52, v53
    v_cvt_pk_bf16_f32 v79, v54, v55
    v_smfmac_f32_16x16x64_bf16 v[60:63], v[24:27], a[160:167], v172
    v_mfma_f32_16x16x32_bf16 v[88:91], v[72:75], v[84:87], 0
    v_mfma_f32_16x16x32_bf16 v[92:95], v[76:79], v[84:87], 0
    v_smfmac_f32_16x16x64_bf16 v[56:59], v[28:31], a[136:143], v172
    v_smfmac_f32_16x16x64_bf16 v[60:63], v[28:31], a[168:175], v172
    s_barrier
    ds_read_b128 v[104:107], v16 offset:2048
    ds_read_b128 v[108:111], v16 offset:3072
    ds_read_b128 v[112:115], v16 offset:4096
    ds_read_b128 v[116:119], v16 offset:5120
    ds_read_b128 v[120:123], v16 offset:6144
    ds_read_b128 v[124:127], v16 offset:7168
    v_smfmac_f32_16x16x64_bf16 v[56:59], v[32:35], a[144:151], v172
    v_smfmac_f32_16x16x64_bf16 v[60:63], v[32:35], a[176:183], v172
    v_smfmac_f32_16x16x64_bf16 v[56:59], v[36:39], a[152:159], v172
    v_smfmac_f32_16x16x64_bf16 v[60:63], v[36:39], a[184:191], v172
    s_waitcnt lgkmcnt(5)
    v_mfma_f32_16x16x32_bf16 v[88:91], v[104:107], v[84:87], v[88:91]
    s_waitcnt lgkmcnt(4)
    v_mfma_f32_16x16x32_bf16 v[92:95], v[108:111], v[84:87], v[92:95]
    s_waitcnt lgkmcnt(3)
    v_mfma_f32_16x16x32_bf16 v[88:91], v[112:115], v[84:87], v[88:91]
    s_waitcnt lgkmcnt(2)
    v_mfma_f32_16x16x32_bf16 v[92:95], v[116:119], v[84:87], v[92:95]
    s_waitcnt lgkmcnt(1)
    v_mfma_f32_16x16x32_bf16 v[88:91], v[120:123], v[84:87], v[88:91]
    s_waitcnt lgkmcnt(0)
    v_mfma_f32_16x16x32_bf16 v[92:95], v[124:127], v[84:87], v[92:95]
    v_cvt_pk_bf16_f32 v80, v56, v57
    v_cvt_pk_bf16_f32 v81, v58, v59
    v_cvt_pk_bf16_f32 v82, v60, v61
    v_cvt_pk_bf16_f32 v83, v62, v63
    ds_write_b128 v17, v[80:83] offset:8192
    s_nop 0
    v_cvt_pk_bf16_f32 v128, v88, v89
    v_cvt_pk_bf16_f32 v129, v90, v91
    v_cvt_pk_bf16_f32 v130, v92, v93
    v_cvt_pk_bf16_f32 v131, v94, v95
    s_nop 1
    v_mfma_f32_16x16x32_bf16 v[144:147], v[132:135], v[128:131], 0
    v_mfma_f32_16x16x32_bf16 v[148:151], v[136:139], v[128:131], 0
    v_mfma_f32_16x16x32_bf16 v[140:143], v[128:131], v[128:131], 0
    s_nop 1
    buffer_store_dwordx4 v[144:147], v3, s[4:7], s16 offen
    s_nop 1
    buffer_store_dwordx4 v[148:151], v3, s[4:7], s16 offen offset:128
    s_nop 1
    buffer_store_dwordx4 v[140:143], v4, s[4:7], s16 offen
    s_cmp_eq_u32 s15, 63
    s_waitcnt lgkmcnt(0)
    s_barrier
    s_cbranch_scc1 recur_fast_last0
    s_nop 15
    s_nop 15
    s_nop 15
    buffer_load_dwordx4 v[132:135], v12, s[4:7], s17 offen sc1
    buffer_load_dwordx4 v[136:139], v12, s[4:7], s17 offen offset:256 sc1
    s_add_u32 s17, s17, 2048
    s_min_u32 s17, s17, 17954816
    buffer_store_dwordx4 v[128:131], v14, s[4:7], s19 offen sc1
    s_add_u32 s19, s19, 512
    s_barrier
    s_nop 15
    s_mov_b32 s23, s25
    buffer_load_dwordx4 v[24:27], v8, s[4:7], s16 offen offset:0 sc1
    s_nop 11
    buffer_load_dwordx4 v[28:31], v8, s[4:7], s16 offen offset:1024 sc1
    s_nop 11
    buffer_load_dwordx4 v[32:35], v8, s[4:7], s16 offen offset:2048 sc1
    s_nop 11
    buffer_load_dwordx4 v[36:39], v8, s[4:7], s16 offen offset:3072 sc1
    s_waitcnt vmcnt(3)
    v_max3_u32 v19, v24, v25, v26
    v_max_u32 v19, v19, v27
    v_cmp_eq_u32 vcc, -1, v19
    s_nop 0
    s_cbranch_vccnz g_29F15_0
    v_smfmac_f32_16x16x64_bf16 v[64:67], v[24:27], a[192:199], v172
    v_smfmac_f32_16x16x64_bf16 v[68:71], v[24:27], a[224:231], v172
    s_waitcnt vmcnt(2)
    v_max3_u32 v19, v28, v29, v30
    v_max_u32 v19, v19, v31
    v_cmp_eq_u32 vcc, -1, v19
    s_nop 0
    s_cbranch_vccnz g_29F14_1
    v_smfmac_f32_16x16x64_bf16 v[64:67], v[28:31], a[200:207], v172
    v_smfmac_f32_16x16x64_bf16 v[68:71], v[28:31], a[232:239], v172
    s_waitcnt vmcnt(1)
    v_max3_u32 v19, v32, v33, v34
    v_max_u32 v19, v19, v35
    v_cmp_eq_u32 vcc, -1, v19
    s_nop 0
    s_cbranch_vccnz g_29F12_2
    v_smfmac_f32_16x16x64_bf16 v[64:67], v[32:35], a[208:215], v172
    v_smfmac_f32_16x16x64_bf16 v[68:71], v[32:35], a[240:247], v172
    s_waitcnt vmcnt(0)
    v_max3_u32 v19, v36, v37, v38
    v_max_u32 v19, v19, v39
    v_cmp_eq_u32 vcc, -1, v19
    s_nop 0
    s_cbranch_vccnz g_29F8_3
    v_smfmac_f32_16x16x64_bf16 v[64:67], v[36:39], a[216:223], v172
    v_smfmac_f32_16x16x64_bf16 v[68:71], v[36:39], a[248:255], v172
    s_nop 4
    v_cvt_pk_bf16_f32 v80, v64, v65
    v_cvt_pk_bf16_f32 v81, v66, v67
    s_nop 0
    v_cvt_pk_bf16_f32 v82, v68, v69
    v_cvt_pk_bf16_f32 v83, v70, v71
    ds_write_b128 v17, v[80:83] offset:9216
gc_30:
    s_waitcnt lgkmcnt(0)
    s_barrier
    s_nop 15
    s_nop 15
    s_nop 15
    v_mov_b32 v40, 0
    v_mov_b32 v41, 0
    v_mov_b32 v42, 0
    v_mov_b32 v43, 0
    v_mov_b32 v44, 0
    v_mov_b32 v45, 0
    v_mov_b32 v46, 0
    v_mov_b32 v47, 0
    v_mov_b32 v48, 0
    v_mov_b32 v49, 0
    v_mov_b32 v50, 0
    v_mov_b32 v51, 0
    v_mov_b32 v52, 0
    v_mov_b32 v53, 0
    v_mov_b32 v54, 0
    v_mov_b32 v55, 0
    v_mov_b32 v56, 0
    v_mov_b32 v57, 0
    v_mov_b32 v58, 0
    v_mov_b32 v59, 0
    v_mov_b32 v60, 0
    v_mov_b32 v61, 0
    v_mov_b32 v62, 0
    v_mov_b32 v63, 0
    v_mov_b32 v64, 0
    v_mov_b32 v65, 0
    v_mov_b32 v66, 0
    v_mov_b32 v67, 0
    v_mov_b32 v68, 0
    v_mov_b32 v69, 0
    v_mov_b32 v70, 0
    v_mov_b32 v71, 0
    s_add_u32 s94, s15, 3
    s_min_u32 s94, s94, 64
    s_mov_b32 s23, s25
fw_31:
    s_cmp_ge_u32 s85, s94
    s_cbranch_scc1 fo_32
    buffer_load_dword v19, v245, s[4:7], 0 offen sc1
    s_add_u32 s23, s23, 1
    s_waitcnt vmcnt(0)
    v_readfirstlane_b32 s85, v19
    s_cmp_lt_u32 s23, 200000
    s_cbranch_scc1 fw_31
    s_mov_b32 s25, 200000
fo_32:
    s_mov_b32 s21, s16
    s_mov_b32 s16, s42
    s_mov_b32 s42, s43
    s_mov_b32 s43, s44
    s_mov_b32 s44, s21
    s_add_u32 s95, s95, 524288
    s_lshr_b32 s84, s95, 8
    s_and_b32 s84, s84, 8192
    s_xor_b32 s84, s84, s46
    s_add_u32 s84, s84, s95
    s_add_u32 s15, s15, 1
    s_barrier
    s_branch recur_fast_w0
g_27L15_0:
    s_waitcnt vmcnt(3)
    v_max3_u32 v19, v24, v25, v26
    v_max_u32 v19, v19, v27
    v_cmp_eq_u32 vcc, -1, v19
    s_nop 0
    s_cbranch_vccnz g_27F15_0
    v_smfmac_f32_16x16x64_bf16 v[40:43], v[24:27], a[0:7], v172
    v_smfmac_f32_16x16x64_bf16 v[44:47], v[24:27], a[64:71], v172
    v_smfmac_f32_16x16x64_bf16 v[48:51], v[24:27], a[32:39], v172
    v_smfmac_f32_16x16x64_bf16 v[52:55], v[24:27], a[96:103], v172
g_27L14_1:
    s_waitcnt vmcnt(2)
    v_max3_u32 v19, v28, v29, v30
    v_max_u32 v19, v19, v31
    v_cmp_eq_u32 vcc, -1, v19
    s_nop 0
    s_cbranch_vccnz g_27F14_1
    v_smfmac_f32_16x16x64_bf16 v[40:43], v[28:31], a[8:15], v172
    v_smfmac_f32_16x16x64_bf16 v[44:47], v[28:31], a[72:79], v172
    v_smfmac_f32_16x16x64_bf16 v[48:51], v[28:31], a[40:47], v172
    v_smfmac_f32_16x16x64_bf16 v[52:55], v[28:31], a[104:111], v172
g_27L12_2:
    s_waitcnt vmcnt(1)
    v_max3_u32 v19, v32, v33, v34
    v_max_u32 v19, v19, v35
    v_cmp_eq_u32 vcc, -1, v19
    s_nop 0
    s_cbranch_vccnz g_27F12_2
    v_smfmac_f32_16x16x64_bf16 v[40:43], v[32:35], a[16:23], v172
    v_smfmac_f32_16x16x64_bf16 v[44:47], v[32:35], a[80:87], v172
    v_smfmac_f32_16x16x64_bf16 v[48:51], v[32:35], a[48:55], v172
    v_smfmac_f32_16x16x64_bf16 v[52:55], v[32:35], a[112:119], v172
g_27L8_3:
    s_waitcnt vmcnt(0)
    v_max3_u32 v19, v36, v37, v38
    v_max_u32 v19, v19, v39
    v_cmp_eq_u32 vcc, -1, v19
    s_nop 0
    s_cbranch_vccnz g_27F8_3
    v_smfmac_f32_16x16x64_bf16 v[40:43], v[36:39], a[24:31], v172
    v_smfmac_f32_16x16x64_bf16 v[44:47], v[36:39], a[88:95], v172
    v_smfmac_f32_16x16x64_bf16 v[48:51], v[36:39], a[56:63], v172
    v_smfmac_f32_16x16x64_bf16 v[52:55], v[36:39], a[120:127], v172
    s_branch gc_28
g_27L15_1:
    s_waitcnt vmcnt(3)
    v_max3_u32 v19, v28, v29, v30
    v_max_u32 v19, v19, v31
    v_cmp_eq_u32 vcc, -1, v19
    s_nop 0
    s_cbranch_vccnz g_27F15_1
    v_smfmac_f32_16x16x64_bf16 v[40:43], v[28:31], a[8:15], v172
    v_smfmac_f32_16x16x64_bf16 v[44:47], v[28:31], a[72:79], v172
    v_smfmac_f32_16x16x64_bf16 v[48:51], v[28:31], a[40:47], v172
    v_smfmac_f32_16x16x64_bf16 v[52:55], v[28:31], a[104:111], v172
g_27L13_2:
    s_waitcnt vmcnt(2)
    v_max3_u32 v19, v32, v33, v34
    v_max_u32 v19, v19, v35
    v_cmp_eq_u32 vcc, -1, v19
    s_nop 0
    s_cbranch_vccnz g_27F13_2
    v_smfmac_f32_16x16x64_bf16 v[40:43], v[32:35], a[16:23], v172
    v_smfmac_f32_16x16x64_bf16 v[44:47], v[32:35], a[80:87], v172
    v_smfmac_f32_16x16x64_bf16 v[48:51], v[32:35], a[48:55], v172
    v_smfmac_f32_16x16x64_bf16 v[52:55], v[32:35], a[112:119], v172
g_27L9_3:
    s_waitcnt vmcnt(1)
    v_max3_u32 v19, v36, v37, v38
    v_max_u32 v19, v19, v39
    v_cmp_eq_u32 vcc, -1, v19
    s_nop 0
    s_cbranch_vccnz g_27F9_3
    v_smfmac_f32_16x16x64_bf16 v[40:43], v[36:39], a[24:31], v172
    v_smfmac_f32_16x16x64_bf16 v[44:47], v[36:39], a[88:95], v172
    v_smfmac_f32_16x16x64_bf16 v[48:51], v[36:39], a[56:63], v172
    v_smfmac_f32_16x16x64_bf16 v[52:55], v[36:39], a[120:127], v172
g_27L1_0:
    s_waitcnt vmcnt(0)
    v_max3_u32 v19, v24, v25, v26
    v_max_u32 v19, v19, v27
    v_cmp_eq_u32 vcc, -1, v19
    s_nop 0
    s_cbranch_vccnz g_27F1_0
    v_smfmac_f32_16x16x64_bf16 v[40:43], v[24:27], a[0:7], v172
    v_smfmac_f32_16x16x64_bf16 v[44:47], v[24:27], a[64:71], v172
    v_smfmac_f32_16x16x64_bf16 v[48:51], v[24:27], a[32:39], v172
    v_smfmac_f32_16x16x64_bf16 v[52:55], v[24:27], a[96:103], v172
    s_branch gc_28
g_27L15_2:
    s_waitcnt vmcnt(3)
    v_max3_u32 v19, v32, v33, v34
    v_max_u32 v19, v19, v35
    v_cmp_eq_u32 vcc, -1, v19
    s_nop 0
    s_cbranch_vccnz g_27F15_2
    v_smfmac_f32_16x16x64_bf16 v[40:43], v[32:35], a[16:23], v172
    v_smfmac_f32_16x16x64_bf16 v[44:47], v[32:35], a[80:87], v172
    v_smfmac_f32_16x16x64_bf16 v[48:51], v[32:35], a[48:55], v172
    v_smfmac_f32_16x16x64_bf16 v[52:55], v[32:35], a[112:119], v172
g_27L11_3:
    s_waitcnt vmcnt(2)
    v_max3_u32 v19, v36, v37, v38
    v_max_u32 v19, v19, v39
    v_cmp_eq_u32 vcc, -1, v19
    s_nop 0
    s_cbranch_vccnz g_27F11_3
    v_smfmac_f32_16x16x64_bf16 v[40:43], v[36:39], a[24:31], v172
    v_smfmac_f32_16x16x64_bf16 v[44:47], v[36:39], a[88:95], v172
    v_smfmac_f32_16x16x64_bf16 v[48:51], v[36:39], a[56:63], v172
    v_smfmac_f32_16x16x64_bf16 v[52:55], v[36:39], a[120:127], v172
g_27L3_0:
    s_waitcnt vmcnt(1)
    v_max3_u32 v19, v24, v25, v26
    v_max_u32 v19, v19, v27
    v_cmp_eq_u32 vcc, -1, v19
    s_nop 0
    s_cbranch_vccnz g_27F3_0
    v_smfmac_f32_16x16x64_bf16 v[40:43], v[24:27], a[0:7], v172
    v_smfmac_f32_16x16x64_bf16 v[44:47], v[24:27], a[64:71], v172
    v_smfmac_f32_16x16x64_bf16 v[48:51], v[24:27], a[32:39], v172
    v_smfmac_f32_16x16x64_bf16 v[52:55], v[24:27], a[96:103], v172
g_27L2_1:
    s_waitcnt vmcnt(0)
    v_max3_u32 v19, v28, v29, v30
    v_max_u32 v19, v19, v31
    v_cmp_eq_u32 vcc, -1, v19
    s_nop 0
    s_cbranch_vccnz g_27F2_1
    v_smfmac_f32_16x16x64_bf16 v[40:43], v[28:31], a[8:15], v172
    v_smfmac_f32_16x16x64_bf16 v[44:47], v[28:31], a[72:79], v172
    v_smfmac_f32_16x16x64_bf16 v[48:51], v[28:31], a[40:47], v172
    v_smfmac_f32_16x16x64_bf16 v[52:55], v[28:31], a[104:111], v172
    s_branch gc_28
g_27L15_3:
    s_waitcnt vmcnt(3)
    v_max3_u32 v19, v36, v37, v38
    v_max_u32 v19, v19, v39
    v_cmp_eq_u32 vcc, -1, v19
    s_nop 0
    s_cbranch_vccnz g_27F15_3
    v_smfmac_f32_16x16x64_bf16 v[40:43], v[36:39], a[24:31], v172
    v_smfmac_f32_16x16x64_bf16 v[44:47], v[36:39], a[88:95], v172
    v_smfmac_f32_16x16x64_bf16 v[48:51], v[36:39], a[56:63], v172
    v_smfmac_f32_16x16x64_bf16 v[52:55], v[36:39], a[120:127], v172
g_27L7_0:
    s_waitcnt vmcnt(2)
    v_max3_u32 v19, v24, v25, v26
    v_max_u32 v19, v19, v27
    v_cmp_eq_u32 vcc, -1, v19
    s_nop 0
    s_cbranch_vccnz g_27F7_0
    v_smfmac_f32_16x16x64_bf16 v[40:43], v[24:27], a[0:7], v172
    v_smfmac_f32_16x16x64_bf16 v[44:47], v[24:27], a[64:71], v172
    v_smfmac_f32_16x16x64_bf16 v[48:51], v[24:27], a[32:39], v172
    v_smfmac_f32_16x16x64_bf16 v[52:55], v[24:27], a[96:103], v172
g_27L6_1:
    s_waitcnt vmcnt(1)
    v_max3_u32 v19, v28, v29, v30
    v_max_u32 v19, v19, v31
    v_cmp_eq_u32 vcc, -1, v19
    s_nop 0
    s_cbranch_vccnz g_27F6_1
    v_smfmac_f32_16x16x64_bf16 v[40:43], v[28:31], a[8:15], v172
    v_smfmac_f32_16x16x64_bf16 v[44:47], v[28:31], a[72:79], v172
    v_smfmac_f32_16x16x64_bf16 v[48:51], v[28:31], a[40:47], v172
    v_smfmac_f32_16x16x64_bf16 v[52:55], v[28:31], a[104:111], v172
g_27L4_2:
    s_waitcnt vmcnt(0)
    v_max3_u32 v19, v32, v33, v34
    v_max_u32 v19, v19, v35
    v_cmp_eq_u32 vcc, -1, v19
    s_nop 0
    s_cbranch_vccnz g_27F4_2
    v_smfmac_f32_16x16x64_bf16 v[40:43], v[32:35], a[16:23], v172
    v_smfmac_f32_16x16x64_bf16 v[44:47], v[32:35], a[80:87], v172
    v_smfmac_f32_16x16x64_bf16 v[48:51], v[32:35], a[48:55], v172
    v_smfmac_f32_16x16x64_bf16 v[52:55], v[32:35], a[112:119], v172
    s_branch gc_28
g_27L7_1:
    s_waitcnt vmcnt(2)
    v_max3_u32 v19, v28, v29, v30
    v_max_u32 v19, v19, v31
    v_cmp_eq_u32 vcc, -1, v19
    s_nop 0
    s_cbranch_vccnz g_27F7_1
    v_smfmac_f32_16x16x64_bf16 v[40:43], v[28:31], a[8:15], v172
    v_smfmac_f32_16x16x64_bf16 v[44:47], v[28:31], a[72:79], v172
    v_smfmac_f32_16x16x64_bf16 v[48:51], v[28:31], a[40:47], v172
    v_smfmac_f32_16x16x64_bf16 v[52:55], v[28:31], a[104:111], v172
g_27L5_2:
    s_waitcnt vmcnt(1)
    v_max3_u32 v19, v32, v33, v34
    v_max_u32 v19, v19, v35
    v_cmp_eq_u32 vcc, -1, v19
    s_nop 0
    s_cbranch_vccnz g_27F5_2
    v_smfmac_f32_16x16x64_bf16 v[40:43], v[32:35], a[16:23], v172
    v_smfmac_f32_16x16x64_bf16 v[44:47], v[32:35], a[80:87], v172
    v_smfmac_f32_16x16x64_bf16 v[48:51], v[32:35], a[48:55], v172
    v_smfmac_f32_16x16x64_bf16 v[52:55], v[32:35], a[112:119], v172
    s_branch g_27L1_0
g_27L7_2:
    s_waitcnt vmcnt(2)
    v_max3_u32 v19, v32, v33, v34
    v_max_u32 v19, v19, v35
    v_cmp_eq_u32 vcc, -1, v19
    s_nop 0
    s_cbranch_vccnz g_27F7_2
    v_smfmac_f32_16x16x64_bf16 v[40:43], v[32:35], a[16:23], v172
    v_smfmac_f32_16x16x64_bf16 v[44:47], v[32:35], a[80:87], v172
    v_smfmac_f32_16x16x64_bf16 v[48:51], v[32:35], a[48:55], v172
    v_smfmac_f32_16x16x64_bf16 v[52:55], v[32:35], a[112:119], v172
    s_branch g_27L3_0
g_27L11_0:
    s_waitcnt vmcnt(2)
    v_max3_u32 v19, v24, v25, v26
    v_max_u32 v19, v19, v27
    v_cmp_eq_u32 vcc, -1, v19
    s_nop 0
    s_cbranch_vccnz g_27F11_0
    v_smfmac_f32_16x16x64_bf16 v[40:43], v[24:27], a[0:7], v172
    v_smfmac_f32_16x16x64_bf16 v[44:47], v[24:27], a[64:71], v172
    v_smfmac_f32_16x16x64_bf16 v[48:51], v[24:27], a[32:39], v172
    v_smfmac_f32_16x16x64_bf16 v[52:55], v[24:27], a[96:103], v172
g_27L10_1:
    s_waitcnt vmcnt(1)
    v_max3_u32 v19, v28, v29, v30
    v_max_u32 v19, v19, v31
    v_cmp_eq_u32 vcc, -1, v19
    s_nop 0
    s_cbranch_vccnz g_27F10_1
    v_smfmac_f32_16x16x64_bf16 v[40:43], v[28:31], a[8:15], v172
    v_smfmac_f32_16x16x64_bf16 v[44:47], v[28:31], a[72:79], v172
    v_smfmac_f32_16x16x64_bf16 v[48:51], v[28:31], a[40:47], v172
    v_smfmac_f32_16x16x64_bf16 v[52:55], v[28:31], a[104:111], v172
    s_branch g_27L8_3
g_27L11_1:
    s_waitcnt vmcnt(2)
    v_max3_u32 v19, v28, v29, v30
    v_max_u32 v19, v19, v31
    v_cmp_eq_u32 vcc, -1, v19
    s_nop 0
    s_cbranch_vccnz g_27F11_1
    v_smfmac_f32_16x16x64_bf16 v[40:43], v[28:31], a[8:15], v172
    v_smfmac_f32_16x16x64_bf16 v[44:47], v[28:31], a[72:79], v172
    v_smfmac_f32_16x16x64_bf16 v[48:51], v[28:31], a[40:47], v172
    v_smfmac_f32_16x16x64_bf16 v[52:55], v[28:31], a[104:111], v172
    s_branch g_27L9_3
g_27L13_0:
    s_waitcnt vmcnt(2)
    v_max3_u32 v19, v24, v25, v26
    v_max_u32 v19, v19, v27
    v_cmp_eq_u32 vcc, -1, v19
    s_nop 0
    s_cbranch_vccnz g_27F13_0
    v_smfmac_f32_16x16x64_bf16 v[40:43], v[24:27], a[0:7], v172
    v_smfmac_f32_16x16x64_bf16 v[44:47], v[24:27], a[64:71], v172
    v_smfmac_f32_16x16x64_bf16 v[48:51], v[24:27], a[32:39], v172
    v_smfmac_f32_16x16x64_bf16 v[52:55], v[24:27], a[96:103], v172
    s_branch g_27L12_2
g_27L13_3:
    s_waitcnt vmcnt(2)
    v_max3_u32 v19, v36, v37, v38
    v_max_u32 v19, v19, v39
    v_cmp_eq_u32 vcc, -1, v19
    s_nop 0
    s_cbranch_vccnz g_27F13_3
    v_smfmac_f32_16x16x64_bf16 v[40:43], v[36:39], a[24:31], v172
    v_smfmac_f32_16x16x64_bf16 v[44:47], v[36:39], a[88:95], v172
    v_smfmac_f32_16x16x64_bf16 v[48:51], v[36:39], a[56:63], v172
    v_smfmac_f32_16x16x64_bf16 v[52:55], v[36:39], a[120:127], v172
g_27L5_0:
    s_waitcnt vmcnt(1)
    v_max3_u32 v19, v24, v25, v26
    v_max_u32 v19, v19, v27
    v_cmp_eq_u32 vcc, -1, v19
    s_nop 0
    s_cbranch_vccnz g_27F5_0
    v_smfmac_f32_16x16x64_bf16 v[40:43], v[24:27], a[0:7], v172
    v_smfmac_f32_16x16x64_bf16 v[44:47], v[24:27], a[64:71], v172
    v_smfmac_f32_16x16x64_bf16 v[48:51], v[24:27], a[32:39], v172
    v_smfmac_f32_16x16x64_bf16 v[52:55], v[24:27], a[96:103], v172
    s_branch g_27L4_2
g_27L14_2:
    s_waitcnt vmcnt(2)
    v_max3_u32 v19, v32, v33, v34
    v_max_u32 v19, v19, v35
    v_cmp_eq_u32 vcc, -1, v19
    s_nop 0
    s_cbranch_vccnz g_27F14_2
    v_smfmac_f32_16x16x64_bf16 v[40:43], v[32:35], a[16:23], v172
    v_smfmac_f32_16x16x64_bf16 v[44:47], v[32:35], a[80:87], v172
    v_smfmac_f32_16x16x64_bf16 v[48:51], v[32:35], a[48:55], v172
    v_smfmac_f32_16x16x64_bf16 v[52:55], v[32:35], a[112:119], v172
g_27L10_3:
    s_waitcnt vmcnt(1)
    v_max3_u32 v19, v36, v37, v38
    v_max_u32 v19, v19, v39
    v_cmp_eq_u32 vcc, -1, v19
    s_nop 0
    s_cbranch_vccnz g_27F10_3
    v_smfmac_f32_16x16x64_bf16 v[40:43], v[36:39], a[24:31], v172
    v_smfmac_f32_16x16x64_bf16 v[44:47], v[36:39], a[88:95], v172
    v_smfmac_f32_16x16x64_bf16 v[48:51], v[36:39], a[56:63], v172
    v_smfmac_f32_16x16x64_bf16 v[52:55], v[36:39], a[120:127], v172
    s_branch g_27L2_1
g_27L14_3:
    s_waitcnt vmcnt(2)
    v_max3_u32 v19, v36, v37, v38
    v_max_u32 v19, v19, v39
    v_cmp_eq_u32 vcc, -1, v19
    s_nop 0
    s_cbranch_vccnz g_27F14_3
    v_smfmac_f32_16x16x64_bf16 v[40:43], v[36:39], a[24:31], v172
    v_smfmac_f32_16x16x64_bf16 v[44:47], v[36:39], a[88:95], v172
    v_smfmac_f32_16x16x64_bf16 v[48:51], v[36:39], a[56:63], v172
    v_smfmac_f32_16x16x64_bf16 v[52:55], v[36:39], a[120:127], v172
    s_branch g_27L6_1
g_27L3_1:
    s_waitcnt vmcnt(1)
    v_max3_u32 v19, v28, v29, v30
    v_max_u32 v19, v19, v31
    v_cmp_eq_u32 vcc, -1, v19
    s_nop 0
    s_cbranch_vccnz g_27F3_1
    v_smfmac_f32_16x16x64_bf16 v[40:43], v[28:31], a[8:15], v172
    v_smfmac_f32_16x16x64_bf16 v[44:47], v[28:31], a[72:79], v172
    v_smfmac_f32_16x16x64_bf16 v[48:51], v[28:31], a[40:47], v172
    v_smfmac_f32_16x16x64_bf16 v[52:55], v[28:31], a[104:111], v172
    s_branch g_27L1_0
g_27L6_2:
    s_waitcnt vmcnt(1)
    v_max3_u32 v19, v32, v33, v34
    v_max_u32 v19, v19, v35
    v_cmp_eq_u32 vcc, -1, v19
    s_nop 0
    s_cbranch_vccnz g_27F6_2
    v_smfmac_f32_16x16x64_bf16 v[40:43], v[32:35], a[16:23], v172
    v_smfmac_f32_16x16x64_bf16 v[44:47], v[32:35], a[80:87], v172
    v_smfmac_f32_16x16x64_bf16 v[48:51], v[32:35], a[48:55], v172
    v_smfmac_f32_16x16x64_bf16 v[52:55], v[32:35], a[112:119], v172
    s_branch g_27L2_1
g_27L9_0:
    s_waitcnt vmcnt(1)
    v_max3_u32 v19, v24, v25, v26
    v_max_u32 v19, v19, v27
    v_cmp_eq_u32 vcc, -1, v19
    s_nop 0
    s_cbranch_vccnz g_27F9_0
    v_smfmac_f32_16x16x64_bf16 v[40:43], v[24:27], a[0:7], v172
    v_smfmac_f32_16x16x64_bf16 v[44:47], v[24:27], a[64:71], v172
    v_smfmac_f32_16x16x64_bf16 v[48:51], v[24:27], a[32:39], v172
    v_smfmac_f32_16x16x64_bf16 v[52:55], v[24:27], a[96:103], v172
    s_branch g_27L8_3
g_27L12_3:
    s_waitcnt vmcnt(1)
    v_max3_u32 v19, v36, v37, v38
    v_max_u32 v19, v19, v39
    v_cmp_eq_u32 vcc, -1, v19
    s_nop 0
    s_cbranch_vccnz g_27F12_3
    v_smfmac_f32_16x16x64_bf16 v[40:43], v[36:39], a[24:31], v172
    v_smfmac_f32_16x16x64_bf16 v[44:47], v[36:39], a[88:95], v172
    v_smfmac_f32_16x16x64_bf16 v[48:51], v[36:39], a[56:63], v172
    v_smfmac_f32_16x16x64_bf16 v[52:55], v[36:39], a[120:127], v172
    s_branch g_27L4_2
g_27F15_0:
    s_mov_b64 exec, vcc
    buffer_load_dwordx4 v[24:27], v2, s[4:7], s16 offen offset:0 sc1
    s_mov_b64 exec, -1
    s_add_u32 s23, s23, 1
    s_cmp_lt_u32 s23, 200000
    s_cbranch_scc1 g_27L15_1
    s_mov_b32 s25, 200000
    s_branch gc_28
g_27F15_1:
    s_mov_b64 exec, vcc
    buffer_load_dwordx4 v[28:31], v2, s[4:7], s16 offen offset:1024 sc1
    s_mov_b64 exec, -1
    s_add_u32 s23, s23, 1
    s_cmp_lt_u32 s23, 200000
    s_cbranch_scc1 g_27L15_2
    s_mov_b32 s25, 200000
    s_branch gc_28
g_27F15_2:
    s_mov_b64 exec, vcc
    buffer_load_dwordx4 v[32:35], v2, s[4:7], s16 offen offset:2048 sc1
    s_mov_b64 exec, -1
    s_add_u32 s23, s23, 1
    s_cmp_lt_u32 s23, 200000
    s_cbranch_scc1 g_27L15_3
    s_mov_b32 s25, 200000
    s_branch gc_28
g_27F15_3:
    s_mov_b64 exec, vcc
    buffer_load_dwordx4 v[36:39], v2, s[4:7], s16 offen offset:3072 sc1
    s_mov_b64 exec, -1
    s_add_u32 s23, s23, 1
    s_cmp_lt_u32 s23, 200000
    s_cbranch_scc1 g_27L15_0
    s_mov_b32 s25, 200000
    s_branch gc_28
g_27F7_0:
    s_mov_b64 exec, vcc
    buffer_load_dwordx4 v[24:27], v2, s[4:7], s16 offen offset:0 sc1
    s_mov_b64 exec, -1
    s_add_u32 s23, s23, 1
    s_cmp_lt_u32 s23, 200000
    s_cbranch_scc1 g_27L7_1
    s_mov_b32 s25, 200000
    s_branch gc_28
g_27F7_1:
    s_mov_b64 exec, vcc
    buffer_load_dwordx4 v[28:31], v2, s[4:7], s16 offen offset:1024 sc1
    s_mov_b64 exec, -1
    s_add_u32 s23, s23, 1
    s_cmp_lt_u32 s23, 200000
    s_cbranch_scc1 g_27L7_2
    s_mov_b32 s25, 200000
    s_branch gc_28
g_27F7_2:
    s_mov_b64 exec, vcc
    buffer_load_dwordx4 v[32:35], v2, s[4:7], s16 offen offset:2048 sc1
    s_mov_b64 exec, -1
    s_add_u32 s23, s23, 1
    s_cmp_lt_u32 s23, 200000
    s_cbranch_scc1 g_27L7_0
    s_mov_b32 s25, 200000
    s_branch gc_28
g_27F11_0:
    s_mov_b64 exec, vcc
    buffer_load_dwordx4 v[24:27], v2, s[4:7], s16 offen offset:0 sc1
    s_mov_b64 exec, -1
    s_add_u32 s23, s23, 1
    s_cmp_lt_u32 s23, 200000
    s_cbranch_scc1 g_27L11_1
    s_mov_b32 s25, 200000
    s_branch gc_28
g_27F11_1:
    s_mov_b64 exec, vcc
    buffer_load_dwordx4 v[28:31], v2, s[4:7], s16 offen offset:1024 sc1
    s_mov_b64 exec, -1
    s_add_u32 s23, s23, 1
    s_cmp_lt_u32 s23, 200000
    s_cbranch_scc1 g_27L11_3
    s_mov_b32 s25, 200000
    s_branch gc_28
g_27F11_3:
    s_mov_b64 exec, vcc
    buffer_load_dwordx4 v[36:39], v2, s[4:7], s16 offen offset:3072 sc1
    s_mov_b64 exec, -1
    s_add_u32 s23, s23, 1
    s_cmp_lt_u32 s23, 200000
    s_cbranch_scc1 g_27L11_0
    s_mov_b32 s25, 200000
    s_branch gc_28
g_27F13_0:
    s_mov_b64 exec, vcc
    buffer_load_dwordx4 v[24:27], v2, s[4:7], s16 offen offset:0 sc1
    s_mov_b64 exec, -1
    s_add_u32 s23, s23, 1
    s_cmp_lt_u32 s23, 200000
    s_cbranch_scc1 g_27L13_2
    s_mov_b32 s25, 200000
    s_branch gc_28
g_27F13_2:
    s_mov_b64 exec, vcc
    buffer_load_dwordx4 v[32:35], v2, s[4:7], s16 offen offset:2048 sc1
    s_mov_b64 exec, -1
    s_add_u32 s23, s23, 1
    s_cmp_lt_u32 s23, 200000
    s_cbranch_scc1 g_27L13_3
    s_mov_b32 s25, 200000
    s_branch gc_28
g_27F13_3:
    s_mov_b64 exec, vcc
    buffer_load_dwordx4 v[36:39], v2, s[4:7], s16 offen offset:3072 sc1
    s_mov_b64 exec, -1
    s_add_u32 s23, s23, 1
    s_cmp_lt_u32 s23, 200000
    s_cbranch_scc1 g_27L13_0
    s_mov_b32 s25, 200000
    s_branch gc_28
g_27F14_1:
    s_mov_b64 exec, vcc
    buffer_load_dwordx4 v[28:31], v2, s[4:7], s16 offen offset:1024 sc1
    s_mov_b64 exec, -1
    s_add_u32 s23, s23, 1
    s_cmp_lt_u32 s23, 200000
    s_cbranch_scc1 g_27L14_2
    s_mov_b32 s25, 200000
    s_branch gc_28
g_27F14_2:
    s_mov_b64 exec, vcc
    buffer_load_dwordx4 v[32:35], v2, s[4:7], s16 offen offset:2048 sc1
    s_mov_b64 exec, -1
    s_add_u32 s23, s23, 1
    s_cmp_lt_u32 s23, 200000
    s_cbranch_scc1 g_27L14_3
    s_mov_b32 s25, 200000
    s_branch gc_28
g_27F14_3:
    s_mov_b64 exec, vcc
    buffer_load_dwordx4 v[36:39], v2, s[4:7], s16 offen offset:3072 sc1
    s_mov_b64 exec, -1
    s_add_u32 s23, s23, 1
    s_cmp_lt_u32 s23, 200000
    s_cbranch_scc1 g_27L14_1
    s_mov_b32 s25, 200000
    s_branch gc_28
g_27F3_0:
    s_mov_b64 exec, vcc
    buffer_load_dwordx4 v[24:27], v2, s[4:7], s16 offen offset:0 sc1
    s_mov_b64 exec, -1
    s_add_u32 s23, s23, 1
    s_cmp_lt_u32 s23, 200000
    s_cbranch_scc1 g_27L3_1
    s_mov_b32 s25, 200000
    s_branch gc_28
g_27F3_1:
    s_mov_b64 exec, vcc
    buffer_load_dwordx4 v[28:31], v2, s[4:7], s16 offen offset:1024 sc1
    s_mov_b64 exec, -1
    s_add_u32 s23, s23, 1
    s_cmp_lt_u32 s23, 200000
    s_cbranch_scc1 g_27L3_0
    s_mov_b32 s25, 200000
    s_branch gc_28
g_27F5_0:
    s_mov_b64 exec, vcc
    buffer_load_dwordx4 v[24:27], v2, s[4:7], s16 offen offset:0 sc1
    s_mov_b64 exec, -1
    s_add_u32 s23, s23, 1
    s_cmp_lt_u32 s23, 200000
    s_cbranch_scc1 g_27L5_2
    s_mov_b32 s25, 200000
    s_branch gc_28
g_27F5_2:
    s_mov_b64 exec, vcc
    buffer_load_dwordx4 v[32:35], v2, s[4:7], s16 offen offset:2048 sc1
    s_mov_b64 exec, -1
    s_add_u32 s23, s23, 1
    s_cmp_lt_u32 s23, 200000
    s_cbranch_scc1 g_27L5_0
    s_mov_b32 s25, 200000
    s_branch gc_28
g_27F6_1:
    s_mov_b64 exec, vcc
    buffer_load_dwordx4 v[28:31], v2, s[4:7], s16 offen offset:1024 sc1
    s_mov_b64 exec, -1
    s_add_u32 s23, s23, 1
    s_cmp_lt_u32 s23, 200000
    s_cbranch_scc1 g_27L6_2
    s_mov_b32 s25, 200000
    s_branch gc_28
g_27F6_2:
    s_mov_b64 exec, vcc
    buffer_load_dwordx4 v[32:35], v2, s[4:7], s16 offen offset:2048 sc1
    s_mov_b64 exec, -1
    s_add_u32 s23, s23, 1
    s_cmp_lt_u32 s23, 200000
    s_cbranch_scc1 g_27L6_1
    s_mov_b32 s25, 200000
    s_branch gc_28
g_27F9_0:
    s_mov_b64 exec, vcc
    buffer_load_dwordx4 v[24:27], v2, s[4:7], s16 offen offset:0 sc1
    s_mov_b64 exec, -1
    s_add_u32 s23, s23, 1
    s_cmp_lt_u32 s23, 200000
    s_cbranch_scc1 g_27L9_3
    s_mov_b32 s25, 200000
    s_branch gc_28
g_27F9_3:
    s_mov_b64 exec, vcc
    buffer_load_dwordx4 v[36:39], v2, s[4:7], s16 offen offset:3072 sc1
    s_mov_b64 exec, -1
    s_add_u32 s23, s23, 1
    s_cmp_lt_u32 s23, 200000
    s_cbranch_scc1 g_27L9_0
    s_mov_b32 s25, 200000
    s_branch gc_28
g_27F10_1:
    s_mov_b64 exec, vcc
    buffer_load_dwordx4 v[28:31], v2, s[4:7], s16 offen offset:1024 sc1
    s_mov_b64 exec, -1
    s_add_u32 s23, s23, 1
    s_cmp_lt_u32 s23, 200000
    s_cbranch_scc1 g_27L10_3
    s_mov_b32 s25, 200000
    s_branch gc_28
g_27F10_3:
    s_mov_b64 exec, vcc
    buffer_load_dwordx4 v[36:39], v2, s[4:7], s16 offen offset:3072 sc1
    s_mov_b64 exec, -1
    s_add_u32 s23, s23, 1
    s_cmp_lt_u32 s23, 200000
    s_cbranch_scc1 g_27L10_1
    s_mov_b32 s25, 200000
    s_branch gc_28
g_27F12_2:
    s_mov_b64 exec, vcc
    buffer_load_dwordx4 v[32:35], v2, s[4:7], s16 offen offset:2048 sc1
    s_mov_b64 exec, -1
    s_add_u32 s23, s23, 1
    s_cmp_lt_u32 s23, 200000
    s_cbranch_scc1 g_27L12_3
    s_mov_b32 s25, 200000
    s_branch gc_28
g_27F12_3:
    s_mov_b64 exec, vcc
    buffer_load_dwordx4 v[36:39], v2, s[4:7], s16 offen offset:3072 sc1
    s_mov_b64 exec, -1
    s_add_u32 s23, s23, 1
    s_cmp_lt_u32 s23, 200000
    s_cbranch_scc1 g_27L12_2
    s_mov_b32 s25, 200000
    s_branch gc_28
g_27F1_0:
    s_mov_b64 exec, vcc
    buffer_load_dwordx4 v[24:27], v2, s[4:7], s16 offen offset:0 sc1
    s_mov_b64 exec, -1
    s_add_u32 s23, s23, 1
    s_cmp_lt_u32 s23, 200000
    s_cbranch_scc1 g_27L1_0
    s_mov_b32 s25, 200000
    s_branch gc_28
g_27F2_1:
    s_mov_b64 exec, vcc
    buffer_load_dwordx4 v[28:31], v2, s[4:7], s16 offen offset:1024 sc1
    s_mov_b64 exec, -1
    s_add_u32 s23, s23, 1
    s_cmp_lt_u32 s23, 200000
    s_cbranch_scc1 g_27L2_1
    s_mov_b32 s25, 200000
    s_branch gc_28
g_27F4_2:
    s_mov_b64 exec, vcc
    buffer_load_dwordx4 v[32:35], v2, s[4:7], s16 offen offset:2048 sc1
    s_mov_b64 exec, -1
    s_add_u32 s23, s23, 1
    s_cmp_lt_u32 s23, 200000
    s_cbranch_scc1 g_27L4_2
    s_mov_b32 s25, 200000
    s_branch gc_28
g_27F8_3:
    s_mov_b64 exec, vcc
    buffer_load_dwordx4 v[36:39], v2, s[4:7], s16 offen offset:3072 sc1
    s_mov_b64 exec, -1
    s_add_u32 s23, s23, 1
    s_cmp_lt_u32 s23, 200000
    s_cbranch_scc1 g_27L8_3
    s_mov_b32 s25, 200000
    s_branch gc_28
recur_fast_last0:
    buffer_store_dwordx4 v[128:131], v14, s[4:7], s19 offen sc1
    s_branch recur_end
g_29L15_0:
    s_waitcnt vmcnt(3)
    v_max3_u32 v19, v24, v25, v26
    v_max_u32 v19, v19, v27
    v_cmp_eq_u32 vcc, -1, v19
    s_nop 0
    s_cbranch_vccnz g_29F15_0
    v_smfmac_f32_16x16x64_bf16 v[64:67], v[24:27], a[192:199], v172
    v_smfmac_f32_16x16x64_bf16 v[68:71], v[24:27], a[224:231], v172
g_29L14_1:
    s_waitcnt vmcnt(2)
    v_max3_u32 v19, v28, v29, v30
    v_max_u32 v19, v19, v31
    v_cmp_eq_u32 vcc, -1, v19
    s_nop 0
    s_cbranch_vccnz g_29F14_1
    v_smfmac_f32_16x16x64_bf16 v[64:67], v[28:31], a[200:207], v172
    v_smfmac_f32_16x16x64_bf16 v[68:71], v[28:31], a[232:239], v172
g_29L12_2:
    s_waitcnt vmcnt(1)
    v_max3_u32 v19, v32, v33, v34
    v_max_u32 v19, v19, v35
    v_cmp_eq_u32 vcc, -1, v19
    s_nop 0
    s_cbranch_vccnz g_29F12_2
    v_smfmac_f32_16x16x64_bf16 v[64:67], v[32:35], a[208:215], v172
    v_smfmac_f32_16x16x64_bf16 v[68:71], v[32:35], a[240:247], v172
g_29L8_3:
    s_waitcnt vmcnt(0)
    v_max3_u32 v19, v36, v37, v38
    v_max_u32 v19, v19, v39
    v_cmp_eq_u32 vcc, -1, v19
    s_nop 0
    s_cbranch_vccnz g_29F8_3
    v_smfmac_f32_16x16x64_bf16 v[64:67], v[36:39], a[216:223], v172
    v_smfmac_f32_16x16x64_bf16 v[68:71], v[36:39], a[248:255], v172
    s_nop 4
    v_cvt_pk_bf16_f32 v80, v64, v65
    v_cvt_pk_bf16_f32 v81, v66, v67
    s_nop 0
    v_cvt_pk_bf16_f32 v82, v68, v69
    v_cvt_pk_bf16_f32 v83, v70, v71
    ds_write_b128 v17, v[80:83] offset:9216
    s_branch gc_30
g_29L15_1:
    s_waitcnt vmcnt(3)
    v_max3_u32 v19, v28, v29, v30
    v_max_u32 v19, v19, v31
    v_cmp_eq_u32 vcc, -1, v19
    s_nop 0
    s_cbranch_vccnz g_29F15_1
    v_smfmac_f32_16x16x64_bf16 v[64:67], v[28:31], a[200:207], v172
    v_smfmac_f32_16x16x64_bf16 v[68:71], v[28:31], a[232:239], v172
g_29L13_2:
    s_waitcnt vmcnt(2)
    v_max3_u32 v19, v32, v33, v34
    v_max_u32 v19, v19, v35
    v_cmp_eq_u32 vcc, -1, v19
    s_nop 0
    s_cbranch_vccnz g_29F13_2
    v_smfmac_f32_16x16x64_bf16 v[64:67], v[32:35], a[208:215], v172
    v_smfmac_f32_16x16x64_bf16 v[68:71], v[32:35], a[240:247], v172
g_29L9_3:
    s_waitcnt vmcnt(1)
    v_max3_u32 v19, v36, v37, v38
    v_max_u32 v19, v19, v39
    v_cmp_eq_u32 vcc, -1, v19
    s_nop 0
    s_cbranch_vccnz g_29F9_3
    v_smfmac_f32_16x16x64_bf16 v[64:67], v[36:39], a[216:223], v172
    v_smfmac_f32_16x16x64_bf16 v[68:71], v[36:39], a[248:255], v172
g_29L1_0:
    s_waitcnt vmcnt(0)
    v_max3_u32 v19, v24, v25, v26
    v_max_u32 v19, v19, v27
    v_cmp_eq_u32 vcc, -1, v19
    s_nop 0
    s_cbranch_vccnz g_29F1_0
    v_smfmac_f32_16x16x64_bf16 v[64:67], v[24:27], a[192:199], v172
    v_smfmac_f32_16x16x64_bf16 v[68:71], v[24:27], a[224:231], v172
    s_nop 4
    v_cvt_pk_bf16_f32 v80, v64, v65
    v_cvt_pk_bf16_f32 v81, v66, v67
    s_nop 0
    v_cvt_pk_bf16_f32 v82, v68, v69
    v_cvt_pk_bf16_f32 v83, v70, v71
    ds_write_b128 v17, v[80:83] offset:9216
    s_branch gc_30
g_29L15_2:
    s_waitcnt vmcnt(3)
    v_max3_u32 v19, v32, v33, v34
    v_max_u32 v19, v19, v35
    v_cmp_eq_u32 vcc, -1, v19
    s_nop 0
    s_cbranch_vccnz g_29F15_2
    v_smfmac_f32_16x16x64_bf16 v[64:67], v[32:35], a[208:215], v172
    v_smfmac_f32_16x16x64_bf16 v[68:71], v[32:35], a[240:247], v172
g_29L11_3:
    s_waitcnt vmcnt(2)
    v_max3_u32 v19, v36, v37, v38
    v_max_u32 v19, v19, v39
    v_cmp_eq_u32 vcc, -1, v19
    s_nop 0
    s_cbranch_vccnz g_29F11_3
    v_smfmac_f32_16x16x64_bf16 v[64:67], v[36:39], a[216:223], v172
    v_smfmac_f32_16x16x64_bf16 v[68:71], v[36:39], a[248:255], v172
g_29L3_0:
    s_waitcnt vmcnt(1)
    v_max3_u32 v19, v24, v25, v26
    v_max_u32 v19, v19, v27
    v_cmp_eq_u32 vcc, -1, v19
    s_nop 0
    s_cbranch_vccnz g_29F3_0
    v_smfmac_f32_16x16x64_bf16 v[64:67], v[24:27], a[192:199], v172
    v_smfmac_f32_16x16x64_bf16 v[68:71], v[24:27], a[224:231], v172
g_29L2_1:
    s_waitcnt vmcnt(0)
    v_max3_u32 v19, v28, v29, v30
    v_max_u32 v19, v19, v31
    v_cmp_eq_u32 vcc, -1, v19
    s_nop 0
    s_cbranch_vccnz g_29F2_1
    v_smfmac_f32_16x16x64_bf16 v[64:67], v[28:31], a[200:207], v172
    v_smfmac_f32_16x16x64_bf16 v[68:71], v[28:31], a[232:239], v172
    s_nop 4
    v_cvt_pk_bf16_f32 v80, v64, v65
    v_cvt_pk_bf16_f32 v81, v66, v67
    s_nop 0
    v_cvt_pk_bf16_f32 v82, v68, v69
    v_cvt_pk_bf16_f32 v83, v70, v71
    ds_write_b128 v17, v[80:83] offset:9216
    s_branch gc_30
g_29L15_3:
    s_waitcnt vmcnt(3)
    v_max3_u32 v19, v36, v37, v38
    v_max_u32 v19, v19, v39
    v_cmp_eq_u32 vcc, -1, v19
    s_nop 0
    s_cbranch_vccnz g_29F15_3
    v_smfmac_f32_16x16x64_bf16 v[64:67], v[36:39], a[216:223], v172
    v_smfmac_f32_16x16x64_bf16 v[68:71], v[36:39], a[248:255], v172
g_29L7_0:
    s_waitcnt vmcnt(2)
    v_max3_u32 v19, v24, v25, v26
    v_max_u32 v19, v19, v27
    v_cmp_eq_u32 vcc, -1, v19
    s_nop 0
    s_cbranch_vccnz g_29F7_0
    v_smfmac_f32_16x16x64_bf16 v[64:67], v[24:27], a[192:199], v172
    v_smfmac_f32_16x16x64_bf16 v[68:71], v[24:27], a[224:231], v172
g_29L6_1:
    s_waitcnt vmcnt(1)
    v_max3_u32 v19, v28, v29, v30
    v_max_u32 v19, v19, v31
    v_cmp_eq_u32 vcc, -1, v19
    s_nop 0
    s_cbranch_vccnz g_29F6_1
    v_smfmac_f32_16x16x64_bf16 v[64:67], v[28:31], a[200:207], v172
    v_smfmac_f32_16x16x64_bf16 v[68:71], v[28:31], a[232:239], v172
g_29L4_2:
    s_waitcnt vmcnt(0)
    v_max3_u32 v19, v32, v33, v34
    v_max_u32 v19, v19, v35
    v_cmp_eq_u32 vcc, -1, v19
    s_nop 0
    s_cbranch_vccnz g_29F4_2
    v_smfmac_f32_16x16x64_bf16 v[64:67], v[32:35], a[208:215], v172
    v_smfmac_f32_16x16x64_bf16 v[68:71], v[32:35], a[240:247], v172
    s_nop 4
    v_cvt_pk_bf16_f32 v80, v64, v65
    v_cvt_pk_bf16_f32 v81, v66, v67
    s_nop 0
    v_cvt_pk_bf16_f32 v82, v68, v69
    v_cvt_pk_bf16_f32 v83, v70, v71
    ds_write_b128 v17, v[80:83] offset:9216
    s_branch gc_30
g_29L7_1:
    s_waitcnt vmcnt(2)
    v_max3_u32 v19, v28, v29, v30
    v_max_u32 v19, v19, v31
    v_cmp_eq_u32 vcc, -1, v19
    s_nop 0
    s_cbranch_vccnz g_29F7_1
    v_smfmac_f32_16x16x64_bf16 v[64:67], v[28:31], a[200:207], v172
    v_smfmac_f32_16x16x64_bf16 v[68:71], v[28:31], a[232:239], v172
g_29L5_2:
    s_waitcnt vmcnt(1)
    v_max3_u32 v19, v32, v33, v34
    v_max_u32 v19, v19, v35
    v_cmp_eq_u32 vcc, -1, v19
    s_nop 0
    s_cbranch_vccnz g_29F5_2
    v_smfmac_f32_16x16x64_bf16 v[64:67], v[32:35], a[208:215], v172
    v_smfmac_f32_16x16x64_bf16 v[68:71], v[32:35], a[240:247], v172
    s_branch g_29L1_0
g_29L7_2:
    s_waitcnt vmcnt(2)
    v_max3_u32 v19, v32, v33, v34
    v_max_u32 v19, v19, v35
    v_cmp_eq_u32 vcc, -1, v19
    s_nop 0
    s_cbranch_vccnz g_29F7_2
    v_smfmac_f32_16x16x64_bf16 v[64:67], v[32:35], a[208:215], v172
    v_smfmac_f32_16x16x64_bf16 v[68:71], v[32:35], a[240:247], v172
    s_branch g_29L3_0
g_29L11_0:
    s_waitcnt vmcnt(2)
    v_max3_u32 v19, v24, v25, v26
    v_max_u32 v19, v19, v27
    v_cmp_eq_u32 vcc, -1, v19
    s_nop 0
    s_cbranch_vccnz g_29F11_0
    v_smfmac_f32_16x16x64_bf16 v[64:67], v[24:27], a[192:199], v172
    v_smfmac_f32_16x16x64_bf16 v[68:71], v[24:27], a[224:231], v172
g_29L10_1:
    s_waitcnt vmcnt(1)
    v_max3_u32 v19, v28, v29, v30
    v_max_u32 v19, v19, v31
    v_cmp_eq_u32 vcc, -1, v19
    s_nop 0
    s_cbranch_vccnz g_29F10_1
    v_smfmac_f32_16x16x64_bf16 v[64:67], v[28:31], a[200:207], v172
    v_smfmac_f32_16x16x64_bf16 v[68:71], v[28:31], a[232:239], v172
    s_branch g_29L8_3
g_29L11_1:
    s_waitcnt vmcnt(2)
    v_max3_u32 v19, v28, v29, v30
    v_max_u32 v19, v19, v31
    v_cmp_eq_u32 vcc, -1, v19
    s_nop 0
    s_cbranch_vccnz g_29F11_1
    v_smfmac_f32_16x16x64_bf16 v[64:67], v[28:31], a[200:207], v172
    v_smfmac_f32_16x16x64_bf16 v[68:71], v[28:31], a[232:239], v172
    s_branch g_29L9_3
g_29L13_0:
    s_waitcnt vmcnt(2)
    v_max3_u32 v19, v24, v25, v26
    v_max_u32 v19, v19, v27
    v_cmp_eq_u32 vcc, -1, v19
    s_nop 0
    s_cbranch_vccnz g_29F13_0
    v_smfmac_f32_16x16x64_bf16 v[64:67], v[24:27], a[192:199], v172
    v_smfmac_f32_16x16x64_bf16 v[68:71], v[24:27], a[224:231], v172
    s_branch g_29L12_2
g_29L13_3:
    s_waitcnt vmcnt(2)
    v_max3_u32 v19, v36, v37, v38
    v_max_u32 v19, v19, v39
    v_cmp_eq_u32 vcc, -1, v19
    s_nop 0
    s_cbranch_vccnz g_29F13_3
    v_smfmac_f32_16x16x64_bf16 v[64:67], v[36:39], a[216:223], v172
    v_smfmac_f32_16x16x64_bf16 v[68:71], v[36:39], a[248:255], v172
g_29L5_0:
    s_waitcnt vmcnt(1)
    v_max3_u32 v19, v24, v25, v26
    v_max_u32 v19, v19, v27
    v_cmp_eq_u32 vcc, -1, v19
    s_nop 0
    s_cbranch_vccnz g_29F5_0
    v_smfmac_f32_16x16x64_bf16 v[64:67], v[24:27], a[192:199], v172
    v_smfmac_f32_16x16x64_bf16 v[68:71], v[24:27], a[224:231], v172
    s_branch g_29L4_2
g_29L14_2:
    s_waitcnt vmcnt(2)
    v_max3_u32 v19, v32, v33, v34
    v_max_u32 v19, v19, v35
    v_cmp_eq_u32 vcc, -1, v19
    s_nop 0
    s_cbranch_vccnz g_29F14_2
    v_smfmac_f32_16x16x64_bf16 v[64:67], v[32:35], a[208:215], v172
    v_smfmac_f32_16x16x64_bf16 v[68:71], v[32:35], a[240:247], v172
g_29L10_3:
    s_waitcnt vmcnt(1)
    v_max3_u32 v19, v36, v37, v38
    v_max_u32 v19, v19, v39
    v_cmp_eq_u32 vcc, -1, v19
    s_nop 0
    s_cbranch_vccnz g_29F10_3
    v_smfmac_f32_16x16x64_bf16 v[64:67], v[36:39], a[216:223], v172
    v_smfmac_f32_16x16x64_bf16 v[68:71], v[36:39], a[248:255], v172
    s_branch g_29L2_1
g_29L14_3:
    s_waitcnt vmcnt(2)
    v_max3_u32 v19, v36, v37, v38
    v_max_u32 v19, v19, v39
    v_cmp_eq_u32 vcc, -1, v19
    s_nop 0
    s_cbranch_vccnz g_29F14_3
    v_smfmac_f32_16x16x64_bf16 v[64:67], v[36:39], a[216:223], v172
    v_smfmac_f32_16x16x64_bf16 v[68:71], v[36:39], a[248:255], v172
    s_branch g_29L6_1
g_29L3_1:
    s_waitcnt vmcnt(1)
    v_max3_u32 v19, v28, v29, v30
    v_max_u32 v19, v19, v31
    v_cmp_eq_u32 vcc, -1, v19
    s_nop 0
    s_cbranch_vccnz g_29F3_1
    v_smfmac_f32_16x16x64_bf16 v[64:67], v[28:31], a[200:207], v172
    v_smfmac_f32_16x16x64_bf16 v[68:71], v[28:31], a[232:239], v172
    s_branch g_29L1_0
g_29L6_2:
    s_waitcnt vmcnt(1)
    v_max3_u32 v19, v32, v33, v34
    v_max_u32 v19, v19, v35
    v_cmp_eq_u32 vcc, -1, v19
    s_nop 0
    s_cbranch_vccnz g_29F6_2
    v_smfmac_f32_16x16x64_bf16 v[64:67], v[32:35], a[208:215], v172
    v_smfmac_f32_16x16x64_bf16 v[68:71], v[32:35], a[240:247], v172
    s_branch g_29L2_1
g_29L9_0:
    s_waitcnt vmcnt(1)
    v_max3_u32 v19, v24, v25, v26
    v_max_u32 v19, v19, v27
    v_cmp_eq_u32 vcc, -1, v19
    s_nop 0
    s_cbranch_vccnz g_29F9_0
    v_smfmac_f32_16x16x64_bf16 v[64:67], v[24:27], a[192:199], v172
    v_smfmac_f32_16x16x64_bf16 v[68:71], v[24:27], a[224:231], v172
    s_branch g_29L8_3
g_29L12_3:
    s_waitcnt vmcnt(1)
    v_max3_u32 v19, v36, v37, v38
    v_max_u32 v19, v19, v39
    v_cmp_eq_u32 vcc, -1, v19
    s_nop 0
    s_cbranch_vccnz g_29F12_3
    v_smfmac_f32_16x16x64_bf16 v[64:67], v[36:39], a[216:223], v172
    v_smfmac_f32_16x16x64_bf16 v[68:71], v[36:39], a[248:255], v172
    s_branch g_29L4_2
g_29F15_0:
    s_mov_b64 exec, vcc
    buffer_load_dwordx4 v[24:27], v8, s[4:7], s16 offen offset:0 sc1
    s_mov_b64 exec, -1
    s_add_u32 s23, s23, 1
    s_cmp_lt_u32 s23, 200000
    s_cbranch_scc1 g_29L15_1
    s_mov_b32 s25, 200000
    s_branch gc_30
g_29F15_1:
    s_mov_b64 exec, vcc
    buffer_load_dwordx4 v[28:31], v8, s[4:7], s16 offen offset:1024 sc1
    s_mov_b64 exec, -1
    s_add_u32 s23, s23, 1
    s_cmp_lt_u32 s23, 200000
    s_cbranch_scc1 g_29L15_2
    s_mov_b32 s25, 200000
    s_branch gc_30
g_29F15_2:
    s_mov_b64 exec, vcc
    buffer_load_dwordx4 v[32:35], v8, s[4:7], s16 offen offset:2048 sc1
    s_mov_b64 exec, -1
    s_add_u32 s23, s23, 1
    s_cmp_lt_u32 s23, 200000
    s_cbranch_scc1 g_29L15_3
    s_mov_b32 s25, 200000
    s_branch gc_30
g_29F15_3:
    s_mov_b64 exec, vcc
    buffer_load_dwordx4 v[36:39], v8, s[4:7], s16 offen offset:3072 sc1
    s_mov_b64 exec, -1
    s_add_u32 s23, s23, 1
    s_cmp_lt_u32 s23, 200000
    s_cbranch_scc1 g_29L15_0
    s_mov_b32 s25, 200000
    s_branch gc_30
g_29F7_0:
    s_mov_b64 exec, vcc
    buffer_load_dwordx4 v[24:27], v8, s[4:7], s16 offen offset:0 sc1
    s_mov_b64 exec, -1
    s_add_u32 s23, s23, 1
    s_cmp_lt_u32 s23, 200000
    s_cbranch_scc1 g_29L7_1
    s_mov_b32 s25, 200000
    s_branch gc_30
g_29F7_1:
    s_mov_b64 exec, vcc
    buffer_load_dwordx4 v[28:31], v8, s[4:7], s16 offen offset:1024 sc1
    s_mov_b64 exec, -1
    s_add_u32 s23, s23, 1
    s_cmp_lt_u32 s23, 200000
    s_cbranch_scc1 g_29L7_2
    s_mov_b32 s25, 200000
    s_branch gc_30
g_29F7_2:
    s_mov_b64 exec, vcc
    buffer_load_dwordx4 v[32:35], v8, s[4:7], s16 offen offset:2048 sc1
    s_mov_b64 exec, -1
    s_add_u32 s23, s23, 1
    s_cmp_lt_u32 s23, 200000
    s_cbranch_scc1 g_29L7_0
    s_mov_b32 s25, 200000
    s_branch gc_30
g_29F11_0:
    s_mov_b64 exec, vcc
    buffer_load_dwordx4 v[24:27], v8, s[4:7], s16 offen offset:0 sc1
    s_mov_b64 exec, -1
    s_add_u32 s23, s23, 1
    s_cmp_lt_u32 s23, 200000
    s_cbranch_scc1 g_29L11_1
    s_mov_b32 s25, 200000
    s_branch gc_30
g_29F11_1:
    s_mov_b64 exec, vcc
    buffer_load_dwordx4 v[28:31], v8, s[4:7], s16 offen offset:1024 sc1
    s_mov_b64 exec, -1
    s_add_u32 s23, s23, 1
    s_cmp_lt_u32 s23, 200000
    s_cbranch_scc1 g_29L11_3
    s_mov_b32 s25, 200000
    s_branch gc_30
g_29F11_3:
    s_mov_b64 exec, vcc
    buffer_load_dwordx4 v[36:39], v8, s[4:7], s16 offen offset:3072 sc1
    s_mov_b64 exec, -1
    s_add_u32 s23, s23, 1
    s_cmp_lt_u32 s23, 200000
    s_cbranch_scc1 g_29L11_0
    s_mov_b32 s25, 200000
    s_branch gc_30
g_29F13_0:
    s_mov_b64 exec, vcc
    buffer_load_dwordx4 v[24:27], v8, s[4:7], s16 offen offset:0 sc1
    s_mov_b64 exec, -1
    s_add_u32 s23, s23, 1
    s_cmp_lt_u32 s23, 200000
    s_cbranch_scc1 g_29L13_2
    s_mov_b32 s25, 200000
    s_branch gc_30
g_29F13_2:
    s_mov_b64 exec, vcc
    buffer_load_dwordx4 v[32:35], v8, s[4:7], s16 offen offset:2048 sc1
    s_mov_b64 exec, -1
    s_add_u32 s23, s23, 1
    s_cmp_lt_u32 s23, 200000
    s_cbranch_scc1 g_29L13_3
    s_mov_b32 s25, 200000
    s_branch gc_30
g_29F13_3:
    s_mov_b64 exec, vcc
    buffer_load_dwordx4 v[36:39], v8, s[4:7], s16 offen offset:3072 sc1
    s_mov_b64 exec, -1
    s_add_u32 s23, s23, 1
    s_cmp_lt_u32 s23, 200000
    s_cbranch_scc1 g_29L13_0
    s_mov_b32 s25, 200000
    s_branch gc_30
g_29F14_1:
    s_mov_b64 exec, vcc
    buffer_load_dwordx4 v[28:31], v8, s[4:7], s16 offen offset:1024 sc1
    s_mov_b64 exec, -1
    s_add_u32 s23, s23, 1
    s_cmp_lt_u32 s23, 200000
    s_cbranch_scc1 g_29L14_2
    s_mov_b32 s25, 200000
    s_branch gc_30
g_29F14_2:
    s_mov_b64 exec, vcc
    buffer_load_dwordx4 v[32:35], v8, s[4:7], s16 offen offset:2048 sc1
    s_mov_b64 exec, -1
    s_add_u32 s23, s23, 1
    s_cmp_lt_u32 s23, 200000
    s_cbranch_scc1 g_29L14_3
    s_mov_b32 s25, 200000
    s_branch gc_30
g_29F14_3:
    s_mov_b64 exec, vcc
    buffer_load_dwordx4 v[36:39], v8, s[4:7], s16 offen offset:3072 sc1
    s_mov_b64 exec, -1
    s_add_u32 s23, s23, 1
    s_cmp_lt_u32 s23, 200000
    s_cbranch_scc1 g_29L14_1
    s_mov_b32 s25, 200000
    s_branch gc_30
g_29F3_0:
    s_mov_b64 exec, vcc
    buffer_load_dwordx4 v[24:27], v8, s[4:7], s16 offen offset:0 sc1
    s_mov_b64 exec, -1
    s_add_u32 s23, s23, 1
    s_cmp_lt_u32 s23, 200000
    s_cbranch_scc1 g_29L3_1
    s_mov_b32 s25, 200000
    s_branch gc_30
g_29F3_1:
    s_mov_b64 exec, vcc
    buffer_load_dwordx4 v[28:31], v8, s[4:7], s16 offen offset:1024 sc1
    s_mov_b64 exec, -1
    s_add_u32 s23, s23, 1
    s_cmp_lt_u32 s23, 200000
    s_cbranch_scc1 g_29L3_0
    s_mov_b32 s25, 200000
    s_branch gc_30
g_29F5_0:
    s_mov_b64 exec, vcc
    buffer_load_dwordx4 v[24:27], v8, s[4:7], s16 offen offset:0 sc1
    s_mov_b64 exec, -1
    s_add_u32 s23, s23, 1
    s_cmp_lt_u32 s23, 200000
    s_cbranch_scc1 g_29L5_2
    s_mov_b32 s25, 200000
    s_branch gc_30
g_29F5_2:
    s_mov_b64 exec, vcc
    buffer_load_dwordx4 v[32:35], v8, s[4:7], s16 offen offset:2048 sc1
    s_mov_b64 exec, -1
    s_add_u32 s23, s23, 1
    s_cmp_lt_u32 s23, 200000
    s_cbranch_scc1 g_29L5_0
    s_mov_b32 s25, 200000
    s_branch gc_30
g_29F6_1:
    s_mov_b64 exec, vcc
    buffer_load_dwordx4 v[28:31], v8, s[4:7], s16 offen offset:1024 sc1
    s_mov_b64 exec, -1
    s_add_u32 s23, s23, 1
    s_cmp_lt_u32 s23, 200000
    s_cbranch_scc1 g_29L6_2
    s_mov_b32 s25, 200000
    s_branch gc_30
g_29F6_2:
    s_mov_b64 exec, vcc
    buffer_load_dwordx4 v[32:35], v8, s[4:7], s16 offen offset:2048 sc1
    s_mov_b64 exec, -1
    s_add_u32 s23, s23, 1
    s_cmp_lt_u32 s23, 200000
    s_cbranch_scc1 g_29L6_1
    s_mov_b32 s25, 200000
    s_branch gc_30
g_29F9_0:
    s_mov_b64 exec, vcc
    buffer_load_dwordx4 v[24:27], v8, s[4:7], s16 offen offset:0 sc1
    s_mov_b64 exec, -1
    s_add_u32 s23, s23, 1
    s_cmp_lt_u32 s23, 200000
    s_cbranch_scc1 g_29L9_3
    s_mov_b32 s25, 200000
    s_branch gc_30
g_29F9_3:
    s_mov_b64 exec, vcc
    buffer_load_dwordx4 v[36:39], v8, s[4:7], s16 offen offset:3072 sc1
    s_mov_b64 exec, -1
    s_add_u32 s23, s23, 1
    s_cmp_lt_u32 s23, 200000
    s_cbranch_scc1 g_29L9_0
    s_mov_b32 s25, 200000
    s_branch gc_30
g_29F10_1:
    s_mov_b64 exec, vcc
    buffer_load_dwordx4 v[28:31], v8, s[4:7], s16 offen offset:1024 sc1
    s_mov_b64 exec, -1
    s_add_u32 s23, s23, 1
    s_cmp_lt_u32 s23, 200000
    s_cbranch_scc1 g_29L10_3
    s_mov_b32 s25, 200000
    s_branch gc_30
g_29F10_3:
    s_mov_b64 exec, vcc
    buffer_load_dwordx4 v[36:39], v8, s[4:7], s16 offen offset:3072 sc1
    s_mov_b64 exec, -1
    s_add_u32 s23, s23, 1
    s_cmp_lt_u32 s23, 200000
    s_cbranch_scc1 g_29L10_1
    s_mov_b32 s25, 200000
    s_branch gc_30
g_29F12_2:
    s_mov_b64 exec, vcc
    buffer_load_dwordx4 v[32:35], v8, s[4:7], s16 offen offset:2048 sc1
    s_mov_b64 exec, -1
    s_add_u32 s23, s23, 1
    s_cmp_lt_u32 s23, 200000
    s_cbranch_scc1 g_29L12_3
    s_mov_b32 s25, 200000
    s_branch gc_30
g_29F12_3:
    s_mov_b64 exec, vcc
    buffer_load_dwordx4 v[36:39], v8, s[4:7], s16 offen offset:3072 sc1
    s_mov_b64 exec, -1
    s_add_u32 s23, s23, 1
    s_cmp_lt_u32 s23, 200000
    s_cbranch_scc1 g_29L12_2
    s_mov_b32 s25, 200000
    s_branch gc_30
g_29F1_0:
    s_mov_b64 exec, vcc
    buffer_load_dwordx4 v[24:27], v8, s[4:7], s16 offen offset:0 sc1
    s_mov_b64 exec, -1
    s_add_u32 s23, s23, 1
    s_cmp_lt_u32 s23, 200000
    s_cbranch_scc1 g_29L1_0
    s_mov_b32 s25, 200000
    s_branch gc_30
g_29F2_1:
    s_mov_b64 exec, vcc
    buffer_load_dwordx4 v[28:31], v8, s[4:7], s16 offen offset:1024 sc1
    s_mov_b64 exec, -1
    s_add_u32 s23, s23, 1
    s_cmp_lt_u32 s23, 200000
    s_cbranch_scc1 g_29L2_1
    s_mov_b32 s25, 200000
    s_branch gc_30
g_29F4_2:
    s_mov_b64 exec, vcc
    buffer_load_dwordx4 v[32:35], v8, s[4:7], s16 offen offset:2048 sc1
    s_mov_b64 exec, -1
    s_add_u32 s23, s23, 1
    s_cmp_lt_u32 s23, 200000
    s_cbranch_scc1 g_29L4_2
    s_mov_b32 s25, 200000
    s_branch gc_30
g_29F8_3:
    s_mov_b64 exec, vcc
    buffer_load_dwordx4 v[36:39], v8, s[4:7], s16 offen offset:3072 sc1
    s_mov_b64 exec, -1
    s_add_u32 s23, s23, 1
    s_cmp_lt_u32 s23, 200000
    s_cbranch_scc1 g_29L8_3
    s_mov_b32 s25, 200000
    s_branch gc_30
.p2align 6
recur_fast_w1:
    s_nop 15
    s_mov_b32 s23, s25
    buffer_load_dwordx4 v[24:27], v2, s[4:7], s16 offen offset:0 sc1
    s_nop 11
    buffer_load_dwordx4 v[28:31], v2, s[4:7], s16 offen offset:1024 sc1
    s_nop 11
    buffer_load_dwordx4 v[32:35], v2, s[4:7], s16 offen offset:2048 sc1
    s_nop 11
    buffer_load_dwordx4 v[36:39], v2, s[4:7], s16 offen offset:3072 sc1
    s_waitcnt vmcnt(3)
    v_max3_u32 v19, v24, v25, v26
    v_max_u32 v19, v19, v27
    v_cmp_eq_u32 vcc, -1, v19
    s_nop 0
    s_cbranch_vccnz g_33F15_0
    v_smfmac_f32_16x16x64_bf16 v[40:43], v[24:27], a[0:7], v172
    v_smfmac_f32_16x16x64_bf16 v[44:47], v[24:27], a[64:71], v172
    s_waitcnt vmcnt(2)
    v_max3_u32 v19, v28, v29, v30
    v_max_u32 v19, v19, v31
    v_smfmac_f32_16x16x64_bf16 v[48:51], v[24:27], a[32:39], v172
    v_cmp_eq_u32 vcc, -1, v19
    v_smfmac_f32_16x16x64_bf16 v[52:55], v[24:27], a[96:103], v172
    s_cbranch_vccnz g_33F14_1
    v_smfmac_f32_16x16x64_bf16 v[40:43], v[28:31], a[8:15], v172
    v_smfmac_f32_16x16x64_bf16 v[44:47], v[28:31], a[72:79], v172
    s_waitcnt vmcnt(1)
    v_max3_u32 v19, v32, v33, v34
    v_max_u32 v19, v19, v35
    v_smfmac_f32_16x16x64_bf16 v[48:51], v[28:31], a[40:47], v172
    v_cmp_eq_u32 vcc, -1, v19
    v_smfmac_f32_16x16x64_bf16 v[52:55], v[28:31], a[104:111], v172
    s_cbranch_vccnz g_33F12_2
    v_smfmac_f32_16x16x64_bf16 v[40:43], v[32:35], a[16:23], v172
    v_smfmac_f32_16x16x64_bf16 v[44:47], v[32:35], a[80:87], v172
    s_waitcnt vmcnt(0)
    v_max3_u32 v19, v36, v37, v38
    v_max_u32 v19, v19, v39
    v_smfmac_f32_16x16x64_bf16 v[48:51], v[32:35], a[48:55], v172
    v_cmp_eq_u32 vcc, -1, v19
    v_smfmac_f32_16x16x64_bf16 v[52:55], v[32:35], a[112:119], v172
    s_cbranch_vccnz g_33F8_3
    v_smfmac_f32_16x16x64_bf16 v[40:43], v[36:39], a[24:31], v172
    v_smfmac_f32_16x16x64_bf16 v[44:47], v[36:39], a[88:95], v172
    v_smfmac_f32_16x16x64_bf16 v[48:51], v[36:39], a[56:63], v172
    v_smfmac_f32_16x16x64_bf16 v[52:55], v[36:39], a[120:127], v172
gc_34:
    v_cvt_pk_bf16_f32 v72, v40, v41
    v_cvt_pk_bf16_f32 v73, v42, v43
    v_cvt_pk_bf16_f32 v74, v44, v45
    v_cvt_pk_bf16_f32 v75, v46, v47
    ds_write_b128 v17, v[72:75] offset:0
    v_cvt_pk_bf16_f32 v76, v48, v49
    v_cvt_pk_bf16_f32 v77, v50, v51
    s_nop 0
    v_cvt_pk_bf16_f32 v78, v52, v53
    v_cvt_pk_bf16_f32 v79, v54, v55
    ds_write_b128 v17, v[76:79] offset:1024
    v_smfmac_f32_16x16x64_bf16 v[56:59], v[24:27], a[128:135], v172
    v_smfmac_f32_16x16x64_bf16 v[60:63], v[24:27], a[160:167], v172
    v_smfmac_f32_16x16x64_bf16 v[56:59], v[28:31], a[136:143], v172
    s_waitcnt lgkmcnt(0)
    s_barrier
    v_smfmac_f32_16x16x64_bf16 v[60:63], v[28:31], a[168:175], v172
    v_smfmac_f32_16x16x64_bf16 v[56:59], v[32:35], a[144:151], v172
    v_smfmac_f32_16x16x64_bf16 v[60:63], v[32:35], a[176:183], v172
    v_smfmac_f32_16x16x64_bf16 v[56:59], v[36:39], a[152:159], v172
    v_smfmac_f32_16x16x64_bf16 v[60:63], v[36:39], a[184:191], v172
    s_nop 4
    v_cvt_pk_bf16_f32 v80, v56, v57
    v_cvt_pk_bf16_f32 v81, v58, v59
    s_nop 0
    v_cvt_pk_bf16_f32 v82, v60, v61
    v_cvt_pk_bf16_f32 v83, v62, v63
    ds_write_b128 v17, v[80:83] offset:8192
    s_cmp_eq_u32 s15, 63
    s_waitcnt lgkmcnt(0)
    s_barrier
    s_cbranch_scc1 recur_end
    s_nop 15
    s_nop 15
    buffer_load_dwordx4 v[208:211], v5, s[4:7], s16 offen offset:0 sc1
    buffer_load_dwordx4 v[212:215], v5, s[4:7], s16 offen offset:1024 sc1
    buffer_load_dwordx4 v[216:219], v5, s[4:7], s16 offen offset:2048 sc1
    buffer_load_dwordx4 v[220:223], v5, s[4:7], s16 offen offset:3072 sc1
    buffer_load_dword v224, v6, s[4:7], s16 offen offset:0 sc1
    buffer_load_dword v225, v6, s[4:7], s16 offen offset:256 sc1
    buffer_load_dword v226, v6, s[4:7], s16 offen offset:512 sc1
    buffer_load_dword v227, v6, s[4:7], s16 offen offset:768 sc1
    buffer_load_dwordx4 v[228:231], v13, s[4:7], s18 offen offset:0 sc1
    buffer_load_dwordx4 v[232:235], v13, s[4:7], s18 offen offset:256 sc1
    s_add_u32 s18, s18, 2048
    s_min_u32 s18, s18, 35780608
    s_mov_b32 s23, s25
    ds_read_b128 v[96:99], v16 offset:8192
    ds_read_b128 v[104:107], v16 offset:12288
    ds_read_b128 v[108:111], v16 offset:14336
    v_mfma_f32_16x16x32_bf16 v[140:143], v[84:87], v[80:83], 0
    s_waitcnt lgkmcnt(2)
    v_mfma_f32_16x16x32_bf16 v[140:143], v[84:87], v[96:99], v[140:143]
    s_waitcnt lgkmcnt(1)
    v_mfma_f32_16x16x32_bf16 v[140:143], v[84:87], v[104:107], v[140:143]
    s_waitcnt lgkmcnt(0)
    v_mfma_f32_16x16x32_bf16 v[140:143], v[84:87], v[108:111], v[140:143]
    s_nop 7
    v_cvt_pk_bf16_f32 v154, v140, v179
    v_cvt_pk_bf16_f32 v158, v141, v179
    v_cvt_pk_bf16_f32 v162, v142, v179
    v_cvt_pk_bf16_f32 v166, v143, v179
    s_waitcnt vmcnt(8)
ss_35:
    v_pk_add_f32 v[180:181], v[208:209], v[212:213]
    v_pk_add_f32 v[182:183], v[210:211], v[214:215]
    s_waitcnt vmcnt(6)
    v_pk_add_f32 v[96:97], v[216:217], v[220:221]
    v_pk_add_f32 v[98:99], v[218:219], v[222:223]
    v_pk_add_f32 v[180:181], v[180:181], v[96:97]
    v_pk_add_f32 v[182:183], v[182:183], v[98:99]
    s_waitcnt vmcnt(2)
    v_pk_add_f32 v[100:101], v[224:225], v[226:227]
    v_cmp_u_f32 s[86:87], v180, v181
    v_add_f32 v184, v100, v101
    v_cmp_u_f32 s[88:89], v182, v183
    v_max3_f32 v185, v180, v181, v182
    v_cmp_u_f32 vcc, v184, v184
    v_max3_f32 v185, v185, v183, v184
    s_or_b64 s[86:87], s[86:87], s[88:89]
    s_or_b64 vcc, vcc, s[86:87]
    v_max_f32_dpp v185, v185, v185 row_ror:8 row_mask:0xf bank_mask:0xf
    s_cbranch_scc1 sb_36
sg_37:
    v_mov_b32 v186, v185
    s_nop 1
    v_permlane16_swap_b32 v185, v186
    v_max_f32 v185, v185, v186
    v_mov_b32 v186, v185
    s_nop 1
    v_permlane32_swap_b32 v185, v186
    v_max_f32 v185, v185, v186
    v_mul_f32 v185, s24, v185
    v_fma_f32 v180, v180, s24, -v185
    v_fma_f32 v181, v181, s24, -v185
    v_fma_f32 v182, v182, s24, -v185
    v_fma_f32 v183, v183, s24, -v185
    v_fma_f32 v184, v184, s24, -v185
    v_exp_f32 v180, v180
    v_exp_f32 v181, v181
    v_exp_f32 v182, v182
    v_exp_f32 v183, v183
    v_exp_f32 v184, v184
    v_cvt_pk_bf16_f32 v176, v180, v181
    v_cvt_pk_bf16_f32 v177, v182, v183
    v_cvt_pk_bf16_f32 v178, v184, v179
    s_nop 1
    v_mfma_f32_16x16x32_bf16 v[240:243], v[236:239], v[176:179], 0
    v_mfma_f32_16x16x32_bf16 v[188:191], v[152:155], v[176:179], 0
    v_mfma_f32_16x16x32_bf16 v[192:195], v[156:159], v[176:179], 0
    v_mfma_f32_16x16x32_bf16 v[196:199], v[160:163], v[176:179], 0
    v_mfma_f32_16x16x32_bf16 v[200:203], v[164:167], v[176:179], 0
    v_add_f32_dpp v185, v240, v240 row_ror:8 row_mask:0xf bank_mask:0xf
    v_rcp_f32 v185, v185
    v_add_f32_dpp v88, v192, v188 row_ror:8 row_mask:0xf bank_mask:0x3
    v_add_f32_dpp v89, v193, v189 row_ror:8 row_mask:0xf bank_mask:0x3
    v_add_f32_dpp v90, v194, v190 row_ror:8 row_mask:0xf bank_mask:0x3
    v_add_f32_dpp v91, v195, v191 row_ror:8 row_mask:0xf bank_mask:0x3
    s_nop 1
    v_add_f32_dpp v88, v196, v200 row_ror:8 row_mask:0xf bank_mask:0xc
    v_add_f32_dpp v89, v197, v201 row_ror:8 row_mask:0xf bank_mask:0xc
    v_add_f32_dpp v90, v198, v202 row_ror:8 row_mask:0xf bank_mask:0xc
    v_add_f32_dpp v91, v199, v203 row_ror:8 row_mask:0xf bank_mask:0xc
    v_mul_f32 v88, v88, v185
    v_mul_f32 v89, v89, v185
    v_mul_f32 v90, v90, v185
    v_mul_f32 v91, v91, v185
    v_cvt_pk_bf16_f32 v88, v88, v89
    v_cvt_pk_bf16_f32 v89, v90, v91
    buffer_store_dwordx2 v[88:89], v7, s[4:7], s16 offen
    s_barrier
    s_nop 15
    s_mov_b32 s23, s25
    buffer_load_dwordx4 v[24:27], v8, s[4:7], s16 offen offset:0 sc1
    s_nop 11
    buffer_load_dwordx4 v[28:31], v8, s[4:7], s16 offen offset:1024 sc1
    s_nop 11
    buffer_load_dwordx4 v[32:35], v8, s[4:7], s16 offen offset:2048 sc1
    s_nop 11
    buffer_load_dwordx4 v[36:39], v8, s[4:7], s16 offen offset:3072 sc1
    s_waitcnt vmcnt(3)
    v_max3_u32 v19, v24, v25, v26
    v_max_u32 v19, v19, v27
    v_cmp_eq_u32 vcc, -1, v19
    s_nop 0
    s_cbranch_vccnz g_38F15_0
    v_smfmac_f32_16x16x64_bf16 v[64:67], v[24:27], a[192:199], v172
    v_smfmac_f32_16x16x64_bf16 v[68:71], v[24:27], a[224:231], v172
    s_waitcnt vmcnt(2)
    v_max3_u32 v19, v28, v29, v30
    v_max_u32 v19, v19, v31
    v_cmp_eq_u32 vcc, -1, v19
    s_nop 0
    s_cbranch_vccnz g_38F14_1
    v_smfmac_f32_16x16x64_bf16 v[64:67], v[28:31], a[200:207], v172
    v_smfmac_f32_16x16x64_bf16 v[68:71], v[28:31], a[232:239], v172
    s_waitcnt vmcnt(1)
    v_max3_u32 v19, v32, v33, v34
    v_max_u32 v19, v19, v35
    v_cmp_eq_u32 vcc, -1, v19
    s_nop 0
    s_cbranch_vccnz g_38F12_2
    v_smfmac_f32_16x16x64_bf16 v[64:67], v[32:35], a[208:215], v172
    v_smfmac_f32_16x16x64_bf16 v[68:71], v[32:35], a[240:247], v172
    s_waitcnt vmcnt(0)
    v_max3_u32 v19, v36, v37, v38
    v_max_u32 v19, v19, v39
    v_cmp_eq_u32 vcc, -1, v19
    s_nop 0
    s_cbranch_vccnz g_38F8_3
    v_smfmac_f32_16x16x64_bf16 v[64:67], v[36:39], a[216:223], v172
    v_smfmac_f32_16x16x64_bf16 v[68:71], v[36:39], a[248:255], v172
    s_nop 4
    v_cvt_pk_bf16_f32 v80, v64, v65
    v_cvt_pk_bf16_f32 v81, v66, v67
    s_nop 0
    v_cvt_pk_bf16_f32 v82, v68, v69
    v_cvt_pk_bf16_f32 v83, v70, v71
    ds_write_b128 v17, v[80:83] offset:9216
gc_39:
    s_waitcnt lgkmcnt(0)
    s_barrier
    s_nop 15
    s_nop 15
    s_nop 15
    v_mov_b32 v152, v228
    v_mov_b32 v153, v229
    v_mov_b32 v156, v230
    v_mov_b32 v157, v231
    v_mov_b32 v160, v232
    v_mov_b32 v161, v233
    v_mov_b32 v164, v234
    v_mov_b32 v165, v235
    v_mov_b32 v40, 0
    v_mov_b32 v41, 0
    v_mov_b32 v42, 0
    v_mov_b32 v43, 0
    v_mov_b32 v44, 0
    v_mov_b32 v45, 0
    v_mov_b32 v46, 0
    v_mov_b32 v47, 0
    v_mov_b32 v48, 0
    v_mov_b32 v49, 0
    v_mov_b32 v50, 0
    v_mov_b32 v51, 0
    v_mov_b32 v52, 0
    v_mov_b32 v53, 0
    v_mov_b32 v54, 0
    v_mov_b32 v55, 0
    v_mov_b32 v56, 0
    v_mov_b32 v57, 0
    v_mov_b32 v58, 0
    v_mov_b32 v59, 0
    v_mov_b32 v60, 0
    v_mov_b32 v61, 0
    v_mov_b32 v62, 0
    v_mov_b32 v63, 0
    v_mov_b32 v64, 0
    v_mov_b32 v65, 0
    v_mov_b32 v66, 0
    v_mov_b32 v67, 0
    v_mov_b32 v68, 0
    v_mov_b32 v69, 0
    v_mov_b32 v70, 0
    v_mov_b32 v71, 0
    s_add_u32 s94, s15, 3
    s_min_u32 s94, s94, 64
    s_mov_b32 s23, s25
fw_40:
    s_cmp_ge_u32 s85, s94
    s_cbranch_scc1 fo_41
    buffer_load_dword v19, v245, s[4:7], 0 offen sc1
    s_add_u32 s23, s23, 1
    s_waitcnt vmcnt(0)
    v_readfirstlane_b32 s85, v19
    s_cmp_lt_u32 s23, 200000
    s_cbranch_scc1 fw_40
    s_mov_b32 s25, 200000
fo_41:
    s_mov_b32 s21, s16
    s_mov_b32 s16, s42
    s_mov_b32 s42, s43
    s_mov_b32 s43, s44
    s_mov_b32 s44, s21
    s_add_u32 s95, s95, 524288
    s_lshr_b32 s84, s95, 8
    s_and_b32 s84, s84, 8192
    s_xor_b32 s84, s84, s46
    s_add_u32 s84, s84, s95
    s_add_u32 s15, s15, 1
    s_barrier
    s_branch recur_fast_w1
g_33L15_0:
    s_waitcnt vmcnt(3)
    v_max3_u32 v19, v24, v25, v26
    v_max_u32 v19, v19, v27
    v_cmp_eq_u32 vcc, -1, v19
    s_nop 0
    s_cbranch_vccnz g_33F15_0
    v_smfmac_f32_16x16x64_bf16 v[40:43], v[24:27], a[0:7], v172
    v_smfmac_f32_16x16x64_bf16 v[44:47], v[24:27], a[64:71], v172
    v_smfmac_f32_16x16x64_bf16 v[48:51], v[24:27], a[32:39], v172
    v_smfmac_f32_16x16x64_bf16 v[52:55], v[24:27], a[96:103], v172
g_33L14_1:
    s_waitcnt vmcnt(2)
    v_max3_u32 v19, v28, v29, v30
    v_max_u32 v19, v19, v31
    v_cmp_eq_u32 vcc, -1, v19
    s_nop 0
    s_cbranch_vccnz g_33F14_1
    v_smfmac_f32_16x16x64_bf16 v[40:43], v[28:31], a[8:15], v172
    v_smfmac_f32_16x16x64_bf16 v[44:47], v[28:31], a[72:79], v172
    v_smfmac_f32_16x16x64_bf16 v[48:51], v[28:31], a[40:47], v172
    v_smfmac_f32_16x16x64_bf16 v[52:55], v[28:31], a[104:111], v172
g_33L12_2:
    s_waitcnt vmcnt(1)
    v_max3_u32 v19, v32, v33, v34
    v_max_u32 v19, v19, v35
    v_cmp_eq_u32 vcc, -1, v19
    s_nop 0
    s_cbranch_vccnz g_33F12_2
    v_smfmac_f32_16x16x64_bf16 v[40:43], v[32:35], a[16:23], v172
    v_smfmac_f32_16x16x64_bf16 v[44:47], v[32:35], a[80:87], v172
    v_smfmac_f32_16x16x64_bf16 v[48:51], v[32:35], a[48:55], v172
    v_smfmac_f32_16x16x64_bf16 v[52:55], v[32:35], a[112:119], v172
g_33L8_3:
    s_waitcnt vmcnt(0)
    v_max3_u32 v19, v36, v37, v38
    v_max_u32 v19, v19, v39
    v_cmp_eq_u32 vcc, -1, v19
    s_nop 0
    s_cbranch_vccnz g_33F8_3
    v_smfmac_f32_16x16x64_bf16 v[40:43], v[36:39], a[24:31], v172
    v_smfmac_f32_16x16x64_bf16 v[44:47], v[36:39], a[88:95], v172
    v_smfmac_f32_16x16x64_bf16 v[48:51], v[36:39], a[56:63], v172
    v_smfmac_f32_16x16x64_bf16 v[52:55], v[36:39], a[120:127], v172
    s_branch gc_34
g_33L15_1:
    s_waitcnt vmcnt(3)
    v_max3_u32 v19, v28, v29, v30
    v_max_u32 v19, v19, v31
    v_cmp_eq_u32 vcc, -1, v19
    s_nop 0
    s_cbranch_vccnz g_33F15_1
    v_smfmac_f32_16x16x64_bf16 v[40:43], v[28:31], a[8:15], v172
    v_smfmac_f32_16x16x64_bf16 v[44:47], v[28:31], a[72:79], v172
    v_smfmac_f32_16x16x64_bf16 v[48:51], v[28:31], a[40:47], v172
    v_smfmac_f32_16x16x64_bf16 v[52:55], v[28:31], a[104:111], v172
g_33L13_2:
    s_waitcnt vmcnt(2)
    v_max3_u32 v19, v32, v33, v34
    v_max_u32 v19, v19, v35
    v_cmp_eq_u32 vcc, -1, v19
    s_nop 0
    s_cbranch_vccnz g_33F13_2
    v_smfmac_f32_16x16x64_bf16 v[40:43], v[32:35], a[16:23], v172
    v_smfmac_f32_16x16x64_bf16 v[44:47], v[32:35], a[80:87], v172
    v_smfmac_f32_16x16x64_bf16 v[48:51], v[32:35], a[48:55], v172
    v_smfmac_f32_16x16x64_bf16 v[52:55], v[32:35], a[112:119], v172
g_33L9_3:
    s_waitcnt vmcnt(1)
    v_max3_u32 v19, v36, v37, v38
    v_max_u32 v19, v19, v39
    v_cmp_eq_u32 vcc, -1, v19
    s_nop 0
    s_cbranch_vccnz g_33F9_3
    v_smfmac_f32_16x16x64_bf16 v[40:43], v[36:39], a[24:31], v172
    v_smfmac_f32_16x16x64_bf16 v[44:47], v[36:39], a[88:95], v172
    v_smfmac_f32_16x16x64_bf16 v[48:51], v[36:39], a[56:63], v172
    v_smfmac_f32_16x16x64_bf16 v[52:55], v[36:39], a[120:127], v172
g_33L1_0:
    s_waitcnt vmcnt(0)
    v_max3_u32 v19, v24, v25, v26
    v_max_u32 v19, v19, v27
    v_cmp_eq_u32 vcc, -1, v19
    s_nop 0
    s_cbranch_vccnz g_33F1_0
    v_smfmac_f32_16x16x64_bf16 v[40:43], v[24:27], a[0:7], v172
    v_smfmac_f32_16x16x64_bf16 v[44:47], v[24:27], a[64:71], v172
    v_smfmac_f32_16x16x64_bf16 v[48:51], v[24:27], a[32:39], v172
    v_smfmac_f32_16x16x64_bf16 v[52:55], v[24:27], a[96:103], v172
    s_branch gc_34
g_33L15_2:
    s_waitcnt vmcnt(3)
    v_max3_u32 v19, v32, v33, v34
    v_max_u32 v19, v19, v35
    v_cmp_eq_u32 vcc, -1, v19
    s_nop 0
    s_cbranch_vccnz g_33F15_2
    v_smfmac_f32_16x16x64_bf16 v[40:43], v[32:35], a[16:23], v172
    v_smfmac_f32_16x16x64_bf16 v[44:47], v[32:35], a[80:87], v172
    v_smfmac_f32_16x16x64_bf16 v[48:51], v[32:35], a[48:55], v172
    v_smfmac_f32_16x16x64_bf16 v[52:55], v[32:35], a[112:119], v172
g_33L11_3:
    s_waitcnt vmcnt(2)
    v_max3_u32 v19, v36, v37, v38
    v_max_u32 v19, v19, v39
    v_cmp_eq_u32 vcc, -1, v19
    s_nop 0
    s_cbranch_vccnz g_33F11_3
    v_smfmac_f32_16x16x64_bf16 v[40:43], v[36:39], a[24:31], v172
    v_smfmac_f32_16x16x64_bf16 v[44:47], v[36:39], a[88:95], v172
    v_smfmac_f32_16x16x64_bf16 v[48:51], v[36:39], a[56:63], v172
    v_smfmac_f32_16x16x64_bf16 v[52:55], v[36:39], a[120:127], v172
g_33L3_0:
    s_waitcnt vmcnt(1)
    v_max3_u32 v19, v24, v25, v26
    v_max_u32 v19, v19, v27
    v_cmp_eq_u32 vcc, -1, v19
    s_nop 0
    s_cbranch_vccnz g_33F3_0
    v_smfmac_f32_16x16x64_bf16 v[40:43], v[24:27], a[0:7], v172
    v_smfmac_f32_16x16x64_bf16 v[44:47], v[24:27], a[64:71], v172
    v_smfmac_f32_16x16x64_bf16 v[48:51], v[24:27], a[32:39], v172
    v_smfmac_f32_16x16x64_bf16 v[52:55], v[24:27], a[96:103], v172
g_33L2_1:
    s_waitcnt vmcnt(0)
    v_max3_u32 v19, v28, v29, v30
    v_max_u32 v19, v19, v31
    v_cmp_eq_u32 vcc, -1, v19
    s_nop 0
    s_cbranch_vccnz g_33F2_1
    v_smfmac_f32_16x16x64_bf16 v[40:43], v[28:31], a[8:15], v172
    v_smfmac_f32_16x16x64_bf16 v[44:47], v[28:31], a[72:79], v172
    v_smfmac_f32_16x16x64_bf16 v[48:51], v[28:31], a[40:47], v172
    v_smfmac_f32_16x16x64_bf16 v[52:55], v[28:31], a[104:111], v172
    s_branch gc_34
g_33L15_3:
    s_waitcnt vmcnt(3)
    v_max3_u32 v19, v36, v37, v38
    v_max_u32 v19, v19, v39
    v_cmp_eq_u32 vcc, -1, v19
    s_nop 0
    s_cbranch_vccnz g_33F15_3
    v_smfmac_f32_16x16x64_bf16 v[40:43], v[36:39], a[24:31], v172
    v_smfmac_f32_16x16x64_bf16 v[44:47], v[36:39], a[88:95], v172
    v_smfmac_f32_16x16x64_bf16 v[48:51], v[36:39], a[56:63], v172
    v_smfmac_f32_16x16x64_bf16 v[52:55], v[36:39], a[120:127], v172
g_33L7_0:
    s_waitcnt vmcnt(2)
    v_max3_u32 v19, v24, v25, v26
    v_max_u32 v19, v19, v27
    v_cmp_eq_u32 vcc, -1, v19
    s_nop 0
    s_cbranch_vccnz g_33F7_0
    v_smfmac_f32_16x16x64_bf16 v[40:43], v[24:27], a[0:7], v172
    v_smfmac_f32_16x16x64_bf16 v[44:47], v[24:27], a[64:71], v172
    v_smfmac_f32_16x16x64_bf16 v[48:51], v[24:27], a[32:39], v172
    v_smfmac_f32_16x16x64_bf16 v[52:55], v[24:27], a[96:103], v172
g_33L6_1:
    s_waitcnt vmcnt(1)
    v_max3_u32 v19, v28, v29, v30
    v_max_u32 v19, v19, v31
    v_cmp_eq_u32 vcc, -1, v19
    s_nop 0
    s_cbranch_vccnz g_33F6_1
    v_smfmac_f32_16x16x64_bf16 v[40:43], v[28:31], a[8:15], v172
    v_smfmac_f32_16x16x64_bf16 v[44:47], v[28:31], a[72:79], v172
    v_smfmac_f32_16x16x64_bf16 v[48:51], v[28:31], a[40:47], v172
    v_smfmac_f32_16x16x64_bf16 v[52:55], v[28:31], a[104:111], v172
g_33L4_2:
    s_waitcnt vmcnt(0)
    v_max3_u32 v19, v32, v33, v34
    v_max_u32 v19, v19, v35
    v_cmp_eq_u32 vcc, -1, v19
    s_nop 0
    s_cbranch_vccnz g_33F4_2
    v_smfmac_f32_16x16x64_bf16 v[40:43], v[32:35], a[16:23], v172
    v_smfmac_f32_16x16x64_bf16 v[44:47], v[32:35], a[80:87], v172
    v_smfmac_f32_16x16x64_bf16 v[48:51], v[32:35], a[48:55], v172
    v_smfmac_f32_16x16x64_bf16 v[52:55], v[32:35], a[112:119], v172
    s_branch gc_34
g_33L7_1:
    s_waitcnt vmcnt(2)
    v_max3_u32 v19, v28, v29, v30
    v_max_u32 v19, v19, v31
    v_cmp_eq_u32 vcc, -1, v19
    s_nop 0
    s_cbranch_vccnz g_33F7_1
    v_smfmac_f32_16x16x64_bf16 v[40:43], v[28:31], a[8:15], v172
    v_smfmac_f32_16x16x64_bf16 v[44:47], v[28:31], a[72:79], v172
    v_smfmac_f32_16x16x64_bf16 v[48:51], v[28:31], a[40:47], v172
    v_smfmac_f32_16x16x64_bf16 v[52:55], v[28:31], a[104:111], v172
g_33L5_2:
    s_waitcnt vmcnt(1)
    v_max3_u32 v19, v32, v33, v34
    v_max_u32 v19, v19, v35
    v_cmp_eq_u32 vcc, -1, v19
    s_nop 0
    s_cbranch_vccnz g_33F5_2
    v_smfmac_f32_16x16x64_bf16 v[40:43], v[32:35], a[16:23], v172
    v_smfmac_f32_16x16x64_bf16 v[44:47], v[32:35], a[80:87], v172
    v_smfmac_f32_16x16x64_bf16 v[48:51], v[32:35], a[48:55], v172
    v_smfmac_f32_16x16x64_bf16 v[52:55], v[32:35], a[112:119], v172
    s_branch g_33L1_0
g_33L7_2:
    s_waitcnt vmcnt(2)
    v_max3_u32 v19, v32, v33, v34
    v_max_u32 v19, v19, v35
    v_cmp_eq_u32 vcc, -1, v19
    s_nop 0
    s_cbranch_vccnz g_33F7_2
    v_smfmac_f32_16x16x64_bf16 v[40:43], v[32:35], a[16:23], v172
    v_smfmac_f32_16x16x64_bf16 v[44:47], v[32:35], a[80:87], v172
    v_smfmac_f32_16x16x64_bf16 v[48:51], v[32:35], a[48:55], v172
    v_smfmac_f32_16x16x64_bf16 v[52:55], v[32:35], a[112:119], v172
    s_branch g_33L3_0
g_33L11_0:
    s_waitcnt vmcnt(2)
    v_max3_u32 v19, v24, v25, v26
    v_max_u32 v19, v19, v27
    v_cmp_eq_u32 vcc, -1, v19
    s_nop 0
    s_cbranch_vccnz g_33F11_0
    v_smfmac_f32_16x16x64_bf16 v[40:43], v[24:27], a[0:7], v172
    v_smfmac_f32_16x16x64_bf16 v[44:47], v[24:27], a[64:71], v172
    v_smfmac_f32_16x16x64_bf16 v[48:51], v[24:27], a[32:39], v172
    v_smfmac_f32_16x16x64_bf16 v[52:55], v[24:27], a[96:103], v172
g_33L10_1:
    s_waitcnt vmcnt(1)
    v_max3_u32 v19, v28, v29, v30
    v_max_u32 v19, v19, v31
    v_cmp_eq_u32 vcc, -1, v19
    s_nop 0
    s_cbranch_vccnz g_33F10_1
    v_smfmac_f32_16x16x64_bf16 v[40:43], v[28:31], a[8:15], v172
    v_smfmac_f32_16x16x64_bf16 v[44:47], v[28:31], a[72:79], v172
    v_smfmac_f32_16x16x64_bf16 v[48:51], v[28:31], a[40:47], v172
    v_smfmac_f32_16x16x64_bf16 v[52:55], v[28:31], a[104:111], v172
    s_branch g_33L8_3
g_33L11_1:
    s_waitcnt vmcnt(2)
    v_max3_u32 v19, v28, v29, v30
    v_max_u32 v19, v19, v31
    v_cmp_eq_u32 vcc, -1, v19
    s_nop 0
    s_cbranch_vccnz g_33F11_1
    v_smfmac_f32_16x16x64_bf16 v[40:43], v[28:31], a[8:15], v172
    v_smfmac_f32_16x16x64_bf16 v[44:47], v[28:31], a[72:79], v172
    v_smfmac_f32_16x16x64_bf16 v[48:51], v[28:31], a[40:47], v172
    v_smfmac_f32_16x16x64_bf16 v[52:55], v[28:31], a[104:111], v172
    s_branch g_33L9_3
g_33L13_0:
    s_waitcnt vmcnt(2)
    v_max3_u32 v19, v24, v25, v26
    v_max_u32 v19, v19, v27
    v_cmp_eq_u32 vcc, -1, v19
    s_nop 0
    s_cbranch_vccnz g_33F13_0
    v_smfmac_f32_16x16x64_bf16 v[40:43], v[24:27], a[0:7], v172
    v_smfmac_f32_16x16x64_bf16 v[44:47], v[24:27], a[64:71], v172
    v_smfmac_f32_16x16x64_bf16 v[48:51], v[24:27], a[32:39], v172
    v_smfmac_f32_16x16x64_bf16 v[52:55], v[24:27], a[96:103], v172
    s_branch g_33L12_2
g_33L13_3:
    s_waitcnt vmcnt(2)
    v_max3_u32 v19, v36, v37, v38
    v_max_u32 v19, v19, v39
    v_cmp_eq_u32 vcc, -1, v19
    s_nop 0
    s_cbranch_vccnz g_33F13_3
    v_smfmac_f32_16x16x64_bf16 v[40:43], v[36:39], a[24:31], v172
    v_smfmac_f32_16x16x64_bf16 v[44:47], v[36:39], a[88:95], v172
    v_smfmac_f32_16x16x64_bf16 v[48:51], v[36:39], a[56:63], v172
    v_smfmac_f32_16x16x64_bf16 v[52:55], v[36:39], a[120:127], v172
g_33L5_0:
    s_waitcnt vmcnt(1)
    v_max3_u32 v19, v24, v25, v26
    v_max_u32 v19, v19, v27
    v_cmp_eq_u32 vcc, -1, v19
    s_nop 0
    s_cbranch_vccnz g_33F5_0
    v_smfmac_f32_16x16x64_bf16 v[40:43], v[24:27], a[0:7], v172
    v_smfmac_f32_16x16x64_bf16 v[44:47], v[24:27], a[64:71], v172
    v_smfmac_f32_16x16x64_bf16 v[48:51], v[24:27], a[32:39], v172
    v_smfmac_f32_16x16x64_bf16 v[52:55], v[24:27], a[96:103], v172
    s_branch g_33L4_2
g_33L14_2:
    s_waitcnt vmcnt(2)
    v_max3_u32 v19, v32, v33, v34
    v_max_u32 v19, v19, v35
    v_cmp_eq_u32 vcc, -1, v19
    s_nop 0
    s_cbranch_vccnz g_33F14_2
    v_smfmac_f32_16x16x64_bf16 v[40:43], v[32:35], a[16:23], v172
    v_smfmac_f32_16x16x64_bf16 v[44:47], v[32:35], a[80:87], v172
    v_smfmac_f32_16x16x64_bf16 v[48:51], v[32:35], a[48:55], v172
    v_smfmac_f32_16x16x64_bf16 v[52:55], v[32:35], a[112:119], v172
g_33L10_3:
    s_waitcnt vmcnt(1)
    v_max3_u32 v19, v36, v37, v38
    v_max_u32 v19, v19, v39
    v_cmp_eq_u32 vcc, -1, v19
    s_nop 0
    s_cbranch_vccnz g_33F10_3
    v_smfmac_f32_16x16x64_bf16 v[40:43], v[36:39], a[24:31], v172
    v_smfmac_f32_16x16x64_bf16 v[44:47], v[36:39], a[88:95], v172
    v_smfmac_f32_16x16x64_bf16 v[48:51], v[36:39], a[56:63], v172
    v_smfmac_f32_16x16x64_bf16 v[52:55], v[36:39], a[120:127], v172
    s_branch g_33L2_1
g_33L14_3:
    s_waitcnt vmcnt(2)
    v_max3_u32 v19, v36, v37, v38
    v_max_u32 v19, v19, v39
    v_cmp_eq_u32 vcc, -1, v19
    s_nop 0
    s_cbranch_vccnz g_33F14_3
    v_smfmac_f32_16x16x64_bf16 v[40:43], v[36:39], a[24:31], v172
    v_smfmac_f32_16x16x64_bf16 v[44:47], v[36:39], a[88:95], v172
    v_smfmac_f32_16x16x64_bf16 v[48:51], v[36:39], a[56:63], v172
    v_smfmac_f32_16x16x64_bf16 v[52:55], v[36:39], a[120:127], v172
    s_branch g_33L6_1
g_33L3_1:
    s_waitcnt vmcnt(1)
    v_max3_u32 v19, v28, v29, v30
    v_max_u32 v19, v19, v31
    v_cmp_eq_u32 vcc, -1, v19
    s_nop 0
    s_cbranch_vccnz g_33F3_1
    v_smfmac_f32_16x16x64_bf16 v[40:43], v[28:31], a[8:15], v172
    v_smfmac_f32_16x16x64_bf16 v[44:47], v[28:31], a[72:79], v172
    v_smfmac_f32_16x16x64_bf16 v[48:51], v[28:31], a[40:47], v172
    v_smfmac_f32_16x16x64_bf16 v[52:55], v[28:31], a[104:111], v172
    s_branch g_33L1_0
g_33L6_2:
    s_waitcnt vmcnt(1)
    v_max3_u32 v19, v32, v33, v34
    v_max_u32 v19, v19, v35
    v_cmp_eq_u32 vcc, -1, v19
    s_nop 0
    s_cbranch_vccnz g_33F6_2
    v_smfmac_f32_16x16x64_bf16 v[40:43], v[32:35], a[16:23], v172
    v_smfmac_f32_16x16x64_bf16 v[44:47], v[32:35], a[80:87], v172
    v_smfmac_f32_16x16x64_bf16 v[48:51], v[32:35], a[48:55], v172
    v_smfmac_f32_16x16x64_bf16 v[52:55], v[32:35], a[112:119], v172
    s_branch g_33L2_1
g_33L9_0:
    s_waitcnt vmcnt(1)
    v_max3_u32 v19, v24, v25, v26
    v_max_u32 v19, v19, v27
    v_cmp_eq_u32 vcc, -1, v19
    s_nop 0
    s_cbranch_vccnz g_33F9_0
    v_smfmac_f32_16x16x64_bf16 v[40:43], v[24:27], a[0:7], v172
    v_smfmac_f32_16x16x64_bf16 v[44:47], v[24:27], a[64:71], v172
    v_smfmac_f32_16x16x64_bf16 v[48:51], v[24:27], a[32:39], v172
    v_smfmac_f32_16x16x64_bf16 v[52:55], v[24:27], a[96:103], v172
    s_branch g_33L8_3
g_33L12_3:
    s_waitcnt vmcnt(1)
    v_max3_u32 v19, v36, v37, v38
    v_max_u32 v19, v19, v39
    v_cmp_eq_u32 vcc, -1, v19
    s_nop 0
    s_cbranch_vccnz g_33F12_3
    v_smfmac_f32_16x16x64_bf16 v[40:43], v[36:39], a[24:31], v172
    v_smfmac_f32_16x16x64_bf16 v[44:47], v[36:39], a[88:95], v172
    v_smfmac_f32_16x16x64_bf16 v[48:51], v[36:39], a[56:63], v172
    v_smfmac_f32_16x16x64_bf16 v[52:55], v[36:39], a[120:127], v172
    s_branch g_33L4_2
g_33F15_0:
    s_mov_b64 exec, vcc
    buffer_load_dwordx4 v[24:27], v2, s[4:7], s16 offen offset:0 sc1
    s_mov_b64 exec, -1
    s_add_u32 s23, s23, 1
    s_cmp_lt_u32 s23, 200000
    s_cbranch_scc1 g_33L15_1
    s_mov_b32 s25, 200000
    s_branch gc_34
g_33F15_1:
    s_mov_b64 exec, vcc
    buffer_load_dwordx4 v[28:31], v2, s[4:7], s16 offen offset:1024 sc1
    s_mov_b64 exec, -1
    s_add_u32 s23, s23, 1
    s_cmp_lt_u32 s23, 200000
    s_cbranch_scc1 g_33L15_2
    s_mov_b32 s25, 200000
    s_branch gc_34
g_33F15_2:
    s_mov_b64 exec, vcc
    buffer_load_dwordx4 v[32:35], v2, s[4:7], s16 offen offset:2048 sc1
    s_mov_b64 exec, -1
    s_add_u32 s23, s23, 1
    s_cmp_lt_u32 s23, 200000
    s_cbranch_scc1 g_33L15_3
    s_mov_b32 s25, 200000
    s_branch gc_34
g_33F15_3:
    s_mov_b64 exec, vcc
    buffer_load_dwordx4 v[36:39], v2, s[4:7], s16 offen offset:3072 sc1
    s_mov_b64 exec, -1
    s_add_u32 s23, s23, 1
    s_cmp_lt_u32 s23, 200000
    s_cbranch_scc1 g_33L15_0
    s_mov_b32 s25, 200000
    s_branch gc_34
g_33F7_0:
    s_mov_b64 exec, vcc
    buffer_load_dwordx4 v[24:27], v2, s[4:7], s16 offen offset:0 sc1
    s_mov_b64 exec, -1
    s_add_u32 s23, s23, 1
    s_cmp_lt_u32 s23, 200000
    s_cbranch_scc1 g_33L7_1
    s_mov_b32 s25, 200000
    s_branch gc_34
g_33F7_1:
    s_mov_b64 exec, vcc
    buffer_load_dwordx4 v[28:31], v2, s[4:7], s16 offen offset:1024 sc1
    s_mov_b64 exec, -1
    s_add_u32 s23, s23, 1
    s_cmp_lt_u32 s23, 200000
    s_cbranch_scc1 g_33L7_2
    s_mov_b32 s25, 200000
    s_branch gc_34
g_33F7_2:
    s_mov_b64 exec, vcc
    buffer_load_dwordx4 v[32:35], v2, s[4:7], s16 offen offset:2048 sc1
    s_mov_b64 exec, -1
    s_add_u32 s23, s23, 1
    s_cmp_lt_u32 s23, 200000
    s_cbranch_scc1 g_33L7_0
    s_mov_b32 s25, 200000
    s_branch gc_34
g_33F11_0:
    s_mov_b64 exec, vcc
    buffer_load_dwordx4 v[24:27], v2, s[4:7], s16 offen offset:0 sc1
    s_mov_b64 exec, -1
    s_add_u32 s23, s23, 1
    s_cmp_lt_u32 s23, 200000
    s_cbranch_scc1 g_33L11_1
    s_mov_b32 s25, 200000
    s_branch gc_34
g_33F11_1:
    s_mov_b64 exec, vcc
    buffer_load_dwordx4 v[28:31], v2, s[4:7], s16 offen offset:1024 sc1
    s_mov_b64 exec, -1
    s_add_u32 s23, s23, 1
    s_cmp_lt_u32 s23, 200000
    s_cbranch_scc1 g_33L11_3
    s_mov_b32 s25, 200000
    s_branch gc_34
g_33F11_3:
    s_mov_b64 exec, vcc
    buffer_load_dwordx4 v[36:39], v2, s[4:7], s16 offen offset:3072 sc1
    s_mov_b64 exec, -1
    s_add_u32 s23, s23, 1
    s_cmp_lt_u32 s23, 200000
    s_cbranch_scc1 g_33L11_0
    s_mov_b32 s25, 200000
    s_branch gc_34
g_33F13_0:
    s_mov_b64 exec, vcc
    buffer_load_dwordx4 v[24:27], v2, s[4:7], s16 offen offset:0 sc1
    s_mov_b64 exec, -1
    s_add_u32 s23, s23, 1
    s_cmp_lt_u32 s23, 200000
    s_cbranch_scc1 g_33L13_2
    s_mov_b32 s25, 200000
    s_branch gc_34
g_33F13_2:
    s_mov_b64 exec, vcc
    buffer_load_dwordx4 v[32:35], v2, s[4:7], s16 offen offset:2048 sc1
    s_mov_b64 exec, -1
    s_add_u32 s23, s23, 1
    s_cmp_lt_u32 s23, 200000
    s_cbranch_scc1 g_33L13_3
    s_mov_b32 s25, 200000
    s_branch gc_34
g_33F13_3:
    s_mov_b64 exec, vcc
    buffer_load_dwordx4 v[36:39], v2, s[4:7], s16 offen offset:3072 sc1
    s_mov_b64 exec, -1
    s_add_u32 s23, s23, 1
    s_cmp_lt_u32 s23, 200000
    s_cbranch_scc1 g_33L13_0
    s_mov_b32 s25, 200000
    s_branch gc_34
g_33F14_1:
    s_mov_b64 exec, vcc
    buffer_load_dwordx4 v[28:31], v2, s[4:7], s16 offen offset:1024 sc1
    s_mov_b64 exec, -1
    s_add_u32 s23, s23, 1
    s_cmp_lt_u32 s23, 200000
    s_cbranch_scc1 g_33L14_2
    s_mov_b32 s25, 200000
    s_branch gc_34
g_33F14_2:
    s_mov_b64 exec, vcc
    buffer_load_dwordx4 v[32:35], v2, s[4:7], s16 offen offset:2048 sc1
    s_mov_b64 exec, -1
    s_add_u32 s23, s23, 1
    s_cmp_lt_u32 s23, 200000
    s_cbranch_scc1 g_33L14_3
    s_mov_b32 s25, 200000
    s_branch gc_34
g_33F14_3:
    s_mov_b64 exec, vcc
    buffer_load_dwordx4 v[36:39], v2, s[4:7], s16 offen offset:3072 sc1
    s_mov_b64 exec, -1
    s_add_u32 s23, s23, 1
    s_cmp_lt_u32 s23, 200000
    s_cbranch_scc1 g_33L14_1
    s_mov_b32 s25, 200000
    s_branch gc_34
g_33F3_0:
    s_mov_b64 exec, vcc
    buffer_load_dwordx4 v[24:27], v2, s[4:7], s16 offen offset:0 sc1
    s_mov_b64 exec, -1
    s_add_u32 s23, s23, 1
    s_cmp_lt_u32 s23, 200000
    s_cbranch_scc1 g_33L3_1
    s_mov_b32 s25, 200000
    s_branch gc_34
g_33F3_1:
    s_mov_b64 exec, vcc
    buffer_load_dwordx4 v[28:31], v2, s[4:7], s16 offen offset:1024 sc1
    s_mov_b64 exec, -1
    s_add_u32 s23, s23, 1
    s_cmp_lt_u32 s23, 200000
    s_cbranch_scc1 g_33L3_0
    s_mov_b32 s25, 200000
    s_branch gc_34
g_33F5_0:
    s_mov_b64 exec, vcc
    buffer_load_dwordx4 v[24:27], v2, s[4:7], s16 offen offset:0 sc1
    s_mov_b64 exec, -1
    s_add_u32 s23, s23, 1
    s_cmp_lt_u32 s23, 200000
    s_cbranch_scc1 g_33L5_2
    s_mov_b32 s25, 200000
    s_branch gc_34
g_33F5_2:
    s_mov_b64 exec, vcc
    buffer_load_dwordx4 v[32:35], v2, s[4:7], s16 offen offset:2048 sc1
    s_mov_b64 exec, -1
    s_add_u32 s23, s23, 1
    s_cmp_lt_u32 s23, 200000
    s_cbranch_scc1 g_33L5_0
    s_mov_b32 s25, 200000
    s_branch gc_34
g_33F6_1:
    s_mov_b64 exec, vcc
    buffer_load_dwordx4 v[28:31], v2, s[4:7], s16 offen offset:1024 sc1
    s_mov_b64 exec, -1
    s_add_u32 s23, s23, 1
    s_cmp_lt_u32 s23, 200000
    s_cbranch_scc1 g_33L6_2
    s_mov_b32 s25, 200000
    s_branch gc_34
g_33F6_2:
    s_mov_b64 exec, vcc
    buffer_load_dwordx4 v[32:35], v2, s[4:7], s16 offen offset:2048 sc1
    s_mov_b64 exec, -1
    s_add_u32 s23, s23, 1
    s_cmp_lt_u32 s23, 200000
    s_cbranch_scc1 g_33L6_1
    s_mov_b32 s25, 200000
    s_branch gc_34
g_33F9_0:
    s_mov_b64 exec, vcc
    buffer_load_dwordx4 v[24:27], v2, s[4:7], s16 offen offset:0 sc1
    s_mov_b64 exec, -1
    s_add_u32 s23, s23, 1
    s_cmp_lt_u32 s23, 200000
    s_cbranch_scc1 g_33L9_3
    s_mov_b32 s25, 200000
    s_branch gc_34
g_33F9_3:
    s_mov_b64 exec, vcc
    buffer_load_dwordx4 v[36:39], v2, s[4:7], s16 offen offset:3072 sc1
    s_mov_b64 exec, -1
    s_add_u32 s23, s23, 1
    s_cmp_lt_u32 s23, 200000
    s_cbranch_scc1 g_33L9_0
    s_mov_b32 s25, 200000
    s_branch gc_34
g_33F10_1:
    s_mov_b64 exec, vcc
    buffer_load_dwordx4 v[28:31], v2, s[4:7], s16 offen offset:1024 sc1
    s_mov_b64 exec, -1
    s_add_u32 s23, s23, 1
    s_cmp_lt_u32 s23, 200000
    s_cbranch_scc1 g_33L10_3
    s_mov_b32 s25, 200000
    s_branch gc_34
g_33F10_3:
    s_mov_b64 exec, vcc
    buffer_load_dwordx4 v[36:39], v2, s[4:7], s16 offen offset:3072 sc1
    s_mov_b64 exec, -1
    s_add_u32 s23, s23, 1
    s_cmp_lt_u32 s23, 200000
    s_cbranch_scc1 g_33L10_1
    s_mov_b32 s25, 200000
    s_branch gc_34
g_33F12_2:
    s_mov_b64 exec, vcc
    buffer_load_dwordx4 v[32:35], v2, s[4:7], s16 offen offset:2048 sc1
    s_mov_b64 exec, -1
    s_add_u32 s23, s23, 1
    s_cmp_lt_u32 s23, 200000
    s_cbranch_scc1 g_33L12_3
    s_mov_b32 s25, 200000
    s_branch gc_34
g_33F12_3:
    s_mov_b64 exec, vcc
    buffer_load_dwordx4 v[36:39], v2, s[4:7], s16 offen offset:3072 sc1
    s_mov_b64 exec, -1
    s_add_u32 s23, s23, 1
    s_cmp_lt_u32 s23, 200000
    s_cbranch_scc1 g_33L12_2
    s_mov_b32 s25, 200000
    s_branch gc_34
g_33F1_0:
    s_mov_b64 exec, vcc
    buffer_load_dwordx4 v[24:27], v2, s[4:7], s16 offen offset:0 sc1
    s_mov_b64 exec, -1
    s_add_u32 s23, s23, 1
    s_cmp_lt_u32 s23, 200000
    s_cbranch_scc1 g_33L1_0
    s_mov_b32 s25, 200000
    s_branch gc_34
g_33F2_1:
    s_mov_b64 exec, vcc
    buffer_load_dwordx4 v[28:31], v2, s[4:7], s16 offen offset:1024 sc1
    s_mov_b64 exec, -1
    s_add_u32 s23, s23, 1
    s_cmp_lt_u32 s23, 200000
    s_cbranch_scc1 g_33L2_1
    s_mov_b32 s25, 200000
    s_branch gc_34
g_33F4_2:
    s_mov_b64 exec, vcc
    buffer_load_dwordx4 v[32:35], v2, s[4:7], s16 offen offset:2048 sc1
    s_mov_b64 exec, -1
    s_add_u32 s23, s23, 1
    s_cmp_lt_u32 s23, 200000
    s_cbranch_scc1 g_33L4_2
    s_mov_b32 s25, 200000
    s_branch gc_34
g_33F8_3:
    s_mov_b64 exec, vcc
    buffer_load_dwordx4 v[36:39], v2, s[4:7], s16 offen offset:3072 sc1
    s_mov_b64 exec, -1
    s_add_u32 s23, s23, 1
    s_cmp_lt_u32 s23, 200000
    s_cbranch_scc1 g_33L8_3
    s_mov_b32 s25, 200000
    s_branch gc_34
sb_36:
    v_max3_u32 v19, v208, v209, v210
    v_max3_u32 v19, v19, v211, v212
    v_max3_u32 v19, v19, v213, v214
    v_max3_u32 v19, v19, v215, v216
    v_max3_u32 v19, v19, v217, v218
    v_max3_u32 v19, v19, v219, v220
    v_max3_u32 v19, v19, v221, v222
    v_max3_u32 v19, v19, v223, v224
    v_max3_u32 v19, v19, v225, v226
    v_max_u32 v19, v19, v227
    v_cmp_eq_u32 vcc, -1, v19
    s_nop 0
    s_cbranch_vccz sg_37
    buffer_load_dwordx4 v[208:211], v5, s[4:7], s16 offen offset:0 sc1
    buffer_load_dwordx4 v[212:215], v5, s[4:7], s16 offen offset:1024 sc1
    buffer_load_dwordx4 v[216:219], v5, s[4:7], s16 offen offset:2048 sc1
    buffer_load_dwordx4 v[220:223], v5, s[4:7], s16 offen offset:3072 sc1
    buffer_load_dword v224, v6, s[4:7], s16 offen offset:0 sc1
    buffer_load_dword v225, v6, s[4:7], s16 offen offset:256 sc1
    buffer_load_dword v226, v6, s[4:7], s16 offen offset:512 sc1
    buffer_load_dword v227, v6, s[4:7], s16 offen offset:768 sc1
    s_waitcnt vmcnt(0)
    s_add_u32 s23, s23, 1
    s_cmp_lt_u32 s23, 200000
    s_cbranch_scc1 ss_35
    s_mov_b32 s25, 200000
    s_branch sg_37
g_38L15_0:
    s_waitcnt vmcnt(3)
    v_max3_u32 v19, v24, v25, v26
    v_max_u32 v19, v19, v27
    v_cmp_eq_u32 vcc, -1, v19
    s_nop 0
    s_cbranch_vccnz g_38F15_0
    v_smfmac_f32_16x16x64_bf16 v[64:67], v[24:27], a[192:199], v172
    v_smfmac_f32_16x16x64_bf16 v[68:71], v[24:27], a[224:231], v172
g_38L14_1:
    s_waitcnt vmcnt(2)
    v_max3_u32 v19, v28, v29, v30
    v_max_u32 v19, v19, v31
    v_cmp_eq_u32 vcc, -1, v19
    s_nop 0
    s_cbranch_vccnz g_38F14_1
    v_smfmac_f32_16x16x64_bf16 v[64:67], v[28:31], a[200:207], v172
    v_smfmac_f32_16x16x64_bf16 v[68:71], v[28:31], a[232:239], v172
g_38L12_2:
    s_waitcnt vmcnt(1)
    v_max3_u32 v19, v32, v33, v34
    v_max_u32 v19, v19, v35
    v_cmp_eq_u32 vcc, -1, v19
    s_nop 0
    s_cbranch_vccnz g_38F12_2
    v_smfmac_f32_16x16x64_bf16 v[64:67], v[32:35], a[208:215], v172
    v_smfmac_f32_16x16x64_bf16 v[68:71], v[32:35], a[240:247], v172
g_38L8_3:
    s_waitcnt vmcnt(0)
    v_max3_u32 v19, v36, v37, v38
    v_max_u32 v19, v19, v39
    v_cmp_eq_u32 vcc, -1, v19
    s_nop 0
    s_cbranch_vccnz g_38F8_3
    v_smfmac_f32_16x16x64_bf16 v[64:67], v[36:39], a[216:223], v172
    v_smfmac_f32_16x16x64_bf16 v[68:71], v[36:39], a[248:255], v172
    s_nop 4
    v_cvt_pk_bf16_f32 v80, v64, v65
    v_cvt_pk_bf16_f32 v81, v66, v67
    s_nop 0
    v_cvt_pk_bf16_f32 v82, v68, v69
    v_cvt_pk_bf16_f32 v83, v70, v71
    ds_write_b128 v17, v[80:83] offset:9216
    s_branch gc_39
g_38L15_1:
    s_waitcnt vmcnt(3)
    v_max3_u32 v19, v28, v29, v30
    v_max_u32 v19, v19, v31
    v_cmp_eq_u32 vcc, -1, v19
    s_nop 0
    s_cbranch_vccnz g_38F15_1
    v_smfmac_f32_16x16x64_bf16 v[64:67], v[28:31], a[200:207], v172
    v_smfmac_f32_16x16x64_bf16 v[68:71], v[28:31], a[232:239], v172
g_38L13_2:
    s_waitcnt vmcnt(2)
    v_max3_u32 v19, v32, v33, v34
    v_max_u32 v19, v19, v35
    v_cmp_eq_u32 vcc, -1, v19
    s_nop 0
    s_cbranch_vccnz g_38F13_2
    v_smfmac_f32_16x16x64_bf16 v[64:67], v[32:35], a[208:215], v172
    v_smfmac_f32_16x16x64_bf16 v[68:71], v[32:35], a[240:247], v172
g_38L9_3:
    s_waitcnt vmcnt(1)
    v_max3_u32 v19, v36, v37, v38
    v_max_u32 v19, v19, v39
    v_cmp_eq_u32 vcc, -1, v19
    s_nop 0
    s_cbranch_vccnz g_38F9_3
    v_smfmac_f32_16x16x64_bf16 v[64:67], v[36:39], a[216:223], v172
    v_smfmac_f32_16x16x64_bf16 v[68:71], v[36:39], a[248:255], v172
g_38L1_0:
    s_waitcnt vmcnt(0)
    v_max3_u32 v19, v24, v25, v26
    v_max_u32 v19, v19, v27
    v_cmp_eq_u32 vcc, -1, v19
    s_nop 0
    s_cbranch_vccnz g_38F1_0
    v_smfmac_f32_16x16x64_bf16 v[64:67], v[24:27], a[192:199], v172
    v_smfmac_f32_16x16x64_bf16 v[68:71], v[24:27], a[224:231], v172
    s_nop 4
    v_cvt_pk_bf16_f32 v80, v64, v65
    v_cvt_pk_bf16_f32 v81, v66, v67
    s_nop 0
    v_cvt_pk_bf16_f32 v82, v68, v69
    v_cvt_pk_bf16_f32 v83, v70, v71
    ds_write_b128 v17, v[80:83] offset:9216
    s_branch gc_39
g_38L15_2:
    s_waitcnt vmcnt(3)
    v_max3_u32 v19, v32, v33, v34
    v_max_u32 v19, v19, v35
    v_cmp_eq_u32 vcc, -1, v19
    s_nop 0
    s_cbranch_vccnz g_38F15_2
    v_smfmac_f32_16x16x64_bf16 v[64:67], v[32:35], a[208:215], v172
    v_smfmac_f32_16x16x64_bf16 v[68:71], v[32:35], a[240:247], v172
g_38L11_3:
    s_waitcnt vmcnt(2)
    v_max3_u32 v19, v36, v37, v38
    v_max_u32 v19, v19, v39
    v_cmp_eq_u32 vcc, -1, v19
    s_nop 0
    s_cbranch_vccnz g_38F11_3
    v_smfmac_f32_16x16x64_bf16 v[64:67], v[36:39], a[216:223], v172
    v_smfmac_f32_16x16x64_bf16 v[68:71], v[36:39], a[248:255], v172
g_38L3_0:
    s_waitcnt vmcnt(1)
    v_max3_u32 v19, v24, v25, v26
    v_max_u32 v19, v19, v27
    v_cmp_eq_u32 vcc, -1, v19
    s_nop 0
    s_cbranch_vccnz g_38F3_0
    v_smfmac_f32_16x16x64_bf16 v[64:67], v[24:27], a[192:199], v172
    v_smfmac_f32_16x16x64_bf16 v[68:71], v[24:27], a[224:231], v172
g_38L2_1:
    s_waitcnt vmcnt(0)
    v_max3_u32 v19, v28, v29, v30
    v_max_u32 v19, v19, v31
    v_cmp_eq_u32 vcc, -1, v19
    s_nop 0
    s_cbranch_vccnz g_38F2_1
    v_smfmac_f32_16x16x64_bf16 v[64:67], v[28:31], a[200:207], v172
    v_smfmac_f32_16x16x64_bf16 v[68:71], v[28:31], a[232:239], v172
    s_nop 4
    v_cvt_pk_bf16_f32 v80, v64, v65
    v_cvt_pk_bf16_f32 v81, v66, v67
    s_nop 0
    v_cvt_pk_bf16_f32 v82, v68, v69
    v_cvt_pk_bf16_f32 v83, v70, v71
    ds_write_b128 v17, v[80:83] offset:9216
    s_branch gc_39
g_38L15_3:
    s_waitcnt vmcnt(3)
    v_max3_u32 v19, v36, v37, v38
    v_max_u32 v19, v19, v39
    v_cmp_eq_u32 vcc, -1, v19
    s_nop 0
    s_cbranch_vccnz g_38F15_3
    v_smfmac_f32_16x16x64_bf16 v[64:67], v[36:39], a[216:223], v172
    v_smfmac_f32_16x16x64_bf16 v[68:71], v[36:39], a[248:255], v172
g_38L7_0:
    s_waitcnt vmcnt(2)
    v_max3_u32 v19, v24, v25, v26
    v_max_u32 v19, v19, v27
    v_cmp_eq_u32 vcc, -1, v19
    s_nop 0
    s_cbranch_vccnz g_38F7_0
    v_smfmac_f32_16x16x64_bf16 v[64:67], v[24:27], a[192:199], v172
    v_smfmac_f32_16x16x64_bf16 v[68:71], v[24:27], a[224:231], v172
g_38L6_1:
    s_waitcnt vmcnt(1)
    v_max3_u32 v19, v28, v29, v30
    v_max_u32 v19, v19, v31
    v_cmp_eq_u32 vcc, -1, v19
    s_nop 0
    s_cbranch_vccnz g_38F6_1
    v_smfmac_f32_16x16x64_bf16 v[64:67], v[28:31], a[200:207], v172
    v_smfmac_f32_16x16x64_bf16 v[68:71], v[28:31], a[232:239], v172
g_38L4_2:
    s_waitcnt vmcnt(0)
    v_max3_u32 v19, v32, v33, v34
    v_max_u32 v19, v19, v35
    v_cmp_eq_u32 vcc, -1, v19
    s_nop 0
    s_cbranch_vccnz g_38F4_2
    v_smfmac_f32_16x16x64_bf16 v[64:67], v[32:35], a[208:215], v172
    v_smfmac_f32_16x16x64_bf16 v[68:71], v[32:35], a[240:247], v172
    s_nop 4
    v_cvt_pk_bf16_f32 v80, v64, v65
    v_cvt_pk_bf16_f32 v81, v66, v67
    s_nop 0
    v_cvt_pk_bf16_f32 v82, v68, v69
    v_cvt_pk_bf16_f32 v83, v70, v71
    ds_write_b128 v17, v[80:83] offset:9216
    s_branch gc_39
g_38L7_1:
    s_waitcnt vmcnt(2)
    v_max3_u32 v19, v28, v29, v30
    v_max_u32 v19, v19, v31
    v_cmp_eq_u32 vcc, -1, v19
    s_nop 0
    s_cbranch_vccnz g_38F7_1
    v_smfmac_f32_16x16x64_bf16 v[64:67], v[28:31], a[200:207], v172
    v_smfmac_f32_16x16x64_bf16 v[68:71], v[28:31], a[232:239], v172
g_38L5_2:
    s_waitcnt vmcnt(1)
    v_max3_u32 v19, v32, v33, v34
    v_max_u32 v19, v19, v35
    v_cmp_eq_u32 vcc, -1, v19
    s_nop 0
    s_cbranch_vccnz g_38F5_2
    v_smfmac_f32_16x16x64_bf16 v[64:67], v[32:35], a[208:215], v172
    v_smfmac_f32_16x16x64_bf16 v[68:71], v[32:35], a[240:247], v172
    s_branch g_38L1_0
g_38L7_2:
    s_waitcnt vmcnt(2)
    v_max3_u32 v19, v32, v33, v34
    v_max_u32 v19, v19, v35
    v_cmp_eq_u32 vcc, -1, v19
    s_nop 0
    s_cbranch_vccnz g_38F7_2
    v_smfmac_f32_16x16x64_bf16 v[64:67], v[32:35], a[208:215], v172
    v_smfmac_f32_16x16x64_bf16 v[68:71], v[32:35], a[240:247], v172
    s_branch g_38L3_0
g_38L11_0:
    s_waitcnt vmcnt(2)
    v_max3_u32 v19, v24, v25, v26
    v_max_u32 v19, v19, v27
    v_cmp_eq_u32 vcc, -1, v19
    s_nop 0
    s_cbranch_vccnz g_38F11_0
    v_smfmac_f32_16x16x64_bf16 v[64:67], v[24:27], a[192:199], v172
    v_smfmac_f32_16x16x64_bf16 v[68:71], v[24:27], a[224:231], v172
g_38L10_1:
    s_waitcnt vmcnt(1)
    v_max3_u32 v19, v28, v29, v30
    v_max_u32 v19, v19, v31
    v_cmp_eq_u32 vcc, -1, v19
    s_nop 0
    s_cbranch_vccnz g_38F10_1
    v_smfmac_f32_16x16x64_bf16 v[64:67], v[28:31], a[200:207], v172
    v_smfmac_f32_16x16x64_bf16 v[68:71], v[28:31], a[232:239], v172
    s_branch g_38L8_3
g_38L11_1:
    s_waitcnt vmcnt(2)
    v_max3_u32 v19, v28, v29, v30
    v_max_u32 v19, v19, v31
    v_cmp_eq_u32 vcc, -1, v19
    s_nop 0
    s_cbranch_vccnz g_38F11_1
    v_smfmac_f32_16x16x64_bf16 v[64:67], v[28:31], a[200:207], v172
    v_smfmac_f32_16x16x64_bf16 v[68:71], v[28:31], a[232:239], v172
    s_branch g_38L9_3
g_38L13_0:
    s_waitcnt vmcnt(2)
    v_max3_u32 v19, v24, v25, v26
    v_max_u32 v19, v19, v27
    v_cmp_eq_u32 vcc, -1, v19
    s_nop 0
    s_cbranch_vccnz g_38F13_0
    v_smfmac_f32_16x16x64_bf16 v[64:67], v[24:27], a[192:199], v172
    v_smfmac_f32_16x16x64_bf16 v[68:71], v[24:27], a[224:231], v172
    s_branch g_38L12_2
g_38L13_3:
    s_waitcnt vmcnt(2)
    v_max3_u32 v19, v36, v37, v38
    v_max_u32 v19, v19, v39
    v_cmp_eq_u32 vcc, -1, v19
    s_nop 0
    s_cbranch_vccnz g_38F13_3
    v_smfmac_f32_16x16x64_bf16 v[64:67], v[36:39], a[216:223], v172
    v_smfmac_f32_16x16x64_bf16 v[68:71], v[36:39], a[248:255], v172
g_38L5_0:
    s_waitcnt vmcnt(1)
    v_max3_u32 v19, v24, v25, v26
    v_max_u32 v19, v19, v27
    v_cmp_eq_u32 vcc, -1, v19
    s_nop 0
    s_cbranch_vccnz g_38F5_0
    v_smfmac_f32_16x16x64_bf16 v[64:67], v[24:27], a[192:199], v172
    v_smfmac_f32_16x16x64_bf16 v[68:71], v[24:27], a[224:231], v172
    s_branch g_38L4_2
g_38L14_2:
    s_waitcnt vmcnt(2)
    v_max3_u32 v19, v32, v33, v34
    v_max_u32 v19, v19, v35
    v_cmp_eq_u32 vcc, -1, v19
    s_nop 0
    s_cbranch_vccnz g_38F14_2
    v_smfmac_f32_16x16x64_bf16 v[64:67], v[32:35], a[208:215], v172
    v_smfmac_f32_16x16x64_bf16 v[68:71], v[32:35], a[240:247], v172
g_38L10_3:
    s_waitcnt vmcnt(1)
    v_max3_u32 v19, v36, v37, v38
    v_max_u32 v19, v19, v39
    v_cmp_eq_u32 vcc, -1, v19
    s_nop 0
    s_cbranch_vccnz g_38F10_3
    v_smfmac_f32_16x16x64_bf16 v[64:67], v[36:39], a[216:223], v172
    v_smfmac_f32_16x16x64_bf16 v[68:71], v[36:39], a[248:255], v172
    s_branch g_38L2_1
g_38L14_3:
    s_waitcnt vmcnt(2)
    v_max3_u32 v19, v36, v37, v38
    v_max_u32 v19, v19, v39
    v_cmp_eq_u32 vcc, -1, v19
    s_nop 0
    s_cbranch_vccnz g_38F14_3
    v_smfmac_f32_16x16x64_bf16 v[64:67], v[36:39], a[216:223], v172
    v_smfmac_f32_16x16x64_bf16 v[68:71], v[36:39], a[248:255], v172
    s_branch g_38L6_1
g_38L3_1:
    s_waitcnt vmcnt(1)
    v_max3_u32 v19, v28, v29, v30
    v_max_u32 v19, v19, v31
    v_cmp_eq_u32 vcc, -1, v19
    s_nop 0
    s_cbranch_vccnz g_38F3_1
    v_smfmac_f32_16x16x64_bf16 v[64:67], v[28:31], a[200:207], v172
    v_smfmac_f32_16x16x64_bf16 v[68:71], v[28:31], a[232:239], v172
    s_branch g_38L1_0
g_38L6_2:
    s_waitcnt vmcnt(1)
    v_max3_u32 v19, v32, v33, v34
    v_max_u32 v19, v19, v35
    v_cmp_eq_u32 vcc, -1, v19
    s_nop 0
    s_cbranch_vccnz g_38F6_2
    v_smfmac_f32_16x16x64_bf16 v[64:67], v[32:35], a[208:215], v172
    v_smfmac_f32_16x16x64_bf16 v[68:71], v[32:35], a[240:247], v172
    s_branch g_38L2_1
g_38L9_0:
    s_waitcnt vmcnt(1)
    v_max3_u32 v19, v24, v25, v26
    v_max_u32 v19, v19, v27
    v_cmp_eq_u32 vcc, -1, v19
    s_nop 0
    s_cbranch_vccnz g_38F9_0
    v_smfmac_f32_16x16x64_bf16 v[64:67], v[24:27], a[192:199], v172
    v_smfmac_f32_16x16x64_bf16 v[68:71], v[24:27], a[224:231], v172
    s_branch g_38L8_3
g_38L12_3:
    s_waitcnt vmcnt(1)
    v_max3_u32 v19, v36, v37, v38
    v_max_u32 v19, v19, v39
    v_cmp_eq_u32 vcc, -1, v19
    s_nop 0
    s_cbranch_vccnz g_38F12_3
    v_smfmac_f32_16x16x64_bf16 v[64:67], v[36:39], a[216:223], v172
    v_smfmac_f32_16x16x64_bf16 v[68:71], v[36:39], a[248:255], v172
    s_branch g_38L4_2
g_38F15_0:
    s_mov_b64 exec, vcc
    buffer_load_dwordx4 v[24:27], v8, s[4:7], s16 offen offset:0 sc1
    s_mov_b64 exec, -1
    s_add_u32 s23, s23, 1
    s_cmp_lt_u32 s23, 200000
    s_cbranch_scc1 g_38L15_1
    s_mov_b32 s25, 200000
    s_branch gc_39
g_38F15_1:
    s_mov_b64 exec, vcc
    buffer_load_dwordx4 v[28:31], v8, s[4:7], s16 offen offset:1024 sc1
    s_mov_b64 exec, -1
    s_add_u32 s23, s23, 1
    s_cmp_lt_u32 s23, 200000
    s_cbranch_scc1 g_38L15_2
    s_mov_b32 s25, 200000
    s_branch gc_39
g_38F15_2:
    s_mov_b64 exec, vcc
    buffer_load_dwordx4 v[32:35], v8, s[4:7], s16 offen offset:2048 sc1
    s_mov_b64 exec, -1
    s_add_u32 s23, s23, 1
    s_cmp_lt_u32 s23, 200000
    s_cbranch_scc1 g_38L15_3
    s_mov_b32 s25, 200000
    s_branch gc_39
g_38F15_3:
    s_mov_b64 exec, vcc
    buffer_load_dwordx4 v[36:39], v8, s[4:7], s16 offen offset:3072 sc1
    s_mov_b64 exec, -1
    s_add_u32 s23, s23, 1
    s_cmp_lt_u32 s23, 200000
    s_cbranch_scc1 g_38L15_0
    s_mov_b32 s25, 200000
    s_branch gc_39
g_38F7_0:
    s_mov_b64 exec, vcc
    buffer_load_dwordx4 v[24:27], v8, s[4:7], s16 offen offset:0 sc1
    s_mov_b64 exec, -1
    s_add_u32 s23, s23, 1
    s_cmp_lt_u32 s23, 200000
    s_cbranch_scc1 g_38L7_1
    s_mov_b32 s25, 200000
    s_branch gc_39
g_38F7_1:
    s_mov_b64 exec, vcc
    buffer_load_dwordx4 v[28:31], v8, s[4:7], s16 offen offset:1024 sc1
    s_mov_b64 exec, -1
    s_add_u32 s23, s23, 1
    s_cmp_lt_u32 s23, 200000
    s_cbranch_scc1 g_38L7_2
    s_mov_b32 s25, 200000
    s_branch gc_39
g_38F7_2:
    s_mov_b64 exec, vcc
    buffer_load_dwordx4 v[32:35], v8, s[4:7], s16 offen offset:2048 sc1
    s_mov_b64 exec, -1
    s_add_u32 s23, s23, 1
    s_cmp_lt_u32 s23, 200000
    s_cbranch_scc1 g_38L7_0
    s_mov_b32 s25, 200000
    s_branch gc_39
g_38F11_0:
    s_mov_b64 exec, vcc
    buffer_load_dwordx4 v[24:27], v8, s[4:7], s16 offen offset:0 sc1
    s_mov_b64 exec, -1
    s_add_u32 s23, s23, 1
    s_cmp_lt_u32 s23, 200000
    s_cbranch_scc1 g_38L11_1
    s_mov_b32 s25, 200000
    s_branch gc_39
g_38F11_1:
    s_mov_b64 exec, vcc
    buffer_load_dwordx4 v[28:31], v8, s[4:7], s16 offen offset:1024 sc1
    s_mov_b64 exec, -1
    s_add_u32 s23, s23, 1
    s_cmp_lt_u32 s23, 200000
    s_cbranch_scc1 g_38L11_3
    s_mov_b32 s25, 200000
    s_branch gc_39
g_38F11_3:
    s_mov_b64 exec, vcc
    buffer_load_dwordx4 v[36:39], v8, s[4:7], s16 offen offset:3072 sc1
    s_mov_b64 exec, -1
    s_add_u32 s23, s23, 1
    s_cmp_lt_u32 s23, 200000
    s_cbranch_scc1 g_38L11_0
    s_mov_b32 s25, 200000
    s_branch gc_39
g_38F13_0:
    s_mov_b64 exec, vcc
    buffer_load_dwordx4 v[24:27], v8, s[4:7], s16 offen offset:0 sc1
    s_mov_b64 exec, -1
    s_add_u32 s23, s23, 1
    s_cmp_lt_u32 s23, 200000
    s_cbranch_scc1 g_38L13_2
    s_mov_b32 s25, 200000
    s_branch gc_39
g_38F13_2:
    s_mov_b64 exec, vcc
    buffer_load_dwordx4 v[32:35], v8, s[4:7], s16 offen offset:2048 sc1
    s_mov_b64 exec, -1
    s_add_u32 s23, s23, 1
    s_cmp_lt_u32 s23, 200000
    s_cbranch_scc1 g_38L13_3
    s_mov_b32 s25, 200000
    s_branch gc_39
g_38F13_3:
    s_mov_b64 exec, vcc
    buffer_load_dwordx4 v[36:39], v8, s[4:7], s16 offen offset:3072 sc1
    s_mov_b64 exec, -1
    s_add_u32 s23, s23, 1
    s_cmp_lt_u32 s23, 200000
    s_cbranch_scc1 g_38L13_0
    s_mov_b32 s25, 200000
    s_branch gc_39
g_38F14_1:
    s_mov_b64 exec, vcc
    buffer_load_dwordx4 v[28:31], v8, s[4:7], s16 offen offset:1024 sc1
    s_mov_b64 exec, -1
    s_add_u32 s23, s23, 1
    s_cmp_lt_u32 s23, 200000
    s_cbranch_scc1 g_38L14_2
    s_mov_b32 s25, 200000
    s_branch gc_39
g_38F14_2:
    s_mov_b64 exec, vcc
    buffer_load_dwordx4 v[32:35], v8, s[4:7], s16 offen offset:2048 sc1
    s_mov_b64 exec, -1
    s_add_u32 s23, s23, 1
    s_cmp_lt_u32 s23, 200000
    s_cbranch_scc1 g_38L14_3
    s_mov_b32 s25, 200000
    s_branch gc_39
g_38F14_3:
    s_mov_b64 exec, vcc
    buffer_load_dwordx4 v[36:39], v8, s[4:7], s16 offen offset:3072 sc1
    s_mov_b64 exec, -1
    s_add_u32 s23, s23, 1
    s_cmp_lt_u32 s23, 200000
    s_cbranch_scc1 g_38L14_1
    s_mov_b32 s25, 200000
    s_branch gc_39
g_38F3_0:
    s_mov_b64 exec, vcc
    buffer_load_dwordx4 v[24:27], v8, s[4:7], s16 offen offset:0 sc1
    s_mov_b64 exec, -1
    s_add_u32 s23, s23, 1
    s_cmp_lt_u32 s23, 200000
    s_cbranch_scc1 g_38L3_1
    s_mov_b32 s25, 200000
    s_branch gc_39
g_38F3_1:
    s_mov_b64 exec, vcc
    buffer_load_dwordx4 v[28:31], v8, s[4:7], s16 offen offset:1024 sc1
    s_mov_b64 exec, -1
    s_add_u32 s23, s23, 1
    s_cmp_lt_u32 s23, 200000
    s_cbranch_scc1 g_38L3_0
    s_mov_b32 s25, 200000
    s_branch gc_39
g_38F5_0:
    s_mov_b64 exec, vcc
    buffer_load_dwordx4 v[24:27], v8, s[4:7], s16 offen offset:0 sc1
    s_mov_b64 exec, -1
    s_add_u32 s23, s23, 1
    s_cmp_lt_u32 s23, 200000
    s_cbranch_scc1 g_38L5_2
    s_mov_b32 s25, 200000
    s_branch gc_39
g_38F5_2:
    s_mov_b64 exec, vcc
    buffer_load_dwordx4 v[32:35], v8, s[4:7], s16 offen offset:2048 sc1
    s_mov_b64 exec, -1
    s_add_u32 s23, s23, 1
    s_cmp_lt_u32 s23, 200000
    s_cbranch_scc1 g_38L5_0
    s_mov_b32 s25, 200000
    s_branch gc_39
g_38F6_1:
    s_mov_b64 exec, vcc
    buffer_load_dwordx4 v[28:31], v8, s[4:7], s16 offen offset:1024 sc1
    s_mov_b64 exec, -1
    s_add_u32 s23, s23, 1
    s_cmp_lt_u32 s23, 200000
    s_cbranch_scc1 g_38L6_2
    s_mov_b32 s25, 200000
    s_branch gc_39
g_38F6_2:
    s_mov_b64 exec, vcc
    buffer_load_dwordx4 v[32:35], v8, s[4:7], s16 offen offset:2048 sc1
    s_mov_b64 exec, -1
    s_add_u32 s23, s23, 1
    s_cmp_lt_u32 s23, 200000
    s_cbranch_scc1 g_38L6_1
    s_mov_b32 s25, 200000
    s_branch gc_39
g_38F9_0:
    s_mov_b64 exec, vcc
    buffer_load_dwordx4 v[24:27], v8, s[4:7], s16 offen offset:0 sc1
    s_mov_b64 exec, -1
    s_add_u32 s23, s23, 1
    s_cmp_lt_u32 s23, 200000
    s_cbranch_scc1 g_38L9_3
    s_mov_b32 s25, 200000
    s_branch gc_39
g_38F9_3:
    s_mov_b64 exec, vcc
    buffer_load_dwordx4 v[36:39], v8, s[4:7], s16 offen offset:3072 sc1
    s_mov_b64 exec, -1
    s_add_u32 s23, s23, 1
    s_cmp_lt_u32 s23, 200000
    s_cbranch_scc1 g_38L9_0
    s_mov_b32 s25, 200000
    s_branch gc_39
g_38F10_1:
    s_mov_b64 exec, vcc
    buffer_load_dwordx4 v[28:31], v8, s[4:7], s16 offen offset:1024 sc1
    s_mov_b64 exec, -1
    s_add_u32 s23, s23, 1
    s_cmp_lt_u32 s23, 200000
    s_cbranch_scc1 g_38L10_3
    s_mov_b32 s25, 200000
    s_branch gc_39
g_38F10_3:
    s_mov_b64 exec, vcc
    buffer_load_dwordx4 v[36:39], v8, s[4:7], s16 offen offset:3072 sc1
    s_mov_b64 exec, -1
    s_add_u32 s23, s23, 1
    s_cmp_lt_u32 s23, 200000
    s_cbranch_scc1 g_38L10_1
    s_mov_b32 s25, 200000
    s_branch gc_39
g_38F12_2:
    s_mov_b64 exec, vcc
    buffer_load_dwordx4 v[32:35], v8, s[4:7], s16 offen offset:2048 sc1
    s_mov_b64 exec, -1
    s_add_u32 s23, s23, 1
    s_cmp_lt_u32 s23, 200000
    s_cbranch_scc1 g_38L12_3
    s_mov_b32 s25, 200000
    s_branch gc_39
g_38F12_3:
    s_mov_b64 exec, vcc
    buffer_load_dwordx4 v[36:39], v8, s[4:7], s16 offen offset:3072 sc1
    s_mov_b64 exec, -1
    s_add_u32 s23, s23, 1
    s_cmp_lt_u32 s23, 200000
    s_cbranch_scc1 g_38L12_2
    s_mov_b32 s25, 200000
    s_branch gc_39
g_38F1_0:
    s_mov_b64 exec, vcc
    buffer_load_dwordx4 v[24:27], v8, s[4:7], s16 offen offset:0 sc1
    s_mov_b64 exec, -1
    s_add_u32 s23, s23, 1
    s_cmp_lt_u32 s23, 200000
    s_cbranch_scc1 g_38L1_0
    s_mov_b32 s25, 200000
    s_branch gc_39
g_38F2_1:
    s_mov_b64 exec, vcc
    buffer_load_dwordx4 v[28:31], v8, s[4:7], s16 offen offset:1024 sc1
    s_mov_b64 exec, -1
    s_add_u32 s23, s23, 1
    s_cmp_lt_u32 s23, 200000
    s_cbranch_scc1 g_38L2_1
    s_mov_b32 s25, 200000
    s_branch gc_39
g_38F4_2:
    s_mov_b64 exec, vcc
    buffer_load_dwordx4 v[32:35], v8, s[4:7], s16 offen offset:2048 sc1
    s_mov_b64 exec, -1
    s_add_u32 s23, s23, 1
    s_cmp_lt_u32 s23, 200000
    s_cbranch_scc1 g_38L4_2
    s_mov_b32 s25, 200000
    s_branch gc_39
g_38F8_3:
    s_mov_b64 exec, vcc
    buffer_load_dwordx4 v[36:39], v8, s[4:7], s16 offen offset:3072 sc1
    s_mov_b64 exec, -1
    s_add_u32 s23, s23, 1
    s_cmp_lt_u32 s23, 200000
    s_cbranch_scc1 g_38L8_3
    s_mov_b32 s25, 200000
    s_branch gc_39
.p2align 6
recur_fast_w2:
    s_nop 15
    s_mov_b32 s23, s25
    buffer_load_dwordx4 v[24:27], v2, s[4:7], s16 offen offset:0 sc1
    s_nop 11
    buffer_load_dwordx4 v[28:31], v2, s[4:7], s16 offen offset:1024 sc1
    s_nop 11
    buffer_load_dwordx4 v[32:35], v2, s[4:7], s16 offen offset:2048 sc1
    s_nop 11
    buffer_load_dwordx4 v[36:39], v2, s[4:7], s16 offen offset:3072 sc1
    s_waitcnt vmcnt(3)
    v_max3_u32 v19, v24, v25, v26
    v_max_u32 v19, v19, v27
    v_cmp_eq_u32 vcc, -1, v19
    s_nop 0
    s_cbranch_vccnz g_42F15_0
    v_smfmac_f32_16x16x64_bf16 v[40:43], v[24:27], a[0:7], v172
    v_smfmac_f32_16x16x64_bf16 v[44:47], v[24:27], a[64:71], v172
    s_waitcnt vmcnt(2)
    v_max3_u32 v19, v28, v29, v30
    v_max_u32 v19, v19, v31
    v_smfmac_f32_16x16x64_bf16 v[48:51], v[24:27], a[32:39], v172
    v_cmp_eq_u32 vcc, -1, v19
    v_smfmac_f32_16x16x64_bf16 v[52:55], v[24:27], a[96:103], v172
    s_cbranch_vccnz g_42F14_1
    v_smfmac_f32_16x16x64_bf16 v[40:43], v[28:31], a[8:15], v172
    v_smfmac_f32_16x16x64_bf16 v[44:47], v[28:31], a[72:79], v172
    s_waitcnt vmcnt(1)
    v_max3_u32 v19, v32, v33, v34
    v_max_u32 v19, v19, v35
    v_smfmac_f32_16x16x64_bf16 v[48:51], v[28:31], a[40:47], v172
    v_cmp_eq_u32 vcc, -1, v19
    v_smfmac_f32_16x16x64_bf16 v[52:55], v[28:31], a[104:111], v172
    s_cbranch_vccnz g_42F12_2
    v_smfmac_f32_16x16x64_bf16 v[40:43], v[32:35], a[16:23], v172
    v_smfmac_f32_16x16x64_bf16 v[44:47], v[32:35], a[80:87], v172
    s_waitcnt vmcnt(0)
    v_max3_u32 v19, v36, v37, v38
    v_max_u32 v19, v19, v39
    v_smfmac_f32_16x16x64_bf16 v[48:51], v[32:35], a[48:55], v172
    v_cmp_eq_u32 vcc, -1, v19
    v_smfmac_f32_16x16x64_bf16 v[52:55], v[32:35], a[112:119], v172
    s_cbranch_vccnz g_42F8_3
    v_smfmac_f32_16x16x64_bf16 v[40:43], v[36:39], a[24:31], v172
    v_smfmac_f32_16x16x64_bf16 v[44:47], v[36:39], a[88:95], v172
    v_smfmac_f32_16x16x64_bf16 v[48:51], v[36:39], a[56:63], v172
    v_smfmac_f32_16x16x64_bf16 v[52:55], v[36:39], a[120:127], v172
gc_43:
    v_cvt_pk_bf16_f32 v72, v40, v41
    v_cvt_pk_bf16_f32 v73, v42, v43
    v_cvt_pk_bf16_f32 v74, v44, v45
    v_cvt_pk_bf16_f32 v75, v46, v47
    ds_write_b128 v17, v[72:75] offset:0
    v_cvt_pk_bf16_f32 v76, v48, v49
    v_cvt_pk_bf16_f32 v77, v50, v51
    s_nop 0
    v_cvt_pk_bf16_f32 v78, v52, v53
    v_cvt_pk_bf16_f32 v79, v54, v55
    ds_write_b128 v17, v[76:79] offset:1024
    v_smfmac_f32_16x16x64_bf16 v[56:59], v[24:27], a[128:135], v172
    v_smfmac_f32_16x16x64_bf16 v[60:63], v[24:27], a[160:167], v172
    v_smfmac_f32_16x16x64_bf16 v[56:59], v[28:31], a[136:143], v172
    s_waitcnt lgkmcnt(0)
    s_barrier
    v_smfmac_f32_16x16x64_bf16 v[60:63], v[28:31], a[168:175], v172
    v_smfmac_f32_16x16x64_bf16 v[56:59], v[32:35], a[144:151], v172
    v_smfmac_f32_16x16x64_bf16 v[60:63], v[32:35], a[176:183], v172
    v_smfmac_f32_16x16x64_bf16 v[56:59], v[36:39], a[152:159], v172
    v_smfmac_f32_16x16x64_bf16 v[60:63], v[36:39], a[184:191], v172
    s_nop 4
    v_cvt_pk_bf16_f32 v80, v56, v57
    v_cvt_pk_bf16_f32 v81, v58, v59
    s_nop 0
    v_cvt_pk_bf16_f32 v82, v60, v61
    v_cvt_pk_bf16_f32 v83, v62, v63
    ds_write_b128 v17, v[80:83] offset:8192
    s_cmp_eq_u32 s15, 63
    s_waitcnt lgkmcnt(0)
    s_barrier
    ds_read_b128 v[96:99], v16 offset:8192
    ds_read_b128 v[100:103], v16 offset:10240
    ds_read_b128 v[108:111], v16 offset:14336
    v_mfma_f32_16x16x32_bf16 v[140:143], v[84:87], v[80:83], 0
    s_waitcnt lgkmcnt(2)
    v_mfma_f32_16x16x32_bf16 v[140:143], v[84:87], v[96:99], v[140:143]
    s_waitcnt lgkmcnt(1)
    v_mfma_f32_16x16x32_bf16 v[140:143], v[84:87], v[100:103], v[140:143]
    s_waitcnt lgkmcnt(0)
    v_mfma_f32_16x16x32_bf16 v[140:143], v[84:87], v[108:111], v[140:143]
    s_nop 7
    v_cvt_pk_bf16_f32 v168, v140, v141
    v_cvt_pk_bf16_f32 v169, v142, v143
    v_mov_b32 v170, v168
    v_mov_b32 v171, v169
    s_nop 0
    v_permlane16_swap_b32 v168, v170
    v_permlane16_swap_b32 v169, v171
    s_cbranch_scc1 recur_fast_last2
    buffer_store_dwordx4 v[168:171], v15, s[4:7], s20 offen sc1
    s_add_u32 s20, s20, 512
    s_add_u32 s21, s95, 1048576
    s_lshr_b32 s22, s21, 8
    s_and_b32 s22, s22, 8192
    s_xor_b32 s22, s22, s46
    s_add_u32 s21, s21, s22
    buffer_store_dwordx4 v[204:207], v9, s[4:7], s21 offen sc1
    s_add_u32 s21, s21, 262144
    s_lshl_b32 s21, s15, 9
    s_add_u32 s21, s21, 71307264
    s_cmp_ge_u32 s15, 56
    s_cselect_b32 s21, 1073741824, s21
    buffer_store_dwordx4 v[204:207], v246, s[4:7], s21 offen sc1
    s_barrier
    s_nop 15
    s_mov_b32 s23, s25
    buffer_load_dwordx4 v[24:27], v8, s[4:7], s16 offen offset:0 sc1
    s_nop 11
    buffer_load_dwordx4 v[28:31], v8, s[4:7], s16 offen offset:1024 sc1
    s_nop 11
    buffer_load_dwordx4 v[32:35], v8, s[4:7], s16 offen offset:2048 sc1
    s_nop 11
    buffer_load_dwordx4 v[36:39], v8, s[4:7], s16 offen offset:3072 sc1
    s_waitcnt vmcnt(3)
    v_max3_u32 v19, v24, v25, v26
    v_max_u32 v19, v19, v27
    v_cmp_eq_u32 vcc, -1, v19
    s_nop 0
    s_cbranch_vccnz g_44F15_0
    v_smfmac_f32_16x16x64_bf16 v[64:67], v[24:27], a[192:199], v172
    v_smfmac_f32_16x16x64_bf16 v[68:71], v[24:27], a[224:231], v172
    s_waitcnt vmcnt(2)
    v_max3_u32 v19, v28, v29, v30
    v_max_u32 v19, v19, v31
    v_cmp_eq_u32 vcc, -1, v19
    s_nop 0
    s_cbranch_vccnz g_44F14_1
    v_smfmac_f32_16x16x64_bf16 v[64:67], v[28:31], a[200:207], v172
    v_smfmac_f32_16x16x64_bf16 v[68:71], v[28:31], a[232:239], v172
    s_waitcnt vmcnt(1)
    v_max3_u32 v19, v32, v33, v34
    v_max_u32 v19, v19, v35
    v_cmp_eq_u32 vcc, -1, v19
    s_nop 0
    s_cbranch_vccnz g_44F12_2
    v_smfmac_f32_16x16x64_bf16 v[64:67], v[32:35], a[208:215], v172
    v_smfmac_f32_16x16x64_bf16 v[68:71], v[32:35], a[240:247], v172
    s_waitcnt vmcnt(0)
    v_max3_u32 v19, v36, v37, v38
    v_max_u32 v19, v19, v39
    v_cmp_eq_u32 vcc, -1, v19
    s_nop 0
    s_cbranch_vccnz g_44F8_3
    v_smfmac_f32_16x16x64_bf16 v[64:67], v[36:39], a[216:223], v172
    v_smfmac_f32_16x16x64_bf16 v[68:71], v[36:39], a[248:255], v172
    s_nop 4
    v_cvt_pk_bf16_f32 v80, v64, v65
    v_cvt_pk_bf16_f32 v81, v66, v67
    s_nop 0
    v_cvt_pk_bf16_f32 v82, v68, v69
    v_cvt_pk_bf16_f32 v83, v70, v71
    ds_write_b128 v17, v[80:83] offset:9216
gc_45:
    s_waitcnt lgkmcnt(0)
    s_barrier
    s_nop 15
    s_nop 15
    s_nop 15
    v_mov_b32 v40, 0
    v_mov_b32 v41, 0
    v_mov_b32 v42, 0
    v_mov_b32 v43, 0
    v_mov_b32 v44, 0
    v_mov_b32 v45, 0
    v_mov_b32 v46, 0
    v_mov_b32 v47, 0
    v_mov_b32 v48, 0
    v_mov_b32 v49, 0
    v_mov_b32 v50, 0
    v_mov_b32 v51, 0
    v_mov_b32 v52, 0
    v_mov_b32 v53, 0
    v_mov_b32 v54, 0
    v_mov_b32 v55, 0
    v_mov_b32 v56, 0
    v_mov_b32 v57, 0
    v_mov_b32 v58, 0
    v_mov_b32 v59, 0
    v_mov_b32 v60, 0
    v_mov_b32 v61, 0
    v_mov_b32 v62, 0
    v_mov_b32 v63, 0
    v_mov_b32 v64, 0
    v_mov_b32 v65, 0
    v_mov_b32 v66, 0
    v_mov_b32 v67, 0
    v_mov_b32 v68, 0
    v_mov_b32 v69, 0
    v_mov_b32 v70, 0
    v_mov_b32 v71, 0
    s_mov_b32 s21, s16
    s_mov_b32 s16, s42
    s_mov_b32 s42, s43
    s_mov_b32 s43, s44
    s_mov_b32 s44, s21
    s_add_u32 s95, s95, 524288
    s_lshr_b32 s84, s95, 8
    s_and_b32 s84, s84, 8192
    s_xor_b32 s84, s84, s46
    s_add_u32 s84, s84, s95
    s_add_u32 s15, s15, 1
    s_barrier
    s_branch recur_fast_w2
g_42L15_0:
    s_waitcnt vmcnt(3)
    v_max3_u32 v19, v24, v25, v26
    v_max_u32 v19, v19, v27
    v_cmp_eq_u32 vcc, -1, v19
    s_nop 0
    s_cbranch_vccnz g_42F15_0
    v_smfmac_f32_16x16x64_bf16 v[40:43], v[24:27], a[0:7], v172
    v_smfmac_f32_16x16x64_bf16 v[44:47], v[24:27], a[64:71], v172
    v_smfmac_f32_16x16x64_bf16 v[48:51], v[24:27], a[32:39], v172
    v_smfmac_f32_16x16x64_bf16 v[52:55], v[24:27], a[96:103], v172
g_42L14_1:
    s_waitcnt vmcnt(2)
    v_max3_u32 v19, v28, v29, v30
    v_max_u32 v19, v19, v31
    v_cmp_eq_u32 vcc, -1, v19
    s_nop 0
    s_cbranch_vccnz g_42F14_1
    v_smfmac_f32_16x16x64_bf16 v[40:43], v[28:31], a[8:15], v172
    v_smfmac_f32_16x16x64_bf16 v[44:47], v[28:31], a[72:79], v172
    v_smfmac_f32_16x16x64_bf16 v[48:51], v[28:31], a[40:47], v172
    v_smfmac_f32_16x16x64_bf16 v[52:55], v[28:31], a[104:111], v172
g_42L12_2:
    s_waitcnt vmcnt(1)
    v_max3_u32 v19, v32, v33, v34
    v_max_u32 v19, v19, v35
    v_cmp_eq_u32 vcc, -1, v19
    s_nop 0
    s_cbranch_vccnz g_42F12_2
    v_smfmac_f32_16x16x64_bf16 v[40:43], v[32:35], a[16:23], v172
    v_smfmac_f32_16x16x64_bf16 v[44:47], v[32:35], a[80:87], v172
    v_smfmac_f32_16x16x64_bf16 v[48:51], v[32:35], a[48:55], v172
    v_smfmac_f32_16x16x64_bf16 v[52:55], v[32:35], a[112:119], v172
g_42L8_3:
    s_waitcnt vmcnt(0)
    v_max3_u32 v19, v36, v37, v38
    v_max_u32 v19, v19, v39
    v_cmp_eq_u32 vcc, -1, v19
    s_nop 0
    s_cbranch_vccnz g_42F8_3
    v_smfmac_f32_16x16x64_bf16 v[40:43], v[36:39], a[24:31], v172
    v_smfmac_f32_16x16x64_bf16 v[44:47], v[36:39], a[88:95], v172
    v_smfmac_f32_16x16x64_bf16 v[48:51], v[36:39], a[56:63], v172
    v_smfmac_f32_16x16x64_bf16 v[52:55], v[36:39], a[120:127], v172
    s_branch gc_43
g_42L15_1:
    s_waitcnt vmcnt(3)
    v_max3_u32 v19, v28, v29, v30
    v_max_u32 v19, v19, v31
    v_cmp_eq_u32 vcc, -1, v19
    s_nop 0
    s_cbranch_vccnz g_42F15_1
    v_smfmac_f32_16x16x64_bf16 v[40:43], v[28:31], a[8:15], v172
    v_smfmac_f32_16x16x64_bf16 v[44:47], v[28:31], a[72:79], v172
    v_smfmac_f32_16x16x64_bf16 v[48:51], v[28:31], a[40:47], v172
    v_smfmac_f32_16x16x64_bf16 v[52:55], v[28:31], a[104:111], v172
g_42L13_2:
    s_waitcnt vmcnt(2)
    v_max3_u32 v19, v32, v33, v34
    v_max_u32 v19, v19, v35
    v_cmp_eq_u32 vcc, -1, v19
    s_nop 0
    s_cbranch_vccnz g_42F13_2
    v_smfmac_f32_16x16x64_bf16 v[40:43], v[32:35], a[16:23], v172
    v_smfmac_f32_16x16x64_bf16 v[44:47], v[32:35], a[80:87], v172
    v_smfmac_f32_16x16x64_bf16 v[48:51], v[32:35], a[48:55], v172
    v_smfmac_f32_16x16x64_bf16 v[52:55], v[32:35], a[112:119], v172
g_42L9_3:
    s_waitcnt vmcnt(1)
    v_max3_u32 v19, v36, v37, v38
    v_max_u32 v19, v19, v39
    v_cmp_eq_u32 vcc, -1, v19
    s_nop 0
    s_cbranch_vccnz g_42F9_3
    v_smfmac_f32_16x16x64_bf16 v[40:43], v[36:39], a[24:31], v172
    v_smfmac_f32_16x16x64_bf16 v[44:47], v[36:39], a[88:95], v172
    v_smfmac_f32_16x16x64_bf16 v[48:51], v[36:39], a[56:63], v172
    v_smfmac_f32_16x16x64_bf16 v[52:55], v[36:39], a[120:127], v172
g_42L1_0:
    s_waitcnt vmcnt(0)
    v_max3_u32 v19, v24, v25, v26
    v_max_u32 v19, v19, v27
    v_cmp_eq_u32 vcc, -1, v19
    s_nop 0
    s_cbranch_vccnz g_42F1_0
    v_smfmac_f32_16x16x64_bf16 v[40:43], v[24:27], a[0:7], v172
    v_smfmac_f32_16x16x64_bf16 v[44:47], v[24:27], a[64:71], v172
    v_smfmac_f32_16x16x64_bf16 v[48:51], v[24:27], a[32:39], v172
    v_smfmac_f32_16x16x64_bf16 v[52:55], v[24:27], a[96:103], v172
    s_branch gc_43
g_42L15_2:
    s_waitcnt vmcnt(3)
    v_max3_u32 v19, v32, v33, v34
    v_max_u32 v19, v19, v35
    v_cmp_eq_u32 vcc, -1, v19
    s_nop 0
    s_cbranch_vccnz g_42F15_2
    v_smfmac_f32_16x16x64_bf16 v[40:43], v[32:35], a[16:23], v172
    v_smfmac_f32_16x16x64_bf16 v[44:47], v[32:35], a[80:87], v172
    v_smfmac_f32_16x16x64_bf16 v[48:51], v[32:35], a[48:55], v172
    v_smfmac_f32_16x16x64_bf16 v[52:55], v[32:35], a[112:119], v172
g_42L11_3:
    s_waitcnt vmcnt(2)
    v_max3_u32 v19, v36, v37, v38
    v_max_u32 v19, v19, v39
    v_cmp_eq_u32 vcc, -1, v19
    s_nop 0
    s_cbranch_vccnz g_42F11_3
    v_smfmac_f32_16x16x64_bf16 v[40:43], v[36:39], a[24:31], v172
    v_smfmac_f32_16x16x64_bf16 v[44:47], v[36:39], a[88:95], v172
    v_smfmac_f32_16x16x64_bf16 v[48:51], v[36:39], a[56:63], v172
    v_smfmac_f32_16x16x64_bf16 v[52:55], v[36:39], a[120:127], v172
g_42L3_0:
    s_waitcnt vmcnt(1)
    v_max3_u32 v19, v24, v25, v26
    v_max_u32 v19, v19, v27
    v_cmp_eq_u32 vcc, -1, v19
    s_nop 0
    s_cbranch_vccnz g_42F3_0
    v_smfmac_f32_16x16x64_bf16 v[40:43], v[24:27], a[0:7], v172
    v_smfmac_f32_16x16x64_bf16 v[44:47], v[24:27], a[64:71], v172
    v_smfmac_f32_16x16x64_bf16 v[48:51], v[24:27], a[32:39], v172
    v_smfmac_f32_16x16x64_bf16 v[52:55], v[24:27], a[96:103], v172
g_42L2_1:
    s_waitcnt vmcnt(0)
    v_max3_u32 v19, v28, v29, v30
    v_max_u32 v19, v19, v31
    v_cmp_eq_u32 vcc, -1, v19
    s_nop 0
    s_cbranch_vccnz g_42F2_1
    v_smfmac_f32_16x16x64_bf16 v[40:43], v[28:31], a[8:15], v172
    v_smfmac_f32_16x16x64_bf16 v[44:47], v[28:31], a[72:79], v172
    v_smfmac_f32_16x16x64_bf16 v[48:51], v[28:31], a[40:47], v172
    v_smfmac_f32_16x16x64_bf16 v[52:55], v[28:31], a[104:111], v172
    s_branch gc_43
g_42L15_3:
    s_waitcnt vmcnt(3)
    v_max3_u32 v19, v36, v37, v38
    v_max_u32 v19, v19, v39
    v_cmp_eq_u32 vcc, -1, v19
    s_nop 0
    s_cbranch_vccnz g_42F15_3
    v_smfmac_f32_16x16x64_bf16 v[40:43], v[36:39], a[24:31], v172
    v_smfmac_f32_16x16x64_bf16 v[44:47], v[36:39], a[88:95], v172
    v_smfmac_f32_16x16x64_bf16 v[48:51], v[36:39], a[56:63], v172
    v_smfmac_f32_16x16x64_bf16 v[52:55], v[36:39], a[120:127], v172
g_42L7_0:
    s_waitcnt vmcnt(2)
    v_max3_u32 v19, v24, v25, v26
    v_max_u32 v19, v19, v27
    v_cmp_eq_u32 vcc, -1, v19
    s_nop 0
    s_cbranch_vccnz g_42F7_0
    v_smfmac_f32_16x16x64_bf16 v[40:43], v[24:27], a[0:7], v172
    v_smfmac_f32_16x16x64_bf16 v[44:47], v[24:27], a[64:71], v172
    v_smfmac_f32_16x16x64_bf16 v[48:51], v[24:27], a[32:39], v172
    v_smfmac_f32_16x16x64_bf16 v[52:55], v[24:27], a[96:103], v172
g_42L6_1:
    s_waitcnt vmcnt(1)
    v_max3_u32 v19, v28, v29, v30
    v_max_u32 v19, v19, v31
    v_cmp_eq_u32 vcc, -1, v19
    s_nop 0
    s_cbranch_vccnz g_42F6_1
    v_smfmac_f32_16x16x64_bf16 v[40:43], v[28:31], a[8:15], v172
    v_smfmac_f32_16x16x64_bf16 v[44:47], v[28:31], a[72:79], v172
    v_smfmac_f32_16x16x64_bf16 v[48:51], v[28:31], a[40:47], v172
    v_smfmac_f32_16x16x64_bf16 v[52:55], v[28:31], a[104:111], v172
g_42L4_2:
    s_waitcnt vmcnt(0)
    v_max3_u32 v19, v32, v33, v34
    v_max_u32 v19, v19, v35
    v_cmp_eq_u32 vcc, -1, v19
    s_nop 0
    s_cbranch_vccnz g_42F4_2
    v_smfmac_f32_16x16x64_bf16 v[40:43], v[32:35], a[16:23], v172
    v_smfmac_f32_16x16x64_bf16 v[44:47], v[32:35], a[80:87], v172
    v_smfmac_f32_16x16x64_bf16 v[48:51], v[32:35], a[48:55], v172
    v_smfmac_f32_16x16x64_bf16 v[52:55], v[32:35], a[112:119], v172
    s_branch gc_43
g_42L7_1:
    s_waitcnt vmcnt(2)
    v_max3_u32 v19, v28, v29, v30
    v_max_u32 v19, v19, v31
    v_cmp_eq_u32 vcc, -1, v19
    s_nop 0
    s_cbranch_vccnz g_42F7_1
    v_smfmac_f32_16x16x64_bf16 v[40:43], v[28:31], a[8:15], v172
    v_smfmac_f32_16x16x64_bf16 v[44:47], v[28:31], a[72:79], v172
    v_smfmac_f32_16x16x64_bf16 v[48:51], v[28:31], a[40:47], v172
    v_smfmac_f32_16x16x64_bf16 v[52:55], v[28:31], a[104:111], v172
g_42L5_2:
    s_waitcnt vmcnt(1)
    v_max3_u32 v19, v32, v33, v34
    v_max_u32 v19, v19, v35
    v_cmp_eq_u32 vcc, -1, v19
    s_nop 0
    s_cbranch_vccnz g_42F5_2
    v_smfmac_f32_16x16x64_bf16 v[40:43], v[32:35], a[16:23], v172
    v_smfmac_f32_16x16x64_bf16 v[44:47], v[32:35], a[80:87], v172
    v_smfmac_f32_16x16x64_bf16 v[48:51], v[32:35], a[48:55], v172
    v_smfmac_f32_16x16x64_bf16 v[52:55], v[32:35], a[112:119], v172
    s_branch g_42L1_0
g_42L7_2:
    s_waitcnt vmcnt(2)
    v_max3_u32 v19, v32, v33, v34
    v_max_u32 v19, v19, v35
    v_cmp_eq_u32 vcc, -1, v19
    s_nop 0
    s_cbranch_vccnz g_42F7_2
    v_smfmac_f32_16x16x64_bf16 v[40:43], v[32:35], a[16:23], v172
    v_smfmac_f32_16x16x64_bf16 v[44:47], v[32:35], a[80:87], v172
    v_smfmac_f32_16x16x64_bf16 v[48:51], v[32:35], a[48:55], v172
    v_smfmac_f32_16x16x64_bf16 v[52:55], v[32:35], a[112:119], v172
    s_branch g_42L3_0
g_42L11_0:
    s_waitcnt vmcnt(2)
    v_max3_u32 v19, v24, v25, v26
    v_max_u32 v19, v19, v27
    v_cmp_eq_u32 vcc, -1, v19
    s_nop 0
    s_cbranch_vccnz g_42F11_0
    v_smfmac_f32_16x16x64_bf16 v[40:43], v[24:27], a[0:7], v172
    v_smfmac_f32_16x16x64_bf16 v[44:47], v[24:27], a[64:71], v172
    v_smfmac_f32_16x16x64_bf16 v[48:51], v[24:27], a[32:39], v172
    v_smfmac_f32_16x16x64_bf16 v[52:55], v[24:27], a[96:103], v172
g_42L10_1:
    s_waitcnt vmcnt(1)
    v_max3_u32 v19, v28, v29, v30
    v_max_u32 v19, v19, v31
    v_cmp_eq_u32 vcc, -1, v19
    s_nop 0
    s_cbranch_vccnz g_42F10_1
    v_smfmac_f32_16x16x64_bf16 v[40:43], v[28:31], a[8:15], v172
    v_smfmac_f32_16x16x64_bf16 v[44:47], v[28:31], a[72:79], v172
    v_smfmac_f32_16x16x64_bf16 v[48:51], v[28:31], a[40:47], v172
    v_smfmac_f32_16x16x64_bf16 v[52:55], v[28:31], a[104:111], v172
    s_branch g_42L8_3
g_42L11_1:
    s_waitcnt vmcnt(2)
    v_max3_u32 v19, v28, v29, v30
    v_max_u32 v19, v19, v31
    v_cmp_eq_u32 vcc, -1, v19
    s_nop 0
    s_cbranch_vccnz g_42F11_1
    v_smfmac_f32_16x16x64_bf16 v[40:43], v[28:31], a[8:15], v172
    v_smfmac_f32_16x16x64_bf16 v[44:47], v[28:31], a[72:79], v172
    v_smfmac_f32_16x16x64_bf16 v[48:51], v[28:31], a[40:47], v172
    v_smfmac_f32_16x16x64_bf16 v[52:55], v[28:31], a[104:111], v172
    s_branch g_42L9_3
g_42L13_0:
    s_waitcnt vmcnt(2)
    v_max3_u32 v19, v24, v25, v26
    v_max_u32 v19, v19, v27
    v_cmp_eq_u32 vcc, -1, v19
    s_nop 0
    s_cbranch_vccnz g_42F13_0
    v_smfmac_f32_16x16x64_bf16 v[40:43], v[24:27], a[0:7], v172
    v_smfmac_f32_16x16x64_bf16 v[44:47], v[24:27], a[64:71], v172
    v_smfmac_f32_16x16x64_bf16 v[48:51], v[24:27], a[32:39], v172
    v_smfmac_f32_16x16x64_bf16 v[52:55], v[24:27], a[96:103], v172
    s_branch g_42L12_2
g_42L13_3:
    s_waitcnt vmcnt(2)
    v_max3_u32 v19, v36, v37, v38
    v_max_u32 v19, v19, v39
    v_cmp_eq_u32 vcc, -1, v19
    s_nop 0
    s_cbranch_vccnz g_42F13_3
    v_smfmac_f32_16x16x64_bf16 v[40:43], v[36:39], a[24:31], v172
    v_smfmac_f32_16x16x64_bf16 v[44:47], v[36:39], a[88:95], v172
    v_smfmac_f32_16x16x64_bf16 v[48:51], v[36:39], a[56:63], v172
    v_smfmac_f32_16x16x64_bf16 v[52:55], v[36:39], a[120:127], v172
g_42L5_0:
    s_waitcnt vmcnt(1)
    v_max3_u32 v19, v24, v25, v26
    v_max_u32 v19, v19, v27
    v_cmp_eq_u32 vcc, -1, v19
    s_nop 0
    s_cbranch_vccnz g_42F5_0
    v_smfmac_f32_16x16x64_bf16 v[40:43], v[24:27], a[0:7], v172
    v_smfmac_f32_16x16x64_bf16 v[44:47], v[24:27], a[64:71], v172
    v_smfmac_f32_16x16x64_bf16 v[48:51], v[24:27], a[32:39], v172
    v_smfmac_f32_16x16x64_bf16 v[52:55], v[24:27], a[96:103], v172
    s_branch g_42L4_2
g_42L14_2:
    s_waitcnt vmcnt(2)
    v_max3_u32 v19, v32, v33, v34
    v_max_u32 v19, v19, v35
    v_cmp_eq_u32 vcc, -1, v19
    s_nop 0
    s_cbranch_vccnz g_42F14_2
    v_smfmac_f32_16x16x64_bf16 v[40:43], v[32:35], a[16:23], v172
    v_smfmac_f32_16x16x64_bf16 v[44:47], v[32:35], a[80:87], v172
    v_smfmac_f32_16x16x64_bf16 v[48:51], v[32:35], a[48:55], v172
    v_smfmac_f32_16x16x64_bf16 v[52:55], v[32:35], a[112:119], v172
g_42L10_3:
    s_waitcnt vmcnt(1)
    v_max3_u32 v19, v36, v37, v38
    v_max_u32 v19, v19, v39
    v_cmp_eq_u32 vcc, -1, v19
    s_nop 0
    s_cbranch_vccnz g_42F10_3
    v_smfmac_f32_16x16x64_bf16 v[40:43], v[36:39], a[24:31], v172
    v_smfmac_f32_16x16x64_bf16 v[44:47], v[36:39], a[88:95], v172
    v_smfmac_f32_16x16x64_bf16 v[48:51], v[36:39], a[56:63], v172
    v_smfmac_f32_16x16x64_bf16 v[52:55], v[36:39], a[120:127], v172
    s_branch g_42L2_1
g_42L14_3:
    s_waitcnt vmcnt(2)
    v_max3_u32 v19, v36, v37, v38
    v_max_u32 v19, v19, v39
    v_cmp_eq_u32 vcc, -1, v19
    s_nop 0
    s_cbranch_vccnz g_42F14_3
    v_smfmac_f32_16x16x64_bf16 v[40:43], v[36:39], a[24:31], v172
    v_smfmac_f32_16x16x64_bf16 v[44:47], v[36:39], a[88:95], v172
    v_smfmac_f32_16x16x64_bf16 v[48:51], v[36:39], a[56:63], v172
    v_smfmac_f32_16x16x64_bf16 v[52:55], v[36:39], a[120:127], v172
    s_branch g_42L6_1
g_42L3_1:
    s_waitcnt vmcnt(1)
    v_max3_u32 v19, v28, v29, v30
    v_max_u32 v19, v19, v31
    v_cmp_eq_u32 vcc, -1, v19
    s_nop 0
    s_cbranch_vccnz g_42F3_1
    v_smfmac_f32_16x16x64_bf16 v[40:43], v[28:31], a[8:15], v172
    v_smfmac_f32_16x16x64_bf16 v[44:47], v[28:31], a[72:79], v172
    v_smfmac_f32_16x16x64_bf16 v[48:51], v[28:31], a[40:47], v172
    v_smfmac_f32_16x16x64_bf16 v[52:55], v[28:31], a[104:111], v172
    s_branch g_42L1_0
g_42L6_2:
    s_waitcnt vmcnt(1)
    v_max3_u32 v19, v32, v33, v34
    v_max_u32 v19, v19, v35
    v_cmp_eq_u32 vcc, -1, v19
    s_nop 0
    s_cbranch_vccnz g_42F6_2
    v_smfmac_f32_16x16x64_bf16 v[40:43], v[32:35], a[16:23], v172
    v_smfmac_f32_16x16x64_bf16 v[44:47], v[32:35], a[80:87], v172
    v_smfmac_f32_16x16x64_bf16 v[48:51], v[32:35], a[48:55], v172
    v_smfmac_f32_16x16x64_bf16 v[52:55], v[32:35], a[112:119], v172
    s_branch g_42L2_1
g_42L9_0:
    s_waitcnt vmcnt(1)
    v_max3_u32 v19, v24, v25, v26
    v_max_u32 v19, v19, v27
    v_cmp_eq_u32 vcc, -1, v19
    s_nop 0
    s_cbranch_vccnz g_42F9_0
    v_smfmac_f32_16x16x64_bf16 v[40:43], v[24:27], a[0:7], v172
    v_smfmac_f32_16x16x64_bf16 v[44:47], v[24:27], a[64:71], v172
    v_smfmac_f32_16x16x64_bf16 v[48:51], v[24:27], a[32:39], v172
    v_smfmac_f32_16x16x64_bf16 v[52:55], v[24:27], a[96:103], v172
    s_branch g_42L8_3
g_42L12_3:
    s_waitcnt vmcnt(1)
    v_max3_u32 v19, v36, v37, v38
    v_max_u32 v19, v19, v39
    v_cmp_eq_u32 vcc, -1, v19
    s_nop 0
    s_cbranch_vccnz g_42F12_3
    v_smfmac_f32_16x16x64_bf16 v[40:43], v[36:39], a[24:31], v172
    v_smfmac_f32_16x16x64_bf16 v[44:47], v[36:39], a[88:95], v172
    v_smfmac_f32_16x16x64_bf16 v[48:51], v[36:39], a[56:63], v172
    v_smfmac_f32_16x16x64_bf16 v[52:55], v[36:39], a[120:127], v172
    s_branch g_42L4_2
g_42F15_0:
    s_mov_b64 exec, vcc
    buffer_load_dwordx4 v[24:27], v2, s[4:7], s16 offen offset:0 sc1
    s_mov_b64 exec, -1
    s_add_u32 s23, s23, 1
    s_cmp_lt_u32 s23, 200000
    s_cbranch_scc1 g_42L15_1
    s_mov_b32 s25, 200000
    s_branch gc_43
g_42F15_1:
    s_mov_b64 exec, vcc
    buffer_load_dwordx4 v[28:31], v2, s[4:7], s16 offen offset:1024 sc1
    s_mov_b64 exec, -1
    s_add_u32 s23, s23, 1
    s_cmp_lt_u32 s23, 200000
    s_cbranch_scc1 g_42L15_2
    s_mov_b32 s25, 200000
    s_branch gc_43
g_42F15_2:
    s_mov_b64 exec, vcc
    buffer_load_dwordx4 v[32:35], v2, s[4:7], s16 offen offset:2048 sc1
    s_mov_b64 exec, -1
    s_add_u32 s23, s23, 1
    s_cmp_lt_u32 s23, 200000
    s_cbranch_scc1 g_42L15_3
    s_mov_b32 s25, 200000
    s_branch gc_43
g_42F15_3:
    s_mov_b64 exec, vcc
    buffer_load_dwordx4 v[36:39], v2, s[4:7], s16 offen offset:3072 sc1
    s_mov_b64 exec, -1
    s_add_u32 s23, s23, 1
    s_cmp_lt_u32 s23, 200000
    s_cbranch_scc1 g_42L15_0
    s_mov_b32 s25, 200000
    s_branch gc_43
g_42F7_0:
    s_mov_b64 exec, vcc
    buffer_load_dwordx4 v[24:27], v2, s[4:7], s16 offen offset:0 sc1
    s_mov_b64 exec, -1
    s_add_u32 s23, s23, 1
    s_cmp_lt_u32 s23, 200000
    s_cbranch_scc1 g_42L7_1
    s_mov_b32 s25, 200000
    s_branch gc_43
g_42F7_1:
    s_mov_b64 exec, vcc
    buffer_load_dwordx4 v[28:31], v2, s[4:7], s16 offen offset:1024 sc1
    s_mov_b64 exec, -1
    s_add_u32 s23, s23, 1
    s_cmp_lt_u32 s23, 200000
    s_cbranch_scc1 g_42L7_2
    s_mov_b32 s25, 200000
    s_branch gc_43
g_42F7_2:
    s_mov_b64 exec, vcc
    buffer_load_dwordx4 v[32:35], v2, s[4:7], s16 offen offset:2048 sc1
    s_mov_b64 exec, -1
    s_add_u32 s23, s23, 1
    s_cmp_lt_u32 s23, 200000
    s_cbranch_scc1 g_42L7_0
    s_mov_b32 s25, 200000
    s_branch gc_43
g_42F11_0:
    s_mov_b64 exec, vcc
    buffer_load_dwordx4 v[24:27], v2, s[4:7], s16 offen offset:0 sc1
    s_mov_b64 exec, -1
    s_add_u32 s23, s23, 1
    s_cmp_lt_u32 s23, 200000
    s_cbranch_scc1 g_42L11_1
    s_mov_b32 s25, 200000
    s_branch gc_43
g_42F11_1:
    s_mov_b64 exec, vcc
    buffer_load_dwordx4 v[28:31], v2, s[4:7], s16 offen offset:1024 sc1
    s_mov_b64 exec, -1
    s_add_u32 s23, s23, 1
    s_cmp_lt_u32 s23, 200000
    s_cbranch_scc1 g_42L11_3
    s_mov_b32 s25, 200000
    s_branch gc_43
g_42F11_3:
    s_mov_b64 exec, vcc
    buffer_load_dwordx4 v[36:39], v2, s[4:7], s16 offen offset:3072 sc1
    s_mov_b64 exec, -1
    s_add_u32 s23, s23, 1
    s_cmp_lt_u32 s23, 200000
    s_cbranch_scc1 g_42L11_0
    s_mov_b32 s25, 200000
    s_branch gc_43
g_42F13_0:
    s_mov_b64 exec, vcc
    buffer_load_dwordx4 v[24:27], v2, s[4:7], s16 offen offset:0 sc1
    s_mov_b64 exec, -1
    s_add_u32 s23, s23, 1
    s_cmp_lt_u32 s23, 200000
    s_cbranch_scc1 g_42L13_2
    s_mov_b32 s25, 200000
    s_branch gc_43
g_42F13_2:
    s_mov_b64 exec, vcc
    buffer_load_dwordx4 v[32:35], v2, s[4:7], s16 offen offset:2048 sc1
    s_mov_b64 exec, -1
    s_add_u32 s23, s23, 1
    s_cmp_lt_u32 s23, 200000
    s_cbranch_scc1 g_42L13_3
    s_mov_b32 s25, 200000
    s_branch gc_43
g_42F13_3:
    s_mov_b64 exec, vcc
    buffer_load_dwordx4 v[36:39], v2, s[4:7], s16 offen offset:3072 sc1
    s_mov_b64 exec, -1
    s_add_u32 s23, s23, 1
    s_cmp_lt_u32 s23, 200000
    s_cbranch_scc1 g_42L13_0
    s_mov_b32 s25, 200000
    s_branch gc_43
g_42F14_1:
    s_mov_b64 exec, vcc
    buffer_load_dwordx4 v[28:31], v2, s[4:7], s16 offen offset:1024 sc1
    s_mov_b64 exec, -1
    s_add_u32 s23, s23, 1
    s_cmp_lt_u32 s23, 200000
    s_cbranch_scc1 g_42L14_2
    s_mov_b32 s25, 200000
    s_branch gc_43
g_42F14_2:
    s_mov_b64 exec, vcc
    buffer_load_dwordx4 v[32:35], v2, s[4:7], s16 offen offset:2048 sc1
    s_mov_b64 exec, -1
    s_add_u32 s23, s23, 1
    s_cmp_lt_u32 s23, 200000
    s_cbranch_scc1 g_42L14_3
    s_mov_b32 s25, 200000
    s_branch gc_43
g_42F14_3:
    s_mov_b64 exec, vcc
    buffer_load_dwordx4 v[36:39], v2, s[4:7], s16 offen offset:3072 sc1
    s_mov_b64 exec, -1
    s_add_u32 s23, s23, 1
    s_cmp_lt_u32 s23, 200000
    s_cbranch_scc1 g_42L14_1
    s_mov_b32 s25, 200000
    s_branch gc_43
g_42F3_0:
    s_mov_b64 exec, vcc
    buffer_load_dwordx4 v[24:27], v2, s[4:7], s16 offen offset:0 sc1
    s_mov_b64 exec, -1
    s_add_u32 s23, s23, 1
    s_cmp_lt_u32 s23, 200000
    s_cbranch_scc1 g_42L3_1
    s_mov_b32 s25, 200000
    s_branch gc_43
g_42F3_1:
    s_mov_b64 exec, vcc
    buffer_load_dwordx4 v[28:31], v2, s[4:7], s16 offen offset:1024 sc1
    s_mov_b64 exec, -1
    s_add_u32 s23, s23, 1
    s_cmp_lt_u32 s23, 200000
    s_cbranch_scc1 g_42L3_0
    s_mov_b32 s25, 200000
    s_branch gc_43
g_42F5_0:
    s_mov_b64 exec, vcc
    buffer_load_dwordx4 v[24:27], v2, s[4:7], s16 offen offset:0 sc1
    s_mov_b64 exec, -1
    s_add_u32 s23, s23, 1
    s_cmp_lt_u32 s23, 200000
    s_cbranch_scc1 g_42L5_2
    s_mov_b32 s25, 200000
    s_branch gc_43
g_42F5_2:
    s_mov_b64 exec, vcc
    buffer_load_dwordx4 v[32:35], v2, s[4:7], s16 offen offset:2048 sc1
    s_mov_b64 exec, -1
    s_add_u32 s23, s23, 1
    s_cmp_lt_u32 s23, 200000
    s_cbranch_scc1 g_42L5_0
    s_mov_b32 s25, 200000
    s_branch gc_43
g_42F6_1:
    s_mov_b64 exec, vcc
    buffer_load_dwordx4 v[28:31], v2, s[4:7], s16 offen offset:1024 sc1
    s_mov_b64 exec, -1
    s_add_u32 s23, s23, 1
    s_cmp_lt_u32 s23, 200000
    s_cbranch_scc1 g_42L6_2
    s_mov_b32 s25, 200000
    s_branch gc_43
g_42F6_2:
    s_mov_b64 exec, vcc
    buffer_load_dwordx4 v[32:35], v2, s[4:7], s16 offen offset:2048 sc1
    s_mov_b64 exec, -1
    s_add_u32 s23, s23, 1
    s_cmp_lt_u32 s23, 200000
    s_cbranch_scc1 g_42L6_1
    s_mov_b32 s25, 200000
    s_branch gc_43
g_42F9_0:
    s_mov_b64 exec, vcc
    buffer_load_dwordx4 v[24:27], v2, s[4:7], s16 offen offset:0 sc1
    s_mov_b64 exec, -1
    s_add_u32 s23, s23, 1
    s_cmp_lt_u32 s23, 200000
    s_cbranch_scc1 g_42L9_3
    s_mov_b32 s25, 200000
    s_branch gc_43
g_42F9_3:
    s_mov_b64 exec, vcc
    buffer_load_dwordx4 v[36:39], v2, s[4:7], s16 offen offset:3072 sc1
    s_mov_b64 exec, -1
    s_add_u32 s23, s23, 1
    s_cmp_lt_u32 s23, 200000
    s_cbranch_scc1 g_42L9_0
    s_mov_b32 s25, 200000
    s_branch gc_43
g_42F10_1:
    s_mov_b64 exec, vcc
    buffer_load_dwordx4 v[28:31], v2, s[4:7], s16 offen offset:1024 sc1
    s_mov_b64 exec, -1
    s_add_u32 s23, s23, 1
    s_cmp_lt_u32 s23, 200000
    s_cbranch_scc1 g_42L10_3
    s_mov_b32 s25, 200000
    s_branch gc_43
g_42F10_3:
    s_mov_b64 exec, vcc
    buffer_load_dwordx4 v[36:39], v2, s[4:7], s16 offen offset:3072 sc1
    s_mov_b64 exec, -1
    s_add_u32 s23, s23, 1
    s_cmp_lt_u32 s23, 200000
    s_cbranch_scc1 g_42L10_1
    s_mov_b32 s25, 200000
    s_branch gc_43
g_42F12_2:
    s_mov_b64 exec, vcc
    buffer_load_dwordx4 v[32:35], v2, s[4:7], s16 offen offset:2048 sc1
    s_mov_b64 exec, -1
    s_add_u32 s23, s23, 1
    s_cmp_lt_u32 s23, 200000
    s_cbranch_scc1 g_42L12_3
    s_mov_b32 s25, 200000
    s_branch gc_43
g_42F12_3:
    s_mov_b64 exec, vcc
    buffer_load_dwordx4 v[36:39], v2, s[4:7], s16 offen offset:3072 sc1
    s_mov_b64 exec, -1
    s_add_u32 s23, s23, 1
    s_cmp_lt_u32 s23, 200000
    s_cbranch_scc1 g_42L12_2
    s_mov_b32 s25, 200000
    s_branch gc_43
g_42F1_0:
    s_mov_b64 exec, vcc
    buffer_load_dwordx4 v[24:27], v2, s[4:7], s16 offen offset:0 sc1
    s_mov_b64 exec, -1
    s_add_u32 s23, s23, 1
    s_cmp_lt_u32 s23, 200000
    s_cbranch_scc1 g_42L1_0
    s_mov_b32 s25, 200000
    s_branch gc_43
g_42F2_1:
    s_mov_b64 exec, vcc
    buffer_load_dwordx4 v[28:31], v2, s[4:7], s16 offen offset:1024 sc1
    s_mov_b64 exec, -1
    s_add_u32 s23, s23, 1
    s_cmp_lt_u32 s23, 200000
    s_cbranch_scc1 g_42L2_1
    s_mov_b32 s25, 200000
    s_branch gc_43
g_42F4_2:
    s_mov_b64 exec, vcc
    buffer_load_dwordx4 v[32:35], v2, s[4:7], s16 offen offset:2048 sc1
    s_mov_b64 exec, -1
    s_add_u32 s23, s23, 1
    s_cmp_lt_u32 s23, 200000
    s_cbranch_scc1 g_42L4_2
    s_mov_b32 s25, 200000
    s_branch gc_43
g_42F8_3:
    s_mov_b64 exec, vcc
    buffer_load_dwordx4 v[36:39], v2, s[4:7], s16 offen offset:3072 sc1
    s_mov_b64 exec, -1
    s_add_u32 s23, s23, 1
    s_cmp_lt_u32 s23, 200000
    s_cbranch_scc1 g_42L8_3
    s_mov_b32 s25, 200000
    s_branch gc_43
recur_fast_last2:
    buffer_store_dwordx4 v[168:171], v15, s[4:7], s20 offen sc1
    s_branch recur_end
g_44L15_0:
    s_waitcnt vmcnt(3)
    v_max3_u32 v19, v24, v25, v26
    v_max_u32 v19, v19, v27
    v_cmp_eq_u32 vcc, -1, v19
    s_nop 0
    s_cbranch_vccnz g_44F15_0
    v_smfmac_f32_16x16x64_bf16 v[64:67], v[24:27], a[192:199], v172
    v_smfmac_f32_16x16x64_bf16 v[68:71], v[24:27], a[224:231], v172
g_44L14_1:
    s_waitcnt vmcnt(2)
    v_max3_u32 v19, v28, v29, v30
    v_max_u32 v19, v19, v31
    v_cmp_eq_u32 vcc, -1, v19
    s_nop 0
    s_cbranch_vccnz g_44F14_1
    v_smfmac_f32_16x16x64_bf16 v[64:67], v[28:31], a[200:207], v172
    v_smfmac_f32_16x16x64_bf16 v[68:71], v[28:31], a[232:239], v172
g_44L12_2:
    s_waitcnt vmcnt(1)
    v_max3_u32 v19, v32, v33, v34
    v_max_u32 v19, v19, v35
    v_cmp_eq_u32 vcc, -1, v19
    s_nop 0
    s_cbranch_vccnz g_44F12_2
    v_smfmac_f32_16x16x64_bf16 v[64:67], v[32:35], a[208:215], v172
    v_smfmac_f32_16x16x64_bf16 v[68:71], v[32:35], a[240:247], v172
g_44L8_3:
    s_waitcnt vmcnt(0)
    v_max3_u32 v19, v36, v37, v38
    v_max_u32 v19, v19, v39
    v_cmp_eq_u32 vcc, -1, v19
    s_nop 0
    s_cbranch_vccnz g_44F8_3
    v_smfmac_f32_16x16x64_bf16 v[64:67], v[36:39], a[216:223], v172
    v_smfmac_f32_16x16x64_bf16 v[68:71], v[36:39], a[248:255], v172
    s_nop 4
    v_cvt_pk_bf16_f32 v80, v64, v65
    v_cvt_pk_bf16_f32 v81, v66, v67
    s_nop 0
    v_cvt_pk_bf16_f32 v82, v68, v69
    v_cvt_pk_bf16_f32 v83, v70, v71
    ds_write_b128 v17, v[80:83] offset:9216
    s_branch gc_45
g_44L15_1:
    s_waitcnt vmcnt(3)
    v_max3_u32 v19, v28, v29, v30
    v_max_u32 v19, v19, v31
    v_cmp_eq_u32 vcc, -1, v19
    s_nop 0
    s_cbranch_vccnz g_44F15_1
    v_smfmac_f32_16x16x64_bf16 v[64:67], v[28:31], a[200:207], v172
    v_smfmac_f32_16x16x64_bf16 v[68:71], v[28:31], a[232:239], v172
g_44L13_2:
    s_waitcnt vmcnt(2)
    v_max3_u32 v19, v32, v33, v34
    v_max_u32 v19, v19, v35
    v_cmp_eq_u32 vcc, -1, v19
    s_nop 0
    s_cbranch_vccnz g_44F13_2
    v_smfmac_f32_16x16x64_bf16 v[64:67], v[32:35], a[208:215], v172
    v_smfmac_f32_16x16x64_bf16 v[68:71], v[32:35], a[240:247], v172
g_44L9_3:
    s_waitcnt vmcnt(1)
    v_max3_u32 v19, v36, v37, v38
    v_max_u32 v19, v19, v39
    v_cmp_eq_u32 vcc, -1, v19
    s_nop 0
    s_cbranch_vccnz g_44F9_3
    v_smfmac_f32_16x16x64_bf16 v[64:67], v[36:39], a[216:223], v172
    v_smfmac_f32_16x16x64_bf16 v[68:71], v[36:39], a[248:255], v172
g_44L1_0:
    s_waitcnt vmcnt(0)
    v_max3_u32 v19, v24, v25, v26
    v_max_u32 v19, v19, v27
    v_cmp_eq_u32 vcc, -1, v19
    s_nop 0
    s_cbranch_vccnz g_44F1_0
    v_smfmac_f32_16x16x64_bf16 v[64:67], v[24:27], a[192:199], v172
    v_smfmac_f32_16x16x64_bf16 v[68:71], v[24:27], a[224:231], v172
    s_nop 4
    v_cvt_pk_bf16_f32 v80, v64, v65
    v_cvt_pk_bf16_f32 v81, v66, v67
    s_nop 0
    v_cvt_pk_bf16_f32 v82, v68, v69
    v_cvt_pk_bf16_f32 v83, v70, v71
    ds_write_b128 v17, v[80:83] offset:9216
    s_branch gc_45
g_44L15_2:
    s_waitcnt vmcnt(3)
    v_max3_u32 v19, v32, v33, v34
    v_max_u32 v19, v19, v35
    v_cmp_eq_u32 vcc, -1, v19
    s_nop 0
    s_cbranch_vccnz g_44F15_2
    v_smfmac_f32_16x16x64_bf16 v[64:67], v[32:35], a[208:215], v172
    v_smfmac_f32_16x16x64_bf16 v[68:71], v[32:35], a[240:247], v172
g_44L11_3:
    s_waitcnt vmcnt(2)
    v_max3_u32 v19, v36, v37, v38
    v_max_u32 v19, v19, v39
    v_cmp_eq_u32 vcc, -1, v19
    s_nop 0
    s_cbranch_vccnz g_44F11_3
    v_smfmac_f32_16x16x64_bf16 v[64:67], v[36:39], a[216:223], v172
    v_smfmac_f32_16x16x64_bf16 v[68:71], v[36:39], a[248:255], v172
g_44L3_0:
    s_waitcnt vmcnt(1)
    v_max3_u32 v19, v24, v25, v26
    v_max_u32 v19, v19, v27
    v_cmp_eq_u32 vcc, -1, v19
    s_nop 0
    s_cbranch_vccnz g_44F3_0
    v_smfmac_f32_16x16x64_bf16 v[64:67], v[24:27], a[192:199], v172
    v_smfmac_f32_16x16x64_bf16 v[68:71], v[24:27], a[224:231], v172
g_44L2_1:
    s_waitcnt vmcnt(0)
    v_max3_u32 v19, v28, v29, v30
    v_max_u32 v19, v19, v31
    v_cmp_eq_u32 vcc, -1, v19
    s_nop 0
    s_cbranch_vccnz g_44F2_1
    v_smfmac_f32_16x16x64_bf16 v[64:67], v[28:31], a[200:207], v172
    v_smfmac_f32_16x16x64_bf16 v[68:71], v[28:31], a[232:239], v172
    s_nop 4
    v_cvt_pk_bf16_f32 v80, v64, v65
    v_cvt_pk_bf16_f32 v81, v66, v67
    s_nop 0
    v_cvt_pk_bf16_f32 v82, v68, v69
    v_cvt_pk_bf16_f32 v83, v70, v71
    ds_write_b128 v17, v[80:83] offset:9216
    s_branch gc_45
g_44L15_3:
    s_waitcnt vmcnt(3)
    v_max3_u32 v19, v36, v37, v38
    v_max_u32 v19, v19, v39
    v_cmp_eq_u32 vcc, -1, v19
    s_nop 0
    s_cbranch_vccnz g_44F15_3
    v_smfmac_f32_16x16x64_bf16 v[64:67], v[36:39], a[216:223], v172
    v_smfmac_f32_16x16x64_bf16 v[68:71], v[36:39], a[248:255], v172
g_44L7_0:
    s_waitcnt vmcnt(2)
    v_max3_u32 v19, v24, v25, v26
    v_max_u32 v19, v19, v27
    v_cmp_eq_u32 vcc, -1, v19
    s_nop 0
    s_cbranch_vccnz g_44F7_0
    v_smfmac_f32_16x16x64_bf16 v[64:67], v[24:27], a[192:199], v172
    v_smfmac_f32_16x16x64_bf16 v[68:71], v[24:27], a[224:231], v172
g_44L6_1:
    s_waitcnt vmcnt(1)
    v_max3_u32 v19, v28, v29, v30
    v_max_u32 v19, v19, v31
    v_cmp_eq_u32 vcc, -1, v19
    s_nop 0
    s_cbranch_vccnz g_44F6_1
    v_smfmac_f32_16x16x64_bf16 v[64:67], v[28:31], a[200:207], v172
    v_smfmac_f32_16x16x64_bf16 v[68:71], v[28:31], a[232:239], v172
g_44L4_2:
    s_waitcnt vmcnt(0)
    v_max3_u32 v19, v32, v33, v34
    v_max_u32 v19, v19, v35
    v_cmp_eq_u32 vcc, -1, v19
    s_nop 0
    s_cbranch_vccnz g_44F4_2
    v_smfmac_f32_16x16x64_bf16 v[64:67], v[32:35], a[208:215], v172
    v_smfmac_f32_16x16x64_bf16 v[68:71], v[32:35], a[240:247], v172
    s_nop 4
    v_cvt_pk_bf16_f32 v80, v64, v65
    v_cvt_pk_bf16_f32 v81, v66, v67
    s_nop 0
    v_cvt_pk_bf16_f32 v82, v68, v69
    v_cvt_pk_bf16_f32 v83, v70, v71
    ds_write_b128 v17, v[80:83] offset:9216
    s_branch gc_45
g_44L7_1:
    s_waitcnt vmcnt(2)
    v_max3_u32 v19, v28, v29, v30
    v_max_u32 v19, v19, v31
    v_cmp_eq_u32 vcc, -1, v19
    s_nop 0
    s_cbranch_vccnz g_44F7_1
    v_smfmac_f32_16x16x64_bf16 v[64:67], v[28:31], a[200:207], v172
    v_smfmac_f32_16x16x64_bf16 v[68:71], v[28:31], a[232:239], v172
g_44L5_2:
    s_waitcnt vmcnt(1)
    v_max3_u32 v19, v32, v33, v34
    v_max_u32 v19, v19, v35
    v_cmp_eq_u32 vcc, -1, v19
    s_nop 0
    s_cbranch_vccnz g_44F5_2
    v_smfmac_f32_16x16x64_bf16 v[64:67], v[32:35], a[208:215], v172
    v_smfmac_f32_16x16x64_bf16 v[68:71], v[32:35], a[240:247], v172
    s_branch g_44L1_0
g_44L7_2:
    s_waitcnt vmcnt(2)
    v_max3_u32 v19, v32, v33, v34
    v_max_u32 v19, v19, v35
    v_cmp_eq_u32 vcc, -1, v19
    s_nop 0
    s_cbranch_vccnz g_44F7_2
    v_smfmac_f32_16x16x64_bf16 v[64:67], v[32:35], a[208:215], v172
    v_smfmac_f32_16x16x64_bf16 v[68:71], v[32:35], a[240:247], v172
    s_branch g_44L3_0
g_44L11_0:
    s_waitcnt vmcnt(2)
    v_max3_u32 v19, v24, v25, v26
    v_max_u32 v19, v19, v27
    v_cmp_eq_u32 vcc, -1, v19
    s_nop 0
    s_cbranch_vccnz g_44F11_0
    v_smfmac_f32_16x16x64_bf16 v[64:67], v[24:27], a[192:199], v172
    v_smfmac_f32_16x16x64_bf16 v[68:71], v[24:27], a[224:231], v172
g_44L10_1:
    s_waitcnt vmcnt(1)
    v_max3_u32 v19, v28, v29, v30
    v_max_u32 v19, v19, v31
    v_cmp_eq_u32 vcc, -1, v19
    s_nop 0
    s_cbranch_vccnz g_44F10_1
    v_smfmac_f32_16x16x64_bf16 v[64:67], v[28:31], a[200:207], v172
    v_smfmac_f32_16x16x64_bf16 v[68:71], v[28:31], a[232:239], v172
    s_branch g_44L8_3
g_44L11_1:
    s_waitcnt vmcnt(2)
    v_max3_u32 v19, v28, v29, v30
    v_max_u32 v19, v19, v31
    v_cmp_eq_u32 vcc, -1, v19
    s_nop 0
    s_cbranch_vccnz g_44F11_1
    v_smfmac_f32_16x16x64_bf16 v[64:67], v[28:31], a[200:207], v172
    v_smfmac_f32_16x16x64_bf16 v[68:71], v[28:31], a[232:239], v172
    s_branch g_44L9_3
g_44L13_0:
    s_waitcnt vmcnt(2)
    v_max3_u32 v19, v24, v25, v26
    v_max_u32 v19, v19, v27
    v_cmp_eq_u32 vcc, -1, v19
    s_nop 0
    s_cbranch_vccnz g_44F13_0
    v_smfmac_f32_16x16x64_bf16 v[64:67], v[24:27], a[192:199], v172
    v_smfmac_f32_16x16x64_bf16 v[68:71], v[24:27], a[224:231], v172
    s_branch g_44L12_2
g_44L13_3:
    s_waitcnt vmcnt(2)
    v_max3_u32 v19, v36, v37, v38
    v_max_u32 v19, v19, v39
    v_cmp_eq_u32 vcc, -1, v19
    s_nop 0
    s_cbranch_vccnz g_44F13_3
    v_smfmac_f32_16x16x64_bf16 v[64:67], v[36:39], a[216:223], v172
    v_smfmac_f32_16x16x64_bf16 v[68:71], v[36:39], a[248:255], v172
g_44L5_0:
    s_waitcnt vmcnt(1)
    v_max3_u32 v19, v24, v25, v26
    v_max_u32 v19, v19, v27
    v_cmp_eq_u32 vcc, -1, v19
    s_nop 0
    s_cbranch_vccnz g_44F5_0
    v_smfmac_f32_16x16x64_bf16 v[64:67], v[24:27], a[192:199], v172
    v_smfmac_f32_16x16x64_bf16 v[68:71], v[24:27], a[224:231], v172
    s_branch g_44L4_2
g_44L14_2:
    s_waitcnt vmcnt(2)
    v_max3_u32 v19, v32, v33, v34
    v_max_u32 v19, v19, v35
    v_cmp_eq_u32 vcc, -1, v19
    s_nop 0
    s_cbranch_vccnz g_44F14_2
    v_smfmac_f32_16x16x64_bf16 v[64:67], v[32:35], a[208:215], v172
    v_smfmac_f32_16x16x64_bf16 v[68:71], v[32:35], a[240:247], v172
g_44L10_3:
    s_waitcnt vmcnt(1)
    v_max3_u32 v19, v36, v37, v38
    v_max_u32 v19, v19, v39
    v_cmp_eq_u32 vcc, -1, v19
    s_nop 0
    s_cbranch_vccnz g_44F10_3
    v_smfmac_f32_16x16x64_bf16 v[64:67], v[36:39], a[216:223], v172
    v_smfmac_f32_16x16x64_bf16 v[68:71], v[36:39], a[248:255], v172
    s_branch g_44L2_1
g_44L14_3:
    s_waitcnt vmcnt(2)
    v_max3_u32 v19, v36, v37, v38
    v_max_u32 v19, v19, v39
    v_cmp_eq_u32 vcc, -1, v19
    s_nop 0
    s_cbranch_vccnz g_44F14_3
    v_smfmac_f32_16x16x64_bf16 v[64:67], v[36:39], a[216:223], v172
    v_smfmac_f32_16x16x64_bf16 v[68:71], v[36:39], a[248:255], v172
    s_branch g_44L6_1
g_44L3_1:
    s_waitcnt vmcnt(1)
    v_max3_u32 v19, v28, v29, v30
    v_max_u32 v19, v19, v31
    v_cmp_eq_u32 vcc, -1, v19
    s_nop 0
    s_cbranch_vccnz g_44F3_1
    v_smfmac_f32_16x16x64_bf16 v[64:67], v[28:31], a[200:207], v172
    v_smfmac_f32_16x16x64_bf16 v[68:71], v[28:31], a[232:239], v172
    s_branch g_44L1_0
g_44L6_2:
    s_waitcnt vmcnt(1)
    v_max3_u32 v19, v32, v33, v34
    v_max_u32 v19, v19, v35
    v_cmp_eq_u32 vcc, -1, v19
    s_nop 0
    s_cbranch_vccnz g_44F6_2
    v_smfmac_f32_16x16x64_bf16 v[64:67], v[32:35], a[208:215], v172
    v_smfmac_f32_16x16x64_bf16 v[68:71], v[32:35], a[240:247], v172
    s_branch g_44L2_1
g_44L9_0:
    s_waitcnt vmcnt(1)
    v_max3_u32 v19, v24, v25, v26
    v_max_u32 v19, v19, v27
    v_cmp_eq_u32 vcc, -1, v19
    s_nop 0
    s_cbranch_vccnz g_44F9_0
    v_smfmac_f32_16x16x64_bf16 v[64:67], v[24:27], a[192:199], v172
    v_smfmac_f32_16x16x64_bf16 v[68:71], v[24:27], a[224:231], v172
    s_branch g_44L8_3
g_44L12_3:
    s_waitcnt vmcnt(1)
    v_max3_u32 v19, v36, v37, v38
    v_max_u32 v19, v19, v39
    v_cmp_eq_u32 vcc, -1, v19
    s_nop 0
    s_cbranch_vccnz g_44F12_3
    v_smfmac_f32_16x16x64_bf16 v[64:67], v[36:39], a[216:223], v172
    v_smfmac_f32_16x16x64_bf16 v[68:71], v[36:39], a[248:255], v172
    s_branch g_44L4_2
g_44F15_0:
    s_mov_b64 exec, vcc
    buffer_load_dwordx4 v[24:27], v8, s[4:7], s16 offen offset:0 sc1
    s_mov_b64 exec, -1
    s_add_u32 s23, s23, 1
    s_cmp_lt_u32 s23, 200000
    s_cbranch_scc1 g_44L15_1
    s_mov_b32 s25, 200000
    s_branch gc_45
g_44F15_1:
    s_mov_b64 exec, vcc
    buffer_load_dwordx4 v[28:31], v8, s[4:7], s16 offen offset:1024 sc1
    s_mov_b64 exec, -1
    s_add_u32 s23, s23, 1
    s_cmp_lt_u32 s23, 200000
    s_cbranch_scc1 g_44L15_2
    s_mov_b32 s25, 200000
    s_branch gc_45
g_44F15_2:
    s_mov_b64 exec, vcc
    buffer_load_dwordx4 v[32:35], v8, s[4:7], s16 offen offset:2048 sc1
    s_mov_b64 exec, -1
    s_add_u32 s23, s23, 1
    s_cmp_lt_u32 s23, 200000
    s_cbranch_scc1 g_44L15_3
    s_mov_b32 s25, 200000
    s_branch gc_45
g_44F15_3:
    s_mov_b64 exec, vcc
    buffer_load_dwordx4 v[36:39], v8, s[4:7], s16 offen offset:3072 sc1
    s_mov_b64 exec, -1
    s_add_u32 s23, s23, 1
    s_cmp_lt_u32 s23, 200000
    s_cbranch_scc1 g_44L15_0
    s_mov_b32 s25, 200000
    s_branch gc_45
g_44F7_0:
    s_mov_b64 exec, vcc
    buffer_load_dwordx4 v[24:27], v8, s[4:7], s16 offen offset:0 sc1
    s_mov_b64 exec, -1
    s_add_u32 s23, s23, 1
    s_cmp_lt_u32 s23, 200000
    s_cbranch_scc1 g_44L7_1
    s_mov_b32 s25, 200000
    s_branch gc_45
g_44F7_1:
    s_mov_b64 exec, vcc
    buffer_load_dwordx4 v[28:31], v8, s[4:7], s16 offen offset:1024 sc1
    s_mov_b64 exec, -1
    s_add_u32 s23, s23, 1
    s_cmp_lt_u32 s23, 200000
    s_cbranch_scc1 g_44L7_2
    s_mov_b32 s25, 200000
    s_branch gc_45
g_44F7_2:
    s_mov_b64 exec, vcc
    buffer_load_dwordx4 v[32:35], v8, s[4:7], s16 offen offset:2048 sc1
    s_mov_b64 exec, -1
    s_add_u32 s23, s23, 1
    s_cmp_lt_u32 s23, 200000
    s_cbranch_scc1 g_44L7_0
    s_mov_b32 s25, 200000
    s_branch gc_45
g_44F11_0:
    s_mov_b64 exec, vcc
    buffer_load_dwordx4 v[24:27], v8, s[4:7], s16 offen offset:0 sc1
    s_mov_b64 exec, -1
    s_add_u32 s23, s23, 1
    s_cmp_lt_u32 s23, 200000
    s_cbranch_scc1 g_44L11_1
    s_mov_b32 s25, 200000
    s_branch gc_45
g_44F11_1:
    s_mov_b64 exec, vcc
    buffer_load_dwordx4 v[28:31], v8, s[4:7], s16 offen offset:1024 sc1
    s_mov_b64 exec, -1
    s_add_u32 s23, s23, 1
    s_cmp_lt_u32 s23, 200000
    s_cbranch_scc1 g_44L11_3
    s_mov_b32 s25, 200000
    s_branch gc_45
g_44F11_3:
    s_mov_b64 exec, vcc
    buffer_load_dwordx4 v[36:39], v8, s[4:7], s16 offen offset:3072 sc1
    s_mov_b64 exec, -1
    s_add_u32 s23, s23, 1
    s_cmp_lt_u32 s23, 200000
    s_cbranch_scc1 g_44L11_0
    s_mov_b32 s25, 200000
    s_branch gc_45
g_44F13_0:
    s_mov_b64 exec, vcc
    buffer_load_dwordx4 v[24:27], v8, s[4:7], s16 offen offset:0 sc1
    s_mov_b64 exec, -1
    s_add_u32 s23, s23, 1
    s_cmp_lt_u32 s23, 200000
    s_cbranch_scc1 g_44L13_2
    s_mov_b32 s25, 200000
    s_branch gc_45
g_44F13_2:
    s_mov_b64 exec, vcc
    buffer_load_dwordx4 v[32:35], v8, s[4:7], s16 offen offset:2048 sc1
    s_mov_b64 exec, -1
    s_add_u32 s23, s23, 1
    s_cmp_lt_u32 s23, 200000
    s_cbranch_scc1 g_44L13_3
    s_mov_b32 s25, 200000
    s_branch gc_45
g_44F13_3:
    s_mov_b64 exec, vcc
    buffer_load_dwordx4 v[36:39], v8, s[4:7], s16 offen offset:3072 sc1
    s_mov_b64 exec, -1
    s_add_u32 s23, s23, 1
    s_cmp_lt_u32 s23, 200000
    s_cbranch_scc1 g_44L13_0
    s_mov_b32 s25, 200000
    s_branch gc_45
g_44F14_1:
    s_mov_b64 exec, vcc
    buffer_load_dwordx4 v[28:31], v8, s[4:7], s16 offen offset:1024 sc1
    s_mov_b64 exec, -1
    s_add_u32 s23, s23, 1
    s_cmp_lt_u32 s23, 200000
    s_cbranch_scc1 g_44L14_2
    s_mov_b32 s25, 200000
    s_branch gc_45
g_44F14_2:
    s_mov_b64 exec, vcc
    buffer_load_dwordx4 v[32:35], v8, s[4:7], s16 offen offset:2048 sc1
    s_mov_b64 exec, -1
    s_add_u32 s23, s23, 1
    s_cmp_lt_u32 s23, 200000
    s_cbranch_scc1 g_44L14_3
    s_mov_b32 s25, 200000
    s_branch gc_45
g_44F14_3:
    s_mov_b64 exec, vcc
    buffer_load_dwordx4 v[36:39], v8, s[4:7], s16 offen offset:3072 sc1
    s_mov_b64 exec, -1
    s_add_u32 s23, s23, 1
    s_cmp_lt_u32 s23, 200000
    s_cbranch_scc1 g_44L14_1
    s_mov_b32 s25, 200000
    s_branch gc_45
g_44F3_0:
    s_mov_b64 exec, vcc
    buffer_load_dwordx4 v[24:27], v8, s[4:7], s16 offen offset:0 sc1
    s_mov_b64 exec, -1
    s_add_u32 s23, s23, 1
    s_cmp_lt_u32 s23, 200000
    s_cbranch_scc1 g_44L3_1
    s_mov_b32 s25, 200000
    s_branch gc_45
g_44F3_1:
    s_mov_b64 exec, vcc
    buffer_load_dwordx4 v[28:31], v8, s[4:7], s16 offen offset:1024 sc1
    s_mov_b64 exec, -1
    s_add_u32 s23, s23, 1
    s_cmp_lt_u32 s23, 200000
    s_cbranch_scc1 g_44L3_0
    s_mov_b32 s25, 200000
    s_branch gc_45
g_44F5_0:
    s_mov_b64 exec, vcc
    buffer_load_dwordx4 v[24:27], v8, s[4:7], s16 offen offset:0 sc1
    s_mov_b64 exec, -1
    s_add_u32 s23, s23, 1
    s_cmp_lt_u32 s23, 200000
    s_cbranch_scc1 g_44L5_2
    s_mov_b32 s25, 200000
    s_branch gc_45
g_44F5_2:
    s_mov_b64 exec, vcc
    buffer_load_dwordx4 v[32:35], v8, s[4:7], s16 offen offset:2048 sc1
    s_mov_b64 exec, -1
    s_add_u32 s23, s23, 1
    s_cmp_lt_u32 s23, 200000
    s_cbranch_scc1 g_44L5_0
    s_mov_b32 s25, 200000
    s_branch gc_45
g_44F6_1:
    s_mov_b64 exec, vcc
    buffer_load_dwordx4 v[28:31], v8, s[4:7], s16 offen offset:1024 sc1
    s_mov_b64 exec, -1
    s_add_u32 s23, s23, 1
    s_cmp_lt_u32 s23, 200000
    s_cbranch_scc1 g_44L6_2
    s_mov_b32 s25, 200000
    s_branch gc_45
g_44F6_2:
    s_mov_b64 exec, vcc
    buffer_load_dwordx4 v[32:35], v8, s[4:7], s16 offen offset:2048 sc1
    s_mov_b64 exec, -1
    s_add_u32 s23, s23, 1
    s_cmp_lt_u32 s23, 200000
    s_cbranch_scc1 g_44L6_1
    s_mov_b32 s25, 200000
    s_branch gc_45
g_44F9_0:
    s_mov_b64 exec, vcc
    buffer_load_dwordx4 v[24:27], v8, s[4:7], s16 offen offset:0 sc1
    s_mov_b64 exec, -1
    s_add_u32 s23, s23, 1
    s_cmp_lt_u32 s23, 200000
    s_cbranch_scc1 g_44L9_3
    s_mov_b32 s25, 200000
    s_branch gc_45
g_44F9_3:
    s_mov_b64 exec, vcc
    buffer_load_dwordx4 v[36:39], v8, s[4:7], s16 offen offset:3072 sc1
    s_mov_b64 exec, -1
    s_add_u32 s23, s23, 1
    s_cmp_lt_u32 s23, 200000
    s_cbranch_scc1 g_44L9_0
    s_mov_b32 s25, 200000
    s_branch gc_45
g_44F10_1:
    s_mov_b64 exec, vcc
    buffer_load_dwordx4 v[28:31], v8, s[4:7], s16 offen offset:1024 sc1
    s_mov_b64 exec, -1
    s_add_u32 s23, s23, 1
    s_cmp_lt_u32 s23, 200000
    s_cbranch_scc1 g_44L10_3
    s_mov_b32 s25, 200000
    s_branch gc_45
g_44F10_3:
    s_mov_b64 exec, vcc
    buffer_load_dwordx4 v[36:39], v8, s[4:7], s16 offen offset:3072 sc1
    s_mov_b64 exec, -1
    s_add_u32 s23, s23, 1
    s_cmp_lt_u32 s23, 200000
    s_cbranch_scc1 g_44L10_1
    s_mov_b32 s25, 200000
    s_branch gc_45
g_44F12_2:
    s_mov_b64 exec, vcc
    buffer_load_dwordx4 v[32:35], v8, s[4:7], s16 offen offset:2048 sc1
    s_mov_b64 exec, -1
    s_add_u32 s23, s23, 1
    s_cmp_lt_u32 s23, 200000
    s_cbranch_scc1 g_44L12_3
    s_mov_b32 s25, 200000
    s_branch gc_45
g_44F12_3:
    s_mov_b64 exec, vcc
    buffer_load_dwordx4 v[36:39], v8, s[4:7], s16 offen offset:3072 sc1
    s_mov_b64 exec, -1
    s_add_u32 s23, s23, 1
    s_cmp_lt_u32 s23, 200000
    s_cbranch_scc1 g_44L12_2
    s_mov_b32 s25, 200000
    s_branch gc_45
g_44F1_0:
    s_mov_b64 exec, vcc
    buffer_load_dwordx4 v[24:27], v8, s[4:7], s16 offen offset:0 sc1
    s_mov_b64 exec, -1
    s_add_u32 s23, s23, 1
    s_cmp_lt_u32 s23, 200000
    s_cbranch_scc1 g_44L1_0
    s_mov_b32 s25, 200000
    s_branch gc_45
g_44F2_1:
    s_mov_b64 exec, vcc
    buffer_load_dwordx4 v[28:31], v8, s[4:7], s16 offen offset:1024 sc1
    s_mov_b64 exec, -1
    s_add_u32 s23, s23, 1
    s_cmp_lt_u32 s23, 200000
    s_cbranch_scc1 g_44L2_1
    s_mov_b32 s25, 200000
    s_branch gc_45
g_44F4_2:
    s_mov_b64 exec, vcc
    buffer_load_dwordx4 v[32:35], v8, s[4:7], s16 offen offset:2048 sc1
    s_mov_b64 exec, -1
    s_add_u32 s23, s23, 1
    s_cmp_lt_u32 s23, 200000
    s_cbranch_scc1 g_44L4_2
    s_mov_b32 s25, 200000
    s_branch gc_45
g_44F8_3:
    s_mov_b64 exec, vcc
    buffer_load_dwordx4 v[36:39], v8, s[4:7], s16 offen offset:3072 sc1
    s_mov_b64 exec, -1
    s_add_u32 s23, s23, 1
    s_cmp_lt_u32 s23, 200000
    s_cbranch_scc1 g_44L8_3
    s_mov_b32 s25, 200000
    s_branch gc_45
.p2align 6
recur_fast_w3:
    s_nop 15
    s_mov_b32 s23, s25
    buffer_load_dwordx4 v[24:27], v2, s[4:7], s16 offen offset:0 sc1
    s_nop 11
    buffer_load_dwordx4 v[28:31], v2, s[4:7], s16 offen offset:1024 sc1
    s_nop 11
    buffer_load_dwordx4 v[32:35], v2, s[4:7], s16 offen offset:2048 sc1
    s_nop 11
    buffer_load_dwordx4 v[36:39], v2, s[4:7], s16 offen offset:3072 sc1
    s_waitcnt vmcnt(3)
    v_max3_u32 v19, v24, v25, v26
    v_max_u32 v19, v19, v27
    v_cmp_eq_u32 vcc, -1, v19
    s_nop 0
    s_cbranch_vccnz g_46F15_0
    v_smfmac_f32_16x16x64_bf16 v[40:43], v[24:27], a[0:7], v172
    v_smfmac_f32_16x16x64_bf16 v[44:47], v[24:27], a[64:71], v172
    s_waitcnt vmcnt(2)
    v_max3_u32 v19, v28, v29, v30
    v_max_u32 v19, v19, v31
    v_smfmac_f32_16x16x64_bf16 v[48:51], v[24:27], a[32:39], v172
    v_cmp_eq_u32 vcc, -1, v19
    v_smfmac_f32_16x16x64_bf16 v[52:55], v[24:27], a[96:103], v172
    s_cbranch_vccnz g_46F14_1
    v_smfmac_f32_16x16x64_bf16 v[40:43], v[28:31], a[8:15], v172
    v_smfmac_f32_16x16x64_bf16 v[44:47], v[28:31], a[72:79], v172
    s_waitcnt vmcnt(1)
    v_max3_u32 v19, v32, v33, v34
    v_max_u32 v19, v19, v35
    v_smfmac_f32_16x16x64_bf16 v[48:51], v[28:31], a[40:47], v172
    v_cmp_eq_u32 vcc, -1, v19
    v_smfmac_f32_16x16x64_bf16 v[52:55], v[28:31], a[104:111], v172
    s_cbranch_vccnz g_46F12_2
    v_smfmac_f32_16x16x64_bf16 v[40:43], v[32:35], a[16:23], v172
    v_smfmac_f32_16x16x64_bf16 v[44:47], v[32:35], a[80:87], v172
    s_waitcnt vmcnt(0)
    v_max3_u32 v19, v36, v37, v38
    v_max_u32 v19, v19, v39
    v_smfmac_f32_16x16x64_bf16 v[48:51], v[32:35], a[48:55], v172
    v_cmp_eq_u32 vcc, -1, v19
    v_smfmac_f32_16x16x64_bf16 v[52:55], v[32:35], a[112:119], v172
    s_cbranch_vccnz g_46F8_3
    v_smfmac_f32_16x16x64_bf16 v[40:43], v[36:39], a[24:31], v172
    v_smfmac_f32_16x16x64_bf16 v[44:47], v[36:39], a[88:95], v172
    v_smfmac_f32_16x16x64_bf16 v[48:51], v[36:39], a[56:63], v172
    v_smfmac_f32_16x16x64_bf16 v[52:55], v[36:39], a[120:127], v172
gc_47:
    v_cvt_pk_bf16_f32 v72, v40, v41
    v_cvt_pk_bf16_f32 v73, v42, v43
    v_cvt_pk_bf16_f32 v74, v44, v45
    v_cvt_pk_bf16_f32 v75, v46, v47
    ds_write_b128 v17, v[72:75] offset:0
    v_cvt_pk_bf16_f32 v76, v48, v49
    v_cvt_pk_bf16_f32 v77, v50, v51
    s_nop 0
    v_cvt_pk_bf16_f32 v78, v52, v53
    v_cvt_pk_bf16_f32 v79, v54, v55
    ds_write_b128 v17, v[76:79] offset:1024
    v_smfmac_f32_16x16x64_bf16 v[56:59], v[24:27], a[128:135], v172
    v_smfmac_f32_16x16x64_bf16 v[60:63], v[24:27], a[160:167], v172
    v_smfmac_f32_16x16x64_bf16 v[56:59], v[28:31], a[136:143], v172
    s_waitcnt lgkmcnt(0)
    s_barrier
    v_smfmac_f32_16x16x64_bf16 v[60:63], v[28:31], a[168:175], v172
    v_smfmac_f32_16x16x64_bf16 v[56:59], v[32:35], a[144:151], v172
    v_smfmac_f32_16x16x64_bf16 v[60:63], v[32:35], a[176:183], v172
    v_smfmac_f32_16x16x64_bf16 v[56:59], v[36:39], a[152:159], v172
    v_smfmac_f32_16x16x64_bf16 v[60:63], v[36:39], a[184:191], v172
    s_nop 4
    v_cvt_pk_bf16_f32 v80, v56, v57
    v_cvt_pk_bf16_f32 v81, v58, v59
    s_nop 0
    v_cvt_pk_bf16_f32 v82, v60, v61
    v_cvt_pk_bf16_f32 v83, v62, v63
    ds_write_b128 v17, v[80:83] offset:8192
    buffer_store_dwordx4 v[204:207], v3, s[4:7], s43 offen
    buffer_store_dwordx4 v[204:207], v3, s[4:7], s43 offen offset:128
    buffer_store_dwordx4 v[204:207], v4, s[4:7], s43 offen
    buffer_store_dwordx2 v[204:205], v7, s[4:7], s43 offen
    buffer_store_dwordx2 v[204:205], v11, s[4:7], s43 offen
    s_cmp_eq_u32 s15, 63
    s_waitcnt lgkmcnt(0)
    s_barrier
    s_cbranch_scc1 recur_end
    s_barrier
    s_nop 15
    s_mov_b32 s23, s25
    buffer_load_dwordx4 v[24:27], v8, s[4:7], s16 offen offset:0 sc1
    s_nop 11
    buffer_load_dwordx4 v[28:31], v8, s[4:7], s16 offen offset:1024 sc1
    s_nop 11
    buffer_load_dwordx4 v[32:35], v8, s[4:7], s16 offen offset:2048 sc1
    s_nop 11
    buffer_load_dwordx4 v[36:39], v8, s[4:7], s16 offen offset:3072 sc1
    s_waitcnt vmcnt(3)
    v_max3_u32 v19, v24, v25, v26
    v_max_u32 v19, v19, v27
    v_cmp_eq_u32 vcc, -1, v19
    s_nop 0
    s_cbranch_vccnz g_48F15_0
    v_smfmac_f32_16x16x64_bf16 v[64:67], v[24:27], a[192:199], v172
    v_smfmac_f32_16x16x64_bf16 v[68:71], v[24:27], a[224:231], v172
    s_waitcnt vmcnt(2)
    v_max3_u32 v19, v28, v29, v30
    v_max_u32 v19, v19, v31
    v_cmp_eq_u32 vcc, -1, v19
    s_nop 0
    s_cbranch_vccnz g_48F14_1
    v_smfmac_f32_16x16x64_bf16 v[64:67], v[28:31], a[200:207], v172
    v_smfmac_f32_16x16x64_bf16 v[68:71], v[28:31], a[232:239], v172
    s_waitcnt vmcnt(1)
    v_max3_u32 v19, v32, v33, v34
    v_max_u32 v19, v19, v35
    v_cmp_eq_u32 vcc, -1, v19
    s_nop 0
    s_cbranch_vccnz g_48F12_2
    v_smfmac_f32_16x16x64_bf16 v[64:67], v[32:35], a[208:215], v172
    v_smfmac_f32_16x16x64_bf16 v[68:71], v[32:35], a[240:247], v172
    s_waitcnt vmcnt(0)
    v_max3_u32 v19, v36, v37, v38
    v_max_u32 v19, v19, v39
    v_cmp_eq_u32 vcc, -1, v19
    s_nop 0
    s_cbranch_vccnz g_48F8_3
    v_smfmac_f32_16x16x64_bf16 v[64:67], v[36:39], a[216:223], v172
    v_smfmac_f32_16x16x64_bf16 v[68:71], v[36:39], a[248:255], v172
    s_nop 4
    v_cvt_pk_bf16_f32 v80, v64, v65
    v_cvt_pk_bf16_f32 v81, v66, v67
    s_nop 0
    v_cvt_pk_bf16_f32 v82, v68, v69
    v_cvt_pk_bf16_f32 v83, v70, v71
    s_nop 1
    v_mfma_f32_16x16x32_bf16 v[88:91], v[80:83], v[84:87], 0
gc_49:
    s_barrier
    ds_read_b128 v[96:99], v16 offset:9216
    ds_read_b128 v[100:103], v16 offset:11264
    ds_read_b128 v[104:107], v16 offset:13312
    s_waitcnt lgkmcnt(2)
    v_mfma_f32_16x16x32_bf16 v[88:91], v[96:99], v[84:87], v[88:91]
    s_waitcnt lgkmcnt(1)
    v_mfma_f32_16x16x32_bf16 v[88:91], v[100:103], v[84:87], v[88:91]
    s_waitcnt lgkmcnt(0)
    v_mfma_f32_16x16x32_bf16 v[88:91], v[104:107], v[84:87], v[88:91]
    s_nop 7
    buffer_store_dwordx4 v[88:91], v9, s[4:7], s84 offen sc1
    s_add_u32 s22, s84, 262144
    s_nop 15
    s_nop 15
    s_nop 15
    s_nop 15
    s_mov_b32 s23, s25
    buffer_load_dwordx4 v[96:99], v10, s[4:7], s84 offen sc1
    buffer_load_dwordx4 v[100:103], v23, s[4:7], s84 offen sc1
    buffer_load_dwordx4 v[104:107], v244, s[4:7], s84 offen sc1
    v_mov_b32 v40, 0
    v_mov_b32 v41, 0
    v_mov_b32 v42, 0
    v_mov_b32 v43, 0
    v_mov_b32 v44, 0
    v_mov_b32 v45, 0
    v_mov_b32 v46, 0
    v_mov_b32 v47, 0
    v_mov_b32 v48, 0
    v_mov_b32 v49, 0
    v_mov_b32 v50, 0
    v_mov_b32 v51, 0
    v_mov_b32 v52, 0
    v_mov_b32 v53, 0
    v_mov_b32 v54, 0
    v_mov_b32 v55, 0
    v_mov_b32 v56, 0
    v_mov_b32 v57, 0
    v_mov_b32 v58, 0
    v_mov_b32 v59, 0
    v_mov_b32 v60, 0
    v_mov_b32 v61, 0
    v_mov_b32 v62, 0
    v_mov_b32 v63, 0
    v_mov_b32 v64, 0
    v_mov_b32 v65, 0
    v_mov_b32 v66, 0
    v_mov_b32 v67, 0
    v_mov_b32 v68, 0
    v_mov_b32 v69, 0
    v_mov_b32 v70, 0
    v_mov_b32 v71, 0
pb_52:
    s_waitcnt vmcnt(2)
    v_pk_add_f32 v[120:121], v[88:89], v[96:97]
    v_pk_add_f32 v[122:123], v[90:91], v[98:99]
    s_waitcnt vmcnt(0)
    v_pk_add_f32 v[124:125], v[100:101], v[104:105]
    v_pk_add_f32 v[126:127], v[102:103], v[106:107]
    v_pk_add_f32 v[120:121], v[120:121], v[124:125]
    v_pk_add_f32 v[122:123], v[122:123], v[126:127]
    v_cmp_u_f32 vcc, v120, v121
    v_cmp_u_f32 s[86:87], v122, v123
    v_cvt_pk_bf16_f32 v180, v120, v121
    v_cvt_pk_bf16_f32 v181, v122, v123
    s_or_b64 vcc, vcc, s[86:87]
    s_cbranch_scc1 pr_50
pg_51:
    buffer_store_dwordx2 v[180:181], v11, s[4:7], s42 offen
    s_barrier
    s_mov_b32 s21, s16
    s_mov_b32 s16, s42
    s_mov_b32 s42, s43
    s_mov_b32 s43, s44
    s_mov_b32 s44, s21
    s_add_u32 s95, s95, 524288
    s_lshr_b32 s84, s95, 8
    s_and_b32 s84, s84, 8192
    s_xor_b32 s84, s84, s46
    s_add_u32 s84, s84, s95
    s_add_u32 s15, s15, 1
    s_branch recur_fast_w3
g_46L15_0:
    s_waitcnt vmcnt(3)
    v_max3_u32 v19, v24, v25, v26
    v_max_u32 v19, v19, v27
    v_cmp_eq_u32 vcc, -1, v19
    s_nop 0
    s_cbranch_vccnz g_46F15_0
    v_smfmac_f32_16x16x64_bf16 v[40:43], v[24:27], a[0:7], v172
    v_smfmac_f32_16x16x64_bf16 v[44:47], v[24:27], a[64:71], v172
    v_smfmac_f32_16x16x64_bf16 v[48:51], v[24:27], a[32:39], v172
    v_smfmac_f32_16x16x64_bf16 v[52:55], v[24:27], a[96:103], v172
g_46L14_1:
    s_waitcnt vmcnt(2)
    v_max3_u32 v19, v28, v29, v30
    v_max_u32 v19, v19, v31
    v_cmp_eq_u32 vcc, -1, v19
    s_nop 0
    s_cbranch_vccnz g_46F14_1
    v_smfmac_f32_16x16x64_bf16 v[40:43], v[28:31], a[8:15], v172
    v_smfmac_f32_16x16x64_bf16 v[44:47], v[28:31], a[72:79], v172
    v_smfmac_f32_16x16x64_bf16 v[48:51], v[28:31], a[40:47], v172
    v_smfmac_f32_16x16x64_bf16 v[52:55], v[28:31], a[104:111], v172
g_46L12_2:
    s_waitcnt vmcnt(1)
    v_max3_u32 v19, v32, v33, v34
    v_max_u32 v19, v19, v35
    v_cmp_eq_u32 vcc, -1, v19
    s_nop 0
    s_cbranch_vccnz g_46F12_2
    v_smfmac_f32_16x16x64_bf16 v[40:43], v[32:35], a[16:23], v172
    v_smfmac_f32_16x16x64_bf16 v[44:47], v[32:35], a[80:87], v172
    v_smfmac_f32_16x16x64_bf16 v[48:51], v[32:35], a[48:55], v172
    v_smfmac_f32_16x16x64_bf16 v[52:55], v[32:35], a[112:119], v172
g_46L8_3:
    s_waitcnt vmcnt(0)
    v_max3_u32 v19, v36, v37, v38
    v_max_u32 v19, v19, v39
    v_cmp_eq_u32 vcc, -1, v19
    s_nop 0
    s_cbranch_vccnz g_46F8_3
    v_smfmac_f32_16x16x64_bf16 v[40:43], v[36:39], a[24:31], v172
    v_smfmac_f32_16x16x64_bf16 v[44:47], v[36:39], a[88:95], v172
    v_smfmac_f32_16x16x64_bf16 v[48:51], v[36:39], a[56:63], v172
    v_smfmac_f32_16x16x64_bf16 v[52:55], v[36:39], a[120:127], v172
    s_branch gc_47
g_46L15_1:
    s_waitcnt vmcnt(3)
    v_max3_u32 v19, v28, v29, v30
    v_max_u32 v19, v19, v31
    v_cmp_eq_u32 vcc, -1, v19
    s_nop 0
    s_cbranch_vccnz g_46F15_1
    v_smfmac_f32_16x16x64_bf16 v[40:43], v[28:31], a[8:15], v172
    v_smfmac_f32_16x16x64_bf16 v[44:47], v[28:31], a[72:79], v172
    v_smfmac_f32_16x16x64_bf16 v[48:51], v[28:31], a[40:47], v172
    v_smfmac_f32_16x16x64_bf16 v[52:55], v[28:31], a[104:111], v172
g_46L13_2:
    s_waitcnt vmcnt(2)
    v_max3_u32 v19, v32, v33, v34
    v_max_u32 v19, v19, v35
    v_cmp_eq_u32 vcc, -1, v19
    s_nop 0
    s_cbranch_vccnz g_46F13_2
    v_smfmac_f32_16x16x64_bf16 v[40:43], v[32:35], a[16:23], v172
    v_smfmac_f32_16x16x64_bf16 v[44:47], v[32:35], a[80:87], v172
    v_smfmac_f32_16x16x64_bf16 v[48:51], v[32:35], a[48:55], v172
    v_smfmac_f32_16x16x64_bf16 v[52:55], v[32:35], a[112:119], v172
g_46L9_3:
    s_waitcnt vmcnt(1)
    v_max3_u32 v19, v36, v37, v38
    v_max_u32 v19, v19, v39
    v_cmp_eq_u32 vcc, -1, v19
    s_nop 0
    s_cbranch_vccnz g_46F9_3
    v_smfmac_f32_16x16x64_bf16 v[40:43], v[36:39], a[24:31], v172
    v_smfmac_f32_16x16x64_bf16 v[44:47], v[36:39], a[88:95], v172
    v_smfmac_f32_16x16x64_bf16 v[48:51], v[36:39], a[56:63], v172
    v_smfmac_f32_16x16x64_bf16 v[52:55], v[36:39], a[120:127], v172
g_46L1_0:
    s_waitcnt vmcnt(0)
    v_max3_u32 v19, v24, v25, v26
    v_max_u32 v19, v19, v27
    v_cmp_eq_u32 vcc, -1, v19
    s_nop 0
    s_cbranch_vccnz g_46F1_0
    v_smfmac_f32_16x16x64_bf16 v[40:43], v[24:27], a[0:7], v172
    v_smfmac_f32_16x16x64_bf16 v[44:47], v[24:27], a[64:71], v172
    v_smfmac_f32_16x16x64_bf16 v[48:51], v[24:27], a[32:39], v172
    v_smfmac_f32_16x16x64_bf16 v[52:55], v[24:27], a[96:103], v172
    s_branch gc_47
g_46L15_2:
    s_waitcnt vmcnt(3)
    v_max3_u32 v19, v32, v33, v34
    v_max_u32 v19, v19, v35
    v_cmp_eq_u32 vcc, -1, v19
    s_nop 0
    s_cbranch_vccnz g_46F15_2
    v_smfmac_f32_16x16x64_bf16 v[40:43], v[32:35], a[16:23], v172
    v_smfmac_f32_16x16x64_bf16 v[44:47], v[32:35], a[80:87], v172
    v_smfmac_f32_16x16x64_bf16 v[48:51], v[32:35], a[48:55], v172
    v_smfmac_f32_16x16x64_bf16 v[52:55], v[32:35], a[112:119], v172
g_46L11_3:
    s_waitcnt vmcnt(2)
    v_max3_u32 v19, v36, v37, v38
    v_max_u32 v19, v19, v39
    v_cmp_eq_u32 vcc, -1, v19
    s_nop 0
    s_cbranch_vccnz g_46F11_3
    v_smfmac_f32_16x16x64_bf16 v[40:43], v[36:39], a[24:31], v172
    v_smfmac_f32_16x16x64_bf16 v[44:47], v[36:39], a[88:95], v172
    v_smfmac_f32_16x16x64_bf16 v[48:51], v[36:39], a[56:63], v172
    v_smfmac_f32_16x16x64_bf16 v[52:55], v[36:39], a[120:127], v172
g_46L3_0:
    s_waitcnt vmcnt(1)
    v_max3_u32 v19, v24, v25, v26
    v_max_u32 v19, v19, v27
    v_cmp_eq_u32 vcc, -1, v19
    s_nop 0
    s_cbranch_vccnz g_46F3_0
    v_smfmac_f32_16x16x64_bf16 v[40:43], v[24:27], a[0:7], v172
    v_smfmac_f32_16x16x64_bf16 v[44:47], v[24:27], a[64:71], v172
    v_smfmac_f32_16x16x64_bf16 v[48:51], v[24:27], a[32:39], v172
    v_smfmac_f32_16x16x64_bf16 v[52:55], v[24:27], a[96:103], v172
g_46L2_1:
    s_waitcnt vmcnt(0)
    v_max3_u32 v19, v28, v29, v30
    v_max_u32 v19, v19, v31
    v_cmp_eq_u32 vcc, -1, v19
    s_nop 0
    s_cbranch_vccnz g_46F2_1
    v_smfmac_f32_16x16x64_bf16 v[40:43], v[28:31], a[8:15], v172
    v_smfmac_f32_16x16x64_bf16 v[44:47], v[28:31], a[72:79], v172
    v_smfmac_f32_16x16x64_bf16 v[48:51], v[28:31], a[40:47], v172
    v_smfmac_f32_16x16x64_bf16 v[52:55], v[28:31], a[104:111], v172
    s_branch gc_47
g_46L15_3:
    s_waitcnt vmcnt(3)
    v_max3_u32 v19, v36, v37, v38
    v_max_u32 v19, v19, v39
    v_cmp_eq_u32 vcc, -1, v19
    s_nop 0
    s_cbranch_vccnz g_46F15_3
    v_smfmac_f32_16x16x64_bf16 v[40:43], v[36:39], a[24:31], v172
    v_smfmac_f32_16x16x64_bf16 v[44:47], v[36:39], a[88:95], v172
    v_smfmac_f32_16x16x64_bf16 v[48:51], v[36:39], a[56:63], v172
    v_smfmac_f32_16x16x64_bf16 v[52:55], v[36:39], a[120:127], v172
g_46L7_0:
    s_waitcnt vmcnt(2)
    v_max3_u32 v19, v24, v25, v26
    v_max_u32 v19, v19, v27
    v_cmp_eq_u32 vcc, -1, v19
    s_nop 0
    s_cbranch_vccnz g_46F7_0
    v_smfmac_f32_16x16x64_bf16 v[40:43], v[24:27], a[0:7], v172
    v_smfmac_f32_16x16x64_bf16 v[44:47], v[24:27], a[64:71], v172
    v_smfmac_f32_16x16x64_bf16 v[48:51], v[24:27], a[32:39], v172
    v_smfmac_f32_16x16x64_bf16 v[52:55], v[24:27], a[96:103], v172
g_46L6_1:
    s_waitcnt vmcnt(1)
    v_max3_u32 v19, v28, v29, v30
    v_max_u32 v19, v19, v31
    v_cmp_eq_u32 vcc, -1, v19
    s_nop 0
    s_cbranch_vccnz g_46F6_1
    v_smfmac_f32_16x16x64_bf16 v[40:43], v[28:31], a[8:15], v172
    v_smfmac_f32_16x16x64_bf16 v[44:47], v[28:31], a[72:79], v172
    v_smfmac_f32_16x16x64_bf16 v[48:51], v[28:31], a[40:47], v172
    v_smfmac_f32_16x16x64_bf16 v[52:55], v[28:31], a[104:111], v172
g_46L4_2:
    s_waitcnt vmcnt(0)
    v_max3_u32 v19, v32, v33, v34
    v_max_u32 v19, v19, v35
    v_cmp_eq_u32 vcc, -1, v19
    s_nop 0
    s_cbranch_vccnz g_46F4_2
    v_smfmac_f32_16x16x64_bf16 v[40:43], v[32:35], a[16:23], v172
    v_smfmac_f32_16x16x64_bf16 v[44:47], v[32:35], a[80:87], v172
    v_smfmac_f32_16x16x64_bf16 v[48:51], v[32:35], a[48:55], v172
    v_smfmac_f32_16x16x64_bf16 v[52:55], v[32:35], a[112:119], v172
    s_branch gc_47
g_46L7_1:
    s_waitcnt vmcnt(2)
    v_max3_u32 v19, v28, v29, v30
    v_max_u32 v19, v19, v31
    v_cmp_eq_u32 vcc, -1, v19
    s_nop 0
    s_cbranch_vccnz g_46F7_1
    v_smfmac_f32_16x16x64_bf16 v[40:43], v[28:31], a[8:15], v172
    v_smfmac_f32_16x16x64_bf16 v[44:47], v[28:31], a[72:79], v172
    v_smfmac_f32_16x16x64_bf16 v[48:51], v[28:31], a[40:47], v172
    v_smfmac_f32_16x16x64_bf16 v[52:55], v[28:31], a[104:111], v172
g_46L5_2:
    s_waitcnt vmcnt(1)
    v_max3_u32 v19, v32, v33, v34
    v_max_u32 v19, v19, v35
    v_cmp_eq_u32 vcc, -1, v19
    s_nop 0
    s_cbranch_vccnz g_46F5_2
    v_smfmac_f32_16x16x64_bf16 v[40:43], v[32:35], a[16:23], v172
    v_smfmac_f32_16x16x64_bf16 v[44:47], v[32:35], a[80:87], v172
    v_smfmac_f32_16x16x64_bf16 v[48:51], v[32:35], a[48:55], v172
    v_smfmac_f32_16x16x64_bf16 v[52:55], v[32:35], a[112:119], v172
    s_branch g_46L1_0
g_46L7_2:
    s_waitcnt vmcnt(2)
    v_max3_u32 v19, v32, v33, v34
    v_max_u32 v19, v19, v35
    v_cmp_eq_u32 vcc, -1, v19
    s_nop 0
    s_cbranch_vccnz g_46F7_2
    v_smfmac_f32_16x16x64_bf16 v[40:43], v[32:35], a[16:23], v172
    v_smfmac_f32_16x16x64_bf16 v[44:47], v[32:35], a[80:87], v172
    v_smfmac_f32_16x16x64_bf16 v[48:51], v[32:35], a[48:55], v172
    v_smfmac_f32_16x16x64_bf16 v[52:55], v[32:35], a[112:119], v172
    s_branch g_46L3_0
g_46L11_0:
    s_waitcnt vmcnt(2)
    v_max3_u32 v19, v24, v25, v26
    v_max_u32 v19, v19, v27
    v_cmp_eq_u32 vcc, -1, v19
    s_nop 0
    s_cbranch_vccnz g_46F11_0
    v_smfmac_f32_16x16x64_bf16 v[40:43], v[24:27], a[0:7], v172
    v_smfmac_f32_16x16x64_bf16 v[44:47], v[24:27], a[64:71], v172
    v_smfmac_f32_16x16x64_bf16 v[48:51], v[24:27], a[32:39], v172
    v_smfmac_f32_16x16x64_bf16 v[52:55], v[24:27], a[96:103], v172
g_46L10_1:
    s_waitcnt vmcnt(1)
    v_max3_u32 v19, v28, v29, v30
    v_max_u32 v19, v19, v31
    v_cmp_eq_u32 vcc, -1, v19
    s_nop 0
    s_cbranch_vccnz g_46F10_1
    v_smfmac_f32_16x16x64_bf16 v[40:43], v[28:31], a[8:15], v172
    v_smfmac_f32_16x16x64_bf16 v[44:47], v[28:31], a[72:79], v172
    v_smfmac_f32_16x16x64_bf16 v[48:51], v[28:31], a[40:47], v172
    v_smfmac_f32_16x16x64_bf16 v[52:55], v[28:31], a[104:111], v172
    s_branch g_46L8_3
g_46L11_1:
    s_waitcnt vmcnt(2)
    v_max3_u32 v19, v28, v29, v30
    v_max_u32 v19, v19, v31
    v_cmp_eq_u32 vcc, -1, v19
    s_nop 0
    s_cbranch_vccnz g_46F11_1
    v_smfmac_f32_16x16x64_bf16 v[40:43], v[28:31], a[8:15], v172
    v_smfmac_f32_16x16x64_bf16 v[44:47], v[28:31], a[72:79], v172
    v_smfmac_f32_16x16x64_bf16 v[48:51], v[28:31], a[40:47], v172
    v_smfmac_f32_16x16x64_bf16 v[52:55], v[28:31], a[104:111], v172
    s_branch g_46L9_3
g_46L13_0:
    s_waitcnt vmcnt(2)
    v_max3_u32 v19, v24, v25, v26
    v_max_u32 v19, v19, v27
    v_cmp_eq_u32 vcc, -1, v19
    s_nop 0
    s_cbranch_vccnz g_46F13_0
    v_smfmac_f32_16x16x64_bf16 v[40:43], v[24:27], a[0:7], v172
    v_smfmac_f32_16x16x64_bf16 v[44:47], v[24:27], a[64:71], v172
    v_smfmac_f32_16x16x64_bf16 v[48:51], v[24:27], a[32:39], v172
    v_smfmac_f32_16x16x64_bf16 v[52:55], v[24:27], a[96:103], v172
    s_branch g_46L12_2
g_46L13_3:
    s_waitcnt vmcnt(2)
    v_max3_u32 v19, v36, v37, v38
    v_max_u32 v19, v19, v39
    v_cmp_eq_u32 vcc, -1, v19
    s_nop 0
    s_cbranch_vccnz g_46F13_3
    v_smfmac_f32_16x16x64_bf16 v[40:43], v[36:39], a[24:31], v172
    v_smfmac_f32_16x16x64_bf16 v[44:47], v[36:39], a[88:95], v172
    v_smfmac_f32_16x16x64_bf16 v[48:51], v[36:39], a[56:63], v172
    v_smfmac_f32_16x16x64_bf16 v[52:55], v[36:39], a[120:127], v172
g_46L5_0:
    s_waitcnt vmcnt(1)
    v_max3_u32 v19, v24, v25, v26
    v_max_u32 v19, v19, v27
    v_cmp_eq_u32 vcc, -1, v19
    s_nop 0
    s_cbranch_vccnz g_46F5_0
    v_smfmac_f32_16x16x64_bf16 v[40:43], v[24:27], a[0:7], v172
    v_smfmac_f32_16x16x64_bf16 v[44:47], v[24:27], a[64:71], v172
    v_smfmac_f32_16x16x64_bf16 v[48:51], v[24:27], a[32:39], v172
    v_smfmac_f32_16x16x64_bf16 v[52:55], v[24:27], a[96:103], v172
    s_branch g_46L4_2
g_46L14_2:
    s_waitcnt vmcnt(2)
    v_max3_u32 v19, v32, v33, v34
    v_max_u32 v19, v19, v35
    v_cmp_eq_u32 vcc, -1, v19
    s_nop 0
    s_cbranch_vccnz g_46F14_2
    v_smfmac_f32_16x16x64_bf16 v[40:43], v[32:35], a[16:23], v172
    v_smfmac_f32_16x16x64_bf16 v[44:47], v[32:35], a[80:87], v172
    v_smfmac_f32_16x16x64_bf16 v[48:51], v[32:35], a[48:55], v172
    v_smfmac_f32_16x16x64_bf16 v[52:55], v[32:35], a[112:119], v172
g_46L10_3:
    s_waitcnt vmcnt(1)
    v_max3_u32 v19, v36, v37, v38
    v_max_u32 v19, v19, v39
    v_cmp_eq_u32 vcc, -1, v19
    s_nop 0
    s_cbranch_vccnz g_46F10_3
    v_smfmac_f32_16x16x64_bf16 v[40:43], v[36:39], a[24:31], v172
    v_smfmac_f32_16x16x64_bf16 v[44:47], v[36:39], a[88:95], v172
    v_smfmac_f32_16x16x64_bf16 v[48:51], v[36:39], a[56:63], v172
    v_smfmac_f32_16x16x64_bf16 v[52:55], v[36:39], a[120:127], v172
    s_branch g_46L2_1
g_46L14_3:
    s_waitcnt vmcnt(2)
    v_max3_u32 v19, v36, v37, v38
    v_max_u32 v19, v19, v39
    v_cmp_eq_u32 vcc, -1, v19
    s_nop 0
    s_cbranch_vccnz g_46F14_3
    v_smfmac_f32_16x16x64_bf16 v[40:43], v[36:39], a[24:31], v172
    v_smfmac_f32_16x16x64_bf16 v[44:47], v[36:39], a[88:95], v172
    v_smfmac_f32_16x16x64_bf16 v[48:51], v[36:39], a[56:63], v172
    v_smfmac_f32_16x16x64_bf16 v[52:55], v[36:39], a[120:127], v172
    s_branch g_46L6_1
g_46L3_1:
    s_waitcnt vmcnt(1)
    v_max3_u32 v19, v28, v29, v30
    v_max_u32 v19, v19, v31
    v_cmp_eq_u32 vcc, -1, v19
    s_nop 0
    s_cbranch_vccnz g_46F3_1
    v_smfmac_f32_16x16x64_bf16 v[40:43], v[28:31], a[8:15], v172
    v_smfmac_f32_16x16x64_bf16 v[44:47], v[28:31], a[72:79], v172
    v_smfmac_f32_16x16x64_bf16 v[48:51], v[28:31], a[40:47], v172
    v_smfmac_f32_16x16x64_bf16 v[52:55], v[28:31], a[104:111], v172
    s_branch g_46L1_0
g_46L6_2:
    s_waitcnt vmcnt(1)
    v_max3_u32 v19, v32, v33, v34
    v_max_u32 v19, v19, v35
    v_cmp_eq_u32 vcc, -1, v19
    s_nop 0
    s_cbranch_vccnz g_46F6_2
    v_smfmac_f32_16x16x64_bf16 v[40:43], v[32:35], a[16:23], v172
    v_smfmac_f32_16x16x64_bf16 v[44:47], v[32:35], a[80:87], v172
    v_smfmac_f32_16x16x64_bf16 v[48:51], v[32:35], a[48:55], v172
    v_smfmac_f32_16x16x64_bf16 v[52:55], v[32:35], a[112:119], v172
    s_branch g_46L2_1
g_46L9_0:
    s_waitcnt vmcnt(1)
    v_max3_u32 v19, v24, v25, v26
    v_max_u32 v19, v19, v27
    v_cmp_eq_u32 vcc, -1, v19
    s_nop 0
    s_cbranch_vccnz g_46F9_0
    v_smfmac_f32_16x16x64_bf16 v[40:43], v[24:27], a[0:7], v172
    v_smfmac_f32_16x16x64_bf16 v[44:47], v[24:27], a[64:71], v172
    v_smfmac_f32_16x16x64_bf16 v[48:51], v[24:27], a[32:39], v172
    v_smfmac_f32_16x16x64_bf16 v[52:55], v[24:27], a[96:103], v172
    s_branch g_46L8_3
g_46L12_3:
    s_waitcnt vmcnt(1)
    v_max3_u32 v19, v36, v37, v38
    v_max_u32 v19, v19, v39
    v_cmp_eq_u32 vcc, -1, v19
    s_nop 0
    s_cbranch_vccnz g_46F12_3
    v_smfmac_f32_16x16x64_bf16 v[40:43], v[36:39], a[24:31], v172
    v_smfmac_f32_16x16x64_bf16 v[44:47], v[36:39], a[88:95], v172
    v_smfmac_f32_16x16x64_bf16 v[48:51], v[36:39], a[56:63], v172
    v_smfmac_f32_16x16x64_bf16 v[52:55], v[36:39], a[120:127], v172
    s_branch g_46L4_2
g_46F15_0:
    s_mov_b64 exec, vcc
    buffer_load_dwordx4 v[24:27], v2, s[4:7], s16 offen offset:0 sc1
    s_mov_b64 exec, -1
    s_add_u32 s23, s23, 1
    s_cmp_lt_u32 s23, 200000
    s_cbranch_scc1 g_46L15_1
    s_mov_b32 s25, 200000
    s_branch gc_47
g_46F15_1:
    s_mov_b64 exec, vcc
    buffer_load_dwordx4 v[28:31], v2, s[4:7], s16 offen offset:1024 sc1
    s_mov_b64 exec, -1
    s_add_u32 s23, s23, 1
    s_cmp_lt_u32 s23, 200000
    s_cbranch_scc1 g_46L15_2
    s_mov_b32 s25, 200000
    s_branch gc_47
g_46F15_2:
    s_mov_b64 exec, vcc
    buffer_load_dwordx4 v[32:35], v2, s[4:7], s16 offen offset:2048 sc1
    s_mov_b64 exec, -1
    s_add_u32 s23, s23, 1
    s_cmp_lt_u32 s23, 200000
    s_cbranch_scc1 g_46L15_3
    s_mov_b32 s25, 200000
    s_branch gc_47
g_46F15_3:
    s_mov_b64 exec, vcc
    buffer_load_dwordx4 v[36:39], v2, s[4:7], s16 offen offset:3072 sc1
    s_mov_b64 exec, -1
    s_add_u32 s23, s23, 1
    s_cmp_lt_u32 s23, 200000
    s_cbranch_scc1 g_46L15_0
    s_mov_b32 s25, 200000
    s_branch gc_47
g_46F7_0:
    s_mov_b64 exec, vcc
    buffer_load_dwordx4 v[24:27], v2, s[4:7], s16 offen offset:0 sc1
    s_mov_b64 exec, -1
    s_add_u32 s23, s23, 1
    s_cmp_lt_u32 s23, 200000
    s_cbranch_scc1 g_46L7_1
    s_mov_b32 s25, 200000
    s_branch gc_47
g_46F7_1:
    s_mov_b64 exec, vcc
    buffer_load_dwordx4 v[28:31], v2, s[4:7], s16 offen offset:1024 sc1
    s_mov_b64 exec, -1
    s_add_u32 s23, s23, 1
    s_cmp_lt_u32 s23, 200000
    s_cbranch_scc1 g_46L7_2
    s_mov_b32 s25, 200000
    s_branch gc_47
g_46F7_2:
    s_mov_b64 exec, vcc
    buffer_load_dwordx4 v[32:35], v2, s[4:7], s16 offen offset:2048 sc1
    s_mov_b64 exec, -1
    s_add_u32 s23, s23, 1
    s_cmp_lt_u32 s23, 200000
    s_cbranch_scc1 g_46L7_0
    s_mov_b32 s25, 200000
    s_branch gc_47
g_46F11_0:
    s_mov_b64 exec, vcc
    buffer_load_dwordx4 v[24:27], v2, s[4:7], s16 offen offset:0 sc1
    s_mov_b64 exec, -1
    s_add_u32 s23, s23, 1
    s_cmp_lt_u32 s23, 200000
    s_cbranch_scc1 g_46L11_1
    s_mov_b32 s25, 200000
    s_branch gc_47
g_46F11_1:
    s_mov_b64 exec, vcc
    buffer_load_dwordx4 v[28:31], v2, s[4:7], s16 offen offset:1024 sc1
    s_mov_b64 exec, -1
    s_add_u32 s23, s23, 1
    s_cmp_lt_u32 s23, 200000
    s_cbranch_scc1 g_46L11_3
    s_mov_b32 s25, 200000
    s_branch gc_47
g_46F11_3:
    s_mov_b64 exec, vcc
    buffer_load_dwordx4 v[36:39], v2, s[4:7], s16 offen offset:3072 sc1
    s_mov_b64 exec, -1
    s_add_u32 s23, s23, 1
    s_cmp_lt_u32 s23, 200000
    s_cbranch_scc1 g_46L11_0
    s_mov_b32 s25, 200000
    s_branch gc_47
g_46F13_0:
    s_mov_b64 exec, vcc
    buffer_load_dwordx4 v[24:27], v2, s[4:7], s16 offen offset:0 sc1
    s_mov_b64 exec, -1
    s_add_u32 s23, s23, 1
    s_cmp_lt_u32 s23, 200000
    s_cbranch_scc1 g_46L13_2
    s_mov_b32 s25, 200000
    s_branch gc_47
g_46F13_2:
    s_mov_b64 exec, vcc
    buffer_load_dwordx4 v[32:35], v2, s[4:7], s16 offen offset:2048 sc1
    s_mov_b64 exec, -1
    s_add_u32 s23, s23, 1
    s_cmp_lt_u32 s23, 200000
    s_cbranch_scc1 g_46L13_3
    s_mov_b32 s25, 200000
    s_branch gc_47
g_46F13_3:
    s_mov_b64 exec, vcc
    buffer_load_dwordx4 v[36:39], v2, s[4:7], s16 offen offset:3072 sc1
    s_mov_b64 exec, -1
    s_add_u32 s23, s23, 1
    s_cmp_lt_u32 s23, 200000
    s_cbranch_scc1 g_46L13_0
    s_mov_b32 s25, 200000
    s_branch gc_47
g_46F14_1:
    s_mov_b64 exec, vcc
    buffer_load_dwordx4 v[28:31], v2, s[4:7], s16 offen offset:1024 sc1
    s_mov_b64 exec, -1
    s_add_u32 s23, s23, 1
    s_cmp_lt_u32 s23, 200000
    s_cbranch_scc1 g_46L14_2
    s_mov_b32 s25, 200000
    s_branch gc_47
g_46F14_2:
    s_mov_b64 exec, vcc
    buffer_load_dwordx4 v[32:35], v2, s[4:7], s16 offen offset:2048 sc1
    s_mov_b64 exec, -1
    s_add_u32 s23, s23, 1
    s_cmp_lt_u32 s23, 200000
    s_cbranch_scc1 g_46L14_3
    s_mov_b32 s25, 200000
    s_branch gc_47
g_46F14_3:
    s_mov_b64 exec, vcc
    buffer_load_dwordx4 v[36:39], v2, s[4:7], s16 offen offset:3072 sc1
    s_mov_b64 exec, -1
    s_add_u32 s23, s23, 1
    s_cmp_lt_u32 s23, 200000
    s_cbranch_scc1 g_46L14_1
    s_mov_b32 s25, 200000
    s_branch gc_47
g_46F3_0:
    s_mov_b64 exec, vcc
    buffer_load_dwordx4 v[24:27], v2, s[4:7], s16 offen offset:0 sc1
    s_mov_b64 exec, -1
    s_add_u32 s23, s23, 1
    s_cmp_lt_u32 s23, 200000
    s_cbranch_scc1 g_46L3_1
    s_mov_b32 s25, 200000
    s_branch gc_47
g_46F3_1:
    s_mov_b64 exec, vcc
    buffer_load_dwordx4 v[28:31], v2, s[4:7], s16 offen offset:1024 sc1
    s_mov_b64 exec, -1
    s_add_u32 s23, s23, 1
    s_cmp_lt_u32 s23, 200000
    s_cbranch_scc1 g_46L3_0
    s_mov_b32 s25, 200000
    s_branch gc_47
g_46F5_0:
    s_mov_b64 exec, vcc
    buffer_load_dwordx4 v[24:27], v2, s[4:7], s16 offen offset:0 sc1
    s_mov_b64 exec, -1
    s_add_u32 s23, s23, 1
    s_cmp_lt_u32 s23, 200000
    s_cbranch_scc1 g_46L5_2
    s_mov_b32 s25, 200000
    s_branch gc_47
g_46F5_2:
    s_mov_b64 exec, vcc
    buffer_load_dwordx4 v[32:35], v2, s[4:7], s16 offen offset:2048 sc1
    s_mov_b64 exec, -1
    s_add_u32 s23, s23, 1
    s_cmp_lt_u32 s23, 200000
    s_cbranch_scc1 g_46L5_0
    s_mov_b32 s25, 200000
    s_branch gc_47
g_46F6_1:
    s_mov_b64 exec, vcc
    buffer_load_dwordx4 v[28:31], v2, s[4:7], s16 offen offset:1024 sc1
    s_mov_b64 exec, -1
    s_add_u32 s23, s23, 1
    s_cmp_lt_u32 s23, 200000
    s_cbranch_scc1 g_46L6_2
    s_mov_b32 s25, 200000
    s_branch gc_47
g_46F6_2:
    s_mov_b64 exec, vcc
    buffer_load_dwordx4 v[32:35], v2, s[4:7], s16 offen offset:2048 sc1
    s_mov_b64 exec, -1
    s_add_u32 s23, s23, 1
    s_cmp_lt_u32 s23, 200000
    s_cbranch_scc1 g_46L6_1
    s_mov_b32 s25, 200000
    s_branch gc_47
g_46F9_0:
    s_mov_b64 exec, vcc
    buffer_load_dwordx4 v[24:27], v2, s[4:7], s16 offen offset:0 sc1
    s_mov_b64 exec, -1
    s_add_u32 s23, s23, 1
    s_cmp_lt_u32 s23, 200000
    s_cbranch_scc1 g_46L9_3
    s_mov_b32 s25, 200000
    s_branch gc_47
g_46F9_3:
    s_mov_b64 exec, vcc
    buffer_load_dwordx4 v[36:39], v2, s[4:7], s16 offen offset:3072 sc1
    s_mov_b64 exec, -1
    s_add_u32 s23, s23, 1
    s_cmp_lt_u32 s23, 200000
    s_cbranch_scc1 g_46L9_0
    s_mov_b32 s25, 200000
    s_branch gc_47
g_46F10_1:
    s_mov_b64 exec, vcc
    buffer_load_dwordx4 v[28:31], v2, s[4:7], s16 offen offset:1024 sc1
    s_mov_b64 exec, -1
    s_add_u32 s23, s23, 1
    s_cmp_lt_u32 s23, 200000
    s_cbranch_scc1 g_46L10_3
    s_mov_b32 s25, 200000
    s_branch gc_47
g_46F10_3:
    s_mov_b64 exec, vcc
    buffer_load_dwordx4 v[36:39], v2, s[4:7], s16 offen offset:3072 sc1
    s_mov_b64 exec, -1
    s_add_u32 s23, s23, 1
    s_cmp_lt_u32 s23, 200000
    s_cbranch_scc1 g_46L10_1
    s_mov_b32 s25, 200000
    s_branch gc_47
g_46F12_2:
    s_mov_b64 exec, vcc
    buffer_load_dwordx4 v[32:35], v2, s[4:7], s16 offen offset:2048 sc1
    s_mov_b64 exec, -1
    s_add_u32 s23, s23, 1
    s_cmp_lt_u32 s23, 200000
    s_cbranch_scc1 g_46L12_3
    s_mov_b32 s25, 200000
    s_branch gc_47
g_46F12_3:
    s_mov_b64 exec, vcc
    buffer_load_dwordx4 v[36:39], v2, s[4:7], s16 offen offset:3072 sc1
    s_mov_b64 exec, -1
    s_add_u32 s23, s23, 1
    s_cmp_lt_u32 s23, 200000
    s_cbranch_scc1 g_46L12_2
    s_mov_b32 s25, 200000
    s_branch gc_47
g_46F1_0:
    s_mov_b64 exec, vcc
    buffer_load_dwordx4 v[24:27], v2, s[4:7], s16 offen offset:0 sc1
    s_mov_b64 exec, -1
    s_add_u32 s23, s23, 1
    s_cmp_lt_u32 s23, 200000
    s_cbranch_scc1 g_46L1_0
    s_mov_b32 s25, 200000
    s_branch gc_47
g_46F2_1:
    s_mov_b64 exec, vcc
    buffer_load_dwordx4 v[28:31], v2, s[4:7], s16 offen offset:1024 sc1
    s_mov_b64 exec, -1
    s_add_u32 s23, s23, 1
    s_cmp_lt_u32 s23, 200000
    s_cbranch_scc1 g_46L2_1
    s_mov_b32 s25, 200000
    s_branch gc_47
g_46F4_2:
    s_mov_b64 exec, vcc
    buffer_load_dwordx4 v[32:35], v2, s[4:7], s16 offen offset:2048 sc1
    s_mov_b64 exec, -1
    s_add_u32 s23, s23, 1
    s_cmp_lt_u32 s23, 200000
    s_cbranch_scc1 g_46L4_2
    s_mov_b32 s25, 200000
    s_branch gc_47
g_46F8_3:
    s_mov_b64 exec, vcc
    buffer_load_dwordx4 v[36:39], v2, s[4:7], s16 offen offset:3072 sc1
    s_mov_b64 exec, -1
    s_add_u32 s23, s23, 1
    s_cmp_lt_u32 s23, 200000
    s_cbranch_scc1 g_46L8_3
    s_mov_b32 s25, 200000
    s_branch gc_47
g_48L15_0:
    s_waitcnt vmcnt(3)
    v_max3_u32 v19, v24, v25, v26
    v_max_u32 v19, v19, v27
    v_cmp_eq_u32 vcc, -1, v19
    s_nop 0
    s_cbranch_vccnz g_48F15_0
    v_smfmac_f32_16x16x64_bf16 v[64:67], v[24:27], a[192:199], v172
    v_smfmac_f32_16x16x64_bf16 v[68:71], v[24:27], a[224:231], v172
g_48L14_1:
    s_waitcnt vmcnt(2)
    v_max3_u32 v19, v28, v29, v30
    v_max_u32 v19, v19, v31
    v_cmp_eq_u32 vcc, -1, v19
    s_nop 0
    s_cbranch_vccnz g_48F14_1
    v_smfmac_f32_16x16x64_bf16 v[64:67], v[28:31], a[200:207], v172
    v_smfmac_f32_16x16x64_bf16 v[68:71], v[28:31], a[232:239], v172
g_48L12_2:
    s_waitcnt vmcnt(1)
    v_max3_u32 v19, v32, v33, v34
    v_max_u32 v19, v19, v35
    v_cmp_eq_u32 vcc, -1, v19
    s_nop 0
    s_cbranch_vccnz g_48F12_2
    v_smfmac_f32_16x16x64_bf16 v[64:67], v[32:35], a[208:215], v172
    v_smfmac_f32_16x16x64_bf16 v[68:71], v[32:35], a[240:247], v172
g_48L8_3:
    s_waitcnt vmcnt(0)
    v_max3_u32 v19, v36, v37, v38
    v_max_u32 v19, v19, v39
    v_cmp_eq_u32 vcc, -1, v19
    s_nop 0
    s_cbranch_vccnz g_48F8_3
    v_smfmac_f32_16x16x64_bf16 v[64:67], v[36:39], a[216:223], v172
    v_smfmac_f32_16x16x64_bf16 v[68:71], v[36:39], a[248:255], v172
    s_nop 4
    v_cvt_pk_bf16_f32 v80, v64, v65
    v_cvt_pk_bf16_f32 v81, v66, v67
    s_nop 0
    v_cvt_pk_bf16_f32 v82, v68, v69
    v_cvt_pk_bf16_f32 v83, v70, v71
    s_nop 1
    v_mfma_f32_16x16x32_bf16 v[88:91], v[80:83], v[84:87], 0
    s_branch gc_49
g_48L15_1:
    s_waitcnt vmcnt(3)
    v_max3_u32 v19, v28, v29, v30
    v_max_u32 v19, v19, v31
    v_cmp_eq_u32 vcc, -1, v19
    s_nop 0
    s_cbranch_vccnz g_48F15_1
    v_smfmac_f32_16x16x64_bf16 v[64:67], v[28:31], a[200:207], v172
    v_smfmac_f32_16x16x64_bf16 v[68:71], v[28:31], a[232:239], v172
g_48L13_2:
    s_waitcnt vmcnt(2)
    v_max3_u32 v19, v32, v33, v34
    v_max_u32 v19, v19, v35
    v_cmp_eq_u32 vcc, -1, v19
    s_nop 0
    s_cbranch_vccnz g_48F13_2
    v_smfmac_f32_16x16x64_bf16 v[64:67], v[32:35], a[208:215], v172
    v_smfmac_f32_16x16x64_bf16 v[68:71], v[32:35], a[240:247], v172
g_48L9_3:
    s_waitcnt vmcnt(1)
    v_max3_u32 v19, v36, v37, v38
    v_max_u32 v19, v19, v39
    v_cmp_eq_u32 vcc, -1, v19
    s_nop 0
    s_cbranch_vccnz g_48F9_3
    v_smfmac_f32_16x16x64_bf16 v[64:67], v[36:39], a[216:223], v172
    v_smfmac_f32_16x16x64_bf16 v[68:71], v[36:39], a[248:255], v172
g_48L1_0:
    s_waitcnt vmcnt(0)
    v_max3_u32 v19, v24, v25, v26
    v_max_u32 v19, v19, v27
    v_cmp_eq_u32 vcc, -1, v19
    s_nop 0
    s_cbranch_vccnz g_48F1_0
    v_smfmac_f32_16x16x64_bf16 v[64:67], v[24:27], a[192:199], v172
    v_smfmac_f32_16x16x64_bf16 v[68:71], v[24:27], a[224:231], v172
    s_nop 4
    v_cvt_pk_bf16_f32 v80, v64, v65
    v_cvt_pk_bf16_f32 v81, v66, v67
    s_nop 0
    v_cvt_pk_bf16_f32 v82, v68, v69
    v_cvt_pk_bf16_f32 v83, v70, v71
    s_nop 1
    v_mfma_f32_16x16x32_bf16 v[88:91], v[80:83], v[84:87], 0
    s_branch gc_49
g_48L15_2:
    s_waitcnt vmcnt(3)
    v_max3_u32 v19, v32, v33, v34
    v_max_u32 v19, v19, v35
    v_cmp_eq_u32 vcc, -1, v19
    s_nop 0
    s_cbranch_vccnz g_48F15_2
    v_smfmac_f32_16x16x64_bf16 v[64:67], v[32:35], a[208:215], v172
    v_smfmac_f32_16x16x64_bf16 v[68:71], v[32:35], a[240:247], v172
g_48L11_3:
    s_waitcnt vmcnt(2)
    v_max3_u32 v19, v36, v37, v38
    v_max_u32 v19, v19, v39
    v_cmp_eq_u32 vcc, -1, v19
    s_nop 0
    s_cbranch_vccnz g_48F11_3
    v_smfmac_f32_16x16x64_bf16 v[64:67], v[36:39], a[216:223], v172
    v_smfmac_f32_16x16x64_bf16 v[68:71], v[36:39], a[248:255], v172
g_48L3_0:
    s_waitcnt vmcnt(1)
    v_max3_u32 v19, v24, v25, v26
    v_max_u32 v19, v19, v27
    v_cmp_eq_u32 vcc, -1, v19
    s_nop 0
    s_cbranch_vccnz g_48F3_0
    v_smfmac_f32_16x16x64_bf16 v[64:67], v[24:27], a[192:199], v172
    v_smfmac_f32_16x16x64_bf16 v[68:71], v[24:27], a[224:231], v172
g_48L2_1:
    s_waitcnt vmcnt(0)
    v_max3_u32 v19, v28, v29, v30
    v_max_u32 v19, v19, v31
    v_cmp_eq_u32 vcc, -1, v19
    s_nop 0
    s_cbranch_vccnz g_48F2_1
    v_smfmac_f32_16x16x64_bf16 v[64:67], v[28:31], a[200:207], v172
    v_smfmac_f32_16x16x64_bf16 v[68:71], v[28:31], a[232:239], v172
    s_nop 4
    v_cvt_pk_bf16_f32 v80, v64, v65
    v_cvt_pk_bf16_f32 v81, v66, v67
    s_nop 0
    v_cvt_pk_bf16_f32 v82, v68, v69
    v_cvt_pk_bf16_f32 v83, v70, v71
    s_nop 1
    v_mfma_f32_16x16x32_bf16 v[88:91], v[80:83], v[84:87], 0
    s_branch gc_49
g_48L15_3:
    s_waitcnt vmcnt(3)
    v_max3_u32 v19, v36, v37, v38
    v_max_u32 v19, v19, v39
    v_cmp_eq_u32 vcc, -1, v19
    s_nop 0
    s_cbranch_vccnz g_48F15_3
    v_smfmac_f32_16x16x64_bf16 v[64:67], v[36:39], a[216:223], v172
    v_smfmac_f32_16x16x64_bf16 v[68:71], v[36:39], a[248:255], v172
g_48L7_0:
    s_waitcnt vmcnt(2)
    v_max3_u32 v19, v24, v25, v26
    v_max_u32 v19, v19, v27
    v_cmp_eq_u32 vcc, -1, v19
    s_nop 0
    s_cbranch_vccnz g_48F7_0
    v_smfmac_f32_16x16x64_bf16 v[64:67], v[24:27], a[192:199], v172
    v_smfmac_f32_16x16x64_bf16 v[68:71], v[24:27], a[224:231], v172
g_48L6_1:
    s_waitcnt vmcnt(1)
    v_max3_u32 v19, v28, v29, v30
    v_max_u32 v19, v19, v31
    v_cmp_eq_u32 vcc, -1, v19
    s_nop 0
    s_cbranch_vccnz g_48F6_1
    v_smfmac_f32_16x16x64_bf16 v[64:67], v[28:31], a[200:207], v172
    v_smfmac_f32_16x16x64_bf16 v[68:71], v[28:31], a[232:239], v172
g_48L4_2:
    s_waitcnt vmcnt(0)
    v_max3_u32 v19, v32, v33, v34
    v_max_u32 v19, v19, v35
    v_cmp_eq_u32 vcc, -1, v19
    s_nop 0
    s_cbranch_vccnz g_48F4_2
    v_smfmac_f32_16x16x64_bf16 v[64:67], v[32:35], a[208:215], v172
    v_smfmac_f32_16x16x64_bf16 v[68:71], v[32:35], a[240:247], v172
    s_nop 4
    v_cvt_pk_bf16_f32 v80, v64, v65
    v_cvt_pk_bf16_f32 v81, v66, v67
    s_nop 0
    v_cvt_pk_bf16_f32 v82, v68, v69
    v_cvt_pk_bf16_f32 v83, v70, v71
    s_nop 1
    v_mfma_f32_16x16x32_bf16 v[88:91], v[80:83], v[84:87], 0
    s_branch gc_49
g_48L7_1:
    s_waitcnt vmcnt(2)
    v_max3_u32 v19, v28, v29, v30
    v_max_u32 v19, v19, v31
    v_cmp_eq_u32 vcc, -1, v19
    s_nop 0
    s_cbranch_vccnz g_48F7_1
    v_smfmac_f32_16x16x64_bf16 v[64:67], v[28:31], a[200:207], v172
    v_smfmac_f32_16x16x64_bf16 v[68:71], v[28:31], a[232:239], v172
g_48L5_2:
    s_waitcnt vmcnt(1)
    v_max3_u32 v19, v32, v33, v34
    v_max_u32 v19, v19, v35
    v_cmp_eq_u32 vcc, -1, v19
    s_nop 0
    s_cbranch_vccnz g_48F5_2
    v_smfmac_f32_16x16x64_bf16 v[64:67], v[32:35], a[208:215], v172
    v_smfmac_f32_16x16x64_bf16 v[68:71], v[32:35], a[240:247], v172
    s_branch g_48L1_0
g_48L7_2:
    s_waitcnt vmcnt(2)
    v_max3_u32 v19, v32, v33, v34
    v_max_u32 v19, v19, v35
    v_cmp_eq_u32 vcc, -1, v19
    s_nop 0
    s_cbranch_vccnz g_48F7_2
    v_smfmac_f32_16x16x64_bf16 v[64:67], v[32:35], a[208:215], v172
    v_smfmac_f32_16x16x64_bf16 v[68:71], v[32:35], a[240:247], v172
    s_branch g_48L3_0
g_48L11_0:
    s_waitcnt vmcnt(2)
    v_max3_u32 v19, v24, v25, v26
    v_max_u32 v19, v19, v27
    v_cmp_eq_u32 vcc, -1, v19
    s_nop 0
    s_cbranch_vccnz g_48F11_0
    v_smfmac_f32_16x16x64_bf16 v[64:67], v[24:27], a[192:199], v172
    v_smfmac_f32_16x16x64_bf16 v[68:71], v[24:27], a[224:231], v172
g_48L10_1:
    s_waitcnt vmcnt(1)
    v_max3_u32 v19, v28, v29, v30
    v_max_u32 v19, v19, v31
    v_cmp_eq_u32 vcc, -1, v19
    s_nop 0
    s_cbranch_vccnz g_48F10_1
    v_smfmac_f32_16x16x64_bf16 v[64:67], v[28:31], a[200:207], v172
    v_smfmac_f32_16x16x64_bf16 v[68:71], v[28:31], a[232:239], v172
    s_branch g_48L8_3
g_48L11_1:
    s_waitcnt vmcnt(2)
    v_max3_u32 v19, v28, v29, v30
    v_max_u32 v19, v19, v31
    v_cmp_eq_u32 vcc, -1, v19
    s_nop 0
    s_cbranch_vccnz g_48F11_1
    v_smfmac_f32_16x16x64_bf16 v[64:67], v[28:31], a[200:207], v172
    v_smfmac_f32_16x16x64_bf16 v[68:71], v[28:31], a[232:239], v172
    s_branch g_48L9_3
g_48L13_0:
    s_waitcnt vmcnt(2)
    v_max3_u32 v19, v24, v25, v26
    v_max_u32 v19, v19, v27
    v_cmp_eq_u32 vcc, -1, v19
    s_nop 0
    s_cbranch_vccnz g_48F13_0
    v_smfmac_f32_16x16x64_bf16 v[64:67], v[24:27], a[192:199], v172
    v_smfmac_f32_16x16x64_bf16 v[68:71], v[24:27], a[224:231], v172
    s_branch g_48L12_2
g_48L13_3:
    s_waitcnt vmcnt(2)
    v_max3_u32 v19, v36, v37, v38
    v_max_u32 v19, v19, v39
    v_cmp_eq_u32 vcc, -1, v19
    s_nop 0
    s_cbranch_vccnz g_48F13_3
    v_smfmac_f32_16x16x64_bf16 v[64:67], v[36:39], a[216:223], v172
    v_smfmac_f32_16x16x64_bf16 v[68:71], v[36:39], a[248:255], v172
g_48L5_0:
    s_waitcnt vmcnt(1)
    v_max3_u32 v19, v24, v25, v26
    v_max_u32 v19, v19, v27
    v_cmp_eq_u32 vcc, -1, v19
    s_nop 0
    s_cbranch_vccnz g_48F5_0
    v_smfmac_f32_16x16x64_bf16 v[64:67], v[24:27], a[192:199], v172
    v_smfmac_f32_16x16x64_bf16 v[68:71], v[24:27], a[224:231], v172
    s_branch g_48L4_2
g_48L14_2:
    s_waitcnt vmcnt(2)
    v_max3_u32 v19, v32, v33, v34
    v_max_u32 v19, v19, v35
    v_cmp_eq_u32 vcc, -1, v19
    s_nop 0
    s_cbranch_vccnz g_48F14_2
    v_smfmac_f32_16x16x64_bf16 v[64:67], v[32:35], a[208:215], v172
    v_smfmac_f32_16x16x64_bf16 v[68:71], v[32:35], a[240:247], v172
g_48L10_3:
    s_waitcnt vmcnt(1)
    v_max3_u32 v19, v36, v37, v38
    v_max_u32 v19, v19, v39
    v_cmp_eq_u32 vcc, -1, v19
    s_nop 0
    s_cbranch_vccnz g_48F10_3
    v_smfmac_f32_16x16x64_bf16 v[64:67], v[36:39], a[216:223], v172
    v_smfmac_f32_16x16x64_bf16 v[68:71], v[36:39], a[248:255], v172
    s_branch g_48L2_1
g_48L14_3:
    s_waitcnt vmcnt(2)
    v_max3_u32 v19, v36, v37, v38
    v_max_u32 v19, v19, v39
    v_cmp_eq_u32 vcc, -1, v19
    s_nop 0
    s_cbranch_vccnz g_48F14_3
    v_smfmac_f32_16x16x64_bf16 v[64:67], v[36:39], a[216:223], v172
    v_smfmac_f32_16x16x64_bf16 v[68:71], v[36:39], a[248:255], v172
    s_branch g_48L6_1
g_48L3_1:
    s_waitcnt vmcnt(1)
    v_max3_u32 v19, v28, v29, v30
    v_max_u32 v19, v19, v31
    v_cmp_eq_u32 vcc, -1, v19
    s_nop 0
    s_cbranch_vccnz g_48F3_1
    v_smfmac_f32_16x16x64_bf16 v[64:67], v[28:31], a[200:207], v172
    v_smfmac_f32_16x16x64_bf16 v[68:71], v[28:31], a[232:239], v172
    s_branch g_48L1_0
g_48L6_2:
    s_waitcnt vmcnt(1)
    v_max3_u32 v19, v32, v33, v34
    v_max_u32 v19, v19, v35
    v_cmp_eq_u32 vcc, -1, v19
    s_nop 0
    s_cbranch_vccnz g_48F6_2
    v_smfmac_f32_16x16x64_bf16 v[64:67], v[32:35], a[208:215], v172
    v_smfmac_f32_16x16x64_bf16 v[68:71], v[32:35], a[240:247], v172
    s_branch g_48L2_1
g_48L9_0:
    s_waitcnt vmcnt(1)
    v_max3_u32 v19, v24, v25, v26
    v_max_u32 v19, v19, v27
    v_cmp_eq_u32 vcc, -1, v19
    s_nop 0
    s_cbranch_vccnz g_48F9_0
    v_smfmac_f32_16x16x64_bf16 v[64:67], v[24:27], a[192:199], v172
    v_smfmac_f32_16x16x64_bf16 v[68:71], v[24:27], a[224:231], v172
    s_branch g_48L8_3
g_48L12_3:
    s_waitcnt vmcnt(1)
    v_max3_u32 v19, v36, v37, v38
    v_max_u32 v19, v19, v39
    v_cmp_eq_u32 vcc, -1, v19
    s_nop 0
    s_cbranch_vccnz g_48F12_3
    v_smfmac_f32_16x16x64_bf16 v[64:67], v[36:39], a[216:223], v172
    v_smfmac_f32_16x16x64_bf16 v[68:71], v[36:39], a[248:255], v172
    s_branch g_48L4_2
g_48F15_0:
    s_mov_b64 exec, vcc
    buffer_load_dwordx4 v[24:27], v8, s[4:7], s16 offen offset:0 sc1
    s_mov_b64 exec, -1
    s_add_u32 s23, s23, 1
    s_cmp_lt_u32 s23, 200000
    s_cbranch_scc1 g_48L15_1
    s_mov_b32 s25, 200000
    s_branch gc_49
g_48F15_1:
    s_mov_b64 exec, vcc
    buffer_load_dwordx4 v[28:31], v8, s[4:7], s16 offen offset:1024 sc1
    s_mov_b64 exec, -1
    s_add_u32 s23, s23, 1
    s_cmp_lt_u32 s23, 200000
    s_cbranch_scc1 g_48L15_2
    s_mov_b32 s25, 200000
    s_branch gc_49
g_48F15_2:
    s_mov_b64 exec, vcc
    buffer_load_dwordx4 v[32:35], v8, s[4:7], s16 offen offset:2048 sc1
    s_mov_b64 exec, -1
    s_add_u32 s23, s23, 1
    s_cmp_lt_u32 s23, 200000
    s_cbranch_scc1 g_48L15_3
    s_mov_b32 s25, 200000
    s_branch gc_49
g_48F15_3:
    s_mov_b64 exec, vcc
    buffer_load_dwordx4 v[36:39], v8, s[4:7], s16 offen offset:3072 sc1
    s_mov_b64 exec, -1
    s_add_u32 s23, s23, 1
    s_cmp_lt_u32 s23, 200000
    s_cbranch_scc1 g_48L15_0
    s_mov_b32 s25, 200000
    s_branch gc_49
g_48F7_0:
    s_mov_b64 exec, vcc
    buffer_load_dwordx4 v[24:27], v8, s[4:7], s16 offen offset:0 sc1
    s_mov_b64 exec, -1
    s_add_u32 s23, s23, 1
    s_cmp_lt_u32 s23, 200000
    s_cbranch_scc1 g_48L7_1
    s_mov_b32 s25, 200000
    s_branch gc_49
g_48F7_1:
    s_mov_b64 exec, vcc
    buffer_load_dwordx4 v[28:31], v8, s[4:7], s16 offen offset:1024 sc1
    s_mov_b64 exec, -1
    s_add_u32 s23, s23, 1
    s_cmp_lt_u32 s23, 200000
    s_cbranch_scc1 g_48L7_2
    s_mov_b32 s25, 200000
    s_branch gc_49
g_48F7_2:
    s_mov_b64 exec, vcc
    buffer_load_dwordx4 v[32:35], v8, s[4:7], s16 offen offset:2048 sc1
    s_mov_b64 exec, -1
    s_add_u32 s23, s23, 1
    s_cmp_lt_u32 s23, 200000
    s_cbranch_scc1 g_48L7_0
    s_mov_b32 s25, 200000
    s_branch gc_49
g_48F11_0:
    s_mov_b64 exec, vcc
    buffer_load_dwordx4 v[24:27], v8, s[4:7], s16 offen offset:0 sc1
    s_mov_b64 exec, -1
    s_add_u32 s23, s23, 1
    s_cmp_lt_u32 s23, 200000
    s_cbranch_scc1 g_48L11_1
    s_mov_b32 s25, 200000
    s_branch gc_49
g_48F11_1:
    s_mov_b64 exec, vcc
    buffer_load_dwordx4 v[28:31], v8, s[4:7], s16 offen offset:1024 sc1
    s_mov_b64 exec, -1
    s_add_u32 s23, s23, 1
    s_cmp_lt_u32 s23, 200000
    s_cbranch_scc1 g_48L11_3
    s_mov_b32 s25, 200000
    s_branch gc_49
g_48F11_3:
    s_mov_b64 exec, vcc
    buffer_load_dwordx4 v[36:39], v8, s[4:7], s16 offen offset:3072 sc1
    s_mov_b64 exec, -1
    s_add_u32 s23, s23, 1
    s_cmp_lt_u32 s23, 200000
    s_cbranch_scc1 g_48L11_0
    s_mov_b32 s25, 200000
    s_branch gc_49
g_48F13_0:
    s_mov_b64 exec, vcc
    buffer_load_dwordx4 v[24:27], v8, s[4:7], s16 offen offset:0 sc1
    s_mov_b64 exec, -1
    s_add_u32 s23, s23, 1
    s_cmp_lt_u32 s23, 200000
    s_cbranch_scc1 g_48L13_2
    s_mov_b32 s25, 200000
    s_branch gc_49
g_48F13_2:
    s_mov_b64 exec, vcc
    buffer_load_dwordx4 v[32:35], v8, s[4:7], s16 offen offset:2048 sc1
    s_mov_b64 exec, -1
    s_add_u32 s23, s23, 1
    s_cmp_lt_u32 s23, 200000
    s_cbranch_scc1 g_48L13_3
    s_mov_b32 s25, 200000
    s_branch gc_49
g_48F13_3:
    s_mov_b64 exec, vcc
    buffer_load_dwordx4 v[36:39], v8, s[4:7], s16 offen offset:3072 sc1
    s_mov_b64 exec, -1
    s_add_u32 s23, s23, 1
    s_cmp_lt_u32 s23, 200000
    s_cbranch_scc1 g_48L13_0
    s_mov_b32 s25, 200000
    s_branch gc_49
g_48F14_1:
    s_mov_b64 exec, vcc
    buffer_load_dwordx4 v[28:31], v8, s[4:7], s16 offen offset:1024 sc1
    s_mov_b64 exec, -1
    s_add_u32 s23, s23, 1
    s_cmp_lt_u32 s23, 200000
    s_cbranch_scc1 g_48L14_2
    s_mov_b32 s25, 200000
    s_branch gc_49
g_48F14_2:
    s_mov_b64 exec, vcc
    buffer_load_dwordx4 v[32:35], v8, s[4:7], s16 offen offset:2048 sc1
    s_mov_b64 exec, -1
    s_add_u32 s23, s23, 1
    s_cmp_lt_u32 s23, 200000
    s_cbranch_scc1 g_48L14_3
    s_mov_b32 s25, 200000
    s_branch gc_49
g_48F14_3:
    s_mov_b64 exec, vcc
    buffer_load_dwordx4 v[36:39], v8, s[4:7], s16 offen offset:3072 sc1
    s_mov_b64 exec, -1
    s_add_u32 s23, s23, 1
    s_cmp_lt_u32 s23, 200000
    s_cbranch_scc1 g_48L14_1
    s_mov_b32 s25, 200000
    s_branch gc_49
g_48F3_0:
    s_mov_b64 exec, vcc
    buffer_load_dwordx4 v[24:27], v8, s[4:7], s16 offen offset:0 sc1
    s_mov_b64 exec, -1
    s_add_u32 s23, s23, 1
    s_cmp_lt_u32 s23, 200000
    s_cbranch_scc1 g_48L3_1
    s_mov_b32 s25, 200000
    s_branch gc_49
g_48F3_1:
    s_mov_b64 exec, vcc
    buffer_load_dwordx4 v[28:31], v8, s[4:7], s16 offen offset:1024 sc1
    s_mov_b64 exec, -1
    s_add_u32 s23, s23, 1
    s_cmp_lt_u32 s23, 200000
    s_cbranch_scc1 g_48L3_0
    s_mov_b32 s25, 200000
    s_branch gc_49
g_48F5_0:
    s_mov_b64 exec, vcc
    buffer_load_dwordx4 v[24:27], v8, s[4:7], s16 offen offset:0 sc1
    s_mov_b64 exec, -1
    s_add_u32 s23, s23, 1
    s_cmp_lt_u32 s23, 200000
    s_cbranch_scc1 g_48L5_2
    s_mov_b32 s25, 200000
    s_branch gc_49
g_48F5_2:
    s_mov_b64 exec, vcc
    buffer_load_dwordx4 v[32:35], v8, s[4:7], s16 offen offset:2048 sc1
    s_mov_b64 exec, -1
    s_add_u32 s23, s23, 1
    s_cmp_lt_u32 s23, 200000
    s_cbranch_scc1 g_48L5_0
    s_mov_b32 s25, 200000
    s_branch gc_49
g_48F6_1:
    s_mov_b64 exec, vcc
    buffer_load_dwordx4 v[28:31], v8, s[4:7], s16 offen offset:1024 sc1
    s_mov_b64 exec, -1
    s_add_u32 s23, s23, 1
    s_cmp_lt_u32 s23, 200000
    s_cbranch_scc1 g_48L6_2
    s_mov_b32 s25, 200000
    s_branch gc_49
g_48F6_2:
    s_mov_b64 exec, vcc
    buffer_load_dwordx4 v[32:35], v8, s[4:7], s16 offen offset:2048 sc1
    s_mov_b64 exec, -1
    s_add_u32 s23, s23, 1
    s_cmp_lt_u32 s23, 200000
    s_cbranch_scc1 g_48L6_1
    s_mov_b32 s25, 200000
    s_branch gc_49
g_48F9_0:
    s_mov_b64 exec, vcc
    buffer_load_dwordx4 v[24:27], v8, s[4:7], s16 offen offset:0 sc1
    s_mov_b64 exec, -1
    s_add_u32 s23, s23, 1
    s_cmp_lt_u32 s23, 200000
    s_cbranch_scc1 g_48L9_3
    s_mov_b32 s25, 200000
    s_branch gc_49
g_48F9_3:
    s_mov_b64 exec, vcc
    buffer_load_dwordx4 v[36:39], v8, s[4:7], s16 offen offset:3072 sc1
    s_mov_b64 exec, -1
    s_add_u32 s23, s23, 1
    s_cmp_lt_u32 s23, 200000
    s_cbranch_scc1 g_48L9_0
    s_mov_b32 s25, 200000
    s_branch gc_49
g_48F10_1:
    s_mov_b64 exec, vcc
    buffer_load_dwordx4 v[28:31], v8, s[4:7], s16 offen offset:1024 sc1
    s_mov_b64 exec, -1
    s_add_u32 s23, s23, 1
    s_cmp_lt_u32 s23, 200000
    s_cbranch_scc1 g_48L10_3
    s_mov_b32 s25, 200000
    s_branch gc_49
g_48F10_3:
    s_mov_b64 exec, vcc
    buffer_load_dwordx4 v[36:39], v8, s[4:7], s16 offen offset:3072 sc1
    s_mov_b64 exec, -1
    s_add_u32 s23, s23, 1
    s_cmp_lt_u32 s23, 200000
    s_cbranch_scc1 g_48L10_1
    s_mov_b32 s25, 200000
    s_branch gc_49
g_48F12_2:
    s_mov_b64 exec, vcc
    buffer_load_dwordx4 v[32:35], v8, s[4:7], s16 offen offset:2048 sc1
    s_mov_b64 exec, -1
    s_add_u32 s23, s23, 1
    s_cmp_lt_u32 s23, 200000
    s_cbranch_scc1 g_48L12_3
    s_mov_b32 s25, 200000
    s_branch gc_49
g_48F12_3:
    s_mov_b64 exec, vcc
    buffer_load_dwordx4 v[36:39], v8, s[4:7], s16 offen offset:3072 sc1
    s_mov_b64 exec, -1
    s_add_u32 s23, s23, 1
    s_cmp_lt_u32 s23, 200000
    s_cbranch_scc1 g_48L12_2
    s_mov_b32 s25, 200000
    s_branch gc_49
g_48F1_0:
    s_mov_b64 exec, vcc
    buffer_load_dwordx4 v[24:27], v8, s[4:7], s16 offen offset:0 sc1
    s_mov_b64 exec, -1
    s_add_u32 s23, s23, 1
    s_cmp_lt_u32 s23, 200000
    s_cbranch_scc1 g_48L1_0
    s_mov_b32 s25, 200000
    s_branch gc_49
g_48F2_1:
    s_mov_b64 exec, vcc
    buffer_load_dwordx4 v[28:31], v8, s[4:7], s16 offen offset:1024 sc1
    s_mov_b64 exec, -1
    s_add_u32 s23, s23, 1
    s_cmp_lt_u32 s23, 200000
    s_cbranch_scc1 g_48L2_1
    s_mov_b32 s25, 200000
    s_branch gc_49
g_48F4_2:
    s_mov_b64 exec, vcc
    buffer_load_dwordx4 v[32:35], v8, s[4:7], s16 offen offset:2048 sc1
    s_mov_b64 exec, -1
    s_add_u32 s23, s23, 1
    s_cmp_lt_u32 s23, 200000
    s_cbranch_scc1 g_48L4_2
    s_mov_b32 s25, 200000
    s_branch gc_49
g_48F8_3:
    s_mov_b64 exec, vcc
    buffer_load_dwordx4 v[36:39], v8, s[4:7], s16 offen offset:3072 sc1
    s_mov_b64 exec, -1
    s_add_u32 s23, s23, 1
    s_cmp_lt_u32 s23, 200000
    s_cbranch_scc1 g_48L8_3
    s_mov_b32 s25, 200000
    s_branch gc_49
pr_50:
    v_max3_u32 v19, v96, v97, v98
    v_max3_u32 v19, v19, v99, v100
    v_max3_u32 v19, v19, v101, v102
    v_max3_u32 v19, v19, v103, v104
    v_max3_u32 v19, v19, v105, v106
    v_max_u32 v19, v19, v107
    v_cmp_eq_u32 vcc, -1, v19
    s_nop 0
    s_cbranch_vccz pg_51
    buffer_load_dwordx4 v[96:99], v10, s[4:7], s84 offen sc1
    buffer_load_dwordx4 v[100:103], v23, s[4:7], s84 offen sc1
    buffer_load_dwordx4 v[104:107], v244, s[4:7], s84 offen sc1
    s_add_u32 s23, s23, 1
    s_cmp_lt_u32 s23, 200000
    s_cbranch_scc1 pb_52
    s_mov_b32 s25, 200000
    s_branch pg_51
.p2align 6
recur_slow_w0:
    s_nop 15
    s_mov_b32 s23, s25
g_54:
    buffer_load_dwordx4 v[24:27], v2, s[4:7], s16 offen offset:0 sc1
    buffer_load_dwordx4 v[28:31], v2, s[4:7], s16 offen offset:1024 sc1
    buffer_load_dwordx4 v[32:35], v2, s[4:7], s16 offen offset:2048 sc1
    buffer_load_dwordx4 v[36:39], v2, s[4:7], s16 offen offset:3072 sc1
    s_waitcnt vmcnt(0)
    v_max3_u32 v19, v24, v25, v26
    v_max3_u32 v19, v19, v27, v28
    v_max3_u32 v19, v19, v29, v30
    v_max3_u32 v19, v19, v31, v32
    v_max3_u32 v19, v19, v33, v34
    v_max3_u32 v19, v19, v35, v36
    v_max3_u32 v19, v19, v37, v38
    v_max_u32 v19, v19, v39
    v_cmp_eq_u32 vcc, -1, v19
    s_nop 0
    s_cbranch_vccz g_54k
    s_add_u32 s23, s23, 1
    s_cmp_lt_u32 s23, 200000
    s_cbranch_scc1 g_54
    s_mov_b32 s25, 200000
g_54k:
    v_smfmac_f32_16x16x64_bf16 v[40:43], v[24:27], a[0:7], v172
    v_smfmac_f32_16x16x64_bf16 v[44:47], v[24:27], a[64:71], v172
    v_smfmac_f32_16x16x64_bf16 v[48:51], v[24:27], a[32:39], v172
    v_smfmac_f32_16x16x64_bf16 v[52:55], v[24:27], a[96:103], v172
    v_smfmac_f32_16x16x64_bf16 v[40:43], v[28:31], a[8:15], v172
    v_smfmac_f32_16x16x64_bf16 v[44:47], v[28:31], a[72:79], v172
    v_smfmac_f32_16x16x64_bf16 v[48:51], v[28:31], a[40:47], v172
    v_smfmac_f32_16x16x64_bf16 v[52:55], v[28:31], a[104:111], v172
    v_smfmac_f32_16x16x64_bf16 v[40:43], v[32:35], a[16:23], v172
    v_smfmac_f32_16x16x64_bf16 v[44:47], v[32:35], a[80:87], v172
    v_smfmac_f32_16x16x64_bf16 v[48:51], v[32:35], a[48:55], v172
    v_smfmac_f32_16x16x64_bf16 v[52:55], v[32:35], a[112:119], v172
    v_smfmac_f32_16x16x64_bf16 v[40:43], v[36:39], a[24:31], v172
    v_smfmac_f32_16x16x64_bf16 v[44:47], v[36:39], a[88:95], v172
    v_smfmac_f32_16x16x64_bf16 v[48:51], v[36:39], a[56:63], v172
    v_smfmac_f32_16x16x64_bf16 v[52:55], v[36:39], a[120:127], v172
    v_cvt_pk_bf16_f32 v72, v40, v41
    v_cvt_pk_bf16_f32 v73, v42, v43
    v_cvt_pk_bf16_f32 v74, v44, v45
    v_cvt_pk_bf16_f32 v75, v46, v47
    v_smfmac_f32_16x16x64_bf16 v[56:59], v[24:27], a[128:135], v172
    v_cvt_pk_bf16_f32 v76, v48, v49
    v_cvt_pk_bf16_f32 v77, v50, v51
    s_nop 0
    v_cvt_pk_bf16_f32 v78, v52, v53
    v_cvt_pk_bf16_f32 v79, v54, v55
    v_smfmac_f32_16x16x64_bf16 v[60:63], v[24:27], a[160:167], v172
    v_mfma_f32_16x16x32_bf16 v[88:91], v[72:75], v[84:87], 0
    v_mfma_f32_16x16x32_bf16 v[92:95], v[76:79], v[84:87], 0
    v_smfmac_f32_16x16x64_bf16 v[56:59], v[28:31], a[136:143], v172
    v_smfmac_f32_16x16x64_bf16 v[60:63], v[28:31], a[168:175], v172
    s_barrier
    ds_read_b128 v[104:107], v16 offset:2048
    ds_read_b128 v[108:111], v16 offset:3072
    ds_read_b128 v[112:115], v16 offset:4096
    ds_read_b128 v[116:119], v16 offset:5120
    ds_read_b128 v[120:123], v16 offset:6144
    ds_read_b128 v[124:127], v16 offset:7168
    v_smfmac_f32_16x16x64_bf16 v[56:59], v[32:35], a[144:151], v172
    v_smfmac_f32_16x16x64_bf16 v[60:63], v[32:35], a[176:183], v172
    v_smfmac_f32_16x16x64_bf16 v[56:59], v[36:39], a[152:159], v172
    v_smfmac_f32_16x16x64_bf16 v[60:63], v[36:39], a[184:191], v172
    s_waitcnt lgkmcnt(5)
    v_mfma_f32_16x16x32_bf16 v[88:91], v[104:107], v[84:87], v[88:91]
    s_waitcnt lgkmcnt(4)
    v_mfma_f32_16x16x32_bf16 v[92:95], v[108:111], v[84:87], v[92:95]
    s_waitcnt lgkmcnt(3)
    v_mfma_f32_16x16x32_bf16 v[88:91], v[112:115], v[84:87], v[88:91]
    s_waitcnt lgkmcnt(2)
    v_mfma_f32_16x16x32_bf16 v[92:95], v[116:119], v[84:87], v[92:95]
    s_waitcnt lgkmcnt(1)
    v_mfma_f32_16x16x32_bf16 v[88:91], v[120:123], v[84:87], v[88:91]
    s_waitcnt lgkmcnt(0)
    v_mfma_f32_16x16x32_bf16 v[92:95], v[124:127], v[84:87], v[92:95]
    v_cvt_pk_bf16_f32 v80, v56, v57
    v_cvt_pk_bf16_f32 v81, v58, v59
    v_cvt_pk_bf16_f32 v82, v60, v61
    v_cvt_pk_bf16_f32 v83, v62, v63
    ds_write_b128 v17, v[80:83] offset:8192
    s_nop 0
    v_cvt_pk_bf16_f32 v128, v88, v89
    v_cvt_pk_bf16_f32 v129, v90, v91
    v_cvt_pk_bf16_f32 v130, v92, v93
    v_cvt_pk_bf16_f32 v131, v94, v95
    s_nop 1
    v_mfma_f32_16x16x32_bf16 v[144:147], v[132:135], v[128:131], 0
    v_mfma_f32_16x16x32_bf16 v[148:151], v[136:139], v[128:131], 0
    v_mfma_f32_16x16x32_bf16 v[140:143], v[128:131], v[128:131], 0
    s_nop 1
    buffer_store_dwordx4 v[144:147], v3, s[4:7], s16 offen sc1
    s_nop 1
    buffer_store_dwordx4 v[148:151], v3, s[4:7], s16 offen offset:128 sc1
    s_nop 1
    buffer_store_dwordx4 v[140:143], v4, s[4:7], s16 offen sc1
    s_cmp_eq_u32 s15, 63
    s_waitcnt lgkmcnt(0)
    s_barrier
    s_cbranch_scc1 recur_slow_last0
    s_nop 15
    s_nop 15
    s_nop 15
    buffer_load_dwordx4 v[132:135], v12, s[4:7], s17 offen sc1
    buffer_load_dwordx4 v[136:139], v12, s[4:7], s17 offen offset:256 sc1
    s_add_u32 s17, s17, 2048
    s_min_u32 s17, s17, 17954816
    buffer_store_dwordx4 v[128:131], v14, s[4:7], s19 offen sc1
    s_add_u32 s19, s19, 512
    s_barrier
    s_nop 15
    s_mov_b32 s23, s25
g_55:
    buffer_load_dwordx4 v[24:27], v8, s[4:7], s16 offen offset:0 sc1
    buffer_load_dwordx4 v[28:31], v8, s[4:7], s16 offen offset:1024 sc1
    buffer_load_dwordx4 v[32:35], v8, s[4:7], s16 offen offset:2048 sc1
    buffer_load_dwordx4 v[36:39], v8, s[4:7], s16 offen offset:3072 sc1
    s_waitcnt vmcnt(0)
    v_max3_u32 v19, v24, v25, v26
    v_max3_u32 v19, v19, v27, v28
    v_max3_u32 v19, v19, v29, v30
    v_max3_u32 v19, v19, v31, v32
    v_max3_u32 v19, v19, v33, v34
    v_max3_u32 v19, v19, v35, v36
    v_max3_u32 v19, v19, v37, v38
    v_max_u32 v19, v19, v39
    v_cmp_eq_u32 vcc, -1, v19
    s_nop 0
    s_cbranch_vccz g_55k
    s_add_u32 s23, s23, 1
    s_cmp_lt_u32 s23, 200000
    s_cbranch_scc1 g_55
    s_mov_b32 s25, 200000
g_55k:
    v_smfmac_f32_16x16x64_bf16 v[64:67], v[24:27], a[192:199], v172
    v_smfmac_f32_16x16x64_bf16 v[68:71], v[24:27], a[224:231], v172
    v_smfmac_f32_16x16x64_bf16 v[64:67], v[28:31], a[200:207], v172
    v_smfmac_f32_16x16x64_bf16 v[68:71], v[28:31], a[232:239], v172
    v_smfmac_f32_16x16x64_bf16 v[64:67], v[32:35], a[208:215], v172
    v_smfmac_f32_16x16x64_bf16 v[68:71], v[32:35], a[240:247], v172
    v_smfmac_f32_16x16x64_bf16 v[64:67], v[36:39], a[216:223], v172
    v_smfmac_f32_16x16x64_bf16 v[68:71], v[36:39], a[248:255], v172
    s_nop 4
    v_cvt_pk_bf16_f32 v80, v64, v65
    v_cvt_pk_bf16_f32 v81, v66, v67
    s_nop 0
    v_cvt_pk_bf16_f32 v82, v68, v69
    v_cvt_pk_bf16_f32 v83, v70, v71
    ds_write_b128 v17, v[80:83] offset:9216
    s_waitcnt lgkmcnt(0)
    s_barrier
    s_nop 15
    s_nop 15
    s_nop 15
    v_mov_b32 v40, 0
    v_mov_b32 v41, 0
    v_mov_b32 v42, 0
    v_mov_b32 v43, 0
    v_mov_b32 v44, 0
    v_mov_b32 v45, 0
    v_mov_b32 v46, 0
    v_mov_b32 v47, 0
    v_mov_b32 v48, 0
    v_mov_b32 v49, 0
    v_mov_b32 v50, 0
    v_mov_b32 v51, 0
    v_mov_b32 v52, 0
    v_mov_b32 v53, 0
    v_mov_b32 v54, 0
    v_mov_b32 v55, 0
    v_mov_b32 v56, 0
    v_mov_b32 v57, 0
    v_mov_b32 v58, 0
    v_mov_b32 v59, 0
    v_mov_b32 v60, 0
    v_mov_b32 v61, 0
    v_mov_b32 v62, 0
    v_mov_b32 v63, 0
    v_mov_b32 v64, 0
    v_mov_b32 v65, 0
    v_mov_b32 v66, 0
    v_mov_b32 v67, 0
    v_mov_b32 v68, 0
    v_mov_b32 v69, 0
    v_mov_b32 v70, 0
    v_mov_b32 v71, 0
    s_add_u32 s94, s15, 3
    s_min_u32 s94, s94, 64
    s_mov_b32 s23, s25
fw_56:
    s_cmp_ge_u32 s85, s94
    s_cbranch_scc1 fo_57
    buffer_load_dword v19, v245, s[4:7], 0 offen sc1
    s_add_u32 s23, s23, 1
    s_waitcnt vmcnt(0)
    v_readfirstlane_b32 s85, v19
    s_cmp_lt_u32 s23, 200000
    s_cbranch_scc1 fw_56
    s_mov_b32 s25, 200000
fo_57:
    s_mov_b32 s21, s16
    s_mov_b32 s16, s42
    s_mov_b32 s42, s43
    s_mov_b32 s43, s44
    s_mov_b32 s44, s21
    s_add_u32 s95, s95, 524288
    s_lshr_b32 s84, s95, 8
    s_and_b32 s84, s84, 8192
    s_xor_b32 s84, s84, s46
    s_add_u32 s84, s84, s95
    s_add_u32 s15, s15, 1
    s_barrier
    s_branch recur_slow_w0
recur_slow_last0:
    buffer_store_dwordx4 v[128:131], v14, s[4:7], s19 offen sc1
    s_branch recur_end
.p2align 6
recur_slow_w1:
    s_nop 15
    s_mov_b32 s23, s25
g_58:
    buffer_load_dwordx4 v[24:27], v2, s[4:7], s16 offen offset:0 sc1
    buffer_load_dwordx4 v[28:31], v2, s[4:7], s16 offen offset:1024 sc1
    buffer_load_dwordx4 v[32:35], v2, s[4:7], s16 offen offset:2048 sc1
    buffer_load_dwordx4 v[36:39], v2, s[4:7], s16 offen offset:3072 sc1
    s_waitcnt vmcnt(0)
    v_max3_u32 v19, v24, v25, v26
    v_max3_u32 v19, v19, v27, v28
    v_max3_u32 v19, v19, v29, v30
    v_max3_u32 v19, v19, v31, v32
    v_max3_u32 v19, v19, v33, v34
    v_max3_u32 v19, v19, v35, v36
    v_max3_u32 v19, v19, v37, v38
    v_max_u32 v19, v19, v39
    v_cmp_eq_u32 vcc, -1, v19
    s_nop 0
    s_cbranch_vccz g_58k
    s_add_u32 s23, s23, 1
    s_cmp_lt_u32 s23, 200000
    s_cbranch_scc1 g_58
    s_mov_b32 s25, 200000
g_58k:
    v_smfmac_f32_16x16x64_bf16 v[40:43], v[24:27], a[0:7], v172
    v_smfmac_f32_16x16x64_bf16 v[44:47], v[24:27], a[64:71], v172
    v_smfmac_f32_16x16x64_bf16 v[48:51], v[24:27], a[32:39], v172
    v_smfmac_f32_16x16x64_bf16 v[52:55], v[24:27], a[96:103], v172
    v_smfmac_f32_16x16x64_bf16 v[40:43], v[28:31], a[8:15], v172
    v_smfmac_f32_16x16x64_bf16 v[44:47], v[28:31], a[72:79], v172
    v_smfmac_f32_16x16x64_bf16 v[48:51], v[28:31], a[40:47], v172
    v_smfmac_f32_16x16x64_bf16 v[52:55], v[28:31], a[104:111], v172
    v_smfmac_f32_16x16x64_bf16 v[40:43], v[32:35], a[16:23], v172
    v_smfmac_f32_16x16x64_bf16 v[44:47], v[32:35], a[80:87], v172
    v_smfmac_f32_16x16x64_bf16 v[48:51], v[32:35], a[48:55], v172
    v_smfmac_f32_16x16x64_bf16 v[52:55], v[32:35], a[112:119], v172
    v_smfmac_f32_16x16x64_bf16 v[40:43], v[36:39], a[24:31], v172
    v_smfmac_f32_16x16x64_bf16 v[44:47], v[36:39], a[88:95], v172
    v_smfmac_f32_16x16x64_bf16 v[48:51], v[36:39], a[56:63], v172
    v_smfmac_f32_16x16x64_bf16 v[52:55], v[36:39], a[120:127], v172
    v_cvt_pk_bf16_f32 v72, v40, v41
    v_cvt_pk_bf16_f32 v73, v42, v43
    v_cvt_pk_bf16_f32 v74, v44, v45
    v_cvt_pk_bf16_f32 v75, v46, v47
    ds_write_b128 v17, v[72:75] offset:0
    v_cvt_pk_bf16_f32 v76, v48, v49
    v_cvt_pk_bf16_f32 v77, v50, v51
    s_nop 0
    v_cvt_pk_bf16_f32 v78, v52, v53
    v_cvt_pk_bf16_f32 v79, v54, v55
    ds_write_b128 v17, v[76:79] offset:1024
    v_smfmac_f32_16x16x64_bf16 v[56:59], v[24:27], a[128:135], v172
    v_smfmac_f32_16x16x64_bf16 v[60:63], v[24:27], a[160:167], v172
    v_smfmac_f32_16x16x64_bf16 v[56:59], v[28:31], a[136:143], v172
    s_waitcnt lgkmcnt(0)
    s_barrier
    v_smfmac_f32_16x16x64_bf16 v[60:63], v[28:31], a[168:175], v172
    v_smfmac_f32_16x16x64_bf16 v[56:59], v[32:35], a[144:151], v172
    v_smfmac_f32_16x16x64_bf16 v[60:63], v[32:35], a[176:183], v172
    v_smfmac_f32_16x16x64_bf16 v[56:59], v[36:39], a[152:159], v172
    v_smfmac_f32_16x16x64_bf16 v[60:63], v[36:39], a[184:191], v172
    s_nop 4
    v_cvt_pk_bf16_f32 v80, v56, v57
    v_cvt_pk_bf16_f32 v81, v58, v59
    s_nop 0
    v_cvt_pk_bf16_f32 v82, v60, v61
    v_cvt_pk_bf16_f32 v83, v62, v63
    ds_write_b128 v17, v[80:83] offset:8192
    s_cmp_eq_u32 s15, 63
    s_waitcnt lgkmcnt(0)
    s_barrier
    s_cbranch_scc1 recur_end
    s_nop 15
    s_nop 15
    buffer_load_dwordx4 v[208:211], v5, s[4:7], s16 offen offset:0 sc1
    buffer_load_dwordx4 v[212:215], v5, s[4:7], s16 offen offset:1024 sc1
    buffer_load_dwordx4 v[216:219], v5, s[4:7], s16 offen offset:2048 sc1
    buffer_load_dwordx4 v[220:223], v5, s[4:7], s16 offen offset:3072 sc1
    buffer_load_dword v224, v6, s[4:7], s16 offen offset:0 sc1
    buffer_load_dword v225, v6, s[4:7], s16 offen offset:256 sc1
    buffer_load_dword v226, v6, s[4:7], s16 offen offset:512 sc1
    buffer_load_dword v227, v6, s[4:7], s16 offen offset:768 sc1
    buffer_load_dwordx4 v[228:231], v13, s[4:7], s18 offen offset:0 sc1
    buffer_load_dwordx4 v[232:235], v13, s[4:7], s18 offen offset:256 sc1
    s_add_u32 s18, s18, 2048
    s_min_u32 s18, s18, 35780608
    s_mov_b32 s23, s25
    ds_read_b128 v[96:99], v16 offset:8192
    ds_read_b128 v[104:107], v16 offset:12288
    ds_read_b128 v[108:111], v16 offset:14336
    v_mfma_f32_16x16x32_bf16 v[140:143], v[84:87], v[80:83], 0
    s_waitcnt lgkmcnt(2)
    v_mfma_f32_16x16x32_bf16 v[140:143], v[84:87], v[96:99], v[140:143]
    s_waitcnt lgkmcnt(1)
    v_mfma_f32_16x16x32_bf16 v[140:143], v[84:87], v[104:107], v[140:143]
    s_waitcnt lgkmcnt(0)
    v_mfma_f32_16x16x32_bf16 v[140:143], v[84:87], v[108:111], v[140:143]
    s_nop 7
    v_cvt_pk_bf16_f32 v154, v140, v179
    v_cvt_pk_bf16_f32 v158, v141, v179
    v_cvt_pk_bf16_f32 v162, v142, v179
    v_cvt_pk_bf16_f32 v166, v143, v179
    s_waitcnt vmcnt(8)
ss_59:
    v_pk_add_f32 v[180:181], v[208:209], v[212:213]
    v_pk_add_f32 v[182:183], v[210:211], v[214:215]
    s_waitcnt vmcnt(6)
    v_pk_add_f32 v[96:97], v[216:217], v[220:221]
    v_pk_add_f32 v[98:99], v[218:219], v[222:223]
    v_pk_add_f32 v[180:181], v[180:181], v[96:97]
    v_pk_add_f32 v[182:183], v[182:183], v[98:99]
    s_waitcnt vmcnt(2)
    v_pk_add_f32 v[100:101], v[224:225], v[226:227]
    v_cmp_u_f32 s[86:87], v180, v181
    v_add_f32 v184, v100, v101
    v_cmp_u_f32 s[88:89], v182, v183
    v_max3_f32 v185, v180, v181, v182
    v_cmp_u_f32 vcc, v184, v184
    v_max3_f32 v185, v185, v183, v184
    s_or_b64 s[86:87], s[86:87], s[88:89]
    s_or_b64 vcc, vcc, s[86:87]
    v_max_f32_dpp v185, v185, v185 row_ror:8 row_mask:0xf bank_mask:0xf
    s_cbranch_scc1 sb_60
sg_61:
    v_mov_b32 v186, v185
    s_nop 1
    v_permlane16_swap_b32 v185, v186
    v_max_f32 v185, v185, v186
    v_mov_b32 v186, v185
    s_nop 1
    v_permlane32_swap_b32 v185, v186
    v_max_f32 v185, v185, v186
    v_mul_f32 v185, s24, v185
    v_fma_f32 v180, v180, s24, -v185
    v_fma_f32 v181, v181, s24, -v185
    v_fma_f32 v182, v182, s24, -v185
    v_fma_f32 v183, v183, s24, -v185
    v_fma_f32 v184, v184, s24, -v185
    v_exp_f32 v180, v180
    v_exp_f32 v181, v181
    v_exp_f32 v182, v182
    v_exp_f32 v183, v183
    v_exp_f32 v184, v184
    v_cvt_pk_bf16_f32 v176, v180, v181
    v_cvt_pk_bf16_f32 v177, v182, v183
    v_cvt_pk_bf16_f32 v178, v184, v179
    s_nop 1
    v_mfma_f32_16x16x32_bf16 v[240:243], v[236:239], v[176:179], 0
    v_mfma_f32_16x16x32_bf16 v[188:191], v[152:155], v[176:179], 0
    v_mfma_f32_16x16x32_bf16 v[192:195], v[156:159], v[176:179], 0
    v_mfma_f32_16x16x32_bf16 v[196:199], v[160:163], v[176:179], 0
    v_mfma_f32_16x16x32_bf16 v[200:203], v[164:167], v[176:179], 0
    v_add_f32_dpp v185, v240, v240 row_ror:8 row_mask:0xf bank_mask:0xf
    v_rcp_f32 v185, v185
    v_add_f32_dpp v88, v192, v188 row_ror:8 row_mask:0xf bank_mask:0x3
    v_add_f32_dpp v89, v193, v189 row_ror:8 row_mask:0xf bank_mask:0x3
    v_add_f32_dpp v90, v194, v190 row_ror:8 row_mask:0xf bank_mask:0x3
    v_add_f32_dpp v91, v195, v191 row_ror:8 row_mask:0xf bank_mask:0x3
    s_nop 1
    v_add_f32_dpp v88, v196, v200 row_ror:8 row_mask:0xf bank_mask:0xc
    v_add_f32_dpp v89, v197, v201 row_ror:8 row_mask:0xf bank_mask:0xc
    v_add_f32_dpp v90, v198, v202 row_ror:8 row_mask:0xf bank_mask:0xc
    v_add_f32_dpp v91, v199, v203 row_ror:8 row_mask:0xf bank_mask:0xc
    v_mul_f32 v88, v88, v185
    v_mul_f32 v89, v89, v185
    v_mul_f32 v90, v90, v185
    v_mul_f32 v91, v91, v185
    v_cvt_pk_bf16_f32 v88, v88, v89
    v_cvt_pk_bf16_f32 v89, v90, v91
    buffer_store_dwordx2 v[88:89], v7, s[4:7], s16 offen sc1
    s_barrier
    s_nop 15
    s_mov_b32 s23, s25
g_62:
    buffer_load_dwordx4 v[24:27], v8, s[4:7], s16 offen offset:0 sc1
    buffer_load_dwordx4 v[28:31], v8, s[4:7], s16 offen offset:1024 sc1
    buffer_load_dwordx4 v[32:35], v8, s[4:7], s16 offen offset:2048 sc1
    buffer_load_dwordx4 v[36:39], v8, s[4:7], s16 offen offset:3072 sc1
    s_waitcnt vmcnt(0)
    v_max3_u32 v19, v24, v25, v26
    v_max3_u32 v19, v19, v27, v28
    v_max3_u32 v19, v19, v29, v30
    v_max3_u32 v19, v19, v31, v32
    v_max3_u32 v19, v19, v33, v34
    v_max3_u32 v19, v19, v35, v36
    v_max3_u32 v19, v19, v37, v38
    v_max_u32 v19, v19, v39
    v_cmp_eq_u32 vcc, -1, v19
    s_nop 0
    s_cbranch_vccz g_62k
    s_add_u32 s23, s23, 1
    s_cmp_lt_u32 s23, 200000
    s_cbranch_scc1 g_62
    s_mov_b32 s25, 200000
g_62k:
    v_smfmac_f32_16x16x64_bf16 v[64:67], v[24:27], a[192:199], v172
    v_smfmac_f32_16x16x64_bf16 v[68:71], v[24:27], a[224:231], v172
    v_smfmac_f32_16x16x64_bf16 v[64:67], v[28:31], a[200:207], v172
    v_smfmac_f32_16x16x64_bf16 v[68:71], v[28:31], a[232:239], v172
    v_smfmac_f32_16x16x64_bf16 v[64:67], v[32:35], a[208:215], v172
    v_smfmac_f32_16x16x64_bf16 v[68:71], v[32:35], a[240:247], v172
    v_smfmac_f32_16x16x64_bf16 v[64:67], v[36:39], a[216:223], v172
    v_smfmac_f32_16x16x64_bf16 v[68:71], v[36:39], a[248:255], v172
    s_nop 4
    v_cvt_pk_bf16_f32 v80, v64, v65
    v_cvt_pk_bf16_f32 v81, v66, v67
    s_nop 0
    v_cvt_pk_bf16_f32 v82, v68, v69
    v_cvt_pk_bf16_f32 v83, v70, v71
    ds_write_b128 v17, v[80:83] offset:9216
    s_waitcnt lgkmcnt(0)
    s_barrier
    s_nop 15
    s_nop 15
    s_nop 15
    v_mov_b32 v152, v228
    v_mov_b32 v153, v229
    v_mov_b32 v156, v230
    v_mov_b32 v157, v231
    v_mov_b32 v160, v232
    v_mov_b32 v161, v233
    v_mov_b32 v164, v234
    v_mov_b32 v165, v235
    v_mov_b32 v40, 0
    v_mov_b32 v41, 0
    v_mov_b32 v42, 0
    v_mov_b32 v43, 0
    v_mov_b32 v44, 0
    v_mov_b32 v45, 0
    v_mov_b32 v46, 0
    v_mov_b32 v47, 0
    v_mov_b32 v48, 0
    v_mov_b32 v49, 0
    v_mov_b32 v50, 0
    v_mov_b32 v51, 0
    v_mov_b32 v52, 0
    v_mov_b32 v53, 0
    v_mov_b32 v54, 0
    v_mov_b32 v55, 0
    v_mov_b32 v56, 0
    v_mov_b32 v57, 0
    v_mov_b32 v58, 0
    v_mov_b32 v59, 0
    v_mov_b32 v60, 0
    v_mov_b32 v61, 0
    v_mov_b32 v62, 0
    v_mov_b32 v63, 0
    v_mov_b32 v64, 0
    v_mov_b32 v65, 0
    v_mov_b32 v66, 0
    v_mov_b32 v67, 0
    v_mov_b32 v68, 0
    v_mov_b32 v69, 0
    v_mov_b32 v70, 0
    v_mov_b32 v71, 0
    s_add_u32 s94, s15, 3
    s_min_u32 s94, s94, 64
    s_mov_b32 s23, s25
fw_63:
    s_cmp_ge_u32 s85, s94
    s_cbranch_scc1 fo_64
    buffer_load_dword v19, v245, s[4:7], 0 offen sc1
    s_add_u32 s23, s23, 1
    s_waitcnt vmcnt(0)
    v_readfirstlane_b32 s85, v19
    s_cmp_lt_u32 s23, 200000
    s_cbranch_scc1 fw_63
    s_mov_b32 s25, 200000
fo_64:
    s_mov_b32 s21, s16
    s_mov_b32 s16, s42
    s_mov_b32 s42, s43
    s_mov_b32 s43, s44
    s_mov_b32 s44, s21
    s_add_u32 s95, s95, 524288
    s_lshr_b32 s84, s95, 8
    s_and_b32 s84, s84, 8192
    s_xor_b32 s84, s84, s46
    s_add_u32 s84, s84, s95
    s_add_u32 s15, s15, 1
    s_barrier
    s_branch recur_slow_w1
sb_60:
    v_max3_u32 v19, v208, v209, v210
    v_max3_u32 v19, v19, v211, v212
    v_max3_u32 v19, v19, v213, v214
    v_max3_u32 v19, v19, v215, v216
    v_max3_u32 v19, v19, v217, v218
    v_max3_u32 v19, v19, v219, v220
    v_max3_u32 v19, v19, v221, v222
    v_max3_u32 v19, v19, v223, v224
    v_max3_u32 v19, v19, v225, v226
    v_max_u32 v19, v19, v227
    v_cmp_eq_u32 vcc, -1, v19
    s_nop 0
    s_cbranch_vccz sg_61
    buffer_load_dwordx4 v[208:211], v5, s[4:7], s16 offen offset:0 sc1
    buffer_load_dwordx4 v[212:215], v5, s[4:7], s16 offen offset:1024 sc1
    buffer_load_dwordx4 v[216:219], v5, s[4:7], s16 offen offset:2048 sc1
    buffer_load_dwordx4 v[220:223], v5, s[4:7], s16 offen offset:3072 sc1
    buffer_load_dword v224, v6, s[4:7], s16 offen offset:0 sc1
    buffer_load_dword v225, v6, s[4:7], s16 offen offset:256 sc1
    buffer_load_dword v226, v6, s[4:7], s16 offen offset:512 sc1
    buffer_load_dword v227, v6, s[4:7], s16 offen offset:768 sc1
    s_waitcnt vmcnt(0)
    s_add_u32 s23, s23, 1
    s_cmp_lt_u32 s23, 200000
    s_cbranch_scc1 ss_59
    s_mov_b32 s25, 200000
    s_branch sg_61
.p2align 6
recur_slow_w2:
    s_nop 15
    s_mov_b32 s23, s25
g_65:
    buffer_load_dwordx4 v[24:27], v2, s[4:7], s16 offen offset:0 sc1
    buffer_load_dwordx4 v[28:31], v2, s[4:7], s16 offen offset:1024 sc1
    buffer_load_dwordx4 v[32:35], v2, s[4:7], s16 offen offset:2048 sc1
    buffer_load_dwordx4 v[36:39], v2, s[4:7], s16 offen offset:3072 sc1
    s_waitcnt vmcnt(0)
    v_max3_u32 v19, v24, v25, v26
    v_max3_u32 v19, v19, v27, v28
    v_max3_u32 v19, v19, v29, v30
    v_max3_u32 v19, v19, v31, v32
    v_max3_u32 v19, v19, v33, v34
    v_max3_u32 v19, v19, v35, v36
    v_max3_u32 v19, v19, v37, v38
    v_max_u32 v19, v19, v39
    v_cmp_eq_u32 vcc, -1, v19
    s_nop 0
    s_cbranch_vccz g_65k
    s_add_u32 s23, s23, 1
    s_cmp_lt_u32 s23, 200000
    s_cbranch_scc1 g_65
    s_mov_b32 s25, 200000
g_65k:
    v_smfmac_f32_16x16x64_bf16 v[40:43], v[24:27], a[0:7], v172
    v_smfmac_f32_16x16x64_bf16 v[44:47], v[24:27], a[64:71], v172
    v_smfmac_f32_16x16x64_bf16 v[48:51], v[24:27], a[32:39], v172
    v_smfmac_f32_16x16x64_bf16 v[52:55], v[24:27], a[96:103], v172
    v_smfmac_f32_16x16x64_bf16 v[40:43], v[28:31], a[8:15], v172
    v_smfmac_f32_16x16x64_bf16 v[44:47], v[28:31], a[72:79], v172
    v_smfmac_f32_16x16x64_bf16 v[48:51], v[28:31], a[40:47], v172
    v_smfmac_f32_16x16x64_bf16 v[52:55], v[28:31], a[104:111], v172
    v_smfmac_f32_16x16x64_bf16 v[40:43], v[32:35], a[16:23], v172
    v_smfmac_f32_16x16x64_bf16 v[44:47], v[32:35], a[80:87], v172
    v_smfmac_f32_16x16x64_bf16 v[48:51], v[32:35], a[48:55], v172
    v_smfmac_f32_16x16x64_bf16 v[52:55], v[32:35], a[112:119], v172
    v_smfmac_f32_16x16x64_bf16 v[40:43], v[36:39], a[24:31], v172
    v_smfmac_f32_16x16x64_bf16 v[44:47], v[36:39], a[88:95], v172
    v_smfmac_f32_16x16x64_bf16 v[48:51], v[36:39], a[56:63], v172
    v_smfmac_f32_16x16x64_bf16 v[52:55], v[36:39], a[120:127], v172
    v_cvt_pk_bf16_f32 v72, v40, v41
    v_cvt_pk_bf16_f32 v73, v42, v43
    v_cvt_pk_bf16_f32 v74, v44, v45
    v_cvt_pk_bf16_f32 v75, v46, v47
    ds_write_b128 v17, v[72:75] offset:0
    v_cvt_pk_bf16_f32 v76, v48, v49
    v_cvt_pk_bf16_f32 v77, v50, v51
    s_nop 0
    v_cvt_pk_bf16_f32 v78, v52, v53
    v_cvt_pk_bf16_f32 v79, v54, v55
    ds_write_b128 v17, v[76:79] offset:1024
    v_smfmac_f32_16x16x64_bf16 v[56:59], v[24:27], a[128:135], v172
    v_smfmac_f32_16x16x64_bf16 v[60:63], v[24:27], a[160:167], v172
    v_smfmac_f32_16x16x64_bf16 v[56:59], v[28:31], a[136:143], v172
    s_waitcnt lgkmcnt(0)
    s_barrier
    v_smfmac_f32_16x16x64_bf16 v[60:63], v[28:31], a[168:175], v172
    v_smfmac_f32_16x16x64_bf16 v[56:59], v[32:35], a[144:151], v172
    v_smfmac_f32_16x16x64_bf16 v[60:63], v[32:35], a[176:183], v172
    v_smfmac_f32_16x16x64_bf16 v[56:59], v[36:39], a[152:159], v172
    v_smfmac_f32_16x16x64_bf16 v[60:63], v[36:39], a[184:191], v172
    s_nop 4
    v_cvt_pk_bf16_f32 v80, v56, v57
    v_cvt_pk_bf16_f32 v81, v58, v59
    s_nop 0
    v_cvt_pk_bf16_f32 v82, v60, v61
    v_cvt_pk_bf16_f32 v83, v62, v63
    ds_write_b128 v17, v[80:83] offset:8192
    s_cmp_eq_u32 s15, 63
    s_waitcnt lgkmcnt(0)
    s_barrier
    ds_read_b128 v[96:99], v16 offset:8192
    ds_read_b128 v[100:103], v16 offset:10240
    ds_read_b128 v[108:111], v16 offset:14336
    v_mfma_f32_16x16x32_bf16 v[140:143], v[84:87], v[80:83], 0
    s_waitcnt lgkmcnt(2)
    v_mfma_f32_16x16x32_bf16 v[140:143], v[84:87], v[96:99], v[140:143]
    s_waitcnt lgkmcnt(1)
    v_mfma_f32_16x16x32_bf16 v[140:143], v[84:87], v[100:103], v[140:143]
    s_waitcnt lgkmcnt(0)
    v_mfma_f32_16x16x32_bf16 v[140:143], v[84:87], v[108:111], v[140:143]
    s_nop 7
    v_cvt_pk_bf16_f32 v168, v140, v141
    v_cvt_pk_bf16_f32 v169, v142, v143
    v_mov_b32 v170, v168
    v_mov_b32 v171, v169
    s_nop 0
    v_permlane16_swap_b32 v168, v170
    v_permlane16_swap_b32 v169, v171
    s_cbranch_scc1 recur_slow_last2
    buffer_store_dwordx4 v[168:171], v15, s[4:7], s20 offen sc1
    s_add_u32 s20, s20, 512
    s_add_u32 s21, s95, 1048576
    s_lshr_b32 s22, s21, 8
    s_and_b32 s22, s22, 8192
    s_xor_b32 s22, s22, s46
    s_add_u32 s21, s21, s22
    buffer_store_dwordx4 v[204:207], v9, s[4:7], s21 offen sc1
    s_add_u32 s21, s21, 262144
    s_lshl_b32 s21, s15, 9
    s_add_u32 s21, s21, 71307264
    s_cmp_ge_u32 s15, 56
    s_cselect_b32 s21, 1073741824, s21
    buffer_store_dwordx4 v[204:207], v246, s[4:7], s21 offen sc1
    s_barrier
    s_nop 15
    s_mov_b32 s23, s25
g_66:
    buffer_load_dwordx4 v[24:27], v8, s[4:7], s16 offen offset:0 sc1
    buffer_load_dwordx4 v[28:31], v8, s[4:7], s16 offen offset:1024 sc1
    buffer_load_dwordx4 v[32:35], v8, s[4:7], s16 offen offset:2048 sc1
    buffer_load_dwordx4 v[36:39], v8, s[4:7], s16 offen offset:3072 sc1
    s_waitcnt vmcnt(0)
    v_max3_u32 v19, v24, v25, v26
    v_max3_u32 v19, v19, v27, v28
    v_max3_u32 v19, v19, v29, v30
    v_max3_u32 v19, v19, v31, v32
    v_max3_u32 v19, v19, v33, v34
    v_max3_u32 v19, v19, v35, v36
    v_max3_u32 v19, v19, v37, v38
    v_max_u32 v19, v19, v39
    v_cmp_eq_u32 vcc, -1, v19
    s_nop 0
    s_cbranch_vccz g_66k
    s_add_u32 s23, s23, 1
    s_cmp_lt_u32 s23, 200000
    s_cbranch_scc1 g_66
    s_mov_b32 s25, 200000
g_66k:
    v_smfmac_f32_16x16x64_bf16 v[64:67], v[24:27], a[192:199], v172
    v_smfmac_f32_16x16x64_bf16 v[68:71], v[24:27], a[224:231], v172
    v_smfmac_f32_16x16x64_bf16 v[64:67], v[28:31], a[200:207], v172
    v_smfmac_f32_16x16x64_bf16 v[68:71], v[28:31], a[232:239], v172
    v_smfmac_f32_16x16x64_bf16 v[64:67], v[32:35], a[208:215], v172
    v_smfmac_f32_16x16x64_bf16 v[68:71], v[32:35], a[240:247], v172
    v_smfmac_f32_16x16x64_bf16 v[64:67], v[36:39], a[216:223], v172
    v_smfmac_f32_16x16x64_bf16 v[68:71], v[36:39], a[248:255], v172
    s_nop 4
    v_cvt_pk_bf16_f32 v80, v64, v65
    v_cvt_pk_bf16_f32 v81, v66, v67
    s_nop 0
    v_cvt_pk_bf16_f32 v82, v68, v69
    v_cvt_pk_bf16_f32 v83, v70, v71
    ds_write_b128 v17, v[80:83] offset:9216
    s_waitcnt lgkmcnt(0)
    s_barrier
    s_nop 15
    s_nop 15
    s_nop 15
    v_mov_b32 v40, 0
    v_mov_b32 v41, 0
    v_mov_b32 v42, 0
    v_mov_b32 v43, 0
    v_mov_b32 v44, 0
    v_mov_b32 v45, 0
    v_mov_b32 v46, 0
    v_mov_b32 v47, 0
    v_mov_b32 v48, 0
    v_mov_b32 v49, 0
    v_mov_b32 v50, 0
    v_mov_b32 v51, 0
    v_mov_b32 v52, 0
    v_mov_b32 v53, 0
    v_mov_b32 v54, 0
    v_mov_b32 v55, 0
    v_mov_b32 v56, 0
    v_mov_b32 v57, 0
    v_mov_b32 v58, 0
    v_mov_b32 v59, 0
    v_mov_b32 v60, 0
    v_mov_b32 v61, 0
    v_mov_b32 v62, 0
    v_mov_b32 v63, 0
    v_mov_b32 v64, 0
    v_mov_b32 v65, 0
    v_mov_b32 v66, 0
    v_mov_b32 v67, 0
    v_mov_b32 v68, 0
    v_mov_b32 v69, 0
    v_mov_b32 v70, 0
    v_mov_b32 v71, 0
    s_mov_b32 s21, s16
    s_mov_b32 s16, s42
    s_mov_b32 s42, s43
    s_mov_b32 s43, s44
    s_mov_b32 s44, s21
    s_add_u32 s95, s95, 524288
    s_lshr_b32 s84, s95, 8
    s_and_b32 s84, s84, 8192
    s_xor_b32 s84, s84, s46
    s_add_u32 s84, s84, s95
    s_add_u32 s15, s15, 1
    s_barrier
    s_branch recur_slow_w2
recur_slow_last2:
    buffer_store_dwordx4 v[168:171], v15, s[4:7], s20 offen sc1
    s_branch recur_end
.p2align 6
recur_slow_w3:
    s_nop 15
    s_mov_b32 s23, s25
g_67:
    buffer_load_dwordx4 v[24:27], v2, s[4:7], s16 offen offset:0 sc1
    buffer_load_dwordx4 v[28:31], v2, s[4:7], s16 offen offset:1024 sc1
    buffer_load_dwordx4 v[32:35], v2, s[4:7], s16 offen offset:2048 sc1
    buffer_load_dwordx4 v[36:39], v2, s[4:7], s16 offen offset:3072 sc1
    s_waitcnt vmcnt(0)
    v_max3_u32 v19, v24, v25, v26
    v_max3_u32 v19, v19, v27, v28
    v_max3_u32 v19, v19, v29, v30
    v_max3_u32 v19, v19, v31, v32
    v_max3_u32 v19, v19, v33, v34
    v_max3_u32 v19, v19, v35, v36
    v_max3_u32 v19, v19, v37, v38
    v_max_u32 v19, v19, v39
    v_cmp_eq_u32 vcc, -1, v19
    s_nop 0
    s_cbranch_vccz g_67k
    s_add_u32 s23, s23, 1
    s_cmp_lt_u32 s23, 200000
    s_cbranch_scc1 g_67
    s_mov_b32 s25, 200000
g_67k:
    v_smfmac_f32_16x16x64_bf16 v[40:43], v[24:27], a[0:7], v172
    v_smfmac_f32_16x16x64_bf16 v[44:47], v[24:27], a[64:71], v172
    v_smfmac_f32_16x16x64_bf16 v[48:51], v[24:27], a[32:39], v172
    v_smfmac_f32_16x16x64_bf16 v[52:55], v[24:27], a[96:103], v172
    v_smfmac_f32_16x16x64_bf16 v[40:43], v[28:31], a[8:15], v172
    v_smfmac_f32_16x16x64_bf16 v[44:47], v[28:31], a[72:79], v172
    v_smfmac_f32_16x16x64_bf16 v[48:51], v[28:31], a[40:47], v172
    v_smfmac_f32_16x16x64_bf16 v[52:55], v[28:31], a[104:111], v172
    v_smfmac_f32_16x16x64_bf16 v[40:43], v[32:35], a[16:23], v172
    v_smfmac_f32_16x16x64_bf16 v[44:47], v[32:35], a[80:87], v172
    v_smfmac_f32_16x16x64_bf16 v[48:51], v[32:35], a[48:55], v172
    v_smfmac_f32_16x16x64_bf16 v[52:55], v[32:35], a[112:119], v172
    v_smfmac_f32_16x16x64_bf16 v[40:43], v[36:39], a[24:31], v172
    v_smfmac_f32_16x16x64_bf16 v[44:47], v[36:39], a[88:95], v172
    v_smfmac_f32_16x16x64_bf16 v[48:51], v[36:39], a[56:63], v172
    v_smfmac_f32_16x16x64_bf16 v[52:55], v[36:39], a[120:127], v172
    v_cvt_pk_bf16_f32 v72, v40, v41
    v_cvt_pk_bf16_f32 v73, v42, v43
    v_cvt_pk_bf16_f32 v74, v44, v45
    v_cvt_pk_bf16_f32 v75, v46, v47
    ds_write_b128 v17, v[72:75] offset:0
    v_cvt_pk_bf16_f32 v76, v48, v49
    v_cvt_pk_bf16_f32 v77, v50, v51
    s_nop 0
    v_cvt_pk_bf16_f32 v78, v52, v53
    v_cvt_pk_bf16_f32 v79, v54, v55
    ds_write_b128 v17, v[76:79] offset:1024
    v_smfmac_f32_16x16x64_bf16 v[56:59], v[24:27], a[128:135], v172
    v_smfmac_f32_16x16x64_bf16 v[60:63], v[24:27], a[160:167], v172
    v_smfmac_f32_16x16x64_bf16 v[56:59], v[28:31], a[136:143], v172
    s_waitcnt lgkmcnt(0)
    s_barrier
    v_smfmac_f32_16x16x64_bf16 v[60:63], v[28:31], a[168:175], v172
    v_smfmac_f32_16x16x64_bf16 v[56:59], v[32:35], a[144:151], v172
    v_smfmac_f32_16x16x64_bf16 v[60:63], v[32:35], a[176:183], v172
    v_smfmac_f32_16x16x64_bf16 v[56:59], v[36:39], a[152:159], v172
    v_smfmac_f32_16x16x64_bf16 v[60:63], v[36:39], a[184:191], v172
    s_nop 4
    v_cvt_pk_bf16_f32 v80, v56, v57
    v_cvt_pk_bf16_f32 v81, v58, v59
    s_nop 0
    v_cvt_pk_bf16_f32 v82, v60, v61
    v_cvt_pk_bf16_f32 v83, v62, v63
    ds_write_b128 v17, v[80:83] offset:8192
    buffer_store_dwordx4 v[204:207], v3, s[4:7], s43 offen sc1
    buffer_store_dwordx4 v[204:207], v3, s[4:7], s43 offen offset:128 sc1
    buffer_store_dwordx4 v[204:207], v4, s[4:7], s43 offen sc1
    buffer_store_dwordx2 v[204:205], v7, s[4:7], s43 offen sc1
    buffer_store_dwordx2 v[204:205], v11, s[4:7], s43 offen sc1
    s_cmp_eq_u32 s15, 63
    s_waitcnt lgkmcnt(0)
    s_barrier
    s_cbranch_scc1 recur_end
    s_barrier
    s_nop 15
    s_mov_b32 s23, s25
g_68:
    buffer_load_dwordx4 v[24:27], v8, s[4:7], s16 offen offset:0 sc1
    buffer_load_dwordx4 v[28:31], v8, s[4:7], s16 offen offset:1024 sc1
    buffer_load_dwordx4 v[32:35], v8, s[4:7], s16 offen offset:2048 sc1
    buffer_load_dwordx4 v[36:39], v8, s[4:7], s16 offen offset:3072 sc1
    s_waitcnt vmcnt(0)
    v_max3_u32 v19, v24, v25, v26
    v_max3_u32 v19, v19, v27, v28
    v_max3_u32 v19, v19, v29, v30
    v_max3_u32 v19, v19, v31, v32
    v_max3_u32 v19, v19, v33, v34
    v_max3_u32 v19, v19, v35, v36
    v_max3_u32 v19, v19, v37, v38
    v_max_u32 v19, v19, v39
    v_cmp_eq_u32 vcc, -1, v19
    s_nop 0
    s_cbranch_vccz g_68k
    s_add_u32 s23, s23, 1
    s_cmp_lt_u32 s23, 200000
    s_cbranch_scc1 g_68
    s_mov_b32 s25, 200000
g_68k:
    v_smfmac_f32_16x16x64_bf16 v[64:67], v[24:27], a[192:199], v172
    v_smfmac_f32_16x16x64_bf16 v[68:71], v[24:27], a[224:231], v172
    v_smfmac_f32_16x16x64_bf16 v[64:67], v[28:31], a[200:207], v172
    v_smfmac_f32_16x16x64_bf16 v[68:71], v[28:31], a[232:239], v172
    v_smfmac_f32_16x16x64_bf16 v[64:67], v[32:35], a[208:215], v172
    v_smfmac_f32_16x16x64_bf16 v[68:71], v[32:35], a[240:247], v172
    v_smfmac_f32_16x16x64_bf16 v[64:67], v[36:39], a[216:223], v172
    v_smfmac_f32_16x16x64_bf16 v[68:71], v[36:39], a[248:255], v172
    s_nop 4
    v_cvt_pk_bf16_f32 v80, v64, v65
    v_cvt_pk_bf16_f32 v81, v66, v67
    s_nop 0
    v_cvt_pk_bf16_f32 v82, v68, v69
    v_cvt_pk_bf16_f32 v83, v70, v71
    s_nop 1
    v_mfma_f32_16x16x32_bf16 v[88:91], v[80:83], v[84:87], 0
    s_barrier
    ds_read_b128 v[96:99], v16 offset:9216
    ds_read_b128 v[100:103], v16 offset:11264
    ds_read_b128 v[104:107], v16 offset:13312
    s_waitcnt lgkmcnt(2)
    v_mfma_f32_16x16x32_bf16 v[88:91], v[96:99], v[84:87], v[88:91]
    s_waitcnt lgkmcnt(1)
    v_mfma_f32_16x16x32_bf16 v[88:91], v[100:103], v[84:87], v[88:91]
    s_waitcnt lgkmcnt(0)
    v_mfma_f32_16x16x32_bf16 v[88:91], v[104:107], v[84:87], v[88:91]
    s_nop 7
    buffer_store_dwordx4 v[88:91], v9, s[4:7], s84 offen sc1
    s_add_u32 s22, s84, 262144
    s_nop 15
    s_nop 15
    s_nop 15
    s_nop 15
    s_mov_b32 s23, s25
    buffer_load_dwordx4 v[96:99], v10, s[4:7], s84 offen sc1
    buffer_load_dwordx4 v[100:103], v23, s[4:7], s84 offen sc1
    buffer_load_dwordx4 v[104:107], v244, s[4:7], s84 offen sc1
    v_mov_b32 v40, 0
    v_mov_b32 v41, 0
    v_mov_b32 v42, 0
    v_mov_b32 v43, 0
    v_mov_b32 v44, 0
    v_mov_b32 v45, 0
    v_mov_b32 v46, 0
    v_mov_b32 v47, 0
    v_mov_b32 v48, 0
    v_mov_b32 v49, 0
    v_mov_b32 v50, 0
    v_mov_b32 v51, 0
    v_mov_b32 v52, 0
    v_mov_b32 v53, 0
    v_mov_b32 v54, 0
    v_mov_b32 v55, 0
    v_mov_b32 v56, 0
    v_mov_b32 v57, 0
    v_mov_b32 v58, 0
    v_mov_b32 v59, 0
    v_mov_b32 v60, 0
    v_mov_b32 v61, 0
    v_mov_b32 v62, 0
    v_mov_b32 v63, 0
    v_mov_b32 v64, 0
    v_mov_b32 v65, 0
    v_mov_b32 v66, 0
    v_mov_b32 v67, 0
    v_mov_b32 v68, 0
    v_mov_b32 v69, 0
    v_mov_b32 v70, 0
    v_mov_b32 v71, 0
pb_71:
    s_waitcnt vmcnt(2)
    v_pk_add_f32 v[120:121], v[88:89], v[96:97]
    v_pk_add_f32 v[122:123], v[90:91], v[98:99]
    s_waitcnt vmcnt(0)
    v_pk_add_f32 v[124:125], v[100:101], v[104:105]
    v_pk_add_f32 v[126:127], v[102:103], v[106:107]
    v_pk_add_f32 v[120:121], v[120:121], v[124:125]
    v_pk_add_f32 v[122:123], v[122:123], v[126:127]
    v_cmp_u_f32 vcc, v120, v121
    v_cmp_u_f32 s[86:87], v122, v123
    v_cvt_pk_bf16_f32 v180, v120, v121
    v_cvt_pk_bf16_f32 v181, v122, v123
    s_or_b64 vcc, vcc, s[86:87]
    s_cbranch_scc1 pr_69
pg_70:
    buffer_store_dwordx2 v[180:181], v11, s[4:7], s42 offen sc1
    s_barrier
    s_mov_b32 s21, s16
    s_mov_b32 s16, s42
    s_mov_b32 s42, s43
    s_mov_b32 s43, s44
    s_mov_b32 s44, s21
    s_add_u32 s95, s95, 524288
    s_lshr_b32 s84, s95, 8
    s_and_b32 s84, s84, 8192
    s_xor_b32 s84, s84, s46
    s_add_u32 s84, s84, s95
    s_add_u32 s15, s15, 1
    s_branch recur_slow_w3
pr_69:
    v_max3_u32 v19, v96, v97, v98
    v_max3_u32 v19, v19, v99, v100
    v_max3_u32 v19, v19, v101, v102
    v_max3_u32 v19, v19, v103, v104
    v_max3_u32 v19, v19, v105, v106
    v_max_u32 v19, v19, v107
    v_cmp_eq_u32 vcc, -1, v19
    s_nop 0
    s_cbranch_vccz pg_70
    buffer_load_dwordx4 v[96:99], v10, s[4:7], s84 offen sc1
    buffer_load_dwordx4 v[100:103], v23, s[4:7], s84 offen sc1
    buffer_load_dwordx4 v[104:107], v244, s[4:7], s84 offen sc1
    s_add_u32 s23, s23, 1
    s_cmp_lt_u32 s23, 200000
    s_cbranch_scc1 pb_71
    s_mov_b32 s25, 200000
    s_branch pg_70
recur_end:
    s_endpgm
.section .rodata,"a"
.p2align 6
.amdhsa_kernel concat_heads__spectral_gfnet__memory_aug_recurrent_mem_tr__prompt_kernel
  .amdhsa_next_free_vgpr 512
  .amdhsa_next_free_sgpr 102
  .amdhsa_accum_offset 256
  .amdhsa_group_segment_fixed_size 0
  .amdhsa_kernarg_size 104
  .amdhsa_user_sgpr_count 2
  .amdhsa_user_sgpr_kernarg_segment_ptr 1
  .amdhsa_system_sgpr_workgroup_id_x 1
  .amdhsa_float_denorm_mode_32 3
.end_amdhsa_kernel
```

```asm
; @launch kernel=concat_heads__spectral_gfnet__memory_aug_recurrent_mem_tr__prompt_kernel grid=(256,1,1) block=(256,1,1) lds=163840
.amdgcn_target "amdgcn-amd-amdhsa--gfx950"
.text
.globl concat_heads__spectral_gfnet__memory_aug_recurrent_mem_tr__prompt_kernel
.p2align 8
.type concat_heads__spectral_gfnet__memory_aug_recurrent_mem_tr__prompt_kernel,@function
concat_heads__spectral_gfnet__memory_aug_recurrent_mem_tr__prompt_kernel:
    s_cmp_ge_u32 s2, 256
    s_cbranch_scc1 W_end
    s_load_dwordx2 s[100:101], s[0:1], 88
    s_mov_b32 s97, s2
    s_mov_b32 s98, 0
    s_getreg_b32 s3, hwreg(HW_REG_XCC_ID, 0, 3)
role_start:
    s_andn2_b32 s2, s97, 7
    s_or_b32 s2, s2, s3
    s_bitcmp1_b32 s3, 2
    s_cbranch_scc0 R_entry
    s_cmp_ge_u32 s2, 256
    s_cbranch_scc1 W_end
    s_load_dwordx2 s[4:5], s[0:1], 96
    v_lshrrev_b32 v5, 6, v0
    v_and_b32 v1, 63, v0
    v_readfirstlane_b32 s16, v5
    s_mov_b32 s6, 268435456
    s_mov_b32 s7, 0x20000
    s_waitcnt lgkmcnt(0)
    s_lshr_b32 s90, s2, 6
    s_bfe_u32 s91, s2, 0x30003
    s_lshl_b32 s91, s91, 2
    s_and_b32 s17, s3, 3
    s_add_u32 s91, s91, s17
    s_mov_b32 s92, 0
    s_lshl_b32 s17, s91, 2
    s_add_u32 s17, s17, s16
    s_lshl_b32 s18, s90, 7
    s_add_u32 s18, s18, s17
    s_lshl_b32 s18, s18, 7
    s_add_u32 s18, s18, 100663296
    s_lshl_b32 s20, s17, 7
    s_add_u32 s20, s20, 100728832
    s_cmp_eq_u32 s90, 3
    s_cselect_b32 s18, s20, s18
    s_cselect_b64 exec, 7, 1
    v_mov_b32 v5, s18
    s_and_b32 s18, s17, 31
    s_lshl_b32 s18, s18, 2
    s_lshr_b32 s20, s91, 3
    s_add_u32 s18, s18, s20
    s_lshl_b32 s18, s18, 7
    s_add_u32 s18, s18, 100745216
    v_writelane_b32 v5, s18, 1
    s_lshl_b32 s18, s17, 7
    s_add_u32 s18, s18, 100761600
    v_writelane_b32 v5, s18, 2
    v_mov_b32 v6, 0
    buffer_store_dword v6, v5, s[4:7], 0 offen sc1
    s_mov_b64 exec, -1
    s_waitcnt vmcnt(0) lgkmcnt(0)
    s_barrier
    s_cmp_lg_u32 s90, 3
    s_cbranch_scc1 W_novote
    s_or_b32 s17, s16, s98
    s_cmp_lg_u32 s17, 0
    s_cbranch_scc1 vote_1
    s_lshl_b32 s17, s91, 14
    s_add_u32 s17, s17, 205520896
    v_lshlrev_b32 v5, 2, v1
    v_add_u32 v5, s17, v5
    v_add_u32 v6, 8192, v5
    s_mov_b32 s20, -1
    s_mov_b32 s21, -1
    s_mov_b64 exec, 1
    buffer_store_dword v1, v5, s[4:7], 0 offen sc1
    s_mov_b32 s22, 0
vp_2:
    s_add_u32 s22, s22, 1
    s_getreg_b32 s18, hwreg(HW_REG_IB_STS, 0, 4)
    s_cmp_lt_u32 s22, 2048
    s_cselect_b32 s18, s18, 0
    s_cmp_lg_u32 s18, 0
    s_cbranch_scc1 vp_2
    s_min_u32 s20, s20, s22
    buffer_store_dword v1, v6, s[4:7], 0 offen sc1
    s_mov_b32 s22, 0
vp_3:
    s_add_u32 s22, s22, 1
    s_getreg_b32 s18, hwreg(HW_REG_IB_STS, 0, 4)
    s_cmp_lt_u32 s22, 2048
    s_cselect_b32 s18, s18, 0
    s_cmp_lg_u32 s18, 0
    s_cbranch_scc1 vp_3
    s_min_u32 s21, s21, s22
    buffer_store_dword v1, v5, s[4:7], 0 offen sc1
    s_mov_b32 s22, 0
vp_4:
    s_add_u32 s22, s22, 1
    s_getreg_b32 s18, hwreg(HW_REG_IB_STS, 0, 4)
    s_cmp_lt_u32 s22, 2048
    s_cselect_b32 s18, s18, 0
    s_cmp_lg_u32 s18, 0
    s_cbranch_scc1 vp_4
    s_min_u32 s20, s20, s22
    buffer_store_dword v1, v6, s[4:7], 0 offen sc1
    s_mov_b32 s22, 0
vp_5:
    s_add_u32 s22, s22, 1
    s_getreg_b32 s18, hwreg(HW_REG_IB_STS, 0, 4)
    s_cmp_lt_u32 s22, 2048
    s_cselect_b32 s18, s18, 0
    s_cmp_lg_u32 s18, 0
    s_cbranch_scc1 vp_5
    s_min_u32 s21, s21, s22
    buffer_store_dword v1, v5, s[4:7], 0 offen sc1
    s_mov_b32 s22, 0
vp_6:
    s_add_u32 s22, s22, 1
    s_getreg_b32 s18, hwreg(HW_REG_IB_STS, 0, 4)
    s_cmp_lt_u32 s22, 2048
    s_cselect_b32 s18, s18, 0
    s_cmp_lg_u32 s18, 0
    s_cbranch_scc1 vp_6
    s_min_u32 s20, s20, s22
    buffer_store_dword v1, v6, s[4:7], 0 offen sc1
    s_mov_b32 s22, 0
vp_7:
    s_add_u32 s22, s22, 1
    s_getreg_b32 s18, hwreg(HW_REG_IB_STS, 0, 4)
    s_cmp_lt_u32 s22, 2048
    s_cselect_b32 s18, s18, 0
    s_cmp_lg_u32 s18, 0
    s_cbranch_scc1 vp_7
    s_min_u32 s21, s21, s22
    buffer_store_dword v1, v5, s[4:7], 0 offen sc1
    s_mov_b32 s22, 0
vp_8:
    s_add_u32 s22, s22, 1
    s_getreg_b32 s18, hwreg(HW_REG_IB_STS, 0, 4)
    s_cmp_lt_u32 s22, 2048
    s_cselect_b32 s18, s18, 0
    s_cmp_lg_u32 s18, 0
    s_cbranch_scc1 vp_8
    s_min_u32 s20, s20, s22
    buffer_store_dword v1, v6, s[4:7], 0 offen sc1
    s_mov_b32 s22, 0
vp_9:
    s_add_u32 s22, s22, 1
    s_getreg_b32 s18, hwreg(HW_REG_IB_STS, 0, 4)
    s_cmp_lt_u32 s22, 2048
    s_cselect_b32 s18, s18, 0
    s_cmp_lg_u32 s18, 0
    s_cbranch_scc1 vp_9
    s_min_u32 s21, s21, s22
    s_and_b32 s17, s97, 3
    s_lshl_b32 s17, s17, 3
    s_lshl_b32 s17, 0x40, s17
    s_cmp_lt_u32 s20, s21
    s_cselect_b32 s17, s17, 0
    s_andn2_b32 s18, s97, 3
    v_mov_b32 v5, s18
    v_mov_b32 v6, s17
    global_atomic_add v5, v6, s[100:101] sc1
    s_mov_b64 exec, -1
    s_waitcnt vmcnt(0)
vote_1:
    s_barrier
W_novote:
    s_cmp_lg_u32 s16, 0
    s_cbranch_scc1 reg_10
    s_and_b32 s17, s2, 3
    s_lshl_b32 s17, s17, 3
    s_lshl_b32 s18, s98, 2
    s_add_u32 s17, s17, s18
    s_lshl_b32 s17, 1, s17
    s_andn2_b32 s18, s2, 3
    v_mov_b32 v5, s18
    v_mov_b32 v6, s17
    s_mov_b64 exec, 1
    global_atomic_add v5, v6, s[100:101] sc1
    s_mov_b64 exec, -1
reg_10:
    s_cmp_eq_u32 s90, 3
    s_cbranch_scc1 W_F
    s_load_dwordx2 s[12:13], s[0:1], 40
    s_load_dwordx2 s[28:29], s[0:1], 48
    s_load_dwordx2 s[30:31], s[0:1], 56
    s_load_dwordx2 s[8:9], s[0:1], 24
    s_mov_b32 s10, 4194304
    s_mov_b32 s11, 0x20000
    s_mov_b32 s14, 8388608
    s_mov_b32 s15, 0x20000
    s_waitcnt lgkmcnt(0)
    s_cmp_eq_u32 s90, 1
    s_cselect_b64 s[12:13], s[28:29], s[12:13]
    s_cmp_eq_u32 s90, 2
    s_cselect_b64 s[12:13], s[30:31], s[12:13]
    s_lshl_b32 s28, s91, 2
    s_add_u32 s28, s28, s16
    s_lshl_b32 s20, s28, 6
    v_lshrrev_b32 v5, 2, v1
    v_and_b32 v6, 3, v1
    v_lshlrev_b32 v7, 4, v6
    v_lshl_add_u32 v7, v5, 13, v7
    v_lshlrev_b32 v8, 4, v6
    v_bfe_u32 v5, v1, 2, 2
    v_lshrrev_b32 v6, 4, v1
    v_lshl_add_u32 v5, v6, 3, v5
    v_lshl_add_u32 v8, v5, 6, v8
    s_lshl_b32 s18, s16, 15
    v_add_u32 v8, s18, v8
    s_add_u32 m0, s18, 0
    s_nop 0
    buffer_load_dwordx4 v7, s[12:15], s20 offen lds
    s_add_u32 s20, s20, 131072
    s_add_u32 m0, s18, 1024
    s_nop 0
    buffer_load_dwordx4 v7, s[12:15], s20 offen lds
    s_add_u32 s20, s20, 131072
    s_add_u32 m0, s18, 2048
    s_nop 0
    buffer_load_dwordx4 v7, s[12:15], s20 offen lds
    s_add_u32 s20, s20, 131072
    s_add_u32 m0, s18, 3072
    s_nop 0
    buffer_load_dwordx4 v7, s[12:15], s20 offen lds
    s_add_u32 s20, s20, 131072
    s_add_u32 m0, s18, 4096
    s_nop 0
    buffer_load_dwordx4 v7, s[12:15], s20 offen lds
    s_add_u32 s20, s20, 131072
    s_add_u32 m0, s18, 5120
    s_nop 0
    buffer_load_dwordx4 v7, s[12:15], s20 offen lds
    s_add_u32 s20, s20, 131072
    s_add_u32 m0, s18, 6144
    s_nop 0
    buffer_load_dwordx4 v7, s[12:15], s20 offen lds
    s_add_u32 s20, s20, 131072
    s_add_u32 m0, s18, 7168
    s_nop 0
    buffer_load_dwordx4 v7, s[12:15], s20 offen lds
    s_add_u32 s20, s20, 131072
    s_add_u32 m0, s18, 8192
    s_nop 0
    buffer_load_dwordx4 v7, s[12:15], s20 offen lds
    s_add_u32 s20, s20, 131072
    s_add_u32 m0, s18, 9216
    s_nop 0
    buffer_load_dwordx4 v7, s[12:15], s20 offen lds
    s_add_u32 s20, s20, 131072
    s_add_u32 m0, s18, 10240
    s_nop 0
    buffer_load_dwordx4 v7, s[12:15], s20 offen lds
    s_add_u32 s20, s20, 131072
    s_add_u32 m0, s18, 11264
    s_nop 0
    buffer_load_dwordx4 v7, s[12:15], s20 offen lds
    s_add_u32 s20, s20, 131072
    s_add_u32 m0, s18, 12288
    s_nop 0
    buffer_load_dwordx4 v7, s[12:15], s20 offen lds
    s_add_u32 s20, s20, 131072
    s_add_u32 m0, s18, 13312
    s_nop 0
    buffer_load_dwordx4 v7, s[12:15], s20 offen lds
    s_add_u32 s20, s20, 131072
    s_add_u32 m0, s18, 14336
    s_nop 0
    buffer_load_dwordx4 v7, s[12:15], s20 offen lds
    s_add_u32 s20, s20, 131072
    s_add_u32 m0, s18, 15360
    s_nop 0
    buffer_load_dwordx4 v7, s[12:15], s20 offen lds
    s_add_u32 s20, s20, 131072
    s_add_u32 m0, s18, 16384
    s_nop 0
    buffer_load_dwordx4 v7, s[12:15], s20 offen lds
    s_add_u32 s20, s20, 131072
    s_add_u32 m0, s18, 17408
    s_nop 0
    buffer_load_dwordx4 v7, s[12:15], s20 offen lds
    s_add_u32 s20, s20, 131072
    s_add_u32 m0, s18, 18432
    s_nop 0
    buffer_load_dwordx4 v7, s[12:15], s20 offen lds
    s_add_u32 s20, s20, 131072
    s_add_u32 m0, s18, 19456
    s_nop 0
    buffer_load_dwordx4 v7, s[12:15], s20 offen lds
    s_add_u32 s20, s20, 131072
    s_add_u32 m0, s18, 20480
    s_nop 0
    buffer_load_dwordx4 v7, s[12:15], s20 offen lds
    s_add_u32 s20, s20, 131072
    s_add_u32 m0, s18, 21504
    s_nop 0
    buffer_load_dwordx4 v7, s[12:15], s20 offen lds
    s_add_u32 s20, s20, 131072
    s_add_u32 m0, s18, 22528
    s_nop 0
    buffer_load_dwordx4 v7, s[12:15], s20 offen lds
    s_add_u32 s20, s20, 131072
    s_add_u32 m0, s18, 23552
    s_nop 0
    buffer_load_dwordx4 v7, s[12:15], s20 offen lds
    s_add_u32 s20, s20, 131072
    s_add_u32 m0, s18, 24576
    s_nop 0
    buffer_load_dwordx4 v7, s[12:15], s20 offen lds
    s_add_u32 s20, s20, 131072
    s_add_u32 m0, s18, 25600
    s_nop 0
    buffer_load_dwordx4 v7, s[12:15], s20 offen lds
    s_add_u32 s20, s20, 131072
    s_add_u32 m0, s18, 26624
    s_nop 0
    buffer_load_dwordx4 v7, s[12:15], s20 offen lds
    s_add_u32 s20, s20, 131072
    s_add_u32 m0, s18, 27648
    s_nop 0
    buffer_load_dwordx4 v7, s[12:15], s20 offen lds
    s_add_u32 s20, s20, 131072
    s_add_u32 m0, s18, 28672
    s_nop 0
    buffer_load_dwordx4 v7, s[12:15], s20 offen lds
    s_add_u32 s20, s20, 131072
    s_add_u32 m0, s18, 29696
    s_nop 0
    buffer_load_dwordx4 v7, s[12:15], s20 offen lds
    s_add_u32 s20, s20, 131072
    s_add_u32 m0, s18, 30720
    s_nop 0
    buffer_load_dwordx4 v7, s[12:15], s20 offen lds
    s_add_u32 s20, s20, 131072
    s_add_u32 m0, s18, 31744
    s_nop 0
    buffer_load_dwordx4 v7, s[12:15], s20 offen lds
    s_add_u32 s20, s20, 131072
    s_waitcnt vmcnt(24)
    ds_read_b64_tr_b16 a[0:1], v8 offset:0
    ds_read_b64_tr_b16 a[2:3], v8 offset:256
    ds_read_b64_tr_b16 a[4:5], v8 offset:8
    ds_read_b64_tr_b16 a[6:7], v8 offset:264
    ds_read_b64_tr_b16 a[8:9], v8 offset:2048
    ds_read_b64_tr_b16 a[10:11], v8 offset:2304
    ds_read_b64_tr_b16 a[12:13], v8 offset:2056
    ds_read_b64_tr_b16 a[14:15], v8 offset:2312
    s_waitcnt lgkmcnt(7)
    ds_read_b64_tr_b16 a[16:17], v8 offset:4096
    ds_read_b64_tr_b16 a[18:19], v8 offset:4352
    ds_read_b64_tr_b16 a[20:21], v8 offset:4104
    ds_read_b64_tr_b16 a[22:23], v8 offset:4360
    ds_read_b64_tr_b16 a[24:25], v8 offset:6144
    ds_read_b64_tr_b16 a[26:27], v8 offset:6400
    ds_read_b64_tr_b16 a[28:29], v8 offset:6152
    ds_read_b64_tr_b16 a[30:31], v8 offset:6408
    s_waitcnt lgkmcnt(7)
    s_waitcnt vmcnt(16)
    ds_read_b64_tr_b16 a[32:33], v8 offset:8192
    ds_read_b64_tr_b16 a[34:35], v8 offset:8448
    ds_read_b64_tr_b16 a[36:37], v8 offset:8200
    ds_read_b64_tr_b16 a[38:39], v8 offset:8456
    ds_read_b64_tr_b16 a[40:41], v8 offset:10240
    ds_read_b64_tr_b16 a[42:43], v8 offset:10496
    ds_read_b64_tr_b16 a[44:45], v8 offset:10248
    ds_read_b64_tr_b16 a[46:47], v8 offset:10504
    s_waitcnt lgkmcnt(7)
    ds_read_b64_tr_b16 a[48:49], v8 offset:12288
    ds_read_b64_tr_b16 a[50:51], v8 offset:12544
    ds_read_b64_tr_b16 a[52:53], v8 offset:12296
    ds_read_b64_tr_b16 a[54:55], v8 offset:12552
    ds_read_b64_tr_b16 a[56:57], v8 offset:14336
    ds_read_b64_tr_b16 a[58:59], v8 offset:14592
    ds_read_b64_tr_b16 a[60:61], v8 offset:14344
    ds_read_b64_tr_b16 a[62:63], v8 offset:14600
    s_waitcnt lgkmcnt(7)
    s_waitcnt vmcnt(8)
    ds_read_b64_tr_b16 a[64:65], v8 offset:16384
    ds_read_b64_tr_b16 a[66:67], v8 offset:16640
    ds_read_b64_tr_b16 a[68:69], v8 offset:16392
    ds_read_b64_tr_b16 a[70:71], v8 offset:16648
    ds_read_b64_tr_b16 a[72:73], v8 offset:18432
    ds_read_b64_tr_b16 a[74:75], v8 offset:18688
    ds_read_b64_tr_b16 a[76:77], v8 offset:18440
    ds_read_b64_tr_b16 a[78:79], v8 offset:18696
    s_waitcnt lgkmcnt(7)
    ds_read_b64_tr_b16 a[80:81], v8 offset:20480
    ds_read_b64_tr_b16 a[82:83], v8 offset:20736
    ds_read_b64_tr_b16 a[84:85], v8 offset:20488
    ds_read_b64_tr_b16 a[86:87], v8 offset:20744
    ds_read_b64_tr_b16 a[88:89], v8 offset:22528
    ds_read_b64_tr_b16 a[90:91], v8 offset:22784
    ds_read_b64_tr_b16 a[92:93], v8 offset:22536
    ds_read_b64_tr_b16 a[94:95], v8 offset:22792
    s_waitcnt lgkmcnt(7)
    s_waitcnt vmcnt(0)
    ds_read_b64_tr_b16 a[96:97], v8 offset:24576
    ds_read_b64_tr_b16 a[98:99], v8 offset:24832
    ds_read_b64_tr_b16 a[100:101], v8 offset:24584
    ds_read_b64_tr_b16 a[102:103], v8 offset:24840
    ds_read_b64_tr_b16 a[104:105], v8 offset:26624
    ds_read_b64_tr_b16 a[106:107], v8 offset:26880
    ds_read_b64_tr_b16 a[108:109], v8 offset:26632
    ds_read_b64_tr_b16 a[110:111], v8 offset:26888
    s_waitcnt lgkmcnt(7)
    ds_read_b64_tr_b16 a[112:113], v8 offset:28672
    ds_read_b64_tr_b16 a[114:115], v8 offset:28928
    ds_read_b64_tr_b16 a[116:117], v8 offset:28680
    ds_read_b64_tr_b16 a[118:119], v8 offset:28936
    ds_read_b64_tr_b16 a[120:121], v8 offset:30720
    ds_read_b64_tr_b16 a[122:123], v8 offset:30976
    ds_read_b64_tr_b16 a[124:125], v8 offset:30728
    ds_read_b64_tr_b16 a[126:127], v8 offset:30984
    s_waitcnt lgkmcnt(7)
    s_waitcnt lgkmcnt(0)
    s_add_u32 m0, s18, 0
    s_nop 0
    buffer_load_dwordx4 v7, s[12:15], s20 offen lds
    s_add_u32 s20, s20, 131072
    s_add_u32 m0, s18, 1024
    s_nop 0
    buffer_load_dwordx4 v7, s[12:15], s20 offen lds
    s_add_u32 s20, s20, 131072
    s_add_u32 m0, s18, 2048
    s_nop 0
    buffer_load_dwordx4 v7, s[12:15], s20 offen lds
    s_add_u32 s20, s20, 131072
    s_add_u32 m0, s18, 3072
    s_nop 0
    buffer_load_dwordx4 v7, s[12:15], s20 offen lds
    s_add_u32 s20, s20, 131072
    s_add_u32 m0, s18, 4096
    s_nop 0
    buffer_load_dwordx4 v7, s[12:15], s20 offen lds
    s_add_u32 s20, s20, 131072
    s_add_u32 m0, s18, 5120
    s_nop 0
    buffer_load_dwordx4 v7, s[12:15], s20 offen lds
    s_add_u32 s20, s20, 131072
    s_add_u32 m0, s18, 6144
    s_nop 0
    buffer_load_dwordx4 v7, s[12:15], s20 offen lds
    s_add_u32 s20, s20, 131072
    s_add_u32 m0, s18, 7168
    s_nop 0
    buffer_load_dwordx4 v7, s[12:15], s20 offen lds
    s_add_u32 s20, s20, 131072
    s_add_u32 m0, s18, 8192
    s_nop 0
    buffer_load_dwordx4 v7, s[12:15], s20 offen lds
    s_add_u32 s20, s20, 131072
    s_add_u32 m0, s18, 9216
    s_nop 0
    buffer_load_dwordx4 v7, s[12:15], s20 offen lds
    s_add_u32 s20, s20, 131072
    s_add_u32 m0, s18, 10240
    s_nop 0
    buffer_load_dwordx4 v7, s[12:15], s20 offen lds
    s_add_u32 s20, s20, 131072
    s_add_u32 m0, s18, 11264
    s_nop 0
    buffer_load_dwordx4 v7, s[12:15], s20 offen lds
    s_add_u32 s20, s20, 131072
    s_add_u32 m0, s18, 12288
    s_nop 0
    buffer_load_dwordx4 v7, s[12:15], s20 offen lds
    s_add_u32 s20, s20, 131072
    s_add_u32 m0, s18, 13312
    s_nop 0
    buffer_load_dwordx4 v7, s[12:15], s20 offen lds
    s_add_u32 s20, s20, 131072
    s_add_u32 m0, s18, 14336
    s_nop 0
    buffer_load_dwordx4 v7, s[12:15], s20 offen lds
    s_add_u32 s20, s20, 131072
    s_add_u32 m0, s18, 15360
    s_nop 0
    buffer_load_dwordx4 v7, s[12:15], s20 offen lds
    s_add_u32 s20, s20, 131072
    s_add_u32 m0, s18, 16384
    s_nop 0
    buffer_load_dwordx4 v7, s[12:15], s20 offen lds
    s_add_u32 s20, s20, 131072
    s_add_u32 m0, s18, 17408
    s_nop 0
    buffer_load_dwordx4 v7, s[12:15], s20 offen lds
    s_add_u32 s20, s20, 131072
    s_add_u32 m0, s18, 18432
    s_nop 0
    buffer_load_dwordx4 v7, s[12:15], s20 offen lds
    s_add_u32 s20, s20, 131072
    s_add_u32 m0, s18, 19456
    s_nop 0
    buffer_load_dwordx4 v7, s[12:15], s20 offen lds
    s_add_u32 s20, s20, 131072
    s_add_u32 m0, s18, 20480
    s_nop 0
    buffer_load_dwordx4 v7, s[12:15], s20 offen lds
    s_add_u32 s20, s20, 131072
    s_add_u32 m0, s18, 21504
    s_nop 0
    buffer_load_dwordx4 v7, s[12:15], s20 offen lds
    s_add_u32 s20, s20, 131072
    s_add_u32 m0, s18, 22528
    s_nop 0
    buffer_load_dwordx4 v7, s[12:15], s20 offen lds
    s_add_u32 s20, s20, 131072
    s_add_u32 m0, s18, 23552
    s_nop 0
    buffer_load_dwordx4 v7, s[12:15], s20 offen lds
    s_add_u32 s20, s20, 131072
    s_add_u32 m0, s18, 24576
    s_nop 0
    buffer_load_dwordx4 v7, s[12:15], s20 offen lds
    s_add_u32 s20, s20, 131072
    s_add_u32 m0, s18, 25600
    s_nop 0
    buffer_load_dwordx4 v7, s[12:15], s20 offen lds
    s_add_u32 s20, s20, 131072
    s_add_u32 m0, s18, 26624
    s_nop 0
    buffer_load_dwordx4 v7, s[12:15], s20 offen lds
    s_add_u32 s20, s20, 131072
    s_add_u32 m0, s18, 27648
    s_nop 0
    buffer_load_dwordx4 v7, s[12:15], s20 offen lds
    s_add_u32 s20, s20, 131072
    s_add_u32 m0, s18, 28672
    s_nop 0
    buffer_load_dwordx4 v7, s[12:15], s20 offen lds
    s_add_u32 s20, s20, 131072
    s_add_u32 m0, s18, 29696
    s_nop 0
    buffer_load_dwordx4 v7, s[12:15], s20 offen lds
    s_add_u32 s20, s20, 131072
    s_add_u32 m0, s18, 30720
    s_nop 0
    buffer_load_dwordx4 v7, s[12:15], s20 offen lds
    s_add_u32 s20, s20, 131072
    s_add_u32 m0, s18, 31744
    s_nop 0
    buffer_load_dwordx4 v7, s[12:15], s20 offen lds
    s_add_u32 s20, s20, 131072
    s_waitcnt vmcnt(24)
    ds_read_b64_tr_b16 a[128:129], v8 offset:0
    ds_read_b64_tr_b16 a[130:131], v8 offset:256
    ds_read_b64_tr_b16 a[132:133], v8 offset:8
    ds_read_b64_tr_b16 a[134:135], v8 offset:264
    ds_read_b64_tr_b16 a[136:137], v8 offset:2048
    ds_read_b64_tr_b16 a[138:139], v8 offset:2304
    ds_read_b64_tr_b16 a[140:141], v8 offset:2056
    ds_read_b64_tr_b16 a[142:143], v8 offset:2312
    s_waitcnt lgkmcnt(7)
    ds_read_b64_tr_b16 a[144:145], v8 offset:4096
    ds_read_b64_tr_b16 a[146:147], v8 offset:4352
    ds_read_b64_tr_b16 a[148:149], v8 offset:4104
    ds_read_b64_tr_b16 a[150:151], v8 offset:4360
    ds_read_b64_tr_b16 a[152:153], v8 offset:6144
    ds_read_b64_tr_b16 a[154:155], v8 offset:6400
    ds_read_b64_tr_b16 a[156:157], v8 offset:6152
    ds_read_b64_tr_b16 a[158:159], v8 offset:6408
    s_waitcnt lgkmcnt(7)
    s_waitcnt vmcnt(16)
    ds_read_b64_tr_b16 a[160:161], v8 offset:8192
    ds_read_b64_tr_b16 a[162:163], v8 offset:8448
    ds_read_b64_tr_b16 a[164:165], v8 offset:8200
    ds_read_b64_tr_b16 a[166:167], v8 offset:8456
    ds_read_b64_tr_b16 a[168:169], v8 offset:10240
    ds_read_b64_tr_b16 a[170:171], v8 offset:10496
    ds_read_b64_tr_b16 a[172:173], v8 offset:10248
    ds_read_b64_tr_b16 a[174:175], v8 offset:10504
    s_waitcnt lgkmcnt(7)
    ds_read_b64_tr_b16 a[176:177], v8 offset:12288
    ds_read_b64_tr_b16 a[178:179], v8 offset:12544
    ds_read_b64_tr_b16 a[180:181], v8 offset:12296
    ds_read_b64_tr_b16 a[182:183], v8 offset:12552
    ds_read_b64_tr_b16 a[184:185], v8 offset:14336
    ds_read_b64_tr_b16 a[186:187], v8 offset:14592
    ds_read_b64_tr_b16 a[188:189], v8 offset:14344
    ds_read_b64_tr_b16 a[190:191], v8 offset:14600
    s_waitcnt lgkmcnt(7)
    s_waitcnt vmcnt(8)
    ds_read_b64_tr_b16 a[192:193], v8 offset:16384
    ds_read_b64_tr_b16 a[194:195], v8 offset:16640
    ds_read_b64_tr_b16 a[196:197], v8 offset:16392
    ds_read_b64_tr_b16 a[198:199], v8 offset:16648
    ds_read_b64_tr_b16 a[200:201], v8 offset:18432
    ds_read_b64_tr_b16 a[202:203], v8 offset:18688
    ds_read_b64_tr_b16 a[204:205], v8 offset:18440
    ds_read_b64_tr_b16 a[206:207], v8 offset:18696
    s_waitcnt lgkmcnt(7)
    ds_read_b64_tr_b16 a[208:209], v8 offset:20480
    ds_read_b64_tr_b16 a[210:211], v8 offset:20736
    ds_read_b64_tr_b16 a[212:213], v8 offset:20488
    ds_read_b64_tr_b16 a[214:215], v8 offset:20744
    ds_read_b64_tr_b16 a[216:217], v8 offset:22528
    ds_read_b64_tr_b16 a[218:219], v8 offset:22784
    ds_read_b64_tr_b16 a[220:221], v8 offset:22536
    ds_read_b64_tr_b16 a[222:223], v8 offset:22792
    s_waitcnt lgkmcnt(7)
    s_waitcnt vmcnt(0)
    ds_read_b64_tr_b16 a[224:225], v8 offset:24576
    ds_read_b64_tr_b16 a[226:227], v8 offset:24832
    ds_read_b64_tr_b16 a[228:229], v8 offset:24584
    ds_read_b64_tr_b16 a[230:231], v8 offset:24840
    ds_read_b64_tr_b16 a[232:233], v8 offset:26624
    ds_read_b64_tr_b16 a[234:235], v8 offset:26880
    ds_read_b64_tr_b16 a[236:237], v8 offset:26632
    ds_read_b64_tr_b16 a[238:239], v8 offset:26888
    s_waitcnt lgkmcnt(7)
    ds_read_b64_tr_b16 a[240:241], v8 offset:28672
    ds_read_b64_tr_b16 a[242:243], v8 offset:28928
    ds_read_b64_tr_b16 a[244:245], v8 offset:28680
    ds_read_b64_tr_b16 a[246:247], v8 offset:28936
    ds_read_b64_tr_b16 a[248:249], v8 offset:30720
    ds_read_b64_tr_b16 a[250:251], v8 offset:30976
    ds_read_b64_tr_b16 a[252:253], v8 offset:30728
    ds_read_b64_tr_b16 a[254:255], v8 offset:30984
    s_waitcnt lgkmcnt(7)
    s_waitcnt lgkmcnt(0)
    v_lshlrev_b32 v5, 2, v1
    s_mov_b32 s18, 0
rdv_11:
    global_load_dword v6, v5, s[100:101] sc1
    s_lshl_b32 s17, s98, 2
    s_waitcnt vmcnt(0)
    v_lshrrev_b32 v7, s17, v6
    s_cmp_eq_u32 s98, 0
    s_cselect_b32 s17, 0x0f0f0f0f, s17
    s_cselect_b32 s17, s17, 0x01010101
    v_and_b32 v7, s17, v7
    v_cmp_ne_u32 vcc, 0x01010101, v7
    s_nop 0
    s_cbranch_vccz rdvok_12
    v_sad_u8 v7, v7, 0, 0
    s_nop 1
    v_add_u32_dpp v7, v7, v7 quad_perm:[1,0,3,2] row_mask:0xf bank_mask:0xf
    v_cmp_ne_u32 vcc, 8, v7
    s_nop 0
    s_cbranch_vccnz rdvw_13
    s_mov_b32 s98, 1
    s_and_b32 s3, s97, 7
    s_barrier
    s_branch role_start
rdvw_13:
    s_sleep 4
    s_add_u32 s18, s18, 1
    s_cmp_lt_u32 s18, 262144
    s_cbranch_scc1 rdv_11
    s_mov_b32 s92, 1048576
rdvok_12:
    v_and_b32 v5, 15, v1
    v_bfe_u32 v6, v1, 1, 3
    v_lshrrev_b32 v7, 4, v1
    v_xor_b32 v6, v6, v7
    v_lshlrev_b32 v6, 4, v6
    v_lshl_add_u32 v10, v5, 7, v6
    s_lshl_b32 s19, s16, 10
    v_xor_b32 v11, 64, v10
    v_add_u32 v12, 0x10000, v10
    v_add_u32 v13, 0x10000, v11
    v_lshrrev_b32 v7, 3, v1
    s_lshl_b32 s17, s16, 3
    v_add_u32 v7, s17, v7
    v_bfe_u32 v8, v7, 1, 3
    v_xor_b32 v8, v8, v1
    v_and_b32 v8, 7, v8
    v_bfe_u32 v5, v7, 2, 2
    v_and_b32 v2, 3, v7
    v_lshl_add_u32 v2, v5, 3, v2
    v_bfe_u32 v5, v7, 4, 1
    v_lshl_add_u32 v2, v5, 2, v2
    v_bfe_u32 v5, v1, 2, 2
    v_and_b32 v3, 3, v1
    v_lshl_add_u32 v3, v5, 3, v3
    v_lshlrev_b32 v2, 11, v2
    v_lshl_add_u32 v2, v8, 4, v2
    v_and_b32 v5, 48, v1
    v_lshl_add_u32 v3, v3, 6, v5
    s_mul_i32 s21, s28, 133120
    s_mul_i32 s18, s90, 17825792
    s_add_u32 s21, s21, s18
    s_lshl_b32 s18, s90, 7
    s_add_u32 s17, s28, s18
    s_lshl_b32 s17, s17, 7
    s_add_u32 s17, s17, 100663296
    v_mov_b32 v4, s17
    v_mov_b32 v5, 1073741824
    v_cmp_eq_u32 vcc, 0, v1
    s_nop 1
    v_cndmask_b32 v4, v5, v4, vcc
    s_mov_b32 s20, 0
    s_mov_b32 s24, 65536
    s_mov_b32 s25, 2048
    s_barrier
    s_cmp_eq_u32 s90, 2
    s_cbranch_scc1 P_v
    s_mov_b32 s26, s25
    s_sub_u32 s25, s21, 1073741824
    s_mov_b32 s21, 1073741824
    s_mov_b32 s23, 0
    s_mov_b32 s22, 0
    s_add_u32 m0, s19, 0
    s_nop 0
    buffer_load_dwordx4 v2, s[8:11], s20 offen offset:0 lds
    s_add_u32 m0, s19, 3968
    s_nop 0
    buffer_load_dwordx4 v2, s[8:11], s20 offen offset:128 lds
    s_add_u32 m0, s19, 7936
    s_nop 0
    buffer_load_dwordx4 v2, s[8:11], s20 offen offset:256 lds
    s_add_u32 m0, s19, 11904
    s_nop 0
    buffer_load_dwordx4 v2, s[8:11], s20 offen offset:384 lds
    s_add_u32 m0, s19, 15872
    s_nop 0
    buffer_load_dwordx4 v2, s[8:11], s20 offen offset:512 lds
    s_add_u32 m0, s19, 19840
    s_nop 0
    buffer_load_dwordx4 v2, s[8:11], s20 offen offset:640 lds
    s_add_u32 m0, s19, 23808
    s_nop 0
    buffer_load_dwordx4 v2, s[8:11], s20 offen offset:768 lds
    s_add_u32 m0, s19, 27776
    s_nop 0
    buffer_load_dwordx4 v2, s[8:11], s20 offen offset:896 lds
    s_add_u32 m0, s19, 31744
    s_nop 0
    buffer_load_dwordx4 v2, s[8:11], s20 offen offset:1024 lds
    s_add_u32 m0, s19, 35712
    s_nop 0
    buffer_load_dwordx4 v2, s[8:11], s20 offen offset:1152 lds
    s_add_u32 m0, s19, 39680
    s_nop 0
    buffer_load_dwordx4 v2, s[8:11], s20 offen offset:1280 lds
    s_add_u32 m0, s19, 43648
    s_nop 0
    buffer_load_dwordx4 v2, s[8:11], s20 offen offset:1408 lds
    s_add_u32 m0, s19, 47616
    s_nop 0
    buffer_load_dwordx4 v2, s[8:11], s20 offen offset:1536 lds
    s_add_u32 m0, s19, 51584
    s_nop 0
    buffer_load_dwordx4 v2, s[8:11], s20 offen offset:1664 lds
    s_add_u32 m0, s19, 55552
    s_nop 0
    buffer_load_dwordx4 v2, s[8:11], s20 offen offset:1792 lds
    s_add_u32 m0, s19, 59520
    s_nop 0
    buffer_load_dwordx4 v2, s[8:11], s20 offen offset:1920 lds
    s_add_u32 s20, s20, s24
    s_add_u32 m0, s19, 65536
    s_nop 0
    buffer_load_dwordx4 v2, s[8:11], s20 offen offset:0 lds
    s_add_u32 m0, s19, 69504
    s_nop 0
    buffer_load_dwordx4 v2, s[8:11], s20 offen offset:128 lds
    s_add_u32 m0, s19, 73472
    s_nop 0
    buffer_load_dwordx4 v2, s[8:11], s20 offen offset:256 lds
    v_mov_b32 v9, s23
    s_add_u32 s23, s23, 1
    buffer_store_dword v9, v4, s[4:7], 0 offen sc1
    s_mov_b32 s23, 0
    s_waitcnt vmcnt(12)
    s_barrier
    ds_read_b128 v[20:23], v10 offset:0
    ds_read_b128 v[24:27], v10 offset:2048
    ds_read_b128 v[28:31], v11 offset:0
    ds_read_b128 v[32:35], v11 offset:2048
    ds_read_b128 v[36:39], v10 offset:4096
    ds_read_b128 v[40:43], v10 offset:6144
    ds_read_b128 v[44:47], v11 offset:4096
.p2align 6
P_qk_top:
    s_waitcnt lgkmcnt(6)
    v_mfma_f32_16x16x32_bf16 v[52:55], a[0:3], v[20:23], 0
    ds_read_b128 v[48:51], v11 offset:6144
    v_mfma_f32_16x16x32_bf16 v[56:59], a[4:7], v[20:23], 0
    s_waitcnt lgkmcnt(6)
    v_mfma_f32_16x16x32_bf16 v[60:63], a[0:3], v[24:27], 0
    ds_read_b128 v[20:23], v10 offset:8192
    s_add_u32 m0, s19, 77440
    v_mfma_f32_16x16x32_bf16 v[64:67], a[4:7], v[24:27], 0
    buffer_load_dwordx4 v2, s[8:11], s20 offen offset:384 lds
    s_waitcnt lgkmcnt(6)
    v_mfma_f32_16x16x32_bf16 v[52:55], a[8:11], v[28:31], v[52:55]
    ds_read_b128 v[24:27], v10 offset:10240
    v_mfma_f32_16x16x32_bf16 v[56:59], a[12:15], v[28:31], v[56:59]
    s_waitcnt lgkmcnt(6)
    v_mfma_f32_16x16x32_bf16 v[60:63], a[8:11], v[32:35], v[60:63]
    ds_read_b128 v[28:31], v11 offset:8192
    s_add_u32 m0, s19, 81408
    v_mfma_f32_16x16x32_bf16 v[64:67], a[12:15], v[32:35], v[64:67]
    buffer_load_dwordx4 v2, s[8:11], s20 offen offset:512 lds
    s_waitcnt lgkmcnt(6)
    v_mfma_f32_16x16x32_bf16 v[52:55], a[16:19], v[36:39], v[52:55]
    ds_read_b128 v[32:35], v11 offset:10240
    v_mfma_f32_16x16x32_bf16 v[56:59], a[20:23], v[36:39], v[56:59]
    s_waitcnt lgkmcnt(6)
    v_mfma_f32_16x16x32_bf16 v[60:63], a[16:19], v[40:43], v[60:63]
    ds_read_b128 v[36:39], v10 offset:12288
    s_add_u32 m0, s19, 85376
    v_mfma_f32_16x16x32_bf16 v[64:67], a[20:23], v[40:43], v[64:67]
    buffer_load_dwordx4 v2, s[8:11], s20 offen offset:640 lds
    s_waitcnt lgkmcnt(6)
    v_mfma_f32_16x16x32_bf16 v[52:55], a[24:27], v[44:47], v[52:55]
    ds_read_b128 v[40:43], v10 offset:14336
    v_mfma_f32_16x16x32_bf16 v[56:59], a[28:31], v[44:47], v[56:59]
    s_waitcnt lgkmcnt(6)
    v_mfma_f32_16x16x32_bf16 v[60:63], a[24:27], v[48:51], v[60:63]
    ds_read_b128 v[44:47], v11 offset:12288
    s_add_u32 m0, s19, 89344
    v_mfma_f32_16x16x32_bf16 v[64:67], a[28:31], v[48:51], v[64:67]
    buffer_load_dwordx4 v2, s[8:11], s20 offen offset:768 lds
    s_waitcnt lgkmcnt(6)
    v_mfma_f32_16x16x32_bf16 v[52:55], a[32:35], v[20:23], v[52:55]
    ds_read_b128 v[48:51], v11 offset:14336
    v_mfma_f32_16x16x32_bf16 v[56:59], a[36:39], v[20:23], v[56:59]
    s_waitcnt lgkmcnt(6)
    v_mfma_f32_16x16x32_bf16 v[60:63], a[32:35], v[24:27], v[60:63]
    ds_read_b128 v[20:23], v10 offset:16384
    s_add_u32 m0, s19, 93312
    v_mfma_f32_16x16x32_bf16 v[64:67], a[36:39], v[24:27], v[64:67]
    buffer_load_dwordx4 v2, s[8:11], s20 offen offset:896 lds
    s_waitcnt lgkmcnt(6)
    v_mfma_f32_16x16x32_bf16 v[52:55], a[40:43], v[28:31], v[52:55]
    ds_read_b128 v[24:27], v10 offset:18432
    v_mfma_f32_16x16x32_bf16 v[56:59], a[44:47], v[28:31], v[56:59]
    v_cvt_pk_bf16_f32 v84, v68, v69
    s_waitcnt lgkmcnt(6)
    v_mfma_f32_16x16x32_bf16 v[60:63], a[40:43], v[32:35], v[60:63]
    ds_read_b128 v[28:31], v11 offset:16384
    v_mfma_f32_16x16x32_bf16 v[64:67], a[44:47], v[32:35], v[64:67]
    v_cvt_pk_bf16_f32 v85, v70, v71
    s_waitcnt lgkmcnt(6)
    v_mfma_f32_16x16x32_bf16 v[52:55], a[48:51], v[36:39], v[52:55]
    ds_read_b128 v[32:35], v11 offset:18432
    v_mfma_f32_16x16x32_bf16 v[56:59], a[52:55], v[36:39], v[56:59]
    v_cvt_pk_bf16_f32 v86, v72, v73
    s_waitcnt lgkmcnt(6)
    v_mfma_f32_16x16x32_bf16 v[60:63], a[48:51], v[40:43], v[60:63]
    ds_read_b128 v[36:39], v10 offset:20480
    v_mfma_f32_16x16x32_bf16 v[64:67], a[52:55], v[40:43], v[64:67]
    v_cvt_pk_bf16_f32 v87, v74, v75
    s_waitcnt lgkmcnt(6)
    v_mfma_f32_16x16x32_bf16 v[52:55], a[56:59], v[44:47], v[52:55]
    ds_read_b128 v[40:43], v10 offset:22528
    v_mfma_f32_16x16x32_bf16 v[56:59], a[60:63], v[44:47], v[56:59]
    v_cvt_pk_bf16_f32 v88, v76, v77
    s_waitcnt lgkmcnt(6)
    v_mfma_f32_16x16x32_bf16 v[60:63], a[56:59], v[48:51], v[60:63]
    ds_read_b128 v[44:47], v11 offset:20480
    v_mfma_f32_16x16x32_bf16 v[64:67], a[60:63], v[48:51], v[64:67]
    v_cvt_pk_bf16_f32 v89, v78, v79
    buffer_store_dwordx4 v[84:87], v3, s[4:7], s21 offen offset:0 sc1
    s_waitcnt lgkmcnt(6)
    v_mfma_f32_16x16x32_bf16 v[52:55], a[64:67], v[20:23], v[52:55]
    ds_read_b128 v[48:51], v11 offset:22528
    v_mfma_f32_16x16x32_bf16 v[56:59], a[68:71], v[20:23], v[56:59]
    v_cvt_pk_bf16_f32 v90, v80, v81
    s_waitcnt lgkmcnt(6)
    v_mfma_f32_16x16x32_bf16 v[60:63], a[64:67], v[24:27], v[60:63]
    ds_read_b128 v[20:23], v10 offset:24576
    v_mfma_f32_16x16x32_bf16 v[64:67], a[68:71], v[24:27], v[64:67]
    v_cvt_pk_bf16_f32 v91, v82, v83
    s_waitcnt lgkmcnt(6)
    v_mfma_f32_16x16x32_bf16 v[52:55], a[72:75], v[28:31], v[52:55]
    ds_read_b128 v[24:27], v10 offset:26624
    v_mfma_f32_16x16x32_bf16 v[56:59], a[76:79], v[28:31], v[56:59]
    s_waitcnt lgkmcnt(6)
    v_mfma_f32_16x16x32_bf16 v[60:63], a[72:75], v[32:35], v[60:63]
    ds_read_b128 v[28:31], v11 offset:24576
    v_mfma_f32_16x16x32_bf16 v[64:67], a[76:79], v[32:35], v[64:67]
    buffer_store_dwordx4 v[88:91], v3, s[4:7], s21 offen offset:256 sc1
    s_waitcnt lgkmcnt(6)
    v_mfma_f32_16x16x32_bf16 v[52:55], a[80:83], v[36:39], v[52:55]
    ds_read_b128 v[32:35], v11 offset:26624
    v_mfma_f32_16x16x32_bf16 v[56:59], a[84:87], v[36:39], v[56:59]
    s_add_u32 s21, s21, s25
    s_mov_b32 s25, s26
    s_waitcnt lgkmcnt(6)
    v_mfma_f32_16x16x32_bf16 v[60:63], a[80:83], v[40:43], v[60:63]
    ds_read_b128 v[36:39], v10 offset:28672
    v_mfma_f32_16x16x32_bf16 v[64:67], a[84:87], v[40:43], v[64:67]
    s_waitcnt lgkmcnt(6)
    v_mfma_f32_16x16x32_bf16 v[52:55], a[88:91], v[44:47], v[52:55]
    ds_read_b128 v[40:43], v10 offset:30720
    v_mfma_f32_16x16x32_bf16 v[56:59], a[92:95], v[44:47], v[56:59]
    s_waitcnt lgkmcnt(6)
    v_mfma_f32_16x16x32_bf16 v[60:63], a[88:91], v[48:51], v[60:63]
    ds_read_b128 v[44:47], v11 offset:28672
    v_mfma_f32_16x16x32_bf16 v[64:67], a[92:95], v[48:51], v[64:67]
    s_waitcnt lgkmcnt(6)
    v_mfma_f32_16x16x32_bf16 v[52:55], a[96:99], v[20:23], v[52:55]
    ds_read_b128 v[48:51], v11 offset:30720
    v_mfma_f32_16x16x32_bf16 v[56:59], a[100:103], v[20:23], v[56:59]
    s_waitcnt lgkmcnt(6)
    v_mfma_f32_16x16x32_bf16 v[60:63], a[96:99], v[24:27], v[60:63]
    s_waitcnt vmcnt(11)
    s_barrier
    ds_read_b128 v[20:23], v10 offset:32768
    v_mfma_f32_16x16x32_bf16 v[64:67], a[100:103], v[24:27], v[64:67]
    s_waitcnt lgkmcnt(6)
    v_mfma_f32_16x16x32_bf16 v[52:55], a[104:107], v[28:31], v[52:55]
    ds_read_b128 v[24:27], v10 offset:34816
    s_add_u32 m0, s19, 97280
    v_mfma_f32_16x16x32_bf16 v[56:59], a[108:111], v[28:31], v[56:59]
    buffer_load_dwordx4 v2, s[8:11], s20 offen offset:1024 lds
    s_waitcnt lgkmcnt(6)
    v_mfma_f32_16x16x32_bf16 v[60:63], a[104:107], v[32:35], v[60:63]
    ds_read_b128 v[28:31], v11 offset:32768
    v_mfma_f32_16x16x32_bf16 v[64:67], a[108:111], v[32:35], v[64:67]
    s_waitcnt lgkmcnt(6)
    v_mfma_f32_16x16x32_bf16 v[52:55], a[112:115], v[36:39], v[52:55]
    ds_read_b128 v[32:35], v11 offset:34816
    s_add_u32 m0, s19, 101248
    v_mfma_f32_16x16x32_bf16 v[56:59], a[116:119], v[36:39], v[56:59]
    buffer_load_dwordx4 v2, s[8:11], s20 offen offset:1152 lds
    s_waitcnt lgkmcnt(6)
    v_mfma_f32_16x16x32_bf16 v[60:63], a[112:115], v[40:43], v[60:63]
    ds_read_b128 v[36:39], v10 offset:36864
    v_mfma_f32_16x16x32_bf16 v[64:67], a[116:119], v[40:43], v[64:67]
    s_waitcnt lgkmcnt(6)
    v_mfma_f32_16x16x32_bf16 v[52:55], a[120:123], v[44:47], v[52:55]
    ds_read_b128 v[40:43], v10 offset:38912
    s_add_u32 m0, s19, 105216
    v_mfma_f32_16x16x32_bf16 v[56:59], a[124:127], v[44:47], v[56:59]
    buffer_load_dwordx4 v2, s[8:11], s20 offen offset:1280 lds
    s_waitcnt lgkmcnt(6)
    v_mfma_f32_16x16x32_bf16 v[60:63], a[120:123], v[48:51], v[60:63]
    ds_read_b128 v[44:47], v11 offset:36864
    v_mfma_f32_16x16x32_bf16 v[64:67], a[124:127], v[48:51], v[64:67]
    s_waitcnt lgkmcnt(6)
    v_mfma_f32_16x16x32_bf16 v[52:55], a[128:131], v[20:23], v[52:55]
    ds_read_b128 v[48:51], v11 offset:38912
    v_mfma_f32_16x16x32_bf16 v[56:59], a[132:135], v[20:23], v[56:59]
    s_waitcnt lgkmcnt(6)
    v_mfma_f32_16x16x32_bf16 v[60:63], a[128:131], v[24:27], v[60:63]
    ds_read_b128 v[20:23], v10 offset:40960
    s_add_u32 m0, s19, 109184
    v_mfma_f32_16x16x32_bf16 v[64:67], a[132:135], v[24:27], v[64:67]
    buffer_load_dwordx4 v2, s[8:11], s20 offen offset:1408 lds
    s_waitcnt lgkmcnt(6)
    v_mfma_f32_16x16x32_bf16 v[52:55], a[136:139], v[28:31], v[52:55]
    ds_read_b128 v[24:27], v10 offset:43008
    v_mfma_f32_16x16x32_bf16 v[56:59], a[140:143], v[28:31], v[56:59]
    s_waitcnt lgkmcnt(6)
    v_mfma_f32_16x16x32_bf16 v[60:63], a[136:139], v[32:35], v[60:63]
    ds_read_b128 v[28:31], v11 offset:40960
    s_add_u32 m0, s19, 113152
    v_mfma_f32_16x16x32_bf16 v[64:67], a[140:143], v[32:35], v[64:67]
    buffer_load_dwordx4 v2, s[8:11], s20 offen offset:1536 lds
    s_waitcnt lgkmcnt(6)
    v_mfma_f32_16x16x32_bf16 v[52:55], a[144:147], v[36:39], v[52:55]
    ds_read_b128 v[32:35], v11 offset:43008
    v_mfma_f32_16x16x32_bf16 v[56:59], a[148:151], v[36:39], v[56:59]
    s_waitcnt lgkmcnt(6)
    v_mfma_f32_16x16x32_bf16 v[60:63], a[144:147], v[40:43], v[60:63]
    ds_read_b128 v[36:39], v10 offset:45056
    s_add_u32 m0, s19, 117120
    v_mfma_f32_16x16x32_bf16 v[64:67], a[148:151], v[40:43], v[64:67]
    buffer_load_dwordx4 v2, s[8:11], s20 offen offset:1664 lds
    s_waitcnt lgkmcnt(6)
    v_mfma_f32_16x16x32_bf16 v[52:55], a[152:155], v[44:47], v[52:55]
    ds_read_b128 v[40:43], v10 offset:47104
    v_mfma_f32_16x16x32_bf16 v[56:59], a[156:159], v[44:47], v[56:59]
    s_waitcnt lgkmcnt(6)
    v_mfma_f32_16x16x32_bf16 v[60:63], a[152:155], v[48:51], v[60:63]
    ds_read_b128 v[44:47], v11 offset:45056
    s_add_u32 m0, s19, 121088
    v_mfma_f32_16x16x32_bf16 v[64:67], a[156:159], v[48:51], v[64:67]
    buffer_load_dwordx4 v2, s[8:11], s20 offen offset:1792 lds
    s_waitcnt lgkmcnt(6)
    v_mfma_f32_16x16x32_bf16 v[52:55], a[160:163], v[20:23], v[52:55]
    ds_read_b128 v[48:51], v11 offset:47104
    v_mfma_f32_16x16x32_bf16 v[56:59], a[164:167], v[20:23], v[56:59]
    s_waitcnt lgkmcnt(6)
    v_mfma_f32_16x16x32_bf16 v[60:63], a[160:163], v[24:27], v[60:63]
    ds_read_b128 v[20:23], v10 offset:49152
    s_add_u32 m0, s19, 125056
    v_mfma_f32_16x16x32_bf16 v[64:67], a[164:167], v[24:27], v[64:67]
    buffer_load_dwordx4 v2, s[8:11], s20 offen offset:1920 lds
    s_waitcnt lgkmcnt(6)
    v_mfma_f32_16x16x32_bf16 v[52:55], a[168:171], v[28:31], v[52:55]
    ds_read_b128 v[24:27], v10 offset:51200
    v_mfma_f32_16x16x32_bf16 v[56:59], a[172:175], v[28:31], v[56:59]
    s_add_u32 s20, s20, s24
    s_waitcnt lgkmcnt(6)
    v_mfma_f32_16x16x32_bf16 v[60:63], a[168:171], v[32:35], v[60:63]
    ds_read_b128 v[28:31], v11 offset:49152
    v_mfma_f32_16x16x32_bf16 v[64:67], a[172:175], v[32:35], v[64:67]
    s_waitcnt lgkmcnt(6)
    v_mfma_f32_16x16x32_bf16 v[52:55], a[176:179], v[36:39], v[52:55]
    ds_read_b128 v[32:35], v11 offset:51200
    v_mfma_f32_16x16x32_bf16 v[56:59], a[180:183], v[36:39], v[56:59]
    s_waitcnt lgkmcnt(6)
    v_mfma_f32_16x16x32_bf16 v[60:63], a[176:179], v[40:43], v[60:63]
    ds_read_b128 v[36:39], v10 offset:53248
    v_mfma_f32_16x16x32_bf16 v[64:67], a[180:183], v[40:43], v[64:67]
    s_waitcnt lgkmcnt(6)
    v_mfma_f32_16x16x32_bf16 v[52:55], a[184:187], v[44:47], v[52:55]
    ds_read_b128 v[40:43], v10 offset:55296
    v_mfma_f32_16x16x32_bf16 v[56:59], a[188:191], v[44:47], v[56:59]
    s_waitcnt lgkmcnt(6)
    v_mfma_f32_16x16x32_bf16 v[60:63], a[184:187], v[48:51], v[60:63]
    ds_read_b128 v[44:47], v11 offset:53248
    v_mfma_f32_16x16x32_bf16 v[64:67], a[188:191], v[48:51], v[64:67]
    s_waitcnt lgkmcnt(6)
    v_mfma_f32_16x16x32_bf16 v[52:55], a[192:195], v[20:23], v[52:55]
    ds_read_b128 v[48:51], v11 offset:55296
    v_mfma_f32_16x16x32_bf16 v[56:59], a[196:199], v[20:23], v[56:59]
    s_waitcnt lgkmcnt(6)
    v_mfma_f32_16x16x32_bf16 v[60:63], a[192:195], v[24:27], v[60:63]
    ds_read_b128 v[20:23], v10 offset:57344
    v_mfma_f32_16x16x32_bf16 v[64:67], a[196:199], v[24:27], v[64:67]
    s_waitcnt lgkmcnt(6)
    v_mfma_f32_16x16x32_bf16 v[52:55], a[200:203], v[28:31], v[52:55]
    ds_read_b128 v[24:27], v10 offset:59392
    v_mfma_f32_16x16x32_bf16 v[56:59], a[204:207], v[28:31], v[56:59]
    s_waitcnt lgkmcnt(6)
    v_mfma_f32_16x16x32_bf16 v[60:63], a[200:203], v[32:35], v[60:63]
    ds_read_b128 v[28:31], v11 offset:57344
    v_mfma_f32_16x16x32_bf16 v[64:67], a[204:207], v[32:35], v[64:67]
    s_waitcnt lgkmcnt(6)
    v_mfma_f32_16x16x32_bf16 v[52:55], a[208:211], v[36:39], v[52:55]
    ds_read_b128 v[32:35], v11 offset:59392
    v_mfma_f32_16x16x32_bf16 v[56:59], a[212:215], v[36:39], v[56:59]
    s_waitcnt lgkmcnt(6)
    v_mfma_f32_16x16x32_bf16 v[60:63], a[208:211], v[40:43], v[60:63]
    ds_read_b128 v[36:39], v10 offset:61440
    v_mfma_f32_16x16x32_bf16 v[64:67], a[212:215], v[40:43], v[64:67]
    s_waitcnt lgkmcnt(6)
    v_mfma_f32_16x16x32_bf16 v[52:55], a[216:219], v[44:47], v[52:55]
    ds_read_b128 v[40:43], v10 offset:63488
    v_mfma_f32_16x16x32_bf16 v[56:59], a[220:223], v[44:47], v[56:59]
    s_waitcnt lgkmcnt(6)
    v_mfma_f32_16x16x32_bf16 v[60:63], a[216:219], v[48:51], v[60:63]
    ds_read_b128 v[44:47], v11 offset:61440
    v_mfma_f32_16x16x32_bf16 v[64:67], a[220:223], v[48:51], v[64:67]
    s_waitcnt lgkmcnt(6)
    v_mfma_f32_16x16x32_bf16 v[52:55], a[224:227], v[20:23], v[52:55]
    ds_read_b128 v[48:51], v11 offset:63488
    v_mfma_f32_16x16x32_bf16 v[56:59], a[228:231], v[20:23], v[56:59]
    s_waitcnt lgkmcnt(6)
    v_mfma_f32_16x16x32_bf16 v[60:63], a[224:227], v[24:27], v[60:63]
    s_waitcnt vmcnt(8)
    s_barrier
    ds_read_b128 v[20:23], v12 offset:0
    v_mfma_f32_16x16x32_bf16 v[64:67], a[228:231], v[24:27], v[64:67]
    s_waitcnt lgkmcnt(6)
    v_mfma_f32_16x16x32_bf16 v[52:55], a[232:235], v[28:31], v[52:55]
    ds_read_b128 v[24:27], v12 offset:2048
    s_add_u32 m0, s19, 0
    v_mfma_f32_16x16x32_bf16 v[56:59], a[236:239], v[28:31], v[56:59]
    buffer_load_dwordx4 v2, s[8:11], s20 offen offset:0 lds
    s_waitcnt lgkmcnt(6)
    v_mfma_f32_16x16x32_bf16 v[60:63], a[232:235], v[32:35], v[60:63]
    ds_read_b128 v[28:31], v13 offset:0
    v_mfma_f32_16x16x32_bf16 v[64:67], a[236:239], v[32:35], v[64:67]
    v_mov_b32 v9, s23
    s_add_u32 s23, s23, 1
    buffer_store_dword v9, v4, s[4:7], 0 offen sc1
    s_waitcnt lgkmcnt(6)
    v_mfma_f32_16x16x32_bf16 v[52:55], a[240:243], v[36:39], v[52:55]
    ds_read_b128 v[32:35], v13 offset:2048
    s_add_u32 m0, s19, 3968
    v_mfma_f32_16x16x32_bf16 v[56:59], a[244:247], v[36:39], v[56:59]
    buffer_load_dwordx4 v2, s[8:11], s20 offen offset:128 lds
    s_waitcnt lgkmcnt(6)
    v_mfma_f32_16x16x32_bf16 v[60:63], a[240:243], v[40:43], v[60:63]
    ds_read_b128 v[36:39], v12 offset:4096
    v_mfma_f32_16x16x32_bf16 v[64:67], a[244:247], v[40:43], v[64:67]
    s_waitcnt lgkmcnt(6)
    v_mfma_f32_16x16x32_bf16 v[52:55], a[248:251], v[44:47], v[52:55]
    ds_read_b128 v[40:43], v12 offset:6144
    s_add_u32 m0, s19, 7936
    v_mfma_f32_16x16x32_bf16 v[56:59], a[252:255], v[44:47], v[56:59]
    buffer_load_dwordx4 v2, s[8:11], s20 offen offset:256 lds
    s_waitcnt lgkmcnt(6)
    v_mfma_f32_16x16x32_bf16 v[60:63], a[248:251], v[48:51], v[60:63]
    ds_read_b128 v[44:47], v13 offset:4096
    v_mfma_f32_16x16x32_bf16 v[64:67], a[252:255], v[48:51], v[64:67]
    s_waitcnt lgkmcnt(6)
    v_mfma_f32_16x16x32_bf16 v[68:71], a[0:3], v[20:23], 0
    ds_read_b128 v[48:51], v13 offset:6144
    v_mfma_f32_16x16x32_bf16 v[72:75], a[4:7], v[20:23], 0
    s_waitcnt lgkmcnt(6)
    v_mfma_f32_16x16x32_bf16 v[76:79], a[0:3], v[24:27], 0
    ds_read_b128 v[20:23], v12 offset:8192
    s_add_u32 m0, s19, 11904
    v_mfma_f32_16x16x32_bf16 v[80:83], a[4:7], v[24:27], 0
    buffer_load_dwordx4 v2, s[8:11], s20 offen offset:384 lds
    s_waitcnt lgkmcnt(6)
    v_mfma_f32_16x16x32_bf16 v[68:71], a[8:11], v[28:31], v[68:71]
    ds_read_b128 v[24:27], v12 offset:10240
    v_mfma_f32_16x16x32_bf16 v[72:75], a[12:15], v[28:31], v[72:75]
    s_waitcnt lgkmcnt(6)
    v_mfma_f32_16x16x32_bf16 v[76:79], a[8:11], v[32:35], v[76:79]
    ds_read_b128 v[28:31], v13 offset:8192
    s_add_u32 m0, s19, 15872
    v_mfma_f32_16x16x32_bf16 v[80:83], a[12:15], v[32:35], v[80:83]
    buffer_load_dwordx4 v2, s[8:11], s20 offen offset:512 lds
    s_waitcnt lgkmcnt(6)
    v_mfma_f32_16x16x32_bf16 v[68:71], a[16:19], v[36:39], v[68:71]
    ds_read_b128 v[32:35], v13 offset:10240
    v_mfma_f32_16x16x32_bf16 v[72:75], a[20:23], v[36:39], v[72:75]
    s_waitcnt lgkmcnt(6)
    v_mfma_f32_16x16x32_bf16 v[76:79], a[16:19], v[40:43], v[76:79]
    ds_read_b128 v[36:39], v12 offset:12288
    s_add_u32 m0, s19, 19840
    v_mfma_f32_16x16x32_bf16 v[80:83], a[20:23], v[40:43], v[80:83]
    buffer_load_dwordx4 v2, s[8:11], s20 offen offset:640 lds
    s_waitcnt lgkmcnt(6)
    v_mfma_f32_16x16x32_bf16 v[68:71], a[24:27], v[44:47], v[68:71]
    ds_read_b128 v[40:43], v12 offset:14336
    v_mfma_f32_16x16x32_bf16 v[72:75], a[28:31], v[44:47], v[72:75]
    s_waitcnt lgkmcnt(6)
    v_mfma_f32_16x16x32_bf16 v[76:79], a[24:27], v[48:51], v[76:79]
    ds_read_b128 v[44:47], v13 offset:12288
    s_add_u32 m0, s19, 23808
    v_mfma_f32_16x16x32_bf16 v[80:83], a[28:31], v[48:51], v[80:83]
    buffer_load_dwordx4 v2, s[8:11], s20 offen offset:768 lds
    s_waitcnt lgkmcnt(6)
    v_mfma_f32_16x16x32_bf16 v[68:71], a[32:35], v[20:23], v[68:71]
    ds_read_b128 v[48:51], v13 offset:14336
    v_mfma_f32_16x16x32_bf16 v[72:75], a[36:39], v[20:23], v[72:75]
    s_waitcnt lgkmcnt(6)
    v_mfma_f32_16x16x32_bf16 v[76:79], a[32:35], v[24:27], v[76:79]
    ds_read_b128 v[20:23], v12 offset:16384
    s_add_u32 m0, s19, 27776
    v_mfma_f32_16x16x32_bf16 v[80:83], a[36:39], v[24:27], v[80:83]
    buffer_load_dwordx4 v2, s[8:11], s20 offen offset:896 lds
    s_waitcnt lgkmcnt(6)
    v_mfma_f32_16x16x32_bf16 v[68:71], a[40:43], v[28:31], v[68:71]
    ds_read_b128 v[24:27], v12 offset:18432
    v_mfma_f32_16x16x32_bf16 v[72:75], a[44:47], v[28:31], v[72:75]
    v_cvt_pk_bf16_f32 v84, v52, v53
    s_waitcnt lgkmcnt(6)
    v_mfma_f32_16x16x32_bf16 v[76:79], a[40:43], v[32:35], v[76:79]
    ds_read_b128 v[28:31], v13 offset:16384
    v_mfma_f32_16x16x32_bf16 v[80:83], a[44:47], v[32:35], v[80:83]
    v_cvt_pk_bf16_f32 v85, v54, v55
    s_waitcnt lgkmcnt(6)
    v_mfma_f32_16x16x32_bf16 v[68:71], a[48:51], v[36:39], v[68:71]
    ds_read_b128 v[32:35], v13 offset:18432
    v_mfma_f32_16x16x32_bf16 v[72:75], a[52:55], v[36:39], v[72:75]
    v_cvt_pk_bf16_f32 v86, v56, v57
    s_waitcnt lgkmcnt(6)
    v_mfma_f32_16x16x32_bf16 v[76:79], a[48:51], v[40:43], v[76:79]
    ds_read_b128 v[36:39], v12 offset:20480
    v_mfma_f32_16x16x32_bf16 v[80:83], a[52:55], v[40:43], v[80:83]
    v_cvt_pk_bf16_f32 v87, v58, v59
    s_waitcnt lgkmcnt(6)
    v_mfma_f32_16x16x32_bf16 v[68:71], a[56:59], v[44:47], v[68:71]
    ds_read_b128 v[40:43], v12 offset:22528
    v_mfma_f32_16x16x32_bf16 v[72:75], a[60:63], v[44:47], v[72:75]
    v_cvt_pk_bf16_f32 v88, v60, v61
    s_waitcnt lgkmcnt(6)
    v_mfma_f32_16x16x32_bf16 v[76:79], a[56:59], v[48:51], v[76:79]
    ds_read_b128 v[44:47], v13 offset:20480
    v_mfma_f32_16x16x32_bf16 v[80:83], a[60:63], v[48:51], v[80:83]
    v_cvt_pk_bf16_f32 v89, v62, v63
    buffer_store_dwordx4 v[84:87], v3, s[4:7], s21 offen offset:0 sc1
    s_waitcnt lgkmcnt(6)
    v_mfma_f32_16x16x32_bf16 v[68:71], a[64:67], v[20:23], v[68:71]
    ds_read_b128 v[48:51], v13 offset:22528
    v_mfma_f32_16x16x32_bf16 v[72:75], a[68:71], v[20:23], v[72:75]
    v_cvt_pk_bf16_f32 v90, v64, v65
    s_waitcnt lgkmcnt(6)
    v_mfma_f32_16x16x32_bf16 v[76:79], a[64:67], v[24:27], v[76:79]
    ds_read_b128 v[20:23], v12 offset:24576
    v_mfma_f32_16x16x32_bf16 v[80:83], a[68:71], v[24:27], v[80:83]
    v_cvt_pk_bf16_f32 v91, v66, v67
    s_waitcnt lgkmcnt(6)
    v_mfma_f32_16x16x32_bf16 v[68:71], a[72:75], v[28:31], v[68:71]
    ds_read_b128 v[24:27], v12 offset:26624
    v_mfma_f32_16x16x32_bf16 v[72:75], a[76:79], v[28:31], v[72:75]
    s_waitcnt lgkmcnt(6)
    v_mfma_f32_16x16x32_bf16 v[76:79], a[72:75], v[32:35], v[76:79]
    ds_read_b128 v[28:31], v13 offset:24576
    v_mfma_f32_16x16x32_bf16 v[80:83], a[76:79], v[32:35], v[80:83]
    buffer_store_dwordx4 v[88:91], v3, s[4:7], s21 offen offset:256 sc1
    s_waitcnt lgkmcnt(6)
    v_mfma_f32_16x16x32_bf16 v[68:71], a[80:83], v[36:39], v[68:71]
    ds_read_b128 v[32:35], v13 offset:26624
    v_mfma_f32_16x16x32_bf16 v[72:75], a[84:87], v[36:39], v[72:75]
    s_add_u32 s21, s21, s25
    s_mov_b32 s25, s26
    s_waitcnt lgkmcnt(6)
    v_mfma_f32_16x16x32_bf16 v[76:79], a[80:83], v[40:43], v[76:79]
    ds_read_b128 v[36:39], v12 offset:28672
    v_mfma_f32_16x16x32_bf16 v[80:83], a[84:87], v[40:43], v[80:83]
    s_waitcnt lgkmcnt(6)
    v_mfma_f32_16x16x32_bf16 v[68:71], a[88:91], v[44:47], v[68:71]
    ds_read_b128 v[40:43], v12 offset:30720
    v_mfma_f32_16x16x32_bf16 v[72:75], a[92:95], v[44:47], v[72:75]
    s_waitcnt lgkmcnt(6)
    v_mfma_f32_16x16x32_bf16 v[76:79], a[88:91], v[48:51], v[76:79]
    ds_read_b128 v[44:47], v13 offset:28672
    v_mfma_f32_16x16x32_bf16 v[80:83], a[92:95], v[48:51], v[80:83]
    s_waitcnt lgkmcnt(6)
    v_mfma_f32_16x16x32_bf16 v[68:71], a[96:99], v[20:23], v[68:71]
    ds_read_b128 v[48:51], v13 offset:30720
    v_mfma_f32_16x16x32_bf16 v[72:75], a[100:103], v[20:23], v[72:75]
    s_waitcnt lgkmcnt(6)
    v_mfma_f32_16x16x32_bf16 v[76:79], a[96:99], v[24:27], v[76:79]
    s_waitcnt vmcnt(11)
    s_barrier
    ds_read_b128 v[20:23], v12 offset:32768
    v_mfma_f32_16x16x32_bf16 v[80:83], a[100:103], v[24:27], v[80:83]
    s_waitcnt lgkmcnt(6)
    v_mfma_f32_16x16x32_bf16 v[68:71], a[104:107], v[28:31], v[68:71]
    ds_read_b128 v[24:27], v12 offset:34816
    s_add_u32 m0, s19, 31744
    v_mfma_f32_16x16x32_bf16 v[72:75], a[108:111], v[28:31], v[72:75]
    buffer_load_dwordx4 v2, s[8:11], s20 offen offset:1024 lds
    s_waitcnt lgkmcnt(6)
    v_mfma_f32_16x16x32_bf16 v[76:79], a[104:107], v[32:35], v[76:79]
    ds_read_b128 v[28:31], v13 offset:32768
    v_mfma_f32_16x16x32_bf16 v[80:83], a[108:111], v[32:35], v[80:83]
    s_waitcnt lgkmcnt(6)
    v_mfma_f32_16x16x32_bf16 v[68:71], a[112:115], v[36:39], v[68:71]
    ds_read_b128 v[32:35], v13 offset:34816
    s_add_u32 m0, s19, 35712
    v_mfma_f32_16x16x32_bf16 v[72:75], a[116:119], v[36:39], v[72:75]
    buffer_load_dwordx4 v2, s[8:11], s20 offen offset:1152 lds
    s_waitcnt lgkmcnt(6)
    v_mfma_f32_16x16x32_bf16 v[76:79], a[112:115], v[40:43], v[76:79]
    ds_read_b128 v[36:39], v12 offset:36864
    v_mfma_f32_16x16x32_bf16 v[80:83], a[116:119], v[40:43], v[80:83]
    s_waitcnt lgkmcnt(6)
    v_mfma_f32_16x16x32_bf16 v[68:71], a[120:123], v[44:47], v[68:71]
    ds_read_b128 v[40:43], v12 offset:38912
    s_add_u32 m0, s19, 39680
    v_mfma_f32_16x16x32_bf16 v[72:75], a[124:127], v[44:47], v[72:75]
    buffer_load_dwordx4 v2, s[8:11], s20 offen offset:1280 lds
    s_waitcnt lgkmcnt(6)
    v_mfma_f32_16x16x32_bf16 v[76:79], a[120:123], v[48:51], v[76:79]
    ds_read_b128 v[44:47], v13 offset:36864
    v_mfma_f32_16x16x32_bf16 v[80:83], a[124:127], v[48:51], v[80:83]
    s_waitcnt lgkmcnt(6)
    v_mfma_f32_16x16x32_bf16 v[68:71], a[128:131], v[20:23], v[68:71]
    ds_read_b128 v[48:51], v13 offset:38912
    v_mfma_f32_16x16x32_bf16 v[72:75], a[132:135], v[20:23], v[72:75]
    s_waitcnt lgkmcnt(6)
    v_mfma_f32_16x16x32_bf16 v[76:79], a[128:131], v[24:27], v[76:79]
    ds_read_b128 v[20:23], v12 offset:40960
    s_add_u32 m0, s19, 43648
    v_mfma_f32_16x16x32_bf16 v[80:83], a[132:135], v[24:27], v[80:83]
    buffer_load_dwordx4 v2, s[8:11], s20 offen offset:1408 lds
    s_waitcnt lgkmcnt(6)
    v_mfma_f32_16x16x32_bf16 v[68:71], a[136:139], v[28:31], v[68:71]
    ds_read_b128 v[24:27], v12 offset:43008
    v_mfma_f32_16x16x32_bf16 v[72:75], a[140:143], v[28:31], v[72:75]
    s_waitcnt lgkmcnt(6)
    v_mfma_f32_16x16x32_bf16 v[76:79], a[136:139], v[32:35], v[76:79]
    ds_read_b128 v[28:31], v13 offset:40960
    s_add_u32 m0, s19, 47616
    v_mfma_f32_16x16x32_bf16 v[80:83], a[140:143], v[32:35], v[80:83]
    buffer_load_dwordx4 v2, s[8:11], s20 offen offset:1536 lds
    s_waitcnt lgkmcnt(6)
    v_mfma_f32_16x16x32_bf16 v[68:71], a[144:147], v[36:39], v[68:71]
    ds_read_b128 v[32:35], v13 offset:43008
    v_mfma_f32_16x16x32_bf16 v[72:75], a[148:151], v[36:39], v[72:75]
    s_waitcnt lgkmcnt(6)
    v_mfma_f32_16x16x32_bf16 v[76:79], a[144:147], v[40:43], v[76:79]
    ds_read_b128 v[36:39], v12 offset:45056
    s_add_u32 m0, s19, 51584
    v_mfma_f32_16x16x32_bf16 v[80:83], a[148:151], v[40:43], v[80:83]
    buffer_load_dwordx4 v2, s[8:11], s20 offen offset:1664 lds
    s_waitcnt lgkmcnt(6)
    v_mfma_f32_16x16x32_bf16 v[68:71], a[152:155], v[44:47], v[68:71]
    ds_read_b128 v[40:43], v12 offset:47104
    v_mfma_f32_16x16x32_bf16 v[72:75], a[156:159], v[44:47], v[72:75]
    s_waitcnt lgkmcnt(6)
    v_mfma_f32_16x16x32_bf16 v[76:79], a[152:155], v[48:51], v[76:79]
    ds_read_b128 v[44:47], v13 offset:45056
    s_add_u32 m0, s19, 55552
    v_mfma_f32_16x16x32_bf16 v[80:83], a[156:159], v[48:51], v[80:83]
    buffer_load_dwordx4 v2, s[8:11], s20 offen offset:1792 lds
    s_waitcnt lgkmcnt(6)
    v_mfma_f32_16x16x32_bf16 v[68:71], a[160:163], v[20:23], v[68:71]
    ds_read_b128 v[48:51], v13 offset:47104
    v_mfma_f32_16x16x32_bf16 v[72:75], a[164:167], v[20:23], v[72:75]
    s_waitcnt lgkmcnt(6)
    v_mfma_f32_16x16x32_bf16 v[76:79], a[160:163], v[24:27], v[76:79]
    ds_read_b128 v[20:23], v12 offset:49152
    s_add_u32 m0, s19, 59520
    v_mfma_f32_16x16x32_bf16 v[80:83], a[164:167], v[24:27], v[80:83]
    buffer_load_dwordx4 v2, s[8:11], s20 offen offset:1920 lds
    s_waitcnt lgkmcnt(6)
    v_mfma_f32_16x16x32_bf16 v[68:71], a[168:171], v[28:31], v[68:71]
    ds_read_b128 v[24:27], v12 offset:51200
    v_mfma_f32_16x16x32_bf16 v[72:75], a[172:175], v[28:31], v[72:75]
    s_add_u32 s20, s20, s24
    s_waitcnt lgkmcnt(6)
    v_mfma_f32_16x16x32_bf16 v[76:79], a[168:171], v[32:35], v[76:79]
    ds_read_b128 v[28:31], v13 offset:49152
    v_mfma_f32_16x16x32_bf16 v[80:83], a[172:175], v[32:35], v[80:83]
    s_waitcnt lgkmcnt(6)
    v_mfma_f32_16x16x32_bf16 v[68:71], a[176:179], v[36:39], v[68:71]
    ds_read_b128 v[32:35], v13 offset:51200
    v_mfma_f32_16x16x32_bf16 v[72:75], a[180:183], v[36:39], v[72:75]
    s_waitcnt lgkmcnt(6)
    v_mfma_f32_16x16x32_bf16 v[76:79], a[176:179], v[40:43], v[76:79]
    ds_read_b128 v[36:39], v12 offset:53248
    v_mfma_f32_16x16x32_bf16 v[80:83], a[180:183], v[40:43], v[80:83]
    s_waitcnt lgkmcnt(6)
    v_mfma_f32_16x16x32_bf16 v[68:71], a[184:187], v[44:47], v[68:71]
    ds_read_b128 v[40:43], v12 offset:55296
    v_mfma_f32_16x16x32_bf16 v[72:75], a[188:191], v[44:47], v[72:75]
    s_waitcnt lgkmcnt(6)
    v_mfma_f32_16x16x32_bf16 v[76:79], a[184:187], v[48:51], v[76:79]
    ds_read_b128 v[44:47], v13 offset:53248
    v_mfma_f32_16x16x32_bf16 v[80:83], a[188:191], v[48:51], v[80:83]
    s_waitcnt lgkmcnt(6)
    v_mfma_f32_16x16x32_bf16 v[68:71], a[192:195], v[20:23], v[68:71]
    ds_read_b128 v[48:51], v13 offset:55296
    v_mfma_f32_16x16x32_bf16 v[72:75], a[196:199], v[20:23], v[72:75]
    s_waitcnt lgkmcnt(6)
    v_mfma_f32_16x16x32_bf16 v[76:79], a[192:195], v[24:27], v[76:79]
    ds_read_b128 v[20:23], v12 offset:57344
    v_mfma_f32_16x16x32_bf16 v[80:83], a[196:199], v[24:27], v[80:83]
    s_waitcnt lgkmcnt(6)
    v_mfma_f32_16x16x32_bf16 v[68:71], a[200:203], v[28:31], v[68:71]
    ds_read_b128 v[24:27], v12 offset:59392
    v_mfma_f32_16x16x32_bf16 v[72:75], a[204:207], v[28:31], v[72:75]
    s_waitcnt lgkmcnt(6)
    v_mfma_f32_16x16x32_bf16 v[76:79], a[200:203], v[32:35], v[76:79]
    ds_read_b128 v[28:31], v13 offset:57344
    v_mfma_f32_16x16x32_bf16 v[80:83], a[204:207], v[32:35], v[80:83]
    s_waitcnt lgkmcnt(6)
    v_mfma_f32_16x16x32_bf16 v[68:71], a[208:211], v[36:39], v[68:71]
    ds_read_b128 v[32:35], v13 offset:59392
    v_mfma_f32_16x16x32_bf16 v[72:75], a[212:215], v[36:39], v[72:75]
    s_waitcnt lgkmcnt(6)
    v_mfma_f32_16x16x32_bf16 v[76:79], a[208:211], v[40:43], v[76:79]
    ds_read_b128 v[36:39], v12 offset:61440
    v_mfma_f32_16x16x32_bf16 v[80:83], a[212:215], v[40:43], v[80:83]
    s_waitcnt lgkmcnt(6)
    v_mfma_f32_16x16x32_bf16 v[68:71], a[216:219], v[44:47], v[68:71]
    ds_read_b128 v[40:43], v12 offset:63488
    v_mfma_f32_16x16x32_bf16 v[72:75], a[220:223], v[44:47], v[72:75]
    s_waitcnt lgkmcnt(6)
    v_mfma_f32_16x16x32_bf16 v[76:79], a[216:219], v[48:51], v[76:79]
    ds_read_b128 v[44:47], v13 offset:61440
    v_mfma_f32_16x16x32_bf16 v[80:83], a[220:223], v[48:51], v[80:83]
    s_waitcnt lgkmcnt(6)
    v_mfma_f32_16x16x32_bf16 v[68:71], a[224:227], v[20:23], v[68:71]
    ds_read_b128 v[48:51], v13 offset:63488
    v_mfma_f32_16x16x32_bf16 v[72:75], a[228:231], v[20:23], v[72:75]
    s_waitcnt lgkmcnt(6)
    v_mfma_f32_16x16x32_bf16 v[76:79], a[224:227], v[24:27], v[76:79]
    s_waitcnt vmcnt(8)
    s_barrier
    ds_read_b128 v[20:23], v10 offset:0
    v_mfma_f32_16x16x32_bf16 v[80:83], a[228:231], v[24:27], v[80:83]
    s_waitcnt lgkmcnt(6)
    v_mfma_f32_16x16x32_bf16 v[68:71], a[232:235], v[28:31], v[68:71]
    ds_read_b128 v[24:27], v10 offset:2048
    s_add_u32 m0, s19, 65536
    v_mfma_f32_16x16x32_bf16 v[72:75], a[236:239], v[28:31], v[72:75]
    buffer_load_dwordx4 v2, s[8:11], s20 offen offset:0 lds
    s_waitcnt lgkmcnt(6)
    v_mfma_f32_16x16x32_bf16 v[76:79], a[232:235], v[32:35], v[76:79]
    ds_read_b128 v[28:31], v11 offset:0
    v_mfma_f32_16x16x32_bf16 v[80:83], a[236:239], v[32:35], v[80:83]
    v_mov_b32 v9, s23
    s_add_u32 s23, s23, 1
    buffer_store_dword v9, v4, s[4:7], 0 offen sc1
    s_waitcnt lgkmcnt(6)
    v_mfma_f32_16x16x32_bf16 v[68:71], a[240:243], v[36:39], v[68:71]
    ds_read_b128 v[32:35], v11 offset:2048
    s_add_u32 m0, s19, 69504
    v_mfma_f32_16x16x32_bf16 v[72:75], a[244:247], v[36:39], v[72:75]
    buffer_load_dwordx4 v2, s[8:11], s20 offen offset:128 lds
    s_waitcnt lgkmcnt(6)
    v_mfma_f32_16x16x32_bf16 v[76:79], a[240:243], v[40:43], v[76:79]
    ds_read_b128 v[36:39], v10 offset:4096
    v_mfma_f32_16x16x32_bf16 v[80:83], a[244:247], v[40:43], v[80:83]
    s_waitcnt lgkmcnt(6)
    v_mfma_f32_16x16x32_bf16 v[68:71], a[248:251], v[44:47], v[68:71]
    ds_read_b128 v[40:43], v10 offset:6144
    s_add_u32 m0, s19, 73472
    v_mfma_f32_16x16x32_bf16 v[72:75], a[252:255], v[44:47], v[72:75]
    buffer_load_dwordx4 v2, s[8:11], s20 offen offset:256 lds
    s_waitcnt lgkmcnt(6)
    v_mfma_f32_16x16x32_bf16 v[76:79], a[248:251], v[48:51], v[76:79]
    ds_read_b128 v[44:47], v11 offset:4096
    v_mfma_f32_16x16x32_bf16 v[80:83], a[252:255], v[48:51], v[80:83]
    s_add_u32 s22, s22, 2
    s_cmp_lt_u32 s22, 64
    s_cbranch_scc1 P_qk_top
    v_cvt_pk_bf16_f32 v84, v68, v69
    v_cvt_pk_bf16_f32 v85, v70, v71
    v_cvt_pk_bf16_f32 v86, v72, v73
    v_cvt_pk_bf16_f32 v87, v74, v75
    v_cvt_pk_bf16_f32 v88, v76, v77
    v_cvt_pk_bf16_f32 v89, v78, v79
    v_cvt_pk_bf16_f32 v90, v80, v81
    v_cvt_pk_bf16_f32 v91, v82, v83
    buffer_store_dwordx4 v[84:87], v3, s[4:7], s21 offen offset:0 sc1
    buffer_store_dwordx4 v[88:91], v3, s[4:7], s21 offen offset:256 sc1
    s_waitcnt vmcnt(0) lgkmcnt(0)
    v_mov_b32 v9, s23
    s_add_u32 s23, s23, 1
    buffer_store_dword v9, v4, s[4:7], 0 offen sc1
    s_branch W_U
P_v:
    s_mov_b32 s26, s25
    s_sub_u32 s25, s21, 1073741824
    s_mov_b32 s21, 1073741824
    s_mov_b32 s23, 0
    s_mov_b32 s22, 0
    s_add_u32 m0, s19, 0
    s_nop 0
    buffer_load_dwordx4 v2, s[8:11], s20 offen offset:0 lds
    s_add_u32 m0, s19, 3968
    s_nop 0
    buffer_load_dwordx4 v2, s[8:11], s20 offen offset:128 lds
    s_add_u32 m0, s19, 7936
    s_nop 0
    buffer_load_dwordx4 v2, s[8:11], s20 offen offset:256 lds
    s_add_u32 m0, s19, 11904
    s_nop 0
    buffer_load_dwordx4 v2, s[8:11], s20 offen offset:384 lds
    s_add_u32 m0, s19, 15872
    s_nop 0
    buffer_load_dwordx4 v2, s[8:11], s20 offen offset:512 lds
    s_add_u32 m0, s19, 19840
    s_nop 0
    buffer_load_dwordx4 v2, s[8:11], s20 offen offset:640 lds
    s_add_u32 m0, s19, 23808
    s_nop 0
    buffer_load_dwordx4 v2, s[8:11], s20 offen offset:768 lds
    s_add_u32 m0, s19, 27776
    s_nop 0
    buffer_load_dwordx4 v2, s[8:11], s20 offen offset:896 lds
    s_add_u32 m0, s19, 31744
    s_nop 0
    buffer_load_dwordx4 v2, s[8:11], s20 offen offset:1024 lds
    s_add_u32 m0, s19, 35712
    s_nop 0
    buffer_load_dwordx4 v2, s[8:11], s20 offen offset:1152 lds
    s_add_u32 m0, s19, 39680
    s_nop 0
    buffer_load_dwordx4 v2, s[8:11], s20 offen offset:1280 lds
    s_add_u32 m0, s19, 43648
    s_nop 0
    buffer_load_dwordx4 v2, s[8:11], s20 offen offset:1408 lds
    s_add_u32 m0, s19, 47616
    s_nop 0
    buffer_load_dwordx4 v2, s[8:11], s20 offen offset:1536 lds
    s_add_u32 m0, s19, 51584
    s_nop 0
    buffer_load_dwordx4 v2, s[8:11], s20 offen offset:1664 lds
    s_add_u32 m0, s19, 55552
    s_nop 0
    buffer_load_dwordx4 v2, s[8:11], s20 offen offset:1792 lds
    s_add_u32 m0, s19, 59520
    s_nop 0
    buffer_load_dwordx4 v2, s[8:11], s20 offen offset:1920 lds
    s_add_u32 s20, s20, s24
    s_add_u32 m0, s19, 65536
    s_nop 0
    buffer_load_dwordx4 v2, s[8:11], s20 offen offset:0 lds
    s_add_u32 m0, s19, 69504
    s_nop 0
    buffer_load_dwordx4 v2, s[8:11], s20 offen offset:128 lds
    s_add_u32 m0, s19, 73472
    s_nop 0
    buffer_load_dwordx4 v2, s[8:11], s20 offen offset:256 lds
    v_mov_b32 v9, s23
    s_add_u32 s23, s23, 1
    buffer_store_dword v9, v4, s[4:7], 0 offen sc1
    s_mov_b32 s23, 0
    s_waitcnt vmcnt(12)
    s_barrier
    ds_read_b128 v[20:23], v10 offset:0
    ds_read_b128 v[24:27], v10 offset:2048
    ds_read_b128 v[28:31], v11 offset:0
    ds_read_b128 v[32:35], v11 offset:2048
    ds_read_b128 v[36:39], v10 offset:4096
    ds_read_b128 v[40:43], v10 offset:6144
    ds_read_b128 v[44:47], v11 offset:4096
.p2align 6
P_v_top:
    s_waitcnt lgkmcnt(6)
    v_mfma_f32_16x16x32_bf16 v[52:55], v[20:23], a[0:3], 0
    ds_read_b128 v[48:51], v11 offset:6144
    v_mfma_f32_16x16x32_bf16 v[60:63], v[20:23], a[4:7], 0
    s_waitcnt lgkmcnt(6)
    v_mfma_f32_16x16x32_bf16 v[56:59], v[24:27], a[0:3], 0
    ds_read_b128 v[20:23], v10 offset:8192
    s_add_u32 m0, s19, 77440
    v_mfma_f32_16x16x32_bf16 v[64:67], v[24:27], a[4:7], 0
    buffer_load_dwordx4 v2, s[8:11], s20 offen offset:384 lds
    s_waitcnt lgkmcnt(6)
    v_mfma_f32_16x16x32_bf16 v[52:55], v[28:31], a[8:11], v[52:55]
    ds_read_b128 v[24:27], v10 offset:10240
    v_mfma_f32_16x16x32_bf16 v[60:63], v[28:31], a[12:15], v[60:63]
    s_waitcnt lgkmcnt(6)
    v_mfma_f32_16x16x32_bf16 v[56:59], v[32:35], a[8:11], v[56:59]
    ds_read_b128 v[28:31], v11 offset:8192
    s_add_u32 m0, s19, 81408
    v_mfma_f32_16x16x32_bf16 v[64:67], v[32:35], a[12:15], v[64:67]
    buffer_load_dwordx4 v2, s[8:11], s20 offen offset:512 lds
    s_waitcnt lgkmcnt(6)
    v_mfma_f32_16x16x32_bf16 v[52:55], v[36:39], a[16:19], v[52:55]
    ds_read_b128 v[32:35], v11 offset:10240
    v_mfma_f32_16x16x32_bf16 v[60:63], v[36:39], a[20:23], v[60:63]
    s_waitcnt lgkmcnt(6)
    v_mfma_f32_16x16x32_bf16 v[56:59], v[40:43], a[16:19], v[56:59]
    ds_read_b128 v[36:39], v10 offset:12288
    s_add_u32 m0, s19, 85376
    v_mfma_f32_16x16x32_bf16 v[64:67], v[40:43], a[20:23], v[64:67]
    buffer_load_dwordx4 v2, s[8:11], s20 offen offset:640 lds
    s_waitcnt lgkmcnt(6)
    v_mfma_f32_16x16x32_bf16 v[52:55], v[44:47], a[24:27], v[52:55]
    ds_read_b128 v[40:43], v10 offset:14336
    v_mfma_f32_16x16x32_bf16 v[60:63], v[44:47], a[28:31], v[60:63]
    s_waitcnt lgkmcnt(6)
    v_mfma_f32_16x16x32_bf16 v[56:59], v[48:51], a[24:27], v[56:59]
    ds_read_b128 v[44:47], v11 offset:12288
    s_add_u32 m0, s19, 89344
    v_mfma_f32_16x16x32_bf16 v[64:67], v[48:51], a[28:31], v[64:67]
    buffer_load_dwordx4 v2, s[8:11], s20 offen offset:768 lds
    s_waitcnt lgkmcnt(6)
    v_mfma_f32_16x16x32_bf16 v[52:55], v[20:23], a[32:35], v[52:55]
    ds_read_b128 v[48:51], v11 offset:14336
    v_mfma_f32_16x16x32_bf16 v[60:63], v[20:23], a[36:39], v[60:63]
    s_waitcnt lgkmcnt(6)
    v_mfma_f32_16x16x32_bf16 v[56:59], v[24:27], a[32:35], v[56:59]
    ds_read_b128 v[20:23], v10 offset:16384
    s_add_u32 m0, s19, 93312
    v_mfma_f32_16x16x32_bf16 v[64:67], v[24:27], a[36:39], v[64:67]
    buffer_load_dwordx4 v2, s[8:11], s20 offen offset:896 lds
    s_waitcnt lgkmcnt(6)
    v_mfma_f32_16x16x32_bf16 v[52:55], v[28:31], a[40:43], v[52:55]
    ds_read_b128 v[24:27], v10 offset:18432
    v_mfma_f32_16x16x32_bf16 v[60:63], v[28:31], a[44:47], v[60:63]
    v_cvt_pk_bf16_f32 v84, v68, v69
    s_waitcnt lgkmcnt(6)
    v_mfma_f32_16x16x32_bf16 v[56:59], v[32:35], a[40:43], v[56:59]
    ds_read_b128 v[28:31], v11 offset:16384
    v_mfma_f32_16x16x32_bf16 v[64:67], v[32:35], a[44:47], v[64:67]
    v_cvt_pk_bf16_f32 v85, v70, v71
    s_waitcnt lgkmcnt(6)
    v_mfma_f32_16x16x32_bf16 v[52:55], v[36:39], a[48:51], v[52:55]
    ds_read_b128 v[32:35], v11 offset:18432
    v_mfma_f32_16x16x32_bf16 v[60:63], v[36:39], a[52:55], v[60:63]
    v_cvt_pk_bf16_f32 v86, v72, v73
    s_waitcnt lgkmcnt(6)
    v_mfma_f32_16x16x32_bf16 v[56:59], v[40:43], a[48:51], v[56:59]
    ds_read_b128 v[36:39], v10 offset:20480
    v_mfma_f32_16x16x32_bf16 v[64:67], v[40:43], a[52:55], v[64:67]
    v_cvt_pk_bf16_f32 v87, v74, v75
    s_waitcnt lgkmcnt(6)
    v_mfma_f32_16x16x32_bf16 v[52:55], v[44:47], a[56:59], v[52:55]
    ds_read_b128 v[40:43], v10 offset:22528
    v_mfma_f32_16x16x32_bf16 v[60:63], v[44:47], a[60:63], v[60:63]
    v_cvt_pk_bf16_f32 v88, v76, v77
    s_waitcnt lgkmcnt(6)
    v_mfma_f32_16x16x32_bf16 v[56:59], v[48:51], a[56:59], v[56:59]
    ds_read_b128 v[44:47], v11 offset:20480
    v_mfma_f32_16x16x32_bf16 v[64:67], v[48:51], a[60:63], v[64:67]
    v_cvt_pk_bf16_f32 v89, v78, v79
    buffer_store_dwordx4 v[84:87], v3, s[4:7], s21 offen offset:0 sc1
    s_waitcnt lgkmcnt(6)
    v_mfma_f32_16x16x32_bf16 v[52:55], v[20:23], a[64:67], v[52:55]
    ds_read_b128 v[48:51], v11 offset:22528
    v_mfma_f32_16x16x32_bf16 v[60:63], v[20:23], a[68:71], v[60:63]
    v_cvt_pk_bf16_f32 v90, v80, v81
    s_waitcnt lgkmcnt(6)
    v_mfma_f32_16x16x32_bf16 v[56:59], v[24:27], a[64:67], v[56:59]
    ds_read_b128 v[20:23], v10 offset:24576
    v_mfma_f32_16x16x32_bf16 v[64:67], v[24:27], a[68:71], v[64:67]
    v_cvt_pk_bf16_f32 v91, v82, v83
    s_waitcnt lgkmcnt(6)
    v_mfma_f32_16x16x32_bf16 v[52:55], v[28:31], a[72:75], v[52:55]
    ds_read_b128 v[24:27], v10 offset:26624
    v_mfma_f32_16x16x32_bf16 v[60:63], v[28:31], a[76:79], v[60:63]
    s_waitcnt lgkmcnt(6)
    v_mfma_f32_16x16x32_bf16 v[56:59], v[32:35], a[72:75], v[56:59]
    ds_read_b128 v[28:31], v11 offset:24576
    v_mfma_f32_16x16x32_bf16 v[64:67], v[32:35], a[76:79], v[64:67]
    buffer_store_dwordx4 v[88:91], v3, s[4:7], s21 offen offset:256 sc1
    s_waitcnt lgkmcnt(6)
    v_mfma_f32_16x16x32_bf16 v[52:55], v[36:39], a[80:83], v[52:55]
    ds_read_b128 v[32:35], v11 offset:26624
    v_mfma_f32_16x16x32_bf16 v[60:63], v[36:39], a[84:87], v[60:63]
    s_add_u32 s21, s21, s25
    s_mov_b32 s25, s26
    s_waitcnt lgkmcnt(6)
    v_mfma_f32_16x16x32_bf16 v[56:59], v[40:43], a[80:83], v[56:59]
    ds_read_b128 v[36:39], v10 offset:28672
    v_mfma_f32_16x16x32_bf16 v[64:67], v[40:43], a[84:87], v[64:67]
    s_waitcnt lgkmcnt(6)
    v_mfma_f32_16x16x32_bf16 v[52:55], v[44:47], a[88:91], v[52:55]
    ds_read_b128 v[40:43], v10 offset:30720
    v_mfma_f32_16x16x32_bf16 v[60:63], v[44:47], a[92:95], v[60:63]
    s_waitcnt lgkmcnt(6)
    v_mfma_f32_16x16x32_bf16 v[56:59], v[48:51], a[88:91], v[56:59]
    ds_read_b128 v[44:47], v11 offset:28672
    v_mfma_f32_16x16x32_bf16 v[64:67], v[48:51], a[92:95], v[64:67]
    s_waitcnt lgkmcnt(6)
    v_mfma_f32_16x16x32_bf16 v[52:55], v[20:23], a[96:99], v[52:55]
    ds_read_b128 v[48:51], v11 offset:30720
    v_mfma_f32_16x16x32_bf16 v[60:63], v[20:23], a[100:103], v[60:63]
    s_waitcnt lgkmcnt(6)
    v_mfma_f32_16x16x32_bf16 v[56:59], v[24:27], a[96:99], v[56:59]
    s_waitcnt vmcnt(11)
    s_barrier
    ds_read_b128 v[20:23], v10 offset:32768
    v_mfma_f32_16x16x32_bf16 v[64:67], v[24:27], a[100:103], v[64:67]
    s_waitcnt lgkmcnt(6)
    v_mfma_f32_16x16x32_bf16 v[52:55], v[28:31], a[104:107], v[52:55]
    ds_read_b128 v[24:27], v10 offset:34816
    s_add_u32 m0, s19, 97280
    v_mfma_f32_16x16x32_bf16 v[60:63], v[28:31], a[108:111], v[60:63]
    buffer_load_dwordx4 v2, s[8:11], s20 offen offset:1024 lds
    s_waitcnt lgkmcnt(6)
    v_mfma_f32_16x16x32_bf16 v[56:59], v[32:35], a[104:107], v[56:59]
    ds_read_b128 v[28:31], v11 offset:32768
    v_mfma_f32_16x16x32_bf16 v[64:67], v[32:35], a[108:111], v[64:67]
    s_waitcnt lgkmcnt(6)
    v_mfma_f32_16x16x32_bf16 v[52:55], v[36:39], a[112:115], v[52:55]
    ds_read_b128 v[32:35], v11 offset:34816
    s_add_u32 m0, s19, 101248
    v_mfma_f32_16x16x32_bf16 v[60:63], v[36:39], a[116:119], v[60:63]
    buffer_load_dwordx4 v2, s[8:11], s20 offen offset:1152 lds
    s_waitcnt lgkmcnt(6)
    v_mfma_f32_16x16x32_bf16 v[56:59], v[40:43], a[112:115], v[56:59]
    ds_read_b128 v[36:39], v10 offset:36864
    v_mfma_f32_16x16x32_bf16 v[64:67], v[40:43], a[116:119], v[64:67]
    s_waitcnt lgkmcnt(6)
    v_mfma_f32_16x16x32_bf16 v[52:55], v[44:47], a[120:123], v[52:55]
    ds_read_b128 v[40:43], v10 offset:38912
    s_add_u32 m0, s19, 105216
    v_mfma_f32_16x16x32_bf16 v[60:63], v[44:47], a[124:127], v[60:63]
    buffer_load_dwordx4 v2, s[8:11], s20 offen offset:1280 lds
    s_waitcnt lgkmcnt(6)
    v_mfma_f32_16x16x32_bf16 v[56:59], v[48:51], a[120:123], v[56:59]
    ds_read_b128 v[44:47], v11 offset:36864
    v_mfma_f32_16x16x32_bf16 v[64:67], v[48:51], a[124:127], v[64:67]
    s_waitcnt lgkmcnt(6)
    v_mfma_f32_16x16x32_bf16 v[52:55], v[20:23], a[128:131], v[52:55]
    ds_read_b128 v[48:51], v11 offset:38912
    v_mfma_f32_16x16x32_bf16 v[60:63], v[20:23], a[132:135], v[60:63]
    s_waitcnt lgkmcnt(6)
    v_mfma_f32_16x16x32_bf16 v[56:59], v[24:27], a[128:131], v[56:59]
    ds_read_b128 v[20:23], v10 offset:40960
    s_add_u32 m0, s19, 109184
    v_mfma_f32_16x16x32_bf16 v[64:67], v[24:27], a[132:135], v[64:67]
    buffer_load_dwordx4 v2, s[8:11], s20 offen offset:1408 lds
    s_waitcnt lgkmcnt(6)
    v_mfma_f32_16x16x32_bf16 v[52:55], v[28:31], a[136:139], v[52:55]
    ds_read_b128 v[24:27], v10 offset:43008
    v_mfma_f32_16x16x32_bf16 v[60:63], v[28:31], a[140:143], v[60:63]
    s_waitcnt lgkmcnt(6)
    v_mfma_f32_16x16x32_bf16 v[56:59], v[32:35], a[136:139], v[56:59]
    ds_read_b128 v[28:31], v11 offset:40960
    s_add_u32 m0, s19, 113152
    v_mfma_f32_16x16x32_bf16 v[64:67], v[32:35], a[140:143], v[64:67]
    buffer_load_dwordx4 v2, s[8:11], s20 offen offset:1536 lds
    s_waitcnt lgkmcnt(6)
    v_mfma_f32_16x16x32_bf16 v[52:55], v[36:39], a[144:147], v[52:55]
    ds_read_b128 v[32:35], v11 offset:43008
    v_mfma_f32_16x16x32_bf16 v[60:63], v[36:39], a[148:151], v[60:63]
    s_waitcnt lgkmcnt(6)
    v_mfma_f32_16x16x32_bf16 v[56:59], v[40:43], a[144:147], v[56:59]
    ds_read_b128 v[36:39], v10 offset:45056
    s_add_u32 m0, s19, 117120
    v_mfma_f32_16x16x32_bf16 v[64:67], v[40:43], a[148:151], v[64:67]
    buffer_load_dwordx4 v2, s[8:11], s20 offen offset:1664 lds
    s_waitcnt lgkmcnt(6)
    v_mfma_f32_16x16x32_bf16 v[52:55], v[44:47], a[152:155], v[52:55]
    ds_read_b128 v[40:43], v10 offset:47104
    v_mfma_f32_16x16x32_bf16 v[60:63], v[44:47], a[156:159], v[60:63]
    s_waitcnt lgkmcnt(6)
    v_mfma_f32_16x16x32_bf16 v[56:59], v[48:51], a[152:155], v[56:59]
    ds_read_b128 v[44:47], v11 offset:45056
    s_add_u32 m0, s19, 121088
    v_mfma_f32_16x16x32_bf16 v[64:67], v[48:51], a[156:159], v[64:67]
    buffer_load_dwordx4 v2, s[8:11], s20 offen offset:1792 lds
    s_waitcnt lgkmcnt(6)
    v_mfma_f32_16x16x32_bf16 v[52:55], v[20:23], a[160:163], v[52:55]
    ds_read_b128 v[48:51], v11 offset:47104
    v_mfma_f32_16x16x32_bf16 v[60:63], v[20:23], a[164:167], v[60:63]
    s_waitcnt lgkmcnt(6)
    v_mfma_f32_16x16x32_bf16 v[56:59], v[24:27], a[160:163], v[56:59]
    ds_read_b128 v[20:23], v10 offset:49152
    s_add_u32 m0, s19, 125056
    v_mfma_f32_16x16x32_bf16 v[64:67], v[24:27], a[164:167], v[64:67]
    buffer_load_dwordx4 v2, s[8:11], s20 offen offset:1920 lds
    s_waitcnt lgkmcnt(6)
    v_mfma_f32_16x16x32_bf16 v[52:55], v[28:31], a[168:171], v[52:55]
    ds_read_b128 v[24:27], v10 offset:51200
    v_mfma_f32_16x16x32_bf16 v[60:63], v[28:31], a[172:175], v[60:63]
    s_add_u32 s20, s20, s24
    s_waitcnt lgkmcnt(6)
    v_mfma_f32_16x16x32_bf16 v[56:59], v[32:35], a[168:171], v[56:59]
    ds_read_b128 v[28:31], v11 offset:49152
    v_mfma_f32_16x16x32_bf16 v[64:67], v[32:35], a[172:175], v[64:67]
    s_waitcnt lgkmcnt(6)
    v_mfma_f32_16x16x32_bf16 v[52:55], v[36:39], a[176:179], v[52:55]
    ds_read_b128 v[32:35], v11 offset:51200
    v_mfma_f32_16x16x32_bf16 v[60:63], v[36:39], a[180:183], v[60:63]
    s_waitcnt lgkmcnt(6)
    v_mfma_f32_16x16x32_bf16 v[56:59], v[40:43], a[176:179], v[56:59]
    ds_read_b128 v[36:39], v10 offset:53248
    v_mfma_f32_16x16x32_bf16 v[64:67], v[40:43], a[180:183], v[64:67]
    s_waitcnt lgkmcnt(6)
    v_mfma_f32_16x16x32_bf16 v[52:55], v[44:47], a[184:187], v[52:55]
    ds_read_b128 v[40:43], v10 offset:55296
    v_mfma_f32_16x16x32_bf16 v[60:63], v[44:47], a[188:191], v[60:63]
    s_waitcnt lgkmcnt(6)
    v_mfma_f32_16x16x32_bf16 v[56:59], v[48:51], a[184:187], v[56:59]
    ds_read_b128 v[44:47], v11 offset:53248
    v_mfma_f32_16x16x32_bf16 v[64:67], v[48:51], a[188:191], v[64:67]
    s_waitcnt lgkmcnt(6)
    v_mfma_f32_16x16x32_bf16 v[52:55], v[20:23], a[192:195], v[52:55]
    ds_read_b128 v[48:51], v11 offset:55296
    v_mfma_f32_16x16x32_bf16 v[60:63], v[20:23], a[196:199], v[60:63]
    s_waitcnt lgkmcnt(6)
    v_mfma_f32_16x16x32_bf16 v[56:59], v[24:27], a[192:195], v[56:59]
    ds_read_b128 v[20:23], v10 offset:57344
    v_mfma_f32_16x16x32_bf16 v[64:67], v[24:27], a[196:199], v[64:67]
    s_waitcnt lgkmcnt(6)
    v_mfma_f32_16x16x32_bf16 v[52:55], v[28:31], a[200:203], v[52:55]
    ds_read_b128 v[24:27], v10 offset:59392
    v_mfma_f32_16x16x32_bf16 v[60:63], v[28:31], a[204:207], v[60:63]
    s_waitcnt lgkmcnt(6)
    v_mfma_f32_16x16x32_bf16 v[56:59], v[32:35], a[200:203], v[56:59]
    ds_read_b128 v[28:31], v11 offset:57344
    v_mfma_f32_16x16x32_bf16 v[64:67], v[32:35], a[204:207], v[64:67]
    s_waitcnt lgkmcnt(6)
    v_mfma_f32_16x16x32_bf16 v[52:55], v[36:39], a[208:211], v[52:55]
    ds_read_b128 v[32:35], v11 offset:59392
    v_mfma_f32_16x16x32_bf16 v[60:63], v[36:39], a[212:215], v[60:63]
    s_waitcnt lgkmcnt(6)
    v_mfma_f32_16x16x32_bf16 v[56:59], v[40:43], a[208:211], v[56:59]
    ds_read_b128 v[36:39], v10 offset:61440
    v_mfma_f32_16x16x32_bf16 v[64:67], v[40:43], a[212:215], v[64:67]
    s_waitcnt lgkmcnt(6)
    v_mfma_f32_16x16x32_bf16 v[52:55], v[44:47], a[216:219], v[52:55]
    ds_read_b128 v[40:43], v10 offset:63488
    v_mfma_f32_16x16x32_bf16 v[60:63], v[44:47], a[220:223], v[60:63]
    s_waitcnt lgkmcnt(6)
    v_mfma_f32_16x16x32_bf16 v[56:59], v[48:51], a[216:219], v[56:59]
    ds_read_b128 v[44:47], v11 offset:61440
    v_mfma_f32_16x16x32_bf16 v[64:67], v[48:51], a[220:223], v[64:67]
    s_waitcnt lgkmcnt(6)
    v_mfma_f32_16x16x32_bf16 v[52:55], v[20:23], a[224:227], v[52:55]
    ds_read_b128 v[48:51], v11 offset:63488
    v_mfma_f32_16x16x32_bf16 v[60:63], v[20:23], a[228:231], v[60:63]
    s_waitcnt lgkmcnt(6)
    v_mfma_f32_16x16x32_bf16 v[56:59], v[24:27], a[224:227], v[56:59]
    s_waitcnt vmcnt(8)
    s_barrier
    ds_read_b128 v[20:23], v12 offset:0
    v_mfma_f32_16x16x32_bf16 v[64:67], v[24:27], a[228:231], v[64:67]
    s_waitcnt lgkmcnt(6)
    v_mfma_f32_16x16x32_bf16 v[52:55], v[28:31], a[232:235], v[52:55]
    ds_read_b128 v[24:27], v12 offset:2048
    s_add_u32 m0, s19, 0
    v_mfma_f32_16x16x32_bf16 v[60:63], v[28:31], a[236:239], v[60:63]
    buffer_load_dwordx4 v2, s[8:11], s20 offen offset:0 lds
    s_waitcnt lgkmcnt(6)
    v_mfma_f32_16x16x32_bf16 v[56:59], v[32:35], a[232:235], v[56:59]
    ds_read_b128 v[28:31], v13 offset:0
    v_mfma_f32_16x16x32_bf16 v[64:67], v[32:35], a[236:239], v[64:67]
    v_mov_b32 v9, s23
    s_add_u32 s23, s23, 1
    buffer_store_dword v9, v4, s[4:7], 0 offen sc1
    s_waitcnt lgkmcnt(6)
    v_mfma_f32_16x16x32_bf16 v[52:55], v[36:39], a[240:243], v[52:55]
    ds_read_b128 v[32:35], v13 offset:2048
    s_add_u32 m0, s19, 3968
    v_mfma_f32_16x16x32_bf16 v[60:63], v[36:39], a[244:247], v[60:63]
    buffer_load_dwordx4 v2, s[8:11], s20 offen offset:128 lds
    s_waitcnt lgkmcnt(6)
    v_mfma_f32_16x16x32_bf16 v[56:59], v[40:43], a[240:243], v[56:59]
    ds_read_b128 v[36:39], v12 offset:4096
    v_mfma_f32_16x16x32_bf16 v[64:67], v[40:43], a[244:247], v[64:67]
    s_waitcnt lgkmcnt(6)
    v_mfma_f32_16x16x32_bf16 v[52:55], v[44:47], a[248:251], v[52:55]
    ds_read_b128 v[40:43], v12 offset:6144
    s_add_u32 m0, s19, 7936
    v_mfma_f32_16x16x32_bf16 v[60:63], v[44:47], a[252:255], v[60:63]
    buffer_load_dwordx4 v2, s[8:11], s20 offen offset:256 lds
    s_waitcnt lgkmcnt(6)
    v_mfma_f32_16x16x32_bf16 v[56:59], v[48:51], a[248:251], v[56:59]
    ds_read_b128 v[44:47], v13 offset:4096
    v_mfma_f32_16x16x32_bf16 v[64:67], v[48:51], a[252:255], v[64:67]
    s_waitcnt lgkmcnt(6)
    v_mfma_f32_16x16x32_bf16 v[68:71], v[20:23], a[0:3], 0
    ds_read_b128 v[48:51], v13 offset:6144
    v_mfma_f32_16x16x32_bf16 v[76:79], v[20:23], a[4:7], 0
    s_waitcnt lgkmcnt(6)
    v_mfma_f32_16x16x32_bf16 v[72:75], v[24:27], a[0:3], 0
    ds_read_b128 v[20:23], v12 offset:8192
    s_add_u32 m0, s19, 11904
    v_mfma_f32_16x16x32_bf16 v[80:83], v[24:27], a[4:7], 0
    buffer_load_dwordx4 v2, s[8:11], s20 offen offset:384 lds
    s_waitcnt lgkmcnt(6)
    v_mfma_f32_16x16x32_bf16 v[68:71], v[28:31], a[8:11], v[68:71]
    ds_read_b128 v[24:27], v12 offset:10240
    v_mfma_f32_16x16x32_bf16 v[76:79], v[28:31], a[12:15], v[76:79]
    s_waitcnt lgkmcnt(6)
    v_mfma_f32_16x16x32_bf16 v[72:75], v[32:35], a[8:11], v[72:75]
    ds_read_b128 v[28:31], v13 offset:8192
    s_add_u32 m0, s19, 15872
    v_mfma_f32_16x16x32_bf16 v[80:83], v[32:35], a[12:15], v[80:83]
    buffer_load_dwordx4 v2, s[8:11], s20 offen offset:512 lds
    s_waitcnt lgkmcnt(6)
    v_mfma_f32_16x16x32_bf16 v[68:71], v[36:39], a[16:19], v[68:71]
    ds_read_b128 v[32:35], v13 offset:10240
    v_mfma_f32_16x16x32_bf16 v[76:79], v[36:39], a[20:23], v[76:79]
    s_waitcnt lgkmcnt(6)
    v_mfma_f32_16x16x32_bf16 v[72:75], v[40:43], a[16:19], v[72:75]
    ds_read_b128 v[36:39], v12 offset:12288
    s_add_u32 m0, s19, 19840
    v_mfma_f32_16x16x32_bf16 v[80:83], v[40:43], a[20:23], v[80:83]
    buffer_load_dwordx4 v2, s[8:11], s20 offen offset:640 lds
    s_waitcnt lgkmcnt(6)
    v_mfma_f32_16x16x32_bf16 v[68:71], v[44:47], a[24:27], v[68:71]
    ds_read_b128 v[40:43], v12 offset:14336
    v_mfma_f32_16x16x32_bf16 v[76:79], v[44:47], a[28:31], v[76:79]
    s_waitcnt lgkmcnt(6)
    v_mfma_f32_16x16x32_bf16 v[72:75], v[48:51], a[24:27], v[72:75]
    ds_read_b128 v[44:47], v13 offset:12288
    s_add_u32 m0, s19, 23808
    v_mfma_f32_16x16x32_bf16 v[80:83], v[48:51], a[28:31], v[80:83]
    buffer_load_dwordx4 v2, s[8:11], s20 offen offset:768 lds
    s_waitcnt lgkmcnt(6)
    v_mfma_f32_16x16x32_bf16 v[68:71], v[20:23], a[32:35], v[68:71]
    ds_read_b128 v[48:51], v13 offset:14336
    v_mfma_f32_16x16x32_bf16 v[76:79], v[20:23], a[36:39], v[76:79]
    s_waitcnt lgkmcnt(6)
    v_mfma_f32_16x16x32_bf16 v[72:75], v[24:27], a[32:35], v[72:75]
    ds_read_b128 v[20:23], v12 offset:16384
    s_add_u32 m0, s19, 27776
    v_mfma_f32_16x16x32_bf16 v[80:83], v[24:27], a[36:39], v[80:83]
    buffer_load_dwordx4 v2, s[8:11], s20 offen offset:896 lds
    s_waitcnt lgkmcnt(6)
    v_mfma_f32_16x16x32_bf16 v[68:71], v[28:31], a[40:43], v[68:71]
    ds_read_b128 v[24:27], v12 offset:18432
    v_mfma_f32_16x16x32_bf16 v[76:79], v[28:31], a[44:47], v[76:79]
    v_cvt_pk_bf16_f32 v84, v52, v53
    s_waitcnt lgkmcnt(6)
    v_mfma_f32_16x16x32_bf16 v[72:75], v[32:35], a[40:43], v[72:75]
    ds_read_b128 v[28:31], v13 offset:16384
    v_mfma_f32_16x16x32_bf16 v[80:83], v[32:35], a[44:47], v[80:83]
    v_cvt_pk_bf16_f32 v85, v54, v55
    s_waitcnt lgkmcnt(6)
    v_mfma_f32_16x16x32_bf16 v[68:71], v[36:39], a[48:51], v[68:71]
    ds_read_b128 v[32:35], v13 offset:18432
    v_mfma_f32_16x16x32_bf16 v[76:79], v[36:39], a[52:55], v[76:79]
    v_cvt_pk_bf16_f32 v86, v56, v57
    s_waitcnt lgkmcnt(6)
    v_mfma_f32_16x16x32_bf16 v[72:75], v[40:43], a[48:51], v[72:75]
    ds_read_b128 v[36:39], v12 offset:20480
    v_mfma_f32_16x16x32_bf16 v[80:83], v[40:43], a[52:55], v[80:83]
    v_cvt_pk_bf16_f32 v87, v58, v59
    s_waitcnt lgkmcnt(6)
    v_mfma_f32_16x16x32_bf16 v[68:71], v[44:47], a[56:59], v[68:71]
    ds_read_b128 v[40:43], v12 offset:22528
    v_mfma_f32_16x16x32_bf16 v[76:79], v[44:47], a[60:63], v[76:79]
    v_cvt_pk_bf16_f32 v88, v60, v61
    s_waitcnt lgkmcnt(6)
    v_mfma_f32_16x16x32_bf16 v[72:75], v[48:51], a[56:59], v[72:75]
    ds_read_b128 v[44:47], v13 offset:20480
    v_mfma_f32_16x16x32_bf16 v[80:83], v[48:51], a[60:63], v[80:83]
    v_cvt_pk_bf16_f32 v89, v62, v63
    buffer_store_dwordx4 v[84:87], v3, s[4:7], s21 offen offset:0 sc1
    s_waitcnt lgkmcnt(6)
    v_mfma_f32_16x16x32_bf16 v[68:71], v[20:23], a[64:67], v[68:71]
    ds_read_b128 v[48:51], v13 offset:22528
    v_mfma_f32_16x16x32_bf16 v[76:79], v[20:23], a[68:71], v[76:79]
    v_cvt_pk_bf16_f32 v90, v64, v65
    s_waitcnt lgkmcnt(6)
    v_mfma_f32_16x16x32_bf16 v[72:75], v[24:27], a[64:67], v[72:75]
    ds_read_b128 v[20:23], v12 offset:24576
    v_mfma_f32_16x16x32_bf16 v[80:83], v[24:27], a[68:71], v[80:83]
    v_cvt_pk_bf16_f32 v91, v66, v67
    s_waitcnt lgkmcnt(6)
    v_mfma_f32_16x16x32_bf16 v[68:71], v[28:31], a[72:75], v[68:71]
    ds_read_b128 v[24:27], v12 offset:26624
    v_mfma_f32_16x16x32_bf16 v[76:79], v[28:31], a[76:79], v[76:79]
    s_waitcnt lgkmcnt(6)
    v_mfma_f32_16x16x32_bf16 v[72:75], v[32:35], a[72:75], v[72:75]
    ds_read_b128 v[28:31], v13 offset:24576
    v_mfma_f32_16x16x32_bf16 v[80:83], v[32:35], a[76:79], v[80:83]
    buffer_store_dwordx4 v[88:91], v3, s[4:7], s21 offen offset:256 sc1
    s_waitcnt lgkmcnt(6)
    v_mfma_f32_16x16x32_bf16 v[68:71], v[36:39], a[80:83], v[68:71]
    ds_read_b128 v[32:35], v13 offset:26624
    v_mfma_f32_16x16x32_bf16 v[76:79], v[36:39], a[84:87], v[76:79]
    s_add_u32 s21, s21, s25
    s_mov_b32 s25, s26
    s_waitcnt lgkmcnt(6)
    v_mfma_f32_16x16x32_bf16 v[72:75], v[40:43], a[80:83], v[72:75]
    ds_read_b128 v[36:39], v12 offset:28672
    v_mfma_f32_16x16x32_bf16 v[80:83], v[40:43], a[84:87], v[80:83]
    s_waitcnt lgkmcnt(6)
    v_mfma_f32_16x16x32_bf16 v[68:71], v[44:47], a[88:91], v[68:71]
    ds_read_b128 v[40:43], v12 offset:30720
    v_mfma_f32_16x16x32_bf16 v[76:79], v[44:47], a[92:95], v[76:79]
    s_waitcnt lgkmcnt(6)
    v_mfma_f32_16x16x32_bf16 v[72:75], v[48:51], a[88:91], v[72:75]
    ds_read_b128 v[44:47], v13 offset:28672
    v_mfma_f32_16x16x32_bf16 v[80:83], v[48:51], a[92:95], v[80:83]
    s_waitcnt lgkmcnt(6)
    v_mfma_f32_16x16x32_bf16 v[68:71], v[20:23], a[96:99], v[68:71]
    ds_read_b128 v[48:51], v13 offset:30720
    v_mfma_f32_16x16x32_bf16 v[76:79], v[20:23], a[100:103], v[76:79]
    s_waitcnt lgkmcnt(6)
    v_mfma_f32_16x16x32_bf16 v[72:75], v[24:27], a[96:99], v[72:75]
    s_waitcnt vmcnt(11)
    s_barrier
    ds_read_b128 v[20:23], v12 offset:32768
    v_mfma_f32_16x16x32_bf16 v[80:83], v[24:27], a[100:103], v[80:83]
    s_waitcnt lgkmcnt(6)
    v_mfma_f32_16x16x32_bf16 v[68:71], v[28:31], a[104:107], v[68:71]
    ds_read_b128 v[24:27], v12 offset:34816
    s_add_u32 m0, s19, 31744
    v_mfma_f32_16x16x32_bf16 v[76:79], v[28:31], a[108:111], v[76:79]
    buffer_load_dwordx4 v2, s[8:11], s20 offen offset:1024 lds
    s_waitcnt lgkmcnt(6)
    v_mfma_f32_16x16x32_bf16 v[72:75], v[32:35], a[104:107], v[72:75]
    ds_read_b128 v[28:31], v13 offset:32768
    v_mfma_f32_16x16x32_bf16 v[80:83], v[32:35], a[108:111], v[80:83]
    s_waitcnt lgkmcnt(6)
    v_mfma_f32_16x16x32_bf16 v[68:71], v[36:39], a[112:115], v[68:71]
    ds_read_b128 v[32:35], v13 offset:34816
    s_add_u32 m0, s19, 35712
    v_mfma_f32_16x16x32_bf16 v[76:79], v[36:39], a[116:119], v[76:79]
    buffer_load_dwordx4 v2, s[8:11], s20 offen offset:1152 lds
    s_waitcnt lgkmcnt(6)
    v_mfma_f32_16x16x32_bf16 v[72:75], v[40:43], a[112:115], v[72:75]
    ds_read_b128 v[36:39], v12 offset:36864
    v_mfma_f32_16x16x32_bf16 v[80:83], v[40:43], a[116:119], v[80:83]
    s_waitcnt lgkmcnt(6)
    v_mfma_f32_16x16x32_bf16 v[68:71], v[44:47], a[120:123], v[68:71]
    ds_read_b128 v[40:43], v12 offset:38912
    s_add_u32 m0, s19, 39680
    v_mfma_f32_16x16x32_bf16 v[76:79], v[44:47], a[124:127], v[76:79]
    buffer_load_dwordx4 v2, s[8:11], s20 offen offset:1280 lds
    s_waitcnt lgkmcnt(6)
    v_mfma_f32_16x16x32_bf16 v[72:75], v[48:51], a[120:123], v[72:75]
    ds_read_b128 v[44:47], v13 offset:36864
    v_mfma_f32_16x16x32_bf16 v[80:83], v[48:51], a[124:127], v[80:83]
    s_waitcnt lgkmcnt(6)
    v_mfma_f32_16x16x32_bf16 v[68:71], v[20:23], a[128:131], v[68:71]
    ds_read_b128 v[48:51], v13 offset:38912
    v_mfma_f32_16x16x32_bf16 v[76:79], v[20:23], a[132:135], v[76:79]
    s_waitcnt lgkmcnt(6)
    v_mfma_f32_16x16x32_bf16 v[72:75], v[24:27], a[128:131], v[72:75]
    ds_read_b128 v[20:23], v12 offset:40960
    s_add_u32 m0, s19, 43648
    v_mfma_f32_16x16x32_bf16 v[80:83], v[24:27], a[132:135], v[80:83]
    buffer_load_dwordx4 v2, s[8:11], s20 offen offset:1408 lds
    s_waitcnt lgkmcnt(6)
    v_mfma_f32_16x16x32_bf16 v[68:71], v[28:31], a[136:139], v[68:71]
    ds_read_b128 v[24:27], v12 offset:43008
    v_mfma_f32_16x16x32_bf16 v[76:79], v[28:31], a[140:143], v[76:79]
    s_waitcnt lgkmcnt(6)
    v_mfma_f32_16x16x32_bf16 v[72:75], v[32:35], a[136:139], v[72:75]
    ds_read_b128 v[28:31], v13 offset:40960
    s_add_u32 m0, s19, 47616
    v_mfma_f32_16x16x32_bf16 v[80:83], v[32:35], a[140:143], v[80:83]
    buffer_load_dwordx4 v2, s[8:11], s20 offen offset:1536 lds
    s_waitcnt lgkmcnt(6)
    v_mfma_f32_16x16x32_bf16 v[68:71], v[36:39], a[144:147], v[68:71]
    ds_read_b128 v[32:35], v13 offset:43008
    v_mfma_f32_16x16x32_bf16 v[76:79], v[36:39], a[148:151], v[76:79]
    s_waitcnt lgkmcnt(6)
    v_mfma_f32_16x16x32_bf16 v[72:75], v[40:43], a[144:147], v[72:75]
    ds_read_b128 v[36:39], v12 offset:45056
    s_add_u32 m0, s19, 51584
    v_mfma_f32_16x16x32_bf16 v[80:83], v[40:43], a[148:151], v[80:83]
    buffer_load_dwordx4 v2, s[8:11], s20 offen offset:1664 lds
    s_waitcnt lgkmcnt(6)
    v_mfma_f32_16x16x32_bf16 v[68:71], v[44:47], a[152:155], v[68:71]
    ds_read_b128 v[40:43], v12 offset:47104
    v_mfma_f32_16x16x32_bf16 v[76:79], v[44:47], a[156:159], v[76:79]
    s_waitcnt lgkmcnt(6)
    v_mfma_f32_16x16x32_bf16 v[72:75], v[48:51], a[152:155], v[72:75]
    ds_read_b128 v[44:47], v13 offset:45056
    s_add_u32 m0, s19, 55552
    v_mfma_f32_16x16x32_bf16 v[80:83], v[48:51], a[156:159], v[80:83]
    buffer_load_dwordx4 v2, s[8:11], s20 offen offset:1792 lds
    s_waitcnt lgkmcnt(6)
    v_mfma_f32_16x16x32_bf16 v[68:71], v[20:23], a[160:163], v[68:71]
    ds_read_b128 v[48:51], v13 offset:47104
    v_mfma_f32_16x16x32_bf16 v[76:79], v[20:23], a[164:167], v[76:79]
    s_waitcnt lgkmcnt(6)
    v_mfma_f32_16x16x32_bf16 v[72:75], v[24:27], a[160:163], v[72:75]
    ds_read_b128 v[20:23], v12 offset:49152
    s_add_u32 m0, s19, 59520
    v_mfma_f32_16x16x32_bf16 v[80:83], v[24:27], a[164:167], v[80:83]
    buffer_load_dwordx4 v2, s[8:11], s20 offen offset:1920 lds
    s_waitcnt lgkmcnt(6)
    v_mfma_f32_16x16x32_bf16 v[68:71], v[28:31], a[168:171], v[68:71]
    ds_read_b128 v[24:27], v12 offset:51200
    v_mfma_f32_16x16x32_bf16 v[76:79], v[28:31], a[172:175], v[76:79]
    s_add_u32 s20, s20, s24
    s_waitcnt lgkmcnt(6)
    v_mfma_f32_16x16x32_bf16 v[72:75], v[32:35], a[168:171], v[72:75]
    ds_read_b128 v[28:31], v13 offset:49152
    v_mfma_f32_16x16x32_bf16 v[80:83], v[32:35], a[172:175], v[80:83]
    s_waitcnt lgkmcnt(6)
    v_mfma_f32_16x16x32_bf16 v[68:71], v[36:39], a[176:179], v[68:71]
    ds_read_b128 v[32:35], v13 offset:51200
    v_mfma_f32_16x16x32_bf16 v[76:79], v[36:39], a[180:183], v[76:79]
    s_waitcnt lgkmcnt(6)
    v_mfma_f32_16x16x32_bf16 v[72:75], v[40:43], a[176:179], v[72:75]
    ds_read_b128 v[36:39], v12 offset:53248
    v_mfma_f32_16x16x32_bf16 v[80:83], v[40:43], a[180:183], v[80:83]
    s_waitcnt lgkmcnt(6)
    v_mfma_f32_16x16x32_bf16 v[68:71], v[44:47], a[184:187], v[68:71]
    ds_read_b128 v[40:43], v12 offset:55296
    v_mfma_f32_16x16x32_bf16 v[76:79], v[44:47], a[188:191], v[76:79]
    s_waitcnt lgkmcnt(6)
    v_mfma_f32_16x16x32_bf16 v[72:75], v[48:51], a[184:187], v[72:75]
    ds_read_b128 v[44:47], v13 offset:53248
    v_mfma_f32_16x16x32_bf16 v[80:83], v[48:51], a[188:191], v[80:83]
    s_waitcnt lgkmcnt(6)
    v_mfma_f32_16x16x32_bf16 v[68:71], v[20:23], a[192:195], v[68:71]
    ds_read_b128 v[48:51], v13 offset:55296
    v_mfma_f32_16x16x32_bf16 v[76:79], v[20:23], a[196:199], v[76:79]
    s_waitcnt lgkmcnt(6)
    v_mfma_f32_16x16x32_bf16 v[72:75], v[24:27], a[192:195], v[72:75]
    ds_read_b128 v[20:23], v12 offset:57344
    v_mfma_f32_16x16x32_bf16 v[80:83], v[24:27], a[196:199], v[80:83]
    s_waitcnt lgkmcnt(6)
    v_mfma_f32_16x16x32_bf16 v[68:71], v[28:31], a[200:203], v[68:71]
    ds_read_b128 v[24:27], v12 offset:59392
    v_mfma_f32_16x16x32_bf16 v[76:79], v[28:31], a[204:207], v[76:79]
    s_waitcnt lgkmcnt(6)
    v_mfma_f32_16x16x32_bf16 v[72:75], v[32:35], a[200:203], v[72:75]
    ds_read_b128 v[28:31], v13 offset:57344
    v_mfma_f32_16x16x32_bf16 v[80:83], v[32:35], a[204:207], v[80:83]
    s_waitcnt lgkmcnt(6)
    v_mfma_f32_16x16x32_bf16 v[68:71], v[36:39], a[208:211], v[68:71]
    ds_read_b128 v[32:35], v13 offset:59392
    v_mfma_f32_16x16x32_bf16 v[76:79], v[36:39], a[212:215], v[76:79]
    s_waitcnt lgkmcnt(6)
    v_mfma_f32_16x16x32_bf16 v[72:75], v[40:43], a[208:211], v[72:75]
    ds_read_b128 v[36:39], v12 offset:61440
    v_mfma_f32_16x16x32_bf16 v[80:83], v[40:43], a[212:215], v[80:83]
    s_waitcnt lgkmcnt(6)
    v_mfma_f32_16x16x32_bf16 v[68:71], v[44:47], a[216:219], v[68:71]
    ds_read_b128 v[40:43], v12 offset:63488
    v_mfma_f32_16x16x32_bf16 v[76:79], v[44:47], a[220:223], v[76:79]
    s_waitcnt lgkmcnt(6)
    v_mfma_f32_16x16x32_bf16 v[72:75], v[48:51], a[216:219], v[72:75]
    ds_read_b128 v[44:47], v13 offset:61440
    v_mfma_f32_16x16x32_bf16 v[80:83], v[48:51], a[220:223], v[80:83]
    s_waitcnt lgkmcnt(6)
    v_mfma_f32_16x16x32_bf16 v[68:71], v[20:23], a[224:227], v[68:71]
    ds_read_b128 v[48:51], v13 offset:63488
    v_mfma_f32_16x16x32_bf16 v[76:79], v[20:23], a[228:231], v[76:79]
    s_waitcnt lgkmcnt(6)
    v_mfma_f32_16x16x32_bf16 v[72:75], v[24:27], a[224:227], v[72:75]
    s_waitcnt vmcnt(8)
    s_barrier
    ds_read_b128 v[20:23], v10 offset:0
    v_mfma_f32_16x16x32_bf16 v[80:83], v[24:27], a[228:231], v[80:83]
    s_waitcnt lgkmcnt(6)
    v_mfma_f32_16x16x32_bf16 v[68:71], v[28:31], a[232:235], v[68:71]
    ds_read_b128 v[24:27], v10 offset:2048
    s_add_u32 m0, s19, 65536
    v_mfma_f32_16x16x32_bf16 v[76:79], v[28:31], a[236:239], v[76:79]
    buffer_load_dwordx4 v2, s[8:11], s20 offen offset:0 lds
    s_waitcnt lgkmcnt(6)
    v_mfma_f32_16x16x32_bf16 v[72:75], v[32:35], a[232:235], v[72:75]
    ds_read_b128 v[28:31], v11 offset:0
    v_mfma_f32_16x16x32_bf16 v[80:83], v[32:35], a[236:239], v[80:83]
    v_mov_b32 v9, s23
    s_add_u32 s23, s23, 1
    buffer_store_dword v9, v4, s[4:7], 0 offen sc1
    s_waitcnt lgkmcnt(6)
    v_mfma_f32_16x16x32_bf16 v[68:71], v[36:39], a[240:243], v[68:71]
    ds_read_b128 v[32:35], v11 offset:2048
    s_add_u32 m0, s19, 69504
    v_mfma_f32_16x16x32_bf16 v[76:79], v[36:39], a[244:247], v[76:79]
    buffer_load_dwordx4 v2, s[8:11], s20 offen offset:128 lds
    s_waitcnt lgkmcnt(6)
    v_mfma_f32_16x16x32_bf16 v[72:75], v[40:43], a[240:243], v[72:75]
    ds_read_b128 v[36:39], v10 offset:4096
    v_mfma_f32_16x16x32_bf16 v[80:83], v[40:43], a[244:247], v[80:83]
    s_waitcnt lgkmcnt(6)
    v_mfma_f32_16x16x32_bf16 v[68:71], v[44:47], a[248:251], v[68:71]
    ds_read_b128 v[40:43], v10 offset:6144
    s_add_u32 m0, s19, 73472
    v_mfma_f32_16x16x32_bf16 v[76:79], v[44:47], a[252:255], v[76:79]
    buffer_load_dwordx4 v2, s[8:11], s20 offen offset:256 lds
    s_waitcnt lgkmcnt(6)
    v_mfma_f32_16x16x32_bf16 v[72:75], v[48:51], a[248:251], v[72:75]
    ds_read_b128 v[44:47], v11 offset:4096
    v_mfma_f32_16x16x32_bf16 v[80:83], v[48:51], a[252:255], v[80:83]
    s_add_u32 s22, s22, 2
    s_cmp_lt_u32 s22, 64
    s_cbranch_scc1 P_v_top
    v_cvt_pk_bf16_f32 v84, v68, v69
    v_cvt_pk_bf16_f32 v85, v70, v71
    s_nop 0
    v_cvt_pk_bf16_f32 v86, v72, v73
    v_cvt_pk_bf16_f32 v87, v74, v75
    v_cvt_pk_bf16_f32 v88, v76, v77
    v_cvt_pk_bf16_f32 v89, v78, v79
    v_cvt_pk_bf16_f32 v90, v80, v81
    v_cvt_pk_bf16_f32 v91, v82, v83
    buffer_store_dwordx4 v[84:87], v3, s[4:7], s21 offen offset:0 sc1
    buffer_store_dwordx4 v[88:91], v3, s[4:7], s21 offen offset:256 sc1
    s_waitcnt vmcnt(0) lgkmcnt(0)
    v_mov_b32 v9, s23
    s_add_u32 s23, s23, 1
    buffer_store_dword v9, v4, s[4:7], 0 offen sc1
    s_branch W_U
W_U:
    s_load_dwordx2 s[8:9], s[0:1], 64
    s_load_dwordx2 s[12:13], s[0:1], 80
    s_mov_b32 s10, 8388608
    s_mov_b32 s11, 0x20000
    s_mov_b32 s14, 8388608
    s_mov_b32 s15, 0x20000
    s_lshr_b32 s35, s91, 2
    s_lshl_b32 s35, s35, 1
    s_and_b32 s17, s91, 1
    s_add_u32 s35, s35, s17
    s_bfe_u32 s28, s91, 0x10001
    s_lshl_b32 s17, s90, 1
    s_add_u32 s28, s28, s17
    s_lshl_b32 s20, s16, 21
    s_lshl_b32 s17, s35, 7
    s_add_u32 s20, s20, s17
    v_lshrrev_b32 v5, 2, v1
    v_and_b32 v6, 3, v1
    v_lshlrev_b32 v7, 4, v6
    v_lshl_add_u32 v7, v5, 11, v7
    v_lshlrev_b32 v8, 3, v6
    v_bfe_u32 v5, v1, 2, 2
    v_lshrrev_b32 v6, 4, v1
    v_lshl_add_u32 v5, v6, 3, v5
    v_lshl_add_u32 v8, v5, 6, v8
    s_lshl_b32 s19, s16, 15
    v_add_u32 v8, s19, v8
    s_waitcnt lgkmcnt(0)
    s_barrier
    s_add_u32 m0, s19, 0
    s_add_u32 s17, s20, 0
    buffer_load_dwordx4 v7, s[8:11], s17 offen lds
    s_add_u32 m0, s19, 1024
    s_add_u32 s17, s20, 32768
    buffer_load_dwordx4 v7, s[8:11], s17 offen lds
    s_add_u32 m0, s19, 2048
    s_add_u32 s17, s20, 65536
    buffer_load_dwordx4 v7, s[8:11], s17 offen lds
    s_add_u32 m0, s19, 3072
    s_add_u32 s17, s20, 98304
    buffer_load_dwordx4 v7, s[8:11], s17 offen lds
    s_add_u32 m0, s19, 4096
    s_add_u32 s17, s20, 131072
    buffer_load_dwordx4 v7, s[8:11], s17 offen lds
    s_add_u32 m0, s19, 5120
    s_add_u32 s17, s20, 163840
    buffer_load_dwordx4 v7, s[8:11], s17 offen lds
    s_add_u32 m0, s19, 6144
    s_add_u32 s17, s20, 196608
    buffer_load_dwordx4 v7, s[8:11], s17 offen lds
    s_add_u32 m0, s19, 7168
    s_add_u32 s17, s20, 229376
    buffer_load_dwordx4 v7, s[8:11], s17 offen lds
    s_add_u32 m0, s19, 8192
    s_add_u32 s17, s20, 262144
    buffer_load_dwordx4 v7, s[8:11], s17 offen lds
    s_add_u32 m0, s19, 9216
    s_add_u32 s17, s20, 294912
    buffer_load_dwordx4 v7, s[8:11], s17 offen lds
    s_add_u32 m0, s19, 10240
    s_add_u32 s17, s20, 327680
    buffer_load_dwordx4 v7, s[8:11], s17 offen lds
    s_add_u32 m0, s19, 11264
    s_add_u32 s17, s20, 360448
    buffer_load_dwordx4 v7, s[8:11], s17 offen lds
    s_add_u32 m0, s19, 12288
    s_add_u32 s17, s20, 393216
    buffer_load_dwordx4 v7, s[8:11], s17 offen lds
    s_add_u32 m0, s19, 13312
    s_add_u32 s17, s20, 425984
    buffer_load_dwordx4 v7, s[8:11], s17 offen lds
    s_add_u32 m0, s19, 14336
    s_add_u32 s17, s20, 458752
    buffer_load_dwordx4 v7, s[8:11], s17 offen lds
    s_add_u32 m0, s19, 15360
    s_add_u32 s17, s20, 491520
    buffer_load_dwordx4 v7, s[8:11], s17 offen lds
    s_add_u32 m0, s19, 16384
    s_add_u32 s17, s20, 524288
    buffer_load_dwordx4 v7, s[8:11], s17 offen lds
    s_add_u32 m0, s19, 17408
    s_add_u32 s17, s20, 557056
    buffer_load_dwordx4 v7, s[8:11], s17 offen lds
    s_add_u32 m0, s19, 18432
    s_add_u32 s17, s20, 589824
    buffer_load_dwordx4 v7, s[8:11], s17 offen lds
    s_add_u32 m0, s19, 19456
    s_add_u32 s17, s20, 622592
    buffer_load_dwordx4 v7, s[8:11], s17 offen lds
    s_add_u32 m0, s19, 20480
    s_add_u32 s17, s20, 655360
    buffer_load_dwordx4 v7, s[8:11], s17 offen lds
    s_add_u32 m0, s19, 21504
    s_add_u32 s17, s20, 688128
    buffer_load_dwordx4 v7, s[8:11], s17 offen lds
    s_add_u32 m0, s19, 22528
    s_add_u32 s17, s20, 720896
    buffer_load_dwordx4 v7, s[8:11], s17 offen lds
    s_add_u32 m0, s19, 23552
    s_add_u32 s17, s20, 753664
    buffer_load_dwordx4 v7, s[8:11], s17 offen lds
    s_add_u32 m0, s19, 24576
    s_add_u32 s17, s20, 786432
    buffer_load_dwordx4 v7, s[8:11], s17 offen lds
    s_add_u32 m0, s19, 25600
    s_add_u32 s17, s20, 819200
    buffer_load_dwordx4 v7, s[8:11], s17 offen lds
    s_add_u32 m0, s19, 26624
    s_add_u32 s17, s20, 851968
    buffer_load_dwordx4 v7, s[8:11], s17 offen lds
    s_add_u32 m0, s19, 27648
    s_add_u32 s17, s20, 884736
    buffer_load_dwordx4 v7, s[8:11], s17 offen lds
    s_add_u32 m0, s19, 28672
    s_add_u32 s17, s20, 917504
    buffer_load_dwordx4 v7, s[8:11], s17 offen lds
    s_add_u32 m0, s19, 29696
    s_add_u32 s17, s20, 950272
    buffer_load_dwordx4 v7, s[8:11], s17 offen lds
    s_add_u32 m0, s19, 30720
    s_add_u32 s17, s20, 983040
    buffer_load_dwordx4 v7, s[8:11], s17 offen lds
    s_add_u32 m0, s19, 31744
    s_add_u32 s17, s20, 1015808
    buffer_load_dwordx4 v7, s[8:11], s17 offen lds
    s_waitcnt vmcnt(30)
    ds_read_b64_tr_b16 a[0:1], v8 offset:0
    ds_read_b64_tr_b16 a[2:3], v8 offset:256
    ds_read_b64_tr_b16 a[4:5], v8 offset:32
    ds_read_b64_tr_b16 a[6:7], v8 offset:288
    s_waitcnt vmcnt(28)
    ds_read_b64_tr_b16 a[8:9], v8 offset:2048
    ds_read_b64_tr_b16 a[10:11], v8 offset:2304
    ds_read_b64_tr_b16 a[12:13], v8 offset:2080
    ds_read_b64_tr_b16 a[14:15], v8 offset:2336
    s_waitcnt lgkmcnt(4)
    s_add_u32 m0, s19, 0
    s_add_u32 s17, s20, 1048576
    buffer_load_dwordx4 v7, s[8:11], s17 offen lds
    s_add_u32 m0, s19, 1024
    s_add_u32 s17, s20, 1081344
    buffer_load_dwordx4 v7, s[8:11], s17 offen lds
    s_waitcnt vmcnt(28)
    ds_read_b64_tr_b16 a[16:17], v8 offset:4096
    ds_read_b64_tr_b16 a[18:19], v8 offset:4352
    ds_read_b64_tr_b16 a[20:21], v8 offset:4128
    ds_read_b64_tr_b16 a[22:23], v8 offset:4384
    s_waitcnt lgkmcnt(4)
    s_add_u32 m0, s19, 2048
    s_add_u32 s17, s20, 1114112
    buffer_load_dwordx4 v7, s[8:11], s17 offen lds
    s_add_u32 m0, s19, 3072
    s_add_u32 s17, s20, 1146880
    buffer_load_dwordx4 v7, s[8:11], s17 offen lds
    s_waitcnt vmcnt(28)
    ds_read_b64_tr_b16 a[24:25], v8 offset:6144
    ds_read_b64_tr_b16 a[26:27], v8 offset:6400
    ds_read_b64_tr_b16 a[28:29], v8 offset:6176
    ds_read_b64_tr_b16 a[30:31], v8 offset:6432
    s_waitcnt lgkmcnt(4)
    s_add_u32 m0, s19, 4096
    s_add_u32 s17, s20, 1179648
    buffer_load_dwordx4 v7, s[8:11], s17 offen lds
    s_add_u32 m0, s19, 5120
    s_add_u32 s17, s20, 1212416
    buffer_load_dwordx4 v7, s[8:11], s17 offen lds
    s_waitcnt vmcnt(28)
    ds_read_b64_tr_b16 a[32:33], v8 offset:8192
    ds_read_b64_tr_b16 a[34:35], v8 offset:8448
    ds_read_b64_tr_b16 a[36:37], v8 offset:8224
    ds_read_b64_tr_b16 a[38:39], v8 offset:8480
    s_waitcnt lgkmcnt(4)
    s_add_u32 m0, s19, 6144
    s_add_u32 s17, s20, 1245184
    buffer_load_dwordx4 v7, s[8:11], s17 offen lds
    s_add_u32 m0, s19, 7168
    s_add_u32 s17, s20, 1277952
    buffer_load_dwordx4 v7, s[8:11], s17 offen lds
    s_waitcnt vmcnt(28)
    ds_read_b64_tr_b16 a[40:41], v8 offset:10240
    ds_read_b64_tr_b16 a[42:43], v8 offset:10496
    ds_read_b64_tr_b16 a[44:45], v8 offset:10272
    ds_read_b64_tr_b16 a[46:47], v8 offset:10528
    s_waitcnt lgkmcnt(4)
    s_add_u32 m0, s19, 8192
    s_add_u32 s17, s20, 1310720
    buffer_load_dwordx4 v7, s[8:11], s17 offen lds
    s_add_u32 m0, s19, 9216
    s_add_u32 s17, s20, 1343488
    buffer_load_dwordx4 v7, s[8:11], s17 offen lds
    s_waitcnt vmcnt(28)
    ds_read_b64_tr_b16 a[48:49], v8 offset:12288
    ds_read_b64_tr_b16 a[50:51], v8 offset:12544
    ds_read_b64_tr_b16 a[52:53], v8 offset:12320
    ds_read_b64_tr_b16 a[54:55], v8 offset:12576
    s_waitcnt lgkmcnt(4)
    s_add_u32 m0, s19, 10240
    s_add_u32 s17, s20, 1376256
    buffer_load_dwordx4 v7, s[8:11], s17 offen lds
    s_add_u32 m0, s19, 11264
    s_add_u32 s17, s20, 1409024
    buffer_load_dwordx4 v7, s[8:11], s17 offen lds
    s_waitcnt vmcnt(28)
    ds_read_b64_tr_b16 a[56:57], v8 offset:14336
    ds_read_b64_tr_b16 a[58:59], v8 offset:14592
    ds_read_b64_tr_b16 a[60:61], v8 offset:14368
    ds_read_b64_tr_b16 a[62:63], v8 offset:14624
    s_waitcnt lgkmcnt(4)
    s_add_u32 m0, s19, 12288
    s_add_u32 s17, s20, 1441792
    buffer_load_dwordx4 v7, s[8:11], s17 offen lds
    s_add_u32 m0, s19, 13312
    s_add_u32 s17, s20, 1474560
    buffer_load_dwordx4 v7, s[8:11], s17 offen lds
    s_waitcnt vmcnt(28)
    ds_read_b64_tr_b16 a[64:65], v8 offset:16384
    ds_read_b64_tr_b16 a[66:67], v8 offset:16640
    ds_read_b64_tr_b16 a[68:69], v8 offset:16416
    ds_read_b64_tr_b16 a[70:71], v8 offset:16672
    s_waitcnt lgkmcnt(4)
    s_add_u32 m0, s19, 14336
    s_add_u32 s17, s20, 1507328
    buffer_load_dwordx4 v7, s[8:11], s17 offen lds
    s_add_u32 m0, s19, 15360
    s_add_u32 s17, s20, 1540096
    buffer_load_dwordx4 v7, s[8:11], s17 offen lds
    s_waitcnt vmcnt(28)
    ds_read_b64_tr_b16 a[72:73], v8 offset:18432
    ds_read_b64_tr_b16 a[74:75], v8 offset:18688
    ds_read_b64_tr_b16 a[76:77], v8 offset:18464
    ds_read_b64_tr_b16 a[78:79], v8 offset:18720
    s_waitcnt lgkmcnt(4)
    s_add_u32 m0, s19, 16384
    s_add_u32 s17, s20, 1572864
    buffer_load_dwordx4 v7, s[8:11], s17 offen lds
    s_add_u32 m0, s19, 17408
    s_add_u32 s17, s20, 1605632
    buffer_load_dwordx4 v7, s[8:11], s17 offen lds
    s_waitcnt vmcnt(28)
    ds_read_b64_tr_b16 a[80:81], v8 offset:20480
    ds_read_b64_tr_b16 a[82:83], v8 offset:20736
    ds_read_b64_tr_b16 a[84:85], v8 offset:20512
    ds_read_b64_tr_b16 a[86:87], v8 offset:20768
    s_waitcnt lgkmcnt(4)
    s_add_u32 m0, s19, 18432
    s_add_u32 s17, s20, 1638400
    buffer_load_dwordx4 v7, s[8:11], s17 offen lds
    s_add_u32 m0, s19, 19456
    s_add_u32 s17, s20, 1671168
    buffer_load_dwordx4 v7, s[8:11], s17 offen lds
    s_waitcnt vmcnt(28)
    ds_read_b64_tr_b16 a[88:89], v8 offset:22528
    ds_read_b64_tr_b16 a[90:91], v8 offset:22784
    ds_read_b64_tr_b16 a[92:93], v8 offset:22560
    ds_read_b64_tr_b16 a[94:95], v8 offset:22816
    s_waitcnt lgkmcnt(4)
    s_add_u32 m0, s19, 20480
    s_add_u32 s17, s20, 1703936
    buffer_load_dwordx4 v7, s[8:11], s17 offen lds
    s_add_u32 m0, s19, 21504
    s_add_u32 s17, s20, 1736704
    buffer_load_dwordx4 v7, s[8:11], s17 offen lds
    s_waitcnt vmcnt(28)
    ds_read_b64_tr_b16 a[96:97], v8 offset:24576
    ds_read_b64_tr_b16 a[98:99], v8 offset:24832
    ds_read_b64_tr_b16 a[100:101], v8 offset:24608
    ds_read_b64_tr_b16 a[102:103], v8 offset:24864
    s_waitcnt lgkmcnt(4)
    s_add_u32 m0, s19, 22528
    s_add_u32 s17, s20, 1769472
    buffer_load_dwordx4 v7, s[8:11], s17 offen lds
    s_add_u32 m0, s19, 23552
    s_add_u32 s17, s20, 1802240
    buffer_load_dwordx4 v7, s[8:11], s17 offen lds
    s_waitcnt vmcnt(28)
    ds_read_b64_tr_b16 a[104:105], v8 offset:26624
    ds_read_b64_tr_b16 a[106:107], v8 offset:26880
    ds_read_b64_tr_b16 a[108:109], v8 offset:26656
    ds_read_b64_tr_b16 a[110:111], v8 offset:26912
    s_waitcnt lgkmcnt(4)
    s_add_u32 m0, s19, 24576
    s_add_u32 s17, s20, 1835008
    buffer_load_dwordx4 v7, s[8:11], s17 offen lds
    s_add_u32 m0, s19, 25600
    s_add_u32 s17, s20, 1867776
    buffer_load_dwordx4 v7, s[8:11], s17 offen lds
    s_waitcnt vmcnt(28)
    ds_read_b64_tr_b16 a[112:113], v8 offset:28672
    ds_read_b64_tr_b16 a[114:115], v8 offset:28928
    ds_read_b64_tr_b16 a[116:117], v8 offset:28704
    ds_read_b64_tr_b16 a[118:119], v8 offset:28960
    s_waitcnt lgkmcnt(4)
    s_add_u32 m0, s19, 26624
    s_add_u32 s17, s20, 1900544
    buffer_load_dwordx4 v7, s[8:11], s17 offen lds
    s_add_u32 m0, s19, 27648
    s_add_u32 s17, s20, 1933312
    buffer_load_dwordx4 v7, s[8:11], s17 offen lds
    s_waitcnt vmcnt(28)
    ds_read_b64_tr_b16 a[120:121], v8 offset:30720
    ds_read_b64_tr_b16 a[122:123], v8 offset:30976
    ds_read_b64_tr_b16 a[124:125], v8 offset:30752
    ds_read_b64_tr_b16 a[126:127], v8 offset:31008
    s_waitcnt lgkmcnt(4)
    s_add_u32 m0, s19, 28672
    s_add_u32 s17, s20, 1966080
    buffer_load_dwordx4 v7, s[8:11], s17 offen lds
    s_add_u32 m0, s19, 29696
    s_add_u32 s17, s20, 1998848
    buffer_load_dwordx4 v7, s[8:11], s17 offen lds
    s_waitcnt vmcnt(28)
    ds_read_b64_tr_b16 a[128:129], v8 offset:0
    ds_read_b64_tr_b16 a[130:131], v8 offset:256
    ds_read_b64_tr_b16 a[132:133], v8 offset:32
    ds_read_b64_tr_b16 a[134:135], v8 offset:288
    s_waitcnt lgkmcnt(4)
    s_add_u32 m0, s19, 30720
    s_add_u32 s17, s20, 2031616
    buffer_load_dwordx4 v7, s[8:11], s17 offen lds
    s_add_u32 m0, s19, 31744
    s_add_u32 s17, s20, 2064384
    buffer_load_dwordx4 v7, s[8:11], s17 offen lds
    s_waitcnt vmcnt(28)
    ds_read_b64_tr_b16 a[136:137], v8 offset:2048
    ds_read_b64_tr_b16 a[138:139], v8 offset:2304
    ds_read_b64_tr_b16 a[140:141], v8 offset:2080
    ds_read_b64_tr_b16 a[142:143], v8 offset:2336
    s_waitcnt lgkmcnt(4)
    s_add_u32 m0, s19, 0
    s_add_u32 s17, s20, 64
    buffer_load_dwordx4 v7, s[8:11], s17 offen lds
    s_add_u32 m0, s19, 1024
    s_add_u32 s17, s20, 32832
    buffer_load_dwordx4 v7, s[8:11], s17 offen lds
    s_waitcnt vmcnt(28)
    ds_read_b64_tr_b16 a[144:145], v8 offset:4096
    ds_read_b64_tr_b16 a[146:147], v8 offset:4352
    ds_read_b64_tr_b16 a[148:149], v8 offset:4128
    ds_read_b64_tr_b16 a[150:151], v8 offset:4384
    s_waitcnt lgkmcnt(4)
    s_add_u32 m0, s19, 2048
    s_add_u32 s17, s20, 131136
    buffer_load_dwordx4 v7, s[8:11], s17 offen lds
    s_add_u32 m0, s19, 3072
    s_add_u32 s17, s20, 163904
    buffer_load_dwordx4 v7, s[8:11], s17 offen lds
    s_waitcnt vmcnt(28)
    ds_read_b64_tr_b16 a[152:153], v8 offset:6144
    ds_read_b64_tr_b16 a[154:155], v8 offset:6400
    ds_read_b64_tr_b16 a[156:157], v8 offset:6176
    ds_read_b64_tr_b16 a[158:159], v8 offset:6432
    s_waitcnt lgkmcnt(4)
    s_add_u32 m0, s19, 4096
    s_add_u32 s17, s20, 262208
    buffer_load_dwordx4 v7, s[8:11], s17 offen lds
    s_add_u32 m0, s19, 5120
    s_add_u32 s17, s20, 294976
    buffer_load_dwordx4 v7, s[8:11], s17 offen lds
    s_waitcnt vmcnt(28)
    ds_read_b64_tr_b16 a[160:161], v8 offset:8192
    ds_read_b64_tr_b16 a[162:163], v8 offset:8448
    ds_read_b64_tr_b16 a[164:165], v8 offset:8224
    ds_read_b64_tr_b16 a[166:167], v8 offset:8480
    s_waitcnt lgkmcnt(4)
    s_add_u32 m0, s19, 6144
    s_add_u32 s17, s20, 393280
    buffer_load_dwordx4 v7, s[8:11], s17 offen lds
    s_add_u32 m0, s19, 7168
    s_add_u32 s17, s20, 426048
    buffer_load_dwordx4 v7, s[8:11], s17 offen lds
    s_waitcnt vmcnt(28)
    ds_read_b64_tr_b16 a[168:169], v8 offset:10240
    ds_read_b64_tr_b16 a[170:171], v8 offset:10496
    ds_read_b64_tr_b16 a[172:173], v8 offset:10272
    ds_read_b64_tr_b16 a[174:175], v8 offset:10528
    s_waitcnt lgkmcnt(4)
    s_add_u32 m0, s19, 8192
    s_add_u32 s17, s20, 524352
    buffer_load_dwordx4 v7, s[8:11], s17 offen lds
    s_add_u32 m0, s19, 9216
    s_add_u32 s17, s20, 557120
    buffer_load_dwordx4 v7, s[8:11], s17 offen lds
    s_waitcnt vmcnt(28)
    ds_read_b64_tr_b16 a[176:177], v8 offset:12288
    ds_read_b64_tr_b16 a[178:179], v8 offset:12544
    ds_read_b64_tr_b16 a[180:181], v8 offset:12320
    ds_read_b64_tr_b16 a[182:183], v8 offset:12576
    s_waitcnt lgkmcnt(4)
    s_add_u32 m0, s19, 10240
    s_add_u32 s17, s20, 655424
    buffer_load_dwordx4 v7, s[8:11], s17 offen lds
    s_add_u32 m0, s19, 11264
    s_add_u32 s17, s20, 688192
    buffer_load_dwordx4 v7, s[8:11], s17 offen lds
    s_waitcnt vmcnt(28)
    ds_read_b64_tr_b16 a[184:185], v8 offset:14336
    ds_read_b64_tr_b16 a[186:187], v8 offset:14592
    ds_read_b64_tr_b16 a[188:189], v8 offset:14368
    ds_read_b64_tr_b16 a[190:191], v8 offset:14624
    s_waitcnt lgkmcnt(4)
    s_add_u32 m0, s19, 12288
    s_add_u32 s17, s20, 786496
    buffer_load_dwordx4 v7, s[8:11], s17 offen lds
    s_add_u32 m0, s19, 13312
    s_add_u32 s17, s20, 819264
    buffer_load_dwordx4 v7, s[8:11], s17 offen lds
    s_waitcnt vmcnt(28)
    ds_read_b64_tr_b16 a[192:193], v8 offset:16384
    ds_read_b64_tr_b16 a[194:195], v8 offset:16640
    ds_read_b64_tr_b16 a[196:197], v8 offset:16416
    ds_read_b64_tr_b16 a[198:199], v8 offset:16672
    s_waitcnt lgkmcnt(4)
    s_add_u32 m0, s19, 14336
    s_add_u32 s17, s20, 917568
    buffer_load_dwordx4 v7, s[8:11], s17 offen lds
    s_add_u32 m0, s19, 15360
    s_add_u32 s17, s20, 950336
    buffer_load_dwordx4 v7, s[8:11], s17 offen lds
    s_waitcnt vmcnt(28)
    ds_read_b64_tr_b16 a[200:201], v8 offset:18432
    ds_read_b64_tr_b16 a[202:203], v8 offset:18688
    ds_read_b64_tr_b16 a[204:205], v8 offset:18464
    ds_read_b64_tr_b16 a[206:207], v8 offset:18720
    s_waitcnt lgkmcnt(4)
    s_add_u32 m0, s19, 16384
    s_add_u32 s17, s20, 1048640
    buffer_load_dwordx4 v7, s[8:11], s17 offen lds
    s_add_u32 m0, s19, 17408
    s_add_u32 s17, s20, 1081408
    buffer_load_dwordx4 v7, s[8:11], s17 offen lds
    s_waitcnt vmcnt(28)
    ds_read_b64_tr_b16 a[208:209], v8 offset:20480
    ds_read_b64_tr_b16 a[210:211], v8 offset:20736
    ds_read_b64_tr_b16 a[212:213], v8 offset:20512
    ds_read_b64_tr_b16 a[214:215], v8 offset:20768
    s_waitcnt lgkmcnt(4)
    s_add_u32 m0, s19, 18432
    s_add_u32 s17, s20, 1179712
    buffer_load_dwordx4 v7, s[8:11], s17 offen lds
    s_add_u32 m0, s19, 19456
    s_add_u32 s17, s20, 1212480
    buffer_load_dwordx4 v7, s[8:11], s17 offen lds
    s_waitcnt vmcnt(28)
    ds_read_b64_tr_b16 a[216:217], v8 offset:22528
    ds_read_b64_tr_b16 a[218:219], v8 offset:22784
    ds_read_b64_tr_b16 a[220:221], v8 offset:22560
    ds_read_b64_tr_b16 a[222:223], v8 offset:22816
    s_waitcnt lgkmcnt(4)
    s_add_u32 m0, s19, 20480
    s_add_u32 s17, s20, 1310784
    buffer_load_dwordx4 v7, s[8:11], s17 offen lds
    s_add_u32 m0, s19, 21504
    s_add_u32 s17, s20, 1343552
    buffer_load_dwordx4 v7, s[8:11], s17 offen lds
    s_waitcnt vmcnt(28)
    ds_read_b64_tr_b16 a[224:225], v8 offset:24576
    ds_read_b64_tr_b16 a[226:227], v8 offset:24832
    ds_read_b64_tr_b16 a[228:229], v8 offset:24608
    ds_read_b64_tr_b16 a[230:231], v8 offset:24864
    s_waitcnt lgkmcnt(4)
    s_add_u32 m0, s19, 22528
    s_add_u32 s17, s20, 1441856
    buffer_load_dwordx4 v7, s[8:11], s17 offen lds
    s_add_u32 m0, s19, 23552
    s_add_u32 s17, s20, 1474624
    buffer_load_dwordx4 v7, s[8:11], s17 offen lds
    s_waitcnt vmcnt(28)
    ds_read_b64_tr_b16 a[232:233], v8 offset:26624
    ds_read_b64_tr_b16 a[234:235], v8 offset:26880
    ds_read_b64_tr_b16 a[236:237], v8 offset:26656
    ds_read_b64_tr_b16 a[238:239], v8 offset:26912
    s_waitcnt lgkmcnt(4)
    s_add_u32 m0, s19, 24576
    s_add_u32 s17, s20, 1572928
    buffer_load_dwordx4 v7, s[8:11], s17 offen lds
    s_add_u32 m0, s19, 25600
    s_add_u32 s17, s20, 1605696
    buffer_load_dwordx4 v7, s[8:11], s17 offen lds
    s_waitcnt vmcnt(28)
    ds_read_b64_tr_b16 a[240:241], v8 offset:28672
    ds_read_b64_tr_b16 a[242:243], v8 offset:28928
    ds_read_b64_tr_b16 a[244:245], v8 offset:28704
    ds_read_b64_tr_b16 a[246:247], v8 offset:28960
    s_waitcnt lgkmcnt(4)
    s_add_u32 m0, s19, 26624
    s_add_u32 s17, s20, 1704000
    buffer_load_dwordx4 v7, s[8:11], s17 offen lds
    s_add_u32 m0, s19, 27648
    s_add_u32 s17, s20, 1736768
    buffer_load_dwordx4 v7, s[8:11], s17 offen lds
    s_waitcnt vmcnt(28)
    ds_read_b64_tr_b16 a[248:249], v8 offset:30720
    ds_read_b64_tr_b16 a[250:251], v8 offset:30976
    ds_read_b64_tr_b16 a[252:253], v8 offset:30752
    ds_read_b64_tr_b16 a[254:255], v8 offset:31008
    s_waitcnt lgkmcnt(4)
    s_add_u32 m0, s19, 28672
    s_add_u32 s17, s20, 1835072
    buffer_load_dwordx4 v7, s[8:11], s17 offen lds
    s_add_u32 m0, s19, 29696
    s_add_u32 s17, s20, 1867840
    buffer_load_dwordx4 v7, s[8:11], s17 offen lds
    s_waitcnt vmcnt(28)
    ds_read_b64_tr_b16 v[128:129], v8 offset:0
    ds_read_b64_tr_b16 v[130:131], v8 offset:256
    ds_read_b64_tr_b16 v[132:133], v8 offset:32
    ds_read_b64_tr_b16 v[134:135], v8 offset:288
    s_waitcnt lgkmcnt(4)
    s_add_u32 m0, s19, 30720
    s_add_u32 s17, s20, 1966144
    buffer_load_dwordx4 v7, s[8:11], s17 offen lds
    s_add_u32 m0, s19, 31744
    s_add_u32 s17, s20, 1998912
    buffer_load_dwordx4 v7, s[8:11], s17 offen lds
    s_waitcnt vmcnt(28)
    ds_read_b64_tr_b16 v[136:137], v8 offset:2048
    ds_read_b64_tr_b16 v[138:139], v8 offset:2304
    ds_read_b64_tr_b16 v[140:141], v8 offset:2080
    ds_read_b64_tr_b16 v[142:143], v8 offset:2336
    s_waitcnt lgkmcnt(4)
    s_add_u32 m0, s19, 0
    s_add_u32 s17, s20, 65600
    buffer_load_dwordx4 v7, s[8:11], s17 offen lds
    s_add_u32 m0, s19, 1024
    s_add_u32 s17, s20, 98368
    buffer_load_dwordx4 v7, s[8:11], s17 offen lds
    s_waitcnt vmcnt(28)
    ds_read_b64_tr_b16 v[144:145], v8 offset:4096
    ds_read_b64_tr_b16 v[146:147], v8 offset:4352
    ds_read_b64_tr_b16 v[148:149], v8 offset:4128
    ds_read_b64_tr_b16 v[150:151], v8 offset:4384
    s_waitcnt lgkmcnt(4)
    s_add_u32 m0, s19, 2048
    s_add_u32 s17, s20, 196672
    buffer_load_dwordx4 v7, s[8:11], s17 offen lds
    s_add_u32 m0, s19, 3072
    s_add_u32 s17, s20, 229440
    buffer_load_dwordx4 v7, s[8:11], s17 offen lds
    s_waitcnt vmcnt(28)
    ds_read_b64_tr_b16 v[152:153], v8 offset:6144
    ds_read_b64_tr_b16 v[154:155], v8 offset:6400
    ds_read_b64_tr_b16 v[156:157], v8 offset:6176
    ds_read_b64_tr_b16 v[158:159], v8 offset:6432
    s_waitcnt lgkmcnt(4)
    s_add_u32 m0, s19, 4096
    s_add_u32 s17, s20, 327744
    buffer_load_dwordx4 v7, s[8:11], s17 offen lds
    s_add_u32 m0, s19, 5120
    s_add_u32 s17, s20, 360512
    buffer_load_dwordx4 v7, s[8:11], s17 offen lds
    s_waitcnt vmcnt(28)
    ds_read_b64_tr_b16 v[160:161], v8 offset:8192
    ds_read_b64_tr_b16 v[162:163], v8 offset:8448
    ds_read_b64_tr_b16 v[164:165], v8 offset:8224
    ds_read_b64_tr_b16 v[166:167], v8 offset:8480
    s_waitcnt lgkmcnt(4)
    s_add_u32 m0, s19, 6144
    s_add_u32 s17, s20, 458816
    buffer_load_dwordx4 v7, s[8:11], s17 offen lds
    s_add_u32 m0, s19, 7168
    s_add_u32 s17, s20, 491584
    buffer_load_dwordx4 v7, s[8:11], s17 offen lds
    s_waitcnt vmcnt(28)
    ds_read_b64_tr_b16 v[168:169], v8 offset:10240
    ds_read_b64_tr_b16 v[170:171], v8 offset:10496
    ds_read_b64_tr_b16 v[172:173], v8 offset:10272
    ds_read_b64_tr_b16 v[174:175], v8 offset:10528
    s_waitcnt lgkmcnt(4)
    s_add_u32 m0, s19, 8192
    s_add_u32 s17, s20, 589888
    buffer_load_dwordx4 v7, s[8:11], s17 offen lds
    s_add_u32 m0, s19, 9216
    s_add_u32 s17, s20, 622656
    buffer_load_dwordx4 v7, s[8:11], s17 offen lds
    s_waitcnt vmcnt(28)
    ds_read_b64_tr_b16 v[176:177], v8 offset:12288
    ds_read_b64_tr_b16 v[178:179], v8 offset:12544
    ds_read_b64_tr_b16 v[180:181], v8 offset:12320
    ds_read_b64_tr_b16 v[182:183], v8 offset:12576
    s_waitcnt lgkmcnt(4)
    s_add_u32 m0, s19, 10240
    s_add_u32 s17, s20, 720960
    buffer_load_dwordx4 v7, s[8:11], s17 offen lds
    s_add_u32 m0, s19, 11264
    s_add_u32 s17, s20, 753728
    buffer_load_dwordx4 v7, s[8:11], s17 offen lds
    s_waitcnt vmcnt(28)
    ds_read_b64_tr_b16 v[184:185], v8 offset:14336
    ds_read_b64_tr_b16 v[186:187], v8 offset:14592
    ds_read_b64_tr_b16 v[188:189], v8 offset:14368
    ds_read_b64_tr_b16 v[190:191], v8 offset:14624
    s_waitcnt lgkmcnt(4)
    s_add_u32 m0, s19, 12288
    s_add_u32 s17, s20, 852032
    buffer_load_dwordx4 v7, s[8:11], s17 offen lds
    s_add_u32 m0, s19, 13312
    s_add_u32 s17, s20, 884800
    buffer_load_dwordx4 v7, s[8:11], s17 offen lds
    s_waitcnt vmcnt(28)
    ds_read_b64_tr_b16 v[192:193], v8 offset:16384
    ds_read_b64_tr_b16 v[194:195], v8 offset:16640
    ds_read_b64_tr_b16 v[196:197], v8 offset:16416
    ds_read_b64_tr_b16 v[198:199], v8 offset:16672
    s_waitcnt lgkmcnt(4)
    s_add_u32 m0, s19, 14336
    s_add_u32 s17, s20, 983104
    buffer_load_dwordx4 v7, s[8:11], s17 offen lds
    s_add_u32 m0, s19, 15360
    s_add_u32 s17, s20, 1015872
    buffer_load_dwordx4 v7, s[8:11], s17 offen lds
    s_waitcnt vmcnt(28)
    ds_read_b64_tr_b16 v[200:201], v8 offset:18432
    ds_read_b64_tr_b16 v[202:203], v8 offset:18688
    ds_read_b64_tr_b16 v[204:205], v8 offset:18464
    ds_read_b64_tr_b16 v[206:207], v8 offset:18720
    s_waitcnt lgkmcnt(4)
    s_add_u32 m0, s19, 16384
    s_add_u32 s17, s20, 1114176
    buffer_load_dwordx4 v7, s[8:11], s17 offen lds
    s_add_u32 m0, s19, 17408
    s_add_u32 s17, s20, 1146944
    buffer_load_dwordx4 v7, s[8:11], s17 offen lds
    s_waitcnt vmcnt(28)
    ds_read_b64_tr_b16 v[208:209], v8 offset:20480
    ds_read_b64_tr_b16 v[210:211], v8 offset:20736
    ds_read_b64_tr_b16 v[212:213], v8 offset:20512
    ds_read_b64_tr_b16 v[214:215], v8 offset:20768
    s_waitcnt lgkmcnt(4)
    s_add_u32 m0, s19, 18432
    s_add_u32 s17, s20, 1245248
    buffer_load_dwordx4 v7, s[8:11], s17 offen lds
    s_add_u32 m0, s19, 19456
    s_add_u32 s17, s20, 1278016
    buffer_load_dwordx4 v7, s[8:11], s17 offen lds
    s_waitcnt vmcnt(28)
    ds_read_b64_tr_b16 v[216:217], v8 offset:22528
    ds_read_b64_tr_b16 v[218:219], v8 offset:22784
    ds_read_b64_tr_b16 v[220:221], v8 offset:22560
    ds_read_b64_tr_b16 v[222:223], v8 offset:22816
    s_waitcnt lgkmcnt(4)
    s_add_u32 m0, s19, 20480
    s_add_u32 s17, s20, 1376320
    buffer_load_dwordx4 v7, s[8:11], s17 offen lds
    s_add_u32 m0, s19, 21504
    s_add_u32 s17, s20, 1409088
    buffer_load_dwordx4 v7, s[8:11], s17 offen lds
    s_waitcnt vmcnt(28)
    ds_read_b64_tr_b16 v[224:225], v8 offset:24576
    ds_read_b64_tr_b16 v[226:227], v8 offset:24832
    ds_read_b64_tr_b16 v[228:229], v8 offset:24608
    ds_read_b64_tr_b16 v[230:231], v8 offset:24864
    s_waitcnt lgkmcnt(4)
    s_add_u32 m0, s19, 22528
    s_add_u32 s17, s20, 1507392
    buffer_load_dwordx4 v7, s[8:11], s17 offen lds
    s_add_u32 m0, s19, 23552
    s_add_u32 s17, s20, 1540160
    buffer_load_dwordx4 v7, s[8:11], s17 offen lds
    s_waitcnt vmcnt(28)
    ds_read_b64_tr_b16 v[232:233], v8 offset:26624
    ds_read_b64_tr_b16 v[234:235], v8 offset:26880
    ds_read_b64_tr_b16 v[236:237], v8 offset:26656
    ds_read_b64_tr_b16 v[238:239], v8 offset:26912
    s_waitcnt lgkmcnt(4)
    s_add_u32 m0, s19, 24576
    s_add_u32 s17, s20, 1638464
    buffer_load_dwordx4 v7, s[8:11], s17 offen lds
    s_add_u32 m0, s19, 25600
    s_add_u32 s17, s20, 1671232
    buffer_load_dwordx4 v7, s[8:11], s17 offen lds
    s_waitcnt vmcnt(28)
    ds_read_b64_tr_b16 v[240:241], v8 offset:28672
    ds_read_b64_tr_b16 v[242:243], v8 offset:28928
    ds_read_b64_tr_b16 v[244:245], v8 offset:28704
    ds_read_b64_tr_b16 v[246:247], v8 offset:28960
    s_waitcnt lgkmcnt(4)
    s_add_u32 m0, s19, 26624
    s_add_u32 s17, s20, 1769536
    buffer_load_dwordx4 v7, s[8:11], s17 offen lds
    s_add_u32 m0, s19, 27648
    s_add_u32 s17, s20, 1802304
    buffer_load_dwordx4 v7, s[8:11], s17 offen lds
    s_waitcnt vmcnt(28)
    ds_read_b64_tr_b16 v[248:249], v8 offset:30720
    ds_read_b64_tr_b16 v[250:251], v8 offset:30976
    ds_read_b64_tr_b16 v[252:253], v8 offset:30752
    ds_read_b64_tr_b16 v[254:255], v8 offset:31008
    s_waitcnt lgkmcnt(4)
    s_add_u32 m0, s19, 28672
    s_add_u32 s17, s20, 1900608
    buffer_load_dwordx4 v7, s[8:11], s17 offen lds
    s_add_u32 m0, s19, 29696
    s_add_u32 s17, s20, 1933376
    buffer_load_dwordx4 v7, s[8:11], s17 offen lds
    s_waitcnt lgkmcnt(0)
    s_add_u32 m0, s19, 30720
    s_add_u32 s17, s20, 2031680
    buffer_load_dwordx4 v7, s[8:11], s17 offen lds
    s_add_u32 m0, s19, 31744
    s_add_u32 s17, s20, 2064448
    buffer_load_dwordx4 v7, s[8:11], s17 offen lds
    v_lshlrev_b32 v15, 4, v1
    v_add_u32 v10, s19, v15
    s_lshl_b32 s17, s16, 10
    s_add_u32 s17, s17, 131072
    v_add_u32 v14, s17, v15
    s_lshl_b32 s17, s16, 12
    s_add_u32 s18, s17, 147456
    v_add_u32 v15, s18, v15
    v_bfe_u32 v11, v1, 3, 2
    v_and_b32 v5, 7, v1
    v_lshlrev_b32 v5, 9, v5
    v_lshl_add_u32 v11, v11, 7, v5
    s_add_u32 s17, s17, 100728832
    v_add_u32 v11, s17, v11
    v_mov_b32 v12, 0
    v_and_b32 v13, 15, v1
    v_lshrrev_b32 v5, 4, v1
    v_lshlrev_b32 v5, 3, v5
    v_lshl_add_u32 v13, v13, 12, v5
    s_lshl_b32 s17, s35, 7
    s_lshl_b32 s18, s16, 5
    s_add_u32 s17, s17, s18
    s_add_u32 s17, s17, 2048
    v_add_u32 v13, s17, v13
    s_waitcnt vmcnt(0)
U_wait:
    s_mov_b32 s29, s92
U_fl:
    s_lshr_b32 s17, s28, 3
    v_cmp_ge_u32 vcc, s17, v12
    s_lshl_b32 s18, s28, 2
    s_and_b32 s18, s18, 24
    s_lshr_b32 s17, vcc_lo, s18
    s_and_b32 s17, s17, 0xff
    s_cbranch_scc0 U_go
    s_cmp_ge_u32 s29, 1048576
    s_cselect_b32 s92, 1048576, s92
    s_cbranch_scc1 U_go
    s_lshl_b32 s17, s17, s18
    s_cmp_eq_u32 s29, 0
    s_cselect_b32 exec_lo, -1, s17
    s_mov_b32 exec_hi, 0
    s_add_u32 s29, s29, 1
    buffer_load_dword v12, v11, s[4:7], 0 offen sc1
    s_mov_b64 exec, -1
    s_sleep 2
    s_waitcnt vmcnt(0)
    s_branch U_fl
U_go:
    s_lshl_b32 s30, s28, 17
    s_add_u32 s30, s30, 54525952
    buffer_load_dwordx4 v[64:67], v10, s[4:7], s30 offen offset:0
    buffer_load_dwordx4 v[68:71], v10, s[4:7], s30 offen offset:1024
    buffer_load_dwordx4 v[72:75], v10, s[4:7], s30 offen offset:2048
    buffer_load_dwordx4 v[76:79], v10, s[4:7], s30 offen offset:3072
    s_add_u32 s30, s30, 4096
    buffer_load_dwordx4 v[80:83], v10, s[4:7], s30 offen offset:0
    buffer_load_dwordx4 v[84:87], v10, s[4:7], s30 offen offset:1024
    buffer_load_dwordx4 v[88:91], v10, s[4:7], s30 offen offset:2048
    buffer_load_dwordx4 v[92:95], v10, s[4:7], s30 offen offset:3072
    s_add_u32 s30, s30, 4096
    buffer_load_dwordx4 v[96:99], v10, s[4:7], s30 offen offset:0
    buffer_load_dwordx4 v[100:103], v10, s[4:7], s30 offen offset:1024
    buffer_load_dwordx4 v[104:107], v10, s[4:7], s30 offen offset:2048
    buffer_load_dwordx4 v[108:111], v10, s[4:7], s30 offen offset:3072
    s_add_u32 s30, s30, 4096
    buffer_load_dwordx4 v[112:115], v10, s[4:7], s30 offen offset:0
    buffer_load_dwordx4 v[116:119], v10, s[4:7], s30 offen offset:1024
    buffer_load_dwordx4 v[120:123], v10, s[4:7], s30 offen offset:2048
    s_mov_b32 s34, 0
    s_mov_b32 s31, 1073741824
    ds_read_b64_tr_b16 v[32:33], v8 offset:0
    ds_read_b64_tr_b16 v[34:35], v8 offset:256
    ds_read_b64_tr_b16 v[36:37], v8 offset:32
    ds_read_b64_tr_b16 v[38:39], v8 offset:288
    ds_read_b128 v[48:51], v15 offset:0
    ds_read_b128 v[52:55], v15 offset:1024
    ds_read_b128 v[56:59], v15 offset:2048
    ds_read_b128 v[60:63], v15 offset:3072
.p2align 6
U_item:
    s_waitcnt vmcnt(14)
    v_mfma_f32_16x16x32_bf16 v[16:19], a[0:3], v[64:67], 0
    buffer_load_dwordx4 v[124:127], v10, s[4:7], s30 offen offset:3072
    v_mfma_f32_16x16x32_bf16 v[20:23], a[4:7], v[64:67], 0
    s_add_u32 s33, s28, 6
    s_lshr_b32 s17, s33, 3
    v_cmp_ge_u32 vcc, s17, v12
    s_lshl_b32 s18, s33, 2
    s_and_b32 s18, s18, 24
    v_mfma_f32_16x16x32_bf16 v[24:27], v[128:131], v[64:67], 0
    s_lshr_b32 s17, vcc_lo, s18
    s_and_b32 s17, s17, 0xff
    s_lshl_b32 exec_lo, s17, s18
    s_mov_b32 exec_hi, 0
    buffer_load_dword v12, v11, s[4:7], 0 offen sc1
    s_mov_b64 exec, -1
    v_mfma_f32_16x16x32_bf16 v[28:31], v[132:135], v[64:67], 0
    s_waitcnt vmcnt(15)
    s_waitcnt lgkmcnt(4)
    v_mfma_f32_16x16x32_bf16 v[16:19], a[8:11], v[68:71], v[16:19]
    s_add_u32 s30, s30, 4096
    buffer_load_dwordx4 v[64:67], v10, s[4:7], s30 offen offset:0
    ds_read_b64_tr_b16 v[40:41], v8 offset:2048
    ds_read_b64_tr_b16 v[42:43], v8 offset:2304
    v_mfma_f32_16x16x32_bf16 v[20:23], a[12:15], v[68:71], v[20:23]
    ds_read_b64_tr_b16 v[44:45], v8 offset:2080
    ds_read_b64_tr_b16 v[46:47], v8 offset:2336
    v_mfma_f32_16x16x32_bf16 v[24:27], v[32:35], v[68:71], v[24:27]
    v_mfma_f32_16x16x32_bf16 v[28:31], v[36:39], v[68:71], v[28:31]
    s_waitcnt vmcnt(15)
    v_mfma_f32_16x16x32_bf16 v[16:19], a[16:19], v[72:75], v[16:19]
    buffer_load_dwordx4 v[68:71], v10, s[4:7], s30 offen offset:1024
    v_mfma_f32_16x16x32_bf16 v[20:23], a[20:23], v[72:75], v[20:23]
    s_waitcnt lgkmcnt(4)
    s_cmp_eq_u32 s34, 0
    s_cbranch_scc1 U_nb
    s_barrier
U_nb:
    v_mfma_f32_16x16x32_bf16 v[24:27], v[136:139], v[72:75], v[24:27]
    ds_read_b128 v[48:51], v15 offset:0
    ds_read_b128 v[52:55], v15 offset:1024
    v_mfma_f32_16x16x32_bf16 v[28:31], v[140:143], v[72:75], v[28:31]
    ds_read_b128 v[56:59], v15 offset:2048
    ds_read_b128 v[60:63], v15 offset:3072
    s_waitcnt vmcnt(15)
    s_waitcnt lgkmcnt(4)
    v_mfma_f32_16x16x32_bf16 v[16:19], a[24:27], v[76:79], v[16:19]
    buffer_load_dwordx4 v[72:75], v10, s[4:7], s30 offen offset:2048
    ds_read_b64_tr_b16 v[32:33], v8 offset:4096
    ds_read_b64_tr_b16 v[34:35], v8 offset:4352
    v_mfma_f32_16x16x32_bf16 v[20:23], a[28:31], v[76:79], v[20:23]
    ds_read_b64_tr_b16 v[36:37], v8 offset:4128
    ds_read_b64_tr_b16 v[38:39], v8 offset:4384
    v_mfma_f32_16x16x32_bf16 v[24:27], v[40:43], v[76:79], v[24:27]
    v_mfma_f32_16x16x32_bf16 v[28:31], v[44:47], v[76:79], v[28:31]
    s_waitcnt vmcnt(15)
    v_mfma_f32_16x16x32_bf16 v[16:19], a[32:35], v[80:83], v[16:19]
    buffer_load_dwordx4 v[76:79], v10, s[4:7], s30 offen offset:3072
    s_waitcnt lgkmcnt(4)
    v_mfma_f32_16x16x32_bf16 v[20:23], a[36:39], v[80:83], v[20:23]
    v_add_f32 v48, v48, v52
    v_add_f32 v49, v49, v53
    v_mfma_f32_16x16x32_bf16 v[24:27], v[144:147], v[80:83], v[24:27]
    v_add_f32 v50, v50, v54
    v_add_f32 v51, v51, v55
    v_mfma_f32_16x16x32_bf16 v[28:31], v[148:151], v[80:83], v[28:31]
    s_waitcnt vmcnt(15)
    s_waitcnt lgkmcnt(0)
    v_mfma_f32_16x16x32_bf16 v[16:19], a[40:43], v[84:87], v[16:19]
    s_add_u32 s30, s30, 4096
    buffer_load_dwordx4 v[80:83], v10, s[4:7], s30 offen offset:0
    ds_read_b64_tr_b16 v[40:41], v8 offset:6144
    ds_read_b64_tr_b16 v[42:43], v8 offset:6400
    v_mfma_f32_16x16x32_bf16 v[20:23], a[44:47], v[84:87], v[20:23]
    v_add_f32 v56, v56, v60
    v_add_f32 v57, v57, v61
    ds_read_b64_tr_b16 v[44:45], v8 offset:6176
    ds_read_b64_tr_b16 v[46:47], v8 offset:6432
    v_mfma_f32_16x16x32_bf16 v[24:27], v[32:35], v[84:87], v[24:27]
    v_add_f32 v58, v58, v62
    v_add_f32 v59, v59, v63
    v_mfma_f32_16x16x32_bf16 v[28:31], v[36:39], v[84:87], v[28:31]
    s_waitcnt vmcnt(15)
    v_mfma_f32_16x16x32_bf16 v[16:19], a[48:51], v[88:91], v[16:19]
    buffer_load_dwordx4 v[84:87], v10, s[4:7], s30 offen offset:1024
    v_mfma_f32_16x16x32_bf16 v[20:23], a[52:55], v[88:91], v[20:23]
    v_add_f32 v48, v48, v56
    v_add_f32 v49, v49, v57
    v_mfma_f32_16x16x32_bf16 v[24:27], v[152:155], v[88:91], v[24:27]
    v_add_f32 v50, v50, v58
    v_add_f32 v51, v51, v59
    v_mfma_f32_16x16x32_bf16 v[28:31], v[156:159], v[88:91], v[28:31]
    s_waitcnt vmcnt(15)
    s_waitcnt lgkmcnt(0)
    v_mfma_f32_16x16x32_bf16 v[16:19], a[56:59], v[92:95], v[16:19]
    buffer_load_dwordx4 v[88:91], v10, s[4:7], s30 offen offset:2048
    ds_read_b64_tr_b16 v[32:33], v8 offset:8192
    ds_read_b64_tr_b16 v[34:35], v8 offset:8448
    v_mfma_f32_16x16x32_bf16 v[20:23], a[60:63], v[92:95], v[20:23]
    v_cvt_pk_bf16_f32 v52, v48, v49
    v_cvt_pk_bf16_f32 v53, v50, v51
    ds_read_b64_tr_b16 v[36:37], v8 offset:8224
    ds_read_b64_tr_b16 v[38:39], v8 offset:8480
    v_mfma_f32_16x16x32_bf16 v[24:27], v[40:43], v[92:95], v[24:27]
    v_mfma_f32_16x16x32_bf16 v[28:31], v[44:47], v[92:95], v[28:31]
    s_waitcnt vmcnt(15)
    v_mfma_f32_16x16x32_bf16 v[16:19], a[64:67], v[96:99], v[16:19]
    buffer_load_dwordx4 v[92:95], v10, s[4:7], s30 offen offset:3072
    v_mfma_f32_16x16x32_bf16 v[20:23], a[68:71], v[96:99], v[20:23]
    buffer_store_dwordx2 v[52:53], v13, s[12:15], s31 offen
    v_xor_b32 v15, 0x4000, v15
    v_mfma_f32_16x16x32_bf16 v[24:27], v[160:163], v[96:99], v[24:27]
    v_mfma_f32_16x16x32_bf16 v[28:31], v[164:167], v[96:99], v[28:31]
    s_waitcnt vmcnt(16)
    s_waitcnt lgkmcnt(0)
    v_mfma_f32_16x16x32_bf16 v[16:19], a[72:75], v[100:103], v[16:19]
    s_add_u32 s30, s30, 4096
    buffer_load_dwordx4 v[96:99], v10, s[4:7], s30 offen offset:0
    ds_read_b64_tr_b16 v[40:41], v8 offset:10240
    ds_read_b64_tr_b16 v[42:43], v8 offset:10496
    v_mfma_f32_16x16x32_bf16 v[20:23], a[76:79], v[100:103], v[20:23]
    ds_read_b64_tr_b16 v[44:45], v8 offset:10272
    ds_read_b64_tr_b16 v[46:47], v8 offset:10528
    v_mfma_f32_16x16x32_bf16 v[24:27], v[32:35], v[100:103], v[24:27]
    v_mfma_f32_16x16x32_bf16 v[28:31], v[36:39], v[100:103], v[28:31]
    s_waitcnt vmcnt(16)
    v_mfma_f32_16x16x32_bf16 v[16:19], a[80:83], v[104:107], v[16:19]
    buffer_load_dwordx4 v[100:103], v10, s[4:7], s30 offen offset:1024
    v_mfma_f32_16x16x32_bf16 v[20:23], a[84:87], v[104:107], v[20:23]
    v_mfma_f32_16x16x32_bf16 v[24:27], v[168:171], v[104:107], v[24:27]
    v_mfma_f32_16x16x32_bf16 v[28:31], v[172:175], v[104:107], v[28:31]
    s_waitcnt vmcnt(16)
    s_waitcnt lgkmcnt(0)
    v_mfma_f32_16x16x32_bf16 v[16:19], a[88:91], v[108:111], v[16:19]
    buffer_load_dwordx4 v[104:107], v10, s[4:7], s30 offen offset:2048
    ds_read_b64_tr_b16 v[32:33], v8 offset:12288
    ds_read_b64_tr_b16 v[34:35], v8 offset:12544
    v_mfma_f32_16x16x32_bf16 v[20:23], a[92:95], v[108:111], v[20:23]
    ds_read_b64_tr_b16 v[36:37], v8 offset:12320
    ds_read_b64_tr_b16 v[38:39], v8 offset:12576
    v_mfma_f32_16x16x32_bf16 v[24:27], v[40:43], v[108:111], v[24:27]
    v_mfma_f32_16x16x32_bf16 v[28:31], v[44:47], v[108:111], v[28:31]
    s_waitcnt vmcnt(16)
    v_mfma_f32_16x16x32_bf16 v[16:19], a[96:99], v[112:115], v[16:19]
    buffer_load_dwordx4 v[108:111], v10, s[4:7], s30 offen offset:3072
    v_mfma_f32_16x16x32_bf16 v[20:23], a[100:103], v[112:115], v[20:23]
    v_mfma_f32_16x16x32_bf16 v[24:27], v[176:179], v[112:115], v[24:27]
    v_mfma_f32_16x16x32_bf16 v[28:31], v[180:183], v[112:115], v[28:31]
    s_waitcnt vmcnt(16)
    s_waitcnt lgkmcnt(0)
    v_mfma_f32_16x16x32_bf16 v[16:19], a[104:107], v[116:119], v[16:19]
    s_add_u32 s30, s30, 4096
    buffer_load_dwordx4 v[112:115], v10, s[4:7], s30 offen offset:0
    ds_read_b64_tr_b16 v[40:41], v8 offset:14336
    ds_read_b64_tr_b16 v[42:43], v8 offset:14592
    v_mfma_f32_16x16x32_bf16 v[20:23], a[108:111], v[116:119], v[20:23]
    ds_read_b64_tr_b16 v[44:45], v8 offset:14368
    ds_read_b64_tr_b16 v[46:47], v8 offset:14624
    v_mfma_f32_16x16x32_bf16 v[24:27], v[32:35], v[116:119], v[24:27]
    v_mfma_f32_16x16x32_bf16 v[28:31], v[36:39], v[116:119], v[28:31]
    s_waitcnt vmcnt(16)
    v_mfma_f32_16x16x32_bf16 v[16:19], a[112:115], v[120:123], v[16:19]
    buffer_load_dwordx4 v[116:119], v10, s[4:7], s30 offen offset:1024
    v_mfma_f32_16x16x32_bf16 v[20:23], a[116:119], v[120:123], v[20:23]
    v_mfma_f32_16x16x32_bf16 v[24:27], v[184:187], v[120:123], v[24:27]
    v_mfma_f32_16x16x32_bf16 v[28:31], v[188:191], v[120:123], v[28:31]
    s_waitcnt vmcnt(16)
    s_waitcnt lgkmcnt(0)
    v_mfma_f32_16x16x32_bf16 v[16:19], a[120:123], v[124:127], v[16:19]
    buffer_load_dwordx4 v[120:123], v10, s[4:7], s30 offen offset:2048
    ds_read_b64_tr_b16 v[32:33], v8 offset:16384
    ds_read_b64_tr_b16 v[34:35], v8 offset:16640
    v_mfma_f32_16x16x32_bf16 v[20:23], a[124:127], v[124:127], v[20:23]
    ds_read_b64_tr_b16 v[36:37], v8 offset:16416
    ds_read_b64_tr_b16 v[38:39], v8 offset:16672
    v_mfma_f32_16x16x32_bf16 v[24:27], v[40:43], v[124:127], v[24:27]
    v_mfma_f32_16x16x32_bf16 v[28:31], v[44:47], v[124:127], v[28:31]
    s_waitcnt vmcnt(15)
    v_mfma_f32_16x16x32_bf16 v[16:19], a[128:131], v[64:67], v[16:19]
    buffer_load_dwordx4 v[124:127], v10, s[4:7], s30 offen offset:3072
    v_mfma_f32_16x16x32_bf16 v[20:23], a[132:135], v[64:67], v[20:23]
    s_lshr_b32 s17, s33, 3
    v_cmp_ge_u32 vcc, s17, v12
    s_lshl_b32 s18, s33, 2
    s_and_b32 s18, s18, 24
    v_mfma_f32_16x16x32_bf16 v[24:27], v[192:195], v[64:67], v[24:27]
    s_lshl_b32 s30, s33, 17
    s_add_u32 s30, s30, 54525952
    s_lshr_b32 s17, vcc_lo, s18
    s_and_b32 s17, s17, 0xff
    s_cselect_b32 s34, 0, 1
    s_cselect_b32 s30, 1073741824, s30
    v_mfma_f32_16x16x32_bf16 v[28:31], v[196:199], v[64:67], v[28:31]
    s_waitcnt vmcnt(15)
    s_waitcnt lgkmcnt(0)
    v_mfma_f32_16x16x32_bf16 v[16:19], a[136:139], v[68:71], v[16:19]
    buffer_load_dwordx4 v[64:67], v10, s[4:7], s30 offen offset:0
    ds_read_b64_tr_b16 v[40:41], v8 offset:18432
    ds_read_b64_tr_b16 v[42:43], v8 offset:18688
    v_mfma_f32_16x16x32_bf16 v[20:23], a[140:143], v[68:71], v[20:23]
    ds_read_b64_tr_b16 v[44:45], v8 offset:18464
    ds_read_b64_tr_b16 v[46:47], v8 offset:18720
    v_mfma_f32_16x16x32_bf16 v[24:27], v[32:35], v[68:71], v[24:27]
    v_mfma_f32_16x16x32_bf16 v[28:31], v[36:39], v[68:71], v[28:31]
    s_waitcnt vmcnt(15)
    v_mfma_f32_16x16x32_bf16 v[16:19], a[144:147], v[72:75], v[16:19]
    buffer_load_dwordx4 v[68:71], v10, s[4:7], s30 offen offset:1024
    v_mfma_f32_16x16x32_bf16 v[20:23], a[148:151], v[72:75], v[20:23]
    v_mfma_f32_16x16x32_bf16 v[24:27], v[200:203], v[72:75], v[24:27]
    v_mfma_f32_16x16x32_bf16 v[28:31], v[204:207], v[72:75], v[28:31]
    s_waitcnt vmcnt(15)
    s_waitcnt lgkmcnt(0)
    v_mfma_f32_16x16x32_bf16 v[16:19], a[152:155], v[76:79], v[16:19]
    buffer_load_dwordx4 v[72:75], v10, s[4:7], s30 offen offset:2048
    ds_read_b64_tr_b16 v[32:33], v8 offset:20480
    ds_read_b64_tr_b16 v[34:35], v8 offset:20736
    v_mfma_f32_16x16x32_bf16 v[20:23], a[156:159], v[76:79], v[20:23]
    ds_read_b64_tr_b16 v[36:37], v8 offset:20512
    ds_read_b64_tr_b16 v[38:39], v8 offset:20768
    v_mfma_f32_16x16x32_bf16 v[24:27], v[40:43], v[76:79], v[24:27]
    v_mfma_f32_16x16x32_bf16 v[28:31], v[44:47], v[76:79], v[28:31]
    s_waitcnt vmcnt(15)
    v_mfma_f32_16x16x32_bf16 v[16:19], a[160:163], v[80:83], v[16:19]
    buffer_load_dwordx4 v[76:79], v10, s[4:7], s30 offen offset:3072
    v_mfma_f32_16x16x32_bf16 v[20:23], a[164:167], v[80:83], v[20:23]
    v_mfma_f32_16x16x32_bf16 v[24:27], v[208:211], v[80:83], v[24:27]
    v_mfma_f32_16x16x32_bf16 v[28:31], v[212:215], v[80:83], v[28:31]
    s_waitcnt vmcnt(15)
    s_waitcnt lgkmcnt(0)
    v_mfma_f32_16x16x32_bf16 v[16:19], a[168:171], v[84:87], v[16:19]
    s_add_u32 s30, s30, 4096
    buffer_load_dwordx4 v[80:83], v10, s[4:7], s30 offen offset:0
    ds_read_b64_tr_b16 v[40:41], v8 offset:22528
    ds_read_b64_tr_b16 v[42:43], v8 offset:22784
    v_mfma_f32_16x16x32_bf16 v[20:23], a[172:175], v[84:87], v[20:23]
    ds_read_b64_tr_b16 v[44:45], v8 offset:22560
    ds_read_b64_tr_b16 v[46:47], v8 offset:22816
    v_mfma_f32_16x16x32_bf16 v[24:27], v[32:35], v[84:87], v[24:27]
    v_mfma_f32_16x16x32_bf16 v[28:31], v[36:39], v[84:87], v[28:31]
    s_waitcnt vmcnt(15)
    v_mfma_f32_16x16x32_bf16 v[16:19], a[176:179], v[88:91], v[16:19]
    buffer_load_dwordx4 v[84:87], v10, s[4:7], s30 offen offset:1024
    v_mfma_f32_16x16x32_bf16 v[20:23], a[180:183], v[88:91], v[20:23]
    v_mfma_f32_16x16x32_bf16 v[24:27], v[216:219], v[88:91], v[24:27]
    v_mfma_f32_16x16x32_bf16 v[28:31], v[220:223], v[88:91], v[28:31]
    s_waitcnt vmcnt(15)
    s_waitcnt lgkmcnt(0)
    v_mfma_f32_16x16x32_bf16 v[16:19], a[184:187], v[92:95], v[16:19]
    buffer_load_dwordx4 v[88:91], v10, s[4:7], s30 offen offset:2048
    ds_read_b64_tr_b16 v[32:33], v8 offset:24576
    ds_read_b64_tr_b16 v[34:35], v8 offset:24832
    v_mfma_f32_16x16x32_bf16 v[20:23], a[188:191], v[92:95], v[20:23]
    ds_read_b64_tr_b16 v[36:37], v8 offset:24608
    ds_read_b64_tr_b16 v[38:39], v8 offset:24864
    v_mfma_f32_16x16x32_bf16 v[24:27], v[40:43], v[92:95], v[24:27]
    v_mfma_f32_16x16x32_bf16 v[28:31], v[44:47], v[92:95], v[28:31]
    s_waitcnt vmcnt(14)
    v_mfma_f32_16x16x32_bf16 v[16:19], a[192:195], v[96:99], v[16:19]
    buffer_load_dwordx4 v[92:95], v10, s[4:7], s30 offen offset:3072
    v_mfma_f32_16x16x32_bf16 v[20:23], a[196:199], v[96:99], v[20:23]
    v_mfma_f32_16x16x32_bf16 v[24:27], v[224:227], v[96:99], v[24:27]
    v_mfma_f32_16x16x32_bf16 v[28:31], v[228:231], v[96:99], v[28:31]
    s_waitcnt vmcnt(14)
    s_waitcnt lgkmcnt(0)
    v_mfma_f32_16x16x32_bf16 v[16:19], a[200:203], v[100:103], v[16:19]
    s_add_u32 s30, s30, 4096
    buffer_load_dwordx4 v[96:99], v10, s[4:7], s30 offen offset:0
    ds_read_b64_tr_b16 v[40:41], v8 offset:26624
    ds_read_b64_tr_b16 v[42:43], v8 offset:26880
    v_mfma_f32_16x16x32_bf16 v[20:23], a[204:207], v[100:103], v[20:23]
    ds_read_b64_tr_b16 v[44:45], v8 offset:26656
    ds_read_b64_tr_b16 v[46:47], v8 offset:26912
    v_mfma_f32_16x16x32_bf16 v[24:27], v[32:35], v[100:103], v[24:27]
    v_mfma_f32_16x16x32_bf16 v[28:31], v[36:39], v[100:103], v[28:31]
    s_waitcnt vmcnt(14)
    v_mfma_f32_16x16x32_bf16 v[16:19], a[208:211], v[104:107], v[16:19]
    buffer_load_dwordx4 v[100:103], v10, s[4:7], s30 offen offset:1024
    v_mfma_f32_16x16x32_bf16 v[20:23], a[212:215], v[104:107], v[20:23]
    v_mfma_f32_16x16x32_bf16 v[24:27], v[232:235], v[104:107], v[24:27]
    v_mfma_f32_16x16x32_bf16 v[28:31], v[236:239], v[104:107], v[28:31]
    s_waitcnt vmcnt(14)
    s_waitcnt lgkmcnt(0)
    v_mfma_f32_16x16x32_bf16 v[16:19], a[216:219], v[108:111], v[16:19]
    buffer_load_dwordx4 v[104:107], v10, s[4:7], s30 offen offset:2048
    ds_read_b64_tr_b16 v[32:33], v8 offset:28672
    ds_read_b64_tr_b16 v[34:35], v8 offset:28928
    v_mfma_f32_16x16x32_bf16 v[20:23], a[220:223], v[108:111], v[20:23]
    ds_read_b64_tr_b16 v[36:37], v8 offset:28704
    ds_read_b64_tr_b16 v[38:39], v8 offset:28960
    v_mfma_f32_16x16x32_bf16 v[24:27], v[40:43], v[108:111], v[24:27]
    v_mfma_f32_16x16x32_bf16 v[28:31], v[44:47], v[108:111], v[28:31]
    s_waitcnt vmcnt(14)
    v_mfma_f32_16x16x32_bf16 v[16:19], a[224:227], v[112:115], v[16:19]
    buffer_load_dwordx4 v[108:111], v10, s[4:7], s30 offen offset:3072
    v_mfma_f32_16x16x32_bf16 v[20:23], a[228:231], v[112:115], v[20:23]
    v_mfma_f32_16x16x32_bf16 v[24:27], v[240:243], v[112:115], v[24:27]
    v_mfma_f32_16x16x32_bf16 v[28:31], v[244:247], v[112:115], v[28:31]
    s_waitcnt vmcnt(14)
    s_waitcnt lgkmcnt(0)
    v_mfma_f32_16x16x32_bf16 v[16:19], a[232:235], v[116:119], v[16:19]
    s_add_u32 s30, s30, 4096
    buffer_load_dwordx4 v[112:115], v10, s[4:7], s30 offen offset:0
    ds_read_b64_tr_b16 v[40:41], v8 offset:30720
    ds_read_b64_tr_b16 v[42:43], v8 offset:30976
    v_mfma_f32_16x16x32_bf16 v[20:23], a[236:239], v[116:119], v[20:23]
    ds_read_b64_tr_b16 v[44:45], v8 offset:30752
    ds_read_b64_tr_b16 v[46:47], v8 offset:31008
    v_mfma_f32_16x16x32_bf16 v[24:27], v[32:35], v[116:119], v[24:27]
    v_mfma_f32_16x16x32_bf16 v[28:31], v[36:39], v[116:119], v[28:31]
    s_waitcnt vmcnt(14)
    v_mfma_f32_16x16x32_bf16 v[16:19], a[240:243], v[120:123], v[16:19]
    buffer_load_dwordx4 v[116:119], v10, s[4:7], s30 offen offset:1024
    v_mfma_f32_16x16x32_bf16 v[20:23], a[244:247], v[120:123], v[20:23]
    v_mfma_f32_16x16x32_bf16 v[24:27], v[248:251], v[120:123], v[24:27]
    v_mfma_f32_16x16x32_bf16 v[28:31], v[252:255], v[120:123], v[28:31]
    s_waitcnt vmcnt(14)
    s_waitcnt lgkmcnt(0)
    v_mfma_f32_16x16x32_bf16 v[16:19], a[248:251], v[124:127], v[16:19]
    buffer_load_dwordx4 v[120:123], v10, s[4:7], s30 offen offset:2048
    ds_read_b64_tr_b16 v[32:33], v8 offset:0
    ds_read_b64_tr_b16 v[34:35], v8 offset:256
    v_mfma_f32_16x16x32_bf16 v[20:23], a[252:255], v[124:127], v[20:23]
    ds_read_b64_tr_b16 v[36:37], v8 offset:32
    ds_read_b64_tr_b16 v[38:39], v8 offset:288
    v_mfma_f32_16x16x32_bf16 v[24:27], v[40:43], v[124:127], v[24:27]
    v_mfma_f32_16x16x32_bf16 v[28:31], v[44:47], v[124:127], v[28:31]
    s_lshl_b32 s31, s28, 16
    s_mov_b32 s28, s33
    s_cmp_eq_u32 s34, 1
    ds_write_b128 v14, v[16:19] offset:0
    ds_write_b128 v14, v[20:23] offset:4096
    ds_write_b128 v14, v[24:27] offset:8192
    s_nop 1
    ds_write_b128 v14, v[28:31] offset:12288
    v_xor_b32 v14, 0x4000, v14
    s_cbranch_scc1 U_item
    s_waitcnt lgkmcnt(0)
    s_barrier
    ds_read_b128 v[48:51], v15 offset:0
    ds_read_b128 v[52:55], v15 offset:1024
    ds_read_b128 v[56:59], v15 offset:2048
    ds_read_b128 v[60:63], v15 offset:3072
    s_waitcnt lgkmcnt(0)
    v_add_f32 v48, v48, v52
    v_add_f32 v49, v49, v53
    v_add_f32 v50, v50, v54
    v_add_f32 v51, v51, v55
    v_add_f32 v56, v56, v60
    v_add_f32 v57, v57, v61
    v_add_f32 v58, v58, v62
    v_add_f32 v59, v59, v63
    v_add_f32 v48, v48, v56
    v_add_f32 v49, v49, v57
    v_add_f32 v50, v50, v58
    v_add_f32 v51, v51, v59
    v_cvt_pk_bf16_f32 v52, v48, v49
    v_cvt_pk_bf16_f32 v53, v50, v51
    buffer_store_dwordx2 v[52:53], v13, s[12:15], s31 offen
    s_cmp_lt_u32 s28, 128
    s_cbranch_scc1 U_wait
    s_branch W_fin
W_F:
    v_and_b32 v10, 19, v1
    v_bfe_u32 v5, v1, 2, 1
    v_bfe_u32 v6, v1, 3, 1
    v_lshl_add_u32 v10, v5, 3, v10
    v_lshl_add_u32 v10, v6, 2, v10
    s_load_dwordx2 s[8:9], s[0:1], 8
    s_load_dwordx2 s[12:13], s[0:1], 16
    s_mov_b32 s10, 2101248
    s_mov_b32 s11, 0x20000
    s_mov_b32 s14, 2101248
    s_mov_b32 s15, 0x20000
    v_lshrrev_b32 v11, 5, v1
    v_lshl_add_u32 v12, v11, 9, v10
    v_mul_u32_u24 v12, 1026, v12
    v_and_b32 v13, 1, v1
    v_lshlrev_b32 v13, 4, v13
    v_lshlrev_b32 v14, 4, v1
    s_lshr_b32 s17, s16, 1
    s_and_b32 s18, s16, 1
    s_lshl_b32 s17, s17, 5
    s_lshl_b32 s18, s18, 10
    s_add_u32 s17, s17, s18
    s_mul_i32 s20, s17, 1026
    s_lshl_b32 s17, s91, 5
    s_add_u32 s20, s20, s17
    s_lshl_b32 s21, s91, 17
    s_lshl_b32 s17, s16, 11
    s_add_u32 s21, s21, s17
    s_add_u32 s21, s21, 117440512
    v_and_b32 v7, -4, v12
    s_mov_b32 s28, 0x05040100
    s_mov_b32 s29, 0x07060302
    s_waitcnt lgkmcnt(0)
    buffer_load_dwordx4 v[20:23], v7, s[8:11], s20 offen
    buffer_load_dwordx4 v[24:27], v7, s[8:11], s20 offen offset:16
    buffer_load_dword v28, v7, s[8:11], s20 offen offset:32
    buffer_load_dwordx4 v[30:33], v7, s[12:15], s20 offen
    buffer_load_dwordx4 v[34:37], v7, s[12:15], s20 offen offset:16
    buffer_load_dword v38, v7, s[12:15], s20 offen offset:32
    s_add_u32 s20, s20, 65664
    buffer_load_dwordx4 v[40:43], v7, s[8:11], s20 offen
    buffer_load_dwordx4 v[44:47], v7, s[8:11], s20 offen offset:16
    buffer_load_dword v48, v7, s[8:11], s20 offen offset:32
    buffer_load_dwordx4 v[50:53], v7, s[12:15], s20 offen
    buffer_load_dwordx4 v[54:57], v7, s[12:15], s20 offen offset:16
    buffer_load_dword v58, v7, s[12:15], s20 offen offset:32
    s_add_u32 s20, s20, 65664
    buffer_load_dwordx4 v[60:63], v7, s[8:11], s20 offen
    buffer_load_dwordx4 v[64:67], v7, s[8:11], s20 offen offset:16
    buffer_load_dword v68, v7, s[8:11], s20 offen offset:32
    buffer_load_dwordx4 v[70:73], v7, s[12:15], s20 offen
    buffer_load_dwordx4 v[74:77], v7, s[12:15], s20 offen offset:16
    buffer_load_dword v78, v7, s[12:15], s20 offen offset:32
    s_add_u32 s20, s20, 65664
    buffer_load_dwordx4 v[80:83], v7, s[8:11], s20 offen
    buffer_load_dwordx4 v[84:87], v7, s[8:11], s20 offen offset:16
    buffer_load_dword v88, v7, s[8:11], s20 offen offset:32
    buffer_load_dwordx4 v[90:93], v7, s[12:15], s20 offen
    buffer_load_dwordx4 v[94:97], v7, s[12:15], s20 offen offset:16
    buffer_load_dword v98, v7, s[12:15], s20 offen offset:32
    s_add_u32 s20, s20, 65664
    s_waitcnt vmcnt(0)
    v_alignbit_b32 v20, v21, v20, v13
    v_alignbit_b32 v21, v22, v21, v13
    v_alignbit_b32 v22, v23, v22, v13
    v_alignbit_b32 v23, v24, v23, v13
    v_alignbit_b32 v24, v25, v24, v13
    v_alignbit_b32 v25, v26, v25, v13
    v_alignbit_b32 v26, v27, v26, v13
    v_alignbit_b32 v27, v28, v27, v13
    v_alignbit_b32 v30, v31, v30, v13
    v_alignbit_b32 v31, v32, v31, v13
    v_alignbit_b32 v32, v33, v32, v13
    v_alignbit_b32 v33, v34, v33, v13
    v_alignbit_b32 v34, v35, v34, v13
    v_alignbit_b32 v35, v36, v35, v13
    v_alignbit_b32 v36, v37, v36, v13
    v_alignbit_b32 v37, v38, v37, v13
    v_perm_b32 v100, v30, v20, s28
    v_perm_b32 v104, v30, v20, s29
    v_perm_b32 v108, v31, v21, s28
    v_perm_b32 v112, v31, v21, s29
    v_perm_b32 v116, v32, v22, s28
    v_perm_b32 v120, v32, v22, s29
    v_perm_b32 v124, v33, v23, s28
    v_perm_b32 v128, v33, v23, s29
    v_perm_b32 v132, v34, v24, s28
    v_perm_b32 v136, v34, v24, s29
    v_perm_b32 v140, v35, v25, s28
    v_perm_b32 v144, v35, v25, s29
    v_perm_b32 v148, v36, v26, s28
    v_perm_b32 v152, v36, v26, s29
    v_perm_b32 v156, v37, v27, s28
    v_perm_b32 v160, v37, v27, s29
    v_alignbit_b32 v40, v41, v40, v13
    v_alignbit_b32 v41, v42, v41, v13
    v_alignbit_b32 v42, v43, v42, v13
    v_alignbit_b32 v43, v44, v43, v13
    v_alignbit_b32 v44, v45, v44, v13
    v_alignbit_b32 v45, v46, v45, v13
    v_alignbit_b32 v46, v47, v46, v13
    v_alignbit_b32 v47, v48, v47, v13
    v_alignbit_b32 v50, v51, v50, v13
    v_alignbit_b32 v51, v52, v51, v13
    v_alignbit_b32 v52, v53, v52, v13
    v_alignbit_b32 v53, v54, v53, v13
    v_alignbit_b32 v54, v55, v54, v13
    v_alignbit_b32 v55, v56, v55, v13
    v_alignbit_b32 v56, v57, v56, v13
    v_alignbit_b32 v57, v58, v57, v13
    v_perm_b32 v101, v50, v40, s28
    v_perm_b32 v105, v50, v40, s29
    v_perm_b32 v109, v51, v41, s28
    v_perm_b32 v113, v51, v41, s29
    v_perm_b32 v117, v52, v42, s28
    v_perm_b32 v121, v52, v42, s29
    v_perm_b32 v125, v53, v43, s28
    v_perm_b32 v129, v53, v43, s29
    v_perm_b32 v133, v54, v44, s28
    v_perm_b32 v137, v54, v44, s29
    v_perm_b32 v141, v55, v45, s28
    v_perm_b32 v145, v55, v45, s29
    v_perm_b32 v149, v56, v46, s28
    v_perm_b32 v153, v56, v46, s29
    v_perm_b32 v157, v57, v47, s28
    v_perm_b32 v161, v57, v47, s29
    v_alignbit_b32 v60, v61, v60, v13
    v_alignbit_b32 v61, v62, v61, v13
    v_alignbit_b32 v62, v63, v62, v13
    v_alignbit_b32 v63, v64, v63, v13
    v_alignbit_b32 v64, v65, v64, v13
    v_alignbit_b32 v65, v66, v65, v13
    v_alignbit_b32 v66, v67, v66, v13
    v_alignbit_b32 v67, v68, v67, v13
    v_alignbit_b32 v70, v71, v70, v13
    v_alignbit_b32 v71, v72, v71, v13
    v_alignbit_b32 v72, v73, v72, v13
    v_alignbit_b32 v73, v74, v73, v13
    v_alignbit_b32 v74, v75, v74, v13
    v_alignbit_b32 v75, v76, v75, v13
    v_alignbit_b32 v76, v77, v76, v13
    v_alignbit_b32 v77, v78, v77, v13
    v_perm_b32 v102, v70, v60, s28
    v_perm_b32 v106, v70, v60, s29
    v_perm_b32 v110, v71, v61, s28
    v_perm_b32 v114, v71, v61, s29
    v_perm_b32 v118, v72, v62, s28
    v_perm_b32 v122, v72, v62, s29
    v_perm_b32 v126, v73, v63, s28
    v_perm_b32 v130, v73, v63, s29
    v_perm_b32 v134, v74, v64, s28
    v_perm_b32 v138, v74, v64, s29
    v_perm_b32 v142, v75, v65, s28
    v_perm_b32 v146, v75, v65, s29
    v_perm_b32 v150, v76, v66, s28
    v_perm_b32 v154, v76, v66, s29
    v_perm_b32 v158, v77, v67, s28
    v_perm_b32 v162, v77, v67, s29
    v_alignbit_b32 v80, v81, v80, v13
    v_alignbit_b32 v81, v82, v81, v13
    v_alignbit_b32 v82, v83, v82, v13
    v_alignbit_b32 v83, v84, v83, v13
    v_alignbit_b32 v84, v85, v84, v13
    v_alignbit_b32 v85, v86, v85, v13
    v_alignbit_b32 v86, v87, v86, v13
    v_alignbit_b32 v87, v88, v87, v13
    v_alignbit_b32 v90, v91, v90, v13
    v_alignbit_b32 v91, v92, v91, v13
    v_alignbit_b32 v92, v93, v92, v13
    v_alignbit_b32 v93, v94, v93, v13
    v_alignbit_b32 v94, v95, v94, v13
    v_alignbit_b32 v95, v96, v95, v13
    v_alignbit_b32 v96, v97, v96, v13
    v_alignbit_b32 v97, v98, v97, v13
    v_perm_b32 v103, v90, v80, s28
    v_perm_b32 v107, v90, v80, s29
    v_perm_b32 v111, v91, v81, s28
    v_perm_b32 v115, v91, v81, s29
    v_perm_b32 v119, v92, v82, s28
    v_perm_b32 v123, v92, v82, s29
    v_perm_b32 v127, v93, v83, s28
    v_perm_b32 v131, v93, v83, s29
    v_perm_b32 v135, v94, v84, s28
    v_perm_b32 v139, v94, v84, s29
    v_perm_b32 v143, v95, v85, s28
    v_perm_b32 v147, v95, v85, s29
    v_perm_b32 v151, v96, v86, s28
    v_perm_b32 v155, v96, v86, s29
    v_perm_b32 v159, v97, v87, s28
    v_perm_b32 v163, v97, v87, s29
    s_add_u32 s17, s21, 0
    buffer_store_dwordx4 v[100:103], v14, s[4:7], s17 offen
    s_add_u32 s17, s21, 8192
    buffer_store_dwordx4 v[104:107], v14, s[4:7], s17 offen
    s_add_u32 s17, s21, 16384
    buffer_store_dwordx4 v[108:111], v14, s[4:7], s17 offen
    s_add_u32 s17, s21, 24576
    buffer_store_dwordx4 v[112:115], v14, s[4:7], s17 offen
    s_add_u32 s17, s21, 32768
    buffer_store_dwordx4 v[116:119], v14, s[4:7], s17 offen
    s_add_u32 s17, s21, 40960
    buffer_store_dwordx4 v[120:123], v14, s[4:7], s17 offen
    s_add_u32 s17, s21, 49152
    buffer_store_dwordx4 v[124:127], v14, s[4:7], s17 offen
    s_add_u32 s17, s21, 57344
    buffer_store_dwordx4 v[128:131], v14, s[4:7], s17 offen
    s_add_u32 s17, s21, 65536
    buffer_store_dwordx4 v[132:135], v14, s[4:7], s17 offen
    s_add_u32 s17, s21, 73728
    buffer_store_dwordx4 v[136:139], v14, s[4:7], s17 offen
    s_add_u32 s17, s21, 81920
    buffer_store_dwordx4 v[140:143], v14, s[4:7], s17 offen
    s_add_u32 s17, s21, 90112
    buffer_store_dwordx4 v[144:147], v14, s[4:7], s17 offen
    s_add_u32 s17, s21, 98304
    buffer_store_dwordx4 v[148:151], v14, s[4:7], s17 offen
    s_add_u32 s17, s21, 106496
    buffer_store_dwordx4 v[152:155], v14, s[4:7], s17 offen
    s_add_u32 s17, s21, 114688
    buffer_store_dwordx4 v[156:159], v14, s[4:7], s17 offen
    s_add_u32 s17, s21, 122880
    buffer_store_dwordx4 v[160:163], v14, s[4:7], s17 offen
    buffer_load_dwordx4 v[20:23], v7, s[8:11], s20 offen
    buffer_load_dwordx4 v[24:27], v7, s[8:11], s20 offen offset:16
    buffer_load_dword v28, v7, s[8:11], s20 offen offset:32
    buffer_load_dwordx4 v[30:33], v7, s[12:15], s20 offen
    buffer_load_dwordx4 v[34:37], v7, s[12:15], s20 offen offset:16
    buffer_load_dword v38, v7, s[12:15], s20 offen offset:32
    s_add_u32 s20, s20, 65664
    buffer_load_dwordx4 v[40:43], v7, s[8:11], s20 offen
    buffer_load_dwordx4 v[44:47], v7, s[8:11], s20 offen offset:16
    buffer_load_dword v48, v7, s[8:11], s20 offen offset:32
    buffer_load_dwordx4 v[50:53], v7, s[12:15], s20 offen
    buffer_load_dwordx4 v[54:57], v7, s[12:15], s20 offen offset:16
    buffer_load_dword v58, v7, s[12:15], s20 offen offset:32
    s_add_u32 s20, s20, 65664
    buffer_load_dwordx4 v[60:63], v7, s[8:11], s20 offen
    buffer_load_dwordx4 v[64:67], v7, s[8:11], s20 offen offset:16
    buffer_load_dword v68, v7, s[8:11], s20 offen offset:32
    buffer_load_dwordx4 v[70:73], v7, s[12:15], s20 offen
    buffer_load_dwordx4 v[74:77], v7, s[12:15], s20 offen offset:16
    buffer_load_dword v78, v7, s[12:15], s20 offen offset:32
    s_add_u32 s20, s20, 65664
    buffer_load_dwordx4 v[80:83], v7, s[8:11], s20 offen
    buffer_load_dwordx4 v[84:87], v7, s[8:11], s20 offen offset:16
    buffer_load_dword v88, v7, s[8:11], s20 offen offset:32
    buffer_load_dwordx4 v[90:93], v7, s[12:15], s20 offen
    buffer_load_dwordx4 v[94:97], v7, s[12:15], s20 offen offset:16
    buffer_load_dword v98, v7, s[12:15], s20 offen offset:32
    s_add_u32 s20, s20, 65664
    s_waitcnt vmcnt(0)
    v_alignbit_b32 v20, v21, v20, v13
    v_alignbit_b32 v21, v22, v21, v13
    v_alignbit_b32 v22, v23, v22, v13
    v_alignbit_b32 v23, v24, v23, v13
    v_alignbit_b32 v24, v25, v24, v13
    v_alignbit_b32 v25, v26, v25, v13
    v_alignbit_b32 v26, v27, v26, v13
    v_alignbit_b32 v27, v28, v27, v13
    v_alignbit_b32 v30, v31, v30, v13
    v_alignbit_b32 v31, v32, v31, v13
    v_alignbit_b32 v32, v33, v32, v13
    v_alignbit_b32 v33, v34, v33, v13
    v_alignbit_b32 v34, v35, v34, v13
    v_alignbit_b32 v35, v36, v35, v13
    v_alignbit_b32 v36, v37, v36, v13
    v_alignbit_b32 v37, v38, v37, v13
    v_perm_b32 v100, v30, v20, s28
    v_perm_b32 v104, v30, v20, s29
    v_perm_b32 v108, v31, v21, s28
    v_perm_b32 v112, v31, v21, s29
    v_perm_b32 v116, v32, v22, s28
    v_perm_b32 v120, v32, v22, s29
    v_perm_b32 v124, v33, v23, s28
    v_perm_b32 v128, v33, v23, s29
    v_perm_b32 v132, v34, v24, s28
    v_perm_b32 v136, v34, v24, s29
    v_perm_b32 v140, v35, v25, s28
    v_perm_b32 v144, v35, v25, s29
    v_perm_b32 v148, v36, v26, s28
    v_perm_b32 v152, v36, v26, s29
    v_perm_b32 v156, v37, v27, s28
    v_perm_b32 v160, v37, v27, s29
    v_alignbit_b32 v40, v41, v40, v13
    v_alignbit_b32 v41, v42, v41, v13
    v_alignbit_b32 v42, v43, v42, v13
    v_alignbit_b32 v43, v44, v43, v13
    v_alignbit_b32 v44, v45, v44, v13
    v_alignbit_b32 v45, v46, v45, v13
    v_alignbit_b32 v46, v47, v46, v13
    v_alignbit_b32 v47, v48, v47, v13
    v_alignbit_b32 v50, v51, v50, v13
    v_alignbit_b32 v51, v52, v51, v13
    v_alignbit_b32 v52, v53, v52, v13
    v_alignbit_b32 v53, v54, v53, v13
    v_alignbit_b32 v54, v55, v54, v13
    v_alignbit_b32 v55, v56, v55, v13
    v_alignbit_b32 v56, v57, v56, v13
    v_alignbit_b32 v57, v58, v57, v13
    v_perm_b32 v101, v50, v40, s28
    v_perm_b32 v105, v50, v40, s29
    v_perm_b32 v109, v51, v41, s28
    v_perm_b32 v113, v51, v41, s29
    v_perm_b32 v117, v52, v42, s28
    v_perm_b32 v121, v52, v42, s29
    v_perm_b32 v125, v53, v43, s28
    v_perm_b32 v129, v53, v43, s29
    v_perm_b32 v133, v54, v44, s28
    v_perm_b32 v137, v54, v44, s29
    v_perm_b32 v141, v55, v45, s28
    v_perm_b32 v145, v55, v45, s29
    v_perm_b32 v149, v56, v46, s28
    v_perm_b32 v153, v56, v46, s29
    v_perm_b32 v157, v57, v47, s28
    v_perm_b32 v161, v57, v47, s29
    v_alignbit_b32 v60, v61, v60, v13
    v_alignbit_b32 v61, v62, v61, v13
    v_alignbit_b32 v62, v63, v62, v13
    v_alignbit_b32 v63, v64, v63, v13
    v_alignbit_b32 v64, v65, v64, v13
    v_alignbit_b32 v65, v66, v65, v13
    v_alignbit_b32 v66, v67, v66, v13
    v_alignbit_b32 v67, v68, v67, v13
    v_alignbit_b32 v70, v71, v70, v13
    v_alignbit_b32 v71, v72, v71, v13
    v_alignbit_b32 v72, v73, v72, v13
    v_alignbit_b32 v73, v74, v73, v13
    v_alignbit_b32 v74, v75, v74, v13
    v_alignbit_b32 v75, v76, v75, v13
    v_alignbit_b32 v76, v77, v76, v13
    v_alignbit_b32 v77, v78, v77, v13
    v_perm_b32 v102, v70, v60, s28
    v_perm_b32 v106, v70, v60, s29
    v_perm_b32 v110, v71, v61, s28
    v_perm_b32 v114, v71, v61, s29
    v_perm_b32 v118, v72, v62, s28
    v_perm_b32 v122, v72, v62, s29
    v_perm_b32 v126, v73, v63, s28
    v_perm_b32 v130, v73, v63, s29
    v_perm_b32 v134, v74, v64, s28
    v_perm_b32 v138, v74, v64, s29
    v_perm_b32 v142, v75, v65, s28
    v_perm_b32 v146, v75, v65, s29
    v_perm_b32 v150, v76, v66, s28
    v_perm_b32 v154, v76, v66, s29
    v_perm_b32 v158, v77, v67, s28
    v_perm_b32 v162, v77, v67, s29
    v_alignbit_b32 v80, v81, v80, v13
    v_alignbit_b32 v81, v82, v81, v13
    v_alignbit_b32 v82, v83, v82, v13
    v_alignbit_b32 v83, v84, v83, v13
    v_alignbit_b32 v84, v85, v84, v13
    v_alignbit_b32 v85, v86, v85, v13
    v_alignbit_b32 v86, v87, v86, v13
    v_alignbit_b32 v87, v88, v87, v13
    v_alignbit_b32 v90, v91, v90, v13
    v_alignbit_b32 v91, v92, v91, v13
    v_alignbit_b32 v92, v93, v92, v13
    v_alignbit_b32 v93, v94, v93, v13
    v_alignbit_b32 v94, v95, v94, v13
    v_alignbit_b32 v95, v96, v95, v13
    v_alignbit_b32 v96, v97, v96, v13
    v_alignbit_b32 v97, v98, v97, v13
    v_perm_b32 v103, v90, v80, s28
    v_perm_b32 v107, v90, v80, s29
    v_perm_b32 v111, v91, v81, s28
    v_perm_b32 v115, v91, v81, s29
    v_perm_b32 v119, v92, v82, s28
    v_perm_b32 v123, v92, v82, s29
    v_perm_b32 v127, v93, v83, s28
    v_perm_b32 v131, v93, v83, s29
    v_perm_b32 v135, v94, v84, s28
    v_perm_b32 v139, v94, v84, s29
    v_perm_b32 v143, v95, v85, s28
    v_perm_b32 v147, v95, v85, s29
    v_perm_b32 v151, v96, v86, s28
    v_perm_b32 v155, v96, v86, s29
    v_perm_b32 v159, v97, v87, s28
    v_perm_b32 v163, v97, v87, s29
    s_add_u32 s17, s21, 1024
    buffer_store_dwordx4 v[100:103], v14, s[4:7], s17 offen
    s_add_u32 s17, s21, 9216
    buffer_store_dwordx4 v[104:107], v14, s[4:7], s17 offen
    s_add_u32 s17, s21, 17408
    buffer_store_dwordx4 v[108:111], v14, s[4:7], s17 offen
    s_add_u32 s17, s21, 25600
    buffer_store_dwordx4 v[112:115], v14, s[4:7], s17 offen
    s_add_u32 s17, s21, 33792
    buffer_store_dwordx4 v[116:119], v14, s[4:7], s17 offen
    s_add_u32 s17, s21, 41984
    buffer_store_dwordx4 v[120:123], v14, s[4:7], s17 offen
    s_add_u32 s17, s21, 50176
    buffer_store_dwordx4 v[124:127], v14, s[4:7], s17 offen
    s_add_u32 s17, s21, 58368
    buffer_store_dwordx4 v[128:131], v14, s[4:7], s17 offen
    s_add_u32 s17, s21, 66560
    buffer_store_dwordx4 v[132:135], v14, s[4:7], s17 offen
    s_add_u32 s17, s21, 74752
    buffer_store_dwordx4 v[136:139], v14, s[4:7], s17 offen
    s_add_u32 s17, s21, 82944
    buffer_store_dwordx4 v[140:143], v14, s[4:7], s17 offen
    s_add_u32 s17, s21, 91136
    buffer_store_dwordx4 v[144:147], v14, s[4:7], s17 offen
    s_add_u32 s17, s21, 99328
    buffer_store_dwordx4 v[148:151], v14, s[4:7], s17 offen
    s_add_u32 s17, s21, 107520
    buffer_store_dwordx4 v[152:155], v14, s[4:7], s17 offen
    s_add_u32 s17, s21, 115712
    buffer_store_dwordx4 v[156:159], v14, s[4:7], s17 offen
    s_add_u32 s17, s21, 123904
    buffer_store_dwordx4 v[160:163], v14, s[4:7], s17 offen
    s_cmp_lg_u32 s91, 0
    s_cbranch_scc1 F_no512
    s_sub_u32 s20, s20, 524288
    buffer_load_ushort v20, v12, s[8:11], s20 offen
    buffer_load_ushort v28, v12, s[12:15], s20 offen
    s_add_u32 s20, s20, 65664
    buffer_load_ushort v21, v12, s[8:11], s20 offen
    buffer_load_ushort v29, v12, s[12:15], s20 offen
    s_add_u32 s20, s20, 65664
    buffer_load_ushort v22, v12, s[8:11], s20 offen
    buffer_load_ushort v30, v12, s[12:15], s20 offen
    s_add_u32 s20, s20, 65664
    buffer_load_ushort v23, v12, s[8:11], s20 offen
    buffer_load_ushort v31, v12, s[12:15], s20 offen
    s_add_u32 s20, s20, 65664
    buffer_load_ushort v24, v12, s[8:11], s20 offen
    buffer_load_ushort v32, v12, s[12:15], s20 offen
    s_add_u32 s20, s20, 65664
    buffer_load_ushort v25, v12, s[8:11], s20 offen
    buffer_load_ushort v33, v12, s[12:15], s20 offen
    s_add_u32 s20, s20, 65664
    buffer_load_ushort v26, v12, s[8:11], s20 offen
    buffer_load_ushort v34, v12, s[12:15], s20 offen
    s_add_u32 s20, s20, 65664
    buffer_load_ushort v27, v12, s[8:11], s20 offen
    buffer_load_ushort v35, v12, s[12:15], s20 offen
    s_add_u32 s20, s20, 65664
    s_waitcnt vmcnt(0)
    v_lshl_or_b32 v20, v28, 16, v20
    v_lshl_or_b32 v21, v29, 16, v21
    v_lshl_or_b32 v22, v30, 16, v22
    v_lshl_or_b32 v23, v31, 16, v23
    v_lshl_or_b32 v24, v32, 16, v24
    v_lshl_or_b32 v25, v33, 16, v25
    v_lshl_or_b32 v26, v34, 16, v26
    v_lshl_or_b32 v27, v35, 16, v27
    s_add_u32 s17, s21, 4194304
    buffer_store_dwordx4 v[20:23], v14, s[4:7], s17 offen
    buffer_store_dwordx4 v[24:27], v14, s[4:7], s17 offen offset:1024
F_no512:
    s_load_dwordx2 s[8:9], s[0:1], 0
    s_load_dwordx2 s[12:13], s[0:1], 80
    s_mov_b32 s10, 4194304
    s_mov_b32 s14, 8388608
    s_lshr_b32 s28, s91, 3
    s_and_b32 s29, s91, 7
    s_lshl_b32 s29, s29, 2
    s_add_u32 s29, s29, s16
    s_waitcnt vmcnt(0) lgkmcnt(0)
    v_bfe_u32 v5, v1, 2, 2
    v_and_b32 v7, 3, v1
    v_lshl_add_u32 v7, v5, 3, v7
    s_lshl_b32 s17, s29, 5
    v_add_u32 v7, s17, v7
    v_lshrrev_b32 v8, 4, v1
    v_cvt_f32_u32 v8, v8
    s_mov_b32 s31, 981467136
    v_add_u32 v5, 0, v7
    v_lshrrev_b32 v6, 1, v5
    v_and_b32 v30, 1, v5
    v_cmp_eq_u32 vcc, 1, v5
    v_mov_b32 v5, 512
    s_nop 0
    v_cndmask_b32 v6, v6, v5, vcc
    v_cndmask_b32 v30, v30, 0, vcc
    v_cvt_f32_u32 v6, v6
    v_cvt_f32_u32 v30, v30
    v_mul_f32 v32, s31, v6
    v_mul_f32 v30, 0x3e800000, v30
    v_mov_b32 v34, v32
    v_mul_f32 v36, 0x42000000, v32
    v_mul_f32 v5, 0x41000000, v32
    v_fma_f32 v30, v5, v8, v30
    v_add_u32 v5, 4, v7
    v_lshrrev_b32 v6, 1, v5
    v_and_b32 v31, 1, v5
    v_cmp_eq_u32 vcc, 1, v5
    v_mov_b32 v5, 512
    s_nop 0
    v_cndmask_b32 v6, v6, v5, vcc
    v_cndmask_b32 v31, v31, 0, vcc
    v_cvt_f32_u32 v6, v6
    v_cvt_f32_u32 v31, v31
    v_mul_f32 v33, s31, v6
    v_mul_f32 v31, 0x3e800000, v31
    v_mov_b32 v35, v33
    v_mul_f32 v37, 0x42000000, v33
    v_mul_f32 v5, 0x41000000, v33
    v_fma_f32 v31, v5, v8, v31
    v_lshlrev_b32 v8, 4, v1
    s_lshl_b32 s18, s16, 15
    v_add_u32 v8, s18, v8
    v_mov_b32 v7, v8
    s_mov_b32 s22, 0
F1_g0:
    v_fract_f32 v40, v30
    v_add_f32 v41, v40, v32
    v_add_f32 v42, v41, v34
    v_add_f32 v43, v42, v32
    v_add_f32 v44, v43, v34
    v_add_f32 v45, v44, v32
    v_add_f32 v46, v45, v34
    v_add_f32 v47, v46, v32
    v_add_f32 v30, v40, v36
    v_cos_f32 v48, v40
    v_cos_f32 v49, v41
    v_cos_f32 v50, v42
    v_cos_f32 v51, v43
    v_cos_f32 v52, v44
    v_cos_f32 v53, v45
    v_cos_f32 v54, v46
    v_cos_f32 v55, v47
    v_cvt_pk_bf16_f32 v56, v48, v49
    v_cvt_pk_bf16_f32 v57, v50, v51
    v_cvt_pk_bf16_f32 v58, v52, v53
    v_cvt_pk_bf16_f32 v59, v54, v55
    ds_write_b128 v7, v[56:59] offset:0
    v_fract_f32 v40, v31
    v_add_f32 v41, v40, v33
    v_add_f32 v42, v41, v35
    v_add_f32 v43, v42, v33
    v_add_f32 v44, v43, v35
    v_add_f32 v45, v44, v33
    v_add_f32 v46, v45, v35
    v_add_f32 v47, v46, v33
    v_add_f32 v31, v40, v37
    v_cos_f32 v48, v40
    v_cos_f32 v49, v41
    v_cos_f32 v50, v42
    v_cos_f32 v51, v43
    v_cos_f32 v52, v44
    v_cos_f32 v53, v45
    v_cos_f32 v54, v46
    v_cos_f32 v55, v47
    v_cvt_pk_bf16_f32 v60, v48, v49
    v_cvt_pk_bf16_f32 v61, v50, v51
    v_cvt_pk_bf16_f32 v62, v52, v53
    v_cvt_pk_bf16_f32 v63, v54, v55
    ds_write_b128 v7, v[60:63] offset:1024
    v_add_u32 v7, 2048, v7
    s_add_u32 s22, s22, 1
    s_cmp_lt_u32 s22, 16
    s_waitcnt lgkmcnt(0)
    s_cbranch_scc1 F1_g0
    ds_read_b128 a[0:3], v8 offset:0
    ds_read_b128 a[4:7], v8 offset:1024
    ds_read_b128 a[8:11], v8 offset:2048
    ds_read_b128 a[12:15], v8 offset:3072
    ds_read_b128 a[16:19], v8 offset:4096
    ds_read_b128 a[20:23], v8 offset:5120
    ds_read_b128 a[24:27], v8 offset:6144
    ds_read_b128 a[28:31], v8 offset:7168
    s_waitcnt lgkmcnt(7)
    ds_read_b128 a[32:35], v8 offset:8192
    ds_read_b128 a[36:39], v8 offset:9216
    ds_read_b128 a[40:43], v8 offset:10240
    ds_read_b128 a[44:47], v8 offset:11264
    ds_read_b128 a[48:51], v8 offset:12288
    ds_read_b128 a[52:55], v8 offset:13312
    ds_read_b128 a[56:59], v8 offset:14336
    ds_read_b128 a[60:63], v8 offset:15360
    s_waitcnt lgkmcnt(7)
    ds_read_b128 a[64:67], v8 offset:16384
    ds_read_b128 a[68:71], v8 offset:17408
    ds_read_b128 a[72:75], v8 offset:18432
    ds_read_b128 a[76:79], v8 offset:19456
    ds_read_b128 a[80:83], v8 offset:20480
    ds_read_b128 a[84:87], v8 offset:21504
    ds_read_b128 a[88:91], v8 offset:22528
    ds_read_b128 a[92:95], v8 offset:23552
    s_waitcnt lgkmcnt(7)
    ds_read_b128 a[96:99], v8 offset:24576
    ds_read_b128 a[100:103], v8 offset:25600
    ds_read_b128 a[104:107], v8 offset:26624
    ds_read_b128 a[108:111], v8 offset:27648
    ds_read_b128 a[112:115], v8 offset:28672
    ds_read_b128 a[116:119], v8 offset:29696
    ds_read_b128 a[120:123], v8 offset:30720
    ds_read_b128 a[124:127], v8 offset:31744
    s_waitcnt lgkmcnt(7)
    s_waitcnt lgkmcnt(0)
    v_mov_b32 v7, v8
    s_mov_b32 s22, 0
F1_g1:
    v_fract_f32 v40, v30
    v_add_f32 v41, v40, v32
    v_add_f32 v42, v41, v34
    v_add_f32 v43, v42, v32
    v_add_f32 v44, v43, v34
    v_add_f32 v45, v44, v32
    v_add_f32 v46, v45, v34
    v_add_f32 v47, v46, v32
    v_add_f32 v30, v40, v36
    v_cos_f32 v48, v40
    v_cos_f32 v49, v41
    v_cos_f32 v50, v42
    v_cos_f32 v51, v43
    v_cos_f32 v52, v44
    v_cos_f32 v53, v45
    v_cos_f32 v54, v46
    v_cos_f32 v55, v47
    v_cvt_pk_bf16_f32 v56, v48, v49
    v_cvt_pk_bf16_f32 v57, v50, v51
    v_cvt_pk_bf16_f32 v58, v52, v53
    v_cvt_pk_bf16_f32 v59, v54, v55
    ds_write_b128 v7, v[56:59] offset:0
    v_fract_f32 v40, v31
    v_add_f32 v41, v40, v33
    v_add_f32 v42, v41, v35
    v_add_f32 v43, v42, v33
    v_add_f32 v44, v43, v35
    v_add_f32 v45, v44, v33
    v_add_f32 v46, v45, v35
    v_add_f32 v47, v46, v33
    v_add_f32 v31, v40, v37
    v_cos_f32 v48, v40
    v_cos_f32 v49, v41
    v_cos_f32 v50, v42
    v_cos_f32 v51, v43
    v_cos_f32 v52, v44
    v_cos_f32 v53, v45
    v_cos_f32 v54, v46
    v_cos_f32 v55, v47
    v_cvt_pk_bf16_f32 v60, v48, v49
    v_cvt_pk_bf16_f32 v61, v50, v51
    v_cvt_pk_bf16_f32 v62, v52, v53
    v_cvt_pk_bf16_f32 v63, v54, v55
    ds_write_b128 v7, v[60:63] offset:1024
    v_add_u32 v7, 2048, v7
    s_add_u32 s22, s22, 1
    s_cmp_lt_u32 s22, 16
    s_waitcnt lgkmcnt(0)
    s_cbranch_scc1 F1_g1
    ds_read_b128 a[128:131], v8 offset:0
    ds_read_b128 a[132:135], v8 offset:1024
    ds_read_b128 a[136:139], v8 offset:2048
    ds_read_b128 a[140:143], v8 offset:3072
    ds_read_b128 a[144:147], v8 offset:4096
    ds_read_b128 a[148:151], v8 offset:5120
    ds_read_b128 a[152:155], v8 offset:6144
    ds_read_b128 a[156:159], v8 offset:7168
    s_waitcnt lgkmcnt(7)
    ds_read_b128 a[160:163], v8 offset:8192
    ds_read_b128 a[164:167], v8 offset:9216
    ds_read_b128 a[168:171], v8 offset:10240
    ds_read_b128 a[172:175], v8 offset:11264
    ds_read_b128 a[176:179], v8 offset:12288
    ds_read_b128 a[180:183], v8 offset:13312
    ds_read_b128 a[184:187], v8 offset:14336
    ds_read_b128 a[188:191], v8 offset:15360
    s_waitcnt lgkmcnt(7)
    ds_read_b128 a[192:195], v8 offset:16384
    ds_read_b128 a[196:199], v8 offset:17408
    ds_read_b128 a[200:203], v8 offset:18432
    ds_read_b128 a[204:207], v8 offset:19456
    ds_read_b128 a[208:211], v8 offset:20480
    ds_read_b128 a[212:215], v8 offset:21504
    ds_read_b128 a[216:219], v8 offset:22528
    ds_read_b128 a[220:223], v8 offset:23552
    s_waitcnt lgkmcnt(7)
    ds_read_b128 a[224:227], v8 offset:24576
    ds_read_b128 a[228:231], v8 offset:25600
    ds_read_b128 a[232:235], v8 offset:26624
    ds_read_b128 a[236:239], v8 offset:27648
    ds_read_b128 a[240:243], v8 offset:28672
    ds_read_b128 a[244:247], v8 offset:29696
    ds_read_b128 a[248:251], v8 offset:30720
    ds_read_b128 a[252:255], v8 offset:31744
    s_waitcnt lgkmcnt(7)
    s_waitcnt lgkmcnt(0)
    v_lshlrev_b32 v5, 2, v1
    s_mov_b32 s18, 0
rdv_14:
    global_load_dword v6, v5, s[100:101] sc1
    s_lshl_b32 s17, s98, 2
    s_waitcnt vmcnt(0)
    v_lshrrev_b32 v7, s17, v6
    s_cmp_eq_u32 s98, 0
    s_cselect_b32 s17, 0x0f0f0f0f, s17
    s_cselect_b32 s17, s17, 0x01010101
    v_and_b32 v7, s17, v7
    v_cmp_ne_u32 vcc, 0x01010101, v7
    s_nop 0
    s_cbranch_vccz rdvok_15
    v_sad_u8 v7, v7, 0, 0
    s_nop 1
    v_add_u32_dpp v7, v7, v7 quad_perm:[1,0,3,2] row_mask:0xf bank_mask:0xf
    v_cmp_ne_u32 vcc, 8, v7
    s_nop 0
    s_cbranch_vccnz rdvw_16
    s_mov_b32 s98, 1
    s_and_b32 s3, s97, 7
    s_barrier
    s_branch role_start
rdvw_16:
    s_sleep 4
    s_add_u32 s18, s18, 1
    s_cmp_lt_u32 s18, 262144
    s_cbranch_scc1 rdv_14
    s_mov_b32 s92, 1048576
rdvok_15:
    v_and_b32 v5, 15, v1
    v_bfe_u32 v6, v1, 1, 3
    v_lshrrev_b32 v7, 4, v1
    v_xor_b32 v6, v6, v7
    v_lshlrev_b32 v6, 4, v6
    v_lshl_add_u32 v10, v5, 7, v6
    s_lshl_b32 s19, s16, 10
    v_xor_b32 v11, 64, v10
    v_add_u32 v12, 0x10000, v10
    v_add_u32 v13, 0x10000, v11
    v_lshrrev_b32 v7, 3, v1
    s_lshl_b32 s17, s16, 3
    v_add_u32 v7, s17, v7
    v_bfe_u32 v8, v7, 1, 3
    v_xor_b32 v8, v8, v1
    v_and_b32 v8, 7, v8
    v_bfe_u32 v5, v7, 2, 2
    v_and_b32 v2, 3, v7
    v_lshl_add_u32 v2, v5, 3, v2
    v_bfe_u32 v5, v7, 4, 1
    v_lshl_add_u32 v2, v5, 2, v2
    v_bfe_u32 v5, v1, 2, 2
    v_and_b32 v3, 3, v1
    v_lshl_add_u32 v3, v5, 3, v3
    v_lshlrev_b32 v2, 16, v2
    v_lshl_add_u32 v2, v8, 4, v2
    v_and_b32 v5, 48, v1
    v_lshl_add_u32 v3, v3, 6, v5
    s_mul_i32 s21, s29, 133120
    s_lshl_b32 s17, s28, 15
    s_add_u32 s21, s21, s17
    s_add_u32 s21, s21, 104857600
    s_and_b32 s20, s28, 1
    s_lshl_b32 s20, s20, 15
    s_lshr_b32 s17, s28, 1
    s_lshl_b32 s17, s17, 21
    s_add_u32 s20, s20, s17
    s_mov_b32 s24, 2048
    s_mov_b32 s25, 2048
    s_barrier
    s_mov_b32 s26, s25
    s_sub_u32 s25, s21, 1073741824
    s_mov_b32 s21, 1073741824
    s_mov_b32 s23, 0
    s_mov_b32 s22, 0
    s_add_u32 m0, s19, 0
    s_nop 0
    buffer_load_dwordx4 v2, s[8:11], s20 offen offset:0 lds
    s_add_u32 m0, s19, 3968
    s_nop 0
    buffer_load_dwordx4 v2, s[8:11], s20 offen offset:128 lds
    s_add_u32 m0, s19, 7936
    s_nop 0
    buffer_load_dwordx4 v2, s[8:11], s20 offen offset:256 lds
    s_add_u32 m0, s19, 11904
    s_nop 0
    buffer_load_dwordx4 v2, s[8:11], s20 offen offset:384 lds
    s_add_u32 m0, s19, 15872
    s_nop 0
    buffer_load_dwordx4 v2, s[8:11], s20 offen offset:512 lds
    s_add_u32 m0, s19, 19840
    s_nop 0
    buffer_load_dwordx4 v2, s[8:11], s20 offen offset:640 lds
    s_add_u32 m0, s19, 23808
    s_nop 0
    buffer_load_dwordx4 v2, s[8:11], s20 offen offset:768 lds
    s_add_u32 m0, s19, 27776
    s_nop 0
    buffer_load_dwordx4 v2, s[8:11], s20 offen offset:896 lds
    s_add_u32 m0, s19, 31744
    s_nop 0
    buffer_load_dwordx4 v2, s[8:11], s20 offen offset:1024 lds
    s_add_u32 m0, s19, 35712
    s_nop 0
    buffer_load_dwordx4 v2, s[8:11], s20 offen offset:1152 lds
    s_add_u32 m0, s19, 39680
    s_nop 0
    buffer_load_dwordx4 v2, s[8:11], s20 offen offset:1280 lds
    s_add_u32 m0, s19, 43648
    s_nop 0
    buffer_load_dwordx4 v2, s[8:11], s20 offen offset:1408 lds
    s_add_u32 m0, s19, 47616
    s_nop 0
    buffer_load_dwordx4 v2, s[8:11], s20 offen offset:1536 lds
    s_add_u32 m0, s19, 51584
    s_nop 0
    buffer_load_dwordx4 v2, s[8:11], s20 offen offset:1664 lds
    s_add_u32 m0, s19, 55552
    s_nop 0
    buffer_load_dwordx4 v2, s[8:11], s20 offen offset:1792 lds
    s_add_u32 m0, s19, 59520
    s_nop 0
    buffer_load_dwordx4 v2, s[8:11], s20 offen offset:1920 lds
    s_add_u32 s20, s20, s24
    s_add_u32 m0, s19, 65536
    s_nop 0
    buffer_load_dwordx4 v2, s[8:11], s20 offen offset:0 lds
    s_add_u32 m0, s19, 69504
    s_nop 0
    buffer_load_dwordx4 v2, s[8:11], s20 offen offset:128 lds
    s_add_u32 m0, s19, 73472
    s_nop 0
    buffer_load_dwordx4 v2, s[8:11], s20 offen offset:256 lds
    s_waitcnt vmcnt(11)
    s_barrier
    ds_read_b128 v[20:23], v10 offset:0
    ds_read_b128 v[24:27], v10 offset:2048
    ds_read_b128 v[28:31], v11 offset:0
    ds_read_b128 v[32:35], v11 offset:2048
    ds_read_b128 v[36:39], v10 offset:4096
    ds_read_b128 v[40:43], v10 offset:6144
    ds_read_b128 v[44:47], v11 offset:4096
.p2align 6
F1_top:
    s_waitcnt lgkmcnt(6)
    v_mfma_f32_16x16x32_bf16 v[52:55], v[20:23], a[0:3], 0
    ds_read_b128 v[48:51], v11 offset:6144
    v_mfma_f32_16x16x32_bf16 v[60:63], v[20:23], a[4:7], 0
    s_waitcnt lgkmcnt(6)
    v_mfma_f32_16x16x32_bf16 v[56:59], v[24:27], a[0:3], 0
    ds_read_b128 v[20:23], v10 offset:8192
    s_add_u32 m0, s19, 77440
    v_mfma_f32_16x16x32_bf16 v[64:67], v[24:27], a[4:7], 0
    buffer_load_dwordx4 v2, s[8:11], s20 offen offset:384 lds
    s_waitcnt lgkmcnt(6)
    v_mfma_f32_16x16x32_bf16 v[52:55], v[28:31], a[8:11], v[52:55]
    ds_read_b128 v[24:27], v10 offset:10240
    v_mfma_f32_16x16x32_bf16 v[60:63], v[28:31], a[12:15], v[60:63]
    s_waitcnt lgkmcnt(6)
    v_mfma_f32_16x16x32_bf16 v[56:59], v[32:35], a[8:11], v[56:59]
    ds_read_b128 v[28:31], v11 offset:8192
    s_add_u32 m0, s19, 81408
    v_mfma_f32_16x16x32_bf16 v[64:67], v[32:35], a[12:15], v[64:67]
    buffer_load_dwordx4 v2, s[8:11], s20 offen offset:512 lds
    s_waitcnt lgkmcnt(6)
    v_mfma_f32_16x16x32_bf16 v[52:55], v[36:39], a[16:19], v[52:55]
    ds_read_b128 v[32:35], v11 offset:10240
    v_mfma_f32_16x16x32_bf16 v[60:63], v[36:39], a[20:23], v[60:63]
    s_waitcnt lgkmcnt(6)
    v_mfma_f32_16x16x32_bf16 v[56:59], v[40:43], a[16:19], v[56:59]
    ds_read_b128 v[36:39], v10 offset:12288
    s_add_u32 m0, s19, 85376
    v_mfma_f32_16x16x32_bf16 v[64:67], v[40:43], a[20:23], v[64:67]
    buffer_load_dwordx4 v2, s[8:11], s20 offen offset:640 lds
    s_waitcnt lgkmcnt(6)
    v_mfma_f32_16x16x32_bf16 v[52:55], v[44:47], a[24:27], v[52:55]
    ds_read_b128 v[40:43], v10 offset:14336
    v_mfma_f32_16x16x32_bf16 v[60:63], v[44:47], a[28:31], v[60:63]
    s_waitcnt lgkmcnt(6)
    v_mfma_f32_16x16x32_bf16 v[56:59], v[48:51], a[24:27], v[56:59]
    ds_read_b128 v[44:47], v11 offset:12288
    s_add_u32 m0, s19, 89344
    v_mfma_f32_16x16x32_bf16 v[64:67], v[48:51], a[28:31], v[64:67]
    buffer_load_dwordx4 v2, s[8:11], s20 offen offset:768 lds
    s_waitcnt lgkmcnt(6)
    v_mfma_f32_16x16x32_bf16 v[52:55], v[20:23], a[32:35], v[52:55]
    ds_read_b128 v[48:51], v11 offset:14336
    v_mfma_f32_16x16x32_bf16 v[60:63], v[20:23], a[36:39], v[60:63]
    s_waitcnt lgkmcnt(6)
    v_mfma_f32_16x16x32_bf16 v[56:59], v[24:27], a[32:35], v[56:59]
    ds_read_b128 v[20:23], v10 offset:16384
    s_add_u32 m0, s19, 93312
    v_mfma_f32_16x16x32_bf16 v[64:67], v[24:27], a[36:39], v[64:67]
    buffer_load_dwordx4 v2, s[8:11], s20 offen offset:896 lds
    s_waitcnt lgkmcnt(6)
    v_mfma_f32_16x16x32_bf16 v[52:55], v[28:31], a[40:43], v[52:55]
    ds_read_b128 v[24:27], v10 offset:18432
    v_mfma_f32_16x16x32_bf16 v[60:63], v[28:31], a[44:47], v[60:63]
    v_cvt_pk_bf16_f32 v84, v68, v69
    s_waitcnt lgkmcnt(6)
    v_mfma_f32_16x16x32_bf16 v[56:59], v[32:35], a[40:43], v[56:59]
    ds_read_b128 v[28:31], v11 offset:16384
    v_mfma_f32_16x16x32_bf16 v[64:67], v[32:35], a[44:47], v[64:67]
    v_cvt_pk_bf16_f32 v85, v70, v71
    s_waitcnt lgkmcnt(6)
    v_mfma_f32_16x16x32_bf16 v[52:55], v[36:39], a[48:51], v[52:55]
    ds_read_b128 v[32:35], v11 offset:18432
    v_mfma_f32_16x16x32_bf16 v[60:63], v[36:39], a[52:55], v[60:63]
    v_cvt_pk_bf16_f32 v86, v72, v73
    s_waitcnt lgkmcnt(6)
    v_mfma_f32_16x16x32_bf16 v[56:59], v[40:43], a[48:51], v[56:59]
    ds_read_b128 v[36:39], v10 offset:20480
    v_mfma_f32_16x16x32_bf16 v[64:67], v[40:43], a[52:55], v[64:67]
    v_cvt_pk_bf16_f32 v87, v74, v75
    s_waitcnt lgkmcnt(6)
    v_mfma_f32_16x16x32_bf16 v[52:55], v[44:47], a[56:59], v[52:55]
    ds_read_b128 v[40:43], v10 offset:22528
    v_mfma_f32_16x16x32_bf16 v[60:63], v[44:47], a[60:63], v[60:63]
    v_cvt_pk_bf16_f32 v88, v76, v77
    s_waitcnt lgkmcnt(6)
    v_mfma_f32_16x16x32_bf16 v[56:59], v[48:51], a[56:59], v[56:59]
    ds_read_b128 v[44:47], v11 offset:20480
    v_mfma_f32_16x16x32_bf16 v[64:67], v[48:51], a[60:63], v[64:67]
    v_cvt_pk_bf16_f32 v89, v78, v79
    buffer_store_dwordx4 v[84:87], v3, s[4:7], s21 offen offset:0 sc1
    s_waitcnt lgkmcnt(6)
    v_mfma_f32_16x16x32_bf16 v[52:55], v[20:23], a[64:67], v[52:55]
    ds_read_b128 v[48:51], v11 offset:22528
    v_mfma_f32_16x16x32_bf16 v[60:63], v[20:23], a[68:71], v[60:63]
    v_cvt_pk_bf16_f32 v90, v80, v81
    s_waitcnt lgkmcnt(6)
    v_mfma_f32_16x16x32_bf16 v[56:59], v[24:27], a[64:67], v[56:59]
    ds_read_b128 v[20:23], v10 offset:24576
    v_mfma_f32_16x16x32_bf16 v[64:67], v[24:27], a[68:71], v[64:67]
    v_cvt_pk_bf16_f32 v91, v82, v83
    s_waitcnt lgkmcnt(6)
    v_mfma_f32_16x16x32_bf16 v[52:55], v[28:31], a[72:75], v[52:55]
    ds_read_b128 v[24:27], v10 offset:26624
    v_mfma_f32_16x16x32_bf16 v[60:63], v[28:31], a[76:79], v[60:63]
    s_waitcnt lgkmcnt(6)
    v_mfma_f32_16x16x32_bf16 v[56:59], v[32:35], a[72:75], v[56:59]
    ds_read_b128 v[28:31], v11 offset:24576
    v_mfma_f32_16x16x32_bf16 v[64:67], v[32:35], a[76:79], v[64:67]
    buffer_store_dwordx4 v[88:91], v3, s[4:7], s21 offen offset:256 sc1
    s_waitcnt lgkmcnt(6)
    v_mfma_f32_16x16x32_bf16 v[52:55], v[36:39], a[80:83], v[52:55]
    ds_read_b128 v[32:35], v11 offset:26624
    v_mfma_f32_16x16x32_bf16 v[60:63], v[36:39], a[84:87], v[60:63]
    s_add_u32 s21, s21, s25
    s_mov_b32 s25, s26
    s_waitcnt lgkmcnt(6)
    v_mfma_f32_16x16x32_bf16 v[56:59], v[40:43], a[80:83], v[56:59]
    ds_read_b128 v[36:39], v10 offset:28672
    v_mfma_f32_16x16x32_bf16 v[64:67], v[40:43], a[84:87], v[64:67]
    s_waitcnt lgkmcnt(6)
    v_mfma_f32_16x16x32_bf16 v[52:55], v[44:47], a[88:91], v[52:55]
    ds_read_b128 v[40:43], v10 offset:30720
    v_mfma_f32_16x16x32_bf16 v[60:63], v[44:47], a[92:95], v[60:63]
    s_waitcnt lgkmcnt(6)
    v_mfma_f32_16x16x32_bf16 v[56:59], v[48:51], a[88:91], v[56:59]
    ds_read_b128 v[44:47], v11 offset:28672
    v_mfma_f32_16x16x32_bf16 v[64:67], v[48:51], a[92:95], v[64:67]
    s_waitcnt lgkmcnt(6)
    v_mfma_f32_16x16x32_bf16 v[52:55], v[20:23], a[96:99], v[52:55]
    ds_read_b128 v[48:51], v11 offset:30720
    v_mfma_f32_16x16x32_bf16 v[60:63], v[20:23], a[100:103], v[60:63]
    s_waitcnt lgkmcnt(6)
    v_mfma_f32_16x16x32_bf16 v[56:59], v[24:27], a[96:99], v[56:59]
    s_waitcnt vmcnt(10)
    s_barrier
    ds_read_b128 v[20:23], v10 offset:32768
    v_mfma_f32_16x16x32_bf16 v[64:67], v[24:27], a[100:103], v[64:67]
    s_waitcnt lgkmcnt(6)
    v_mfma_f32_16x16x32_bf16 v[52:55], v[28:31], a[104:107], v[52:55]
    ds_read_b128 v[24:27], v10 offset:34816
    s_add_u32 m0, s19, 97280
    v_mfma_f32_16x16x32_bf16 v[60:63], v[28:31], a[108:111], v[60:63]
    buffer_load_dwordx4 v2, s[8:11], s20 offen offset:1024 lds
    s_waitcnt lgkmcnt(6)
    v_mfma_f32_16x16x32_bf16 v[56:59], v[32:35], a[104:107], v[56:59]
    ds_read_b128 v[28:31], v11 offset:32768
    v_mfma_f32_16x16x32_bf16 v[64:67], v[32:35], a[108:111], v[64:67]
    s_waitcnt lgkmcnt(6)
    v_mfma_f32_16x16x32_bf16 v[52:55], v[36:39], a[112:115], v[52:55]
    ds_read_b128 v[32:35], v11 offset:34816
    s_add_u32 m0, s19, 101248
    v_mfma_f32_16x16x32_bf16 v[60:63], v[36:39], a[116:119], v[60:63]
    buffer_load_dwordx4 v2, s[8:11], s20 offen offset:1152 lds
    s_waitcnt lgkmcnt(6)
    v_mfma_f32_16x16x32_bf16 v[56:59], v[40:43], a[112:115], v[56:59]
    ds_read_b128 v[36:39], v10 offset:36864
    v_mfma_f32_16x16x32_bf16 v[64:67], v[40:43], a[116:119], v[64:67]
    s_waitcnt lgkmcnt(6)
    v_mfma_f32_16x16x32_bf16 v[52:55], v[44:47], a[120:123], v[52:55]
    ds_read_b128 v[40:43], v10 offset:38912
    s_add_u32 m0, s19, 105216
    v_mfma_f32_16x16x32_bf16 v[60:63], v[44:47], a[124:127], v[60:63]
    buffer_load_dwordx4 v2, s[8:11], s20 offen offset:1280 lds
    s_waitcnt lgkmcnt(6)
    v_mfma_f32_16x16x32_bf16 v[56:59], v[48:51], a[120:123], v[56:59]
    ds_read_b128 v[44:47], v11 offset:36864
    v_mfma_f32_16x16x32_bf16 v[64:67], v[48:51], a[124:127], v[64:67]
    s_waitcnt lgkmcnt(6)
    v_mfma_f32_16x16x32_bf16 v[52:55], v[20:23], a[128:131], v[52:55]
    ds_read_b128 v[48:51], v11 offset:38912
    v_mfma_f32_16x16x32_bf16 v[60:63], v[20:23], a[132:135], v[60:63]
    s_waitcnt lgkmcnt(6)
    v_mfma_f32_16x16x32_bf16 v[56:59], v[24:27], a[128:131], v[56:59]
    ds_read_b128 v[20:23], v10 offset:40960
    s_add_u32 m0, s19, 109184
    v_mfma_f32_16x16x32_bf16 v[64:67], v[24:27], a[132:135], v[64:67]
    buffer_load_dwordx4 v2, s[8:11], s20 offen offset:1408 lds
    s_waitcnt lgkmcnt(6)
    v_mfma_f32_16x16x32_bf16 v[52:55], v[28:31], a[136:139], v[52:55]
    ds_read_b128 v[24:27], v10 offset:43008
    v_mfma_f32_16x16x32_bf16 v[60:63], v[28:31], a[140:143], v[60:63]
    s_waitcnt lgkmcnt(6)
    v_mfma_f32_16x16x32_bf16 v[56:59], v[32:35], a[136:139], v[56:59]
    ds_read_b128 v[28:31], v11 offset:40960
    s_add_u32 m0, s19, 113152
    v_mfma_f32_16x16x32_bf16 v[64:67], v[32:35], a[140:143], v[64:67]
    buffer_load_dwordx4 v2, s[8:11], s20 offen offset:1536 lds
    s_waitcnt lgkmcnt(6)
    v_mfma_f32_16x16x32_bf16 v[52:55], v[36:39], a[144:147], v[52:55]
    ds_read_b128 v[32:35], v11 offset:43008
    v_mfma_f32_16x16x32_bf16 v[60:63], v[36:39], a[148:151], v[60:63]
    s_waitcnt lgkmcnt(6)
    v_mfma_f32_16x16x32_bf16 v[56:59], v[40:43], a[144:147], v[56:59]
    ds_read_b128 v[36:39], v10 offset:45056
    s_add_u32 m0, s19, 117120
    v_mfma_f32_16x16x32_bf16 v[64:67], v[40:43], a[148:151], v[64:67]
    buffer_load_dwordx4 v2, s[8:11], s20 offen offset:1664 lds
    s_waitcnt lgkmcnt(6)
    v_mfma_f32_16x16x32_bf16 v[52:55], v[44:47], a[152:155], v[52:55]
    ds_read_b128 v[40:43], v10 offset:47104
    v_mfma_f32_16x16x32_bf16 v[60:63], v[44:47], a[156:159], v[60:63]
    s_waitcnt lgkmcnt(6)
    v_mfma_f32_16x16x32_bf16 v[56:59], v[48:51], a[152:155], v[56:59]
    ds_read_b128 v[44:47], v11 offset:45056
    s_add_u32 m0, s19, 121088
    v_mfma_f32_16x16x32_bf16 v[64:67], v[48:51], a[156:159], v[64:67]
    buffer_load_dwordx4 v2, s[8:11], s20 offen offset:1792 lds
    s_waitcnt lgkmcnt(6)
    v_mfma_f32_16x16x32_bf16 v[52:55], v[20:23], a[160:163], v[52:55]
    ds_read_b128 v[48:51], v11 offset:47104
    v_mfma_f32_16x16x32_bf16 v[60:63], v[20:23], a[164:167], v[60:63]
    s_waitcnt lgkmcnt(6)
    v_mfma_f32_16x16x32_bf16 v[56:59], v[24:27], a[160:163], v[56:59]
    ds_read_b128 v[20:23], v10 offset:49152
    s_add_u32 m0, s19, 125056
    v_mfma_f32_16x16x32_bf16 v[64:67], v[24:27], a[164:167], v[64:67]
    buffer_load_dwordx4 v2, s[8:11], s20 offen offset:1920 lds
    s_waitcnt lgkmcnt(6)
    v_mfma_f32_16x16x32_bf16 v[52:55], v[28:31], a[168:171], v[52:55]
    ds_read_b128 v[24:27], v10 offset:51200
    v_mfma_f32_16x16x32_bf16 v[60:63], v[28:31], a[172:175], v[60:63]
    s_add_u32 s20, s20, s24
    s_waitcnt lgkmcnt(6)
    v_mfma_f32_16x16x32_bf16 v[56:59], v[32:35], a[168:171], v[56:59]
    ds_read_b128 v[28:31], v11 offset:49152
    v_mfma_f32_16x16x32_bf16 v[64:67], v[32:35], a[172:175], v[64:67]
    s_waitcnt lgkmcnt(6)
    v_mfma_f32_16x16x32_bf16 v[52:55], v[36:39], a[176:179], v[52:55]
    ds_read_b128 v[32:35], v11 offset:51200
    v_mfma_f32_16x16x32_bf16 v[60:63], v[36:39], a[180:183], v[60:63]
    s_waitcnt lgkmcnt(6)
    v_mfma_f32_16x16x32_bf16 v[56:59], v[40:43], a[176:179], v[56:59]
    ds_read_b128 v[36:39], v10 offset:53248
    v_mfma_f32_16x16x32_bf16 v[64:67], v[40:43], a[180:183], v[64:67]
    s_waitcnt lgkmcnt(6)
    v_mfma_f32_16x16x32_bf16 v[52:55], v[44:47], a[184:187], v[52:55]
    ds_read_b128 v[40:43], v10 offset:55296
    v_mfma_f32_16x16x32_bf16 v[60:63], v[44:47], a[188:191], v[60:63]
    s_waitcnt lgkmcnt(6)
    v_mfma_f32_16x16x32_bf16 v[56:59], v[48:51], a[184:187], v[56:59]
    ds_read_b128 v[44:47], v11 offset:53248
    v_mfma_f32_16x16x32_bf16 v[64:67], v[48:51], a[188:191], v[64:67]
    s_waitcnt lgkmcnt(6)
    v_mfma_f32_16x16x32_bf16 v[52:55], v[20:23], a[192:195], v[52:55]
    ds_read_b128 v[48:51], v11 offset:55296
    v_mfma_f32_16x16x32_bf16 v[60:63], v[20:23], a[196:199], v[60:63]
    s_waitcnt lgkmcnt(6)
    v_mfma_f32_16x16x32_bf16 v[56:59], v[24:27], a[192:195], v[56:59]
    ds_read_b128 v[20:23], v10 offset:57344
    v_mfma_f32_16x16x32_bf16 v[64:67], v[24:27], a[196:199], v[64:67]
    s_waitcnt lgkmcnt(6)
    v_mfma_f32_16x16x32_bf16 v[52:55], v[28:31], a[200:203], v[52:55]
    ds_read_b128 v[24:27], v10 offset:59392
    v_mfma_f32_16x16x32_bf16 v[60:63], v[28:31], a[204:207], v[60:63]
    s_waitcnt lgkmcnt(6)
    v_mfma_f32_16x16x32_bf16 v[56:59], v[32:35], a[200:203], v[56:59]
    ds_read_b128 v[28:31], v11 offset:57344
    v_mfma_f32_16x16x32_bf16 v[64:67], v[32:35], a[204:207], v[64:67]
    s_waitcnt lgkmcnt(6)
    v_mfma_f32_16x16x32_bf16 v[52:55], v[36:39], a[208:211], v[52:55]
    ds_read_b128 v[32:35], v11 offset:59392
    v_mfma_f32_16x16x32_bf16 v[60:63], v[36:39], a[212:215], v[60:63]
    s_waitcnt lgkmcnt(6)
    v_mfma_f32_16x16x32_bf16 v[56:59], v[40:43], a[208:211], v[56:59]
    ds_read_b128 v[36:39], v10 offset:61440
    v_mfma_f32_16x16x32_bf16 v[64:67], v[40:43], a[212:215], v[64:67]
    s_waitcnt lgkmcnt(6)
    v_mfma_f32_16x16x32_bf16 v[52:55], v[44:47], a[216:219], v[52:55]
    ds_read_b128 v[40:43], v10 offset:63488
    v_mfma_f32_16x16x32_bf16 v[60:63], v[44:47], a[220:223], v[60:63]
    s_waitcnt lgkmcnt(6)
    v_mfma_f32_16x16x32_bf16 v[56:59], v[48:51], a[216:219], v[56:59]
    ds_read_b128 v[44:47], v11 offset:61440
    v_mfma_f32_16x16x32_bf16 v[64:67], v[48:51], a[220:223], v[64:67]
    s_waitcnt lgkmcnt(6)
    v_mfma_f32_16x16x32_bf16 v[52:55], v[20:23], a[224:227], v[52:55]
    ds_read_b128 v[48:51], v11 offset:63488
    v_mfma_f32_16x16x32_bf16 v[60:63], v[20:23], a[228:231], v[60:63]
    s_waitcnt lgkmcnt(6)
    v_mfma_f32_16x16x32_bf16 v[56:59], v[24:27], a[224:227], v[56:59]
    s_waitcnt vmcnt(8)
    s_barrier
    ds_read_b128 v[20:23], v12 offset:0
    v_mfma_f32_16x16x32_bf16 v[64:67], v[24:27], a[228:231], v[64:67]
    s_waitcnt lgkmcnt(6)
    v_mfma_f32_16x16x32_bf16 v[52:55], v[28:31], a[232:235], v[52:55]
    ds_read_b128 v[24:27], v12 offset:2048
    s_add_u32 m0, s19, 0
    v_mfma_f32_16x16x32_bf16 v[60:63], v[28:31], a[236:239], v[60:63]
    buffer_load_dwordx4 v2, s[8:11], s20 offen offset:0 lds
    s_waitcnt lgkmcnt(6)
    v_mfma_f32_16x16x32_bf16 v[56:59], v[32:35], a[232:235], v[56:59]
    ds_read_b128 v[28:31], v13 offset:0
    v_mfma_f32_16x16x32_bf16 v[64:67], v[32:35], a[236:239], v[64:67]
    s_waitcnt lgkmcnt(6)
    v_mfma_f32_16x16x32_bf16 v[52:55], v[36:39], a[240:243], v[52:55]
    ds_read_b128 v[32:35], v13 offset:2048
    s_add_u32 m0, s19, 3968
    v_mfma_f32_16x16x32_bf16 v[60:63], v[36:39], a[244:247], v[60:63]
    buffer_load_dwordx4 v2, s[8:11], s20 offen offset:128 lds
    s_waitcnt lgkmcnt(6)
    v_mfma_f32_16x16x32_bf16 v[56:59], v[40:43], a[240:243], v[56:59]
    ds_read_b128 v[36:39], v12 offset:4096
    v_mfma_f32_16x16x32_bf16 v[64:67], v[40:43], a[244:247], v[64:67]
    s_waitcnt lgkmcnt(6)
    v_mfma_f32_16x16x32_bf16 v[52:55], v[44:47], a[248:251], v[52:55]
    ds_read_b128 v[40:43], v12 offset:6144
    s_add_u32 m0, s19, 7936
    v_mfma_f32_16x16x32_bf16 v[60:63], v[44:47], a[252:255], v[60:63]
    buffer_load_dwordx4 v2, s[8:11], s20 offen offset:256 lds
    s_waitcnt lgkmcnt(6)
    v_mfma_f32_16x16x32_bf16 v[56:59], v[48:51], a[248:251], v[56:59]
    ds_read_b128 v[44:47], v13 offset:4096
    v_mfma_f32_16x16x32_bf16 v[64:67], v[48:51], a[252:255], v[64:67]
    s_waitcnt lgkmcnt(6)
    v_mfma_f32_16x16x32_bf16 v[68:71], v[20:23], a[0:3], 0
    ds_read_b128 v[48:51], v13 offset:6144
    v_mfma_f32_16x16x32_bf16 v[76:79], v[20:23], a[4:7], 0
    s_waitcnt lgkmcnt(6)
    v_mfma_f32_16x16x32_bf16 v[72:75], v[24:27], a[0:3], 0
    ds_read_b128 v[20:23], v12 offset:8192
    s_add_u32 m0, s19, 11904
    v_mfma_f32_16x16x32_bf16 v[80:83], v[24:27], a[4:7], 0
    buffer_load_dwordx4 v2, s[8:11], s20 offen offset:384 lds
    s_waitcnt lgkmcnt(6)
    v_mfma_f32_16x16x32_bf16 v[68:71], v[28:31], a[8:11], v[68:71]
    ds_read_b128 v[24:27], v12 offset:10240
    v_mfma_f32_16x16x32_bf16 v[76:79], v[28:31], a[12:15], v[76:79]
    s_waitcnt lgkmcnt(6)
    v_mfma_f32_16x16x32_bf16 v[72:75], v[32:35], a[8:11], v[72:75]
    ds_read_b128 v[28:31], v13 offset:8192
    s_add_u32 m0, s19, 15872
    v_mfma_f32_16x16x32_bf16 v[80:83], v[32:35], a[12:15], v[80:83]
    buffer_load_dwordx4 v2, s[8:11], s20 offen offset:512 lds
    s_waitcnt lgkmcnt(6)
    v_mfma_f32_16x16x32_bf16 v[68:71], v[36:39], a[16:19], v[68:71]
    ds_read_b128 v[32:35], v13 offset:10240
    v_mfma_f32_16x16x32_bf16 v[76:79], v[36:39], a[20:23], v[76:79]
    s_waitcnt lgkmcnt(6)
    v_mfma_f32_16x16x32_bf16 v[72:75], v[40:43], a[16:19], v[72:75]
    ds_read_b128 v[36:39], v12 offset:12288
    s_add_u32 m0, s19, 19840
    v_mfma_f32_16x16x32_bf16 v[80:83], v[40:43], a[20:23], v[80:83]
    buffer_load_dwordx4 v2, s[8:11], s20 offen offset:640 lds
    s_waitcnt lgkmcnt(6)
    v_mfma_f32_16x16x32_bf16 v[68:71], v[44:47], a[24:27], v[68:71]
    ds_read_b128 v[40:43], v12 offset:14336
    v_mfma_f32_16x16x32_bf16 v[76:79], v[44:47], a[28:31], v[76:79]
    s_waitcnt lgkmcnt(6)
    v_mfma_f32_16x16x32_bf16 v[72:75], v[48:51], a[24:27], v[72:75]
    ds_read_b128 v[44:47], v13 offset:12288
    s_add_u32 m0, s19, 23808
    v_mfma_f32_16x16x32_bf16 v[80:83], v[48:51], a[28:31], v[80:83]
    buffer_load_dwordx4 v2, s[8:11], s20 offen offset:768 lds
    s_waitcnt lgkmcnt(6)
    v_mfma_f32_16x16x32_bf16 v[68:71], v[20:23], a[32:35], v[68:71]
    ds_read_b128 v[48:51], v13 offset:14336
    v_mfma_f32_16x16x32_bf16 v[76:79], v[20:23], a[36:39], v[76:79]
    s_waitcnt lgkmcnt(6)
    v_mfma_f32_16x16x32_bf16 v[72:75], v[24:27], a[32:35], v[72:75]
    ds_read_b128 v[20:23], v12 offset:16384
    s_add_u32 m0, s19, 27776
    v_mfma_f32_16x16x32_bf16 v[80:83], v[24:27], a[36:39], v[80:83]
    buffer_load_dwordx4 v2, s[8:11], s20 offen offset:896 lds
    s_waitcnt lgkmcnt(6)
    v_mfma_f32_16x16x32_bf16 v[68:71], v[28:31], a[40:43], v[68:71]
    ds_read_b128 v[24:27], v12 offset:18432
    v_mfma_f32_16x16x32_bf16 v[76:79], v[28:31], a[44:47], v[76:79]
    v_cvt_pk_bf16_f32 v84, v52, v53
    s_waitcnt lgkmcnt(6)
    v_mfma_f32_16x16x32_bf16 v[72:75], v[32:35], a[40:43], v[72:75]
    ds_read_b128 v[28:31], v13 offset:16384
    v_mfma_f32_16x16x32_bf16 v[80:83], v[32:35], a[44:47], v[80:83]
    v_cvt_pk_bf16_f32 v85, v54, v55
    s_waitcnt lgkmcnt(6)
    v_mfma_f32_16x16x32_bf16 v[68:71], v[36:39], a[48:51], v[68:71]
    ds_read_b128 v[32:35], v13 offset:18432
    v_mfma_f32_16x16x32_bf16 v[76:79], v[36:39], a[52:55], v[76:79]
    v_cvt_pk_bf16_f32 v86, v56, v57
    s_waitcnt lgkmcnt(6)
    v_mfma_f32_16x16x32_bf16 v[72:75], v[40:43], a[48:51], v[72:75]
    ds_read_b128 v[36:39], v12 offset:20480
    v_mfma_f32_16x16x32_bf16 v[80:83], v[40:43], a[52:55], v[80:83]
    v_cvt_pk_bf16_f32 v87, v58, v59
    s_waitcnt lgkmcnt(6)
    v_mfma_f32_16x16x32_bf16 v[68:71], v[44:47], a[56:59], v[68:71]
    ds_read_b128 v[40:43], v12 offset:22528
    v_mfma_f32_16x16x32_bf16 v[76:79], v[44:47], a[60:63], v[76:79]
    v_cvt_pk_bf16_f32 v88, v60, v61
    s_waitcnt lgkmcnt(6)
    v_mfma_f32_16x16x32_bf16 v[72:75], v[48:51], a[56:59], v[72:75]
    ds_read_b128 v[44:47], v13 offset:20480
    v_mfma_f32_16x16x32_bf16 v[80:83], v[48:51], a[60:63], v[80:83]
    v_cvt_pk_bf16_f32 v89, v62, v63
    buffer_store_dwordx4 v[84:87], v3, s[4:7], s21 offen offset:0 sc1
    s_waitcnt lgkmcnt(6)
    v_mfma_f32_16x16x32_bf16 v[68:71], v[20:23], a[64:67], v[68:71]
    ds_read_b128 v[48:51], v13 offset:22528
    v_mfma_f32_16x16x32_bf16 v[76:79], v[20:23], a[68:71], v[76:79]
    v_cvt_pk_bf16_f32 v90, v64, v65
    s_waitcnt lgkmcnt(6)
    v_mfma_f32_16x16x32_bf16 v[72:75], v[24:27], a[64:67], v[72:75]
    ds_read_b128 v[20:23], v12 offset:24576
    v_mfma_f32_16x16x32_bf16 v[80:83], v[24:27], a[68:71], v[80:83]
    v_cvt_pk_bf16_f32 v91, v66, v67
    s_waitcnt lgkmcnt(6)
    v_mfma_f32_16x16x32_bf16 v[68:71], v[28:31], a[72:75], v[68:71]
    ds_read_b128 v[24:27], v12 offset:26624
    v_mfma_f32_16x16x32_bf16 v[76:79], v[28:31], a[76:79], v[76:79]
    s_waitcnt lgkmcnt(6)
    v_mfma_f32_16x16x32_bf16 v[72:75], v[32:35], a[72:75], v[72:75]
    ds_read_b128 v[28:31], v13 offset:24576
    v_mfma_f32_16x16x32_bf16 v[80:83], v[32:35], a[76:79], v[80:83]
    buffer_store_dwordx4 v[88:91], v3, s[4:7], s21 offen offset:256 sc1
    s_waitcnt lgkmcnt(6)
    v_mfma_f32_16x16x32_bf16 v[68:71], v[36:39], a[80:83], v[68:71]
    ds_read_b128 v[32:35], v13 offset:26624
    v_mfma_f32_16x16x32_bf16 v[76:79], v[36:39], a[84:87], v[76:79]
    s_add_u32 s21, s21, s25
    s_mov_b32 s25, s26
    s_waitcnt lgkmcnt(6)
    v_mfma_f32_16x16x32_bf16 v[72:75], v[40:43], a[80:83], v[72:75]
    ds_read_b128 v[36:39], v12 offset:28672
    v_mfma_f32_16x16x32_bf16 v[80:83], v[40:43], a[84:87], v[80:83]
    s_waitcnt lgkmcnt(6)
    v_mfma_f32_16x16x32_bf16 v[68:71], v[44:47], a[88:91], v[68:71]
    ds_read_b128 v[40:43], v12 offset:30720
    v_mfma_f32_16x16x32_bf16 v[76:79], v[44:47], a[92:95], v[76:79]
    s_waitcnt lgkmcnt(6)
    v_mfma_f32_16x16x32_bf16 v[72:75], v[48:51], a[88:91], v[72:75]
    ds_read_b128 v[44:47], v13 offset:28672
    v_mfma_f32_16x16x32_bf16 v[80:83], v[48:51], a[92:95], v[80:83]
    s_waitcnt lgkmcnt(6)
    v_mfma_f32_16x16x32_bf16 v[68:71], v[20:23], a[96:99], v[68:71]
    ds_read_b128 v[48:51], v13 offset:30720
    v_mfma_f32_16x16x32_bf16 v[76:79], v[20:23], a[100:103], v[76:79]
    s_waitcnt lgkmcnt(6)
    v_mfma_f32_16x16x32_bf16 v[72:75], v[24:27], a[96:99], v[72:75]
    s_waitcnt vmcnt(10)
    s_barrier
    ds_read_b128 v[20:23], v12 offset:32768
    v_mfma_f32_16x16x32_bf16 v[80:83], v[24:27], a[100:103], v[80:83]
    s_waitcnt lgkmcnt(6)
    v_mfma_f32_16x16x32_bf16 v[68:71], v[28:31], a[104:107], v[68:71]
    ds_read_b128 v[24:27], v12 offset:34816
    s_add_u32 m0, s19, 31744
    v_mfma_f32_16x16x32_bf16 v[76:79], v[28:31], a[108:111], v[76:79]
    buffer_load_dwordx4 v2, s[8:11], s20 offen offset:1024 lds
    s_waitcnt lgkmcnt(6)
    v_mfma_f32_16x16x32_bf16 v[72:75], v[32:35], a[104:107], v[72:75]
    ds_read_b128 v[28:31], v13 offset:32768
    v_mfma_f32_16x16x32_bf16 v[80:83], v[32:35], a[108:111], v[80:83]
    s_waitcnt lgkmcnt(6)
    v_mfma_f32_16x16x32_bf16 v[68:71], v[36:39], a[112:115], v[68:71]
    ds_read_b128 v[32:35], v13 offset:34816
    s_add_u32 m0, s19, 35712
    v_mfma_f32_16x16x32_bf16 v[76:79], v[36:39], a[116:119], v[76:79]
    buffer_load_dwordx4 v2, s[8:11], s20 offen offset:1152 lds
    s_waitcnt lgkmcnt(6)
    v_mfma_f32_16x16x32_bf16 v[72:75], v[40:43], a[112:115], v[72:75]
    ds_read_b128 v[36:39], v12 offset:36864
    v_mfma_f32_16x16x32_bf16 v[80:83], v[40:43], a[116:119], v[80:83]
    s_waitcnt lgkmcnt(6)
    v_mfma_f32_16x16x32_bf16 v[68:71], v[44:47], a[120:123], v[68:71]
    ds_read_b128 v[40:43], v12 offset:38912
    s_add_u32 m0, s19, 39680
    v_mfma_f32_16x16x32_bf16 v[76:79], v[44:47], a[124:127], v[76:79]
    buffer_load_dwordx4 v2, s[8:11], s20 offen offset:1280 lds
    s_waitcnt lgkmcnt(6)
    v_mfma_f32_16x16x32_bf16 v[72:75], v[48:51], a[120:123], v[72:75]
    ds_read_b128 v[44:47], v13 offset:36864
    v_mfma_f32_16x16x32_bf16 v[80:83], v[48:51], a[124:127], v[80:83]
    s_waitcnt lgkmcnt(6)
    v_mfma_f32_16x16x32_bf16 v[68:71], v[20:23], a[128:131], v[68:71]
    ds_read_b128 v[48:51], v13 offset:38912
    v_mfma_f32_16x16x32_bf16 v[76:79], v[20:23], a[132:135], v[76:79]
    s_waitcnt lgkmcnt(6)
    v_mfma_f32_16x16x32_bf16 v[72:75], v[24:27], a[128:131], v[72:75]
    ds_read_b128 v[20:23], v12 offset:40960
    s_add_u32 m0, s19, 43648
    v_mfma_f32_16x16x32_bf16 v[80:83], v[24:27], a[132:135], v[80:83]
    buffer_load_dwordx4 v2, s[8:11], s20 offen offset:1408 lds
    s_waitcnt lgkmcnt(6)
    v_mfma_f32_16x16x32_bf16 v[68:71], v[28:31], a[136:139], v[68:71]
    ds_read_b128 v[24:27], v12 offset:43008
    v_mfma_f32_16x16x32_bf16 v[76:79], v[28:31], a[140:143], v[76:79]
    s_waitcnt lgkmcnt(6)
    v_mfma_f32_16x16x32_bf16 v[72:75], v[32:35], a[136:139], v[72:75]
    ds_read_b128 v[28:31], v13 offset:40960
    s_add_u32 m0, s19, 47616
    v_mfma_f32_16x16x32_bf16 v[80:83], v[32:35], a[140:143], v[80:83]
    buffer_load_dwordx4 v2, s[8:11], s20 offen offset:1536 lds
    s_waitcnt lgkmcnt(6)
    v_mfma_f32_16x16x32_bf16 v[68:71], v[36:39], a[144:147], v[68:71]
    ds_read_b128 v[32:35], v13 offset:43008
    v_mfma_f32_16x16x32_bf16 v[76:79], v[36:39], a[148:151], v[76:79]
    s_waitcnt lgkmcnt(6)
    v_mfma_f32_16x16x32_bf16 v[72:75], v[40:43], a[144:147], v[72:75]
    ds_read_b128 v[36:39], v12 offset:45056
    s_add_u32 m0, s19, 51584
    v_mfma_f32_16x16x32_bf16 v[80:83], v[40:43], a[148:151], v[80:83]
    buffer_load_dwordx4 v2, s[8:11], s20 offen offset:1664 lds
    s_waitcnt lgkmcnt(6)
    v_mfma_f32_16x16x32_bf16 v[68:71], v[44:47], a[152:155], v[68:71]
    ds_read_b128 v[40:43], v12 offset:47104
    v_mfma_f32_16x16x32_bf16 v[76:79], v[44:47], a[156:159], v[76:79]
    s_waitcnt lgkmcnt(6)
    v_mfma_f32_16x16x32_bf16 v[72:75], v[48:51], a[152:155], v[72:75]
    ds_read_b128 v[44:47], v13 offset:45056
    s_add_u32 m0, s19, 55552
    v_mfma_f32_16x16x32_bf16 v[80:83], v[48:51], a[156:159], v[80:83]
    buffer_load_dwordx4 v2, s[8:11], s20 offen offset:1792 lds
    s_waitcnt lgkmcnt(6)
    v_mfma_f32_16x16x32_bf16 v[68:71], v[20:23], a[160:163], v[68:71]
    ds_read_b128 v[48:51], v13 offset:47104
    v_mfma_f32_16x16x32_bf16 v[76:79], v[20:23], a[164:167], v[76:79]
    s_waitcnt lgkmcnt(6)
    v_mfma_f32_16x16x32_bf16 v[72:75], v[24:27], a[160:163], v[72:75]
    ds_read_b128 v[20:23], v12 offset:49152
    s_add_u32 m0, s19, 59520
    v_mfma_f32_16x16x32_bf16 v[80:83], v[24:27], a[164:167], v[80:83]
    buffer_load_dwordx4 v2, s[8:11], s20 offen offset:1920 lds
    s_waitcnt lgkmcnt(6)
    v_mfma_f32_16x16x32_bf16 v[68:71], v[28:31], a[168:171], v[68:71]
    ds_read_b128 v[24:27], v12 offset:51200
    v_mfma_f32_16x16x32_bf16 v[76:79], v[28:31], a[172:175], v[76:79]
    s_add_u32 s20, s20, s24
    s_waitcnt lgkmcnt(6)
    v_mfma_f32_16x16x32_bf16 v[72:75], v[32:35], a[168:171], v[72:75]
    ds_read_b128 v[28:31], v13 offset:49152
    v_mfma_f32_16x16x32_bf16 v[80:83], v[32:35], a[172:175], v[80:83]
    s_waitcnt lgkmcnt(6)
    v_mfma_f32_16x16x32_bf16 v[68:71], v[36:39], a[176:179], v[68:71]
    ds_read_b128 v[32:35], v13 offset:51200
    v_mfma_f32_16x16x32_bf16 v[76:79], v[36:39], a[180:183], v[76:79]
    s_waitcnt lgkmcnt(6)
    v_mfma_f32_16x16x32_bf16 v[72:75], v[40:43], a[176:179], v[72:75]
    ds_read_b128 v[36:39], v12 offset:53248
    v_mfma_f32_16x16x32_bf16 v[80:83], v[40:43], a[180:183], v[80:83]
    s_waitcnt lgkmcnt(6)
    v_mfma_f32_16x16x32_bf16 v[68:71], v[44:47], a[184:187], v[68:71]
    ds_read_b128 v[40:43], v12 offset:55296
    v_mfma_f32_16x16x32_bf16 v[76:79], v[44:47], a[188:191], v[76:79]
    s_waitcnt lgkmcnt(6)
    v_mfma_f32_16x16x32_bf16 v[72:75], v[48:51], a[184:187], v[72:75]
    ds_read_b128 v[44:47], v13 offset:53248
    v_mfma_f32_16x16x32_bf16 v[80:83], v[48:51], a[188:191], v[80:83]
    s_waitcnt lgkmcnt(6)
    v_mfma_f32_16x16x32_bf16 v[68:71], v[20:23], a[192:195], v[68:71]
    ds_read_b128 v[48:51], v13 offset:55296
    v_mfma_f32_16x16x32_bf16 v[76:79], v[20:23], a[196:199], v[76:79]
    s_waitcnt lgkmcnt(6)
    v_mfma_f32_16x16x32_bf16 v[72:75], v[24:27], a[192:195], v[72:75]
    ds_read_b128 v[20:23], v12 offset:57344
    v_mfma_f32_16x16x32_bf16 v[80:83], v[24:27], a[196:199], v[80:83]
    s_waitcnt lgkmcnt(6)
    v_mfma_f32_16x16x32_bf16 v[68:71], v[28:31], a[200:203], v[68:71]
    ds_read_b128 v[24:27], v12 offset:59392
    v_mfma_f32_16x16x32_bf16 v[76:79], v[28:31], a[204:207], v[76:79]
    s_waitcnt lgkmcnt(6)
    v_mfma_f32_16x16x32_bf16 v[72:75], v[32:35], a[200:203], v[72:75]
    ds_read_b128 v[28:31], v13 offset:57344
    v_mfma_f32_16x16x32_bf16 v[80:83], v[32:35], a[204:207], v[80:83]
    s_waitcnt lgkmcnt(6)
    v_mfma_f32_16x16x32_bf16 v[68:71], v[36:39], a[208:211], v[68:71]
    ds_read_b128 v[32:35], v13 offset:59392
    v_mfma_f32_16x16x32_bf16 v[76:79], v[36:39], a[212:215], v[76:79]
    s_waitcnt lgkmcnt(6)
    v_mfma_f32_16x16x32_bf16 v[72:75], v[40:43], a[208:211], v[72:75]
    ds_read_b128 v[36:39], v12 offset:61440
    v_mfma_f32_16x16x32_bf16 v[80:83], v[40:43], a[212:215], v[80:83]
    s_waitcnt lgkmcnt(6)
    v_mfma_f32_16x16x32_bf16 v[68:71], v[44:47], a[216:219], v[68:71]
    ds_read_b128 v[40:43], v12 offset:63488
    v_mfma_f32_16x16x32_bf16 v[76:79], v[44:47], a[220:223], v[76:79]
    s_waitcnt lgkmcnt(6)
    v_mfma_f32_16x16x32_bf16 v[72:75], v[48:51], a[216:219], v[72:75]
    ds_read_b128 v[44:47], v13 offset:61440
    v_mfma_f32_16x16x32_bf16 v[80:83], v[48:51], a[220:223], v[80:83]
    s_waitcnt lgkmcnt(6)
    v_mfma_f32_16x16x32_bf16 v[68:71], v[20:23], a[224:227], v[68:71]
    ds_read_b128 v[48:51], v13 offset:63488
    v_mfma_f32_16x16x32_bf16 v[76:79], v[20:23], a[228:231], v[76:79]
    s_waitcnt lgkmcnt(6)
    v_mfma_f32_16x16x32_bf16 v[72:75], v[24:27], a[224:227], v[72:75]
    s_waitcnt vmcnt(8)
    s_barrier
    ds_read_b128 v[20:23], v10 offset:0
    v_mfma_f32_16x16x32_bf16 v[80:83], v[24:27], a[228:231], v[80:83]
    s_waitcnt lgkmcnt(6)
    v_mfma_f32_16x16x32_bf16 v[68:71], v[28:31], a[232:235], v[68:71]
    ds_read_b128 v[24:27], v10 offset:2048
    s_add_u32 m0, s19, 65536
    v_mfma_f32_16x16x32_bf16 v[76:79], v[28:31], a[236:239], v[76:79]
    buffer_load_dwordx4 v2, s[8:11], s20 offen offset:0 lds
    s_waitcnt lgkmcnt(6)
    v_mfma_f32_16x16x32_bf16 v[72:75], v[32:35], a[232:235], v[72:75]
    ds_read_b128 v[28:31], v11 offset:0
    v_mfma_f32_16x16x32_bf16 v[80:83], v[32:35], a[236:239], v[80:83]
    s_waitcnt lgkmcnt(6)
    v_mfma_f32_16x16x32_bf16 v[68:71], v[36:39], a[240:243], v[68:71]
    ds_read_b128 v[32:35], v11 offset:2048
    s_add_u32 m0, s19, 69504
    v_mfma_f32_16x16x32_bf16 v[76:79], v[36:39], a[244:247], v[76:79]
    buffer_load_dwordx4 v2, s[8:11], s20 offen offset:128 lds
    s_waitcnt lgkmcnt(6)
    v_mfma_f32_16x16x32_bf16 v[72:75], v[40:43], a[240:243], v[72:75]
    ds_read_b128 v[36:39], v10 offset:4096
    v_mfma_f32_16x16x32_bf16 v[80:83], v[40:43], a[244:247], v[80:83]
    s_waitcnt lgkmcnt(6)
    v_mfma_f32_16x16x32_bf16 v[68:71], v[44:47], a[248:251], v[68:71]
    ds_read_b128 v[40:43], v10 offset:6144
    s_add_u32 m0, s19, 73472
    v_mfma_f32_16x16x32_bf16 v[76:79], v[44:47], a[252:255], v[76:79]
    buffer_load_dwordx4 v2, s[8:11], s20 offen offset:256 lds
    s_waitcnt lgkmcnt(6)
    v_mfma_f32_16x16x32_bf16 v[72:75], v[48:51], a[248:251], v[72:75]
    ds_read_b128 v[44:47], v11 offset:4096
    v_mfma_f32_16x16x32_bf16 v[80:83], v[48:51], a[252:255], v[80:83]
    s_add_u32 s22, s22, 2
    s_cmp_lt_u32 s22, 16
    s_cbranch_scc1 F1_top
    v_cvt_pk_bf16_f32 v84, v68, v69
    v_cvt_pk_bf16_f32 v85, v70, v71
    s_nop 0
    v_cvt_pk_bf16_f32 v86, v72, v73
    v_cvt_pk_bf16_f32 v87, v74, v75
    v_cvt_pk_bf16_f32 v88, v76, v77
    v_cvt_pk_bf16_f32 v89, v78, v79
    v_cvt_pk_bf16_f32 v90, v80, v81
    v_cvt_pk_bf16_f32 v91, v82, v83
    buffer_store_dwordx4 v[84:87], v3, s[4:7], s21 offen offset:0 sc1
    buffer_store_dwordx4 v[88:91], v3, s[4:7], s21 offen offset:256 sc1
    s_waitcnt vmcnt(0) lgkmcnt(0)
    s_barrier
    s_lshl_b32 s31, s29, 2
    s_add_u32 s31, s31, s28
    s_lshl_b32 s17, s31, 7
    s_add_u32 s17, s17, 100745216
    v_lshl_add_u32 v5, v1, 2, s17
    v_mov_b32 v6, 1
    s_mov_b64 exec, 0xffffffff
    buffer_store_dword v6, v5, s[4:7], 0 offen sc1
    s_mov_b64 exec, -1
    v_and_b32 v10, 19, v1
    v_bfe_u32 v5, v1, 2, 1
    v_bfe_u32 v6, v1, 3, 1
    v_lshl_add_u32 v10, v5, 3, v10
    v_lshl_add_u32 v10, v6, 2, v10
    v_lshrrev_b32 v11, 5, v1
    v_cvt_f32_u32 v16, v10
    v_lshlrev_b32 v17, 3, v11
    v_cvt_f32_u32 v17, v17
    v_lshlrev_b32 v14, 4, v1
    v_add_f32 v5, 0, v16
    v_mul_f32 v5, 1015021568, v5
    v_mul_f32 v6, v5, v17
    v_mul_f32 v7, 0x41800000, v5
    v_fract_f32 v32, v6
    v_add_f32 v33, v32, v5
    v_add_f32 v34, v33, v5
    v_add_f32 v35, v34, v5
    v_add_f32 v36, v35, v5
    v_add_f32 v37, v36, v5
    v_add_f32 v38, v37, v5
    v_add_f32 v39, v38, v5
    v_add_f32 v6, v32, v7
    v_cos_f32 v40, v32
    v_sin_f32 v48, v32
    v_cos_f32 v41, v33
    v_sin_f32 v49, v33
    v_cos_f32 v42, v34
    v_sin_f32 v50, v34
    v_cos_f32 v43, v35
    v_sin_f32 v51, v35
    v_cos_f32 v44, v36
    v_sin_f32 v52, v36
    v_cos_f32 v45, v37
    v_sin_f32 v53, v37
    v_cos_f32 v46, v38
    v_sin_f32 v54, v38
    v_cos_f32 v47, v39
    v_sin_f32 v55, v39
    v_cvt_pk_bf16_f32 v56, v40, v41
    v_cvt_pk_bf16_f32 v57, v48, v49
    v_accvgpr_write_b32 a0, v56
    v_xor_b32 v58, 0x80008000, v57
    v_accvgpr_write_b32 a32, v57
    v_accvgpr_write_b32 a64, v58
    v_cvt_pk_bf16_f32 v56, v42, v43
    v_cvt_pk_bf16_f32 v57, v50, v51
    v_accvgpr_write_b32 a1, v56
    v_xor_b32 v58, 0x80008000, v57
    v_accvgpr_write_b32 a33, v57
    v_accvgpr_write_b32 a65, v58
    v_cvt_pk_bf16_f32 v56, v44, v45
    v_cvt_pk_bf16_f32 v57, v52, v53
    v_accvgpr_write_b32 a2, v56
    v_xor_b32 v58, 0x80008000, v57
    v_accvgpr_write_b32 a34, v57
    v_accvgpr_write_b32 a66, v58
    v_cvt_pk_bf16_f32 v56, v46, v47
    v_cvt_pk_bf16_f32 v57, v54, v55
    v_accvgpr_write_b32 a3, v56
    v_xor_b32 v58, 0x80008000, v57
    v_accvgpr_write_b32 a35, v57
    v_accvgpr_write_b32 a67, v58
    v_fract_f32 v32, v6
    v_add_f32 v33, v32, v5
    v_add_f32 v34, v33, v5
    v_add_f32 v35, v34, v5
    v_add_f32 v36, v35, v5
    v_add_f32 v37, v36, v5
    v_add_f32 v38, v37, v5
    v_add_f32 v39, v38, v5
    v_add_f32 v6, v32, v7
    v_cos_f32 v40, v32
    v_sin_f32 v48, v32
    v_cos_f32 v41, v33
    v_sin_f32 v49, v33
    v_cos_f32 v42, v34
    v_sin_f32 v50, v34
    v_cos_f32 v43, v35
    v_sin_f32 v51, v35
    v_cos_f32 v44, v36
    v_sin_f32 v52, v36
    v_cos_f32 v45, v37
    v_sin_f32 v53, v37
    v_cos_f32 v46, v38
    v_sin_f32 v54, v38
    v_cos_f32 v47, v39
    v_sin_f32 v55, v39
    v_cvt_pk_bf16_f32 v56, v40, v41
    v_cvt_pk_bf16_f32 v57, v48, v49
    v_accvgpr_write_b32 a4, v56
    v_xor_b32 v58, 0x80008000, v57
    v_accvgpr_write_b32 a36, v57
    v_accvgpr_write_b32 a68, v58
    v_cvt_pk_bf16_f32 v56, v42, v43
    v_cvt_pk_bf16_f32 v57, v50, v51
    v_accvgpr_write_b32 a5, v56
    v_xor_b32 v58, 0x80008000, v57
    v_accvgpr_write_b32 a37, v57
    v_accvgpr_write_b32 a69, v58
    v_cvt_pk_bf16_f32 v56, v44, v45
    v_cvt_pk_bf16_f32 v57, v52, v53
    v_accvgpr_write_b32 a6, v56
    v_xor_b32 v58, 0x80008000, v57
    v_accvgpr_write_b32 a38, v57
    v_accvgpr_write_b32 a70, v58
    v_cvt_pk_bf16_f32 v56, v46, v47
    v_cvt_pk_bf16_f32 v57, v54, v55
    v_accvgpr_write_b32 a7, v56
    v_xor_b32 v58, 0x80008000, v57
    v_accvgpr_write_b32 a39, v57
    v_accvgpr_write_b32 a71, v58
    v_fract_f32 v32, v6
    v_add_f32 v33, v32, v5
    v_add_f32 v34, v33, v5
    v_add_f32 v35, v34, v5
    v_add_f32 v36, v35, v5
    v_add_f32 v37, v36, v5
    v_add_f32 v38, v37, v5
    v_add_f32 v39, v38, v5
    v_add_f32 v6, v32, v7
    v_cos_f32 v40, v32
    v_sin_f32 v48, v32
    v_cos_f32 v41, v33
    v_sin_f32 v49, v33
    v_cos_f32 v42, v34
    v_sin_f32 v50, v34
    v_cos_f32 v43, v35
    v_sin_f32 v51, v35
    v_cos_f32 v44, v36
    v_sin_f32 v52, v36
    v_cos_f32 v45, v37
    v_sin_f32 v53, v37
    v_cos_f32 v46, v38
    v_sin_f32 v54, v38
    v_cos_f32 v47, v39
    v_sin_f32 v55, v39
    v_cvt_pk_bf16_f32 v56, v40, v41
    v_cvt_pk_bf16_f32 v57, v48, v49
    v_accvgpr_write_b32 a8, v56
    v_xor_b32 v58, 0x80008000, v57
    v_accvgpr_write_b32 a40, v57
    v_accvgpr_write_b32 a72, v58
    v_cvt_pk_bf16_f32 v56, v42, v43
    v_cvt_pk_bf16_f32 v57, v50, v51
    v_accvgpr_write_b32 a9, v56
    v_xor_b32 v58, 0x80008000, v57
    v_accvgpr_write_b32 a41, v57
    v_accvgpr_write_b32 a73, v58
    v_cvt_pk_bf16_f32 v56, v44, v45
    v_cvt_pk_bf16_f32 v57, v52, v53
    v_accvgpr_write_b32 a10, v56
    v_xor_b32 v58, 0x80008000, v57
    v_accvgpr_write_b32 a42, v57
    v_accvgpr_write_b32 a74, v58
    v_cvt_pk_bf16_f32 v56, v46, v47
    v_cvt_pk_bf16_f32 v57, v54, v55
    v_accvgpr_write_b32 a11, v56
    v_xor_b32 v58, 0x80008000, v57
    v_accvgpr_write_b32 a43, v57
    v_accvgpr_write_b32 a75, v58
    v_fract_f32 v32, v6
    v_add_f32 v33, v32, v5
    v_add_f32 v34, v33, v5
    v_add_f32 v35, v34, v5
    v_add_f32 v36, v35, v5
    v_add_f32 v37, v36, v5
    v_add_f32 v38, v37, v5
    v_add_f32 v39, v38, v5
    v_add_f32 v6, v32, v7
    v_cos_f32 v40, v32
    v_sin_f32 v48, v32
    v_cos_f32 v41, v33
    v_sin_f32 v49, v33
    v_cos_f32 v42, v34
    v_sin_f32 v50, v34
    v_cos_f32 v43, v35
    v_sin_f32 v51, v35
    v_cos_f32 v44, v36
    v_sin_f32 v52, v36
    v_cos_f32 v45, v37
    v_sin_f32 v53, v37
    v_cos_f32 v46, v38
    v_sin_f32 v54, v38
    v_cos_f32 v47, v39
    v_sin_f32 v55, v39
    v_cvt_pk_bf16_f32 v56, v40, v41
    v_cvt_pk_bf16_f32 v57, v48, v49
    v_accvgpr_write_b32 a12, v56
    v_xor_b32 v58, 0x80008000, v57
    v_accvgpr_write_b32 a44, v57
    v_accvgpr_write_b32 a76, v58
    v_cvt_pk_bf16_f32 v56, v42, v43
    v_cvt_pk_bf16_f32 v57, v50, v51
    v_accvgpr_write_b32 a13, v56
    v_xor_b32 v58, 0x80008000, v57
    v_accvgpr_write_b32 a45, v57
    v_accvgpr_write_b32 a77, v58
    v_cvt_pk_bf16_f32 v56, v44, v45
    v_cvt_pk_bf16_f32 v57, v52, v53
    v_accvgpr_write_b32 a14, v56
    v_xor_b32 v58, 0x80008000, v57
    v_accvgpr_write_b32 a46, v57
    v_accvgpr_write_b32 a78, v58
    v_cvt_pk_bf16_f32 v56, v46, v47
    v_cvt_pk_bf16_f32 v57, v54, v55
    v_accvgpr_write_b32 a15, v56
    v_xor_b32 v58, 0x80008000, v57
    v_accvgpr_write_b32 a47, v57
    v_accvgpr_write_b32 a79, v58
    v_add_f32 v5, 1107296256, v16
    v_mul_f32 v5, 1015021568, v5
    v_mul_f32 v6, v5, v17
    v_mul_f32 v7, 0x41800000, v5
    v_fract_f32 v32, v6
    v_add_f32 v33, v32, v5
    v_add_f32 v34, v33, v5
    v_add_f32 v35, v34, v5
    v_add_f32 v36, v35, v5
    v_add_f32 v37, v36, v5
    v_add_f32 v38, v37, v5
    v_add_f32 v39, v38, v5
    v_add_f32 v6, v32, v7
    v_cos_f32 v40, v32
    v_sin_f32 v48, v32
    v_cos_f32 v41, v33
    v_sin_f32 v49, v33
    v_cos_f32 v42, v34
    v_sin_f32 v50, v34
    v_cos_f32 v43, v35
    v_sin_f32 v51, v35
    v_cos_f32 v44, v36
    v_sin_f32 v52, v36
    v_cos_f32 v45, v37
    v_sin_f32 v53, v37
    v_cos_f32 v46, v38
    v_sin_f32 v54, v38
    v_cos_f32 v47, v39
    v_sin_f32 v55, v39
    v_cvt_pk_bf16_f32 v56, v40, v41
    v_cvt_pk_bf16_f32 v57, v48, v49
    v_accvgpr_write_b32 a16, v56
    v_xor_b32 v58, 0x80008000, v57
    v_accvgpr_write_b32 a48, v57
    v_accvgpr_write_b32 a80, v58
    v_cvt_pk_bf16_f32 v56, v42, v43
    v_cvt_pk_bf16_f32 v57, v50, v51
    v_accvgpr_write_b32 a17, v56
    v_xor_b32 v58, 0x80008000, v57
    v_accvgpr_write_b32 a49, v57
    v_accvgpr_write_b32 a81, v58
    v_cvt_pk_bf16_f32 v56, v44, v45
    v_cvt_pk_bf16_f32 v57, v52, v53
    v_accvgpr_write_b32 a18, v56
    v_xor_b32 v58, 0x80008000, v57
    v_accvgpr_write_b32 a50, v57
    v_accvgpr_write_b32 a82, v58
    v_cvt_pk_bf16_f32 v56, v46, v47
    v_cvt_pk_bf16_f32 v57, v54, v55
    v_accvgpr_write_b32 a19, v56
    v_xor_b32 v58, 0x80008000, v57
    v_accvgpr_write_b32 a51, v57
    v_accvgpr_write_b32 a83, v58
    v_fract_f32 v32, v6
    v_add_f32 v33, v32, v5
    v_add_f32 v34, v33, v5
    v_add_f32 v35, v34, v5
    v_add_f32 v36, v35, v5
    v_add_f32 v37, v36, v5
    v_add_f32 v38, v37, v5
    v_add_f32 v39, v38, v5
    v_add_f32 v6, v32, v7
    v_cos_f32 v40, v32
    v_sin_f32 v48, v32
    v_cos_f32 v41, v33
    v_sin_f32 v49, v33
    v_cos_f32 v42, v34
    v_sin_f32 v50, v34
    v_cos_f32 v43, v35
    v_sin_f32 v51, v35
    v_cos_f32 v44, v36
    v_sin_f32 v52, v36
    v_cos_f32 v45, v37
    v_sin_f32 v53, v37
    v_cos_f32 v46, v38
    v_sin_f32 v54, v38
    v_cos_f32 v47, v39
    v_sin_f32 v55, v39
    v_cvt_pk_bf16_f32 v56, v40, v41
    v_cvt_pk_bf16_f32 v57, v48, v49
    v_accvgpr_write_b32 a20, v56
    v_xor_b32 v58, 0x80008000, v57
    v_accvgpr_write_b32 a52, v57
    v_accvgpr_write_b32 a84, v58
    v_cvt_pk_bf16_f32 v56, v42, v43
    v_cvt_pk_bf16_f32 v57, v50, v51
    v_accvgpr_write_b32 a21, v56
    v_xor_b32 v58, 0x80008000, v57
    v_accvgpr_write_b32 a53, v57
    v_accvgpr_write_b32 a85, v58
    v_cvt_pk_bf16_f32 v56, v44, v45
    v_cvt_pk_bf16_f32 v57, v52, v53
    v_accvgpr_write_b32 a22, v56
    v_xor_b32 v58, 0x80008000, v57
    v_accvgpr_write_b32 a54, v57
    v_accvgpr_write_b32 a86, v58
    v_cvt_pk_bf16_f32 v56, v46, v47
    v_cvt_pk_bf16_f32 v57, v54, v55
    v_accvgpr_write_b32 a23, v56
    v_xor_b32 v58, 0x80008000, v57
    v_accvgpr_write_b32 a55, v57
    v_accvgpr_write_b32 a87, v58
    v_fract_f32 v32, v6
    v_add_f32 v33, v32, v5
    v_add_f32 v34, v33, v5
    v_add_f32 v35, v34, v5
    v_add_f32 v36, v35, v5
    v_add_f32 v37, v36, v5
    v_add_f32 v38, v37, v5
    v_add_f32 v39, v38, v5
    v_add_f32 v6, v32, v7
    v_cos_f32 v40, v32
    v_sin_f32 v48, v32
    v_cos_f32 v41, v33
    v_sin_f32 v49, v33
    v_cos_f32 v42, v34
    v_sin_f32 v50, v34
    v_cos_f32 v43, v35
    v_sin_f32 v51, v35
    v_cos_f32 v44, v36
    v_sin_f32 v52, v36
    v_cos_f32 v45, v37
    v_sin_f32 v53, v37
    v_cos_f32 v46, v38
    v_sin_f32 v54, v38
    v_cos_f32 v47, v39
    v_sin_f32 v55, v39
    v_cvt_pk_bf16_f32 v56, v40, v41
    v_cvt_pk_bf16_f32 v57, v48, v49
    v_accvgpr_write_b32 a24, v56
    v_xor_b32 v58, 0x80008000, v57
    v_accvgpr_write_b32 a56, v57
    v_accvgpr_write_b32 a88, v58
    v_cvt_pk_bf16_f32 v56, v42, v43
    v_cvt_pk_bf16_f32 v57, v50, v51
    v_accvgpr_write_b32 a25, v56
    v_xor_b32 v58, 0x80008000, v57
    v_accvgpr_write_b32 a57, v57
    v_accvgpr_write_b32 a89, v58
    v_cvt_pk_bf16_f32 v56, v44, v45
    v_cvt_pk_bf16_f32 v57, v52, v53
    v_accvgpr_write_b32 a26, v56
    v_xor_b32 v58, 0x80008000, v57
    v_accvgpr_write_b32 a58, v57
    v_accvgpr_write_b32 a90, v58
    v_cvt_pk_bf16_f32 v56, v46, v47
    v_cvt_pk_bf16_f32 v57, v54, v55
    v_accvgpr_write_b32 a27, v56
    v_xor_b32 v58, 0x80008000, v57
    v_accvgpr_write_b32 a59, v57
    v_accvgpr_write_b32 a91, v58
    v_fract_f32 v32, v6
    v_add_f32 v33, v32, v5
    v_add_f32 v34, v33, v5
    v_add_f32 v35, v34, v5
    v_add_f32 v36, v35, v5
    v_add_f32 v37, v36, v5
    v_add_f32 v38, v37, v5
    v_add_f32 v39, v38, v5
    v_add_f32 v6, v32, v7
    v_cos_f32 v40, v32
    v_sin_f32 v48, v32
    v_cos_f32 v41, v33
    v_sin_f32 v49, v33
    v_cos_f32 v42, v34
    v_sin_f32 v50, v34
    v_cos_f32 v43, v35
    v_sin_f32 v51, v35
    v_cos_f32 v44, v36
    v_sin_f32 v52, v36
    v_cos_f32 v45, v37
    v_sin_f32 v53, v37
    v_cos_f32 v46, v38
    v_sin_f32 v54, v38
    v_cos_f32 v47, v39
    v_sin_f32 v55, v39
    v_cvt_pk_bf16_f32 v56, v40, v41
    v_cvt_pk_bf16_f32 v57, v48, v49
    v_accvgpr_write_b32 a28, v56
    v_xor_b32 v58, 0x80008000, v57
    v_accvgpr_write_b32 a60, v57
    v_accvgpr_write_b32 a92, v58
    v_cvt_pk_bf16_f32 v56, v42, v43
    v_cvt_pk_bf16_f32 v57, v50, v51
    v_accvgpr_write_b32 a29, v56
    v_xor_b32 v58, 0x80008000, v57
    v_accvgpr_write_b32 a61, v57
    v_accvgpr_write_b32 a93, v58
    v_cvt_pk_bf16_f32 v56, v44, v45
    v_cvt_pk_bf16_f32 v57, v52, v53
    v_accvgpr_write_b32 a30, v56
    v_xor_b32 v58, 0x80008000, v57
    v_accvgpr_write_b32 a62, v57
    v_accvgpr_write_b32 a94, v58
    v_cvt_pk_bf16_f32 v56, v46, v47
    v_cvt_pk_bf16_f32 v57, v54, v55
    v_accvgpr_write_b32 a31, v56
    v_xor_b32 v58, 0x80008000, v57
    v_accvgpr_write_b32 a63, v57
    v_accvgpr_write_b32 a95, v58
    v_add_f32 v5, 0, v16
    v_mul_f32 v5, 1023410176, v5
    v_mul_f32 v6, v5, v17
    v_mul_f32 v7, 0x41800000, v5
    v_fract_f32 v32, v6
    v_add_f32 v33, v32, v5
    v_add_f32 v34, v33, v5
    v_add_f32 v35, v34, v5
    v_add_f32 v36, v35, v5
    v_add_f32 v37, v36, v5
    v_add_f32 v38, v37, v5
    v_add_f32 v39, v38, v5
    v_add_f32 v6, v32, v7
    v_cos_f32 v40, v32
    v_sin_f32 v48, v32
    v_cos_f32 v41, v33
    v_sin_f32 v49, v33
    v_cos_f32 v42, v34
    v_sin_f32 v50, v34
    v_cos_f32 v43, v35
    v_sin_f32 v51, v35
    v_cos_f32 v44, v36
    v_sin_f32 v52, v36
    v_cos_f32 v45, v37
    v_sin_f32 v53, v37
    v_cos_f32 v46, v38
    v_sin_f32 v54, v38
    v_cos_f32 v47, v39
    v_sin_f32 v55, v39
    v_cvt_pk_bf16_f32 v56, v40, v41
    v_cvt_pk_bf16_f32 v57, v48, v49
    v_accvgpr_write_b32 a96, v56
    v_xor_b32 v58, 0x80008000, v57
    v_accvgpr_write_b32 a104, v57
    v_accvgpr_write_b32 a112, v58
    v_cvt_pk_bf16_f32 v56, v42, v43
    v_cvt_pk_bf16_f32 v57, v50, v51
    v_accvgpr_write_b32 a97, v56
    v_xor_b32 v58, 0x80008000, v57
    v_accvgpr_write_b32 a105, v57
    v_accvgpr_write_b32 a113, v58
    v_cvt_pk_bf16_f32 v56, v44, v45
    v_cvt_pk_bf16_f32 v57, v52, v53
    v_accvgpr_write_b32 a98, v56
    v_xor_b32 v58, 0x80008000, v57
    v_accvgpr_write_b32 a106, v57
    v_accvgpr_write_b32 a114, v58
    v_cvt_pk_bf16_f32 v56, v46, v47
    v_cvt_pk_bf16_f32 v57, v54, v55
    v_accvgpr_write_b32 a99, v56
    v_xor_b32 v58, 0x80008000, v57
    v_accvgpr_write_b32 a107, v57
    v_accvgpr_write_b32 a115, v58
    v_fract_f32 v32, v6
    v_add_f32 v33, v32, v5
    v_add_f32 v34, v33, v5
    v_add_f32 v35, v34, v5
    v_add_f32 v36, v35, v5
    v_add_f32 v37, v36, v5
    v_add_f32 v38, v37, v5
    v_add_f32 v39, v38, v5
    v_add_f32 v6, v32, v7
    v_cos_f32 v40, v32
    v_sin_f32 v48, v32
    v_cos_f32 v41, v33
    v_sin_f32 v49, v33
    v_cos_f32 v42, v34
    v_sin_f32 v50, v34
    v_cos_f32 v43, v35
    v_sin_f32 v51, v35
    v_cos_f32 v44, v36
    v_sin_f32 v52, v36
    v_cos_f32 v45, v37
    v_sin_f32 v53, v37
    v_cos_f32 v46, v38
    v_sin_f32 v54, v38
    v_cos_f32 v47, v39
    v_sin_f32 v55, v39
    v_cvt_pk_bf16_f32 v56, v40, v41
    v_cvt_pk_bf16_f32 v57, v48, v49
    v_accvgpr_write_b32 a100, v56
    v_xor_b32 v58, 0x80008000, v57
    v_accvgpr_write_b32 a108, v57
    v_accvgpr_write_b32 a116, v58
    v_cvt_pk_bf16_f32 v56, v42, v43
    v_cvt_pk_bf16_f32 v57, v50, v51
    v_accvgpr_write_b32 a101, v56
    v_xor_b32 v58, 0x80008000, v57
    v_accvgpr_write_b32 a109, v57
    v_accvgpr_write_b32 a117, v58
    v_cvt_pk_bf16_f32 v56, v44, v45
    v_cvt_pk_bf16_f32 v57, v52, v53
    v_accvgpr_write_b32 a102, v56
    v_xor_b32 v58, 0x80008000, v57
    v_accvgpr_write_b32 a110, v57
    v_accvgpr_write_b32 a118, v58
    v_cvt_pk_bf16_f32 v56, v46, v47
    v_cvt_pk_bf16_f32 v57, v54, v55
    v_accvgpr_write_b32 a103, v56
    v_xor_b32 v58, 0x80008000, v57
    v_accvgpr_write_b32 a111, v57
    v_accvgpr_write_b32 a119, v58
    v_add_f32 v5, 0, v16
    v_mul_f32 v5, 973078528, v5
    v_add_f32 v6, 0, v17
    v_mul_f32 v6, v6, v5
    v_cos_f32 v160, v6
    v_sin_f32 v176, v6
    v_add_f32 v6, 1065353216, v17
    v_mul_f32 v6, v6, v5
    v_cos_f32 v161, v6
    v_sin_f32 v177, v6
    v_add_f32 v6, 1073741824, v17
    v_mul_f32 v6, v6, v5
    v_cos_f32 v162, v6
    v_sin_f32 v178, v6
    v_add_f32 v6, 1077936128, v17
    v_mul_f32 v6, v6, v5
    v_cos_f32 v163, v6
    v_sin_f32 v179, v6
    v_add_f32 v6, 1082130432, v17
    v_mul_f32 v6, v6, v5
    v_cos_f32 v164, v6
    v_sin_f32 v180, v6
    v_add_f32 v6, 1084227584, v17
    v_mul_f32 v6, v6, v5
    v_cos_f32 v165, v6
    v_sin_f32 v181, v6
    v_add_f32 v6, 1086324736, v17
    v_mul_f32 v6, v6, v5
    v_cos_f32 v166, v6
    v_sin_f32 v182, v6
    v_add_f32 v6, 1088421888, v17
    v_mul_f32 v6, v6, v5
    v_cos_f32 v167, v6
    v_sin_f32 v183, v6
    v_add_f32 v6, 1098907648, v17
    v_mul_f32 v6, v6, v5
    v_cos_f32 v168, v6
    v_sin_f32 v184, v6
    v_add_f32 v6, 1099431936, v17
    v_mul_f32 v6, v6, v5
    v_cos_f32 v169, v6
    v_sin_f32 v185, v6
    v_add_f32 v6, 1099956224, v17
    v_mul_f32 v6, v6, v5
    v_cos_f32 v170, v6
    v_sin_f32 v186, v6
    v_add_f32 v6, 1100480512, v17
    v_mul_f32 v6, v6, v5
    v_cos_f32 v171, v6
    v_sin_f32 v187, v6
    v_add_f32 v6, 1101004800, v17
    v_mul_f32 v6, v6, v5
    v_cos_f32 v172, v6
    v_sin_f32 v188, v6
    v_add_f32 v6, 1101529088, v17
    v_mul_f32 v6, v6, v5
    v_cos_f32 v173, v6
    v_sin_f32 v189, v6
    v_add_f32 v6, 1102053376, v17
    v_mul_f32 v6, v6, v5
    v_cos_f32 v174, v6
    v_sin_f32 v190, v6
    v_add_f32 v6, 1102577664, v17
    v_mul_f32 v6, v6, v5
    v_cos_f32 v175, v6
    v_sin_f32 v191, v6
    v_add_f32 v5, 1107296256, v16
    v_mul_f32 v5, 973078528, v5
    v_add_f32 v6, 0, v17
    v_mul_f32 v6, v6, v5
    v_cos_f32 v192, v6
    v_sin_f32 v208, v6
    v_add_f32 v6, 1065353216, v17
    v_mul_f32 v6, v6, v5
    v_cos_f32 v193, v6
    v_sin_f32 v209, v6
    v_add_f32 v6, 1073741824, v17
    v_mul_f32 v6, v6, v5
    v_cos_f32 v194, v6
    v_sin_f32 v210, v6
    v_add_f32 v6, 1077936128, v17
    v_mul_f32 v6, v6, v5
    v_cos_f32 v195, v6
    v_sin_f32 v211, v6
    v_add_f32 v6, 1082130432, v17
    v_mul_f32 v6, v6, v5
    v_cos_f32 v196, v6
    v_sin_f32 v212, v6
    v_add_f32 v6, 1084227584, v17
    v_mul_f32 v6, v6, v5
    v_cos_f32 v197, v6
    v_sin_f32 v213, v6
    v_add_f32 v6, 1086324736, v17
    v_mul_f32 v6, v6, v5
    v_cos_f32 v198, v6
    v_sin_f32 v214, v6
    v_add_f32 v6, 1088421888, v17
    v_mul_f32 v6, v6, v5
    v_cos_f32 v199, v6
    v_sin_f32 v215, v6
    v_add_f32 v6, 1098907648, v17
    v_mul_f32 v6, v6, v5
    v_cos_f32 v200, v6
    v_sin_f32 v216, v6
    v_add_f32 v6, 1099431936, v17
    v_mul_f32 v6, v6, v5
    v_cos_f32 v201, v6
    v_sin_f32 v217, v6
    v_add_f32 v6, 1099956224, v17
    v_mul_f32 v6, v6, v5
    v_cos_f32 v202, v6
    v_sin_f32 v218, v6
    v_add_f32 v6, 1100480512, v17
    v_mul_f32 v6, v6, v5
    v_cos_f32 v203, v6
    v_sin_f32 v219, v6
    v_add_f32 v6, 1101004800, v17
    v_mul_f32 v6, v6, v5
    v_cos_f32 v204, v6
    v_sin_f32 v220, v6
    v_add_f32 v6, 1101529088, v17
    v_mul_f32 v6, v6, v5
    v_cos_f32 v205, v6
    v_sin_f32 v221, v6
    v_add_f32 v6, 1102053376, v17
    v_mul_f32 v6, v6, v5
    v_cos_f32 v206, v6
    v_sin_f32 v222, v6
    v_add_f32 v6, 1102577664, v17
    v_mul_f32 v6, v6, v5
    v_cos_f32 v207, v6
    v_sin_f32 v223, v6
    v_add_f32 v5, 0, v16
    v_mul_f32 v5, 973078528, v5
    v_add_f32 v6, 1107296256, v17
    v_mul_f32 v6, v6, v5
    v_cos_f32 v224, v6
    v_sin_f32 v240, v6
    v_add_f32 v6, 1107558400, v17
    v_mul_f32 v6, v6, v5
    v_cos_f32 v225, v6
    v_sin_f32 v241, v6
    v_add_f32 v6, 1107820544, v17
    v_mul_f32 v6, v6, v5
    v_cos_f32 v226, v6
    v_sin_f32 v242, v6
    v_add_f32 v6, 1108082688, v17
    v_mul_f32 v6, v6, v5
    v_cos_f32 v227, v6
    v_sin_f32 v243, v6
    v_add_f32 v6, 1108344832, v17
    v_mul_f32 v6, v6, v5
    v_cos_f32 v228, v6
    v_sin_f32 v244, v6
    v_add_f32 v6, 1108606976, v17
    v_mul_f32 v6, v6, v5
    v_cos_f32 v229, v6
    v_sin_f32 v245, v6
    v_add_f32 v6, 1108869120, v17
    v_mul_f32 v6, v6, v5
    v_cos_f32 v230, v6
    v_sin_f32 v246, v6
    v_add_f32 v6, 1109131264, v17
    v_mul_f32 v6, v6, v5
    v_cos_f32 v231, v6
    v_sin_f32 v247, v6
    v_add_f32 v6, 1111490560, v17
    v_mul_f32 v6, v6, v5
    v_cos_f32 v232, v6
    v_sin_f32 v248, v6
    v_add_f32 v6, 1111752704, v17
    v_mul_f32 v6, v6, v5
    v_cos_f32 v233, v6
    v_sin_f32 v249, v6
    v_add_f32 v6, 1112014848, v17
    v_mul_f32 v6, v6, v5
    v_cos_f32 v234, v6
    v_sin_f32 v250, v6
    v_add_f32 v6, 1112276992, v17
    v_mul_f32 v6, v6, v5
    v_cos_f32 v235, v6
    v_sin_f32 v251, v6
    v_add_f32 v6, 1112539136, v17
    v_mul_f32 v6, v6, v5
    v_cos_f32 v236, v6
    v_sin_f32 v252, v6
    v_add_f32 v6, 1112801280, v17
    v_mul_f32 v6, v6, v5
    v_cos_f32 v237, v6
    v_sin_f32 v253, v6
    v_add_f32 v6, 1113063424, v17
    v_mul_f32 v6, v6, v5
    v_cos_f32 v238, v6
    v_sin_f32 v254, v6
    v_add_f32 v6, 1113325568, v17
    v_mul_f32 v6, v6, v5
    v_cos_f32 v239, v6
    v_sin_f32 v255, v6
    v_lshlrev_b32 v15, 4, v11
    v_lshl_add_u32 v15, v10, 11, v15
    v_lshlrev_b32 v18, 12, v11
    v_lshl_add_u32 v18, v10, 4, v18
    s_mul_i32 s32, s91, 133120
    s_lshl_b32 s17, s16, 9
    s_add_u32 s32, s32, s17
    s_add_u32 s32, s32, 104857600
    s_add_u32 s33, s32, 64
    s_lshl_b32 s31, s91, 2
    s_add_u32 s31, s31, s16
    s_lshl_b32 s34, s31, 15
    s_add_u32 s34, s34, 117440512
    s_mov_b32 s38, 0xffff0000
    s_mov_b32 s36, 0
    s_cmp_eq_u32 s31, 0
    s_cselect_b32 s37, 5, 4
    s_cselect_b32 s33, 1073741824, s33
    s_mov_b32 s35, 897581056
    s_cselect_b32 s35, 889192448, s35
    v_and_b32 v7, 3, v1
    v_lshlrev_b32 v7, 7, v7
    s_lshl_b32 s17, s91, 9
    s_add_u32 s17, s17, 100745216
    v_add_u32 v7, s17, v7
    s_mov_b32 s30, s92
F2_w:
    buffer_load_dword v5, v7, s[4:7], 0 offen sc1
    s_waitcnt vmcnt(0)
    v_cmp_gt_u32 vcc, 1, v5
    s_nop 0
    s_and_b32 s17, vcc_lo, 15
    s_cbranch_scc0 F2_w_ok
    s_cmp_ge_u32 s30, 1048576
    s_cselect_b32 s92, 1048576, s92
    s_cbranch_scc1 F2_w_ok
    s_add_u32 s30, s30, 1
    s_sleep 8
    s_branch F2_w
F2_w_ok:
F2_top:
    s_add_u32 s17, s32, 65536
    buffer_load_dwordx4 v[96:99], v15, s[4:7], s32 offen offset:0
    buffer_load_dwordx4 v[100:103], v15, s[4:7], s32 offen offset:32
    buffer_load_dwordx4 v[104:107], v15, s[4:7], s17 offen offset:0
    buffer_load_dwordx4 v[108:111], v15, s[4:7], s17 offen offset:32
    s_add_u32 s17, s33, 65536
    buffer_load_dwordx4 v[112:115], v15, s[4:7], s33 offen offset:0
    buffer_load_dwordx4 v[116:119], v15, s[4:7], s33 offen offset:32
    buffer_load_dwordx4 v[120:123], v15, s[4:7], s17 offen offset:0
    buffer_load_dwordx4 v[124:127], v15, s[4:7], s17 offen offset:32
    s_add_u32 s17, s34, 4096
    buffer_load_dwordx4 v[128:131], v14, s[4:7], s34 offen offset:0
    buffer_load_dwordx4 v[132:135], v14, s[4:7], s34 offen offset:1024
    buffer_load_dwordx4 v[136:139], v14, s[4:7], s34 offen offset:2048
    buffer_load_dwordx4 v[140:143], v14, s[4:7], s34 offen offset:3072
    buffer_load_dwordx4 v[144:147], v14, s[4:7], s17 offen offset:0
    buffer_load_dwordx4 v[148:151], v14, s[4:7], s17 offen offset:1024
    buffer_load_dwordx4 v[152:155], v14, s[4:7], s17 offen offset:2048
    buffer_load_dwordx4 v[156:159], v14, s[4:7], s17 offen offset:3072
    s_waitcnt vmcnt(8)
    v_mfma_f32_32x32x16_bf16 v[32:47], v[96:99], a[0:3], 0
    v_mfma_f32_32x32x16_bf16 v[48:63], v[112:115], a[0:3], 0
    v_mfma_f32_32x32x16_bf16 v[32:47], v[112:115], a[32:35], v[32:47]
    v_mfma_f32_32x32x16_bf16 v[48:63], v[96:99], a[64:67], v[48:63]
    v_mfma_f32_32x32x16_bf16 v[32:47], v[100:103], a[4:7], v[32:47]
    v_mfma_f32_32x32x16_bf16 v[48:63], v[116:119], a[4:7], v[48:63]
    v_mfma_f32_32x32x16_bf16 v[32:47], v[116:119], a[36:39], v[32:47]
    v_mfma_f32_32x32x16_bf16 v[48:63], v[100:103], a[68:71], v[48:63]
    v_mfma_f32_32x32x16_bf16 v[32:47], v[104:107], a[8:11], v[32:47]
    v_mfma_f32_32x32x16_bf16 v[48:63], v[120:123], a[8:11], v[48:63]
    v_mfma_f32_32x32x16_bf16 v[32:47], v[120:123], a[40:43], v[32:47]
    v_mfma_f32_32x32x16_bf16 v[48:63], v[104:107], a[72:75], v[48:63]
    v_mfma_f32_32x32x16_bf16 v[32:47], v[108:111], a[12:15], v[32:47]
    v_mfma_f32_32x32x16_bf16 v[48:63], v[124:127], a[12:15], v[48:63]
    v_mfma_f32_32x32x16_bf16 v[32:47], v[124:127], a[44:47], v[32:47]
    v_mfma_f32_32x32x16_bf16 v[48:63], v[108:111], a[76:79], v[48:63]
    v_mfma_f32_32x32x16_bf16 v[64:79], v[96:99], a[16:19], 0
    v_mfma_f32_32x32x16_bf16 v[80:95], v[112:115], a[16:19], 0
    v_mfma_f32_32x32x16_bf16 v[64:79], v[112:115], a[48:51], v[64:79]
    v_mfma_f32_32x32x16_bf16 v[80:95], v[96:99], a[80:83], v[80:95]
    v_mfma_f32_32x32x16_bf16 v[64:79], v[100:103], a[20:23], v[64:79]
    v_mfma_f32_32x32x16_bf16 v[80:95], v[116:119], a[20:23], v[80:95]
    v_mfma_f32_32x32x16_bf16 v[64:79], v[116:119], a[52:55], v[64:79]
    v_mfma_f32_32x32x16_bf16 v[80:95], v[100:103], a[84:87], v[80:95]
    v_mfma_f32_32x32x16_bf16 v[64:79], v[104:107], a[24:27], v[64:79]
    v_mfma_f32_32x32x16_bf16 v[80:95], v[120:123], a[24:27], v[80:95]
    v_mfma_f32_32x32x16_bf16 v[64:79], v[120:123], a[56:59], v[64:79]
    v_mfma_f32_32x32x16_bf16 v[80:95], v[104:107], a[88:91], v[80:95]
    v_mfma_f32_32x32x16_bf16 v[64:79], v[108:111], a[28:31], v[64:79]
    v_mfma_f32_32x32x16_bf16 v[80:95], v[124:127], a[28:31], v[80:95]
    v_mfma_f32_32x32x16_bf16 v[64:79], v[124:127], a[60:63], v[64:79]
    v_mfma_f32_32x32x16_bf16 v[80:95], v[108:111], a[92:95], v[80:95]
    v_mul_f32 v5, v32, v160
    v_mul_f32 v7, v48, v160
    v_fma_f32 v5, v48, v176, v5
    v_fma_f32 v7, -v32, v176, v7
    v_mul_f32 v6, v33, v161
    v_mul_f32 v8, v49, v161
    v_fma_f32 v6, v49, v177, v6
    v_fma_f32 v8, -v33, v177, v8
    v_cvt_pk_bf16_f32 v96, v5, v6
    v_cvt_pk_bf16_f32 v112, v7, v8
    v_mul_f32 v5, v34, v162
    v_mul_f32 v7, v50, v162
    v_fma_f32 v5, v50, v178, v5
    v_fma_f32 v7, -v34, v178, v7
    v_mul_f32 v6, v35, v163
    v_mul_f32 v8, v51, v163
    v_fma_f32 v6, v51, v179, v6
    v_fma_f32 v8, -v35, v179, v8
    v_cvt_pk_bf16_f32 v97, v5, v6
    v_cvt_pk_bf16_f32 v113, v7, v8
    v_mul_f32 v5, v36, v164
    v_mul_f32 v7, v52, v164
    v_fma_f32 v5, v52, v180, v5
    v_fma_f32 v7, -v36, v180, v7
    v_mul_f32 v6, v37, v165
    v_mul_f32 v8, v53, v165
    v_fma_f32 v6, v53, v181, v6
    v_fma_f32 v8, -v37, v181, v8
    v_cvt_pk_bf16_f32 v98, v5, v6
    v_cvt_pk_bf16_f32 v114, v7, v8
    v_mul_f32 v5, v38, v166
    v_mul_f32 v7, v54, v166
    v_fma_f32 v5, v54, v182, v5
    v_fma_f32 v7, -v38, v182, v7
    v_mul_f32 v6, v39, v167
    v_mul_f32 v8, v55, v167
    v_fma_f32 v6, v55, v183, v6
    v_fma_f32 v8, -v39, v183, v8
    v_cvt_pk_bf16_f32 v99, v5, v6
    v_cvt_pk_bf16_f32 v115, v7, v8
    v_mul_f32 v5, v40, v168
    v_mul_f32 v7, v56, v168
    v_fma_f32 v5, v56, v184, v5
    v_fma_f32 v7, -v40, v184, v7
    v_mul_f32 v6, v41, v169
    v_mul_f32 v8, v57, v169
    v_fma_f32 v6, v57, v185, v6
    v_fma_f32 v8, -v41, v185, v8
    v_cvt_pk_bf16_f32 v100, v5, v6
    v_cvt_pk_bf16_f32 v116, v7, v8
    v_mul_f32 v5, v42, v170
    v_mul_f32 v7, v58, v170
    v_fma_f32 v5, v58, v186, v5
    v_fma_f32 v7, -v42, v186, v7
    v_mul_f32 v6, v43, v171
    v_mul_f32 v8, v59, v171
    v_fma_f32 v6, v59, v187, v6
    v_fma_f32 v8, -v43, v187, v8
    v_cvt_pk_bf16_f32 v101, v5, v6
    v_cvt_pk_bf16_f32 v117, v7, v8
    v_mul_f32 v5, v44, v172
    v_mul_f32 v7, v60, v172
    v_fma_f32 v5, v60, v188, v5
    v_fma_f32 v7, -v44, v188, v7
    v_mul_f32 v6, v45, v173
    v_mul_f32 v8, v61, v173
    v_fma_f32 v6, v61, v189, v6
    v_fma_f32 v8, -v45, v189, v8
    v_cvt_pk_bf16_f32 v102, v5, v6
    v_cvt_pk_bf16_f32 v118, v7, v8
    v_mul_f32 v5, v46, v174
    v_mul_f32 v7, v62, v174
    v_fma_f32 v5, v62, v190, v5
    v_fma_f32 v7, -v46, v190, v7
    v_mul_f32 v6, v47, v175
    v_mul_f32 v8, v63, v175
    v_fma_f32 v6, v63, v191, v6
    v_fma_f32 v8, -v47, v191, v8
    v_cvt_pk_bf16_f32 v103, v5, v6
    v_cvt_pk_bf16_f32 v119, v7, v8
    v_mul_f32 v5, v64, v192
    v_mul_f32 v7, v80, v192
    v_fma_f32 v5, v80, v208, v5
    v_fma_f32 v7, -v64, v208, v7
    v_mul_f32 v6, v65, v193
    v_mul_f32 v8, v81, v193
    v_fma_f32 v6, v81, v209, v6
    v_fma_f32 v8, -v65, v209, v8
    v_cvt_pk_bf16_f32 v104, v5, v6
    v_cvt_pk_bf16_f32 v120, v7, v8
    v_mul_f32 v5, v66, v194
    v_mul_f32 v7, v82, v194
    v_fma_f32 v5, v82, v210, v5
    v_fma_f32 v7, -v66, v210, v7
    v_mul_f32 v6, v67, v195
    v_mul_f32 v8, v83, v195
    v_fma_f32 v6, v83, v211, v6
    v_fma_f32 v8, -v67, v211, v8
    v_cvt_pk_bf16_f32 v105, v5, v6
    v_cvt_pk_bf16_f32 v121, v7, v8
    v_mul_f32 v5, v68, v196
    v_mul_f32 v7, v84, v196
    v_fma_f32 v5, v84, v212, v5
    v_fma_f32 v7, -v68, v212, v7
    v_mul_f32 v6, v69, v197
    v_mul_f32 v8, v85, v197
    v_fma_f32 v6, v85, v213, v6
    v_fma_f32 v8, -v69, v213, v8
    v_cvt_pk_bf16_f32 v106, v5, v6
    v_cvt_pk_bf16_f32 v122, v7, v8
    v_mul_f32 v5, v70, v198
    v_mul_f32 v7, v86, v198
    v_fma_f32 v5, v86, v214, v5
    v_fma_f32 v7, -v70, v214, v7
    v_mul_f32 v6, v71, v199
    v_mul_f32 v8, v87, v199
    v_fma_f32 v6, v87, v215, v6
    v_fma_f32 v8, -v71, v215, v8
    v_cvt_pk_bf16_f32 v107, v5, v6
    v_cvt_pk_bf16_f32 v123, v7, v8
    v_mul_f32 v5, v72, v200
    v_mul_f32 v7, v88, v200
    v_fma_f32 v5, v88, v216, v5
    v_fma_f32 v7, -v72, v216, v7
    v_mul_f32 v6, v73, v201
    v_mul_f32 v8, v89, v201
    v_fma_f32 v6, v89, v217, v6
    v_fma_f32 v8, -v73, v217, v8
    v_cvt_pk_bf16_f32 v108, v5, v6
    v_cvt_pk_bf16_f32 v124, v7, v8
    v_mul_f32 v5, v74, v202
    v_mul_f32 v7, v90, v202
    v_fma_f32 v5, v90, v218, v5
    v_fma_f32 v7, -v74, v218, v7
    v_mul_f32 v6, v75, v203
    v_mul_f32 v8, v91, v203
    v_fma_f32 v6, v91, v219, v6
    v_fma_f32 v8, -v75, v219, v8
    v_cvt_pk_bf16_f32 v109, v5, v6
    v_cvt_pk_bf16_f32 v125, v7, v8
    v_mul_f32 v5, v76, v204
    v_mul_f32 v7, v92, v204
    v_fma_f32 v5, v92, v220, v5
    v_fma_f32 v7, -v76, v220, v7
    v_mul_f32 v6, v77, v205
    v_mul_f32 v8, v93, v205
    v_fma_f32 v6, v93, v221, v6
    v_fma_f32 v8, -v77, v221, v8
    v_cvt_pk_bf16_f32 v110, v5, v6
    v_cvt_pk_bf16_f32 v126, v7, v8
    v_mul_f32 v5, v78, v206
    v_mul_f32 v7, v94, v206
    v_fma_f32 v5, v94, v222, v5
    v_fma_f32 v7, -v78, v222, v7
    v_mul_f32 v6, v79, v207
    v_mul_f32 v8, v95, v207
    v_fma_f32 v6, v95, v223, v6
    v_fma_f32 v8, -v79, v223, v8
    v_cvt_pk_bf16_f32 v111, v5, v6
    v_cvt_pk_bf16_f32 v127, v7, v8
    v_mfma_f32_32x32x16_bf16 v[32:47], a[96:99], v[96:99], 0
    v_mfma_f32_32x32x16_bf16 v[48:63], a[96:99], v[112:115], 0
    v_mfma_f32_32x32x16_bf16 v[32:47], a[104:107], v[112:115], v[32:47]
    v_mfma_f32_32x32x16_bf16 v[48:63], a[112:115], v[96:99], v[48:63]
    v_mfma_f32_32x32x16_bf16 v[32:47], a[100:103], v[100:103], v[32:47]
    v_mfma_f32_32x32x16_bf16 v[48:63], a[100:103], v[116:119], v[48:63]
    v_mfma_f32_32x32x16_bf16 v[32:47], a[108:111], v[116:119], v[32:47]
    v_mfma_f32_32x32x16_bf16 v[48:63], a[116:119], v[100:103], v[48:63]
    v_mfma_f32_32x32x16_bf16 v[64:79], a[96:99], v[104:107], 0
    v_mfma_f32_32x32x16_bf16 v[80:95], a[96:99], v[120:123], 0
    v_mfma_f32_32x32x16_bf16 v[64:79], a[104:107], v[120:123], v[64:79]
    v_mfma_f32_32x32x16_bf16 v[80:95], a[112:115], v[104:107], v[80:95]
    v_mfma_f32_32x32x16_bf16 v[64:79], a[100:103], v[108:111], v[64:79]
    v_mfma_f32_32x32x16_bf16 v[80:95], a[100:103], v[124:127], v[80:95]
    v_mfma_f32_32x32x16_bf16 v[64:79], a[108:111], v[124:127], v[64:79]
    v_mfma_f32_32x32x16_bf16 v[80:95], a[116:119], v[108:111], v[80:95]
    s_waitcnt vmcnt(0)
    v_lshlrev_b32 v20, 16, v128
    v_and_b32 v22, s38, v128
    v_mul_f32 v5, v32, v20
    v_mul_f32 v7, v48, v20
    v_fma_f32 v5, -v48, v22, v5
    v_fma_f32 v7, v32, v22, v7
    v_lshlrev_b32 v21, 16, v129
    v_and_b32 v23, s38, v129
    v_mul_f32 v6, v33, v21
    v_mul_f32 v8, v49, v21
    v_fma_f32 v6, -v49, v23, v6
    v_fma_f32 v8, v33, v23, v8
    v_cvt_pk_bf16_f32 v96, v5, v6
    v_cvt_pk_bf16_f32 v112, v7, v8
    v_lshlrev_b32 v20, 16, v130
    v_and_b32 v22, s38, v130
    v_mul_f32 v5, v34, v20
    v_mul_f32 v7, v50, v20
    v_fma_f32 v5, -v50, v22, v5
    v_fma_f32 v7, v34, v22, v7
    v_lshlrev_b32 v21, 16, v131
    v_and_b32 v23, s38, v131
    v_mul_f32 v6, v35, v21
    v_mul_f32 v8, v51, v21
    v_fma_f32 v6, -v51, v23, v6
    v_fma_f32 v8, v35, v23, v8
    v_cvt_pk_bf16_f32 v97, v5, v6
    v_cvt_pk_bf16_f32 v113, v7, v8
    v_lshlrev_b32 v20, 16, v132
    v_and_b32 v22, s38, v132
    v_mul_f32 v5, v36, v20
    v_mul_f32 v7, v52, v20
    v_fma_f32 v5, -v52, v22, v5
    v_fma_f32 v7, v36, v22, v7
    v_lshlrev_b32 v21, 16, v133
    v_and_b32 v23, s38, v133
    v_mul_f32 v6, v37, v21
    v_mul_f32 v8, v53, v21
    v_fma_f32 v6, -v53, v23, v6
    v_fma_f32 v8, v37, v23, v8
    v_cvt_pk_bf16_f32 v98, v5, v6
    v_cvt_pk_bf16_f32 v114, v7, v8
    v_lshlrev_b32 v20, 16, v134
    v_and_b32 v22, s38, v134
    v_mul_f32 v5, v38, v20
    v_mul_f32 v7, v54, v20
    v_fma_f32 v5, -v54, v22, v5
    v_fma_f32 v7, v38, v22, v7
    v_lshlrev_b32 v21, 16, v135
    v_and_b32 v23, s38, v135
    v_mul_f32 v6, v39, v21
    v_mul_f32 v8, v55, v21
    v_fma_f32 v6, -v55, v23, v6
    v_fma_f32 v8, v39, v23, v8
    v_cvt_pk_bf16_f32 v99, v5, v6
    v_cvt_pk_bf16_f32 v115, v7, v8
    v_lshlrev_b32 v20, 16, v136
    v_and_b32 v22, s38, v136
    v_mul_f32 v5, v40, v20
    v_mul_f32 v7, v56, v20
    v_fma_f32 v5, -v56, v22, v5
    v_fma_f32 v7, v40, v22, v7
    v_lshlrev_b32 v21, 16, v137
    v_and_b32 v23, s38, v137
    v_mul_f32 v6, v41, v21
    v_mul_f32 v8, v57, v21
    v_fma_f32 v6, -v57, v23, v6
    v_fma_f32 v8, v41, v23, v8
    v_cvt_pk_bf16_f32 v100, v5, v6
    v_cvt_pk_bf16_f32 v116, v7, v8
    v_lshlrev_b32 v20, 16, v138
    v_and_b32 v22, s38, v138
    v_mul_f32 v5, v42, v20
    v_mul_f32 v7, v58, v20
    v_fma_f32 v5, -v58, v22, v5
    v_fma_f32 v7, v42, v22, v7
    v_lshlrev_b32 v21, 16, v139
    v_and_b32 v23, s38, v139
    v_mul_f32 v6, v43, v21
    v_mul_f32 v8, v59, v21
    v_fma_f32 v6, -v59, v23, v6
    v_fma_f32 v8, v43, v23, v8
    v_cvt_pk_bf16_f32 v101, v5, v6
    v_cvt_pk_bf16_f32 v117, v7, v8
    v_lshlrev_b32 v20, 16, v140
    v_and_b32 v22, s38, v140
    v_mul_f32 v5, v44, v20
    v_mul_f32 v7, v60, v20
    v_fma_f32 v5, -v60, v22, v5
    v_fma_f32 v7, v44, v22, v7
    v_lshlrev_b32 v21, 16, v141
    v_and_b32 v23, s38, v141
    v_mul_f32 v6, v45, v21
    v_mul_f32 v8, v61, v21
    v_fma_f32 v6, -v61, v23, v6
    v_fma_f32 v8, v45, v23, v8
    v_cvt_pk_bf16_f32 v102, v5, v6
    v_cvt_pk_bf16_f32 v118, v7, v8
    v_lshlrev_b32 v20, 16, v142
    v_and_b32 v22, s38, v142
    v_mul_f32 v5, v46, v20
    v_mul_f32 v7, v62, v20
    v_fma_f32 v5, -v62, v22, v5
    v_fma_f32 v7, v46, v22, v7
    v_lshlrev_b32 v21, 16, v143
    v_and_b32 v23, s38, v143
    v_mul_f32 v6, v47, v21
    v_mul_f32 v8, v63, v21
    v_fma_f32 v6, -v63, v23, v6
    v_fma_f32 v8, v47, v23, v8
    v_cvt_pk_bf16_f32 v103, v5, v6
    v_cvt_pk_bf16_f32 v119, v7, v8
    v_lshlrev_b32 v20, 16, v144
    v_and_b32 v22, s38, v144
    v_mul_f32 v5, v64, v20
    v_mul_f32 v7, v80, v20
    v_fma_f32 v5, -v80, v22, v5
    v_fma_f32 v7, v64, v22, v7
    v_lshlrev_b32 v21, 16, v145
    v_and_b32 v23, s38, v145
    v_mul_f32 v6, v65, v21
    v_mul_f32 v8, v81, v21
    v_fma_f32 v6, -v81, v23, v6
    v_fma_f32 v8, v65, v23, v8
    v_cvt_pk_bf16_f32 v104, v5, v6
    v_cvt_pk_bf16_f32 v120, v7, v8
    v_lshlrev_b32 v20, 16, v146
    v_and_b32 v22, s38, v146
    v_mul_f32 v5, v66, v20
    v_mul_f32 v7, v82, v20
    v_fma_f32 v5, -v82, v22, v5
    v_fma_f32 v7, v66, v22, v7
    v_lshlrev_b32 v21, 16, v147
    v_and_b32 v23, s38, v147
    v_mul_f32 v6, v67, v21
    v_mul_f32 v8, v83, v21
    v_fma_f32 v6, -v83, v23, v6
    v_fma_f32 v8, v67, v23, v8
    v_cvt_pk_bf16_f32 v105, v5, v6
    v_cvt_pk_bf16_f32 v121, v7, v8
    v_lshlrev_b32 v20, 16, v148
    v_and_b32 v22, s38, v148
    v_mul_f32 v5, v68, v20
    v_mul_f32 v7, v84, v20
    v_fma_f32 v5, -v84, v22, v5
    v_fma_f32 v7, v68, v22, v7
    v_lshlrev_b32 v21, 16, v149
    v_and_b32 v23, s38, v149
    v_mul_f32 v6, v69, v21
    v_mul_f32 v8, v85, v21
    v_fma_f32 v6, -v85, v23, v6
    v_fma_f32 v8, v69, v23, v8
    v_cvt_pk_bf16_f32 v106, v5, v6
    v_cvt_pk_bf16_f32 v122, v7, v8
    v_lshlrev_b32 v20, 16, v150
    v_and_b32 v22, s38, v150
    v_mul_f32 v5, v70, v20
    v_mul_f32 v7, v86, v20
    v_fma_f32 v5, -v86, v22, v5
    v_fma_f32 v7, v70, v22, v7
    v_lshlrev_b32 v21, 16, v151
    v_and_b32 v23, s38, v151
    v_mul_f32 v6, v71, v21
    v_mul_f32 v8, v87, v21
    v_fma_f32 v6, -v87, v23, v6
    v_fma_f32 v8, v71, v23, v8
    v_cvt_pk_bf16_f32 v107, v5, v6
    v_cvt_pk_bf16_f32 v123, v7, v8
    v_lshlrev_b32 v20, 16, v152
    v_and_b32 v22, s38, v152
    v_mul_f32 v5, v72, v20
    v_mul_f32 v7, v88, v20
    v_fma_f32 v5, -v88, v22, v5
    v_fma_f32 v7, v72, v22, v7
    v_lshlrev_b32 v21, 16, v153
    v_and_b32 v23, s38, v153
    v_mul_f32 v6, v73, v21
    v_mul_f32 v8, v89, v21
    v_fma_f32 v6, -v89, v23, v6
    v_fma_f32 v8, v73, v23, v8
    v_cvt_pk_bf16_f32 v108, v5, v6
    v_cvt_pk_bf16_f32 v124, v7, v8
    v_lshlrev_b32 v20, 16, v154
    v_and_b32 v22, s38, v154
    v_mul_f32 v5, v74, v20
    v_mul_f32 v7, v90, v20
    v_fma_f32 v5, -v90, v22, v5
    v_fma_f32 v7, v74, v22, v7
    v_lshlrev_b32 v21, 16, v155
    v_and_b32 v23, s38, v155
    v_mul_f32 v6, v75, v21
    v_mul_f32 v8, v91, v21
    v_fma_f32 v6, -v91, v23, v6
    v_fma_f32 v8, v75, v23, v8
    v_cvt_pk_bf16_f32 v109, v5, v6
    v_cvt_pk_bf16_f32 v125, v7, v8
    v_lshlrev_b32 v20, 16, v156
    v_and_b32 v22, s38, v156
    v_mul_f32 v5, v76, v20
    v_mul_f32 v7, v92, v20
    v_fma_f32 v5, -v92, v22, v5
    v_fma_f32 v7, v76, v22, v7
    v_lshlrev_b32 v21, 16, v157
    v_and_b32 v23, s38, v157
    v_mul_f32 v6, v77, v21
    v_mul_f32 v8, v93, v21
    v_fma_f32 v6, -v93, v23, v6
    v_fma_f32 v8, v77, v23, v8
    v_cvt_pk_bf16_f32 v110, v5, v6
    v_cvt_pk_bf16_f32 v126, v7, v8
    v_lshlrev_b32 v20, 16, v158
    v_and_b32 v22, s38, v158
    v_mul_f32 v5, v78, v20
    v_mul_f32 v7, v94, v20
    v_fma_f32 v5, -v94, v22, v5
    v_fma_f32 v7, v78, v22, v7
    v_lshlrev_b32 v21, 16, v159
    v_and_b32 v23, s38, v159
    v_mul_f32 v6, v79, v21
    v_mul_f32 v8, v95, v21
    v_fma_f32 v6, -v95, v23, v6
    v_fma_f32 v8, v79, v23, v8
    v_cvt_pk_bf16_f32 v111, v5, v6
    v_cvt_pk_bf16_f32 v127, v7, v8
    v_mfma_f32_32x32x16_bf16 v[32:47], v[96:99], a[96:99], 0
    v_mfma_f32_32x32x16_bf16 v[48:63], v[112:115], a[96:99], 0
    v_mfma_f32_32x32x16_bf16 v[32:47], v[112:115], a[112:115], v[32:47]
    v_mfma_f32_32x32x16_bf16 v[48:63], v[96:99], a[104:107], v[48:63]
    v_mfma_f32_32x32x16_bf16 v[32:47], v[100:103], a[100:103], v[32:47]
    v_mfma_f32_32x32x16_bf16 v[48:63], v[116:119], a[100:103], v[48:63]
    v_mfma_f32_32x32x16_bf16 v[32:47], v[116:119], a[116:119], v[32:47]
    v_mfma_f32_32x32x16_bf16 v[48:63], v[100:103], a[108:111], v[48:63]
    v_mfma_f32_32x32x16_bf16 v[64:79], v[104:107], a[96:99], 0
    v_mfma_f32_32x32x16_bf16 v[80:95], v[120:123], a[96:99], 0
    v_mfma_f32_32x32x16_bf16 v[64:79], v[120:123], a[112:115], v[64:79]
    v_mfma_f32_32x32x16_bf16 v[80:95], v[104:107], a[104:107], v[80:95]
    v_mfma_f32_32x32x16_bf16 v[64:79], v[108:111], a[100:103], v[64:79]
    v_mfma_f32_32x32x16_bf16 v[80:95], v[124:127], a[100:103], v[80:95]
    v_mfma_f32_32x32x16_bf16 v[64:79], v[124:127], a[116:119], v[64:79]
    v_mfma_f32_32x32x16_bf16 v[80:95], v[108:111], a[108:111], v[80:95]
    v_mul_f32 v5, v32, v160
    v_mul_f32 v7, v48, v160
    v_fma_f32 v5, -v48, v176, v5
    v_fma_f32 v7, v32, v176, v7
    v_mul_f32 v6, v33, v161
    v_mul_f32 v8, v49, v161
    v_fma_f32 v6, -v49, v177, v6
    v_fma_f32 v8, v33, v177, v8
    v_cvt_pk_bf16_f32 v96, v5, v6
    v_cvt_pk_bf16_f32 v112, v7, v8
    v_mul_f32 v5, v34, v162
    v_mul_f32 v7, v50, v162
    v_fma_f32 v5, -v50, v178, v5
    v_fma_f32 v7, v34, v178, v7
    v_mul_f32 v6, v35, v163
    v_mul_f32 v8, v51, v163
    v_fma_f32 v6, -v51, v179, v6
    v_fma_f32 v8, v35, v179, v8
    v_cvt_pk_bf16_f32 v97, v5, v6
    v_cvt_pk_bf16_f32 v113, v7, v8
    v_mul_f32 v5, v36, v164
    v_mul_f32 v7, v52, v164
    v_fma_f32 v5, -v52, v180, v5
    v_fma_f32 v7, v36, v180, v7
    v_mul_f32 v6, v37, v165
    v_mul_f32 v8, v53, v165
    v_fma_f32 v6, -v53, v181, v6
    v_fma_f32 v8, v37, v181, v8
    v_cvt_pk_bf16_f32 v98, v5, v6
    v_cvt_pk_bf16_f32 v114, v7, v8
    v_mul_f32 v5, v38, v166
    v_mul_f32 v7, v54, v166
    v_fma_f32 v5, -v54, v182, v5
    v_fma_f32 v7, v38, v182, v7
    v_mul_f32 v6, v39, v167
    v_mul_f32 v8, v55, v167
    v_fma_f32 v6, -v55, v183, v6
    v_fma_f32 v8, v39, v183, v8
    v_cvt_pk_bf16_f32 v99, v5, v6
    v_cvt_pk_bf16_f32 v115, v7, v8
    v_mul_f32 v5, v40, v168
    v_mul_f32 v7, v56, v168
    v_fma_f32 v5, -v56, v184, v5
    v_fma_f32 v7, v40, v184, v7
    v_mul_f32 v6, v41, v169
    v_mul_f32 v8, v57, v169
    v_fma_f32 v6, -v57, v185, v6
    v_fma_f32 v8, v41, v185, v8
    v_cvt_pk_bf16_f32 v100, v5, v6
    v_cvt_pk_bf16_f32 v116, v7, v8
    v_mul_f32 v5, v42, v170
    v_mul_f32 v7, v58, v170
    v_fma_f32 v5, -v58, v186, v5
    v_fma_f32 v7, v42, v186, v7
    v_mul_f32 v6, v43, v171
    v_mul_f32 v8, v59, v171
    v_fma_f32 v6, -v59, v187, v6
    v_fma_f32 v8, v43, v187, v8
    v_cvt_pk_bf16_f32 v101, v5, v6
    v_cvt_pk_bf16_f32 v117, v7, v8
    v_mul_f32 v5, v44, v172
    v_mul_f32 v7, v60, v172
    v_fma_f32 v5, -v60, v188, v5
    v_fma_f32 v7, v44, v188, v7
    v_mul_f32 v6, v45, v173
    v_mul_f32 v8, v61, v173
    v_fma_f32 v6, -v61, v189, v6
    v_fma_f32 v8, v45, v189, v8
    v_cvt_pk_bf16_f32 v102, v5, v6
    v_cvt_pk_bf16_f32 v118, v7, v8
    v_mul_f32 v5, v46, v174
    v_mul_f32 v7, v62, v174
    v_fma_f32 v5, -v62, v190, v5
    v_fma_f32 v7, v46, v190, v7
    v_mul_f32 v6, v47, v175
    v_mul_f32 v8, v63, v175
    v_fma_f32 v6, -v63, v191, v6
    v_fma_f32 v8, v47, v191, v8
    v_cvt_pk_bf16_f32 v103, v5, v6
    v_cvt_pk_bf16_f32 v119, v7, v8
    v_mul_f32 v5, v64, v224
    v_mul_f32 v7, v80, v224
    v_fma_f32 v5, -v80, v240, v5
    v_fma_f32 v7, v64, v240, v7
    v_mul_f32 v6, v65, v225
    v_mul_f32 v8, v81, v225
    v_fma_f32 v6, -v81, v241, v6
    v_fma_f32 v8, v65, v241, v8
    v_cvt_pk_bf16_f32 v104, v5, v6
    v_cvt_pk_bf16_f32 v120, v7, v8
    v_mul_f32 v5, v66, v226
    v_mul_f32 v7, v82, v226
    v_fma_f32 v5, -v82, v242, v5
    v_fma_f32 v7, v66, v242, v7
    v_mul_f32 v6, v67, v227
    v_mul_f32 v8, v83, v227
    v_fma_f32 v6, -v83, v243, v6
    v_fma_f32 v8, v67, v243, v8
    v_cvt_pk_bf16_f32 v105, v5, v6
    v_cvt_pk_bf16_f32 v121, v7, v8
    v_mul_f32 v5, v68, v228
    v_mul_f32 v7, v84, v228
    v_fma_f32 v5, -v84, v244, v5
    v_fma_f32 v7, v68, v244, v7
    v_mul_f32 v6, v69, v229
    v_mul_f32 v8, v85, v229
    v_fma_f32 v6, -v85, v245, v6
    v_fma_f32 v8, v69, v245, v8
    v_cvt_pk_bf16_f32 v106, v5, v6
    v_cvt_pk_bf16_f32 v122, v7, v8
    v_mul_f32 v5, v70, v230
    v_mul_f32 v7, v86, v230
    v_fma_f32 v5, -v86, v246, v5
    v_fma_f32 v7, v70, v246, v7
    v_mul_f32 v6, v71, v231
    v_mul_f32 v8, v87, v231
    v_fma_f32 v6, -v87, v247, v6
    v_fma_f32 v8, v71, v247, v8
    v_cvt_pk_bf16_f32 v107, v5, v6
    v_cvt_pk_bf16_f32 v123, v7, v8
    v_mul_f32 v5, v72, v232
    v_mul_f32 v7, v88, v232
    v_fma_f32 v5, -v88, v248, v5
    v_fma_f32 v7, v72, v248, v7
    v_mul_f32 v6, v73, v233
    v_mul_f32 v8, v89, v233
    v_fma_f32 v6, -v89, v249, v6
    v_fma_f32 v8, v73, v249, v8
    v_cvt_pk_bf16_f32 v108, v5, v6
    v_cvt_pk_bf16_f32 v124, v7, v8
    v_mul_f32 v5, v74, v234
    v_mul_f32 v7, v90, v234
    v_fma_f32 v5, -v90, v250, v5
    v_fma_f32 v7, v74, v250, v7
    v_mul_f32 v6, v75, v235
    v_mul_f32 v8, v91, v235
    v_fma_f32 v6, -v91, v251, v6
    v_fma_f32 v8, v75, v251, v8
    v_cvt_pk_bf16_f32 v109, v5, v6
    v_cvt_pk_bf16_f32 v125, v7, v8
    v_mul_f32 v5, v76, v236
    v_mul_f32 v7, v92, v236
    v_fma_f32 v5, -v92, v252, v5
    v_fma_f32 v7, v76, v252, v7
    v_mul_f32 v6, v77, v237
    v_mul_f32 v8, v93, v237
    v_fma_f32 v6, -v93, v253, v6
    v_fma_f32 v8, v77, v253, v8
    v_cvt_pk_bf16_f32 v110, v5, v6
    v_cvt_pk_bf16_f32 v126, v7, v8
    v_mul_f32 v5, v78, v238
    v_mul_f32 v7, v94, v238
    v_fma_f32 v5, -v94, v254, v5
    v_fma_f32 v7, v78, v254, v7
    v_mul_f32 v6, v79, v239
    v_mul_f32 v8, v95, v239
    v_fma_f32 v6, -v95, v255, v6
    v_fma_f32 v8, v79, v255, v8
    v_cvt_pk_bf16_f32 v111, v5, v6
    v_cvt_pk_bf16_f32 v127, v7, v8
    v_mfma_f32_32x32x16_bf16 v[32:47], a[0:3], v[96:99], 0
    v_mfma_f32_32x32x16_bf16 v[48:63], a[0:3], v[112:115], 0
    v_mfma_f32_32x32x16_bf16 v[32:47], a[64:67], v[112:115], v[32:47]
    v_mfma_f32_32x32x16_bf16 v[48:63], a[32:35], v[96:99], v[48:63]
    v_mfma_f32_32x32x16_bf16 v[32:47], a[4:7], v[100:103], v[32:47]
    v_mfma_f32_32x32x16_bf16 v[48:63], a[4:7], v[116:119], v[48:63]
    v_mfma_f32_32x32x16_bf16 v[32:47], a[68:71], v[116:119], v[32:47]
    v_mfma_f32_32x32x16_bf16 v[48:63], a[36:39], v[100:103], v[48:63]
    v_mfma_f32_32x32x16_bf16 v[32:47], a[8:11], v[104:107], v[32:47]
    v_mfma_f32_32x32x16_bf16 v[48:63], a[8:11], v[120:123], v[48:63]
    v_mfma_f32_32x32x16_bf16 v[32:47], a[72:75], v[120:123], v[32:47]
    v_mfma_f32_32x32x16_bf16 v[48:63], a[40:43], v[104:107], v[48:63]
    v_mfma_f32_32x32x16_bf16 v[32:47], a[12:15], v[108:111], v[32:47]
    v_mfma_f32_32x32x16_bf16 v[48:63], a[12:15], v[124:127], v[48:63]
    v_mfma_f32_32x32x16_bf16 v[32:47], a[76:79], v[124:127], v[32:47]
    v_mfma_f32_32x32x16_bf16 v[48:63], a[44:47], v[108:111], v[48:63]
    v_mfma_f32_32x32x16_bf16 v[64:79], a[16:19], v[96:99], 0
    v_mfma_f32_32x32x16_bf16 v[80:95], a[16:19], v[112:115], 0
    v_mfma_f32_32x32x16_bf16 v[64:79], a[80:83], v[112:115], v[64:79]
    v_mfma_f32_32x32x16_bf16 v[80:95], a[48:51], v[96:99], v[80:95]
    v_mfma_f32_32x32x16_bf16 v[64:79], a[20:23], v[100:103], v[64:79]
    v_mfma_f32_32x32x16_bf16 v[80:95], a[20:23], v[116:119], v[80:95]
    v_mfma_f32_32x32x16_bf16 v[64:79], a[84:87], v[116:119], v[64:79]
    v_mfma_f32_32x32x16_bf16 v[80:95], a[52:55], v[100:103], v[80:95]
    v_mfma_f32_32x32x16_bf16 v[64:79], a[24:27], v[104:107], v[64:79]
    v_mfma_f32_32x32x16_bf16 v[80:95], a[24:27], v[120:123], v[80:95]
    v_mfma_f32_32x32x16_bf16 v[64:79], a[88:91], v[120:123], v[64:79]
    v_mfma_f32_32x32x16_bf16 v[80:95], a[56:59], v[104:107], v[80:95]
    v_mfma_f32_32x32x16_bf16 v[64:79], a[28:31], v[108:111], v[64:79]
    v_mfma_f32_32x32x16_bf16 v[80:95], a[28:31], v[124:127], v[80:95]
    v_mfma_f32_32x32x16_bf16 v[64:79], a[92:95], v[124:127], v[64:79]
    v_mfma_f32_32x32x16_bf16 v[80:95], a[60:63], v[108:111], v[80:95]
    v_mul_f32 v32, s35, v32
    v_mul_f32 v48, s35, v48
    v_cvt_pk_bf16_f32 v128, v32, v48
    v_mul_f32 v33, s35, v33
    v_mul_f32 v49, s35, v49
    v_cvt_pk_bf16_f32 v129, v33, v49
    v_mul_f32 v34, s35, v34
    v_mul_f32 v50, s35, v50
    v_cvt_pk_bf16_f32 v130, v34, v50
    v_mul_f32 v35, s35, v35
    v_mul_f32 v51, s35, v51
    v_cvt_pk_bf16_f32 v131, v35, v51
    v_mul_f32 v36, s35, v36
    v_mul_f32 v52, s35, v52
    v_cvt_pk_bf16_f32 v132, v36, v52
    v_mul_f32 v37, s35, v37
    v_mul_f32 v53, s35, v53
    v_cvt_pk_bf16_f32 v133, v37, v53
    v_mul_f32 v38, s35, v38
    v_mul_f32 v54, s35, v54
    v_cvt_pk_bf16_f32 v134, v38, v54
    v_mul_f32 v39, s35, v39
    v_mul_f32 v55, s35, v55
    v_cvt_pk_bf16_f32 v135, v39, v55
    v_mul_f32 v40, s35, v40
    v_mul_f32 v56, s35, v56
    v_cvt_pk_bf16_f32 v136, v40, v56
    v_mul_f32 v41, s35, v41
    v_mul_f32 v57, s35, v57
    v_cvt_pk_bf16_f32 v137, v41, v57
    v_mul_f32 v42, s35, v42
    v_mul_f32 v58, s35, v58
    v_cvt_pk_bf16_f32 v138, v42, v58
    v_mul_f32 v43, s35, v43
    v_mul_f32 v59, s35, v59
    v_cvt_pk_bf16_f32 v139, v43, v59
    v_mul_f32 v44, s35, v44
    v_mul_f32 v60, s35, v60
    v_cvt_pk_bf16_f32 v140, v44, v60
    v_mul_f32 v45, s35, v45
    v_mul_f32 v61, s35, v61
    v_cvt_pk_bf16_f32 v141, v45, v61
    v_mul_f32 v46, s35, v46
    v_mul_f32 v62, s35, v62
    v_cvt_pk_bf16_f32 v142, v46, v62
    v_mul_f32 v47, s35, v47
    v_mul_f32 v63, s35, v63
    v_cvt_pk_bf16_f32 v143, v47, v63
    v_mul_f32 v64, s35, v64
    v_mul_f32 v80, s35, v80
    v_cvt_pk_bf16_f32 v144, v64, v80
    v_mul_f32 v65, s35, v65
    v_mul_f32 v81, s35, v81
    v_cvt_pk_bf16_f32 v145, v65, v81
    v_mul_f32 v66, s35, v66
    v_mul_f32 v82, s35, v82
    v_cvt_pk_bf16_f32 v146, v66, v82
    v_mul_f32 v67, s35, v67
    v_mul_f32 v83, s35, v83
    v_cvt_pk_bf16_f32 v147, v67, v83
    v_mul_f32 v68, s35, v68
    v_mul_f32 v84, s35, v84
    v_cvt_pk_bf16_f32 v148, v68, v84
    v_mul_f32 v69, s35, v69
    v_mul_f32 v85, s35, v85
    v_cvt_pk_bf16_f32 v149, v69, v85
    v_mul_f32 v70, s35, v70
    v_mul_f32 v86, s35, v86
    v_cvt_pk_bf16_f32 v150, v70, v86
    v_mul_f32 v71, s35, v71
    v_mul_f32 v87, s35, v87
    v_cvt_pk_bf16_f32 v151, v71, v87
    v_mul_f32 v72, s35, v72
    v_mul_f32 v88, s35, v88
    v_cvt_pk_bf16_f32 v152, v72, v88
    v_mul_f32 v73, s35, v73
    v_mul_f32 v89, s35, v89
    v_cvt_pk_bf16_f32 v153, v73, v89
    v_mul_f32 v74, s35, v74
    v_mul_f32 v90, s35, v90
    v_cvt_pk_bf16_f32 v154, v74, v90
    v_mul_f32 v75, s35, v75
    v_mul_f32 v91, s35, v91
    v_cvt_pk_bf16_f32 v155, v75, v91
    v_mul_f32 v76, s35, v76
    v_mul_f32 v92, s35, v92
    v_cvt_pk_bf16_f32 v156, v76, v92
    v_mul_f32 v77, s35, v77
    v_mul_f32 v93, s35, v93
    v_cvt_pk_bf16_f32 v157, v77, v93
    v_mul_f32 v78, s35, v78
    v_mul_f32 v94, s35, v94
    v_cvt_pk_bf16_f32 v158, v78, v94
    v_mul_f32 v79, s35, v79
    v_mul_f32 v95, s35, v95
    v_cvt_pk_bf16_f32 v159, v79, v95
    s_cmp_eq_u32 s36, 1
    s_cbranch_scc1 F2_o1
    s_cmp_eq_u32 s36, 2
    s_cbranch_scc1 F2_o2
    s_cmp_eq_u32 s36, 3
    s_cbranch_scc1 F2_o3
    s_cmp_eq_u32 s36, 4
    s_cbranch_scc1 F2_o4
    v_accvgpr_write_b32 a120, v128
    v_accvgpr_write_b32 a124, v129
    v_accvgpr_write_b32 a128, v130
    v_accvgpr_write_b32 a132, v131
    v_accvgpr_write_b32 a136, v132
    v_accvgpr_write_b32 a140, v133
    v_accvgpr_write_b32 a144, v134
    v_accvgpr_write_b32 a148, v135
    v_accvgpr_write_b32 a152, v136
    v_accvgpr_write_b32 a156, v137
    v_accvgpr_write_b32 a160, v138
    v_accvgpr_write_b32 a164, v139
    v_accvgpr_write_b32 a168, v140
    v_accvgpr_write_b32 a172, v141
    v_accvgpr_write_b32 a176, v142
    v_accvgpr_write_b32 a180, v143
    v_accvgpr_write_b32 a184, v144
    v_accvgpr_write_b32 a188, v145
    v_accvgpr_write_b32 a192, v146
    v_accvgpr_write_b32 a196, v147
    v_accvgpr_write_b32 a200, v148
    v_accvgpr_write_b32 a204, v149
    v_accvgpr_write_b32 a208, v150
    v_accvgpr_write_b32 a212, v151
    v_accvgpr_write_b32 a216, v152
    v_accvgpr_write_b32 a220, v153
    v_accvgpr_write_b32 a224, v154
    v_accvgpr_write_b32 a228, v155
    v_accvgpr_write_b32 a232, v156
    v_accvgpr_write_b32 a236, v157
    v_accvgpr_write_b32 a240, v158
    v_accvgpr_write_b32 a244, v159
    s_branch F2_nx
F2_o1:
    v_accvgpr_write_b32 a121, v128
    v_accvgpr_write_b32 a125, v129
    v_accvgpr_write_b32 a129, v130
    v_accvgpr_write_b32 a133, v131
    v_accvgpr_write_b32 a137, v132
    v_accvgpr_write_b32 a141, v133
    v_accvgpr_write_b32 a145, v134
    v_accvgpr_write_b32 a149, v135
    v_accvgpr_write_b32 a153, v136
    v_accvgpr_write_b32 a157, v137
    v_accvgpr_write_b32 a161, v138
    v_accvgpr_write_b32 a165, v139
    v_accvgpr_write_b32 a169, v140
    v_accvgpr_write_b32 a173, v141
    v_accvgpr_write_b32 a177, v142
    v_accvgpr_write_b32 a181, v143
    v_accvgpr_write_b32 a185, v144
    v_accvgpr_write_b32 a189, v145
    v_accvgpr_write_b32 a193, v146
    v_accvgpr_write_b32 a197, v147
    v_accvgpr_write_b32 a201, v148
    v_accvgpr_write_b32 a205, v149
    v_accvgpr_write_b32 a209, v150
    v_accvgpr_write_b32 a213, v151
    v_accvgpr_write_b32 a217, v152
    v_accvgpr_write_b32 a221, v153
    v_accvgpr_write_b32 a225, v154
    v_accvgpr_write_b32 a229, v155
    v_accvgpr_write_b32 a233, v156
    v_accvgpr_write_b32 a237, v157
    v_accvgpr_write_b32 a241, v158
    v_accvgpr_write_b32 a245, v159
    s_branch F2_nx
F2_o2:
    v_accvgpr_write_b32 a122, v128
    v_accvgpr_write_b32 a126, v129
    v_accvgpr_write_b32 a130, v130
    v_accvgpr_write_b32 a134, v131
    v_accvgpr_write_b32 a138, v132
    v_accvgpr_write_b32 a142, v133
    v_accvgpr_write_b32 a146, v134
    v_accvgpr_write_b32 a150, v135
    v_accvgpr_write_b32 a154, v136
    v_accvgpr_write_b32 a158, v137
    v_accvgpr_write_b32 a162, v138
    v_accvgpr_write_b32 a166, v139
    v_accvgpr_write_b32 a170, v140
    v_accvgpr_write_b32 a174, v141
    v_accvgpr_write_b32 a178, v142
    v_accvgpr_write_b32 a182, v143
    v_accvgpr_write_b32 a186, v144
    v_accvgpr_write_b32 a190, v145
    v_accvgpr_write_b32 a194, v146
    v_accvgpr_write_b32 a198, v147
    v_accvgpr_write_b32 a202, v148
    v_accvgpr_write_b32 a206, v149
    v_accvgpr_write_b32 a210, v150
    v_accvgpr_write_b32 a214, v151
    v_accvgpr_write_b32 a218, v152
    v_accvgpr_write_b32 a222, v153
    v_accvgpr_write_b32 a226, v154
    v_accvgpr_write_b32 a230, v155
    v_accvgpr_write_b32 a234, v156
    v_accvgpr_write_b32 a238, v157
    v_accvgpr_write_b32 a242, v158
    v_accvgpr_write_b32 a246, v159
    s_branch F2_nx
F2_o3:
    v_accvgpr_write_b32 a123, v128
    v_accvgpr_write_b32 a127, v129
    v_accvgpr_write_b32 a131, v130
    v_accvgpr_write_b32 a135, v131
    v_accvgpr_write_b32 a139, v132
    v_accvgpr_write_b32 a143, v133
    v_accvgpr_write_b32 a147, v134
    v_accvgpr_write_b32 a151, v135
    v_accvgpr_write_b32 a155, v136
    v_accvgpr_write_b32 a159, v137
    v_accvgpr_write_b32 a163, v138
    v_accvgpr_write_b32 a167, v139
    v_accvgpr_write_b32 a171, v140
    v_accvgpr_write_b32 a175, v141
    v_accvgpr_write_b32 a179, v142
    v_accvgpr_write_b32 a183, v143
    v_accvgpr_write_b32 a187, v144
    v_accvgpr_write_b32 a191, v145
    v_accvgpr_write_b32 a195, v146
    v_accvgpr_write_b32 a199, v147
    v_accvgpr_write_b32 a203, v148
    v_accvgpr_write_b32 a207, v149
    v_accvgpr_write_b32 a211, v150
    v_accvgpr_write_b32 a215, v151
    v_accvgpr_write_b32 a219, v152
    v_accvgpr_write_b32 a223, v153
    v_accvgpr_write_b32 a227, v154
    v_accvgpr_write_b32 a231, v155
    v_accvgpr_write_b32 a235, v156
    v_accvgpr_write_b32 a239, v157
    v_accvgpr_write_b32 a243, v158
    v_accvgpr_write_b32 a247, v159
    s_branch F2_nx
F2_o4:
    v_accvgpr_read_b32 v5, a120
    v_lshlrev_b32 v6, 16, v128
    v_bfi_b32 v5, s38, v6, v5
    v_accvgpr_write_b32 a120, v5
    v_accvgpr_read_b32 v5, a124
    v_lshlrev_b32 v6, 16, v129
    v_bfi_b32 v5, s38, v6, v5
    v_accvgpr_write_b32 a124, v5
    v_accvgpr_read_b32 v5, a128
    v_lshlrev_b32 v6, 16, v130
    v_bfi_b32 v5, s38, v6, v5
    v_accvgpr_write_b32 a128, v5
    v_accvgpr_read_b32 v5, a132
    v_lshlrev_b32 v6, 16, v131
    v_bfi_b32 v5, s38, v6, v5
    v_accvgpr_write_b32 a132, v5
    v_accvgpr_read_b32 v5, a136
    v_lshlrev_b32 v6, 16, v132
    v_bfi_b32 v5, s38, v6, v5
    v_accvgpr_write_b32 a136, v5
    v_accvgpr_read_b32 v5, a140
    v_lshlrev_b32 v6, 16, v133
    v_bfi_b32 v5, s38, v6, v5
    v_accvgpr_write_b32 a140, v5
    v_accvgpr_read_b32 v5, a144
    v_lshlrev_b32 v6, 16, v134
    v_bfi_b32 v5, s38, v6, v5
    v_accvgpr_write_b32 a144, v5
    v_accvgpr_read_b32 v5, a148
    v_lshlrev_b32 v6, 16, v135
    v_bfi_b32 v5, s38, v6, v5
    v_accvgpr_write_b32 a148, v5
    v_accvgpr_read_b32 v5, a152
    v_lshlrev_b32 v6, 16, v136
    v_bfi_b32 v5, s38, v6, v5
    v_accvgpr_write_b32 a152, v5
    v_accvgpr_read_b32 v5, a156
    v_lshlrev_b32 v6, 16, v137
    v_bfi_b32 v5, s38, v6, v5
    v_accvgpr_write_b32 a156, v5
    v_accvgpr_read_b32 v5, a160
    v_lshlrev_b32 v6, 16, v138
    v_bfi_b32 v5, s38, v6, v5
    v_accvgpr_write_b32 a160, v5
    v_accvgpr_read_b32 v5, a164
    v_lshlrev_b32 v6, 16, v139
    v_bfi_b32 v5, s38, v6, v5
    v_accvgpr_write_b32 a164, v5
    v_accvgpr_read_b32 v5, a168
    v_lshlrev_b32 v6, 16, v140
    v_bfi_b32 v5, s38, v6, v5
    v_accvgpr_write_b32 a168, v5
    v_accvgpr_read_b32 v5, a172
    v_lshlrev_b32 v6, 16, v141
    v_bfi_b32 v5, s38, v6, v5
    v_accvgpr_write_b32 a172, v5
    v_accvgpr_read_b32 v5, a176
    v_lshlrev_b32 v6, 16, v142
    v_bfi_b32 v5, s38, v6, v5
    v_accvgpr_write_b32 a176, v5
    v_accvgpr_read_b32 v5, a180
    v_lshlrev_b32 v6, 16, v143
    v_bfi_b32 v5, s38, v6, v5
    v_accvgpr_write_b32 a180, v5
    v_accvgpr_read_b32 v5, a184
    v_lshlrev_b32 v6, 16, v144
    v_bfi_b32 v5, s38, v6, v5
    v_accvgpr_write_b32 a184, v5
    v_accvgpr_read_b32 v5, a188
    v_lshlrev_b32 v6, 16, v145
    v_bfi_b32 v5, s38, v6, v5
    v_accvgpr_write_b32 a188, v5
    v_accvgpr_read_b32 v5, a192
    v_lshlrev_b32 v6, 16, v146
    v_bfi_b32 v5, s38, v6, v5
    v_accvgpr_write_b32 a192, v5
    v_accvgpr_read_b32 v5, a196
    v_lshlrev_b32 v6, 16, v147
    v_bfi_b32 v5, s38, v6, v5
    v_accvgpr_write_b32 a196, v5
    v_accvgpr_read_b32 v5, a200
    v_lshlrev_b32 v6, 16, v148
    v_bfi_b32 v5, s38, v6, v5
    v_accvgpr_write_b32 a200, v5
    v_accvgpr_read_b32 v5, a204
    v_lshlrev_b32 v6, 16, v149
    v_bfi_b32 v5, s38, v6, v5
    v_accvgpr_write_b32 a204, v5
    v_accvgpr_read_b32 v5, a208
    v_lshlrev_b32 v6, 16, v150
    v_bfi_b32 v5, s38, v6, v5
    v_accvgpr_write_b32 a208, v5
    v_accvgpr_read_b32 v5, a212
    v_lshlrev_b32 v6, 16, v151
    v_bfi_b32 v5, s38, v6, v5
    v_accvgpr_write_b32 a212, v5
    v_accvgpr_read_b32 v5, a216
    v_lshlrev_b32 v6, 16, v152
    v_bfi_b32 v5, s38, v6, v5
    v_accvgpr_write_b32 a216, v5
    v_accvgpr_read_b32 v5, a220
    v_lshlrev_b32 v6, 16, v153
    v_bfi_b32 v5, s38, v6, v5
    v_accvgpr_write_b32 a220, v5
    v_accvgpr_read_b32 v5, a224
    v_lshlrev_b32 v6, 16, v154
    v_bfi_b32 v5, s38, v6, v5
    v_accvgpr_write_b32 a224, v5
    v_accvgpr_read_b32 v5, a228
    v_lshlrev_b32 v6, 16, v155
    v_bfi_b32 v5, s38, v6, v5
    v_accvgpr_write_b32 a228, v5
    v_accvgpr_read_b32 v5, a232
    v_lshlrev_b32 v6, 16, v156
    v_bfi_b32 v5, s38, v6, v5
    v_accvgpr_write_b32 a232, v5
    v_accvgpr_read_b32 v5, a236
    v_lshlrev_b32 v6, 16, v157
    v_bfi_b32 v5, s38, v6, v5
    v_accvgpr_write_b32 a236, v5
    v_accvgpr_read_b32 v5, a240
    v_lshlrev_b32 v6, 16, v158
    v_bfi_b32 v5, s38, v6, v5
    v_accvgpr_write_b32 a240, v5
    v_accvgpr_read_b32 v5, a244
    v_lshlrev_b32 v6, 16, v159
    v_bfi_b32 v5, s38, v6, v5
    v_accvgpr_write_b32 a244, v5
F2_nx:
    s_add_u32 s36, s36, 1
    s_add_u32 s32, s32, 128
    s_add_u32 s33, s32, 64
    s_add_u32 s34, s34, 8192
    s_mov_b32 s35, 897581056
    s_cmp_eq_u32 s36, 4
    s_cselect_b32 s32, 104857664, s32
    s_cselect_b32 s33, 1073741824, s33
    s_cselect_b32 s34, 121634816, s34
    s_cselect_b32 s35, 889192448, s35
    s_cmp_lt_u32 s36, s37
    s_cbranch_scc1 F2_top
    s_mul_i32 s21, s31, 33024
    s_add_u32 s21, s21, 111149056
    s_add_u32 s17, s21, 0
    buffer_store_dwordx4 a[120:123], v18, s[4:7], s17 offen offset:0 sc1
    buffer_store_dwordx4 a[124:127], v18, s[4:7], s17 offen offset:512 sc1
    buffer_store_dwordx4 a[128:131], v18, s[4:7], s17 offen offset:1024 sc1
    buffer_store_dwordx4 a[132:135], v18, s[4:7], s17 offen offset:1536 sc1
    buffer_store_dwordx4 a[136:139], v18, s[4:7], s17 offen offset:2048 sc1
    buffer_store_dwordx4 a[140:143], v18, s[4:7], s17 offen offset:2560 sc1
    buffer_store_dwordx4 a[144:147], v18, s[4:7], s17 offen offset:3072 sc1
    buffer_store_dwordx4 a[148:151], v18, s[4:7], s17 offen offset:3584 sc1
    s_add_u32 s17, s21, 8192
    buffer_store_dwordx4 a[152:155], v18, s[4:7], s17 offen offset:0 sc1
    buffer_store_dwordx4 a[156:159], v18, s[4:7], s17 offen offset:512 sc1
    buffer_store_dwordx4 a[160:163], v18, s[4:7], s17 offen offset:1024 sc1
    buffer_store_dwordx4 a[164:167], v18, s[4:7], s17 offen offset:1536 sc1
    buffer_store_dwordx4 a[168:171], v18, s[4:7], s17 offen offset:2048 sc1
    buffer_store_dwordx4 a[172:175], v18, s[4:7], s17 offen offset:2560 sc1
    buffer_store_dwordx4 a[176:179], v18, s[4:7], s17 offen offset:3072 sc1
    buffer_store_dwordx4 a[180:183], v18, s[4:7], s17 offen offset:3584 sc1
    s_add_u32 s17, s21, 16384
    buffer_store_dwordx4 a[184:187], v18, s[4:7], s17 offen offset:0 sc1
    buffer_store_dwordx4 a[188:191], v18, s[4:7], s17 offen offset:512 sc1
    buffer_store_dwordx4 a[192:195], v18, s[4:7], s17 offen offset:1024 sc1
    buffer_store_dwordx4 a[196:199], v18, s[4:7], s17 offen offset:1536 sc1
    buffer_store_dwordx4 a[200:203], v18, s[4:7], s17 offen offset:2048 sc1
    buffer_store_dwordx4 a[204:207], v18, s[4:7], s17 offen offset:2560 sc1
    buffer_store_dwordx4 a[208:211], v18, s[4:7], s17 offen offset:3072 sc1
    buffer_store_dwordx4 a[212:215], v18, s[4:7], s17 offen offset:3584 sc1
    s_add_u32 s17, s21, 24576
    buffer_store_dwordx4 a[216:219], v18, s[4:7], s17 offen offset:0 sc1
    buffer_store_dwordx4 a[220:223], v18, s[4:7], s17 offen offset:512 sc1
    buffer_store_dwordx4 a[224:227], v18, s[4:7], s17 offen offset:1024 sc1
    buffer_store_dwordx4 a[228:231], v18, s[4:7], s17 offen offset:1536 sc1
    buffer_store_dwordx4 a[232:235], v18, s[4:7], s17 offen offset:2048 sc1
    buffer_store_dwordx4 a[236:239], v18, s[4:7], s17 offen offset:2560 sc1
    buffer_store_dwordx4 a[240:243], v18, s[4:7], s17 offen offset:3072 sc1
    buffer_store_dwordx4 a[244:247], v18, s[4:7], s17 offen offset:3584 sc1
    s_waitcnt vmcnt(0)
    s_lshl_b32 s17, s31, 7
    s_add_u32 s17, s17, 100761600
    v_lshl_add_u32 v5, v1, 2, s17
    v_mov_b32 v6, 1
    s_mov_b64 exec, 0xffffffff
    buffer_store_dword v6, v5, s[4:7], 0 offen sc1
    s_mov_b64 exec, -1
    v_bfe_u32 v5, v1, 2, 2
    v_and_b32 v7, 3, v1
    v_lshl_add_u32 v7, v5, 3, v7
    s_lshl_b32 s17, s29, 5
    v_add_u32 v7, s17, v7
    v_lshrrev_b32 v8, 4, v1
    v_cvt_f32_u32 v8, v8
    s_mov_b32 s31, 981467136
    v_and_b32 v38, 1, v7
    v_add_u32 v5, 0, v7
    v_cvt_f32_u32 v6, v5
    v_mul_f32 v6, s31, v6
    v_mov_b32 v32, 0x3e800000
    v_sub_f32 v34, v6, v32
    v_mul_f32 v36, 0x41800000, v6
    v_mul_f32 v5, 4.0, v6
    v_mul_f32 v30, v5, v8
    v_add_u32 v5, 4, v7
    v_cvt_f32_u32 v6, v5
    v_mul_f32 v6, s31, v6
    v_mov_b32 v33, 0x3e800000
    v_sub_f32 v35, v6, v33
    v_mul_f32 v37, 0x41800000, v6
    v_mul_f32 v5, 4.0, v6
    v_mul_f32 v31, v5, v8
    v_lshlrev_b32 v8, 4, v1
    s_lshl_b32 s18, s16, 15
    v_add_u32 v8, s18, v8
    v_mov_b32 v7, v8
    s_mov_b32 s22, 0
F3_g0:
    v_fract_f32 v40, v30
    v_add_f32 v41, v40, v32
    v_add_f32 v42, v41, v34
    v_add_f32 v43, v42, v32
    v_add_f32 v44, v43, v34
    v_add_f32 v45, v44, v32
    v_add_f32 v46, v45, v34
    v_add_f32 v47, v46, v32
    v_add_f32 v30, v40, v36
    v_cos_f32 v48, v40
    v_cos_f32 v49, v41
    v_cos_f32 v50, v42
    v_cos_f32 v51, v43
    v_cos_f32 v52, v44
    v_cos_f32 v53, v45
    v_cos_f32 v54, v46
    v_cos_f32 v55, v47
    v_cvt_pk_bf16_f32 v56, v48, v49
    v_cvt_pk_bf16_f32 v57, v50, v51
    v_cvt_pk_bf16_f32 v58, v52, v53
    v_cvt_pk_bf16_f32 v59, v54, v55
    ds_write_b128 v7, v[56:59] offset:0
    v_fract_f32 v40, v31
    v_add_f32 v41, v40, v33
    v_add_f32 v42, v41, v35
    v_add_f32 v43, v42, v33
    v_add_f32 v44, v43, v35
    v_add_f32 v45, v44, v33
    v_add_f32 v46, v45, v35
    v_add_f32 v47, v46, v33
    v_add_f32 v31, v40, v37
    v_cos_f32 v48, v40
    v_cos_f32 v49, v41
    v_cos_f32 v50, v42
    v_cos_f32 v51, v43
    v_cos_f32 v52, v44
    v_cos_f32 v53, v45
    v_cos_f32 v54, v46
    v_cos_f32 v55, v47
    v_cvt_pk_bf16_f32 v60, v48, v49
    v_cvt_pk_bf16_f32 v61, v50, v51
    v_cvt_pk_bf16_f32 v62, v52, v53
    v_cvt_pk_bf16_f32 v63, v54, v55
    ds_write_b128 v7, v[60:63] offset:1024
    v_add_u32 v7, 2048, v7
    s_add_u32 s22, s22, 1
    s_cmp_lt_u32 s22, 16
    s_waitcnt lgkmcnt(0)
    s_cbranch_scc1 F3_g0
    ds_read_b128 a[0:3], v8 offset:0
    ds_read_b128 a[4:7], v8 offset:1024
    ds_read_b128 a[8:11], v8 offset:2048
    ds_read_b128 a[12:15], v8 offset:3072
    ds_read_b128 a[16:19], v8 offset:4096
    ds_read_b128 a[20:23], v8 offset:5120
    ds_read_b128 a[24:27], v8 offset:6144
    ds_read_b128 a[28:31], v8 offset:7168
    s_waitcnt lgkmcnt(7)
    ds_read_b128 a[32:35], v8 offset:8192
    ds_read_b128 a[36:39], v8 offset:9216
    ds_read_b128 a[40:43], v8 offset:10240
    ds_read_b128 a[44:47], v8 offset:11264
    ds_read_b128 a[48:51], v8 offset:12288
    ds_read_b128 a[52:55], v8 offset:13312
    ds_read_b128 a[56:59], v8 offset:14336
    ds_read_b128 a[60:63], v8 offset:15360
    s_waitcnt lgkmcnt(7)
    ds_read_b128 a[64:67], v8 offset:16384
    ds_read_b128 a[68:71], v8 offset:17408
    ds_read_b128 a[72:75], v8 offset:18432
    ds_read_b128 a[76:79], v8 offset:19456
    ds_read_b128 a[80:83], v8 offset:20480
    ds_read_b128 a[84:87], v8 offset:21504
    ds_read_b128 a[88:91], v8 offset:22528
    ds_read_b128 a[92:95], v8 offset:23552
    s_waitcnt lgkmcnt(7)
    ds_read_b128 a[96:99], v8 offset:24576
    ds_read_b128 a[100:103], v8 offset:25600
    ds_read_b128 a[104:107], v8 offset:26624
    ds_read_b128 a[108:111], v8 offset:27648
    ds_read_b128 a[112:115], v8 offset:28672
    ds_read_b128 a[116:119], v8 offset:29696
    ds_read_b128 a[120:123], v8 offset:30720
    ds_read_b128 a[124:127], v8 offset:31744
    s_waitcnt lgkmcnt(7)
    s_waitcnt lgkmcnt(0)
    v_mov_b32 v7, v8
    s_mov_b32 s22, 0
F3_g1:
    v_fract_f32 v40, v30
    v_add_f32 v41, v40, v32
    v_add_f32 v42, v41, v34
    v_add_f32 v43, v42, v32
    v_add_f32 v44, v43, v34
    v_add_f32 v45, v44, v32
    v_add_f32 v46, v45, v34
    v_add_f32 v47, v46, v32
    v_add_f32 v30, v40, v36
    v_cos_f32 v48, v40
    v_cos_f32 v49, v41
    v_cos_f32 v50, v42
    v_cos_f32 v51, v43
    v_cos_f32 v52, v44
    v_cos_f32 v53, v45
    v_cos_f32 v54, v46
    v_cos_f32 v55, v47
    v_cvt_pk_bf16_f32 v56, v48, v49
    v_cvt_pk_bf16_f32 v57, v50, v51
    v_cvt_pk_bf16_f32 v58, v52, v53
    v_cvt_pk_bf16_f32 v59, v54, v55
    ds_write_b128 v7, v[56:59] offset:0
    v_fract_f32 v40, v31
    v_add_f32 v41, v40, v33
    v_add_f32 v42, v41, v35
    v_add_f32 v43, v42, v33
    v_add_f32 v44, v43, v35
    v_add_f32 v45, v44, v33
    v_add_f32 v46, v45, v35
    v_add_f32 v47, v46, v33
    v_add_f32 v31, v40, v37
    v_cos_f32 v48, v40
    v_cos_f32 v49, v41
    v_cos_f32 v50, v42
    v_cos_f32 v51, v43
    v_cos_f32 v52, v44
    v_cos_f32 v53, v45
    v_cos_f32 v54, v46
    v_cos_f32 v55, v47
    v_cvt_pk_bf16_f32 v60, v48, v49
    v_cvt_pk_bf16_f32 v61, v50, v51
    v_cvt_pk_bf16_f32 v62, v52, v53
    v_cvt_pk_bf16_f32 v63, v54, v55
    ds_write_b128 v7, v[60:63] offset:1024
    v_add_u32 v7, 2048, v7
    s_add_u32 s22, s22, 1
    s_cmp_lt_u32 s22, 16
    s_waitcnt lgkmcnt(0)
    s_cbranch_scc1 F3_g1
    ds_read_b128 a[128:131], v8 offset:0
    ds_read_b128 a[132:135], v8 offset:1024
    ds_read_b128 a[136:139], v8 offset:2048
    ds_read_b128 a[140:143], v8 offset:3072
    ds_read_b128 a[144:147], v8 offset:4096
    ds_read_b128 a[148:151], v8 offset:5120
    ds_read_b128 a[152:155], v8 offset:6144
    ds_read_b128 a[156:159], v8 offset:7168
    s_waitcnt lgkmcnt(7)
    ds_read_b128 a[160:163], v8 offset:8192
    ds_read_b128 a[164:167], v8 offset:9216
    ds_read_b128 a[168:171], v8 offset:10240
    ds_read_b128 a[172:175], v8 offset:11264
    ds_read_b128 a[176:179], v8 offset:12288
    ds_read_b128 a[180:183], v8 offset:13312
    ds_read_b128 a[184:187], v8 offset:14336
    ds_read_b128 a[188:191], v8 offset:15360
    s_waitcnt lgkmcnt(7)
    ds_read_b128 a[192:195], v8 offset:16384
    ds_read_b128 a[196:199], v8 offset:17408
    ds_read_b128 a[200:203], v8 offset:18432
    ds_read_b128 a[204:207], v8 offset:19456
    ds_read_b128 a[208:211], v8 offset:20480
    ds_read_b128 a[212:215], v8 offset:21504
    ds_read_b128 a[216:219], v8 offset:22528
    ds_read_b128 a[220:223], v8 offset:23552
    s_waitcnt lgkmcnt(7)
    ds_read_b128 a[224:227], v8 offset:24576
    ds_read_b128 a[228:231], v8 offset:25600
    ds_read_b128 a[232:235], v8 offset:26624
    ds_read_b128 a[236:239], v8 offset:27648
    ds_read_b128 a[240:243], v8 offset:28672
    ds_read_b128 a[244:247], v8 offset:29696
    ds_read_b128 a[248:251], v8 offset:30720
    ds_read_b128 a[252:255], v8 offset:31744
    s_waitcnt lgkmcnt(7)
    s_waitcnt lgkmcnt(0)
    v_lshlrev_b32 v6, 31, v38
    v_or_b32 v6, 0x3f803f80, v6
    v_cmp_gt_u32 vcc, 16, v1
    v_accvgpr_read_b32 v5, a0
    s_nop 0
    v_cndmask_b32 v5, v5, v6, vcc
    v_accvgpr_write_b32 a0, v5
    v_accvgpr_read_b32 v5, a4
    v_cndmask_b32 v5, v5, v6, vcc
    v_accvgpr_write_b32 a4, v5
    v_and_b32 v5, 15, v1
    v_lshrrev_b32 v6, 4, v1
    v_lshlrev_b32 v5, 4, v5
    v_lshl_add_u32 v10, v6, 9, v5
    v_add_u32 v11, 2048, v10
    v_add_u32 v12, 0x10000, v10
    v_add_u32 v13, 0x10000, v11
    s_lshl_b32 s19, s16, 10
    s_lshl_b32 s17, s16, 1
    v_lshrrev_b32 v8, 5, v1
    v_add_u32 v8, s17, v8
    v_and_b32 v7, 31, v1
    v_mul_u32_u24 v2, 33024, v8
    v_lshl_add_u32 v2, v7, 4, v2
    v_and_b32 v3, 15, v1
    v_and_b32 v5, 48, v1
    v_lshl_add_u32 v3, v3, 12, v5
    v_add_u32 v4, 0x10000, v3
    s_lshl_b32 s21, s28, 21
    s_lshl_b32 s17, s29, 6
    s_add_u32 s21, s21, s17
    s_lshl_b32 s20, s28, 13
    s_add_u32 s20, s20, 111149056
    s_mov_b32 s24, 512
    s_mov_b32 s25, 131072
    v_and_b32 v7, 31, v1
    v_lshlrev_b32 v7, 7, v7
    s_lshl_b32 s17, s16, 12
    s_add_u32 s17, s17, 100761600
    v_add_u32 v7, s17, v7
    s_mov_b32 s30, s92
F3_w0:
    buffer_load_dword v5, v7, s[4:7], 0 offen sc1
    s_waitcnt vmcnt(0)
    v_cmp_gt_u32 vcc, 1, v5
    s_nop 0
    s_cmp_lg_u64 vcc, 0
    s_cbranch_scc0 F3_w0_ok
    s_cmp_ge_u32 s30, 1048576
    s_cselect_b32 s92, 1048576, s92
    s_cbranch_scc1 F3_w0_ok
    s_add_u32 s30, s30, 1
    s_sleep 8
    s_branch F3_w0
F3_w0_ok:
    s_barrier
    s_mov_b32 s26, s25
    s_sub_u32 s25, s21, 1073741824
    s_mov_b32 s21, 1073741824
    s_mov_b32 s23, 0
    s_mov_b32 s22, 0
    s_add_u32 m0, s19, 0
    s_add_u32 s17, s20, 0
    buffer_load_dwordx4 v2, s[4:7], s17 offen lds
    s_add_u32 m0, s19, 4096
    s_add_u32 s17, s20, 264192
    buffer_load_dwordx4 v2, s[4:7], s17 offen lds
    s_add_u32 m0, s19, 8192
    s_add_u32 s17, s20, 528384
    buffer_load_dwordx4 v2, s[4:7], s17 offen lds
    s_add_u32 m0, s19, 12288
    s_add_u32 s17, s20, 792576
    buffer_load_dwordx4 v2, s[4:7], s17 offen lds
    s_add_u32 m0, s19, 16384
    s_add_u32 s17, s20, 1056768
    buffer_load_dwordx4 v2, s[4:7], s17 offen lds
    s_add_u32 m0, s19, 20480
    s_add_u32 s17, s20, 1320960
    buffer_load_dwordx4 v2, s[4:7], s17 offen lds
    s_add_u32 m0, s19, 24576
    s_add_u32 s17, s20, 1585152
    buffer_load_dwordx4 v2, s[4:7], s17 offen lds
    s_add_u32 m0, s19, 28672
    s_add_u32 s17, s20, 1849344
    buffer_load_dwordx4 v2, s[4:7], s17 offen lds
    s_add_u32 m0, s19, 32768
    s_add_u32 s17, s20, 2113536
    buffer_load_dwordx4 v2, s[4:7], s17 offen lds
    s_add_u32 m0, s19, 36864
    s_add_u32 s17, s20, 2377728
    buffer_load_dwordx4 v2, s[4:7], s17 offen lds
    s_add_u32 m0, s19, 40960
    s_add_u32 s17, s20, 2641920
    buffer_load_dwordx4 v2, s[4:7], s17 offen lds
    s_add_u32 m0, s19, 45056
    s_add_u32 s17, s20, 2906112
    buffer_load_dwordx4 v2, s[4:7], s17 offen lds
    s_add_u32 m0, s19, 49152
    s_add_u32 s17, s20, 3170304
    buffer_load_dwordx4 v2, s[4:7], s17 offen lds
    s_add_u32 m0, s19, 53248
    s_add_u32 s17, s20, 3434496
    buffer_load_dwordx4 v2, s[4:7], s17 offen lds
    s_add_u32 m0, s19, 57344
    s_add_u32 s17, s20, 3698688
    buffer_load_dwordx4 v2, s[4:7], s17 offen lds
    s_add_u32 m0, s19, 61440
    s_add_u32 s17, s20, 3962880
    buffer_load_dwordx4 v2, s[4:7], s17 offen lds
    s_add_u32 s20, s20, s24
    s_add_u32 m0, s19, 65536
    s_add_u32 s17, s20, 0
    buffer_load_dwordx4 v2, s[4:7], s17 offen lds
    s_add_u32 m0, s19, 69632
    s_add_u32 s17, s20, 264192
    buffer_load_dwordx4 v2, s[4:7], s17 offen lds
    s_add_u32 m0, s19, 73728
    s_add_u32 s17, s20, 528384
    buffer_load_dwordx4 v2, s[4:7], s17 offen lds
    s_waitcnt vmcnt(11)
    s_barrier
    ds_read_b128 v[20:23], v10 offset:0
    ds_read_b128 v[24:27], v10 offset:256
    ds_read_b128 v[28:31], v11 offset:0
    ds_read_b128 v[32:35], v11 offset:256
    ds_read_b128 v[36:39], v10 offset:4096
    ds_read_b128 v[40:43], v10 offset:4352
    ds_read_b128 v[44:47], v11 offset:4096
.p2align 6
F3_top:
    s_waitcnt lgkmcnt(6)
    v_mfma_f32_16x16x32_bf16 v[52:55], a[0:3], v[20:23], 0
    ds_read_b128 v[48:51], v11 offset:4352
    v_mfma_f32_16x16x32_bf16 v[56:59], a[4:7], v[20:23], 0
    s_waitcnt lgkmcnt(6)
    v_mfma_f32_16x16x32_bf16 v[60:63], a[0:3], v[24:27], 0
    ds_read_b128 v[20:23], v10 offset:8192
    s_add_u32 m0, s19, 77824
    v_mfma_f32_16x16x32_bf16 v[64:67], a[4:7], v[24:27], 0
    s_add_u32 s17, s20, 792576
    buffer_load_dwordx4 v2, s[4:7], s17 offen lds
    s_waitcnt lgkmcnt(6)
    v_mfma_f32_16x16x32_bf16 v[52:55], a[8:11], v[28:31], v[52:55]
    ds_read_b128 v[24:27], v10 offset:8448
    v_mfma_f32_16x16x32_bf16 v[56:59], a[12:15], v[28:31], v[56:59]
    s_waitcnt lgkmcnt(6)
    v_mfma_f32_16x16x32_bf16 v[60:63], a[8:11], v[32:35], v[60:63]
    ds_read_b128 v[28:31], v11 offset:8192
    s_add_u32 m0, s19, 81920
    v_mfma_f32_16x16x32_bf16 v[64:67], a[12:15], v[32:35], v[64:67]
    s_add_u32 s17, s20, 1056768
    buffer_load_dwordx4 v2, s[4:7], s17 offen lds
    s_waitcnt lgkmcnt(6)
    v_mfma_f32_16x16x32_bf16 v[52:55], a[16:19], v[36:39], v[52:55]
    ds_read_b128 v[32:35], v11 offset:8448
    v_mfma_f32_16x16x32_bf16 v[56:59], a[20:23], v[36:39], v[56:59]
    s_waitcnt lgkmcnt(6)
    v_mfma_f32_16x16x32_bf16 v[60:63], a[16:19], v[40:43], v[60:63]
    ds_read_b128 v[36:39], v10 offset:12288
    s_add_u32 m0, s19, 86016
    v_mfma_f32_16x16x32_bf16 v[64:67], a[20:23], v[40:43], v[64:67]
    s_add_u32 s17, s20, 1320960
    buffer_load_dwordx4 v2, s[4:7], s17 offen lds
    s_waitcnt lgkmcnt(6)
    v_mfma_f32_16x16x32_bf16 v[52:55], a[24:27], v[44:47], v[52:55]
    ds_read_b128 v[40:43], v10 offset:12544
    v_mfma_f32_16x16x32_bf16 v[56:59], a[28:31], v[44:47], v[56:59]
    s_waitcnt lgkmcnt(6)
    v_mfma_f32_16x16x32_bf16 v[60:63], a[24:27], v[48:51], v[60:63]
    ds_read_b128 v[44:47], v11 offset:12288
    s_add_u32 m0, s19, 90112
    v_mfma_f32_16x16x32_bf16 v[64:67], a[28:31], v[48:51], v[64:67]
    s_add_u32 s17, s20, 1585152
    buffer_load_dwordx4 v2, s[4:7], s17 offen lds
    s_waitcnt lgkmcnt(6)
    v_mfma_f32_16x16x32_bf16 v[52:55], a[32:35], v[20:23], v[52:55]
    ds_read_b128 v[48:51], v11 offset:12544
    v_mfma_f32_16x16x32_bf16 v[56:59], a[36:39], v[20:23], v[56:59]
    s_waitcnt lgkmcnt(6)
    v_mfma_f32_16x16x32_bf16 v[60:63], a[32:35], v[24:27], v[60:63]
    ds_read_b128 v[20:23], v10 offset:16384
    s_add_u32 m0, s19, 94208
    v_mfma_f32_16x16x32_bf16 v[64:67], a[36:39], v[24:27], v[64:67]
    s_add_u32 s17, s20, 1849344
    buffer_load_dwordx4 v2, s[4:7], s17 offen lds
    s_waitcnt lgkmcnt(6)
    v_mfma_f32_16x16x32_bf16 v[52:55], a[40:43], v[28:31], v[52:55]
    ds_read_b128 v[24:27], v10 offset:16640
    v_mfma_f32_16x16x32_bf16 v[56:59], a[44:47], v[28:31], v[56:59]
    v_cvt_pk_bf16_f32 v84, v68, v69
    s_waitcnt lgkmcnt(6)
    v_mfma_f32_16x16x32_bf16 v[60:63], a[40:43], v[32:35], v[60:63]
    ds_read_b128 v[28:31], v11 offset:16384
    v_mfma_f32_16x16x32_bf16 v[64:67], a[44:47], v[32:35], v[64:67]
    v_cvt_pk_bf16_f32 v85, v70, v71
    s_waitcnt lgkmcnt(6)
    v_mfma_f32_16x16x32_bf16 v[52:55], a[48:51], v[36:39], v[52:55]
    ds_read_b128 v[32:35], v11 offset:16640
    v_mfma_f32_16x16x32_bf16 v[56:59], a[52:55], v[36:39], v[56:59]
    v_cvt_pk_bf16_f32 v86, v72, v73
    s_waitcnt lgkmcnt(6)
    v_mfma_f32_16x16x32_bf16 v[60:63], a[48:51], v[40:43], v[60:63]
    ds_read_b128 v[36:39], v10 offset:20480
    v_mfma_f32_16x16x32_bf16 v[64:67], a[52:55], v[40:43], v[64:67]
    v_cvt_pk_bf16_f32 v87, v74, v75
    s_waitcnt lgkmcnt(6)
    v_mfma_f32_16x16x32_bf16 v[52:55], a[56:59], v[44:47], v[52:55]
    ds_read_b128 v[40:43], v10 offset:20736
    v_mfma_f32_16x16x32_bf16 v[56:59], a[60:63], v[44:47], v[56:59]
    v_cvt_pk_bf16_f32 v88, v76, v77
    s_waitcnt lgkmcnt(6)
    v_mfma_f32_16x16x32_bf16 v[60:63], a[56:59], v[48:51], v[60:63]
    ds_read_b128 v[44:47], v11 offset:20480
    v_mfma_f32_16x16x32_bf16 v[64:67], a[60:63], v[48:51], v[64:67]
    v_cvt_pk_bf16_f32 v89, v78, v79
    buffer_store_dwordx4 v[84:87], v3, s[12:15], s21 offen
    s_waitcnt lgkmcnt(6)
    v_mfma_f32_16x16x32_bf16 v[52:55], a[64:67], v[20:23], v[52:55]
    ds_read_b128 v[48:51], v11 offset:20736
    v_mfma_f32_16x16x32_bf16 v[56:59], a[68:71], v[20:23], v[56:59]
    v_cvt_pk_bf16_f32 v90, v80, v81
    s_waitcnt lgkmcnt(6)
    v_mfma_f32_16x16x32_bf16 v[60:63], a[64:67], v[24:27], v[60:63]
    ds_read_b128 v[20:23], v10 offset:24576
    v_mfma_f32_16x16x32_bf16 v[64:67], a[68:71], v[24:27], v[64:67]
    v_cvt_pk_bf16_f32 v91, v82, v83
    s_waitcnt lgkmcnt(6)
    v_mfma_f32_16x16x32_bf16 v[52:55], a[72:75], v[28:31], v[52:55]
    ds_read_b128 v[24:27], v10 offset:24832
    v_mfma_f32_16x16x32_bf16 v[56:59], a[76:79], v[28:31], v[56:59]
    s_waitcnt lgkmcnt(6)
    v_mfma_f32_16x16x32_bf16 v[60:63], a[72:75], v[32:35], v[60:63]
    ds_read_b128 v[28:31], v11 offset:24576
    v_mfma_f32_16x16x32_bf16 v[64:67], a[76:79], v[32:35], v[64:67]
    buffer_store_dwordx4 v[88:91], v4, s[12:15], s21 offen
    s_waitcnt lgkmcnt(6)
    v_mfma_f32_16x16x32_bf16 v[52:55], a[80:83], v[36:39], v[52:55]
    ds_read_b128 v[32:35], v11 offset:24832
    v_mfma_f32_16x16x32_bf16 v[56:59], a[84:87], v[36:39], v[56:59]
    s_add_u32 s21, s21, s25
    s_mov_b32 s25, s26
    s_waitcnt lgkmcnt(6)
    v_mfma_f32_16x16x32_bf16 v[60:63], a[80:83], v[40:43], v[60:63]
    ds_read_b128 v[36:39], v10 offset:28672
    v_mfma_f32_16x16x32_bf16 v[64:67], a[84:87], v[40:43], v[64:67]
    s_waitcnt lgkmcnt(6)
    v_mfma_f32_16x16x32_bf16 v[52:55], a[88:91], v[44:47], v[52:55]
    ds_read_b128 v[40:43], v10 offset:28928
    v_mfma_f32_16x16x32_bf16 v[56:59], a[92:95], v[44:47], v[56:59]
    s_waitcnt lgkmcnt(6)
    v_mfma_f32_16x16x32_bf16 v[60:63], a[88:91], v[48:51], v[60:63]
    ds_read_b128 v[44:47], v11 offset:28672
    v_mfma_f32_16x16x32_bf16 v[64:67], a[92:95], v[48:51], v[64:67]
    s_waitcnt lgkmcnt(6)
    v_mfma_f32_16x16x32_bf16 v[52:55], a[96:99], v[20:23], v[52:55]
    ds_read_b128 v[48:51], v11 offset:28928
    v_mfma_f32_16x16x32_bf16 v[56:59], a[100:103], v[20:23], v[56:59]
    s_waitcnt lgkmcnt(6)
    v_mfma_f32_16x16x32_bf16 v[60:63], a[96:99], v[24:27], v[60:63]
    s_waitcnt vmcnt(10)
    s_barrier
    ds_read_b128 v[20:23], v10 offset:32768
    v_mfma_f32_16x16x32_bf16 v[64:67], a[100:103], v[24:27], v[64:67]
    s_waitcnt lgkmcnt(6)
    v_mfma_f32_16x16x32_bf16 v[52:55], a[104:107], v[28:31], v[52:55]
    ds_read_b128 v[24:27], v10 offset:33024
    s_add_u32 m0, s19, 98304
    v_mfma_f32_16x16x32_bf16 v[56:59], a[108:111], v[28:31], v[56:59]
    s_add_u32 s17, s20, 2113536
    buffer_load_dwordx4 v2, s[4:7], s17 offen lds
    s_waitcnt lgkmcnt(6)
    v_mfma_f32_16x16x32_bf16 v[60:63], a[104:107], v[32:35], v[60:63]
    ds_read_b128 v[28:31], v11 offset:32768
    v_mfma_f32_16x16x32_bf16 v[64:67], a[108:111], v[32:35], v[64:67]
    s_waitcnt lgkmcnt(6)
    v_mfma_f32_16x16x32_bf16 v[52:55], a[112:115], v[36:39], v[52:55]
    ds_read_b128 v[32:35], v11 offset:33024
    s_add_u32 m0, s19, 102400
    v_mfma_f32_16x16x32_bf16 v[56:59], a[116:119], v[36:39], v[56:59]
    s_add_u32 s17, s20, 2377728
    buffer_load_dwordx4 v2, s[4:7], s17 offen lds
    s_waitcnt lgkmcnt(6)
    v_mfma_f32_16x16x32_bf16 v[60:63], a[112:115], v[40:43], v[60:63]
    ds_read_b128 v[36:39], v10 offset:36864
    v_mfma_f32_16x16x32_bf16 v[64:67], a[116:119], v[40:43], v[64:67]
    s_waitcnt lgkmcnt(6)
    v_mfma_f32_16x16x32_bf16 v[52:55], a[120:123], v[44:47], v[52:55]
    ds_read_b128 v[40:43], v10 offset:37120
    s_add_u32 m0, s19, 106496
    v_mfma_f32_16x16x32_bf16 v[56:59], a[124:127], v[44:47], v[56:59]
    s_add_u32 s17, s20, 2641920
    buffer_load_dwordx4 v2, s[4:7], s17 offen lds
    s_waitcnt lgkmcnt(6)
    v_mfma_f32_16x16x32_bf16 v[60:63], a[120:123], v[48:51], v[60:63]
    ds_read_b128 v[44:47], v11 offset:36864
    v_mfma_f32_16x16x32_bf16 v[64:67], a[124:127], v[48:51], v[64:67]
    s_waitcnt lgkmcnt(6)
    v_mfma_f32_16x16x32_bf16 v[52:55], a[128:131], v[20:23], v[52:55]
    ds_read_b128 v[48:51], v11 offset:37120
    v_mfma_f32_16x16x32_bf16 v[56:59], a[132:135], v[20:23], v[56:59]
    s_waitcnt lgkmcnt(6)
    v_mfma_f32_16x16x32_bf16 v[60:63], a[128:131], v[24:27], v[60:63]
    ds_read_b128 v[20:23], v10 offset:40960
    s_add_u32 m0, s19, 110592
    v_mfma_f32_16x16x32_bf16 v[64:67], a[132:135], v[24:27], v[64:67]
    s_add_u32 s17, s20, 2906112
    buffer_load_dwordx4 v2, s[4:7], s17 offen lds
    s_waitcnt lgkmcnt(6)
    v_mfma_f32_16x16x32_bf16 v[52:55], a[136:139], v[28:31], v[52:55]
    ds_read_b128 v[24:27], v10 offset:41216
    v_mfma_f32_16x16x32_bf16 v[56:59], a[140:143], v[28:31], v[56:59]
    s_waitcnt lgkmcnt(6)
    v_mfma_f32_16x16x32_bf16 v[60:63], a[136:139], v[32:35], v[60:63]
    ds_read_b128 v[28:31], v11 offset:40960
    s_add_u32 m0, s19, 114688
    v_mfma_f32_16x16x32_bf16 v[64:67], a[140:143], v[32:35], v[64:67]
    s_add_u32 s17, s20, 3170304
    buffer_load_dwordx4 v2, s[4:7], s17 offen lds
    s_waitcnt lgkmcnt(6)
    v_mfma_f32_16x16x32_bf16 v[52:55], a[144:147], v[36:39], v[52:55]
    ds_read_b128 v[32:35], v11 offset:41216
    v_mfma_f32_16x16x32_bf16 v[56:59], a[148:151], v[36:39], v[56:59]
    s_waitcnt lgkmcnt(6)
    v_mfma_f32_16x16x32_bf16 v[60:63], a[144:147], v[40:43], v[60:63]
    ds_read_b128 v[36:39], v10 offset:45056
    s_add_u32 m0, s19, 118784
    v_mfma_f32_16x16x32_bf16 v[64:67], a[148:151], v[40:43], v[64:67]
    s_add_u32 s17, s20, 3434496
    buffer_load_dwordx4 v2, s[4:7], s17 offen lds
    s_waitcnt lgkmcnt(6)
    v_mfma_f32_16x16x32_bf16 v[52:55], a[152:155], v[44:47], v[52:55]
    ds_read_b128 v[40:43], v10 offset:45312
    v_mfma_f32_16x16x32_bf16 v[56:59], a[156:159], v[44:47], v[56:59]
    s_waitcnt lgkmcnt(6)
    v_mfma_f32_16x16x32_bf16 v[60:63], a[152:155], v[48:51], v[60:63]
    ds_read_b128 v[44:47], v11 offset:45056
    s_add_u32 m0, s19, 122880
    v_mfma_f32_16x16x32_bf16 v[64:67], a[156:159], v[48:51], v[64:67]
    s_add_u32 s17, s20, 3698688
    buffer_load_dwordx4 v2, s[4:7], s17 offen lds
    s_waitcnt lgkmcnt(6)
    v_mfma_f32_16x16x32_bf16 v[52:55], a[160:163], v[20:23], v[52:55]
    ds_read_b128 v[48:51], v11 offset:45312
    v_mfma_f32_16x16x32_bf16 v[56:59], a[164:167], v[20:23], v[56:59]
    s_waitcnt lgkmcnt(6)
    v_mfma_f32_16x16x32_bf16 v[60:63], a[160:163], v[24:27], v[60:63]
    ds_read_b128 v[20:23], v10 offset:49152
    s_add_u32 m0, s19, 126976
    v_mfma_f32_16x16x32_bf16 v[64:67], a[164:167], v[24:27], v[64:67]
    s_add_u32 s17, s20, 3962880
    buffer_load_dwordx4 v2, s[4:7], s17 offen lds
    s_waitcnt lgkmcnt(6)
    v_mfma_f32_16x16x32_bf16 v[52:55], a[168:171], v[28:31], v[52:55]
    ds_read_b128 v[24:27], v10 offset:49408
    v_mfma_f32_16x16x32_bf16 v[56:59], a[172:175], v[28:31], v[56:59]
    s_add_u32 s20, s20, s24
    s_waitcnt lgkmcnt(6)
    v_mfma_f32_16x16x32_bf16 v[60:63], a[168:171], v[32:35], v[60:63]
    ds_read_b128 v[28:31], v11 offset:49152
    v_mfma_f32_16x16x32_bf16 v[64:67], a[172:175], v[32:35], v[64:67]
    s_waitcnt lgkmcnt(6)
    v_mfma_f32_16x16x32_bf16 v[52:55], a[176:179], v[36:39], v[52:55]
    ds_read_b128 v[32:35], v11 offset:49408
    v_mfma_f32_16x16x32_bf16 v[56:59], a[180:183], v[36:39], v[56:59]
    s_waitcnt lgkmcnt(6)
    v_mfma_f32_16x16x32_bf16 v[60:63], a[176:179], v[40:43], v[60:63]
    ds_read_b128 v[36:39], v10 offset:53248
    v_mfma_f32_16x16x32_bf16 v[64:67], a[180:183], v[40:43], v[64:67]
    s_waitcnt lgkmcnt(6)
    v_mfma_f32_16x16x32_bf16 v[52:55], a[184:187], v[44:47], v[52:55]
    ds_read_b128 v[40:43], v10 offset:53504
    v_mfma_f32_16x16x32_bf16 v[56:59], a[188:191], v[44:47], v[56:59]
    s_waitcnt lgkmcnt(6)
    v_mfma_f32_16x16x32_bf16 v[60:63], a[184:187], v[48:51], v[60:63]
    ds_read_b128 v[44:47], v11 offset:53248
    v_mfma_f32_16x16x32_bf16 v[64:67], a[188:191], v[48:51], v[64:67]
    s_waitcnt lgkmcnt(6)
    v_mfma_f32_16x16x32_bf16 v[52:55], a[192:195], v[20:23], v[52:55]
    ds_read_b128 v[48:51], v11 offset:53504
    v_mfma_f32_16x16x32_bf16 v[56:59], a[196:199], v[20:23], v[56:59]
    s_waitcnt lgkmcnt(6)
    v_mfma_f32_16x16x32_bf16 v[60:63], a[192:195], v[24:27], v[60:63]
    ds_read_b128 v[20:23], v10 offset:57344
    v_mfma_f32_16x16x32_bf16 v[64:67], a[196:199], v[24:27], v[64:67]
    s_waitcnt lgkmcnt(6)
    v_mfma_f32_16x16x32_bf16 v[52:55], a[200:203], v[28:31], v[52:55]
    ds_read_b128 v[24:27], v10 offset:57600
    v_mfma_f32_16x16x32_bf16 v[56:59], a[204:207], v[28:31], v[56:59]
    s_waitcnt lgkmcnt(6)
    v_mfma_f32_16x16x32_bf16 v[60:63], a[200:203], v[32:35], v[60:63]
    ds_read_b128 v[28:31], v11 offset:57344
    v_mfma_f32_16x16x32_bf16 v[64:67], a[204:207], v[32:35], v[64:67]
    s_waitcnt lgkmcnt(6)
    v_mfma_f32_16x16x32_bf16 v[52:55], a[208:211], v[36:39], v[52:55]
    ds_read_b128 v[32:35], v11 offset:57600
    v_mfma_f32_16x16x32_bf16 v[56:59], a[212:215], v[36:39], v[56:59]
    s_waitcnt lgkmcnt(6)
    v_mfma_f32_16x16x32_bf16 v[60:63], a[208:211], v[40:43], v[60:63]
    ds_read_b128 v[36:39], v10 offset:61440
    v_mfma_f32_16x16x32_bf16 v[64:67], a[212:215], v[40:43], v[64:67]
    s_waitcnt lgkmcnt(6)
    v_mfma_f32_16x16x32_bf16 v[52:55], a[216:219], v[44:47], v[52:55]
    ds_read_b128 v[40:43], v10 offset:61696
    v_mfma_f32_16x16x32_bf16 v[56:59], a[220:223], v[44:47], v[56:59]
    s_waitcnt lgkmcnt(6)
    v_mfma_f32_16x16x32_bf16 v[60:63], a[216:219], v[48:51], v[60:63]
    ds_read_b128 v[44:47], v11 offset:61440
    v_mfma_f32_16x16x32_bf16 v[64:67], a[220:223], v[48:51], v[64:67]
    s_waitcnt lgkmcnt(6)
    v_mfma_f32_16x16x32_bf16 v[52:55], a[224:227], v[20:23], v[52:55]
    ds_read_b128 v[48:51], v11 offset:61696
    v_mfma_f32_16x16x32_bf16 v[56:59], a[228:231], v[20:23], v[56:59]
    s_waitcnt lgkmcnt(6)
    v_mfma_f32_16x16x32_bf16 v[60:63], a[224:227], v[24:27], v[60:63]
    s_waitcnt vmcnt(8)
    s_barrier
    ds_read_b128 v[20:23], v12 offset:0
    v_mfma_f32_16x16x32_bf16 v[64:67], a[228:231], v[24:27], v[64:67]
    s_waitcnt lgkmcnt(6)
    v_mfma_f32_16x16x32_bf16 v[52:55], a[232:235], v[28:31], v[52:55]
    ds_read_b128 v[24:27], v12 offset:256
    s_add_u32 m0, s19, 0
    v_mfma_f32_16x16x32_bf16 v[56:59], a[236:239], v[28:31], v[56:59]
    s_add_u32 s17, s20, 0
    buffer_load_dwordx4 v2, s[4:7], s17 offen lds
    s_waitcnt lgkmcnt(6)
    v_mfma_f32_16x16x32_bf16 v[60:63], a[232:235], v[32:35], v[60:63]
    ds_read_b128 v[28:31], v13 offset:0
    v_mfma_f32_16x16x32_bf16 v[64:67], a[236:239], v[32:35], v[64:67]
    s_waitcnt lgkmcnt(6)
    v_mfma_f32_16x16x32_bf16 v[52:55], a[240:243], v[36:39], v[52:55]
    ds_read_b128 v[32:35], v13 offset:256
    s_add_u32 m0, s19, 4096
    v_mfma_f32_16x16x32_bf16 v[56:59], a[244:247], v[36:39], v[56:59]
    s_add_u32 s17, s20, 264192
    buffer_load_dwordx4 v2, s[4:7], s17 offen lds
    s_waitcnt lgkmcnt(6)
    v_mfma_f32_16x16x32_bf16 v[60:63], a[240:243], v[40:43], v[60:63]
    ds_read_b128 v[36:39], v12 offset:4096
    v_mfma_f32_16x16x32_bf16 v[64:67], a[244:247], v[40:43], v[64:67]
    s_waitcnt lgkmcnt(6)
    v_mfma_f32_16x16x32_bf16 v[52:55], a[248:251], v[44:47], v[52:55]
    ds_read_b128 v[40:43], v12 offset:4352
    s_add_u32 m0, s19, 8192
    v_mfma_f32_16x16x32_bf16 v[56:59], a[252:255], v[44:47], v[56:59]
    s_add_u32 s17, s20, 528384
    buffer_load_dwordx4 v2, s[4:7], s17 offen lds
    s_waitcnt lgkmcnt(6)
    v_mfma_f32_16x16x32_bf16 v[60:63], a[248:251], v[48:51], v[60:63]
    ds_read_b128 v[44:47], v13 offset:4096
    v_mfma_f32_16x16x32_bf16 v[64:67], a[252:255], v[48:51], v[64:67]
    s_waitcnt lgkmcnt(6)
    v_mfma_f32_16x16x32_bf16 v[68:71], a[0:3], v[20:23], 0
    ds_read_b128 v[48:51], v13 offset:4352
    v_mfma_f32_16x16x32_bf16 v[72:75], a[4:7], v[20:23], 0
    s_waitcnt lgkmcnt(6)
    v_mfma_f32_16x16x32_bf16 v[76:79], a[0:3], v[24:27], 0
    ds_read_b128 v[20:23], v12 offset:8192
    s_add_u32 m0, s19, 12288
    v_mfma_f32_16x16x32_bf16 v[80:83], a[4:7], v[24:27], 0
    s_add_u32 s17, s20, 792576
    buffer_load_dwordx4 v2, s[4:7], s17 offen lds
    s_waitcnt lgkmcnt(6)
    v_mfma_f32_16x16x32_bf16 v[68:71], a[8:11], v[28:31], v[68:71]
    ds_read_b128 v[24:27], v12 offset:8448
    v_mfma_f32_16x16x32_bf16 v[72:75], a[12:15], v[28:31], v[72:75]
    s_waitcnt lgkmcnt(6)
    v_mfma_f32_16x16x32_bf16 v[76:79], a[8:11], v[32:35], v[76:79]
    ds_read_b128 v[28:31], v13 offset:8192
    s_add_u32 m0, s19, 16384
    v_mfma_f32_16x16x32_bf16 v[80:83], a[12:15], v[32:35], v[80:83]
    s_add_u32 s17, s20, 1056768
    buffer_load_dwordx4 v2, s[4:7], s17 offen lds
    s_waitcnt lgkmcnt(6)
    v_mfma_f32_16x16x32_bf16 v[68:71], a[16:19], v[36:39], v[68:71]
    ds_read_b128 v[32:35], v13 offset:8448
    v_mfma_f32_16x16x32_bf16 v[72:75], a[20:23], v[36:39], v[72:75]
    s_waitcnt lgkmcnt(6)
    v_mfma_f32_16x16x32_bf16 v[76:79], a[16:19], v[40:43], v[76:79]
    ds_read_b128 v[36:39], v12 offset:12288
    s_add_u32 m0, s19, 20480
    v_mfma_f32_16x16x32_bf16 v[80:83], a[20:23], v[40:43], v[80:83]
    s_add_u32 s17, s20, 1320960
    buffer_load_dwordx4 v2, s[4:7], s17 offen lds
    s_waitcnt lgkmcnt(6)
    v_mfma_f32_16x16x32_bf16 v[68:71], a[24:27], v[44:47], v[68:71]
    ds_read_b128 v[40:43], v12 offset:12544
    v_mfma_f32_16x16x32_bf16 v[72:75], a[28:31], v[44:47], v[72:75]
    s_waitcnt lgkmcnt(6)
    v_mfma_f32_16x16x32_bf16 v[76:79], a[24:27], v[48:51], v[76:79]
    ds_read_b128 v[44:47], v13 offset:12288
    s_add_u32 m0, s19, 24576
    v_mfma_f32_16x16x32_bf16 v[80:83], a[28:31], v[48:51], v[80:83]
    s_add_u32 s17, s20, 1585152
    buffer_load_dwordx4 v2, s[4:7], s17 offen lds
    s_waitcnt lgkmcnt(6)
    v_mfma_f32_16x16x32_bf16 v[68:71], a[32:35], v[20:23], v[68:71]
    ds_read_b128 v[48:51], v13 offset:12544
    v_mfma_f32_16x16x32_bf16 v[72:75], a[36:39], v[20:23], v[72:75]
    s_waitcnt lgkmcnt(6)
    v_mfma_f32_16x16x32_bf16 v[76:79], a[32:35], v[24:27], v[76:79]
    ds_read_b128 v[20:23], v12 offset:16384
    s_add_u32 m0, s19, 28672
    v_mfma_f32_16x16x32_bf16 v[80:83], a[36:39], v[24:27], v[80:83]
    s_add_u32 s17, s20, 1849344
    buffer_load_dwordx4 v2, s[4:7], s17 offen lds
    s_waitcnt lgkmcnt(6)
    v_mfma_f32_16x16x32_bf16 v[68:71], a[40:43], v[28:31], v[68:71]
    ds_read_b128 v[24:27], v12 offset:16640
    v_mfma_f32_16x16x32_bf16 v[72:75], a[44:47], v[28:31], v[72:75]
    v_cvt_pk_bf16_f32 v84, v52, v53
    s_waitcnt lgkmcnt(6)
    v_mfma_f32_16x16x32_bf16 v[76:79], a[40:43], v[32:35], v[76:79]
    ds_read_b128 v[28:31], v13 offset:16384
    v_mfma_f32_16x16x32_bf16 v[80:83], a[44:47], v[32:35], v[80:83]
    v_cvt_pk_bf16_f32 v85, v54, v55
    s_waitcnt lgkmcnt(6)
    v_mfma_f32_16x16x32_bf16 v[68:71], a[48:51], v[36:39], v[68:71]
    ds_read_b128 v[32:35], v13 offset:16640
    v_mfma_f32_16x16x32_bf16 v[72:75], a[52:55], v[36:39], v[72:75]
    v_cvt_pk_bf16_f32 v86, v56, v57
    s_waitcnt lgkmcnt(6)
    v_mfma_f32_16x16x32_bf16 v[76:79], a[48:51], v[40:43], v[76:79]
    ds_read_b128 v[36:39], v12 offset:20480
    v_mfma_f32_16x16x32_bf16 v[80:83], a[52:55], v[40:43], v[80:83]
    v_cvt_pk_bf16_f32 v87, v58, v59
    s_waitcnt lgkmcnt(6)
    v_mfma_f32_16x16x32_bf16 v[68:71], a[56:59], v[44:47], v[68:71]
    ds_read_b128 v[40:43], v12 offset:20736
    v_mfma_f32_16x16x32_bf16 v[72:75], a[60:63], v[44:47], v[72:75]
    v_cvt_pk_bf16_f32 v88, v60, v61
    s_waitcnt lgkmcnt(6)
    v_mfma_f32_16x16x32_bf16 v[76:79], a[56:59], v[48:51], v[76:79]
    ds_read_b128 v[44:47], v13 offset:20480
    v_mfma_f32_16x16x32_bf16 v[80:83], a[60:63], v[48:51], v[80:83]
    v_cvt_pk_bf16_f32 v89, v62, v63
    buffer_store_dwordx4 v[84:87], v3, s[12:15], s21 offen
    s_waitcnt lgkmcnt(6)
    v_mfma_f32_16x16x32_bf16 v[68:71], a[64:67], v[20:23], v[68:71]
    ds_read_b128 v[48:51], v13 offset:20736
    v_mfma_f32_16x16x32_bf16 v[72:75], a[68:71], v[20:23], v[72:75]
    v_cvt_pk_bf16_f32 v90, v64, v65
    s_waitcnt lgkmcnt(6)
    v_mfma_f32_16x16x32_bf16 v[76:79], a[64:67], v[24:27], v[76:79]
    ds_read_b128 v[20:23], v12 offset:24576
    v_mfma_f32_16x16x32_bf16 v[80:83], a[68:71], v[24:27], v[80:83]
    v_cvt_pk_bf16_f32 v91, v66, v67
    s_waitcnt lgkmcnt(6)
    v_mfma_f32_16x16x32_bf16 v[68:71], a[72:75], v[28:31], v[68:71]
    ds_read_b128 v[24:27], v12 offset:24832
    v_mfma_f32_16x16x32_bf16 v[72:75], a[76:79], v[28:31], v[72:75]
    s_waitcnt lgkmcnt(6)
    v_mfma_f32_16x16x32_bf16 v[76:79], a[72:75], v[32:35], v[76:79]
    ds_read_b128 v[28:31], v13 offset:24576
    v_mfma_f32_16x16x32_bf16 v[80:83], a[76:79], v[32:35], v[80:83]
    buffer_store_dwordx4 v[88:91], v4, s[12:15], s21 offen
    s_waitcnt lgkmcnt(6)
    v_mfma_f32_16x16x32_bf16 v[68:71], a[80:83], v[36:39], v[68:71]
    ds_read_b128 v[32:35], v13 offset:24832
    v_mfma_f32_16x16x32_bf16 v[72:75], a[84:87], v[36:39], v[72:75]
    s_add_u32 s21, s21, s25
    s_mov_b32 s25, s26
    s_waitcnt lgkmcnt(6)
    v_mfma_f32_16x16x32_bf16 v[76:79], a[80:83], v[40:43], v[76:79]
    ds_read_b128 v[36:39], v12 offset:28672
    v_mfma_f32_16x16x32_bf16 v[80:83], a[84:87], v[40:43], v[80:83]
    s_waitcnt lgkmcnt(6)
    v_mfma_f32_16x16x32_bf16 v[68:71], a[88:91], v[44:47], v[68:71]
    ds_read_b128 v[40:43], v12 offset:28928
    v_mfma_f32_16x16x32_bf16 v[72:75], a[92:95], v[44:47], v[72:75]
    s_waitcnt lgkmcnt(6)
    v_mfma_f32_16x16x32_bf16 v[76:79], a[88:91], v[48:51], v[76:79]
    ds_read_b128 v[44:47], v13 offset:28672
    v_mfma_f32_16x16x32_bf16 v[80:83], a[92:95], v[48:51], v[80:83]
    s_waitcnt lgkmcnt(6)
    v_mfma_f32_16x16x32_bf16 v[68:71], a[96:99], v[20:23], v[68:71]
    ds_read_b128 v[48:51], v13 offset:28928
    v_mfma_f32_16x16x32_bf16 v[72:75], a[100:103], v[20:23], v[72:75]
    s_waitcnt lgkmcnt(6)
    v_mfma_f32_16x16x32_bf16 v[76:79], a[96:99], v[24:27], v[76:79]
    s_waitcnt vmcnt(10)
    s_barrier
    ds_read_b128 v[20:23], v12 offset:32768
    v_mfma_f32_16x16x32_bf16 v[80:83], a[100:103], v[24:27], v[80:83]
    s_waitcnt lgkmcnt(6)
    v_mfma_f32_16x16x32_bf16 v[68:71], a[104:107], v[28:31], v[68:71]
    ds_read_b128 v[24:27], v12 offset:33024
    s_add_u32 m0, s19, 32768
    v_mfma_f32_16x16x32_bf16 v[72:75], a[108:111], v[28:31], v[72:75]
    s_add_u32 s17, s20, 2113536
    buffer_load_dwordx4 v2, s[4:7], s17 offen lds
    s_waitcnt lgkmcnt(6)
    v_mfma_f32_16x16x32_bf16 v[76:79], a[104:107], v[32:35], v[76:79]
    ds_read_b128 v[28:31], v13 offset:32768
    v_mfma_f32_16x16x32_bf16 v[80:83], a[108:111], v[32:35], v[80:83]
    s_waitcnt lgkmcnt(6)
    v_mfma_f32_16x16x32_bf16 v[68:71], a[112:115], v[36:39], v[68:71]
    ds_read_b128 v[32:35], v13 offset:33024
    s_add_u32 m0, s19, 36864
    v_mfma_f32_16x16x32_bf16 v[72:75], a[116:119], v[36:39], v[72:75]
    s_add_u32 s17, s20, 2377728
    buffer_load_dwordx4 v2, s[4:7], s17 offen lds
    s_waitcnt lgkmcnt(6)
    v_mfma_f32_16x16x32_bf16 v[76:79], a[112:115], v[40:43], v[76:79]
    ds_read_b128 v[36:39], v12 offset:36864
    v_mfma_f32_16x16x32_bf16 v[80:83], a[116:119], v[40:43], v[80:83]
    s_waitcnt lgkmcnt(6)
    v_mfma_f32_16x16x32_bf16 v[68:71], a[120:123], v[44:47], v[68:71]
    ds_read_b128 v[40:43], v12 offset:37120
    s_add_u32 m0, s19, 40960
    v_mfma_f32_16x16x32_bf16 v[72:75], a[124:127], v[44:47], v[72:75]
    s_add_u32 s17, s20, 2641920
    buffer_load_dwordx4 v2, s[4:7], s17 offen lds
    s_waitcnt lgkmcnt(6)
    v_mfma_f32_16x16x32_bf16 v[76:79], a[120:123], v[48:51], v[76:79]
    ds_read_b128 v[44:47], v13 offset:36864
    v_mfma_f32_16x16x32_bf16 v[80:83], a[124:127], v[48:51], v[80:83]
    s_waitcnt lgkmcnt(6)
    v_mfma_f32_16x16x32_bf16 v[68:71], a[128:131], v[20:23], v[68:71]
    ds_read_b128 v[48:51], v13 offset:37120
    v_mfma_f32_16x16x32_bf16 v[72:75], a[132:135], v[20:23], v[72:75]
    s_waitcnt lgkmcnt(6)
    v_mfma_f32_16x16x32_bf16 v[76:79], a[128:131], v[24:27], v[76:79]
    ds_read_b128 v[20:23], v12 offset:40960
    s_add_u32 m0, s19, 45056
    v_mfma_f32_16x16x32_bf16 v[80:83], a[132:135], v[24:27], v[80:83]
    s_add_u32 s17, s20, 2906112
    buffer_load_dwordx4 v2, s[4:7], s17 offen lds
    s_waitcnt lgkmcnt(6)
    v_mfma_f32_16x16x32_bf16 v[68:71], a[136:139], v[28:31], v[68:71]
    ds_read_b128 v[24:27], v12 offset:41216
    v_mfma_f32_16x16x32_bf16 v[72:75], a[140:143], v[28:31], v[72:75]
    s_waitcnt lgkmcnt(6)
    v_mfma_f32_16x16x32_bf16 v[76:79], a[136:139], v[32:35], v[76:79]
    ds_read_b128 v[28:31], v13 offset:40960
    s_add_u32 m0, s19, 49152
    v_mfma_f32_16x16x32_bf16 v[80:83], a[140:143], v[32:35], v[80:83]
    s_add_u32 s17, s20, 3170304
    buffer_load_dwordx4 v2, s[4:7], s17 offen lds
    s_waitcnt lgkmcnt(6)
    v_mfma_f32_16x16x32_bf16 v[68:71], a[144:147], v[36:39], v[68:71]
    ds_read_b128 v[32:35], v13 offset:41216
    v_mfma_f32_16x16x32_bf16 v[72:75], a[148:151], v[36:39], v[72:75]
    s_waitcnt lgkmcnt(6)
    v_mfma_f32_16x16x32_bf16 v[76:79], a[144:147], v[40:43], v[76:79]
    ds_read_b128 v[36:39], v12 offset:45056
    s_add_u32 m0, s19, 53248
    v_mfma_f32_16x16x32_bf16 v[80:83], a[148:151], v[40:43], v[80:83]
    s_add_u32 s17, s20, 3434496
    buffer_load_dwordx4 v2, s[4:7], s17 offen lds
    s_waitcnt lgkmcnt(6)
    v_mfma_f32_16x16x32_bf16 v[68:71], a[152:155], v[44:47], v[68:71]
    ds_read_b128 v[40:43], v12 offset:45312
    v_mfma_f32_16x16x32_bf16 v[72:75], a[156:159], v[44:47], v[72:75]
    s_waitcnt lgkmcnt(6)
    v_mfma_f32_16x16x32_bf16 v[76:79], a[152:155], v[48:51], v[76:79]
    ds_read_b128 v[44:47], v13 offset:45056
    s_add_u32 m0, s19, 57344
    v_mfma_f32_16x16x32_bf16 v[80:83], a[156:159], v[48:51], v[80:83]
    s_add_u32 s17, s20, 3698688
    buffer_load_dwordx4 v2, s[4:7], s17 offen lds
    s_waitcnt lgkmcnt(6)
    v_mfma_f32_16x16x32_bf16 v[68:71], a[160:163], v[20:23], v[68:71]
    ds_read_b128 v[48:51], v13 offset:45312
    v_mfma_f32_16x16x32_bf16 v[72:75], a[164:167], v[20:23], v[72:75]
    s_waitcnt lgkmcnt(6)
    v_mfma_f32_16x16x32_bf16 v[76:79], a[160:163], v[24:27], v[76:79]
    ds_read_b128 v[20:23], v12 offset:49152
    s_add_u32 m0, s19, 61440
    v_mfma_f32_16x16x32_bf16 v[80:83], a[164:167], v[24:27], v[80:83]
    s_add_u32 s17, s20, 3962880
    buffer_load_dwordx4 v2, s[4:7], s17 offen lds
    s_waitcnt lgkmcnt(6)
    v_mfma_f32_16x16x32_bf16 v[68:71], a[168:171], v[28:31], v[68:71]
    ds_read_b128 v[24:27], v12 offset:49408
    v_mfma_f32_16x16x32_bf16 v[72:75], a[172:175], v[28:31], v[72:75]
    s_add_u32 s20, s20, s24
    s_waitcnt lgkmcnt(6)
    v_mfma_f32_16x16x32_bf16 v[76:79], a[168:171], v[32:35], v[76:79]
    ds_read_b128 v[28:31], v13 offset:49152
    v_mfma_f32_16x16x32_bf16 v[80:83], a[172:175], v[32:35], v[80:83]
    s_waitcnt lgkmcnt(6)
    v_mfma_f32_16x16x32_bf16 v[68:71], a[176:179], v[36:39], v[68:71]
    ds_read_b128 v[32:35], v13 offset:49408
    v_mfma_f32_16x16x32_bf16 v[72:75], a[180:183], v[36:39], v[72:75]
    s_waitcnt lgkmcnt(6)
    v_mfma_f32_16x16x32_bf16 v[76:79], a[176:179], v[40:43], v[76:79]
    ds_read_b128 v[36:39], v12 offset:53248
    v_mfma_f32_16x16x32_bf16 v[80:83], a[180:183], v[40:43], v[80:83]
    s_waitcnt lgkmcnt(6)
    v_mfma_f32_16x16x32_bf16 v[68:71], a[184:187], v[44:47], v[68:71]
    ds_read_b128 v[40:43], v12 offset:53504
    v_mfma_f32_16x16x32_bf16 v[72:75], a[188:191], v[44:47], v[72:75]
    s_waitcnt lgkmcnt(6)
    v_mfma_f32_16x16x32_bf16 v[76:79], a[184:187], v[48:51], v[76:79]
    ds_read_b128 v[44:47], v13 offset:53248
    v_mfma_f32_16x16x32_bf16 v[80:83], a[188:191], v[48:51], v[80:83]
    s_waitcnt lgkmcnt(6)
    v_mfma_f32_16x16x32_bf16 v[68:71], a[192:195], v[20:23], v[68:71]
    ds_read_b128 v[48:51], v13 offset:53504
    v_mfma_f32_16x16x32_bf16 v[72:75], a[196:199], v[20:23], v[72:75]
    s_waitcnt lgkmcnt(6)
    v_mfma_f32_16x16x32_bf16 v[76:79], a[192:195], v[24:27], v[76:79]
    ds_read_b128 v[20:23], v12 offset:57344
    v_mfma_f32_16x16x32_bf16 v[80:83], a[196:199], v[24:27], v[80:83]
    s_waitcnt lgkmcnt(6)
    v_mfma_f32_16x16x32_bf16 v[68:71], a[200:203], v[28:31], v[68:71]
    ds_read_b128 v[24:27], v12 offset:57600
    v_mfma_f32_16x16x32_bf16 v[72:75], a[204:207], v[28:31], v[72:75]
    s_waitcnt lgkmcnt(6)
    v_mfma_f32_16x16x32_bf16 v[76:79], a[200:203], v[32:35], v[76:79]
    ds_read_b128 v[28:31], v13 offset:57344
    v_mfma_f32_16x16x32_bf16 v[80:83], a[204:207], v[32:35], v[80:83]
    s_waitcnt lgkmcnt(6)
    v_mfma_f32_16x16x32_bf16 v[68:71], a[208:211], v[36:39], v[68:71]
    ds_read_b128 v[32:35], v13 offset:57600
    v_mfma_f32_16x16x32_bf16 v[72:75], a[212:215], v[36:39], v[72:75]
    s_waitcnt lgkmcnt(6)
    v_mfma_f32_16x16x32_bf16 v[76:79], a[208:211], v[40:43], v[76:79]
    ds_read_b128 v[36:39], v12 offset:61440
    v_mfma_f32_16x16x32_bf16 v[80:83], a[212:215], v[40:43], v[80:83]
    s_waitcnt lgkmcnt(6)
    v_mfma_f32_16x16x32_bf16 v[68:71], a[216:219], v[44:47], v[68:71]
    ds_read_b128 v[40:43], v12 offset:61696
    v_mfma_f32_16x16x32_bf16 v[72:75], a[220:223], v[44:47], v[72:75]
    s_waitcnt lgkmcnt(6)
    v_mfma_f32_16x16x32_bf16 v[76:79], a[216:219], v[48:51], v[76:79]
    ds_read_b128 v[44:47], v13 offset:61440
    v_mfma_f32_16x16x32_bf16 v[80:83], a[220:223], v[48:51], v[80:83]
    s_waitcnt lgkmcnt(6)
    v_mfma_f32_16x16x32_bf16 v[68:71], a[224:227], v[20:23], v[68:71]
    ds_read_b128 v[48:51], v13 offset:61696
    v_mfma_f32_16x16x32_bf16 v[72:75], a[228:231], v[20:23], v[72:75]
    s_waitcnt lgkmcnt(6)
    v_mfma_f32_16x16x32_bf16 v[76:79], a[224:227], v[24:27], v[76:79]
    s_waitcnt vmcnt(8)
    s_barrier
    ds_read_b128 v[20:23], v10 offset:0
    v_mfma_f32_16x16x32_bf16 v[80:83], a[228:231], v[24:27], v[80:83]
    s_waitcnt lgkmcnt(6)
    v_mfma_f32_16x16x32_bf16 v[68:71], a[232:235], v[28:31], v[68:71]
    ds_read_b128 v[24:27], v10 offset:256
    s_add_u32 m0, s19, 65536
    v_mfma_f32_16x16x32_bf16 v[72:75], a[236:239], v[28:31], v[72:75]
    s_add_u32 s17, s20, 0
    buffer_load_dwordx4 v2, s[4:7], s17 offen lds
    s_waitcnt lgkmcnt(6)
    v_mfma_f32_16x16x32_bf16 v[76:79], a[232:235], v[32:35], v[76:79]
    ds_read_b128 v[28:31], v11 offset:0
    v_mfma_f32_16x16x32_bf16 v[80:83], a[236:239], v[32:35], v[80:83]
    s_waitcnt lgkmcnt(6)
    v_mfma_f32_16x16x32_bf16 v[68:71], a[240:243], v[36:39], v[68:71]
    ds_read_b128 v[32:35], v11 offset:256
    s_add_u32 m0, s19, 69632
    v_mfma_f32_16x16x32_bf16 v[72:75], a[244:247], v[36:39], v[72:75]
    s_add_u32 s17, s20, 264192
    buffer_load_dwordx4 v2, s[4:7], s17 offen lds
    s_waitcnt lgkmcnt(6)
    v_mfma_f32_16x16x32_bf16 v[76:79], a[240:243], v[40:43], v[76:79]
    ds_read_b128 v[36:39], v10 offset:4096
    v_mfma_f32_16x16x32_bf16 v[80:83], a[244:247], v[40:43], v[80:83]
    s_waitcnt lgkmcnt(6)
    v_mfma_f32_16x16x32_bf16 v[68:71], a[248:251], v[44:47], v[68:71]
    ds_read_b128 v[40:43], v10 offset:4352
    s_add_u32 m0, s19, 73728
    v_mfma_f32_16x16x32_bf16 v[72:75], a[252:255], v[44:47], v[72:75]
    s_add_u32 s17, s20, 528384
    buffer_load_dwordx4 v2, s[4:7], s17 offen lds
    s_waitcnt lgkmcnt(6)
    v_mfma_f32_16x16x32_bf16 v[76:79], a[248:251], v[48:51], v[76:79]
    ds_read_b128 v[44:47], v11 offset:4096
    v_mfma_f32_16x16x32_bf16 v[80:83], a[252:255], v[48:51], v[80:83]
    s_add_u32 s22, s22, 2
    s_cmp_lt_u32 s22, 16
    s_cbranch_scc1 F3_top
    v_cvt_pk_bf16_f32 v84, v68, v69
    v_cvt_pk_bf16_f32 v85, v70, v71
    v_cvt_pk_bf16_f32 v86, v72, v73
    v_cvt_pk_bf16_f32 v87, v74, v75
    v_cvt_pk_bf16_f32 v88, v76, v77
    v_cvt_pk_bf16_f32 v89, v78, v79
    v_cvt_pk_bf16_f32 v90, v80, v81
    v_cvt_pk_bf16_f32 v91, v82, v83
    buffer_store_dwordx4 v[84:87], v3, s[12:15], s21 offen
    buffer_store_dwordx4 v[88:91], v4, s[12:15], s21 offen
    s_waitcnt vmcnt(0) lgkmcnt(0)
    s_branch W_T
W_T:
    v_and_b32 v7, 19, v1
    v_bfe_u32 v5, v1, 2, 1
    v_bfe_u32 v6, v1, 3, 1
    v_lshl_add_u32 v7, v5, 3, v7
    v_lshl_add_u32 v7, v6, 2, v7
    v_lshrrev_b32 v5, 5, v1
    v_and_b32 v6, 31, v1
    v_lshlrev_b32 v8, 4, v5
    v_lshl_add_u32 v10, v6, 6, v8
    v_lshl_add_u32 v11, v7, 6, v8
    v_mov_b32 v17, 1073741824
    v_cmp_gt_u32 vcc, 8, v6
    s_nop 1
    v_cndmask_b32 v12, v17, v10, vcc
    v_lshlrev_b32 v13, 3, v5
    v_lshl_add_u32 v13, v7, 4, v13
    v_and_b32 v14, 15, v1
    v_lshlrev_b32 v14, 4, v14
    v_lshl_add_u32 v14, v5, 8, v14
    v_bfe_u32 v8, v1, 4, 1
    v_lshl_add_u32 v14, v8, 17, v14
    v_lshrrev_b32 v15, 2, v1
    v_and_b32 v8, 3, v1
    v_lshl_add_u32 v15, v15, 7, v8
    s_lshl_b32 s17, s91, 2
    v_add_u32 v15, s17, v15
    v_lshlrev_b32 v15, 7, v15
    v_add_u32 v15, 100663296, v15
    v_cmp_gt_u32 vcc, 16, v1
    s_nop 1
    v_cndmask_b32 v15, v17, v15, vcc
    v_mov_b32 v16, 0
    s_add_u32 s18, s16, s17
    s_lshl_b32 s18, s18, 7
    s_add_u32 s18, s18, 100728832
    v_lshl_add_u32 v4, v1, 2, s18
    v_cmp_gt_u32 vcc, 32, v1
    s_nop 1
    v_cndmask_b32 v4, v17, v4, vcc
    v_lshlrev_b32 v5, 3, v5
    v_sub_u32 v6, v6, v5
    s_mov_b32 s29, 1040356334
    s_mov_b32 s28, s16
    s_mul_i32 s31, s17, 133120
    s_lshl_b32 s18, s28, 11
    s_add_u32 s31, s31, s18
    s_mul_i32 s32, s17, 33280
    s_lshl_b32 s18, s28, 9
    s_add_u32 s32, s32, s18
    s_add_u32 s32, s32, 71303168
    s_lshl_b32 s33, s28, 18
    s_lshl_b32 s18, s91, 12
    s_add_u32 s33, s33, s18
    s_add_u32 s33, s33, 54525952
    v_mov_b32 v17, 0xff800000
    s_mov_b32 s35, 0
    v_mov_b32 v9, 0
    v_cmp_le_i32 s[36:37], 0, v6
    v_cmp_le_i32 s[38:39], 1, v6
    v_cmp_le_i32 s[40:41], 2, v6
    v_cmp_le_i32 s[42:43], 3, v6
    v_cmp_le_i32 s[44:45], 4, v6
    v_cmp_le_i32 s[46:47], 5, v6
    v_cmp_le_i32 s[48:49], 6, v6
    v_cmp_le_i32 s[50:51], 7, v6
    v_cmp_le_i32 s[52:53], 16, v6
    v_cmp_le_i32 s[54:55], 17, v6
    v_cmp_le_i32 s[56:57], 18, v6
    v_cmp_le_i32 s[58:59], 19, v6
    v_cmp_le_i32 s[60:61], 20, v6
    v_cmp_le_i32 s[62:63], 21, v6
    v_cmp_le_i32 s[64:65], 22, v6
    v_cmp_le_i32 s[66:67], 23, v6
    v_mov_b32 v54, 0
    v_mov_b32 v55, 0
    v_mov_b32 v58, 0
    v_mov_b32 v59, 0
    v_mov_b32 v62, 0
    v_mov_b32 v63, 0
    v_mov_b32 v66, 0
    v_mov_b32 v67, 0
    v_mov_b32 v102, 0
    v_mov_b32 v103, 0
    v_mov_b32 v106, 0
    v_mov_b32 v107, 0
    v_mov_b32 v110, 0
    v_mov_b32 v111, 0
    v_mov_b32 v114, 0
    v_mov_b32 v115, 0
    v_mov_b32 v158, 0
    v_mov_b32 v159, 0
    s_mov_b32 s30, s92
T_p:
    v_cmp_ge_u32 vcc, s28, v16
    s_nop 0
    s_and_b32 s17, vcc_lo, 4095
    s_cbranch_scc0 T_pk
    s_cmp_ge_u32 s30, 1048576
    s_cselect_b32 s92, 1048576, s92
    s_cbranch_scc1 T_pk
    s_add_u32 s30, s30, 1
    buffer_load_dword v16, v15, s[4:7], 0 offen sc1
    s_sleep 8
    s_waitcnt vmcnt(0)
    s_branch T_p
T_pk:
    s_add_u32 s17, s31, 0
    buffer_load_dwordx4 a[0:3], v10, s[4:7], s17 offen offset:0
    buffer_load_dwordx4 a[4:7], v10, s[4:7], s17 offen offset:32
    s_add_u32 s17, s31, 133120
    buffer_load_dwordx4 a[8:11], v10, s[4:7], s17 offen offset:0
    buffer_load_dwordx4 a[12:15], v10, s[4:7], s17 offen offset:32
    s_add_u32 s17, s31, 266240
    buffer_load_dwordx4 a[16:19], v10, s[4:7], s17 offen offset:0
    buffer_load_dwordx4 a[20:23], v10, s[4:7], s17 offen offset:32
    s_add_u32 s17, s31, 399360
    buffer_load_dwordx4 a[24:27], v10, s[4:7], s17 offen offset:0
    buffer_load_dwordx4 a[28:31], v10, s[4:7], s17 offen offset:32
    s_add_u32 s17, s31, 17825792
    buffer_load_dwordx4 a[32:35], v11, s[4:7], s17 offen offset:0
    buffer_load_dwordx4 a[36:39], v11, s[4:7], s17 offen offset:32
    s_add_u32 s17, s31, 17958912
    buffer_load_dwordx4 a[40:43], v11, s[4:7], s17 offen offset:0
    buffer_load_dwordx4 a[44:47], v11, s[4:7], s17 offen offset:32
    s_add_u32 s17, s31, 18092032
    buffer_load_dwordx4 a[48:51], v11, s[4:7], s17 offen offset:0
    buffer_load_dwordx4 a[52:55], v11, s[4:7], s17 offen offset:32
    s_add_u32 s17, s31, 18225152
    buffer_load_dwordx4 a[56:59], v11, s[4:7], s17 offen offset:0
    buffer_load_dwordx4 a[60:63], v11, s[4:7], s17 offen offset:32
    s_add_u32 s17, s31, 35651584
    buffer_load_dwordx4 a[64:67], v11, s[4:7], s17 offen offset:0
    buffer_load_dwordx4 a[68:71], v11, s[4:7], s17 offen offset:32
    s_add_u32 s17, s31, 35784704
    buffer_load_dwordx4 a[72:75], v11, s[4:7], s17 offen offset:0
    buffer_load_dwordx4 a[76:79], v11, s[4:7], s17 offen offset:32
    s_add_u32 s17, s31, 35917824
    buffer_load_dwordx4 a[80:83], v11, s[4:7], s17 offen offset:0
    buffer_load_dwordx4 a[84:87], v11, s[4:7], s17 offen offset:32
    s_add_u32 s17, s31, 36050944
    buffer_load_dwordx4 a[88:91], v11, s[4:7], s17 offen offset:0
    buffer_load_dwordx4 a[92:95], v11, s[4:7], s17 offen offset:32
T_top0:
    s_cmp_eq_u32 s35, 0
    s_cbranch_scc1 T_slow0
T_go0:
    s_add_u32 s34, s28, 4
    s_min_u32 s68, s34, 63
    s_waitcnt vmcnt(8)
    v_cmp_ge_u32 vcc, s68, v16
    s_nop 0
    s_and_b32 s17, vcc_lo, 0xfff
    s_cbranch_scc1 T_pw0
T_pok0:
    s_add_u32 s31, s31, 8192
    s_add_u32 s32, s32, 2048
    s_and_b32 s17, vcc_lo, 0xf000
    s_cselect_b32 s35, 0, 1
    s_cselect_b32 s69, 1073741824, s32
    s_cmp_lt_u32 s34, 64
    s_cselect_b32 s68, s31, 1073741824
    s_cselect_b32 s69, s69, 1073741824
    buffer_load_dword v16, v15, s[4:7], 0 offen sc1
    v_mfma_f32_32x32x16_bf16 v[116:131], a[32:35], a[0:3], 0
    s_add_u32 s17, s68, 0
    buffer_load_dwordx4 a[96:99], v10, s[4:7], s17 offen offset:0
    buffer_load_dwordx4 a[100:103], v10, s[4:7], s17 offen offset:32
    v_mfma_f32_32x32x16_bf16 v[116:131], a[36:39], a[4:7], v[116:131]
    s_add_u32 s17, s68, 133120
    buffer_load_dwordx4 a[104:107], v10, s[4:7], s17 offen offset:0
    buffer_load_dwordx4 a[108:111], v10, s[4:7], s17 offen offset:32
    v_mfma_f32_32x32x16_bf16 v[116:131], a[40:43], a[8:11], v[116:131]
    s_add_u32 s17, s68, 266240
    buffer_load_dwordx4 a[112:115], v10, s[4:7], s17 offen offset:0
    buffer_load_dwordx4 a[116:119], v10, s[4:7], s17 offen offset:32
    v_mfma_f32_32x32x16_bf16 v[116:131], a[44:47], a[12:15], v[116:131]
    s_add_u32 s17, s68, 399360
    buffer_load_dwordx4 a[120:123], v10, s[4:7], s17 offen offset:0
    buffer_load_dwordx4 a[124:127], v10, s[4:7], s17 offen offset:32
    v_mfma_f32_32x32x16_bf16 v[116:131], a[48:51], a[16:19], v[116:131]
    s_add_u32 s17, s68, 17825792
    buffer_load_dwordx4 a[128:131], v11, s[4:7], s17 offen offset:0
    buffer_load_dwordx4 a[132:135], v11, s[4:7], s17 offen offset:32
    v_mfma_f32_32x32x16_bf16 v[116:131], a[52:55], a[20:23], v[116:131]
    s_add_u32 s17, s68, 17958912
    buffer_load_dwordx4 a[136:139], v11, s[4:7], s17 offen offset:0
    buffer_load_dwordx4 a[140:143], v11, s[4:7], s17 offen offset:32
    v_mfma_f32_32x32x16_bf16 v[116:131], a[56:59], a[24:27], v[116:131]
    s_add_u32 s17, s68, 18092032
    buffer_load_dwordx4 a[144:147], v11, s[4:7], s17 offen offset:0
    buffer_load_dwordx4 a[148:151], v11, s[4:7], s17 offen offset:32
    v_mfma_f32_32x32x16_bf16 v[116:131], a[60:63], a[28:31], v[116:131]
    s_add_u32 s17, s68, 18225152
    buffer_load_dwordx4 a[152:155], v11, s[4:7], s17 offen offset:0
    buffer_load_dwordx4 a[156:159], v11, s[4:7], s17 offen offset:32
    v_mfma_f32_32x32x16_bf16 v[132:147], v[20:23], a[0:3], 0
    s_add_u32 s17, s68, 35651584
    buffer_load_dwordx4 a[160:163], v11, s[4:7], s17 offen offset:0
    buffer_load_dwordx4 a[164:167], v11, s[4:7], s17 offen offset:32
    v_mfma_f32_32x32x16_bf16 v[132:147], v[24:27], a[4:7], v[132:147]
    s_add_u32 s17, s68, 35784704
    buffer_load_dwordx4 a[168:171], v11, s[4:7], s17 offen offset:0
    buffer_load_dwordx4 a[172:175], v11, s[4:7], s17 offen offset:32
    v_mfma_f32_32x32x16_bf16 v[132:147], v[28:31], a[8:11], v[132:147]
    s_add_u32 s17, s68, 35917824
    buffer_load_dwordx4 a[176:179], v11, s[4:7], s17 offen offset:0
    buffer_load_dwordx4 a[180:183], v11, s[4:7], s17 offen offset:32
    v_mfma_f32_32x32x16_bf16 v[132:147], v[32:35], a[12:15], v[132:147]
    s_add_u32 s17, s68, 36050944
    buffer_load_dwordx4 a[184:187], v11, s[4:7], s17 offen offset:0
    buffer_load_dwordx4 a[188:191], v11, s[4:7], s17 offen offset:32
    v_mfma_f32_32x32x16_bf16 v[132:147], v[36:39], a[16:19], v[132:147]
    s_add_u32 s17, s69, 0
    s_add_u32 s18, s69, 5242880
    buffer_load_dwordx4 v[68:71], v12, s[4:7], s17 offen offset:0
    buffer_load_dwordx4 v[72:75], v12, s[4:7], s17 offen offset:32
    buffer_load_dwordx2 v[100:101], v13, s[4:7], s18 offen
    v_mfma_f32_32x32x16_bf16 v[132:147], v[40:43], a[20:23], v[132:147]
    s_add_u32 s17, s69, 33280
    s_add_u32 s18, s69, 5276160
    buffer_load_dwordx4 v[76:79], v12, s[4:7], s17 offen offset:0
    buffer_load_dwordx4 v[80:83], v12, s[4:7], s17 offen offset:32
    buffer_load_dwordx2 v[104:105], v13, s[4:7], s18 offen
    v_mfma_f32_32x32x16_bf16 v[132:147], v[44:47], a[24:27], v[132:147]
    s_add_u32 s17, s69, 66560
    s_add_u32 s18, s69, 5309440
    buffer_load_dwordx4 v[84:87], v12, s[4:7], s17 offen offset:0
    buffer_load_dwordx4 v[88:91], v12, s[4:7], s17 offen offset:32
    buffer_load_dwordx2 v[108:109], v13, s[4:7], s18 offen
    v_mfma_f32_32x32x16_bf16 v[132:147], v[48:51], a[28:31], v[132:147]
    s_add_u32 s17, s69, 99840
    s_add_u32 s18, s69, 5342720
    buffer_load_dwordx4 v[92:95], v12, s[4:7], s17 offen offset:0
    buffer_load_dwordx4 v[96:99], v12, s[4:7], s17 offen offset:32
    buffer_load_dwordx2 v[112:113], v13, s[4:7], s18 offen
    v_cndmask_b32 v116, v17, v116, s[36:37]
    v_cndmask_b32 v117, v17, v117, s[38:39]
    v_cndmask_b32 v118, v17, v118, s[40:41]
    v_cndmask_b32 v119, v17, v119, s[42:43]
    v_cndmask_b32 v120, v17, v120, s[44:45]
    v_cndmask_b32 v121, v17, v121, s[46:47]
    v_cndmask_b32 v122, v17, v122, s[48:49]
    v_cndmask_b32 v123, v17, v123, s[50:51]
    v_cndmask_b32 v124, v17, v124, s[52:53]
    v_cndmask_b32 v125, v17, v125, s[54:55]
    v_cndmask_b32 v126, v17, v126, s[56:57]
    v_cndmask_b32 v127, v17, v127, s[58:59]
    v_cndmask_b32 v128, v17, v128, s[60:61]
    v_cndmask_b32 v129, v17, v129, s[62:63]
    v_cndmask_b32 v130, v17, v130, s[64:65]
    v_cndmask_b32 v131, v17, v131, s[66:67]
    v_max3_f32 v18, v116, v117, v118
    v_max3_f32 v18, v18, v119, v120
    v_max3_f32 v18, v18, v121, v122
    v_max3_f32 v18, v18, v123, v124
    v_max3_f32 v18, v18, v125, v126
    v_max3_f32 v18, v18, v127, v128
    v_max3_f32 v18, v18, v129, v130
    v_max3_f32 v18, v18, v131, v132
    v_max3_f32 v18, v18, v133, v134
    v_max_f32 v18, v18, v135
    v_mov_b32 v5, v18
    s_nop 1
    v_permlane32_swap_b32 v18, v5
    v_max_f32 v18, v18, v5
    v_mul_f32 v18, s29, v18
    v_fma_f32 v116, v116, s29, -v18
    v_fma_f32 v117, v117, s29, -v18
    v_fma_f32 v118, v118, s29, -v18
    v_fma_f32 v119, v119, s29, -v18
    v_fma_f32 v120, v120, s29, -v18
    v_fma_f32 v121, v121, s29, -v18
    v_fma_f32 v122, v122, s29, -v18
    v_fma_f32 v123, v123, s29, -v18
    v_fma_f32 v124, v124, s29, -v18
    v_fma_f32 v125, v125, s29, -v18
    v_fma_f32 v126, v126, s29, -v18
    v_fma_f32 v127, v127, s29, -v18
    v_fma_f32 v128, v128, s29, -v18
    v_fma_f32 v129, v129, s29, -v18
    v_fma_f32 v130, v130, s29, -v18
    v_fma_f32 v131, v131, s29, -v18
    v_fma_f32 v132, v132, s29, -v18
    v_fma_f32 v133, v133, s29, -v18
    v_fma_f32 v134, v134, s29, -v18
    v_fma_f32 v135, v135, s29, -v18
    v_exp_f32 v116, v116
    v_exp_f32 v117, v117
    v_exp_f32 v118, v118
    v_exp_f32 v119, v119
    v_exp_f32 v120, v120
    v_exp_f32 v121, v121
    v_exp_f32 v122, v122
    v_exp_f32 v123, v123
    v_exp_f32 v124, v124
    v_exp_f32 v125, v125
    v_exp_f32 v126, v126
    v_exp_f32 v127, v127
    v_exp_f32 v128, v128
    v_exp_f32 v129, v129
    v_exp_f32 v130, v130
    v_exp_f32 v131, v131
    v_exp_f32 v132, v132
    v_exp_f32 v133, v133
    v_exp_f32 v134, v134
    v_exp_f32 v135, v135
    s_waitcnt vmcnt(37)
    buffer_store_dword v9, v4, s[4:7], 0 offen sc1
    v_add_f32 v19, v116, v117
    v_add_f32 v6, v118, v119
    v_add_f32 v19, v19, v120
    v_add_f32 v6, v6, v121
    v_add_f32 v19, v19, v122
    v_add_f32 v6, v6, v123
    v_add_f32 v19, v19, v124
    v_add_f32 v6, v6, v125
    v_add_f32 v19, v19, v126
    v_add_f32 v6, v6, v127
    v_add_f32 v19, v19, v128
    v_add_f32 v6, v6, v129
    v_add_f32 v19, v19, v130
    v_add_f32 v6, v6, v131
    v_add_f32 v19, v19, v132
    v_add_f32 v6, v6, v133
    v_add_f32 v19, v19, v134
    v_add_f32 v6, v6, v135
    v_add_f32 v19, v19, v6
    v_mov_b32 v5, v19
    s_nop 1
    v_permlane32_swap_b32 v19, v5
    v_add_f32 v19, v19, v5
    v_rcp_f32 v19, v19
    s_nop 0
    v_mul_f32 v116, v116, v19
    v_mul_f32 v117, v117, v19
    v_mul_f32 v118, v118, v19
    v_mul_f32 v119, v119, v19
    v_mul_f32 v120, v120, v19
    v_mul_f32 v121, v121, v19
    v_mul_f32 v122, v122, v19
    v_mul_f32 v123, v123, v19
    v_mul_f32 v124, v124, v19
    v_mul_f32 v125, v125, v19
    v_mul_f32 v126, v126, v19
    v_mul_f32 v127, v127, v19
    v_mul_f32 v128, v128, v19
    v_mul_f32 v129, v129, v19
    v_mul_f32 v130, v130, v19
    v_mul_f32 v131, v131, v19
    v_mul_f32 v132, v132, v19
    v_mul_f32 v133, v133, v19
    v_mul_f32 v134, v134, v19
    v_mul_f32 v135, v135, v19
    v_cvt_pk_bf16_f32 v148, v116, v117
    v_cvt_pk_bf16_f32 v149, v118, v119
    v_cvt_pk_bf16_f32 v150, v120, v121
    v_cvt_pk_bf16_f32 v151, v122, v123
    v_cvt_pk_bf16_f32 v152, v124, v125
    v_cvt_pk_bf16_f32 v153, v126, v127
    v_cvt_pk_bf16_f32 v154, v128, v129
    v_cvt_pk_bf16_f32 v155, v130, v131
    v_cvt_pk_bf16_f32 v156, v132, v133
    v_cvt_pk_bf16_f32 v157, v134, v135
    v_mfma_f32_32x32x16_bf16 v[160:175], a[64:67], v[148:151], 0
    v_mfma_f32_32x32x16_bf16 v[160:175], a[68:71], v[152:155], v[160:175]
    v_mfma_f32_32x32x16_bf16 v[160:175], v[52:55], v[156:159], v[160:175]
    v_mfma_f32_32x32x16_bf16 v[176:191], a[72:75], v[148:151], 0
    v_mfma_f32_32x32x16_bf16 v[176:191], a[76:79], v[152:155], v[176:191]
    v_mfma_f32_32x32x16_bf16 v[176:191], v[56:59], v[156:159], v[176:191]
    s_nop 2
    v_cvt_pk_bf16_f32 v224, v160, v161
    v_cvt_pk_bf16_f32 v225, v162, v163
    v_cvt_pk_bf16_f32 v226, v164, v165
    v_cvt_pk_bf16_f32 v227, v166, v167
    v_cvt_pk_bf16_f32 v228, v168, v169
    v_cvt_pk_bf16_f32 v229, v170, v171
    v_cvt_pk_bf16_f32 v230, v172, v173
    v_cvt_pk_bf16_f32 v231, v174, v175
    buffer_store_dwordx4 v[224:227], v14, s[4:7], s33 offen offset:0 sc1
    buffer_store_dwordx4 v[228:231], v14, s[4:7], s33 offen offset:512 sc1
    v_mfma_f32_32x32x16_bf16 v[192:207], a[80:83], v[148:151], 0
    v_mfma_f32_32x32x16_bf16 v[192:207], a[84:87], v[152:155], v[192:207]
    v_mfma_f32_32x32x16_bf16 v[192:207], v[60:63], v[156:159], v[192:207]
    v_cvt_pk_bf16_f32 v232, v176, v177
    v_cvt_pk_bf16_f32 v233, v178, v179
    v_cvt_pk_bf16_f32 v234, v180, v181
    v_cvt_pk_bf16_f32 v235, v182, v183
    v_cvt_pk_bf16_f32 v236, v184, v185
    v_cvt_pk_bf16_f32 v237, v186, v187
    v_cvt_pk_bf16_f32 v238, v188, v189
    v_cvt_pk_bf16_f32 v239, v190, v191
    buffer_store_dwordx4 v[232:235], v14, s[4:7], s33 offen offset:1024 sc1
    buffer_store_dwordx4 v[236:239], v14, s[4:7], s33 offen offset:1536 sc1
    v_mfma_f32_32x32x16_bf16 v[208:223], a[88:91], v[148:151], 0
    v_mfma_f32_32x32x16_bf16 v[208:223], a[92:95], v[152:155], v[208:223]
    v_mfma_f32_32x32x16_bf16 v[208:223], v[64:67], v[156:159], v[208:223]
    v_cvt_pk_bf16_f32 v240, v192, v193
    v_cvt_pk_bf16_f32 v241, v194, v195
    v_cvt_pk_bf16_f32 v242, v196, v197
    v_cvt_pk_bf16_f32 v243, v198, v199
    v_cvt_pk_bf16_f32 v244, v200, v201
    v_cvt_pk_bf16_f32 v245, v202, v203
    v_cvt_pk_bf16_f32 v246, v204, v205
    v_cvt_pk_bf16_f32 v247, v206, v207
    buffer_store_dwordx4 v[240:243], v14, s[4:7], s33 offen offset:2048 sc1
    buffer_store_dwordx4 v[244:247], v14, s[4:7], s33 offen offset:2560 sc1
    v_add_u32 v9, 1, v9
    s_nop 0
    v_cvt_pk_bf16_f32 v248, v208, v209
    v_cvt_pk_bf16_f32 v249, v210, v211
    v_cvt_pk_bf16_f32 v250, v212, v213
    v_cvt_pk_bf16_f32 v251, v214, v215
    v_cvt_pk_bf16_f32 v252, v216, v217
    v_cvt_pk_bf16_f32 v253, v218, v219
    v_cvt_pk_bf16_f32 v254, v220, v221
    v_cvt_pk_bf16_f32 v255, v222, v223
    buffer_store_dwordx4 v[248:251], v14, s[4:7], s33 offen offset:3072 sc1
    buffer_store_dwordx4 v[252:255], v14, s[4:7], s33 offen offset:3584 sc1
    s_mov_b32 s28, s34
    s_add_u32 s33, s33, 1048576
T_top1:
    s_cmp_eq_u32 s35, 0
    s_cbranch_scc1 T_slow1
T_go1:
    s_add_u32 s34, s28, 4
    s_min_u32 s68, s34, 63
    s_waitcnt vmcnt(8)
    v_cmp_ge_u32 vcc, s68, v16
    s_nop 0
    s_and_b32 s17, vcc_lo, 0xfff
    s_cbranch_scc1 T_pw1
T_pok1:
    s_add_u32 s31, s31, 8192
    s_add_u32 s32, s32, 2048
    s_and_b32 s17, vcc_lo, 0xf000
    s_cselect_b32 s35, 0, 1
    s_cselect_b32 s69, 1073741824, s32
    s_cmp_lt_u32 s34, 64
    s_cselect_b32 s68, s31, 1073741824
    s_cselect_b32 s69, s69, 1073741824
    buffer_load_dword v16, v15, s[4:7], 0 offen sc1
    v_mfma_f32_32x32x16_bf16 v[116:131], a[128:131], a[96:99], 0
    s_add_u32 s17, s68, 0
    buffer_load_dwordx4 a[0:3], v10, s[4:7], s17 offen offset:0
    buffer_load_dwordx4 a[4:7], v10, s[4:7], s17 offen offset:32
    v_mfma_f32_32x32x16_bf16 v[116:131], a[132:135], a[100:103], v[116:131]
    s_add_u32 s17, s68, 133120
    buffer_load_dwordx4 a[8:11], v10, s[4:7], s17 offen offset:0
    buffer_load_dwordx4 a[12:15], v10, s[4:7], s17 offen offset:32
    v_mfma_f32_32x32x16_bf16 v[116:131], a[136:139], a[104:107], v[116:131]
    s_add_u32 s17, s68, 266240
    buffer_load_dwordx4 a[16:19], v10, s[4:7], s17 offen offset:0
    buffer_load_dwordx4 a[20:23], v10, s[4:7], s17 offen offset:32
    v_mfma_f32_32x32x16_bf16 v[116:131], a[140:143], a[108:111], v[116:131]
    s_add_u32 s17, s68, 399360
    buffer_load_dwordx4 a[24:27], v10, s[4:7], s17 offen offset:0
    buffer_load_dwordx4 a[28:31], v10, s[4:7], s17 offen offset:32
    v_mfma_f32_32x32x16_bf16 v[116:131], a[144:147], a[112:115], v[116:131]
    s_add_u32 s17, s68, 17825792
    buffer_load_dwordx4 a[32:35], v11, s[4:7], s17 offen offset:0
    buffer_load_dwordx4 a[36:39], v11, s[4:7], s17 offen offset:32
    v_mfma_f32_32x32x16_bf16 v[116:131], a[148:151], a[116:119], v[116:131]
    s_add_u32 s17, s68, 17958912
    buffer_load_dwordx4 a[40:43], v11, s[4:7], s17 offen offset:0
    buffer_load_dwordx4 a[44:47], v11, s[4:7], s17 offen offset:32
    v_mfma_f32_32x32x16_bf16 v[116:131], a[152:155], a[120:123], v[116:131]
    s_add_u32 s17, s68, 18092032
    buffer_load_dwordx4 a[48:51], v11, s[4:7], s17 offen offset:0
    buffer_load_dwordx4 a[52:55], v11, s[4:7], s17 offen offset:32
    v_mfma_f32_32x32x16_bf16 v[116:131], a[156:159], a[124:127], v[116:131]
    s_add_u32 s17, s68, 18225152
    buffer_load_dwordx4 a[56:59], v11, s[4:7], s17 offen offset:0
    buffer_load_dwordx4 a[60:63], v11, s[4:7], s17 offen offset:32
    v_mfma_f32_32x32x16_bf16 v[132:147], v[68:71], a[96:99], 0
    s_add_u32 s17, s68, 35651584
    buffer_load_dwordx4 a[64:67], v11, s[4:7], s17 offen offset:0
    buffer_load_dwordx4 a[68:71], v11, s[4:7], s17 offen offset:32
    v_mfma_f32_32x32x16_bf16 v[132:147], v[72:75], a[100:103], v[132:147]
    s_add_u32 s17, s68, 35784704
    buffer_load_dwordx4 a[72:75], v11, s[4:7], s17 offen offset:0
    buffer_load_dwordx4 a[76:79], v11, s[4:7], s17 offen offset:32
    v_mfma_f32_32x32x16_bf16 v[132:147], v[76:79], a[104:107], v[132:147]
    s_add_u32 s17, s68, 35917824
    buffer_load_dwordx4 a[80:83], v11, s[4:7], s17 offen offset:0
    buffer_load_dwordx4 a[84:87], v11, s[4:7], s17 offen offset:32
    v_mfma_f32_32x32x16_bf16 v[132:147], v[80:83], a[108:111], v[132:147]
    s_add_u32 s17, s68, 36050944
    buffer_load_dwordx4 a[88:91], v11, s[4:7], s17 offen offset:0
    buffer_load_dwordx4 a[92:95], v11, s[4:7], s17 offen offset:32
    v_mfma_f32_32x32x16_bf16 v[132:147], v[84:87], a[112:115], v[132:147]
    s_add_u32 s17, s69, 0
    s_add_u32 s18, s69, 5242880
    buffer_load_dwordx4 v[20:23], v12, s[4:7], s17 offen offset:0
    buffer_load_dwordx4 v[24:27], v12, s[4:7], s17 offen offset:32
    buffer_load_dwordx2 v[52:53], v13, s[4:7], s18 offen
    v_mfma_f32_32x32x16_bf16 v[132:147], v[88:91], a[116:119], v[132:147]
    s_add_u32 s17, s69, 33280
    s_add_u32 s18, s69, 5276160
    buffer_load_dwordx4 v[28:31], v12, s[4:7], s17 offen offset:0
    buffer_load_dwordx4 v[32:35], v12, s[4:7], s17 offen offset:32
    buffer_load_dwordx2 v[56:57], v13, s[4:7], s18 offen
    v_mfma_f32_32x32x16_bf16 v[132:147], v[92:95], a[120:123], v[132:147]
    s_add_u32 s17, s69, 66560
    s_add_u32 s18, s69, 5309440
    buffer_load_dwordx4 v[36:39], v12, s[4:7], s17 offen offset:0
    buffer_load_dwordx4 v[40:43], v12, s[4:7], s17 offen offset:32
    buffer_load_dwordx2 v[60:61], v13, s[4:7], s18 offen
    v_mfma_f32_32x32x16_bf16 v[132:147], v[96:99], a[124:127], v[132:147]
    s_add_u32 s17, s69, 99840
    s_add_u32 s18, s69, 5342720
    buffer_load_dwordx4 v[44:47], v12, s[4:7], s17 offen offset:0
    buffer_load_dwordx4 v[48:51], v12, s[4:7], s17 offen offset:32
    buffer_load_dwordx2 v[64:65], v13, s[4:7], s18 offen
    v_cndmask_b32 v116, v17, v116, s[36:37]
    v_cndmask_b32 v117, v17, v117, s[38:39]
    v_cndmask_b32 v118, v17, v118, s[40:41]
    v_cndmask_b32 v119, v17, v119, s[42:43]
    v_cndmask_b32 v120, v17, v120, s[44:45]
    v_cndmask_b32 v121, v17, v121, s[46:47]
    v_cndmask_b32 v122, v17, v122, s[48:49]
    v_cndmask_b32 v123, v17, v123, s[50:51]
    v_cndmask_b32 v124, v17, v124, s[52:53]
    v_cndmask_b32 v125, v17, v125, s[54:55]
    v_cndmask_b32 v126, v17, v126, s[56:57]
    v_cndmask_b32 v127, v17, v127, s[58:59]
    v_cndmask_b32 v128, v17, v128, s[60:61]
    v_cndmask_b32 v129, v17, v129, s[62:63]
    v_cndmask_b32 v130, v17, v130, s[64:65]
    v_cndmask_b32 v131, v17, v131, s[66:67]
    v_max3_f32 v18, v116, v117, v118
    v_max3_f32 v18, v18, v119, v120
    v_max3_f32 v18, v18, v121, v122
    v_max3_f32 v18, v18, v123, v124
    v_max3_f32 v18, v18, v125, v126
    v_max3_f32 v18, v18, v127, v128
    v_max3_f32 v18, v18, v129, v130
    v_max3_f32 v18, v18, v131, v132
    v_max3_f32 v18, v18, v133, v134
    v_max_f32 v18, v18, v135
    v_mov_b32 v5, v18
    s_nop 1
    v_permlane32_swap_b32 v18, v5
    v_max_f32 v18, v18, v5
    v_mul_f32 v18, s29, v18
    v_fma_f32 v116, v116, s29, -v18
    v_fma_f32 v117, v117, s29, -v18
    v_fma_f32 v118, v118, s29, -v18
    v_fma_f32 v119, v119, s29, -v18
    v_fma_f32 v120, v120, s29, -v18
    v_fma_f32 v121, v121, s29, -v18
    v_fma_f32 v122, v122, s29, -v18
    v_fma_f32 v123, v123, s29, -v18
    v_fma_f32 v124, v124, s29, -v18
    v_fma_f32 v125, v125, s29, -v18
    v_fma_f32 v126, v126, s29, -v18
    v_fma_f32 v127, v127, s29, -v18
    v_fma_f32 v128, v128, s29, -v18
    v_fma_f32 v129, v129, s29, -v18
    v_fma_f32 v130, v130, s29, -v18
    v_fma_f32 v131, v131, s29, -v18
    v_fma_f32 v132, v132, s29, -v18
    v_fma_f32 v133, v133, s29, -v18
    v_fma_f32 v134, v134, s29, -v18
    v_fma_f32 v135, v135, s29, -v18
    v_exp_f32 v116, v116
    v_exp_f32 v117, v117
    v_exp_f32 v118, v118
    v_exp_f32 v119, v119
    v_exp_f32 v120, v120
    v_exp_f32 v121, v121
    v_exp_f32 v122, v122
    v_exp_f32 v123, v123
    v_exp_f32 v124, v124
    v_exp_f32 v125, v125
    v_exp_f32 v126, v126
    v_exp_f32 v127, v127
    v_exp_f32 v128, v128
    v_exp_f32 v129, v129
    v_exp_f32 v130, v130
    v_exp_f32 v131, v131
    v_exp_f32 v132, v132
    v_exp_f32 v133, v133
    v_exp_f32 v134, v134
    v_exp_f32 v135, v135
    s_waitcnt vmcnt(37)
    buffer_store_dword v9, v4, s[4:7], 0 offen sc1
    v_add_f32 v19, v116, v117
    v_add_f32 v6, v118, v119
    v_add_f32 v19, v19, v120
    v_add_f32 v6, v6, v121
    v_add_f32 v19, v19, v122
    v_add_f32 v6, v6, v123
    v_add_f32 v19, v19, v124
    v_add_f32 v6, v6, v125
    v_add_f32 v19, v19, v126
    v_add_f32 v6, v6, v127
    v_add_f32 v19, v19, v128
    v_add_f32 v6, v6, v129
    v_add_f32 v19, v19, v130
    v_add_f32 v6, v6, v131
    v_add_f32 v19, v19, v132
    v_add_f32 v6, v6, v133
    v_add_f32 v19, v19, v134
    v_add_f32 v6, v6, v135
    v_add_f32 v19, v19, v6
    v_mov_b32 v5, v19
    s_nop 1
    v_permlane32_swap_b32 v19, v5
    v_add_f32 v19, v19, v5
    v_rcp_f32 v19, v19
    s_nop 0
    v_mul_f32 v116, v116, v19
    v_mul_f32 v117, v117, v19
    v_mul_f32 v118, v118, v19
    v_mul_f32 v119, v119, v19
    v_mul_f32 v120, v120, v19
    v_mul_f32 v121, v121, v19
    v_mul_f32 v122, v122, v19
    v_mul_f32 v123, v123, v19
    v_mul_f32 v124, v124, v19
    v_mul_f32 v125, v125, v19
    v_mul_f32 v126, v126, v19
    v_mul_f32 v127, v127, v19
    v_mul_f32 v128, v128, v19
    v_mul_f32 v129, v129, v19
    v_mul_f32 v130, v130, v19
    v_mul_f32 v131, v131, v19
    v_mul_f32 v132, v132, v19
    v_mul_f32 v133, v133, v19
    v_mul_f32 v134, v134, v19
    v_mul_f32 v135, v135, v19
    v_cvt_pk_bf16_f32 v148, v116, v117
    v_cvt_pk_bf16_f32 v149, v118, v119
    v_cvt_pk_bf16_f32 v150, v120, v121
    v_cvt_pk_bf16_f32 v151, v122, v123
    v_cvt_pk_bf16_f32 v152, v124, v125
    v_cvt_pk_bf16_f32 v153, v126, v127
    v_cvt_pk_bf16_f32 v154, v128, v129
    v_cvt_pk_bf16_f32 v155, v130, v131
    v_cvt_pk_bf16_f32 v156, v132, v133
    v_cvt_pk_bf16_f32 v157, v134, v135
    v_mfma_f32_32x32x16_bf16 v[160:175], a[160:163], v[148:151], 0
    v_mfma_f32_32x32x16_bf16 v[160:175], a[164:167], v[152:155], v[160:175]
    v_mfma_f32_32x32x16_bf16 v[160:175], v[100:103], v[156:159], v[160:175]
    v_mfma_f32_32x32x16_bf16 v[176:191], a[168:171], v[148:151], 0
    v_mfma_f32_32x32x16_bf16 v[176:191], a[172:175], v[152:155], v[176:191]
    v_mfma_f32_32x32x16_bf16 v[176:191], v[104:107], v[156:159], v[176:191]
    s_nop 2
    v_cvt_pk_bf16_f32 v224, v160, v161
    v_cvt_pk_bf16_f32 v225, v162, v163
    v_cvt_pk_bf16_f32 v226, v164, v165
    v_cvt_pk_bf16_f32 v227, v166, v167
    v_cvt_pk_bf16_f32 v228, v168, v169
    v_cvt_pk_bf16_f32 v229, v170, v171
    v_cvt_pk_bf16_f32 v230, v172, v173
    v_cvt_pk_bf16_f32 v231, v174, v175
    buffer_store_dwordx4 v[224:227], v14, s[4:7], s33 offen offset:0 sc1
    buffer_store_dwordx4 v[228:231], v14, s[4:7], s33 offen offset:512 sc1
    v_mfma_f32_32x32x16_bf16 v[192:207], a[176:179], v[148:151], 0
    v_mfma_f32_32x32x16_bf16 v[192:207], a[180:183], v[152:155], v[192:207]
    v_mfma_f32_32x32x16_bf16 v[192:207], v[108:111], v[156:159], v[192:207]
    v_cvt_pk_bf16_f32 v232, v176, v177
    v_cvt_pk_bf16_f32 v233, v178, v179
    v_cvt_pk_bf16_f32 v234, v180, v181
    v_cvt_pk_bf16_f32 v235, v182, v183
    v_cvt_pk_bf16_f32 v236, v184, v185
    v_cvt_pk_bf16_f32 v237, v186, v187
    v_cvt_pk_bf16_f32 v238, v188, v189
    v_cvt_pk_bf16_f32 v239, v190, v191
    buffer_store_dwordx4 v[232:235], v14, s[4:7], s33 offen offset:1024 sc1
    buffer_store_dwordx4 v[236:239], v14, s[4:7], s33 offen offset:1536 sc1
    v_mfma_f32_32x32x16_bf16 v[208:223], a[184:187], v[148:151], 0
    v_mfma_f32_32x32x16_bf16 v[208:223], a[188:191], v[152:155], v[208:223]
    v_mfma_f32_32x32x16_bf16 v[208:223], v[112:115], v[156:159], v[208:223]
    v_cvt_pk_bf16_f32 v240, v192, v193
    v_cvt_pk_bf16_f32 v241, v194, v195
    v_cvt_pk_bf16_f32 v242, v196, v197
    v_cvt_pk_bf16_f32 v243, v198, v199
    v_cvt_pk_bf16_f32 v244, v200, v201
    v_cvt_pk_bf16_f32 v245, v202, v203
    v_cvt_pk_bf16_f32 v246, v204, v205
    v_cvt_pk_bf16_f32 v247, v206, v207
    buffer_store_dwordx4 v[240:243], v14, s[4:7], s33 offen offset:2048 sc1
    buffer_store_dwordx4 v[244:247], v14, s[4:7], s33 offen offset:2560 sc1
    v_add_u32 v9, 1, v9
    s_nop 0
    v_cvt_pk_bf16_f32 v248, v208, v209
    v_cvt_pk_bf16_f32 v249, v210, v211
    v_cvt_pk_bf16_f32 v250, v212, v213
    v_cvt_pk_bf16_f32 v251, v214, v215
    v_cvt_pk_bf16_f32 v252, v216, v217
    v_cvt_pk_bf16_f32 v253, v218, v219
    v_cvt_pk_bf16_f32 v254, v220, v221
    v_cvt_pk_bf16_f32 v255, v222, v223
    buffer_store_dwordx4 v[248:251], v14, s[4:7], s33 offen offset:3072 sc1
    buffer_store_dwordx4 v[252:255], v14, s[4:7], s33 offen offset:3584 sc1
    s_mov_b32 s28, s34
    s_add_u32 s33, s33, 1048576
    s_cmp_lt_u32 s28, 64
    s_cbranch_scc1 T_top0
    s_waitcnt vmcnt(0)
    buffer_store_dword v9, v4, s[4:7], 0 offen sc1
    s_branch W_fin
T_slow0:
    s_waitcnt vmcnt(0)
    buffer_store_dword v9, v4, s[4:7], 0 offen sc1
    s_mov_b32 s30, s92
T_s0:
    v_cmp_ge_u32 vcc, s28, v16
    s_nop 0
    s_and_b32 s17, vcc_lo, 61440
    s_cbranch_scc0 T_sk0
    s_cmp_ge_u32 s30, 1048576
    s_cselect_b32 s92, 1048576, s92
    s_cbranch_scc1 T_sk0
    s_add_u32 s30, s30, 1
    buffer_load_dword v16, v15, s[4:7], 0 offen sc1
    s_sleep 2
    s_waitcnt vmcnt(0)
    s_branch T_s0
T_sk0:
    s_add_u32 s17, s32, 0
    s_add_u32 s18, s32, 5242880
    buffer_load_dwordx4 v[20:23], v12, s[4:7], s17 offen offset:0
    buffer_load_dwordx4 v[24:27], v12, s[4:7], s17 offen offset:32
    buffer_load_dwordx2 v[52:53], v13, s[4:7], s18 offen
    s_add_u32 s17, s32, 33280
    s_add_u32 s18, s32, 5276160
    buffer_load_dwordx4 v[28:31], v12, s[4:7], s17 offen offset:0
    buffer_load_dwordx4 v[32:35], v12, s[4:7], s17 offen offset:32
    buffer_load_dwordx2 v[56:57], v13, s[4:7], s18 offen
    s_add_u32 s17, s32, 66560
    s_add_u32 s18, s32, 5309440
    buffer_load_dwordx4 v[36:39], v12, s[4:7], s17 offen offset:0
    buffer_load_dwordx4 v[40:43], v12, s[4:7], s17 offen offset:32
    buffer_load_dwordx2 v[60:61], v13, s[4:7], s18 offen
    s_add_u32 s17, s32, 99840
    s_add_u32 s18, s32, 5342720
    buffer_load_dwordx4 v[44:47], v12, s[4:7], s17 offen offset:0
    buffer_load_dwordx4 v[48:51], v12, s[4:7], s17 offen offset:32
    buffer_load_dwordx2 v[64:65], v13, s[4:7], s18 offen
    s_waitcnt vmcnt(0)
    s_branch T_go0
T_pw0:
    s_mov_b32 s30, s92
T_q0:
    v_cmp_ge_u32 vcc, s68, v16
    s_nop 0
    s_and_b32 s17, vcc_lo, 4095
    s_cbranch_scc0 T_pok0
    s_cmp_ge_u32 s30, 1048576
    s_cselect_b32 s92, 1048576, s92
    s_cbranch_scc1 T_pok0
    s_add_u32 s30, s30, 1
    buffer_load_dword v16, v15, s[4:7], 0 offen sc1
    s_sleep 8
    s_waitcnt vmcnt(0)
    s_branch T_q0
T_slow1:
    s_waitcnt vmcnt(0)
    buffer_store_dword v9, v4, s[4:7], 0 offen sc1
    s_mov_b32 s30, s92
T_s1:
    v_cmp_ge_u32 vcc, s28, v16
    s_nop 0
    s_and_b32 s17, vcc_lo, 61440
    s_cbranch_scc0 T_sk1
    s_cmp_ge_u32 s30, 1048576
    s_cselect_b32 s92, 1048576, s92
    s_cbranch_scc1 T_sk1
    s_add_u32 s30, s30, 1
    buffer_load_dword v16, v15, s[4:7], 0 offen sc1
    s_sleep 2
    s_waitcnt vmcnt(0)
    s_branch T_s1
T_sk1:
    s_add_u32 s17, s32, 0
    s_add_u32 s18, s32, 5242880
    buffer_load_dwordx4 v[68:71], v12, s[4:7], s17 offen offset:0
    buffer_load_dwordx4 v[72:75], v12, s[4:7], s17 offen offset:32
    buffer_load_dwordx2 v[100:101], v13, s[4:7], s18 offen
    s_add_u32 s17, s32, 33280
    s_add_u32 s18, s32, 5276160
    buffer_load_dwordx4 v[76:79], v12, s[4:7], s17 offen offset:0
    buffer_load_dwordx4 v[80:83], v12, s[4:7], s17 offen offset:32
    buffer_load_dwordx2 v[104:105], v13, s[4:7], s18 offen
    s_add_u32 s17, s32, 66560
    s_add_u32 s18, s32, 5309440
    buffer_load_dwordx4 v[84:87], v12, s[4:7], s17 offen offset:0
    buffer_load_dwordx4 v[88:91], v12, s[4:7], s17 offen offset:32
    buffer_load_dwordx2 v[108:109], v13, s[4:7], s18 offen
    s_add_u32 s17, s32, 99840
    s_add_u32 s18, s32, 5342720
    buffer_load_dwordx4 v[92:95], v12, s[4:7], s17 offen offset:0
    buffer_load_dwordx4 v[96:99], v12, s[4:7], s17 offen offset:32
    buffer_load_dwordx2 v[112:113], v13, s[4:7], s18 offen
    s_waitcnt vmcnt(0)
    s_branch T_go1
T_pw1:
    s_mov_b32 s30, s92
T_q1:
    v_cmp_ge_u32 vcc, s68, v16
    s_nop 0
    s_and_b32 s17, vcc_lo, 4095
    s_cbranch_scc0 T_pok1
    s_cmp_ge_u32 s30, 1048576
    s_cselect_b32 s92, 1048576, s92
    s_cbranch_scc1 T_pok1
    s_add_u32 s30, s30, 1
    buffer_load_dword v16, v15, s[4:7], 0 offen sc1
    s_sleep 8
    s_waitcnt vmcnt(0)
    s_branch T_q1
W_fin:
W_end:
    s_endpgm
R_entry:
    s_mov_b32 s12, s3
    s_lshr_b32 s13, s2, 3
    s_load_dwordx2 s[4:5], s[0:1], 96
    s_load_dwordx2 s[28:29], s[0:1], 32
    s_load_dwordx2 s[30:31], s[0:1], 40
    s_load_dwordx2 s[32:33], s[0:1], 48
    s_load_dwordx2 s[34:35], s[0:1], 56
    s_load_dwordx2 s[36:37], s[0:1], 64
    v_lshrrev_b32 v19, 6, v0
    v_and_b32 v1, 63, v0
    v_readfirstlane_b32 s14, v19
    s_mov_b32 s6, 268435456
    s_mov_b32 s7, 0x20000
    s_mov_b32 s10, 8388608
    s_mov_b32 s11, 0x20000
    s_mov_b32 s25, 0
    s_mov_b32 s24, 1040356334
    s_waitcnt lgkmcnt(0)
    v_and_b32 v96, 7, v1
    v_bfe_u32 v97, v1, 3, 1
    v_lshrrev_b32 v98, 4, v1
    v_lshlrev_b32 v19, 4, v1
    s_lshl_b32 s21, s12, 14
    s_lshl_b32 s22, s14, 12
    s_add_u32 s21, s21, s22
    s_add_u32 s22, s21, 0
    v_add_u32 v2, s22, v19
    s_add_u32 s22, s21, 229376
    v_add_u32 v8, s22, v19
    s_lshr_b32 s21, s13, 1
    s_lshl_b32 s21, s21, 10
    s_and_b32 s22, s13, 1
    s_lshl_b32 s22, s22, 7
    s_add_u32 s21, s21, s22
    s_lshl_b32 s22, s12, 14
    s_add_u32 s21, s21, s22
    v_lshlrev_b32 v20, 8, v98
    v_lshl_add_u32 v20, v96, 4, v20
    v_lshl_add_u32 v20, v97, 3, v20
    s_add_u32 s22, s21, 229376
    v_add_u32 v7, s22, v20
    s_add_u32 s22, s21, 0
    v_add_u32 v11, s22, v20
    s_lshr_b32 s21, s13, 1
    s_lshl_b32 s21, s21, 14
    s_and_b32 s22, s13, 1
    s_lshl_b32 s22, s22, 12
    s_add_u32 s21, s21, s22
    s_lshl_b32 s22, s12, 10
    s_add_u32 s22, s21, s22
    v_add_u32 v9, s22, v19
    v_xor_b32 v10, 1024, v9
    v_xor_b32 v23, 2048, v9
    v_xor_b32 v244, 3072, v9
    s_mov_b32 s95, 167772160
    s_lshr_b32 s40, s13, 2
    s_lshl_b32 s21, s12, 3
    s_add_u32 s40, s40, s21
    s_and_b32 s41, s13, 3
    s_mul_i32 s21, s40, 5120
    s_add_u32 s21, s21, 65536
    v_add_u32 v5, s21, v19
    v_lshlrev_b32 v20, 2, v1
    s_add_u32 s22, s21, 4096
    v_add_u32 v6, s22, v20
    s_lshl_b32 s22, s41, 10
    s_add_u32 s22, s22, s21
    v_add_u32 v3, s22, v19
    v_mov_b32 v21, 1073741824
    v_cmp_eq_u32 vcc, 0, v97
    s_nop 1
    v_cndmask_b32 v3, v21, v3, vcc
    s_lshl_b32 s22, s41, 8
    s_add_u32 s22, s22, s21
    s_add_u32 s22, s22, 4096
    v_lshlrev_b32 v20, 4, v98
    v_lshl_add_u32 v20, v96, 5, v20
    v_add_u32 v4, s22, v20
    v_cndmask_b32 v4, v4, v21, vcc
    v_cmp_gt_u32 vcc, 2, v98
    s_nop 1
    v_cndmask_b32 v4, v21, v4, vcc
    s_lshl_b32 s27, s40, 7
    s_lshl_b32 s21, s41, 5
    s_add_u32 s27, s27, s21
    v_bfe_u32 v20, v1, 2, 2
    v_and_b32 v22, 3, v1
    v_lshl_add_u32 v20, v20, 3, v22
    v_lshlrev_b32 v12, 6, v20
    v_lshl_add_u32 v12, v98, 4, v12
    s_and_b32 s21, s14, 1
    s_lshl_b32 s21, s21, 14
    s_lshl_b32 s22, s27, 2
    s_add_u32 s21, s21, s22
    s_add_u32 s21, s21, 100679680
    v_mov_b32 v245, s21
    s_mov_b32 s85, 0
    s_mul_i32 s21, s27, 4160
    v_add_u32 v12, s21, v12
    v_mov_b32 v13, v12
    v_lshlrev_b32 v15, 4, v20
    v_lshl_add_u32 v15, v98, 5, v15
    s_mul_i32 s21, s27, 1040
    v_add_u32 v15, s21, v15
    v_and_b32 v22, 1, v98
    v_cmp_eq_u32 vcc, 0, v22
    s_nop 1
    v_cndmask_b32 v15, v21, v15, vcc
    v_lshlrev_b32 v14, 6, v96
    v_lshl_add_u32 v14, v98, 4, v14
    v_add_u32 v14, s21, v14
    v_cmp_eq_u32 vcc, 1, v97
    s_nop 1
    v_cndmask_b32 v14, v21, v14, vcc
    v_mov_b32 v16, v19
    s_lshl_b32 s21, s14, 11
    v_add_u32 v17, s21, v19
    v_and_b32 v20, 15, v1
    v_bfe_u32 v22, v1, 2, 2
    v_and_b32 v18, 1, v1
    v_lshl_add_u32 v18, v22, 1, v18
    v_bfe_u32 v22, v1, 1, 1
    v_lshl_add_u32 v18, v22, 3, v18
    s_cmp_eq_u32 s14, 1
    s_cselect_b64 vcc, -1, 0
    v_cndmask_b32 v20, v20, v18, vcc
    v_and_b32 v22, 1, v98
    v_lshlrev_b32 v22, 2, v22
    v_sub_u32 v20, v20, v22
    v_mov_b32 v22, 0x3f80
    v_mov_b32 v18, 0x3f800000
    v_mov_b32 v172, 0x4444
    v_mov_b32 v84, 0xeeee
    v_cmp_eq_u32 vcc, 1, v97
    s_nop 1
    v_cndmask_b32 v172, v172, v84, vcc
    v_cmp_eq_u32 vcc, 0, v20
    s_nop 1
    v_cndmask_b32 v84, 0, v22, vcc
    v_cmp_eq_u32 vcc, 1, v20
    s_nop 1
    v_cndmask_b32 v84, v84, v18, vcc
    v_cmp_eq_u32 vcc, 2, v20
    s_nop 1
    v_cndmask_b32 v85, 0, v22, vcc
    v_cmp_eq_u32 vcc, 3, v20
    s_nop 1
    v_cndmask_b32 v85, v85, v18, vcc
    v_cmp_eq_u32 vcc, 8, v20
    s_nop 1
    v_cndmask_b32 v86, 0, v22, vcc
    v_cmp_eq_u32 vcc, 9, v20
    s_nop 1
    v_cndmask_b32 v86, v86, v18, vcc
    v_cmp_eq_u32 vcc, 10, v20
    s_nop 1
    v_cndmask_b32 v87, 0, v22, vcc
    v_cmp_eq_u32 vcc, 11, v20
    s_nop 1
    v_cndmask_b32 v87, v87, v18, vcc
    s_mov_b32 s16, 81788928
    s_mov_b32 s42, 82083840
    s_mov_b32 s43, 82378752
    s_mov_b32 s44, 82673664
    s_mov_b32 s17, 17825792
    s_mov_b32 s18, 35651584
    s_mov_b32 s19, 71303168
    s_mov_b32 s20, 76546048
    s_mov_b32 s15, 0
    v_mov_b32 v204, -1
    v_mov_b32 v205, -1
    v_mov_b32 v206, -1
    v_mov_b32 v207, -1
    v_mov_b32 v236, 0x3f803f80
    v_mov_b32 v237, 0x3f803f80
    v_mov_b32 v238, 0x3f803f80
    v_mov_b32 v239, 0x3f803f80
    s_mul_i32 s22, s14, 294912
    s_add_u32 s22, s22, 81788928
    buffer_store_dwordx4 v[204:207], v3, s[4:7], s22 offen sc1
    buffer_store_dwordx4 v[204:207], v3, s[4:7], s22 offen offset:128 sc1
    buffer_store_dwordx4 v[204:207], v4, s[4:7], s22 offen sc1
    buffer_store_dwordx2 v[204:205], v7, s[4:7], s22 offen sc1
    buffer_store_dwordx2 v[204:205], v11, s[4:7], s22 offen sc1
    s_lshl_b32 s22, s14, 18
    s_add_u32 s22, s22, 167772160
    buffer_store_dwordx4 v[204:207], v9, s[4:7], s22 offen sc1
    s_add_u32 s22, s22, 8192
    buffer_store_dwordx4 v[204:207], v9, s[4:7], s22 offen sc1
    s_lshl_b32 s22, s27, 2
    s_add_u32 s22, s22, 100712448
    v_lshlrev_b32 v246, 2, v1
    v_add_u32 v246, s22, v246
    v_cmp_gt_u32 vcc, 32, v1
    s_nop 1
    v_cndmask_b32 v246, v21, v246, vcc
    v_mov_b32 v247, 0
    buffer_store_dword v247, v246, s[4:7], 0 offen sc1
    s_waitcnt vmcnt(0)
    s_barrier
    s_cmp_lg_u32 s14, 0
    s_cbranch_scc1 reg_17
    s_and_b32 s21, s2, 3
    s_lshl_b32 s21, s21, 3
    s_lshl_b32 s22, s98, 2
    s_add_u32 s21, s21, s22
    s_lshl_b32 s21, 1, s21
    s_andn2_b32 s22, s2, 3
    v_mov_b32 v20, s22
    v_mov_b32 v21, s21
    s_mov_b64 exec, 1
    global_atomic_add v20, v21, s[100:101] sc1
    s_mov_b64 exec, -1
reg_17:
    v_lshrrev_b32 v19, 2, v1
    v_and_b32 v22, 3, v1
    v_lshlrev_b32 v22, 4, v22
    v_lshl_add_u32 v20, v19, 13, v22
    v_lshl_add_u32 v21, v19, 11, v22
    v_bfe_u32 v19, v1, 2, 1
    v_lshl_add_u32 v19, v98, 2, v19
    v_lshl_add_u32 v19, v97, 5, v19
    v_lshl_add_u32 v22, v19, 6, v22
    s_lshl_b32 s21, s14, 15
    v_add_u32 v22, s21, v22
    s_mov_b32 s8, s30
    s_mov_b32 s9, s31
    s_lshl_b32 s21, s14, 21
    s_lshl_b32 s22, s27, 1
    s_add_u32 s21, s21, s22
    s_lshl_b32 s22, s14, 15
    s_add_u32 s22, s22, 0
    s_mov_b32 m0, s22
    s_nop 0
    buffer_load_dwordx4 v20, s[8:11], s21 offen lds
    s_add_u32 s21, s21, 131072
    s_add_u32 s22, s22, 1024
    s_mov_b32 m0, s22
    s_nop 0
    buffer_load_dwordx4 v20, s[8:11], s21 offen lds
    s_add_u32 s21, s21, 131072
    s_add_u32 s22, s22, 1024
    s_mov_b32 m0, s22
    s_nop 0
    buffer_load_dwordx4 v20, s[8:11], s21 offen lds
    s_add_u32 s21, s21, 131072
    s_add_u32 s22, s22, 1024
    s_mov_b32 m0, s22
    s_nop 0
    buffer_load_dwordx4 v20, s[8:11], s21 offen lds
    s_add_u32 s21, s21, 131072
    s_add_u32 s22, s22, 1024
    s_mov_b32 m0, s22
    s_nop 0
    buffer_load_dwordx4 v20, s[8:11], s21 offen lds
    s_add_u32 s21, s21, 131072
    s_add_u32 s22, s22, 1024
    s_mov_b32 m0, s22
    s_nop 0
    buffer_load_dwordx4 v20, s[8:11], s21 offen lds
    s_add_u32 s21, s21, 131072
    s_add_u32 s22, s22, 1024
    s_mov_b32 m0, s22
    s_nop 0
    buffer_load_dwordx4 v20, s[8:11], s21 offen lds
    s_add_u32 s21, s21, 131072
    s_add_u32 s22, s22, 1024
    s_mov_b32 m0, s22
    s_nop 0
    buffer_load_dwordx4 v20, s[8:11], s21 offen lds
    s_add_u32 s21, s21, 131072
    s_add_u32 s22, s22, 1024
    s_mov_b32 m0, s22
    s_nop 0
    buffer_load_dwordx4 v20, s[8:11], s21 offen lds
    s_add_u32 s21, s21, 131072
    s_add_u32 s22, s22, 1024
    s_mov_b32 m0, s22
    s_nop 0
    buffer_load_dwordx4 v20, s[8:11], s21 offen lds
    s_add_u32 s21, s21, 131072
    s_add_u32 s22, s22, 1024
    s_mov_b32 m0, s22
    s_nop 0
    buffer_load_dwordx4 v20, s[8:11], s21 offen lds
    s_add_u32 s21, s21, 131072
    s_add_u32 s22, s22, 1024
    s_mov_b32 m0, s22
    s_nop 0
    buffer_load_dwordx4 v20, s[8:11], s21 offen lds
    s_add_u32 s21, s21, 131072
    s_add_u32 s22, s22, 1024
    s_mov_b32 m0, s22
    s_nop 0
    buffer_load_dwordx4 v20, s[8:11], s21 offen lds
    s_add_u32 s21, s21, 131072
    s_add_u32 s22, s22, 1024
    s_mov_b32 m0, s22
    s_nop 0
    buffer_load_dwordx4 v20, s[8:11], s21 offen lds
    s_add_u32 s21, s21, 131072
    s_add_u32 s22, s22, 1024
    s_mov_b32 m0, s22
    s_nop 0
    buffer_load_dwordx4 v20, s[8:11], s21 offen lds
    s_add_u32 s21, s21, 131072
    s_add_u32 s22, s22, 1024
    s_mov_b32 m0, s22
    s_nop 0
    buffer_load_dwordx4 v20, s[8:11], s21 offen lds
    s_add_u32 s21, s21, 131072
    s_add_u32 s22, s22, 1024
    s_mov_b32 s8, s32
    s_mov_b32 s9, s33
    s_lshl_b32 s21, s14, 21
    s_lshl_b32 s22, s27, 1
    s_add_u32 s21, s21, s22
    s_lshl_b32 s22, s14, 15
    s_add_u32 s22, s22, 16384
    s_mov_b32 m0, s22
    s_nop 0
    buffer_load_dwordx4 v20, s[8:11], s21 offen lds
    s_add_u32 s21, s21, 131072
    s_add_u32 s22, s22, 1024
    s_mov_b32 m0, s22
    s_nop 0
    buffer_load_dwordx4 v20, s[8:11], s21 offen lds
    s_add_u32 s21, s21, 131072
    s_add_u32 s22, s22, 1024
    s_mov_b32 m0, s22
    s_nop 0
    buffer_load_dwordx4 v20, s[8:11], s21 offen lds
    s_add_u32 s21, s21, 131072
    s_add_u32 s22, s22, 1024
    s_mov_b32 m0, s22
    s_nop 0
    buffer_load_dwordx4 v20, s[8:11], s21 offen lds
    s_add_u32 s21, s21, 131072
    s_add_u32 s22, s22, 1024
    s_mov_b32 m0, s22
    s_nop 0
    buffer_load_dwordx4 v20, s[8:11], s21 offen lds
    s_add_u32 s21, s21, 131072
    s_add_u32 s22, s22, 1024
    s_mov_b32 m0, s22
    s_nop 0
    buffer_load_dwordx4 v20, s[8:11], s21 offen lds
    s_add_u32 s21, s21, 131072
    s_add_u32 s22, s22, 1024
    s_mov_b32 m0, s22
    s_nop 0
    buffer_load_dwordx4 v20, s[8:11], s21 offen lds
    s_add_u32 s21, s21, 131072
    s_add_u32 s22, s22, 1024
    s_mov_b32 m0, s22
    s_nop 0
    buffer_load_dwordx4 v20, s[8:11], s21 offen lds
    s_add_u32 s21, s21, 131072
    s_add_u32 s22, s22, 1024
    s_mov_b32 m0, s22
    s_nop 0
    buffer_load_dwordx4 v20, s[8:11], s21 offen lds
    s_add_u32 s21, s21, 131072
    s_add_u32 s22, s22, 1024
    s_mov_b32 m0, s22
    s_nop 0
    buffer_load_dwordx4 v20, s[8:11], s21 offen lds
    s_add_u32 s21, s21, 131072
    s_add_u32 s22, s22, 1024
    s_mov_b32 m0, s22
    s_nop 0
    buffer_load_dwordx4 v20, s[8:11], s21 offen lds
    s_add_u32 s21, s21, 131072
    s_add_u32 s22, s22, 1024
    s_mov_b32 m0, s22
    s_nop 0
    buffer_load_dwordx4 v20, s[8:11], s21 offen lds
    s_add_u32 s21, s21, 131072
    s_add_u32 s22, s22, 1024
    s_mov_b32 m0, s22
    s_nop 0
    buffer_load_dwordx4 v20, s[8:11], s21 offen lds
    s_add_u32 s21, s21, 131072
    s_add_u32 s22, s22, 1024
    s_mov_b32 m0, s22
    s_nop 0
    buffer_load_dwordx4 v20, s[8:11], s21 offen lds
    s_add_u32 s21, s21, 131072
    s_add_u32 s22, s22, 1024
    s_mov_b32 m0, s22
    s_nop 0
    buffer_load_dwordx4 v20, s[8:11], s21 offen lds
    s_add_u32 s21, s21, 131072
    s_add_u32 s22, s22, 1024
    s_mov_b32 m0, s22
    s_nop 0
    buffer_load_dwordx4 v20, s[8:11], s21 offen lds
    s_add_u32 s21, s21, 131072
    s_add_u32 s22, s22, 1024
    s_waitcnt vmcnt(0)
    ds_read_b64_tr_b16 a[0:1], v22 offset:0
    ds_read_b64_tr_b16 a[2:3], v22 offset:128
    ds_read_b64_tr_b16 a[4:5], v22 offset:1024
    ds_read_b64_tr_b16 a[6:7], v22 offset:1152
    ds_read_b64_tr_b16 a[8:9], v22 offset:4096
    ds_read_b64_tr_b16 a[10:11], v22 offset:4224
    ds_read_b64_tr_b16 a[12:13], v22 offset:5120
    ds_read_b64_tr_b16 a[14:15], v22 offset:5248
    ds_read_b64_tr_b16 a[16:17], v22 offset:8192
    ds_read_b64_tr_b16 a[18:19], v22 offset:8320
    ds_read_b64_tr_b16 a[20:21], v22 offset:9216
    ds_read_b64_tr_b16 a[22:23], v22 offset:9344
    ds_read_b64_tr_b16 a[24:25], v22 offset:12288
    ds_read_b64_tr_b16 a[26:27], v22 offset:12416
    ds_read_b64_tr_b16 a[28:29], v22 offset:13312
    ds_read_b64_tr_b16 a[30:31], v22 offset:13440
    s_waitcnt lgkmcnt(0)
    ds_read_b64_tr_b16 a[32:33], v22 offset:8
    ds_read_b64_tr_b16 a[34:35], v22 offset:136
    ds_read_b64_tr_b16 a[36:37], v22 offset:1032
    ds_read_b64_tr_b16 a[38:39], v22 offset:1160
    ds_read_b64_tr_b16 a[40:41], v22 offset:4104
    ds_read_b64_tr_b16 a[42:43], v22 offset:4232
    ds_read_b64_tr_b16 a[44:45], v22 offset:5128
    ds_read_b64_tr_b16 a[46:47], v22 offset:5256
    ds_read_b64_tr_b16 a[48:49], v22 offset:8200
    ds_read_b64_tr_b16 a[50:51], v22 offset:8328
    ds_read_b64_tr_b16 a[52:53], v22 offset:9224
    ds_read_b64_tr_b16 a[54:55], v22 offset:9352
    ds_read_b64_tr_b16 a[56:57], v22 offset:12296
    ds_read_b64_tr_b16 a[58:59], v22 offset:12424
    ds_read_b64_tr_b16 a[60:61], v22 offset:13320
    ds_read_b64_tr_b16 a[62:63], v22 offset:13448
    s_waitcnt lgkmcnt(0)
    ds_read_b64_tr_b16 a[64:65], v22 offset:16384
    ds_read_b64_tr_b16 a[66:67], v22 offset:16512
    ds_read_b64_tr_b16 a[68:69], v22 offset:17408
    ds_read_b64_tr_b16 a[70:71], v22 offset:17536
    ds_read_b64_tr_b16 a[72:73], v22 offset:20480
    ds_read_b64_tr_b16 a[74:75], v22 offset:20608
    ds_read_b64_tr_b16 a[76:77], v22 offset:21504
    ds_read_b64_tr_b16 a[78:79], v22 offset:21632
    ds_read_b64_tr_b16 a[80:81], v22 offset:24576
    ds_read_b64_tr_b16 a[82:83], v22 offset:24704
    ds_read_b64_tr_b16 a[84:85], v22 offset:25600
    ds_read_b64_tr_b16 a[86:87], v22 offset:25728
    ds_read_b64_tr_b16 a[88:89], v22 offset:28672
    ds_read_b64_tr_b16 a[90:91], v22 offset:28800
    ds_read_b64_tr_b16 a[92:93], v22 offset:29696
    ds_read_b64_tr_b16 a[94:95], v22 offset:29824
    s_waitcnt lgkmcnt(0)
    ds_read_b64_tr_b16 a[96:97], v22 offset:16392
    ds_read_b64_tr_b16 a[98:99], v22 offset:16520
    ds_read_b64_tr_b16 a[100:101], v22 offset:17416
    ds_read_b64_tr_b16 a[102:103], v22 offset:17544
    ds_read_b64_tr_b16 a[104:105], v22 offset:20488
    ds_read_b64_tr_b16 a[106:107], v22 offset:20616
    ds_read_b64_tr_b16 a[108:109], v22 offset:21512
    ds_read_b64_tr_b16 a[110:111], v22 offset:21640
    ds_read_b64_tr_b16 a[112:113], v22 offset:24584
    ds_read_b64_tr_b16 a[114:115], v22 offset:24712
    ds_read_b64_tr_b16 a[116:117], v22 offset:25608
    ds_read_b64_tr_b16 a[118:119], v22 offset:25736
    ds_read_b64_tr_b16 a[120:121], v22 offset:28680
    ds_read_b64_tr_b16 a[122:123], v22 offset:28808
    ds_read_b64_tr_b16 a[124:125], v22 offset:29704
    ds_read_b64_tr_b16 a[126:127], v22 offset:29832
    s_waitcnt lgkmcnt(0)
    s_mov_b32 s8, s34
    s_mov_b32 s9, s35
    s_lshl_b32 s21, s14, 21
    s_lshl_b32 s22, s27, 1
    s_add_u32 s21, s21, s22
    s_lshl_b32 s22, s14, 15
    s_add_u32 s22, s22, 0
    s_mov_b32 m0, s22
    s_nop 0
    buffer_load_dwordx4 v20, s[8:11], s21 offen lds
    s_add_u32 s21, s21, 131072
    s_add_u32 s22, s22, 1024
    s_mov_b32 m0, s22
    s_nop 0
    buffer_load_dwordx4 v20, s[8:11], s21 offen lds
    s_add_u32 s21, s21, 131072
    s_add_u32 s22, s22, 1024
    s_mov_b32 m0, s22
    s_nop 0
    buffer_load_dwordx4 v20, s[8:11], s21 offen lds
    s_add_u32 s21, s21, 131072
    s_add_u32 s22, s22, 1024
    s_mov_b32 m0, s22
    s_nop 0
    buffer_load_dwordx4 v20, s[8:11], s21 offen lds
    s_add_u32 s21, s21, 131072
    s_add_u32 s22, s22, 1024
    s_mov_b32 m0, s22
    s_nop 0
    buffer_load_dwordx4 v20, s[8:11], s21 offen lds
    s_add_u32 s21, s21, 131072
    s_add_u32 s22, s22, 1024
    s_mov_b32 m0, s22
    s_nop 0
    buffer_load_dwordx4 v20, s[8:11], s21 offen lds
    s_add_u32 s21, s21, 131072
    s_add_u32 s22, s22, 1024
    s_mov_b32 m0, s22
    s_nop 0
    buffer_load_dwordx4 v20, s[8:11], s21 offen lds
    s_add_u32 s21, s21, 131072
    s_add_u32 s22, s22, 1024
    s_mov_b32 m0, s22
    s_nop 0
    buffer_load_dwordx4 v20, s[8:11], s21 offen lds
    s_add_u32 s21, s21, 131072
    s_add_u32 s22, s22, 1024
    s_mov_b32 m0, s22
    s_nop 0
    buffer_load_dwordx4 v20, s[8:11], s21 offen lds
    s_add_u32 s21, s21, 131072
    s_add_u32 s22, s22, 1024
    s_mov_b32 m0, s22
    s_nop 0
    buffer_load_dwordx4 v20, s[8:11], s21 offen lds
    s_add_u32 s21, s21, 131072
    s_add_u32 s22, s22, 1024
    s_mov_b32 m0, s22
    s_nop 0
    buffer_load_dwordx4 v20, s[8:11], s21 offen lds
    s_add_u32 s21, s21, 131072
    s_add_u32 s22, s22, 1024
    s_mov_b32 m0, s22
    s_nop 0
    buffer_load_dwordx4 v20, s[8:11], s21 offen lds
    s_add_u32 s21, s21, 131072
    s_add_u32 s22, s22, 1024
    s_mov_b32 m0, s22
    s_nop 0
    buffer_load_dwordx4 v20, s[8:11], s21 offen lds
    s_add_u32 s21, s21, 131072
    s_add_u32 s22, s22, 1024
    s_mov_b32 m0, s22
    s_nop 0
    buffer_load_dwordx4 v20, s[8:11], s21 offen lds
    s_add_u32 s21, s21, 131072
    s_add_u32 s22, s22, 1024
    s_mov_b32 m0, s22
    s_nop 0
    buffer_load_dwordx4 v20, s[8:11], s21 offen lds
    s_add_u32 s21, s21, 131072
    s_add_u32 s22, s22, 1024
    s_mov_b32 m0, s22
    s_nop 0
    buffer_load_dwordx4 v20, s[8:11], s21 offen lds
    s_add_u32 s21, s21, 131072
    s_add_u32 s22, s22, 1024
    s_mov_b32 s8, s36
    s_mov_b32 s9, s37
    s_lshl_b32 s21, s12, 21
    s_lshl_b32 s22, s14, 19
    s_add_u32 s21, s21, s22
    s_lshl_b32 s22, s13, 6
    s_add_u32 s21, s21, s22
    s_lshl_b32 s22, s14, 15
    s_add_u32 s22, s22, 16384
    s_mov_b32 m0, s22
    s_nop 0
    buffer_load_dwordx4 v21, s[8:11], s21 offen lds
    s_add_u32 s21, s21, 32768
    s_add_u32 s22, s22, 1024
    s_mov_b32 m0, s22
    s_nop 0
    buffer_load_dwordx4 v21, s[8:11], s21 offen lds
    s_add_u32 s21, s21, 32768
    s_add_u32 s22, s22, 1024
    s_mov_b32 m0, s22
    s_nop 0
    buffer_load_dwordx4 v21, s[8:11], s21 offen lds
    s_add_u32 s21, s21, 32768
    s_add_u32 s22, s22, 1024
    s_mov_b32 m0, s22
    s_nop 0
    buffer_load_dwordx4 v21, s[8:11], s21 offen lds
    s_add_u32 s21, s21, 32768
    s_add_u32 s22, s22, 1024
    s_mov_b32 m0, s22
    s_nop 0
    buffer_load_dwordx4 v21, s[8:11], s21 offen lds
    s_add_u32 s21, s21, 32768
    s_add_u32 s22, s22, 1024
    s_mov_b32 m0, s22
    s_nop 0
    buffer_load_dwordx4 v21, s[8:11], s21 offen lds
    s_add_u32 s21, s21, 32768
    s_add_u32 s22, s22, 1024
    s_mov_b32 m0, s22
    s_nop 0
    buffer_load_dwordx4 v21, s[8:11], s21 offen lds
    s_add_u32 s21, s21, 32768
    s_add_u32 s22, s22, 1024
    s_mov_b32 m0, s22
    s_nop 0
    buffer_load_dwordx4 v21, s[8:11], s21 offen lds
    s_add_u32 s21, s21, 32768
    s_add_u32 s22, s22, 1024
    s_mov_b32 m0, s22
    s_nop 0
    buffer_load_dwordx4 v21, s[8:11], s21 offen lds
    s_add_u32 s21, s21, 32768
    s_add_u32 s22, s22, 1024
    s_mov_b32 m0, s22
    s_nop 0
    buffer_load_dwordx4 v21, s[8:11], s21 offen lds
    s_add_u32 s21, s21, 32768
    s_add_u32 s22, s22, 1024
    s_mov_b32 m0, s22
    s_nop 0
    buffer_load_dwordx4 v21, s[8:11], s21 offen lds
    s_add_u32 s21, s21, 32768
    s_add_u32 s22, s22, 1024
    s_mov_b32 m0, s22
    s_nop 0
    buffer_load_dwordx4 v21, s[8:11], s21 offen lds
    s_add_u32 s21, s21, 32768
    s_add_u32 s22, s22, 1024
    s_mov_b32 m0, s22
    s_nop 0
    buffer_load_dwordx4 v21, s[8:11], s21 offen lds
    s_add_u32 s21, s21, 32768
    s_add_u32 s22, s22, 1024
    s_mov_b32 m0, s22
    s_nop 0
    buffer_load_dwordx4 v21, s[8:11], s21 offen lds
    s_add_u32 s21, s21, 32768
    s_add_u32 s22, s22, 1024
    s_mov_b32 m0, s22
    s_nop 0
    buffer_load_dwordx4 v21, s[8:11], s21 offen lds
    s_add_u32 s21, s21, 32768
    s_add_u32 s22, s22, 1024
    s_mov_b32 m0, s22
    s_nop 0
    buffer_load_dwordx4 v21, s[8:11], s21 offen lds
    s_add_u32 s21, s21, 32768
    s_add_u32 s22, s22, 1024
    s_waitcnt vmcnt(0)
    ds_read_b64_tr_b16 a[128:129], v22 offset:0
    ds_read_b64_tr_b16 a[130:131], v22 offset:128
    ds_read_b64_tr_b16 a[132:133], v22 offset:1024
    ds_read_b64_tr_b16 a[134:135], v22 offset:1152
    ds_read_b64_tr_b16 a[136:137], v22 offset:4096
    ds_read_b64_tr_b16 a[138:139], v22 offset:4224
    ds_read_b64_tr_b16 a[140:141], v22 offset:5120
    ds_read_b64_tr_b16 a[142:143], v22 offset:5248
    ds_read_b64_tr_b16 a[144:145], v22 offset:8192
    ds_read_b64_tr_b16 a[146:147], v22 offset:8320
    ds_read_b64_tr_b16 a[148:149], v22 offset:9216
    ds_read_b64_tr_b16 a[150:151], v22 offset:9344
    ds_read_b64_tr_b16 a[152:153], v22 offset:12288
    ds_read_b64_tr_b16 a[154:155], v22 offset:12416
    ds_read_b64_tr_b16 a[156:157], v22 offset:13312
    ds_read_b64_tr_b16 a[158:159], v22 offset:13440
    s_waitcnt lgkmcnt(0)
    ds_read_b64_tr_b16 a[160:161], v22 offset:8
    ds_read_b64_tr_b16 a[162:163], v22 offset:136
    ds_read_b64_tr_b16 a[164:165], v22 offset:1032
    ds_read_b64_tr_b16 a[166:167], v22 offset:1160
    ds_read_b64_tr_b16 a[168:169], v22 offset:4104
    ds_read_b64_tr_b16 a[170:171], v22 offset:4232
    ds_read_b64_tr_b16 a[172:173], v22 offset:5128
    ds_read_b64_tr_b16 a[174:175], v22 offset:5256
    ds_read_b64_tr_b16 a[176:177], v22 offset:8200
    ds_read_b64_tr_b16 a[178:179], v22 offset:8328
    ds_read_b64_tr_b16 a[180:181], v22 offset:9224
    ds_read_b64_tr_b16 a[182:183], v22 offset:9352
    ds_read_b64_tr_b16 a[184:185], v22 offset:12296
    ds_read_b64_tr_b16 a[186:187], v22 offset:12424
    ds_read_b64_tr_b16 a[188:189], v22 offset:13320
    ds_read_b64_tr_b16 a[190:191], v22 offset:13448
    s_waitcnt lgkmcnt(0)
    ds_read_b64_tr_b16 a[192:193], v22 offset:16384
    ds_read_b64_tr_b16 a[194:195], v22 offset:16512
    ds_read_b64_tr_b16 a[196:197], v22 offset:17408
    ds_read_b64_tr_b16 a[198:199], v22 offset:17536
    ds_read_b64_tr_b16 a[200:201], v22 offset:20480
    ds_read_b64_tr_b16 a[202:203], v22 offset:20608
    ds_read_b64_tr_b16 a[204:205], v22 offset:21504
    ds_read_b64_tr_b16 a[206:207], v22 offset:21632
    ds_read_b64_tr_b16 a[208:209], v22 offset:24576
    ds_read_b64_tr_b16 a[210:211], v22 offset:24704
    ds_read_b64_tr_b16 a[212:213], v22 offset:25600
    ds_read_b64_tr_b16 a[214:215], v22 offset:25728
    ds_read_b64_tr_b16 a[216:217], v22 offset:28672
    ds_read_b64_tr_b16 a[218:219], v22 offset:28800
    ds_read_b64_tr_b16 a[220:221], v22 offset:29696
    ds_read_b64_tr_b16 a[222:223], v22 offset:29824
    s_waitcnt lgkmcnt(0)
    ds_read_b64_tr_b16 a[224:225], v22 offset:16392
    ds_read_b64_tr_b16 a[226:227], v22 offset:16520
    ds_read_b64_tr_b16 a[228:229], v22 offset:17416
    ds_read_b64_tr_b16 a[230:231], v22 offset:17544
    ds_read_b64_tr_b16 a[232:233], v22 offset:20488
    ds_read_b64_tr_b16 a[234:235], v22 offset:20616
    ds_read_b64_tr_b16 a[236:237], v22 offset:21512
    ds_read_b64_tr_b16 a[238:239], v22 offset:21640
    ds_read_b64_tr_b16 a[240:241], v22 offset:24584
    ds_read_b64_tr_b16 a[242:243], v22 offset:24712
    ds_read_b64_tr_b16 a[244:245], v22 offset:25608
    ds_read_b64_tr_b16 a[246:247], v22 offset:25736
    ds_read_b64_tr_b16 a[248:249], v22 offset:28680
    ds_read_b64_tr_b16 a[250:251], v22 offset:28808
    ds_read_b64_tr_b16 a[252:253], v22 offset:29704
    ds_read_b64_tr_b16 a[254:255], v22 offset:29832
    s_waitcnt lgkmcnt(0)
    v_mov_b32 v155, 0
    v_mov_b32 v159, 0
    v_mov_b32 v163, 0
    v_mov_b32 v167, 0
    v_mov_b32 v179, 0
    s_mov_b32 s8, s28
    s_mov_b32 s9, s29
    s_mov_b32 s10, 16384
    v_lshlrev_b32 v20, 11, v96
    v_lshl_add_u32 v20, v98, 4, v20
    v_lshl_add_u32 v20, v97, 3, v20
    s_lshl_b32 s21, s13, 6
    buffer_load_dwordx2 v[88:89], v20, s[8:11], s21 offen
    v_lshlrev_b32 v20, 2, v1
    s_mov_b32 s22, 0
rdv_18:
    global_load_dword v21, v20, s[100:101] sc1
    s_lshl_b32 s21, s98, 2
    s_waitcnt vmcnt(0)
    v_lshrrev_b32 v22, s21, v21
    s_cmp_eq_u32 s98, 0
    s_cselect_b32 s21, 0x0f0f0f0f, s21
    s_cselect_b32 s21, s21, 0x01010101
    v_and_b32 v22, s21, v22
    v_cmp_ne_u32 vcc, 0x01010101, v22
    s_nop 0
    s_cbranch_vccz rdvok_19
    v_sad_u8 v22, v22, 0, 0
    s_nop 1
    v_add_u32_dpp v22, v22, v22 quad_perm:[1,0,3,2] row_mask:0xf bank_mask:0xf
    v_cmp_ne_u32 vcc, 8, v22
    s_nop 0
    s_cbranch_vccnz rdvw_20
    s_mov_b32 s98, 1
    s_and_b32 s3, s97, 7
    s_barrier
    s_branch role_start
rdvw_20:
    s_sleep 4
    s_add_u32 s22, s22, 1
    s_cmp_lt_u32 s22, 262144
    s_cbranch_scc1 rdv_18
    s_mov_b32 s25, 200000
rdvok_19:
    v_and_b32 v22, 0x40404040, v21
    v_bcnt_u32_b32 v22, v22, 0
    s_mov_b32 s46, 0
    v_cmp_le_u32 vcc, 1, v22
    s_nop 0
    s_bcnt1_i32_b64 s21, vcc
    s_add_u32 s46, s46, s21
    v_cmp_le_u32 vcc, 2, v22
    s_nop 0
    s_bcnt1_i32_b64 s21, vcc
    s_add_u32 s46, s46, s21
    v_cmp_le_u32 vcc, 3, v22
    s_nop 0
    s_bcnt1_i32_b64 s21, vcc
    s_add_u32 s46, s46, s21
    v_cmp_le_u32 vcc, 4, v22
    s_nop 0
    s_bcnt1_i32_b64 s21, vcc
    s_add_u32 s46, s46, s21
    s_cmp_gt_u32 s46, 16
    s_cselect_b32 s46, 8192, 0
    s_add_u32 s84, s95, s46
    s_xor_b32 s45, s98, 1
    v_min_u32 v88, -2, v88
    v_min_u32 v89, -2, v89
    buffer_store_dwordx2 v[88:89], v11, s[4:7], s16 offen sc1
    v_mov_b32 v40, 0
    v_mov_b32 v41, 0
    v_mov_b32 v42, 0
    v_mov_b32 v43, 0
    v_mov_b32 v44, 0
    v_mov_b32 v45, 0
    v_mov_b32 v46, 0
    v_mov_b32 v47, 0
    v_mov_b32 v48, 0
    v_mov_b32 v49, 0
    v_mov_b32 v50, 0
    v_mov_b32 v51, 0
    v_mov_b32 v52, 0
    v_mov_b32 v53, 0
    v_mov_b32 v54, 0
    v_mov_b32 v55, 0
    v_mov_b32 v56, 0
    v_mov_b32 v57, 0
    v_mov_b32 v58, 0
    v_mov_b32 v59, 0
    v_mov_b32 v60, 0
    v_mov_b32 v61, 0
    v_mov_b32 v62, 0
    v_mov_b32 v63, 0
    v_mov_b32 v64, 0
    v_mov_b32 v65, 0
    v_mov_b32 v66, 0
    v_mov_b32 v67, 0
    v_mov_b32 v68, 0
    v_mov_b32 v69, 0
    v_mov_b32 v70, 0
    v_mov_b32 v71, 0
    s_cmp_ge_u32 s14, 2
    s_cbranch_scc1 kv_21
    s_mov_b32 s94, 1
    s_mov_b32 s23, s25
fw_23:
    s_cmp_ge_u32 s85, s94
    s_cbranch_scc1 fo_24
    buffer_load_dword v247, v245, s[4:7], 0 offen sc1
    s_add_u32 s23, s23, 1
    s_waitcnt vmcnt(0)
    v_readfirstlane_b32 s85, v247
    s_cmp_lt_u32 s23, 200000
    s_cbranch_scc1 fw_23
    s_mov_b32 s25, 200000
fo_24:
    s_cmp_eq_u32 s14, 1
    s_cbranch_scc1 kv_22
    buffer_load_dwordx4 v[132:135], v12, s[4:7], s17 offen sc1
    buffer_load_dwordx4 v[136:139], v12, s[4:7], s17 offen offset:256 sc1
    s_add_u32 s17, s17, 2048
    s_min_u32 s17, s17, 17954816
    s_branch kv_21
kv_22:
    buffer_load_dwordx4 v[228:231], v13, s[4:7], s18 offen offset:0 sc1
    buffer_load_dwordx4 v[232:235], v13, s[4:7], s18 offen offset:256 sc1
    s_add_u32 s18, s18, 2048
    s_min_u32 s18, s18, 35780608
kv_21:
    s_mov_b32 s23, s25
    s_barrier
    s_cmp_eq_u32 s45, 0
    s_cbranch_scc1 recur_slow_disp
    s_cmp_eq_u32 s14, 1
    s_cbranch_scc1 recur_fast_w1
    s_cmp_eq_u32 s14, 2
    s_cbranch_scc1 recur_fast_w2
    s_cmp_eq_u32 s14, 3
    s_cbranch_scc1 recur_fast_w3
    s_branch recur_fast_w0
recur_slow_disp:
    s_cmp_eq_u32 s14, 1
    s_cbranch_scc1 recur_slow_w1
    s_cmp_eq_u32 s14, 2
    s_cbranch_scc1 recur_slow_w2
    s_cmp_eq_u32 s14, 3
    s_cbranch_scc1 recur_slow_w3
    s_branch recur_slow_w0
.p2align 6
recur_fast_w0:
    s_nop 15
    s_mov_b32 s23, s25
    buffer_load_dwordx4 v[24:27], v2, s[4:7], s16 offen offset:0 sc1
    s_nop 11
    buffer_load_dwordx4 v[28:31], v2, s[4:7], s16 offen offset:1024 sc1
    s_nop 11
    buffer_load_dwordx4 v[32:35], v2, s[4:7], s16 offen offset:2048 sc1
    s_nop 11
    buffer_load_dwordx4 v[36:39], v2, s[4:7], s16 offen offset:3072 sc1
    s_waitcnt vmcnt(3)
    v_max3_u32 v19, v24, v25, v26
    v_max_u32 v19, v19, v27
    v_cmp_eq_u32 vcc, -1, v19
    s_nop 0
    s_cbranch_vccnz g_25F15_0
    v_smfmac_f32_16x16x64_bf16 v[40:43], v[24:27], a[0:7], v172
    s_waitcnt vmcnt(2)
    v_max3_u32 v19, v28, v29, v30
    v_max_u32 v19, v19, v31
    v_smfmac_f32_16x16x64_bf16 v[44:47], v[24:27], a[64:71], v172
    v_cmp_eq_u32 vcc, -1, v19
    v_smfmac_f32_16x16x64_bf16 v[48:51], v[24:27], a[32:39], v172
    v_smfmac_f32_16x16x64_bf16 v[52:55], v[24:27], a[96:103], v172
    s_cbranch_vccnz g_25F14_1
    v_smfmac_f32_16x16x64_bf16 v[40:43], v[28:31], a[8:15], v172
    s_waitcnt vmcnt(1)
    v_max3_u32 v19, v32, v33, v34
    v_max_u32 v19, v19, v35
    v_smfmac_f32_16x16x64_bf16 v[44:47], v[28:31], a[72:79], v172
    v_cmp_eq_u32 vcc, -1, v19
    v_smfmac_f32_16x16x64_bf16 v[48:51], v[28:31], a[40:47], v172
    v_smfmac_f32_16x16x64_bf16 v[52:55], v[28:31], a[104:111], v172
    s_cbranch_vccnz g_25F12_2
    v_smfmac_f32_16x16x64_bf16 v[40:43], v[32:35], a[16:23], v172
    s_waitcnt vmcnt(0)
    v_max3_u32 v19, v36, v37, v38
    v_max_u32 v19, v19, v39
    v_smfmac_f32_16x16x64_bf16 v[44:47], v[32:35], a[80:87], v172
    v_cmp_eq_u32 vcc, -1, v19
    v_smfmac_f32_16x16x64_bf16 v[48:51], v[32:35], a[48:55], v172
    v_smfmac_f32_16x16x64_bf16 v[52:55], v[32:35], a[112:119], v172
    s_cbranch_vccnz g_25F8_3
    v_smfmac_f32_16x16x64_bf16 v[40:43], v[36:39], a[24:31], v172
    v_smfmac_f32_16x16x64_bf16 v[44:47], v[36:39], a[88:95], v172
    v_smfmac_f32_16x16x64_bf16 v[48:51], v[36:39], a[56:63], v172
    v_smfmac_f32_16x16x64_bf16 v[52:55], v[36:39], a[120:127], v172
gc_26:
    v_cvt_pk_bf16_f32 v72, v40, v41
    v_cvt_pk_bf16_f32 v73, v42, v43
    v_cvt_pk_bf16_f32 v74, v44, v45
    v_cvt_pk_bf16_f32 v75, v46, v47
    v_smfmac_f32_16x16x64_bf16 v[56:59], v[24:27], a[128:135], v172
    v_cvt_pk_bf16_f32 v76, v48, v49
    v_cvt_pk_bf16_f32 v77, v50, v51
    s_nop 0
    v_cvt_pk_bf16_f32 v78, v52, v53
    v_cvt_pk_bf16_f32 v79, v54, v55
    v_smfmac_f32_16x16x64_bf16 v[60:63], v[24:27], a[160:167], v172
    v_mfma_f32_16x16x32_bf16 v[88:91], v[72:75], v[84:87], 0
    v_mfma_f32_16x16x32_bf16 v[92:95], v[76:79], v[84:87], 0
    v_smfmac_f32_16x16x64_bf16 v[56:59], v[28:31], a[136:143], v172
    v_smfmac_f32_16x16x64_bf16 v[60:63], v[28:31], a[168:175], v172
    s_barrier
    ds_read_b128 v[104:107], v16 offset:2048
    ds_read_b128 v[108:111], v16 offset:3072
    ds_read_b128 v[112:115], v16 offset:4096
    ds_read_b128 v[116:119], v16 offset:5120
    ds_read_b128 v[120:123], v16 offset:6144
    ds_read_b128 v[124:127], v16 offset:7168
    v_smfmac_f32_16x16x64_bf16 v[56:59], v[32:35], a[144:151], v172
    v_smfmac_f32_16x16x64_bf16 v[60:63], v[32:35], a[176:183], v172
    v_smfmac_f32_16x16x64_bf16 v[56:59], v[36:39], a[152:159], v172
    v_smfmac_f32_16x16x64_bf16 v[60:63], v[36:39], a[184:191], v172
    s_waitcnt lgkmcnt(5)
    v_mfma_f32_16x16x32_bf16 v[88:91], v[104:107], v[84:87], v[88:91]
    s_waitcnt lgkmcnt(4)
    v_mfma_f32_16x16x32_bf16 v[92:95], v[108:111], v[84:87], v[92:95]
    s_waitcnt lgkmcnt(3)
    v_mfma_f32_16x16x32_bf16 v[88:91], v[112:115], v[84:87], v[88:91]
    s_waitcnt lgkmcnt(2)
    v_mfma_f32_16x16x32_bf16 v[92:95], v[116:119], v[84:87], v[92:95]
    s_waitcnt lgkmcnt(1)
    v_mfma_f32_16x16x32_bf16 v[88:91], v[120:123], v[84:87], v[88:91]
    s_waitcnt lgkmcnt(0)
    v_mfma_f32_16x16x32_bf16 v[92:95], v[124:127], v[84:87], v[92:95]
    v_cvt_pk_bf16_f32 v80, v56, v57
    v_cvt_pk_bf16_f32 v81, v58, v59
    v_cvt_pk_bf16_f32 v82, v60, v61
    v_cvt_pk_bf16_f32 v83, v62, v63
    ds_write_b128 v17, v[80:83] offset:8192
    s_nop 0
    v_cvt_pk_bf16_f32 v128, v88, v89
    v_cvt_pk_bf16_f32 v129, v90, v91
    v_cvt_pk_bf16_f32 v130, v92, v93
    v_cvt_pk_bf16_f32 v131, v94, v95
    s_nop 1
    v_mfma_f32_16x16x32_bf16 v[144:147], v[132:135], v[128:131], 0
    v_mfma_f32_16x16x32_bf16 v[148:151], v[136:139], v[128:131], 0
    v_mfma_f32_16x16x32_bf16 v[140:143], v[128:131], v[128:131], 0
    s_nop 1
    buffer_store_dwordx4 v[144:147], v3, s[4:7], s16 offen
    s_nop 1
    buffer_store_dwordx4 v[148:151], v3, s[4:7], s16 offen offset:128
    s_nop 1
    buffer_store_dwordx4 v[140:143], v4, s[4:7], s16 offen
    s_cmp_eq_u32 s15, 63
    s_waitcnt lgkmcnt(0)
    s_barrier
    s_cbranch_scc1 recur_fast_last0
    v_readfirstlane_b32 s85, v247
    s_add_u32 s94, s15, 2
    s_barrier
    s_nop 15
    s_mov_b32 s23, s25
    buffer_load_dwordx4 v[24:27], v8, s[4:7], s16 offen offset:0 sc1
    s_nop 11
    buffer_load_dwordx4 v[28:31], v8, s[4:7], s16 offen offset:1024 sc1
    s_nop 11
    buffer_load_dwordx4 v[32:35], v8, s[4:7], s16 offen offset:2048 sc1
    s_nop 11
    buffer_load_dwordx4 v[36:39], v8, s[4:7], s16 offen offset:3072 sc1
    s_waitcnt vmcnt(3)
    v_max3_u32 v19, v24, v25, v26
    v_max_u32 v19, v19, v27
    v_cmp_eq_u32 vcc, -1, v19
    s_nop 0
    s_cbranch_vccnz g_27F15_0
    v_smfmac_f32_16x16x64_bf16 v[64:67], v[24:27], a[192:199], v172
    v_smfmac_f32_16x16x64_bf16 v[68:71], v[24:27], a[224:231], v172
    s_waitcnt vmcnt(2)
    v_max3_u32 v19, v28, v29, v30
    v_max_u32 v19, v19, v31
    v_cmp_eq_u32 vcc, -1, v19
    s_nop 0
    s_cbranch_vccnz g_27F14_1
    v_smfmac_f32_16x16x64_bf16 v[64:67], v[28:31], a[200:207], v172
    v_smfmac_f32_16x16x64_bf16 v[68:71], v[28:31], a[232:239], v172
    s_waitcnt vmcnt(1)
    v_max3_u32 v19, v32, v33, v34
    v_max_u32 v19, v19, v35
    v_cmp_eq_u32 vcc, -1, v19
    s_nop 0
    s_cbranch_vccnz g_27F12_2
    v_smfmac_f32_16x16x64_bf16 v[64:67], v[32:35], a[208:215], v172
    v_smfmac_f32_16x16x64_bf16 v[68:71], v[32:35], a[240:247], v172
    s_waitcnt vmcnt(0)
    v_max3_u32 v19, v36, v37, v38
    v_max_u32 v19, v19, v39
    v_cmp_eq_u32 vcc, -1, v19
    s_nop 0
    s_cbranch_vccnz g_27F8_3
    v_smfmac_f32_16x16x64_bf16 v[64:67], v[36:39], a[216:223], v172
    v_smfmac_f32_16x16x64_bf16 v[68:71], v[36:39], a[248:255], v172
    s_nop 4
    v_cvt_pk_bf16_f32 v80, v64, v65
    v_cvt_pk_bf16_f32 v81, v66, v67
    s_nop 0
    v_cvt_pk_bf16_f32 v82, v68, v69
    v_cvt_pk_bf16_f32 v83, v70, v71
    ds_write_b128 v17, v[80:83] offset:9216
gc_28:
    s_waitcnt lgkmcnt(0)
    s_barrier
    s_nop 15
    s_nop 15
    s_nop 15
    s_nop 15
    buffer_store_dwordx4 v[128:131], v14, s[4:7], s19 offen sc1
    s_add_u32 s19, s19, 512
    s_mov_b32 s23, s25
fw_29:
    s_cmp_ge_u32 s85, s94
    s_cbranch_scc1 fo_30
    buffer_load_dword v247, v245, s[4:7], 0 offen sc1
    s_add_u32 s23, s23, 1
    s_waitcnt vmcnt(0)
    v_readfirstlane_b32 s85, v247
    s_cmp_lt_u32 s23, 200000
    s_cbranch_scc1 fw_29
    s_mov_b32 s25, 200000
fo_30:
    buffer_load_dwordx4 v[132:135], v12, s[4:7], s17 offen sc1
    buffer_load_dwordx4 v[136:139], v12, s[4:7], s17 offen offset:256 sc1
    s_add_u32 s17, s17, 2048
    s_min_u32 s17, s17, 17954816
    buffer_load_dword v247, v245, s[4:7], 0 offen sc1
    v_mov_b32 v40, 0
    v_mov_b32 v41, 0
    v_mov_b32 v42, 0
    v_mov_b32 v43, 0
    v_mov_b32 v44, 0
    v_mov_b32 v45, 0
    v_mov_b32 v46, 0
    v_mov_b32 v47, 0
    v_mov_b32 v48, 0
    v_mov_b32 v49, 0
    v_mov_b32 v50, 0
    v_mov_b32 v51, 0
    v_mov_b32 v52, 0
    v_mov_b32 v53, 0
    v_mov_b32 v54, 0
    v_mov_b32 v55, 0
    v_mov_b32 v56, 0
    v_mov_b32 v57, 0
    v_mov_b32 v58, 0
    v_mov_b32 v59, 0
    v_mov_b32 v60, 0
    v_mov_b32 v61, 0
    v_mov_b32 v62, 0
    v_mov_b32 v63, 0
    v_mov_b32 v64, 0
    v_mov_b32 v65, 0
    v_mov_b32 v66, 0
    v_mov_b32 v67, 0
    v_mov_b32 v68, 0
    v_mov_b32 v69, 0
    v_mov_b32 v70, 0
    v_mov_b32 v71, 0
    s_mov_b32 s21, s16
    s_mov_b32 s16, s42
    s_mov_b32 s42, s43
    s_mov_b32 s43, s44
    s_mov_b32 s44, s21
    s_add_u32 s95, s95, 524288
    s_lshr_b32 s84, s95, 8
    s_and_b32 s84, s84, 8192
    s_xor_b32 s84, s84, s46
    s_add_u32 s84, s84, s95
    s_add_u32 s15, s15, 1
    s_barrier
    s_branch recur_fast_w0
g_25L15_0:
    s_waitcnt vmcnt(3)
    v_max3_u32 v19, v24, v25, v26
    v_max_u32 v19, v19, v27
    v_cmp_eq_u32 vcc, -1, v19
    s_nop 0
    s_cbranch_vccnz g_25F15_0
    v_smfmac_f32_16x16x64_bf16 v[40:43], v[24:27], a[0:7], v172
    v_smfmac_f32_16x16x64_bf16 v[44:47], v[24:27], a[64:71], v172
    v_smfmac_f32_16x16x64_bf16 v[48:51], v[24:27], a[32:39], v172
    v_smfmac_f32_16x16x64_bf16 v[52:55], v[24:27], a[96:103], v172
g_25L14_1:
    s_waitcnt vmcnt(2)
    v_max3_u32 v19, v28, v29, v30
    v_max_u32 v19, v19, v31
    v_cmp_eq_u32 vcc, -1, v19
    s_nop 0
    s_cbranch_vccnz g_25F14_1
    v_smfmac_f32_16x16x64_bf16 v[40:43], v[28:31], a[8:15], v172
    v_smfmac_f32_16x16x64_bf16 v[44:47], v[28:31], a[72:79], v172
    v_smfmac_f32_16x16x64_bf16 v[48:51], v[28:31], a[40:47], v172
    v_smfmac_f32_16x16x64_bf16 v[52:55], v[28:31], a[104:111], v172
g_25L12_2:
    s_waitcnt vmcnt(1)
    v_max3_u32 v19, v32, v33, v34
    v_max_u32 v19, v19, v35
    v_cmp_eq_u32 vcc, -1, v19
    s_nop 0
    s_cbranch_vccnz g_25F12_2
    v_smfmac_f32_16x16x64_bf16 v[40:43], v[32:35], a[16:23], v172
    v_smfmac_f32_16x16x64_bf16 v[44:47], v[32:35], a[80:87], v172
    v_smfmac_f32_16x16x64_bf16 v[48:51], v[32:35], a[48:55], v172
    v_smfmac_f32_16x16x64_bf16 v[52:55], v[32:35], a[112:119], v172
g_25L8_3:
    s_waitcnt vmcnt(0)
    v_max3_u32 v19, v36, v37, v38
    v_max_u32 v19, v19, v39
    v_cmp_eq_u32 vcc, -1, v19
    s_nop 0
    s_cbranch_vccnz g_25F8_3
    v_smfmac_f32_16x16x64_bf16 v[40:43], v[36:39], a[24:31], v172
    v_smfmac_f32_16x16x64_bf16 v[44:47], v[36:39], a[88:95], v172
    v_smfmac_f32_16x16x64_bf16 v[48:51], v[36:39], a[56:63], v172
    v_smfmac_f32_16x16x64_bf16 v[52:55], v[36:39], a[120:127], v172
    s_branch gc_26
g_25L15_1:
    s_waitcnt vmcnt(3)
    v_max3_u32 v19, v28, v29, v30
    v_max_u32 v19, v19, v31
    v_cmp_eq_u32 vcc, -1, v19
    s_nop 0
    s_cbranch_vccnz g_25F15_1
    v_smfmac_f32_16x16x64_bf16 v[40:43], v[28:31], a[8:15], v172
    v_smfmac_f32_16x16x64_bf16 v[44:47], v[28:31], a[72:79], v172
    v_smfmac_f32_16x16x64_bf16 v[48:51], v[28:31], a[40:47], v172
    v_smfmac_f32_16x16x64_bf16 v[52:55], v[28:31], a[104:111], v172
g_25L13_2:
    s_waitcnt vmcnt(2)
    v_max3_u32 v19, v32, v33, v34
    v_max_u32 v19, v19, v35
    v_cmp_eq_u32 vcc, -1, v19
    s_nop 0
    s_cbranch_vccnz g_25F13_2
    v_smfmac_f32_16x16x64_bf16 v[40:43], v[32:35], a[16:23], v172
    v_smfmac_f32_16x16x64_bf16 v[44:47], v[32:35], a[80:87], v172
    v_smfmac_f32_16x16x64_bf16 v[48:51], v[32:35], a[48:55], v172
    v_smfmac_f32_16x16x64_bf16 v[52:55], v[32:35], a[112:119], v172
g_25L9_3:
    s_waitcnt vmcnt(1)
    v_max3_u32 v19, v36, v37, v38
    v_max_u32 v19, v19, v39
    v_cmp_eq_u32 vcc, -1, v19
    s_nop 0
    s_cbranch_vccnz g_25F9_3
    v_smfmac_f32_16x16x64_bf16 v[40:43], v[36:39], a[24:31], v172
    v_smfmac_f32_16x16x64_bf16 v[44:47], v[36:39], a[88:95], v172
    v_smfmac_f32_16x16x64_bf16 v[48:51], v[36:39], a[56:63], v172
    v_smfmac_f32_16x16x64_bf16 v[52:55], v[36:39], a[120:127], v172
g_25L1_0:
    s_waitcnt vmcnt(0)
    v_max3_u32 v19, v24, v25, v26
    v_max_u32 v19, v19, v27
    v_cmp_eq_u32 vcc, -1, v19
    s_nop 0
    s_cbranch_vccnz g_25F1_0
    v_smfmac_f32_16x16x64_bf16 v[40:43], v[24:27], a[0:7], v172
    v_smfmac_f32_16x16x64_bf16 v[44:47], v[24:27], a[64:71], v172
    v_smfmac_f32_16x16x64_bf16 v[48:51], v[24:27], a[32:39], v172
    v_smfmac_f32_16x16x64_bf16 v[52:55], v[24:27], a[96:103], v172
    s_branch gc_26
g_25L15_2:
    s_waitcnt vmcnt(3)
    v_max3_u32 v19, v32, v33, v34
    v_max_u32 v19, v19, v35
    v_cmp_eq_u32 vcc, -1, v19
    s_nop 0
    s_cbranch_vccnz g_25F15_2
    v_smfmac_f32_16x16x64_bf16 v[40:43], v[32:35], a[16:23], v172
    v_smfmac_f32_16x16x64_bf16 v[44:47], v[32:35], a[80:87], v172
    v_smfmac_f32_16x16x64_bf16 v[48:51], v[32:35], a[48:55], v172
    v_smfmac_f32_16x16x64_bf16 v[52:55], v[32:35], a[112:119], v172
g_25L11_3:
    s_waitcnt vmcnt(2)
    v_max3_u32 v19, v36, v37, v38
    v_max_u32 v19, v19, v39
    v_cmp_eq_u32 vcc, -1, v19
    s_nop 0
    s_cbranch_vccnz g_25F11_3
    v_smfmac_f32_16x16x64_bf16 v[40:43], v[36:39], a[24:31], v172
    v_smfmac_f32_16x16x64_bf16 v[44:47], v[36:39], a[88:95], v172
    v_smfmac_f32_16x16x64_bf16 v[48:51], v[36:39], a[56:63], v172
    v_smfmac_f32_16x16x64_bf16 v[52:55], v[36:39], a[120:127], v172
g_25L3_0:
    s_waitcnt vmcnt(1)
    v_max3_u32 v19, v24, v25, v26
    v_max_u32 v19, v19, v27
    v_cmp_eq_u32 vcc, -1, v19
    s_nop 0
    s_cbranch_vccnz g_25F3_0
    v_smfmac_f32_16x16x64_bf16 v[40:43], v[24:27], a[0:7], v172
    v_smfmac_f32_16x16x64_bf16 v[44:47], v[24:27], a[64:71], v172
    v_smfmac_f32_16x16x64_bf16 v[48:51], v[24:27], a[32:39], v172
    v_smfmac_f32_16x16x64_bf16 v[52:55], v[24:27], a[96:103], v172
g_25L2_1:
    s_waitcnt vmcnt(0)
    v_max3_u32 v19, v28, v29, v30
    v_max_u32 v19, v19, v31
    v_cmp_eq_u32 vcc, -1, v19
    s_nop 0
    s_cbranch_vccnz g_25F2_1
    v_smfmac_f32_16x16x64_bf16 v[40:43], v[28:31], a[8:15], v172
    v_smfmac_f32_16x16x64_bf16 v[44:47], v[28:31], a[72:79], v172
    v_smfmac_f32_16x16x64_bf16 v[48:51], v[28:31], a[40:47], v172
    v_smfmac_f32_16x16x64_bf16 v[52:55], v[28:31], a[104:111], v172
    s_branch gc_26
g_25L15_3:
    s_waitcnt vmcnt(3)
    v_max3_u32 v19, v36, v37, v38
    v_max_u32 v19, v19, v39
    v_cmp_eq_u32 vcc, -1, v19
    s_nop 0
    s_cbranch_vccnz g_25F15_3
    v_smfmac_f32_16x16x64_bf16 v[40:43], v[36:39], a[24:31], v172
    v_smfmac_f32_16x16x64_bf16 v[44:47], v[36:39], a[88:95], v172
    v_smfmac_f32_16x16x64_bf16 v[48:51], v[36:39], a[56:63], v172
    v_smfmac_f32_16x16x64_bf16 v[52:55], v[36:39], a[120:127], v172
g_25L7_0:
    s_waitcnt vmcnt(2)
    v_max3_u32 v19, v24, v25, v26
    v_max_u32 v19, v19, v27
    v_cmp_eq_u32 vcc, -1, v19
    s_nop 0
    s_cbranch_vccnz g_25F7_0
    v_smfmac_f32_16x16x64_bf16 v[40:43], v[24:27], a[0:7], v172
    v_smfmac_f32_16x16x64_bf16 v[44:47], v[24:27], a[64:71], v172
    v_smfmac_f32_16x16x64_bf16 v[48:51], v[24:27], a[32:39], v172
    v_smfmac_f32_16x16x64_bf16 v[52:55], v[24:27], a[96:103], v172
g_25L6_1:
    s_waitcnt vmcnt(1)
    v_max3_u32 v19, v28, v29, v30
    v_max_u32 v19, v19, v31
    v_cmp_eq_u32 vcc, -1, v19
    s_nop 0
    s_cbranch_vccnz g_25F6_1
    v_smfmac_f32_16x16x64_bf16 v[40:43], v[28:31], a[8:15], v172
    v_smfmac_f32_16x16x64_bf16 v[44:47], v[28:31], a[72:79], v172
    v_smfmac_f32_16x16x64_bf16 v[48:51], v[28:31], a[40:47], v172
    v_smfmac_f32_16x16x64_bf16 v[52:55], v[28:31], a[104:111], v172
g_25L4_2:
    s_waitcnt vmcnt(0)
    v_max3_u32 v19, v32, v33, v34
    v_max_u32 v19, v19, v35
    v_cmp_eq_u32 vcc, -1, v19
    s_nop 0
    s_cbranch_vccnz g_25F4_2
    v_smfmac_f32_16x16x64_bf16 v[40:43], v[32:35], a[16:23], v172
    v_smfmac_f32_16x16x64_bf16 v[44:47], v[32:35], a[80:87], v172
    v_smfmac_f32_16x16x64_bf16 v[48:51], v[32:35], a[48:55], v172
    v_smfmac_f32_16x16x64_bf16 v[52:55], v[32:35], a[112:119], v172
    s_branch gc_26
g_25L7_1:
    s_waitcnt vmcnt(2)
    v_max3_u32 v19, v28, v29, v30
    v_max_u32 v19, v19, v31
    v_cmp_eq_u32 vcc, -1, v19
    s_nop 0
    s_cbranch_vccnz g_25F7_1
    v_smfmac_f32_16x16x64_bf16 v[40:43], v[28:31], a[8:15], v172
    v_smfmac_f32_16x16x64_bf16 v[44:47], v[28:31], a[72:79], v172
    v_smfmac_f32_16x16x64_bf16 v[48:51], v[28:31], a[40:47], v172
    v_smfmac_f32_16x16x64_bf16 v[52:55], v[28:31], a[104:111], v172
g_25L5_2:
    s_waitcnt vmcnt(1)
    v_max3_u32 v19, v32, v33, v34
    v_max_u32 v19, v19, v35
    v_cmp_eq_u32 vcc, -1, v19
    s_nop 0
    s_cbranch_vccnz g_25F5_2
    v_smfmac_f32_16x16x64_bf16 v[40:43], v[32:35], a[16:23], v172
    v_smfmac_f32_16x16x64_bf16 v[44:47], v[32:35], a[80:87], v172
    v_smfmac_f32_16x16x64_bf16 v[48:51], v[32:35], a[48:55], v172
    v_smfmac_f32_16x16x64_bf16 v[52:55], v[32:35], a[112:119], v172
    s_branch g_25L1_0
g_25L7_2:
    s_waitcnt vmcnt(2)
    v_max3_u32 v19, v32, v33, v34
    v_max_u32 v19, v19, v35
    v_cmp_eq_u32 vcc, -1, v19
    s_nop 0
    s_cbranch_vccnz g_25F7_2
    v_smfmac_f32_16x16x64_bf16 v[40:43], v[32:35], a[16:23], v172
    v_smfmac_f32_16x16x64_bf16 v[44:47], v[32:35], a[80:87], v172
    v_smfmac_f32_16x16x64_bf16 v[48:51], v[32:35], a[48:55], v172
    v_smfmac_f32_16x16x64_bf16 v[52:55], v[32:35], a[112:119], v172
    s_branch g_25L3_0
g_25L11_0:
    s_waitcnt vmcnt(2)
    v_max3_u32 v19, v24, v25, v26
    v_max_u32 v19, v19, v27
    v_cmp_eq_u32 vcc, -1, v19
    s_nop 0
    s_cbranch_vccnz g_25F11_0
    v_smfmac_f32_16x16x64_bf16 v[40:43], v[24:27], a[0:7], v172
    v_smfmac_f32_16x16x64_bf16 v[44:47], v[24:27], a[64:71], v172
    v_smfmac_f32_16x16x64_bf16 v[48:51], v[24:27], a[32:39], v172
    v_smfmac_f32_16x16x64_bf16 v[52:55], v[24:27], a[96:103], v172
g_25L10_1:
    s_waitcnt vmcnt(1)
    v_max3_u32 v19, v28, v29, v30
    v_max_u32 v19, v19, v31
    v_cmp_eq_u32 vcc, -1, v19
    s_nop 0
    s_cbranch_vccnz g_25F10_1
    v_smfmac_f32_16x16x64_bf16 v[40:43], v[28:31], a[8:15], v172
    v_smfmac_f32_16x16x64_bf16 v[44:47], v[28:31], a[72:79], v172
    v_smfmac_f32_16x16x64_bf16 v[48:51], v[28:31], a[40:47], v172
    v_smfmac_f32_16x16x64_bf16 v[52:55], v[28:31], a[104:111], v172
    s_branch g_25L8_3
g_25L11_1:
    s_waitcnt vmcnt(2)
    v_max3_u32 v19, v28, v29, v30
    v_max_u32 v19, v19, v31
    v_cmp_eq_u32 vcc, -1, v19
    s_nop 0
    s_cbranch_vccnz g_25F11_1
    v_smfmac_f32_16x16x64_bf16 v[40:43], v[28:31], a[8:15], v172
    v_smfmac_f32_16x16x64_bf16 v[44:47], v[28:31], a[72:79], v172
    v_smfmac_f32_16x16x64_bf16 v[48:51], v[28:31], a[40:47], v172
    v_smfmac_f32_16x16x64_bf16 v[52:55], v[28:31], a[104:111], v172
    s_branch g_25L9_3
g_25L13_0:
    s_waitcnt vmcnt(2)
    v_max3_u32 v19, v24, v25, v26
    v_max_u32 v19, v19, v27
    v_cmp_eq_u32 vcc, -1, v19
    s_nop 0
    s_cbranch_vccnz g_25F13_0
    v_smfmac_f32_16x16x64_bf16 v[40:43], v[24:27], a[0:7], v172
    v_smfmac_f32_16x16x64_bf16 v[44:47], v[24:27], a[64:71], v172
    v_smfmac_f32_16x16x64_bf16 v[48:51], v[24:27], a[32:39], v172
    v_smfmac_f32_16x16x64_bf16 v[52:55], v[24:27], a[96:103], v172
    s_branch g_25L12_2
g_25L13_3:
    s_waitcnt vmcnt(2)
    v_max3_u32 v19, v36, v37, v38
    v_max_u32 v19, v19, v39
    v_cmp_eq_u32 vcc, -1, v19
    s_nop 0
    s_cbranch_vccnz g_25F13_3
    v_smfmac_f32_16x16x64_bf16 v[40:43], v[36:39], a[24:31], v172
    v_smfmac_f32_16x16x64_bf16 v[44:47], v[36:39], a[88:95], v172
    v_smfmac_f32_16x16x64_bf16 v[48:51], v[36:39], a[56:63], v172
    v_smfmac_f32_16x16x64_bf16 v[52:55], v[36:39], a[120:127], v172
g_25L5_0:
    s_waitcnt vmcnt(1)
    v_max3_u32 v19, v24, v25, v26
    v_max_u32 v19, v19, v27
    v_cmp_eq_u32 vcc, -1, v19
    s_nop 0
    s_cbranch_vccnz g_25F5_0
    v_smfmac_f32_16x16x64_bf16 v[40:43], v[24:27], a[0:7], v172
    v_smfmac_f32_16x16x64_bf16 v[44:47], v[24:27], a[64:71], v172
    v_smfmac_f32_16x16x64_bf16 v[48:51], v[24:27], a[32:39], v172
    v_smfmac_f32_16x16x64_bf16 v[52:55], v[24:27], a[96:103], v172
    s_branch g_25L4_2
g_25L14_2:
    s_waitcnt vmcnt(2)
    v_max3_u32 v19, v32, v33, v34
    v_max_u32 v19, v19, v35
    v_cmp_eq_u32 vcc, -1, v19
    s_nop 0
    s_cbranch_vccnz g_25F14_2
    v_smfmac_f32_16x16x64_bf16 v[40:43], v[32:35], a[16:23], v172
    v_smfmac_f32_16x16x64_bf16 v[44:47], v[32:35], a[80:87], v172
    v_smfmac_f32_16x16x64_bf16 v[48:51], v[32:35], a[48:55], v172
    v_smfmac_f32_16x16x64_bf16 v[52:55], v[32:35], a[112:119], v172
g_25L10_3:
    s_waitcnt vmcnt(1)
    v_max3_u32 v19, v36, v37, v38
    v_max_u32 v19, v19, v39
    v_cmp_eq_u32 vcc, -1, v19
    s_nop 0
    s_cbranch_vccnz g_25F10_3
    v_smfmac_f32_16x16x64_bf16 v[40:43], v[36:39], a[24:31], v172
    v_smfmac_f32_16x16x64_bf16 v[44:47], v[36:39], a[88:95], v172
    v_smfmac_f32_16x16x64_bf16 v[48:51], v[36:39], a[56:63], v172
    v_smfmac_f32_16x16x64_bf16 v[52:55], v[36:39], a[120:127], v172
    s_branch g_25L2_1
g_25L14_3:
    s_waitcnt vmcnt(2)
    v_max3_u32 v19, v36, v37, v38
    v_max_u32 v19, v19, v39
    v_cmp_eq_u32 vcc, -1, v19
    s_nop 0
    s_cbranch_vccnz g_25F14_3
    v_smfmac_f32_16x16x64_bf16 v[40:43], v[36:39], a[24:31], v172
    v_smfmac_f32_16x16x64_bf16 v[44:47], v[36:39], a[88:95], v172
    v_smfmac_f32_16x16x64_bf16 v[48:51], v[36:39], a[56:63], v172
    v_smfmac_f32_16x16x64_bf16 v[52:55], v[36:39], a[120:127], v172
    s_branch g_25L6_1
g_25L3_1:
    s_waitcnt vmcnt(1)
    v_max3_u32 v19, v28, v29, v30
    v_max_u32 v19, v19, v31
    v_cmp_eq_u32 vcc, -1, v19
    s_nop 0
    s_cbranch_vccnz g_25F3_1
    v_smfmac_f32_16x16x64_bf16 v[40:43], v[28:31], a[8:15], v172
    v_smfmac_f32_16x16x64_bf16 v[44:47], v[28:31], a[72:79], v172
    v_smfmac_f32_16x16x64_bf16 v[48:51], v[28:31], a[40:47], v172
    v_smfmac_f32_16x16x64_bf16 v[52:55], v[28:31], a[104:111], v172
    s_branch g_25L1_0
g_25L6_2:
    s_waitcnt vmcnt(1)
    v_max3_u32 v19, v32, v33, v34
    v_max_u32 v19, v19, v35
    v_cmp_eq_u32 vcc, -1, v19
    s_nop 0
    s_cbranch_vccnz g_25F6_2
    v_smfmac_f32_16x16x64_bf16 v[40:43], v[32:35], a[16:23], v172
    v_smfmac_f32_16x16x64_bf16 v[44:47], v[32:35], a[80:87], v172
    v_smfmac_f32_16x16x64_bf16 v[48:51], v[32:35], a[48:55], v172
    v_smfmac_f32_16x16x64_bf16 v[52:55], v[32:35], a[112:119], v172
    s_branch g_25L2_1
g_25L9_0:
    s_waitcnt vmcnt(1)
    v_max3_u32 v19, v24, v25, v26
    v_max_u32 v19, v19, v27
    v_cmp_eq_u32 vcc, -1, v19
    s_nop 0
    s_cbranch_vccnz g_25F9_0
    v_smfmac_f32_16x16x64_bf16 v[40:43], v[24:27], a[0:7], v172
    v_smfmac_f32_16x16x64_bf16 v[44:47], v[24:27], a[64:71], v172
    v_smfmac_f32_16x16x64_bf16 v[48:51], v[24:27], a[32:39], v172
    v_smfmac_f32_16x16x64_bf16 v[52:55], v[24:27], a[96:103], v172
    s_branch g_25L8_3
g_25L12_3:
    s_waitcnt vmcnt(1)
    v_max3_u32 v19, v36, v37, v38
    v_max_u32 v19, v19, v39
    v_cmp_eq_u32 vcc, -1, v19
    s_nop 0
    s_cbranch_vccnz g_25F12_3
    v_smfmac_f32_16x16x64_bf16 v[40:43], v[36:39], a[24:31], v172
    v_smfmac_f32_16x16x64_bf16 v[44:47], v[36:39], a[88:95], v172
    v_smfmac_f32_16x16x64_bf16 v[48:51], v[36:39], a[56:63], v172
    v_smfmac_f32_16x16x64_bf16 v[52:55], v[36:39], a[120:127], v172
    s_branch g_25L4_2
g_25F15_0:
    s_mov_b64 exec, vcc
    buffer_load_dwordx4 v[24:27], v2, s[4:7], s16 offen offset:0 sc1
    s_mov_b64 exec, -1
    s_add_u32 s23, s23, 1
    s_cmp_lt_u32 s23, 200000
    s_cbranch_scc1 g_25L15_1
    s_mov_b32 s25, 200000
    s_branch gc_26
g_25F15_1:
    s_mov_b64 exec, vcc
    buffer_load_dwordx4 v[28:31], v2, s[4:7], s16 offen offset:1024 sc1
    s_mov_b64 exec, -1
    s_add_u32 s23, s23, 1
    s_cmp_lt_u32 s23, 200000
    s_cbranch_scc1 g_25L15_2
    s_mov_b32 s25, 200000
    s_branch gc_26
g_25F15_2:
    s_mov_b64 exec, vcc
    buffer_load_dwordx4 v[32:35], v2, s[4:7], s16 offen offset:2048 sc1
    s_mov_b64 exec, -1
    s_add_u32 s23, s23, 1
    s_cmp_lt_u32 s23, 200000
    s_cbranch_scc1 g_25L15_3
    s_mov_b32 s25, 200000
    s_branch gc_26
g_25F15_3:
    s_mov_b64 exec, vcc
    buffer_load_dwordx4 v[36:39], v2, s[4:7], s16 offen offset:3072 sc1
    s_mov_b64 exec, -1
    s_add_u32 s23, s23, 1
    s_cmp_lt_u32 s23, 200000
    s_cbranch_scc1 g_25L15_0
    s_mov_b32 s25, 200000
    s_branch gc_26
g_25F7_0:
    s_mov_b64 exec, vcc
    buffer_load_dwordx4 v[24:27], v2, s[4:7], s16 offen offset:0 sc1
    s_mov_b64 exec, -1
    s_add_u32 s23, s23, 1
    s_cmp_lt_u32 s23, 200000
    s_cbranch_scc1 g_25L7_1
    s_mov_b32 s25, 200000
    s_branch gc_26
g_25F7_1:
    s_mov_b64 exec, vcc
    buffer_load_dwordx4 v[28:31], v2, s[4:7], s16 offen offset:1024 sc1
    s_mov_b64 exec, -1
    s_add_u32 s23, s23, 1
    s_cmp_lt_u32 s23, 200000
    s_cbranch_scc1 g_25L7_2
    s_mov_b32 s25, 200000
    s_branch gc_26
g_25F7_2:
    s_mov_b64 exec, vcc
    buffer_load_dwordx4 v[32:35], v2, s[4:7], s16 offen offset:2048 sc1
    s_mov_b64 exec, -1
    s_add_u32 s23, s23, 1
    s_cmp_lt_u32 s23, 200000
    s_cbranch_scc1 g_25L7_0
    s_mov_b32 s25, 200000
    s_branch gc_26
g_25F11_0:
    s_mov_b64 exec, vcc
    buffer_load_dwordx4 v[24:27], v2, s[4:7], s16 offen offset:0 sc1
    s_mov_b64 exec, -1
    s_add_u32 s23, s23, 1
    s_cmp_lt_u32 s23, 200000
    s_cbranch_scc1 g_25L11_1
    s_mov_b32 s25, 200000
    s_branch gc_26
g_25F11_1:
    s_mov_b64 exec, vcc
    buffer_load_dwordx4 v[28:31], v2, s[4:7], s16 offen offset:1024 sc1
    s_mov_b64 exec, -1
    s_add_u32 s23, s23, 1
    s_cmp_lt_u32 s23, 200000
    s_cbranch_scc1 g_25L11_3
    s_mov_b32 s25, 200000
    s_branch gc_26
g_25F11_3:
    s_mov_b64 exec, vcc
    buffer_load_dwordx4 v[36:39], v2, s[4:7], s16 offen offset:3072 sc1
    s_mov_b64 exec, -1
    s_add_u32 s23, s23, 1
    s_cmp_lt_u32 s23, 200000
    s_cbranch_scc1 g_25L11_0
    s_mov_b32 s25, 200000
    s_branch gc_26
g_25F13_0:
    s_mov_b64 exec, vcc
    buffer_load_dwordx4 v[24:27], v2, s[4:7], s16 offen offset:0 sc1
    s_mov_b64 exec, -1
    s_add_u32 s23, s23, 1
    s_cmp_lt_u32 s23, 200000
    s_cbranch_scc1 g_25L13_2
    s_mov_b32 s25, 200000
    s_branch gc_26
g_25F13_2:
    s_mov_b64 exec, vcc
    buffer_load_dwordx4 v[32:35], v2, s[4:7], s16 offen offset:2048 sc1
    s_mov_b64 exec, -1
    s_add_u32 s23, s23, 1
    s_cmp_lt_u32 s23, 200000
    s_cbranch_scc1 g_25L13_3
    s_mov_b32 s25, 200000
    s_branch gc_26
g_25F13_3:
    s_mov_b64 exec, vcc
    buffer_load_dwordx4 v[36:39], v2, s[4:7], s16 offen offset:3072 sc1
    s_mov_b64 exec, -1
    s_add_u32 s23, s23, 1
    s_cmp_lt_u32 s23, 200000
    s_cbranch_scc1 g_25L13_0
    s_mov_b32 s25, 200000
    s_branch gc_26
g_25F14_1:
    s_mov_b64 exec, vcc
    buffer_load_dwordx4 v[28:31], v2, s[4:7], s16 offen offset:1024 sc1
    s_mov_b64 exec, -1
    s_add_u32 s23, s23, 1
    s_cmp_lt_u32 s23, 200000
    s_cbranch_scc1 g_25L14_2
    s_mov_b32 s25, 200000
    s_branch gc_26
g_25F14_2:
    s_mov_b64 exec, vcc
    buffer_load_dwordx4 v[32:35], v2, s[4:7], s16 offen offset:2048 sc1
    s_mov_b64 exec, -1
    s_add_u32 s23, s23, 1
    s_cmp_lt_u32 s23, 200000
    s_cbranch_scc1 g_25L14_3
    s_mov_b32 s25, 200000
    s_branch gc_26
g_25F14_3:
    s_mov_b64 exec, vcc
    buffer_load_dwordx4 v[36:39], v2, s[4:7], s16 offen offset:3072 sc1
    s_mov_b64 exec, -1
    s_add_u32 s23, s23, 1
    s_cmp_lt_u32 s23, 200000
    s_cbranch_scc1 g_25L14_1
    s_mov_b32 s25, 200000
    s_branch gc_26
g_25F3_0:
    s_mov_b64 exec, vcc
    buffer_load_dwordx4 v[24:27], v2, s[4:7], s16 offen offset:0 sc1
    s_mov_b64 exec, -1
    s_add_u32 s23, s23, 1
    s_cmp_lt_u32 s23, 200000
    s_cbranch_scc1 g_25L3_1
    s_mov_b32 s25, 200000
    s_branch gc_26
g_25F3_1:
    s_mov_b64 exec, vcc
    buffer_load_dwordx4 v[28:31], v2, s[4:7], s16 offen offset:1024 sc1
    s_mov_b64 exec, -1
    s_add_u32 s23, s23, 1
    s_cmp_lt_u32 s23, 200000
    s_cbranch_scc1 g_25L3_0
    s_mov_b32 s25, 200000
    s_branch gc_26
g_25F5_0:
    s_mov_b64 exec, vcc
    buffer_load_dwordx4 v[24:27], v2, s[4:7], s16 offen offset:0 sc1
    s_mov_b64 exec, -1
    s_add_u32 s23, s23, 1
    s_cmp_lt_u32 s23, 200000
    s_cbranch_scc1 g_25L5_2
    s_mov_b32 s25, 200000
    s_branch gc_26
g_25F5_2:
    s_mov_b64 exec, vcc
    buffer_load_dwordx4 v[32:35], v2, s[4:7], s16 offen offset:2048 sc1
    s_mov_b64 exec, -1
    s_add_u32 s23, s23, 1
    s_cmp_lt_u32 s23, 200000
    s_cbranch_scc1 g_25L5_0
    s_mov_b32 s25, 200000
    s_branch gc_26
g_25F6_1:
    s_mov_b64 exec, vcc
    buffer_load_dwordx4 v[28:31], v2, s[4:7], s16 offen offset:1024 sc1
    s_mov_b64 exec, -1
    s_add_u32 s23, s23, 1
    s_cmp_lt_u32 s23, 200000
    s_cbranch_scc1 g_25L6_2
    s_mov_b32 s25, 200000
    s_branch gc_26
g_25F6_2:
    s_mov_b64 exec, vcc
    buffer_load_dwordx4 v[32:35], v2, s[4:7], s16 offen offset:2048 sc1
    s_mov_b64 exec, -1
    s_add_u32 s23, s23, 1
    s_cmp_lt_u32 s23, 200000
    s_cbranch_scc1 g_25L6_1
    s_mov_b32 s25, 200000
    s_branch gc_26
g_25F9_0:
    s_mov_b64 exec, vcc
    buffer_load_dwordx4 v[24:27], v2, s[4:7], s16 offen offset:0 sc1
    s_mov_b64 exec, -1
    s_add_u32 s23, s23, 1
    s_cmp_lt_u32 s23, 200000
    s_cbranch_scc1 g_25L9_3
    s_mov_b32 s25, 200000
    s_branch gc_26
g_25F9_3:
    s_mov_b64 exec, vcc
    buffer_load_dwordx4 v[36:39], v2, s[4:7], s16 offen offset:3072 sc1
    s_mov_b64 exec, -1
    s_add_u32 s23, s23, 1
    s_cmp_lt_u32 s23, 200000
    s_cbranch_scc1 g_25L9_0
    s_mov_b32 s25, 200000
    s_branch gc_26
g_25F10_1:
    s_mov_b64 exec, vcc
    buffer_load_dwordx4 v[28:31], v2, s[4:7], s16 offen offset:1024 sc1
    s_mov_b64 exec, -1
    s_add_u32 s23, s23, 1
    s_cmp_lt_u32 s23, 200000
    s_cbranch_scc1 g_25L10_3
    s_mov_b32 s25, 200000
    s_branch gc_26
g_25F10_3:
    s_mov_b64 exec, vcc
    buffer_load_dwordx4 v[36:39], v2, s[4:7], s16 offen offset:3072 sc1
    s_mov_b64 exec, -1
    s_add_u32 s23, s23, 1
    s_cmp_lt_u32 s23, 200000
    s_cbranch_scc1 g_25L10_1
    s_mov_b32 s25, 200000
    s_branch gc_26
g_25F12_2:
    s_mov_b64 exec, vcc
    buffer_load_dwordx4 v[32:35], v2, s[4:7], s16 offen offset:2048 sc1
    s_mov_b64 exec, -1
    s_add_u32 s23, s23, 1
    s_cmp_lt_u32 s23, 200000
    s_cbranch_scc1 g_25L12_3
    s_mov_b32 s25, 200000
    s_branch gc_26
g_25F12_3:
    s_mov_b64 exec, vcc
    buffer_load_dwordx4 v[36:39], v2, s[4:7], s16 offen offset:3072 sc1
    s_mov_b64 exec, -1
    s_add_u32 s23, s23, 1
    s_cmp_lt_u32 s23, 200000
    s_cbranch_scc1 g_25L12_2
    s_mov_b32 s25, 200000
    s_branch gc_26
g_25F1_0:
    s_mov_b64 exec, vcc
    buffer_load_dwordx4 v[24:27], v2, s[4:7], s16 offen offset:0 sc1
    s_mov_b64 exec, -1
    s_add_u32 s23, s23, 1
    s_cmp_lt_u32 s23, 200000
    s_cbranch_scc1 g_25L1_0
    s_mov_b32 s25, 200000
    s_branch gc_26
g_25F2_1:
    s_mov_b64 exec, vcc
    buffer_load_dwordx4 v[28:31], v2, s[4:7], s16 offen offset:1024 sc1
    s_mov_b64 exec, -1
    s_add_u32 s23, s23, 1
    s_cmp_lt_u32 s23, 200000
    s_cbranch_scc1 g_25L2_1
    s_mov_b32 s25, 200000
    s_branch gc_26
g_25F4_2:
    s_mov_b64 exec, vcc
    buffer_load_dwordx4 v[32:35], v2, s[4:7], s16 offen offset:2048 sc1
    s_mov_b64 exec, -1
    s_add_u32 s23, s23, 1
    s_cmp_lt_u32 s23, 200000
    s_cbranch_scc1 g_25L4_2
    s_mov_b32 s25, 200000
    s_branch gc_26
g_25F8_3:
    s_mov_b64 exec, vcc
    buffer_load_dwordx4 v[36:39], v2, s[4:7], s16 offen offset:3072 sc1
    s_mov_b64 exec, -1
    s_add_u32 s23, s23, 1
    s_cmp_lt_u32 s23, 200000
    s_cbranch_scc1 g_25L8_3
    s_mov_b32 s25, 200000
    s_branch gc_26
recur_fast_last0:
    buffer_store_dwordx4 v[128:131], v14, s[4:7], s19 offen sc1
    s_waitcnt vmcnt(0)
    s_branch recur_end
g_27L15_0:
    s_waitcnt vmcnt(3)
    v_max3_u32 v19, v24, v25, v26
    v_max_u32 v19, v19, v27
    v_cmp_eq_u32 vcc, -1, v19
    s_nop 0
    s_cbranch_vccnz g_27F15_0
    v_smfmac_f32_16x16x64_bf16 v[64:67], v[24:27], a[192:199], v172
    v_smfmac_f32_16x16x64_bf16 v[68:71], v[24:27], a[224:231], v172
g_27L14_1:
    s_waitcnt vmcnt(2)
    v_max3_u32 v19, v28, v29, v30
    v_max_u32 v19, v19, v31
    v_cmp_eq_u32 vcc, -1, v19
    s_nop 0
    s_cbranch_vccnz g_27F14_1
    v_smfmac_f32_16x16x64_bf16 v[64:67], v[28:31], a[200:207], v172
    v_smfmac_f32_16x16x64_bf16 v[68:71], v[28:31], a[232:239], v172
g_27L12_2:
    s_waitcnt vmcnt(1)
    v_max3_u32 v19, v32, v33, v34
    v_max_u32 v19, v19, v35
    v_cmp_eq_u32 vcc, -1, v19
    s_nop 0
    s_cbranch_vccnz g_27F12_2
    v_smfmac_f32_16x16x64_bf16 v[64:67], v[32:35], a[208:215], v172
    v_smfmac_f32_16x16x64_bf16 v[68:71], v[32:35], a[240:247], v172
g_27L8_3:
    s_waitcnt vmcnt(0)
    v_max3_u32 v19, v36, v37, v38
    v_max_u32 v19, v19, v39
    v_cmp_eq_u32 vcc, -1, v19
    s_nop 0
    s_cbranch_vccnz g_27F8_3
    v_smfmac_f32_16x16x64_bf16 v[64:67], v[36:39], a[216:223], v172
    v_smfmac_f32_16x16x64_bf16 v[68:71], v[36:39], a[248:255], v172
    s_nop 4
    v_cvt_pk_bf16_f32 v80, v64, v65
    v_cvt_pk_bf16_f32 v81, v66, v67
    s_nop 0
    v_cvt_pk_bf16_f32 v82, v68, v69
    v_cvt_pk_bf16_f32 v83, v70, v71
    ds_write_b128 v17, v[80:83] offset:9216
    s_branch gc_28
g_27L15_1:
    s_waitcnt vmcnt(3)
    v_max3_u32 v19, v28, v29, v30
    v_max_u32 v19, v19, v31
    v_cmp_eq_u32 vcc, -1, v19
    s_nop 0
    s_cbranch_vccnz g_27F15_1
    v_smfmac_f32_16x16x64_bf16 v[64:67], v[28:31], a[200:207], v172
    v_smfmac_f32_16x16x64_bf16 v[68:71], v[28:31], a[232:239], v172
g_27L13_2:
    s_waitcnt vmcnt(2)
    v_max3_u32 v19, v32, v33, v34
    v_max_u32 v19, v19, v35
    v_cmp_eq_u32 vcc, -1, v19
    s_nop 0
    s_cbranch_vccnz g_27F13_2
    v_smfmac_f32_16x16x64_bf16 v[64:67], v[32:35], a[208:215], v172
    v_smfmac_f32_16x16x64_bf16 v[68:71], v[32:35], a[240:247], v172
g_27L9_3:
    s_waitcnt vmcnt(1)
    v_max3_u32 v19, v36, v37, v38
    v_max_u32 v19, v19, v39
    v_cmp_eq_u32 vcc, -1, v19
    s_nop 0
    s_cbranch_vccnz g_27F9_3
    v_smfmac_f32_16x16x64_bf16 v[64:67], v[36:39], a[216:223], v172
    v_smfmac_f32_16x16x64_bf16 v[68:71], v[36:39], a[248:255], v172
g_27L1_0:
    s_waitcnt vmcnt(0)
    v_max3_u32 v19, v24, v25, v26
    v_max_u32 v19, v19, v27
    v_cmp_eq_u32 vcc, -1, v19
    s_nop 0
    s_cbranch_vccnz g_27F1_0
    v_smfmac_f32_16x16x64_bf16 v[64:67], v[24:27], a[192:199], v172
    v_smfmac_f32_16x16x64_bf16 v[68:71], v[24:27], a[224:231], v172
    s_nop 4
    v_cvt_pk_bf16_f32 v80, v64, v65
    v_cvt_pk_bf16_f32 v81, v66, v67
    s_nop 0
    v_cvt_pk_bf16_f32 v82, v68, v69
    v_cvt_pk_bf16_f32 v83, v70, v71
    ds_write_b128 v17, v[80:83] offset:9216
    s_branch gc_28
g_27L15_2:
    s_waitcnt vmcnt(3)
    v_max3_u32 v19, v32, v33, v34
    v_max_u32 v19, v19, v35
    v_cmp_eq_u32 vcc, -1, v19
    s_nop 0
    s_cbranch_vccnz g_27F15_2
    v_smfmac_f32_16x16x64_bf16 v[64:67], v[32:35], a[208:215], v172
    v_smfmac_f32_16x16x64_bf16 v[68:71], v[32:35], a[240:247], v172
g_27L11_3:
    s_waitcnt vmcnt(2)
    v_max3_u32 v19, v36, v37, v38
    v_max_u32 v19, v19, v39
    v_cmp_eq_u32 vcc, -1, v19
    s_nop 0
    s_cbranch_vccnz g_27F11_3
    v_smfmac_f32_16x16x64_bf16 v[64:67], v[36:39], a[216:223], v172
    v_smfmac_f32_16x16x64_bf16 v[68:71], v[36:39], a[248:255], v172
g_27L3_0:
    s_waitcnt vmcnt(1)
    v_max3_u32 v19, v24, v25, v26
    v_max_u32 v19, v19, v27
    v_cmp_eq_u32 vcc, -1, v19
    s_nop 0
    s_cbranch_vccnz g_27F3_0
    v_smfmac_f32_16x16x64_bf16 v[64:67], v[24:27], a[192:199], v172
    v_smfmac_f32_16x16x64_bf16 v[68:71], v[24:27], a[224:231], v172
g_27L2_1:
    s_waitcnt vmcnt(0)
    v_max3_u32 v19, v28, v29, v30
    v_max_u32 v19, v19, v31
    v_cmp_eq_u32 vcc, -1, v19
    s_nop 0
    s_cbranch_vccnz g_27F2_1
    v_smfmac_f32_16x16x64_bf16 v[64:67], v[28:31], a[200:207], v172
    v_smfmac_f32_16x16x64_bf16 v[68:71], v[28:31], a[232:239], v172
    s_nop 4
    v_cvt_pk_bf16_f32 v80, v64, v65
    v_cvt_pk_bf16_f32 v81, v66, v67
    s_nop 0
    v_cvt_pk_bf16_f32 v82, v68, v69
    v_cvt_pk_bf16_f32 v83, v70, v71
    ds_write_b128 v17, v[80:83] offset:9216
    s_branch gc_28
g_27L15_3:
    s_waitcnt vmcnt(3)
    v_max3_u32 v19, v36, v37, v38
    v_max_u32 v19, v19, v39
    v_cmp_eq_u32 vcc, -1, v19
    s_nop 0
    s_cbranch_vccnz g_27F15_3
    v_smfmac_f32_16x16x64_bf16 v[64:67], v[36:39], a[216:223], v172
    v_smfmac_f32_16x16x64_bf16 v[68:71], v[36:39], a[248:255], v172
g_27L7_0:
    s_waitcnt vmcnt(2)
    v_max3_u32 v19, v24, v25, v26
    v_max_u32 v19, v19, v27
    v_cmp_eq_u32 vcc, -1, v19
    s_nop 0
    s_cbranch_vccnz g_27F7_0
    v_smfmac_f32_16x16x64_bf16 v[64:67], v[24:27], a[192:199], v172
    v_smfmac_f32_16x16x64_bf16 v[68:71], v[24:27], a[224:231], v172
g_27L6_1:
    s_waitcnt vmcnt(1)
    v_max3_u32 v19, v28, v29, v30
    v_max_u32 v19, v19, v31
    v_cmp_eq_u32 vcc, -1, v19
    s_nop 0
    s_cbranch_vccnz g_27F6_1
    v_smfmac_f32_16x16x64_bf16 v[64:67], v[28:31], a[200:207], v172
    v_smfmac_f32_16x16x64_bf16 v[68:71], v[28:31], a[232:239], v172
g_27L4_2:
    s_waitcnt vmcnt(0)
    v_max3_u32 v19, v32, v33, v34
    v_max_u32 v19, v19, v35
    v_cmp_eq_u32 vcc, -1, v19
    s_nop 0
    s_cbranch_vccnz g_27F4_2
    v_smfmac_f32_16x16x64_bf16 v[64:67], v[32:35], a[208:215], v172
    v_smfmac_f32_16x16x64_bf16 v[68:71], v[32:35], a[240:247], v172
    s_nop 4
    v_cvt_pk_bf16_f32 v80, v64, v65
    v_cvt_pk_bf16_f32 v81, v66, v67
    s_nop 0
    v_cvt_pk_bf16_f32 v82, v68, v69
    v_cvt_pk_bf16_f32 v83, v70, v71
    ds_write_b128 v17, v[80:83] offset:9216
    s_branch gc_28
g_27L7_1:
    s_waitcnt vmcnt(2)
    v_max3_u32 v19, v28, v29, v30
    v_max_u32 v19, v19, v31
    v_cmp_eq_u32 vcc, -1, v19
    s_nop 0
    s_cbranch_vccnz g_27F7_1
    v_smfmac_f32_16x16x64_bf16 v[64:67], v[28:31], a[200:207], v172
    v_smfmac_f32_16x16x64_bf16 v[68:71], v[28:31], a[232:239], v172
g_27L5_2:
    s_waitcnt vmcnt(1)
    v_max3_u32 v19, v32, v33, v34
    v_max_u32 v19, v19, v35
    v_cmp_eq_u32 vcc, -1, v19
    s_nop 0
    s_cbranch_vccnz g_27F5_2
    v_smfmac_f32_16x16x64_bf16 v[64:67], v[32:35], a[208:215], v172
    v_smfmac_f32_16x16x64_bf16 v[68:71], v[32:35], a[240:247], v172
    s_branch g_27L1_0
g_27L7_2:
    s_waitcnt vmcnt(2)
    v_max3_u32 v19, v32, v33, v34
    v_max_u32 v19, v19, v35
    v_cmp_eq_u32 vcc, -1, v19
    s_nop 0
    s_cbranch_vccnz g_27F7_2
    v_smfmac_f32_16x16x64_bf16 v[64:67], v[32:35], a[208:215], v172
    v_smfmac_f32_16x16x64_bf16 v[68:71], v[32:35], a[240:247], v172
    s_branch g_27L3_0
g_27L11_0:
    s_waitcnt vmcnt(2)
    v_max3_u32 v19, v24, v25, v26
    v_max_u32 v19, v19, v27
    v_cmp_eq_u32 vcc, -1, v19
    s_nop 0
    s_cbranch_vccnz g_27F11_0
    v_smfmac_f32_16x16x64_bf16 v[64:67], v[24:27], a[192:199], v172
    v_smfmac_f32_16x16x64_bf16 v[68:71], v[24:27], a[224:231], v172
g_27L10_1:
    s_waitcnt vmcnt(1)
    v_max3_u32 v19, v28, v29, v30
    v_max_u32 v19, v19, v31
    v_cmp_eq_u32 vcc, -1, v19
    s_nop 0
    s_cbranch_vccnz g_27F10_1
    v_smfmac_f32_16x16x64_bf16 v[64:67], v[28:31], a[200:207], v172
    v_smfmac_f32_16x16x64_bf16 v[68:71], v[28:31], a[232:239], v172
    s_branch g_27L8_3
g_27L11_1:
    s_waitcnt vmcnt(2)
    v_max3_u32 v19, v28, v29, v30
    v_max_u32 v19, v19, v31
    v_cmp_eq_u32 vcc, -1, v19
    s_nop 0
    s_cbranch_vccnz g_27F11_1
    v_smfmac_f32_16x16x64_bf16 v[64:67], v[28:31], a[200:207], v172
    v_smfmac_f32_16x16x64_bf16 v[68:71], v[28:31], a[232:239], v172
    s_branch g_27L9_3
g_27L13_0:
    s_waitcnt vmcnt(2)
    v_max3_u32 v19, v24, v25, v26
    v_max_u32 v19, v19, v27
    v_cmp_eq_u32 vcc, -1, v19
    s_nop 0
    s_cbranch_vccnz g_27F13_0
    v_smfmac_f32_16x16x64_bf16 v[64:67], v[24:27], a[192:199], v172
    v_smfmac_f32_16x16x64_bf16 v[68:71], v[24:27], a[224:231], v172
    s_branch g_27L12_2
g_27L13_3:
    s_waitcnt vmcnt(2)
    v_max3_u32 v19, v36, v37, v38
    v_max_u32 v19, v19, v39
    v_cmp_eq_u32 vcc, -1, v19
    s_nop 0
    s_cbranch_vccnz g_27F13_3
    v_smfmac_f32_16x16x64_bf16 v[64:67], v[36:39], a[216:223], v172
    v_smfmac_f32_16x16x64_bf16 v[68:71], v[36:39], a[248:255], v172
g_27L5_0:
    s_waitcnt vmcnt(1)
    v_max3_u32 v19, v24, v25, v26
    v_max_u32 v19, v19, v27
    v_cmp_eq_u32 vcc, -1, v19
    s_nop 0
    s_cbranch_vccnz g_27F5_0
    v_smfmac_f32_16x16x64_bf16 v[64:67], v[24:27], a[192:199], v172
    v_smfmac_f32_16x16x64_bf16 v[68:71], v[24:27], a[224:231], v172
    s_branch g_27L4_2
g_27L14_2:
    s_waitcnt vmcnt(2)
    v_max3_u32 v19, v32, v33, v34
    v_max_u32 v19, v19, v35
    v_cmp_eq_u32 vcc, -1, v19
    s_nop 0
    s_cbranch_vccnz g_27F14_2
    v_smfmac_f32_16x16x64_bf16 v[64:67], v[32:35], a[208:215], v172
    v_smfmac_f32_16x16x64_bf16 v[68:71], v[32:35], a[240:247], v172
g_27L10_3:
    s_waitcnt vmcnt(1)
    v_max3_u32 v19, v36, v37, v38
    v_max_u32 v19, v19, v39
    v_cmp_eq_u32 vcc, -1, v19
    s_nop 0
    s_cbranch_vccnz g_27F10_3
    v_smfmac_f32_16x16x64_bf16 v[64:67], v[36:39], a[216:223], v172
    v_smfmac_f32_16x16x64_bf16 v[68:71], v[36:39], a[248:255], v172
    s_branch g_27L2_1
g_27L14_3:
    s_waitcnt vmcnt(2)
    v_max3_u32 v19, v36, v37, v38
    v_max_u32 v19, v19, v39
    v_cmp_eq_u32 vcc, -1, v19
    s_nop 0
    s_cbranch_vccnz g_27F14_3
    v_smfmac_f32_16x16x64_bf16 v[64:67], v[36:39], a[216:223], v172
    v_smfmac_f32_16x16x64_bf16 v[68:71], v[36:39], a[248:255], v172
    s_branch g_27L6_1
g_27L3_1:
    s_waitcnt vmcnt(1)
    v_max3_u32 v19, v28, v29, v30
    v_max_u32 v19, v19, v31
    v_cmp_eq_u32 vcc, -1, v19
    s_nop 0
    s_cbranch_vccnz g_27F3_1
    v_smfmac_f32_16x16x64_bf16 v[64:67], v[28:31], a[200:207], v172
    v_smfmac_f32_16x16x64_bf16 v[68:71], v[28:31], a[232:239], v172
    s_branch g_27L1_0
g_27L6_2:
    s_waitcnt vmcnt(1)
    v_max3_u32 v19, v32, v33, v34
    v_max_u32 v19, v19, v35
    v_cmp_eq_u32 vcc, -1, v19
    s_nop 0
    s_cbranch_vccnz g_27F6_2
    v_smfmac_f32_16x16x64_bf16 v[64:67], v[32:35], a[208:215], v172
    v_smfmac_f32_16x16x64_bf16 v[68:71], v[32:35], a[240:247], v172
    s_branch g_27L2_1
g_27L9_0:
    s_waitcnt vmcnt(1)
    v_max3_u32 v19, v24, v25, v26
    v_max_u32 v19, v19, v27
    v_cmp_eq_u32 vcc, -1, v19
    s_nop 0
    s_cbranch_vccnz g_27F9_0
    v_smfmac_f32_16x16x64_bf16 v[64:67], v[24:27], a[192:199], v172
    v_smfmac_f32_16x16x64_bf16 v[68:71], v[24:27], a[224:231], v172
    s_branch g_27L8_3
g_27L12_3:
    s_waitcnt vmcnt(1)
    v_max3_u32 v19, v36, v37, v38
    v_max_u32 v19, v19, v39
    v_cmp_eq_u32 vcc, -1, v19
    s_nop 0
    s_cbranch_vccnz g_27F12_3
    v_smfmac_f32_16x16x64_bf16 v[64:67], v[36:39], a[216:223], v172
    v_smfmac_f32_16x16x64_bf16 v[68:71], v[36:39], a[248:255], v172
    s_branch g_27L4_2
g_27F15_0:
    s_mov_b64 exec, vcc
    buffer_load_dwordx4 v[24:27], v8, s[4:7], s16 offen offset:0 sc1
    s_mov_b64 exec, -1
    s_add_u32 s23, s23, 1
    s_cmp_lt_u32 s23, 200000
    s_cbranch_scc1 g_27L15_1
    s_mov_b32 s25, 200000
    s_branch gc_28
g_27F15_1:
    s_mov_b64 exec, vcc
    buffer_load_dwordx4 v[28:31], v8, s[4:7], s16 offen offset:1024 sc1
    s_mov_b64 exec, -1
    s_add_u32 s23, s23, 1
    s_cmp_lt_u32 s23, 200000
    s_cbranch_scc1 g_27L15_2
    s_mov_b32 s25, 200000
    s_branch gc_28
g_27F15_2:
    s_mov_b64 exec, vcc
    buffer_load_dwordx4 v[32:35], v8, s[4:7], s16 offen offset:2048 sc1
    s_mov_b64 exec, -1
    s_add_u32 s23, s23, 1
    s_cmp_lt_u32 s23, 200000
    s_cbranch_scc1 g_27L15_3
    s_mov_b32 s25, 200000
    s_branch gc_28
g_27F15_3:
    s_mov_b64 exec, vcc
    buffer_load_dwordx4 v[36:39], v8, s[4:7], s16 offen offset:3072 sc1
    s_mov_b64 exec, -1
    s_add_u32 s23, s23, 1
    s_cmp_lt_u32 s23, 200000
    s_cbranch_scc1 g_27L15_0
    s_mov_b32 s25, 200000
    s_branch gc_28
g_27F7_0:
    s_mov_b64 exec, vcc
    buffer_load_dwordx4 v[24:27], v8, s[4:7], s16 offen offset:0 sc1
    s_mov_b64 exec, -1
    s_add_u32 s23, s23, 1
    s_cmp_lt_u32 s23, 200000
    s_cbranch_scc1 g_27L7_1
    s_mov_b32 s25, 200000
    s_branch gc_28
g_27F7_1:
    s_mov_b64 exec, vcc
    buffer_load_dwordx4 v[28:31], v8, s[4:7], s16 offen offset:1024 sc1
    s_mov_b64 exec, -1
    s_add_u32 s23, s23, 1
    s_cmp_lt_u32 s23, 200000
    s_cbranch_scc1 g_27L7_2
    s_mov_b32 s25, 200000
    s_branch gc_28
g_27F7_2:
    s_mov_b64 exec, vcc
    buffer_load_dwordx4 v[32:35], v8, s[4:7], s16 offen offset:2048 sc1
    s_mov_b64 exec, -1
    s_add_u32 s23, s23, 1
    s_cmp_lt_u32 s23, 200000
    s_cbranch_scc1 g_27L7_0
    s_mov_b32 s25, 200000
    s_branch gc_28
g_27F11_0:
    s_mov_b64 exec, vcc
    buffer_load_dwordx4 v[24:27], v8, s[4:7], s16 offen offset:0 sc1
    s_mov_b64 exec, -1
    s_add_u32 s23, s23, 1
    s_cmp_lt_u32 s23, 200000
    s_cbranch_scc1 g_27L11_1
    s_mov_b32 s25, 200000
    s_branch gc_28
g_27F11_1:
    s_mov_b64 exec, vcc
    buffer_load_dwordx4 v[28:31], v8, s[4:7], s16 offen offset:1024 sc1
    s_mov_b64 exec, -1
    s_add_u32 s23, s23, 1
    s_cmp_lt_u32 s23, 200000
    s_cbranch_scc1 g_27L11_3
    s_mov_b32 s25, 200000
    s_branch gc_28
g_27F11_3:
    s_mov_b64 exec, vcc
    buffer_load_dwordx4 v[36:39], v8, s[4:7], s16 offen offset:3072 sc1
    s_mov_b64 exec, -1
    s_add_u32 s23, s23, 1
    s_cmp_lt_u32 s23, 200000
    s_cbranch_scc1 g_27L11_0
    s_mov_b32 s25, 200000
    s_branch gc_28
g_27F13_0:
    s_mov_b64 exec, vcc
    buffer_load_dwordx4 v[24:27], v8, s[4:7], s16 offen offset:0 sc1
    s_mov_b64 exec, -1
    s_add_u32 s23, s23, 1
    s_cmp_lt_u32 s23, 200000
    s_cbranch_scc1 g_27L13_2
    s_mov_b32 s25, 200000
    s_branch gc_28
g_27F13_2:
    s_mov_b64 exec, vcc
    buffer_load_dwordx4 v[32:35], v8, s[4:7], s16 offen offset:2048 sc1
    s_mov_b64 exec, -1
    s_add_u32 s23, s23, 1
    s_cmp_lt_u32 s23, 200000
    s_cbranch_scc1 g_27L13_3
    s_mov_b32 s25, 200000
    s_branch gc_28
g_27F13_3:
    s_mov_b64 exec, vcc
    buffer_load_dwordx4 v[36:39], v8, s[4:7], s16 offen offset:3072 sc1
    s_mov_b64 exec, -1
    s_add_u32 s23, s23, 1
    s_cmp_lt_u32 s23, 200000
    s_cbranch_scc1 g_27L13_0
    s_mov_b32 s25, 200000
    s_branch gc_28
g_27F14_1:
    s_mov_b64 exec, vcc
    buffer_load_dwordx4 v[28:31], v8, s[4:7], s16 offen offset:1024 sc1
    s_mov_b64 exec, -1
    s_add_u32 s23, s23, 1
    s_cmp_lt_u32 s23, 200000
    s_cbranch_scc1 g_27L14_2
    s_mov_b32 s25, 200000
    s_branch gc_28
g_27F14_2:
    s_mov_b64 exec, vcc
    buffer_load_dwordx4 v[32:35], v8, s[4:7], s16 offen offset:2048 sc1
    s_mov_b64 exec, -1
    s_add_u32 s23, s23, 1
    s_cmp_lt_u32 s23, 200000
    s_cbranch_scc1 g_27L14_3
    s_mov_b32 s25, 200000
    s_branch gc_28
g_27F14_3:
    s_mov_b64 exec, vcc
    buffer_load_dwordx4 v[36:39], v8, s[4:7], s16 offen offset:3072 sc1
    s_mov_b64 exec, -1
    s_add_u32 s23, s23, 1
    s_cmp_lt_u32 s23, 200000
    s_cbranch_scc1 g_27L14_1
    s_mov_b32 s25, 200000
    s_branch gc_28
g_27F3_0:
    s_mov_b64 exec, vcc
    buffer_load_dwordx4 v[24:27], v8, s[4:7], s16 offen offset:0 sc1
    s_mov_b64 exec, -1
    s_add_u32 s23, s23, 1
    s_cmp_lt_u32 s23, 200000
    s_cbranch_scc1 g_27L3_1
    s_mov_b32 s25, 200000
    s_branch gc_28
g_27F3_1:
    s_mov_b64 exec, vcc
    buffer_load_dwordx4 v[28:31], v8, s[4:7], s16 offen offset:1024 sc1
    s_mov_b64 exec, -1
    s_add_u32 s23, s23, 1
    s_cmp_lt_u32 s23, 200000
    s_cbranch_scc1 g_27L3_0
    s_mov_b32 s25, 200000
    s_branch gc_28
g_27F5_0:
    s_mov_b64 exec, vcc
    buffer_load_dwordx4 v[24:27], v8, s[4:7], s16 offen offset:0 sc1
    s_mov_b64 exec, -1
    s_add_u32 s23, s23, 1
    s_cmp_lt_u32 s23, 200000
    s_cbranch_scc1 g_27L5_2
    s_mov_b32 s25, 200000
    s_branch gc_28
g_27F5_2:
    s_mov_b64 exec, vcc
    buffer_load_dwordx4 v[32:35], v8, s[4:7], s16 offen offset:2048 sc1
    s_mov_b64 exec, -1
    s_add_u32 s23, s23, 1
    s_cmp_lt_u32 s23, 200000
    s_cbranch_scc1 g_27L5_0
    s_mov_b32 s25, 200000
    s_branch gc_28
g_27F6_1:
    s_mov_b64 exec, vcc
    buffer_load_dwordx4 v[28:31], v8, s[4:7], s16 offen offset:1024 sc1
    s_mov_b64 exec, -1
    s_add_u32 s23, s23, 1
    s_cmp_lt_u32 s23, 200000
    s_cbranch_scc1 g_27L6_2
    s_mov_b32 s25, 200000
    s_branch gc_28
g_27F6_2:
    s_mov_b64 exec, vcc
    buffer_load_dwordx4 v[32:35], v8, s[4:7], s16 offen offset:2048 sc1
    s_mov_b64 exec, -1
    s_add_u32 s23, s23, 1
    s_cmp_lt_u32 s23, 200000
    s_cbranch_scc1 g_27L6_1
    s_mov_b32 s25, 200000
    s_branch gc_28
g_27F9_0:
    s_mov_b64 exec, vcc
    buffer_load_dwordx4 v[24:27], v8, s[4:7], s16 offen offset:0 sc1
    s_mov_b64 exec, -1
    s_add_u32 s23, s23, 1
    s_cmp_lt_u32 s23, 200000
    s_cbranch_scc1 g_27L9_3
    s_mov_b32 s25, 200000
    s_branch gc_28
g_27F9_3:
    s_mov_b64 exec, vcc
    buffer_load_dwordx4 v[36:39], v8, s[4:7], s16 offen offset:3072 sc1
    s_mov_b64 exec, -1
    s_add_u32 s23, s23, 1
    s_cmp_lt_u32 s23, 200000
    s_cbranch_scc1 g_27L9_0
    s_mov_b32 s25, 200000
    s_branch gc_28
g_27F10_1:
    s_mov_b64 exec, vcc
    buffer_load_dwordx4 v[28:31], v8, s[4:7], s16 offen offset:1024 sc1
    s_mov_b64 exec, -1
    s_add_u32 s23, s23, 1
    s_cmp_lt_u32 s23, 200000
    s_cbranch_scc1 g_27L10_3
    s_mov_b32 s25, 200000
    s_branch gc_28
g_27F10_3:
    s_mov_b64 exec, vcc
    buffer_load_dwordx4 v[36:39], v8, s[4:7], s16 offen offset:3072 sc1
    s_mov_b64 exec, -1
    s_add_u32 s23, s23, 1
    s_cmp_lt_u32 s23, 200000
    s_cbranch_scc1 g_27L10_1
    s_mov_b32 s25, 200000
    s_branch gc_28
g_27F12_2:
    s_mov_b64 exec, vcc
    buffer_load_dwordx4 v[32:35], v8, s[4:7], s16 offen offset:2048 sc1
    s_mov_b64 exec, -1
    s_add_u32 s23, s23, 1
    s_cmp_lt_u32 s23, 200000
    s_cbranch_scc1 g_27L12_3
    s_mov_b32 s25, 200000
    s_branch gc_28
g_27F12_3:
    s_mov_b64 exec, vcc
    buffer_load_dwordx4 v[36:39], v8, s[4:7], s16 offen offset:3072 sc1
    s_mov_b64 exec, -1
    s_add_u32 s23, s23, 1
    s_cmp_lt_u32 s23, 200000
    s_cbranch_scc1 g_27L12_2
    s_mov_b32 s25, 200000
    s_branch gc_28
g_27F1_0:
    s_mov_b64 exec, vcc
    buffer_load_dwordx4 v[24:27], v8, s[4:7], s16 offen offset:0 sc1
    s_mov_b64 exec, -1
    s_add_u32 s23, s23, 1
    s_cmp_lt_u32 s23, 200000
    s_cbranch_scc1 g_27L1_0
    s_mov_b32 s25, 200000
    s_branch gc_28
g_27F2_1:
    s_mov_b64 exec, vcc
    buffer_load_dwordx4 v[28:31], v8, s[4:7], s16 offen offset:1024 sc1
    s_mov_b64 exec, -1
    s_add_u32 s23, s23, 1
    s_cmp_lt_u32 s23, 200000
    s_cbranch_scc1 g_27L2_1
    s_mov_b32 s25, 200000
    s_branch gc_28
g_27F4_2:
    s_mov_b64 exec, vcc
    buffer_load_dwordx4 v[32:35], v8, s[4:7], s16 offen offset:2048 sc1
    s_mov_b64 exec, -1
    s_add_u32 s23, s23, 1
    s_cmp_lt_u32 s23, 200000
    s_cbranch_scc1 g_27L4_2
    s_mov_b32 s25, 200000
    s_branch gc_28
g_27F8_3:
    s_mov_b64 exec, vcc
    buffer_load_dwordx4 v[36:39], v8, s[4:7], s16 offen offset:3072 sc1
    s_mov_b64 exec, -1
    s_add_u32 s23, s23, 1
    s_cmp_lt_u32 s23, 200000
    s_cbranch_scc1 g_27L8_3
    s_mov_b32 s25, 200000
    s_branch gc_28
.p2align 6
recur_fast_w1:
    s_nop 15
    s_mov_b32 s23, s25
    buffer_load_dwordx4 v[24:27], v2, s[4:7], s16 offen offset:0 sc1
    s_nop 11
    buffer_load_dwordx4 v[28:31], v2, s[4:7], s16 offen offset:1024 sc1
    s_nop 11
    buffer_load_dwordx4 v[32:35], v2, s[4:7], s16 offen offset:2048 sc1
    s_nop 11
    buffer_load_dwordx4 v[36:39], v2, s[4:7], s16 offen offset:3072 sc1
    s_waitcnt vmcnt(3)
    v_max3_u32 v19, v24, v25, v26
    v_max_u32 v19, v19, v27
    v_cmp_eq_u32 vcc, -1, v19
    s_nop 0
    s_cbranch_vccnz g_31F15_0
    v_smfmac_f32_16x16x64_bf16 v[40:43], v[24:27], a[0:7], v172
    s_waitcnt vmcnt(2)
    v_max3_u32 v19, v28, v29, v30
    v_max_u32 v19, v19, v31
    v_smfmac_f32_16x16x64_bf16 v[44:47], v[24:27], a[64:71], v172
    v_cmp_eq_u32 vcc, -1, v19
    v_smfmac_f32_16x16x64_bf16 v[48:51], v[24:27], a[32:39], v172
    v_smfmac_f32_16x16x64_bf16 v[52:55], v[24:27], a[96:103], v172
    s_cbranch_vccnz g_31F14_1
    v_smfmac_f32_16x16x64_bf16 v[40:43], v[28:31], a[8:15], v172
    s_waitcnt vmcnt(1)
    v_max3_u32 v19, v32, v33, v34
    v_max_u32 v19, v19, v35
    v_smfmac_f32_16x16x64_bf16 v[44:47], v[28:31], a[72:79], v172
    v_cmp_eq_u32 vcc, -1, v19
    v_smfmac_f32_16x16x64_bf16 v[48:51], v[28:31], a[40:47], v172
    v_smfmac_f32_16x16x64_bf16 v[52:55], v[28:31], a[104:111], v172
    s_cbranch_vccnz g_31F12_2
    v_smfmac_f32_16x16x64_bf16 v[40:43], v[32:35], a[16:23], v172
    s_waitcnt vmcnt(0)
    v_max3_u32 v19, v36, v37, v38
    v_max_u32 v19, v19, v39
    v_smfmac_f32_16x16x64_bf16 v[44:47], v[32:35], a[80:87], v172
    v_cmp_eq_u32 vcc, -1, v19
    v_smfmac_f32_16x16x64_bf16 v[48:51], v[32:35], a[48:55], v172
    v_smfmac_f32_16x16x64_bf16 v[52:55], v[32:35], a[112:119], v172
    s_cbranch_vccnz g_31F8_3
    v_smfmac_f32_16x16x64_bf16 v[40:43], v[36:39], a[24:31], v172
    v_smfmac_f32_16x16x64_bf16 v[44:47], v[36:39], a[88:95], v172
    v_smfmac_f32_16x16x64_bf16 v[48:51], v[36:39], a[56:63], v172
    v_smfmac_f32_16x16x64_bf16 v[52:55], v[36:39], a[120:127], v172
gc_32:
    v_cvt_pk_bf16_f32 v72, v40, v41
    v_cvt_pk_bf16_f32 v73, v42, v43
    v_cvt_pk_bf16_f32 v74, v44, v45
    v_cvt_pk_bf16_f32 v75, v46, v47
    ds_write_b128 v17, v[72:75] offset:0
    v_cvt_pk_bf16_f32 v76, v48, v49
    v_cvt_pk_bf16_f32 v77, v50, v51
    s_nop 0
    v_cvt_pk_bf16_f32 v78, v52, v53
    v_cvt_pk_bf16_f32 v79, v54, v55
    ds_write_b128 v17, v[76:79] offset:1024
    v_smfmac_f32_16x16x64_bf16 v[56:59], v[24:27], a[128:135], v172
    v_smfmac_f32_16x16x64_bf16 v[60:63], v[24:27], a[160:167], v172
    v_smfmac_f32_16x16x64_bf16 v[56:59], v[28:31], a[136:143], v172
    s_waitcnt lgkmcnt(0)
    s_barrier
    v_smfmac_f32_16x16x64_bf16 v[60:63], v[28:31], a[168:175], v172
    v_smfmac_f32_16x16x64_bf16 v[56:59], v[32:35], a[144:151], v172
    v_smfmac_f32_16x16x64_bf16 v[60:63], v[32:35], a[176:183], v172
    v_smfmac_f32_16x16x64_bf16 v[56:59], v[36:39], a[152:159], v172
    v_smfmac_f32_16x16x64_bf16 v[60:63], v[36:39], a[184:191], v172
    s_nop 4
    v_cvt_pk_bf16_f32 v80, v56, v57
    v_cvt_pk_bf16_f32 v81, v58, v59
    s_nop 0
    v_cvt_pk_bf16_f32 v82, v60, v61
    v_cvt_pk_bf16_f32 v83, v62, v63
    ds_write_b128 v17, v[80:83] offset:8192
    v_mov_b32 v152, v228
    v_mov_b32 v153, v229
    v_mov_b32 v156, v230
    v_mov_b32 v157, v231
    v_mov_b32 v160, v232
    v_mov_b32 v161, v233
    v_mov_b32 v164, v234
    v_mov_b32 v165, v235
    s_cmp_eq_u32 s15, 63
    s_waitcnt lgkmcnt(0)
    s_barrier
    s_cbranch_scc1 recur_end
    s_nop 15
    s_nop 15
    s_nop 7
    buffer_load_dwordx4 v[208:211], v5, s[4:7], s16 offen offset:0 sc1
    buffer_load_dwordx4 v[212:215], v5, s[4:7], s16 offen offset:1024 sc1
    buffer_load_dwordx4 v[216:219], v5, s[4:7], s16 offen offset:2048 sc1
    buffer_load_dwordx4 v[220:223], v5, s[4:7], s16 offen offset:3072 sc1
    buffer_load_dword v224, v6, s[4:7], s16 offen offset:0 sc1
    buffer_load_dword v225, v6, s[4:7], s16 offen offset:256 sc1
    buffer_load_dword v226, v6, s[4:7], s16 offen offset:512 sc1
    buffer_load_dword v227, v6, s[4:7], s16 offen offset:768 sc1
    s_mov_b32 s23, s25
    ds_read_b128 v[96:99], v16 offset:8192
    ds_read_b128 v[104:107], v16 offset:12288
    ds_read_b128 v[108:111], v16 offset:14336
    v_mfma_f32_16x16x32_bf16 v[140:143], v[84:87], v[80:83], 0
    s_waitcnt lgkmcnt(2)
    v_mfma_f32_16x16x32_bf16 v[140:143], v[84:87], v[96:99], v[140:143]
    s_waitcnt lgkmcnt(1)
    v_mfma_f32_16x16x32_bf16 v[140:143], v[84:87], v[104:107], v[140:143]
    s_waitcnt lgkmcnt(0)
    v_mfma_f32_16x16x32_bf16 v[140:143], v[84:87], v[108:111], v[140:143]
    buffer_load_dwordx4 v[24:27], v5, s[4:7], s16 offen offset:0 sc1
    buffer_load_dwordx4 v[28:31], v5, s[4:7], s16 offen offset:1024 sc1
    buffer_load_dwordx4 v[32:35], v5, s[4:7], s16 offen offset:2048 sc1
    buffer_load_dwordx4 v[36:39], v5, s[4:7], s16 offen offset:3072 sc1
    buffer_load_dword v40, v6, s[4:7], s16 offen offset:0 sc1
    buffer_load_dword v41, v6, s[4:7], s16 offen offset:256 sc1
    buffer_load_dword v42, v6, s[4:7], s16 offen offset:512 sc1
    buffer_load_dword v43, v6, s[4:7], s16 offen offset:768 sc1
    v_cvt_pk_bf16_f32 v154, v140, v179
    v_cvt_pk_bf16_f32 v158, v141, v179
    v_cvt_pk_bf16_f32 v162, v142, v179
    v_cvt_pk_bf16_f32 v166, v143, v179
    s_waitcnt vmcnt(14)
    v_pk_add_f32 v[180:181], v[208:209], v[212:213]
    v_pk_add_f32 v[182:183], v[210:211], v[214:215]
    s_waitcnt vmcnt(12)
    v_pk_add_f32 v[188:189], v[216:217], v[220:221]
    v_pk_add_f32 v[190:191], v[218:219], v[222:223]
    v_pk_add_f32 v[180:181], v[180:181], v[188:189]
    v_pk_add_f32 v[182:183], v[182:183], v[190:191]
    v_pk_add_f32 v[188:189], v[180:181], v[182:183]
    v_max3_f32 v185, v180, v181, v182
    s_waitcnt vmcnt(8)
    v_pk_add_f32 v[192:193], v[224:225], v[226:227]
    v_add_f32 v188, v188, v189
    v_add_f32 v184, v192, v193
    v_max3_f32 v185, v185, v183, v184
    v_cmp_u_f32 vcc, v188, v184
    s_nop 0
    v_max_f32_dpp v185, v185, v185 row_ror:8 row_mask:0xf bank_mask:0xf
    v_mov_b32 v186, v185
    s_nop 1
    v_permlane16_swap_b32 v185, v186
    v_max_f32 v185, v185, v186
    v_mov_b32 v186, v185
    s_cbranch_vccnz ss_33
sg_35:
    s_nop 0
    v_permlane32_swap_b32 v185, v186
    v_max_f32 v185, v185, v186
    v_mul_f32 v185, s24, v185
    v_fma_f32 v180, v180, s24, -v185
    v_fma_f32 v181, v181, s24, -v185
    v_fma_f32 v182, v182, s24, -v185
    v_fma_f32 v183, v183, s24, -v185
    v_fma_f32 v184, v184, s24, -v185
    v_exp_f32 v180, v180
    v_exp_f32 v181, v181
    v_exp_f32 v182, v182
    v_exp_f32 v183, v183
    v_exp_f32 v184, v184
    v_cvt_pk_bf16_f32 v176, v180, v181
    v_cvt_pk_bf16_f32 v177, v182, v183
    v_cvt_pk_bf16_f32 v178, v184, v179
    s_nop 1
    v_mfma_f32_16x16x32_bf16 v[240:243], v[236:239], v[176:179], 0
    v_mfma_f32_16x16x32_bf16 v[188:191], v[152:155], v[176:179], 0
    v_mfma_f32_16x16x32_bf16 v[192:195], v[156:159], v[176:179], 0
    v_mfma_f32_16x16x32_bf16 v[196:199], v[160:163], v[176:179], 0
    v_mfma_f32_16x16x32_bf16 v[200:203], v[164:167], v[176:179], 0
    v_add_f32_dpp v185, v240, v240 row_ror:8 row_mask:0xf bank_mask:0xf
    v_rcp_f32 v185, v185
    v_add_f32_dpp v88, v192, v188 row_ror:8 row_mask:0xf bank_mask:0x3
    v_add_f32_dpp v89, v193, v189 row_ror:8 row_mask:0xf bank_mask:0x3
    v_add_f32_dpp v90, v194, v190 row_ror:8 row_mask:0xf bank_mask:0x3
    v_add_f32_dpp v91, v195, v191 row_ror:8 row_mask:0xf bank_mask:0x3
    s_nop 1
    v_add_f32_dpp v88, v196, v200 row_ror:8 row_mask:0xf bank_mask:0xc
    v_add_f32_dpp v89, v197, v201 row_ror:8 row_mask:0xf bank_mask:0xc
    v_add_f32_dpp v90, v198, v202 row_ror:8 row_mask:0xf bank_mask:0xc
    v_add_f32_dpp v91, v199, v203 row_ror:8 row_mask:0xf bank_mask:0xc
    v_mul_f32 v88, v88, v185
    v_mul_f32 v89, v89, v185
    v_mul_f32 v90, v90, v185
    v_mul_f32 v91, v91, v185
    v_cvt_pk_bf16_f32 v88, v88, v89
    v_cvt_pk_bf16_f32 v89, v90, v91
    buffer_store_dwordx2 v[88:89], v7, s[4:7], s16 offen
    v_readfirstlane_b32 s85, v247
    s_add_u32 s94, s15, 2
    s_barrier
    s_nop 15
    s_mov_b32 s23, s25
    buffer_load_dwordx4 v[24:27], v8, s[4:7], s16 offen offset:0 sc1
    s_nop 11
    buffer_load_dwordx4 v[28:31], v8, s[4:7], s16 offen offset:1024 sc1
    s_nop 11
    buffer_load_dwordx4 v[32:35], v8, s[4:7], s16 offen offset:2048 sc1
    s_nop 11
    buffer_load_dwordx4 v[36:39], v8, s[4:7], s16 offen offset:3072 sc1
    s_waitcnt vmcnt(3)
    v_max3_u32 v19, v24, v25, v26
    v_max_u32 v19, v19, v27
    v_cmp_eq_u32 vcc, -1, v19
    s_nop 0
    s_cbranch_vccnz g_36F15_0
    v_smfmac_f32_16x16x64_bf16 v[64:67], v[24:27], a[192:199], v172
    v_smfmac_f32_16x16x64_bf16 v[68:71], v[24:27], a[224:231], v172
    s_waitcnt vmcnt(2)
    v_max3_u32 v19, v28, v29, v30
    v_max_u32 v19, v19, v31
    v_cmp_eq_u32 vcc, -1, v19
    s_nop 0
    s_cbranch_vccnz g_36F14_1
    v_smfmac_f32_16x16x64_bf16 v[64:67], v[28:31], a[200:207], v172
    v_smfmac_f32_16x16x64_bf16 v[68:71], v[28:31], a[232:239], v172
    s_waitcnt vmcnt(1)
    v_max3_u32 v19, v32, v33, v34
    v_max_u32 v19, v19, v35
    v_cmp_eq_u32 vcc, -1, v19
    s_nop 0
    s_cbranch_vccnz g_36F12_2
    v_smfmac_f32_16x16x64_bf16 v[64:67], v[32:35], a[208:215], v172
    v_smfmac_f32_16x16x64_bf16 v[68:71], v[32:35], a[240:247], v172
    s_waitcnt vmcnt(0)
    v_max3_u32 v19, v36, v37, v38
    v_max_u32 v19, v19, v39
    v_cmp_eq_u32 vcc, -1, v19
    s_nop 0
    s_cbranch_vccnz g_36F8_3
    v_smfmac_f32_16x16x64_bf16 v[64:67], v[36:39], a[216:223], v172
    v_smfmac_f32_16x16x64_bf16 v[68:71], v[36:39], a[248:255], v172
    s_nop 4
    v_cvt_pk_bf16_f32 v80, v64, v65
    v_cvt_pk_bf16_f32 v81, v66, v67
    s_nop 0
    v_cvt_pk_bf16_f32 v82, v68, v69
    v_cvt_pk_bf16_f32 v83, v70, v71
    ds_write_b128 v17, v[80:83] offset:9216
gc_37:
    s_waitcnt lgkmcnt(0)
    s_barrier
    s_nop 15
    s_nop 15
    s_nop 15
    s_nop 15
    s_mov_b32 s23, s25
fw_38:
    s_cmp_ge_u32 s85, s94
    s_cbranch_scc1 fo_39
    buffer_load_dword v247, v245, s[4:7], 0 offen sc1
    s_add_u32 s23, s23, 1
    s_waitcnt vmcnt(0)
    v_readfirstlane_b32 s85, v247
    s_cmp_lt_u32 s23, 200000
    s_cbranch_scc1 fw_38
    s_mov_b32 s25, 200000
fo_39:
    buffer_load_dwordx4 v[228:231], v13, s[4:7], s18 offen offset:0 sc1
    buffer_load_dwordx4 v[232:235], v13, s[4:7], s18 offen offset:256 sc1
    s_add_u32 s18, s18, 2048
    s_min_u32 s18, s18, 35780608
    buffer_load_dword v247, v245, s[4:7], 0 offen sc1
    v_mov_b32 v40, 0
    v_mov_b32 v41, 0
    v_mov_b32 v42, 0
    v_mov_b32 v43, 0
    v_mov_b32 v44, 0
    v_mov_b32 v45, 0
    v_mov_b32 v46, 0
    v_mov_b32 v47, 0
    v_mov_b32 v48, 0
    v_mov_b32 v49, 0
    v_mov_b32 v50, 0
    v_mov_b32 v51, 0
    v_mov_b32 v52, 0
    v_mov_b32 v53, 0
    v_mov_b32 v54, 0
    v_mov_b32 v55, 0
    v_mov_b32 v56, 0
    v_mov_b32 v57, 0
    v_mov_b32 v58, 0
    v_mov_b32 v59, 0
    v_mov_b32 v60, 0
    v_mov_b32 v61, 0
    v_mov_b32 v62, 0
    v_mov_b32 v63, 0
    v_mov_b32 v64, 0
    v_mov_b32 v65, 0
    v_mov_b32 v66, 0
    v_mov_b32 v67, 0
    v_mov_b32 v68, 0
    v_mov_b32 v69, 0
    v_mov_b32 v70, 0
    v_mov_b32 v71, 0
    s_mov_b32 s21, s16
    s_mov_b32 s16, s42
    s_mov_b32 s42, s43
    s_mov_b32 s43, s44
    s_mov_b32 s44, s21
    s_add_u32 s95, s95, 524288
    s_lshr_b32 s84, s95, 8
    s_and_b32 s84, s84, 8192
    s_xor_b32 s84, s84, s46
    s_add_u32 s84, s84, s95
    s_add_u32 s15, s15, 1
    s_barrier
    s_branch recur_fast_w1
g_31L15_0:
    s_waitcnt vmcnt(3)
    v_max3_u32 v19, v24, v25, v26
    v_max_u32 v19, v19, v27
    v_cmp_eq_u32 vcc, -1, v19
    s_nop 0
    s_cbranch_vccnz g_31F15_0
    v_smfmac_f32_16x16x64_bf16 v[40:43], v[24:27], a[0:7], v172
    v_smfmac_f32_16x16x64_bf16 v[44:47], v[24:27], a[64:71], v172
    v_smfmac_f32_16x16x64_bf16 v[48:51], v[24:27], a[32:39], v172
    v_smfmac_f32_16x16x64_bf16 v[52:55], v[24:27], a[96:103], v172
g_31L14_1:
    s_waitcnt vmcnt(2)
    v_max3_u32 v19, v28, v29, v30
    v_max_u32 v19, v19, v31
    v_cmp_eq_u32 vcc, -1, v19
    s_nop 0
    s_cbranch_vccnz g_31F14_1
    v_smfmac_f32_16x16x64_bf16 v[40:43], v[28:31], a[8:15], v172
    v_smfmac_f32_16x16x64_bf16 v[44:47], v[28:31], a[72:79], v172
    v_smfmac_f32_16x16x64_bf16 v[48:51], v[28:31], a[40:47], v172
    v_smfmac_f32_16x16x64_bf16 v[52:55], v[28:31], a[104:111], v172
g_31L12_2:
    s_waitcnt vmcnt(1)
    v_max3_u32 v19, v32, v33, v34
    v_max_u32 v19, v19, v35
    v_cmp_eq_u32 vcc, -1, v19
    s_nop 0
    s_cbranch_vccnz g_31F12_2
    v_smfmac_f32_16x16x64_bf16 v[40:43], v[32:35], a[16:23], v172
    v_smfmac_f32_16x16x64_bf16 v[44:47], v[32:35], a[80:87], v172
    v_smfmac_f32_16x16x64_bf16 v[48:51], v[32:35], a[48:55], v172
    v_smfmac_f32_16x16x64_bf16 v[52:55], v[32:35], a[112:119], v172
g_31L8_3:
    s_waitcnt vmcnt(0)
    v_max3_u32 v19, v36, v37, v38
    v_max_u32 v19, v19, v39
    v_cmp_eq_u32 vcc, -1, v19
    s_nop 0
    s_cbranch_vccnz g_31F8_3
    v_smfmac_f32_16x16x64_bf16 v[40:43], v[36:39], a[24:31], v172
    v_smfmac_f32_16x16x64_bf16 v[44:47], v[36:39], a[88:95], v172
    v_smfmac_f32_16x16x64_bf16 v[48:51], v[36:39], a[56:63], v172
    v_smfmac_f32_16x16x64_bf16 v[52:55], v[36:39], a[120:127], v172
    s_branch gc_32
g_31L15_1:
    s_waitcnt vmcnt(3)
    v_max3_u32 v19, v28, v29, v30
    v_max_u32 v19, v19, v31
    v_cmp_eq_u32 vcc, -1, v19
    s_nop 0
    s_cbranch_vccnz g_31F15_1
    v_smfmac_f32_16x16x64_bf16 v[40:43], v[28:31], a[8:15], v172
    v_smfmac_f32_16x16x64_bf16 v[44:47], v[28:31], a[72:79], v172
    v_smfmac_f32_16x16x64_bf16 v[48:51], v[28:31], a[40:47], v172
    v_smfmac_f32_16x16x64_bf16 v[52:55], v[28:31], a[104:111], v172
g_31L13_2:
    s_waitcnt vmcnt(2)
    v_max3_u32 v19, v32, v33, v34
    v_max_u32 v19, v19, v35
    v_cmp_eq_u32 vcc, -1, v19
    s_nop 0
    s_cbranch_vccnz g_31F13_2
    v_smfmac_f32_16x16x64_bf16 v[40:43], v[32:35], a[16:23], v172
    v_smfmac_f32_16x16x64_bf16 v[44:47], v[32:35], a[80:87], v172
    v_smfmac_f32_16x16x64_bf16 v[48:51], v[32:35], a[48:55], v172
    v_smfmac_f32_16x16x64_bf16 v[52:55], v[32:35], a[112:119], v172
g_31L9_3:
    s_waitcnt vmcnt(1)
    v_max3_u32 v19, v36, v37, v38
    v_max_u32 v19, v19, v39
    v_cmp_eq_u32 vcc, -1, v19
    s_nop 0
    s_cbranch_vccnz g_31F9_3
    v_smfmac_f32_16x16x64_bf16 v[40:43], v[36:39], a[24:31], v172
    v_smfmac_f32_16x16x64_bf16 v[44:47], v[36:39], a[88:95], v172
    v_smfmac_f32_16x16x64_bf16 v[48:51], v[36:39], a[56:63], v172
    v_smfmac_f32_16x16x64_bf16 v[52:55], v[36:39], a[120:127], v172
g_31L1_0:
    s_waitcnt vmcnt(0)
    v_max3_u32 v19, v24, v25, v26
    v_max_u32 v19, v19, v27
    v_cmp_eq_u32 vcc, -1, v19
    s_nop 0
    s_cbranch_vccnz g_31F1_0
    v_smfmac_f32_16x16x64_bf16 v[40:43], v[24:27], a[0:7], v172
    v_smfmac_f32_16x16x64_bf16 v[44:47], v[24:27], a[64:71], v172
    v_smfmac_f32_16x16x64_bf16 v[48:51], v[24:27], a[32:39], v172
    v_smfmac_f32_16x16x64_bf16 v[52:55], v[24:27], a[96:103], v172
    s_branch gc_32
g_31L15_2:
    s_waitcnt vmcnt(3)
    v_max3_u32 v19, v32, v33, v34
    v_max_u32 v19, v19, v35
    v_cmp_eq_u32 vcc, -1, v19
    s_nop 0
    s_cbranch_vccnz g_31F15_2
    v_smfmac_f32_16x16x64_bf16 v[40:43], v[32:35], a[16:23], v172
    v_smfmac_f32_16x16x64_bf16 v[44:47], v[32:35], a[80:87], v172
    v_smfmac_f32_16x16x64_bf16 v[48:51], v[32:35], a[48:55], v172
    v_smfmac_f32_16x16x64_bf16 v[52:55], v[32:35], a[112:119], v172
g_31L11_3:
    s_waitcnt vmcnt(2)
    v_max3_u32 v19, v36, v37, v38
    v_max_u32 v19, v19, v39
    v_cmp_eq_u32 vcc, -1, v19
    s_nop 0
    s_cbranch_vccnz g_31F11_3
    v_smfmac_f32_16x16x64_bf16 v[40:43], v[36:39], a[24:31], v172
    v_smfmac_f32_16x16x64_bf16 v[44:47], v[36:39], a[88:95], v172
    v_smfmac_f32_16x16x64_bf16 v[48:51], v[36:39], a[56:63], v172
    v_smfmac_f32_16x16x64_bf16 v[52:55], v[36:39], a[120:127], v172
g_31L3_0:
    s_waitcnt vmcnt(1)
    v_max3_u32 v19, v24, v25, v26
    v_max_u32 v19, v19, v27
    v_cmp_eq_u32 vcc, -1, v19
    s_nop 0
    s_cbranch_vccnz g_31F3_0
    v_smfmac_f32_16x16x64_bf16 v[40:43], v[24:27], a[0:7], v172
    v_smfmac_f32_16x16x64_bf16 v[44:47], v[24:27], a[64:71], v172
    v_smfmac_f32_16x16x64_bf16 v[48:51], v[24:27], a[32:39], v172
    v_smfmac_f32_16x16x64_bf16 v[52:55], v[24:27], a[96:103], v172
g_31L2_1:
    s_waitcnt vmcnt(0)
    v_max3_u32 v19, v28, v29, v30
    v_max_u32 v19, v19, v31
    v_cmp_eq_u32 vcc, -1, v19
    s_nop 0
    s_cbranch_vccnz g_31F2_1
    v_smfmac_f32_16x16x64_bf16 v[40:43], v[28:31], a[8:15], v172
    v_smfmac_f32_16x16x64_bf16 v[44:47], v[28:31], a[72:79], v172
    v_smfmac_f32_16x16x64_bf16 v[48:51], v[28:31], a[40:47], v172
    v_smfmac_f32_16x16x64_bf16 v[52:55], v[28:31], a[104:111], v172
    s_branch gc_32
g_31L15_3:
    s_waitcnt vmcnt(3)
    v_max3_u32 v19, v36, v37, v38
    v_max_u32 v19, v19, v39
    v_cmp_eq_u32 vcc, -1, v19
    s_nop 0
    s_cbranch_vccnz g_31F15_3
    v_smfmac_f32_16x16x64_bf16 v[40:43], v[36:39], a[24:31], v172
    v_smfmac_f32_16x16x64_bf16 v[44:47], v[36:39], a[88:95], v172
    v_smfmac_f32_16x16x64_bf16 v[48:51], v[36:39], a[56:63], v172
    v_smfmac_f32_16x16x64_bf16 v[52:55], v[36:39], a[120:127], v172
g_31L7_0:
    s_waitcnt vmcnt(2)
    v_max3_u32 v19, v24, v25, v26
    v_max_u32 v19, v19, v27
    v_cmp_eq_u32 vcc, -1, v19
    s_nop 0
    s_cbranch_vccnz g_31F7_0
    v_smfmac_f32_16x16x64_bf16 v[40:43], v[24:27], a[0:7], v172
    v_smfmac_f32_16x16x64_bf16 v[44:47], v[24:27], a[64:71], v172
    v_smfmac_f32_16x16x64_bf16 v[48:51], v[24:27], a[32:39], v172
    v_smfmac_f32_16x16x64_bf16 v[52:55], v[24:27], a[96:103], v172
g_31L6_1:
    s_waitcnt vmcnt(1)
    v_max3_u32 v19, v28, v29, v30
    v_max_u32 v19, v19, v31
    v_cmp_eq_u32 vcc, -1, v19
    s_nop 0
    s_cbranch_vccnz g_31F6_1
    v_smfmac_f32_16x16x64_bf16 v[40:43], v[28:31], a[8:15], v172
    v_smfmac_f32_16x16x64_bf16 v[44:47], v[28:31], a[72:79], v172
    v_smfmac_f32_16x16x64_bf16 v[48:51], v[28:31], a[40:47], v172
    v_smfmac_f32_16x16x64_bf16 v[52:55], v[28:31], a[104:111], v172
g_31L4_2:
    s_waitcnt vmcnt(0)
    v_max3_u32 v19, v32, v33, v34
    v_max_u32 v19, v19, v35
    v_cmp_eq_u32 vcc, -1, v19
    s_nop 0
    s_cbranch_vccnz g_31F4_2
    v_smfmac_f32_16x16x64_bf16 v[40:43], v[32:35], a[16:23], v172
    v_smfmac_f32_16x16x64_bf16 v[44:47], v[32:35], a[80:87], v172
    v_smfmac_f32_16x16x64_bf16 v[48:51], v[32:35], a[48:55], v172
    v_smfmac_f32_16x16x64_bf16 v[52:55], v[32:35], a[112:119], v172
    s_branch gc_32
g_31L7_1:
    s_waitcnt vmcnt(2)
    v_max3_u32 v19, v28, v29, v30
    v_max_u32 v19, v19, v31
    v_cmp_eq_u32 vcc, -1, v19
    s_nop 0
    s_cbranch_vccnz g_31F7_1
    v_smfmac_f32_16x16x64_bf16 v[40:43], v[28:31], a[8:15], v172
    v_smfmac_f32_16x16x64_bf16 v[44:47], v[28:31], a[72:79], v172
    v_smfmac_f32_16x16x64_bf16 v[48:51], v[28:31], a[40:47], v172
    v_smfmac_f32_16x16x64_bf16 v[52:55], v[28:31], a[104:111], v172
g_31L5_2:
    s_waitcnt vmcnt(1)
    v_max3_u32 v19, v32, v33, v34
    v_max_u32 v19, v19, v35
    v_cmp_eq_u32 vcc, -1, v19
    s_nop 0
    s_cbranch_vccnz g_31F5_2
    v_smfmac_f32_16x16x64_bf16 v[40:43], v[32:35], a[16:23], v172
    v_smfmac_f32_16x16x64_bf16 v[44:47], v[32:35], a[80:87], v172
    v_smfmac_f32_16x16x64_bf16 v[48:51], v[32:35], a[48:55], v172
    v_smfmac_f32_16x16x64_bf16 v[52:55], v[32:35], a[112:119], v172
    s_branch g_31L1_0
g_31L7_2:
    s_waitcnt vmcnt(2)
    v_max3_u32 v19, v32, v33, v34
    v_max_u32 v19, v19, v35
    v_cmp_eq_u32 vcc, -1, v19
    s_nop 0
    s_cbranch_vccnz g_31F7_2
    v_smfmac_f32_16x16x64_bf16 v[40:43], v[32:35], a[16:23], v172
    v_smfmac_f32_16x16x64_bf16 v[44:47], v[32:35], a[80:87], v172
    v_smfmac_f32_16x16x64_bf16 v[48:51], v[32:35], a[48:55], v172
    v_smfmac_f32_16x16x64_bf16 v[52:55], v[32:35], a[112:119], v172
    s_branch g_31L3_0
g_31L11_0:
    s_waitcnt vmcnt(2)
    v_max3_u32 v19, v24, v25, v26
    v_max_u32 v19, v19, v27
    v_cmp_eq_u32 vcc, -1, v19
    s_nop 0
    s_cbranch_vccnz g_31F11_0
    v_smfmac_f32_16x16x64_bf16 v[40:43], v[24:27], a[0:7], v172
    v_smfmac_f32_16x16x64_bf16 v[44:47], v[24:27], a[64:71], v172
    v_smfmac_f32_16x16x64_bf16 v[48:51], v[24:27], a[32:39], v172
    v_smfmac_f32_16x16x64_bf16 v[52:55], v[24:27], a[96:103], v172
g_31L10_1:
    s_waitcnt vmcnt(1)
    v_max3_u32 v19, v28, v29, v30
    v_max_u32 v19, v19, v31
    v_cmp_eq_u32 vcc, -1, v19
    s_nop 0
    s_cbranch_vccnz g_31F10_1
    v_smfmac_f32_16x16x64_bf16 v[40:43], v[28:31], a[8:15], v172
    v_smfmac_f32_16x16x64_bf16 v[44:47], v[28:31], a[72:79], v172
    v_smfmac_f32_16x16x64_bf16 v[48:51], v[28:31], a[40:47], v172
    v_smfmac_f32_16x16x64_bf16 v[52:55], v[28:31], a[104:111], v172
    s_branch g_31L8_3
g_31L11_1:
    s_waitcnt vmcnt(2)
    v_max3_u32 v19, v28, v29, v30
    v_max_u32 v19, v19, v31
    v_cmp_eq_u32 vcc, -1, v19
    s_nop 0
    s_cbranch_vccnz g_31F11_1
    v_smfmac_f32_16x16x64_bf16 v[40:43], v[28:31], a[8:15], v172
    v_smfmac_f32_16x16x64_bf16 v[44:47], v[28:31], a[72:79], v172
    v_smfmac_f32_16x16x64_bf16 v[48:51], v[28:31], a[40:47], v172
    v_smfmac_f32_16x16x64_bf16 v[52:55], v[28:31], a[104:111], v172
    s_branch g_31L9_3
g_31L13_0:
    s_waitcnt vmcnt(2)
    v_max3_u32 v19, v24, v25, v26
    v_max_u32 v19, v19, v27
    v_cmp_eq_u32 vcc, -1, v19
    s_nop 0
    s_cbranch_vccnz g_31F13_0
    v_smfmac_f32_16x16x64_bf16 v[40:43], v[24:27], a[0:7], v172
    v_smfmac_f32_16x16x64_bf16 v[44:47], v[24:27], a[64:71], v172
    v_smfmac_f32_16x16x64_bf16 v[48:51], v[24:27], a[32:39], v172
    v_smfmac_f32_16x16x64_bf16 v[52:55], v[24:27], a[96:103], v172
    s_branch g_31L12_2
g_31L13_3:
    s_waitcnt vmcnt(2)
    v_max3_u32 v19, v36, v37, v38
    v_max_u32 v19, v19, v39
    v_cmp_eq_u32 vcc, -1, v19
    s_nop 0
    s_cbranch_vccnz g_31F13_3
    v_smfmac_f32_16x16x64_bf16 v[40:43], v[36:39], a[24:31], v172
    v_smfmac_f32_16x16x64_bf16 v[44:47], v[36:39], a[88:95], v172
    v_smfmac_f32_16x16x64_bf16 v[48:51], v[36:39], a[56:63], v172
    v_smfmac_f32_16x16x64_bf16 v[52:55], v[36:39], a[120:127], v172
g_31L5_0:
    s_waitcnt vmcnt(1)
    v_max3_u32 v19, v24, v25, v26
    v_max_u32 v19, v19, v27
    v_cmp_eq_u32 vcc, -1, v19
    s_nop 0
    s_cbranch_vccnz g_31F5_0
    v_smfmac_f32_16x16x64_bf16 v[40:43], v[24:27], a[0:7], v172
    v_smfmac_f32_16x16x64_bf16 v[44:47], v[24:27], a[64:71], v172
    v_smfmac_f32_16x16x64_bf16 v[48:51], v[24:27], a[32:39], v172
    v_smfmac_f32_16x16x64_bf16 v[52:55], v[24:27], a[96:103], v172
    s_branch g_31L4_2
g_31L14_2:
    s_waitcnt vmcnt(2)
    v_max3_u32 v19, v32, v33, v34
    v_max_u32 v19, v19, v35
    v_cmp_eq_u32 vcc, -1, v19
    s_nop 0
    s_cbranch_vccnz g_31F14_2
    v_smfmac_f32_16x16x64_bf16 v[40:43], v[32:35], a[16:23], v172
    v_smfmac_f32_16x16x64_bf16 v[44:47], v[32:35], a[80:87], v172
    v_smfmac_f32_16x16x64_bf16 v[48:51], v[32:35], a[48:55], v172
    v_smfmac_f32_16x16x64_bf16 v[52:55], v[32:35], a[112:119], v172
g_31L10_3:
    s_waitcnt vmcnt(1)
    v_max3_u32 v19, v36, v37, v38
    v_max_u32 v19, v19, v39
    v_cmp_eq_u32 vcc, -1, v19
    s_nop 0
    s_cbranch_vccnz g_31F10_3
    v_smfmac_f32_16x16x64_bf16 v[40:43], v[36:39], a[24:31], v172
    v_smfmac_f32_16x16x64_bf16 v[44:47], v[36:39], a[88:95], v172
    v_smfmac_f32_16x16x64_bf16 v[48:51], v[36:39], a[56:63], v172
    v_smfmac_f32_16x16x64_bf16 v[52:55], v[36:39], a[120:127], v172
    s_branch g_31L2_1
g_31L14_3:
    s_waitcnt vmcnt(2)
    v_max3_u32 v19, v36, v37, v38
    v_max_u32 v19, v19, v39
    v_cmp_eq_u32 vcc, -1, v19
    s_nop 0
    s_cbranch_vccnz g_31F14_3
    v_smfmac_f32_16x16x64_bf16 v[40:43], v[36:39], a[24:31], v172
    v_smfmac_f32_16x16x64_bf16 v[44:47], v[36:39], a[88:95], v172
    v_smfmac_f32_16x16x64_bf16 v[48:51], v[36:39], a[56:63], v172
    v_smfmac_f32_16x16x64_bf16 v[52:55], v[36:39], a[120:127], v172
    s_branch g_31L6_1
g_31L3_1:
    s_waitcnt vmcnt(1)
    v_max3_u32 v19, v28, v29, v30
    v_max_u32 v19, v19, v31
    v_cmp_eq_u32 vcc, -1, v19
    s_nop 0
    s_cbranch_vccnz g_31F3_1
    v_smfmac_f32_16x16x64_bf16 v[40:43], v[28:31], a[8:15], v172
    v_smfmac_f32_16x16x64_bf16 v[44:47], v[28:31], a[72:79], v172
    v_smfmac_f32_16x16x64_bf16 v[48:51], v[28:31], a[40:47], v172
    v_smfmac_f32_16x16x64_bf16 v[52:55], v[28:31], a[104:111], v172
    s_branch g_31L1_0
g_31L6_2:
    s_waitcnt vmcnt(1)
    v_max3_u32 v19, v32, v33, v34
    v_max_u32 v19, v19, v35
    v_cmp_eq_u32 vcc, -1, v19
    s_nop 0
    s_cbranch_vccnz g_31F6_2
    v_smfmac_f32_16x16x64_bf16 v[40:43], v[32:35], a[16:23], v172
    v_smfmac_f32_16x16x64_bf16 v[44:47], v[32:35], a[80:87], v172
    v_smfmac_f32_16x16x64_bf16 v[48:51], v[32:35], a[48:55], v172
    v_smfmac_f32_16x16x64_bf16 v[52:55], v[32:35], a[112:119], v172
    s_branch g_31L2_1
g_31L9_0:
    s_waitcnt vmcnt(1)
    v_max3_u32 v19, v24, v25, v26
    v_max_u32 v19, v19, v27
    v_cmp_eq_u32 vcc, -1, v19
    s_nop 0
    s_cbranch_vccnz g_31F9_0
    v_smfmac_f32_16x16x64_bf16 v[40:43], v[24:27], a[0:7], v172
    v_smfmac_f32_16x16x64_bf16 v[44:47], v[24:27], a[64:71], v172
    v_smfmac_f32_16x16x64_bf16 v[48:51], v[24:27], a[32:39], v172
    v_smfmac_f32_16x16x64_bf16 v[52:55], v[24:27], a[96:103], v172
    s_branch g_31L8_3
g_31L12_3:
    s_waitcnt vmcnt(1)
    v_max3_u32 v19, v36, v37, v38
    v_max_u32 v19, v19, v39
    v_cmp_eq_u32 vcc, -1, v19
    s_nop 0
    s_cbranch_vccnz g_31F12_3
    v_smfmac_f32_16x16x64_bf16 v[40:43], v[36:39], a[24:31], v172
    v_smfmac_f32_16x16x64_bf16 v[44:47], v[36:39], a[88:95], v172
    v_smfmac_f32_16x16x64_bf16 v[48:51], v[36:39], a[56:63], v172
    v_smfmac_f32_16x16x64_bf16 v[52:55], v[36:39], a[120:127], v172
    s_branch g_31L4_2
g_31F15_0:
    s_mov_b64 exec, vcc
    buffer_load_dwordx4 v[24:27], v2, s[4:7], s16 offen offset:0 sc1
    s_mov_b64 exec, -1
    s_add_u32 s23, s23, 1
    s_cmp_lt_u32 s23, 200000
    s_cbranch_scc1 g_31L15_1
    s_mov_b32 s25, 200000
    s_branch gc_32
g_31F15_1:
    s_mov_b64 exec, vcc
    buffer_load_dwordx4 v[28:31], v2, s[4:7], s16 offen offset:1024 sc1
    s_mov_b64 exec, -1
    s_add_u32 s23, s23, 1
    s_cmp_lt_u32 s23, 200000
    s_cbranch_scc1 g_31L15_2
    s_mov_b32 s25, 200000
    s_branch gc_32
g_31F15_2:
    s_mov_b64 exec, vcc
    buffer_load_dwordx4 v[32:35], v2, s[4:7], s16 offen offset:2048 sc1
    s_mov_b64 exec, -1
    s_add_u32 s23, s23, 1
    s_cmp_lt_u32 s23, 200000
    s_cbranch_scc1 g_31L15_3
    s_mov_b32 s25, 200000
    s_branch gc_32
g_31F15_3:
    s_mov_b64 exec, vcc
    buffer_load_dwordx4 v[36:39], v2, s[4:7], s16 offen offset:3072 sc1
    s_mov_b64 exec, -1
    s_add_u32 s23, s23, 1
    s_cmp_lt_u32 s23, 200000
    s_cbranch_scc1 g_31L15_0
    s_mov_b32 s25, 200000
    s_branch gc_32
g_31F7_0:
    s_mov_b64 exec, vcc
    buffer_load_dwordx4 v[24:27], v2, s[4:7], s16 offen offset:0 sc1
    s_mov_b64 exec, -1
    s_add_u32 s23, s23, 1
    s_cmp_lt_u32 s23, 200000
    s_cbranch_scc1 g_31L7_1
    s_mov_b32 s25, 200000
    s_branch gc_32
g_31F7_1:
    s_mov_b64 exec, vcc
    buffer_load_dwordx4 v[28:31], v2, s[4:7], s16 offen offset:1024 sc1
    s_mov_b64 exec, -1
    s_add_u32 s23, s23, 1
    s_cmp_lt_u32 s23, 200000
    s_cbranch_scc1 g_31L7_2
    s_mov_b32 s25, 200000
    s_branch gc_32
g_31F7_2:
    s_mov_b64 exec, vcc
    buffer_load_dwordx4 v[32:35], v2, s[4:7], s16 offen offset:2048 sc1
    s_mov_b64 exec, -1
    s_add_u32 s23, s23, 1
    s_cmp_lt_u32 s23, 200000
    s_cbranch_scc1 g_31L7_0
    s_mov_b32 s25, 200000
    s_branch gc_32
g_31F11_0:
    s_mov_b64 exec, vcc
    buffer_load_dwordx4 v[24:27], v2, s[4:7], s16 offen offset:0 sc1
    s_mov_b64 exec, -1
    s_add_u32 s23, s23, 1
    s_cmp_lt_u32 s23, 200000
    s_cbranch_scc1 g_31L11_1
    s_mov_b32 s25, 200000
    s_branch gc_32
g_31F11_1:
    s_mov_b64 exec, vcc
    buffer_load_dwordx4 v[28:31], v2, s[4:7], s16 offen offset:1024 sc1
    s_mov_b64 exec, -1
    s_add_u32 s23, s23, 1
    s_cmp_lt_u32 s23, 200000
    s_cbranch_scc1 g_31L11_3
    s_mov_b32 s25, 200000
    s_branch gc_32
g_31F11_3:
    s_mov_b64 exec, vcc
    buffer_load_dwordx4 v[36:39], v2, s[4:7], s16 offen offset:3072 sc1
    s_mov_b64 exec, -1
    s_add_u32 s23, s23, 1
    s_cmp_lt_u32 s23, 200000
    s_cbranch_scc1 g_31L11_0
    s_mov_b32 s25, 200000
    s_branch gc_32
g_31F13_0:
    s_mov_b64 exec, vcc
    buffer_load_dwordx4 v[24:27], v2, s[4:7], s16 offen offset:0 sc1
    s_mov_b64 exec, -1
    s_add_u32 s23, s23, 1
    s_cmp_lt_u32 s23, 200000
    s_cbranch_scc1 g_31L13_2
    s_mov_b32 s25, 200000
    s_branch gc_32
g_31F13_2:
    s_mov_b64 exec, vcc
    buffer_load_dwordx4 v[32:35], v2, s[4:7], s16 offen offset:2048 sc1
    s_mov_b64 exec, -1
    s_add_u32 s23, s23, 1
    s_cmp_lt_u32 s23, 200000
    s_cbranch_scc1 g_31L13_3
    s_mov_b32 s25, 200000
    s_branch gc_32
g_31F13_3:
    s_mov_b64 exec, vcc
    buffer_load_dwordx4 v[36:39], v2, s[4:7], s16 offen offset:3072 sc1
    s_mov_b64 exec, -1
    s_add_u32 s23, s23, 1
    s_cmp_lt_u32 s23, 200000
    s_cbranch_scc1 g_31L13_0
    s_mov_b32 s25, 200000
    s_branch gc_32
g_31F14_1:
    s_mov_b64 exec, vcc
    buffer_load_dwordx4 v[28:31], v2, s[4:7], s16 offen offset:1024 sc1
    s_mov_b64 exec, -1
    s_add_u32 s23, s23, 1
    s_cmp_lt_u32 s23, 200000
    s_cbranch_scc1 g_31L14_2
    s_mov_b32 s25, 200000
    s_branch gc_32
g_31F14_2:
    s_mov_b64 exec, vcc
    buffer_load_dwordx4 v[32:35], v2, s[4:7], s16 offen offset:2048 sc1
    s_mov_b64 exec, -1
    s_add_u32 s23, s23, 1
    s_cmp_lt_u32 s23, 200000
    s_cbranch_scc1 g_31L14_3
    s_mov_b32 s25, 200000
    s_branch gc_32
g_31F14_3:
    s_mov_b64 exec, vcc
    buffer_load_dwordx4 v[36:39], v2, s[4:7], s16 offen offset:3072 sc1
    s_mov_b64 exec, -1
    s_add_u32 s23, s23, 1
    s_cmp_lt_u32 s23, 200000
    s_cbranch_scc1 g_31L14_1
    s_mov_b32 s25, 200000
    s_branch gc_32
g_31F3_0:
    s_mov_b64 exec, vcc
    buffer_load_dwordx4 v[24:27], v2, s[4:7], s16 offen offset:0 sc1
    s_mov_b64 exec, -1
    s_add_u32 s23, s23, 1
    s_cmp_lt_u32 s23, 200000
    s_cbranch_scc1 g_31L3_1
    s_mov_b32 s25, 200000
    s_branch gc_32
g_31F3_1:
    s_mov_b64 exec, vcc
    buffer_load_dwordx4 v[28:31], v2, s[4:7], s16 offen offset:1024 sc1
    s_mov_b64 exec, -1
    s_add_u32 s23, s23, 1
    s_cmp_lt_u32 s23, 200000
    s_cbranch_scc1 g_31L3_0
    s_mov_b32 s25, 200000
    s_branch gc_32
g_31F5_0:
    s_mov_b64 exec, vcc
    buffer_load_dwordx4 v[24:27], v2, s[4:7], s16 offen offset:0 sc1
    s_mov_b64 exec, -1
    s_add_u32 s23, s23, 1
    s_cmp_lt_u32 s23, 200000
    s_cbranch_scc1 g_31L5_2
    s_mov_b32 s25, 200000
    s_branch gc_32
g_31F5_2:
    s_mov_b64 exec, vcc
    buffer_load_dwordx4 v[32:35], v2, s[4:7], s16 offen offset:2048 sc1
    s_mov_b64 exec, -1
    s_add_u32 s23, s23, 1
    s_cmp_lt_u32 s23, 200000
    s_cbranch_scc1 g_31L5_0
    s_mov_b32 s25, 200000
    s_branch gc_32
g_31F6_1:
    s_mov_b64 exec, vcc
    buffer_load_dwordx4 v[28:31], v2, s[4:7], s16 offen offset:1024 sc1
    s_mov_b64 exec, -1
    s_add_u32 s23, s23, 1
    s_cmp_lt_u32 s23, 200000
    s_cbranch_scc1 g_31L6_2
    s_mov_b32 s25, 200000
    s_branch gc_32
g_31F6_2:
    s_mov_b64 exec, vcc
    buffer_load_dwordx4 v[32:35], v2, s[4:7], s16 offen offset:2048 sc1
    s_mov_b64 exec, -1
    s_add_u32 s23, s23, 1
    s_cmp_lt_u32 s23, 200000
    s_cbranch_scc1 g_31L6_1
    s_mov_b32 s25, 200000
    s_branch gc_32
g_31F9_0:
    s_mov_b64 exec, vcc
    buffer_load_dwordx4 v[24:27], v2, s[4:7], s16 offen offset:0 sc1
    s_mov_b64 exec, -1
    s_add_u32 s23, s23, 1
    s_cmp_lt_u32 s23, 200000
    s_cbranch_scc1 g_31L9_3
    s_mov_b32 s25, 200000
    s_branch gc_32
g_31F9_3:
    s_mov_b64 exec, vcc
    buffer_load_dwordx4 v[36:39], v2, s[4:7], s16 offen offset:3072 sc1
    s_mov_b64 exec, -1
    s_add_u32 s23, s23, 1
    s_cmp_lt_u32 s23, 200000
    s_cbranch_scc1 g_31L9_0
    s_mov_b32 s25, 200000
    s_branch gc_32
g_31F10_1:
    s_mov_b64 exec, vcc
    buffer_load_dwordx4 v[28:31], v2, s[4:7], s16 offen offset:1024 sc1
    s_mov_b64 exec, -1
    s_add_u32 s23, s23, 1
    s_cmp_lt_u32 s23, 200000
    s_cbranch_scc1 g_31L10_3
    s_mov_b32 s25, 200000
    s_branch gc_32
g_31F10_3:
    s_mov_b64 exec, vcc
    buffer_load_dwordx4 v[36:39], v2, s[4:7], s16 offen offset:3072 sc1
    s_mov_b64 exec, -1
    s_add_u32 s23, s23, 1
    s_cmp_lt_u32 s23, 200000
    s_cbranch_scc1 g_31L10_1
    s_mov_b32 s25, 200000
    s_branch gc_32
g_31F12_2:
    s_mov_b64 exec, vcc
    buffer_load_dwordx4 v[32:35], v2, s[4:7], s16 offen offset:2048 sc1
    s_mov_b64 exec, -1
    s_add_u32 s23, s23, 1
    s_cmp_lt_u32 s23, 200000
    s_cbranch_scc1 g_31L12_3
    s_mov_b32 s25, 200000
    s_branch gc_32
g_31F12_3:
    s_mov_b64 exec, vcc
    buffer_load_dwordx4 v[36:39], v2, s[4:7], s16 offen offset:3072 sc1
    s_mov_b64 exec, -1
    s_add_u32 s23, s23, 1
    s_cmp_lt_u32 s23, 200000
    s_cbranch_scc1 g_31L12_2
    s_mov_b32 s25, 200000
    s_branch gc_32
g_31F1_0:
    s_mov_b64 exec, vcc
    buffer_load_dwordx4 v[24:27], v2, s[4:7], s16 offen offset:0 sc1
    s_mov_b64 exec, -1
    s_add_u32 s23, s23, 1
    s_cmp_lt_u32 s23, 200000
    s_cbranch_scc1 g_31L1_0
    s_mov_b32 s25, 200000
    s_branch gc_32
g_31F2_1:
    s_mov_b64 exec, vcc
    buffer_load_dwordx4 v[28:31], v2, s[4:7], s16 offen offset:1024 sc1
    s_mov_b64 exec, -1
    s_add_u32 s23, s23, 1
    s_cmp_lt_u32 s23, 200000
    s_cbranch_scc1 g_31L2_1
    s_mov_b32 s25, 200000
    s_branch gc_32
g_31F4_2:
    s_mov_b64 exec, vcc
    buffer_load_dwordx4 v[32:35], v2, s[4:7], s16 offen offset:2048 sc1
    s_mov_b64 exec, -1
    s_add_u32 s23, s23, 1
    s_cmp_lt_u32 s23, 200000
    s_cbranch_scc1 g_31L4_2
    s_mov_b32 s25, 200000
    s_branch gc_32
g_31F8_3:
    s_mov_b64 exec, vcc
    buffer_load_dwordx4 v[36:39], v2, s[4:7], s16 offen offset:3072 sc1
    s_mov_b64 exec, -1
    s_add_u32 s23, s23, 1
    s_cmp_lt_u32 s23, 200000
    s_cbranch_scc1 g_31L8_3
    s_mov_b32 s25, 200000
    s_branch gc_32
sb_34:
    v_max3_u32 v19, v24, v25, v26
    v_max3_u32 v19, v19, v27, v28
    v_max3_u32 v19, v19, v29, v30
    v_max3_u32 v19, v19, v31, v32
    v_max3_u32 v19, v19, v33, v34
    v_max3_u32 v19, v19, v35, v36
    v_max3_u32 v19, v19, v37, v38
    v_max3_u32 v19, v19, v39, v40
    v_max3_u32 v19, v19, v41, v42
    v_max_u32 v19, v19, v43
    v_cmp_eq_u32 vcc, -1, v19
    s_nop 0
    s_cbranch_vccz sg_35
    buffer_load_dwordx4 v[24:27], v5, s[4:7], s16 offen offset:0 sc1
    buffer_load_dwordx4 v[28:31], v5, s[4:7], s16 offen offset:1024 sc1
    buffer_load_dwordx4 v[32:35], v5, s[4:7], s16 offen offset:2048 sc1
    buffer_load_dwordx4 v[36:39], v5, s[4:7], s16 offen offset:3072 sc1
    buffer_load_dword v40, v6, s[4:7], s16 offen offset:0 sc1
    buffer_load_dword v41, v6, s[4:7], s16 offen offset:256 sc1
    buffer_load_dword v42, v6, s[4:7], s16 offen offset:512 sc1
    buffer_load_dword v43, v6, s[4:7], s16 offen offset:768 sc1
    s_add_u32 s23, s23, 1
    s_cmp_lt_u32 s23, 200000
    s_cbranch_scc1 ss_33
    s_mov_b32 s25, 200000
    s_branch sg_35
ss_33:
    s_waitcnt vmcnt(6)
    v_pk_add_f32 v[180:181], v[24:25], v[28:29]
    v_pk_add_f32 v[182:183], v[26:27], v[30:31]
    s_waitcnt vmcnt(4)
    v_pk_add_f32 v[188:189], v[32:33], v[36:37]
    v_pk_add_f32 v[190:191], v[34:35], v[38:39]
    v_pk_add_f32 v[180:181], v[180:181], v[188:189]
    v_pk_add_f32 v[182:183], v[182:183], v[190:191]
    v_pk_add_f32 v[188:189], v[180:181], v[182:183]
    v_max3_f32 v185, v180, v181, v182
    s_waitcnt vmcnt(0)
    v_pk_add_f32 v[192:193], v[40:41], v[42:43]
    v_add_f32 v188, v188, v189
    v_add_f32 v184, v192, v193
    v_max3_f32 v185, v185, v183, v184
    v_cmp_u_f32 vcc, v188, v184
    s_nop 0
    v_max_f32_dpp v185, v185, v185 row_ror:8 row_mask:0xf bank_mask:0xf
    v_mov_b32 v186, v185
    s_nop 1
    v_permlane16_swap_b32 v185, v186
    v_max_f32 v185, v185, v186
    v_mov_b32 v186, v185
    s_cbranch_vccnz sb_34
    s_branch sg_35
g_36L15_0:
    s_waitcnt vmcnt(3)
    v_max3_u32 v19, v24, v25, v26
    v_max_u32 v19, v19, v27
    v_cmp_eq_u32 vcc, -1, v19
    s_nop 0
    s_cbranch_vccnz g_36F15_0
    v_smfmac_f32_16x16x64_bf16 v[64:67], v[24:27], a[192:199], v172
    v_smfmac_f32_16x16x64_bf16 v[68:71], v[24:27], a[224:231], v172
g_36L14_1:
    s_waitcnt vmcnt(2)
    v_max3_u32 v19, v28, v29, v30
    v_max_u32 v19, v19, v31
    v_cmp_eq_u32 vcc, -1, v19
    s_nop 0
    s_cbranch_vccnz g_36F14_1
    v_smfmac_f32_16x16x64_bf16 v[64:67], v[28:31], a[200:207], v172
    v_smfmac_f32_16x16x64_bf16 v[68:71], v[28:31], a[232:239], v172
g_36L12_2:
    s_waitcnt vmcnt(1)
    v_max3_u32 v19, v32, v33, v34
    v_max_u32 v19, v19, v35
    v_cmp_eq_u32 vcc, -1, v19
    s_nop 0
    s_cbranch_vccnz g_36F12_2
    v_smfmac_f32_16x16x64_bf16 v[64:67], v[32:35], a[208:215], v172
    v_smfmac_f32_16x16x64_bf16 v[68:71], v[32:35], a[240:247], v172
g_36L8_3:
    s_waitcnt vmcnt(0)
    v_max3_u32 v19, v36, v37, v38
    v_max_u32 v19, v19, v39
    v_cmp_eq_u32 vcc, -1, v19
    s_nop 0
    s_cbranch_vccnz g_36F8_3
    v_smfmac_f32_16x16x64_bf16 v[64:67], v[36:39], a[216:223], v172
    v_smfmac_f32_16x16x64_bf16 v[68:71], v[36:39], a[248:255], v172
    s_nop 4
    v_cvt_pk_bf16_f32 v80, v64, v65
    v_cvt_pk_bf16_f32 v81, v66, v67
    s_nop 0
    v_cvt_pk_bf16_f32 v82, v68, v69
    v_cvt_pk_bf16_f32 v83, v70, v71
    ds_write_b128 v17, v[80:83] offset:9216
    s_branch gc_37
g_36L15_1:
    s_waitcnt vmcnt(3)
    v_max3_u32 v19, v28, v29, v30
    v_max_u32 v19, v19, v31
    v_cmp_eq_u32 vcc, -1, v19
    s_nop 0
    s_cbranch_vccnz g_36F15_1
    v_smfmac_f32_16x16x64_bf16 v[64:67], v[28:31], a[200:207], v172
    v_smfmac_f32_16x16x64_bf16 v[68:71], v[28:31], a[232:239], v172
g_36L13_2:
    s_waitcnt vmcnt(2)
    v_max3_u32 v19, v32, v33, v34
    v_max_u32 v19, v19, v35
    v_cmp_eq_u32 vcc, -1, v19
    s_nop 0
    s_cbranch_vccnz g_36F13_2
    v_smfmac_f32_16x16x64_bf16 v[64:67], v[32:35], a[208:215], v172
    v_smfmac_f32_16x16x64_bf16 v[68:71], v[32:35], a[240:247], v172
g_36L9_3:
    s_waitcnt vmcnt(1)
    v_max3_u32 v19, v36, v37, v38
    v_max_u32 v19, v19, v39
    v_cmp_eq_u32 vcc, -1, v19
    s_nop 0
    s_cbranch_vccnz g_36F9_3
    v_smfmac_f32_16x16x64_bf16 v[64:67], v[36:39], a[216:223], v172
    v_smfmac_f32_16x16x64_bf16 v[68:71], v[36:39], a[248:255], v172
g_36L1_0:
    s_waitcnt vmcnt(0)
    v_max3_u32 v19, v24, v25, v26
    v_max_u32 v19, v19, v27
    v_cmp_eq_u32 vcc, -1, v19
    s_nop 0
    s_cbranch_vccnz g_36F1_0
    v_smfmac_f32_16x16x64_bf16 v[64:67], v[24:27], a[192:199], v172
    v_smfmac_f32_16x16x64_bf16 v[68:71], v[24:27], a[224:231], v172
    s_nop 4
    v_cvt_pk_bf16_f32 v80, v64, v65
    v_cvt_pk_bf16_f32 v81, v66, v67
    s_nop 0
    v_cvt_pk_bf16_f32 v82, v68, v69
    v_cvt_pk_bf16_f32 v83, v70, v71
    ds_write_b128 v17, v[80:83] offset:9216
    s_branch gc_37
g_36L15_2:
    s_waitcnt vmcnt(3)
    v_max3_u32 v19, v32, v33, v34
    v_max_u32 v19, v19, v35
    v_cmp_eq_u32 vcc, -1, v19
    s_nop 0
    s_cbranch_vccnz g_36F15_2
    v_smfmac_f32_16x16x64_bf16 v[64:67], v[32:35], a[208:215], v172
    v_smfmac_f32_16x16x64_bf16 v[68:71], v[32:35], a[240:247], v172
g_36L11_3:
    s_waitcnt vmcnt(2)
    v_max3_u32 v19, v36, v37, v38
    v_max_u32 v19, v19, v39
    v_cmp_eq_u32 vcc, -1, v19
    s_nop 0
    s_cbranch_vccnz g_36F11_3
    v_smfmac_f32_16x16x64_bf16 v[64:67], v[36:39], a[216:223], v172
    v_smfmac_f32_16x16x64_bf16 v[68:71], v[36:39], a[248:255], v172
g_36L3_0:
    s_waitcnt vmcnt(1)
    v_max3_u32 v19, v24, v25, v26
    v_max_u32 v19, v19, v27
    v_cmp_eq_u32 vcc, -1, v19
    s_nop 0
    s_cbranch_vccnz g_36F3_0
    v_smfmac_f32_16x16x64_bf16 v[64:67], v[24:27], a[192:199], v172
    v_smfmac_f32_16x16x64_bf16 v[68:71], v[24:27], a[224:231], v172
g_36L2_1:
    s_waitcnt vmcnt(0)
    v_max3_u32 v19, v28, v29, v30
    v_max_u32 v19, v19, v31
    v_cmp_eq_u32 vcc, -1, v19
    s_nop 0
    s_cbranch_vccnz g_36F2_1
    v_smfmac_f32_16x16x64_bf16 v[64:67], v[28:31], a[200:207], v172
    v_smfmac_f32_16x16x64_bf16 v[68:71], v[28:31], a[232:239], v172
    s_nop 4
    v_cvt_pk_bf16_f32 v80, v64, v65
    v_cvt_pk_bf16_f32 v81, v66, v67
    s_nop 0
    v_cvt_pk_bf16_f32 v82, v68, v69
    v_cvt_pk_bf16_f32 v83, v70, v71
    ds_write_b128 v17, v[80:83] offset:9216
    s_branch gc_37
g_36L15_3:
    s_waitcnt vmcnt(3)
    v_max3_u32 v19, v36, v37, v38
    v_max_u32 v19, v19, v39
    v_cmp_eq_u32 vcc, -1, v19
    s_nop 0
    s_cbranch_vccnz g_36F15_3
    v_smfmac_f32_16x16x64_bf16 v[64:67], v[36:39], a[216:223], v172
    v_smfmac_f32_16x16x64_bf16 v[68:71], v[36:39], a[248:255], v172
g_36L7_0:
    s_waitcnt vmcnt(2)
    v_max3_u32 v19, v24, v25, v26
    v_max_u32 v19, v19, v27
    v_cmp_eq_u32 vcc, -1, v19
    s_nop 0
    s_cbranch_vccnz g_36F7_0
    v_smfmac_f32_16x16x64_bf16 v[64:67], v[24:27], a[192:199], v172
    v_smfmac_f32_16x16x64_bf16 v[68:71], v[24:27], a[224:231], v172
g_36L6_1:
    s_waitcnt vmcnt(1)
    v_max3_u32 v19, v28, v29, v30
    v_max_u32 v19, v19, v31
    v_cmp_eq_u32 vcc, -1, v19
    s_nop 0
    s_cbranch_vccnz g_36F6_1
    v_smfmac_f32_16x16x64_bf16 v[64:67], v[28:31], a[200:207], v172
    v_smfmac_f32_16x16x64_bf16 v[68:71], v[28:31], a[232:239], v172
g_36L4_2:
    s_waitcnt vmcnt(0)
    v_max3_u32 v19, v32, v33, v34
    v_max_u32 v19, v19, v35
    v_cmp_eq_u32 vcc, -1, v19
    s_nop 0
    s_cbranch_vccnz g_36F4_2
    v_smfmac_f32_16x16x64_bf16 v[64:67], v[32:35], a[208:215], v172
    v_smfmac_f32_16x16x64_bf16 v[68:71], v[32:35], a[240:247], v172
    s_nop 4
    v_cvt_pk_bf16_f32 v80, v64, v65
    v_cvt_pk_bf16_f32 v81, v66, v67
    s_nop 0
    v_cvt_pk_bf16_f32 v82, v68, v69
    v_cvt_pk_bf16_f32 v83, v70, v71
    ds_write_b128 v17, v[80:83] offset:9216
    s_branch gc_37
g_36L7_1:
    s_waitcnt vmcnt(2)
    v_max3_u32 v19, v28, v29, v30
    v_max_u32 v19, v19, v31
    v_cmp_eq_u32 vcc, -1, v19
    s_nop 0
    s_cbranch_vccnz g_36F7_1
    v_smfmac_f32_16x16x64_bf16 v[64:67], v[28:31], a[200:207], v172
    v_smfmac_f32_16x16x64_bf16 v[68:71], v[28:31], a[232:239], v172
g_36L5_2:
    s_waitcnt vmcnt(1)
    v_max3_u32 v19, v32, v33, v34
    v_max_u32 v19, v19, v35
    v_cmp_eq_u32 vcc, -1, v19
    s_nop 0
    s_cbranch_vccnz g_36F5_2
    v_smfmac_f32_16x16x64_bf16 v[64:67], v[32:35], a[208:215], v172
    v_smfmac_f32_16x16x64_bf16 v[68:71], v[32:35], a[240:247], v172
    s_branch g_36L1_0
g_36L7_2:
    s_waitcnt vmcnt(2)
    v_max3_u32 v19, v32, v33, v34
    v_max_u32 v19, v19, v35
    v_cmp_eq_u32 vcc, -1, v19
    s_nop 0
    s_cbranch_vccnz g_36F7_2
    v_smfmac_f32_16x16x64_bf16 v[64:67], v[32:35], a[208:215], v172
    v_smfmac_f32_16x16x64_bf16 v[68:71], v[32:35], a[240:247], v172
    s_branch g_36L3_0
g_36L11_0:
    s_waitcnt vmcnt(2)
    v_max3_u32 v19, v24, v25, v26
    v_max_u32 v19, v19, v27
    v_cmp_eq_u32 vcc, -1, v19
    s_nop 0
    s_cbranch_vccnz g_36F11_0
    v_smfmac_f32_16x16x64_bf16 v[64:67], v[24:27], a[192:199], v172
    v_smfmac_f32_16x16x64_bf16 v[68:71], v[24:27], a[224:231], v172
g_36L10_1:
    s_waitcnt vmcnt(1)
    v_max3_u32 v19, v28, v29, v30
    v_max_u32 v19, v19, v31
    v_cmp_eq_u32 vcc, -1, v19
    s_nop 0
    s_cbranch_vccnz g_36F10_1
    v_smfmac_f32_16x16x64_bf16 v[64:67], v[28:31], a[200:207], v172
    v_smfmac_f32_16x16x64_bf16 v[68:71], v[28:31], a[232:239], v172
    s_branch g_36L8_3
g_36L11_1:
    s_waitcnt vmcnt(2)
    v_max3_u32 v19, v28, v29, v30
    v_max_u32 v19, v19, v31
    v_cmp_eq_u32 vcc, -1, v19
    s_nop 0
    s_cbranch_vccnz g_36F11_1
    v_smfmac_f32_16x16x64_bf16 v[64:67], v[28:31], a[200:207], v172
    v_smfmac_f32_16x16x64_bf16 v[68:71], v[28:31], a[232:239], v172
    s_branch g_36L9_3
g_36L13_0:
    s_waitcnt vmcnt(2)
    v_max3_u32 v19, v24, v25, v26
    v_max_u32 v19, v19, v27
    v_cmp_eq_u32 vcc, -1, v19
    s_nop 0
    s_cbranch_vccnz g_36F13_0
    v_smfmac_f32_16x16x64_bf16 v[64:67], v[24:27], a[192:199], v172
    v_smfmac_f32_16x16x64_bf16 v[68:71], v[24:27], a[224:231], v172
    s_branch g_36L12_2
g_36L13_3:
    s_waitcnt vmcnt(2)
    v_max3_u32 v19, v36, v37, v38
    v_max_u32 v19, v19, v39
    v_cmp_eq_u32 vcc, -1, v19
    s_nop 0
    s_cbranch_vccnz g_36F13_3
    v_smfmac_f32_16x16x64_bf16 v[64:67], v[36:39], a[216:223], v172
    v_smfmac_f32_16x16x64_bf16 v[68:71], v[36:39], a[248:255], v172
g_36L5_0:
    s_waitcnt vmcnt(1)
    v_max3_u32 v19, v24, v25, v26
    v_max_u32 v19, v19, v27
    v_cmp_eq_u32 vcc, -1, v19
    s_nop 0
    s_cbranch_vccnz g_36F5_0
    v_smfmac_f32_16x16x64_bf16 v[64:67], v[24:27], a[192:199], v172
    v_smfmac_f32_16x16x64_bf16 v[68:71], v[24:27], a[224:231], v172
    s_branch g_36L4_2
g_36L14_2:
    s_waitcnt vmcnt(2)
    v_max3_u32 v19, v32, v33, v34
    v_max_u32 v19, v19, v35
    v_cmp_eq_u32 vcc, -1, v19
    s_nop 0
    s_cbranch_vccnz g_36F14_2
    v_smfmac_f32_16x16x64_bf16 v[64:67], v[32:35], a[208:215], v172
    v_smfmac_f32_16x16x64_bf16 v[68:71], v[32:35], a[240:247], v172
g_36L10_3:
    s_waitcnt vmcnt(1)
    v_max3_u32 v19, v36, v37, v38
    v_max_u32 v19, v19, v39
    v_cmp_eq_u32 vcc, -1, v19
    s_nop 0
    s_cbranch_vccnz g_36F10_3
    v_smfmac_f32_16x16x64_bf16 v[64:67], v[36:39], a[216:223], v172
    v_smfmac_f32_16x16x64_bf16 v[68:71], v[36:39], a[248:255], v172
    s_branch g_36L2_1
g_36L14_3:
    s_waitcnt vmcnt(2)
    v_max3_u32 v19, v36, v37, v38
    v_max_u32 v19, v19, v39
    v_cmp_eq_u32 vcc, -1, v19
    s_nop 0
    s_cbranch_vccnz g_36F14_3
    v_smfmac_f32_16x16x64_bf16 v[64:67], v[36:39], a[216:223], v172
    v_smfmac_f32_16x16x64_bf16 v[68:71], v[36:39], a[248:255], v172
    s_branch g_36L6_1
g_36L3_1:
    s_waitcnt vmcnt(1)
    v_max3_u32 v19, v28, v29, v30
    v_max_u32 v19, v19, v31
    v_cmp_eq_u32 vcc, -1, v19
    s_nop 0
    s_cbranch_vccnz g_36F3_1
    v_smfmac_f32_16x16x64_bf16 v[64:67], v[28:31], a[200:207], v172
    v_smfmac_f32_16x16x64_bf16 v[68:71], v[28:31], a[232:239], v172
    s_branch g_36L1_0
g_36L6_2:
    s_waitcnt vmcnt(1)
    v_max3_u32 v19, v32, v33, v34
    v_max_u32 v19, v19, v35
    v_cmp_eq_u32 vcc, -1, v19
    s_nop 0
    s_cbranch_vccnz g_36F6_2
    v_smfmac_f32_16x16x64_bf16 v[64:67], v[32:35], a[208:215], v172
    v_smfmac_f32_16x16x64_bf16 v[68:71], v[32:35], a[240:247], v172
    s_branch g_36L2_1
g_36L9_0:
    s_waitcnt vmcnt(1)
    v_max3_u32 v19, v24, v25, v26
    v_max_u32 v19, v19, v27
    v_cmp_eq_u32 vcc, -1, v19
    s_nop 0
    s_cbranch_vccnz g_36F9_0
    v_smfmac_f32_16x16x64_bf16 v[64:67], v[24:27], a[192:199], v172
    v_smfmac_f32_16x16x64_bf16 v[68:71], v[24:27], a[224:231], v172
    s_branch g_36L8_3
g_36L12_3:
    s_waitcnt vmcnt(1)
    v_max3_u32 v19, v36, v37, v38
    v_max_u32 v19, v19, v39
    v_cmp_eq_u32 vcc, -1, v19
    s_nop 0
    s_cbranch_vccnz g_36F12_3
    v_smfmac_f32_16x16x64_bf16 v[64:67], v[36:39], a[216:223], v172
    v_smfmac_f32_16x16x64_bf16 v[68:71], v[36:39], a[248:255], v172
    s_branch g_36L4_2
g_36F15_0:
    s_mov_b64 exec, vcc
    buffer_load_dwordx4 v[24:27], v8, s[4:7], s16 offen offset:0 sc1
    s_mov_b64 exec, -1
    s_add_u32 s23, s23, 1
    s_cmp_lt_u32 s23, 200000
    s_cbranch_scc1 g_36L15_1
    s_mov_b32 s25, 200000
    s_branch gc_37
g_36F15_1:
    s_mov_b64 exec, vcc
    buffer_load_dwordx4 v[28:31], v8, s[4:7], s16 offen offset:1024 sc1
    s_mov_b64 exec, -1
    s_add_u32 s23, s23, 1
    s_cmp_lt_u32 s23, 200000
    s_cbranch_scc1 g_36L15_2
    s_mov_b32 s25, 200000
    s_branch gc_37
g_36F15_2:
    s_mov_b64 exec, vcc
    buffer_load_dwordx4 v[32:35], v8, s[4:7], s16 offen offset:2048 sc1
    s_mov_b64 exec, -1
    s_add_u32 s23, s23, 1
    s_cmp_lt_u32 s23, 200000
    s_cbranch_scc1 g_36L15_3
    s_mov_b32 s25, 200000
    s_branch gc_37
g_36F15_3:
    s_mov_b64 exec, vcc
    buffer_load_dwordx4 v[36:39], v8, s[4:7], s16 offen offset:3072 sc1
    s_mov_b64 exec, -1
    s_add_u32 s23, s23, 1
    s_cmp_lt_u32 s23, 200000
    s_cbranch_scc1 g_36L15_0
    s_mov_b32 s25, 200000
    s_branch gc_37
g_36F7_0:
    s_mov_b64 exec, vcc
    buffer_load_dwordx4 v[24:27], v8, s[4:7], s16 offen offset:0 sc1
    s_mov_b64 exec, -1
    s_add_u32 s23, s23, 1
    s_cmp_lt_u32 s23, 200000
    s_cbranch_scc1 g_36L7_1
    s_mov_b32 s25, 200000
    s_branch gc_37
g_36F7_1:
    s_mov_b64 exec, vcc
    buffer_load_dwordx4 v[28:31], v8, s[4:7], s16 offen offset:1024 sc1
    s_mov_b64 exec, -1
    s_add_u32 s23, s23, 1
    s_cmp_lt_u32 s23, 200000
    s_cbranch_scc1 g_36L7_2
    s_mov_b32 s25, 200000
    s_branch gc_37
g_36F7_2:
    s_mov_b64 exec, vcc
    buffer_load_dwordx4 v[32:35], v8, s[4:7], s16 offen offset:2048 sc1
    s_mov_b64 exec, -1
    s_add_u32 s23, s23, 1
    s_cmp_lt_u32 s23, 200000
    s_cbranch_scc1 g_36L7_0
    s_mov_b32 s25, 200000
    s_branch gc_37
g_36F11_0:
    s_mov_b64 exec, vcc
    buffer_load_dwordx4 v[24:27], v8, s[4:7], s16 offen offset:0 sc1
    s_mov_b64 exec, -1
    s_add_u32 s23, s23, 1
    s_cmp_lt_u32 s23, 200000
    s_cbranch_scc1 g_36L11_1
    s_mov_b32 s25, 200000
    s_branch gc_37
g_36F11_1:
    s_mov_b64 exec, vcc
    buffer_load_dwordx4 v[28:31], v8, s[4:7], s16 offen offset:1024 sc1
    s_mov_b64 exec, -1
    s_add_u32 s23, s23, 1
    s_cmp_lt_u32 s23, 200000
    s_cbranch_scc1 g_36L11_3
    s_mov_b32 s25, 200000
    s_branch gc_37
g_36F11_3:
    s_mov_b64 exec, vcc
    buffer_load_dwordx4 v[36:39], v8, s[4:7], s16 offen offset:3072 sc1
    s_mov_b64 exec, -1
    s_add_u32 s23, s23, 1
    s_cmp_lt_u32 s23, 200000
    s_cbranch_scc1 g_36L11_0
    s_mov_b32 s25, 200000
    s_branch gc_37
g_36F13_0:
    s_mov_b64 exec, vcc
    buffer_load_dwordx4 v[24:27], v8, s[4:7], s16 offen offset:0 sc1
    s_mov_b64 exec, -1
    s_add_u32 s23, s23, 1
    s_cmp_lt_u32 s23, 200000
    s_cbranch_scc1 g_36L13_2
    s_mov_b32 s25, 200000
    s_branch gc_37
g_36F13_2:
    s_mov_b64 exec, vcc
    buffer_load_dwordx4 v[32:35], v8, s[4:7], s16 offen offset:2048 sc1
    s_mov_b64 exec, -1
    s_add_u32 s23, s23, 1
    s_cmp_lt_u32 s23, 200000
    s_cbranch_scc1 g_36L13_3
    s_mov_b32 s25, 200000
    s_branch gc_37
g_36F13_3:
    s_mov_b64 exec, vcc
    buffer_load_dwordx4 v[36:39], v8, s[4:7], s16 offen offset:3072 sc1
    s_mov_b64 exec, -1
    s_add_u32 s23, s23, 1
    s_cmp_lt_u32 s23, 200000
    s_cbranch_scc1 g_36L13_0
    s_mov_b32 s25, 200000
    s_branch gc_37
g_36F14_1:
    s_mov_b64 exec, vcc
    buffer_load_dwordx4 v[28:31], v8, s[4:7], s16 offen offset:1024 sc1
    s_mov_b64 exec, -1
    s_add_u32 s23, s23, 1
    s_cmp_lt_u32 s23, 200000
    s_cbranch_scc1 g_36L14_2
    s_mov_b32 s25, 200000
    s_branch gc_37
g_36F14_2:
    s_mov_b64 exec, vcc
    buffer_load_dwordx4 v[32:35], v8, s[4:7], s16 offen offset:2048 sc1
    s_mov_b64 exec, -1
    s_add_u32 s23, s23, 1
    s_cmp_lt_u32 s23, 200000
    s_cbranch_scc1 g_36L14_3
    s_mov_b32 s25, 200000
    s_branch gc_37
g_36F14_3:
    s_mov_b64 exec, vcc
    buffer_load_dwordx4 v[36:39], v8, s[4:7], s16 offen offset:3072 sc1
    s_mov_b64 exec, -1
    s_add_u32 s23, s23, 1
    s_cmp_lt_u32 s23, 200000
    s_cbranch_scc1 g_36L14_1
    s_mov_b32 s25, 200000
    s_branch gc_37
g_36F3_0:
    s_mov_b64 exec, vcc
    buffer_load_dwordx4 v[24:27], v8, s[4:7], s16 offen offset:0 sc1
    s_mov_b64 exec, -1
    s_add_u32 s23, s23, 1
    s_cmp_lt_u32 s23, 200000
    s_cbranch_scc1 g_36L3_1
    s_mov_b32 s25, 200000
    s_branch gc_37
g_36F3_1:
    s_mov_b64 exec, vcc
    buffer_load_dwordx4 v[28:31], v8, s[4:7], s16 offen offset:1024 sc1
    s_mov_b64 exec, -1
    s_add_u32 s23, s23, 1
    s_cmp_lt_u32 s23, 200000
    s_cbranch_scc1 g_36L3_0
    s_mov_b32 s25, 200000
    s_branch gc_37
g_36F5_0:
    s_mov_b64 exec, vcc
    buffer_load_dwordx4 v[24:27], v8, s[4:7], s16 offen offset:0 sc1
    s_mov_b64 exec, -1
    s_add_u32 s23, s23, 1
    s_cmp_lt_u32 s23, 200000
    s_cbranch_scc1 g_36L5_2
    s_mov_b32 s25, 200000
    s_branch gc_37
g_36F5_2:
    s_mov_b64 exec, vcc
    buffer_load_dwordx4 v[32:35], v8, s[4:7], s16 offen offset:2048 sc1
    s_mov_b64 exec, -1
    s_add_u32 s23, s23, 1
    s_cmp_lt_u32 s23, 200000
    s_cbranch_scc1 g_36L5_0
    s_mov_b32 s25, 200000
    s_branch gc_37
g_36F6_1:
    s_mov_b64 exec, vcc
    buffer_load_dwordx4 v[28:31], v8, s[4:7], s16 offen offset:1024 sc1
    s_mov_b64 exec, -1
    s_add_u32 s23, s23, 1
    s_cmp_lt_u32 s23, 200000
    s_cbranch_scc1 g_36L6_2
    s_mov_b32 s25, 200000
    s_branch gc_37
g_36F6_2:
    s_mov_b64 exec, vcc
    buffer_load_dwordx4 v[32:35], v8, s[4:7], s16 offen offset:2048 sc1
    s_mov_b64 exec, -1
    s_add_u32 s23, s23, 1
    s_cmp_lt_u32 s23, 200000
    s_cbranch_scc1 g_36L6_1
    s_mov_b32 s25, 200000
    s_branch gc_37
g_36F9_0:
    s_mov_b64 exec, vcc
    buffer_load_dwordx4 v[24:27], v8, s[4:7], s16 offen offset:0 sc1
    s_mov_b64 exec, -1
    s_add_u32 s23, s23, 1
    s_cmp_lt_u32 s23, 200000
    s_cbranch_scc1 g_36L9_3
    s_mov_b32 s25, 200000
    s_branch gc_37
g_36F9_3:
    s_mov_b64 exec, vcc
    buffer_load_dwordx4 v[36:39], v8, s[4:7], s16 offen offset:3072 sc1
    s_mov_b64 exec, -1
    s_add_u32 s23, s23, 1
    s_cmp_lt_u32 s23, 200000
    s_cbranch_scc1 g_36L9_0
    s_mov_b32 s25, 200000
    s_branch gc_37
g_36F10_1:
    s_mov_b64 exec, vcc
    buffer_load_dwordx4 v[28:31], v8, s[4:7], s16 offen offset:1024 sc1
    s_mov_b64 exec, -1
    s_add_u32 s23, s23, 1
    s_cmp_lt_u32 s23, 200000
    s_cbranch_scc1 g_36L10_3
    s_mov_b32 s25, 200000
    s_branch gc_37
g_36F10_3:
    s_mov_b64 exec, vcc
    buffer_load_dwordx4 v[36:39], v8, s[4:7], s16 offen offset:3072 sc1
    s_mov_b64 exec, -1
    s_add_u32 s23, s23, 1
    s_cmp_lt_u32 s23, 200000
    s_cbranch_scc1 g_36L10_1
    s_mov_b32 s25, 200000
    s_branch gc_37
g_36F12_2:
    s_mov_b64 exec, vcc
    buffer_load_dwordx4 v[32:35], v8, s[4:7], s16 offen offset:2048 sc1
    s_mov_b64 exec, -1
    s_add_u32 s23, s23, 1
    s_cmp_lt_u32 s23, 200000
    s_cbranch_scc1 g_36L12_3
    s_mov_b32 s25, 200000
    s_branch gc_37
g_36F12_3:
    s_mov_b64 exec, vcc
    buffer_load_dwordx4 v[36:39], v8, s[4:7], s16 offen offset:3072 sc1
    s_mov_b64 exec, -1
    s_add_u32 s23, s23, 1
    s_cmp_lt_u32 s23, 200000
    s_cbranch_scc1 g_36L12_2
    s_mov_b32 s25, 200000
    s_branch gc_37
g_36F1_0:
    s_mov_b64 exec, vcc
    buffer_load_dwordx4 v[24:27], v8, s[4:7], s16 offen offset:0 sc1
    s_mov_b64 exec, -1
    s_add_u32 s23, s23, 1
    s_cmp_lt_u32 s23, 200000
    s_cbranch_scc1 g_36L1_0
    s_mov_b32 s25, 200000
    s_branch gc_37
g_36F2_1:
    s_mov_b64 exec, vcc
    buffer_load_dwordx4 v[28:31], v8, s[4:7], s16 offen offset:1024 sc1
    s_mov_b64 exec, -1
    s_add_u32 s23, s23, 1
    s_cmp_lt_u32 s23, 200000
    s_cbranch_scc1 g_36L2_1
    s_mov_b32 s25, 200000
    s_branch gc_37
g_36F4_2:
    s_mov_b64 exec, vcc
    buffer_load_dwordx4 v[32:35], v8, s[4:7], s16 offen offset:2048 sc1
    s_mov_b64 exec, -1
    s_add_u32 s23, s23, 1
    s_cmp_lt_u32 s23, 200000
    s_cbranch_scc1 g_36L4_2
    s_mov_b32 s25, 200000
    s_branch gc_37
g_36F8_3:
    s_mov_b64 exec, vcc
    buffer_load_dwordx4 v[36:39], v8, s[4:7], s16 offen offset:3072 sc1
    s_mov_b64 exec, -1
    s_add_u32 s23, s23, 1
    s_cmp_lt_u32 s23, 200000
    s_cbranch_scc1 g_36L8_3
    s_mov_b32 s25, 200000
    s_branch gc_37
.p2align 6
recur_fast_w2:
    s_nop 15
    s_mov_b32 s23, s25
    buffer_load_dwordx4 v[24:27], v2, s[4:7], s16 offen offset:0 sc1
    s_nop 11
    buffer_load_dwordx4 v[28:31], v2, s[4:7], s16 offen offset:1024 sc1
    s_nop 11
    buffer_load_dwordx4 v[32:35], v2, s[4:7], s16 offen offset:2048 sc1
    s_nop 11
    buffer_load_dwordx4 v[36:39], v2, s[4:7], s16 offen offset:3072 sc1
    s_waitcnt vmcnt(3)
    v_max3_u32 v19, v24, v25, v26
    v_max_u32 v19, v19, v27
    v_cmp_eq_u32 vcc, -1, v19
    s_nop 0
    s_cbranch_vccnz g_40F15_0
    v_smfmac_f32_16x16x64_bf16 v[40:43], v[24:27], a[0:7], v172
    s_waitcnt vmcnt(2)
    v_max3_u32 v19, v28, v29, v30
    v_max_u32 v19, v19, v31
    v_smfmac_f32_16x16x64_bf16 v[44:47], v[24:27], a[64:71], v172
    v_cmp_eq_u32 vcc, -1, v19
    v_smfmac_f32_16x16x64_bf16 v[48:51], v[24:27], a[32:39], v172
    v_smfmac_f32_16x16x64_bf16 v[52:55], v[24:27], a[96:103], v172
    s_cbranch_vccnz g_40F14_1
    v_smfmac_f32_16x16x64_bf16 v[40:43], v[28:31], a[8:15], v172
    s_waitcnt vmcnt(1)
    v_max3_u32 v19, v32, v33, v34
    v_max_u32 v19, v19, v35
    v_smfmac_f32_16x16x64_bf16 v[44:47], v[28:31], a[72:79], v172
    v_cmp_eq_u32 vcc, -1, v19
    v_smfmac_f32_16x16x64_bf16 v[48:51], v[28:31], a[40:47], v172
    v_smfmac_f32_16x16x64_bf16 v[52:55], v[28:31], a[104:111], v172
    s_cbranch_vccnz g_40F12_2
    v_smfmac_f32_16x16x64_bf16 v[40:43], v[32:35], a[16:23], v172
    s_waitcnt vmcnt(0)
    v_max3_u32 v19, v36, v37, v38
    v_max_u32 v19, v19, v39
    v_smfmac_f32_16x16x64_bf16 v[44:47], v[32:35], a[80:87], v172
    v_cmp_eq_u32 vcc, -1, v19
    v_smfmac_f32_16x16x64_bf16 v[48:51], v[32:35], a[48:55], v172
    v_smfmac_f32_16x16x64_bf16 v[52:55], v[32:35], a[112:119], v172
    s_cbranch_vccnz g_40F8_3
    v_smfmac_f32_16x16x64_bf16 v[40:43], v[36:39], a[24:31], v172
    v_smfmac_f32_16x16x64_bf16 v[44:47], v[36:39], a[88:95], v172
    v_smfmac_f32_16x16x64_bf16 v[48:51], v[36:39], a[56:63], v172
    v_smfmac_f32_16x16x64_bf16 v[52:55], v[36:39], a[120:127], v172
gc_41:
    v_cvt_pk_bf16_f32 v72, v40, v41
    v_cvt_pk_bf16_f32 v73, v42, v43
    v_cvt_pk_bf16_f32 v74, v44, v45
    v_cvt_pk_bf16_f32 v75, v46, v47
    ds_write_b128 v17, v[72:75] offset:0
    v_cvt_pk_bf16_f32 v76, v48, v49
    v_cvt_pk_bf16_f32 v77, v50, v51
    s_nop 0
    v_cvt_pk_bf16_f32 v78, v52, v53
    v_cvt_pk_bf16_f32 v79, v54, v55
    ds_write_b128 v17, v[76:79] offset:1024
    v_smfmac_f32_16x16x64_bf16 v[56:59], v[24:27], a[128:135], v172
    v_smfmac_f32_16x16x64_bf16 v[60:63], v[24:27], a[160:167], v172
    v_smfmac_f32_16x16x64_bf16 v[56:59], v[28:31], a[136:143], v172
    s_waitcnt lgkmcnt(0)
    s_barrier
    v_smfmac_f32_16x16x64_bf16 v[60:63], v[28:31], a[168:175], v172
    v_smfmac_f32_16x16x64_bf16 v[56:59], v[32:35], a[144:151], v172
    v_smfmac_f32_16x16x64_bf16 v[60:63], v[32:35], a[176:183], v172
    v_smfmac_f32_16x16x64_bf16 v[56:59], v[36:39], a[152:159], v172
    v_smfmac_f32_16x16x64_bf16 v[60:63], v[36:39], a[184:191], v172
    s_nop 4
    v_cvt_pk_bf16_f32 v80, v56, v57
    v_cvt_pk_bf16_f32 v81, v58, v59
    s_nop 0
    v_cvt_pk_bf16_f32 v82, v60, v61
    v_cvt_pk_bf16_f32 v83, v62, v63
    ds_write_b128 v17, v[80:83] offset:8192
    s_cmp_eq_u32 s15, 63
    s_waitcnt lgkmcnt(0)
    s_barrier
    ds_read_b128 v[96:99], v16 offset:8192
    ds_read_b128 v[100:103], v16 offset:10240
    ds_read_b128 v[108:111], v16 offset:14336
    v_mfma_f32_16x16x32_bf16 v[140:143], v[84:87], v[80:83], 0
    s_waitcnt lgkmcnt(2)
    v_mfma_f32_16x16x32_bf16 v[140:143], v[84:87], v[96:99], v[140:143]
    s_waitcnt lgkmcnt(1)
    v_mfma_f32_16x16x32_bf16 v[140:143], v[84:87], v[100:103], v[140:143]
    s_waitcnt lgkmcnt(0)
    v_mfma_f32_16x16x32_bf16 v[140:143], v[84:87], v[108:111], v[140:143]
    s_nop 7
    v_cvt_pk_bf16_f32 v168, v140, v141
    v_cvt_pk_bf16_f32 v169, v142, v143
    v_mov_b32 v170, v168
    v_mov_b32 v171, v169
    s_nop 0
    v_permlane16_swap_b32 v168, v170
    v_permlane16_swap_b32 v169, v171
    v_mov_b32 v247, s15
    s_cbranch_scc1 recur_fast_last2
    s_barrier
    s_nop 15
    s_mov_b32 s23, s25
    buffer_load_dwordx4 v[24:27], v8, s[4:7], s16 offen offset:0 sc1
    s_nop 11
    buffer_load_dwordx4 v[28:31], v8, s[4:7], s16 offen offset:1024 sc1
    s_nop 11
    buffer_load_dwordx4 v[32:35], v8, s[4:7], s16 offen offset:2048 sc1
    s_nop 11
    buffer_load_dwordx4 v[36:39], v8, s[4:7], s16 offen offset:3072 sc1
    s_waitcnt vmcnt(3)
    v_max3_u32 v19, v24, v25, v26
    v_max_u32 v19, v19, v27
    v_cmp_eq_u32 vcc, -1, v19
    s_nop 0
    s_cbranch_vccnz g_42F15_0
    v_smfmac_f32_16x16x64_bf16 v[64:67], v[24:27], a[192:199], v172
    v_smfmac_f32_16x16x64_bf16 v[68:71], v[24:27], a[224:231], v172
    s_waitcnt vmcnt(2)
    v_max3_u32 v19, v28, v29, v30
    v_max_u32 v19, v19, v31
    v_cmp_eq_u32 vcc, -1, v19
    s_nop 0
    s_cbranch_vccnz g_42F14_1
    v_smfmac_f32_16x16x64_bf16 v[64:67], v[28:31], a[200:207], v172
    v_smfmac_f32_16x16x64_bf16 v[68:71], v[28:31], a[232:239], v172
    s_waitcnt vmcnt(1)
    v_max3_u32 v19, v32, v33, v34
    v_max_u32 v19, v19, v35
    v_cmp_eq_u32 vcc, -1, v19
    s_nop 0
    s_cbranch_vccnz g_42F12_2
    v_smfmac_f32_16x16x64_bf16 v[64:67], v[32:35], a[208:215], v172
    v_smfmac_f32_16x16x64_bf16 v[68:71], v[32:35], a[240:247], v172
    s_waitcnt vmcnt(0)
    v_max3_u32 v19, v36, v37, v38
    v_max_u32 v19, v19, v39
    v_cmp_eq_u32 vcc, -1, v19
    s_nop 0
    s_cbranch_vccnz g_42F8_3
    v_smfmac_f32_16x16x64_bf16 v[64:67], v[36:39], a[216:223], v172
    v_smfmac_f32_16x16x64_bf16 v[68:71], v[36:39], a[248:255], v172
    s_nop 4
    v_cvt_pk_bf16_f32 v80, v64, v65
    v_cvt_pk_bf16_f32 v81, v66, v67
    s_nop 0
    v_cvt_pk_bf16_f32 v82, v68, v69
    v_cvt_pk_bf16_f32 v83, v70, v71
    ds_write_b128 v17, v[80:83] offset:9216
gc_43:
    s_waitcnt lgkmcnt(0)
    s_barrier
    s_nop 15
    s_nop 15
    s_nop 15
    s_nop 15
    buffer_store_dwordx4 v[168:171], v15, s[4:7], s20 offen sc1
    s_add_u32 s20, s20, 512
    s_add_u32 s21, s95, 1048576
    s_lshr_b32 s22, s21, 8
    s_and_b32 s22, s22, 8192
    s_xor_b32 s22, s22, s46
    s_add_u32 s21, s21, s22
    buffer_store_dwordx4 v[204:207], v9, s[4:7], s21 offen sc1
    s_add_u32 s21, s21, 262144
    buffer_store_dword v247, v246, s[4:7], 0 offen sc1
    v_mov_b32 v40, 0
    v_mov_b32 v41, 0
    v_mov_b32 v42, 0
    v_mov_b32 v43, 0
    v_mov_b32 v44, 0
    v_mov_b32 v45, 0
    v_mov_b32 v46, 0
    v_mov_b32 v47, 0
    v_mov_b32 v48, 0
    v_mov_b32 v49, 0
    v_mov_b32 v50, 0
    v_mov_b32 v51, 0
    v_mov_b32 v52, 0
    v_mov_b32 v53, 0
    v_mov_b32 v54, 0
    v_mov_b32 v55, 0
    v_mov_b32 v56, 0
    v_mov_b32 v57, 0
    v_mov_b32 v58, 0
    v_mov_b32 v59, 0
    v_mov_b32 v60, 0
    v_mov_b32 v61, 0
    v_mov_b32 v62, 0
    v_mov_b32 v63, 0
    v_mov_b32 v64, 0
    v_mov_b32 v65, 0
    v_mov_b32 v66, 0
    v_mov_b32 v67, 0
    v_mov_b32 v68, 0
    v_mov_b32 v69, 0
    v_mov_b32 v70, 0
    v_mov_b32 v71, 0
    s_mov_b32 s21, s16
    s_mov_b32 s16, s42
    s_mov_b32 s42, s43
    s_mov_b32 s43, s44
    s_mov_b32 s44, s21
    s_add_u32 s95, s95, 524288
    s_lshr_b32 s84, s95, 8
    s_and_b32 s84, s84, 8192
    s_xor_b32 s84, s84, s46
    s_add_u32 s84, s84, s95
    s_add_u32 s15, s15, 1
    s_barrier
    s_branch recur_fast_w2
g_40L15_0:
    s_waitcnt vmcnt(3)
    v_max3_u32 v19, v24, v25, v26
    v_max_u32 v19, v19, v27
    v_cmp_eq_u32 vcc, -1, v19
    s_nop 0
    s_cbranch_vccnz g_40F15_0
    v_smfmac_f32_16x16x64_bf16 v[40:43], v[24:27], a[0:7], v172
    v_smfmac_f32_16x16x64_bf16 v[44:47], v[24:27], a[64:71], v172
    v_smfmac_f32_16x16x64_bf16 v[48:51], v[24:27], a[32:39], v172
    v_smfmac_f32_16x16x64_bf16 v[52:55], v[24:27], a[96:103], v172
g_40L14_1:
    s_waitcnt vmcnt(2)
    v_max3_u32 v19, v28, v29, v30
    v_max_u32 v19, v19, v31
    v_cmp_eq_u32 vcc, -1, v19
    s_nop 0
    s_cbranch_vccnz g_40F14_1
    v_smfmac_f32_16x16x64_bf16 v[40:43], v[28:31], a[8:15], v172
    v_smfmac_f32_16x16x64_bf16 v[44:47], v[28:31], a[72:79], v172
    v_smfmac_f32_16x16x64_bf16 v[48:51], v[28:31], a[40:47], v172
    v_smfmac_f32_16x16x64_bf16 v[52:55], v[28:31], a[104:111], v172
g_40L12_2:
    s_waitcnt vmcnt(1)
    v_max3_u32 v19, v32, v33, v34
    v_max_u32 v19, v19, v35
    v_cmp_eq_u32 vcc, -1, v19
    s_nop 0
    s_cbranch_vccnz g_40F12_2
    v_smfmac_f32_16x16x64_bf16 v[40:43], v[32:35], a[16:23], v172
    v_smfmac_f32_16x16x64_bf16 v[44:47], v[32:35], a[80:87], v172
    v_smfmac_f32_16x16x64_bf16 v[48:51], v[32:35], a[48:55], v172
    v_smfmac_f32_16x16x64_bf16 v[52:55], v[32:35], a[112:119], v172
g_40L8_3:
    s_waitcnt vmcnt(0)
    v_max3_u32 v19, v36, v37, v38
    v_max_u32 v19, v19, v39
    v_cmp_eq_u32 vcc, -1, v19
    s_nop 0
    s_cbranch_vccnz g_40F8_3
    v_smfmac_f32_16x16x64_bf16 v[40:43], v[36:39], a[24:31], v172
    v_smfmac_f32_16x16x64_bf16 v[44:47], v[36:39], a[88:95], v172
    v_smfmac_f32_16x16x64_bf16 v[48:51], v[36:39], a[56:63], v172
    v_smfmac_f32_16x16x64_bf16 v[52:55], v[36:39], a[120:127], v172
    s_branch gc_41
g_40L15_1:
    s_waitcnt vmcnt(3)
    v_max3_u32 v19, v28, v29, v30
    v_max_u32 v19, v19, v31
    v_cmp_eq_u32 vcc, -1, v19
    s_nop 0
    s_cbranch_vccnz g_40F15_1
    v_smfmac_f32_16x16x64_bf16 v[40:43], v[28:31], a[8:15], v172
    v_smfmac_f32_16x16x64_bf16 v[44:47], v[28:31], a[72:79], v172
    v_smfmac_f32_16x16x64_bf16 v[48:51], v[28:31], a[40:47], v172
    v_smfmac_f32_16x16x64_bf16 v[52:55], v[28:31], a[104:111], v172
g_40L13_2:
    s_waitcnt vmcnt(2)
    v_max3_u32 v19, v32, v33, v34
    v_max_u32 v19, v19, v35
    v_cmp_eq_u32 vcc, -1, v19
    s_nop 0
    s_cbranch_vccnz g_40F13_2
    v_smfmac_f32_16x16x64_bf16 v[40:43], v[32:35], a[16:23], v172
    v_smfmac_f32_16x16x64_bf16 v[44:47], v[32:35], a[80:87], v172
    v_smfmac_f32_16x16x64_bf16 v[48:51], v[32:35], a[48:55], v172
    v_smfmac_f32_16x16x64_bf16 v[52:55], v[32:35], a[112:119], v172
g_40L9_3:
    s_waitcnt vmcnt(1)
    v_max3_u32 v19, v36, v37, v38
    v_max_u32 v19, v19, v39
    v_cmp_eq_u32 vcc, -1, v19
    s_nop 0
    s_cbranch_vccnz g_40F9_3
    v_smfmac_f32_16x16x64_bf16 v[40:43], v[36:39], a[24:31], v172
    v_smfmac_f32_16x16x64_bf16 v[44:47], v[36:39], a[88:95], v172
    v_smfmac_f32_16x16x64_bf16 v[48:51], v[36:39], a[56:63], v172
    v_smfmac_f32_16x16x64_bf16 v[52:55], v[36:39], a[120:127], v172
g_40L1_0:
    s_waitcnt vmcnt(0)
    v_max3_u32 v19, v24, v25, v26
    v_max_u32 v19, v19, v27
    v_cmp_eq_u32 vcc, -1, v19
    s_nop 0
    s_cbranch_vccnz g_40F1_0
    v_smfmac_f32_16x16x64_bf16 v[40:43], v[24:27], a[0:7], v172
    v_smfmac_f32_16x16x64_bf16 v[44:47], v[24:27], a[64:71], v172
    v_smfmac_f32_16x16x64_bf16 v[48:51], v[24:27], a[32:39], v172
    v_smfmac_f32_16x16x64_bf16 v[52:55], v[24:27], a[96:103], v172
    s_branch gc_41
g_40L15_2:
    s_waitcnt vmcnt(3)
    v_max3_u32 v19, v32, v33, v34
    v_max_u32 v19, v19, v35
    v_cmp_eq_u32 vcc, -1, v19
    s_nop 0
    s_cbranch_vccnz g_40F15_2
    v_smfmac_f32_16x16x64_bf16 v[40:43], v[32:35], a[16:23], v172
    v_smfmac_f32_16x16x64_bf16 v[44:47], v[32:35], a[80:87], v172
    v_smfmac_f32_16x16x64_bf16 v[48:51], v[32:35], a[48:55], v172
    v_smfmac_f32_16x16x64_bf16 v[52:55], v[32:35], a[112:119], v172
g_40L11_3:
    s_waitcnt vmcnt(2)
    v_max3_u32 v19, v36, v37, v38
    v_max_u32 v19, v19, v39
    v_cmp_eq_u32 vcc, -1, v19
    s_nop 0
    s_cbranch_vccnz g_40F11_3
    v_smfmac_f32_16x16x64_bf16 v[40:43], v[36:39], a[24:31], v172
    v_smfmac_f32_16x16x64_bf16 v[44:47], v[36:39], a[88:95], v172
    v_smfmac_f32_16x16x64_bf16 v[48:51], v[36:39], a[56:63], v172
    v_smfmac_f32_16x16x64_bf16 v[52:55], v[36:39], a[120:127], v172
g_40L3_0:
    s_waitcnt vmcnt(1)
    v_max3_u32 v19, v24, v25, v26
    v_max_u32 v19, v19, v27
    v_cmp_eq_u32 vcc, -1, v19
    s_nop 0
    s_cbranch_vccnz g_40F3_0
    v_smfmac_f32_16x16x64_bf16 v[40:43], v[24:27], a[0:7], v172
    v_smfmac_f32_16x16x64_bf16 v[44:47], v[24:27], a[64:71], v172
    v_smfmac_f32_16x16x64_bf16 v[48:51], v[24:27], a[32:39], v172
    v_smfmac_f32_16x16x64_bf16 v[52:55], v[24:27], a[96:103], v172
g_40L2_1:
    s_waitcnt vmcnt(0)
    v_max3_u32 v19, v28, v29, v30
    v_max_u32 v19, v19, v31
    v_cmp_eq_u32 vcc, -1, v19
    s_nop 0
    s_cbranch_vccnz g_40F2_1
    v_smfmac_f32_16x16x64_bf16 v[40:43], v[28:31], a[8:15], v172
    v_smfmac_f32_16x16x64_bf16 v[44:47], v[28:31], a[72:79], v172
    v_smfmac_f32_16x16x64_bf16 v[48:51], v[28:31], a[40:47], v172
    v_smfmac_f32_16x16x64_bf16 v[52:55], v[28:31], a[104:111], v172
    s_branch gc_41
g_40L15_3:
    s_waitcnt vmcnt(3)
    v_max3_u32 v19, v36, v37, v38
    v_max_u32 v19, v19, v39
    v_cmp_eq_u32 vcc, -1, v19
    s_nop 0
    s_cbranch_vccnz g_40F15_3
    v_smfmac_f32_16x16x64_bf16 v[40:43], v[36:39], a[24:31], v172
    v_smfmac_f32_16x16x64_bf16 v[44:47], v[36:39], a[88:95], v172
    v_smfmac_f32_16x16x64_bf16 v[48:51], v[36:39], a[56:63], v172
    v_smfmac_f32_16x16x64_bf16 v[52:55], v[36:39], a[120:127], v172
g_40L7_0:
    s_waitcnt vmcnt(2)
    v_max3_u32 v19, v24, v25, v26
    v_max_u32 v19, v19, v27
    v_cmp_eq_u32 vcc, -1, v19
    s_nop 0
    s_cbranch_vccnz g_40F7_0
    v_smfmac_f32_16x16x64_bf16 v[40:43], v[24:27], a[0:7], v172
    v_smfmac_f32_16x16x64_bf16 v[44:47], v[24:27], a[64:71], v172
    v_smfmac_f32_16x16x64_bf16 v[48:51], v[24:27], a[32:39], v172
    v_smfmac_f32_16x16x64_bf16 v[52:55], v[24:27], a[96:103], v172
g_40L6_1:
    s_waitcnt vmcnt(1)
    v_max3_u32 v19, v28, v29, v30
    v_max_u32 v19, v19, v31
    v_cmp_eq_u32 vcc, -1, v19
    s_nop 0
    s_cbranch_vccnz g_40F6_1
    v_smfmac_f32_16x16x64_bf16 v[40:43], v[28:31], a[8:15], v172
    v_smfmac_f32_16x16x64_bf16 v[44:47], v[28:31], a[72:79], v172
    v_smfmac_f32_16x16x64_bf16 v[48:51], v[28:31], a[40:47], v172
    v_smfmac_f32_16x16x64_bf16 v[52:55], v[28:31], a[104:111], v172
g_40L4_2:
    s_waitcnt vmcnt(0)
    v_max3_u32 v19, v32, v33, v34
    v_max_u32 v19, v19, v35
    v_cmp_eq_u32 vcc, -1, v19
    s_nop 0
    s_cbranch_vccnz g_40F4_2
    v_smfmac_f32_16x16x64_bf16 v[40:43], v[32:35], a[16:23], v172
    v_smfmac_f32_16x16x64_bf16 v[44:47], v[32:35], a[80:87], v172
    v_smfmac_f32_16x16x64_bf16 v[48:51], v[32:35], a[48:55], v172
    v_smfmac_f32_16x16x64_bf16 v[52:55], v[32:35], a[112:119], v172
    s_branch gc_41
g_40L7_1:
    s_waitcnt vmcnt(2)
    v_max3_u32 v19, v28, v29, v30
    v_max_u32 v19, v19, v31
    v_cmp_eq_u32 vcc, -1, v19
    s_nop 0
    s_cbranch_vccnz g_40F7_1
    v_smfmac_f32_16x16x64_bf16 v[40:43], v[28:31], a[8:15], v172
    v_smfmac_f32_16x16x64_bf16 v[44:47], v[28:31], a[72:79], v172
    v_smfmac_f32_16x16x64_bf16 v[48:51], v[28:31], a[40:47], v172
    v_smfmac_f32_16x16x64_bf16 v[52:55], v[28:31], a[104:111], v172
g_40L5_2:
    s_waitcnt vmcnt(1)
    v_max3_u32 v19, v32, v33, v34
    v_max_u32 v19, v19, v35
    v_cmp_eq_u32 vcc, -1, v19
    s_nop 0
    s_cbranch_vccnz g_40F5_2
    v_smfmac_f32_16x16x64_bf16 v[40:43], v[32:35], a[16:23], v172
    v_smfmac_f32_16x16x64_bf16 v[44:47], v[32:35], a[80:87], v172
    v_smfmac_f32_16x16x64_bf16 v[48:51], v[32:35], a[48:55], v172
    v_smfmac_f32_16x16x64_bf16 v[52:55], v[32:35], a[112:119], v172
    s_branch g_40L1_0
g_40L7_2:
    s_waitcnt vmcnt(2)
    v_max3_u32 v19, v32, v33, v34
    v_max_u32 v19, v19, v35
    v_cmp_eq_u32 vcc, -1, v19
    s_nop 0
    s_cbranch_vccnz g_40F7_2
    v_smfmac_f32_16x16x64_bf16 v[40:43], v[32:35], a[16:23], v172
    v_smfmac_f32_16x16x64_bf16 v[44:47], v[32:35], a[80:87], v172
    v_smfmac_f32_16x16x64_bf16 v[48:51], v[32:35], a[48:55], v172
    v_smfmac_f32_16x16x64_bf16 v[52:55], v[32:35], a[112:119], v172
    s_branch g_40L3_0
g_40L11_0:
    s_waitcnt vmcnt(2)
    v_max3_u32 v19, v24, v25, v26
    v_max_u32 v19, v19, v27
    v_cmp_eq_u32 vcc, -1, v19
    s_nop 0
    s_cbranch_vccnz g_40F11_0
    v_smfmac_f32_16x16x64_bf16 v[40:43], v[24:27], a[0:7], v172
    v_smfmac_f32_16x16x64_bf16 v[44:47], v[24:27], a[64:71], v172
    v_smfmac_f32_16x16x64_bf16 v[48:51], v[24:27], a[32:39], v172
    v_smfmac_f32_16x16x64_bf16 v[52:55], v[24:27], a[96:103], v172
g_40L10_1:
    s_waitcnt vmcnt(1)
    v_max3_u32 v19, v28, v29, v30
    v_max_u32 v19, v19, v31
    v_cmp_eq_u32 vcc, -1, v19
    s_nop 0
    s_cbranch_vccnz g_40F10_1
    v_smfmac_f32_16x16x64_bf16 v[40:43], v[28:31], a[8:15], v172
    v_smfmac_f32_16x16x64_bf16 v[44:47], v[28:31], a[72:79], v172
    v_smfmac_f32_16x16x64_bf16 v[48:51], v[28:31], a[40:47], v172
    v_smfmac_f32_16x16x64_bf16 v[52:55], v[28:31], a[104:111], v172
    s_branch g_40L8_3
g_40L11_1:
    s_waitcnt vmcnt(2)
    v_max3_u32 v19, v28, v29, v30
    v_max_u32 v19, v19, v31
    v_cmp_eq_u32 vcc, -1, v19
    s_nop 0
    s_cbranch_vccnz g_40F11_1
    v_smfmac_f32_16x16x64_bf16 v[40:43], v[28:31], a[8:15], v172
    v_smfmac_f32_16x16x64_bf16 v[44:47], v[28:31], a[72:79], v172
    v_smfmac_f32_16x16x64_bf16 v[48:51], v[28:31], a[40:47], v172
    v_smfmac_f32_16x16x64_bf16 v[52:55], v[28:31], a[104:111], v172
    s_branch g_40L9_3
g_40L13_0:
    s_waitcnt vmcnt(2)
    v_max3_u32 v19, v24, v25, v26
    v_max_u32 v19, v19, v27
    v_cmp_eq_u32 vcc, -1, v19
    s_nop 0
    s_cbranch_vccnz g_40F13_0
    v_smfmac_f32_16x16x64_bf16 v[40:43], v[24:27], a[0:7], v172
    v_smfmac_f32_16x16x64_bf16 v[44:47], v[24:27], a[64:71], v172
    v_smfmac_f32_16x16x64_bf16 v[48:51], v[24:27], a[32:39], v172
    v_smfmac_f32_16x16x64_bf16 v[52:55], v[24:27], a[96:103], v172
    s_branch g_40L12_2
g_40L13_3:
    s_waitcnt vmcnt(2)
    v_max3_u32 v19, v36, v37, v38
    v_max_u32 v19, v19, v39
    v_cmp_eq_u32 vcc, -1, v19
    s_nop 0
    s_cbranch_vccnz g_40F13_3
    v_smfmac_f32_16x16x64_bf16 v[40:43], v[36:39], a[24:31], v172
    v_smfmac_f32_16x16x64_bf16 v[44:47], v[36:39], a[88:95], v172
    v_smfmac_f32_16x16x64_bf16 v[48:51], v[36:39], a[56:63], v172
    v_smfmac_f32_16x16x64_bf16 v[52:55], v[36:39], a[120:127], v172
g_40L5_0:
    s_waitcnt vmcnt(1)
    v_max3_u32 v19, v24, v25, v26
    v_max_u32 v19, v19, v27
    v_cmp_eq_u32 vcc, -1, v19
    s_nop 0
    s_cbranch_vccnz g_40F5_0
    v_smfmac_f32_16x16x64_bf16 v[40:43], v[24:27], a[0:7], v172
    v_smfmac_f32_16x16x64_bf16 v[44:47], v[24:27], a[64:71], v172
    v_smfmac_f32_16x16x64_bf16 v[48:51], v[24:27], a[32:39], v172
    v_smfmac_f32_16x16x64_bf16 v[52:55], v[24:27], a[96:103], v172
    s_branch g_40L4_2
g_40L14_2:
    s_waitcnt vmcnt(2)
    v_max3_u32 v19, v32, v33, v34
    v_max_u32 v19, v19, v35
    v_cmp_eq_u32 vcc, -1, v19
    s_nop 0
    s_cbranch_vccnz g_40F14_2
    v_smfmac_f32_16x16x64_bf16 v[40:43], v[32:35], a[16:23], v172
    v_smfmac_f32_16x16x64_bf16 v[44:47], v[32:35], a[80:87], v172
    v_smfmac_f32_16x16x64_bf16 v[48:51], v[32:35], a[48:55], v172
    v_smfmac_f32_16x16x64_bf16 v[52:55], v[32:35], a[112:119], v172
g_40L10_3:
    s_waitcnt vmcnt(1)
    v_max3_u32 v19, v36, v37, v38
    v_max_u32 v19, v19, v39
    v_cmp_eq_u32 vcc, -1, v19
    s_nop 0
    s_cbranch_vccnz g_40F10_3
    v_smfmac_f32_16x16x64_bf16 v[40:43], v[36:39], a[24:31], v172
    v_smfmac_f32_16x16x64_bf16 v[44:47], v[36:39], a[88:95], v172
    v_smfmac_f32_16x16x64_bf16 v[48:51], v[36:39], a[56:63], v172
    v_smfmac_f32_16x16x64_bf16 v[52:55], v[36:39], a[120:127], v172
    s_branch g_40L2_1
g_40L14_3:
    s_waitcnt vmcnt(2)
    v_max3_u32 v19, v36, v37, v38
    v_max_u32 v19, v19, v39
    v_cmp_eq_u32 vcc, -1, v19
    s_nop 0
    s_cbranch_vccnz g_40F14_3
    v_smfmac_f32_16x16x64_bf16 v[40:43], v[36:39], a[24:31], v172
    v_smfmac_f32_16x16x64_bf16 v[44:47], v[36:39], a[88:95], v172
    v_smfmac_f32_16x16x64_bf16 v[48:51], v[36:39], a[56:63], v172
    v_smfmac_f32_16x16x64_bf16 v[52:55], v[36:39], a[120:127], v172
    s_branch g_40L6_1
g_40L3_1:
    s_waitcnt vmcnt(1)
    v_max3_u32 v19, v28, v29, v30
    v_max_u32 v19, v19, v31
    v_cmp_eq_u32 vcc, -1, v19
    s_nop 0
    s_cbranch_vccnz g_40F3_1
    v_smfmac_f32_16x16x64_bf16 v[40:43], v[28:31], a[8:15], v172
    v_smfmac_f32_16x16x64_bf16 v[44:47], v[28:31], a[72:79], v172
    v_smfmac_f32_16x16x64_bf16 v[48:51], v[28:31], a[40:47], v172
    v_smfmac_f32_16x16x64_bf16 v[52:55], v[28:31], a[104:111], v172
    s_branch g_40L1_0
g_40L6_2:
    s_waitcnt vmcnt(1)
    v_max3_u32 v19, v32, v33, v34
    v_max_u32 v19, v19, v35
    v_cmp_eq_u32 vcc, -1, v19
    s_nop 0
    s_cbranch_vccnz g_40F6_2
    v_smfmac_f32_16x16x64_bf16 v[40:43], v[32:35], a[16:23], v172
    v_smfmac_f32_16x16x64_bf16 v[44:47], v[32:35], a[80:87], v172
    v_smfmac_f32_16x16x64_bf16 v[48:51], v[32:35], a[48:55], v172
    v_smfmac_f32_16x16x64_bf16 v[52:55], v[32:35], a[112:119], v172
    s_branch g_40L2_1
g_40L9_0:
    s_waitcnt vmcnt(1)
    v_max3_u32 v19, v24, v25, v26
    v_max_u32 v19, v19, v27
    v_cmp_eq_u32 vcc, -1, v19
    s_nop 0
    s_cbranch_vccnz g_40F9_0
    v_smfmac_f32_16x16x64_bf16 v[40:43], v[24:27], a[0:7], v172
    v_smfmac_f32_16x16x64_bf16 v[44:47], v[24:27], a[64:71], v172
    v_smfmac_f32_16x16x64_bf16 v[48:51], v[24:27], a[32:39], v172
    v_smfmac_f32_16x16x64_bf16 v[52:55], v[24:27], a[96:103], v172
    s_branch g_40L8_3
g_40L12_3:
    s_waitcnt vmcnt(1)
    v_max3_u32 v19, v36, v37, v38
    v_max_u32 v19, v19, v39
    v_cmp_eq_u32 vcc, -1, v19
    s_nop 0
    s_cbranch_vccnz g_40F12_3
    v_smfmac_f32_16x16x64_bf16 v[40:43], v[36:39], a[24:31], v172
    v_smfmac_f32_16x16x64_bf16 v[44:47], v[36:39], a[88:95], v172
    v_smfmac_f32_16x16x64_bf16 v[48:51], v[36:39], a[56:63], v172
    v_smfmac_f32_16x16x64_bf16 v[52:55], v[36:39], a[120:127], v172
    s_branch g_40L4_2
g_40F15_0:
    s_mov_b64 exec, vcc
    buffer_load_dwordx4 v[24:27], v2, s[4:7], s16 offen offset:0 sc1
    s_mov_b64 exec, -1
    s_add_u32 s23, s23, 1
    s_cmp_lt_u32 s23, 200000
    s_cbranch_scc1 g_40L15_1
    s_mov_b32 s25, 200000
    s_branch gc_41
g_40F15_1:
    s_mov_b64 exec, vcc
    buffer_load_dwordx4 v[28:31], v2, s[4:7], s16 offen offset:1024 sc1
    s_mov_b64 exec, -1
    s_add_u32 s23, s23, 1
    s_cmp_lt_u32 s23, 200000
    s_cbranch_scc1 g_40L15_2
    s_mov_b32 s25, 200000
    s_branch gc_41
g_40F15_2:
    s_mov_b64 exec, vcc
    buffer_load_dwordx4 v[32:35], v2, s[4:7], s16 offen offset:2048 sc1
    s_mov_b64 exec, -1
    s_add_u32 s23, s23, 1
    s_cmp_lt_u32 s23, 200000
    s_cbranch_scc1 g_40L15_3
    s_mov_b32 s25, 200000
    s_branch gc_41
g_40F15_3:
    s_mov_b64 exec, vcc
    buffer_load_dwordx4 v[36:39], v2, s[4:7], s16 offen offset:3072 sc1
    s_mov_b64 exec, -1
    s_add_u32 s23, s23, 1
    s_cmp_lt_u32 s23, 200000
    s_cbranch_scc1 g_40L15_0
    s_mov_b32 s25, 200000
    s_branch gc_41
g_40F7_0:
    s_mov_b64 exec, vcc
    buffer_load_dwordx4 v[24:27], v2, s[4:7], s16 offen offset:0 sc1
    s_mov_b64 exec, -1
    s_add_u32 s23, s23, 1
    s_cmp_lt_u32 s23, 200000
    s_cbranch_scc1 g_40L7_1
    s_mov_b32 s25, 200000
    s_branch gc_41
g_40F7_1:
    s_mov_b64 exec, vcc
    buffer_load_dwordx4 v[28:31], v2, s[4:7], s16 offen offset:1024 sc1
    s_mov_b64 exec, -1
    s_add_u32 s23, s23, 1
    s_cmp_lt_u32 s23, 200000
    s_cbranch_scc1 g_40L7_2
    s_mov_b32 s25, 200000
    s_branch gc_41
g_40F7_2:
    s_mov_b64 exec, vcc
    buffer_load_dwordx4 v[32:35], v2, s[4:7], s16 offen offset:2048 sc1
    s_mov_b64 exec, -1
    s_add_u32 s23, s23, 1
    s_cmp_lt_u32 s23, 200000
    s_cbranch_scc1 g_40L7_0
    s_mov_b32 s25, 200000
    s_branch gc_41
g_40F11_0:
    s_mov_b64 exec, vcc
    buffer_load_dwordx4 v[24:27], v2, s[4:7], s16 offen offset:0 sc1
    s_mov_b64 exec, -1
    s_add_u32 s23, s23, 1
    s_cmp_lt_u32 s23, 200000
    s_cbranch_scc1 g_40L11_1
    s_mov_b32 s25, 200000
    s_branch gc_41
g_40F11_1:
    s_mov_b64 exec, vcc
    buffer_load_dwordx4 v[28:31], v2, s[4:7], s16 offen offset:1024 sc1
    s_mov_b64 exec, -1
    s_add_u32 s23, s23, 1
    s_cmp_lt_u32 s23, 200000
    s_cbranch_scc1 g_40L11_3
    s_mov_b32 s25, 200000
    s_branch gc_41
g_40F11_3:
    s_mov_b64 exec, vcc
    buffer_load_dwordx4 v[36:39], v2, s[4:7], s16 offen offset:3072 sc1
    s_mov_b64 exec, -1
    s_add_u32 s23, s23, 1
    s_cmp_lt_u32 s23, 200000
    s_cbranch_scc1 g_40L11_0
    s_mov_b32 s25, 200000
    s_branch gc_41
g_40F13_0:
    s_mov_b64 exec, vcc
    buffer_load_dwordx4 v[24:27], v2, s[4:7], s16 offen offset:0 sc1
    s_mov_b64 exec, -1
    s_add_u32 s23, s23, 1
    s_cmp_lt_u32 s23, 200000
    s_cbranch_scc1 g_40L13_2
    s_mov_b32 s25, 200000
    s_branch gc_41
g_40F13_2:
    s_mov_b64 exec, vcc
    buffer_load_dwordx4 v[32:35], v2, s[4:7], s16 offen offset:2048 sc1
    s_mov_b64 exec, -1
    s_add_u32 s23, s23, 1
    s_cmp_lt_u32 s23, 200000
    s_cbranch_scc1 g_40L13_3
    s_mov_b32 s25, 200000
    s_branch gc_41
g_40F13_3:
    s_mov_b64 exec, vcc
    buffer_load_dwordx4 v[36:39], v2, s[4:7], s16 offen offset:3072 sc1
    s_mov_b64 exec, -1
    s_add_u32 s23, s23, 1
    s_cmp_lt_u32 s23, 200000
    s_cbranch_scc1 g_40L13_0
    s_mov_b32 s25, 200000
    s_branch gc_41
g_40F14_1:
    s_mov_b64 exec, vcc
    buffer_load_dwordx4 v[28:31], v2, s[4:7], s16 offen offset:1024 sc1
    s_mov_b64 exec, -1
    s_add_u32 s23, s23, 1
    s_cmp_lt_u32 s23, 200000
    s_cbranch_scc1 g_40L14_2
    s_mov_b32 s25, 200000
    s_branch gc_41
g_40F14_2:
    s_mov_b64 exec, vcc
    buffer_load_dwordx4 v[32:35], v2, s[4:7], s16 offen offset:2048 sc1
    s_mov_b64 exec, -1
    s_add_u32 s23, s23, 1
    s_cmp_lt_u32 s23, 200000
    s_cbranch_scc1 g_40L14_3
    s_mov_b32 s25, 200000
    s_branch gc_41
g_40F14_3:
    s_mov_b64 exec, vcc
    buffer_load_dwordx4 v[36:39], v2, s[4:7], s16 offen offset:3072 sc1
    s_mov_b64 exec, -1
    s_add_u32 s23, s23, 1
    s_cmp_lt_u32 s23, 200000
    s_cbranch_scc1 g_40L14_1
    s_mov_b32 s25, 200000
    s_branch gc_41
g_40F3_0:
    s_mov_b64 exec, vcc
    buffer_load_dwordx4 v[24:27], v2, s[4:7], s16 offen offset:0 sc1
    s_mov_b64 exec, -1
    s_add_u32 s23, s23, 1
    s_cmp_lt_u32 s23, 200000
    s_cbranch_scc1 g_40L3_1
    s_mov_b32 s25, 200000
    s_branch gc_41
g_40F3_1:
    s_mov_b64 exec, vcc
    buffer_load_dwordx4 v[28:31], v2, s[4:7], s16 offen offset:1024 sc1
    s_mov_b64 exec, -1
    s_add_u32 s23, s23, 1
    s_cmp_lt_u32 s23, 200000
    s_cbranch_scc1 g_40L3_0
    s_mov_b32 s25, 200000
    s_branch gc_41
g_40F5_0:
    s_mov_b64 exec, vcc
    buffer_load_dwordx4 v[24:27], v2, s[4:7], s16 offen offset:0 sc1
    s_mov_b64 exec, -1
    s_add_u32 s23, s23, 1
    s_cmp_lt_u32 s23, 200000
    s_cbranch_scc1 g_40L5_2
    s_mov_b32 s25, 200000
    s_branch gc_41
g_40F5_2:
    s_mov_b64 exec, vcc
    buffer_load_dwordx4 v[32:35], v2, s[4:7], s16 offen offset:2048 sc1
    s_mov_b64 exec, -1
    s_add_u32 s23, s23, 1
    s_cmp_lt_u32 s23, 200000
    s_cbranch_scc1 g_40L5_0
    s_mov_b32 s25, 200000
    s_branch gc_41
g_40F6_1:
    s_mov_b64 exec, vcc
    buffer_load_dwordx4 v[28:31], v2, s[4:7], s16 offen offset:1024 sc1
    s_mov_b64 exec, -1
    s_add_u32 s23, s23, 1
    s_cmp_lt_u32 s23, 200000
    s_cbranch_scc1 g_40L6_2
    s_mov_b32 s25, 200000
    s_branch gc_41
g_40F6_2:
    s_mov_b64 exec, vcc
    buffer_load_dwordx4 v[32:35], v2, s[4:7], s16 offen offset:2048 sc1
    s_mov_b64 exec, -1
    s_add_u32 s23, s23, 1
    s_cmp_lt_u32 s23, 200000
    s_cbranch_scc1 g_40L6_1
    s_mov_b32 s25, 200000
    s_branch gc_41
g_40F9_0:
    s_mov_b64 exec, vcc
    buffer_load_dwordx4 v[24:27], v2, s[4:7], s16 offen offset:0 sc1
    s_mov_b64 exec, -1
    s_add_u32 s23, s23, 1
    s_cmp_lt_u32 s23, 200000
    s_cbranch_scc1 g_40L9_3
    s_mov_b32 s25, 200000
    s_branch gc_41
g_40F9_3:
    s_mov_b64 exec, vcc
    buffer_load_dwordx4 v[36:39], v2, s[4:7], s16 offen offset:3072 sc1
    s_mov_b64 exec, -1
    s_add_u32 s23, s23, 1
    s_cmp_lt_u32 s23, 200000
    s_cbranch_scc1 g_40L9_0
    s_mov_b32 s25, 200000
    s_branch gc_41
g_40F10_1:
    s_mov_b64 exec, vcc
    buffer_load_dwordx4 v[28:31], v2, s[4:7], s16 offen offset:1024 sc1
    s_mov_b64 exec, -1
    s_add_u32 s23, s23, 1
    s_cmp_lt_u32 s23, 200000
    s_cbranch_scc1 g_40L10_3
    s_mov_b32 s25, 200000
    s_branch gc_41
g_40F10_3:
    s_mov_b64 exec, vcc
    buffer_load_dwordx4 v[36:39], v2, s[4:7], s16 offen offset:3072 sc1
    s_mov_b64 exec, -1
    s_add_u32 s23, s23, 1
    s_cmp_lt_u32 s23, 200000
    s_cbranch_scc1 g_40L10_1
    s_mov_b32 s25, 200000
    s_branch gc_41
g_40F12_2:
    s_mov_b64 exec, vcc
    buffer_load_dwordx4 v[32:35], v2, s[4:7], s16 offen offset:2048 sc1
    s_mov_b64 exec, -1
    s_add_u32 s23, s23, 1
    s_cmp_lt_u32 s23, 200000
    s_cbranch_scc1 g_40L12_3
    s_mov_b32 s25, 200000
    s_branch gc_41
g_40F12_3:
    s_mov_b64 exec, vcc
    buffer_load_dwordx4 v[36:39], v2, s[4:7], s16 offen offset:3072 sc1
    s_mov_b64 exec, -1
    s_add_u32 s23, s23, 1
    s_cmp_lt_u32 s23, 200000
    s_cbranch_scc1 g_40L12_2
    s_mov_b32 s25, 200000
    s_branch gc_41
g_40F1_0:
    s_mov_b64 exec, vcc
    buffer_load_dwordx4 v[24:27], v2, s[4:7], s16 offen offset:0 sc1
    s_mov_b64 exec, -1
    s_add_u32 s23, s23, 1
    s_cmp_lt_u32 s23, 200000
    s_cbranch_scc1 g_40L1_0
    s_mov_b32 s25, 200000
    s_branch gc_41
g_40F2_1:
    s_mov_b64 exec, vcc
    buffer_load_dwordx4 v[28:31], v2, s[4:7], s16 offen offset:1024 sc1
    s_mov_b64 exec, -1
    s_add_u32 s23, s23, 1
    s_cmp_lt_u32 s23, 200000
    s_cbranch_scc1 g_40L2_1
    s_mov_b32 s25, 200000
    s_branch gc_41
g_40F4_2:
    s_mov_b64 exec, vcc
    buffer_load_dwordx4 v[32:35], v2, s[4:7], s16 offen offset:2048 sc1
    s_mov_b64 exec, -1
    s_add_u32 s23, s23, 1
    s_cmp_lt_u32 s23, 200000
    s_cbranch_scc1 g_40L4_2
    s_mov_b32 s25, 200000
    s_branch gc_41
g_40F8_3:
    s_mov_b64 exec, vcc
    buffer_load_dwordx4 v[36:39], v2, s[4:7], s16 offen offset:3072 sc1
    s_mov_b64 exec, -1
    s_add_u32 s23, s23, 1
    s_cmp_lt_u32 s23, 200000
    s_cbranch_scc1 g_40L8_3
    s_mov_b32 s25, 200000
    s_branch gc_41
recur_fast_last2:
    buffer_store_dwordx4 v[168:171], v15, s[4:7], s20 offen sc1
    s_waitcnt vmcnt(0)
    s_branch recur_end
g_42L15_0:
    s_waitcnt vmcnt(3)
    v_max3_u32 v19, v24, v25, v26
    v_max_u32 v19, v19, v27
    v_cmp_eq_u32 vcc, -1, v19
    s_nop 0
    s_cbranch_vccnz g_42F15_0
    v_smfmac_f32_16x16x64_bf16 v[64:67], v[24:27], a[192:199], v172
    v_smfmac_f32_16x16x64_bf16 v[68:71], v[24:27], a[224:231], v172
g_42L14_1:
    s_waitcnt vmcnt(2)
    v_max3_u32 v19, v28, v29, v30
    v_max_u32 v19, v19, v31
    v_cmp_eq_u32 vcc, -1, v19
    s_nop 0
    s_cbranch_vccnz g_42F14_1
    v_smfmac_f32_16x16x64_bf16 v[64:67], v[28:31], a[200:207], v172
    v_smfmac_f32_16x16x64_bf16 v[68:71], v[28:31], a[232:239], v172
g_42L12_2:
    s_waitcnt vmcnt(1)
    v_max3_u32 v19, v32, v33, v34
    v_max_u32 v19, v19, v35
    v_cmp_eq_u32 vcc, -1, v19
    s_nop 0
    s_cbranch_vccnz g_42F12_2
    v_smfmac_f32_16x16x64_bf16 v[64:67], v[32:35], a[208:215], v172
    v_smfmac_f32_16x16x64_bf16 v[68:71], v[32:35], a[240:247], v172
g_42L8_3:
    s_waitcnt vmcnt(0)
    v_max3_u32 v19, v36, v37, v38
    v_max_u32 v19, v19, v39
    v_cmp_eq_u32 vcc, -1, v19
    s_nop 0
    s_cbranch_vccnz g_42F8_3
    v_smfmac_f32_16x16x64_bf16 v[64:67], v[36:39], a[216:223], v172
    v_smfmac_f32_16x16x64_bf16 v[68:71], v[36:39], a[248:255], v172
    s_nop 4
    v_cvt_pk_bf16_f32 v80, v64, v65
    v_cvt_pk_bf16_f32 v81, v66, v67
    s_nop 0
    v_cvt_pk_bf16_f32 v82, v68, v69
    v_cvt_pk_bf16_f32 v83, v70, v71
    ds_write_b128 v17, v[80:83] offset:9216
    s_branch gc_43
g_42L15_1:
    s_waitcnt vmcnt(3)
    v_max3_u32 v19, v28, v29, v30
    v_max_u32 v19, v19, v31
    v_cmp_eq_u32 vcc, -1, v19
    s_nop 0
    s_cbranch_vccnz g_42F15_1
    v_smfmac_f32_16x16x64_bf16 v[64:67], v[28:31], a[200:207], v172
    v_smfmac_f32_16x16x64_bf16 v[68:71], v[28:31], a[232:239], v172
g_42L13_2:
    s_waitcnt vmcnt(2)
    v_max3_u32 v19, v32, v33, v34
    v_max_u32 v19, v19, v35
    v_cmp_eq_u32 vcc, -1, v19
    s_nop 0
    s_cbranch_vccnz g_42F13_2
    v_smfmac_f32_16x16x64_bf16 v[64:67], v[32:35], a[208:215], v172
    v_smfmac_f32_16x16x64_bf16 v[68:71], v[32:35], a[240:247], v172
g_42L9_3:
    s_waitcnt vmcnt(1)
    v_max3_u32 v19, v36, v37, v38
    v_max_u32 v19, v19, v39
    v_cmp_eq_u32 vcc, -1, v19
    s_nop 0
    s_cbranch_vccnz g_42F9_3
    v_smfmac_f32_16x16x64_bf16 v[64:67], v[36:39], a[216:223], v172
    v_smfmac_f32_16x16x64_bf16 v[68:71], v[36:39], a[248:255], v172
g_42L1_0:
    s_waitcnt vmcnt(0)
    v_max3_u32 v19, v24, v25, v26
    v_max_u32 v19, v19, v27
    v_cmp_eq_u32 vcc, -1, v19
    s_nop 0
    s_cbranch_vccnz g_42F1_0
    v_smfmac_f32_16x16x64_bf16 v[64:67], v[24:27], a[192:199], v172
    v_smfmac_f32_16x16x64_bf16 v[68:71], v[24:27], a[224:231], v172
    s_nop 4
    v_cvt_pk_bf16_f32 v80, v64, v65
    v_cvt_pk_bf16_f32 v81, v66, v67
    s_nop 0
    v_cvt_pk_bf16_f32 v82, v68, v69
    v_cvt_pk_bf16_f32 v83, v70, v71
    ds_write_b128 v17, v[80:83] offset:9216
    s_branch gc_43
g_42L15_2:
    s_waitcnt vmcnt(3)
    v_max3_u32 v19, v32, v33, v34
    v_max_u32 v19, v19, v35
    v_cmp_eq_u32 vcc, -1, v19
    s_nop 0
    s_cbranch_vccnz g_42F15_2
    v_smfmac_f32_16x16x64_bf16 v[64:67], v[32:35], a[208:215], v172
    v_smfmac_f32_16x16x64_bf16 v[68:71], v[32:35], a[240:247], v172
g_42L11_3:
    s_waitcnt vmcnt(2)
    v_max3_u32 v19, v36, v37, v38
    v_max_u32 v19, v19, v39
    v_cmp_eq_u32 vcc, -1, v19
    s_nop 0
    s_cbranch_vccnz g_42F11_3
    v_smfmac_f32_16x16x64_bf16 v[64:67], v[36:39], a[216:223], v172
    v_smfmac_f32_16x16x64_bf16 v[68:71], v[36:39], a[248:255], v172
g_42L3_0:
    s_waitcnt vmcnt(1)
    v_max3_u32 v19, v24, v25, v26
    v_max_u32 v19, v19, v27
    v_cmp_eq_u32 vcc, -1, v19
    s_nop 0
    s_cbranch_vccnz g_42F3_0
    v_smfmac_f32_16x16x64_bf16 v[64:67], v[24:27], a[192:199], v172
    v_smfmac_f32_16x16x64_bf16 v[68:71], v[24:27], a[224:231], v172
g_42L2_1:
    s_waitcnt vmcnt(0)
    v_max3_u32 v19, v28, v29, v30
    v_max_u32 v19, v19, v31
    v_cmp_eq_u32 vcc, -1, v19
    s_nop 0
    s_cbranch_vccnz g_42F2_1
    v_smfmac_f32_16x16x64_bf16 v[64:67], v[28:31], a[200:207], v172
    v_smfmac_f32_16x16x64_bf16 v[68:71], v[28:31], a[232:239], v172
    s_nop 4
    v_cvt_pk_bf16_f32 v80, v64, v65
    v_cvt_pk_bf16_f32 v81, v66, v67
    s_nop 0
    v_cvt_pk_bf16_f32 v82, v68, v69
    v_cvt_pk_bf16_f32 v83, v70, v71
    ds_write_b128 v17, v[80:83] offset:9216
    s_branch gc_43
g_42L15_3:
    s_waitcnt vmcnt(3)
    v_max3_u32 v19, v36, v37, v38
    v_max_u32 v19, v19, v39
    v_cmp_eq_u32 vcc, -1, v19
    s_nop 0
    s_cbranch_vccnz g_42F15_3
    v_smfmac_f32_16x16x64_bf16 v[64:67], v[36:39], a[216:223], v172
    v_smfmac_f32_16x16x64_bf16 v[68:71], v[36:39], a[248:255], v172
g_42L7_0:
    s_waitcnt vmcnt(2)
    v_max3_u32 v19, v24, v25, v26
    v_max_u32 v19, v19, v27
    v_cmp_eq_u32 vcc, -1, v19
    s_nop 0
    s_cbranch_vccnz g_42F7_0
    v_smfmac_f32_16x16x64_bf16 v[64:67], v[24:27], a[192:199], v172
    v_smfmac_f32_16x16x64_bf16 v[68:71], v[24:27], a[224:231], v172
g_42L6_1:
    s_waitcnt vmcnt(1)
    v_max3_u32 v19, v28, v29, v30
    v_max_u32 v19, v19, v31
    v_cmp_eq_u32 vcc, -1, v19
    s_nop 0
    s_cbranch_vccnz g_42F6_1
    v_smfmac_f32_16x16x64_bf16 v[64:67], v[28:31], a[200:207], v172
    v_smfmac_f32_16x16x64_bf16 v[68:71], v[28:31], a[232:239], v172
g_42L4_2:
    s_waitcnt vmcnt(0)
    v_max3_u32 v19, v32, v33, v34
    v_max_u32 v19, v19, v35
    v_cmp_eq_u32 vcc, -1, v19
    s_nop 0
    s_cbranch_vccnz g_42F4_2
    v_smfmac_f32_16x16x64_bf16 v[64:67], v[32:35], a[208:215], v172
    v_smfmac_f32_16x16x64_bf16 v[68:71], v[32:35], a[240:247], v172
    s_nop 4
    v_cvt_pk_bf16_f32 v80, v64, v65
    v_cvt_pk_bf16_f32 v81, v66, v67
    s_nop 0
    v_cvt_pk_bf16_f32 v82, v68, v69
    v_cvt_pk_bf16_f32 v83, v70, v71
    ds_write_b128 v17, v[80:83] offset:9216
    s_branch gc_43
g_42L7_1:
    s_waitcnt vmcnt(2)
    v_max3_u32 v19, v28, v29, v30
    v_max_u32 v19, v19, v31
    v_cmp_eq_u32 vcc, -1, v19
    s_nop 0
    s_cbranch_vccnz g_42F7_1
    v_smfmac_f32_16x16x64_bf16 v[64:67], v[28:31], a[200:207], v172
    v_smfmac_f32_16x16x64_bf16 v[68:71], v[28:31], a[232:239], v172
g_42L5_2:
    s_waitcnt vmcnt(1)
    v_max3_u32 v19, v32, v33, v34
    v_max_u32 v19, v19, v35
    v_cmp_eq_u32 vcc, -1, v19
    s_nop 0
    s_cbranch_vccnz g_42F5_2
    v_smfmac_f32_16x16x64_bf16 v[64:67], v[32:35], a[208:215], v172
    v_smfmac_f32_16x16x64_bf16 v[68:71], v[32:35], a[240:247], v172
    s_branch g_42L1_0
g_42L7_2:
    s_waitcnt vmcnt(2)
    v_max3_u32 v19, v32, v33, v34
    v_max_u32 v19, v19, v35
    v_cmp_eq_u32 vcc, -1, v19
    s_nop 0
    s_cbranch_vccnz g_42F7_2
    v_smfmac_f32_16x16x64_bf16 v[64:67], v[32:35], a[208:215], v172
    v_smfmac_f32_16x16x64_bf16 v[68:71], v[32:35], a[240:247], v172
    s_branch g_42L3_0
g_42L11_0:
    s_waitcnt vmcnt(2)
    v_max3_u32 v19, v24, v25, v26
    v_max_u32 v19, v19, v27
    v_cmp_eq_u32 vcc, -1, v19
    s_nop 0
    s_cbranch_vccnz g_42F11_0
    v_smfmac_f32_16x16x64_bf16 v[64:67], v[24:27], a[192:199], v172
    v_smfmac_f32_16x16x64_bf16 v[68:71], v[24:27], a[224:231], v172
g_42L10_1:
    s_waitcnt vmcnt(1)
    v_max3_u32 v19, v28, v29, v30
    v_max_u32 v19, v19, v31
    v_cmp_eq_u32 vcc, -1, v19
    s_nop 0
    s_cbranch_vccnz g_42F10_1
    v_smfmac_f32_16x16x64_bf16 v[64:67], v[28:31], a[200:207], v172
    v_smfmac_f32_16x16x64_bf16 v[68:71], v[28:31], a[232:239], v172
    s_branch g_42L8_3
g_42L11_1:
    s_waitcnt vmcnt(2)
    v_max3_u32 v19, v28, v29, v30
    v_max_u32 v19, v19, v31
    v_cmp_eq_u32 vcc, -1, v19
    s_nop 0
    s_cbranch_vccnz g_42F11_1
    v_smfmac_f32_16x16x64_bf16 v[64:67], v[28:31], a[200:207], v172
    v_smfmac_f32_16x16x64_bf16 v[68:71], v[28:31], a[232:239], v172
    s_branch g_42L9_3
g_42L13_0:
    s_waitcnt vmcnt(2)
    v_max3_u32 v19, v24, v25, v26
    v_max_u32 v19, v19, v27
    v_cmp_eq_u32 vcc, -1, v19
    s_nop 0
    s_cbranch_vccnz g_42F13_0
    v_smfmac_f32_16x16x64_bf16 v[64:67], v[24:27], a[192:199], v172
    v_smfmac_f32_16x16x64_bf16 v[68:71], v[24:27], a[224:231], v172
    s_branch g_42L12_2
g_42L13_3:
    s_waitcnt vmcnt(2)
    v_max3_u32 v19, v36, v37, v38
    v_max_u32 v19, v19, v39
    v_cmp_eq_u32 vcc, -1, v19
    s_nop 0
    s_cbranch_vccnz g_42F13_3
    v_smfmac_f32_16x16x64_bf16 v[64:67], v[36:39], a[216:223], v172
    v_smfmac_f32_16x16x64_bf16 v[68:71], v[36:39], a[248:255], v172
g_42L5_0:
    s_waitcnt vmcnt(1)
    v_max3_u32 v19, v24, v25, v26
    v_max_u32 v19, v19, v27
    v_cmp_eq_u32 vcc, -1, v19
    s_nop 0
    s_cbranch_vccnz g_42F5_0
    v_smfmac_f32_16x16x64_bf16 v[64:67], v[24:27], a[192:199], v172
    v_smfmac_f32_16x16x64_bf16 v[68:71], v[24:27], a[224:231], v172
    s_branch g_42L4_2
g_42L14_2:
    s_waitcnt vmcnt(2)
    v_max3_u32 v19, v32, v33, v34
    v_max_u32 v19, v19, v35
    v_cmp_eq_u32 vcc, -1, v19
    s_nop 0
    s_cbranch_vccnz g_42F14_2
    v_smfmac_f32_16x16x64_bf16 v[64:67], v[32:35], a[208:215], v172
    v_smfmac_f32_16x16x64_bf16 v[68:71], v[32:35], a[240:247], v172
g_42L10_3:
    s_waitcnt vmcnt(1)
    v_max3_u32 v19, v36, v37, v38
    v_max_u32 v19, v19, v39
    v_cmp_eq_u32 vcc, -1, v19
    s_nop 0
    s_cbranch_vccnz g_42F10_3
    v_smfmac_f32_16x16x64_bf16 v[64:67], v[36:39], a[216:223], v172
    v_smfmac_f32_16x16x64_bf16 v[68:71], v[36:39], a[248:255], v172
    s_branch g_42L2_1
g_42L14_3:
    s_waitcnt vmcnt(2)
    v_max3_u32 v19, v36, v37, v38
    v_max_u32 v19, v19, v39
    v_cmp_eq_u32 vcc, -1, v19
    s_nop 0
    s_cbranch_vccnz g_42F14_3
    v_smfmac_f32_16x16x64_bf16 v[64:67], v[36:39], a[216:223], v172
    v_smfmac_f32_16x16x64_bf16 v[68:71], v[36:39], a[248:255], v172
    s_branch g_42L6_1
g_42L3_1:
    s_waitcnt vmcnt(1)
    v_max3_u32 v19, v28, v29, v30
    v_max_u32 v19, v19, v31
    v_cmp_eq_u32 vcc, -1, v19
    s_nop 0
    s_cbranch_vccnz g_42F3_1
    v_smfmac_f32_16x16x64_bf16 v[64:67], v[28:31], a[200:207], v172
    v_smfmac_f32_16x16x64_bf16 v[68:71], v[28:31], a[232:239], v172
    s_branch g_42L1_0
g_42L6_2:
    s_waitcnt vmcnt(1)
    v_max3_u32 v19, v32, v33, v34
    v_max_u32 v19, v19, v35
    v_cmp_eq_u32 vcc, -1, v19
    s_nop 0
    s_cbranch_vccnz g_42F6_2
    v_smfmac_f32_16x16x64_bf16 v[64:67], v[32:35], a[208:215], v172
    v_smfmac_f32_16x16x64_bf16 v[68:71], v[32:35], a[240:247], v172
    s_branch g_42L2_1
g_42L9_0:
    s_waitcnt vmcnt(1)
    v_max3_u32 v19, v24, v25, v26
    v_max_u32 v19, v19, v27
    v_cmp_eq_u32 vcc, -1, v19
    s_nop 0
    s_cbranch_vccnz g_42F9_0
    v_smfmac_f32_16x16x64_bf16 v[64:67], v[24:27], a[192:199], v172
    v_smfmac_f32_16x16x64_bf16 v[68:71], v[24:27], a[224:231], v172
    s_branch g_42L8_3
g_42L12_3:
    s_waitcnt vmcnt(1)
    v_max3_u32 v19, v36, v37, v38
    v_max_u32 v19, v19, v39
    v_cmp_eq_u32 vcc, -1, v19
    s_nop 0
    s_cbranch_vccnz g_42F12_3
    v_smfmac_f32_16x16x64_bf16 v[64:67], v[36:39], a[216:223], v172
    v_smfmac_f32_16x16x64_bf16 v[68:71], v[36:39], a[248:255], v172
    s_branch g_42L4_2
g_42F15_0:
    s_mov_b64 exec, vcc
    buffer_load_dwordx4 v[24:27], v8, s[4:7], s16 offen offset:0 sc1
    s_mov_b64 exec, -1
    s_add_u32 s23, s23, 1
    s_cmp_lt_u32 s23, 200000
    s_cbranch_scc1 g_42L15_1
    s_mov_b32 s25, 200000
    s_branch gc_43
g_42F15_1:
    s_mov_b64 exec, vcc
    buffer_load_dwordx4 v[28:31], v8, s[4:7], s16 offen offset:1024 sc1
    s_mov_b64 exec, -1
    s_add_u32 s23, s23, 1
    s_cmp_lt_u32 s23, 200000
    s_cbranch_scc1 g_42L15_2
    s_mov_b32 s25, 200000
    s_branch gc_43
g_42F15_2:
    s_mov_b64 exec, vcc
    buffer_load_dwordx4 v[32:35], v8, s[4:7], s16 offen offset:2048 sc1
    s_mov_b64 exec, -1
    s_add_u32 s23, s23, 1
    s_cmp_lt_u32 s23, 200000
    s_cbranch_scc1 g_42L15_3
    s_mov_b32 s25, 200000
    s_branch gc_43
g_42F15_3:
    s_mov_b64 exec, vcc
    buffer_load_dwordx4 v[36:39], v8, s[4:7], s16 offen offset:3072 sc1
    s_mov_b64 exec, -1
    s_add_u32 s23, s23, 1
    s_cmp_lt_u32 s23, 200000
    s_cbranch_scc1 g_42L15_0
    s_mov_b32 s25, 200000
    s_branch gc_43
g_42F7_0:
    s_mov_b64 exec, vcc
    buffer_load_dwordx4 v[24:27], v8, s[4:7], s16 offen offset:0 sc1
    s_mov_b64 exec, -1
    s_add_u32 s23, s23, 1
    s_cmp_lt_u32 s23, 200000
    s_cbranch_scc1 g_42L7_1
    s_mov_b32 s25, 200000
    s_branch gc_43
g_42F7_1:
    s_mov_b64 exec, vcc
    buffer_load_dwordx4 v[28:31], v8, s[4:7], s16 offen offset:1024 sc1
    s_mov_b64 exec, -1
    s_add_u32 s23, s23, 1
    s_cmp_lt_u32 s23, 200000
    s_cbranch_scc1 g_42L7_2
    s_mov_b32 s25, 200000
    s_branch gc_43
g_42F7_2:
    s_mov_b64 exec, vcc
    buffer_load_dwordx4 v[32:35], v8, s[4:7], s16 offen offset:2048 sc1
    s_mov_b64 exec, -1
    s_add_u32 s23, s23, 1
    s_cmp_lt_u32 s23, 200000
    s_cbranch_scc1 g_42L7_0
    s_mov_b32 s25, 200000
    s_branch gc_43
g_42F11_0:
    s_mov_b64 exec, vcc
    buffer_load_dwordx4 v[24:27], v8, s[4:7], s16 offen offset:0 sc1
    s_mov_b64 exec, -1
    s_add_u32 s23, s23, 1
    s_cmp_lt_u32 s23, 200000
    s_cbranch_scc1 g_42L11_1
    s_mov_b32 s25, 200000
    s_branch gc_43
g_42F11_1:
    s_mov_b64 exec, vcc
    buffer_load_dwordx4 v[28:31], v8, s[4:7], s16 offen offset:1024 sc1
    s_mov_b64 exec, -1
    s_add_u32 s23, s23, 1
    s_cmp_lt_u32 s23, 200000
    s_cbranch_scc1 g_42L11_3
    s_mov_b32 s25, 200000
    s_branch gc_43
g_42F11_3:
    s_mov_b64 exec, vcc
    buffer_load_dwordx4 v[36:39], v8, s[4:7], s16 offen offset:3072 sc1
    s_mov_b64 exec, -1
    s_add_u32 s23, s23, 1
    s_cmp_lt_u32 s23, 200000
    s_cbranch_scc1 g_42L11_0
    s_mov_b32 s25, 200000
    s_branch gc_43
g_42F13_0:
    s_mov_b64 exec, vcc
    buffer_load_dwordx4 v[24:27], v8, s[4:7], s16 offen offset:0 sc1
    s_mov_b64 exec, -1
    s_add_u32 s23, s23, 1
    s_cmp_lt_u32 s23, 200000
    s_cbranch_scc1 g_42L13_2
    s_mov_b32 s25, 200000
    s_branch gc_43
g_42F13_2:
    s_mov_b64 exec, vcc
    buffer_load_dwordx4 v[32:35], v8, s[4:7], s16 offen offset:2048 sc1
    s_mov_b64 exec, -1
    s_add_u32 s23, s23, 1
    s_cmp_lt_u32 s23, 200000
    s_cbranch_scc1 g_42L13_3
    s_mov_b32 s25, 200000
    s_branch gc_43
g_42F13_3:
    s_mov_b64 exec, vcc
    buffer_load_dwordx4 v[36:39], v8, s[4:7], s16 offen offset:3072 sc1
    s_mov_b64 exec, -1
    s_add_u32 s23, s23, 1
    s_cmp_lt_u32 s23, 200000
    s_cbranch_scc1 g_42L13_0
    s_mov_b32 s25, 200000
    s_branch gc_43
g_42F14_1:
    s_mov_b64 exec, vcc
    buffer_load_dwordx4 v[28:31], v8, s[4:7], s16 offen offset:1024 sc1
    s_mov_b64 exec, -1
    s_add_u32 s23, s23, 1
    s_cmp_lt_u32 s23, 200000
    s_cbranch_scc1 g_42L14_2
    s_mov_b32 s25, 200000
    s_branch gc_43
g_42F14_2:
    s_mov_b64 exec, vcc
    buffer_load_dwordx4 v[32:35], v8, s[4:7], s16 offen offset:2048 sc1
    s_mov_b64 exec, -1
    s_add_u32 s23, s23, 1
    s_cmp_lt_u32 s23, 200000
    s_cbranch_scc1 g_42L14_3
    s_mov_b32 s25, 200000
    s_branch gc_43
g_42F14_3:
    s_mov_b64 exec, vcc
    buffer_load_dwordx4 v[36:39], v8, s[4:7], s16 offen offset:3072 sc1
    s_mov_b64 exec, -1
    s_add_u32 s23, s23, 1
    s_cmp_lt_u32 s23, 200000
    s_cbranch_scc1 g_42L14_1
    s_mov_b32 s25, 200000
    s_branch gc_43
g_42F3_0:
    s_mov_b64 exec, vcc
    buffer_load_dwordx4 v[24:27], v8, s[4:7], s16 offen offset:0 sc1
    s_mov_b64 exec, -1
    s_add_u32 s23, s23, 1
    s_cmp_lt_u32 s23, 200000
    s_cbranch_scc1 g_42L3_1
    s_mov_b32 s25, 200000
    s_branch gc_43
g_42F3_1:
    s_mov_b64 exec, vcc
    buffer_load_dwordx4 v[28:31], v8, s[4:7], s16 offen offset:1024 sc1
    s_mov_b64 exec, -1
    s_add_u32 s23, s23, 1
    s_cmp_lt_u32 s23, 200000
    s_cbranch_scc1 g_42L3_0
    s_mov_b32 s25, 200000
    s_branch gc_43
g_42F5_0:
    s_mov_b64 exec, vcc
    buffer_load_dwordx4 v[24:27], v8, s[4:7], s16 offen offset:0 sc1
    s_mov_b64 exec, -1
    s_add_u32 s23, s23, 1
    s_cmp_lt_u32 s23, 200000
    s_cbranch_scc1 g_42L5_2
    s_mov_b32 s25, 200000
    s_branch gc_43
g_42F5_2:
    s_mov_b64 exec, vcc
    buffer_load_dwordx4 v[32:35], v8, s[4:7], s16 offen offset:2048 sc1
    s_mov_b64 exec, -1
    s_add_u32 s23, s23, 1
    s_cmp_lt_u32 s23, 200000
    s_cbranch_scc1 g_42L5_0
    s_mov_b32 s25, 200000
    s_branch gc_43
g_42F6_1:
    s_mov_b64 exec, vcc
    buffer_load_dwordx4 v[28:31], v8, s[4:7], s16 offen offset:1024 sc1
    s_mov_b64 exec, -1
    s_add_u32 s23, s23, 1
    s_cmp_lt_u32 s23, 200000
    s_cbranch_scc1 g_42L6_2
    s_mov_b32 s25, 200000
    s_branch gc_43
g_42F6_2:
    s_mov_b64 exec, vcc
    buffer_load_dwordx4 v[32:35], v8, s[4:7], s16 offen offset:2048 sc1
    s_mov_b64 exec, -1
    s_add_u32 s23, s23, 1
    s_cmp_lt_u32 s23, 200000
    s_cbranch_scc1 g_42L6_1
    s_mov_b32 s25, 200000
    s_branch gc_43
g_42F9_0:
    s_mov_b64 exec, vcc
    buffer_load_dwordx4 v[24:27], v8, s[4:7], s16 offen offset:0 sc1
    s_mov_b64 exec, -1
    s_add_u32 s23, s23, 1
    s_cmp_lt_u32 s23, 200000
    s_cbranch_scc1 g_42L9_3
    s_mov_b32 s25, 200000
    s_branch gc_43
g_42F9_3:
    s_mov_b64 exec, vcc
    buffer_load_dwordx4 v[36:39], v8, s[4:7], s16 offen offset:3072 sc1
    s_mov_b64 exec, -1
    s_add_u32 s23, s23, 1
    s_cmp_lt_u32 s23, 200000
    s_cbranch_scc1 g_42L9_0
    s_mov_b32 s25, 200000
    s_branch gc_43
g_42F10_1:
    s_mov_b64 exec, vcc
    buffer_load_dwordx4 v[28:31], v8, s[4:7], s16 offen offset:1024 sc1
    s_mov_b64 exec, -1
    s_add_u32 s23, s23, 1
    s_cmp_lt_u32 s23, 200000
    s_cbranch_scc1 g_42L10_3
    s_mov_b32 s25, 200000
    s_branch gc_43
g_42F10_3:
    s_mov_b64 exec, vcc
    buffer_load_dwordx4 v[36:39], v8, s[4:7], s16 offen offset:3072 sc1
    s_mov_b64 exec, -1
    s_add_u32 s23, s23, 1
    s_cmp_lt_u32 s23, 200000
    s_cbranch_scc1 g_42L10_1
    s_mov_b32 s25, 200000
    s_branch gc_43
g_42F12_2:
    s_mov_b64 exec, vcc
    buffer_load_dwordx4 v[32:35], v8, s[4:7], s16 offen offset:2048 sc1
    s_mov_b64 exec, -1
    s_add_u32 s23, s23, 1
    s_cmp_lt_u32 s23, 200000
    s_cbranch_scc1 g_42L12_3
    s_mov_b32 s25, 200000
    s_branch gc_43
g_42F12_3:
    s_mov_b64 exec, vcc
    buffer_load_dwordx4 v[36:39], v8, s[4:7], s16 offen offset:3072 sc1
    s_mov_b64 exec, -1
    s_add_u32 s23, s23, 1
    s_cmp_lt_u32 s23, 200000
    s_cbranch_scc1 g_42L12_2
    s_mov_b32 s25, 200000
    s_branch gc_43
g_42F1_0:
    s_mov_b64 exec, vcc
    buffer_load_dwordx4 v[24:27], v8, s[4:7], s16 offen offset:0 sc1
    s_mov_b64 exec, -1
    s_add_u32 s23, s23, 1
    s_cmp_lt_u32 s23, 200000
    s_cbranch_scc1 g_42L1_0
    s_mov_b32 s25, 200000
    s_branch gc_43
g_42F2_1:
    s_mov_b64 exec, vcc
    buffer_load_dwordx4 v[28:31], v8, s[4:7], s16 offen offset:1024 sc1
    s_mov_b64 exec, -1
    s_add_u32 s23, s23, 1
    s_cmp_lt_u32 s23, 200000
    s_cbranch_scc1 g_42L2_1
    s_mov_b32 s25, 200000
    s_branch gc_43
g_42F4_2:
    s_mov_b64 exec, vcc
    buffer_load_dwordx4 v[32:35], v8, s[4:7], s16 offen offset:2048 sc1
    s_mov_b64 exec, -1
    s_add_u32 s23, s23, 1
    s_cmp_lt_u32 s23, 200000
    s_cbranch_scc1 g_42L4_2
    s_mov_b32 s25, 200000
    s_branch gc_43
g_42F8_3:
    s_mov_b64 exec, vcc
    buffer_load_dwordx4 v[36:39], v8, s[4:7], s16 offen offset:3072 sc1
    s_mov_b64 exec, -1
    s_add_u32 s23, s23, 1
    s_cmp_lt_u32 s23, 200000
    s_cbranch_scc1 g_42L8_3
    s_mov_b32 s25, 200000
    s_branch gc_43
.p2align 6
recur_fast_w3:
    s_nop 15
    s_mov_b32 s23, s25
    buffer_load_dwordx4 v[24:27], v2, s[4:7], s16 offen offset:0 sc1
    s_nop 11
    buffer_load_dwordx4 v[28:31], v2, s[4:7], s16 offen offset:1024 sc1
    s_nop 11
    buffer_load_dwordx4 v[32:35], v2, s[4:7], s16 offen offset:2048 sc1
    s_nop 11
    buffer_load_dwordx4 v[36:39], v2, s[4:7], s16 offen offset:3072 sc1
    s_waitcnt vmcnt(3)
    v_max3_u32 v19, v24, v25, v26
    v_max_u32 v19, v19, v27
    v_cmp_eq_u32 vcc, -1, v19
    s_nop 0
    s_cbranch_vccnz g_44F15_0
    v_smfmac_f32_16x16x64_bf16 v[40:43], v[24:27], a[0:7], v172
    s_waitcnt vmcnt(2)
    v_max3_u32 v19, v28, v29, v30
    v_max_u32 v19, v19, v31
    v_smfmac_f32_16x16x64_bf16 v[44:47], v[24:27], a[64:71], v172
    v_cmp_eq_u32 vcc, -1, v19
    v_smfmac_f32_16x16x64_bf16 v[48:51], v[24:27], a[32:39], v172
    v_smfmac_f32_16x16x64_bf16 v[52:55], v[24:27], a[96:103], v172
    s_cbranch_vccnz g_44F14_1
    v_smfmac_f32_16x16x64_bf16 v[40:43], v[28:31], a[8:15], v172
    s_waitcnt vmcnt(1)
    v_max3_u32 v19, v32, v33, v34
    v_max_u32 v19, v19, v35
    v_smfmac_f32_16x16x64_bf16 v[44:47], v[28:31], a[72:79], v172
    v_cmp_eq_u32 vcc, -1, v19
    v_smfmac_f32_16x16x64_bf16 v[48:51], v[28:31], a[40:47], v172
    v_smfmac_f32_16x16x64_bf16 v[52:55], v[28:31], a[104:111], v172
    s_cbranch_vccnz g_44F12_2
    v_smfmac_f32_16x16x64_bf16 v[40:43], v[32:35], a[16:23], v172
    s_waitcnt vmcnt(0)
    v_max3_u32 v19, v36, v37, v38
    v_max_u32 v19, v19, v39
    v_smfmac_f32_16x16x64_bf16 v[44:47], v[32:35], a[80:87], v172
    v_cmp_eq_u32 vcc, -1, v19
    v_smfmac_f32_16x16x64_bf16 v[48:51], v[32:35], a[48:55], v172
    v_smfmac_f32_16x16x64_bf16 v[52:55], v[32:35], a[112:119], v172
    s_cbranch_vccnz g_44F8_3
    v_smfmac_f32_16x16x64_bf16 v[40:43], v[36:39], a[24:31], v172
    v_smfmac_f32_16x16x64_bf16 v[44:47], v[36:39], a[88:95], v172
    v_smfmac_f32_16x16x64_bf16 v[48:51], v[36:39], a[56:63], v172
    v_smfmac_f32_16x16x64_bf16 v[52:55], v[36:39], a[120:127], v172
gc_45:
    v_cvt_pk_bf16_f32 v72, v40, v41
    v_cvt_pk_bf16_f32 v73, v42, v43
    v_cvt_pk_bf16_f32 v74, v44, v45
    v_cvt_pk_bf16_f32 v75, v46, v47
    ds_write_b128 v17, v[72:75] offset:0
    v_cvt_pk_bf16_f32 v76, v48, v49
    v_cvt_pk_bf16_f32 v77, v50, v51
    s_nop 0
    v_cvt_pk_bf16_f32 v78, v52, v53
    v_cvt_pk_bf16_f32 v79, v54, v55
    ds_write_b128 v17, v[76:79] offset:1024
    v_smfmac_f32_16x16x64_bf16 v[56:59], v[24:27], a[128:135], v172
    v_smfmac_f32_16x16x64_bf16 v[60:63], v[24:27], a[160:167], v172
    v_smfmac_f32_16x16x64_bf16 v[56:59], v[28:31], a[136:143], v172
    s_waitcnt lgkmcnt(0)
    s_barrier
    v_smfmac_f32_16x16x64_bf16 v[60:63], v[28:31], a[168:175], v172
    v_smfmac_f32_16x16x64_bf16 v[56:59], v[32:35], a[144:151], v172
    v_smfmac_f32_16x16x64_bf16 v[60:63], v[32:35], a[176:183], v172
    v_smfmac_f32_16x16x64_bf16 v[56:59], v[36:39], a[152:159], v172
    v_smfmac_f32_16x16x64_bf16 v[60:63], v[36:39], a[184:191], v172
    s_nop 4
    v_cvt_pk_bf16_f32 v80, v56, v57
    v_cvt_pk_bf16_f32 v81, v58, v59
    s_nop 0
    v_cvt_pk_bf16_f32 v82, v60, v61
    v_cvt_pk_bf16_f32 v83, v62, v63
    ds_write_b128 v17, v[80:83] offset:8192
    buffer_store_dwordx4 v[204:207], v3, s[4:7], s43 offen
    buffer_store_dwordx4 v[204:207], v3, s[4:7], s43 offen offset:128
    buffer_store_dwordx4 v[204:207], v4, s[4:7], s43 offen
    buffer_store_dwordx2 v[204:205], v7, s[4:7], s43 offen
    buffer_store_dwordx2 v[204:205], v11, s[4:7], s43 offen
    s_cmp_eq_u32 s15, 63
    s_waitcnt lgkmcnt(0)
    s_barrier
    s_cbranch_scc1 recur_end
    s_barrier
    s_nop 15
    s_mov_b32 s23, s25
    buffer_load_dwordx4 v[24:27], v8, s[4:7], s16 offen offset:0 sc1
    s_nop 11
    buffer_load_dwordx4 v[28:31], v8, s[4:7], s16 offen offset:1024 sc1
    s_nop 11
    buffer_load_dwordx4 v[32:35], v8, s[4:7], s16 offen offset:2048 sc1
    s_nop 11
    buffer_load_dwordx4 v[36:39], v8, s[4:7], s16 offen offset:3072 sc1
    s_waitcnt vmcnt(3)
    v_max3_u32 v19, v24, v25, v26
    v_max_u32 v19, v19, v27
    v_cmp_eq_u32 vcc, -1, v19
    s_nop 0
    s_cbranch_vccnz g_46F15_0
    v_smfmac_f32_16x16x64_bf16 v[64:67], v[24:27], a[192:199], v172
    v_smfmac_f32_16x16x64_bf16 v[68:71], v[24:27], a[224:231], v172
    s_waitcnt vmcnt(2)
    v_max3_u32 v19, v28, v29, v30
    v_max_u32 v19, v19, v31
    v_cmp_eq_u32 vcc, -1, v19
    s_nop 0
    s_cbranch_vccnz g_46F14_1
    v_smfmac_f32_16x16x64_bf16 v[64:67], v[28:31], a[200:207], v172
    v_smfmac_f32_16x16x64_bf16 v[68:71], v[28:31], a[232:239], v172
    s_waitcnt vmcnt(1)
    v_max3_u32 v19, v32, v33, v34
    v_max_u32 v19, v19, v35
    v_cmp_eq_u32 vcc, -1, v19
    s_nop 0
    s_cbranch_vccnz g_46F12_2
    v_smfmac_f32_16x16x64_bf16 v[64:67], v[32:35], a[208:215], v172
    v_smfmac_f32_16x16x64_bf16 v[68:71], v[32:35], a[240:247], v172
    s_waitcnt vmcnt(0)
    v_max3_u32 v19, v36, v37, v38
    v_max_u32 v19, v19, v39
    v_cmp_eq_u32 vcc, -1, v19
    s_nop 0
    s_cbranch_vccnz g_46F8_3
    v_smfmac_f32_16x16x64_bf16 v[64:67], v[36:39], a[216:223], v172
    v_smfmac_f32_16x16x64_bf16 v[68:71], v[36:39], a[248:255], v172
    s_nop 4
    v_cvt_pk_bf16_f32 v80, v64, v65
    v_cvt_pk_bf16_f32 v81, v66, v67
    s_nop 0
    v_cvt_pk_bf16_f32 v82, v68, v69
    v_cvt_pk_bf16_f32 v83, v70, v71
    s_nop 1
    v_mfma_f32_16x16x32_bf16 v[88:91], v[80:83], v[84:87], 0
gc_47:
    s_barrier
    ds_read_b128 v[96:99], v16 offset:9216
    ds_read_b128 v[100:103], v16 offset:11264
    ds_read_b128 v[104:107], v16 offset:13312
    s_waitcnt lgkmcnt(2)
    v_mfma_f32_16x16x32_bf16 v[88:91], v[96:99], v[84:87], v[88:91]
    s_waitcnt lgkmcnt(1)
    v_mfma_f32_16x16x32_bf16 v[88:91], v[100:103], v[84:87], v[88:91]
    s_waitcnt lgkmcnt(0)
    v_mfma_f32_16x16x32_bf16 v[88:91], v[104:107], v[84:87], v[88:91]
    s_nop 7
    buffer_store_dwordx4 v[88:91], v9, s[4:7], s84 offen sc1
    s_add_u32 s22, s84, 262144
    s_nop 15
    s_nop 15
    s_nop 15
    s_nop 15
    s_nop 15
    s_nop 15
    s_nop 15
    s_nop 15
    s_mov_b32 s23, s25
    buffer_load_dwordx4 v[96:99], v10, s[4:7], s84 offen sc1
    buffer_load_dwordx4 v[100:103], v23, s[4:7], s84 offen sc1
    buffer_load_dwordx4 v[104:107], v244, s[4:7], s84 offen sc1
    v_mov_b32 v40, 0
    v_mov_b32 v41, 0
    v_mov_b32 v42, 0
    v_mov_b32 v43, 0
    v_mov_b32 v44, 0
    v_mov_b32 v45, 0
    v_mov_b32 v46, 0
    v_mov_b32 v47, 0
    v_mov_b32 v48, 0
    v_mov_b32 v49, 0
    v_mov_b32 v50, 0
    v_mov_b32 v51, 0
    v_mov_b32 v52, 0
    v_mov_b32 v53, 0
    v_mov_b32 v54, 0
    v_mov_b32 v55, 0
    v_mov_b32 v56, 0
    v_mov_b32 v57, 0
    v_mov_b32 v58, 0
    v_mov_b32 v59, 0
    v_mov_b32 v60, 0
    v_mov_b32 v61, 0
    v_mov_b32 v62, 0
    v_mov_b32 v63, 0
    v_mov_b32 v64, 0
    v_mov_b32 v65, 0
    v_mov_b32 v66, 0
    v_mov_b32 v67, 0
    v_mov_b32 v68, 0
    v_mov_b32 v69, 0
    v_mov_b32 v70, 0
    v_mov_b32 v71, 0
pb_50:
    s_waitcnt vmcnt(2)
    v_pk_add_f32 v[120:121], v[88:89], v[96:97]
    v_pk_add_f32 v[122:123], v[90:91], v[98:99]
    s_waitcnt vmcnt(1)
    v_pk_add_f32 v[120:121], v[120:121], v[100:101]
    v_pk_add_f32 v[122:123], v[122:123], v[102:103]
    s_waitcnt vmcnt(0)
    v_pk_add_f32 v[120:121], v[120:121], v[104:105]
    v_pk_add_f32 v[122:123], v[122:123], v[106:107]
    v_cvt_pk_bf16_f32 v180, v120, v121
    v_pk_add_f32 v[124:125], v[120:121], v[122:123]
    v_cvt_pk_bf16_f32 v181, v122, v123
    v_cmpx_o_f32 vcc, v124, v125
    buffer_store_dwordx2 v[180:181], v11, s[4:7], s42 offen
    s_cmp_eq_u64 vcc, -1
    s_mov_b64 exec, -1
    s_cbranch_scc0 pr_48
pg_49:
    s_barrier
    s_mov_b32 s21, s16
    s_mov_b32 s16, s42
    s_mov_b32 s42, s43
    s_mov_b32 s43, s44
    s_mov_b32 s44, s21
    s_add_u32 s95, s95, 524288
    s_lshr_b32 s84, s95, 8
    s_and_b32 s84, s84, 8192
    s_xor_b32 s84, s84, s46
    s_add_u32 s84, s84, s95
    s_add_u32 s15, s15, 1
    s_branch recur_fast_w3
g_44L15_0:
    s_waitcnt vmcnt(3)
    v_max3_u32 v19, v24, v25, v26
    v_max_u32 v19, v19, v27
    v_cmp_eq_u32 vcc, -1, v19
    s_nop 0
    s_cbranch_vccnz g_44F15_0
    v_smfmac_f32_16x16x64_bf16 v[40:43], v[24:27], a[0:7], v172
    v_smfmac_f32_16x16x64_bf16 v[44:47], v[24:27], a[64:71], v172
    v_smfmac_f32_16x16x64_bf16 v[48:51], v[24:27], a[32:39], v172
    v_smfmac_f32_16x16x64_bf16 v[52:55], v[24:27], a[96:103], v172
g_44L14_1:
    s_waitcnt vmcnt(2)
    v_max3_u32 v19, v28, v29, v30
    v_max_u32 v19, v19, v31
    v_cmp_eq_u32 vcc, -1, v19
    s_nop 0
    s_cbranch_vccnz g_44F14_1
    v_smfmac_f32_16x16x64_bf16 v[40:43], v[28:31], a[8:15], v172
    v_smfmac_f32_16x16x64_bf16 v[44:47], v[28:31], a[72:79], v172
    v_smfmac_f32_16x16x64_bf16 v[48:51], v[28:31], a[40:47], v172
    v_smfmac_f32_16x16x64_bf16 v[52:55], v[28:31], a[104:111], v172
g_44L12_2:
    s_waitcnt vmcnt(1)
    v_max3_u32 v19, v32, v33, v34
    v_max_u32 v19, v19, v35
    v_cmp_eq_u32 vcc, -1, v19
    s_nop 0
    s_cbranch_vccnz g_44F12_2
    v_smfmac_f32_16x16x64_bf16 v[40:43], v[32:35], a[16:23], v172
    v_smfmac_f32_16x16x64_bf16 v[44:47], v[32:35], a[80:87], v172
    v_smfmac_f32_16x16x64_bf16 v[48:51], v[32:35], a[48:55], v172
    v_smfmac_f32_16x16x64_bf16 v[52:55], v[32:35], a[112:119], v172
g_44L8_3:
    s_waitcnt vmcnt(0)
    v_max3_u32 v19, v36, v37, v38
    v_max_u32 v19, v19, v39
    v_cmp_eq_u32 vcc, -1, v19
    s_nop 0
    s_cbranch_vccnz g_44F8_3
    v_smfmac_f32_16x16x64_bf16 v[40:43], v[36:39], a[24:31], v172
    v_smfmac_f32_16x16x64_bf16 v[44:47], v[36:39], a[88:95], v172
    v_smfmac_f32_16x16x64_bf16 v[48:51], v[36:39], a[56:63], v172
    v_smfmac_f32_16x16x64_bf16 v[52:55], v[36:39], a[120:127], v172
    s_branch gc_45
g_44L15_1:
    s_waitcnt vmcnt(3)
    v_max3_u32 v19, v28, v29, v30
    v_max_u32 v19, v19, v31
    v_cmp_eq_u32 vcc, -1, v19
    s_nop 0
    s_cbranch_vccnz g_44F15_1
    v_smfmac_f32_16x16x64_bf16 v[40:43], v[28:31], a[8:15], v172
    v_smfmac_f32_16x16x64_bf16 v[44:47], v[28:31], a[72:79], v172
    v_smfmac_f32_16x16x64_bf16 v[48:51], v[28:31], a[40:47], v172
    v_smfmac_f32_16x16x64_bf16 v[52:55], v[28:31], a[104:111], v172
g_44L13_2:
    s_waitcnt vmcnt(2)
    v_max3_u32 v19, v32, v33, v34
    v_max_u32 v19, v19, v35
    v_cmp_eq_u32 vcc, -1, v19
    s_nop 0
    s_cbranch_vccnz g_44F13_2
    v_smfmac_f32_16x16x64_bf16 v[40:43], v[32:35], a[16:23], v172
    v_smfmac_f32_16x16x64_bf16 v[44:47], v[32:35], a[80:87], v172
    v_smfmac_f32_16x16x64_bf16 v[48:51], v[32:35], a[48:55], v172
    v_smfmac_f32_16x16x64_bf16 v[52:55], v[32:35], a[112:119], v172
g_44L9_3:
    s_waitcnt vmcnt(1)
    v_max3_u32 v19, v36, v37, v38
    v_max_u32 v19, v19, v39
    v_cmp_eq_u32 vcc, -1, v19
    s_nop 0
    s_cbranch_vccnz g_44F9_3
    v_smfmac_f32_16x16x64_bf16 v[40:43], v[36:39], a[24:31], v172
    v_smfmac_f32_16x16x64_bf16 v[44:47], v[36:39], a[88:95], v172
    v_smfmac_f32_16x16x64_bf16 v[48:51], v[36:39], a[56:63], v172
    v_smfmac_f32_16x16x64_bf16 v[52:55], v[36:39], a[120:127], v172
g_44L1_0:
    s_waitcnt vmcnt(0)
    v_max3_u32 v19, v24, v25, v26
    v_max_u32 v19, v19, v27
    v_cmp_eq_u32 vcc, -1, v19
    s_nop 0
    s_cbranch_vccnz g_44F1_0
    v_smfmac_f32_16x16x64_bf16 v[40:43], v[24:27], a[0:7], v172
    v_smfmac_f32_16x16x64_bf16 v[44:47], v[24:27], a[64:71], v172
    v_smfmac_f32_16x16x64_bf16 v[48:51], v[24:27], a[32:39], v172
    v_smfmac_f32_16x16x64_bf16 v[52:55], v[24:27], a[96:103], v172
    s_branch gc_45
g_44L15_2:
    s_waitcnt vmcnt(3)
    v_max3_u32 v19, v32, v33, v34
    v_max_u32 v19, v19, v35
    v_cmp_eq_u32 vcc, -1, v19
    s_nop 0
    s_cbranch_vccnz g_44F15_2
    v_smfmac_f32_16x16x64_bf16 v[40:43], v[32:35], a[16:23], v172
    v_smfmac_f32_16x16x64_bf16 v[44:47], v[32:35], a[80:87], v172
    v_smfmac_f32_16x16x64_bf16 v[48:51], v[32:35], a[48:55], v172
    v_smfmac_f32_16x16x64_bf16 v[52:55], v[32:35], a[112:119], v172
g_44L11_3:
    s_waitcnt vmcnt(2)
    v_max3_u32 v19, v36, v37, v38
    v_max_u32 v19, v19, v39
    v_cmp_eq_u32 vcc, -1, v19
    s_nop 0
    s_cbranch_vccnz g_44F11_3
    v_smfmac_f32_16x16x64_bf16 v[40:43], v[36:39], a[24:31], v172
    v_smfmac_f32_16x16x64_bf16 v[44:47], v[36:39], a[88:95], v172
    v_smfmac_f32_16x16x64_bf16 v[48:51], v[36:39], a[56:63], v172
    v_smfmac_f32_16x16x64_bf16 v[52:55], v[36:39], a[120:127], v172
g_44L3_0:
    s_waitcnt vmcnt(1)
    v_max3_u32 v19, v24, v25, v26
    v_max_u32 v19, v19, v27
    v_cmp_eq_u32 vcc, -1, v19
    s_nop 0
    s_cbranch_vccnz g_44F3_0
    v_smfmac_f32_16x16x64_bf16 v[40:43], v[24:27], a[0:7], v172
    v_smfmac_f32_16x16x64_bf16 v[44:47], v[24:27], a[64:71], v172
    v_smfmac_f32_16x16x64_bf16 v[48:51], v[24:27], a[32:39], v172
    v_smfmac_f32_16x16x64_bf16 v[52:55], v[24:27], a[96:103], v172
g_44L2_1:
    s_waitcnt vmcnt(0)
    v_max3_u32 v19, v28, v29, v30
    v_max_u32 v19, v19, v31
    v_cmp_eq_u32 vcc, -1, v19
    s_nop 0
    s_cbranch_vccnz g_44F2_1
    v_smfmac_f32_16x16x64_bf16 v[40:43], v[28:31], a[8:15], v172
    v_smfmac_f32_16x16x64_bf16 v[44:47], v[28:31], a[72:79], v172
    v_smfmac_f32_16x16x64_bf16 v[48:51], v[28:31], a[40:47], v172
    v_smfmac_f32_16x16x64_bf16 v[52:55], v[28:31], a[104:111], v172
    s_branch gc_45
g_44L15_3:
    s_waitcnt vmcnt(3)
    v_max3_u32 v19, v36, v37, v38
    v_max_u32 v19, v19, v39
    v_cmp_eq_u32 vcc, -1, v19
    s_nop 0
    s_cbranch_vccnz g_44F15_3
    v_smfmac_f32_16x16x64_bf16 v[40:43], v[36:39], a[24:31], v172
    v_smfmac_f32_16x16x64_bf16 v[44:47], v[36:39], a[88:95], v172
    v_smfmac_f32_16x16x64_bf16 v[48:51], v[36:39], a[56:63], v172
    v_smfmac_f32_16x16x64_bf16 v[52:55], v[36:39], a[120:127], v172
g_44L7_0:
    s_waitcnt vmcnt(2)
    v_max3_u32 v19, v24, v25, v26
    v_max_u32 v19, v19, v27
    v_cmp_eq_u32 vcc, -1, v19
    s_nop 0
    s_cbranch_vccnz g_44F7_0
    v_smfmac_f32_16x16x64_bf16 v[40:43], v[24:27], a[0:7], v172
    v_smfmac_f32_16x16x64_bf16 v[44:47], v[24:27], a[64:71], v172
    v_smfmac_f32_16x16x64_bf16 v[48:51], v[24:27], a[32:39], v172
    v_smfmac_f32_16x16x64_bf16 v[52:55], v[24:27], a[96:103], v172
g_44L6_1:
    s_waitcnt vmcnt(1)
    v_max3_u32 v19, v28, v29, v30
    v_max_u32 v19, v19, v31
    v_cmp_eq_u32 vcc, -1, v19
    s_nop 0
    s_cbranch_vccnz g_44F6_1
    v_smfmac_f32_16x16x64_bf16 v[40:43], v[28:31], a[8:15], v172
    v_smfmac_f32_16x16x64_bf16 v[44:47], v[28:31], a[72:79], v172
    v_smfmac_f32_16x16x64_bf16 v[48:51], v[28:31], a[40:47], v172
    v_smfmac_f32_16x16x64_bf16 v[52:55], v[28:31], a[104:111], v172
g_44L4_2:
    s_waitcnt vmcnt(0)
    v_max3_u32 v19, v32, v33, v34
    v_max_u32 v19, v19, v35
    v_cmp_eq_u32 vcc, -1, v19
    s_nop 0
    s_cbranch_vccnz g_44F4_2
    v_smfmac_f32_16x16x64_bf16 v[40:43], v[32:35], a[16:23], v172
    v_smfmac_f32_16x16x64_bf16 v[44:47], v[32:35], a[80:87], v172
    v_smfmac_f32_16x16x64_bf16 v[48:51], v[32:35], a[48:55], v172
    v_smfmac_f32_16x16x64_bf16 v[52:55], v[32:35], a[112:119], v172
    s_branch gc_45
g_44L7_1:
    s_waitcnt vmcnt(2)
    v_max3_u32 v19, v28, v29, v30
    v_max_u32 v19, v19, v31
    v_cmp_eq_u32 vcc, -1, v19
    s_nop 0
    s_cbranch_vccnz g_44F7_1
    v_smfmac_f32_16x16x64_bf16 v[40:43], v[28:31], a[8:15], v172
    v_smfmac_f32_16x16x64_bf16 v[44:47], v[28:31], a[72:79], v172
    v_smfmac_f32_16x16x64_bf16 v[48:51], v[28:31], a[40:47], v172
    v_smfmac_f32_16x16x64_bf16 v[52:55], v[28:31], a[104:111], v172
g_44L5_2:
    s_waitcnt vmcnt(1)
    v_max3_u32 v19, v32, v33, v34
    v_max_u32 v19, v19, v35
    v_cmp_eq_u32 vcc, -1, v19
    s_nop 0
    s_cbranch_vccnz g_44F5_2
    v_smfmac_f32_16x16x64_bf16 v[40:43], v[32:35], a[16:23], v172
    v_smfmac_f32_16x16x64_bf16 v[44:47], v[32:35], a[80:87], v172
    v_smfmac_f32_16x16x64_bf16 v[48:51], v[32:35], a[48:55], v172
    v_smfmac_f32_16x16x64_bf16 v[52:55], v[32:35], a[112:119], v172
    s_branch g_44L1_0
g_44L7_2:
    s_waitcnt vmcnt(2)
    v_max3_u32 v19, v32, v33, v34
    v_max_u32 v19, v19, v35
    v_cmp_eq_u32 vcc, -1, v19
    s_nop 0
    s_cbranch_vccnz g_44F7_2
    v_smfmac_f32_16x16x64_bf16 v[40:43], v[32:35], a[16:23], v172
    v_smfmac_f32_16x16x64_bf16 v[44:47], v[32:35], a[80:87], v172
    v_smfmac_f32_16x16x64_bf16 v[48:51], v[32:35], a[48:55], v172
    v_smfmac_f32_16x16x64_bf16 v[52:55], v[32:35], a[112:119], v172
    s_branch g_44L3_0
g_44L11_0:
    s_waitcnt vmcnt(2)
    v_max3_u32 v19, v24, v25, v26
    v_max_u32 v19, v19, v27
    v_cmp_eq_u32 vcc, -1, v19
    s_nop 0
    s_cbranch_vccnz g_44F11_0
    v_smfmac_f32_16x16x64_bf16 v[40:43], v[24:27], a[0:7], v172
    v_smfmac_f32_16x16x64_bf16 v[44:47], v[24:27], a[64:71], v172
    v_smfmac_f32_16x16x64_bf16 v[48:51], v[24:27], a[32:39], v172
    v_smfmac_f32_16x16x64_bf16 v[52:55], v[24:27], a[96:103], v172
g_44L10_1:
    s_waitcnt vmcnt(1)
    v_max3_u32 v19, v28, v29, v30
    v_max_u32 v19, v19, v31
    v_cmp_eq_u32 vcc, -1, v19
    s_nop 0
    s_cbranch_vccnz g_44F10_1
    v_smfmac_f32_16x16x64_bf16 v[40:43], v[28:31], a[8:15], v172
    v_smfmac_f32_16x16x64_bf16 v[44:47], v[28:31], a[72:79], v172
    v_smfmac_f32_16x16x64_bf16 v[48:51], v[28:31], a[40:47], v172
    v_smfmac_f32_16x16x64_bf16 v[52:55], v[28:31], a[104:111], v172
    s_branch g_44L8_3
g_44L11_1:
    s_waitcnt vmcnt(2)
    v_max3_u32 v19, v28, v29, v30
    v_max_u32 v19, v19, v31
    v_cmp_eq_u32 vcc, -1, v19
    s_nop 0
    s_cbranch_vccnz g_44F11_1
    v_smfmac_f32_16x16x64_bf16 v[40:43], v[28:31], a[8:15], v172
    v_smfmac_f32_16x16x64_bf16 v[44:47], v[28:31], a[72:79], v172
    v_smfmac_f32_16x16x64_bf16 v[48:51], v[28:31], a[40:47], v172
    v_smfmac_f32_16x16x64_bf16 v[52:55], v[28:31], a[104:111], v172
    s_branch g_44L9_3
g_44L13_0:
    s_waitcnt vmcnt(2)
    v_max3_u32 v19, v24, v25, v26
    v_max_u32 v19, v19, v27
    v_cmp_eq_u32 vcc, -1, v19
    s_nop 0
    s_cbranch_vccnz g_44F13_0
    v_smfmac_f32_16x16x64_bf16 v[40:43], v[24:27], a[0:7], v172
    v_smfmac_f32_16x16x64_bf16 v[44:47], v[24:27], a[64:71], v172
    v_smfmac_f32_16x16x64_bf16 v[48:51], v[24:27], a[32:39], v172
    v_smfmac_f32_16x16x64_bf16 v[52:55], v[24:27], a[96:103], v172
    s_branch g_44L12_2
g_44L13_3:
    s_waitcnt vmcnt(2)
    v_max3_u32 v19, v36, v37, v38
    v_max_u32 v19, v19, v39
    v_cmp_eq_u32 vcc, -1, v19
    s_nop 0
    s_cbranch_vccnz g_44F13_3
    v_smfmac_f32_16x16x64_bf16 v[40:43], v[36:39], a[24:31], v172
    v_smfmac_f32_16x16x64_bf16 v[44:47], v[36:39], a[88:95], v172
    v_smfmac_f32_16x16x64_bf16 v[48:51], v[36:39], a[56:63], v172
    v_smfmac_f32_16x16x64_bf16 v[52:55], v[36:39], a[120:127], v172
g_44L5_0:
    s_waitcnt vmcnt(1)
    v_max3_u32 v19, v24, v25, v26
    v_max_u32 v19, v19, v27
    v_cmp_eq_u32 vcc, -1, v19
    s_nop 0
    s_cbranch_vccnz g_44F5_0
    v_smfmac_f32_16x16x64_bf16 v[40:43], v[24:27], a[0:7], v172
    v_smfmac_f32_16x16x64_bf16 v[44:47], v[24:27], a[64:71], v172
    v_smfmac_f32_16x16x64_bf16 v[48:51], v[24:27], a[32:39], v172
    v_smfmac_f32_16x16x64_bf16 v[52:55], v[24:27], a[96:103], v172
    s_branch g_44L4_2
g_44L14_2:
    s_waitcnt vmcnt(2)
    v_max3_u32 v19, v32, v33, v34
    v_max_u32 v19, v19, v35
    v_cmp_eq_u32 vcc, -1, v19
    s_nop 0
    s_cbranch_vccnz g_44F14_2
    v_smfmac_f32_16x16x64_bf16 v[40:43], v[32:35], a[16:23], v172
    v_smfmac_f32_16x16x64_bf16 v[44:47], v[32:35], a[80:87], v172
    v_smfmac_f32_16x16x64_bf16 v[48:51], v[32:35], a[48:55], v172
    v_smfmac_f32_16x16x64_bf16 v[52:55], v[32:35], a[112:119], v172
g_44L10_3:
    s_waitcnt vmcnt(1)
    v_max3_u32 v19, v36, v37, v38
    v_max_u32 v19, v19, v39
    v_cmp_eq_u32 vcc, -1, v19
    s_nop 0
    s_cbranch_vccnz g_44F10_3
    v_smfmac_f32_16x16x64_bf16 v[40:43], v[36:39], a[24:31], v172
    v_smfmac_f32_16x16x64_bf16 v[44:47], v[36:39], a[88:95], v172
    v_smfmac_f32_16x16x64_bf16 v[48:51], v[36:39], a[56:63], v172
    v_smfmac_f32_16x16x64_bf16 v[52:55], v[36:39], a[120:127], v172
    s_branch g_44L2_1
g_44L14_3:
    s_waitcnt vmcnt(2)
    v_max3_u32 v19, v36, v37, v38
    v_max_u32 v19, v19, v39
    v_cmp_eq_u32 vcc, -1, v19
    s_nop 0
    s_cbranch_vccnz g_44F14_3
    v_smfmac_f32_16x16x64_bf16 v[40:43], v[36:39], a[24:31], v172
    v_smfmac_f32_16x16x64_bf16 v[44:47], v[36:39], a[88:95], v172
    v_smfmac_f32_16x16x64_bf16 v[48:51], v[36:39], a[56:63], v172
    v_smfmac_f32_16x16x64_bf16 v[52:55], v[36:39], a[120:127], v172
    s_branch g_44L6_1
g_44L3_1:
    s_waitcnt vmcnt(1)
    v_max3_u32 v19, v28, v29, v30
    v_max_u32 v19, v19, v31
    v_cmp_eq_u32 vcc, -1, v19
    s_nop 0
    s_cbranch_vccnz g_44F3_1
    v_smfmac_f32_16x16x64_bf16 v[40:43], v[28:31], a[8:15], v172
    v_smfmac_f32_16x16x64_bf16 v[44:47], v[28:31], a[72:79], v172
    v_smfmac_f32_16x16x64_bf16 v[48:51], v[28:31], a[40:47], v172
    v_smfmac_f32_16x16x64_bf16 v[52:55], v[28:31], a[104:111], v172
    s_branch g_44L1_0
g_44L6_2:
    s_waitcnt vmcnt(1)
    v_max3_u32 v19, v32, v33, v34
    v_max_u32 v19, v19, v35
    v_cmp_eq_u32 vcc, -1, v19
    s_nop 0
    s_cbranch_vccnz g_44F6_2
    v_smfmac_f32_16x16x64_bf16 v[40:43], v[32:35], a[16:23], v172
    v_smfmac_f32_16x16x64_bf16 v[44:47], v[32:35], a[80:87], v172
    v_smfmac_f32_16x16x64_bf16 v[48:51], v[32:35], a[48:55], v172
    v_smfmac_f32_16x16x64_bf16 v[52:55], v[32:35], a[112:119], v172
    s_branch g_44L2_1
g_44L9_0:
    s_waitcnt vmcnt(1)
    v_max3_u32 v19, v24, v25, v26
    v_max_u32 v19, v19, v27
    v_cmp_eq_u32 vcc, -1, v19
    s_nop 0
    s_cbranch_vccnz g_44F9_0
    v_smfmac_f32_16x16x64_bf16 v[40:43], v[24:27], a[0:7], v172
    v_smfmac_f32_16x16x64_bf16 v[44:47], v[24:27], a[64:71], v172
    v_smfmac_f32_16x16x64_bf16 v[48:51], v[24:27], a[32:39], v172
    v_smfmac_f32_16x16x64_bf16 v[52:55], v[24:27], a[96:103], v172
    s_branch g_44L8_3
g_44L12_3:
    s_waitcnt vmcnt(1)
    v_max3_u32 v19, v36, v37, v38
    v_max_u32 v19, v19, v39
    v_cmp_eq_u32 vcc, -1, v19
    s_nop 0
    s_cbranch_vccnz g_44F12_3
    v_smfmac_f32_16x16x64_bf16 v[40:43], v[36:39], a[24:31], v172
    v_smfmac_f32_16x16x64_bf16 v[44:47], v[36:39], a[88:95], v172
    v_smfmac_f32_16x16x64_bf16 v[48:51], v[36:39], a[56:63], v172
    v_smfmac_f32_16x16x64_bf16 v[52:55], v[36:39], a[120:127], v172
    s_branch g_44L4_2
g_44F15_0:
    s_mov_b64 exec, vcc
    buffer_load_dwordx4 v[24:27], v2, s[4:7], s16 offen offset:0 sc1
    s_mov_b64 exec, -1
    s_add_u32 s23, s23, 1
    s_cmp_lt_u32 s23, 200000
    s_cbranch_scc1 g_44L15_1
    s_mov_b32 s25, 200000
    s_branch gc_45
g_44F15_1:
    s_mov_b64 exec, vcc
    buffer_load_dwordx4 v[28:31], v2, s[4:7], s16 offen offset:1024 sc1
    s_mov_b64 exec, -1
    s_add_u32 s23, s23, 1
    s_cmp_lt_u32 s23, 200000
    s_cbranch_scc1 g_44L15_2
    s_mov_b32 s25, 200000
    s_branch gc_45
g_44F15_2:
    s_mov_b64 exec, vcc
    buffer_load_dwordx4 v[32:35], v2, s[4:7], s16 offen offset:2048 sc1
    s_mov_b64 exec, -1
    s_add_u32 s23, s23, 1
    s_cmp_lt_u32 s23, 200000
    s_cbranch_scc1 g_44L15_3
    s_mov_b32 s25, 200000
    s_branch gc_45
g_44F15_3:
    s_mov_b64 exec, vcc
    buffer_load_dwordx4 v[36:39], v2, s[4:7], s16 offen offset:3072 sc1
    s_mov_b64 exec, -1
    s_add_u32 s23, s23, 1
    s_cmp_lt_u32 s23, 200000
    s_cbranch_scc1 g_44L15_0
    s_mov_b32 s25, 200000
    s_branch gc_45
g_44F7_0:
    s_mov_b64 exec, vcc
    buffer_load_dwordx4 v[24:27], v2, s[4:7], s16 offen offset:0 sc1
    s_mov_b64 exec, -1
    s_add_u32 s23, s23, 1
    s_cmp_lt_u32 s23, 200000
    s_cbranch_scc1 g_44L7_1
    s_mov_b32 s25, 200000
    s_branch gc_45
g_44F7_1:
    s_mov_b64 exec, vcc
    buffer_load_dwordx4 v[28:31], v2, s[4:7], s16 offen offset:1024 sc1
    s_mov_b64 exec, -1
    s_add_u32 s23, s23, 1
    s_cmp_lt_u32 s23, 200000
    s_cbranch_scc1 g_44L7_2
    s_mov_b32 s25, 200000
    s_branch gc_45
g_44F7_2:
    s_mov_b64 exec, vcc
    buffer_load_dwordx4 v[32:35], v2, s[4:7], s16 offen offset:2048 sc1
    s_mov_b64 exec, -1
    s_add_u32 s23, s23, 1
    s_cmp_lt_u32 s23, 200000
    s_cbranch_scc1 g_44L7_0
    s_mov_b32 s25, 200000
    s_branch gc_45
g_44F11_0:
    s_mov_b64 exec, vcc
    buffer_load_dwordx4 v[24:27], v2, s[4:7], s16 offen offset:0 sc1
    s_mov_b64 exec, -1
    s_add_u32 s23, s23, 1
    s_cmp_lt_u32 s23, 200000
    s_cbranch_scc1 g_44L11_1
    s_mov_b32 s25, 200000
    s_branch gc_45
g_44F11_1:
    s_mov_b64 exec, vcc
    buffer_load_dwordx4 v[28:31], v2, s[4:7], s16 offen offset:1024 sc1
    s_mov_b64 exec, -1
    s_add_u32 s23, s23, 1
    s_cmp_lt_u32 s23, 200000
    s_cbranch_scc1 g_44L11_3
    s_mov_b32 s25, 200000
    s_branch gc_45
g_44F11_3:
    s_mov_b64 exec, vcc
    buffer_load_dwordx4 v[36:39], v2, s[4:7], s16 offen offset:3072 sc1
    s_mov_b64 exec, -1
    s_add_u32 s23, s23, 1
    s_cmp_lt_u32 s23, 200000
    s_cbranch_scc1 g_44L11_0
    s_mov_b32 s25, 200000
    s_branch gc_45
g_44F13_0:
    s_mov_b64 exec, vcc
    buffer_load_dwordx4 v[24:27], v2, s[4:7], s16 offen offset:0 sc1
    s_mov_b64 exec, -1
    s_add_u32 s23, s23, 1
    s_cmp_lt_u32 s23, 200000
    s_cbranch_scc1 g_44L13_2
    s_mov_b32 s25, 200000
    s_branch gc_45
g_44F13_2:
    s_mov_b64 exec, vcc
    buffer_load_dwordx4 v[32:35], v2, s[4:7], s16 offen offset:2048 sc1
    s_mov_b64 exec, -1
    s_add_u32 s23, s23, 1
    s_cmp_lt_u32 s23, 200000
    s_cbranch_scc1 g_44L13_3
    s_mov_b32 s25, 200000
    s_branch gc_45
g_44F13_3:
    s_mov_b64 exec, vcc
    buffer_load_dwordx4 v[36:39], v2, s[4:7], s16 offen offset:3072 sc1
    s_mov_b64 exec, -1
    s_add_u32 s23, s23, 1
    s_cmp_lt_u32 s23, 200000
    s_cbranch_scc1 g_44L13_0
    s_mov_b32 s25, 200000
    s_branch gc_45
g_44F14_1:
    s_mov_b64 exec, vcc
    buffer_load_dwordx4 v[28:31], v2, s[4:7], s16 offen offset:1024 sc1
    s_mov_b64 exec, -1
    s_add_u32 s23, s23, 1
    s_cmp_lt_u32 s23, 200000
    s_cbranch_scc1 g_44L14_2
    s_mov_b32 s25, 200000
    s_branch gc_45
g_44F14_2:
    s_mov_b64 exec, vcc
    buffer_load_dwordx4 v[32:35], v2, s[4:7], s16 offen offset:2048 sc1
    s_mov_b64 exec, -1
    s_add_u32 s23, s23, 1
    s_cmp_lt_u32 s23, 200000
    s_cbranch_scc1 g_44L14_3
    s_mov_b32 s25, 200000
    s_branch gc_45
g_44F14_3:
    s_mov_b64 exec, vcc
    buffer_load_dwordx4 v[36:39], v2, s[4:7], s16 offen offset:3072 sc1
    s_mov_b64 exec, -1
    s_add_u32 s23, s23, 1
    s_cmp_lt_u32 s23, 200000
    s_cbranch_scc1 g_44L14_1
    s_mov_b32 s25, 200000
    s_branch gc_45
g_44F3_0:
    s_mov_b64 exec, vcc
    buffer_load_dwordx4 v[24:27], v2, s[4:7], s16 offen offset:0 sc1
    s_mov_b64 exec, -1
    s_add_u32 s23, s23, 1
    s_cmp_lt_u32 s23, 200000
    s_cbranch_scc1 g_44L3_1
    s_mov_b32 s25, 200000
    s_branch gc_45
g_44F3_1:
    s_mov_b64 exec, vcc
    buffer_load_dwordx4 v[28:31], v2, s[4:7], s16 offen offset:1024 sc1
    s_mov_b64 exec, -1
    s_add_u32 s23, s23, 1
    s_cmp_lt_u32 s23, 200000
    s_cbranch_scc1 g_44L3_0
    s_mov_b32 s25, 200000
    s_branch gc_45
g_44F5_0:
    s_mov_b64 exec, vcc
    buffer_load_dwordx4 v[24:27], v2, s[4:7], s16 offen offset:0 sc1
    s_mov_b64 exec, -1
    s_add_u32 s23, s23, 1
    s_cmp_lt_u32 s23, 200000
    s_cbranch_scc1 g_44L5_2
    s_mov_b32 s25, 200000
    s_branch gc_45
g_44F5_2:
    s_mov_b64 exec, vcc
    buffer_load_dwordx4 v[32:35], v2, s[4:7], s16 offen offset:2048 sc1
    s_mov_b64 exec, -1
    s_add_u32 s23, s23, 1
    s_cmp_lt_u32 s23, 200000
    s_cbranch_scc1 g_44L5_0
    s_mov_b32 s25, 200000
    s_branch gc_45
g_44F6_1:
    s_mov_b64 exec, vcc
    buffer_load_dwordx4 v[28:31], v2, s[4:7], s16 offen offset:1024 sc1
    s_mov_b64 exec, -1
    s_add_u32 s23, s23, 1
    s_cmp_lt_u32 s23, 200000
    s_cbranch_scc1 g_44L6_2
    s_mov_b32 s25, 200000
    s_branch gc_45
g_44F6_2:
    s_mov_b64 exec, vcc
    buffer_load_dwordx4 v[32:35], v2, s[4:7], s16 offen offset:2048 sc1
    s_mov_b64 exec, -1
    s_add_u32 s23, s23, 1
    s_cmp_lt_u32 s23, 200000
    s_cbranch_scc1 g_44L6_1
    s_mov_b32 s25, 200000
    s_branch gc_45
g_44F9_0:
    s_mov_b64 exec, vcc
    buffer_load_dwordx4 v[24:27], v2, s[4:7], s16 offen offset:0 sc1
    s_mov_b64 exec, -1
    s_add_u32 s23, s23, 1
    s_cmp_lt_u32 s23, 200000
    s_cbranch_scc1 g_44L9_3
    s_mov_b32 s25, 200000
    s_branch gc_45
g_44F9_3:
    s_mov_b64 exec, vcc
    buffer_load_dwordx4 v[36:39], v2, s[4:7], s16 offen offset:3072 sc1
    s_mov_b64 exec, -1
    s_add_u32 s23, s23, 1
    s_cmp_lt_u32 s23, 200000
    s_cbranch_scc1 g_44L9_0
    s_mov_b32 s25, 200000
    s_branch gc_45
g_44F10_1:
    s_mov_b64 exec, vcc
    buffer_load_dwordx4 v[28:31], v2, s[4:7], s16 offen offset:1024 sc1
    s_mov_b64 exec, -1
    s_add_u32 s23, s23, 1
    s_cmp_lt_u32 s23, 200000
    s_cbranch_scc1 g_44L10_3
    s_mov_b32 s25, 200000
    s_branch gc_45
g_44F10_3:
    s_mov_b64 exec, vcc
    buffer_load_dwordx4 v[36:39], v2, s[4:7], s16 offen offset:3072 sc1
    s_mov_b64 exec, -1
    s_add_u32 s23, s23, 1
    s_cmp_lt_u32 s23, 200000
    s_cbranch_scc1 g_44L10_1
    s_mov_b32 s25, 200000
    s_branch gc_45
g_44F12_2:
    s_mov_b64 exec, vcc
    buffer_load_dwordx4 v[32:35], v2, s[4:7], s16 offen offset:2048 sc1
    s_mov_b64 exec, -1
    s_add_u32 s23, s23, 1
    s_cmp_lt_u32 s23, 200000
    s_cbranch_scc1 g_44L12_3
    s_mov_b32 s25, 200000
    s_branch gc_45
g_44F12_3:
    s_mov_b64 exec, vcc
    buffer_load_dwordx4 v[36:39], v2, s[4:7], s16 offen offset:3072 sc1
    s_mov_b64 exec, -1
    s_add_u32 s23, s23, 1
    s_cmp_lt_u32 s23, 200000
    s_cbranch_scc1 g_44L12_2
    s_mov_b32 s25, 200000
    s_branch gc_45
g_44F1_0:
    s_mov_b64 exec, vcc
    buffer_load_dwordx4 v[24:27], v2, s[4:7], s16 offen offset:0 sc1
    s_mov_b64 exec, -1
    s_add_u32 s23, s23, 1
    s_cmp_lt_u32 s23, 200000
    s_cbranch_scc1 g_44L1_0
    s_mov_b32 s25, 200000
    s_branch gc_45
g_44F2_1:
    s_mov_b64 exec, vcc
    buffer_load_dwordx4 v[28:31], v2, s[4:7], s16 offen offset:1024 sc1
    s_mov_b64 exec, -1
    s_add_u32 s23, s23, 1
    s_cmp_lt_u32 s23, 200000
    s_cbranch_scc1 g_44L2_1
    s_mov_b32 s25, 200000
    s_branch gc_45
g_44F4_2:
    s_mov_b64 exec, vcc
    buffer_load_dwordx4 v[32:35], v2, s[4:7], s16 offen offset:2048 sc1
    s_mov_b64 exec, -1
    s_add_u32 s23, s23, 1
    s_cmp_lt_u32 s23, 200000
    s_cbranch_scc1 g_44L4_2
    s_mov_b32 s25, 200000
    s_branch gc_45
g_44F8_3:
    s_mov_b64 exec, vcc
    buffer_load_dwordx4 v[36:39], v2, s[4:7], s16 offen offset:3072 sc1
    s_mov_b64 exec, -1
    s_add_u32 s23, s23, 1
    s_cmp_lt_u32 s23, 200000
    s_cbranch_scc1 g_44L8_3
    s_mov_b32 s25, 200000
    s_branch gc_45
g_46L15_0:
    s_waitcnt vmcnt(3)
    v_max3_u32 v19, v24, v25, v26
    v_max_u32 v19, v19, v27
    v_cmp_eq_u32 vcc, -1, v19
    s_nop 0
    s_cbranch_vccnz g_46F15_0
    v_smfmac_f32_16x16x64_bf16 v[64:67], v[24:27], a[192:199], v172
    v_smfmac_f32_16x16x64_bf16 v[68:71], v[24:27], a[224:231], v172
g_46L14_1:
    s_waitcnt vmcnt(2)
    v_max3_u32 v19, v28, v29, v30
    v_max_u32 v19, v19, v31
    v_cmp_eq_u32 vcc, -1, v19
    s_nop 0
    s_cbranch_vccnz g_46F14_1
    v_smfmac_f32_16x16x64_bf16 v[64:67], v[28:31], a[200:207], v172
    v_smfmac_f32_16x16x64_bf16 v[68:71], v[28:31], a[232:239], v172
g_46L12_2:
    s_waitcnt vmcnt(1)
    v_max3_u32 v19, v32, v33, v34
    v_max_u32 v19, v19, v35
    v_cmp_eq_u32 vcc, -1, v19
    s_nop 0
    s_cbranch_vccnz g_46F12_2
    v_smfmac_f32_16x16x64_bf16 v[64:67], v[32:35], a[208:215], v172
    v_smfmac_f32_16x16x64_bf16 v[68:71], v[32:35], a[240:247], v172
g_46L8_3:
    s_waitcnt vmcnt(0)
    v_max3_u32 v19, v36, v37, v38
    v_max_u32 v19, v19, v39
    v_cmp_eq_u32 vcc, -1, v19
    s_nop 0
    s_cbranch_vccnz g_46F8_3
    v_smfmac_f32_16x16x64_bf16 v[64:67], v[36:39], a[216:223], v172
    v_smfmac_f32_16x16x64_bf16 v[68:71], v[36:39], a[248:255], v172
    s_nop 4
    v_cvt_pk_bf16_f32 v80, v64, v65
    v_cvt_pk_bf16_f32 v81, v66, v67
    s_nop 0
    v_cvt_pk_bf16_f32 v82, v68, v69
    v_cvt_pk_bf16_f32 v83, v70, v71
    s_nop 1
    v_mfma_f32_16x16x32_bf16 v[88:91], v[80:83], v[84:87], 0
    s_branch gc_47
g_46L15_1:
    s_waitcnt vmcnt(3)
    v_max3_u32 v19, v28, v29, v30
    v_max_u32 v19, v19, v31
    v_cmp_eq_u32 vcc, -1, v19
    s_nop 0
    s_cbranch_vccnz g_46F15_1
    v_smfmac_f32_16x16x64_bf16 v[64:67], v[28:31], a[200:207], v172
    v_smfmac_f32_16x16x64_bf16 v[68:71], v[28:31], a[232:239], v172
g_46L13_2:
    s_waitcnt vmcnt(2)
    v_max3_u32 v19, v32, v33, v34
    v_max_u32 v19, v19, v35
    v_cmp_eq_u32 vcc, -1, v19
    s_nop 0
    s_cbranch_vccnz g_46F13_2
    v_smfmac_f32_16x16x64_bf16 v[64:67], v[32:35], a[208:215], v172
    v_smfmac_f32_16x16x64_bf16 v[68:71], v[32:35], a[240:247], v172
g_46L9_3:
    s_waitcnt vmcnt(1)
    v_max3_u32 v19, v36, v37, v38
    v_max_u32 v19, v19, v39
    v_cmp_eq_u32 vcc, -1, v19
    s_nop 0
    s_cbranch_vccnz g_46F9_3
    v_smfmac_f32_16x16x64_bf16 v[64:67], v[36:39], a[216:223], v172
    v_smfmac_f32_16x16x64_bf16 v[68:71], v[36:39], a[248:255], v172
g_46L1_0:
    s_waitcnt vmcnt(0)
    v_max3_u32 v19, v24, v25, v26
    v_max_u32 v19, v19, v27
    v_cmp_eq_u32 vcc, -1, v19
    s_nop 0
    s_cbranch_vccnz g_46F1_0
    v_smfmac_f32_16x16x64_bf16 v[64:67], v[24:27], a[192:199], v172
    v_smfmac_f32_16x16x64_bf16 v[68:71], v[24:27], a[224:231], v172
    s_nop 4
    v_cvt_pk_bf16_f32 v80, v64, v65
    v_cvt_pk_bf16_f32 v81, v66, v67
    s_nop 0
    v_cvt_pk_bf16_f32 v82, v68, v69
    v_cvt_pk_bf16_f32 v83, v70, v71
    s_nop 1
    v_mfma_f32_16x16x32_bf16 v[88:91], v[80:83], v[84:87], 0
    s_branch gc_47
g_46L15_2:
    s_waitcnt vmcnt(3)
    v_max3_u32 v19, v32, v33, v34
    v_max_u32 v19, v19, v35
    v_cmp_eq_u32 vcc, -1, v19
    s_nop 0
    s_cbranch_vccnz g_46F15_2
    v_smfmac_f32_16x16x64_bf16 v[64:67], v[32:35], a[208:215], v172
    v_smfmac_f32_16x16x64_bf16 v[68:71], v[32:35], a[240:247], v172
g_46L11_3:
    s_waitcnt vmcnt(2)
    v_max3_u32 v19, v36, v37, v38
    v_max_u32 v19, v19, v39
    v_cmp_eq_u32 vcc, -1, v19
    s_nop 0
    s_cbranch_vccnz g_46F11_3
    v_smfmac_f32_16x16x64_bf16 v[64:67], v[36:39], a[216:223], v172
    v_smfmac_f32_16x16x64_bf16 v[68:71], v[36:39], a[248:255], v172
g_46L3_0:
    s_waitcnt vmcnt(1)
    v_max3_u32 v19, v24, v25, v26
    v_max_u32 v19, v19, v27
    v_cmp_eq_u32 vcc, -1, v19
    s_nop 0
    s_cbranch_vccnz g_46F3_0
    v_smfmac_f32_16x16x64_bf16 v[64:67], v[24:27], a[192:199], v172
    v_smfmac_f32_16x16x64_bf16 v[68:71], v[24:27], a[224:231], v172
g_46L2_1:
    s_waitcnt vmcnt(0)
    v_max3_u32 v19, v28, v29, v30
    v_max_u32 v19, v19, v31
    v_cmp_eq_u32 vcc, -1, v19
    s_nop 0
    s_cbranch_vccnz g_46F2_1
    v_smfmac_f32_16x16x64_bf16 v[64:67], v[28:31], a[200:207], v172
    v_smfmac_f32_16x16x64_bf16 v[68:71], v[28:31], a[232:239], v172
    s_nop 4
    v_cvt_pk_bf16_f32 v80, v64, v65
    v_cvt_pk_bf16_f32 v81, v66, v67
    s_nop 0
    v_cvt_pk_bf16_f32 v82, v68, v69
    v_cvt_pk_bf16_f32 v83, v70, v71
    s_nop 1
    v_mfma_f32_16x16x32_bf16 v[88:91], v[80:83], v[84:87], 0
    s_branch gc_47
g_46L15_3:
    s_waitcnt vmcnt(3)
    v_max3_u32 v19, v36, v37, v38
    v_max_u32 v19, v19, v39
    v_cmp_eq_u32 vcc, -1, v19
    s_nop 0
    s_cbranch_vccnz g_46F15_3
    v_smfmac_f32_16x16x64_bf16 v[64:67], v[36:39], a[216:223], v172
    v_smfmac_f32_16x16x64_bf16 v[68:71], v[36:39], a[248:255], v172
g_46L7_0:
    s_waitcnt vmcnt(2)
    v_max3_u32 v19, v24, v25, v26
    v_max_u32 v19, v19, v27
    v_cmp_eq_u32 vcc, -1, v19
    s_nop 0
    s_cbranch_vccnz g_46F7_0
    v_smfmac_f32_16x16x64_bf16 v[64:67], v[24:27], a[192:199], v172
    v_smfmac_f32_16x16x64_bf16 v[68:71], v[24:27], a[224:231], v172
g_46L6_1:
    s_waitcnt vmcnt(1)
    v_max3_u32 v19, v28, v29, v30
    v_max_u32 v19, v19, v31
    v_cmp_eq_u32 vcc, -1, v19
    s_nop 0
    s_cbranch_vccnz g_46F6_1
    v_smfmac_f32_16x16x64_bf16 v[64:67], v[28:31], a[200:207], v172
    v_smfmac_f32_16x16x64_bf16 v[68:71], v[28:31], a[232:239], v172
g_46L4_2:
    s_waitcnt vmcnt(0)
    v_max3_u32 v19, v32, v33, v34
    v_max_u32 v19, v19, v35
    v_cmp_eq_u32 vcc, -1, v19
    s_nop 0
    s_cbranch_vccnz g_46F4_2
    v_smfmac_f32_16x16x64_bf16 v[64:67], v[32:35], a[208:215], v172
    v_smfmac_f32_16x16x64_bf16 v[68:71], v[32:35], a[240:247], v172
    s_nop 4
    v_cvt_pk_bf16_f32 v80, v64, v65
    v_cvt_pk_bf16_f32 v81, v66, v67
    s_nop 0
    v_cvt_pk_bf16_f32 v82, v68, v69
    v_cvt_pk_bf16_f32 v83, v70, v71
    s_nop 1
    v_mfma_f32_16x16x32_bf16 v[88:91], v[80:83], v[84:87], 0
    s_branch gc_47
g_46L7_1:
    s_waitcnt vmcnt(2)
    v_max3_u32 v19, v28, v29, v30
    v_max_u32 v19, v19, v31
    v_cmp_eq_u32 vcc, -1, v19
    s_nop 0
    s_cbranch_vccnz g_46F7_1
    v_smfmac_f32_16x16x64_bf16 v[64:67], v[28:31], a[200:207], v172
    v_smfmac_f32_16x16x64_bf16 v[68:71], v[28:31], a[232:239], v172
g_46L5_2:
    s_waitcnt vmcnt(1)
    v_max3_u32 v19, v32, v33, v34
    v_max_u32 v19, v19, v35
    v_cmp_eq_u32 vcc, -1, v19
    s_nop 0
    s_cbranch_vccnz g_46F5_2
    v_smfmac_f32_16x16x64_bf16 v[64:67], v[32:35], a[208:215], v172
    v_smfmac_f32_16x16x64_bf16 v[68:71], v[32:35], a[240:247], v172
    s_branch g_46L1_0
g_46L7_2:
    s_waitcnt vmcnt(2)
    v_max3_u32 v19, v32, v33, v34
    v_max_u32 v19, v19, v35
    v_cmp_eq_u32 vcc, -1, v19
    s_nop 0
    s_cbranch_vccnz g_46F7_2
    v_smfmac_f32_16x16x64_bf16 v[64:67], v[32:35], a[208:215], v172
    v_smfmac_f32_16x16x64_bf16 v[68:71], v[32:35], a[240:247], v172
    s_branch g_46L3_0
g_46L11_0:
    s_waitcnt vmcnt(2)
    v_max3_u32 v19, v24, v25, v26
    v_max_u32 v19, v19, v27
    v_cmp_eq_u32 vcc, -1, v19
    s_nop 0
    s_cbranch_vccnz g_46F11_0
    v_smfmac_f32_16x16x64_bf16 v[64:67], v[24:27], a[192:199], v172
    v_smfmac_f32_16x16x64_bf16 v[68:71], v[24:27], a[224:231], v172
g_46L10_1:
    s_waitcnt vmcnt(1)
    v_max3_u32 v19, v28, v29, v30
    v_max_u32 v19, v19, v31
    v_cmp_eq_u32 vcc, -1, v19
    s_nop 0
    s_cbranch_vccnz g_46F10_1
    v_smfmac_f32_16x16x64_bf16 v[64:67], v[28:31], a[200:207], v172
    v_smfmac_f32_16x16x64_bf16 v[68:71], v[28:31], a[232:239], v172
    s_branch g_46L8_3
g_46L11_1:
    s_waitcnt vmcnt(2)
    v_max3_u32 v19, v28, v29, v30
    v_max_u32 v19, v19, v31
    v_cmp_eq_u32 vcc, -1, v19
    s_nop 0
    s_cbranch_vccnz g_46F11_1
    v_smfmac_f32_16x16x64_bf16 v[64:67], v[28:31], a[200:207], v172
    v_smfmac_f32_16x16x64_bf16 v[68:71], v[28:31], a[232:239], v172
    s_branch g_46L9_3
g_46L13_0:
    s_waitcnt vmcnt(2)
    v_max3_u32 v19, v24, v25, v26
    v_max_u32 v19, v19, v27
    v_cmp_eq_u32 vcc, -1, v19
    s_nop 0
    s_cbranch_vccnz g_46F13_0
    v_smfmac_f32_16x16x64_bf16 v[64:67], v[24:27], a[192:199], v172
    v_smfmac_f32_16x16x64_bf16 v[68:71], v[24:27], a[224:231], v172
    s_branch g_46L12_2
g_46L13_3:
    s_waitcnt vmcnt(2)
    v_max3_u32 v19, v36, v37, v38
    v_max_u32 v19, v19, v39
    v_cmp_eq_u32 vcc, -1, v19
    s_nop 0
    s_cbranch_vccnz g_46F13_3
    v_smfmac_f32_16x16x64_bf16 v[64:67], v[36:39], a[216:223], v172
    v_smfmac_f32_16x16x64_bf16 v[68:71], v[36:39], a[248:255], v172
g_46L5_0:
    s_waitcnt vmcnt(1)
    v_max3_u32 v19, v24, v25, v26
    v_max_u32 v19, v19, v27
    v_cmp_eq_u32 vcc, -1, v19
    s_nop 0
    s_cbranch_vccnz g_46F5_0
    v_smfmac_f32_16x16x64_bf16 v[64:67], v[24:27], a[192:199], v172
    v_smfmac_f32_16x16x64_bf16 v[68:71], v[24:27], a[224:231], v172
    s_branch g_46L4_2
g_46L14_2:
    s_waitcnt vmcnt(2)
    v_max3_u32 v19, v32, v33, v34
    v_max_u32 v19, v19, v35
    v_cmp_eq_u32 vcc, -1, v19
    s_nop 0
    s_cbranch_vccnz g_46F14_2
    v_smfmac_f32_16x16x64_bf16 v[64:67], v[32:35], a[208:215], v172
    v_smfmac_f32_16x16x64_bf16 v[68:71], v[32:35], a[240:247], v172
g_46L10_3:
    s_waitcnt vmcnt(1)
    v_max3_u32 v19, v36, v37, v38
    v_max_u32 v19, v19, v39
    v_cmp_eq_u32 vcc, -1, v19
    s_nop 0
    s_cbranch_vccnz g_46F10_3
    v_smfmac_f32_16x16x64_bf16 v[64:67], v[36:39], a[216:223], v172
    v_smfmac_f32_16x16x64_bf16 v[68:71], v[36:39], a[248:255], v172
    s_branch g_46L2_1
g_46L14_3:
    s_waitcnt vmcnt(2)
    v_max3_u32 v19, v36, v37, v38
    v_max_u32 v19, v19, v39
    v_cmp_eq_u32 vcc, -1, v19
    s_nop 0
    s_cbranch_vccnz g_46F14_3
    v_smfmac_f32_16x16x64_bf16 v[64:67], v[36:39], a[216:223], v172
    v_smfmac_f32_16x16x64_bf16 v[68:71], v[36:39], a[248:255], v172
    s_branch g_46L6_1
g_46L3_1:
    s_waitcnt vmcnt(1)
    v_max3_u32 v19, v28, v29, v30
    v_max_u32 v19, v19, v31
    v_cmp_eq_u32 vcc, -1, v19
    s_nop 0
    s_cbranch_vccnz g_46F3_1
    v_smfmac_f32_16x16x64_bf16 v[64:67], v[28:31], a[200:207], v172
    v_smfmac_f32_16x16x64_bf16 v[68:71], v[28:31], a[232:239], v172
    s_branch g_46L1_0
g_46L6_2:
    s_waitcnt vmcnt(1)
    v_max3_u32 v19, v32, v33, v34
    v_max_u32 v19, v19, v35
    v_cmp_eq_u32 vcc, -1, v19
    s_nop 0
    s_cbranch_vccnz g_46F6_2
    v_smfmac_f32_16x16x64_bf16 v[64:67], v[32:35], a[208:215], v172
    v_smfmac_f32_16x16x64_bf16 v[68:71], v[32:35], a[240:247], v172
    s_branch g_46L2_1
g_46L9_0:
    s_waitcnt vmcnt(1)
    v_max3_u32 v19, v24, v25, v26
    v_max_u32 v19, v19, v27
    v_cmp_eq_u32 vcc, -1, v19
    s_nop 0
    s_cbranch_vccnz g_46F9_0
    v_smfmac_f32_16x16x64_bf16 v[64:67], v[24:27], a[192:199], v172
    v_smfmac_f32_16x16x64_bf16 v[68:71], v[24:27], a[224:231], v172
    s_branch g_46L8_3
g_46L12_3:
    s_waitcnt vmcnt(1)
    v_max3_u32 v19, v36, v37, v38
    v_max_u32 v19, v19, v39
    v_cmp_eq_u32 vcc, -1, v19
    s_nop 0
    s_cbranch_vccnz g_46F12_3
    v_smfmac_f32_16x16x64_bf16 v[64:67], v[36:39], a[216:223], v172
    v_smfmac_f32_16x16x64_bf16 v[68:71], v[36:39], a[248:255], v172
    s_branch g_46L4_2
g_46F15_0:
    s_mov_b64 exec, vcc
    buffer_load_dwordx4 v[24:27], v8, s[4:7], s16 offen offset:0 sc1
    s_mov_b64 exec, -1
    s_add_u32 s23, s23, 1
    s_cmp_lt_u32 s23, 200000
    s_cbranch_scc1 g_46L15_1
    s_mov_b32 s25, 200000
    s_branch gc_47
g_46F15_1:
    s_mov_b64 exec, vcc
    buffer_load_dwordx4 v[28:31], v8, s[4:7], s16 offen offset:1024 sc1
    s_mov_b64 exec, -1
    s_add_u32 s23, s23, 1
    s_cmp_lt_u32 s23, 200000
    s_cbranch_scc1 g_46L15_2
    s_mov_b32 s25, 200000
    s_branch gc_47
g_46F15_2:
    s_mov_b64 exec, vcc
    buffer_load_dwordx4 v[32:35], v8, s[4:7], s16 offen offset:2048 sc1
    s_mov_b64 exec, -1
    s_add_u32 s23, s23, 1
    s_cmp_lt_u32 s23, 200000
    s_cbranch_scc1 g_46L15_3
    s_mov_b32 s25, 200000
    s_branch gc_47
g_46F15_3:
    s_mov_b64 exec, vcc
    buffer_load_dwordx4 v[36:39], v8, s[4:7], s16 offen offset:3072 sc1
    s_mov_b64 exec, -1
    s_add_u32 s23, s23, 1
    s_cmp_lt_u32 s23, 200000
    s_cbranch_scc1 g_46L15_0
    s_mov_b32 s25, 200000
    s_branch gc_47
g_46F7_0:
    s_mov_b64 exec, vcc
    buffer_load_dwordx4 v[24:27], v8, s[4:7], s16 offen offset:0 sc1
    s_mov_b64 exec, -1
    s_add_u32 s23, s23, 1
    s_cmp_lt_u32 s23, 200000
    s_cbranch_scc1 g_46L7_1
    s_mov_b32 s25, 200000
    s_branch gc_47
g_46F7_1:
    s_mov_b64 exec, vcc
    buffer_load_dwordx4 v[28:31], v8, s[4:7], s16 offen offset:1024 sc1
    s_mov_b64 exec, -1
    s_add_u32 s23, s23, 1
    s_cmp_lt_u32 s23, 200000
    s_cbranch_scc1 g_46L7_2
    s_mov_b32 s25, 200000
    s_branch gc_47
g_46F7_2:
    s_mov_b64 exec, vcc
    buffer_load_dwordx4 v[32:35], v8, s[4:7], s16 offen offset:2048 sc1
    s_mov_b64 exec, -1
    s_add_u32 s23, s23, 1
    s_cmp_lt_u32 s23, 200000
    s_cbranch_scc1 g_46L7_0
    s_mov_b32 s25, 200000
    s_branch gc_47
g_46F11_0:
    s_mov_b64 exec, vcc
    buffer_load_dwordx4 v[24:27], v8, s[4:7], s16 offen offset:0 sc1
    s_mov_b64 exec, -1
    s_add_u32 s23, s23, 1
    s_cmp_lt_u32 s23, 200000
    s_cbranch_scc1 g_46L11_1
    s_mov_b32 s25, 200000
    s_branch gc_47
g_46F11_1:
    s_mov_b64 exec, vcc
    buffer_load_dwordx4 v[28:31], v8, s[4:7], s16 offen offset:1024 sc1
    s_mov_b64 exec, -1
    s_add_u32 s23, s23, 1
    s_cmp_lt_u32 s23, 200000
    s_cbranch_scc1 g_46L11_3
    s_mov_b32 s25, 200000
    s_branch gc_47
g_46F11_3:
    s_mov_b64 exec, vcc
    buffer_load_dwordx4 v[36:39], v8, s[4:7], s16 offen offset:3072 sc1
    s_mov_b64 exec, -1
    s_add_u32 s23, s23, 1
    s_cmp_lt_u32 s23, 200000
    s_cbranch_scc1 g_46L11_0
    s_mov_b32 s25, 200000
    s_branch gc_47
g_46F13_0:
    s_mov_b64 exec, vcc
    buffer_load_dwordx4 v[24:27], v8, s[4:7], s16 offen offset:0 sc1
    s_mov_b64 exec, -1
    s_add_u32 s23, s23, 1
    s_cmp_lt_u32 s23, 200000
    s_cbranch_scc1 g_46L13_2
    s_mov_b32 s25, 200000
    s_branch gc_47
g_46F13_2:
    s_mov_b64 exec, vcc
    buffer_load_dwordx4 v[32:35], v8, s[4:7], s16 offen offset:2048 sc1
    s_mov_b64 exec, -1
    s_add_u32 s23, s23, 1
    s_cmp_lt_u32 s23, 200000
    s_cbranch_scc1 g_46L13_3
    s_mov_b32 s25, 200000
    s_branch gc_47
g_46F13_3:
    s_mov_b64 exec, vcc
    buffer_load_dwordx4 v[36:39], v8, s[4:7], s16 offen offset:3072 sc1
    s_mov_b64 exec, -1
    s_add_u32 s23, s23, 1
    s_cmp_lt_u32 s23, 200000
    s_cbranch_scc1 g_46L13_0
    s_mov_b32 s25, 200000
    s_branch gc_47
g_46F14_1:
    s_mov_b64 exec, vcc
    buffer_load_dwordx4 v[28:31], v8, s[4:7], s16 offen offset:1024 sc1
    s_mov_b64 exec, -1
    s_add_u32 s23, s23, 1
    s_cmp_lt_u32 s23, 200000
    s_cbranch_scc1 g_46L14_2
    s_mov_b32 s25, 200000
    s_branch gc_47
g_46F14_2:
    s_mov_b64 exec, vcc
    buffer_load_dwordx4 v[32:35], v8, s[4:7], s16 offen offset:2048 sc1
    s_mov_b64 exec, -1
    s_add_u32 s23, s23, 1
    s_cmp_lt_u32 s23, 200000
    s_cbranch_scc1 g_46L14_3
    s_mov_b32 s25, 200000
    s_branch gc_47
g_46F14_3:
    s_mov_b64 exec, vcc
    buffer_load_dwordx4 v[36:39], v8, s[4:7], s16 offen offset:3072 sc1
    s_mov_b64 exec, -1
    s_add_u32 s23, s23, 1
    s_cmp_lt_u32 s23, 200000
    s_cbranch_scc1 g_46L14_1
    s_mov_b32 s25, 200000
    s_branch gc_47
g_46F3_0:
    s_mov_b64 exec, vcc
    buffer_load_dwordx4 v[24:27], v8, s[4:7], s16 offen offset:0 sc1
    s_mov_b64 exec, -1
    s_add_u32 s23, s23, 1
    s_cmp_lt_u32 s23, 200000
    s_cbranch_scc1 g_46L3_1
    s_mov_b32 s25, 200000
    s_branch gc_47
g_46F3_1:
    s_mov_b64 exec, vcc
    buffer_load_dwordx4 v[28:31], v8, s[4:7], s16 offen offset:1024 sc1
    s_mov_b64 exec, -1
    s_add_u32 s23, s23, 1
    s_cmp_lt_u32 s23, 200000
    s_cbranch_scc1 g_46L3_0
    s_mov_b32 s25, 200000
    s_branch gc_47
g_46F5_0:
    s_mov_b64 exec, vcc
    buffer_load_dwordx4 v[24:27], v8, s[4:7], s16 offen offset:0 sc1
    s_mov_b64 exec, -1
    s_add_u32 s23, s23, 1
    s_cmp_lt_u32 s23, 200000
    s_cbranch_scc1 g_46L5_2
    s_mov_b32 s25, 200000
    s_branch gc_47
g_46F5_2:
    s_mov_b64 exec, vcc
    buffer_load_dwordx4 v[32:35], v8, s[4:7], s16 offen offset:2048 sc1
    s_mov_b64 exec, -1
    s_add_u32 s23, s23, 1
    s_cmp_lt_u32 s23, 200000
    s_cbranch_scc1 g_46L5_0
    s_mov_b32 s25, 200000
    s_branch gc_47
g_46F6_1:
    s_mov_b64 exec, vcc
    buffer_load_dwordx4 v[28:31], v8, s[4:7], s16 offen offset:1024 sc1
    s_mov_b64 exec, -1
    s_add_u32 s23, s23, 1
    s_cmp_lt_u32 s23, 200000
    s_cbranch_scc1 g_46L6_2
    s_mov_b32 s25, 200000
    s_branch gc_47
g_46F6_2:
    s_mov_b64 exec, vcc
    buffer_load_dwordx4 v[32:35], v8, s[4:7], s16 offen offset:2048 sc1
    s_mov_b64 exec, -1
    s_add_u32 s23, s23, 1
    s_cmp_lt_u32 s23, 200000
    s_cbranch_scc1 g_46L6_1
    s_mov_b32 s25, 200000
    s_branch gc_47
g_46F9_0:
    s_mov_b64 exec, vcc
    buffer_load_dwordx4 v[24:27], v8, s[4:7], s16 offen offset:0 sc1
    s_mov_b64 exec, -1
    s_add_u32 s23, s23, 1
    s_cmp_lt_u32 s23, 200000
    s_cbranch_scc1 g_46L9_3
    s_mov_b32 s25, 200000
    s_branch gc_47
g_46F9_3:
    s_mov_b64 exec, vcc
    buffer_load_dwordx4 v[36:39], v8, s[4:7], s16 offen offset:3072 sc1
    s_mov_b64 exec, -1
    s_add_u32 s23, s23, 1
    s_cmp_lt_u32 s23, 200000
    s_cbranch_scc1 g_46L9_0
    s_mov_b32 s25, 200000
    s_branch gc_47
g_46F10_1:
    s_mov_b64 exec, vcc
    buffer_load_dwordx4 v[28:31], v8, s[4:7], s16 offen offset:1024 sc1
    s_mov_b64 exec, -1
    s_add_u32 s23, s23, 1
    s_cmp_lt_u32 s23, 200000
    s_cbranch_scc1 g_46L10_3
    s_mov_b32 s25, 200000
    s_branch gc_47
g_46F10_3:
    s_mov_b64 exec, vcc
    buffer_load_dwordx4 v[36:39], v8, s[4:7], s16 offen offset:3072 sc1
    s_mov_b64 exec, -1
    s_add_u32 s23, s23, 1
    s_cmp_lt_u32 s23, 200000
    s_cbranch_scc1 g_46L10_1
    s_mov_b32 s25, 200000
    s_branch gc_47
g_46F12_2:
    s_mov_b64 exec, vcc
    buffer_load_dwordx4 v[32:35], v8, s[4:7], s16 offen offset:2048 sc1
    s_mov_b64 exec, -1
    s_add_u32 s23, s23, 1
    s_cmp_lt_u32 s23, 200000
    s_cbranch_scc1 g_46L12_3
    s_mov_b32 s25, 200000
    s_branch gc_47
g_46F12_3:
    s_mov_b64 exec, vcc
    buffer_load_dwordx4 v[36:39], v8, s[4:7], s16 offen offset:3072 sc1
    s_mov_b64 exec, -1
    s_add_u32 s23, s23, 1
    s_cmp_lt_u32 s23, 200000
    s_cbranch_scc1 g_46L12_2
    s_mov_b32 s25, 200000
    s_branch gc_47
g_46F1_0:
    s_mov_b64 exec, vcc
    buffer_load_dwordx4 v[24:27], v8, s[4:7], s16 offen offset:0 sc1
    s_mov_b64 exec, -1
    s_add_u32 s23, s23, 1
    s_cmp_lt_u32 s23, 200000
    s_cbranch_scc1 g_46L1_0
    s_mov_b32 s25, 200000
    s_branch gc_47
g_46F2_1:
    s_mov_b64 exec, vcc
    buffer_load_dwordx4 v[28:31], v8, s[4:7], s16 offen offset:1024 sc1
    s_mov_b64 exec, -1
    s_add_u32 s23, s23, 1
    s_cmp_lt_u32 s23, 200000
    s_cbranch_scc1 g_46L2_1
    s_mov_b32 s25, 200000
    s_branch gc_47
g_46F4_2:
    s_mov_b64 exec, vcc
    buffer_load_dwordx4 v[32:35], v8, s[4:7], s16 offen offset:2048 sc1
    s_mov_b64 exec, -1
    s_add_u32 s23, s23, 1
    s_cmp_lt_u32 s23, 200000
    s_cbranch_scc1 g_46L4_2
    s_mov_b32 s25, 200000
    s_branch gc_47
g_46F8_3:
    s_mov_b64 exec, vcc
    buffer_load_dwordx4 v[36:39], v8, s[4:7], s16 offen offset:3072 sc1
    s_mov_b64 exec, -1
    s_add_u32 s23, s23, 1
    s_cmp_lt_u32 s23, 200000
    s_cbranch_scc1 g_46L8_3
    s_mov_b32 s25, 200000
    s_branch gc_47
pr_48:
    v_max3_u32 v19, v96, v97, v98
    v_max3_u32 v19, v19, v99, v100
    v_max3_u32 v19, v19, v101, v102
    v_max3_u32 v19, v19, v103, v104
    v_max3_u32 v19, v19, v105, v106
    v_max_u32 v19, v19, v107
    v_cmp_eq_u32 vcc, -1, v19
    s_nop 0
    s_cbranch_vccz pf_52
    buffer_load_dwordx4 v[96:99], v10, s[4:7], s84 offen sc1
    buffer_load_dwordx4 v[100:103], v23, s[4:7], s84 offen sc1
    buffer_load_dwordx4 v[104:107], v244, s[4:7], s84 offen sc1
    s_add_u32 s23, s23, 1
    s_cmp_lt_u32 s23, 200000
    s_cbranch_scc1 pb_50
    s_mov_b32 s25, 200000
pf_52:
    buffer_store_dwordx2 v[180:181], v11, s[4:7], s42 offen
    s_branch pg_49
.p2align 6
recur_slow_w0:
    s_nop 15
    s_mov_b32 s23, s25
g_53:
    buffer_load_dwordx4 v[24:27], v2, s[4:7], s16 offen offset:0 sc1
    buffer_load_dwordx4 v[28:31], v2, s[4:7], s16 offen offset:1024 sc1
    buffer_load_dwordx4 v[32:35], v2, s[4:7], s16 offen offset:2048 sc1
    buffer_load_dwordx4 v[36:39], v2, s[4:7], s16 offen offset:3072 sc1
    s_waitcnt vmcnt(0)
    v_max3_u32 v19, v24, v25, v26
    v_max3_u32 v19, v19, v27, v28
    v_max3_u32 v19, v19, v29, v30
    v_max3_u32 v19, v19, v31, v32
    v_max3_u32 v19, v19, v33, v34
    v_max3_u32 v19, v19, v35, v36
    v_max3_u32 v19, v19, v37, v38
    v_max_u32 v19, v19, v39
    v_cmp_eq_u32 vcc, -1, v19
    s_nop 0
    s_cbranch_vccz g_53k
    s_add_u32 s23, s23, 1
    s_cmp_lt_u32 s23, 200000
    s_cbranch_scc1 g_53
    s_mov_b32 s25, 200000
g_53k:
    v_smfmac_f32_16x16x64_bf16 v[40:43], v[24:27], a[0:7], v172
    v_smfmac_f32_16x16x64_bf16 v[44:47], v[24:27], a[64:71], v172
    v_smfmac_f32_16x16x64_bf16 v[48:51], v[24:27], a[32:39], v172
    v_smfmac_f32_16x16x64_bf16 v[52:55], v[24:27], a[96:103], v172
    v_smfmac_f32_16x16x64_bf16 v[40:43], v[28:31], a[8:15], v172
    v_smfmac_f32_16x16x64_bf16 v[44:47], v[28:31], a[72:79], v172
    v_smfmac_f32_16x16x64_bf16 v[48:51], v[28:31], a[40:47], v172
    v_smfmac_f32_16x16x64_bf16 v[52:55], v[28:31], a[104:111], v172
    v_smfmac_f32_16x16x64_bf16 v[40:43], v[32:35], a[16:23], v172
    v_smfmac_f32_16x16x64_bf16 v[44:47], v[32:35], a[80:87], v172
    v_smfmac_f32_16x16x64_bf16 v[48:51], v[32:35], a[48:55], v172
    v_smfmac_f32_16x16x64_bf16 v[52:55], v[32:35], a[112:119], v172
    v_smfmac_f32_16x16x64_bf16 v[40:43], v[36:39], a[24:31], v172
    v_smfmac_f32_16x16x64_bf16 v[44:47], v[36:39], a[88:95], v172
    v_smfmac_f32_16x16x64_bf16 v[48:51], v[36:39], a[56:63], v172
    v_smfmac_f32_16x16x64_bf16 v[52:55], v[36:39], a[120:127], v172
    v_cvt_pk_bf16_f32 v72, v40, v41
    v_cvt_pk_bf16_f32 v73, v42, v43
    v_cvt_pk_bf16_f32 v74, v44, v45
    v_cvt_pk_bf16_f32 v75, v46, v47
    v_smfmac_f32_16x16x64_bf16 v[56:59], v[24:27], a[128:135], v172
    v_cvt_pk_bf16_f32 v76, v48, v49
    v_cvt_pk_bf16_f32 v77, v50, v51
    s_nop 0
    v_cvt_pk_bf16_f32 v78, v52, v53
    v_cvt_pk_bf16_f32 v79, v54, v55
    v_smfmac_f32_16x16x64_bf16 v[60:63], v[24:27], a[160:167], v172
    v_mfma_f32_16x16x32_bf16 v[88:91], v[72:75], v[84:87], 0
    v_mfma_f32_16x16x32_bf16 v[92:95], v[76:79], v[84:87], 0
    v_smfmac_f32_16x16x64_bf16 v[56:59], v[28:31], a[136:143], v172
    v_smfmac_f32_16x16x64_bf16 v[60:63], v[28:31], a[168:175], v172
    s_barrier
    ds_read_b128 v[104:107], v16 offset:2048
    ds_read_b128 v[108:111], v16 offset:3072
    ds_read_b128 v[112:115], v16 offset:4096
    ds_read_b128 v[116:119], v16 offset:5120
    ds_read_b128 v[120:123], v16 offset:6144
    ds_read_b128 v[124:127], v16 offset:7168
    v_smfmac_f32_16x16x64_bf16 v[56:59], v[32:35], a[144:151], v172
    v_smfmac_f32_16x16x64_bf16 v[60:63], v[32:35], a[176:183], v172
    v_smfmac_f32_16x16x64_bf16 v[56:59], v[36:39], a[152:159], v172
    v_smfmac_f32_16x16x64_bf16 v[60:63], v[36:39], a[184:191], v172
    s_waitcnt lgkmcnt(5)
    v_mfma_f32_16x16x32_bf16 v[88:91], v[104:107], v[84:87], v[88:91]
    s_waitcnt lgkmcnt(4)
    v_mfma_f32_16x16x32_bf16 v[92:95], v[108:111], v[84:87], v[92:95]
    s_waitcnt lgkmcnt(3)
    v_mfma_f32_16x16x32_bf16 v[88:91], v[112:115], v[84:87], v[88:91]
    s_waitcnt lgkmcnt(2)
    v_mfma_f32_16x16x32_bf16 v[92:95], v[116:119], v[84:87], v[92:95]
    s_waitcnt lgkmcnt(1)
    v_mfma_f32_16x16x32_bf16 v[88:91], v[120:123], v[84:87], v[88:91]
    s_waitcnt lgkmcnt(0)
    v_mfma_f32_16x16x32_bf16 v[92:95], v[124:127], v[84:87], v[92:95]
    v_cvt_pk_bf16_f32 v80, v56, v57
    v_cvt_pk_bf16_f32 v81, v58, v59
    v_cvt_pk_bf16_f32 v82, v60, v61
    v_cvt_pk_bf16_f32 v83, v62, v63
    ds_write_b128 v17, v[80:83] offset:8192
    s_nop 0
    v_cvt_pk_bf16_f32 v128, v88, v89
    v_cvt_pk_bf16_f32 v129, v90, v91
    v_cvt_pk_bf16_f32 v130, v92, v93
    v_cvt_pk_bf16_f32 v131, v94, v95
    s_nop 1
    v_mfma_f32_16x16x32_bf16 v[144:147], v[132:135], v[128:131], 0
    v_mfma_f32_16x16x32_bf16 v[148:151], v[136:139], v[128:131], 0
    v_mfma_f32_16x16x32_bf16 v[140:143], v[128:131], v[128:131], 0
    s_nop 1
    buffer_store_dwordx4 v[144:147], v3, s[4:7], s16 offen sc1
    s_nop 1
    buffer_store_dwordx4 v[148:151], v3, s[4:7], s16 offen offset:128 sc1
    s_nop 1
    buffer_store_dwordx4 v[140:143], v4, s[4:7], s16 offen sc1
    s_cmp_eq_u32 s15, 63
    s_waitcnt lgkmcnt(0)
    s_barrier
    s_cbranch_scc1 recur_slow_last0
    v_readfirstlane_b32 s85, v247
    s_add_u32 s94, s15, 2
    s_barrier
    s_nop 15
    s_mov_b32 s23, s25
g_54:
    buffer_load_dwordx4 v[24:27], v8, s[4:7], s16 offen offset:0 sc1
    buffer_load_dwordx4 v[28:31], v8, s[4:7], s16 offen offset:1024 sc1
    buffer_load_dwordx4 v[32:35], v8, s[4:7], s16 offen offset:2048 sc1
    buffer_load_dwordx4 v[36:39], v8, s[4:7], s16 offen offset:3072 sc1
    s_waitcnt vmcnt(0)
    v_max3_u32 v19, v24, v25, v26
    v_max3_u32 v19, v19, v27, v28
    v_max3_u32 v19, v19, v29, v30
    v_max3_u32 v19, v19, v31, v32
    v_max3_u32 v19, v19, v33, v34
    v_max3_u32 v19, v19, v35, v36
    v_max3_u32 v19, v19, v37, v38
    v_max_u32 v19, v19, v39
    v_cmp_eq_u32 vcc, -1, v19
    s_nop 0
    s_cbranch_vccz g_54k
    s_add_u32 s23, s23, 1
    s_cmp_lt_u32 s23, 200000
    s_cbranch_scc1 g_54
    s_mov_b32 s25, 200000
g_54k:
    v_smfmac_f32_16x16x64_bf16 v[64:67], v[24:27], a[192:199], v172
    v_smfmac_f32_16x16x64_bf16 v[68:71], v[24:27], a[224:231], v172
    v_smfmac_f32_16x16x64_bf16 v[64:67], v[28:31], a[200:207], v172
    v_smfmac_f32_16x16x64_bf16 v[68:71], v[28:31], a[232:239], v172
    v_smfmac_f32_16x16x64_bf16 v[64:67], v[32:35], a[208:215], v172
    v_smfmac_f32_16x16x64_bf16 v[68:71], v[32:35], a[240:247], v172
    v_smfmac_f32_16x16x64_bf16 v[64:67], v[36:39], a[216:223], v172
    v_smfmac_f32_16x16x64_bf16 v[68:71], v[36:39], a[248:255], v172
    s_nop 4
    v_cvt_pk_bf16_f32 v80, v64, v65
    v_cvt_pk_bf16_f32 v81, v66, v67
    s_nop 0
    v_cvt_pk_bf16_f32 v82, v68, v69
    v_cvt_pk_bf16_f32 v83, v70, v71
    ds_write_b128 v17, v[80:83] offset:9216
    s_waitcnt lgkmcnt(0)
    s_barrier
    s_nop 15
    s_nop 15
    s_nop 15
    s_nop 15
    buffer_store_dwordx4 v[128:131], v14, s[4:7], s19 offen sc1
    s_add_u32 s19, s19, 512
    s_mov_b32 s23, s25
fw_55:
    s_cmp_ge_u32 s85, s94
    s_cbranch_scc1 fo_56
    buffer_load_dword v247, v245, s[4:7], 0 offen sc1
    s_add_u32 s23, s23, 1
    s_waitcnt vmcnt(0)
    v_readfirstlane_b32 s85, v247
    s_cmp_lt_u32 s23, 200000
    s_cbranch_scc1 fw_55
    s_mov_b32 s25, 200000
fo_56:
    buffer_load_dwordx4 v[132:135], v12, s[4:7], s17 offen sc1
    buffer_load_dwordx4 v[136:139], v12, s[4:7], s17 offen offset:256 sc1
    s_add_u32 s17, s17, 2048
    s_min_u32 s17, s17, 17954816
    buffer_load_dword v247, v245, s[4:7], 0 offen sc1
    v_mov_b32 v40, 0
    v_mov_b32 v41, 0
    v_mov_b32 v42, 0
    v_mov_b32 v43, 0
    v_mov_b32 v44, 0
    v_mov_b32 v45, 0
    v_mov_b32 v46, 0
    v_mov_b32 v47, 0
    v_mov_b32 v48, 0
    v_mov_b32 v49, 0
    v_mov_b32 v50, 0
    v_mov_b32 v51, 0
    v_mov_b32 v52, 0
    v_mov_b32 v53, 0
    v_mov_b32 v54, 0
    v_mov_b32 v55, 0
    v_mov_b32 v56, 0
    v_mov_b32 v57, 0
    v_mov_b32 v58, 0
    v_mov_b32 v59, 0
    v_mov_b32 v60, 0
    v_mov_b32 v61, 0
    v_mov_b32 v62, 0
    v_mov_b32 v63, 0
    v_mov_b32 v64, 0
    v_mov_b32 v65, 0
    v_mov_b32 v66, 0
    v_mov_b32 v67, 0
    v_mov_b32 v68, 0
    v_mov_b32 v69, 0
    v_mov_b32 v70, 0
    v_mov_b32 v71, 0
    s_mov_b32 s21, s16
    s_mov_b32 s16, s42
    s_mov_b32 s42, s43
    s_mov_b32 s43, s44
    s_mov_b32 s44, s21
    s_add_u32 s95, s95, 524288
    s_lshr_b32 s84, s95, 8
    s_and_b32 s84, s84, 8192
    s_xor_b32 s84, s84, s46
    s_add_u32 s84, s84, s95
    s_add_u32 s15, s15, 1
    s_barrier
    s_branch recur_slow_w0
recur_slow_last0:
    buffer_store_dwordx4 v[128:131], v14, s[4:7], s19 offen sc1
    s_waitcnt vmcnt(0)
    s_branch recur_end
.p2align 6
recur_slow_w1:
    s_nop 15
    s_mov_b32 s23, s25
g_57:
    buffer_load_dwordx4 v[24:27], v2, s[4:7], s16 offen offset:0 sc1
    buffer_load_dwordx4 v[28:31], v2, s[4:7], s16 offen offset:1024 sc1
    buffer_load_dwordx4 v[32:35], v2, s[4:7], s16 offen offset:2048 sc1
    buffer_load_dwordx4 v[36:39], v2, s[4:7], s16 offen offset:3072 sc1
    s_waitcnt vmcnt(0)
    v_max3_u32 v19, v24, v25, v26
    v_max3_u32 v19, v19, v27, v28
    v_max3_u32 v19, v19, v29, v30
    v_max3_u32 v19, v19, v31, v32
    v_max3_u32 v19, v19, v33, v34
    v_max3_u32 v19, v19, v35, v36
    v_max3_u32 v19, v19, v37, v38
    v_max_u32 v19, v19, v39
    v_cmp_eq_u32 vcc, -1, v19
    s_nop 0
    s_cbranch_vccz g_57k
    s_add_u32 s23, s23, 1
    s_cmp_lt_u32 s23, 200000
    s_cbranch_scc1 g_57
    s_mov_b32 s25, 200000
g_57k:
    v_smfmac_f32_16x16x64_bf16 v[40:43], v[24:27], a[0:7], v172
    v_smfmac_f32_16x16x64_bf16 v[44:47], v[24:27], a[64:71], v172
    v_smfmac_f32_16x16x64_bf16 v[48:51], v[24:27], a[32:39], v172
    v_smfmac_f32_16x16x64_bf16 v[52:55], v[24:27], a[96:103], v172
    v_smfmac_f32_16x16x64_bf16 v[40:43], v[28:31], a[8:15], v172
    v_smfmac_f32_16x16x64_bf16 v[44:47], v[28:31], a[72:79], v172
    v_smfmac_f32_16x16x64_bf16 v[48:51], v[28:31], a[40:47], v172
    v_smfmac_f32_16x16x64_bf16 v[52:55], v[28:31], a[104:111], v172
    v_smfmac_f32_16x16x64_bf16 v[40:43], v[32:35], a[16:23], v172
    v_smfmac_f32_16x16x64_bf16 v[44:47], v[32:35], a[80:87], v172
    v_smfmac_f32_16x16x64_bf16 v[48:51], v[32:35], a[48:55], v172
    v_smfmac_f32_16x16x64_bf16 v[52:55], v[32:35], a[112:119], v172
    v_smfmac_f32_16x16x64_bf16 v[40:43], v[36:39], a[24:31], v172
    v_smfmac_f32_16x16x64_bf16 v[44:47], v[36:39], a[88:95], v172
    v_smfmac_f32_16x16x64_bf16 v[48:51], v[36:39], a[56:63], v172
    v_smfmac_f32_16x16x64_bf16 v[52:55], v[36:39], a[120:127], v172
    v_cvt_pk_bf16_f32 v72, v40, v41
    v_cvt_pk_bf16_f32 v73, v42, v43
    v_cvt_pk_bf16_f32 v74, v44, v45
    v_cvt_pk_bf16_f32 v75, v46, v47
    ds_write_b128 v17, v[72:75] offset:0
    v_cvt_pk_bf16_f32 v76, v48, v49
    v_cvt_pk_bf16_f32 v77, v50, v51
    s_nop 0
    v_cvt_pk_bf16_f32 v78, v52, v53
    v_cvt_pk_bf16_f32 v79, v54, v55
    ds_write_b128 v17, v[76:79] offset:1024
    v_smfmac_f32_16x16x64_bf16 v[56:59], v[24:27], a[128:135], v172
    v_smfmac_f32_16x16x64_bf16 v[60:63], v[24:27], a[160:167], v172
    v_smfmac_f32_16x16x64_bf16 v[56:59], v[28:31], a[136:143], v172
    s_waitcnt lgkmcnt(0)
    s_barrier
    v_smfmac_f32_16x16x64_bf16 v[60:63], v[28:31], a[168:175], v172
    v_smfmac_f32_16x16x64_bf16 v[56:59], v[32:35], a[144:151], v172
    v_smfmac_f32_16x16x64_bf16 v[60:63], v[32:35], a[176:183], v172
    v_smfmac_f32_16x16x64_bf16 v[56:59], v[36:39], a[152:159], v172
    v_smfmac_f32_16x16x64_bf16 v[60:63], v[36:39], a[184:191], v172
    s_nop 4
    v_cvt_pk_bf16_f32 v80, v56, v57
    v_cvt_pk_bf16_f32 v81, v58, v59
    s_nop 0
    v_cvt_pk_bf16_f32 v82, v60, v61
    v_cvt_pk_bf16_f32 v83, v62, v63
    ds_write_b128 v17, v[80:83] offset:8192
    v_mov_b32 v152, v228
    v_mov_b32 v153, v229
    v_mov_b32 v156, v230
    v_mov_b32 v157, v231
    v_mov_b32 v160, v232
    v_mov_b32 v161, v233
    v_mov_b32 v164, v234
    v_mov_b32 v165, v235
    s_cmp_eq_u32 s15, 63
    s_waitcnt lgkmcnt(0)
    s_barrier
    s_cbranch_scc1 recur_end
    s_nop 15
    s_nop 15
    s_nop 7
    buffer_load_dwordx4 v[208:211], v5, s[4:7], s16 offen offset:0 sc1
    buffer_load_dwordx4 v[212:215], v5, s[4:7], s16 offen offset:1024 sc1
    buffer_load_dwordx4 v[216:219], v5, s[4:7], s16 offen offset:2048 sc1
    buffer_load_dwordx4 v[220:223], v5, s[4:7], s16 offen offset:3072 sc1
    buffer_load_dword v224, v6, s[4:7], s16 offen offset:0 sc1
    buffer_load_dword v225, v6, s[4:7], s16 offen offset:256 sc1
    buffer_load_dword v226, v6, s[4:7], s16 offen offset:512 sc1
    buffer_load_dword v227, v6, s[4:7], s16 offen offset:768 sc1
    s_mov_b32 s23, s25
    ds_read_b128 v[96:99], v16 offset:8192
    ds_read_b128 v[104:107], v16 offset:12288
    ds_read_b128 v[108:111], v16 offset:14336
    v_mfma_f32_16x16x32_bf16 v[140:143], v[84:87], v[80:83], 0
    s_waitcnt lgkmcnt(2)
    v_mfma_f32_16x16x32_bf16 v[140:143], v[84:87], v[96:99], v[140:143]
    s_waitcnt lgkmcnt(1)
    v_mfma_f32_16x16x32_bf16 v[140:143], v[84:87], v[104:107], v[140:143]
    s_waitcnt lgkmcnt(0)
    v_mfma_f32_16x16x32_bf16 v[140:143], v[84:87], v[108:111], v[140:143]
    buffer_load_dwordx4 v[24:27], v5, s[4:7], s16 offen offset:0 sc1
    buffer_load_dwordx4 v[28:31], v5, s[4:7], s16 offen offset:1024 sc1
    buffer_load_dwordx4 v[32:35], v5, s[4:7], s16 offen offset:2048 sc1
    buffer_load_dwordx4 v[36:39], v5, s[4:7], s16 offen offset:3072 sc1
    buffer_load_dword v40, v6, s[4:7], s16 offen offset:0 sc1
    buffer_load_dword v41, v6, s[4:7], s16 offen offset:256 sc1
    buffer_load_dword v42, v6, s[4:7], s16 offen offset:512 sc1
    buffer_load_dword v43, v6, s[4:7], s16 offen offset:768 sc1
    v_cvt_pk_bf16_f32 v154, v140, v179
    v_cvt_pk_bf16_f32 v158, v141, v179
    v_cvt_pk_bf16_f32 v162, v142, v179
    v_cvt_pk_bf16_f32 v166, v143, v179
    s_waitcnt vmcnt(14)
    v_pk_add_f32 v[180:181], v[208:209], v[212:213]
    v_pk_add_f32 v[182:183], v[210:211], v[214:215]
    s_waitcnt vmcnt(12)
    v_pk_add_f32 v[188:189], v[216:217], v[220:221]
    v_pk_add_f32 v[190:191], v[218:219], v[222:223]
    v_pk_add_f32 v[180:181], v[180:181], v[188:189]
    v_pk_add_f32 v[182:183], v[182:183], v[190:191]
    v_pk_add_f32 v[188:189], v[180:181], v[182:183]
    v_max3_f32 v185, v180, v181, v182
    s_waitcnt vmcnt(8)
    v_pk_add_f32 v[192:193], v[224:225], v[226:227]
    v_add_f32 v188, v188, v189
    v_add_f32 v184, v192, v193
    v_max3_f32 v185, v185, v183, v184
    v_cmp_u_f32 vcc, v188, v184
    s_nop 0
    v_max_f32_dpp v185, v185, v185 row_ror:8 row_mask:0xf bank_mask:0xf
    v_mov_b32 v186, v185
    s_nop 1
    v_permlane16_swap_b32 v185, v186
    v_max_f32 v185, v185, v186
    v_mov_b32 v186, v185
    s_cbranch_vccnz ss_58
sg_60:
    s_nop 0
    v_permlane32_swap_b32 v185, v186
    v_max_f32 v185, v185, v186
    v_mul_f32 v185, s24, v185
    v_fma_f32 v180, v180, s24, -v185
    v_fma_f32 v181, v181, s24, -v185
    v_fma_f32 v182, v182, s24, -v185
    v_fma_f32 v183, v183, s24, -v185
    v_fma_f32 v184, v184, s24, -v185
    v_exp_f32 v180, v180
    v_exp_f32 v181, v181
    v_exp_f32 v182, v182
    v_exp_f32 v183, v183
    v_exp_f32 v184, v184
    v_cvt_pk_bf16_f32 v176, v180, v181
    v_cvt_pk_bf16_f32 v177, v182, v183
    v_cvt_pk_bf16_f32 v178, v184, v179
    s_nop 1
    v_mfma_f32_16x16x32_bf16 v[240:243], v[236:239], v[176:179], 0
    v_mfma_f32_16x16x32_bf16 v[188:191], v[152:155], v[176:179], 0
    v_mfma_f32_16x16x32_bf16 v[192:195], v[156:159], v[176:179], 0
    v_mfma_f32_16x16x32_bf16 v[196:199], v[160:163], v[176:179], 0
    v_mfma_f32_16x16x32_bf16 v[200:203], v[164:167], v[176:179], 0
    v_add_f32_dpp v185, v240, v240 row_ror:8 row_mask:0xf bank_mask:0xf
    v_rcp_f32 v185, v185
    v_add_f32_dpp v88, v192, v188 row_ror:8 row_mask:0xf bank_mask:0x3
    v_add_f32_dpp v89, v193, v189 row_ror:8 row_mask:0xf bank_mask:0x3
    v_add_f32_dpp v90, v194, v190 row_ror:8 row_mask:0xf bank_mask:0x3
    v_add_f32_dpp v91, v195, v191 row_ror:8 row_mask:0xf bank_mask:0x3
    s_nop 1
    v_add_f32_dpp v88, v196, v200 row_ror:8 row_mask:0xf bank_mask:0xc
    v_add_f32_dpp v89, v197, v201 row_ror:8 row_mask:0xf bank_mask:0xc
    v_add_f32_dpp v90, v198, v202 row_ror:8 row_mask:0xf bank_mask:0xc
    v_add_f32_dpp v91, v199, v203 row_ror:8 row_mask:0xf bank_mask:0xc
    v_mul_f32 v88, v88, v185
    v_mul_f32 v89, v89, v185
    v_mul_f32 v90, v90, v185
    v_mul_f32 v91, v91, v185
    v_cvt_pk_bf16_f32 v88, v88, v89
    v_cvt_pk_bf16_f32 v89, v90, v91
    buffer_store_dwordx2 v[88:89], v7, s[4:7], s16 offen sc1
    v_readfirstlane_b32 s85, v247
    s_add_u32 s94, s15, 2
    s_barrier
    s_nop 15
    s_mov_b32 s23, s25
g_61:
    buffer_load_dwordx4 v[24:27], v8, s[4:7], s16 offen offset:0 sc1
    buffer_load_dwordx4 v[28:31], v8, s[4:7], s16 offen offset:1024 sc1
    buffer_load_dwordx4 v[32:35], v8, s[4:7], s16 offen offset:2048 sc1
    buffer_load_dwordx4 v[36:39], v8, s[4:7], s16 offen offset:3072 sc1
    s_waitcnt vmcnt(0)
    v_max3_u32 v19, v24, v25, v26
    v_max3_u32 v19, v19, v27, v28
    v_max3_u32 v19, v19, v29, v30
    v_max3_u32 v19, v19, v31, v32
    v_max3_u32 v19, v19, v33, v34
    v_max3_u32 v19, v19, v35, v36
    v_max3_u32 v19, v19, v37, v38
    v_max_u32 v19, v19, v39
    v_cmp_eq_u32 vcc, -1, v19
    s_nop 0
    s_cbranch_vccz g_61k
    s_add_u32 s23, s23, 1
    s_cmp_lt_u32 s23, 200000
    s_cbranch_scc1 g_61
    s_mov_b32 s25, 200000
g_61k:
    v_smfmac_f32_16x16x64_bf16 v[64:67], v[24:27], a[192:199], v172
    v_smfmac_f32_16x16x64_bf16 v[68:71], v[24:27], a[224:231], v172
    v_smfmac_f32_16x16x64_bf16 v[64:67], v[28:31], a[200:207], v172
    v_smfmac_f32_16x16x64_bf16 v[68:71], v[28:31], a[232:239], v172
    v_smfmac_f32_16x16x64_bf16 v[64:67], v[32:35], a[208:215], v172
    v_smfmac_f32_16x16x64_bf16 v[68:71], v[32:35], a[240:247], v172
    v_smfmac_f32_16x16x64_bf16 v[64:67], v[36:39], a[216:223], v172
    v_smfmac_f32_16x16x64_bf16 v[68:71], v[36:39], a[248:255], v172
    s_nop 4
    v_cvt_pk_bf16_f32 v80, v64, v65
    v_cvt_pk_bf16_f32 v81, v66, v67
    s_nop 0
    v_cvt_pk_bf16_f32 v82, v68, v69
    v_cvt_pk_bf16_f32 v83, v70, v71
    ds_write_b128 v17, v[80:83] offset:9216
    s_waitcnt lgkmcnt(0)
    s_barrier
    s_nop 15
    s_nop 15
    s_nop 15
    s_nop 15
    s_mov_b32 s23, s25
fw_62:
    s_cmp_ge_u32 s85, s94
    s_cbranch_scc1 fo_63
    buffer_load_dword v247, v245, s[4:7], 0 offen sc1
    s_add_u32 s23, s23, 1
    s_waitcnt vmcnt(0)
    v_readfirstlane_b32 s85, v247
    s_cmp_lt_u32 s23, 200000
    s_cbranch_scc1 fw_62
    s_mov_b32 s25, 200000
fo_63:
    buffer_load_dwordx4 v[228:231], v13, s[4:7], s18 offen offset:0 sc1
    buffer_load_dwordx4 v[232:235], v13, s[4:7], s18 offen offset:256 sc1
    s_add_u32 s18, s18, 2048
    s_min_u32 s18, s18, 35780608
    buffer_load_dword v247, v245, s[4:7], 0 offen sc1
    v_mov_b32 v40, 0
    v_mov_b32 v41, 0
    v_mov_b32 v42, 0
    v_mov_b32 v43, 0
    v_mov_b32 v44, 0
    v_mov_b32 v45, 0
    v_mov_b32 v46, 0
    v_mov_b32 v47, 0
    v_mov_b32 v48, 0
    v_mov_b32 v49, 0
    v_mov_b32 v50, 0
    v_mov_b32 v51, 0
    v_mov_b32 v52, 0
    v_mov_b32 v53, 0
    v_mov_b32 v54, 0
    v_mov_b32 v55, 0
    v_mov_b32 v56, 0
    v_mov_b32 v57, 0
    v_mov_b32 v58, 0
    v_mov_b32 v59, 0
    v_mov_b32 v60, 0
    v_mov_b32 v61, 0
    v_mov_b32 v62, 0
    v_mov_b32 v63, 0
    v_mov_b32 v64, 0
    v_mov_b32 v65, 0
    v_mov_b32 v66, 0
    v_mov_b32 v67, 0
    v_mov_b32 v68, 0
    v_mov_b32 v69, 0
    v_mov_b32 v70, 0
    v_mov_b32 v71, 0
    s_mov_b32 s21, s16
    s_mov_b32 s16, s42
    s_mov_b32 s42, s43
    s_mov_b32 s43, s44
    s_mov_b32 s44, s21
    s_add_u32 s95, s95, 524288
    s_lshr_b32 s84, s95, 8
    s_and_b32 s84, s84, 8192
    s_xor_b32 s84, s84, s46
    s_add_u32 s84, s84, s95
    s_add_u32 s15, s15, 1
    s_barrier
    s_branch recur_slow_w1
sb_59:
    v_max3_u32 v19, v24, v25, v26
    v_max3_u32 v19, v19, v27, v28
    v_max3_u32 v19, v19, v29, v30
    v_max3_u32 v19, v19, v31, v32
    v_max3_u32 v19, v19, v33, v34
    v_max3_u32 v19, v19, v35, v36
    v_max3_u32 v19, v19, v37, v38
    v_max3_u32 v19, v19, v39, v40
    v_max3_u32 v19, v19, v41, v42
    v_max_u32 v19, v19, v43
    v_cmp_eq_u32 vcc, -1, v19
    s_nop 0
    s_cbranch_vccz sg_60
    buffer_load_dwordx4 v[24:27], v5, s[4:7], s16 offen offset:0 sc1
    buffer_load_dwordx4 v[28:31], v5, s[4:7], s16 offen offset:1024 sc1
    buffer_load_dwordx4 v[32:35], v5, s[4:7], s16 offen offset:2048 sc1
    buffer_load_dwordx4 v[36:39], v5, s[4:7], s16 offen offset:3072 sc1
    buffer_load_dword v40, v6, s[4:7], s16 offen offset:0 sc1
    buffer_load_dword v41, v6, s[4:7], s16 offen offset:256 sc1
    buffer_load_dword v42, v6, s[4:7], s16 offen offset:512 sc1
    buffer_load_dword v43, v6, s[4:7], s16 offen offset:768 sc1
    s_add_u32 s23, s23, 1
    s_cmp_lt_u32 s23, 200000
    s_cbranch_scc1 ss_58
    s_mov_b32 s25, 200000
    s_branch sg_60
ss_58:
    s_waitcnt vmcnt(6)
    v_pk_add_f32 v[180:181], v[24:25], v[28:29]
    v_pk_add_f32 v[182:183], v[26:27], v[30:31]
    s_waitcnt vmcnt(4)
    v_pk_add_f32 v[188:189], v[32:33], v[36:37]
    v_pk_add_f32 v[190:191], v[34:35], v[38:39]
    v_pk_add_f32 v[180:181], v[180:181], v[188:189]
    v_pk_add_f32 v[182:183], v[182:183], v[190:191]
    v_pk_add_f32 v[188:189], v[180:181], v[182:183]
    v_max3_f32 v185, v180, v181, v182
    s_waitcnt vmcnt(0)
    v_pk_add_f32 v[192:193], v[40:41], v[42:43]
    v_add_f32 v188, v188, v189
    v_add_f32 v184, v192, v193
    v_max3_f32 v185, v185, v183, v184
    v_cmp_u_f32 vcc, v188, v184
    s_nop 0
    v_max_f32_dpp v185, v185, v185 row_ror:8 row_mask:0xf bank_mask:0xf
    v_mov_b32 v186, v185
    s_nop 1
    v_permlane16_swap_b32 v185, v186
    v_max_f32 v185, v185, v186
    v_mov_b32 v186, v185
    s_cbranch_vccnz sb_59
    s_branch sg_60
.p2align 6
recur_slow_w2:
    s_nop 15
    s_mov_b32 s23, s25
g_64:
    buffer_load_dwordx4 v[24:27], v2, s[4:7], s16 offen offset:0 sc1
    buffer_load_dwordx4 v[28:31], v2, s[4:7], s16 offen offset:1024 sc1
    buffer_load_dwordx4 v[32:35], v2, s[4:7], s16 offen offset:2048 sc1
    buffer_load_dwordx4 v[36:39], v2, s[4:7], s16 offen offset:3072 sc1
    s_waitcnt vmcnt(0)
    v_max3_u32 v19, v24, v25, v26
    v_max3_u32 v19, v19, v27, v28
    v_max3_u32 v19, v19, v29, v30
    v_max3_u32 v19, v19, v31, v32
    v_max3_u32 v19, v19, v33, v34
    v_max3_u32 v19, v19, v35, v36
    v_max3_u32 v19, v19, v37, v38
    v_max_u32 v19, v19, v39
    v_cmp_eq_u32 vcc, -1, v19
    s_nop 0
    s_cbranch_vccz g_64k
    s_add_u32 s23, s23, 1
    s_cmp_lt_u32 s23, 200000
    s_cbranch_scc1 g_64
    s_mov_b32 s25, 200000
g_64k:
    v_smfmac_f32_16x16x64_bf16 v[40:43], v[24:27], a[0:7], v172
    v_smfmac_f32_16x16x64_bf16 v[44:47], v[24:27], a[64:71], v172
    v_smfmac_f32_16x16x64_bf16 v[48:51], v[24:27], a[32:39], v172
    v_smfmac_f32_16x16x64_bf16 v[52:55], v[24:27], a[96:103], v172
    v_smfmac_f32_16x16x64_bf16 v[40:43], v[28:31], a[8:15], v172
    v_smfmac_f32_16x16x64_bf16 v[44:47], v[28:31], a[72:79], v172
    v_smfmac_f32_16x16x64_bf16 v[48:51], v[28:31], a[40:47], v172
    v_smfmac_f32_16x16x64_bf16 v[52:55], v[28:31], a[104:111], v172
    v_smfmac_f32_16x16x64_bf16 v[40:43], v[32:35], a[16:23], v172
    v_smfmac_f32_16x16x64_bf16 v[44:47], v[32:35], a[80:87], v172
    v_smfmac_f32_16x16x64_bf16 v[48:51], v[32:35], a[48:55], v172
    v_smfmac_f32_16x16x64_bf16 v[52:55], v[32:35], a[112:119], v172
    v_smfmac_f32_16x16x64_bf16 v[40:43], v[36:39], a[24:31], v172
    v_smfmac_f32_16x16x64_bf16 v[44:47], v[36:39], a[88:95], v172
    v_smfmac_f32_16x16x64_bf16 v[48:51], v[36:39], a[56:63], v172
    v_smfmac_f32_16x16x64_bf16 v[52:55], v[36:39], a[120:127], v172
    v_cvt_pk_bf16_f32 v72, v40, v41
    v_cvt_pk_bf16_f32 v73, v42, v43
    v_cvt_pk_bf16_f32 v74, v44, v45
    v_cvt_pk_bf16_f32 v75, v46, v47
    ds_write_b128 v17, v[72:75] offset:0
    v_cvt_pk_bf16_f32 v76, v48, v49
    v_cvt_pk_bf16_f32 v77, v50, v51
    s_nop 0
    v_cvt_pk_bf16_f32 v78, v52, v53
    v_cvt_pk_bf16_f32 v79, v54, v55
    ds_write_b128 v17, v[76:79] offset:1024
    v_smfmac_f32_16x16x64_bf16 v[56:59], v[24:27], a[128:135], v172
    v_smfmac_f32_16x16x64_bf16 v[60:63], v[24:27], a[160:167], v172
    v_smfmac_f32_16x16x64_bf16 v[56:59], v[28:31], a[136:143], v172
    s_waitcnt lgkmcnt(0)
    s_barrier
    v_smfmac_f32_16x16x64_bf16 v[60:63], v[28:31], a[168:175], v172
    v_smfmac_f32_16x16x64_bf16 v[56:59], v[32:35], a[144:151], v172
    v_smfmac_f32_16x16x64_bf16 v[60:63], v[32:35], a[176:183], v172
    v_smfmac_f32_16x16x64_bf16 v[56:59], v[36:39], a[152:159], v172
    v_smfmac_f32_16x16x64_bf16 v[60:63], v[36:39], a[184:191], v172
    s_nop 4
    v_cvt_pk_bf16_f32 v80, v56, v57
    v_cvt_pk_bf16_f32 v81, v58, v59
    s_nop 0
    v_cvt_pk_bf16_f32 v82, v60, v61
    v_cvt_pk_bf16_f32 v83, v62, v63
    ds_write_b128 v17, v[80:83] offset:8192
    s_cmp_eq_u32 s15, 63
    s_waitcnt lgkmcnt(0)
    s_barrier
    ds_read_b128 v[96:99], v16 offset:8192
    ds_read_b128 v[100:103], v16 offset:10240
    ds_read_b128 v[108:111], v16 offset:14336
    v_mfma_f32_16x16x32_bf16 v[140:143], v[84:87], v[80:83], 0
    s_waitcnt lgkmcnt(2)
    v_mfma_f32_16x16x32_bf16 v[140:143], v[84:87], v[96:99], v[140:143]
    s_waitcnt lgkmcnt(1)
    v_mfma_f32_16x16x32_bf16 v[140:143], v[84:87], v[100:103], v[140:143]
    s_waitcnt lgkmcnt(0)
    v_mfma_f32_16x16x32_bf16 v[140:143], v[84:87], v[108:111], v[140:143]
    s_nop 7
    v_cvt_pk_bf16_f32 v168, v140, v141
    v_cvt_pk_bf16_f32 v169, v142, v143
    v_mov_b32 v170, v168
    v_mov_b32 v171, v169
    s_nop 0
    v_permlane16_swap_b32 v168, v170
    v_permlane16_swap_b32 v169, v171
    v_mov_b32 v247, s15
    s_cbranch_scc1 recur_slow_last2
    s_barrier
    s_nop 15
    s_mov_b32 s23, s25
g_65:
    buffer_load_dwordx4 v[24:27], v8, s[4:7], s16 offen offset:0 sc1
    buffer_load_dwordx4 v[28:31], v8, s[4:7], s16 offen offset:1024 sc1
    buffer_load_dwordx4 v[32:35], v8, s[4:7], s16 offen offset:2048 sc1
    buffer_load_dwordx4 v[36:39], v8, s[4:7], s16 offen offset:3072 sc1
    s_waitcnt vmcnt(0)
    v_max3_u32 v19, v24, v25, v26
    v_max3_u32 v19, v19, v27, v28
    v_max3_u32 v19, v19, v29, v30
    v_max3_u32 v19, v19, v31, v32
    v_max3_u32 v19, v19, v33, v34
    v_max3_u32 v19, v19, v35, v36
    v_max3_u32 v19, v19, v37, v38
    v_max_u32 v19, v19, v39
    v_cmp_eq_u32 vcc, -1, v19
    s_nop 0
    s_cbranch_vccz g_65k
    s_add_u32 s23, s23, 1
    s_cmp_lt_u32 s23, 200000
    s_cbranch_scc1 g_65
    s_mov_b32 s25, 200000
g_65k:
    v_smfmac_f32_16x16x64_bf16 v[64:67], v[24:27], a[192:199], v172
    v_smfmac_f32_16x16x64_bf16 v[68:71], v[24:27], a[224:231], v172
    v_smfmac_f32_16x16x64_bf16 v[64:67], v[28:31], a[200:207], v172
    v_smfmac_f32_16x16x64_bf16 v[68:71], v[28:31], a[232:239], v172
    v_smfmac_f32_16x16x64_bf16 v[64:67], v[32:35], a[208:215], v172
    v_smfmac_f32_16x16x64_bf16 v[68:71], v[32:35], a[240:247], v172
    v_smfmac_f32_16x16x64_bf16 v[64:67], v[36:39], a[216:223], v172
    v_smfmac_f32_16x16x64_bf16 v[68:71], v[36:39], a[248:255], v172
    s_nop 4
    v_cvt_pk_bf16_f32 v80, v64, v65
    v_cvt_pk_bf16_f32 v81, v66, v67
    s_nop 0
    v_cvt_pk_bf16_f32 v82, v68, v69
    v_cvt_pk_bf16_f32 v83, v70, v71
    ds_write_b128 v17, v[80:83] offset:9216
    s_waitcnt lgkmcnt(0)
    s_barrier
    s_nop 15
    s_nop 15
    s_nop 15
    s_nop 15
    buffer_store_dwordx4 v[168:171], v15, s[4:7], s20 offen sc1
    s_add_u32 s20, s20, 512
    s_add_u32 s21, s95, 1048576
    s_lshr_b32 s22, s21, 8
    s_and_b32 s22, s22, 8192
    s_xor_b32 s22, s22, s46
    s_add_u32 s21, s21, s22
    buffer_store_dwordx4 v[204:207], v9, s[4:7], s21 offen sc1
    s_add_u32 s21, s21, 262144
    buffer_store_dword v247, v246, s[4:7], 0 offen sc1
    v_mov_b32 v40, 0
    v_mov_b32 v41, 0
    v_mov_b32 v42, 0
    v_mov_b32 v43, 0
    v_mov_b32 v44, 0
    v_mov_b32 v45, 0
    v_mov_b32 v46, 0
    v_mov_b32 v47, 0
    v_mov_b32 v48, 0
    v_mov_b32 v49, 0
    v_mov_b32 v50, 0
    v_mov_b32 v51, 0
    v_mov_b32 v52, 0
    v_mov_b32 v53, 0
    v_mov_b32 v54, 0
    v_mov_b32 v55, 0
    v_mov_b32 v56, 0
    v_mov_b32 v57, 0
    v_mov_b32 v58, 0
    v_mov_b32 v59, 0
    v_mov_b32 v60, 0
    v_mov_b32 v61, 0
    v_mov_b32 v62, 0
    v_mov_b32 v63, 0
    v_mov_b32 v64, 0
    v_mov_b32 v65, 0
    v_mov_b32 v66, 0
    v_mov_b32 v67, 0
    v_mov_b32 v68, 0
    v_mov_b32 v69, 0
    v_mov_b32 v70, 0
    v_mov_b32 v71, 0
    s_mov_b32 s21, s16
    s_mov_b32 s16, s42
    s_mov_b32 s42, s43
    s_mov_b32 s43, s44
    s_mov_b32 s44, s21
    s_add_u32 s95, s95, 524288
    s_lshr_b32 s84, s95, 8
    s_and_b32 s84, s84, 8192
    s_xor_b32 s84, s84, s46
    s_add_u32 s84, s84, s95
    s_add_u32 s15, s15, 1
    s_barrier
    s_branch recur_slow_w2
recur_slow_last2:
    buffer_store_dwordx4 v[168:171], v15, s[4:7], s20 offen sc1
    s_waitcnt vmcnt(0)
    s_branch recur_end
.p2align 6
recur_slow_w3:
    s_nop 15
    s_mov_b32 s23, s25
g_66:
    buffer_load_dwordx4 v[24:27], v2, s[4:7], s16 offen offset:0 sc1
    buffer_load_dwordx4 v[28:31], v2, s[4:7], s16 offen offset:1024 sc1
    buffer_load_dwordx4 v[32:35], v2, s[4:7], s16 offen offset:2048 sc1
    buffer_load_dwordx4 v[36:39], v2, s[4:7], s16 offen offset:3072 sc1
    s_waitcnt vmcnt(0)
    v_max3_u32 v19, v24, v25, v26
    v_max3_u32 v19, v19, v27, v28
    v_max3_u32 v19, v19, v29, v30
    v_max3_u32 v19, v19, v31, v32
    v_max3_u32 v19, v19, v33, v34
    v_max3_u32 v19, v19, v35, v36
    v_max3_u32 v19, v19, v37, v38
    v_max_u32 v19, v19, v39
    v_cmp_eq_u32 vcc, -1, v19
    s_nop 0
    s_cbranch_vccz g_66k
    s_add_u32 s23, s23, 1
    s_cmp_lt_u32 s23, 200000
    s_cbranch_scc1 g_66
    s_mov_b32 s25, 200000
g_66k:
    v_smfmac_f32_16x16x64_bf16 v[40:43], v[24:27], a[0:7], v172
    v_smfmac_f32_16x16x64_bf16 v[44:47], v[24:27], a[64:71], v172
    v_smfmac_f32_16x16x64_bf16 v[48:51], v[24:27], a[32:39], v172
    v_smfmac_f32_16x16x64_bf16 v[52:55], v[24:27], a[96:103], v172
    v_smfmac_f32_16x16x64_bf16 v[40:43], v[28:31], a[8:15], v172
    v_smfmac_f32_16x16x64_bf16 v[44:47], v[28:31], a[72:79], v172
    v_smfmac_f32_16x16x64_bf16 v[48:51], v[28:31], a[40:47], v172
    v_smfmac_f32_16x16x64_bf16 v[52:55], v[28:31], a[104:111], v172
    v_smfmac_f32_16x16x64_bf16 v[40:43], v[32:35], a[16:23], v172
    v_smfmac_f32_16x16x64_bf16 v[44:47], v[32:35], a[80:87], v172
    v_smfmac_f32_16x16x64_bf16 v[48:51], v[32:35], a[48:55], v172
    v_smfmac_f32_16x16x64_bf16 v[52:55], v[32:35], a[112:119], v172
    v_smfmac_f32_16x16x64_bf16 v[40:43], v[36:39], a[24:31], v172
    v_smfmac_f32_16x16x64_bf16 v[44:47], v[36:39], a[88:95], v172
    v_smfmac_f32_16x16x64_bf16 v[48:51], v[36:39], a[56:63], v172
    v_smfmac_f32_16x16x64_bf16 v[52:55], v[36:39], a[120:127], v172
    v_cvt_pk_bf16_f32 v72, v40, v41
    v_cvt_pk_bf16_f32 v73, v42, v43
    v_cvt_pk_bf16_f32 v74, v44, v45
    v_cvt_pk_bf16_f32 v75, v46, v47
    ds_write_b128 v17, v[72:75] offset:0
    v_cvt_pk_bf16_f32 v76, v48, v49
    v_cvt_pk_bf16_f32 v77, v50, v51
    s_nop 0
    v_cvt_pk_bf16_f32 v78, v52, v53
    v_cvt_pk_bf16_f32 v79, v54, v55
    ds_write_b128 v17, v[76:79] offset:1024
    v_smfmac_f32_16x16x64_bf16 v[56:59], v[24:27], a[128:135], v172
    v_smfmac_f32_16x16x64_bf16 v[60:63], v[24:27], a[160:167], v172
    v_smfmac_f32_16x16x64_bf16 v[56:59], v[28:31], a[136:143], v172
    s_waitcnt lgkmcnt(0)
    s_barrier
    v_smfmac_f32_16x16x64_bf16 v[60:63], v[28:31], a[168:175], v172
    v_smfmac_f32_16x16x64_bf16 v[56:59], v[32:35], a[144:151], v172
    v_smfmac_f32_16x16x64_bf16 v[60:63], v[32:35], a[176:183], v172
    v_smfmac_f32_16x16x64_bf16 v[56:59], v[36:39], a[152:159], v172
    v_smfmac_f32_16x16x64_bf16 v[60:63], v[36:39], a[184:191], v172
    s_nop 4
    v_cvt_pk_bf16_f32 v80, v56, v57
    v_cvt_pk_bf16_f32 v81, v58, v59
    s_nop 0
    v_cvt_pk_bf16_f32 v82, v60, v61
    v_cvt_pk_bf16_f32 v83, v62, v63
    ds_write_b128 v17, v[80:83] offset:8192
    buffer_store_dwordx4 v[204:207], v3, s[4:7], s43 offen sc1
    buffer_store_dwordx4 v[204:207], v3, s[4:7], s43 offen offset:128 sc1
    buffer_store_dwordx4 v[204:207], v4, s[4:7], s43 offen sc1
    buffer_store_dwordx2 v[204:205], v7, s[4:7], s43 offen sc1
    buffer_store_dwordx2 v[204:205], v11, s[4:7], s43 offen sc1
    s_cmp_eq_u32 s15, 63
    s_waitcnt lgkmcnt(0)
    s_barrier
    s_cbranch_scc1 recur_end
    s_barrier
    s_nop 15
    s_mov_b32 s23, s25
g_67:
    buffer_load_dwordx4 v[24:27], v8, s[4:7], s16 offen offset:0 sc1
    buffer_load_dwordx4 v[28:31], v8, s[4:7], s16 offen offset:1024 sc1
    buffer_load_dwordx4 v[32:35], v8, s[4:7], s16 offen offset:2048 sc1
    buffer_load_dwordx4 v[36:39], v8, s[4:7], s16 offen offset:3072 sc1
    s_waitcnt vmcnt(0)
    v_max3_u32 v19, v24, v25, v26
    v_max3_u32 v19, v19, v27, v28
    v_max3_u32 v19, v19, v29, v30
    v_max3_u32 v19, v19, v31, v32
    v_max3_u32 v19, v19, v33, v34
    v_max3_u32 v19, v19, v35, v36
    v_max3_u32 v19, v19, v37, v38
    v_max_u32 v19, v19, v39
    v_cmp_eq_u32 vcc, -1, v19
    s_nop 0
    s_cbranch_vccz g_67k
    s_add_u32 s23, s23, 1
    s_cmp_lt_u32 s23, 200000
    s_cbranch_scc1 g_67
    s_mov_b32 s25, 200000
g_67k:
    v_smfmac_f32_16x16x64_bf16 v[64:67], v[24:27], a[192:199], v172
    v_smfmac_f32_16x16x64_bf16 v[68:71], v[24:27], a[224:231], v172
    v_smfmac_f32_16x16x64_bf16 v[64:67], v[28:31], a[200:207], v172
    v_smfmac_f32_16x16x64_bf16 v[68:71], v[28:31], a[232:239], v172
    v_smfmac_f32_16x16x64_bf16 v[64:67], v[32:35], a[208:215], v172
    v_smfmac_f32_16x16x64_bf16 v[68:71], v[32:35], a[240:247], v172
    v_smfmac_f32_16x16x64_bf16 v[64:67], v[36:39], a[216:223], v172
    v_smfmac_f32_16x16x64_bf16 v[68:71], v[36:39], a[248:255], v172
    s_nop 4
    v_cvt_pk_bf16_f32 v80, v64, v65
    v_cvt_pk_bf16_f32 v81, v66, v67
    s_nop 0
    v_cvt_pk_bf16_f32 v82, v68, v69
    v_cvt_pk_bf16_f32 v83, v70, v71
    s_nop 1
    v_mfma_f32_16x16x32_bf16 v[88:91], v[80:83], v[84:87], 0
    s_barrier
    ds_read_b128 v[96:99], v16 offset:9216
    ds_read_b128 v[100:103], v16 offset:11264
    ds_read_b128 v[104:107], v16 offset:13312
    s_waitcnt lgkmcnt(2)
    v_mfma_f32_16x16x32_bf16 v[88:91], v[96:99], v[84:87], v[88:91]
    s_waitcnt lgkmcnt(1)
    v_mfma_f32_16x16x32_bf16 v[88:91], v[100:103], v[84:87], v[88:91]
    s_waitcnt lgkmcnt(0)
    v_mfma_f32_16x16x32_bf16 v[88:91], v[104:107], v[84:87], v[88:91]
    s_nop 7
    buffer_store_dwordx4 v[88:91], v9, s[4:7], s84 offen sc1
    s_add_u32 s22, s84, 262144
    s_nop 15
    s_nop 15
    s_nop 15
    s_nop 15
    s_nop 15
    s_nop 15
    s_nop 15
    s_nop 15
    s_mov_b32 s23, s25
    buffer_load_dwordx4 v[96:99], v10, s[4:7], s84 offen sc1
    buffer_load_dwordx4 v[100:103], v23, s[4:7], s84 offen sc1
    buffer_load_dwordx4 v[104:107], v244, s[4:7], s84 offen sc1
    v_mov_b32 v40, 0
    v_mov_b32 v41, 0
    v_mov_b32 v42, 0
    v_mov_b32 v43, 0
    v_mov_b32 v44, 0
    v_mov_b32 v45, 0
    v_mov_b32 v46, 0
    v_mov_b32 v47, 0
    v_mov_b32 v48, 0
    v_mov_b32 v49, 0
    v_mov_b32 v50, 0
    v_mov_b32 v51, 0
    v_mov_b32 v52, 0
    v_mov_b32 v53, 0
    v_mov_b32 v54, 0
    v_mov_b32 v55, 0
    v_mov_b32 v56, 0
    v_mov_b32 v57, 0
    v_mov_b32 v58, 0
    v_mov_b32 v59, 0
    v_mov_b32 v60, 0
    v_mov_b32 v61, 0
    v_mov_b32 v62, 0
    v_mov_b32 v63, 0
    v_mov_b32 v64, 0
    v_mov_b32 v65, 0
    v_mov_b32 v66, 0
    v_mov_b32 v67, 0
    v_mov_b32 v68, 0
    v_mov_b32 v69, 0
    v_mov_b32 v70, 0
    v_mov_b32 v71, 0
pb_70:
    s_waitcnt vmcnt(2)
    v_pk_add_f32 v[120:121], v[88:89], v[96:97]
    v_pk_add_f32 v[122:123], v[90:91], v[98:99]
    s_waitcnt vmcnt(1)
    v_pk_add_f32 v[120:121], v[120:121], v[100:101]
    v_pk_add_f32 v[122:123], v[122:123], v[102:103]
    s_waitcnt vmcnt(0)
    v_pk_add_f32 v[120:121], v[120:121], v[104:105]
    v_pk_add_f32 v[122:123], v[122:123], v[106:107]
    v_cvt_pk_bf16_f32 v180, v120, v121
    v_pk_add_f32 v[124:125], v[120:121], v[122:123]
    v_cvt_pk_bf16_f32 v181, v122, v123
    v_cmpx_o_f32 vcc, v124, v125
    buffer_store_dwordx2 v[180:181], v11, s[4:7], s42 offen sc1
    s_cmp_eq_u64 vcc, -1
    s_mov_b64 exec, -1
    s_cbranch_scc0 pr_68
pg_69:
    s_barrier
    s_mov_b32 s21, s16
    s_mov_b32 s16, s42
    s_mov_b32 s42, s43
    s_mov_b32 s43, s44
    s_mov_b32 s44, s21
    s_add_u32 s95, s95, 524288
    s_lshr_b32 s84, s95, 8
    s_and_b32 s84, s84, 8192
    s_xor_b32 s84, s84, s46
    s_add_u32 s84, s84, s95
    s_add_u32 s15, s15, 1
    s_branch recur_slow_w3
pr_68:
    v_max3_u32 v19, v96, v97, v98
    v_max3_u32 v19, v19, v99, v100
    v_max3_u32 v19, v19, v101, v102
    v_max3_u32 v19, v19, v103, v104
    v_max3_u32 v19, v19, v105, v106
    v_max_u32 v19, v19, v107
    v_cmp_eq_u32 vcc, -1, v19
    s_nop 0
    s_cbranch_vccz pf_72
    buffer_load_dwordx4 v[96:99], v10, s[4:7], s84 offen sc1
    buffer_load_dwordx4 v[100:103], v23, s[4:7], s84 offen sc1
    buffer_load_dwordx4 v[104:107], v244, s[4:7], s84 offen sc1
    s_add_u32 s23, s23, 1
    s_cmp_lt_u32 s23, 200000
    s_cbranch_scc1 pb_70
    s_mov_b32 s25, 200000
pf_72:
    buffer_store_dwordx2 v[180:181], v11, s[4:7], s42 offen sc1
    s_branch pg_69
recur_end:
    s_barrier
    v_mov_b32 v247, 64
    buffer_store_dword v247, v246, s[4:7], 0 offen sc1
    s_endpgm
.section .rodata,"a"
.p2align 6
.amdhsa_kernel concat_heads__spectral_gfnet__memory_aug_recurrent_mem_tr__prompt_kernel
  .amdhsa_next_free_vgpr 512
  .amdhsa_next_free_sgpr 102
  .amdhsa_accum_offset 256
  .amdhsa_group_segment_fixed_size 0
  .amdhsa_kernarg_size 104
  .amdhsa_user_sgpr_count 2
  .amdhsa_user_sgpr_kernarg_segment_ptr 1
  .amdhsa_system_sgpr_workgroup_id_x 1
  .amdhsa_float_denorm_mode_32 3
.end_amdhsa_kernel
```

```asm
; @launch kernel=concat_heads__spectral_gfnet__memory_aug_recurrent_mem_tr__prompt_kernel grid=(256,1,1) block=(256,1,1) lds=163840
.amdgcn_target "amdgcn-amd-amdhsa--gfx950"
.text
.globl concat_heads__spectral_gfnet__memory_aug_recurrent_mem_tr__prompt_kernel
.p2align 8
.type concat_heads__spectral_gfnet__memory_aug_recurrent_mem_tr__prompt_kernel,@function
concat_heads__spectral_gfnet__memory_aug_recurrent_mem_tr__prompt_kernel:
    s_cmp_ge_u32 s2, 256
    s_cbranch_scc1 W_end
    s_load_dwordx2 s[100:101], s[0:1], 88
    s_mov_b32 s97, s2
    s_mov_b32 s98, 0
    s_getreg_b32 s3, hwreg(HW_REG_XCC_ID, 0, 3)
role_start:
    s_andn2_b32 s2, s97, 7
    s_or_b32 s2, s2, s3
    s_bitcmp1_b32 s3, 2
    s_cbranch_scc0 R_entry
    s_cmp_ge_u32 s2, 256
    s_cbranch_scc1 W_end
    s_load_dwordx2 s[4:5], s[0:1], 96
    v_lshrrev_b32 v5, 6, v0
    v_and_b32 v1, 63, v0
    v_readfirstlane_b32 s16, v5
    s_mov_b32 s6, 268435456
    s_mov_b32 s7, 0x20000
    s_waitcnt lgkmcnt(0)
    s_lshr_b32 s90, s2, 6
    s_bfe_u32 s91, s2, 0x30003
    s_lshl_b32 s91, s91, 2
    s_and_b32 s17, s3, 3
    s_add_u32 s91, s91, s17
    s_lshl_b32 s93, s17, 3
    s_lshr_b32 s17, s91, 2
    s_add_u32 s93, s93, s17
    s_mov_b32 s92, 0
    s_lshl_b32 s17, s93, 2
    s_add_u32 s17, s17, s16
    s_lshl_b32 s18, s90, 7
    s_add_u32 s18, s18, s17
    s_lshl_b32 s18, s18, 7
    s_add_u32 s18, s18, 100663296
    s_lshl_b32 s20, s17, 7
    s_add_u32 s20, s20, 100728832
    s_cmp_eq_u32 s90, 3
    s_cselect_b32 s18, s20, s18
    s_cselect_b64 exec, 7, 1
    v_mov_b32 v5, s18
    s_and_b32 s18, s17, 31
    s_lshl_b32 s18, s18, 2
    s_lshr_b32 s20, s93, 3
    s_add_u32 s18, s18, s20
    s_lshl_b32 s18, s18, 7
    s_add_u32 s18, s18, 100745216
    v_writelane_b32 v5, s18, 1
    s_lshl_b32 s18, s17, 7
    s_add_u32 s18, s18, 100761600
    v_writelane_b32 v5, s18, 2
    v_mov_b32 v6, 0
    buffer_store_dword v6, v5, s[4:7], 0 offen sc1
    s_mov_b64 exec, -1
    s_cmp_eq_u32 s90, 3
    s_cbranch_scc1 W_F
    s_load_dwordx2 s[8:9], s[0:1], 24
    s_mov_b32 s10, 4194304
    s_mov_b32 s11, 0x20000
    s_lshr_b32 s17, s2, 3
    s_lshl_b32 s17, s17, 15
    v_lshlrev_b32 v5, 7, v0
    s_waitcnt lgkmcnt(0)
    buffer_load_dword v254, v5, s[8:11], s17 offen
    s_cmp_lg_u32 s90, 0
    s_cbranch_scc1 W_P
    s_waitcnt vmcnt(0)
    s_barrier
    s_or_b32 s17, s16, s98
    s_cmp_lg_u32 s17, 0
    s_cbranch_scc1 vote_1
    s_lshl_b32 s17, s91, 14
    s_add_u32 s17, s17, 205520896
    v_lshlrev_b32 v5, 2, v1
    v_add_u32 v5, s17, v5
    v_add_u32 v6, 8192, v5
    s_mov_b32 s20, -1
    s_mov_b32 s21, -1
    s_mov_b64 exec, 1
    buffer_store_dword v1, v5, s[4:7], 0 offen sc1
    s_mov_b32 s22, 0
vp_2:
    s_add_u32 s22, s22, 1
    s_getreg_b32 s18, hwreg(HW_REG_IB_STS, 0, 4)
    s_cmp_lt_u32 s22, 2048
    s_cselect_b32 s18, s18, 0
    s_cmp_lg_u32 s18, 0
    s_cbranch_scc1 vp_2
    s_min_u32 s20, s20, s22
    buffer_store_dword v1, v6, s[4:7], 0 offen sc1
    s_mov_b32 s22, 0
vp_3:
    s_add_u32 s22, s22, 1
    s_getreg_b32 s18, hwreg(HW_REG_IB_STS, 0, 4)
    s_cmp_lt_u32 s22, 2048
    s_cselect_b32 s18, s18, 0
    s_cmp_lg_u32 s18, 0
    s_cbranch_scc1 vp_3
    s_min_u32 s21, s21, s22
    buffer_store_dword v1, v5, s[4:7], 0 offen sc1
    s_mov_b32 s22, 0
vp_4:
    s_add_u32 s22, s22, 1
    s_getreg_b32 s18, hwreg(HW_REG_IB_STS, 0, 4)
    s_cmp_lt_u32 s22, 2048
    s_cselect_b32 s18, s18, 0
    s_cmp_lg_u32 s18, 0
    s_cbranch_scc1 vp_4
    s_min_u32 s20, s20, s22
    buffer_store_dword v1, v6, s[4:7], 0 offen sc1
    s_mov_b32 s22, 0
vp_5:
    s_add_u32 s22, s22, 1
    s_getreg_b32 s18, hwreg(HW_REG_IB_STS, 0, 4)
    s_cmp_lt_u32 s22, 2048
    s_cselect_b32 s18, s18, 0
    s_cmp_lg_u32 s18, 0
    s_cbranch_scc1 vp_5
    s_min_u32 s21, s21, s22
    buffer_store_dword v1, v5, s[4:7], 0 offen sc1
    s_mov_b32 s22, 0
vp_6:
    s_add_u32 s22, s22, 1
    s_getreg_b32 s18, hwreg(HW_REG_IB_STS, 0, 4)
    s_cmp_lt_u32 s22, 2048
    s_cselect_b32 s18, s18, 0
    s_cmp_lg_u32 s18, 0
    s_cbranch_scc1 vp_6
    s_min_u32 s20, s20, s22
    buffer_store_dword v1, v6, s[4:7], 0 offen sc1
    s_mov_b32 s22, 0
vp_7:
    s_add_u32 s22, s22, 1
    s_getreg_b32 s18, hwreg(HW_REG_IB_STS, 0, 4)
    s_cmp_lt_u32 s22, 2048
    s_cselect_b32 s18, s18, 0
    s_cmp_lg_u32 s18, 0
    s_cbranch_scc1 vp_7
    s_min_u32 s21, s21, s22
    buffer_store_dword v1, v5, s[4:7], 0 offen sc1
    s_mov_b32 s22, 0
vp_8:
    s_add_u32 s22, s22, 1
    s_getreg_b32 s18, hwreg(HW_REG_IB_STS, 0, 4)
    s_cmp_lt_u32 s22, 2048
    s_cselect_b32 s18, s18, 0
    s_cmp_lg_u32 s18, 0
    s_cbranch_scc1 vp_8
    s_min_u32 s20, s20, s22
    buffer_store_dword v1, v6, s[4:7], 0 offen sc1
    s_mov_b32 s22, 0
vp_9:
    s_add_u32 s22, s22, 1
    s_getreg_b32 s18, hwreg(HW_REG_IB_STS, 0, 4)
    s_cmp_lt_u32 s22, 2048
    s_cselect_b32 s18, s18, 0
    s_cmp_lg_u32 s18, 0
    s_cbranch_scc1 vp_9
    s_min_u32 s21, s21, s22
    s_and_b32 s17, s97, 3
    s_lshl_b32 s17, s17, 3
    s_lshl_b32 s17, 0x40, s17
    s_cmp_lt_u32 s20, s21
    s_cselect_b32 s17, s17, 0
    s_andn2_b32 s18, s97, 3
    v_mov_b32 v5, s18
    v_mov_b32 v6, s17
    global_atomic_add v5, v6, s[100:101] sc1
    s_mov_b64 exec, -1
    s_waitcnt vmcnt(0)
vote_1:
    s_waitcnt vmcnt(0)
    s_barrier
    s_cmp_lg_u32 s16, 0
    s_cbranch_scc1 reg_10
    s_and_b32 s17, s2, 3
    s_lshl_b32 s17, s17, 3
    s_lshl_b32 s18, s98, 2
    s_add_u32 s17, s17, s18
    s_lshl_b32 s17, 1, s17
    s_andn2_b32 s18, s2, 3
    v_mov_b32 v5, s18
    v_mov_b32 v6, s17
    s_mov_b64 exec, 1
    global_atomic_add v5, v6, s[100:101] sc1
    s_mov_b64 exec, -1
reg_10:
W_P:
    s_load_dwordx2 s[12:13], s[0:1], 40
    s_load_dwordx2 s[28:29], s[0:1], 48
    s_load_dwordx2 s[30:31], s[0:1], 56
    s_load_dwordx2 s[8:9], s[0:1], 24
    s_mov_b32 s10, 4194304
    s_mov_b32 s11, 0x20000
    s_mov_b32 s14, 8388608
    s_mov_b32 s15, 0x20000
    s_waitcnt lgkmcnt(0)
    s_cmp_eq_u32 s90, 1
    s_cselect_b64 s[12:13], s[28:29], s[12:13]
    s_cmp_eq_u32 s90, 2
    s_cselect_b64 s[12:13], s[30:31], s[12:13]
    s_lshl_b32 s28, s93, 2
    s_add_u32 s28, s28, s16
    s_lshl_b32 s20, s28, 6
    v_lshrrev_b32 v5, 2, v1
    v_and_b32 v6, 3, v1
    v_lshlrev_b32 v8, 4, v6
    v_lshl_add_u32 v7, v5, 13, v8
    s_mul_i32 s19, s16, 40960
    s_and_b32 s17, s93, 3
    s_lshl_b32 s17, s17, 8
    v_add_lshl_u32 v2, v0, s17, 13
    s_andn2_b32 s17, s93, 3
    s_lshl_b32 s17, s17, 8
    buffer_load_dword v253, v2, s[12:15], s17 offen offset:384
    s_add_u32 m0, s19, 0
    s_nop 0
    buffer_load_dwordx4 v7, s[12:15], s20 offen lds
    s_add_u32 s20, s20, 131072
    s_add_u32 m0, s19, 1024
    s_nop 0
    buffer_load_dwordx4 v7, s[12:15], s20 offen lds
    s_add_u32 s20, s20, 131072
    s_add_u32 m0, s19, 2048
    s_nop 0
    buffer_load_dwordx4 v7, s[12:15], s20 offen lds
    s_add_u32 s20, s20, 131072
    s_add_u32 m0, s19, 3072
    s_nop 0
    buffer_load_dwordx4 v7, s[12:15], s20 offen lds
    s_add_u32 s20, s20, 131072
    v_bfe_u32 v5, v1, 2, 2
    v_lshrrev_b32 v6, 4, v1
    v_lshl_add_u32 v5, v6, 3, v5
    v_lshl_add_u32 v8, v5, 6, v8
    v_add_u32 v8, s19, v8
    s_cmp_eq_u32 s90, 0
    s_cbranch_scc1 nq_11
    s_waitcnt vmcnt(6)
    s_barrier
    s_cmp_lg_u32 s16, 0
    s_cbranch_scc1 reg_12
    s_and_b32 s17, s2, 3
    s_lshl_b32 s17, s17, 3
    s_lshl_b32 s18, s98, 2
    s_add_u32 s17, s17, s18
    s_lshl_b32 s17, 1, s17
    s_andn2_b32 s18, s2, 3
    v_mov_b32 v5, s18
    v_mov_b32 v6, s17
    s_mov_b64 exec, 1
    global_atomic_add v5, v6, s[100:101] sc1
    s_mov_b64 exec, -1
reg_12:
    s_barrier
nq_11:
    s_add_u32 m0, s19, 4096
    s_nop 0
    buffer_load_dwordx4 v7, s[12:15], s20 offen lds
    s_add_u32 s20, s20, 131072
    s_add_u32 m0, s19, 5120
    s_nop 0
    buffer_load_dwordx4 v7, s[12:15], s20 offen lds
    s_add_u32 s20, s20, 131072
    s_add_u32 m0, s19, 6144
    s_nop 0
    buffer_load_dwordx4 v7, s[12:15], s20 offen lds
    s_add_u32 s20, s20, 131072
    s_add_u32 m0, s19, 7168
    s_nop 0
    buffer_load_dwordx4 v7, s[12:15], s20 offen lds
    s_add_u32 s20, s20, 131072
    s_add_u32 m0, s19, 8192
    s_nop 0
    buffer_load_dwordx4 v7, s[12:15], s20 offen lds
    s_add_u32 s20, s20, 131072
    s_add_u32 m0, s19, 9216
    s_nop 0
    buffer_load_dwordx4 v7, s[12:15], s20 offen lds
    s_add_u32 s20, s20, 131072
    s_add_u32 m0, s19, 10240
    s_nop 0
    buffer_load_dwordx4 v7, s[12:15], s20 offen lds
    s_add_u32 s20, s20, 131072
    s_add_u32 m0, s19, 11264
    s_nop 0
    buffer_load_dwordx4 v7, s[12:15], s20 offen lds
    s_add_u32 s20, s20, 131072
    s_add_u32 m0, s19, 12288
    s_nop 0
    buffer_load_dwordx4 v7, s[12:15], s20 offen lds
    s_add_u32 s20, s20, 131072
    s_add_u32 m0, s19, 13312
    s_nop 0
    buffer_load_dwordx4 v7, s[12:15], s20 offen lds
    s_add_u32 s20, s20, 131072
    s_add_u32 m0, s19, 14336
    s_nop 0
    buffer_load_dwordx4 v7, s[12:15], s20 offen lds
    s_add_u32 s20, s20, 131072
    s_add_u32 m0, s19, 15360
    s_nop 0
    buffer_load_dwordx4 v7, s[12:15], s20 offen lds
    s_add_u32 s20, s20, 131072
    s_add_u32 m0, s19, 16384
    s_nop 0
    buffer_load_dwordx4 v7, s[12:15], s20 offen lds
    s_add_u32 s20, s20, 131072
    s_add_u32 m0, s19, 17408
    s_nop 0
    buffer_load_dwordx4 v7, s[12:15], s20 offen lds
    s_add_u32 s20, s20, 131072
    s_add_u32 m0, s19, 18432
    s_nop 0
    buffer_load_dwordx4 v7, s[12:15], s20 offen lds
    s_add_u32 s20, s20, 131072
    s_add_u32 m0, s19, 19456
    s_nop 0
    buffer_load_dwordx4 v7, s[12:15], s20 offen lds
    s_add_u32 s20, s20, 131072
    s_add_u32 m0, s19, 20480
    s_nop 0
    buffer_load_dwordx4 v7, s[12:15], s20 offen lds
    s_add_u32 s20, s20, 131072
    s_add_u32 m0, s19, 21504
    s_nop 0
    buffer_load_dwordx4 v7, s[12:15], s20 offen lds
    s_add_u32 s20, s20, 131072
    s_add_u32 m0, s19, 22528
    s_nop 0
    buffer_load_dwordx4 v7, s[12:15], s20 offen lds
    s_add_u32 s20, s20, 131072
    s_add_u32 m0, s19, 23552
    s_nop 0
    buffer_load_dwordx4 v7, s[12:15], s20 offen lds
    s_add_u32 s20, s20, 131072
    s_add_u32 m0, s19, 24576
    s_nop 0
    buffer_load_dwordx4 v7, s[12:15], s20 offen lds
    s_add_u32 s20, s20, 131072
    s_add_u32 m0, s19, 25600
    s_nop 0
    buffer_load_dwordx4 v7, s[12:15], s20 offen lds
    s_add_u32 s20, s20, 131072
    s_add_u32 m0, s19, 26624
    s_nop 0
    buffer_load_dwordx4 v7, s[12:15], s20 offen lds
    s_add_u32 s20, s20, 131072
    s_add_u32 m0, s19, 27648
    s_nop 0
    buffer_load_dwordx4 v7, s[12:15], s20 offen lds
    s_add_u32 s20, s20, 131072
    s_add_u32 m0, s19, 28672
    s_nop 0
    buffer_load_dwordx4 v7, s[12:15], s20 offen lds
    s_add_u32 s20, s20, 131072
    s_add_u32 m0, s19, 29696
    s_nop 0
    buffer_load_dwordx4 v7, s[12:15], s20 offen lds
    s_add_u32 s20, s20, 131072
    s_add_u32 m0, s19, 30720
    s_nop 0
    buffer_load_dwordx4 v7, s[12:15], s20 offen lds
    s_add_u32 s20, s20, 131072
    s_add_u32 m0, s19, 31744
    s_nop 0
    buffer_load_dwordx4 v7, s[12:15], s20 offen lds
    s_add_u32 s20, s20, 131072
    s_add_u32 m0, s19, 32768
    s_nop 0
    buffer_load_dwordx4 v7, s[12:15], s20 offen lds
    s_add_u32 s20, s20, 131072
    s_add_u32 m0, s19, 33792
    s_nop 0
    buffer_load_dwordx4 v7, s[12:15], s20 offen lds
    s_add_u32 s20, s20, 131072
    s_add_u32 m0, s19, 34816
    s_nop 0
    buffer_load_dwordx4 v7, s[12:15], s20 offen lds
    s_add_u32 s20, s20, 131072
    s_add_u32 m0, s19, 35840
    s_nop 0
    buffer_load_dwordx4 v7, s[12:15], s20 offen lds
    s_add_u32 s20, s20, 131072
    s_add_u32 m0, s19, 36864
    s_nop 0
    buffer_load_dwordx4 v7, s[12:15], s20 offen lds
    s_add_u32 s20, s20, 131072
    s_add_u32 m0, s19, 37888
    s_nop 0
    buffer_load_dwordx4 v7, s[12:15], s20 offen lds
    s_add_u32 s20, s20, 131072
    s_add_u32 m0, s19, 38912
    s_nop 0
    buffer_load_dwordx4 v7, s[12:15], s20 offen lds
    s_add_u32 s20, s20, 131072
    s_add_u32 m0, s19, 39936
    s_nop 0
    buffer_load_dwordx4 v7, s[12:15], s20 offen lds
    s_add_u32 s20, s20, 131072
    s_waitcnt vmcnt(38)
    ds_read_b64_tr_b16 a[0:1], v8 offset:0
    ds_read_b64_tr_b16 a[2:3], v8 offset:256
    ds_read_b64_tr_b16 a[4:5], v8 offset:8
    ds_read_b64_tr_b16 a[6:7], v8 offset:264
    s_waitcnt vmcnt(36)
    ds_read_b64_tr_b16 a[8:9], v8 offset:2048
    ds_read_b64_tr_b16 a[10:11], v8 offset:2304
    ds_read_b64_tr_b16 a[12:13], v8 offset:2056
    ds_read_b64_tr_b16 a[14:15], v8 offset:2312
    s_waitcnt lgkmcnt(4)
    s_add_u32 m0, s19, 0
    s_nop 0
    buffer_load_dwordx4 v7, s[12:15], s20 offen lds
    s_add_u32 s20, s20, 131072
    s_add_u32 m0, s19, 1024
    s_nop 0
    buffer_load_dwordx4 v7, s[12:15], s20 offen lds
    s_add_u32 s20, s20, 131072
    s_waitcnt vmcnt(36)
    ds_read_b64_tr_b16 a[16:17], v8 offset:4096
    ds_read_b64_tr_b16 a[18:19], v8 offset:4352
    ds_read_b64_tr_b16 a[20:21], v8 offset:4104
    ds_read_b64_tr_b16 a[22:23], v8 offset:4360
    s_waitcnt lgkmcnt(4)
    s_add_u32 m0, s19, 2048
    s_nop 0
    buffer_load_dwordx4 v7, s[12:15], s20 offen lds
    s_add_u32 s20, s20, 131072
    s_add_u32 m0, s19, 3072
    s_nop 0
    buffer_load_dwordx4 v7, s[12:15], s20 offen lds
    s_add_u32 s20, s20, 131072
    s_waitcnt vmcnt(36)
    ds_read_b64_tr_b16 a[24:25], v8 offset:6144
    ds_read_b64_tr_b16 a[26:27], v8 offset:6400
    ds_read_b64_tr_b16 a[28:29], v8 offset:6152
    ds_read_b64_tr_b16 a[30:31], v8 offset:6408
    s_waitcnt lgkmcnt(4)
    s_add_u32 m0, s19, 4096
    s_nop 0
    buffer_load_dwordx4 v7, s[12:15], s20 offen lds
    s_add_u32 s20, s20, 131072
    s_add_u32 m0, s19, 5120
    s_nop 0
    buffer_load_dwordx4 v7, s[12:15], s20 offen lds
    s_add_u32 s20, s20, 131072
    s_waitcnt vmcnt(36)
    ds_read_b64_tr_b16 a[32:33], v8 offset:8192
    ds_read_b64_tr_b16 a[34:35], v8 offset:8448
    ds_read_b64_tr_b16 a[36:37], v8 offset:8200
    ds_read_b64_tr_b16 a[38:39], v8 offset:8456
    s_waitcnt lgkmcnt(4)
    s_add_u32 m0, s19, 6144
    s_nop 0
    buffer_load_dwordx4 v7, s[12:15], s20 offen lds
    s_add_u32 s20, s20, 131072
    s_add_u32 m0, s19, 7168
    s_nop 0
    buffer_load_dwordx4 v7, s[12:15], s20 offen lds
    s_add_u32 s20, s20, 131072
    s_waitcnt vmcnt(36)
    ds_read_b64_tr_b16 a[40:41], v8 offset:10240
    ds_read_b64_tr_b16 a[42:43], v8 offset:10496
    ds_read_b64_tr_b16 a[44:45], v8 offset:10248
    ds_read_b64_tr_b16 a[46:47], v8 offset:10504
    s_waitcnt lgkmcnt(4)
    s_add_u32 m0, s19, 8192
    s_nop 0
    buffer_load_dwordx4 v7, s[12:15], s20 offen lds
    s_add_u32 s20, s20, 131072
    s_add_u32 m0, s19, 9216
    s_nop 0
    buffer_load_dwordx4 v7, s[12:15], s20 offen lds
    s_add_u32 s20, s20, 131072
    s_waitcnt vmcnt(36)
    ds_read_b64_tr_b16 a[48:49], v8 offset:12288
    ds_read_b64_tr_b16 a[50:51], v8 offset:12544
    ds_read_b64_tr_b16 a[52:53], v8 offset:12296
    ds_read_b64_tr_b16 a[54:55], v8 offset:12552
    s_waitcnt lgkmcnt(4)
    s_add_u32 m0, s19, 10240
    s_nop 0
    buffer_load_dwordx4 v7, s[12:15], s20 offen lds
    s_add_u32 s20, s20, 131072
    s_add_u32 m0, s19, 11264
    s_nop 0
    buffer_load_dwordx4 v7, s[12:15], s20 offen lds
    s_add_u32 s20, s20, 131072
    s_waitcnt vmcnt(36)
    ds_read_b64_tr_b16 a[56:57], v8 offset:14336
    ds_read_b64_tr_b16 a[58:59], v8 offset:14592
    ds_read_b64_tr_b16 a[60:61], v8 offset:14344
    ds_read_b64_tr_b16 a[62:63], v8 offset:14600
    s_waitcnt lgkmcnt(4)
    s_add_u32 m0, s19, 12288
    s_nop 0
    buffer_load_dwordx4 v7, s[12:15], s20 offen lds
    s_add_u32 s20, s20, 131072
    s_add_u32 m0, s19, 13312
    s_nop 0
    buffer_load_dwordx4 v7, s[12:15], s20 offen lds
    s_add_u32 s20, s20, 131072
    s_waitcnt vmcnt(36)
    ds_read_b64_tr_b16 a[64:65], v8 offset:16384
    ds_read_b64_tr_b16 a[66:67], v8 offset:16640
    ds_read_b64_tr_b16 a[68:69], v8 offset:16392
    ds_read_b64_tr_b16 a[70:71], v8 offset:16648
    s_waitcnt lgkmcnt(4)
    s_add_u32 m0, s19, 14336
    s_nop 0
    buffer_load_dwordx4 v7, s[12:15], s20 offen lds
    s_add_u32 s20, s20, 131072
    s_add_u32 m0, s19, 15360
    s_nop 0
    buffer_load_dwordx4 v7, s[12:15], s20 offen lds
    s_add_u32 s20, s20, 131072
    s_waitcnt vmcnt(36)
    ds_read_b64_tr_b16 a[72:73], v8 offset:18432
    ds_read_b64_tr_b16 a[74:75], v8 offset:18688
    ds_read_b64_tr_b16 a[76:77], v8 offset:18440
    ds_read_b64_tr_b16 a[78:79], v8 offset:18696
    s_waitcnt lgkmcnt(4)
    s_add_u32 m0, s19, 16384
    s_nop 0
    buffer_load_dwordx4 v7, s[12:15], s20 offen lds
    s_add_u32 s20, s20, 131072
    s_add_u32 m0, s19, 17408
    s_nop 0
    buffer_load_dwordx4 v7, s[12:15], s20 offen lds
    s_add_u32 s20, s20, 131072
    s_waitcnt vmcnt(36)
    ds_read_b64_tr_b16 a[80:81], v8 offset:20480
    ds_read_b64_tr_b16 a[82:83], v8 offset:20736
    ds_read_b64_tr_b16 a[84:85], v8 offset:20488
    ds_read_b64_tr_b16 a[86:87], v8 offset:20744
    s_waitcnt lgkmcnt(4)
    s_add_u32 m0, s19, 18432
    s_nop 0
    buffer_load_dwordx4 v7, s[12:15], s20 offen lds
    s_add_u32 s20, s20, 131072
    s_add_u32 m0, s19, 19456
    s_nop 0
    buffer_load_dwordx4 v7, s[12:15], s20 offen lds
    s_add_u32 s20, s20, 131072
    s_waitcnt vmcnt(36)
    ds_read_b64_tr_b16 a[88:89], v8 offset:22528
    ds_read_b64_tr_b16 a[90:91], v8 offset:22784
    ds_read_b64_tr_b16 a[92:93], v8 offset:22536
    ds_read_b64_tr_b16 a[94:95], v8 offset:22792
    s_waitcnt lgkmcnt(4)
    s_add_u32 m0, s19, 20480
    s_nop 0
    buffer_load_dwordx4 v7, s[12:15], s20 offen lds
    s_add_u32 s20, s20, 131072
    s_add_u32 m0, s19, 21504
    s_nop 0
    buffer_load_dwordx4 v7, s[12:15], s20 offen lds
    s_add_u32 s20, s20, 131072
    s_waitcnt vmcnt(36)
    ds_read_b64_tr_b16 a[96:97], v8 offset:24576
    ds_read_b64_tr_b16 a[98:99], v8 offset:24832
    ds_read_b64_tr_b16 a[100:101], v8 offset:24584
    ds_read_b64_tr_b16 a[102:103], v8 offset:24840
    s_waitcnt lgkmcnt(4)
    s_add_u32 m0, s19, 22528
    s_nop 0
    buffer_load_dwordx4 v7, s[12:15], s20 offen lds
    s_add_u32 s20, s20, 131072
    s_add_u32 m0, s19, 23552
    s_nop 0
    buffer_load_dwordx4 v7, s[12:15], s20 offen lds
    s_add_u32 s20, s20, 131072
    s_waitcnt vmcnt(36)
    ds_read_b64_tr_b16 a[104:105], v8 offset:26624
    ds_read_b64_tr_b16 a[106:107], v8 offset:26880
    ds_read_b64_tr_b16 a[108:109], v8 offset:26632
    ds_read_b64_tr_b16 a[110:111], v8 offset:26888
    s_waitcnt lgkmcnt(7)
    s_waitcnt vmcnt(34)
    ds_read_b64_tr_b16 a[112:113], v8 offset:28672
    ds_read_b64_tr_b16 a[114:115], v8 offset:28928
    ds_read_b64_tr_b16 a[116:117], v8 offset:28680
    ds_read_b64_tr_b16 a[118:119], v8 offset:28936
    s_waitcnt vmcnt(32)
    ds_read_b64_tr_b16 a[120:121], v8 offset:30720
    ds_read_b64_tr_b16 a[122:123], v8 offset:30976
    ds_read_b64_tr_b16 a[124:125], v8 offset:30728
    ds_read_b64_tr_b16 a[126:127], v8 offset:30984
    s_waitcnt lgkmcnt(7)
    s_waitcnt vmcnt(30)
    ds_read_b64_tr_b16 a[128:129], v8 offset:32768
    ds_read_b64_tr_b16 a[130:131], v8 offset:33024
    ds_read_b64_tr_b16 a[132:133], v8 offset:32776
    ds_read_b64_tr_b16 a[134:135], v8 offset:33032
    s_waitcnt vmcnt(28)
    ds_read_b64_tr_b16 a[136:137], v8 offset:34816
    ds_read_b64_tr_b16 a[138:139], v8 offset:35072
    ds_read_b64_tr_b16 a[140:141], v8 offset:34824
    ds_read_b64_tr_b16 a[142:143], v8 offset:35080
    s_waitcnt lgkmcnt(7)
    s_waitcnt vmcnt(26)
    ds_read_b64_tr_b16 a[144:145], v8 offset:36864
    ds_read_b64_tr_b16 a[146:147], v8 offset:37120
    ds_read_b64_tr_b16 a[148:149], v8 offset:36872
    ds_read_b64_tr_b16 a[150:151], v8 offset:37128
    s_waitcnt vmcnt(24)
    ds_read_b64_tr_b16 a[152:153], v8 offset:38912
    ds_read_b64_tr_b16 a[154:155], v8 offset:39168
    ds_read_b64_tr_b16 a[156:157], v8 offset:38920
    ds_read_b64_tr_b16 a[158:159], v8 offset:39176
    s_waitcnt lgkmcnt(7)
    s_waitcnt vmcnt(22)
    ds_read_b64_tr_b16 a[160:161], v8 offset:0
    ds_read_b64_tr_b16 a[162:163], v8 offset:256
    ds_read_b64_tr_b16 a[164:165], v8 offset:8
    ds_read_b64_tr_b16 a[166:167], v8 offset:264
    s_waitcnt vmcnt(20)
    ds_read_b64_tr_b16 a[168:169], v8 offset:2048
    ds_read_b64_tr_b16 a[170:171], v8 offset:2304
    ds_read_b64_tr_b16 a[172:173], v8 offset:2056
    ds_read_b64_tr_b16 a[174:175], v8 offset:2312
    s_waitcnt lgkmcnt(7)
    s_waitcnt vmcnt(18)
    ds_read_b64_tr_b16 a[176:177], v8 offset:4096
    ds_read_b64_tr_b16 a[178:179], v8 offset:4352
    ds_read_b64_tr_b16 a[180:181], v8 offset:4104
    ds_read_b64_tr_b16 a[182:183], v8 offset:4360
    s_waitcnt vmcnt(16)
    ds_read_b64_tr_b16 a[184:185], v8 offset:6144
    ds_read_b64_tr_b16 a[186:187], v8 offset:6400
    ds_read_b64_tr_b16 a[188:189], v8 offset:6152
    ds_read_b64_tr_b16 a[190:191], v8 offset:6408
    s_waitcnt lgkmcnt(7)
    s_waitcnt vmcnt(14)
    ds_read_b64_tr_b16 a[192:193], v8 offset:8192
    ds_read_b64_tr_b16 a[194:195], v8 offset:8448
    ds_read_b64_tr_b16 a[196:197], v8 offset:8200
    ds_read_b64_tr_b16 a[198:199], v8 offset:8456
    s_waitcnt vmcnt(12)
    ds_read_b64_tr_b16 a[200:201], v8 offset:10240
    ds_read_b64_tr_b16 a[202:203], v8 offset:10496
    ds_read_b64_tr_b16 a[204:205], v8 offset:10248
    ds_read_b64_tr_b16 a[206:207], v8 offset:10504
    s_waitcnt lgkmcnt(7)
    s_waitcnt vmcnt(10)
    ds_read_b64_tr_b16 a[208:209], v8 offset:12288
    ds_read_b64_tr_b16 a[210:211], v8 offset:12544
    ds_read_b64_tr_b16 a[212:213], v8 offset:12296
    ds_read_b64_tr_b16 a[214:215], v8 offset:12552
    s_waitcnt vmcnt(8)
    ds_read_b64_tr_b16 a[216:217], v8 offset:14336
    ds_read_b64_tr_b16 a[218:219], v8 offset:14592
    ds_read_b64_tr_b16 a[220:221], v8 offset:14344
    ds_read_b64_tr_b16 a[222:223], v8 offset:14600
    s_waitcnt lgkmcnt(7)
    s_waitcnt vmcnt(6)
    ds_read_b64_tr_b16 a[224:225], v8 offset:16384
    ds_read_b64_tr_b16 a[226:227], v8 offset:16640
    ds_read_b64_tr_b16 a[228:229], v8 offset:16392
    ds_read_b64_tr_b16 a[230:231], v8 offset:16648
    s_waitcnt vmcnt(4)
    ds_read_b64_tr_b16 a[232:233], v8 offset:18432
    ds_read_b64_tr_b16 a[234:235], v8 offset:18688
    ds_read_b64_tr_b16 a[236:237], v8 offset:18440
    ds_read_b64_tr_b16 a[238:239], v8 offset:18696
    s_waitcnt lgkmcnt(7)
    s_waitcnt vmcnt(2)
    ds_read_b64_tr_b16 a[240:241], v8 offset:20480
    ds_read_b64_tr_b16 a[242:243], v8 offset:20736
    ds_read_b64_tr_b16 a[244:245], v8 offset:20488
    ds_read_b64_tr_b16 a[246:247], v8 offset:20744
    s_waitcnt vmcnt(0)
    ds_read_b64_tr_b16 a[248:249], v8 offset:22528
    ds_read_b64_tr_b16 a[250:251], v8 offset:22784
    ds_read_b64_tr_b16 a[252:253], v8 offset:22536
    ds_read_b64_tr_b16 a[254:255], v8 offset:22792
    s_waitcnt lgkmcnt(7)
    s_waitcnt lgkmcnt(0)
    v_and_b32 v5, 15, v1
    v_bfe_u32 v6, v1, 1, 3
    v_lshrrev_b32 v7, 4, v1
    v_xor_b32 v6, v6, v7
    v_lshlrev_b32 v6, 4, v6
    v_lshl_add_u32 v10, v5, 7, v6
    s_lshl_b32 s19, s16, 10
    v_xor_b32 v11, 64, v10
    v_add_u32 v12, 0x10000, v10
    v_add_u32 v13, 0x10000, v11
    v_lshrrev_b32 v7, 3, v1
    s_lshl_b32 s17, s16, 3
    v_add_u32 v7, s17, v7
    v_bfe_u32 v8, v7, 1, 3
    v_xor_b32 v8, v8, v1
    v_and_b32 v8, 7, v8
    v_bfe_u32 v5, v7, 2, 2
    v_and_b32 v2, 3, v7
    v_lshl_add_u32 v2, v5, 3, v2
    v_bfe_u32 v5, v7, 4, 1
    v_lshl_add_u32 v2, v5, 2, v2
    v_bfe_u32 v5, v1, 2, 2
    v_and_b32 v3, 3, v1
    v_lshl_add_u32 v3, v5, 3, v3
    v_lshlrev_b32 v2, 11, v2
    v_lshl_add_u32 v2, v8, 4, v2
    v_and_b32 v5, 48, v1
    v_lshl_add_u32 v3, v3, 6, v5
    s_mul_i32 s21, s28, 133120
    s_mul_i32 s18, s90, 17825792
    s_add_u32 s21, s21, s18
    s_lshl_b32 s18, s90, 7
    s_add_u32 s17, s28, s18
    s_lshl_b32 s17, s17, 7
    s_add_u32 s17, s17, 100663296
    v_mov_b32 v4, s17
    v_mov_b32 v5, 1073741824
    v_cmp_eq_u32 vcc, 0, v1
    s_nop 1
    v_cndmask_b32 v4, v5, v4, vcc
    s_mov_b32 s20, 0
    s_mov_b32 s24, 65536
    s_mov_b32 s25, 2048
    s_barrier
    s_cmp_eq_u32 s90, 2
    s_cbranch_scc1 P_v
    s_mov_b32 s26, s25
    s_sub_u32 s25, s21, 1073741824
    s_mov_b32 s21, 1073741824
    s_mov_b32 s23, 0
    s_mov_b32 s22, 0
    s_add_u32 m0, s19, 0
    s_nop 0
    buffer_load_dwordx4 v2, s[8:11], s20 offen offset:0 lds
    s_add_u32 m0, s19, 3968
    s_nop 0
    buffer_load_dwordx4 v2, s[8:11], s20 offen offset:128 lds
    s_add_u32 m0, s19, 7936
    s_nop 0
    buffer_load_dwordx4 v2, s[8:11], s20 offen offset:256 lds
    s_add_u32 m0, s19, 11904
    s_nop 0
    buffer_load_dwordx4 v2, s[8:11], s20 offen offset:384 lds
    s_add_u32 m0, s19, 15872
    s_nop 0
    buffer_load_dwordx4 v2, s[8:11], s20 offen offset:512 lds
    s_add_u32 m0, s19, 19840
    s_nop 0
    buffer_load_dwordx4 v2, s[8:11], s20 offen offset:640 lds
    s_add_u32 m0, s19, 23808
    s_nop 0
    buffer_load_dwordx4 v2, s[8:11], s20 offen offset:768 lds
    s_add_u32 m0, s19, 27776
    s_nop 0
    buffer_load_dwordx4 v2, s[8:11], s20 offen offset:896 lds
    s_add_u32 m0, s19, 31744
    s_nop 0
    buffer_load_dwordx4 v2, s[8:11], s20 offen offset:1024 lds
    s_add_u32 m0, s19, 35712
    s_nop 0
    buffer_load_dwordx4 v2, s[8:11], s20 offen offset:1152 lds
    s_add_u32 m0, s19, 39680
    s_nop 0
    buffer_load_dwordx4 v2, s[8:11], s20 offen offset:1280 lds
    s_add_u32 m0, s19, 43648
    s_nop 0
    buffer_load_dwordx4 v2, s[8:11], s20 offen offset:1408 lds
    s_add_u32 m0, s19, 47616
    s_nop 0
    buffer_load_dwordx4 v2, s[8:11], s20 offen offset:1536 lds
    s_add_u32 m0, s19, 51584
    s_nop 0
    buffer_load_dwordx4 v2, s[8:11], s20 offen offset:1664 lds
    s_add_u32 m0, s19, 55552
    s_nop 0
    buffer_load_dwordx4 v2, s[8:11], s20 offen offset:1792 lds
    s_add_u32 m0, s19, 59520
    s_nop 0
    buffer_load_dwordx4 v2, s[8:11], s20 offen offset:1920 lds
    s_add_u32 s20, s20, s24
    s_add_u32 m0, s19, 65536
    s_nop 0
    buffer_load_dwordx4 v2, s[8:11], s20 offen offset:0 lds
    s_add_u32 m0, s19, 69504
    s_nop 0
    buffer_load_dwordx4 v2, s[8:11], s20 offen offset:128 lds
    s_add_u32 m0, s19, 73472
    s_nop 0
    buffer_load_dwordx4 v2, s[8:11], s20 offen offset:256 lds
    v_mov_b32 v9, s23
    s_add_u32 s23, s23, 1
    buffer_store_dword v9, v4, s[4:7], 0 offen sc1
    s_mov_b32 s23, 0
    s_waitcnt vmcnt(12)
    s_barrier
    ds_read_b128 v[20:23], v10 offset:0
    ds_read_b128 v[24:27], v10 offset:2048
    ds_read_b128 v[28:31], v11 offset:0
    ds_read_b128 v[32:35], v11 offset:2048
    ds_read_b128 v[36:39], v10 offset:4096
    ds_read_b128 v[40:43], v10 offset:6144
    ds_read_b128 v[44:47], v11 offset:4096
.p2align 6
P_qk_top:
    s_waitcnt lgkmcnt(6)
    v_mfma_f32_16x16x32_bf16 v[52:55], a[0:3], v[20:23], 0
    ds_read_b128 v[48:51], v11 offset:6144
    v_mfma_f32_16x16x32_bf16 v[56:59], a[4:7], v[20:23], 0
    s_waitcnt lgkmcnt(6)
    v_mfma_f32_16x16x32_bf16 v[60:63], a[0:3], v[24:27], 0
    ds_read_b128 v[20:23], v10 offset:8192
    s_add_u32 m0, s19, 77440
    v_mfma_f32_16x16x32_bf16 v[64:67], a[4:7], v[24:27], 0
    buffer_load_dwordx4 v2, s[8:11], s20 offen offset:384 lds
    s_waitcnt lgkmcnt(6)
    v_mfma_f32_16x16x32_bf16 v[52:55], a[8:11], v[28:31], v[52:55]
    ds_read_b128 v[24:27], v10 offset:10240
    v_mfma_f32_16x16x32_bf16 v[56:59], a[12:15], v[28:31], v[56:59]
    s_waitcnt lgkmcnt(6)
    v_mfma_f32_16x16x32_bf16 v[60:63], a[8:11], v[32:35], v[60:63]
    ds_read_b128 v[28:31], v11 offset:8192
    s_add_u32 m0, s19, 81408
    v_mfma_f32_16x16x32_bf16 v[64:67], a[12:15], v[32:35], v[64:67]
    buffer_load_dwordx4 v2, s[8:11], s20 offen offset:512 lds
    s_waitcnt lgkmcnt(6)
    v_mfma_f32_16x16x32_bf16 v[52:55], a[16:19], v[36:39], v[52:55]
    ds_read_b128 v[32:35], v11 offset:10240
    v_mfma_f32_16x16x32_bf16 v[56:59], a[20:23], v[36:39], v[56:59]
    s_waitcnt lgkmcnt(6)
    v_mfma_f32_16x16x32_bf16 v[60:63], a[16:19], v[40:43], v[60:63]
    ds_read_b128 v[36:39], v10 offset:12288
    s_add_u32 m0, s19, 85376
    v_mfma_f32_16x16x32_bf16 v[64:67], a[20:23], v[40:43], v[64:67]
    buffer_load_dwordx4 v2, s[8:11], s20 offen offset:640 lds
    s_waitcnt lgkmcnt(6)
    v_mfma_f32_16x16x32_bf16 v[52:55], a[24:27], v[44:47], v[52:55]
    ds_read_b128 v[40:43], v10 offset:14336
    v_mfma_f32_16x16x32_bf16 v[56:59], a[28:31], v[44:47], v[56:59]
    s_waitcnt lgkmcnt(6)
    v_mfma_f32_16x16x32_bf16 v[60:63], a[24:27], v[48:51], v[60:63]
    ds_read_b128 v[44:47], v11 offset:12288
    s_add_u32 m0, s19, 89344
    v_mfma_f32_16x16x32_bf16 v[64:67], a[28:31], v[48:51], v[64:67]
    buffer_load_dwordx4 v2, s[8:11], s20 offen offset:768 lds
    s_waitcnt lgkmcnt(6)
    v_mfma_f32_16x16x32_bf16 v[52:55], a[32:35], v[20:23], v[52:55]
    ds_read_b128 v[48:51], v11 offset:14336
    v_mfma_f32_16x16x32_bf16 v[56:59], a[36:39], v[20:23], v[56:59]
    s_waitcnt lgkmcnt(6)
    v_mfma_f32_16x16x32_bf16 v[60:63], a[32:35], v[24:27], v[60:63]
    ds_read_b128 v[20:23], v10 offset:16384
    s_add_u32 m0, s19, 93312
    v_mfma_f32_16x16x32_bf16 v[64:67], a[36:39], v[24:27], v[64:67]
    buffer_load_dwordx4 v2, s[8:11], s20 offen offset:896 lds
    s_waitcnt lgkmcnt(6)
    v_mfma_f32_16x16x32_bf16 v[52:55], a[40:43], v[28:31], v[52:55]
    ds_read_b128 v[24:27], v10 offset:18432
    v_mfma_f32_16x16x32_bf16 v[56:59], a[44:47], v[28:31], v[56:59]
    v_cvt_pk_bf16_f32 v84, v68, v69
    s_waitcnt lgkmcnt(6)
    v_mfma_f32_16x16x32_bf16 v[60:63], a[40:43], v[32:35], v[60:63]
    ds_read_b128 v[28:31], v11 offset:16384
    v_mfma_f32_16x16x32_bf16 v[64:67], a[44:47], v[32:35], v[64:67]
    v_cvt_pk_bf16_f32 v85, v70, v71
    s_waitcnt lgkmcnt(6)
    v_mfma_f32_16x16x32_bf16 v[52:55], a[48:51], v[36:39], v[52:55]
    ds_read_b128 v[32:35], v11 offset:18432
    v_mfma_f32_16x16x32_bf16 v[56:59], a[52:55], v[36:39], v[56:59]
    v_cvt_pk_bf16_f32 v86, v72, v73
    s_waitcnt lgkmcnt(6)
    v_mfma_f32_16x16x32_bf16 v[60:63], a[48:51], v[40:43], v[60:63]
    ds_read_b128 v[36:39], v10 offset:20480
    v_mfma_f32_16x16x32_bf16 v[64:67], a[52:55], v[40:43], v[64:67]
    v_cvt_pk_bf16_f32 v87, v74, v75
    s_waitcnt lgkmcnt(6)
    v_mfma_f32_16x16x32_bf16 v[52:55], a[56:59], v[44:47], v[52:55]
    ds_read_b128 v[40:43], v10 offset:22528
    v_mfma_f32_16x16x32_bf16 v[56:59], a[60:63], v[44:47], v[56:59]
    v_cvt_pk_bf16_f32 v88, v76, v77
    s_waitcnt lgkmcnt(6)
    v_mfma_f32_16x16x32_bf16 v[60:63], a[56:59], v[48:51], v[60:63]
    ds_read_b128 v[44:47], v11 offset:20480
    v_mfma_f32_16x16x32_bf16 v[64:67], a[60:63], v[48:51], v[64:67]
    v_cvt_pk_bf16_f32 v89, v78, v79
    buffer_store_dwordx4 v[84:87], v3, s[4:7], s21 offen offset:0 sc1
    s_waitcnt lgkmcnt(6)
    v_mfma_f32_16x16x32_bf16 v[52:55], a[64:67], v[20:23], v[52:55]
    ds_read_b128 v[48:51], v11 offset:22528
    v_mfma_f32_16x16x32_bf16 v[56:59], a[68:71], v[20:23], v[56:59]
    v_cvt_pk_bf16_f32 v90, v80, v81
    s_waitcnt lgkmcnt(6)
    v_mfma_f32_16x16x32_bf16 v[60:63], a[64:67], v[24:27], v[60:63]
    ds_read_b128 v[20:23], v10 offset:24576
    v_mfma_f32_16x16x32_bf16 v[64:67], a[68:71], v[24:27], v[64:67]
    v_cvt_pk_bf16_f32 v91, v82, v83
    s_waitcnt lgkmcnt(6)
    v_mfma_f32_16x16x32_bf16 v[52:55], a[72:75], v[28:31], v[52:55]
    ds_read_b128 v[24:27], v10 offset:26624
    v_mfma_f32_16x16x32_bf16 v[56:59], a[76:79], v[28:31], v[56:59]
    s_waitcnt lgkmcnt(6)
    v_mfma_f32_16x16x32_bf16 v[60:63], a[72:75], v[32:35], v[60:63]
    ds_read_b128 v[28:31], v11 offset:24576
    v_mfma_f32_16x16x32_bf16 v[64:67], a[76:79], v[32:35], v[64:67]
    buffer_store_dwordx4 v[88:91], v3, s[4:7], s21 offen offset:256 sc1
    s_waitcnt lgkmcnt(6)
    v_mfma_f32_16x16x32_bf16 v[52:55], a[80:83], v[36:39], v[52:55]
    ds_read_b128 v[32:35], v11 offset:26624
    v_mfma_f32_16x16x32_bf16 v[56:59], a[84:87], v[36:39], v[56:59]
    s_add_u32 s21, s21, s25
    s_mov_b32 s25, s26
    s_waitcnt lgkmcnt(6)
    v_mfma_f32_16x16x32_bf16 v[60:63], a[80:83], v[40:43], v[60:63]
    ds_read_b128 v[36:39], v10 offset:28672
    v_mfma_f32_16x16x32_bf16 v[64:67], a[84:87], v[40:43], v[64:67]
    s_waitcnt lgkmcnt(6)
    v_mfma_f32_16x16x32_bf16 v[52:55], a[88:91], v[44:47], v[52:55]
    ds_read_b128 v[40:43], v10 offset:30720
    v_mfma_f32_16x16x32_bf16 v[56:59], a[92:95], v[44:47], v[56:59]
    s_waitcnt lgkmcnt(6)
    v_mfma_f32_16x16x32_bf16 v[60:63], a[88:91], v[48:51], v[60:63]
    ds_read_b128 v[44:47], v11 offset:28672
    v_mfma_f32_16x16x32_bf16 v[64:67], a[92:95], v[48:51], v[64:67]
    s_waitcnt lgkmcnt(6)
    v_mfma_f32_16x16x32_bf16 v[52:55], a[96:99], v[20:23], v[52:55]
    ds_read_b128 v[48:51], v11 offset:30720
    v_mfma_f32_16x16x32_bf16 v[56:59], a[100:103], v[20:23], v[56:59]
    s_waitcnt lgkmcnt(6)
    v_mfma_f32_16x16x32_bf16 v[60:63], a[96:99], v[24:27], v[60:63]
    s_waitcnt vmcnt(11)
    s_barrier
    ds_read_b128 v[20:23], v10 offset:32768
    v_mfma_f32_16x16x32_bf16 v[64:67], a[100:103], v[24:27], v[64:67]
    s_waitcnt lgkmcnt(6)
    v_mfma_f32_16x16x32_bf16 v[52:55], a[104:107], v[28:31], v[52:55]
    ds_read_b128 v[24:27], v10 offset:34816
    s_add_u32 m0, s19, 97280
    v_mfma_f32_16x16x32_bf16 v[56:59], a[108:111], v[28:31], v[56:59]
    buffer_load_dwordx4 v2, s[8:11], s20 offen offset:1024 lds
    s_waitcnt lgkmcnt(6)
    v_mfma_f32_16x16x32_bf16 v[60:63], a[104:107], v[32:35], v[60:63]
    ds_read_b128 v[28:31], v11 offset:32768
    v_mfma_f32_16x16x32_bf16 v[64:67], a[108:111], v[32:35], v[64:67]
    s_waitcnt lgkmcnt(6)
    v_mfma_f32_16x16x32_bf16 v[52:55], a[112:115], v[36:39], v[52:55]
    ds_read_b128 v[32:35], v11 offset:34816
    s_add_u32 m0, s19, 101248
    v_mfma_f32_16x16x32_bf16 v[56:59], a[116:119], v[36:39], v[56:59]
    buffer_load_dwordx4 v2, s[8:11], s20 offen offset:1152 lds
    s_waitcnt lgkmcnt(6)
    v_mfma_f32_16x16x32_bf16 v[60:63], a[112:115], v[40:43], v[60:63]
    ds_read_b128 v[36:39], v10 offset:36864
    v_mfma_f32_16x16x32_bf16 v[64:67], a[116:119], v[40:43], v[64:67]
    s_waitcnt lgkmcnt(6)
    v_mfma_f32_16x16x32_bf16 v[52:55], a[120:123], v[44:47], v[52:55]
    ds_read_b128 v[40:43], v10 offset:38912
    s_add_u32 m0, s19, 105216
    v_mfma_f32_16x16x32_bf16 v[56:59], a[124:127], v[44:47], v[56:59]
    buffer_load_dwordx4 v2, s[8:11], s20 offen offset:1280 lds
    s_waitcnt lgkmcnt(6)
    v_mfma_f32_16x16x32_bf16 v[60:63], a[120:123], v[48:51], v[60:63]
    ds_read_b128 v[44:47], v11 offset:36864
    v_mfma_f32_16x16x32_bf16 v[64:67], a[124:127], v[48:51], v[64:67]
    s_waitcnt lgkmcnt(6)
    v_mfma_f32_16x16x32_bf16 v[52:55], a[128:131], v[20:23], v[52:55]
    ds_read_b128 v[48:51], v11 offset:38912
    v_mfma_f32_16x16x32_bf16 v[56:59], a[132:135], v[20:23], v[56:59]
    s_waitcnt lgkmcnt(6)
    v_mfma_f32_16x16x32_bf16 v[60:63], a[128:131], v[24:27], v[60:63]
    ds_read_b128 v[20:23], v10 offset:40960
    s_add_u32 m0, s19, 109184
    v_mfma_f32_16x16x32_bf16 v[64:67], a[132:135], v[24:27], v[64:67]
    buffer_load_dwordx4 v2, s[8:11], s20 offen offset:1408 lds
    s_waitcnt lgkmcnt(6)
    v_mfma_f32_16x16x32_bf16 v[52:55], a[136:139], v[28:31], v[52:55]
    ds_read_b128 v[24:27], v10 offset:43008
    v_mfma_f32_16x16x32_bf16 v[56:59], a[140:143], v[28:31], v[56:59]
    s_waitcnt lgkmcnt(6)
    v_mfma_f32_16x16x32_bf16 v[60:63], a[136:139], v[32:35], v[60:63]
    ds_read_b128 v[28:31], v11 offset:40960
    s_add_u32 m0, s19, 113152
    v_mfma_f32_16x16x32_bf16 v[64:67], a[140:143], v[32:35], v[64:67]
    buffer_load_dwordx4 v2, s[8:11], s20 offen offset:1536 lds
    s_waitcnt lgkmcnt(6)
    v_mfma_f32_16x16x32_bf16 v[52:55], a[144:147], v[36:39], v[52:55]
    ds_read_b128 v[32:35], v11 offset:43008
    v_mfma_f32_16x16x32_bf16 v[56:59], a[148:151], v[36:39], v[56:59]
    s_waitcnt lgkmcnt(6)
    v_mfma_f32_16x16x32_bf16 v[60:63], a[144:147], v[40:43], v[60:63]
    ds_read_b128 v[36:39], v10 offset:45056
    s_add_u32 m0, s19, 117120
    v_mfma_f32_16x16x32_bf16 v[64:67], a[148:151], v[40:43], v[64:67]
    buffer_load_dwordx4 v2, s[8:11], s20 offen offset:1664 lds
    s_waitcnt lgkmcnt(6)
    v_mfma_f32_16x16x32_bf16 v[52:55], a[152:155], v[44:47], v[52:55]
    ds_read_b128 v[40:43], v10 offset:47104
    v_mfma_f32_16x16x32_bf16 v[56:59], a[156:159], v[44:47], v[56:59]
    s_waitcnt lgkmcnt(6)
    v_mfma_f32_16x16x32_bf16 v[60:63], a[152:155], v[48:51], v[60:63]
    ds_read_b128 v[44:47], v11 offset:45056
    s_add_u32 m0, s19, 121088
    v_mfma_f32_16x16x32_bf16 v[64:67], a[156:159], v[48:51], v[64:67]
    buffer_load_dwordx4 v2, s[8:11], s20 offen offset:1792 lds
    s_waitcnt lgkmcnt(6)
    v_mfma_f32_16x16x32_bf16 v[52:55], a[160:163], v[20:23], v[52:55]
    ds_read_b128 v[48:51], v11 offset:47104
    v_mfma_f32_16x16x32_bf16 v[56:59], a[164:167], v[20:23], v[56:59]
    s_waitcnt lgkmcnt(6)
    v_mfma_f32_16x16x32_bf16 v[60:63], a[160:163], v[24:27], v[60:63]
    ds_read_b128 v[20:23], v10 offset:49152
    s_add_u32 m0, s19, 125056
    v_mfma_f32_16x16x32_bf16 v[64:67], a[164:167], v[24:27], v[64:67]
    buffer_load_dwordx4 v2, s[8:11], s20 offen offset:1920 lds
    s_waitcnt lgkmcnt(6)
    v_mfma_f32_16x16x32_bf16 v[52:55], a[168:171], v[28:31], v[52:55]
    ds_read_b128 v[24:27], v10 offset:51200
    v_mfma_f32_16x16x32_bf16 v[56:59], a[172:175], v[28:31], v[56:59]
    s_add_u32 s20, s20, s24
    s_waitcnt lgkmcnt(6)
    v_mfma_f32_16x16x32_bf16 v[60:63], a[168:171], v[32:35], v[60:63]
    ds_read_b128 v[28:31], v11 offset:49152
    v_mfma_f32_16x16x32_bf16 v[64:67], a[172:175], v[32:35], v[64:67]
    s_waitcnt lgkmcnt(6)
    v_mfma_f32_16x16x32_bf16 v[52:55], a[176:179], v[36:39], v[52:55]
    ds_read_b128 v[32:35], v11 offset:51200
    v_mfma_f32_16x16x32_bf16 v[56:59], a[180:183], v[36:39], v[56:59]
    s_waitcnt lgkmcnt(6)
    v_mfma_f32_16x16x32_bf16 v[60:63], a[176:179], v[40:43], v[60:63]
    ds_read_b128 v[36:39], v10 offset:53248
    v_mfma_f32_16x16x32_bf16 v[64:67], a[180:183], v[40:43], v[64:67]
    s_waitcnt lgkmcnt(6)
    v_mfma_f32_16x16x32_bf16 v[52:55], a[184:187], v[44:47], v[52:55]
    ds_read_b128 v[40:43], v10 offset:55296
    v_mfma_f32_16x16x32_bf16 v[56:59], a[188:191], v[44:47], v[56:59]
    s_waitcnt lgkmcnt(6)
    v_mfma_f32_16x16x32_bf16 v[60:63], a[184:187], v[48:51], v[60:63]
    ds_read_b128 v[44:47], v11 offset:53248
    v_mfma_f32_16x16x32_bf16 v[64:67], a[188:191], v[48:51], v[64:67]
    s_waitcnt lgkmcnt(6)
    v_mfma_f32_16x16x32_bf16 v[52:55], a[192:195], v[20:23], v[52:55]
    ds_read_b128 v[48:51], v11 offset:55296
    v_mfma_f32_16x16x32_bf16 v[56:59], a[196:199], v[20:23], v[56:59]
    s_waitcnt lgkmcnt(6)
    v_mfma_f32_16x16x32_bf16 v[60:63], a[192:195], v[24:27], v[60:63]
    ds_read_b128 v[20:23], v10 offset:57344
    v_mfma_f32_16x16x32_bf16 v[64:67], a[196:199], v[24:27], v[64:67]
    s_waitcnt lgkmcnt(6)
    v_mfma_f32_16x16x32_bf16 v[52:55], a[200:203], v[28:31], v[52:55]
    ds_read_b128 v[24:27], v10 offset:59392
    v_mfma_f32_16x16x32_bf16 v[56:59], a[204:207], v[28:31], v[56:59]
    s_waitcnt lgkmcnt(6)
    v_mfma_f32_16x16x32_bf16 v[60:63], a[200:203], v[32:35], v[60:63]
    ds_read_b128 v[28:31], v11 offset:57344
    v_mfma_f32_16x16x32_bf16 v[64:67], a[204:207], v[32:35], v[64:67]
    s_waitcnt lgkmcnt(6)
    v_mfma_f32_16x16x32_bf16 v[52:55], a[208:211], v[36:39], v[52:55]
    ds_read_b128 v[32:35], v11 offset:59392
    v_mfma_f32_16x16x32_bf16 v[56:59], a[212:215], v[36:39], v[56:59]
    s_waitcnt lgkmcnt(6)
    v_mfma_f32_16x16x32_bf16 v[60:63], a[208:211], v[40:43], v[60:63]
    ds_read_b128 v[36:39], v10 offset:61440
    v_mfma_f32_16x16x32_bf16 v[64:67], a[212:215], v[40:43], v[64:67]
    s_waitcnt lgkmcnt(6)
    v_mfma_f32_16x16x32_bf16 v[52:55], a[216:219], v[44:47], v[52:55]
    ds_read_b128 v[40:43], v10 offset:63488
    v_mfma_f32_16x16x32_bf16 v[56:59], a[220:223], v[44:47], v[56:59]
    s_waitcnt lgkmcnt(6)
    v_mfma_f32_16x16x32_bf16 v[60:63], a[216:219], v[48:51], v[60:63]
    ds_read_b128 v[44:47], v11 offset:61440
    v_mfma_f32_16x16x32_bf16 v[64:67], a[220:223], v[48:51], v[64:67]
    s_waitcnt lgkmcnt(6)
    v_mfma_f32_16x16x32_bf16 v[52:55], a[224:227], v[20:23], v[52:55]
    ds_read_b128 v[48:51], v11 offset:63488
    v_mfma_f32_16x16x32_bf16 v[56:59], a[228:231], v[20:23], v[56:59]
    s_waitcnt lgkmcnt(6)
    v_mfma_f32_16x16x32_bf16 v[60:63], a[224:227], v[24:27], v[60:63]
    s_waitcnt vmcnt(8)
    s_barrier
    ds_read_b128 v[20:23], v12 offset:0
    v_mfma_f32_16x16x32_bf16 v[64:67], a[228:231], v[24:27], v[64:67]
    s_waitcnt lgkmcnt(6)
    v_mfma_f32_16x16x32_bf16 v[52:55], a[232:235], v[28:31], v[52:55]
    ds_read_b128 v[24:27], v12 offset:2048
    s_add_u32 m0, s19, 0
    v_mfma_f32_16x16x32_bf16 v[56:59], a[236:239], v[28:31], v[56:59]
    buffer_load_dwordx4 v2, s[8:11], s20 offen offset:0 lds
    s_waitcnt lgkmcnt(6)
    v_mfma_f32_16x16x32_bf16 v[60:63], a[232:235], v[32:35], v[60:63]
    ds_read_b128 v[28:31], v13 offset:0
    v_mfma_f32_16x16x32_bf16 v[64:67], a[236:239], v[32:35], v[64:67]
    v_mov_b32 v9, s23
    s_add_u32 s23, s23, 1
    buffer_store_dword v9, v4, s[4:7], 0 offen sc1
    s_waitcnt lgkmcnt(6)
    v_mfma_f32_16x16x32_bf16 v[52:55], a[240:243], v[36:39], v[52:55]
    ds_read_b128 v[32:35], v13 offset:2048
    s_add_u32 m0, s19, 3968
    v_mfma_f32_16x16x32_bf16 v[56:59], a[244:247], v[36:39], v[56:59]
    buffer_load_dwordx4 v2, s[8:11], s20 offen offset:128 lds
    s_waitcnt lgkmcnt(6)
    v_mfma_f32_16x16x32_bf16 v[60:63], a[240:243], v[40:43], v[60:63]
    ds_read_b128 v[36:39], v12 offset:4096
    v_mfma_f32_16x16x32_bf16 v[64:67], a[244:247], v[40:43], v[64:67]
    s_waitcnt lgkmcnt(6)
    v_mfma_f32_16x16x32_bf16 v[52:55], a[248:251], v[44:47], v[52:55]
    ds_read_b128 v[40:43], v12 offset:6144
    s_add_u32 m0, s19, 7936
    v_mfma_f32_16x16x32_bf16 v[56:59], a[252:255], v[44:47], v[56:59]
    buffer_load_dwordx4 v2, s[8:11], s20 offen offset:256 lds
    s_waitcnt lgkmcnt(6)
    v_mfma_f32_16x16x32_bf16 v[60:63], a[248:251], v[48:51], v[60:63]
    ds_read_b128 v[44:47], v13 offset:4096
    v_mfma_f32_16x16x32_bf16 v[64:67], a[252:255], v[48:51], v[64:67]
    s_waitcnt lgkmcnt(6)
    v_mfma_f32_16x16x32_bf16 v[68:71], a[0:3], v[20:23], 0
    ds_read_b128 v[48:51], v13 offset:6144
    v_mfma_f32_16x16x32_bf16 v[72:75], a[4:7], v[20:23], 0
    s_waitcnt lgkmcnt(6)
    v_mfma_f32_16x16x32_bf16 v[76:79], a[0:3], v[24:27], 0
    ds_read_b128 v[20:23], v12 offset:8192
    s_add_u32 m0, s19, 11904
    v_mfma_f32_16x16x32_bf16 v[80:83], a[4:7], v[24:27], 0
    buffer_load_dwordx4 v2, s[8:11], s20 offen offset:384 lds
    s_waitcnt lgkmcnt(6)
    v_mfma_f32_16x16x32_bf16 v[68:71], a[8:11], v[28:31], v[68:71]
    ds_read_b128 v[24:27], v12 offset:10240
    v_mfma_f32_16x16x32_bf16 v[72:75], a[12:15], v[28:31], v[72:75]
    s_waitcnt lgkmcnt(6)
    v_mfma_f32_16x16x32_bf16 v[76:79], a[8:11], v[32:35], v[76:79]
    ds_read_b128 v[28:31], v13 offset:8192
    s_add_u32 m0, s19, 15872
    v_mfma_f32_16x16x32_bf16 v[80:83], a[12:15], v[32:35], v[80:83]
    buffer_load_dwordx4 v2, s[8:11], s20 offen offset:512 lds
    s_waitcnt lgkmcnt(6)
    v_mfma_f32_16x16x32_bf16 v[68:71], a[16:19], v[36:39], v[68:71]
    ds_read_b128 v[32:35], v13 offset:10240
    v_mfma_f32_16x16x32_bf16 v[72:75], a[20:23], v[36:39], v[72:75]
    s_waitcnt lgkmcnt(6)
    v_mfma_f32_16x16x32_bf16 v[76:79], a[16:19], v[40:43], v[76:79]
    ds_read_b128 v[36:39], v12 offset:12288
    s_add_u32 m0, s19, 19840
    v_mfma_f32_16x16x32_bf16 v[80:83], a[20:23], v[40:43], v[80:83]
    buffer_load_dwordx4 v2, s[8:11], s20 offen offset:640 lds
    s_waitcnt lgkmcnt(6)
    v_mfma_f32_16x16x32_bf16 v[68:71], a[24:27], v[44:47], v[68:71]
    ds_read_b128 v[40:43], v12 offset:14336
    v_mfma_f32_16x16x32_bf16 v[72:75], a[28:31], v[44:47], v[72:75]
    s_waitcnt lgkmcnt(6)
    v_mfma_f32_16x16x32_bf16 v[76:79], a[24:27], v[48:51], v[76:79]
    ds_read_b128 v[44:47], v13 offset:12288
    s_add_u32 m0, s19, 23808
    v_mfma_f32_16x16x32_bf16 v[80:83], a[28:31], v[48:51], v[80:83]
    buffer_load_dwordx4 v2, s[8:11], s20 offen offset:768 lds
    s_waitcnt lgkmcnt(6)
    v_mfma_f32_16x16x32_bf16 v[68:71], a[32:35], v[20:23], v[68:71]
    ds_read_b128 v[48:51], v13 offset:14336
    v_mfma_f32_16x16x32_bf16 v[72:75], a[36:39], v[20:23], v[72:75]
    s_waitcnt lgkmcnt(6)
    v_mfma_f32_16x16x32_bf16 v[76:79], a[32:35], v[24:27], v[76:79]
    ds_read_b128 v[20:23], v12 offset:16384
    s_add_u32 m0, s19, 27776
    v_mfma_f32_16x16x32_bf16 v[80:83], a[36:39], v[24:27], v[80:83]
    buffer_load_dwordx4 v2, s[8:11], s20 offen offset:896 lds
    s_waitcnt lgkmcnt(6)
    v_mfma_f32_16x16x32_bf16 v[68:71], a[40:43], v[28:31], v[68:71]
    ds_read_b128 v[24:27], v12 offset:18432
    v_mfma_f32_16x16x32_bf16 v[72:75], a[44:47], v[28:31], v[72:75]
    v_cvt_pk_bf16_f32 v84, v52, v53
    s_waitcnt lgkmcnt(6)
    v_mfma_f32_16x16x32_bf16 v[76:79], a[40:43], v[32:35], v[76:79]
    ds_read_b128 v[28:31], v13 offset:16384
    v_mfma_f32_16x16x32_bf16 v[80:83], a[44:47], v[32:35], v[80:83]
    v_cvt_pk_bf16_f32 v85, v54, v55
    s_waitcnt lgkmcnt(6)
    v_mfma_f32_16x16x32_bf16 v[68:71], a[48:51], v[36:39], v[68:71]
    ds_read_b128 v[32:35], v13 offset:18432
    v_mfma_f32_16x16x32_bf16 v[72:75], a[52:55], v[36:39], v[72:75]
    v_cvt_pk_bf16_f32 v86, v56, v57
    s_waitcnt lgkmcnt(6)
    v_mfma_f32_16x16x32_bf16 v[76:79], a[48:51], v[40:43], v[76:79]
    ds_read_b128 v[36:39], v12 offset:20480
    v_mfma_f32_16x16x32_bf16 v[80:83], a[52:55], v[40:43], v[80:83]
    v_cvt_pk_bf16_f32 v87, v58, v59
    s_waitcnt lgkmcnt(6)
    v_mfma_f32_16x16x32_bf16 v[68:71], a[56:59], v[44:47], v[68:71]
    ds_read_b128 v[40:43], v12 offset:22528
    v_mfma_f32_16x16x32_bf16 v[72:75], a[60:63], v[44:47], v[72:75]
    v_cvt_pk_bf16_f32 v88, v60, v61
    s_waitcnt lgkmcnt(6)
    v_mfma_f32_16x16x32_bf16 v[76:79], a[56:59], v[48:51], v[76:79]
    ds_read_b128 v[44:47], v13 offset:20480
    v_mfma_f32_16x16x32_bf16 v[80:83], a[60:63], v[48:51], v[80:83]
    v_cvt_pk_bf16_f32 v89, v62, v63
    buffer_store_dwordx4 v[84:87], v3, s[4:7], s21 offen offset:0 sc1
    s_waitcnt lgkmcnt(6)
    v_mfma_f32_16x16x32_bf16 v[68:71], a[64:67], v[20:23], v[68:71]
    ds_read_b128 v[48:51], v13 offset:22528
    v_mfma_f32_16x16x32_bf16 v[72:75], a[68:71], v[20:23], v[72:75]
    v_cvt_pk_bf16_f32 v90, v64, v65
    s_waitcnt lgkmcnt(6)
    v_mfma_f32_16x16x32_bf16 v[76:79], a[64:67], v[24:27], v[76:79]
    ds_read_b128 v[20:23], v12 offset:24576
    v_mfma_f32_16x16x32_bf16 v[80:83], a[68:71], v[24:27], v[80:83]
    v_cvt_pk_bf16_f32 v91, v66, v67
    s_waitcnt lgkmcnt(6)
    v_mfma_f32_16x16x32_bf16 v[68:71], a[72:75], v[28:31], v[68:71]
    ds_read_b128 v[24:27], v12 offset:26624
    v_mfma_f32_16x16x32_bf16 v[72:75], a[76:79], v[28:31], v[72:75]
    s_waitcnt lgkmcnt(6)
    v_mfma_f32_16x16x32_bf16 v[76:79], a[72:75], v[32:35], v[76:79]
    ds_read_b128 v[28:31], v13 offset:24576
    v_mfma_f32_16x16x32_bf16 v[80:83], a[76:79], v[32:35], v[80:83]
    buffer_store_dwordx4 v[88:91], v3, s[4:7], s21 offen offset:256 sc1
    s_waitcnt lgkmcnt(6)
    v_mfma_f32_16x16x32_bf16 v[68:71], a[80:83], v[36:39], v[68:71]
    ds_read_b128 v[32:35], v13 offset:26624
    v_mfma_f32_16x16x32_bf16 v[72:75], a[84:87], v[36:39], v[72:75]
    s_add_u32 s21, s21, s25
    s_mov_b32 s25, s26
    s_waitcnt lgkmcnt(6)
    v_mfma_f32_16x16x32_bf16 v[76:79], a[80:83], v[40:43], v[76:79]
    ds_read_b128 v[36:39], v12 offset:28672
    v_mfma_f32_16x16x32_bf16 v[80:83], a[84:87], v[40:43], v[80:83]
    s_waitcnt lgkmcnt(6)
    v_mfma_f32_16x16x32_bf16 v[68:71], a[88:91], v[44:47], v[68:71]
    ds_read_b128 v[40:43], v12 offset:30720
    v_mfma_f32_16x16x32_bf16 v[72:75], a[92:95], v[44:47], v[72:75]
    s_waitcnt lgkmcnt(6)
    v_mfma_f32_16x16x32_bf16 v[76:79], a[88:91], v[48:51], v[76:79]
    ds_read_b128 v[44:47], v13 offset:28672
    v_mfma_f32_16x16x32_bf16 v[80:83], a[92:95], v[48:51], v[80:83]
    s_waitcnt lgkmcnt(6)
    v_mfma_f32_16x16x32_bf16 v[68:71], a[96:99], v[20:23], v[68:71]
    ds_read_b128 v[48:51], v13 offset:30720
    v_mfma_f32_16x16x32_bf16 v[72:75], a[100:103], v[20:23], v[72:75]
    s_waitcnt lgkmcnt(6)
    v_mfma_f32_16x16x32_bf16 v[76:79], a[96:99], v[24:27], v[76:79]
    s_waitcnt vmcnt(11)
    s_barrier
    ds_read_b128 v[20:23], v12 offset:32768
    v_mfma_f32_16x16x32_bf16 v[80:83], a[100:103], v[24:27], v[80:83]
    s_waitcnt lgkmcnt(6)
    v_mfma_f32_16x16x32_bf16 v[68:71], a[104:107], v[28:31], v[68:71]
    ds_read_b128 v[24:27], v12 offset:34816
    s_add_u32 m0, s19, 31744
    v_mfma_f32_16x16x32_bf16 v[72:75], a[108:111], v[28:31], v[72:75]
    buffer_load_dwordx4 v2, s[8:11], s20 offen offset:1024 lds
    s_waitcnt lgkmcnt(6)
    v_mfma_f32_16x16x32_bf16 v[76:79], a[104:107], v[32:35], v[76:79]
    ds_read_b128 v[28:31], v13 offset:32768
    v_mfma_f32_16x16x32_bf16 v[80:83], a[108:111], v[32:35], v[80:83]
    s_waitcnt lgkmcnt(6)
    v_mfma_f32_16x16x32_bf16 v[68:71], a[112:115], v[36:39], v[68:71]
    ds_read_b128 v[32:35], v13 offset:34816
    s_add_u32 m0, s19, 35712
    v_mfma_f32_16x16x32_bf16 v[72:75], a[116:119], v[36:39], v[72:75]
    buffer_load_dwordx4 v2, s[8:11], s20 offen offset:1152 lds
    s_waitcnt lgkmcnt(6)
    v_mfma_f32_16x16x32_bf16 v[76:79], a[112:115], v[40:43], v[76:79]
    ds_read_b128 v[36:39], v12 offset:36864
    v_mfma_f32_16x16x32_bf16 v[80:83], a[116:119], v[40:43], v[80:83]
    s_waitcnt lgkmcnt(6)
    v_mfma_f32_16x16x32_bf16 v[68:71], a[120:123], v[44:47], v[68:71]
    ds_read_b128 v[40:43], v12 offset:38912
    s_add_u32 m0, s19, 39680
    v_mfma_f32_16x16x32_bf16 v[72:75], a[124:127], v[44:47], v[72:75]
    buffer_load_dwordx4 v2, s[8:11], s20 offen offset:1280 lds
    s_waitcnt lgkmcnt(6)
    v_mfma_f32_16x16x32_bf16 v[76:79], a[120:123], v[48:51], v[76:79]
    ds_read_b128 v[44:47], v13 offset:36864
    v_mfma_f32_16x16x32_bf16 v[80:83], a[124:127], v[48:51], v[80:83]
    s_waitcnt lgkmcnt(6)
    v_mfma_f32_16x16x32_bf16 v[68:71], a[128:131], v[20:23], v[68:71]
    ds_read_b128 v[48:51], v13 offset:38912
    v_mfma_f32_16x16x32_bf16 v[72:75], a[132:135], v[20:23], v[72:75]
    s_waitcnt lgkmcnt(6)
    v_mfma_f32_16x16x32_bf16 v[76:79], a[128:131], v[24:27], v[76:79]
    ds_read_b128 v[20:23], v12 offset:40960
    s_add_u32 m0, s19, 43648
    v_mfma_f32_16x16x32_bf16 v[80:83], a[132:135], v[24:27], v[80:83]
    buffer_load_dwordx4 v2, s[8:11], s20 offen offset:1408 lds
    s_waitcnt lgkmcnt(6)
    v_mfma_f32_16x16x32_bf16 v[68:71], a[136:139], v[28:31], v[68:71]
    ds_read_b128 v[24:27], v12 offset:43008
    v_mfma_f32_16x16x32_bf16 v[72:75], a[140:143], v[28:31], v[72:75]
    s_waitcnt lgkmcnt(6)
    v_mfma_f32_16x16x32_bf16 v[76:79], a[136:139], v[32:35], v[76:79]
    ds_read_b128 v[28:31], v13 offset:40960
    s_add_u32 m0, s19, 47616
    v_mfma_f32_16x16x32_bf16 v[80:83], a[140:143], v[32:35], v[80:83]
    buffer_load_dwordx4 v2, s[8:11], s20 offen offset:1536 lds
    s_waitcnt lgkmcnt(6)
    v_mfma_f32_16x16x32_bf16 v[68:71], a[144:147], v[36:39], v[68:71]
    ds_read_b128 v[32:35], v13 offset:43008
    v_mfma_f32_16x16x32_bf16 v[72:75], a[148:151], v[36:39], v[72:75]
    s_waitcnt lgkmcnt(6)
    v_mfma_f32_16x16x32_bf16 v[76:79], a[144:147], v[40:43], v[76:79]
    ds_read_b128 v[36:39], v12 offset:45056
    s_add_u32 m0, s19, 51584
    v_mfma_f32_16x16x32_bf16 v[80:83], a[148:151], v[40:43], v[80:83]
    buffer_load_dwordx4 v2, s[8:11], s20 offen offset:1664 lds
    s_waitcnt lgkmcnt(6)
    v_mfma_f32_16x16x32_bf16 v[68:71], a[152:155], v[44:47], v[68:71]
    ds_read_b128 v[40:43], v12 offset:47104
    v_mfma_f32_16x16x32_bf16 v[72:75], a[156:159], v[44:47], v[72:75]
    s_waitcnt lgkmcnt(6)
    v_mfma_f32_16x16x32_bf16 v[76:79], a[152:155], v[48:51], v[76:79]
    ds_read_b128 v[44:47], v13 offset:45056
    s_add_u32 m0, s19, 55552
    v_mfma_f32_16x16x32_bf16 v[80:83], a[156:159], v[48:51], v[80:83]
    buffer_load_dwordx4 v2, s[8:11], s20 offen offset:1792 lds
    s_waitcnt lgkmcnt(6)
    v_mfma_f32_16x16x32_bf16 v[68:71], a[160:163], v[20:23], v[68:71]
    ds_read_b128 v[48:51], v13 offset:47104
    v_mfma_f32_16x16x32_bf16 v[72:75], a[164:167], v[20:23], v[72:75]
    s_waitcnt lgkmcnt(6)
    v_mfma_f32_16x16x32_bf16 v[76:79], a[160:163], v[24:27], v[76:79]
    ds_read_b128 v[20:23], v12 offset:49152
    s_add_u32 m0, s19, 59520
    v_mfma_f32_16x16x32_bf16 v[80:83], a[164:167], v[24:27], v[80:83]
    buffer_load_dwordx4 v2, s[8:11], s20 offen offset:1920 lds
    s_waitcnt lgkmcnt(6)
    v_mfma_f32_16x16x32_bf16 v[68:71], a[168:171], v[28:31], v[68:71]
    ds_read_b128 v[24:27], v12 offset:51200
    v_mfma_f32_16x16x32_bf16 v[72:75], a[172:175], v[28:31], v[72:75]
    s_add_u32 s20, s20, s24
    s_waitcnt lgkmcnt(6)
    v_mfma_f32_16x16x32_bf16 v[76:79], a[168:171], v[32:35], v[76:79]
    ds_read_b128 v[28:31], v13 offset:49152
    v_mfma_f32_16x16x32_bf16 v[80:83], a[172:175], v[32:35], v[80:83]
    s_waitcnt lgkmcnt(6)
    v_mfma_f32_16x16x32_bf16 v[68:71], a[176:179], v[36:39], v[68:71]
    ds_read_b128 v[32:35], v13 offset:51200
    v_mfma_f32_16x16x32_bf16 v[72:75], a[180:183], v[36:39], v[72:75]
    s_waitcnt lgkmcnt(6)
    v_mfma_f32_16x16x32_bf16 v[76:79], a[176:179], v[40:43], v[76:79]
    ds_read_b128 v[36:39], v12 offset:53248
    v_mfma_f32_16x16x32_bf16 v[80:83], a[180:183], v[40:43], v[80:83]
    s_waitcnt lgkmcnt(6)
    v_mfma_f32_16x16x32_bf16 v[68:71], a[184:187], v[44:47], v[68:71]
    ds_read_b128 v[40:43], v12 offset:55296
    v_mfma_f32_16x16x32_bf16 v[72:75], a[188:191], v[44:47], v[72:75]
    s_waitcnt lgkmcnt(6)
    v_mfma_f32_16x16x32_bf16 v[76:79], a[184:187], v[48:51], v[76:79]
    ds_read_b128 v[44:47], v13 offset:53248
    v_mfma_f32_16x16x32_bf16 v[80:83], a[188:191], v[48:51], v[80:83]
    s_waitcnt lgkmcnt(6)
    v_mfma_f32_16x16x32_bf16 v[68:71], a[192:195], v[20:23], v[68:71]
    ds_read_b128 v[48:51], v13 offset:55296
    v_mfma_f32_16x16x32_bf16 v[72:75], a[196:199], v[20:23], v[72:75]
    s_waitcnt lgkmcnt(6)
    v_mfma_f32_16x16x32_bf16 v[76:79], a[192:195], v[24:27], v[76:79]
    ds_read_b128 v[20:23], v12 offset:57344
    v_mfma_f32_16x16x32_bf16 v[80:83], a[196:199], v[24:27], v[80:83]
    s_waitcnt lgkmcnt(6)
    v_mfma_f32_16x16x32_bf16 v[68:71], a[200:203], v[28:31], v[68:71]
    ds_read_b128 v[24:27], v12 offset:59392
    v_mfma_f32_16x16x32_bf16 v[72:75], a[204:207], v[28:31], v[72:75]
    s_waitcnt lgkmcnt(6)
    v_mfma_f32_16x16x32_bf16 v[76:79], a[200:203], v[32:35], v[76:79]
    ds_read_b128 v[28:31], v13 offset:57344
    v_mfma_f32_16x16x32_bf16 v[80:83], a[204:207], v[32:35], v[80:83]
    s_waitcnt lgkmcnt(6)
    v_mfma_f32_16x16x32_bf16 v[68:71], a[208:211], v[36:39], v[68:71]
    ds_read_b128 v[32:35], v13 offset:59392
    v_mfma_f32_16x16x32_bf16 v[72:75], a[212:215], v[36:39], v[72:75]
    s_waitcnt lgkmcnt(6)
    v_mfma_f32_16x16x32_bf16 v[76:79], a[208:211], v[40:43], v[76:79]
    ds_read_b128 v[36:39], v12 offset:61440
    v_mfma_f32_16x16x32_bf16 v[80:83], a[212:215], v[40:43], v[80:83]
    s_waitcnt lgkmcnt(6)
    v_mfma_f32_16x16x32_bf16 v[68:71], a[216:219], v[44:47], v[68:71]
    ds_read_b128 v[40:43], v12 offset:63488
    v_mfma_f32_16x16x32_bf16 v[72:75], a[220:223], v[44:47], v[72:75]
    s_waitcnt lgkmcnt(6)
    v_mfma_f32_16x16x32_bf16 v[76:79], a[216:219], v[48:51], v[76:79]
    ds_read_b128 v[44:47], v13 offset:61440
    v_mfma_f32_16x16x32_bf16 v[80:83], a[220:223], v[48:51], v[80:83]
    s_waitcnt lgkmcnt(6)
    v_mfma_f32_16x16x32_bf16 v[68:71], a[224:227], v[20:23], v[68:71]
    ds_read_b128 v[48:51], v13 offset:63488
    v_mfma_f32_16x16x32_bf16 v[72:75], a[228:231], v[20:23], v[72:75]
    s_waitcnt lgkmcnt(6)
    v_mfma_f32_16x16x32_bf16 v[76:79], a[224:227], v[24:27], v[76:79]
    s_waitcnt vmcnt(8)
    s_barrier
    ds_read_b128 v[20:23], v10 offset:0
    v_mfma_f32_16x16x32_bf16 v[80:83], a[228:231], v[24:27], v[80:83]
    s_waitcnt lgkmcnt(6)
    v_mfma_f32_16x16x32_bf16 v[68:71], a[232:235], v[28:31], v[68:71]
    ds_read_b128 v[24:27], v10 offset:2048
    s_add_u32 m0, s19, 65536
    v_mfma_f32_16x16x32_bf16 v[72:75], a[236:239], v[28:31], v[72:75]
    buffer_load_dwordx4 v2, s[8:11], s20 offen offset:0 lds
    s_waitcnt lgkmcnt(6)
    v_mfma_f32_16x16x32_bf16 v[76:79], a[232:235], v[32:35], v[76:79]
    ds_read_b128 v[28:31], v11 offset:0
    v_mfma_f32_16x16x32_bf16 v[80:83], a[236:239], v[32:35], v[80:83]
    v_mov_b32 v9, s23
    s_add_u32 s23, s23, 1
    buffer_store_dword v9, v4, s[4:7], 0 offen sc1
    s_waitcnt lgkmcnt(6)
    v_mfma_f32_16x16x32_bf16 v[68:71], a[240:243], v[36:39], v[68:71]
    ds_read_b128 v[32:35], v11 offset:2048
    s_add_u32 m0, s19, 69504
    v_mfma_f32_16x16x32_bf16 v[72:75], a[244:247], v[36:39], v[72:75]
    buffer_load_dwordx4 v2, s[8:11], s20 offen offset:128 lds
    s_waitcnt lgkmcnt(6)
    v_mfma_f32_16x16x32_bf16 v[76:79], a[240:243], v[40:43], v[76:79]
    ds_read_b128 v[36:39], v10 offset:4096
    v_mfma_f32_16x16x32_bf16 v[80:83], a[244:247], v[40:43], v[80:83]
    s_waitcnt lgkmcnt(6)
    v_mfma_f32_16x16x32_bf16 v[68:71], a[248:251], v[44:47], v[68:71]
    ds_read_b128 v[40:43], v10 offset:6144
    s_add_u32 m0, s19, 73472
    v_mfma_f32_16x16x32_bf16 v[72:75], a[252:255], v[44:47], v[72:75]
    buffer_load_dwordx4 v2, s[8:11], s20 offen offset:256 lds
    s_waitcnt lgkmcnt(6)
    v_mfma_f32_16x16x32_bf16 v[76:79], a[248:251], v[48:51], v[76:79]
    ds_read_b128 v[44:47], v11 offset:4096
    v_mfma_f32_16x16x32_bf16 v[80:83], a[252:255], v[48:51], v[80:83]
    s_add_u32 s22, s22, 2
    s_cmp_lt_u32 s22, 64
    s_cbranch_scc1 P_qk_top
    v_cvt_pk_bf16_f32 v84, v68, v69
    v_cvt_pk_bf16_f32 v85, v70, v71
    v_cvt_pk_bf16_f32 v86, v72, v73
    v_cvt_pk_bf16_f32 v87, v74, v75
    v_cvt_pk_bf16_f32 v88, v76, v77
    v_cvt_pk_bf16_f32 v89, v78, v79
    v_cvt_pk_bf16_f32 v90, v80, v81
    v_cvt_pk_bf16_f32 v91, v82, v83
    buffer_store_dwordx4 v[84:87], v3, s[4:7], s21 offen offset:0 sc1
    buffer_store_dwordx4 v[88:91], v3, s[4:7], s21 offen offset:256 sc1
    s_waitcnt vmcnt(0) lgkmcnt(0)
    v_mov_b32 v9, s23
    s_add_u32 s23, s23, 1
    buffer_store_dword v9, v4, s[4:7], 0 offen sc1
    s_branch W_U
P_v:
    s_mov_b32 s26, s25
    s_sub_u32 s25, s21, 1073741824
    s_mov_b32 s21, 1073741824
    s_mov_b32 s23, 0
    s_mov_b32 s22, 0
    s_add_u32 m0, s19, 0
    s_nop 0
    buffer_load_dwordx4 v2, s[8:11], s20 offen offset:0 lds
    s_add_u32 m0, s19, 3968
    s_nop 0
    buffer_load_dwordx4 v2, s[8:11], s20 offen offset:128 lds
    s_add_u32 m0, s19, 7936
    s_nop 0
    buffer_load_dwordx4 v2, s[8:11], s20 offen offset:256 lds
    s_add_u32 m0, s19, 11904
    s_nop 0
    buffer_load_dwordx4 v2, s[8:11], s20 offen offset:384 lds
    s_add_u32 m0, s19, 15872
    s_nop 0
    buffer_load_dwordx4 v2, s[8:11], s20 offen offset:512 lds
    s_add_u32 m0, s19, 19840
    s_nop 0
    buffer_load_dwordx4 v2, s[8:11], s20 offen offset:640 lds
    s_add_u32 m0, s19, 23808
    s_nop 0
    buffer_load_dwordx4 v2, s[8:11], s20 offen offset:768 lds
    s_add_u32 m0, s19, 27776
    s_nop 0
    buffer_load_dwordx4 v2, s[8:11], s20 offen offset:896 lds
    s_add_u32 m0, s19, 31744
    s_nop 0
    buffer_load_dwordx4 v2, s[8:11], s20 offen offset:1024 lds
    s_add_u32 m0, s19, 35712
    s_nop 0
    buffer_load_dwordx4 v2, s[8:11], s20 offen offset:1152 lds
    s_add_u32 m0, s19, 39680
    s_nop 0
    buffer_load_dwordx4 v2, s[8:11], s20 offen offset:1280 lds
    s_add_u32 m0, s19, 43648
    s_nop 0
    buffer_load_dwordx4 v2, s[8:11], s20 offen offset:1408 lds
    s_add_u32 m0, s19, 47616
    s_nop 0
    buffer_load_dwordx4 v2, s[8:11], s20 offen offset:1536 lds
    s_add_u32 m0, s19, 51584
    s_nop 0
    buffer_load_dwordx4 v2, s[8:11], s20 offen offset:1664 lds
    s_add_u32 m0, s19, 55552
    s_nop 0
    buffer_load_dwordx4 v2, s[8:11], s20 offen offset:1792 lds
    s_add_u32 m0, s19, 59520
    s_nop 0
    buffer_load_dwordx4 v2, s[8:11], s20 offen offset:1920 lds
    s_add_u32 s20, s20, s24
    s_add_u32 m0, s19, 65536
    s_nop 0
    buffer_load_dwordx4 v2, s[8:11], s20 offen offset:0 lds
    s_add_u32 m0, s19, 69504
    s_nop 0
    buffer_load_dwordx4 v2, s[8:11], s20 offen offset:128 lds
    s_add_u32 m0, s19, 73472
    s_nop 0
    buffer_load_dwordx4 v2, s[8:11], s20 offen offset:256 lds
    v_mov_b32 v9, s23
    s_add_u32 s23, s23, 1
    buffer_store_dword v9, v4, s[4:7], 0 offen sc1
    s_mov_b32 s23, 0
    s_waitcnt vmcnt(12)
    s_barrier
    ds_read_b128 v[20:23], v10 offset:0
    ds_read_b128 v[24:27], v10 offset:2048
    ds_read_b128 v[28:31], v11 offset:0
    ds_read_b128 v[32:35], v11 offset:2048
    ds_read_b128 v[36:39], v10 offset:4096
    ds_read_b128 v[40:43], v10 offset:6144
    ds_read_b128 v[44:47], v11 offset:4096
.p2align 6
P_v_top:
    s_waitcnt lgkmcnt(6)
    v_mfma_f32_16x16x32_bf16 v[52:55], v[20:23], a[0:3], 0
    ds_read_b128 v[48:51], v11 offset:6144
    v_mfma_f32_16x16x32_bf16 v[60:63], v[20:23], a[4:7], 0
    s_waitcnt lgkmcnt(6)
    v_mfma_f32_16x16x32_bf16 v[56:59], v[24:27], a[0:3], 0
    ds_read_b128 v[20:23], v10 offset:8192
    s_add_u32 m0, s19, 77440
    v_mfma_f32_16x16x32_bf16 v[64:67], v[24:27], a[4:7], 0
    buffer_load_dwordx4 v2, s[8:11], s20 offen offset:384 lds
    s_waitcnt lgkmcnt(6)
    v_mfma_f32_16x16x32_bf16 v[52:55], v[28:31], a[8:11], v[52:55]
    ds_read_b128 v[24:27], v10 offset:10240
    v_mfma_f32_16x16x32_bf16 v[60:63], v[28:31], a[12:15], v[60:63]
    s_waitcnt lgkmcnt(6)
    v_mfma_f32_16x16x32_bf16 v[56:59], v[32:35], a[8:11], v[56:59]
    ds_read_b128 v[28:31], v11 offset:8192
    s_add_u32 m0, s19, 81408
    v_mfma_f32_16x16x32_bf16 v[64:67], v[32:35], a[12:15], v[64:67]
    buffer_load_dwordx4 v2, s[8:11], s20 offen offset:512 lds
    s_waitcnt lgkmcnt(6)
    v_mfma_f32_16x16x32_bf16 v[52:55], v[36:39], a[16:19], v[52:55]
    ds_read_b128 v[32:35], v11 offset:10240
    v_mfma_f32_16x16x32_bf16 v[60:63], v[36:39], a[20:23], v[60:63]
    s_waitcnt lgkmcnt(6)
    v_mfma_f32_16x16x32_bf16 v[56:59], v[40:43], a[16:19], v[56:59]
    ds_read_b128 v[36:39], v10 offset:12288
    s_add_u32 m0, s19, 85376
    v_mfma_f32_16x16x32_bf16 v[64:67], v[40:43], a[20:23], v[64:67]
    buffer_load_dwordx4 v2, s[8:11], s20 offen offset:640 lds
    s_waitcnt lgkmcnt(6)
    v_mfma_f32_16x16x32_bf16 v[52:55], v[44:47], a[24:27], v[52:55]
    ds_read_b128 v[40:43], v10 offset:14336
    v_mfma_f32_16x16x32_bf16 v[60:63], v[44:47], a[28:31], v[60:63]
    s_waitcnt lgkmcnt(6)
    v_mfma_f32_16x16x32_bf16 v[56:59], v[48:51], a[24:27], v[56:59]
    ds_read_b128 v[44:47], v11 offset:12288
    s_add_u32 m0, s19, 89344
    v_mfma_f32_16x16x32_bf16 v[64:67], v[48:51], a[28:31], v[64:67]
    buffer_load_dwordx4 v2, s[8:11], s20 offen offset:768 lds
    s_waitcnt lgkmcnt(6)
    v_mfma_f32_16x16x32_bf16 v[52:55], v[20:23], a[32:35], v[52:55]
    ds_read_b128 v[48:51], v11 offset:14336
    v_mfma_f32_16x16x32_bf16 v[60:63], v[20:23], a[36:39], v[60:63]
    s_waitcnt lgkmcnt(6)
    v_mfma_f32_16x16x32_bf16 v[56:59], v[24:27], a[32:35], v[56:59]
    ds_read_b128 v[20:23], v10 offset:16384
    s_add_u32 m0, s19, 93312
    v_mfma_f32_16x16x32_bf16 v[64:67], v[24:27], a[36:39], v[64:67]
    buffer_load_dwordx4 v2, s[8:11], s20 offen offset:896 lds
    s_waitcnt lgkmcnt(6)
    v_mfma_f32_16x16x32_bf16 v[52:55], v[28:31], a[40:43], v[52:55]
    ds_read_b128 v[24:27], v10 offset:18432
    v_mfma_f32_16x16x32_bf16 v[60:63], v[28:31], a[44:47], v[60:63]
    v_cvt_pk_bf16_f32 v84, v68, v69
    s_waitcnt lgkmcnt(6)
    v_mfma_f32_16x16x32_bf16 v[56:59], v[32:35], a[40:43], v[56:59]
    ds_read_b128 v[28:31], v11 offset:16384
    v_mfma_f32_16x16x32_bf16 v[64:67], v[32:35], a[44:47], v[64:67]
    v_cvt_pk_bf16_f32 v85, v70, v71
    s_waitcnt lgkmcnt(6)
    v_mfma_f32_16x16x32_bf16 v[52:55], v[36:39], a[48:51], v[52:55]
    ds_read_b128 v[32:35], v11 offset:18432
    v_mfma_f32_16x16x32_bf16 v[60:63], v[36:39], a[52:55], v[60:63]
    v_cvt_pk_bf16_f32 v86, v72, v73
    s_waitcnt lgkmcnt(6)
    v_mfma_f32_16x16x32_bf16 v[56:59], v[40:43], a[48:51], v[56:59]
    ds_read_b128 v[36:39], v10 offset:20480
    v_mfma_f32_16x16x32_bf16 v[64:67], v[40:43], a[52:55], v[64:67]
    v_cvt_pk_bf16_f32 v87, v74, v75
    s_waitcnt lgkmcnt(6)
    v_mfma_f32_16x16x32_bf16 v[52:55], v[44:47], a[56:59], v[52:55]
    ds_read_b128 v[40:43], v10 offset:22528
    v_mfma_f32_16x16x32_bf16 v[60:63], v[44:47], a[60:63], v[60:63]
    v_cvt_pk_bf16_f32 v88, v76, v77
    s_waitcnt lgkmcnt(6)
    v_mfma_f32_16x16x32_bf16 v[56:59], v[48:51], a[56:59], v[56:59]
    ds_read_b128 v[44:47], v11 offset:20480
    v_mfma_f32_16x16x32_bf16 v[64:67], v[48:51], a[60:63], v[64:67]
    v_cvt_pk_bf16_f32 v89, v78, v79
    buffer_store_dwordx4 v[84:87], v3, s[4:7], s21 offen offset:0 sc1
    s_waitcnt lgkmcnt(6)
    v_mfma_f32_16x16x32_bf16 v[52:55], v[20:23], a[64:67], v[52:55]
    ds_read_b128 v[48:51], v11 offset:22528
    v_mfma_f32_16x16x32_bf16 v[60:63], v[20:23], a[68:71], v[60:63]
    v_cvt_pk_bf16_f32 v90, v80, v81
    s_waitcnt lgkmcnt(6)
    v_mfma_f32_16x16x32_bf16 v[56:59], v[24:27], a[64:67], v[56:59]
    ds_read_b128 v[20:23], v10 offset:24576
    v_mfma_f32_16x16x32_bf16 v[64:67], v[24:27], a[68:71], v[64:67]
    v_cvt_pk_bf16_f32 v91, v82, v83
    s_waitcnt lgkmcnt(6)
    v_mfma_f32_16x16x32_bf16 v[52:55], v[28:31], a[72:75], v[52:55]
    ds_read_b128 v[24:27], v10 offset:26624
    v_mfma_f32_16x16x32_bf16 v[60:63], v[28:31], a[76:79], v[60:63]
    s_waitcnt lgkmcnt(6)
    v_mfma_f32_16x16x32_bf16 v[56:59], v[32:35], a[72:75], v[56:59]
    ds_read_b128 v[28:31], v11 offset:24576
    v_mfma_f32_16x16x32_bf16 v[64:67], v[32:35], a[76:79], v[64:67]
    buffer_store_dwordx4 v[88:91], v3, s[4:7], s21 offen offset:256 sc1
    s_waitcnt lgkmcnt(6)
    v_mfma_f32_16x16x32_bf16 v[52:55], v[36:39], a[80:83], v[52:55]
    ds_read_b128 v[32:35], v11 offset:26624
    v_mfma_f32_16x16x32_bf16 v[60:63], v[36:39], a[84:87], v[60:63]
    s_add_u32 s21, s21, s25
    s_mov_b32 s25, s26
    s_waitcnt lgkmcnt(6)
    v_mfma_f32_16x16x32_bf16 v[56:59], v[40:43], a[80:83], v[56:59]
    ds_read_b128 v[36:39], v10 offset:28672
    v_mfma_f32_16x16x32_bf16 v[64:67], v[40:43], a[84:87], v[64:67]
    s_waitcnt lgkmcnt(6)
    v_mfma_f32_16x16x32_bf16 v[52:55], v[44:47], a[88:91], v[52:55]
    ds_read_b128 v[40:43], v10 offset:30720
    v_mfma_f32_16x16x32_bf16 v[60:63], v[44:47], a[92:95], v[60:63]
    s_waitcnt lgkmcnt(6)
    v_mfma_f32_16x16x32_bf16 v[56:59], v[48:51], a[88:91], v[56:59]
    ds_read_b128 v[44:47], v11 offset:28672
    v_mfma_f32_16x16x32_bf16 v[64:67], v[48:51], a[92:95], v[64:67]
    s_waitcnt lgkmcnt(6)
    v_mfma_f32_16x16x32_bf16 v[52:55], v[20:23], a[96:99], v[52:55]
    ds_read_b128 v[48:51], v11 offset:30720
    v_mfma_f32_16x16x32_bf16 v[60:63], v[20:23], a[100:103], v[60:63]
    s_waitcnt lgkmcnt(6)
    v_mfma_f32_16x16x32_bf16 v[56:59], v[24:27], a[96:99], v[56:59]
    s_waitcnt vmcnt(11)
    s_barrier
    ds_read_b128 v[20:23], v10 offset:32768
    v_mfma_f32_16x16x32_bf16 v[64:67], v[24:27], a[100:103], v[64:67]
    s_waitcnt lgkmcnt(6)
    v_mfma_f32_16x16x32_bf16 v[52:55], v[28:31], a[104:107], v[52:55]
    ds_read_b128 v[24:27], v10 offset:34816
    s_add_u32 m0, s19, 97280
    v_mfma_f32_16x16x32_bf16 v[60:63], v[28:31], a[108:111], v[60:63]
    buffer_load_dwordx4 v2, s[8:11], s20 offen offset:1024 lds
    s_waitcnt lgkmcnt(6)
    v_mfma_f32_16x16x32_bf16 v[56:59], v[32:35], a[104:107], v[56:59]
    ds_read_b128 v[28:31], v11 offset:32768
    v_mfma_f32_16x16x32_bf16 v[64:67], v[32:35], a[108:111], v[64:67]
    s_waitcnt lgkmcnt(6)
    v_mfma_f32_16x16x32_bf16 v[52:55], v[36:39], a[112:115], v[52:55]
    ds_read_b128 v[32:35], v11 offset:34816
    s_add_u32 m0, s19, 101248
    v_mfma_f32_16x16x32_bf16 v[60:63], v[36:39], a[116:119], v[60:63]
    buffer_load_dwordx4 v2, s[8:11], s20 offen offset:1152 lds
    s_waitcnt lgkmcnt(6)
    v_mfma_f32_16x16x32_bf16 v[56:59], v[40:43], a[112:115], v[56:59]
    ds_read_b128 v[36:39], v10 offset:36864
    v_mfma_f32_16x16x32_bf16 v[64:67], v[40:43], a[116:119], v[64:67]
    s_waitcnt lgkmcnt(6)
    v_mfma_f32_16x16x32_bf16 v[52:55], v[44:47], a[120:123], v[52:55]
    ds_read_b128 v[40:43], v10 offset:38912
    s_add_u32 m0, s19, 105216
    v_mfma_f32_16x16x32_bf16 v[60:63], v[44:47], a[124:127], v[60:63]
    buffer_load_dwordx4 v2, s[8:11], s20 offen offset:1280 lds
    s_waitcnt lgkmcnt(6)
    v_mfma_f32_16x16x32_bf16 v[56:59], v[48:51], a[120:123], v[56:59]
    ds_read_b128 v[44:47], v11 offset:36864
    v_mfma_f32_16x16x32_bf16 v[64:67], v[48:51], a[124:127], v[64:67]
    s_waitcnt lgkmcnt(6)
    v_mfma_f32_16x16x32_bf16 v[52:55], v[20:23], a[128:131], v[52:55]
    ds_read_b128 v[48:51], v11 offset:38912
    v_mfma_f32_16x16x32_bf16 v[60:63], v[20:23], a[132:135], v[60:63]
    s_waitcnt lgkmcnt(6)
    v_mfma_f32_16x16x32_bf16 v[56:59], v[24:27], a[128:131], v[56:59]
    ds_read_b128 v[20:23], v10 offset:40960
    s_add_u32 m0, s19, 109184
    v_mfma_f32_16x16x32_bf16 v[64:67], v[24:27], a[132:135], v[64:67]
    buffer_load_dwordx4 v2, s[8:11], s20 offen offset:1408 lds
    s_waitcnt lgkmcnt(6)
    v_mfma_f32_16x16x32_bf16 v[52:55], v[28:31], a[136:139], v[52:55]
    ds_read_b128 v[24:27], v10 offset:43008
    v_mfma_f32_16x16x32_bf16 v[60:63], v[28:31], a[140:143], v[60:63]
    s_waitcnt lgkmcnt(6)
    v_mfma_f32_16x16x32_bf16 v[56:59], v[32:35], a[136:139], v[56:59]
    ds_read_b128 v[28:31], v11 offset:40960
    s_add_u32 m0, s19, 113152
    v_mfma_f32_16x16x32_bf16 v[64:67], v[32:35], a[140:143], v[64:67]
    buffer_load_dwordx4 v2, s[8:11], s20 offen offset:1536 lds
    s_waitcnt lgkmcnt(6)
    v_mfma_f32_16x16x32_bf16 v[52:55], v[36:39], a[144:147], v[52:55]
    ds_read_b128 v[32:35], v11 offset:43008
    v_mfma_f32_16x16x32_bf16 v[60:63], v[36:39], a[148:151], v[60:63]
    s_waitcnt lgkmcnt(6)
    v_mfma_f32_16x16x32_bf16 v[56:59], v[40:43], a[144:147], v[56:59]
    ds_read_b128 v[36:39], v10 offset:45056
    s_add_u32 m0, s19, 117120
    v_mfma_f32_16x16x32_bf16 v[64:67], v[40:43], a[148:151], v[64:67]
    buffer_load_dwordx4 v2, s[8:11], s20 offen offset:1664 lds
    s_waitcnt lgkmcnt(6)
    v_mfma_f32_16x16x32_bf16 v[52:55], v[44:47], a[152:155], v[52:55]
    ds_read_b128 v[40:43], v10 offset:47104
    v_mfma_f32_16x16x32_bf16 v[60:63], v[44:47], a[156:159], v[60:63]
    s_waitcnt lgkmcnt(6)
    v_mfma_f32_16x16x32_bf16 v[56:59], v[48:51], a[152:155], v[56:59]
    ds_read_b128 v[44:47], v11 offset:45056
    s_add_u32 m0, s19, 121088
    v_mfma_f32_16x16x32_bf16 v[64:67], v[48:51], a[156:159], v[64:67]
    buffer_load_dwordx4 v2, s[8:11], s20 offen offset:1792 lds
    s_waitcnt lgkmcnt(6)
    v_mfma_f32_16x16x32_bf16 v[52:55], v[20:23], a[160:163], v[52:55]
    ds_read_b128 v[48:51], v11 offset:47104
    v_mfma_f32_16x16x32_bf16 v[60:63], v[20:23], a[164:167], v[60:63]
    s_waitcnt lgkmcnt(6)
    v_mfma_f32_16x16x32_bf16 v[56:59], v[24:27], a[160:163], v[56:59]
    ds_read_b128 v[20:23], v10 offset:49152
    s_add_u32 m0, s19, 125056
    v_mfma_f32_16x16x32_bf16 v[64:67], v[24:27], a[164:167], v[64:67]
    buffer_load_dwordx4 v2, s[8:11], s20 offen offset:1920 lds
    s_waitcnt lgkmcnt(6)
    v_mfma_f32_16x16x32_bf16 v[52:55], v[28:31], a[168:171], v[52:55]
    ds_read_b128 v[24:27], v10 offset:51200
    v_mfma_f32_16x16x32_bf16 v[60:63], v[28:31], a[172:175], v[60:63]
    s_add_u32 s20, s20, s24
    s_waitcnt lgkmcnt(6)
    v_mfma_f32_16x16x32_bf16 v[56:59], v[32:35], a[168:171], v[56:59]
    ds_read_b128 v[28:31], v11 offset:49152
    v_mfma_f32_16x16x32_bf16 v[64:67], v[32:35], a[172:175], v[64:67]
    s_waitcnt lgkmcnt(6)
    v_mfma_f32_16x16x32_bf16 v[52:55], v[36:39], a[176:179], v[52:55]
    ds_read_b128 v[32:35], v11 offset:51200
    v_mfma_f32_16x16x32_bf16 v[60:63], v[36:39], a[180:183], v[60:63]
    s_waitcnt lgkmcnt(6)
    v_mfma_f32_16x16x32_bf16 v[56:59], v[40:43], a[176:179], v[56:59]
    ds_read_b128 v[36:39], v10 offset:53248
    v_mfma_f32_16x16x32_bf16 v[64:67], v[40:43], a[180:183], v[64:67]
    s_waitcnt lgkmcnt(6)
    v_mfma_f32_16x16x32_bf16 v[52:55], v[44:47], a[184:187], v[52:55]
    ds_read_b128 v[40:43], v10 offset:55296
    v_mfma_f32_16x16x32_bf16 v[60:63], v[44:47], a[188:191], v[60:63]
    s_waitcnt lgkmcnt(6)
    v_mfma_f32_16x16x32_bf16 v[56:59], v[48:51], a[184:187], v[56:59]
    ds_read_b128 v[44:47], v11 offset:53248
    v_mfma_f32_16x16x32_bf16 v[64:67], v[48:51], a[188:191], v[64:67]
    s_waitcnt lgkmcnt(6)
    v_mfma_f32_16x16x32_bf16 v[52:55], v[20:23], a[192:195], v[52:55]
    ds_read_b128 v[48:51], v11 offset:55296
    v_mfma_f32_16x16x32_bf16 v[60:63], v[20:23], a[196:199], v[60:63]
    s_waitcnt lgkmcnt(6)
    v_mfma_f32_16x16x32_bf16 v[56:59], v[24:27], a[192:195], v[56:59]
    ds_read_b128 v[20:23], v10 offset:57344
    v_mfma_f32_16x16x32_bf16 v[64:67], v[24:27], a[196:199], v[64:67]
    s_waitcnt lgkmcnt(6)
    v_mfma_f32_16x16x32_bf16 v[52:55], v[28:31], a[200:203], v[52:55]
    ds_read_b128 v[24:27], v10 offset:59392
    v_mfma_f32_16x16x32_bf16 v[60:63], v[28:31], a[204:207], v[60:63]
    s_waitcnt lgkmcnt(6)
    v_mfma_f32_16x16x32_bf16 v[56:59], v[32:35], a[200:203], v[56:59]
    ds_read_b128 v[28:31], v11 offset:57344
    v_mfma_f32_16x16x32_bf16 v[64:67], v[32:35], a[204:207], v[64:67]
    s_waitcnt lgkmcnt(6)
    v_mfma_f32_16x16x32_bf16 v[52:55], v[36:39], a[208:211], v[52:55]
    ds_read_b128 v[32:35], v11 offset:59392
    v_mfma_f32_16x16x32_bf16 v[60:63], v[36:39], a[212:215], v[60:63]
    s_waitcnt lgkmcnt(6)
    v_mfma_f32_16x16x32_bf16 v[56:59], v[40:43], a[208:211], v[56:59]
    ds_read_b128 v[36:39], v10 offset:61440
    v_mfma_f32_16x16x32_bf16 v[64:67], v[40:43], a[212:215], v[64:67]
    s_waitcnt lgkmcnt(6)
    v_mfma_f32_16x16x32_bf16 v[52:55], v[44:47], a[216:219], v[52:55]
    ds_read_b128 v[40:43], v10 offset:63488
    v_mfma_f32_16x16x32_bf16 v[60:63], v[44:47], a[220:223], v[60:63]
    s_waitcnt lgkmcnt(6)
    v_mfma_f32_16x16x32_bf16 v[56:59], v[48:51], a[216:219], v[56:59]
    ds_read_b128 v[44:47], v11 offset:61440
    v_mfma_f32_16x16x32_bf16 v[64:67], v[48:51], a[220:223], v[64:67]
    s_waitcnt lgkmcnt(6)
    v_mfma_f32_16x16x32_bf16 v[52:55], v[20:23], a[224:227], v[52:55]
    ds_read_b128 v[48:51], v11 offset:63488
    v_mfma_f32_16x16x32_bf16 v[60:63], v[20:23], a[228:231], v[60:63]
    s_waitcnt lgkmcnt(6)
    v_mfma_f32_16x16x32_bf16 v[56:59], v[24:27], a[224:227], v[56:59]
    s_waitcnt vmcnt(8)
    s_barrier
    ds_read_b128 v[20:23], v12 offset:0
    v_mfma_f32_16x16x32_bf16 v[64:67], v[24:27], a[228:231], v[64:67]
    s_waitcnt lgkmcnt(6)
    v_mfma_f32_16x16x32_bf16 v[52:55], v[28:31], a[232:235], v[52:55]
    ds_read_b128 v[24:27], v12 offset:2048
    s_add_u32 m0, s19, 0
    v_mfma_f32_16x16x32_bf16 v[60:63], v[28:31], a[236:239], v[60:63]
    buffer_load_dwordx4 v2, s[8:11], s20 offen offset:0 lds
    s_waitcnt lgkmcnt(6)
    v_mfma_f32_16x16x32_bf16 v[56:59], v[32:35], a[232:235], v[56:59]
    ds_read_b128 v[28:31], v13 offset:0
    v_mfma_f32_16x16x32_bf16 v[64:67], v[32:35], a[236:239], v[64:67]
    v_mov_b32 v9, s23
    s_add_u32 s23, s23, 1
    buffer_store_dword v9, v4, s[4:7], 0 offen sc1
    s_waitcnt lgkmcnt(6)
    v_mfma_f32_16x16x32_bf16 v[52:55], v[36:39], a[240:243], v[52:55]
    ds_read_b128 v[32:35], v13 offset:2048
    s_add_u32 m0, s19, 3968
    v_mfma_f32_16x16x32_bf16 v[60:63], v[36:39], a[244:247], v[60:63]
    buffer_load_dwordx4 v2, s[8:11], s20 offen offset:128 lds
    s_waitcnt lgkmcnt(6)
    v_mfma_f32_16x16x32_bf16 v[56:59], v[40:43], a[240:243], v[56:59]
    ds_read_b128 v[36:39], v12 offset:4096
    v_mfma_f32_16x16x32_bf16 v[64:67], v[40:43], a[244:247], v[64:67]
    s_waitcnt lgkmcnt(6)
    v_mfma_f32_16x16x32_bf16 v[52:55], v[44:47], a[248:251], v[52:55]
    ds_read_b128 v[40:43], v12 offset:6144
    s_add_u32 m0, s19, 7936
    v_mfma_f32_16x16x32_bf16 v[60:63], v[44:47], a[252:255], v[60:63]
    buffer_load_dwordx4 v2, s[8:11], s20 offen offset:256 lds
    s_waitcnt lgkmcnt(6)
    v_mfma_f32_16x16x32_bf16 v[56:59], v[48:51], a[248:251], v[56:59]
    ds_read_b128 v[44:47], v13 offset:4096
    v_mfma_f32_16x16x32_bf16 v[64:67], v[48:51], a[252:255], v[64:67]
    s_waitcnt lgkmcnt(6)
    v_mfma_f32_16x16x32_bf16 v[68:71], v[20:23], a[0:3], 0
    ds_read_b128 v[48:51], v13 offset:6144
    v_mfma_f32_16x16x32_bf16 v[76:79], v[20:23], a[4:7], 0
    s_waitcnt lgkmcnt(6)
    v_mfma_f32_16x16x32_bf16 v[72:75], v[24:27], a[0:3], 0
    ds_read_b128 v[20:23], v12 offset:8192
    s_add_u32 m0, s19, 11904
    v_mfma_f32_16x16x32_bf16 v[80:83], v[24:27], a[4:7], 0
    buffer_load_dwordx4 v2, s[8:11], s20 offen offset:384 lds
    s_waitcnt lgkmcnt(6)
    v_mfma_f32_16x16x32_bf16 v[68:71], v[28:31], a[8:11], v[68:71]
    ds_read_b128 v[24:27], v12 offset:10240
    v_mfma_f32_16x16x32_bf16 v[76:79], v[28:31], a[12:15], v[76:79]
    s_waitcnt lgkmcnt(6)
    v_mfma_f32_16x16x32_bf16 v[72:75], v[32:35], a[8:11], v[72:75]
    ds_read_b128 v[28:31], v13 offset:8192
    s_add_u32 m0, s19, 15872
    v_mfma_f32_16x16x32_bf16 v[80:83], v[32:35], a[12:15], v[80:83]
    buffer_load_dwordx4 v2, s[8:11], s20 offen offset:512 lds
    s_waitcnt lgkmcnt(6)
    v_mfma_f32_16x16x32_bf16 v[68:71], v[36:39], a[16:19], v[68:71]
    ds_read_b128 v[32:35], v13 offset:10240
    v_mfma_f32_16x16x32_bf16 v[76:79], v[36:39], a[20:23], v[76:79]
    s_waitcnt lgkmcnt(6)
    v_mfma_f32_16x16x32_bf16 v[72:75], v[40:43], a[16:19], v[72:75]
    ds_read_b128 v[36:39], v12 offset:12288
    s_add_u32 m0, s19, 19840
    v_mfma_f32_16x16x32_bf16 v[80:83], v[40:43], a[20:23], v[80:83]
    buffer_load_dwordx4 v2, s[8:11], s20 offen offset:640 lds
    s_waitcnt lgkmcnt(6)
    v_mfma_f32_16x16x32_bf16 v[68:71], v[44:47], a[24:27], v[68:71]
    ds_read_b128 v[40:43], v12 offset:14336
    v_mfma_f32_16x16x32_bf16 v[76:79], v[44:47], a[28:31], v[76:79]
    s_waitcnt lgkmcnt(6)
    v_mfma_f32_16x16x32_bf16 v[72:75], v[48:51], a[24:27], v[72:75]
    ds_read_b128 v[44:47], v13 offset:12288
    s_add_u32 m0, s19, 23808
    v_mfma_f32_16x16x32_bf16 v[80:83], v[48:51], a[28:31], v[80:83]
    buffer_load_dwordx4 v2, s[8:11], s20 offen offset:768 lds
    s_waitcnt lgkmcnt(6)
    v_mfma_f32_16x16x32_bf16 v[68:71], v[20:23], a[32:35], v[68:71]
    ds_read_b128 v[48:51], v13 offset:14336
    v_mfma_f32_16x16x32_bf16 v[76:79], v[20:23], a[36:39], v[76:79]
    s_waitcnt lgkmcnt(6)
    v_mfma_f32_16x16x32_bf16 v[72:75], v[24:27], a[32:35], v[72:75]
    ds_read_b128 v[20:23], v12 offset:16384
    s_add_u32 m0, s19, 27776
    v_mfma_f32_16x16x32_bf16 v[80:83], v[24:27], a[36:39], v[80:83]
    buffer_load_dwordx4 v2, s[8:11], s20 offen offset:896 lds
    s_waitcnt lgkmcnt(6)
    v_mfma_f32_16x16x32_bf16 v[68:71], v[28:31], a[40:43], v[68:71]
    ds_read_b128 v[24:27], v12 offset:18432
    v_mfma_f32_16x16x32_bf16 v[76:79], v[28:31], a[44:47], v[76:79]
    v_cvt_pk_bf16_f32 v84, v52, v53
    s_waitcnt lgkmcnt(6)
    v_mfma_f32_16x16x32_bf16 v[72:75], v[32:35], a[40:43], v[72:75]
    ds_read_b128 v[28:31], v13 offset:16384
    v_mfma_f32_16x16x32_bf16 v[80:83], v[32:35], a[44:47], v[80:83]
    v_cvt_pk_bf16_f32 v85, v54, v55
    s_waitcnt lgkmcnt(6)
    v_mfma_f32_16x16x32_bf16 v[68:71], v[36:39], a[48:51], v[68:71]
    ds_read_b128 v[32:35], v13 offset:18432
    v_mfma_f32_16x16x32_bf16 v[76:79], v[36:39], a[52:55], v[76:79]
    v_cvt_pk_bf16_f32 v86, v56, v57
    s_waitcnt lgkmcnt(6)
    v_mfma_f32_16x16x32_bf16 v[72:75], v[40:43], a[48:51], v[72:75]
    ds_read_b128 v[36:39], v12 offset:20480
    v_mfma_f32_16x16x32_bf16 v[80:83], v[40:43], a[52:55], v[80:83]
    v_cvt_pk_bf16_f32 v87, v58, v59
    s_waitcnt lgkmcnt(6)
    v_mfma_f32_16x16x32_bf16 v[68:71], v[44:47], a[56:59], v[68:71]
    ds_read_b128 v[40:43], v12 offset:22528
    v_mfma_f32_16x16x32_bf16 v[76:79], v[44:47], a[60:63], v[76:79]
    v_cvt_pk_bf16_f32 v88, v60, v61
    s_waitcnt lgkmcnt(6)
    v_mfma_f32_16x16x32_bf16 v[72:75], v[48:51], a[56:59], v[72:75]
    ds_read_b128 v[44:47], v13 offset:20480
    v_mfma_f32_16x16x32_bf16 v[80:83], v[48:51], a[60:63], v[80:83]
    v_cvt_pk_bf16_f32 v89, v62, v63
    buffer_store_dwordx4 v[84:87], v3, s[4:7], s21 offen offset:0 sc1
    s_waitcnt lgkmcnt(6)
    v_mfma_f32_16x16x32_bf16 v[68:71], v[20:23], a[64:67], v[68:71]
    ds_read_b128 v[48:51], v13 offset:22528
    v_mfma_f32_16x16x32_bf16 v[76:79], v[20:23], a[68:71], v[76:79]
    v_cvt_pk_bf16_f32 v90, v64, v65
    s_waitcnt lgkmcnt(6)
    v_mfma_f32_16x16x32_bf16 v[72:75], v[24:27], a[64:67], v[72:75]
    ds_read_b128 v[20:23], v12 offset:24576
    v_mfma_f32_16x16x32_bf16 v[80:83], v[24:27], a[68:71], v[80:83]
    v_cvt_pk_bf16_f32 v91, v66, v67
    s_waitcnt lgkmcnt(6)
    v_mfma_f32_16x16x32_bf16 v[68:71], v[28:31], a[72:75], v[68:71]
    ds_read_b128 v[24:27], v12 offset:26624
    v_mfma_f32_16x16x32_bf16 v[76:79], v[28:31], a[76:79], v[76:79]
    s_waitcnt lgkmcnt(6)
    v_mfma_f32_16x16x32_bf16 v[72:75], v[32:35], a[72:75], v[72:75]
    ds_read_b128 v[28:31], v13 offset:24576
    v_mfma_f32_16x16x32_bf16 v[80:83], v[32:35], a[76:79], v[80:83]
    buffer_store_dwordx4 v[88:91], v3, s[4:7], s21 offen offset:256 sc1
    s_waitcnt lgkmcnt(6)
    v_mfma_f32_16x16x32_bf16 v[68:71], v[36:39], a[80:83], v[68:71]
    ds_read_b128 v[32:35], v13 offset:26624
    v_mfma_f32_16x16x32_bf16 v[76:79], v[36:39], a[84:87], v[76:79]
    s_add_u32 s21, s21, s25
    s_mov_b32 s25, s26
    s_waitcnt lgkmcnt(6)
    v_mfma_f32_16x16x32_bf16 v[72:75], v[40:43], a[80:83], v[72:75]
    ds_read_b128 v[36:39], v12 offset:28672
    v_mfma_f32_16x16x32_bf16 v[80:83], v[40:43], a[84:87], v[80:83]
    s_waitcnt lgkmcnt(6)
    v_mfma_f32_16x16x32_bf16 v[68:71], v[44:47], a[88:91], v[68:71]
    ds_read_b128 v[40:43], v12 offset:30720
    v_mfma_f32_16x16x32_bf16 v[76:79], v[44:47], a[92:95], v[76:79]
    s_waitcnt lgkmcnt(6)
    v_mfma_f32_16x16x32_bf16 v[72:75], v[48:51], a[88:91], v[72:75]
    ds_read_b128 v[44:47], v13 offset:28672
    v_mfma_f32_16x16x32_bf16 v[80:83], v[48:51], a[92:95], v[80:83]
    s_waitcnt lgkmcnt(6)
    v_mfma_f32_16x16x32_bf16 v[68:71], v[20:23], a[96:99], v[68:71]
    ds_read_b128 v[48:51], v13 offset:30720
    v_mfma_f32_16x16x32_bf16 v[76:79], v[20:23], a[100:103], v[76:79]
    s_waitcnt lgkmcnt(6)
    v_mfma_f32_16x16x32_bf16 v[72:75], v[24:27], a[96:99], v[72:75]
    s_waitcnt vmcnt(11)
    s_barrier
    ds_read_b128 v[20:23], v12 offset:32768
    v_mfma_f32_16x16x32_bf16 v[80:83], v[24:27], a[100:103], v[80:83]
    s_waitcnt lgkmcnt(6)
    v_mfma_f32_16x16x32_bf16 v[68:71], v[28:31], a[104:107], v[68:71]
    ds_read_b128 v[24:27], v12 offset:34816
    s_add_u32 m0, s19, 31744
    v_mfma_f32_16x16x32_bf16 v[76:79], v[28:31], a[108:111], v[76:79]
    buffer_load_dwordx4 v2, s[8:11], s20 offen offset:1024 lds
    s_waitcnt lgkmcnt(6)
    v_mfma_f32_16x16x32_bf16 v[72:75], v[32:35], a[104:107], v[72:75]
    ds_read_b128 v[28:31], v13 offset:32768
    v_mfma_f32_16x16x32_bf16 v[80:83], v[32:35], a[108:111], v[80:83]
    s_waitcnt lgkmcnt(6)
    v_mfma_f32_16x16x32_bf16 v[68:71], v[36:39], a[112:115], v[68:71]
    ds_read_b128 v[32:35], v13 offset:34816
    s_add_u32 m0, s19, 35712
    v_mfma_f32_16x16x32_bf16 v[76:79], v[36:39], a[116:119], v[76:79]
    buffer_load_dwordx4 v2, s[8:11], s20 offen offset:1152 lds
    s_waitcnt lgkmcnt(6)
    v_mfma_f32_16x16x32_bf16 v[72:75], v[40:43], a[112:115], v[72:75]
    ds_read_b128 v[36:39], v12 offset:36864
    v_mfma_f32_16x16x32_bf16 v[80:83], v[40:43], a[116:119], v[80:83]
    s_waitcnt lgkmcnt(6)
    v_mfma_f32_16x16x32_bf16 v[68:71], v[44:47], a[120:123], v[68:71]
    ds_read_b128 v[40:43], v12 offset:38912
    s_add_u32 m0, s19, 39680
    v_mfma_f32_16x16x32_bf16 v[76:79], v[44:47], a[124:127], v[76:79]
    buffer_load_dwordx4 v2, s[8:11], s20 offen offset:1280 lds
    s_waitcnt lgkmcnt(6)
    v_mfma_f32_16x16x32_bf16 v[72:75], v[48:51], a[120:123], v[72:75]
    ds_read_b128 v[44:47], v13 offset:36864
    v_mfma_f32_16x16x32_bf16 v[80:83], v[48:51], a[124:127], v[80:83]
    s_waitcnt lgkmcnt(6)
    v_mfma_f32_16x16x32_bf16 v[68:71], v[20:23], a[128:131], v[68:71]
    ds_read_b128 v[48:51], v13 offset:38912
    v_mfma_f32_16x16x32_bf16 v[76:79], v[20:23], a[132:135], v[76:79]
    s_waitcnt lgkmcnt(6)
    v_mfma_f32_16x16x32_bf16 v[72:75], v[24:27], a[128:131], v[72:75]
    ds_read_b128 v[20:23], v12 offset:40960
    s_add_u32 m0, s19, 43648
    v_mfma_f32_16x16x32_bf16 v[80:83], v[24:27], a[132:135], v[80:83]
    buffer_load_dwordx4 v2, s[8:11], s20 offen offset:1408 lds
    s_waitcnt lgkmcnt(6)
    v_mfma_f32_16x16x32_bf16 v[68:71], v[28:31], a[136:139], v[68:71]
    ds_read_b128 v[24:27], v12 offset:43008
    v_mfma_f32_16x16x32_bf16 v[76:79], v[28:31], a[140:143], v[76:79]
    s_waitcnt lgkmcnt(6)
    v_mfma_f32_16x16x32_bf16 v[72:75], v[32:35], a[136:139], v[72:75]
    ds_read_b128 v[28:31], v13 offset:40960
    s_add_u32 m0, s19, 47616
    v_mfma_f32_16x16x32_bf16 v[80:83], v[32:35], a[140:143], v[80:83]
    buffer_load_dwordx4 v2, s[8:11], s20 offen offset:1536 lds
    s_waitcnt lgkmcnt(6)
    v_mfma_f32_16x16x32_bf16 v[68:71], v[36:39], a[144:147], v[68:71]
    ds_read_b128 v[32:35], v13 offset:43008
    v_mfma_f32_16x16x32_bf16 v[76:79], v[36:39], a[148:151], v[76:79]
    s_waitcnt lgkmcnt(6)
    v_mfma_f32_16x16x32_bf16 v[72:75], v[40:43], a[144:147], v[72:75]
    ds_read_b128 v[36:39], v12 offset:45056
    s_add_u32 m0, s19, 51584
    v_mfma_f32_16x16x32_bf16 v[80:83], v[40:43], a[148:151], v[80:83]
    buffer_load_dwordx4 v2, s[8:11], s20 offen offset:1664 lds
    s_waitcnt lgkmcnt(6)
    v_mfma_f32_16x16x32_bf16 v[68:71], v[44:47], a[152:155], v[68:71]
    ds_read_b128 v[40:43], v12 offset:47104
    v_mfma_f32_16x16x32_bf16 v[76:79], v[44:47], a[156:159], v[76:79]
    s_waitcnt lgkmcnt(6)
    v_mfma_f32_16x16x32_bf16 v[72:75], v[48:51], a[152:155], v[72:75]
    ds_read_b128 v[44:47], v13 offset:45056
    s_add_u32 m0, s19, 55552
    v_mfma_f32_16x16x32_bf16 v[80:83], v[48:51], a[156:159], v[80:83]
    buffer_load_dwordx4 v2, s[8:11], s20 offen offset:1792 lds
    s_waitcnt lgkmcnt(6)
    v_mfma_f32_16x16x32_bf16 v[68:71], v[20:23], a[160:163], v[68:71]
    ds_read_b128 v[48:51], v13 offset:47104
    v_mfma_f32_16x16x32_bf16 v[76:79], v[20:23], a[164:167], v[76:79]
    s_waitcnt lgkmcnt(6)
    v_mfma_f32_16x16x32_bf16 v[72:75], v[24:27], a[160:163], v[72:75]
    ds_read_b128 v[20:23], v12 offset:49152
    s_add_u32 m0, s19, 59520
    v_mfma_f32_16x16x32_bf16 v[80:83], v[24:27], a[164:167], v[80:83]
    buffer_load_dwordx4 v2, s[8:11], s20 offen offset:1920 lds
    s_waitcnt lgkmcnt(6)
    v_mfma_f32_16x16x32_bf16 v[68:71], v[28:31], a[168:171], v[68:71]
    ds_read_b128 v[24:27], v12 offset:51200
    v_mfma_f32_16x16x32_bf16 v[76:79], v[28:31], a[172:175], v[76:79]
    s_add_u32 s20, s20, s24
    s_waitcnt lgkmcnt(6)
    v_mfma_f32_16x16x32_bf16 v[72:75], v[32:35], a[168:171], v[72:75]
    ds_read_b128 v[28:31], v13 offset:49152
    v_mfma_f32_16x16x32_bf16 v[80:83], v[32:35], a[172:175], v[80:83]
    s_waitcnt lgkmcnt(6)
    v_mfma_f32_16x16x32_bf16 v[68:71], v[36:39], a[176:179], v[68:71]
    ds_read_b128 v[32:35], v13 offset:51200
    v_mfma_f32_16x16x32_bf16 v[76:79], v[36:39], a[180:183], v[76:79]
    s_waitcnt lgkmcnt(6)
    v_mfma_f32_16x16x32_bf16 v[72:75], v[40:43], a[176:179], v[72:75]
    ds_read_b128 v[36:39], v12 offset:53248
    v_mfma_f32_16x16x32_bf16 v[80:83], v[40:43], a[180:183], v[80:83]
    s_waitcnt lgkmcnt(6)
    v_mfma_f32_16x16x32_bf16 v[68:71], v[44:47], a[184:187], v[68:71]
    ds_read_b128 v[40:43], v12 offset:55296
    v_mfma_f32_16x16x32_bf16 v[76:79], v[44:47], a[188:191], v[76:79]
    s_waitcnt lgkmcnt(6)
    v_mfma_f32_16x16x32_bf16 v[72:75], v[48:51], a[184:187], v[72:75]
    ds_read_b128 v[44:47], v13 offset:53248
    v_mfma_f32_16x16x32_bf16 v[80:83], v[48:51], a[188:191], v[80:83]
    s_waitcnt lgkmcnt(6)
    v_mfma_f32_16x16x32_bf16 v[68:71], v[20:23], a[192:195], v[68:71]
    ds_read_b128 v[48:51], v13 offset:55296
    v_mfma_f32_16x16x32_bf16 v[76:79], v[20:23], a[196:199], v[76:79]
    s_waitcnt lgkmcnt(6)
    v_mfma_f32_16x16x32_bf16 v[72:75], v[24:27], a[192:195], v[72:75]
    ds_read_b128 v[20:23], v12 offset:57344
    v_mfma_f32_16x16x32_bf16 v[80:83], v[24:27], a[196:199], v[80:83]
    s_waitcnt lgkmcnt(6)
    v_mfma_f32_16x16x32_bf16 v[68:71], v[28:31], a[200:203], v[68:71]
    ds_read_b128 v[24:27], v12 offset:59392
    v_mfma_f32_16x16x32_bf16 v[76:79], v[28:31], a[204:207], v[76:79]
    s_waitcnt lgkmcnt(6)
    v_mfma_f32_16x16x32_bf16 v[72:75], v[32:35], a[200:203], v[72:75]
    ds_read_b128 v[28:31], v13 offset:57344
    v_mfma_f32_16x16x32_bf16 v[80:83], v[32:35], a[204:207], v[80:83]
    s_waitcnt lgkmcnt(6)
    v_mfma_f32_16x16x32_bf16 v[68:71], v[36:39], a[208:211], v[68:71]
    ds_read_b128 v[32:35], v13 offset:59392
    v_mfma_f32_16x16x32_bf16 v[76:79], v[36:39], a[212:215], v[76:79]
    s_waitcnt lgkmcnt(6)
    v_mfma_f32_16x16x32_bf16 v[72:75], v[40:43], a[208:211], v[72:75]
    ds_read_b128 v[36:39], v12 offset:61440
    v_mfma_f32_16x16x32_bf16 v[80:83], v[40:43], a[212:215], v[80:83]
    s_waitcnt lgkmcnt(6)
    v_mfma_f32_16x16x32_bf16 v[68:71], v[44:47], a[216:219], v[68:71]
    ds_read_b128 v[40:43], v12 offset:63488
    v_mfma_f32_16x16x32_bf16 v[76:79], v[44:47], a[220:223], v[76:79]
    s_waitcnt lgkmcnt(6)
    v_mfma_f32_16x16x32_bf16 v[72:75], v[48:51], a[216:219], v[72:75]
    ds_read_b128 v[44:47], v13 offset:61440
    v_mfma_f32_16x16x32_bf16 v[80:83], v[48:51], a[220:223], v[80:83]
    s_waitcnt lgkmcnt(6)
    v_mfma_f32_16x16x32_bf16 v[68:71], v[20:23], a[224:227], v[68:71]
    ds_read_b128 v[48:51], v13 offset:63488
    v_mfma_f32_16x16x32_bf16 v[76:79], v[20:23], a[228:231], v[76:79]
    s_waitcnt lgkmcnt(6)
    v_mfma_f32_16x16x32_bf16 v[72:75], v[24:27], a[224:227], v[72:75]
    s_waitcnt vmcnt(8)
    s_barrier
    ds_read_b128 v[20:23], v10 offset:0
    v_mfma_f32_16x16x32_bf16 v[80:83], v[24:27], a[228:231], v[80:83]
    s_waitcnt lgkmcnt(6)
    v_mfma_f32_16x16x32_bf16 v[68:71], v[28:31], a[232:235], v[68:71]
    ds_read_b128 v[24:27], v10 offset:2048
    s_add_u32 m0, s19, 65536
    v_mfma_f32_16x16x32_bf16 v[76:79], v[28:31], a[236:239], v[76:79]
    buffer_load_dwordx4 v2, s[8:11], s20 offen offset:0 lds
    s_waitcnt lgkmcnt(6)
    v_mfma_f32_16x16x32_bf16 v[72:75], v[32:35], a[232:235], v[72:75]
    ds_read_b128 v[28:31], v11 offset:0
    v_mfma_f32_16x16x32_bf16 v[80:83], v[32:35], a[236:239], v[80:83]
    v_mov_b32 v9, s23
    s_add_u32 s23, s23, 1
    buffer_store_dword v9, v4, s[4:7], 0 offen sc1
    s_waitcnt lgkmcnt(6)
    v_mfma_f32_16x16x32_bf16 v[68:71], v[36:39], a[240:243], v[68:71]
    ds_read_b128 v[32:35], v11 offset:2048
    s_add_u32 m0, s19, 69504
    v_mfma_f32_16x16x32_bf16 v[76:79], v[36:39], a[244:247], v[76:79]
    buffer_load_dwordx4 v2, s[8:11], s20 offen offset:128 lds
    s_waitcnt lgkmcnt(6)
    v_mfma_f32_16x16x32_bf16 v[72:75], v[40:43], a[240:243], v[72:75]
    ds_read_b128 v[36:39], v10 offset:4096
    v_mfma_f32_16x16x32_bf16 v[80:83], v[40:43], a[244:247], v[80:83]
    s_waitcnt lgkmcnt(6)
    v_mfma_f32_16x16x32_bf16 v[68:71], v[44:47], a[248:251], v[68:71]
    ds_read_b128 v[40:43], v10 offset:6144
    s_add_u32 m0, s19, 73472
    v_mfma_f32_16x16x32_bf16 v[76:79], v[44:47], a[252:255], v[76:79]
    buffer_load_dwordx4 v2, s[8:11], s20 offen offset:256 lds
    s_waitcnt lgkmcnt(6)
    v_mfma_f32_16x16x32_bf16 v[72:75], v[48:51], a[248:251], v[72:75]
    ds_read_b128 v[44:47], v11 offset:4096
    v_mfma_f32_16x16x32_bf16 v[80:83], v[48:51], a[252:255], v[80:83]
    s_add_u32 s22, s22, 2
    s_cmp_lt_u32 s22, 64
    s_cbranch_scc1 P_v_top
    v_cvt_pk_bf16_f32 v84, v68, v69
    v_cvt_pk_bf16_f32 v85, v70, v71
    s_nop 0
    v_cvt_pk_bf16_f32 v86, v72, v73
    v_cvt_pk_bf16_f32 v87, v74, v75
    v_cvt_pk_bf16_f32 v88, v76, v77
    v_cvt_pk_bf16_f32 v89, v78, v79
    v_cvt_pk_bf16_f32 v90, v80, v81
    v_cvt_pk_bf16_f32 v91, v82, v83
    buffer_store_dwordx4 v[84:87], v3, s[4:7], s21 offen offset:0 sc1
    buffer_store_dwordx4 v[88:91], v3, s[4:7], s21 offen offset:256 sc1
    s_waitcnt vmcnt(0) lgkmcnt(0)
    v_mov_b32 v9, s23
    s_add_u32 s23, s23, 1
    buffer_store_dword v9, v4, s[4:7], 0 offen sc1
    s_branch W_U
W_U:
    v_lshlrev_b32 v5, 2, v1
    s_mov_b32 s18, 0
rdv_13:
    global_load_dword v6, v5, s[100:101] sc1
    s_lshl_b32 s17, s98, 2
    s_waitcnt vmcnt(0)
    v_lshrrev_b32 v9, s17, v6
    s_cmp_eq_u32 s98, 0
    s_cselect_b32 s17, 0x0f0f0f0f, s17
    s_cselect_b32 s17, s17, 0x01010101
    v_and_b32 v9, s17, v9
    v_cmp_ne_u32 vcc, 0x01010101, v9
    s_nop 0
    s_cbranch_vccz rdvok_14
    v_sad_u8 v9, v9, 0, 0
    s_nop 1
    v_add_u32_dpp v9, v9, v9 quad_perm:[1,0,3,2] row_mask:0xf bank_mask:0xf
    v_cmp_ne_u32 vcc, 8, v9
    s_nop 0
    s_cbranch_vccnz rdvw_15
    s_mov_b32 s98, 1
    s_and_b32 s3, s97, 7
    s_barrier
    s_branch role_start
rdvw_15:
    s_sleep 4
    s_add_u32 s18, s18, 1
    s_cmp_lt_u32 s18, 262144
    s_cbranch_scc1 rdv_13
    s_mov_b32 s92, 1048576
rdvok_14:
    s_load_dwordx2 s[8:9], s[0:1], 64
    s_load_dwordx2 s[12:13], s[0:1], 80
    s_mov_b32 s10, 8388608
    s_mov_b32 s11, 0x20000
    s_mov_b32 s14, 8388608
    s_mov_b32 s15, 0x20000
    s_and_b32 s35, s93, 15
    s_lshr_b32 s28, s93, 4
    s_lshl_b32 s17, s90, 1
    s_add_u32 s28, s28, s17
    s_lshl_b32 s20, s16, 21
    s_lshl_b32 s17, s35, 7
    s_add_u32 s20, s20, s17
    v_lshrrev_b32 v5, 2, v1
    v_and_b32 v6, 3, v1
    v_lshlrev_b32 v7, 4, v6
    v_lshl_add_u32 v7, v5, 11, v7
    v_lshlrev_b32 v8, 3, v6
    v_bfe_u32 v5, v1, 2, 2
    v_lshrrev_b32 v6, 4, v1
    v_lshl_add_u32 v5, v6, 3, v5
    v_lshl_add_u32 v8, v5, 6, v8
    s_lshl_b32 s19, s16, 15
    v_add_u32 v8, s19, v8
    s_waitcnt lgkmcnt(0)
    s_barrier
    s_sub_u32 s17, s90, 1
    s_and_b32 s17, s17, 3
    s_lshl_b32 s17, s17, 3
    s_and_b32 s18, s93, 7
    s_add_u32 s17, s17, s18
    s_lshl_b32 s17, s17, 8
    v_add_lshl_u32 v5, v0, s17, 11
    s_and_b32 s17, s93, 8
    s_lshl_b32 s17, s17, 7
    buffer_load_dword v48, v5, s[8:11], s17 offen offset:384
    s_add_u32 m0, s19, 0
    s_add_u32 s17, s20, 0
    buffer_load_dwordx4 v7, s[8:11], s17 offen lds
    s_add_u32 m0, s19, 1024
    s_add_u32 s17, s20, 32768
    buffer_load_dwordx4 v7, s[8:11], s17 offen lds
    s_add_u32 m0, s19, 2048
    s_add_u32 s17, s20, 65536
    buffer_load_dwordx4 v7, s[8:11], s17 offen lds
    s_add_u32 m0, s19, 3072
    s_add_u32 s17, s20, 98304
    buffer_load_dwordx4 v7, s[8:11], s17 offen lds
    s_add_u32 m0, s19, 4096
    s_add_u32 s17, s20, 131072
    buffer_load_dwordx4 v7, s[8:11], s17 offen lds
    s_add_u32 m0, s19, 5120
    s_add_u32 s17, s20, 163840
    buffer_load_dwordx4 v7, s[8:11], s17 offen lds
    s_add_u32 m0, s19, 6144
    s_add_u32 s17, s20, 196608
    buffer_load_dwordx4 v7, s[8:11], s17 offen lds
    s_add_u32 m0, s19, 7168
    s_add_u32 s17, s20, 229376
    buffer_load_dwordx4 v7, s[8:11], s17 offen lds
    s_add_u32 m0, s19, 8192
    s_add_u32 s17, s20, 262144
    buffer_load_dwordx4 v7, s[8:11], s17 offen lds
    s_add_u32 m0, s19, 9216
    s_add_u32 s17, s20, 294912
    buffer_load_dwordx4 v7, s[8:11], s17 offen lds
    s_add_u32 m0, s19, 10240
    s_add_u32 s17, s20, 327680
    buffer_load_dwordx4 v7, s[8:11], s17 offen lds
    s_add_u32 m0, s19, 11264
    s_add_u32 s17, s20, 360448
    buffer_load_dwordx4 v7, s[8:11], s17 offen lds
    s_add_u32 m0, s19, 12288
    s_add_u32 s17, s20, 393216
    buffer_load_dwordx4 v7, s[8:11], s17 offen lds
    s_add_u32 m0, s19, 13312
    s_add_u32 s17, s20, 425984
    buffer_load_dwordx4 v7, s[8:11], s17 offen lds
    s_add_u32 m0, s19, 14336
    s_add_u32 s17, s20, 458752
    buffer_load_dwordx4 v7, s[8:11], s17 offen lds
    s_add_u32 m0, s19, 15360
    s_add_u32 s17, s20, 491520
    buffer_load_dwordx4 v7, s[8:11], s17 offen lds
    s_add_u32 m0, s19, 16384
    s_add_u32 s17, s20, 524288
    buffer_load_dwordx4 v7, s[8:11], s17 offen lds
    s_add_u32 m0, s19, 17408
    s_add_u32 s17, s20, 557056
    buffer_load_dwordx4 v7, s[8:11], s17 offen lds
    s_add_u32 m0, s19, 18432
    s_add_u32 s17, s20, 589824
    buffer_load_dwordx4 v7, s[8:11], s17 offen lds
    s_add_u32 m0, s19, 19456
    s_add_u32 s17, s20, 622592
    buffer_load_dwordx4 v7, s[8:11], s17 offen lds
    s_add_u32 m0, s19, 20480
    s_add_u32 s17, s20, 655360
    buffer_load_dwordx4 v7, s[8:11], s17 offen lds
    s_add_u32 m0, s19, 21504
    s_add_u32 s17, s20, 688128
    buffer_load_dwordx4 v7, s[8:11], s17 offen lds
    s_add_u32 m0, s19, 22528
    s_add_u32 s17, s20, 720896
    buffer_load_dwordx4 v7, s[8:11], s17 offen lds
    s_add_u32 m0, s19, 23552
    s_add_u32 s17, s20, 753664
    buffer_load_dwordx4 v7, s[8:11], s17 offen lds
    s_add_u32 m0, s19, 24576
    s_add_u32 s17, s20, 786432
    buffer_load_dwordx4 v7, s[8:11], s17 offen lds
    s_add_u32 m0, s19, 25600
    s_add_u32 s17, s20, 819200
    buffer_load_dwordx4 v7, s[8:11], s17 offen lds
    s_add_u32 m0, s19, 26624
    s_add_u32 s17, s20, 851968
    buffer_load_dwordx4 v7, s[8:11], s17 offen lds
    s_add_u32 m0, s19, 27648
    s_add_u32 s17, s20, 884736
    buffer_load_dwordx4 v7, s[8:11], s17 offen lds
    s_add_u32 m0, s19, 28672
    s_add_u32 s17, s20, 917504
    buffer_load_dwordx4 v7, s[8:11], s17 offen lds
    s_add_u32 m0, s19, 29696
    s_add_u32 s17, s20, 950272
    buffer_load_dwordx4 v7, s[8:11], s17 offen lds
    s_add_u32 m0, s19, 30720
    s_add_u32 s17, s20, 983040
    buffer_load_dwordx4 v7, s[8:11], s17 offen lds
    s_add_u32 m0, s19, 31744
    s_add_u32 s17, s20, 1015808
    buffer_load_dwordx4 v7, s[8:11], s17 offen lds
    s_waitcnt vmcnt(30)
    ds_read_b64_tr_b16 a[0:1], v8 offset:0
    ds_read_b64_tr_b16 a[2:3], v8 offset:256
    ds_read_b64_tr_b16 a[4:5], v8 offset:32
    ds_read_b64_tr_b16 a[6:7], v8 offset:288
    s_waitcnt vmcnt(28)
    ds_read_b64_tr_b16 a[8:9], v8 offset:2048
    ds_read_b64_tr_b16 a[10:11], v8 offset:2304
    ds_read_b64_tr_b16 a[12:13], v8 offset:2080
    ds_read_b64_tr_b16 a[14:15], v8 offset:2336
    s_waitcnt lgkmcnt(4)
    s_add_u32 m0, s19, 0
    s_add_u32 s17, s20, 1048576
    buffer_load_dwordx4 v7, s[8:11], s17 offen lds
    s_add_u32 m0, s19, 1024
    s_add_u32 s17, s20, 1081344
    buffer_load_dwordx4 v7, s[8:11], s17 offen lds
    s_waitcnt vmcnt(28)
    ds_read_b64_tr_b16 a[16:17], v8 offset:4096
    ds_read_b64_tr_b16 a[18:19], v8 offset:4352
    ds_read_b64_tr_b16 a[20:21], v8 offset:4128
    ds_read_b64_tr_b16 a[22:23], v8 offset:4384
    s_waitcnt lgkmcnt(4)
    s_add_u32 m0, s19, 2048
    s_add_u32 s17, s20, 1114112
    buffer_load_dwordx4 v7, s[8:11], s17 offen lds
    s_add_u32 m0, s19, 3072
    s_add_u32 s17, s20, 1146880
    buffer_load_dwordx4 v7, s[8:11], s17 offen lds
    s_waitcnt vmcnt(28)
    ds_read_b64_tr_b16 a[24:25], v8 offset:6144
    ds_read_b64_tr_b16 a[26:27], v8 offset:6400
    ds_read_b64_tr_b16 a[28:29], v8 offset:6176
    ds_read_b64_tr_b16 a[30:31], v8 offset:6432
    s_waitcnt lgkmcnt(4)
    s_add_u32 m0, s19, 4096
    s_add_u32 s17, s20, 1179648
    buffer_load_dwordx4 v7, s[8:11], s17 offen lds
    s_add_u32 m0, s19, 5120
    s_add_u32 s17, s20, 1212416
    buffer_load_dwordx4 v7, s[8:11], s17 offen lds
    s_waitcnt vmcnt(28)
    ds_read_b64_tr_b16 a[32:33], v8 offset:8192
    ds_read_b64_tr_b16 a[34:35], v8 offset:8448
    ds_read_b64_tr_b16 a[36:37], v8 offset:8224
    ds_read_b64_tr_b16 a[38:39], v8 offset:8480
    s_waitcnt lgkmcnt(4)
    s_add_u32 m0, s19, 6144
    s_add_u32 s17, s20, 1245184
    buffer_load_dwordx4 v7, s[8:11], s17 offen lds
    s_add_u32 m0, s19, 7168
    s_add_u32 s17, s20, 1277952
    buffer_load_dwordx4 v7, s[8:11], s17 offen lds
    s_waitcnt vmcnt(28)
    ds_read_b64_tr_b16 a[40:41], v8 offset:10240
    ds_read_b64_tr_b16 a[42:43], v8 offset:10496
    ds_read_b64_tr_b16 a[44:45], v8 offset:10272
    ds_read_b64_tr_b16 a[46:47], v8 offset:10528
    s_waitcnt lgkmcnt(4)
    s_add_u32 m0, s19, 8192
    s_add_u32 s17, s20, 1310720
    buffer_load_dwordx4 v7, s[8:11], s17 offen lds
    s_add_u32 m0, s19, 9216
    s_add_u32 s17, s20, 1343488
    buffer_load_dwordx4 v7, s[8:11], s17 offen lds
    s_waitcnt vmcnt(28)
    ds_read_b64_tr_b16 a[48:49], v8 offset:12288
    ds_read_b64_tr_b16 a[50:51], v8 offset:12544
    ds_read_b64_tr_b16 a[52:53], v8 offset:12320
    ds_read_b64_tr_b16 a[54:55], v8 offset:12576
    s_waitcnt lgkmcnt(4)
    s_add_u32 m0, s19, 10240
    s_add_u32 s17, s20, 1376256
    buffer_load_dwordx4 v7, s[8:11], s17 offen lds
    s_add_u32 m0, s19, 11264
    s_add_u32 s17, s20, 1409024
    buffer_load_dwordx4 v7, s[8:11], s17 offen lds
    s_waitcnt vmcnt(28)
    ds_read_b64_tr_b16 a[56:57], v8 offset:14336
    ds_read_b64_tr_b16 a[58:59], v8 offset:14592
    ds_read_b64_tr_b16 a[60:61], v8 offset:14368
    ds_read_b64_tr_b16 a[62:63], v8 offset:14624
    s_waitcnt lgkmcnt(4)
    s_add_u32 m0, s19, 12288
    s_add_u32 s17, s20, 1441792
    buffer_load_dwordx4 v7, s[8:11], s17 offen lds
    s_add_u32 m0, s19, 13312
    s_add_u32 s17, s20, 1474560
    buffer_load_dwordx4 v7, s[8:11], s17 offen lds
    s_waitcnt vmcnt(28)
    ds_read_b64_tr_b16 a[64:65], v8 offset:16384
    ds_read_b64_tr_b16 a[66:67], v8 offset:16640
    ds_read_b64_tr_b16 a[68:69], v8 offset:16416
    ds_read_b64_tr_b16 a[70:71], v8 offset:16672
    s_waitcnt lgkmcnt(4)
    s_add_u32 m0, s19, 14336
    s_add_u32 s17, s20, 1507328
    buffer_load_dwordx4 v7, s[8:11], s17 offen lds
    s_add_u32 m0, s19, 15360
    s_add_u32 s17, s20, 1540096
    buffer_load_dwordx4 v7, s[8:11], s17 offen lds
    s_waitcnt vmcnt(28)
    ds_read_b64_tr_b16 a[72:73], v8 offset:18432
    ds_read_b64_tr_b16 a[74:75], v8 offset:18688
    ds_read_b64_tr_b16 a[76:77], v8 offset:18464
    ds_read_b64_tr_b16 a[78:79], v8 offset:18720
    s_waitcnt lgkmcnt(4)
    s_add_u32 m0, s19, 16384
    s_add_u32 s17, s20, 1572864
    buffer_load_dwordx4 v7, s[8:11], s17 offen lds
    s_add_u32 m0, s19, 17408
    s_add_u32 s17, s20, 1605632
    buffer_load_dwordx4 v7, s[8:11], s17 offen lds
    s_waitcnt vmcnt(28)
    ds_read_b64_tr_b16 a[80:81], v8 offset:20480
    ds_read_b64_tr_b16 a[82:83], v8 offset:20736
    ds_read_b64_tr_b16 a[84:85], v8 offset:20512
    ds_read_b64_tr_b16 a[86:87], v8 offset:20768
    s_waitcnt lgkmcnt(4)
    s_add_u32 m0, s19, 18432
    s_add_u32 s17, s20, 1638400
    buffer_load_dwordx4 v7, s[8:11], s17 offen lds
    s_add_u32 m0, s19, 19456
    s_add_u32 s17, s20, 1671168
    buffer_load_dwordx4 v7, s[8:11], s17 offen lds
    s_waitcnt vmcnt(28)
    ds_read_b64_tr_b16 a[88:89], v8 offset:22528
    ds_read_b64_tr_b16 a[90:91], v8 offset:22784
    ds_read_b64_tr_b16 a[92:93], v8 offset:22560
    ds_read_b64_tr_b16 a[94:95], v8 offset:22816
    s_waitcnt lgkmcnt(4)
    s_add_u32 m0, s19, 20480
    s_add_u32 s17, s20, 1703936
    buffer_load_dwordx4 v7, s[8:11], s17 offen lds
    s_add_u32 m0, s19, 21504
    s_add_u32 s17, s20, 1736704
    buffer_load_dwordx4 v7, s[8:11], s17 offen lds
    s_waitcnt vmcnt(28)
    ds_read_b64_tr_b16 a[96:97], v8 offset:24576
    ds_read_b64_tr_b16 a[98:99], v8 offset:24832
    ds_read_b64_tr_b16 a[100:101], v8 offset:24608
    ds_read_b64_tr_b16 a[102:103], v8 offset:24864
    s_waitcnt lgkmcnt(4)
    s_add_u32 m0, s19, 22528
    s_add_u32 s17, s20, 1769472
    buffer_load_dwordx4 v7, s[8:11], s17 offen lds
    s_add_u32 m0, s19, 23552
    s_add_u32 s17, s20, 1802240
    buffer_load_dwordx4 v7, s[8:11], s17 offen lds
    s_waitcnt vmcnt(28)
    ds_read_b64_tr_b16 a[104:105], v8 offset:26624
    ds_read_b64_tr_b16 a[106:107], v8 offset:26880
    ds_read_b64_tr_b16 a[108:109], v8 offset:26656
    ds_read_b64_tr_b16 a[110:111], v8 offset:26912
    s_waitcnt lgkmcnt(4)
    s_add_u32 m0, s19, 24576
    s_add_u32 s17, s20, 1835008
    buffer_load_dwordx4 v7, s[8:11], s17 offen lds
    s_add_u32 m0, s19, 25600
    s_add_u32 s17, s20, 1867776
    buffer_load_dwordx4 v7, s[8:11], s17 offen lds
    s_waitcnt vmcnt(28)
    ds_read_b64_tr_b16 a[112:113], v8 offset:28672
    ds_read_b64_tr_b16 a[114:115], v8 offset:28928
    ds_read_b64_tr_b16 a[116:117], v8 offset:28704
    ds_read_b64_tr_b16 a[118:119], v8 offset:28960
    s_waitcnt lgkmcnt(4)
    s_add_u32 m0, s19, 26624
    s_add_u32 s17, s20, 1900544
    buffer_load_dwordx4 v7, s[8:11], s17 offen lds
    s_add_u32 m0, s19, 27648
    s_add_u32 s17, s20, 1933312
    buffer_load_dwordx4 v7, s[8:11], s17 offen lds
    s_waitcnt vmcnt(28)
    ds_read_b64_tr_b16 a[120:121], v8 offset:30720
    ds_read_b64_tr_b16 a[122:123], v8 offset:30976
    ds_read_b64_tr_b16 a[124:125], v8 offset:30752
    ds_read_b64_tr_b16 a[126:127], v8 offset:31008
    s_waitcnt lgkmcnt(4)
    s_add_u32 m0, s19, 28672
    s_add_u32 s17, s20, 1966080
    buffer_load_dwordx4 v7, s[8:11], s17 offen lds
    s_add_u32 m0, s19, 29696
    s_add_u32 s17, s20, 1998848
    buffer_load_dwordx4 v7, s[8:11], s17 offen lds
    s_waitcnt vmcnt(28)
    ds_read_b64_tr_b16 a[128:129], v8 offset:0
    ds_read_b64_tr_b16 a[130:131], v8 offset:256
    ds_read_b64_tr_b16 a[132:133], v8 offset:32
    ds_read_b64_tr_b16 a[134:135], v8 offset:288
    s_waitcnt lgkmcnt(4)
    s_add_u32 m0, s19, 30720
    s_add_u32 s17, s20, 2031616
    buffer_load_dwordx4 v7, s[8:11], s17 offen lds
    s_add_u32 m0, s19, 31744
    s_add_u32 s17, s20, 2064384
    buffer_load_dwordx4 v7, s[8:11], s17 offen lds
    s_waitcnt vmcnt(28)
    ds_read_b64_tr_b16 a[136:137], v8 offset:2048
    ds_read_b64_tr_b16 a[138:139], v8 offset:2304
    ds_read_b64_tr_b16 a[140:141], v8 offset:2080
    ds_read_b64_tr_b16 a[142:143], v8 offset:2336
    s_waitcnt lgkmcnt(4)
    s_add_u32 m0, s19, 0
    s_add_u32 s17, s20, 64
    buffer_load_dwordx4 v7, s[8:11], s17 offen lds
    s_add_u32 m0, s19, 1024
    s_add_u32 s17, s20, 32832
    buffer_load_dwordx4 v7, s[8:11], s17 offen lds
    s_waitcnt vmcnt(28)
    ds_read_b64_tr_b16 a[144:145], v8 offset:4096
    ds_read_b64_tr_b16 a[146:147], v8 offset:4352
    ds_read_b64_tr_b16 a[148:149], v8 offset:4128
    ds_read_b64_tr_b16 a[150:151], v8 offset:4384
    s_waitcnt lgkmcnt(4)
    s_add_u32 m0, s19, 2048
    s_add_u32 s17, s20, 131136
    buffer_load_dwordx4 v7, s[8:11], s17 offen lds
    s_add_u32 m0, s19, 3072
    s_add_u32 s17, s20, 163904
    buffer_load_dwordx4 v7, s[8:11], s17 offen lds
    s_waitcnt vmcnt(28)
    ds_read_b64_tr_b16 a[152:153], v8 offset:6144
    ds_read_b64_tr_b16 a[154:155], v8 offset:6400
    ds_read_b64_tr_b16 a[156:157], v8 offset:6176
    ds_read_b64_tr_b16 a[158:159], v8 offset:6432
    s_waitcnt lgkmcnt(4)
    s_add_u32 m0, s19, 4096
    s_add_u32 s17, s20, 262208
    buffer_load_dwordx4 v7, s[8:11], s17 offen lds
    s_add_u32 m0, s19, 5120
    s_add_u32 s17, s20, 294976
    buffer_load_dwordx4 v7, s[8:11], s17 offen lds
    s_waitcnt vmcnt(28)
    ds_read_b64_tr_b16 a[160:161], v8 offset:8192
    ds_read_b64_tr_b16 a[162:163], v8 offset:8448
    ds_read_b64_tr_b16 a[164:165], v8 offset:8224
    ds_read_b64_tr_b16 a[166:167], v8 offset:8480
    s_waitcnt lgkmcnt(4)
    s_add_u32 m0, s19, 6144
    s_add_u32 s17, s20, 393280
    buffer_load_dwordx4 v7, s[8:11], s17 offen lds
    s_add_u32 m0, s19, 7168
    s_add_u32 s17, s20, 426048
    buffer_load_dwordx4 v7, s[8:11], s17 offen lds
    s_waitcnt vmcnt(28)
    ds_read_b64_tr_b16 a[168:169], v8 offset:10240
    ds_read_b64_tr_b16 a[170:171], v8 offset:10496
    ds_read_b64_tr_b16 a[172:173], v8 offset:10272
    ds_read_b64_tr_b16 a[174:175], v8 offset:10528
    s_waitcnt lgkmcnt(4)
    s_add_u32 m0, s19, 8192
    s_add_u32 s17, s20, 524352
    buffer_load_dwordx4 v7, s[8:11], s17 offen lds
    s_add_u32 m0, s19, 9216
    s_add_u32 s17, s20, 557120
    buffer_load_dwordx4 v7, s[8:11], s17 offen lds
    s_waitcnt vmcnt(28)
    ds_read_b64_tr_b16 a[176:177], v8 offset:12288
    ds_read_b64_tr_b16 a[178:179], v8 offset:12544
    ds_read_b64_tr_b16 a[180:181], v8 offset:12320
    ds_read_b64_tr_b16 a[182:183], v8 offset:12576
    s_waitcnt lgkmcnt(4)
    s_add_u32 m0, s19, 10240
    s_add_u32 s17, s20, 655424
    buffer_load_dwordx4 v7, s[8:11], s17 offen lds
    s_add_u32 m0, s19, 11264
    s_add_u32 s17, s20, 688192
    buffer_load_dwordx4 v7, s[8:11], s17 offen lds
    s_waitcnt vmcnt(28)
    ds_read_b64_tr_b16 a[184:185], v8 offset:14336
    ds_read_b64_tr_b16 a[186:187], v8 offset:14592
    ds_read_b64_tr_b16 a[188:189], v8 offset:14368
    ds_read_b64_tr_b16 a[190:191], v8 offset:14624
    s_waitcnt lgkmcnt(4)
    s_add_u32 m0, s19, 12288
    s_add_u32 s17, s20, 786496
    buffer_load_dwordx4 v7, s[8:11], s17 offen lds
    s_add_u32 m0, s19, 13312
    s_add_u32 s17, s20, 819264
    buffer_load_dwordx4 v7, s[8:11], s17 offen lds
    s_waitcnt vmcnt(28)
    ds_read_b64_tr_b16 a[192:193], v8 offset:16384
    ds_read_b64_tr_b16 a[194:195], v8 offset:16640
    ds_read_b64_tr_b16 a[196:197], v8 offset:16416
    ds_read_b64_tr_b16 a[198:199], v8 offset:16672
    s_waitcnt lgkmcnt(4)
    s_add_u32 m0, s19, 14336
    s_add_u32 s17, s20, 917568
    buffer_load_dwordx4 v7, s[8:11], s17 offen lds
    s_add_u32 m0, s19, 15360
    s_add_u32 s17, s20, 950336
    buffer_load_dwordx4 v7, s[8:11], s17 offen lds
    s_waitcnt vmcnt(28)
    ds_read_b64_tr_b16 a[200:201], v8 offset:18432
    ds_read_b64_tr_b16 a[202:203], v8 offset:18688
    ds_read_b64_tr_b16 a[204:205], v8 offset:18464
    ds_read_b64_tr_b16 a[206:207], v8 offset:18720
    s_waitcnt lgkmcnt(4)
    s_add_u32 m0, s19, 16384
    s_add_u32 s17, s20, 1048640
    buffer_load_dwordx4 v7, s[8:11], s17 offen lds
    s_add_u32 m0, s19, 17408
    s_add_u32 s17, s20, 1081408
    buffer_load_dwordx4 v7, s[8:11], s17 offen lds
    s_waitcnt vmcnt(28)
    ds_read_b64_tr_b16 a[208:209], v8 offset:20480
    ds_read_b64_tr_b16 a[210:211], v8 offset:20736
    ds_read_b64_tr_b16 a[212:213], v8 offset:20512
    ds_read_b64_tr_b16 a[214:215], v8 offset:20768
    s_waitcnt lgkmcnt(4)
    s_add_u32 m0, s19, 18432
    s_add_u32 s17, s20, 1179712
    buffer_load_dwordx4 v7, s[8:11], s17 offen lds
    s_add_u32 m0, s19, 19456
    s_add_u32 s17, s20, 1212480
    buffer_load_dwordx4 v7, s[8:11], s17 offen lds
    s_waitcnt vmcnt(28)
    ds_read_b64_tr_b16 a[216:217], v8 offset:22528
    ds_read_b64_tr_b16 a[218:219], v8 offset:22784
    ds_read_b64_tr_b16 a[220:221], v8 offset:22560
    ds_read_b64_tr_b16 a[222:223], v8 offset:22816
    s_waitcnt lgkmcnt(4)
    s_add_u32 m0, s19, 20480
    s_add_u32 s17, s20, 1310784
    buffer_load_dwordx4 v7, s[8:11], s17 offen lds
    s_add_u32 m0, s19, 21504
    s_add_u32 s17, s20, 1343552
    buffer_load_dwordx4 v7, s[8:11], s17 offen lds
    s_waitcnt vmcnt(28)
    ds_read_b64_tr_b16 a[224:225], v8 offset:24576
    ds_read_b64_tr_b16 a[226:227], v8 offset:24832
    ds_read_b64_tr_b16 a[228:229], v8 offset:24608
    ds_read_b64_tr_b16 a[230:231], v8 offset:24864
    s_waitcnt lgkmcnt(4)
    s_add_u32 m0, s19, 22528
    s_add_u32 s17, s20, 1441856
    buffer_load_dwordx4 v7, s[8:11], s17 offen lds
    s_add_u32 m0, s19, 23552
    s_add_u32 s17, s20, 1474624
    buffer_load_dwordx4 v7, s[8:11], s17 offen lds
    s_waitcnt vmcnt(28)
    ds_read_b64_tr_b16 a[232:233], v8 offset:26624
    ds_read_b64_tr_b16 a[234:235], v8 offset:26880
    ds_read_b64_tr_b16 a[236:237], v8 offset:26656
    ds_read_b64_tr_b16 a[238:239], v8 offset:26912
    s_waitcnt lgkmcnt(4)
    s_add_u32 m0, s19, 24576
    s_add_u32 s17, s20, 1572928
    buffer_load_dwordx4 v7, s[8:11], s17 offen lds
    s_add_u32 m0, s19, 25600
    s_add_u32 s17, s20, 1605696
    buffer_load_dwordx4 v7, s[8:11], s17 offen lds
    s_waitcnt vmcnt(28)
    ds_read_b64_tr_b16 a[240:241], v8 offset:28672
    ds_read_b64_tr_b16 a[242:243], v8 offset:28928
    ds_read_b64_tr_b16 a[244:245], v8 offset:28704
    ds_read_b64_tr_b16 a[246:247], v8 offset:28960
    s_waitcnt lgkmcnt(4)
    s_add_u32 m0, s19, 26624
    s_add_u32 s17, s20, 1704000
    buffer_load_dwordx4 v7, s[8:11], s17 offen lds
    s_add_u32 m0, s19, 27648
    s_add_u32 s17, s20, 1736768
    buffer_load_dwordx4 v7, s[8:11], s17 offen lds
    s_waitcnt vmcnt(28)
    ds_read_b64_tr_b16 a[248:249], v8 offset:30720
    ds_read_b64_tr_b16 a[250:251], v8 offset:30976
    ds_read_b64_tr_b16 a[252:253], v8 offset:30752
    ds_read_b64_tr_b16 a[254:255], v8 offset:31008
    s_waitcnt lgkmcnt(4)
    s_add_u32 m0, s19, 28672
    s_add_u32 s17, s20, 1835072
    buffer_load_dwordx4 v7, s[8:11], s17 offen lds
    s_add_u32 m0, s19, 29696
    s_add_u32 s17, s20, 1867840
    buffer_load_dwordx4 v7, s[8:11], s17 offen lds
    s_waitcnt vmcnt(28)
    ds_read_b64_tr_b16 v[128:129], v8 offset:0
    ds_read_b64_tr_b16 v[130:131], v8 offset:256
    ds_read_b64_tr_b16 v[132:133], v8 offset:32
    ds_read_b64_tr_b16 v[134:135], v8 offset:288
    s_waitcnt lgkmcnt(4)
    s_add_u32 m0, s19, 30720
    s_add_u32 s17, s20, 1966144
    buffer_load_dwordx4 v7, s[8:11], s17 offen lds
    s_add_u32 m0, s19, 31744
    s_add_u32 s17, s20, 1998912
    buffer_load_dwordx4 v7, s[8:11], s17 offen lds
    s_waitcnt vmcnt(28)
    ds_read_b64_tr_b16 v[136:137], v8 offset:2048
    ds_read_b64_tr_b16 v[138:139], v8 offset:2304
    ds_read_b64_tr_b16 v[140:141], v8 offset:2080
    ds_read_b64_tr_b16 v[142:143], v8 offset:2336
    s_waitcnt lgkmcnt(4)
    s_add_u32 m0, s19, 0
    s_add_u32 s17, s20, 65600
    buffer_load_dwordx4 v7, s[8:11], s17 offen lds
    s_add_u32 m0, s19, 1024
    s_add_u32 s17, s20, 98368
    buffer_load_dwordx4 v7, s[8:11], s17 offen lds
    s_waitcnt vmcnt(28)
    ds_read_b64_tr_b16 v[144:145], v8 offset:4096
    ds_read_b64_tr_b16 v[146:147], v8 offset:4352
    ds_read_b64_tr_b16 v[148:149], v8 offset:4128
    ds_read_b64_tr_b16 v[150:151], v8 offset:4384
    s_waitcnt lgkmcnt(4)
    s_add_u32 m0, s19, 2048
    s_add_u32 s17, s20, 196672
    buffer_load_dwordx4 v7, s[8:11], s17 offen lds
    s_add_u32 m0, s19, 3072
    s_add_u32 s17, s20, 229440
    buffer_load_dwordx4 v7, s[8:11], s17 offen lds
    s_waitcnt vmcnt(28)
    ds_read_b64_tr_b16 v[152:153], v8 offset:6144
    ds_read_b64_tr_b16 v[154:155], v8 offset:6400
    ds_read_b64_tr_b16 v[156:157], v8 offset:6176
    ds_read_b64_tr_b16 v[158:159], v8 offset:6432
    s_waitcnt lgkmcnt(4)
    s_add_u32 m0, s19, 4096
    s_add_u32 s17, s20, 327744
    buffer_load_dwordx4 v7, s[8:11], s17 offen lds
    s_add_u32 m0, s19, 5120
    s_add_u32 s17, s20, 360512
    buffer_load_dwordx4 v7, s[8:11], s17 offen lds
    s_waitcnt vmcnt(28)
    ds_read_b64_tr_b16 v[160:161], v8 offset:8192
    ds_read_b64_tr_b16 v[162:163], v8 offset:8448
    ds_read_b64_tr_b16 v[164:165], v8 offset:8224
    ds_read_b64_tr_b16 v[166:167], v8 offset:8480
    s_waitcnt lgkmcnt(4)
    s_add_u32 m0, s19, 6144
    s_add_u32 s17, s20, 458816
    buffer_load_dwordx4 v7, s[8:11], s17 offen lds
    s_add_u32 m0, s19, 7168
    s_add_u32 s17, s20, 491584
    buffer_load_dwordx4 v7, s[8:11], s17 offen lds
    s_waitcnt vmcnt(28)
    ds_read_b64_tr_b16 v[168:169], v8 offset:10240
    ds_read_b64_tr_b16 v[170:171], v8 offset:10496
    ds_read_b64_tr_b16 v[172:173], v8 offset:10272
    ds_read_b64_tr_b16 v[174:175], v8 offset:10528
    s_waitcnt lgkmcnt(4)
    s_add_u32 m0, s19, 8192
    s_add_u32 s17, s20, 589888
    buffer_load_dwordx4 v7, s[8:11], s17 offen lds
    s_add_u32 m0, s19, 9216
    s_add_u32 s17, s20, 622656
    buffer_load_dwordx4 v7, s[8:11], s17 offen lds
    s_waitcnt vmcnt(28)
    ds_read_b64_tr_b16 v[176:177], v8 offset:12288
    ds_read_b64_tr_b16 v[178:179], v8 offset:12544
    ds_read_b64_tr_b16 v[180:181], v8 offset:12320
    ds_read_b64_tr_b16 v[182:183], v8 offset:12576
    s_waitcnt lgkmcnt(4)
    s_add_u32 m0, s19, 10240
    s_add_u32 s17, s20, 720960
    buffer_load_dwordx4 v7, s[8:11], s17 offen lds
    s_add_u32 m0, s19, 11264
    s_add_u32 s17, s20, 753728
    buffer_load_dwordx4 v7, s[8:11], s17 offen lds
    s_waitcnt vmcnt(28)
    ds_read_b64_tr_b16 v[184:185], v8 offset:14336
    ds_read_b64_tr_b16 v[186:187], v8 offset:14592
    ds_read_b64_tr_b16 v[188:189], v8 offset:14368
    ds_read_b64_tr_b16 v[190:191], v8 offset:14624
    s_waitcnt lgkmcnt(4)
    s_add_u32 m0, s19, 12288
    s_add_u32 s17, s20, 852032
    buffer_load_dwordx4 v7, s[8:11], s17 offen lds
    s_add_u32 m0, s19, 13312
    s_add_u32 s17, s20, 884800
    buffer_load_dwordx4 v7, s[8:11], s17 offen lds
    s_waitcnt vmcnt(28)
    ds_read_b64_tr_b16 v[192:193], v8 offset:16384
    ds_read_b64_tr_b16 v[194:195], v8 offset:16640
    ds_read_b64_tr_b16 v[196:197], v8 offset:16416
    ds_read_b64_tr_b16 v[198:199], v8 offset:16672
    s_waitcnt lgkmcnt(4)
    s_add_u32 m0, s19, 14336
    s_add_u32 s17, s20, 983104
    buffer_load_dwordx4 v7, s[8:11], s17 offen lds
    s_add_u32 m0, s19, 15360
    s_add_u32 s17, s20, 1015872
    buffer_load_dwordx4 v7, s[8:11], s17 offen lds
    s_waitcnt vmcnt(28)
    ds_read_b64_tr_b16 v[200:201], v8 offset:18432
    ds_read_b64_tr_b16 v[202:203], v8 offset:18688
    ds_read_b64_tr_b16 v[204:205], v8 offset:18464
    ds_read_b64_tr_b16 v[206:207], v8 offset:18720
    s_waitcnt lgkmcnt(4)
    s_add_u32 m0, s19, 16384
    s_add_u32 s17, s20, 1114176
    buffer_load_dwordx4 v7, s[8:11], s17 offen lds
    s_add_u32 m0, s19, 17408
    s_add_u32 s17, s20, 1146944
    buffer_load_dwordx4 v7, s[8:11], s17 offen lds
    s_waitcnt vmcnt(28)
    ds_read_b64_tr_b16 v[208:209], v8 offset:20480
    ds_read_b64_tr_b16 v[210:211], v8 offset:20736
    ds_read_b64_tr_b16 v[212:213], v8 offset:20512
    ds_read_b64_tr_b16 v[214:215], v8 offset:20768
    s_waitcnt lgkmcnt(4)
    s_add_u32 m0, s19, 18432
    s_add_u32 s17, s20, 1245248
    buffer_load_dwordx4 v7, s[8:11], s17 offen lds
    s_add_u32 m0, s19, 19456
    s_add_u32 s17, s20, 1278016
    buffer_load_dwordx4 v7, s[8:11], s17 offen lds
    s_waitcnt vmcnt(28)
    ds_read_b64_tr_b16 v[216:217], v8 offset:22528
    ds_read_b64_tr_b16 v[218:219], v8 offset:22784
    ds_read_b64_tr_b16 v[220:221], v8 offset:22560
    ds_read_b64_tr_b16 v[222:223], v8 offset:22816
    s_waitcnt lgkmcnt(4)
    s_add_u32 m0, s19, 20480
    s_add_u32 s17, s20, 1376320
    buffer_load_dwordx4 v7, s[8:11], s17 offen lds
    s_add_u32 m0, s19, 21504
    s_add_u32 s17, s20, 1409088
    buffer_load_dwordx4 v7, s[8:11], s17 offen lds
    s_waitcnt vmcnt(28)
    ds_read_b64_tr_b16 v[224:225], v8 offset:24576
    ds_read_b64_tr_b16 v[226:227], v8 offset:24832
    ds_read_b64_tr_b16 v[228:229], v8 offset:24608
    ds_read_b64_tr_b16 v[230:231], v8 offset:24864
    s_waitcnt lgkmcnt(4)
    s_add_u32 m0, s19, 22528
    s_add_u32 s17, s20, 1507392
    buffer_load_dwordx4 v7, s[8:11], s17 offen lds
    s_add_u32 m0, s19, 23552
    s_add_u32 s17, s20, 1540160
    buffer_load_dwordx4 v7, s[8:11], s17 offen lds
    s_waitcnt vmcnt(28)
    ds_read_b64_tr_b16 v[232:233], v8 offset:26624
    ds_read_b64_tr_b16 v[234:235], v8 offset:26880
    ds_read_b64_tr_b16 v[236:237], v8 offset:26656
    ds_read_b64_tr_b16 v[238:239], v8 offset:26912
    s_waitcnt lgkmcnt(4)
    s_add_u32 m0, s19, 24576
    s_add_u32 s17, s20, 1638464
    buffer_load_dwordx4 v7, s[8:11], s17 offen lds
    s_add_u32 m0, s19, 25600
    s_add_u32 s17, s20, 1671232
    buffer_load_dwordx4 v7, s[8:11], s17 offen lds
    s_waitcnt vmcnt(28)
    ds_read_b64_tr_b16 v[240:241], v8 offset:28672
    ds_read_b64_tr_b16 v[242:243], v8 offset:28928
    ds_read_b64_tr_b16 v[244:245], v8 offset:28704
    ds_read_b64_tr_b16 v[246:247], v8 offset:28960
    s_waitcnt lgkmcnt(4)
    s_add_u32 m0, s19, 26624
    s_add_u32 s17, s20, 1769536
    buffer_load_dwordx4 v7, s[8:11], s17 offen lds
    s_add_u32 m0, s19, 27648
    s_add_u32 s17, s20, 1802304
    buffer_load_dwordx4 v7, s[8:11], s17 offen lds
    s_waitcnt vmcnt(28)
    ds_read_b64_tr_b16 v[248:249], v8 offset:30720
    ds_read_b64_tr_b16 v[250:251], v8 offset:30976
    ds_read_b64_tr_b16 v[252:253], v8 offset:30752
    ds_read_b64_tr_b16 v[254:255], v8 offset:31008
    s_waitcnt lgkmcnt(4)
    s_add_u32 m0, s19, 28672
    s_add_u32 s17, s20, 1900608
    buffer_load_dwordx4 v7, s[8:11], s17 offen lds
    s_add_u32 m0, s19, 29696
    s_add_u32 s17, s20, 1933376
    buffer_load_dwordx4 v7, s[8:11], s17 offen lds
    s_waitcnt lgkmcnt(0)
    s_add_u32 m0, s19, 30720
    s_add_u32 s17, s20, 2031680
    buffer_load_dwordx4 v7, s[8:11], s17 offen lds
    s_add_u32 m0, s19, 31744
    s_add_u32 s17, s20, 2064448
    buffer_load_dwordx4 v7, s[8:11], s17 offen lds
    v_lshlrev_b32 v15, 4, v1
    v_add_u32 v10, s19, v15
    s_lshl_b32 s17, s16, 10
    s_add_u32 s17, s17, 131072
    v_add_u32 v14, s17, v15
    s_lshl_b32 s17, s16, 12
    s_add_u32 s18, s17, 147456
    v_add_u32 v15, s18, v15
    v_bfe_u32 v11, v1, 3, 2
    v_and_b32 v5, 7, v1
    v_lshlrev_b32 v5, 9, v5
    v_lshl_add_u32 v11, v11, 7, v5
    s_add_u32 s17, s17, 100728832
    v_add_u32 v11, s17, v11
    v_mov_b32 v12, 0
    v_and_b32 v13, 15, v1
    v_lshrrev_b32 v5, 4, v1
    v_lshlrev_b32 v5, 3, v5
    v_lshl_add_u32 v13, v13, 12, v5
    s_lshl_b32 s17, s35, 7
    s_lshl_b32 s18, s16, 5
    s_add_u32 s17, s17, s18
    s_add_u32 s17, s17, 2048
    v_add_u32 v13, s17, v13
    s_waitcnt vmcnt(0)
U_wait:
    s_mov_b32 s29, s92
U_fl:
    s_lshr_b32 s17, s28, 3
    v_cmp_ge_u32 vcc, s17, v12
    s_lshl_b32 s18, s28, 2
    s_and_b32 s18, s18, 24
    s_lshr_b32 s17, vcc_lo, s18
    s_and_b32 s17, s17, 0xff
    s_cbranch_scc0 U_go
    s_cmp_ge_u32 s29, 1048576
    s_cselect_b32 s92, 1048576, s92
    s_cbranch_scc1 U_go
    s_lshl_b32 s17, s17, s18
    s_cmp_eq_u32 s29, 0
    s_cselect_b32 exec_lo, -1, s17
    s_mov_b32 exec_hi, 0
    s_add_u32 s29, s29, 1
    buffer_load_dword v12, v11, s[4:7], 0 offen sc1
    s_mov_b64 exec, -1
    s_sleep 2
    s_waitcnt vmcnt(0)
    s_branch U_fl
U_go:
    s_lshl_b32 s30, s28, 17
    s_add_u32 s30, s30, 54525952
    buffer_load_dwordx4 v[64:67], v10, s[4:7], s30 offen offset:0
    buffer_load_dwordx4 v[68:71], v10, s[4:7], s30 offen offset:1024
    buffer_load_dwordx4 v[72:75], v10, s[4:7], s30 offen offset:2048
    buffer_load_dwordx4 v[76:79], v10, s[4:7], s30 offen offset:3072
    s_add_u32 s30, s30, 4096
    buffer_load_dwordx4 v[80:83], v10, s[4:7], s30 offen offset:0
    buffer_load_dwordx4 v[84:87], v10, s[4:7], s30 offen offset:1024
    buffer_load_dwordx4 v[88:91], v10, s[4:7], s30 offen offset:2048
    buffer_load_dwordx4 v[92:95], v10, s[4:7], s30 offen offset:3072
    s_add_u32 s30, s30, 4096
    buffer_load_dwordx4 v[96:99], v10, s[4:7], s30 offen offset:0
    buffer_load_dwordx4 v[100:103], v10, s[4:7], s30 offen offset:1024
    buffer_load_dwordx4 v[104:107], v10, s[4:7], s30 offen offset:2048
    buffer_load_dwordx4 v[108:111], v10, s[4:7], s30 offen offset:3072
    s_add_u32 s30, s30, 4096
    buffer_load_dwordx4 v[112:115], v10, s[4:7], s30 offen offset:0
    buffer_load_dwordx4 v[116:119], v10, s[4:7], s30 offen offset:1024
    buffer_load_dwordx4 v[120:123], v10, s[4:7], s30 offen offset:2048
    s_mov_b32 s34, 0
    s_mov_b32 s31, 1073741824
    ds_read_b64_tr_b16 v[32:33], v8 offset:0
    ds_read_b64_tr_b16 v[34:35], v8 offset:256
    ds_read_b64_tr_b16 v[36:37], v8 offset:32
    ds_read_b64_tr_b16 v[38:39], v8 offset:288
    ds_read_b128 v[48:51], v15 offset:0
    ds_read_b128 v[52:55], v15 offset:1024
    ds_read_b128 v[56:59], v15 offset:2048
    ds_read_b128 v[60:63], v15 offset:3072
.p2align 6
U_item:
    s_waitcnt vmcnt(14)
    v_mfma_f32_16x16x32_bf16 v[16:19], a[0:3], v[64:67], 0
    buffer_load_dwordx4 v[124:127], v10, s[4:7], s30 offen offset:3072
    v_mfma_f32_16x16x32_bf16 v[20:23], a[4:7], v[64:67], 0
    s_add_u32 s33, s28, 6
    s_lshr_b32 s17, s33, 3
    v_cmp_ge_u32 vcc, s17, v12
    s_lshl_b32 s18, s33, 2
    s_and_b32 s18, s18, 24
    v_mfma_f32_16x16x32_bf16 v[24:27], v[128:131], v[64:67], 0
    s_lshr_b32 s17, vcc_lo, s18
    s_and_b32 s17, s17, 0xff
    s_lshl_b32 exec_lo, s17, s18
    s_mov_b32 exec_hi, 0
    buffer_load_dword v12, v11, s[4:7], 0 offen sc1
    s_mov_b64 exec, -1
    v_mfma_f32_16x16x32_bf16 v[28:31], v[132:135], v[64:67], 0
    s_waitcnt vmcnt(15)
    s_waitcnt lgkmcnt(4)
    v_mfma_f32_16x16x32_bf16 v[16:19], a[8:11], v[68:71], v[16:19]
    s_add_u32 s30, s30, 4096
    buffer_load_dwordx4 v[64:67], v10, s[4:7], s30 offen offset:0
    ds_read_b64_tr_b16 v[40:41], v8 offset:2048
    ds_read_b64_tr_b16 v[42:43], v8 offset:2304
    v_mfma_f32_16x16x32_bf16 v[20:23], a[12:15], v[68:71], v[20:23]
    ds_read_b64_tr_b16 v[44:45], v8 offset:2080
    ds_read_b64_tr_b16 v[46:47], v8 offset:2336
    v_mfma_f32_16x16x32_bf16 v[24:27], v[32:35], v[68:71], v[24:27]
    v_mfma_f32_16x16x32_bf16 v[28:31], v[36:39], v[68:71], v[28:31]
    s_waitcnt vmcnt(15)
    v_mfma_f32_16x16x32_bf16 v[16:19], a[16:19], v[72:75], v[16:19]
    buffer_load_dwordx4 v[68:71], v10, s[4:7], s30 offen offset:1024
    v_mfma_f32_16x16x32_bf16 v[20:23], a[20:23], v[72:75], v[20:23]
    s_waitcnt lgkmcnt(4)
    s_cmp_eq_u32 s34, 0
    s_cbranch_scc1 U_nb
    s_barrier
U_nb:
    v_mfma_f32_16x16x32_bf16 v[24:27], v[136:139], v[72:75], v[24:27]
    ds_read_b128 v[48:51], v15 offset:0
    ds_read_b128 v[52:55], v15 offset:1024
    v_mfma_f32_16x16x32_bf16 v[28:31], v[140:143], v[72:75], v[28:31]
    ds_read_b128 v[56:59], v15 offset:2048
    ds_read_b128 v[60:63], v15 offset:3072
    s_waitcnt vmcnt(15)
    s_waitcnt lgkmcnt(4)
    v_mfma_f32_16x16x32_bf16 v[16:19], a[24:27], v[76:79], v[16:19]
    buffer_load_dwordx4 v[72:75], v10, s[4:7], s30 offen offset:2048
    ds_read_b64_tr_b16 v[32:33], v8 offset:4096
    ds_read_b64_tr_b16 v[34:35], v8 offset:4352
    v_mfma_f32_16x16x32_bf16 v[20:23], a[28:31], v[76:79], v[20:23]
    ds_read_b64_tr_b16 v[36:37], v8 offset:4128
    ds_read_b64_tr_b16 v[38:39], v8 offset:4384
    v_mfma_f32_16x16x32_bf16 v[24:27], v[40:43], v[76:79], v[24:27]
    v_mfma_f32_16x16x32_bf16 v[28:31], v[44:47], v[76:79], v[28:31]
    s_waitcnt vmcnt(15)
    v_mfma_f32_16x16x32_bf16 v[16:19], a[32:35], v[80:83], v[16:19]
    buffer_load_dwordx4 v[76:79], v10, s[4:7], s30 offen offset:3072
    s_waitcnt lgkmcnt(4)
    v_mfma_f32_16x16x32_bf16 v[20:23], a[36:39], v[80:83], v[20:23]
    v_add_f32 v48, v48, v52
    v_add_f32 v49, v49, v53
    v_mfma_f32_16x16x32_bf16 v[24:27], v[144:147], v[80:83], v[24:27]
    v_add_f32 v50, v50, v54
    v_add_f32 v51, v51, v55
    v_mfma_f32_16x16x32_bf16 v[28:31], v[148:151], v[80:83], v[28:31]
    s_waitcnt vmcnt(15)
    s_waitcnt lgkmcnt(0)
    v_mfma_f32_16x16x32_bf16 v[16:19], a[40:43], v[84:87], v[16:19]
    s_add_u32 s30, s30, 4096
    buffer_load_dwordx4 v[80:83], v10, s[4:7], s30 offen offset:0
    ds_read_b64_tr_b16 v[40:41], v8 offset:6144
    ds_read_b64_tr_b16 v[42:43], v8 offset:6400
    v_mfma_f32_16x16x32_bf16 v[20:23], a[44:47], v[84:87], v[20:23]
    v_add_f32 v56, v56, v60
    v_add_f32 v57, v57, v61
    ds_read_b64_tr_b16 v[44:45], v8 offset:6176
    ds_read_b64_tr_b16 v[46:47], v8 offset:6432
    v_mfma_f32_16x16x32_bf16 v[24:27], v[32:35], v[84:87], v[24:27]
    v_add_f32 v58, v58, v62
    v_add_f32 v59, v59, v63
    v_mfma_f32_16x16x32_bf16 v[28:31], v[36:39], v[84:87], v[28:31]
    s_waitcnt vmcnt(15)
    v_mfma_f32_16x16x32_bf16 v[16:19], a[48:51], v[88:91], v[16:19]
    buffer_load_dwordx4 v[84:87], v10, s[4:7], s30 offen offset:1024
    v_mfma_f32_16x16x32_bf16 v[20:23], a[52:55], v[88:91], v[20:23]
    v_add_f32 v48, v48, v56
    v_add_f32 v49, v49, v57
    v_mfma_f32_16x16x32_bf16 v[24:27], v[152:155], v[88:91], v[24:27]
    v_add_f32 v50, v50, v58
    v_add_f32 v51, v51, v59
    v_mfma_f32_16x16x32_bf16 v[28:31], v[156:159], v[88:91], v[28:31]
    s_waitcnt vmcnt(15)
    s_waitcnt lgkmcnt(0)
    v_mfma_f32_16x16x32_bf16 v[16:19], a[56:59], v[92:95], v[16:19]
    buffer_load_dwordx4 v[88:91], v10, s[4:7], s30 offen offset:2048
    ds_read_b64_tr_b16 v[32:33], v8 offset:8192
    ds_read_b64_tr_b16 v[34:35], v8 offset:8448
    v_mfma_f32_16x16x32_bf16 v[20:23], a[60:63], v[92:95], v[20:23]
    v_cvt_pk_bf16_f32 v52, v48, v49
    v_cvt_pk_bf16_f32 v53, v50, v51
    ds_read_b64_tr_b16 v[36:37], v8 offset:8224
    ds_read_b64_tr_b16 v[38:39], v8 offset:8480
    v_mfma_f32_16x16x32_bf16 v[24:27], v[40:43], v[92:95], v[24:27]
    v_mfma_f32_16x16x32_bf16 v[28:31], v[44:47], v[92:95], v[28:31]
    s_waitcnt vmcnt(15)
    v_mfma_f32_16x16x32_bf16 v[16:19], a[64:67], v[96:99], v[16:19]
    buffer_load_dwordx4 v[92:95], v10, s[4:7], s30 offen offset:3072
    v_mfma_f32_16x16x32_bf16 v[20:23], a[68:71], v[96:99], v[20:23]
    buffer_store_dwordx2 v[52:53], v13, s[12:15], s31 offen
    v_xor_b32 v15, 0x4000, v15
    v_mfma_f32_16x16x32_bf16 v[24:27], v[160:163], v[96:99], v[24:27]
    v_mfma_f32_16x16x32_bf16 v[28:31], v[164:167], v[96:99], v[28:31]
    s_waitcnt vmcnt(16)
    s_waitcnt lgkmcnt(0)
    v_mfma_f32_16x16x32_bf16 v[16:19], a[72:75], v[100:103], v[16:19]
    s_add_u32 s30, s30, 4096
    buffer_load_dwordx4 v[96:99], v10, s[4:7], s30 offen offset:0
    ds_read_b64_tr_b16 v[40:41], v8 offset:10240
    ds_read_b64_tr_b16 v[42:43], v8 offset:10496
    v_mfma_f32_16x16x32_bf16 v[20:23], a[76:79], v[100:103], v[20:23]
    ds_read_b64_tr_b16 v[44:45], v8 offset:10272
    ds_read_b64_tr_b16 v[46:47], v8 offset:10528
    v_mfma_f32_16x16x32_bf16 v[24:27], v[32:35], v[100:103], v[24:27]
    v_mfma_f32_16x16x32_bf16 v[28:31], v[36:39], v[100:103], v[28:31]
    s_waitcnt vmcnt(16)
    v_mfma_f32_16x16x32_bf16 v[16:19], a[80:83], v[104:107], v[16:19]
    buffer_load_dwordx4 v[100:103], v10, s[4:7], s30 offen offset:1024
    v_mfma_f32_16x16x32_bf16 v[20:23], a[84:87], v[104:107], v[20:23]
    v_mfma_f32_16x16x32_bf16 v[24:27], v[168:171], v[104:107], v[24:27]
    v_mfma_f32_16x16x32_bf16 v[28:31], v[172:175], v[104:107], v[28:31]
    s_waitcnt vmcnt(16)
    s_waitcnt lgkmcnt(0)
    v_mfma_f32_16x16x32_bf16 v[16:19], a[88:91], v[108:111], v[16:19]
    buffer_load_dwordx4 v[104:107], v10, s[4:7], s30 offen offset:2048
    ds_read_b64_tr_b16 v[32:33], v8 offset:12288
    ds_read_b64_tr_b16 v[34:35], v8 offset:12544
    v_mfma_f32_16x16x32_bf16 v[20:23], a[92:95], v[108:111], v[20:23]
    ds_read_b64_tr_b16 v[36:37], v8 offset:12320
    ds_read_b64_tr_b16 v[38:39], v8 offset:12576
    v_mfma_f32_16x16x32_bf16 v[24:27], v[40:43], v[108:111], v[24:27]
    v_mfma_f32_16x16x32_bf16 v[28:31], v[44:47], v[108:111], v[28:31]
    s_waitcnt vmcnt(16)
    v_mfma_f32_16x16x32_bf16 v[16:19], a[96:99], v[112:115], v[16:19]
    buffer_load_dwordx4 v[108:111], v10, s[4:7], s30 offen offset:3072
    v_mfma_f32_16x16x32_bf16 v[20:23], a[100:103], v[112:115], v[20:23]
    v_mfma_f32_16x16x32_bf16 v[24:27], v[176:179], v[112:115], v[24:27]
    v_mfma_f32_16x16x32_bf16 v[28:31], v[180:183], v[112:115], v[28:31]
    s_waitcnt vmcnt(16)
    s_waitcnt lgkmcnt(0)
    v_mfma_f32_16x16x32_bf16 v[16:19], a[104:107], v[116:119], v[16:19]
    s_add_u32 s30, s30, 4096
    buffer_load_dwordx4 v[112:115], v10, s[4:7], s30 offen offset:0
    ds_read_b64_tr_b16 v[40:41], v8 offset:14336
    ds_read_b64_tr_b16 v[42:43], v8 offset:14592
    v_mfma_f32_16x16x32_bf16 v[20:23], a[108:111], v[116:119], v[20:23]
    ds_read_b64_tr_b16 v[44:45], v8 offset:14368
    ds_read_b64_tr_b16 v[46:47], v8 offset:14624
    v_mfma_f32_16x16x32_bf16 v[24:27], v[32:35], v[116:119], v[24:27]
    v_mfma_f32_16x16x32_bf16 v[28:31], v[36:39], v[116:119], v[28:31]
    s_waitcnt vmcnt(16)
    v_mfma_f32_16x16x32_bf16 v[16:19], a[112:115], v[120:123], v[16:19]
    buffer_load_dwordx4 v[116:119], v10, s[4:7], s30 offen offset:1024
    v_mfma_f32_16x16x32_bf16 v[20:23], a[116:119], v[120:123], v[20:23]
    v_mfma_f32_16x16x32_bf16 v[24:27], v[184:187], v[120:123], v[24:27]
    v_mfma_f32_16x16x32_bf16 v[28:31], v[188:191], v[120:123], v[28:31]
    s_waitcnt vmcnt(16)
    s_waitcnt lgkmcnt(0)
    v_mfma_f32_16x16x32_bf16 v[16:19], a[120:123], v[124:127], v[16:19]
    buffer_load_dwordx4 v[120:123], v10, s[4:7], s30 offen offset:2048
    ds_read_b64_tr_b16 v[32:33], v8 offset:16384
    ds_read_b64_tr_b16 v[34:35], v8 offset:16640
    v_mfma_f32_16x16x32_bf16 v[20:23], a[124:127], v[124:127], v[20:23]
    ds_read_b64_tr_b16 v[36:37], v8 offset:16416
    ds_read_b64_tr_b16 v[38:39], v8 offset:16672
    v_mfma_f32_16x16x32_bf16 v[24:27], v[40:43], v[124:127], v[24:27]
    v_mfma_f32_16x16x32_bf16 v[28:31], v[44:47], v[124:127], v[28:31]
    s_waitcnt vmcnt(15)
    v_mfma_f32_16x16x32_bf16 v[16:19], a[128:131], v[64:67], v[16:19]
    buffer_load_dwordx4 v[124:127], v10, s[4:7], s30 offen offset:3072
    v_mfma_f32_16x16x32_bf16 v[20:23], a[132:135], v[64:67], v[20:23]
    s_lshr_b32 s17, s33, 3
    v_cmp_ge_u32 vcc, s17, v12
    s_lshl_b32 s18, s33, 2
    s_and_b32 s18, s18, 24
    v_mfma_f32_16x16x32_bf16 v[24:27], v[192:195], v[64:67], v[24:27]
    s_lshl_b32 s30, s33, 17
    s_add_u32 s30, s30, 54525952
    s_lshr_b32 s17, vcc_lo, s18
    s_and_b32 s17, s17, 0xff
    s_cselect_b32 s34, 0, 1
    s_cselect_b32 s30, 1073741824, s30
    v_mfma_f32_16x16x32_bf16 v[28:31], v[196:199], v[64:67], v[28:31]
    s_waitcnt vmcnt(15)
    s_waitcnt lgkmcnt(0)
    v_mfma_f32_16x16x32_bf16 v[16:19], a[136:139], v[68:71], v[16:19]
    buffer_load_dwordx4 v[64:67], v10, s[4:7], s30 offen offset:0
    ds_read_b64_tr_b16 v[40:41], v8 offset:18432
    ds_read_b64_tr_b16 v[42:43], v8 offset:18688
    v_mfma_f32_16x16x32_bf16 v[20:23], a[140:143], v[68:71], v[20:23]
    ds_read_b64_tr_b16 v[44:45], v8 offset:18464
    ds_read_b64_tr_b16 v[46:47], v8 offset:18720
    v_mfma_f32_16x16x32_bf16 v[24:27], v[32:35], v[68:71], v[24:27]
    v_mfma_f32_16x16x32_bf16 v[28:31], v[36:39], v[68:71], v[28:31]
    s_waitcnt vmcnt(15)
    v_mfma_f32_16x16x32_bf16 v[16:19], a[144:147], v[72:75], v[16:19]
    buffer_load_dwordx4 v[68:71], v10, s[4:7], s30 offen offset:1024
    v_mfma_f32_16x16x32_bf16 v[20:23], a[148:151], v[72:75], v[20:23]
    v_mfma_f32_16x16x32_bf16 v[24:27], v[200:203], v[72:75], v[24:27]
    v_mfma_f32_16x16x32_bf16 v[28:31], v[204:207], v[72:75], v[28:31]
    s_waitcnt vmcnt(15)
    s_waitcnt lgkmcnt(0)
    v_mfma_f32_16x16x32_bf16 v[16:19], a[152:155], v[76:79], v[16:19]
    buffer_load_dwordx4 v[72:75], v10, s[4:7], s30 offen offset:2048
    ds_read_b64_tr_b16 v[32:33], v8 offset:20480
    ds_read_b64_tr_b16 v[34:35], v8 offset:20736
    v_mfma_f32_16x16x32_bf16 v[20:23], a[156:159], v[76:79], v[20:23]
    ds_read_b64_tr_b16 v[36:37], v8 offset:20512
    ds_read_b64_tr_b16 v[38:39], v8 offset:20768
    v_mfma_f32_16x16x32_bf16 v[24:27], v[40:43], v[76:79], v[24:27]
    v_mfma_f32_16x16x32_bf16 v[28:31], v[44:47], v[76:79], v[28:31]
    s_waitcnt vmcnt(15)
    v_mfma_f32_16x16x32_bf16 v[16:19], a[160:163], v[80:83], v[16:19]
    buffer_load_dwordx4 v[76:79], v10, s[4:7], s30 offen offset:3072
    v_mfma_f32_16x16x32_bf16 v[20:23], a[164:167], v[80:83], v[20:23]
    v_mfma_f32_16x16x32_bf16 v[24:27], v[208:211], v[80:83], v[24:27]
    v_mfma_f32_16x16x32_bf16 v[28:31], v[212:215], v[80:83], v[28:31]
    s_waitcnt vmcnt(15)
    s_waitcnt lgkmcnt(0)
    v_mfma_f32_16x16x32_bf16 v[16:19], a[168:171], v[84:87], v[16:19]
    s_add_u32 s30, s30, 4096
    buffer_load_dwordx4 v[80:83], v10, s[4:7], s30 offen offset:0
    ds_read_b64_tr_b16 v[40:41], v8 offset:22528
    ds_read_b64_tr_b16 v[42:43], v8 offset:22784
    v_mfma_f32_16x16x32_bf16 v[20:23], a[172:175], v[84:87], v[20:23]
    ds_read_b64_tr_b16 v[44:45], v8 offset:22560
    ds_read_b64_tr_b16 v[46:47], v8 offset:22816
    v_mfma_f32_16x16x32_bf16 v[24:27], v[32:35], v[84:87], v[24:27]
    v_mfma_f32_16x16x32_bf16 v[28:31], v[36:39], v[84:87], v[28:31]
    s_waitcnt vmcnt(15)
    v_mfma_f32_16x16x32_bf16 v[16:19], a[176:179], v[88:91], v[16:19]
    buffer_load_dwordx4 v[84:87], v10, s[4:7], s30 offen offset:1024
    v_mfma_f32_16x16x32_bf16 v[20:23], a[180:183], v[88:91], v[20:23]
    v_mfma_f32_16x16x32_bf16 v[24:27], v[216:219], v[88:91], v[24:27]
    v_mfma_f32_16x16x32_bf16 v[28:31], v[220:223], v[88:91], v[28:31]
    s_waitcnt vmcnt(15)
    s_waitcnt lgkmcnt(0)
    v_mfma_f32_16x16x32_bf16 v[16:19], a[184:187], v[92:95], v[16:19]
    buffer_load_dwordx4 v[88:91], v10, s[4:7], s30 offen offset:2048
    ds_read_b64_tr_b16 v[32:33], v8 offset:24576
    ds_read_b64_tr_b16 v[34:35], v8 offset:24832
    v_mfma_f32_16x16x32_bf16 v[20:23], a[188:191], v[92:95], v[20:23]
    ds_read_b64_tr_b16 v[36:37], v8 offset:24608
    ds_read_b64_tr_b16 v[38:39], v8 offset:24864
    v_mfma_f32_16x16x32_bf16 v[24:27], v[40:43], v[92:95], v[24:27]
    v_mfma_f32_16x16x32_bf16 v[28:31], v[44:47], v[92:95], v[28:31]
    s_waitcnt vmcnt(14)
    v_mfma_f32_16x16x32_bf16 v[16:19], a[192:195], v[96:99], v[16:19]
    buffer_load_dwordx4 v[92:95], v10, s[4:7], s30 offen offset:3072
    v_mfma_f32_16x16x32_bf16 v[20:23], a[196:199], v[96:99], v[20:23]
    v_mfma_f32_16x16x32_bf16 v[24:27], v[224:227], v[96:99], v[24:27]
    v_mfma_f32_16x16x32_bf16 v[28:31], v[228:231], v[96:99], v[28:31]
    s_waitcnt vmcnt(14)
    s_waitcnt lgkmcnt(0)
    v_mfma_f32_16x16x32_bf16 v[16:19], a[200:203], v[100:103], v[16:19]
    s_add_u32 s30, s30, 4096
    buffer_load_dwordx4 v[96:99], v10, s[4:7], s30 offen offset:0
    ds_read_b64_tr_b16 v[40:41], v8 offset:26624
    ds_read_b64_tr_b16 v[42:43], v8 offset:26880
    v_mfma_f32_16x16x32_bf16 v[20:23], a[204:207], v[100:103], v[20:23]
    ds_read_b64_tr_b16 v[44:45], v8 offset:26656
    ds_read_b64_tr_b16 v[46:47], v8 offset:26912
    v_mfma_f32_16x16x32_bf16 v[24:27], v[32:35], v[100:103], v[24:27]
    v_mfma_f32_16x16x32_bf16 v[28:31], v[36:39], v[100:103], v[28:31]
    s_waitcnt vmcnt(14)
    v_mfma_f32_16x16x32_bf16 v[16:19], a[208:211], v[104:107], v[16:19]
    buffer_load_dwordx4 v[100:103], v10, s[4:7], s30 offen offset:1024
    v_mfma_f32_16x16x32_bf16 v[20:23], a[212:215], v[104:107], v[20:23]
    v_mfma_f32_16x16x32_bf16 v[24:27], v[232:235], v[104:107], v[24:27]
    v_mfma_f32_16x16x32_bf16 v[28:31], v[236:239], v[104:107], v[28:31]
    s_waitcnt vmcnt(14)
    s_waitcnt lgkmcnt(0)
    v_mfma_f32_16x16x32_bf16 v[16:19], a[216:219], v[108:111], v[16:19]
    buffer_load_dwordx4 v[104:107], v10, s[4:7], s30 offen offset:2048
    ds_read_b64_tr_b16 v[32:33], v8 offset:28672
    ds_read_b64_tr_b16 v[34:35], v8 offset:28928
    v_mfma_f32_16x16x32_bf16 v[20:23], a[220:223], v[108:111], v[20:23]
    ds_read_b64_tr_b16 v[36:37], v8 offset:28704
    ds_read_b64_tr_b16 v[38:39], v8 offset:28960
    v_mfma_f32_16x16x32_bf16 v[24:27], v[40:43], v[108:111], v[24:27]
    v_mfma_f32_16x16x32_bf16 v[28:31], v[44:47], v[108:111], v[28:31]
    s_waitcnt vmcnt(14)
    v_mfma_f32_16x16x32_bf16 v[16:19], a[224:227], v[112:115], v[16:19]
    buffer_load_dwordx4 v[108:111], v10, s[4:7], s30 offen offset:3072
    v_mfma_f32_16x16x32_bf16 v[20:23], a[228:231], v[112:115], v[20:23]
    v_mfma_f32_16x16x32_bf16 v[24:27], v[240:243], v[112:115], v[24:27]
    v_mfma_f32_16x16x32_bf16 v[28:31], v[244:247], v[112:115], v[28:31]
    s_waitcnt vmcnt(14)
    s_waitcnt lgkmcnt(0)
    v_mfma_f32_16x16x32_bf16 v[16:19], a[232:235], v[116:119], v[16:19]
    s_add_u32 s30, s30, 4096
    buffer_load_dwordx4 v[112:115], v10, s[4:7], s30 offen offset:0
    ds_read_b64_tr_b16 v[40:41], v8 offset:30720
    ds_read_b64_tr_b16 v[42:43], v8 offset:30976
    v_mfma_f32_16x16x32_bf16 v[20:23], a[236:239], v[116:119], v[20:23]
    ds_read_b64_tr_b16 v[44:45], v8 offset:30752
    ds_read_b64_tr_b16 v[46:47], v8 offset:31008
    v_mfma_f32_16x16x32_bf16 v[24:27], v[32:35], v[116:119], v[24:27]
    v_mfma_f32_16x16x32_bf16 v[28:31], v[36:39], v[116:119], v[28:31]
    s_waitcnt vmcnt(14)
    v_mfma_f32_16x16x32_bf16 v[16:19], a[240:243], v[120:123], v[16:19]
    buffer_load_dwordx4 v[116:119], v10, s[4:7], s30 offen offset:1024
    v_mfma_f32_16x16x32_bf16 v[20:23], a[244:247], v[120:123], v[20:23]
    v_mfma_f32_16x16x32_bf16 v[24:27], v[248:251], v[120:123], v[24:27]
    v_mfma_f32_16x16x32_bf16 v[28:31], v[252:255], v[120:123], v[28:31]
    s_waitcnt vmcnt(14)
    s_waitcnt lgkmcnt(0)
    v_mfma_f32_16x16x32_bf16 v[16:19], a[248:251], v[124:127], v[16:19]
    buffer_load_dwordx4 v[120:123], v10, s[4:7], s30 offen offset:2048
    ds_read_b64_tr_b16 v[32:33], v8 offset:0
    ds_read_b64_tr_b16 v[34:35], v8 offset:256
    v_mfma_f32_16x16x32_bf16 v[20:23], a[252:255], v[124:127], v[20:23]
    ds_read_b64_tr_b16 v[36:37], v8 offset:32
    ds_read_b64_tr_b16 v[38:39], v8 offset:288
    v_mfma_f32_16x16x32_bf16 v[24:27], v[40:43], v[124:127], v[24:27]
    v_mfma_f32_16x16x32_bf16 v[28:31], v[44:47], v[124:127], v[28:31]
    s_lshl_b32 s31, s28, 16
    s_mov_b32 s28, s33
    s_cmp_eq_u32 s34, 1
    ds_write_b128 v14, v[16:19] offset:0
    ds_write_b128 v14, v[20:23] offset:4096
    ds_write_b128 v14, v[24:27] offset:8192
    s_nop 1
    ds_write_b128 v14, v[28:31] offset:12288
    v_xor_b32 v14, 0x4000, v14
    s_cbranch_scc1 U_item
    s_waitcnt lgkmcnt(0)
    s_barrier
    ds_read_b128 v[48:51], v15 offset:0
    ds_read_b128 v[52:55], v15 offset:1024
    ds_read_b128 v[56:59], v15 offset:2048
    ds_read_b128 v[60:63], v15 offset:3072
    s_waitcnt lgkmcnt(0)
    v_add_f32 v48, v48, v52
    v_add_f32 v49, v49, v53
    v_add_f32 v50, v50, v54
    v_add_f32 v51, v51, v55
    v_add_f32 v56, v56, v60
    v_add_f32 v57, v57, v61
    v_add_f32 v58, v58, v62
    v_add_f32 v59, v59, v63
    v_add_f32 v48, v48, v56
    v_add_f32 v49, v49, v57
    v_add_f32 v50, v50, v58
    v_add_f32 v51, v51, v59
    v_cvt_pk_bf16_f32 v52, v48, v49
    v_cvt_pk_bf16_f32 v53, v50, v51
    buffer_store_dwordx2 v[52:53], v13, s[12:15], s31 offen
    s_cmp_lt_u32 s28, 128
    s_cbranch_scc1 U_wait
    s_branch W_fin
W_F:
    s_waitcnt vmcnt(0)
    s_barrier
    s_cmp_lg_u32 s16, 0
    s_cbranch_scc1 reg_16
    s_and_b32 s17, s2, 3
    s_lshl_b32 s17, s17, 3
    s_lshl_b32 s18, s98, 2
    s_add_u32 s17, s17, s18
    s_lshl_b32 s17, 1, s17
    s_andn2_b32 s18, s2, 3
    v_mov_b32 v5, s18
    v_mov_b32 v6, s17
    s_mov_b64 exec, 1
    global_atomic_add v5, v6, s[100:101] sc1
    s_mov_b64 exec, -1
reg_16:
    s_load_dwordx2 s[40:41], s[0:1], 0
    s_load_dwordx2 s[44:45], s[0:1], 24
    s_mov_b32 s42, 4194304
    s_mov_b32 s43, 0x20000
    s_mov_b32 s46, 4194304
    s_mov_b32 s47, 0x20000
    s_lshr_b32 s28, s93, 3
    s_and_b32 s29, s93, 7
    s_lshl_b32 s29, s29, 2
    s_add_u32 s29, s29, s16
    v_bfe_u32 v5, v1, 2, 2
    v_and_b32 v7, 3, v1
    v_lshl_add_u32 v7, v5, 3, v7
    s_lshl_b32 s17, s29, 5
    v_add_u32 v7, s17, v7
    v_lshrrev_b32 v8, 4, v1
    v_cvt_f32_u32 v8, v8
    s_mov_b32 s31, 981467136
    v_add_u32 v5, 0, v7
    v_lshrrev_b32 v6, 1, v5
    v_and_b32 v30, 1, v5
    v_cmp_eq_u32 vcc, 1, v5
    v_mov_b32 v5, 512
    s_nop 0
    v_cndmask_b32 v6, v6, v5, vcc
    v_cndmask_b32 v30, v30, 0, vcc
    v_add_u32 v5, v6, v30
    v_bfe_i32 v40, v5, 1, 1
    v_add_u32 v5, v6, v5
    v_bfe_i32 v42, v5, 1, 1
    v_add_u32 v5, v6, v5
    v_bfe_i32 v44, v5, 1, 1
    v_and_b32 v40, 0x80008000, v40
    v_and_b32 v42, 0x80008000, v42
    v_and_b32 v44, 0x80008000, v44
    v_cvt_f32_u32 v6, v6
    v_cvt_f32_u32 v30, v30
    v_mul_f32 v32, s31, v6
    v_mul_f32 v30, 0x3e800000, v30
    v_mov_b32 v34, v32
    v_mul_f32 v36, 0x42000000, v32
    v_mul_f32 v5, 0x41000000, v32
    v_fma_f32 v30, v5, v8, v30
    v_add_u32 v5, 4, v7
    v_lshrrev_b32 v6, 1, v5
    v_and_b32 v31, 1, v5
    v_cmp_eq_u32 vcc, 1, v5
    v_mov_b32 v5, 512
    s_nop 0
    v_cndmask_b32 v6, v6, v5, vcc
    v_cndmask_b32 v31, v31, 0, vcc
    v_add_u32 v5, v6, v31
    v_bfe_i32 v41, v5, 1, 1
    v_add_u32 v5, v6, v5
    v_bfe_i32 v43, v5, 1, 1
    v_add_u32 v5, v6, v5
    v_bfe_i32 v45, v5, 1, 1
    v_and_b32 v41, 0x80008000, v41
    v_and_b32 v43, 0x80008000, v43
    v_and_b32 v45, 0x80008000, v45
    v_cvt_f32_u32 v6, v6
    v_cvt_f32_u32 v31, v31
    v_mul_f32 v33, s31, v6
    v_mul_f32 v31, 0x3e800000, v31
    v_mov_b32 v35, v33
    v_mul_f32 v37, 0x42000000, v33
    v_mul_f32 v5, 0x41000000, v33
    v_fma_f32 v31, v5, v8, v31
    v_fract_f32 v48, v30
    v_add_f32 v49, v48, v32
    v_cos_f32 v56, v48
    v_add_f32 v50, v49, v34
    v_cos_f32 v57, v49
    v_add_f32 v51, v50, v32
    v_cos_f32 v58, v50
    v_add_f32 v52, v51, v34
    v_cos_f32 v59, v51
    v_add_f32 v53, v52, v32
    v_cos_f32 v60, v52
    v_add_f32 v54, v53, v34
    v_cos_f32 v61, v53
    v_add_f32 v55, v54, v32
    v_cos_f32 v62, v54
    v_cos_f32 v63, v55
    v_add_f32 v30, v48, v36
    v_cvt_pk_bf16_f32 v64, v56, v57
    v_cvt_pk_bf16_f32 v65, v58, v59
    v_cvt_pk_bf16_f32 v66, v60, v61
    v_cvt_pk_bf16_f32 v67, v62, v63
    v_accvgpr_write_b32 a0, v64
    v_accvgpr_write_b32 a1, v65
    v_accvgpr_write_b32 a2, v66
    v_accvgpr_write_b32 a3, v67
    v_xor_b32_dpp v68, v64, v40 quad_perm:[0,1,3,2] row_mask:0xf bank_mask:0xf
    v_xor_b32_dpp v69, v65, v40 quad_perm:[0,1,3,2] row_mask:0xf bank_mask:0xf
    v_xor_b32_dpp v70, v66, v40 quad_perm:[0,1,3,2] row_mask:0xf bank_mask:0xf
    v_xor_b32_dpp v71, v67, v40 quad_perm:[0,1,3,2] row_mask:0xf bank_mask:0xf
    v_accvgpr_write_b32 a64, v68
    v_accvgpr_write_b32 a65, v69
    v_accvgpr_write_b32 a66, v70
    v_accvgpr_write_b32 a67, v71
    v_xor_b32 v68, v64, v42
    v_xor_b32 v69, v65, v42
    v_xor_b32 v70, v66, v42
    v_xor_b32 v71, v67, v42
    v_accvgpr_write_b32 a128, v68
    v_accvgpr_write_b32 a129, v69
    v_accvgpr_write_b32 a130, v70
    v_accvgpr_write_b32 a131, v71
    v_xor_b32_dpp v68, v64, v44 quad_perm:[0,1,3,2] row_mask:0xf bank_mask:0xf
    v_xor_b32_dpp v69, v65, v44 quad_perm:[0,1,3,2] row_mask:0xf bank_mask:0xf
    v_xor_b32_dpp v70, v66, v44 quad_perm:[0,1,3,2] row_mask:0xf bank_mask:0xf
    v_xor_b32_dpp v71, v67, v44 quad_perm:[0,1,3,2] row_mask:0xf bank_mask:0xf
    v_accvgpr_write_b32 a192, v68
    v_accvgpr_write_b32 a193, v69
    v_accvgpr_write_b32 a194, v70
    v_accvgpr_write_b32 a195, v71
    v_fract_f32 v48, v31
    v_add_f32 v49, v48, v33
    v_cos_f32 v56, v48
    v_add_f32 v50, v49, v35
    v_cos_f32 v57, v49
    v_add_f32 v51, v50, v33
    v_cos_f32 v58, v50
    v_add_f32 v52, v51, v35
    v_cos_f32 v59, v51
    v_add_f32 v53, v52, v33
    v_cos_f32 v60, v52
    v_add_f32 v54, v53, v35
    v_cos_f32 v61, v53
    v_add_f32 v55, v54, v33
    v_cos_f32 v62, v54
    v_cos_f32 v63, v55
    v_add_f32 v31, v48, v37
    v_cvt_pk_bf16_f32 v64, v56, v57
    v_cvt_pk_bf16_f32 v65, v58, v59
    v_cvt_pk_bf16_f32 v66, v60, v61
    v_cvt_pk_bf16_f32 v67, v62, v63
    v_accvgpr_write_b32 a4, v64
    v_accvgpr_write_b32 a5, v65
    v_accvgpr_write_b32 a6, v66
    v_accvgpr_write_b32 a7, v67
    v_xor_b32_dpp v68, v64, v41 quad_perm:[0,1,3,2] row_mask:0xf bank_mask:0xf
    v_xor_b32_dpp v69, v65, v41 quad_perm:[0,1,3,2] row_mask:0xf bank_mask:0xf
    v_xor_b32_dpp v70, v66, v41 quad_perm:[0,1,3,2] row_mask:0xf bank_mask:0xf
    v_xor_b32_dpp v71, v67, v41 quad_perm:[0,1,3,2] row_mask:0xf bank_mask:0xf
    v_accvgpr_write_b32 a68, v68
    v_accvgpr_write_b32 a69, v69
    v_accvgpr_write_b32 a70, v70
    v_accvgpr_write_b32 a71, v71
    v_xor_b32 v68, v64, v43
    v_xor_b32 v69, v65, v43
    v_xor_b32 v70, v66, v43
    v_xor_b32 v71, v67, v43
    v_accvgpr_write_b32 a132, v68
    v_accvgpr_write_b32 a133, v69
    v_accvgpr_write_b32 a134, v70
    v_accvgpr_write_b32 a135, v71
    v_xor_b32_dpp v68, v64, v45 quad_perm:[0,1,3,2] row_mask:0xf bank_mask:0xf
    v_xor_b32_dpp v69, v65, v45 quad_perm:[0,1,3,2] row_mask:0xf bank_mask:0xf
    v_xor_b32_dpp v70, v66, v45 quad_perm:[0,1,3,2] row_mask:0xf bank_mask:0xf
    v_xor_b32_dpp v71, v67, v45 quad_perm:[0,1,3,2] row_mask:0xf bank_mask:0xf
    v_accvgpr_write_b32 a196, v68
    v_accvgpr_write_b32 a197, v69
    v_accvgpr_write_b32 a198, v70
    v_accvgpr_write_b32 a199, v71
    v_fract_f32 v48, v30
    v_add_f32 v49, v48, v32
    v_cos_f32 v56, v48
    v_add_f32 v50, v49, v34
    v_cos_f32 v57, v49
    v_add_f32 v51, v50, v32
    v_cos_f32 v58, v50
    v_add_f32 v52, v51, v34
    v_cos_f32 v59, v51
    v_add_f32 v53, v52, v32
    v_cos_f32 v60, v52
    v_add_f32 v54, v53, v34
    v_cos_f32 v61, v53
    v_add_f32 v55, v54, v32
    v_cos_f32 v62, v54
    v_cos_f32 v63, v55
    v_add_f32 v30, v48, v36
    v_cvt_pk_bf16_f32 v64, v56, v57
    v_cvt_pk_bf16_f32 v65, v58, v59
    v_cvt_pk_bf16_f32 v66, v60, v61
    v_cvt_pk_bf16_f32 v67, v62, v63
    v_accvgpr_write_b32 a8, v64
    v_accvgpr_write_b32 a9, v65
    v_accvgpr_write_b32 a10, v66
    v_accvgpr_write_b32 a11, v67
    v_xor_b32_dpp v68, v64, v40 quad_perm:[0,1,3,2] row_mask:0xf bank_mask:0xf
    v_xor_b32_dpp v69, v65, v40 quad_perm:[0,1,3,2] row_mask:0xf bank_mask:0xf
    v_xor_b32_dpp v70, v66, v40 quad_perm:[0,1,3,2] row_mask:0xf bank_mask:0xf
    v_xor_b32_dpp v71, v67, v40 quad_perm:[0,1,3,2] row_mask:0xf bank_mask:0xf
    v_accvgpr_write_b32 a72, v68
    v_accvgpr_write_b32 a73, v69
    v_accvgpr_write_b32 a74, v70
    v_accvgpr_write_b32 a75, v71
    v_xor_b32 v68, v64, v42
    v_xor_b32 v69, v65, v42
    v_xor_b32 v70, v66, v42
    v_xor_b32 v71, v67, v42
    v_accvgpr_write_b32 a136, v68
    v_accvgpr_write_b32 a137, v69
    v_accvgpr_write_b32 a138, v70
    v_accvgpr_write_b32 a139, v71
    v_xor_b32_dpp v68, v64, v44 quad_perm:[0,1,3,2] row_mask:0xf bank_mask:0xf
    v_xor_b32_dpp v69, v65, v44 quad_perm:[0,1,3,2] row_mask:0xf bank_mask:0xf
    v_xor_b32_dpp v70, v66, v44 quad_perm:[0,1,3,2] row_mask:0xf bank_mask:0xf
    v_xor_b32_dpp v71, v67, v44 quad_perm:[0,1,3,2] row_mask:0xf bank_mask:0xf
    v_accvgpr_write_b32 a200, v68
    v_accvgpr_write_b32 a201, v69
    v_accvgpr_write_b32 a202, v70
    v_accvgpr_write_b32 a203, v71
    v_fract_f32 v48, v31
    v_add_f32 v49, v48, v33
    v_cos_f32 v56, v48
    v_add_f32 v50, v49, v35
    v_cos_f32 v57, v49
    v_add_f32 v51, v50, v33
    v_cos_f32 v58, v50
    v_add_f32 v52, v51, v35
    v_cos_f32 v59, v51
    v_add_f32 v53, v52, v33
    v_cos_f32 v60, v52
    v_add_f32 v54, v53, v35
    v_cos_f32 v61, v53
    v_add_f32 v55, v54, v33
    v_cos_f32 v62, v54
    v_cos_f32 v63, v55
    v_add_f32 v31, v48, v37
    v_cvt_pk_bf16_f32 v64, v56, v57
    v_cvt_pk_bf16_f32 v65, v58, v59
    v_cvt_pk_bf16_f32 v66, v60, v61
    v_cvt_pk_bf16_f32 v67, v62, v63
    v_accvgpr_write_b32 a12, v64
    v_accvgpr_write_b32 a13, v65
    v_accvgpr_write_b32 a14, v66
    v_accvgpr_write_b32 a15, v67
    v_xor_b32_dpp v68, v64, v41 quad_perm:[0,1,3,2] row_mask:0xf bank_mask:0xf
    v_xor_b32_dpp v69, v65, v41 quad_perm:[0,1,3,2] row_mask:0xf bank_mask:0xf
    v_xor_b32_dpp v70, v66, v41 quad_perm:[0,1,3,2] row_mask:0xf bank_mask:0xf
    v_xor_b32_dpp v71, v67, v41 quad_perm:[0,1,3,2] row_mask:0xf bank_mask:0xf
    v_accvgpr_write_b32 a76, v68
    v_accvgpr_write_b32 a77, v69
    v_accvgpr_write_b32 a78, v70
    v_accvgpr_write_b32 a79, v71
    v_xor_b32 v68, v64, v43
    v_xor_b32 v69, v65, v43
    v_xor_b32 v70, v66, v43
    v_xor_b32 v71, v67, v43
    v_accvgpr_write_b32 a140, v68
    v_accvgpr_write_b32 a141, v69
    v_accvgpr_write_b32 a142, v70
    v_accvgpr_write_b32 a143, v71
    v_xor_b32_dpp v68, v64, v45 quad_perm:[0,1,3,2] row_mask:0xf bank_mask:0xf
    v_xor_b32_dpp v69, v65, v45 quad_perm:[0,1,3,2] row_mask:0xf bank_mask:0xf
    v_xor_b32_dpp v70, v66, v45 quad_perm:[0,1,3,2] row_mask:0xf bank_mask:0xf
    v_xor_b32_dpp v71, v67, v45 quad_perm:[0,1,3,2] row_mask:0xf bank_mask:0xf
    v_accvgpr_write_b32 a204, v68
    v_accvgpr_write_b32 a205, v69
    v_accvgpr_write_b32 a206, v70
    v_accvgpr_write_b32 a207, v71
    v_fract_f32 v48, v30
    v_add_f32 v49, v48, v32
    v_cos_f32 v56, v48
    v_add_f32 v50, v49, v34
    v_cos_f32 v57, v49
    v_add_f32 v51, v50, v32
    v_cos_f32 v58, v50
    v_add_f32 v52, v51, v34
    v_cos_f32 v59, v51
    v_add_f32 v53, v52, v32
    v_cos_f32 v60, v52
    v_add_f32 v54, v53, v34
    v_cos_f32 v61, v53
    v_add_f32 v55, v54, v32
    v_cos_f32 v62, v54
    v_cos_f32 v63, v55
    v_add_f32 v30, v48, v36
    v_cvt_pk_bf16_f32 v64, v56, v57
    v_cvt_pk_bf16_f32 v65, v58, v59
    v_cvt_pk_bf16_f32 v66, v60, v61
    v_cvt_pk_bf16_f32 v67, v62, v63
    v_accvgpr_write_b32 a16, v64
    v_accvgpr_write_b32 a17, v65
    v_accvgpr_write_b32 a18, v66
    v_accvgpr_write_b32 a19, v67
    v_xor_b32_dpp v68, v64, v40 quad_perm:[0,1,3,2] row_mask:0xf bank_mask:0xf
    v_xor_b32_dpp v69, v65, v40 quad_perm:[0,1,3,2] row_mask:0xf bank_mask:0xf
    v_xor_b32_dpp v70, v66, v40 quad_perm:[0,1,3,2] row_mask:0xf bank_mask:0xf
    v_xor_b32_dpp v71, v67, v40 quad_perm:[0,1,3,2] row_mask:0xf bank_mask:0xf
    v_accvgpr_write_b32 a80, v68
    v_accvgpr_write_b32 a81, v69
    v_accvgpr_write_b32 a82, v70
    v_accvgpr_write_b32 a83, v71
    v_xor_b32 v68, v64, v42
    v_xor_b32 v69, v65, v42
    v_xor_b32 v70, v66, v42
    v_xor_b32 v71, v67, v42
    v_accvgpr_write_b32 a144, v68
    v_accvgpr_write_b32 a145, v69
    v_accvgpr_write_b32 a146, v70
    v_accvgpr_write_b32 a147, v71
    v_xor_b32_dpp v68, v64, v44 quad_perm:[0,1,3,2] row_mask:0xf bank_mask:0xf
    v_xor_b32_dpp v69, v65, v44 quad_perm:[0,1,3,2] row_mask:0xf bank_mask:0xf
    v_xor_b32_dpp v70, v66, v44 quad_perm:[0,1,3,2] row_mask:0xf bank_mask:0xf
    v_xor_b32_dpp v71, v67, v44 quad_perm:[0,1,3,2] row_mask:0xf bank_mask:0xf
    v_accvgpr_write_b32 a208, v68
    v_accvgpr_write_b32 a209, v69
    v_accvgpr_write_b32 a210, v70
    v_accvgpr_write_b32 a211, v71
    v_fract_f32 v48, v31
    v_add_f32 v49, v48, v33
    v_cos_f32 v56, v48
    v_add_f32 v50, v49, v35
    v_cos_f32 v57, v49
    v_add_f32 v51, v50, v33
    v_cos_f32 v58, v50
    v_add_f32 v52, v51, v35
    v_cos_f32 v59, v51
    v_add_f32 v53, v52, v33
    v_cos_f32 v60, v52
    v_add_f32 v54, v53, v35
    v_cos_f32 v61, v53
    v_add_f32 v55, v54, v33
    v_cos_f32 v62, v54
    v_cos_f32 v63, v55
    v_add_f32 v31, v48, v37
    v_cvt_pk_bf16_f32 v64, v56, v57
    v_cvt_pk_bf16_f32 v65, v58, v59
    v_cvt_pk_bf16_f32 v66, v60, v61
    v_cvt_pk_bf16_f32 v67, v62, v63
    v_accvgpr_write_b32 a20, v64
    v_accvgpr_write_b32 a21, v65
    v_accvgpr_write_b32 a22, v66
    v_accvgpr_write_b32 a23, v67
    v_xor_b32_dpp v68, v64, v41 quad_perm:[0,1,3,2] row_mask:0xf bank_mask:0xf
    v_xor_b32_dpp v69, v65, v41 quad_perm:[0,1,3,2] row_mask:0xf bank_mask:0xf
    v_xor_b32_dpp v70, v66, v41 quad_perm:[0,1,3,2] row_mask:0xf bank_mask:0xf
    v_xor_b32_dpp v71, v67, v41 quad_perm:[0,1,3,2] row_mask:0xf bank_mask:0xf
    v_accvgpr_write_b32 a84, v68
    v_accvgpr_write_b32 a85, v69
    v_accvgpr_write_b32 a86, v70
    v_accvgpr_write_b32 a87, v71
    v_xor_b32 v68, v64, v43
    v_xor_b32 v69, v65, v43
    v_xor_b32 v70, v66, v43
    v_xor_b32 v71, v67, v43
    v_accvgpr_write_b32 a148, v68
    v_accvgpr_write_b32 a149, v69
    v_accvgpr_write_b32 a150, v70
    v_accvgpr_write_b32 a151, v71
    v_xor_b32_dpp v68, v64, v45 quad_perm:[0,1,3,2] row_mask:0xf bank_mask:0xf
    v_xor_b32_dpp v69, v65, v45 quad_perm:[0,1,3,2] row_mask:0xf bank_mask:0xf
    v_xor_b32_dpp v70, v66, v45 quad_perm:[0,1,3,2] row_mask:0xf bank_mask:0xf
    v_xor_b32_dpp v71, v67, v45 quad_perm:[0,1,3,2] row_mask:0xf bank_mask:0xf
    v_accvgpr_write_b32 a212, v68
    v_accvgpr_write_b32 a213, v69
    v_accvgpr_write_b32 a214, v70
    v_accvgpr_write_b32 a215, v71
    v_fract_f32 v48, v30
    v_add_f32 v49, v48, v32
    v_cos_f32 v56, v48
    v_add_f32 v50, v49, v34
    v_cos_f32 v57, v49
    v_add_f32 v51, v50, v32
    v_cos_f32 v58, v50
    v_add_f32 v52, v51, v34
    v_cos_f32 v59, v51
    v_add_f32 v53, v52, v32
    v_cos_f32 v60, v52
    v_add_f32 v54, v53, v34
    v_cos_f32 v61, v53
    v_add_f32 v55, v54, v32
    v_cos_f32 v62, v54
    v_cos_f32 v63, v55
    v_add_f32 v30, v48, v36
    v_cvt_pk_bf16_f32 v64, v56, v57
    v_cvt_pk_bf16_f32 v65, v58, v59
    v_cvt_pk_bf16_f32 v66, v60, v61
    v_cvt_pk_bf16_f32 v67, v62, v63
    v_accvgpr_write_b32 a24, v64
    v_accvgpr_write_b32 a25, v65
    v_accvgpr_write_b32 a26, v66
    v_accvgpr_write_b32 a27, v67
    v_xor_b32_dpp v68, v64, v40 quad_perm:[0,1,3,2] row_mask:0xf bank_mask:0xf
    v_xor_b32_dpp v69, v65, v40 quad_perm:[0,1,3,2] row_mask:0xf bank_mask:0xf
    v_xor_b32_dpp v70, v66, v40 quad_perm:[0,1,3,2] row_mask:0xf bank_mask:0xf
    v_xor_b32_dpp v71, v67, v40 quad_perm:[0,1,3,2] row_mask:0xf bank_mask:0xf
    v_accvgpr_write_b32 a88, v68
    v_accvgpr_write_b32 a89, v69
    v_accvgpr_write_b32 a90, v70
    v_accvgpr_write_b32 a91, v71
    v_xor_b32 v68, v64, v42
    v_xor_b32 v69, v65, v42
    v_xor_b32 v70, v66, v42
    v_xor_b32 v71, v67, v42
    v_accvgpr_write_b32 a152, v68
    v_accvgpr_write_b32 a153, v69
    v_accvgpr_write_b32 a154, v70
    v_accvgpr_write_b32 a155, v71
    v_xor_b32_dpp v68, v64, v44 quad_perm:[0,1,3,2] row_mask:0xf bank_mask:0xf
    v_xor_b32_dpp v69, v65, v44 quad_perm:[0,1,3,2] row_mask:0xf bank_mask:0xf
    v_xor_b32_dpp v70, v66, v44 quad_perm:[0,1,3,2] row_mask:0xf bank_mask:0xf
    v_xor_b32_dpp v71, v67, v44 quad_perm:[0,1,3,2] row_mask:0xf bank_mask:0xf
    v_accvgpr_write_b32 a216, v68
    v_accvgpr_write_b32 a217, v69
    v_accvgpr_write_b32 a218, v70
    v_accvgpr_write_b32 a219, v71
    v_fract_f32 v48, v31
    v_add_f32 v49, v48, v33
    v_cos_f32 v56, v48
    v_add_f32 v50, v49, v35
    v_cos_f32 v57, v49
    v_add_f32 v51, v50, v33
    v_cos_f32 v58, v50
    v_add_f32 v52, v51, v35
    v_cos_f32 v59, v51
    v_add_f32 v53, v52, v33
    v_cos_f32 v60, v52
    v_add_f32 v54, v53, v35
    v_cos_f32 v61, v53
    v_add_f32 v55, v54, v33
    v_cos_f32 v62, v54
    v_cos_f32 v63, v55
    v_add_f32 v31, v48, v37
    v_cvt_pk_bf16_f32 v64, v56, v57
    v_cvt_pk_bf16_f32 v65, v58, v59
    v_cvt_pk_bf16_f32 v66, v60, v61
    v_cvt_pk_bf16_f32 v67, v62, v63
    v_accvgpr_write_b32 a28, v64
    v_accvgpr_write_b32 a29, v65
    v_accvgpr_write_b32 a30, v66
    v_accvgpr_write_b32 a31, v67
    v_xor_b32_dpp v68, v64, v41 quad_perm:[0,1,3,2] row_mask:0xf bank_mask:0xf
    v_xor_b32_dpp v69, v65, v41 quad_perm:[0,1,3,2] row_mask:0xf bank_mask:0xf
    v_xor_b32_dpp v70, v66, v41 quad_perm:[0,1,3,2] row_mask:0xf bank_mask:0xf
    v_xor_b32_dpp v71, v67, v41 quad_perm:[0,1,3,2] row_mask:0xf bank_mask:0xf
    v_accvgpr_write_b32 a92, v68
    v_accvgpr_write_b32 a93, v69
    v_accvgpr_write_b32 a94, v70
    v_accvgpr_write_b32 a95, v71
    v_xor_b32 v68, v64, v43
    v_xor_b32 v69, v65, v43
    v_xor_b32 v70, v66, v43
    v_xor_b32 v71, v67, v43
    v_accvgpr_write_b32 a156, v68
    v_accvgpr_write_b32 a157, v69
    v_accvgpr_write_b32 a158, v70
    v_accvgpr_write_b32 a159, v71
    v_xor_b32_dpp v68, v64, v45 quad_perm:[0,1,3,2] row_mask:0xf bank_mask:0xf
    v_xor_b32_dpp v69, v65, v45 quad_perm:[0,1,3,2] row_mask:0xf bank_mask:0xf
    v_xor_b32_dpp v70, v66, v45 quad_perm:[0,1,3,2] row_mask:0xf bank_mask:0xf
    v_xor_b32_dpp v71, v67, v45 quad_perm:[0,1,3,2] row_mask:0xf bank_mask:0xf
    v_accvgpr_write_b32 a220, v68
    v_accvgpr_write_b32 a221, v69
    v_accvgpr_write_b32 a222, v70
    v_accvgpr_write_b32 a223, v71
    v_fract_f32 v48, v30
    v_add_f32 v49, v48, v32
    v_cos_f32 v56, v48
    v_add_f32 v50, v49, v34
    v_cos_f32 v57, v49
    v_add_f32 v51, v50, v32
    v_cos_f32 v58, v50
    v_add_f32 v52, v51, v34
    v_cos_f32 v59, v51
    v_add_f32 v53, v52, v32
    v_cos_f32 v60, v52
    v_add_f32 v54, v53, v34
    v_cos_f32 v61, v53
    v_add_f32 v55, v54, v32
    v_cos_f32 v62, v54
    v_cos_f32 v63, v55
    v_add_f32 v30, v48, v36
    v_cvt_pk_bf16_f32 v64, v56, v57
    v_cvt_pk_bf16_f32 v65, v58, v59
    v_cvt_pk_bf16_f32 v66, v60, v61
    v_cvt_pk_bf16_f32 v67, v62, v63
    v_accvgpr_write_b32 a32, v64
    v_accvgpr_write_b32 a33, v65
    v_accvgpr_write_b32 a34, v66
    v_accvgpr_write_b32 a35, v67
    v_xor_b32_dpp v68, v64, v40 quad_perm:[0,1,3,2] row_mask:0xf bank_mask:0xf
    v_xor_b32_dpp v69, v65, v40 quad_perm:[0,1,3,2] row_mask:0xf bank_mask:0xf
    v_xor_b32_dpp v70, v66, v40 quad_perm:[0,1,3,2] row_mask:0xf bank_mask:0xf
    v_xor_b32_dpp v71, v67, v40 quad_perm:[0,1,3,2] row_mask:0xf bank_mask:0xf
    v_accvgpr_write_b32 a96, v68
    v_accvgpr_write_b32 a97, v69
    v_accvgpr_write_b32 a98, v70
    v_accvgpr_write_b32 a99, v71
    v_xor_b32 v68, v64, v42
    v_xor_b32 v69, v65, v42
    v_xor_b32 v70, v66, v42
    v_xor_b32 v71, v67, v42
    v_accvgpr_write_b32 a160, v68
    v_accvgpr_write_b32 a161, v69
    v_accvgpr_write_b32 a162, v70
    v_accvgpr_write_b32 a163, v71
    v_xor_b32_dpp v68, v64, v44 quad_perm:[0,1,3,2] row_mask:0xf bank_mask:0xf
    v_xor_b32_dpp v69, v65, v44 quad_perm:[0,1,3,2] row_mask:0xf bank_mask:0xf
    v_xor_b32_dpp v70, v66, v44 quad_perm:[0,1,3,2] row_mask:0xf bank_mask:0xf
    v_xor_b32_dpp v71, v67, v44 quad_perm:[0,1,3,2] row_mask:0xf bank_mask:0xf
    v_accvgpr_write_b32 a224, v68
    v_accvgpr_write_b32 a225, v69
    v_accvgpr_write_b32 a226, v70
    v_accvgpr_write_b32 a227, v71
    v_fract_f32 v48, v31
    v_add_f32 v49, v48, v33
    v_cos_f32 v56, v48
    v_add_f32 v50, v49, v35
    v_cos_f32 v57, v49
    v_add_f32 v51, v50, v33
    v_cos_f32 v58, v50
    v_add_f32 v52, v51, v35
    v_cos_f32 v59, v51
    v_add_f32 v53, v52, v33
    v_cos_f32 v60, v52
    v_add_f32 v54, v53, v35
    v_cos_f32 v61, v53
    v_add_f32 v55, v54, v33
    v_cos_f32 v62, v54
    v_cos_f32 v63, v55
    v_add_f32 v31, v48, v37
    v_cvt_pk_bf16_f32 v64, v56, v57
    v_cvt_pk_bf16_f32 v65, v58, v59
    v_cvt_pk_bf16_f32 v66, v60, v61
    v_cvt_pk_bf16_f32 v67, v62, v63
    v_accvgpr_write_b32 a36, v64
    v_accvgpr_write_b32 a37, v65
    v_accvgpr_write_b32 a38, v66
    v_accvgpr_write_b32 a39, v67
    v_xor_b32_dpp v68, v64, v41 quad_perm:[0,1,3,2] row_mask:0xf bank_mask:0xf
    v_xor_b32_dpp v69, v65, v41 quad_perm:[0,1,3,2] row_mask:0xf bank_mask:0xf
    v_xor_b32_dpp v70, v66, v41 quad_perm:[0,1,3,2] row_mask:0xf bank_mask:0xf
    v_xor_b32_dpp v71, v67, v41 quad_perm:[0,1,3,2] row_mask:0xf bank_mask:0xf
    v_accvgpr_write_b32 a100, v68
    v_accvgpr_write_b32 a101, v69
    v_accvgpr_write_b32 a102, v70
    v_accvgpr_write_b32 a103, v71
    v_xor_b32 v68, v64, v43
    v_xor_b32 v69, v65, v43
    v_xor_b32 v70, v66, v43
    v_xor_b32 v71, v67, v43
    v_accvgpr_write_b32 a164, v68
    v_accvgpr_write_b32 a165, v69
    v_accvgpr_write_b32 a166, v70
    v_accvgpr_write_b32 a167, v71
    v_xor_b32_dpp v68, v64, v45 quad_perm:[0,1,3,2] row_mask:0xf bank_mask:0xf
    v_xor_b32_dpp v69, v65, v45 quad_perm:[0,1,3,2] row_mask:0xf bank_mask:0xf
    v_xor_b32_dpp v70, v66, v45 quad_perm:[0,1,3,2] row_mask:0xf bank_mask:0xf
    v_xor_b32_dpp v71, v67, v45 quad_perm:[0,1,3,2] row_mask:0xf bank_mask:0xf
    v_accvgpr_write_b32 a228, v68
    v_accvgpr_write_b32 a229, v69
    v_accvgpr_write_b32 a230, v70
    v_accvgpr_write_b32 a231, v71
    v_fract_f32 v48, v30
    v_add_f32 v49, v48, v32
    v_cos_f32 v56, v48
    v_add_f32 v50, v49, v34
    v_cos_f32 v57, v49
    v_add_f32 v51, v50, v32
    v_cos_f32 v58, v50
    v_add_f32 v52, v51, v34
    v_cos_f32 v59, v51
    v_add_f32 v53, v52, v32
    v_cos_f32 v60, v52
    v_add_f32 v54, v53, v34
    v_cos_f32 v61, v53
    v_add_f32 v55, v54, v32
    v_cos_f32 v62, v54
    v_cos_f32 v63, v55
    v_add_f32 v30, v48, v36
    v_cvt_pk_bf16_f32 v64, v56, v57
    v_cvt_pk_bf16_f32 v65, v58, v59
    v_cvt_pk_bf16_f32 v66, v60, v61
    v_cvt_pk_bf16_f32 v67, v62, v63
    v_accvgpr_write_b32 a40, v64
    v_accvgpr_write_b32 a41, v65
    v_accvgpr_write_b32 a42, v66
    v_accvgpr_write_b32 a43, v67
    v_xor_b32_dpp v68, v64, v40 quad_perm:[0,1,3,2] row_mask:0xf bank_mask:0xf
    v_xor_b32_dpp v69, v65, v40 quad_perm:[0,1,3,2] row_mask:0xf bank_mask:0xf
    v_xor_b32_dpp v70, v66, v40 quad_perm:[0,1,3,2] row_mask:0xf bank_mask:0xf
    v_xor_b32_dpp v71, v67, v40 quad_perm:[0,1,3,2] row_mask:0xf bank_mask:0xf
    v_accvgpr_write_b32 a104, v68
    v_accvgpr_write_b32 a105, v69
    v_accvgpr_write_b32 a106, v70
    v_accvgpr_write_b32 a107, v71
    v_xor_b32 v68, v64, v42
    v_xor_b32 v69, v65, v42
    v_xor_b32 v70, v66, v42
    v_xor_b32 v71, v67, v42
    v_accvgpr_write_b32 a168, v68
    v_accvgpr_write_b32 a169, v69
    v_accvgpr_write_b32 a170, v70
    v_accvgpr_write_b32 a171, v71
    v_xor_b32_dpp v68, v64, v44 quad_perm:[0,1,3,2] row_mask:0xf bank_mask:0xf
    v_xor_b32_dpp v69, v65, v44 quad_perm:[0,1,3,2] row_mask:0xf bank_mask:0xf
    v_xor_b32_dpp v70, v66, v44 quad_perm:[0,1,3,2] row_mask:0xf bank_mask:0xf
    v_xor_b32_dpp v71, v67, v44 quad_perm:[0,1,3,2] row_mask:0xf bank_mask:0xf
    v_accvgpr_write_b32 a232, v68
    v_accvgpr_write_b32 a233, v69
    v_accvgpr_write_b32 a234, v70
    v_accvgpr_write_b32 a235, v71
    v_fract_f32 v48, v31
    v_add_f32 v49, v48, v33
    v_cos_f32 v56, v48
    v_add_f32 v50, v49, v35
    v_cos_f32 v57, v49
    v_add_f32 v51, v50, v33
    v_cos_f32 v58, v50
    v_add_f32 v52, v51, v35
    v_cos_f32 v59, v51
    v_add_f32 v53, v52, v33
    v_cos_f32 v60, v52
    v_add_f32 v54, v53, v35
    v_cos_f32 v61, v53
    v_add_f32 v55, v54, v33
    v_cos_f32 v62, v54
    v_cos_f32 v63, v55
    v_add_f32 v31, v48, v37
    v_cvt_pk_bf16_f32 v64, v56, v57
    v_cvt_pk_bf16_f32 v65, v58, v59
    v_cvt_pk_bf16_f32 v66, v60, v61
    v_cvt_pk_bf16_f32 v67, v62, v63
    v_accvgpr_write_b32 a44, v64
    v_accvgpr_write_b32 a45, v65
    v_accvgpr_write_b32 a46, v66
    v_accvgpr_write_b32 a47, v67
    v_xor_b32_dpp v68, v64, v41 quad_perm:[0,1,3,2] row_mask:0xf bank_mask:0xf
    v_xor_b32_dpp v69, v65, v41 quad_perm:[0,1,3,2] row_mask:0xf bank_mask:0xf
    v_xor_b32_dpp v70, v66, v41 quad_perm:[0,1,3,2] row_mask:0xf bank_mask:0xf
    v_xor_b32_dpp v71, v67, v41 quad_perm:[0,1,3,2] row_mask:0xf bank_mask:0xf
    v_accvgpr_write_b32 a108, v68
    v_accvgpr_write_b32 a109, v69
    v_accvgpr_write_b32 a110, v70
    v_accvgpr_write_b32 a111, v71
    v_xor_b32 v68, v64, v43
    v_xor_b32 v69, v65, v43
    v_xor_b32 v70, v66, v43
    v_xor_b32 v71, v67, v43
    v_accvgpr_write_b32 a172, v68
    v_accvgpr_write_b32 a173, v69
    v_accvgpr_write_b32 a174, v70
    v_accvgpr_write_b32 a175, v71
    v_xor_b32_dpp v68, v64, v45 quad_perm:[0,1,3,2] row_mask:0xf bank_mask:0xf
    v_xor_b32_dpp v69, v65, v45 quad_perm:[0,1,3,2] row_mask:0xf bank_mask:0xf
    v_xor_b32_dpp v70, v66, v45 quad_perm:[0,1,3,2] row_mask:0xf bank_mask:0xf
    v_xor_b32_dpp v71, v67, v45 quad_perm:[0,1,3,2] row_mask:0xf bank_mask:0xf
    v_accvgpr_write_b32 a236, v68
    v_accvgpr_write_b32 a237, v69
    v_accvgpr_write_b32 a238, v70
    v_accvgpr_write_b32 a239, v71
    v_fract_f32 v48, v30
    v_add_f32 v49, v48, v32
    v_cos_f32 v56, v48
    v_add_f32 v50, v49, v34
    v_cos_f32 v57, v49
    v_add_f32 v51, v50, v32
    v_cos_f32 v58, v50
    v_add_f32 v52, v51, v34
    v_cos_f32 v59, v51
    v_add_f32 v53, v52, v32
    v_cos_f32 v60, v52
    v_add_f32 v54, v53, v34
    v_cos_f32 v61, v53
    v_add_f32 v55, v54, v32
    v_cos_f32 v62, v54
    v_cos_f32 v63, v55
    v_add_f32 v30, v48, v36
    v_cvt_pk_bf16_f32 v64, v56, v57
    v_cvt_pk_bf16_f32 v65, v58, v59
    v_cvt_pk_bf16_f32 v66, v60, v61
    v_cvt_pk_bf16_f32 v67, v62, v63
    v_accvgpr_write_b32 a48, v64
    v_accvgpr_write_b32 a49, v65
    v_accvgpr_write_b32 a50, v66
    v_accvgpr_write_b32 a51, v67
    v_xor_b32_dpp v68, v64, v40 quad_perm:[0,1,3,2] row_mask:0xf bank_mask:0xf
    v_xor_b32_dpp v69, v65, v40 quad_perm:[0,1,3,2] row_mask:0xf bank_mask:0xf
    v_xor_b32_dpp v70, v66, v40 quad_perm:[0,1,3,2] row_mask:0xf bank_mask:0xf
    v_xor_b32_dpp v71, v67, v40 quad_perm:[0,1,3,2] row_mask:0xf bank_mask:0xf
    v_accvgpr_write_b32 a112, v68
    v_accvgpr_write_b32 a113, v69
    v_accvgpr_write_b32 a114, v70
    v_accvgpr_write_b32 a115, v71
    v_xor_b32 v68, v64, v42
    v_xor_b32 v69, v65, v42
    v_xor_b32 v70, v66, v42
    v_xor_b32 v71, v67, v42
    v_accvgpr_write_b32 a176, v68
    v_accvgpr_write_b32 a177, v69
    v_accvgpr_write_b32 a178, v70
    v_accvgpr_write_b32 a179, v71
    v_xor_b32_dpp v68, v64, v44 quad_perm:[0,1,3,2] row_mask:0xf bank_mask:0xf
    v_xor_b32_dpp v69, v65, v44 quad_perm:[0,1,3,2] row_mask:0xf bank_mask:0xf
    v_xor_b32_dpp v70, v66, v44 quad_perm:[0,1,3,2] row_mask:0xf bank_mask:0xf
    v_xor_b32_dpp v71, v67, v44 quad_perm:[0,1,3,2] row_mask:0xf bank_mask:0xf
    v_accvgpr_write_b32 a240, v68
    v_accvgpr_write_b32 a241, v69
    v_accvgpr_write_b32 a242, v70
    v_accvgpr_write_b32 a243, v71
    v_fract_f32 v48, v31
    v_add_f32 v49, v48, v33
    v_cos_f32 v56, v48
    v_add_f32 v50, v49, v35
    v_cos_f32 v57, v49
    v_add_f32 v51, v50, v33
    v_cos_f32 v58, v50
    v_add_f32 v52, v51, v35
    v_cos_f32 v59, v51
    v_add_f32 v53, v52, v33
    v_cos_f32 v60, v52
    v_add_f32 v54, v53, v35
    v_cos_f32 v61, v53
    v_add_f32 v55, v54, v33
    v_cos_f32 v62, v54
    v_cos_f32 v63, v55
    v_add_f32 v31, v48, v37
    v_cvt_pk_bf16_f32 v64, v56, v57
    v_cvt_pk_bf16_f32 v65, v58, v59
    v_cvt_pk_bf16_f32 v66, v60, v61
    v_cvt_pk_bf16_f32 v67, v62, v63
    v_accvgpr_write_b32 a52, v64
    v_accvgpr_write_b32 a53, v65
    v_accvgpr_write_b32 a54, v66
    v_accvgpr_write_b32 a55, v67
    v_xor_b32_dpp v68, v64, v41 quad_perm:[0,1,3,2] row_mask:0xf bank_mask:0xf
    v_xor_b32_dpp v69, v65, v41 quad_perm:[0,1,3,2] row_mask:0xf bank_mask:0xf
    v_xor_b32_dpp v70, v66, v41 quad_perm:[0,1,3,2] row_mask:0xf bank_mask:0xf
    v_xor_b32_dpp v71, v67, v41 quad_perm:[0,1,3,2] row_mask:0xf bank_mask:0xf
    v_accvgpr_write_b32 a116, v68
    v_accvgpr_write_b32 a117, v69
    v_accvgpr_write_b32 a118, v70
    v_accvgpr_write_b32 a119, v71
    v_xor_b32 v68, v64, v43
    v_xor_b32 v69, v65, v43
    v_xor_b32 v70, v66, v43
    v_xor_b32 v71, v67, v43
    v_accvgpr_write_b32 a180, v68
    v_accvgpr_write_b32 a181, v69
    v_accvgpr_write_b32 a182, v70
    v_accvgpr_write_b32 a183, v71
    v_xor_b32_dpp v68, v64, v45 quad_perm:[0,1,3,2] row_mask:0xf bank_mask:0xf
    v_xor_b32_dpp v69, v65, v45 quad_perm:[0,1,3,2] row_mask:0xf bank_mask:0xf
    v_xor_b32_dpp v70, v66, v45 quad_perm:[0,1,3,2] row_mask:0xf bank_mask:0xf
    v_xor_b32_dpp v71, v67, v45 quad_perm:[0,1,3,2] row_mask:0xf bank_mask:0xf
    v_accvgpr_write_b32 a244, v68
    v_accvgpr_write_b32 a245, v69
    v_accvgpr_write_b32 a246, v70
    v_accvgpr_write_b32 a247, v71
    v_fract_f32 v48, v30
    v_add_f32 v49, v48, v32
    v_cos_f32 v56, v48
    v_add_f32 v50, v49, v34
    v_cos_f32 v57, v49
    v_add_f32 v51, v50, v32
    v_cos_f32 v58, v50
    v_add_f32 v52, v51, v34
    v_cos_f32 v59, v51
    v_add_f32 v53, v52, v32
    v_cos_f32 v60, v52
    v_add_f32 v54, v53, v34
    v_cos_f32 v61, v53
    v_add_f32 v55, v54, v32
    v_cos_f32 v62, v54
    v_cos_f32 v63, v55
    v_add_f32 v30, v48, v36
    v_cvt_pk_bf16_f32 v64, v56, v57
    v_cvt_pk_bf16_f32 v65, v58, v59
    v_cvt_pk_bf16_f32 v66, v60, v61
    v_cvt_pk_bf16_f32 v67, v62, v63
    v_accvgpr_write_b32 a56, v64
    v_accvgpr_write_b32 a57, v65
    v_accvgpr_write_b32 a58, v66
    v_accvgpr_write_b32 a59, v67
    v_xor_b32_dpp v68, v64, v40 quad_perm:[0,1,3,2] row_mask:0xf bank_mask:0xf
    v_xor_b32_dpp v69, v65, v40 quad_perm:[0,1,3,2] row_mask:0xf bank_mask:0xf
    v_xor_b32_dpp v70, v66, v40 quad_perm:[0,1,3,2] row_mask:0xf bank_mask:0xf
    v_xor_b32_dpp v71, v67, v40 quad_perm:[0,1,3,2] row_mask:0xf bank_mask:0xf
    v_accvgpr_write_b32 a120, v68
    v_accvgpr_write_b32 a121, v69
    v_accvgpr_write_b32 a122, v70
    v_accvgpr_write_b32 a123, v71
    v_xor_b32 v68, v64, v42
    v_xor_b32 v69, v65, v42
    v_xor_b32 v70, v66, v42
    v_xor_b32 v71, v67, v42
    v_accvgpr_write_b32 a184, v68
    v_accvgpr_write_b32 a185, v69
    v_accvgpr_write_b32 a186, v70
    v_accvgpr_write_b32 a187, v71
    v_xor_b32_dpp v68, v64, v44 quad_perm:[0,1,3,2] row_mask:0xf bank_mask:0xf
    v_xor_b32_dpp v69, v65, v44 quad_perm:[0,1,3,2] row_mask:0xf bank_mask:0xf
    v_xor_b32_dpp v70, v66, v44 quad_perm:[0,1,3,2] row_mask:0xf bank_mask:0xf
    v_xor_b32_dpp v71, v67, v44 quad_perm:[0,1,3,2] row_mask:0xf bank_mask:0xf
    v_accvgpr_write_b32 a248, v68
    v_accvgpr_write_b32 a249, v69
    v_accvgpr_write_b32 a250, v70
    v_accvgpr_write_b32 a251, v71
    v_fract_f32 v48, v31
    v_add_f32 v49, v48, v33
    v_cos_f32 v56, v48
    v_add_f32 v50, v49, v35
    v_cos_f32 v57, v49
    v_add_f32 v51, v50, v33
    v_cos_f32 v58, v50
    v_add_f32 v52, v51, v35
    v_cos_f32 v59, v51
    v_add_f32 v53, v52, v33
    v_cos_f32 v60, v52
    v_add_f32 v54, v53, v35
    v_cos_f32 v61, v53
    v_add_f32 v55, v54, v33
    v_cos_f32 v62, v54
    v_cos_f32 v63, v55
    v_add_f32 v31, v48, v37
    v_cvt_pk_bf16_f32 v64, v56, v57
    v_cvt_pk_bf16_f32 v65, v58, v59
    v_cvt_pk_bf16_f32 v66, v60, v61
    v_cvt_pk_bf16_f32 v67, v62, v63
    v_accvgpr_write_b32 a60, v64
    v_accvgpr_write_b32 a61, v65
    v_accvgpr_write_b32 a62, v66
    v_accvgpr_write_b32 a63, v67
    v_xor_b32_dpp v68, v64, v41 quad_perm:[0,1,3,2] row_mask:0xf bank_mask:0xf
    v_xor_b32_dpp v69, v65, v41 quad_perm:[0,1,3,2] row_mask:0xf bank_mask:0xf
    v_xor_b32_dpp v70, v66, v41 quad_perm:[0,1,3,2] row_mask:0xf bank_mask:0xf
    v_xor_b32_dpp v71, v67, v41 quad_perm:[0,1,3,2] row_mask:0xf bank_mask:0xf
    v_accvgpr_write_b32 a124, v68
    v_accvgpr_write_b32 a125, v69
    v_accvgpr_write_b32 a126, v70
    v_accvgpr_write_b32 a127, v71
    v_xor_b32 v68, v64, v43
    v_xor_b32 v69, v65, v43
    v_xor_b32 v70, v66, v43
    v_xor_b32 v71, v67, v43
    v_accvgpr_write_b32 a188, v68
    v_accvgpr_write_b32 a189, v69
    v_accvgpr_write_b32 a190, v70
    v_accvgpr_write_b32 a191, v71
    v_xor_b32_dpp v68, v64, v45 quad_perm:[0,1,3,2] row_mask:0xf bank_mask:0xf
    v_xor_b32_dpp v69, v65, v45 quad_perm:[0,1,3,2] row_mask:0xf bank_mask:0xf
    v_xor_b32_dpp v70, v66, v45 quad_perm:[0,1,3,2] row_mask:0xf bank_mask:0xf
    v_xor_b32_dpp v71, v67, v45 quad_perm:[0,1,3,2] row_mask:0xf bank_mask:0xf
    v_accvgpr_write_b32 a252, v68
    v_accvgpr_write_b32 a253, v69
    v_accvgpr_write_b32 a254, v70
    v_accvgpr_write_b32 a255, v71
    s_and_b32 s17, s28, 1
    s_lshl_b32 s17, s17, 15
    s_lshr_b32 s18, s28, 1
    s_lshl_b32 s18, s18, 21
    s_add_u32 s17, s17, s18
    s_lshl_b32 s18, s29, 16
    s_add_u32 s17, s17, s18
    v_lshlrev_b32 v15, 7, v1
    s_waitcnt lgkmcnt(0)
    buffer_load_dword v248, v15, s[40:43], s17 offen
    s_add_u32 s17, s17, 8192
    buffer_load_dword v249, v15, s[40:43], s17 offen
    s_add_u32 s17, s17, 8192
    buffer_load_dword v250, v15, s[40:43], s17 offen
    s_add_u32 s17, s17, 8192
    buffer_load_dword v251, v15, s[40:43], s17 offen
    s_add_u32 s17, s17, 8192
    s_lshl_b32 s34, s93, 2
    s_add_u32 s34, s34, s16
    s_lshl_b32 s34, s34, 13
    s_sub_u32 s34, s34, 262144
    v_mov_b32 v247, v15
    s_load_dwordx2 s[8:9], s[0:1], 0
    s_mov_b32 s10, 4194304
    s_mov_b32 s11, 0x20000
    s_waitcnt lgkmcnt(0)
    v_and_b32 v5, 15, v1
    v_bfe_u32 v6, v1, 1, 3
    v_lshrrev_b32 v7, 4, v1
    v_xor_b32 v6, v6, v7
    v_lshlrev_b32 v6, 4, v6
    v_lshl_add_u32 v10, v5, 7, v6
    s_lshl_b32 s19, s16, 10
    v_xor_b32 v11, 64, v10
    v_add_u32 v12, 0x10000, v10
    v_add_u32 v13, 0x10000, v11
    v_lshrrev_b32 v7, 3, v1
    s_lshl_b32 s17, s16, 3
    v_add_u32 v7, s17, v7
    v_bfe_u32 v8, v7, 1, 3
    v_xor_b32 v8, v8, v1
    v_and_b32 v8, 7, v8
    v_bfe_u32 v5, v7, 2, 2
    v_and_b32 v2, 3, v7
    v_lshl_add_u32 v2, v5, 3, v2
    v_bfe_u32 v5, v7, 4, 1
    v_lshl_add_u32 v2, v5, 2, v2
    v_bfe_u32 v5, v1, 2, 2
    v_and_b32 v3, 3, v1
    v_lshl_add_u32 v3, v5, 3, v3
    v_lshlrev_b32 v2, 16, v2
    v_lshl_add_u32 v2, v8, 4, v2
    v_and_b32 v5, 48, v1
    v_lshl_add_u32 v3, v3, 6, v5
    s_mul_i32 s21, s29, 133120
    s_lshl_b32 s17, s28, 15
    s_add_u32 s21, s21, s17
    s_add_u32 s21, s21, 104857600
    s_and_b32 s20, s28, 1
    s_lshl_b32 s20, s20, 15
    s_lshr_b32 s17, s28, 1
    s_lshl_b32 s17, s17, 21
    s_add_u32 s20, s20, s17
    s_mov_b32 s24, 2048
    s_mov_b32 s25, 2048
    s_barrier
    s_mov_b32 s26, s25
    s_sub_u32 s25, s21, 1073741824
    s_mov_b32 s21, 1073741824
    s_mov_b32 s23, 0
    s_mov_b32 s22, 0
    s_add_u32 m0, s19, 0
    s_nop 0
    buffer_load_dwordx4 v2, s[8:11], s20 offen offset:0 lds
    s_add_u32 m0, s19, 3968
    s_nop 0
    buffer_load_dwordx4 v2, s[8:11], s20 offen offset:128 lds
    s_add_u32 m0, s19, 7936
    s_nop 0
    buffer_load_dwordx4 v2, s[8:11], s20 offen offset:256 lds
    s_add_u32 m0, s19, 11904
    s_nop 0
    buffer_load_dwordx4 v2, s[8:11], s20 offen offset:384 lds
    s_add_u32 m0, s19, 15872
    s_nop 0
    buffer_load_dwordx4 v2, s[8:11], s20 offen offset:512 lds
    s_add_u32 m0, s19, 19840
    s_nop 0
    buffer_load_dwordx4 v2, s[8:11], s20 offen offset:640 lds
    s_add_u32 m0, s19, 23808
    s_nop 0
    buffer_load_dwordx4 v2, s[8:11], s20 offen offset:768 lds
    s_add_u32 m0, s19, 27776
    s_nop 0
    buffer_load_dwordx4 v2, s[8:11], s20 offen offset:896 lds
    s_add_u32 m0, s19, 31744
    s_nop 0
    buffer_load_dwordx4 v2, s[8:11], s20 offen offset:1024 lds
    s_add_u32 m0, s19, 35712
    s_nop 0
    buffer_load_dwordx4 v2, s[8:11], s20 offen offset:1152 lds
    s_add_u32 m0, s19, 39680
    s_nop 0
    buffer_load_dwordx4 v2, s[8:11], s20 offen offset:1280 lds
    s_add_u32 m0, s19, 43648
    s_nop 0
    buffer_load_dwordx4 v2, s[8:11], s20 offen offset:1408 lds
    s_add_u32 m0, s19, 47616
    s_nop 0
    buffer_load_dwordx4 v2, s[8:11], s20 offen offset:1536 lds
    s_add_u32 m0, s19, 51584
    s_nop 0
    buffer_load_dwordx4 v2, s[8:11], s20 offen offset:1664 lds
    s_add_u32 m0, s19, 55552
    s_nop 0
    buffer_load_dwordx4 v2, s[8:11], s20 offen offset:1792 lds
    s_add_u32 m0, s19, 59520
    s_nop 0
    buffer_load_dwordx4 v2, s[8:11], s20 offen offset:1920 lds
    s_add_u32 s20, s20, s24
    s_add_u32 m0, s19, 65536
    s_nop 0
    buffer_load_dwordx4 v2, s[8:11], s20 offen offset:0 lds
    s_add_u32 m0, s19, 69504
    s_nop 0
    buffer_load_dwordx4 v2, s[8:11], s20 offen offset:128 lds
    s_add_u32 m0, s19, 73472
    s_nop 0
    buffer_load_dwordx4 v2, s[8:11], s20 offen offset:256 lds
    s_waitcnt vmcnt(11)
    s_barrier
    ds_read_b128 v[20:23], v10 offset:0
    ds_read_b128 v[24:27], v10 offset:2048
    ds_read_b128 v[28:31], v11 offset:0
    ds_read_b128 v[32:35], v11 offset:2048
    ds_read_b128 v[36:39], v10 offset:4096
    ds_read_b128 v[40:43], v10 offset:6144
    ds_read_b128 v[44:47], v11 offset:4096
.p2align 6
F1_top:
    s_waitcnt lgkmcnt(6)
    v_mfma_f32_16x16x32_bf16 v[52:55], v[20:23], a[0:3], 0
    ds_read_b128 v[48:51], v11 offset:6144
    v_mfma_f32_16x16x32_bf16 v[60:63], v[20:23], a[4:7], 0
    s_waitcnt lgkmcnt(6)
    v_mfma_f32_16x16x32_bf16 v[56:59], v[24:27], a[0:3], 0
    ds_read_b128 v[20:23], v10 offset:8192
    s_add_u32 m0, s19, 77440
    v_mfma_f32_16x16x32_bf16 v[64:67], v[24:27], a[4:7], 0
    buffer_load_dwordx4 v2, s[8:11], s20 offen offset:384 lds
    s_waitcnt lgkmcnt(6)
    v_mfma_f32_16x16x32_bf16 v[52:55], v[28:31], a[8:11], v[52:55]
    ds_read_b128 v[24:27], v10 offset:10240
    v_mfma_f32_16x16x32_bf16 v[60:63], v[28:31], a[12:15], v[60:63]
    s_waitcnt lgkmcnt(6)
    v_mfma_f32_16x16x32_bf16 v[56:59], v[32:35], a[8:11], v[56:59]
    ds_read_b128 v[28:31], v11 offset:8192
    s_add_u32 m0, s19, 81408
    v_mfma_f32_16x16x32_bf16 v[64:67], v[32:35], a[12:15], v[64:67]
    buffer_load_dwordx4 v2, s[8:11], s20 offen offset:512 lds
    s_waitcnt lgkmcnt(6)
    v_mfma_f32_16x16x32_bf16 v[52:55], v[36:39], a[16:19], v[52:55]
    ds_read_b128 v[32:35], v11 offset:10240
    v_mfma_f32_16x16x32_bf16 v[60:63], v[36:39], a[20:23], v[60:63]
    s_waitcnt lgkmcnt(6)
    v_mfma_f32_16x16x32_bf16 v[56:59], v[40:43], a[16:19], v[56:59]
    ds_read_b128 v[36:39], v10 offset:12288
    s_add_u32 m0, s19, 85376
    v_mfma_f32_16x16x32_bf16 v[64:67], v[40:43], a[20:23], v[64:67]
    buffer_load_dwordx4 v2, s[8:11], s20 offen offset:640 lds
    s_waitcnt lgkmcnt(6)
    v_mfma_f32_16x16x32_bf16 v[52:55], v[44:47], a[24:27], v[52:55]
    ds_read_b128 v[40:43], v10 offset:14336
    v_mfma_f32_16x16x32_bf16 v[60:63], v[44:47], a[28:31], v[60:63]
    s_waitcnt lgkmcnt(6)
    v_mfma_f32_16x16x32_bf16 v[56:59], v[48:51], a[24:27], v[56:59]
    ds_read_b128 v[44:47], v11 offset:12288
    s_add_u32 m0, s19, 89344
    v_mfma_f32_16x16x32_bf16 v[64:67], v[48:51], a[28:31], v[64:67]
    buffer_load_dwordx4 v2, s[8:11], s20 offen offset:768 lds
    s_waitcnt lgkmcnt(6)
    v_mfma_f32_16x16x32_bf16 v[52:55], v[20:23], a[32:35], v[52:55]
    ds_read_b128 v[48:51], v11 offset:14336
    v_mfma_f32_16x16x32_bf16 v[60:63], v[20:23], a[36:39], v[60:63]
    s_waitcnt lgkmcnt(6)
    v_mfma_f32_16x16x32_bf16 v[56:59], v[24:27], a[32:35], v[56:59]
    ds_read_b128 v[20:23], v10 offset:16384
    s_add_u32 m0, s19, 93312
    v_mfma_f32_16x16x32_bf16 v[64:67], v[24:27], a[36:39], v[64:67]
    buffer_load_dwordx4 v2, s[8:11], s20 offen offset:896 lds
    s_waitcnt lgkmcnt(6)
    v_mfma_f32_16x16x32_bf16 v[52:55], v[28:31], a[40:43], v[52:55]
    ds_read_b128 v[24:27], v10 offset:18432
    v_mfma_f32_16x16x32_bf16 v[60:63], v[28:31], a[44:47], v[60:63]
    v_cvt_pk_bf16_f32 v84, v68, v69
    s_waitcnt lgkmcnt(6)
    v_mfma_f32_16x16x32_bf16 v[56:59], v[32:35], a[40:43], v[56:59]
    ds_read_b128 v[28:31], v11 offset:16384
    v_mfma_f32_16x16x32_bf16 v[64:67], v[32:35], a[44:47], v[64:67]
    v_cvt_pk_bf16_f32 v85, v70, v71
    s_waitcnt lgkmcnt(6)
    v_mfma_f32_16x16x32_bf16 v[52:55], v[36:39], a[48:51], v[52:55]
    ds_read_b128 v[32:35], v11 offset:18432
    v_mfma_f32_16x16x32_bf16 v[60:63], v[36:39], a[52:55], v[60:63]
    v_cvt_pk_bf16_f32 v86, v72, v73
    s_waitcnt lgkmcnt(6)
    v_mfma_f32_16x16x32_bf16 v[56:59], v[40:43], a[48:51], v[56:59]
    ds_read_b128 v[36:39], v10 offset:20480
    v_mfma_f32_16x16x32_bf16 v[64:67], v[40:43], a[52:55], v[64:67]
    v_cvt_pk_bf16_f32 v87, v74, v75
    s_waitcnt lgkmcnt(6)
    v_mfma_f32_16x16x32_bf16 v[52:55], v[44:47], a[56:59], v[52:55]
    ds_read_b128 v[40:43], v10 offset:22528
    v_mfma_f32_16x16x32_bf16 v[60:63], v[44:47], a[60:63], v[60:63]
    v_cvt_pk_bf16_f32 v88, v76, v77
    s_waitcnt lgkmcnt(6)
    v_mfma_f32_16x16x32_bf16 v[56:59], v[48:51], a[56:59], v[56:59]
    ds_read_b128 v[44:47], v11 offset:20480
    v_mfma_f32_16x16x32_bf16 v[64:67], v[48:51], a[60:63], v[64:67]
    v_cvt_pk_bf16_f32 v89, v78, v79
    buffer_store_dwordx4 v[84:87], v3, s[4:7], s21 offen offset:0 sc1
    s_waitcnt lgkmcnt(6)
    v_mfma_f32_16x16x32_bf16 v[52:55], v[20:23], a[64:67], v[52:55]
    ds_read_b128 v[48:51], v11 offset:22528
    v_mfma_f32_16x16x32_bf16 v[60:63], v[20:23], a[68:71], v[60:63]
    v_cvt_pk_bf16_f32 v90, v80, v81
    s_waitcnt lgkmcnt(6)
    v_mfma_f32_16x16x32_bf16 v[56:59], v[24:27], a[64:67], v[56:59]
    ds_read_b128 v[20:23], v10 offset:24576
    v_mfma_f32_16x16x32_bf16 v[64:67], v[24:27], a[68:71], v[64:67]
    v_cvt_pk_bf16_f32 v91, v82, v83
    s_waitcnt lgkmcnt(6)
    v_mfma_f32_16x16x32_bf16 v[52:55], v[28:31], a[72:75], v[52:55]
    ds_read_b128 v[24:27], v10 offset:26624
    v_mfma_f32_16x16x32_bf16 v[60:63], v[28:31], a[76:79], v[60:63]
    s_waitcnt lgkmcnt(6)
    v_mfma_f32_16x16x32_bf16 v[56:59], v[32:35], a[72:75], v[56:59]
    ds_read_b128 v[28:31], v11 offset:24576
    v_mfma_f32_16x16x32_bf16 v[64:67], v[32:35], a[76:79], v[64:67]
    buffer_store_dwordx4 v[88:91], v3, s[4:7], s21 offen offset:256 sc1
    s_waitcnt lgkmcnt(6)
    v_mfma_f32_16x16x32_bf16 v[52:55], v[36:39], a[80:83], v[52:55]
    ds_read_b128 v[32:35], v11 offset:26624
    v_mfma_f32_16x16x32_bf16 v[60:63], v[36:39], a[84:87], v[60:63]
    s_add_u32 s21, s21, s25
    s_mov_b32 s25, s26
    s_waitcnt lgkmcnt(6)
    v_mfma_f32_16x16x32_bf16 v[56:59], v[40:43], a[80:83], v[56:59]
    ds_read_b128 v[36:39], v10 offset:28672
    v_mfma_f32_16x16x32_bf16 v[64:67], v[40:43], a[84:87], v[64:67]
    s_waitcnt lgkmcnt(6)
    v_mfma_f32_16x16x32_bf16 v[52:55], v[44:47], a[88:91], v[52:55]
    ds_read_b128 v[40:43], v10 offset:30720
    v_mfma_f32_16x16x32_bf16 v[60:63], v[44:47], a[92:95], v[60:63]
    buffer_load_dword v248, v247, s[44:47], s34 offen
    s_add_u32 s34, s34, 1048576
    s_waitcnt lgkmcnt(6)
    v_mfma_f32_16x16x32_bf16 v[56:59], v[48:51], a[88:91], v[56:59]
    ds_read_b128 v[44:47], v11 offset:28672
    v_mfma_f32_16x16x32_bf16 v[64:67], v[48:51], a[92:95], v[64:67]
    s_waitcnt lgkmcnt(6)
    v_mfma_f32_16x16x32_bf16 v[52:55], v[20:23], a[96:99], v[52:55]
    ds_read_b128 v[48:51], v11 offset:30720
    v_mfma_f32_16x16x32_bf16 v[60:63], v[20:23], a[100:103], v[60:63]
    s_waitcnt lgkmcnt(6)
    v_mfma_f32_16x16x32_bf16 v[56:59], v[24:27], a[96:99], v[56:59]
    s_waitcnt vmcnt(11)
    s_barrier
    ds_read_b128 v[20:23], v10 offset:32768
    v_mfma_f32_16x16x32_bf16 v[64:67], v[24:27], a[100:103], v[64:67]
    s_waitcnt lgkmcnt(6)
    v_mfma_f32_16x16x32_bf16 v[52:55], v[28:31], a[104:107], v[52:55]
    ds_read_b128 v[24:27], v10 offset:34816
    s_add_u32 m0, s19, 97280
    v_mfma_f32_16x16x32_bf16 v[60:63], v[28:31], a[108:111], v[60:63]
    buffer_load_dwordx4 v2, s[8:11], s20 offen offset:1024 lds
    s_waitcnt lgkmcnt(6)
    v_mfma_f32_16x16x32_bf16 v[56:59], v[32:35], a[104:107], v[56:59]
    ds_read_b128 v[28:31], v11 offset:32768
    v_mfma_f32_16x16x32_bf16 v[64:67], v[32:35], a[108:111], v[64:67]
    s_waitcnt lgkmcnt(6)
    v_mfma_f32_16x16x32_bf16 v[52:55], v[36:39], a[112:115], v[52:55]
    ds_read_b128 v[32:35], v11 offset:34816
    s_add_u32 m0, s19, 101248
    v_mfma_f32_16x16x32_bf16 v[60:63], v[36:39], a[116:119], v[60:63]
    buffer_load_dwordx4 v2, s[8:11], s20 offen offset:1152 lds
    s_waitcnt lgkmcnt(6)
    v_mfma_f32_16x16x32_bf16 v[56:59], v[40:43], a[112:115], v[56:59]
    ds_read_b128 v[36:39], v10 offset:36864
    v_mfma_f32_16x16x32_bf16 v[64:67], v[40:43], a[116:119], v[64:67]
    s_waitcnt lgkmcnt(6)
    v_mfma_f32_16x16x32_bf16 v[52:55], v[44:47], a[120:123], v[52:55]
    ds_read_b128 v[40:43], v10 offset:38912
    s_add_u32 m0, s19, 105216
    v_mfma_f32_16x16x32_bf16 v[60:63], v[44:47], a[124:127], v[60:63]
    buffer_load_dwordx4 v2, s[8:11], s20 offen offset:1280 lds
    s_waitcnt lgkmcnt(6)
    v_mfma_f32_16x16x32_bf16 v[56:59], v[48:51], a[120:123], v[56:59]
    ds_read_b128 v[44:47], v11 offset:36864
    v_mfma_f32_16x16x32_bf16 v[64:67], v[48:51], a[124:127], v[64:67]
    s_waitcnt lgkmcnt(6)
    v_mfma_f32_16x16x32_bf16 v[52:55], v[20:23], a[128:131], v[52:55]
    ds_read_b128 v[48:51], v11 offset:38912
    v_mfma_f32_16x16x32_bf16 v[60:63], v[20:23], a[132:135], v[60:63]
    s_waitcnt lgkmcnt(6)
    v_mfma_f32_16x16x32_bf16 v[56:59], v[24:27], a[128:131], v[56:59]
    ds_read_b128 v[20:23], v10 offset:40960
    s_add_u32 m0, s19, 109184
    v_mfma_f32_16x16x32_bf16 v[64:67], v[24:27], a[132:135], v[64:67]
    buffer_load_dwordx4 v2, s[8:11], s20 offen offset:1408 lds
    s_waitcnt lgkmcnt(6)
    v_mfma_f32_16x16x32_bf16 v[52:55], v[28:31], a[136:139], v[52:55]
    ds_read_b128 v[24:27], v10 offset:43008
    v_mfma_f32_16x16x32_bf16 v[60:63], v[28:31], a[140:143], v[60:63]
    s_waitcnt lgkmcnt(6)
    v_mfma_f32_16x16x32_bf16 v[56:59], v[32:35], a[136:139], v[56:59]
    ds_read_b128 v[28:31], v11 offset:40960
    s_add_u32 m0, s19, 113152
    v_mfma_f32_16x16x32_bf16 v[64:67], v[32:35], a[140:143], v[64:67]
    buffer_load_dwordx4 v2, s[8:11], s20 offen offset:1536 lds
    s_waitcnt lgkmcnt(6)
    v_mfma_f32_16x16x32_bf16 v[52:55], v[36:39], a[144:147], v[52:55]
    ds_read_b128 v[32:35], v11 offset:43008
    v_mfma_f32_16x16x32_bf16 v[60:63], v[36:39], a[148:151], v[60:63]
    s_waitcnt lgkmcnt(6)
    v_mfma_f32_16x16x32_bf16 v[56:59], v[40:43], a[144:147], v[56:59]
    ds_read_b128 v[36:39], v10 offset:45056
    s_add_u32 m0, s19, 117120
    v_mfma_f32_16x16x32_bf16 v[64:67], v[40:43], a[148:151], v[64:67]
    buffer_load_dwordx4 v2, s[8:11], s20 offen offset:1664 lds
    s_waitcnt lgkmcnt(6)
    v_mfma_f32_16x16x32_bf16 v[52:55], v[44:47], a[152:155], v[52:55]
    ds_read_b128 v[40:43], v10 offset:47104
    v_mfma_f32_16x16x32_bf16 v[60:63], v[44:47], a[156:159], v[60:63]
    s_waitcnt lgkmcnt(6)
    v_mfma_f32_16x16x32_bf16 v[56:59], v[48:51], a[152:155], v[56:59]
    ds_read_b128 v[44:47], v11 offset:45056
    s_add_u32 m0, s19, 121088
    v_mfma_f32_16x16x32_bf16 v[64:67], v[48:51], a[156:159], v[64:67]
    buffer_load_dwordx4 v2, s[8:11], s20 offen offset:1792 lds
    s_waitcnt lgkmcnt(6)
    v_mfma_f32_16x16x32_bf16 v[52:55], v[20:23], a[160:163], v[52:55]
    ds_read_b128 v[48:51], v11 offset:47104
    v_mfma_f32_16x16x32_bf16 v[60:63], v[20:23], a[164:167], v[60:63]
    s_waitcnt lgkmcnt(6)
    v_mfma_f32_16x16x32_bf16 v[56:59], v[24:27], a[160:163], v[56:59]
    ds_read_b128 v[20:23], v10 offset:49152
    s_add_u32 m0, s19, 125056
    v_mfma_f32_16x16x32_bf16 v[64:67], v[24:27], a[164:167], v[64:67]
    buffer_load_dwordx4 v2, s[8:11], s20 offen offset:1920 lds
    s_waitcnt lgkmcnt(6)
    v_mfma_f32_16x16x32_bf16 v[52:55], v[28:31], a[168:171], v[52:55]
    ds_read_b128 v[24:27], v10 offset:51200
    v_mfma_f32_16x16x32_bf16 v[60:63], v[28:31], a[172:175], v[60:63]
    s_add_u32 s20, s20, s24
    s_waitcnt lgkmcnt(6)
    v_mfma_f32_16x16x32_bf16 v[56:59], v[32:35], a[168:171], v[56:59]
    ds_read_b128 v[28:31], v11 offset:49152
    v_mfma_f32_16x16x32_bf16 v[64:67], v[32:35], a[172:175], v[64:67]
    s_waitcnt lgkmcnt(6)
    v_mfma_f32_16x16x32_bf16 v[52:55], v[36:39], a[176:179], v[52:55]
    ds_read_b128 v[32:35], v11 offset:51200
    v_mfma_f32_16x16x32_bf16 v[60:63], v[36:39], a[180:183], v[60:63]
    s_waitcnt lgkmcnt(6)
    v_mfma_f32_16x16x32_bf16 v[56:59], v[40:43], a[176:179], v[56:59]
    ds_read_b128 v[36:39], v10 offset:53248
    v_mfma_f32_16x16x32_bf16 v[64:67], v[40:43], a[180:183], v[64:67]
    s_waitcnt lgkmcnt(6)
    v_mfma_f32_16x16x32_bf16 v[52:55], v[44:47], a[184:187], v[52:55]
    ds_read_b128 v[40:43], v10 offset:55296
    v_mfma_f32_16x16x32_bf16 v[60:63], v[44:47], a[188:191], v[60:63]
    s_waitcnt lgkmcnt(6)
    v_mfma_f32_16x16x32_bf16 v[56:59], v[48:51], a[184:187], v[56:59]
    ds_read_b128 v[44:47], v11 offset:53248
    v_mfma_f32_16x16x32_bf16 v[64:67], v[48:51], a[188:191], v[64:67]
    s_waitcnt lgkmcnt(6)
    v_mfma_f32_16x16x32_bf16 v[52:55], v[20:23], a[192:195], v[52:55]
    ds_read_b128 v[48:51], v11 offset:55296
    v_mfma_f32_16x16x32_bf16 v[60:63], v[20:23], a[196:199], v[60:63]
    s_waitcnt lgkmcnt(6)
    v_mfma_f32_16x16x32_bf16 v[56:59], v[24:27], a[192:195], v[56:59]
    ds_read_b128 v[20:23], v10 offset:57344
    v_mfma_f32_16x16x32_bf16 v[64:67], v[24:27], a[196:199], v[64:67]
    s_waitcnt lgkmcnt(6)
    v_mfma_f32_16x16x32_bf16 v[52:55], v[28:31], a[200:203], v[52:55]
    ds_read_b128 v[24:27], v10 offset:59392
    v_mfma_f32_16x16x32_bf16 v[60:63], v[28:31], a[204:207], v[60:63]
    s_waitcnt lgkmcnt(6)
    v_mfma_f32_16x16x32_bf16 v[56:59], v[32:35], a[200:203], v[56:59]
    ds_read_b128 v[28:31], v11 offset:57344
    v_mfma_f32_16x16x32_bf16 v[64:67], v[32:35], a[204:207], v[64:67]
    s_waitcnt lgkmcnt(6)
    v_mfma_f32_16x16x32_bf16 v[52:55], v[36:39], a[208:211], v[52:55]
    ds_read_b128 v[32:35], v11 offset:59392
    v_mfma_f32_16x16x32_bf16 v[60:63], v[36:39], a[212:215], v[60:63]
    s_waitcnt lgkmcnt(6)
    v_mfma_f32_16x16x32_bf16 v[56:59], v[40:43], a[208:211], v[56:59]
    ds_read_b128 v[36:39], v10 offset:61440
    v_mfma_f32_16x16x32_bf16 v[64:67], v[40:43], a[212:215], v[64:67]
    s_waitcnt lgkmcnt(6)
    v_mfma_f32_16x16x32_bf16 v[52:55], v[44:47], a[216:219], v[52:55]
    ds_read_b128 v[40:43], v10 offset:63488
    v_mfma_f32_16x16x32_bf16 v[60:63], v[44:47], a[220:223], v[60:63]
    s_waitcnt lgkmcnt(6)
    v_mfma_f32_16x16x32_bf16 v[56:59], v[48:51], a[216:219], v[56:59]
    ds_read_b128 v[44:47], v11 offset:61440
    v_mfma_f32_16x16x32_bf16 v[64:67], v[48:51], a[220:223], v[64:67]
    s_waitcnt lgkmcnt(6)
    v_mfma_f32_16x16x32_bf16 v[52:55], v[20:23], a[224:227], v[52:55]
    ds_read_b128 v[48:51], v11 offset:63488
    v_mfma_f32_16x16x32_bf16 v[60:63], v[20:23], a[228:231], v[60:63]
    s_waitcnt lgkmcnt(6)
    v_mfma_f32_16x16x32_bf16 v[56:59], v[24:27], a[224:227], v[56:59]
    s_waitcnt vmcnt(8)
    s_barrier
    ds_read_b128 v[20:23], v12 offset:0
    v_mfma_f32_16x16x32_bf16 v[64:67], v[24:27], a[228:231], v[64:67]
    s_waitcnt lgkmcnt(6)
    v_mfma_f32_16x16x32_bf16 v[52:55], v[28:31], a[232:235], v[52:55]
    ds_read_b128 v[24:27], v12 offset:2048
    s_add_u32 m0, s19, 0
    v_mfma_f32_16x16x32_bf16 v[60:63], v[28:31], a[236:239], v[60:63]
    buffer_load_dwordx4 v2, s[8:11], s20 offen offset:0 lds
    s_waitcnt lgkmcnt(6)
    v_mfma_f32_16x16x32_bf16 v[56:59], v[32:35], a[232:235], v[56:59]
    ds_read_b128 v[28:31], v13 offset:0
    v_mfma_f32_16x16x32_bf16 v[64:67], v[32:35], a[236:239], v[64:67]
    s_waitcnt lgkmcnt(6)
    v_mfma_f32_16x16x32_bf16 v[52:55], v[36:39], a[240:243], v[52:55]
    ds_read_b128 v[32:35], v13 offset:2048
    s_add_u32 m0, s19, 3968
    v_mfma_f32_16x16x32_bf16 v[60:63], v[36:39], a[244:247], v[60:63]
    buffer_load_dwordx4 v2, s[8:11], s20 offen offset:128 lds
    s_waitcnt lgkmcnt(6)
    v_mfma_f32_16x16x32_bf16 v[56:59], v[40:43], a[240:243], v[56:59]
    ds_read_b128 v[36:39], v12 offset:4096
    v_mfma_f32_16x16x32_bf16 v[64:67], v[40:43], a[244:247], v[64:67]
    s_waitcnt lgkmcnt(6)
    v_mfma_f32_16x16x32_bf16 v[52:55], v[44:47], a[248:251], v[52:55]
    ds_read_b128 v[40:43], v12 offset:6144
    s_add_u32 m0, s19, 7936
    v_mfma_f32_16x16x32_bf16 v[60:63], v[44:47], a[252:255], v[60:63]
    buffer_load_dwordx4 v2, s[8:11], s20 offen offset:256 lds
    s_waitcnt lgkmcnt(6)
    v_mfma_f32_16x16x32_bf16 v[56:59], v[48:51], a[248:251], v[56:59]
    ds_read_b128 v[44:47], v13 offset:4096
    v_mfma_f32_16x16x32_bf16 v[64:67], v[48:51], a[252:255], v[64:67]
    s_waitcnt lgkmcnt(6)
    v_mfma_f32_16x16x32_bf16 v[68:71], v[20:23], a[0:3], 0
    ds_read_b128 v[48:51], v13 offset:6144
    v_mfma_f32_16x16x32_bf16 v[76:79], v[20:23], a[4:7], 0
    s_waitcnt lgkmcnt(6)
    v_mfma_f32_16x16x32_bf16 v[72:75], v[24:27], a[0:3], 0
    ds_read_b128 v[20:23], v12 offset:8192
    s_add_u32 m0, s19, 11904
    v_mfma_f32_16x16x32_bf16 v[80:83], v[24:27], a[4:7], 0
    buffer_load_dwordx4 v2, s[8:11], s20 offen offset:384 lds
    s_waitcnt lgkmcnt(6)
    v_mfma_f32_16x16x32_bf16 v[68:71], v[28:31], a[8:11], v[68:71]
    ds_read_b128 v[24:27], v12 offset:10240
    v_mfma_f32_16x16x32_bf16 v[76:79], v[28:31], a[12:15], v[76:79]
    s_waitcnt lgkmcnt(6)
    v_mfma_f32_16x16x32_bf16 v[72:75], v[32:35], a[8:11], v[72:75]
    ds_read_b128 v[28:31], v13 offset:8192
    s_add_u32 m0, s19, 15872
    v_mfma_f32_16x16x32_bf16 v[80:83], v[32:35], a[12:15], v[80:83]
    buffer_load_dwordx4 v2, s[8:11], s20 offen offset:512 lds
    s_waitcnt lgkmcnt(6)
    v_mfma_f32_16x16x32_bf16 v[68:71], v[36:39], a[16:19], v[68:71]
    ds_read_b128 v[32:35], v13 offset:10240
    v_mfma_f32_16x16x32_bf16 v[76:79], v[36:39], a[20:23], v[76:79]
    s_waitcnt lgkmcnt(6)
    v_mfma_f32_16x16x32_bf16 v[72:75], v[40:43], a[16:19], v[72:75]
    ds_read_b128 v[36:39], v12 offset:12288
    s_add_u32 m0, s19, 19840
    v_mfma_f32_16x16x32_bf16 v[80:83], v[40:43], a[20:23], v[80:83]
    buffer_load_dwordx4 v2, s[8:11], s20 offen offset:640 lds
    s_waitcnt lgkmcnt(6)
    v_mfma_f32_16x16x32_bf16 v[68:71], v[44:47], a[24:27], v[68:71]
    ds_read_b128 v[40:43], v12 offset:14336
    v_mfma_f32_16x16x32_bf16 v[76:79], v[44:47], a[28:31], v[76:79]
    s_waitcnt lgkmcnt(6)
    v_mfma_f32_16x16x32_bf16 v[72:75], v[48:51], a[24:27], v[72:75]
    ds_read_b128 v[44:47], v13 offset:12288
    s_add_u32 m0, s19, 23808
    v_mfma_f32_16x16x32_bf16 v[80:83], v[48:51], a[28:31], v[80:83]
    buffer_load_dwordx4 v2, s[8:11], s20 offen offset:768 lds
    s_waitcnt lgkmcnt(6)
    v_mfma_f32_16x16x32_bf16 v[68:71], v[20:23], a[32:35], v[68:71]
    ds_read_b128 v[48:51], v13 offset:14336
    v_mfma_f32_16x16x32_bf16 v[76:79], v[20:23], a[36:39], v[76:79]
    s_waitcnt lgkmcnt(6)
    v_mfma_f32_16x16x32_bf16 v[72:75], v[24:27], a[32:35], v[72:75]
    ds_read_b128 v[20:23], v12 offset:16384
    s_add_u32 m0, s19, 27776
    v_mfma_f32_16x16x32_bf16 v[80:83], v[24:27], a[36:39], v[80:83]
    buffer_load_dwordx4 v2, s[8:11], s20 offen offset:896 lds
    s_waitcnt lgkmcnt(6)
    v_mfma_f32_16x16x32_bf16 v[68:71], v[28:31], a[40:43], v[68:71]
    ds_read_b128 v[24:27], v12 offset:18432
    v_mfma_f32_16x16x32_bf16 v[76:79], v[28:31], a[44:47], v[76:79]
    v_cvt_pk_bf16_f32 v84, v52, v53
    s_waitcnt lgkmcnt(6)
    v_mfma_f32_16x16x32_bf16 v[72:75], v[32:35], a[40:43], v[72:75]
    ds_read_b128 v[28:31], v13 offset:16384
    v_mfma_f32_16x16x32_bf16 v[80:83], v[32:35], a[44:47], v[80:83]
    v_cvt_pk_bf16_f32 v85, v54, v55
    s_waitcnt lgkmcnt(6)
    v_mfma_f32_16x16x32_bf16 v[68:71], v[36:39], a[48:51], v[68:71]
    ds_read_b128 v[32:35], v13 offset:18432
    v_mfma_f32_16x16x32_bf16 v[76:79], v[36:39], a[52:55], v[76:79]
    v_cvt_pk_bf16_f32 v86, v56, v57
    s_waitcnt lgkmcnt(6)
    v_mfma_f32_16x16x32_bf16 v[72:75], v[40:43], a[48:51], v[72:75]
    ds_read_b128 v[36:39], v12 offset:20480
    v_mfma_f32_16x16x32_bf16 v[80:83], v[40:43], a[52:55], v[80:83]
    v_cvt_pk_bf16_f32 v87, v58, v59
    s_waitcnt lgkmcnt(6)
    v_mfma_f32_16x16x32_bf16 v[68:71], v[44:47], a[56:59], v[68:71]
    ds_read_b128 v[40:43], v12 offset:22528
    v_mfma_f32_16x16x32_bf16 v[76:79], v[44:47], a[60:63], v[76:79]
    v_cvt_pk_bf16_f32 v88, v60, v61
    s_waitcnt lgkmcnt(6)
    v_mfma_f32_16x16x32_bf16 v[72:75], v[48:51], a[56:59], v[72:75]
    ds_read_b128 v[44:47], v13 offset:20480
    v_mfma_f32_16x16x32_bf16 v[80:83], v[48:51], a[60:63], v[80:83]
    v_cvt_pk_bf16_f32 v89, v62, v63
    buffer_store_dwordx4 v[84:87], v3, s[4:7], s21 offen offset:0 sc1
    s_waitcnt lgkmcnt(6)
    v_mfma_f32_16x16x32_bf16 v[68:71], v[20:23], a[64:67], v[68:71]
    ds_read_b128 v[48:51], v13 offset:22528
    v_mfma_f32_16x16x32_bf16 v[76:79], v[20:23], a[68:71], v[76:79]
    v_cvt_pk_bf16_f32 v90, v64, v65
    s_waitcnt lgkmcnt(6)
    v_mfma_f32_16x16x32_bf16 v[72:75], v[24:27], a[64:67], v[72:75]
    ds_read_b128 v[20:23], v12 offset:24576
    v_mfma_f32_16x16x32_bf16 v[80:83], v[24:27], a[68:71], v[80:83]
    v_cvt_pk_bf16_f32 v91, v66, v67
    s_waitcnt lgkmcnt(6)
    v_mfma_f32_16x16x32_bf16 v[68:71], v[28:31], a[72:75], v[68:71]
    ds_read_b128 v[24:27], v12 offset:26624
    v_mfma_f32_16x16x32_bf16 v[76:79], v[28:31], a[76:79], v[76:79]
    s_waitcnt lgkmcnt(6)
    v_mfma_f32_16x16x32_bf16 v[72:75], v[32:35], a[72:75], v[72:75]
    ds_read_b128 v[28:31], v13 offset:24576
    v_mfma_f32_16x16x32_bf16 v[80:83], v[32:35], a[76:79], v[80:83]
    buffer_store_dwordx4 v[88:91], v3, s[4:7], s21 offen offset:256 sc1
    s_waitcnt lgkmcnt(6)
    v_mfma_f32_16x16x32_bf16 v[68:71], v[36:39], a[80:83], v[68:71]
    ds_read_b128 v[32:35], v13 offset:26624
    v_mfma_f32_16x16x32_bf16 v[76:79], v[36:39], a[84:87], v[76:79]
    s_add_u32 s21, s21, s25
    s_mov_b32 s25, s26
    s_waitcnt lgkmcnt(6)
    v_mfma_f32_16x16x32_bf16 v[72:75], v[40:43], a[80:83], v[72:75]
    ds_read_b128 v[36:39], v12 offset:28672
    v_mfma_f32_16x16x32_bf16 v[80:83], v[40:43], a[84:87], v[80:83]
    s_waitcnt lgkmcnt(6)
    v_mfma_f32_16x16x32_bf16 v[68:71], v[44:47], a[88:91], v[68:71]
    ds_read_b128 v[40:43], v12 offset:30720
    v_mfma_f32_16x16x32_bf16 v[76:79], v[44:47], a[92:95], v[76:79]
    s_waitcnt lgkmcnt(6)
    v_mfma_f32_16x16x32_bf16 v[72:75], v[48:51], a[88:91], v[72:75]
    ds_read_b128 v[44:47], v13 offset:28672
    v_mfma_f32_16x16x32_bf16 v[80:83], v[48:51], a[92:95], v[80:83]
    s_waitcnt lgkmcnt(6)
    v_mfma_f32_16x16x32_bf16 v[68:71], v[20:23], a[96:99], v[68:71]
    ds_read_b128 v[48:51], v13 offset:30720
    v_mfma_f32_16x16x32_bf16 v[76:79], v[20:23], a[100:103], v[76:79]
    s_waitcnt lgkmcnt(6)
    v_mfma_f32_16x16x32_bf16 v[72:75], v[24:27], a[96:99], v[72:75]
    s_waitcnt vmcnt(10)
    s_barrier
    ds_read_b128 v[20:23], v12 offset:32768
    v_mfma_f32_16x16x32_bf16 v[80:83], v[24:27], a[100:103], v[80:83]
    s_waitcnt lgkmcnt(6)
    v_mfma_f32_16x16x32_bf16 v[68:71], v[28:31], a[104:107], v[68:71]
    ds_read_b128 v[24:27], v12 offset:34816
    s_add_u32 m0, s19, 31744
    v_mfma_f32_16x16x32_bf16 v[76:79], v[28:31], a[108:111], v[76:79]
    buffer_load_dwordx4 v2, s[8:11], s20 offen offset:1024 lds
    s_waitcnt lgkmcnt(6)
    v_mfma_f32_16x16x32_bf16 v[72:75], v[32:35], a[104:107], v[72:75]
    ds_read_b128 v[28:31], v13 offset:32768
    v_mfma_f32_16x16x32_bf16 v[80:83], v[32:35], a[108:111], v[80:83]
    s_waitcnt lgkmcnt(6)
    v_mfma_f32_16x16x32_bf16 v[68:71], v[36:39], a[112:115], v[68:71]
    ds_read_b128 v[32:35], v13 offset:34816
    s_add_u32 m0, s19, 35712
    v_mfma_f32_16x16x32_bf16 v[76:79], v[36:39], a[116:119], v[76:79]
    buffer_load_dwordx4 v2, s[8:11], s20 offen offset:1152 lds
    s_waitcnt lgkmcnt(6)
    v_mfma_f32_16x16x32_bf16 v[72:75], v[40:43], a[112:115], v[72:75]
    ds_read_b128 v[36:39], v12 offset:36864
    v_mfma_f32_16x16x32_bf16 v[80:83], v[40:43], a[116:119], v[80:83]
    s_waitcnt lgkmcnt(6)
    v_mfma_f32_16x16x32_bf16 v[68:71], v[44:47], a[120:123], v[68:71]
    ds_read_b128 v[40:43], v12 offset:38912
    s_add_u32 m0, s19, 39680
    v_mfma_f32_16x16x32_bf16 v[76:79], v[44:47], a[124:127], v[76:79]
    buffer_load_dwordx4 v2, s[8:11], s20 offen offset:1280 lds
    s_waitcnt lgkmcnt(6)
    v_mfma_f32_16x16x32_bf16 v[72:75], v[48:51], a[120:123], v[72:75]
    ds_read_b128 v[44:47], v13 offset:36864
    v_mfma_f32_16x16x32_bf16 v[80:83], v[48:51], a[124:127], v[80:83]
    s_waitcnt lgkmcnt(6)
    v_mfma_f32_16x16x32_bf16 v[68:71], v[20:23], a[128:131], v[68:71]
    ds_read_b128 v[48:51], v13 offset:38912
    v_mfma_f32_16x16x32_bf16 v[76:79], v[20:23], a[132:135], v[76:79]
    s_waitcnt lgkmcnt(6)
    v_mfma_f32_16x16x32_bf16 v[72:75], v[24:27], a[128:131], v[72:75]
    ds_read_b128 v[20:23], v12 offset:40960
    s_add_u32 m0, s19, 43648
    v_mfma_f32_16x16x32_bf16 v[80:83], v[24:27], a[132:135], v[80:83]
    buffer_load_dwordx4 v2, s[8:11], s20 offen offset:1408 lds
    s_waitcnt lgkmcnt(6)
    v_mfma_f32_16x16x32_bf16 v[68:71], v[28:31], a[136:139], v[68:71]
    ds_read_b128 v[24:27], v12 offset:43008
    v_mfma_f32_16x16x32_bf16 v[76:79], v[28:31], a[140:143], v[76:79]
    s_waitcnt lgkmcnt(6)
    v_mfma_f32_16x16x32_bf16 v[72:75], v[32:35], a[136:139], v[72:75]
    ds_read_b128 v[28:31], v13 offset:40960
    s_add_u32 m0, s19, 47616
    v_mfma_f32_16x16x32_bf16 v[80:83], v[32:35], a[140:143], v[80:83]
    buffer_load_dwordx4 v2, s[8:11], s20 offen offset:1536 lds
    s_waitcnt lgkmcnt(6)
    v_mfma_f32_16x16x32_bf16 v[68:71], v[36:39], a[144:147], v[68:71]
    ds_read_b128 v[32:35], v13 offset:43008
    v_mfma_f32_16x16x32_bf16 v[76:79], v[36:39], a[148:151], v[76:79]
    s_waitcnt lgkmcnt(6)
    v_mfma_f32_16x16x32_bf16 v[72:75], v[40:43], a[144:147], v[72:75]
    ds_read_b128 v[36:39], v12 offset:45056
    s_add_u32 m0, s19, 51584
    v_mfma_f32_16x16x32_bf16 v[80:83], v[40:43], a[148:151], v[80:83]
    buffer_load_dwordx4 v2, s[8:11], s20 offen offset:1664 lds
    s_waitcnt lgkmcnt(6)
    v_mfma_f32_16x16x32_bf16 v[68:71], v[44:47], a[152:155], v[68:71]
    ds_read_b128 v[40:43], v12 offset:47104
    v_mfma_f32_16x16x32_bf16 v[76:79], v[44:47], a[156:159], v[76:79]
    s_waitcnt lgkmcnt(6)
    v_mfma_f32_16x16x32_bf16 v[72:75], v[48:51], a[152:155], v[72:75]
    ds_read_b128 v[44:47], v13 offset:45056
    s_add_u32 m0, s19, 55552
    v_mfma_f32_16x16x32_bf16 v[80:83], v[48:51], a[156:159], v[80:83]
    buffer_load_dwordx4 v2, s[8:11], s20 offen offset:1792 lds
    s_waitcnt lgkmcnt(6)
    v_mfma_f32_16x16x32_bf16 v[68:71], v[20:23], a[160:163], v[68:71]
    ds_read_b128 v[48:51], v13 offset:47104
    v_mfma_f32_16x16x32_bf16 v[76:79], v[20:23], a[164:167], v[76:79]
    s_waitcnt lgkmcnt(6)
    v_mfma_f32_16x16x32_bf16 v[72:75], v[24:27], a[160:163], v[72:75]
    ds_read_b128 v[20:23], v12 offset:49152
    s_add_u32 m0, s19, 59520
    v_mfma_f32_16x16x32_bf16 v[80:83], v[24:27], a[164:167], v[80:83]
    buffer_load_dwordx4 v2, s[8:11], s20 offen offset:1920 lds
    s_waitcnt lgkmcnt(6)
    v_mfma_f32_16x16x32_bf16 v[68:71], v[28:31], a[168:171], v[68:71]
    ds_read_b128 v[24:27], v12 offset:51200
    v_mfma_f32_16x16x32_bf16 v[76:79], v[28:31], a[172:175], v[76:79]
    s_add_u32 s20, s20, s24
    s_waitcnt lgkmcnt(6)
    v_mfma_f32_16x16x32_bf16 v[72:75], v[32:35], a[168:171], v[72:75]
    ds_read_b128 v[28:31], v13 offset:49152
    v_mfma_f32_16x16x32_bf16 v[80:83], v[32:35], a[172:175], v[80:83]
    s_waitcnt lgkmcnt(6)
    v_mfma_f32_16x16x32_bf16 v[68:71], v[36:39], a[176:179], v[68:71]
    ds_read_b128 v[32:35], v13 offset:51200
    v_mfma_f32_16x16x32_bf16 v[76:79], v[36:39], a[180:183], v[76:79]
    s_waitcnt lgkmcnt(6)
    v_mfma_f32_16x16x32_bf16 v[72:75], v[40:43], a[176:179], v[72:75]
    ds_read_b128 v[36:39], v12 offset:53248
    v_mfma_f32_16x16x32_bf16 v[80:83], v[40:43], a[180:183], v[80:83]
    s_waitcnt lgkmcnt(6)
    v_mfma_f32_16x16x32_bf16 v[68:71], v[44:47], a[184:187], v[68:71]
    ds_read_b128 v[40:43], v12 offset:55296
    v_mfma_f32_16x16x32_bf16 v[76:79], v[44:47], a[188:191], v[76:79]
    s_waitcnt lgkmcnt(6)
    v_mfma_f32_16x16x32_bf16 v[72:75], v[48:51], a[184:187], v[72:75]
    ds_read_b128 v[44:47], v13 offset:53248
    v_mfma_f32_16x16x32_bf16 v[80:83], v[48:51], a[188:191], v[80:83]
    s_waitcnt lgkmcnt(6)
    v_mfma_f32_16x16x32_bf16 v[68:71], v[20:23], a[192:195], v[68:71]
    ds_read_b128 v[48:51], v13 offset:55296
    v_mfma_f32_16x16x32_bf16 v[76:79], v[20:23], a[196:199], v[76:79]
    s_waitcnt lgkmcnt(6)
    v_mfma_f32_16x16x32_bf16 v[72:75], v[24:27], a[192:195], v[72:75]
    ds_read_b128 v[20:23], v12 offset:57344
    v_mfma_f32_16x16x32_bf16 v[80:83], v[24:27], a[196:199], v[80:83]
    s_waitcnt lgkmcnt(6)
    v_mfma_f32_16x16x32_bf16 v[68:71], v[28:31], a[200:203], v[68:71]
    ds_read_b128 v[24:27], v12 offset:59392
    v_mfma_f32_16x16x32_bf16 v[76:79], v[28:31], a[204:207], v[76:79]
    s_waitcnt lgkmcnt(6)
    v_mfma_f32_16x16x32_bf16 v[72:75], v[32:35], a[200:203], v[72:75]
    ds_read_b128 v[28:31], v13 offset:57344
    v_mfma_f32_16x16x32_bf16 v[80:83], v[32:35], a[204:207], v[80:83]
    s_waitcnt lgkmcnt(6)
    v_mfma_f32_16x16x32_bf16 v[68:71], v[36:39], a[208:211], v[68:71]
    ds_read_b128 v[32:35], v13 offset:59392
    v_mfma_f32_16x16x32_bf16 v[76:79], v[36:39], a[212:215], v[76:79]
    s_waitcnt lgkmcnt(6)
    v_mfma_f32_16x16x32_bf16 v[72:75], v[40:43], a[208:211], v[72:75]
    ds_read_b128 v[36:39], v12 offset:61440
    v_mfma_f32_16x16x32_bf16 v[80:83], v[40:43], a[212:215], v[80:83]
    s_waitcnt lgkmcnt(6)
    v_mfma_f32_16x16x32_bf16 v[68:71], v[44:47], a[216:219], v[68:71]
    ds_read_b128 v[40:43], v12 offset:63488
    v_mfma_f32_16x16x32_bf16 v[76:79], v[44:47], a[220:223], v[76:79]
    s_waitcnt lgkmcnt(6)
    v_mfma_f32_16x16x32_bf16 v[72:75], v[48:51], a[216:219], v[72:75]
    ds_read_b128 v[44:47], v13 offset:61440
    v_mfma_f32_16x16x32_bf16 v[80:83], v[48:51], a[220:223], v[80:83]
    s_waitcnt lgkmcnt(6)
    v_mfma_f32_16x16x32_bf16 v[68:71], v[20:23], a[224:227], v[68:71]
    ds_read_b128 v[48:51], v13 offset:63488
    v_mfma_f32_16x16x32_bf16 v[76:79], v[20:23], a[228:231], v[76:79]
    s_waitcnt lgkmcnt(6)
    v_mfma_f32_16x16x32_bf16 v[72:75], v[24:27], a[224:227], v[72:75]
    s_waitcnt vmcnt(8)
    s_barrier
    ds_read_b128 v[20:23], v10 offset:0
    v_mfma_f32_16x16x32_bf16 v[80:83], v[24:27], a[228:231], v[80:83]
    s_waitcnt lgkmcnt(6)
    v_mfma_f32_16x16x32_bf16 v[68:71], v[28:31], a[232:235], v[68:71]
    ds_read_b128 v[24:27], v10 offset:2048
    s_add_u32 m0, s19, 65536
    v_mfma_f32_16x16x32_bf16 v[76:79], v[28:31], a[236:239], v[76:79]
    buffer_load_dwordx4 v2, s[8:11], s20 offen offset:0 lds
    s_waitcnt lgkmcnt(6)
    v_mfma_f32_16x16x32_bf16 v[72:75], v[32:35], a[232:235], v[72:75]
    ds_read_b128 v[28:31], v11 offset:0
    v_mfma_f32_16x16x32_bf16 v[80:83], v[32:35], a[236:239], v[80:83]
    s_waitcnt lgkmcnt(6)
    v_mfma_f32_16x16x32_bf16 v[68:71], v[36:39], a[240:243], v[68:71]
    ds_read_b128 v[32:35], v11 offset:2048
    s_add_u32 m0, s19, 69504
    v_mfma_f32_16x16x32_bf16 v[76:79], v[36:39], a[244:247], v[76:79]
    buffer_load_dwordx4 v2, s[8:11], s20 offen offset:128 lds
    s_waitcnt lgkmcnt(6)
    v_mfma_f32_16x16x32_bf16 v[72:75], v[40:43], a[240:243], v[72:75]
    ds_read_b128 v[36:39], v10 offset:4096
    v_mfma_f32_16x16x32_bf16 v[80:83], v[40:43], a[244:247], v[80:83]
    s_waitcnt lgkmcnt(6)
    v_mfma_f32_16x16x32_bf16 v[68:71], v[44:47], a[248:251], v[68:71]
    ds_read_b128 v[40:43], v10 offset:6144
    s_add_u32 m0, s19, 73472
    v_mfma_f32_16x16x32_bf16 v[76:79], v[44:47], a[252:255], v[76:79]
    buffer_load_dwordx4 v2, s[8:11], s20 offen offset:256 lds
    s_waitcnt lgkmcnt(6)
    v_mfma_f32_16x16x32_bf16 v[72:75], v[48:51], a[248:251], v[72:75]
    ds_read_b128 v[44:47], v11 offset:4096
    v_mfma_f32_16x16x32_bf16 v[80:83], v[48:51], a[252:255], v[80:83]
    s_add_u32 s22, s22, 2
    s_cmp_lt_u32 s22, 16
    s_cbranch_scc1 F1_top
    v_cvt_pk_bf16_f32 v84, v68, v69
    v_cvt_pk_bf16_f32 v85, v70, v71
    s_nop 0
    v_cvt_pk_bf16_f32 v86, v72, v73
    v_cvt_pk_bf16_f32 v87, v74, v75
    v_cvt_pk_bf16_f32 v88, v76, v77
    v_cvt_pk_bf16_f32 v89, v78, v79
    v_cvt_pk_bf16_f32 v90, v80, v81
    v_cvt_pk_bf16_f32 v91, v82, v83
    buffer_store_dwordx4 v[84:87], v3, s[4:7], s21 offen offset:0 sc1
    buffer_store_dwordx4 v[88:91], v3, s[4:7], s21 offen offset:256 sc1
    s_waitcnt vmcnt(0) lgkmcnt(0)
    v_lshlrev_b32 v5, 2, v1
    s_mov_b32 s18, 0
rdv_17:
    global_load_dword v6, v5, s[100:101] sc1
    s_lshl_b32 s17, s98, 2
    s_waitcnt vmcnt(0)
    v_lshrrev_b32 v9, s17, v6
    s_cmp_eq_u32 s98, 0
    s_cselect_b32 s17, 0x0f0f0f0f, s17
    s_cselect_b32 s17, s17, 0x01010101
    v_and_b32 v9, s17, v9
    v_cmp_ne_u32 vcc, 0x01010101, v9
    s_nop 0
    s_cbranch_vccz rdvok_18
    v_sad_u8 v9, v9, 0, 0
    s_nop 1
    v_add_u32_dpp v9, v9, v9 quad_perm:[1,0,3,2] row_mask:0xf bank_mask:0xf
    v_cmp_ne_u32 vcc, 8, v9
    s_nop 0
    s_cbranch_vccnz rdvw_19
    s_mov_b32 s98, 1
    s_and_b32 s3, s97, 7
    s_barrier
    s_branch role_start
rdvw_19:
    s_sleep 4
    s_add_u32 s18, s18, 1
    s_cmp_lt_u32 s18, 262144
    s_cbranch_scc1 rdv_17
    s_mov_b32 s92, 1048576
rdvok_18:
    s_barrier
    s_lshl_b32 s31, s29, 2
    s_add_u32 s31, s31, s28
    s_lshl_b32 s17, s31, 7
    s_add_u32 s17, s17, 100745216
    v_lshl_add_u32 v5, v1, 2, s17
    v_mov_b32 v6, 1
    s_mov_b64 exec, 0xffffffff
    buffer_store_dword v6, v5, s[4:7], 0 offen sc1
    s_mov_b64 exec, -1
    v_and_b32 v10, 19, v1
    v_bfe_u32 v5, v1, 2, 1
    v_bfe_u32 v6, v1, 3, 1
    v_lshl_add_u32 v10, v5, 3, v10
    v_lshl_add_u32 v10, v6, 2, v10
    s_load_dwordx2 s[8:9], s[0:1], 8
    s_load_dwordx2 s[12:13], s[0:1], 16
    s_mov_b32 s10, 2101248
    s_mov_b32 s11, 0x20000
    s_mov_b32 s14, 2101248
    s_mov_b32 s15, 0x20000
    v_lshrrev_b32 v11, 5, v1
    v_lshl_add_u32 v12, v11, 9, v10
    v_mul_u32_u24 v12, 1026, v12
    v_and_b32 v13, 1, v1
    v_lshlrev_b32 v13, 4, v13
    v_lshlrev_b32 v14, 4, v1
    s_lshr_b32 s17, s16, 1
    s_and_b32 s18, s16, 1
    s_lshl_b32 s17, s17, 5
    s_lshl_b32 s18, s18, 10
    s_add_u32 s17, s17, s18
    s_mul_i32 s20, s17, 1026
    s_lshl_b32 s17, s93, 5
    s_add_u32 s20, s20, s17
    s_lshl_b32 s21, s93, 17
    s_lshl_b32 s17, s16, 11
    s_add_u32 s21, s21, s17
    s_add_u32 s21, s21, 117440512
    v_and_b32 v7, -4, v12
    s_mov_b32 s32, 0x05040100
    s_mov_b32 s33, 0x07060302
    s_waitcnt lgkmcnt(0)
    buffer_load_dwordx4 v[20:23], v7, s[8:11], s20 offen
    buffer_load_dwordx4 v[24:27], v7, s[8:11], s20 offen offset:16
    buffer_load_dword v28, v7, s[8:11], s20 offen offset:32
    buffer_load_dwordx4 v[30:33], v7, s[12:15], s20 offen
    buffer_load_dwordx4 v[34:37], v7, s[12:15], s20 offen offset:16
    buffer_load_dword v38, v7, s[12:15], s20 offen offset:32
    s_add_u32 s20, s20, 65664
    buffer_load_dwordx4 v[40:43], v7, s[8:11], s20 offen
    buffer_load_dwordx4 v[44:47], v7, s[8:11], s20 offen offset:16
    buffer_load_dword v48, v7, s[8:11], s20 offen offset:32
    buffer_load_dwordx4 v[50:53], v7, s[12:15], s20 offen
    buffer_load_dwordx4 v[54:57], v7, s[12:15], s20 offen offset:16
    buffer_load_dword v58, v7, s[12:15], s20 offen offset:32
    s_add_u32 s20, s20, 65664
    buffer_load_dwordx4 v[60:63], v7, s[8:11], s20 offen
    buffer_load_dwordx4 v[64:67], v7, s[8:11], s20 offen offset:16
    buffer_load_dword v68, v7, s[8:11], s20 offen offset:32
    buffer_load_dwordx4 v[70:73], v7, s[12:15], s20 offen
    buffer_load_dwordx4 v[74:77], v7, s[12:15], s20 offen offset:16
    buffer_load_dword v78, v7, s[12:15], s20 offen offset:32
    s_add_u32 s20, s20, 65664
    buffer_load_dwordx4 v[80:83], v7, s[8:11], s20 offen
    buffer_load_dwordx4 v[84:87], v7, s[8:11], s20 offen offset:16
    buffer_load_dword v88, v7, s[8:11], s20 offen offset:32
    buffer_load_dwordx4 v[90:93], v7, s[12:15], s20 offen
    buffer_load_dwordx4 v[94:97], v7, s[12:15], s20 offen offset:16
    buffer_load_dword v98, v7, s[12:15], s20 offen offset:32
    s_add_u32 s20, s20, 65664
    s_waitcnt vmcnt(0)
    v_alignbit_b32 v20, v21, v20, v13
    v_alignbit_b32 v21, v22, v21, v13
    v_alignbit_b32 v22, v23, v22, v13
    v_alignbit_b32 v23, v24, v23, v13
    v_alignbit_b32 v24, v25, v24, v13
    v_alignbit_b32 v25, v26, v25, v13
    v_alignbit_b32 v26, v27, v26, v13
    v_alignbit_b32 v27, v28, v27, v13
    v_alignbit_b32 v30, v31, v30, v13
    v_alignbit_b32 v31, v32, v31, v13
    v_alignbit_b32 v32, v33, v32, v13
    v_alignbit_b32 v33, v34, v33, v13
    v_alignbit_b32 v34, v35, v34, v13
    v_alignbit_b32 v35, v36, v35, v13
    v_alignbit_b32 v36, v37, v36, v13
    v_alignbit_b32 v37, v38, v37, v13
    v_perm_b32 v100, v30, v20, s32
    v_perm_b32 v104, v30, v20, s33
    v_perm_b32 v108, v31, v21, s32
    v_perm_b32 v112, v31, v21, s33
    v_perm_b32 v116, v32, v22, s32
    v_perm_b32 v120, v32, v22, s33
    v_perm_b32 v124, v33, v23, s32
    v_perm_b32 v128, v33, v23, s33
    v_perm_b32 v132, v34, v24, s32
    v_perm_b32 v136, v34, v24, s33
    v_perm_b32 v140, v35, v25, s32
    v_perm_b32 v144, v35, v25, s33
    v_perm_b32 v148, v36, v26, s32
    v_perm_b32 v152, v36, v26, s33
    v_perm_b32 v156, v37, v27, s32
    v_perm_b32 v160, v37, v27, s33
    v_alignbit_b32 v40, v41, v40, v13
    v_alignbit_b32 v41, v42, v41, v13
    v_alignbit_b32 v42, v43, v42, v13
    v_alignbit_b32 v43, v44, v43, v13
    v_alignbit_b32 v44, v45, v44, v13
    v_alignbit_b32 v45, v46, v45, v13
    v_alignbit_b32 v46, v47, v46, v13
    v_alignbit_b32 v47, v48, v47, v13
    v_alignbit_b32 v50, v51, v50, v13
    v_alignbit_b32 v51, v52, v51, v13
    v_alignbit_b32 v52, v53, v52, v13
    v_alignbit_b32 v53, v54, v53, v13
    v_alignbit_b32 v54, v55, v54, v13
    v_alignbit_b32 v55, v56, v55, v13
    v_alignbit_b32 v56, v57, v56, v13
    v_alignbit_b32 v57, v58, v57, v13
    v_perm_b32 v101, v50, v40, s32
    v_perm_b32 v105, v50, v40, s33
    v_perm_b32 v109, v51, v41, s32
    v_perm_b32 v113, v51, v41, s33
    v_perm_b32 v117, v52, v42, s32
    v_perm_b32 v121, v52, v42, s33
    v_perm_b32 v125, v53, v43, s32
    v_perm_b32 v129, v53, v43, s33
    v_perm_b32 v133, v54, v44, s32
    v_perm_b32 v137, v54, v44, s33
    v_perm_b32 v141, v55, v45, s32
    v_perm_b32 v145, v55, v45, s33
    v_perm_b32 v149, v56, v46, s32
    v_perm_b32 v153, v56, v46, s33
    v_perm_b32 v157, v57, v47, s32
    v_perm_b32 v161, v57, v47, s33
    v_alignbit_b32 v60, v61, v60, v13
    v_alignbit_b32 v61, v62, v61, v13
    v_alignbit_b32 v62, v63, v62, v13
    v_alignbit_b32 v63, v64, v63, v13
    v_alignbit_b32 v64, v65, v64, v13
    v_alignbit_b32 v65, v66, v65, v13
    v_alignbit_b32 v66, v67, v66, v13
    v_alignbit_b32 v67, v68, v67, v13
    v_alignbit_b32 v70, v71, v70, v13
    v_alignbit_b32 v71, v72, v71, v13
    v_alignbit_b32 v72, v73, v72, v13
    v_alignbit_b32 v73, v74, v73, v13
    v_alignbit_b32 v74, v75, v74, v13
    v_alignbit_b32 v75, v76, v75, v13
    v_alignbit_b32 v76, v77, v76, v13
    v_alignbit_b32 v77, v78, v77, v13
    v_perm_b32 v102, v70, v60, s32
    v_perm_b32 v106, v70, v60, s33
    v_perm_b32 v110, v71, v61, s32
    v_perm_b32 v114, v71, v61, s33
    v_perm_b32 v118, v72, v62, s32
    v_perm_b32 v122, v72, v62, s33
    v_perm_b32 v126, v73, v63, s32
    v_perm_b32 v130, v73, v63, s33
    v_perm_b32 v134, v74, v64, s32
    v_perm_b32 v138, v74, v64, s33
    v_perm_b32 v142, v75, v65, s32
    v_perm_b32 v146, v75, v65, s33
    v_perm_b32 v150, v76, v66, s32
    v_perm_b32 v154, v76, v66, s33
    v_perm_b32 v158, v77, v67, s32
    v_perm_b32 v162, v77, v67, s33
    v_alignbit_b32 v80, v81, v80, v13
    v_alignbit_b32 v81, v82, v81, v13
    v_alignbit_b32 v82, v83, v82, v13
    v_alignbit_b32 v83, v84, v83, v13
    v_alignbit_b32 v84, v85, v84, v13
    v_alignbit_b32 v85, v86, v85, v13
    v_alignbit_b32 v86, v87, v86, v13
    v_alignbit_b32 v87, v88, v87, v13
    v_alignbit_b32 v90, v91, v90, v13
    v_alignbit_b32 v91, v92, v91, v13
    v_alignbit_b32 v92, v93, v92, v13
    v_alignbit_b32 v93, v94, v93, v13
    v_alignbit_b32 v94, v95, v94, v13
    v_alignbit_b32 v95, v96, v95, v13
    v_alignbit_b32 v96, v97, v96, v13
    v_alignbit_b32 v97, v98, v97, v13
    v_perm_b32 v103, v90, v80, s32
    v_perm_b32 v107, v90, v80, s33
    v_perm_b32 v111, v91, v81, s32
    v_perm_b32 v115, v91, v81, s33
    v_perm_b32 v119, v92, v82, s32
    v_perm_b32 v123, v92, v82, s33
    v_perm_b32 v127, v93, v83, s32
    v_perm_b32 v131, v93, v83, s33
    v_perm_b32 v135, v94, v84, s32
    v_perm_b32 v139, v94, v84, s33
    v_perm_b32 v143, v95, v85, s32
    v_perm_b32 v147, v95, v85, s33
    v_perm_b32 v151, v96, v86, s32
    v_perm_b32 v155, v96, v86, s33
    v_perm_b32 v159, v97, v87, s32
    v_perm_b32 v163, v97, v87, s33
    s_add_u32 s17, s21, 0
    buffer_store_dwordx4 v[100:103], v14, s[4:7], s17 offen
    s_add_u32 s17, s21, 8192
    buffer_store_dwordx4 v[104:107], v14, s[4:7], s17 offen
    s_add_u32 s17, s21, 16384
    buffer_store_dwordx4 v[108:111], v14, s[4:7], s17 offen
    s_add_u32 s17, s21, 24576
    buffer_store_dwordx4 v[112:115], v14, s[4:7], s17 offen
    s_add_u32 s17, s21, 32768
    buffer_store_dwordx4 v[116:119], v14, s[4:7], s17 offen
    s_add_u32 s17, s21, 40960
    buffer_store_dwordx4 v[120:123], v14, s[4:7], s17 offen
    s_add_u32 s17, s21, 49152
    buffer_store_dwordx4 v[124:127], v14, s[4:7], s17 offen
    s_add_u32 s17, s21, 57344
    buffer_store_dwordx4 v[128:131], v14, s[4:7], s17 offen
    s_add_u32 s17, s21, 65536
    buffer_store_dwordx4 v[132:135], v14, s[4:7], s17 offen
    s_add_u32 s17, s21, 73728
    buffer_store_dwordx4 v[136:139], v14, s[4:7], s17 offen
    s_add_u32 s17, s21, 81920
    buffer_store_dwordx4 v[140:143], v14, s[4:7], s17 offen
    s_add_u32 s17, s21, 90112
    buffer_store_dwordx4 v[144:147], v14, s[4:7], s17 offen
    s_add_u32 s17, s21, 98304
    buffer_store_dwordx4 v[148:151], v14, s[4:7], s17 offen
    s_add_u32 s17, s21, 106496
    buffer_store_dwordx4 v[152:155], v14, s[4:7], s17 offen
    s_add_u32 s17, s21, 114688
    buffer_store_dwordx4 v[156:159], v14, s[4:7], s17 offen
    s_add_u32 s17, s21, 122880
    buffer_store_dwordx4 v[160:163], v14, s[4:7], s17 offen
    buffer_load_dwordx4 v[20:23], v7, s[8:11], s20 offen
    buffer_load_dwordx4 v[24:27], v7, s[8:11], s20 offen offset:16
    buffer_load_dword v28, v7, s[8:11], s20 offen offset:32
    buffer_load_dwordx4 v[30:33], v7, s[12:15], s20 offen
    buffer_load_dwordx4 v[34:37], v7, s[12:15], s20 offen offset:16
    buffer_load_dword v38, v7, s[12:15], s20 offen offset:32
    s_add_u32 s20, s20, 65664
    buffer_load_dwordx4 v[40:43], v7, s[8:11], s20 offen
    buffer_load_dwordx4 v[44:47], v7, s[8:11], s20 offen offset:16
    buffer_load_dword v48, v7, s[8:11], s20 offen offset:32
    buffer_load_dwordx4 v[50:53], v7, s[12:15], s20 offen
    buffer_load_dwordx4 v[54:57], v7, s[12:15], s20 offen offset:16
    buffer_load_dword v58, v7, s[12:15], s20 offen offset:32
    s_add_u32 s20, s20, 65664
    buffer_load_dwordx4 v[60:63], v7, s[8:11], s20 offen
    buffer_load_dwordx4 v[64:67], v7, s[8:11], s20 offen offset:16
    buffer_load_dword v68, v7, s[8:11], s20 offen offset:32
    buffer_load_dwordx4 v[70:73], v7, s[12:15], s20 offen
    buffer_load_dwordx4 v[74:77], v7, s[12:15], s20 offen offset:16
    buffer_load_dword v78, v7, s[12:15], s20 offen offset:32
    s_add_u32 s20, s20, 65664
    buffer_load_dwordx4 v[80:83], v7, s[8:11], s20 offen
    buffer_load_dwordx4 v[84:87], v7, s[8:11], s20 offen offset:16
    buffer_load_dword v88, v7, s[8:11], s20 offen offset:32
    buffer_load_dwordx4 v[90:93], v7, s[12:15], s20 offen
    buffer_load_dwordx4 v[94:97], v7, s[12:15], s20 offen offset:16
    buffer_load_dword v98, v7, s[12:15], s20 offen offset:32
    s_add_u32 s20, s20, 65664
    s_cmp_lg_u32 s93, 0
    s_cbranch_scc1 F_nl512
    s_sub_u32 s20, s20, 524288
    buffer_load_ushort v164, v12, s[8:11], s20 offen
    buffer_load_ushort v172, v12, s[12:15], s20 offen
    s_add_u32 s20, s20, 65664
    buffer_load_ushort v165, v12, s[8:11], s20 offen
    buffer_load_ushort v173, v12, s[12:15], s20 offen
    s_add_u32 s20, s20, 65664
    buffer_load_ushort v166, v12, s[8:11], s20 offen
    buffer_load_ushort v174, v12, s[12:15], s20 offen
    s_add_u32 s20, s20, 65664
    buffer_load_ushort v167, v12, s[8:11], s20 offen
    buffer_load_ushort v175, v12, s[12:15], s20 offen
    s_add_u32 s20, s20, 65664
    buffer_load_ushort v168, v12, s[8:11], s20 offen
    buffer_load_ushort v176, v12, s[12:15], s20 offen
    s_add_u32 s20, s20, 65664
    buffer_load_ushort v169, v12, s[8:11], s20 offen
    buffer_load_ushort v177, v12, s[12:15], s20 offen
    s_add_u32 s20, s20, 65664
    buffer_load_ushort v170, v12, s[8:11], s20 offen
    buffer_load_ushort v178, v12, s[12:15], s20 offen
    s_add_u32 s20, s20, 65664
    buffer_load_ushort v171, v12, s[8:11], s20 offen
    buffer_load_ushort v179, v12, s[12:15], s20 offen
    s_add_u32 s20, s20, 65664
F_nl512:
    s_waitcnt vmcnt(0)
    v_alignbit_b32 v20, v21, v20, v13
    v_alignbit_b32 v21, v22, v21, v13
    v_alignbit_b32 v22, v23, v22, v13
    v_alignbit_b32 v23, v24, v23, v13
    v_alignbit_b32 v24, v25, v24, v13
    v_alignbit_b32 v25, v26, v25, v13
    v_alignbit_b32 v26, v27, v26, v13
    v_alignbit_b32 v27, v28, v27, v13
    v_alignbit_b32 v30, v31, v30, v13
    v_alignbit_b32 v31, v32, v31, v13
    v_alignbit_b32 v32, v33, v32, v13
    v_alignbit_b32 v33, v34, v33, v13
    v_alignbit_b32 v34, v35, v34, v13
    v_alignbit_b32 v35, v36, v35, v13
    v_alignbit_b32 v36, v37, v36, v13
    v_alignbit_b32 v37, v38, v37, v13
    v_perm_b32 v100, v30, v20, s32
    v_perm_b32 v104, v30, v20, s33
    v_perm_b32 v108, v31, v21, s32
    v_perm_b32 v112, v31, v21, s33
    v_perm_b32 v116, v32, v22, s32
    v_perm_b32 v120, v32, v22, s33
    v_perm_b32 v124, v33, v23, s32
    v_perm_b32 v128, v33, v23, s33
    v_perm_b32 v132, v34, v24, s32
    v_perm_b32 v136, v34, v24, s33
    v_perm_b32 v140, v35, v25, s32
    v_perm_b32 v144, v35, v25, s33
    v_perm_b32 v148, v36, v26, s32
    v_perm_b32 v152, v36, v26, s33
    v_perm_b32 v156, v37, v27, s32
    v_perm_b32 v160, v37, v27, s33
    v_alignbit_b32 v40, v41, v40, v13
    v_alignbit_b32 v41, v42, v41, v13
    v_alignbit_b32 v42, v43, v42, v13
    v_alignbit_b32 v43, v44, v43, v13
    v_alignbit_b32 v44, v45, v44, v13
    v_alignbit_b32 v45, v46, v45, v13
    v_alignbit_b32 v46, v47, v46, v13
    v_alignbit_b32 v47, v48, v47, v13
    v_alignbit_b32 v50, v51, v50, v13
    v_alignbit_b32 v51, v52, v51, v13
    v_alignbit_b32 v52, v53, v52, v13
    v_alignbit_b32 v53, v54, v53, v13
    v_alignbit_b32 v54, v55, v54, v13
    v_alignbit_b32 v55, v56, v55, v13
    v_alignbit_b32 v56, v57, v56, v13
    v_alignbit_b32 v57, v58, v57, v13
    v_perm_b32 v101, v50, v40, s32
    v_perm_b32 v105, v50, v40, s33
    v_perm_b32 v109, v51, v41, s32
    v_perm_b32 v113, v51, v41, s33
    v_perm_b32 v117, v52, v42, s32
    v_perm_b32 v121, v52, v42, s33
    v_perm_b32 v125, v53, v43, s32
    v_perm_b32 v129, v53, v43, s33
    v_perm_b32 v133, v54, v44, s32
    v_perm_b32 v137, v54, v44, s33
    v_perm_b32 v141, v55, v45, s32
    v_perm_b32 v145, v55, v45, s33
    v_perm_b32 v149, v56, v46, s32
    v_perm_b32 v153, v56, v46, s33
    v_perm_b32 v157, v57, v47, s32
    v_perm_b32 v161, v57, v47, s33
    v_alignbit_b32 v60, v61, v60, v13
    v_alignbit_b32 v61, v62, v61, v13
    v_alignbit_b32 v62, v63, v62, v13
    v_alignbit_b32 v63, v64, v63, v13
    v_alignbit_b32 v64, v65, v64, v13
    v_alignbit_b32 v65, v66, v65, v13
    v_alignbit_b32 v66, v67, v66, v13
    v_alignbit_b32 v67, v68, v67, v13
    v_alignbit_b32 v70, v71, v70, v13
    v_alignbit_b32 v71, v72, v71, v13
    v_alignbit_b32 v72, v73, v72, v13
    v_alignbit_b32 v73, v74, v73, v13
    v_alignbit_b32 v74, v75, v74, v13
    v_alignbit_b32 v75, v76, v75, v13
    v_alignbit_b32 v76, v77, v76, v13
    v_alignbit_b32 v77, v78, v77, v13
    v_perm_b32 v102, v70, v60, s32
    v_perm_b32 v106, v70, v60, s33
    v_perm_b32 v110, v71, v61, s32
    v_perm_b32 v114, v71, v61, s33
    v_perm_b32 v118, v72, v62, s32
    v_perm_b32 v122, v72, v62, s33
    v_perm_b32 v126, v73, v63, s32
    v_perm_b32 v130, v73, v63, s33
    v_perm_b32 v134, v74, v64, s32
    v_perm_b32 v138, v74, v64, s33
    v_perm_b32 v142, v75, v65, s32
    v_perm_b32 v146, v75, v65, s33
    v_perm_b32 v150, v76, v66, s32
    v_perm_b32 v154, v76, v66, s33
    v_perm_b32 v158, v77, v67, s32
    v_perm_b32 v162, v77, v67, s33
    v_alignbit_b32 v80, v81, v80, v13
    v_alignbit_b32 v81, v82, v81, v13
    v_alignbit_b32 v82, v83, v82, v13
    v_alignbit_b32 v83, v84, v83, v13
    v_alignbit_b32 v84, v85, v84, v13
    v_alignbit_b32 v85, v86, v85, v13
    v_alignbit_b32 v86, v87, v86, v13
    v_alignbit_b32 v87, v88, v87, v13
    v_alignbit_b32 v90, v91, v90, v13
    v_alignbit_b32 v91, v92, v91, v13
    v_alignbit_b32 v92, v93, v92, v13
    v_alignbit_b32 v93, v94, v93, v13
    v_alignbit_b32 v94, v95, v94, v13
    v_alignbit_b32 v95, v96, v95, v13
    v_alignbit_b32 v96, v97, v96, v13
    v_alignbit_b32 v97, v98, v97, v13
    v_perm_b32 v103, v90, v80, s32
    v_perm_b32 v107, v90, v80, s33
    v_perm_b32 v111, v91, v81, s32
    v_perm_b32 v115, v91, v81, s33
    v_perm_b32 v119, v92, v82, s32
    v_perm_b32 v123, v92, v82, s33
    v_perm_b32 v127, v93, v83, s32
    v_perm_b32 v131, v93, v83, s33
    v_perm_b32 v135, v94, v84, s32
    v_perm_b32 v139, v94, v84, s33
    v_perm_b32 v143, v95, v85, s32
    v_perm_b32 v147, v95, v85, s33
    v_perm_b32 v151, v96, v86, s32
    v_perm_b32 v155, v96, v86, s33
    v_perm_b32 v159, v97, v87, s32
    v_perm_b32 v163, v97, v87, s33
    s_add_u32 s17, s21, 1024
    buffer_store_dwordx4 v[100:103], v14, s[4:7], s17 offen
    s_add_u32 s17, s21, 9216
    buffer_store_dwordx4 v[104:107], v14, s[4:7], s17 offen
    s_add_u32 s17, s21, 17408
    buffer_store_dwordx4 v[108:111], v14, s[4:7], s17 offen
    s_add_u32 s17, s21, 25600
    buffer_store_dwordx4 v[112:115], v14, s[4:7], s17 offen
    s_add_u32 s17, s21, 33792
    buffer_store_dwordx4 v[116:119], v14, s[4:7], s17 offen
    s_add_u32 s17, s21, 41984
    buffer_store_dwordx4 v[120:123], v14, s[4:7], s17 offen
    s_add_u32 s17, s21, 50176
    buffer_store_dwordx4 v[124:127], v14, s[4:7], s17 offen
    s_add_u32 s17, s21, 58368
    buffer_store_dwordx4 v[128:131], v14, s[4:7], s17 offen
    s_add_u32 s17, s21, 66560
    buffer_store_dwordx4 v[132:135], v14, s[4:7], s17 offen
    s_add_u32 s17, s21, 74752
    buffer_store_dwordx4 v[136:139], v14, s[4:7], s17 offen
    s_add_u32 s17, s21, 82944
    buffer_store_dwordx4 v[140:143], v14, s[4:7], s17 offen
    s_add_u32 s17, s21, 91136
    buffer_store_dwordx4 v[144:147], v14, s[4:7], s17 offen
    s_add_u32 s17, s21, 99328
    buffer_store_dwordx4 v[148:151], v14, s[4:7], s17 offen
    s_add_u32 s17, s21, 107520
    buffer_store_dwordx4 v[152:155], v14, s[4:7], s17 offen
    s_add_u32 s17, s21, 115712
    buffer_store_dwordx4 v[156:159], v14, s[4:7], s17 offen
    s_add_u32 s17, s21, 123904
    buffer_store_dwordx4 v[160:163], v14, s[4:7], s17 offen
    s_cmp_lg_u32 s93, 0
    s_cbranch_scc1 F_no512
    v_lshl_or_b32 v164, v172, 16, v164
    v_lshl_or_b32 v165, v173, 16, v165
    v_lshl_or_b32 v166, v174, 16, v166
    v_lshl_or_b32 v167, v175, 16, v167
    v_lshl_or_b32 v168, v176, 16, v168
    v_lshl_or_b32 v169, v177, 16, v169
    v_lshl_or_b32 v170, v178, 16, v170
    v_lshl_or_b32 v171, v179, 16, v171
    s_add_u32 s17, s21, 4194304
    buffer_store_dwordx4 v[164:167], v14, s[4:7], s17 offen
    buffer_store_dwordx4 v[168:171], v14, s[4:7], s17 offen offset:1024
F_no512:
    s_load_dwordx2 s[12:13], s[0:1], 80
    s_mov_b32 s14, 8388608
    v_and_b32 v10, 19, v1
    v_bfe_u32 v5, v1, 2, 1
    v_bfe_u32 v6, v1, 3, 1
    v_lshl_add_u32 v10, v5, 3, v10
    v_lshl_add_u32 v10, v6, 2, v10
    v_lshrrev_b32 v11, 5, v1
    v_cvt_f32_u32 v16, v10
    v_lshlrev_b32 v17, 3, v11
    v_cvt_f32_u32 v17, v17
    v_lshlrev_b32 v14, 4, v1
    v_add_f32 v5, 0, v16
    v_mul_f32 v5, 1015021568, v5
    v_mul_f32 v6, v5, v17
    v_mul_f32 v7, 0x41800000, v5
    v_fract_f32 v32, v6
    v_add_f32 v33, v32, v5
    v_add_f32 v34, v33, v5
    v_add_f32 v35, v34, v5
    v_add_f32 v36, v35, v5
    v_add_f32 v37, v36, v5
    v_add_f32 v38, v37, v5
    v_add_f32 v39, v38, v5
    v_add_f32 v6, v32, v7
    v_cos_f32 v40, v32
    v_sin_f32 v48, v32
    v_cos_f32 v41, v33
    v_sin_f32 v49, v33
    v_cos_f32 v42, v34
    v_sin_f32 v50, v34
    v_cos_f32 v43, v35
    v_sin_f32 v51, v35
    v_cos_f32 v44, v36
    v_sin_f32 v52, v36
    v_cos_f32 v45, v37
    v_sin_f32 v53, v37
    v_cos_f32 v46, v38
    v_sin_f32 v54, v38
    v_cos_f32 v47, v39
    v_sin_f32 v55, v39
    v_cvt_pk_bf16_f32 v56, v40, v41
    v_cvt_pk_bf16_f32 v57, v48, v49
    v_accvgpr_write_b32 a0, v56
    v_xor_b32 v58, 0x80008000, v57
    v_accvgpr_write_b32 a32, v57
    v_accvgpr_write_b32 a64, v58
    v_cvt_pk_bf16_f32 v56, v42, v43
    v_cvt_pk_bf16_f32 v57, v50, v51
    v_accvgpr_write_b32 a1, v56
    v_xor_b32 v58, 0x80008000, v57
    v_accvgpr_write_b32 a33, v57
    v_accvgpr_write_b32 a65, v58
    v_cvt_pk_bf16_f32 v56, v44, v45
    v_cvt_pk_bf16_f32 v57, v52, v53
    v_accvgpr_write_b32 a2, v56
    v_xor_b32 v58, 0x80008000, v57
    v_accvgpr_write_b32 a34, v57
    v_accvgpr_write_b32 a66, v58
    v_cvt_pk_bf16_f32 v56, v46, v47
    v_cvt_pk_bf16_f32 v57, v54, v55
    v_accvgpr_write_b32 a3, v56
    v_xor_b32 v58, 0x80008000, v57
    v_accvgpr_write_b32 a35, v57
    v_accvgpr_write_b32 a67, v58
    v_fract_f32 v32, v6
    v_add_f32 v33, v32, v5
    v_add_f32 v34, v33, v5
    v_add_f32 v35, v34, v5
    v_add_f32 v36, v35, v5
    v_add_f32 v37, v36, v5
    v_add_f32 v38, v37, v5
    v_add_f32 v39, v38, v5
    v_add_f32 v6, v32, v7
    v_cos_f32 v40, v32
    v_sin_f32 v48, v32
    v_cos_f32 v41, v33
    v_sin_f32 v49, v33
    v_cos_f32 v42, v34
    v_sin_f32 v50, v34
    v_cos_f32 v43, v35
    v_sin_f32 v51, v35
    v_cos_f32 v44, v36
    v_sin_f32 v52, v36
    v_cos_f32 v45, v37
    v_sin_f32 v53, v37
    v_cos_f32 v46, v38
    v_sin_f32 v54, v38
    v_cos_f32 v47, v39
    v_sin_f32 v55, v39
    v_cvt_pk_bf16_f32 v56, v40, v41
    v_cvt_pk_bf16_f32 v57, v48, v49
    v_accvgpr_write_b32 a4, v56
    v_xor_b32 v58, 0x80008000, v57
    v_accvgpr_write_b32 a36, v57
    v_accvgpr_write_b32 a68, v58
    v_cvt_pk_bf16_f32 v56, v42, v43
    v_cvt_pk_bf16_f32 v57, v50, v51
    v_accvgpr_write_b32 a5, v56
    v_xor_b32 v58, 0x80008000, v57
    v_accvgpr_write_b32 a37, v57
    v_accvgpr_write_b32 a69, v58
    v_cvt_pk_bf16_f32 v56, v44, v45
    v_cvt_pk_bf16_f32 v57, v52, v53
    v_accvgpr_write_b32 a6, v56
    v_xor_b32 v58, 0x80008000, v57
    v_accvgpr_write_b32 a38, v57
    v_accvgpr_write_b32 a70, v58
    v_cvt_pk_bf16_f32 v56, v46, v47
    v_cvt_pk_bf16_f32 v57, v54, v55
    v_accvgpr_write_b32 a7, v56
    v_xor_b32 v58, 0x80008000, v57
    v_accvgpr_write_b32 a39, v57
    v_accvgpr_write_b32 a71, v58
    v_fract_f32 v32, v6
    v_add_f32 v33, v32, v5
    v_add_f32 v34, v33, v5
    v_add_f32 v35, v34, v5
    v_add_f32 v36, v35, v5
    v_add_f32 v37, v36, v5
    v_add_f32 v38, v37, v5
    v_add_f32 v39, v38, v5
    v_add_f32 v6, v32, v7
    v_cos_f32 v40, v32
    v_sin_f32 v48, v32
    v_cos_f32 v41, v33
    v_sin_f32 v49, v33
    v_cos_f32 v42, v34
    v_sin_f32 v50, v34
    v_cos_f32 v43, v35
    v_sin_f32 v51, v35
    v_cos_f32 v44, v36
    v_sin_f32 v52, v36
    v_cos_f32 v45, v37
    v_sin_f32 v53, v37
    v_cos_f32 v46, v38
    v_sin_f32 v54, v38
    v_cos_f32 v47, v39
    v_sin_f32 v55, v39
    v_cvt_pk_bf16_f32 v56, v40, v41
    v_cvt_pk_bf16_f32 v57, v48, v49
    v_accvgpr_write_b32 a8, v56
    v_xor_b32 v58, 0x80008000, v57
    v_accvgpr_write_b32 a40, v57
    v_accvgpr_write_b32 a72, v58
    v_cvt_pk_bf16_f32 v56, v42, v43
    v_cvt_pk_bf16_f32 v57, v50, v51
    v_accvgpr_write_b32 a9, v56
    v_xor_b32 v58, 0x80008000, v57
    v_accvgpr_write_b32 a41, v57
    v_accvgpr_write_b32 a73, v58
    v_cvt_pk_bf16_f32 v56, v44, v45
    v_cvt_pk_bf16_f32 v57, v52, v53
    v_accvgpr_write_b32 a10, v56
    v_xor_b32 v58, 0x80008000, v57
    v_accvgpr_write_b32 a42, v57
    v_accvgpr_write_b32 a74, v58
    v_cvt_pk_bf16_f32 v56, v46, v47
    v_cvt_pk_bf16_f32 v57, v54, v55
    v_accvgpr_write_b32 a11, v56
    v_xor_b32 v58, 0x80008000, v57
    v_accvgpr_write_b32 a43, v57
    v_accvgpr_write_b32 a75, v58
    v_fract_f32 v32, v6
    v_add_f32 v33, v32, v5
    v_add_f32 v34, v33, v5
    v_add_f32 v35, v34, v5
    v_add_f32 v36, v35, v5
    v_add_f32 v37, v36, v5
    v_add_f32 v38, v37, v5
    v_add_f32 v39, v38, v5
    v_add_f32 v6, v32, v7
    v_cos_f32 v40, v32
    v_sin_f32 v48, v32
    v_cos_f32 v41, v33
    v_sin_f32 v49, v33
    v_cos_f32 v42, v34
    v_sin_f32 v50, v34
    v_cos_f32 v43, v35
    v_sin_f32 v51, v35
    v_cos_f32 v44, v36
    v_sin_f32 v52, v36
    v_cos_f32 v45, v37
    v_sin_f32 v53, v37
    v_cos_f32 v46, v38
    v_sin_f32 v54, v38
    v_cos_f32 v47, v39
    v_sin_f32 v55, v39
    v_cvt_pk_bf16_f32 v56, v40, v41
    v_cvt_pk_bf16_f32 v57, v48, v49
    v_accvgpr_write_b32 a12, v56
    v_xor_b32 v58, 0x80008000, v57
    v_accvgpr_write_b32 a44, v57
    v_accvgpr_write_b32 a76, v58
    v_cvt_pk_bf16_f32 v56, v42, v43
    v_cvt_pk_bf16_f32 v57, v50, v51
    v_accvgpr_write_b32 a13, v56
    v_xor_b32 v58, 0x80008000, v57
    v_accvgpr_write_b32 a45, v57
    v_accvgpr_write_b32 a77, v58
    v_cvt_pk_bf16_f32 v56, v44, v45
    v_cvt_pk_bf16_f32 v57, v52, v53
    v_accvgpr_write_b32 a14, v56
    v_xor_b32 v58, 0x80008000, v57
    v_accvgpr_write_b32 a46, v57
    v_accvgpr_write_b32 a78, v58
    v_cvt_pk_bf16_f32 v56, v46, v47
    v_cvt_pk_bf16_f32 v57, v54, v55
    v_accvgpr_write_b32 a15, v56
    v_xor_b32 v58, 0x80008000, v57
    v_accvgpr_write_b32 a47, v57
    v_accvgpr_write_b32 a79, v58
    v_add_f32 v5, 1107296256, v16
    v_mul_f32 v5, 1015021568, v5
    v_mul_f32 v6, v5, v17
    v_mul_f32 v7, 0x41800000, v5
    v_fract_f32 v32, v6
    v_add_f32 v33, v32, v5
    v_add_f32 v34, v33, v5
    v_add_f32 v35, v34, v5
    v_add_f32 v36, v35, v5
    v_add_f32 v37, v36, v5
    v_add_f32 v38, v37, v5
    v_add_f32 v39, v38, v5
    v_add_f32 v6, v32, v7
    v_cos_f32 v40, v32
    v_sin_f32 v48, v32
    v_cos_f32 v41, v33
    v_sin_f32 v49, v33
    v_cos_f32 v42, v34
    v_sin_f32 v50, v34
    v_cos_f32 v43, v35
    v_sin_f32 v51, v35
    v_cos_f32 v44, v36
    v_sin_f32 v52, v36
    v_cos_f32 v45, v37
    v_sin_f32 v53, v37
    v_cos_f32 v46, v38
    v_sin_f32 v54, v38
    v_cos_f32 v47, v39
    v_sin_f32 v55, v39
    v_cvt_pk_bf16_f32 v56, v40, v41
    v_cvt_pk_bf16_f32 v57, v48, v49
    v_accvgpr_write_b32 a16, v56
    v_xor_b32 v58, 0x80008000, v57
    v_accvgpr_write_b32 a48, v57
    v_accvgpr_write_b32 a80, v58
    v_cvt_pk_bf16_f32 v56, v42, v43
    v_cvt_pk_bf16_f32 v57, v50, v51
    v_accvgpr_write_b32 a17, v56
    v_xor_b32 v58, 0x80008000, v57
    v_accvgpr_write_b32 a49, v57
    v_accvgpr_write_b32 a81, v58
    v_cvt_pk_bf16_f32 v56, v44, v45
    v_cvt_pk_bf16_f32 v57, v52, v53
    v_accvgpr_write_b32 a18, v56
    v_xor_b32 v58, 0x80008000, v57
    v_accvgpr_write_b32 a50, v57
    v_accvgpr_write_b32 a82, v58
    v_cvt_pk_bf16_f32 v56, v46, v47
    v_cvt_pk_bf16_f32 v57, v54, v55
    v_accvgpr_write_b32 a19, v56
    v_xor_b32 v58, 0x80008000, v57
    v_accvgpr_write_b32 a51, v57
    v_accvgpr_write_b32 a83, v58
    v_fract_f32 v32, v6
    v_add_f32 v33, v32, v5
    v_add_f32 v34, v33, v5
    v_add_f32 v35, v34, v5
    v_add_f32 v36, v35, v5
    v_add_f32 v37, v36, v5
    v_add_f32 v38, v37, v5
    v_add_f32 v39, v38, v5
    v_add_f32 v6, v32, v7
    v_cos_f32 v40, v32
    v_sin_f32 v48, v32
    v_cos_f32 v41, v33
    v_sin_f32 v49, v33
    v_cos_f32 v42, v34
    v_sin_f32 v50, v34
    v_cos_f32 v43, v35
    v_sin_f32 v51, v35
    v_cos_f32 v44, v36
    v_sin_f32 v52, v36
    v_cos_f32 v45, v37
    v_sin_f32 v53, v37
    v_cos_f32 v46, v38
    v_sin_f32 v54, v38
    v_cos_f32 v47, v39
    v_sin_f32 v55, v39
    v_cvt_pk_bf16_f32 v56, v40, v41
    v_cvt_pk_bf16_f32 v57, v48, v49
    v_accvgpr_write_b32 a20, v56
    v_xor_b32 v58, 0x80008000, v57
    v_accvgpr_write_b32 a52, v57
    v_accvgpr_write_b32 a84, v58
    v_cvt_pk_bf16_f32 v56, v42, v43
    v_cvt_pk_bf16_f32 v57, v50, v51
    v_accvgpr_write_b32 a21, v56
    v_xor_b32 v58, 0x80008000, v57
    v_accvgpr_write_b32 a53, v57
    v_accvgpr_write_b32 a85, v58
    v_cvt_pk_bf16_f32 v56, v44, v45
    v_cvt_pk_bf16_f32 v57, v52, v53
    v_accvgpr_write_b32 a22, v56
    v_xor_b32 v58, 0x80008000, v57
    v_accvgpr_write_b32 a54, v57
    v_accvgpr_write_b32 a86, v58
    v_cvt_pk_bf16_f32 v56, v46, v47
    v_cvt_pk_bf16_f32 v57, v54, v55
    v_accvgpr_write_b32 a23, v56
    v_xor_b32 v58, 0x80008000, v57
    v_accvgpr_write_b32 a55, v57
    v_accvgpr_write_b32 a87, v58
    v_fract_f32 v32, v6
    v_add_f32 v33, v32, v5
    v_add_f32 v34, v33, v5
    v_add_f32 v35, v34, v5
    v_add_f32 v36, v35, v5
    v_add_f32 v37, v36, v5
    v_add_f32 v38, v37, v5
    v_add_f32 v39, v38, v5
    v_add_f32 v6, v32, v7
    v_cos_f32 v40, v32
    v_sin_f32 v48, v32
    v_cos_f32 v41, v33
    v_sin_f32 v49, v33
    v_cos_f32 v42, v34
    v_sin_f32 v50, v34
    v_cos_f32 v43, v35
    v_sin_f32 v51, v35
    v_cos_f32 v44, v36
    v_sin_f32 v52, v36
    v_cos_f32 v45, v37
    v_sin_f32 v53, v37
    v_cos_f32 v46, v38
    v_sin_f32 v54, v38
    v_cos_f32 v47, v39
    v_sin_f32 v55, v39
    v_cvt_pk_bf16_f32 v56, v40, v41
    v_cvt_pk_bf16_f32 v57, v48, v49
    v_accvgpr_write_b32 a24, v56
    v_xor_b32 v58, 0x80008000, v57
    v_accvgpr_write_b32 a56, v57
    v_accvgpr_write_b32 a88, v58
    v_cvt_pk_bf16_f32 v56, v42, v43
    v_cvt_pk_bf16_f32 v57, v50, v51
    v_accvgpr_write_b32 a25, v56
    v_xor_b32 v58, 0x80008000, v57
    v_accvgpr_write_b32 a57, v57
    v_accvgpr_write_b32 a89, v58
    v_cvt_pk_bf16_f32 v56, v44, v45
    v_cvt_pk_bf16_f32 v57, v52, v53
    v_accvgpr_write_b32 a26, v56
    v_xor_b32 v58, 0x80008000, v57
    v_accvgpr_write_b32 a58, v57
    v_accvgpr_write_b32 a90, v58
    v_cvt_pk_bf16_f32 v56, v46, v47
    v_cvt_pk_bf16_f32 v57, v54, v55
    v_accvgpr_write_b32 a27, v56
    v_xor_b32 v58, 0x80008000, v57
    v_accvgpr_write_b32 a59, v57
    v_accvgpr_write_b32 a91, v58
    v_fract_f32 v32, v6
    v_add_f32 v33, v32, v5
    v_add_f32 v34, v33, v5
    v_add_f32 v35, v34, v5
    v_add_f32 v36, v35, v5
    v_add_f32 v37, v36, v5
    v_add_f32 v38, v37, v5
    v_add_f32 v39, v38, v5
    v_add_f32 v6, v32, v7
    v_cos_f32 v40, v32
    v_sin_f32 v48, v32
    v_cos_f32 v41, v33
    v_sin_f32 v49, v33
    v_cos_f32 v42, v34
    v_sin_f32 v50, v34
    v_cos_f32 v43, v35
    v_sin_f32 v51, v35
    v_cos_f32 v44, v36
    v_sin_f32 v52, v36
    v_cos_f32 v45, v37
    v_sin_f32 v53, v37
    v_cos_f32 v46, v38
    v_sin_f32 v54, v38
    v_cos_f32 v47, v39
    v_sin_f32 v55, v39
    v_cvt_pk_bf16_f32 v56, v40, v41
    v_cvt_pk_bf16_f32 v57, v48, v49
    v_accvgpr_write_b32 a28, v56
    v_xor_b32 v58, 0x80008000, v57
    v_accvgpr_write_b32 a60, v57
    v_accvgpr_write_b32 a92, v58
    v_cvt_pk_bf16_f32 v56, v42, v43
    v_cvt_pk_bf16_f32 v57, v50, v51
    v_accvgpr_write_b32 a29, v56
    v_xor_b32 v58, 0x80008000, v57
    v_accvgpr_write_b32 a61, v57
    v_accvgpr_write_b32 a93, v58
    v_cvt_pk_bf16_f32 v56, v44, v45
    v_cvt_pk_bf16_f32 v57, v52, v53
    v_accvgpr_write_b32 a30, v56
    v_xor_b32 v58, 0x80008000, v57
    v_accvgpr_write_b32 a62, v57
    v_accvgpr_write_b32 a94, v58
    v_cvt_pk_bf16_f32 v56, v46, v47
    v_cvt_pk_bf16_f32 v57, v54, v55
    v_accvgpr_write_b32 a31, v56
    v_xor_b32 v58, 0x80008000, v57
    v_accvgpr_write_b32 a63, v57
    v_accvgpr_write_b32 a95, v58
    v_add_f32 v5, 0, v16
    v_mul_f32 v5, 1023410176, v5
    v_mul_f32 v6, v5, v17
    v_mul_f32 v7, 0x41800000, v5
    v_fract_f32 v32, v6
    v_add_f32 v33, v32, v5
    v_add_f32 v34, v33, v5
    v_add_f32 v35, v34, v5
    v_add_f32 v36, v35, v5
    v_add_f32 v37, v36, v5
    v_add_f32 v38, v37, v5
    v_add_f32 v39, v38, v5
    v_add_f32 v6, v32, v7
    v_cos_f32 v40, v32
    v_sin_f32 v48, v32
    v_cos_f32 v41, v33
    v_sin_f32 v49, v33
    v_cos_f32 v42, v34
    v_sin_f32 v50, v34
    v_cos_f32 v43, v35
    v_sin_f32 v51, v35
    v_cos_f32 v44, v36
    v_sin_f32 v52, v36
    v_cos_f32 v45, v37
    v_sin_f32 v53, v37
    v_cos_f32 v46, v38
    v_sin_f32 v54, v38
    v_cos_f32 v47, v39
    v_sin_f32 v55, v39
    v_cvt_pk_bf16_f32 v56, v40, v41
    v_cvt_pk_bf16_f32 v57, v48, v49
    v_accvgpr_write_b32 a96, v56
    v_xor_b32 v58, 0x80008000, v57
    v_accvgpr_write_b32 a104, v57
    v_accvgpr_write_b32 a112, v58
    v_cvt_pk_bf16_f32 v56, v42, v43
    v_cvt_pk_bf16_f32 v57, v50, v51
    v_accvgpr_write_b32 a97, v56
    v_xor_b32 v58, 0x80008000, v57
    v_accvgpr_write_b32 a105, v57
    v_accvgpr_write_b32 a113, v58
    v_cvt_pk_bf16_f32 v56, v44, v45
    v_cvt_pk_bf16_f32 v57, v52, v53
    v_accvgpr_write_b32 a98, v56
    v_xor_b32 v58, 0x80008000, v57
    v_accvgpr_write_b32 a106, v57
    v_accvgpr_write_b32 a114, v58
    v_cvt_pk_bf16_f32 v56, v46, v47
    v_cvt_pk_bf16_f32 v57, v54, v55
    v_accvgpr_write_b32 a99, v56
    v_xor_b32 v58, 0x80008000, v57
    v_accvgpr_write_b32 a107, v57
    v_accvgpr_write_b32 a115, v58
    v_fract_f32 v32, v6
    v_add_f32 v33, v32, v5
    v_add_f32 v34, v33, v5
    v_add_f32 v35, v34, v5
    v_add_f32 v36, v35, v5
    v_add_f32 v37, v36, v5
    v_add_f32 v38, v37, v5
    v_add_f32 v39, v38, v5
    v_add_f32 v6, v32, v7
    v_cos_f32 v40, v32
    v_sin_f32 v48, v32
    v_cos_f32 v41, v33
    v_sin_f32 v49, v33
    v_cos_f32 v42, v34
    v_sin_f32 v50, v34
    v_cos_f32 v43, v35
    v_sin_f32 v51, v35
    v_cos_f32 v44, v36
    v_sin_f32 v52, v36
    v_cos_f32 v45, v37
    v_sin_f32 v53, v37
    v_cos_f32 v46, v38
    v_sin_f32 v54, v38
    v_cos_f32 v47, v39
    v_sin_f32 v55, v39
    v_cvt_pk_bf16_f32 v56, v40, v41
    v_cvt_pk_bf16_f32 v57, v48, v49
    v_accvgpr_write_b32 a100, v56
    v_xor_b32 v58, 0x80008000, v57
    v_accvgpr_write_b32 a108, v57
    v_accvgpr_write_b32 a116, v58
    v_cvt_pk_bf16_f32 v56, v42, v43
    v_cvt_pk_bf16_f32 v57, v50, v51
    v_accvgpr_write_b32 a101, v56
    v_xor_b32 v58, 0x80008000, v57
    v_accvgpr_write_b32 a109, v57
    v_accvgpr_write_b32 a117, v58
    v_cvt_pk_bf16_f32 v56, v44, v45
    v_cvt_pk_bf16_f32 v57, v52, v53
    v_accvgpr_write_b32 a102, v56
    v_xor_b32 v58, 0x80008000, v57
    v_accvgpr_write_b32 a110, v57
    v_accvgpr_write_b32 a118, v58
    v_cvt_pk_bf16_f32 v56, v46, v47
    v_cvt_pk_bf16_f32 v57, v54, v55
    v_accvgpr_write_b32 a103, v56
    v_xor_b32 v58, 0x80008000, v57
    v_accvgpr_write_b32 a111, v57
    v_accvgpr_write_b32 a119, v58
    v_add_f32 v5, 0, v16
    v_mul_f32 v5, 973078528, v5
    v_add_f32 v6, 0, v17
    v_mul_f32 v6, v6, v5
    v_cos_f32 v160, v6
    v_sin_f32 v176, v6
    v_add_f32 v6, 1065353216, v17
    v_mul_f32 v6, v6, v5
    v_cos_f32 v161, v6
    v_sin_f32 v177, v6
    v_add_f32 v6, 1073741824, v17
    v_mul_f32 v6, v6, v5
    v_cos_f32 v162, v6
    v_sin_f32 v178, v6
    v_add_f32 v6, 1077936128, v17
    v_mul_f32 v6, v6, v5
    v_cos_f32 v163, v6
    v_sin_f32 v179, v6
    v_add_f32 v6, 1082130432, v17
    v_mul_f32 v6, v6, v5
    v_cos_f32 v164, v6
    v_sin_f32 v180, v6
    v_add_f32 v6, 1084227584, v17
    v_mul_f32 v6, v6, v5
    v_cos_f32 v165, v6
    v_sin_f32 v181, v6
    v_add_f32 v6, 1086324736, v17
    v_mul_f32 v6, v6, v5
    v_cos_f32 v166, v6
    v_sin_f32 v182, v6
    v_add_f32 v6, 1088421888, v17
    v_mul_f32 v6, v6, v5
    v_cos_f32 v167, v6
    v_sin_f32 v183, v6
    v_add_f32 v6, 1098907648, v17
    v_mul_f32 v6, v6, v5
    v_cos_f32 v168, v6
    v_sin_f32 v184, v6
    v_add_f32 v6, 1099431936, v17
    v_mul_f32 v6, v6, v5
    v_cos_f32 v169, v6
    v_sin_f32 v185, v6
    v_add_f32 v6, 1099956224, v17
    v_mul_f32 v6, v6, v5
    v_cos_f32 v170, v6
    v_sin_f32 v186, v6
    v_add_f32 v6, 1100480512, v17
    v_mul_f32 v6, v6, v5
    v_cos_f32 v171, v6
    v_sin_f32 v187, v6
    v_add_f32 v6, 1101004800, v17
    v_mul_f32 v6, v6, v5
    v_cos_f32 v172, v6
    v_sin_f32 v188, v6
    v_add_f32 v6, 1101529088, v17
    v_mul_f32 v6, v6, v5
    v_cos_f32 v173, v6
    v_sin_f32 v189, v6
    v_add_f32 v6, 1102053376, v17
    v_mul_f32 v6, v6, v5
    v_cos_f32 v174, v6
    v_sin_f32 v190, v6
    v_add_f32 v6, 1102577664, v17
    v_mul_f32 v6, v6, v5
    v_cos_f32 v175, v6
    v_sin_f32 v191, v6
    v_add_f32 v5, 1107296256, v16
    v_mul_f32 v5, 973078528, v5
    v_add_f32 v6, 0, v17
    v_mul_f32 v6, v6, v5
    v_cos_f32 v192, v6
    v_sin_f32 v208, v6
    v_add_f32 v6, 1065353216, v17
    v_mul_f32 v6, v6, v5
    v_cos_f32 v193, v6
    v_sin_f32 v209, v6
    v_add_f32 v6, 1073741824, v17
    v_mul_f32 v6, v6, v5
    v_cos_f32 v194, v6
    v_sin_f32 v210, v6
    v_add_f32 v6, 1077936128, v17
    v_mul_f32 v6, v6, v5
    v_cos_f32 v195, v6
    v_sin_f32 v211, v6
    v_add_f32 v6, 1082130432, v17
    v_mul_f32 v6, v6, v5
    v_cos_f32 v196, v6
    v_sin_f32 v212, v6
    v_add_f32 v6, 1084227584, v17
    v_mul_f32 v6, v6, v5
    v_cos_f32 v197, v6
    v_sin_f32 v213, v6
    v_add_f32 v6, 1086324736, v17
    v_mul_f32 v6, v6, v5
    v_cos_f32 v198, v6
    v_sin_f32 v214, v6
    v_add_f32 v6, 1088421888, v17
    v_mul_f32 v6, v6, v5
    v_cos_f32 v199, v6
    v_sin_f32 v215, v6
    v_add_f32 v6, 1098907648, v17
    v_mul_f32 v6, v6, v5
    v_cos_f32 v200, v6
    v_sin_f32 v216, v6
    v_add_f32 v6, 1099431936, v17
    v_mul_f32 v6, v6, v5
    v_cos_f32 v201, v6
    v_sin_f32 v217, v6
    v_add_f32 v6, 1099956224, v17
    v_mul_f32 v6, v6, v5
    v_cos_f32 v202, v6
    v_sin_f32 v218, v6
    v_add_f32 v6, 1100480512, v17
    v_mul_f32 v6, v6, v5
    v_cos_f32 v203, v6
    v_sin_f32 v219, v6
    v_add_f32 v6, 1101004800, v17
    v_mul_f32 v6, v6, v5
    v_cos_f32 v204, v6
    v_sin_f32 v220, v6
    v_add_f32 v6, 1101529088, v17
    v_mul_f32 v6, v6, v5
    v_cos_f32 v205, v6
    v_sin_f32 v221, v6
    v_add_f32 v6, 1102053376, v17
    v_mul_f32 v6, v6, v5
    v_cos_f32 v206, v6
    v_sin_f32 v222, v6
    v_add_f32 v6, 1102577664, v17
    v_mul_f32 v6, v6, v5
    v_cos_f32 v207, v6
    v_sin_f32 v223, v6
    v_add_f32 v5, 0, v16
    v_mul_f32 v5, 973078528, v5
    v_add_f32 v6, 1107296256, v17
    v_mul_f32 v6, v6, v5
    v_cos_f32 v224, v6
    v_sin_f32 v240, v6
    v_add_f32 v6, 1107558400, v17
    v_mul_f32 v6, v6, v5
    v_cos_f32 v225, v6
    v_sin_f32 v241, v6
    v_add_f32 v6, 1107820544, v17
    v_mul_f32 v6, v6, v5
    v_cos_f32 v226, v6
    v_sin_f32 v242, v6
    v_add_f32 v6, 1108082688, v17
    v_mul_f32 v6, v6, v5
    v_cos_f32 v227, v6
    v_sin_f32 v243, v6
    v_add_f32 v6, 1108344832, v17
    v_mul_f32 v6, v6, v5
    v_cos_f32 v228, v6
    v_sin_f32 v244, v6
    v_add_f32 v6, 1108606976, v17
    v_mul_f32 v6, v6, v5
    v_cos_f32 v229, v6
    v_sin_f32 v245, v6
    v_add_f32 v6, 1108869120, v17
    v_mul_f32 v6, v6, v5
    v_cos_f32 v230, v6
    v_sin_f32 v246, v6
    v_add_f32 v6, 1109131264, v17
    v_mul_f32 v6, v6, v5
    v_cos_f32 v231, v6
    v_sin_f32 v247, v6
    v_add_f32 v6, 1111490560, v17
    v_mul_f32 v6, v6, v5
    v_cos_f32 v232, v6
    v_sin_f32 v248, v6
    v_add_f32 v6, 1111752704, v17
    v_mul_f32 v6, v6, v5
    v_cos_f32 v233, v6
    v_sin_f32 v249, v6
    v_add_f32 v6, 1112014848, v17
    v_mul_f32 v6, v6, v5
    v_cos_f32 v234, v6
    v_sin_f32 v250, v6
    v_add_f32 v6, 1112276992, v17
    v_mul_f32 v6, v6, v5
    v_cos_f32 v235, v6
    v_sin_f32 v251, v6
    v_add_f32 v6, 1112539136, v17
    v_mul_f32 v6, v6, v5
    v_cos_f32 v236, v6
    v_sin_f32 v252, v6
    v_add_f32 v6, 1112801280, v17
    v_mul_f32 v6, v6, v5
    v_cos_f32 v237, v6
    v_sin_f32 v253, v6
    v_add_f32 v6, 1113063424, v17
    v_mul_f32 v6, v6, v5
    v_cos_f32 v238, v6
    v_sin_f32 v254, v6
    v_add_f32 v6, 1113325568, v17
    v_mul_f32 v6, v6, v5
    v_cos_f32 v239, v6
    v_sin_f32 v255, v6
    v_lshlrev_b32 v15, 4, v11
    v_lshl_add_u32 v15, v10, 11, v15
    v_lshlrev_b32 v18, 12, v11
    v_lshl_add_u32 v18, v10, 4, v18
    s_mul_i32 s32, s93, 133120
    s_lshl_b32 s17, s16, 9
    s_add_u32 s32, s32, s17
    s_add_u32 s32, s32, 104857600
    s_add_u32 s33, s32, 64
    s_lshl_b32 s31, s93, 2
    s_add_u32 s31, s31, s16
    s_lshl_b32 s34, s31, 15
    s_add_u32 s34, s34, 117440512
    s_mov_b32 s38, 0xffff0000
    s_mov_b32 s36, 0
    s_cmp_eq_u32 s31, 0
    s_cselect_b32 s37, 5, 4
    s_cselect_b32 s33, 1073741824, s33
    s_mov_b32 s35, 897581056
    s_cselect_b32 s35, 889192448, s35
    v_and_b32 v7, 3, v1
    v_lshlrev_b32 v7, 7, v7
    s_lshl_b32 s17, s93, 9
    s_add_u32 s17, s17, 100745216
    v_add_u32 v7, s17, v7
    s_mov_b32 s30, s92
F2_w:
    buffer_load_dword v5, v7, s[4:7], 0 offen sc1
    s_waitcnt vmcnt(0)
    v_cmp_gt_u32 vcc, 1, v5
    s_nop 0
    s_and_b32 s17, vcc_lo, 15
    s_cbranch_scc0 F2_w_ok
    s_cmp_ge_u32 s30, 1048576
    s_cselect_b32 s92, 1048576, s92
    s_cbranch_scc1 F2_w_ok
    s_add_u32 s30, s30, 1
    s_sleep 8
    s_branch F2_w
F2_w_ok:
    s_waitcnt lgkmcnt(0)
    s_barrier
F2_top:
    s_add_u32 s17, s32, 65536
    buffer_load_dwordx4 v[96:99], v15, s[4:7], s32 offen offset:0
    buffer_load_dwordx4 v[100:103], v15, s[4:7], s32 offen offset:32
    buffer_load_dwordx4 v[104:107], v15, s[4:7], s17 offen offset:0
    buffer_load_dwordx4 v[108:111], v15, s[4:7], s17 offen offset:32
    s_add_u32 s17, s33, 65536
    buffer_load_dwordx4 v[112:115], v15, s[4:7], s33 offen offset:0
    buffer_load_dwordx4 v[116:119], v15, s[4:7], s33 offen offset:32
    buffer_load_dwordx4 v[120:123], v15, s[4:7], s17 offen offset:0
    buffer_load_dwordx4 v[124:127], v15, s[4:7], s17 offen offset:32
    s_add_u32 s17, s34, 4096
    buffer_load_dwordx4 v[128:131], v14, s[4:7], s34 offen offset:0
    buffer_load_dwordx4 v[132:135], v14, s[4:7], s34 offen offset:1024
    buffer_load_dwordx4 v[136:139], v14, s[4:7], s34 offen offset:2048
    buffer_load_dwordx4 v[140:143], v14, s[4:7], s34 offen offset:3072
    buffer_load_dwordx4 v[144:147], v14, s[4:7], s17 offen offset:0
    buffer_load_dwordx4 v[148:151], v14, s[4:7], s17 offen offset:1024
    buffer_load_dwordx4 v[152:155], v14, s[4:7], s17 offen offset:2048
    buffer_load_dwordx4 v[156:159], v14, s[4:7], s17 offen offset:3072
    s_waitcnt vmcnt(8)
    v_mfma_f32_32x32x16_bf16 v[32:47], v[96:99], a[0:3], 0
    v_mfma_f32_32x32x16_bf16 v[48:63], v[112:115], a[0:3], 0
    v_mfma_f32_32x32x16_bf16 v[32:47], v[112:115], a[32:35], v[32:47]
    v_mfma_f32_32x32x16_bf16 v[48:63], v[96:99], a[64:67], v[48:63]
    v_mfma_f32_32x32x16_bf16 v[32:47], v[100:103], a[4:7], v[32:47]
    v_mfma_f32_32x32x16_bf16 v[48:63], v[116:119], a[4:7], v[48:63]
    v_mfma_f32_32x32x16_bf16 v[32:47], v[116:119], a[36:39], v[32:47]
    v_mfma_f32_32x32x16_bf16 v[48:63], v[100:103], a[68:71], v[48:63]
    v_mfma_f32_32x32x16_bf16 v[32:47], v[104:107], a[8:11], v[32:47]
    v_mfma_f32_32x32x16_bf16 v[48:63], v[120:123], a[8:11], v[48:63]
    v_mfma_f32_32x32x16_bf16 v[32:47], v[120:123], a[40:43], v[32:47]
    v_mfma_f32_32x32x16_bf16 v[48:63], v[104:107], a[72:75], v[48:63]
    v_mfma_f32_32x32x16_bf16 v[32:47], v[108:111], a[12:15], v[32:47]
    v_mfma_f32_32x32x16_bf16 v[48:63], v[124:127], a[12:15], v[48:63]
    v_mfma_f32_32x32x16_bf16 v[32:47], v[124:127], a[44:47], v[32:47]
    v_mfma_f32_32x32x16_bf16 v[48:63], v[108:111], a[76:79], v[48:63]
    v_mfma_f32_32x32x16_bf16 v[64:79], v[96:99], a[16:19], 0
    v_mfma_f32_32x32x16_bf16 v[80:95], v[112:115], a[16:19], 0
    v_mfma_f32_32x32x16_bf16 v[64:79], v[112:115], a[48:51], v[64:79]
    v_mfma_f32_32x32x16_bf16 v[80:95], v[96:99], a[80:83], v[80:95]
    v_mfma_f32_32x32x16_bf16 v[64:79], v[100:103], a[20:23], v[64:79]
    v_mfma_f32_32x32x16_bf16 v[80:95], v[116:119], a[20:23], v[80:95]
    v_mfma_f32_32x32x16_bf16 v[64:79], v[116:119], a[52:55], v[64:79]
    v_mfma_f32_32x32x16_bf16 v[80:95], v[100:103], a[84:87], v[80:95]
    v_mfma_f32_32x32x16_bf16 v[64:79], v[104:107], a[24:27], v[64:79]
    v_mfma_f32_32x32x16_bf16 v[80:95], v[120:123], a[24:27], v[80:95]
    v_mfma_f32_32x32x16_bf16 v[64:79], v[120:123], a[56:59], v[64:79]
    v_mfma_f32_32x32x16_bf16 v[80:95], v[104:107], a[88:91], v[80:95]
    v_mfma_f32_32x32x16_bf16 v[64:79], v[108:111], a[28:31], v[64:79]
    v_mfma_f32_32x32x16_bf16 v[80:95], v[124:127], a[28:31], v[80:95]
    v_mfma_f32_32x32x16_bf16 v[64:79], v[124:127], a[60:63], v[64:79]
    v_mfma_f32_32x32x16_bf16 v[80:95], v[108:111], a[92:95], v[80:95]
    v_mul_f32 v5, v32, v160
    v_mul_f32 v7, v48, v160
    v_fma_f32 v5, v48, v176, v5
    v_fma_f32 v7, -v32, v176, v7
    v_mul_f32 v6, v33, v161
    v_mul_f32 v8, v49, v161
    v_fma_f32 v6, v49, v177, v6
    v_fma_f32 v8, -v33, v177, v8
    v_cvt_pk_bf16_f32 v96, v5, v6
    v_cvt_pk_bf16_f32 v112, v7, v8
    v_mul_f32 v5, v34, v162
    v_mul_f32 v7, v50, v162
    v_fma_f32 v5, v50, v178, v5
    v_fma_f32 v7, -v34, v178, v7
    v_mul_f32 v6, v35, v163
    v_mul_f32 v8, v51, v163
    v_fma_f32 v6, v51, v179, v6
    v_fma_f32 v8, -v35, v179, v8
    v_cvt_pk_bf16_f32 v97, v5, v6
    v_cvt_pk_bf16_f32 v113, v7, v8
    v_mul_f32 v5, v36, v164
    v_mul_f32 v7, v52, v164
    v_fma_f32 v5, v52, v180, v5
    v_fma_f32 v7, -v36, v180, v7
    v_mul_f32 v6, v37, v165
    v_mul_f32 v8, v53, v165
    v_fma_f32 v6, v53, v181, v6
    v_fma_f32 v8, -v37, v181, v8
    v_cvt_pk_bf16_f32 v98, v5, v6
    v_cvt_pk_bf16_f32 v114, v7, v8
    v_mul_f32 v5, v38, v166
    v_mul_f32 v7, v54, v166
    v_fma_f32 v5, v54, v182, v5
    v_fma_f32 v7, -v38, v182, v7
    v_mul_f32 v6, v39, v167
    v_mul_f32 v8, v55, v167
    v_fma_f32 v6, v55, v183, v6
    v_fma_f32 v8, -v39, v183, v8
    v_cvt_pk_bf16_f32 v99, v5, v6
    v_cvt_pk_bf16_f32 v115, v7, v8
    v_mul_f32 v5, v40, v168
    v_mul_f32 v7, v56, v168
    v_fma_f32 v5, v56, v184, v5
    v_fma_f32 v7, -v40, v184, v7
    v_mul_f32 v6, v41, v169
    v_mul_f32 v8, v57, v169
    v_fma_f32 v6, v57, v185, v6
    v_fma_f32 v8, -v41, v185, v8
    v_cvt_pk_bf16_f32 v100, v5, v6
    v_cvt_pk_bf16_f32 v116, v7, v8
    v_mul_f32 v5, v42, v170
    v_mul_f32 v7, v58, v170
    v_fma_f32 v5, v58, v186, v5
    v_fma_f32 v7, -v42, v186, v7
    v_mul_f32 v6, v43, v171
    v_mul_f32 v8, v59, v171
    v_fma_f32 v6, v59, v187, v6
    v_fma_f32 v8, -v43, v187, v8
    v_cvt_pk_bf16_f32 v101, v5, v6
    v_cvt_pk_bf16_f32 v117, v7, v8
    v_mul_f32 v5, v44, v172
    v_mul_f32 v7, v60, v172
    v_fma_f32 v5, v60, v188, v5
    v_fma_f32 v7, -v44, v188, v7
    v_mul_f32 v6, v45, v173
    v_mul_f32 v8, v61, v173
    v_fma_f32 v6, v61, v189, v6
    v_fma_f32 v8, -v45, v189, v8
    v_cvt_pk_bf16_f32 v102, v5, v6
    v_cvt_pk_bf16_f32 v118, v7, v8
    v_mul_f32 v5, v46, v174
    v_mul_f32 v7, v62, v174
    v_fma_f32 v5, v62, v190, v5
    v_fma_f32 v7, -v46, v190, v7
    v_mul_f32 v6, v47, v175
    v_mul_f32 v8, v63, v175
    v_fma_f32 v6, v63, v191, v6
    v_fma_f32 v8, -v47, v191, v8
    v_cvt_pk_bf16_f32 v103, v5, v6
    v_cvt_pk_bf16_f32 v119, v7, v8
    v_mul_f32 v5, v64, v192
    v_mul_f32 v7, v80, v192
    v_fma_f32 v5, v80, v208, v5
    v_fma_f32 v7, -v64, v208, v7
    v_mul_f32 v6, v65, v193
    v_mul_f32 v8, v81, v193
    v_fma_f32 v6, v81, v209, v6
    v_fma_f32 v8, -v65, v209, v8
    v_cvt_pk_bf16_f32 v104, v5, v6
    v_cvt_pk_bf16_f32 v120, v7, v8
    v_mul_f32 v5, v66, v194
    v_mul_f32 v7, v82, v194
    v_fma_f32 v5, v82, v210, v5
    v_fma_f32 v7, -v66, v210, v7
    v_mul_f32 v6, v67, v195
    v_mul_f32 v8, v83, v195
    v_fma_f32 v6, v83, v211, v6
    v_fma_f32 v8, -v67, v211, v8
    v_cvt_pk_bf16_f32 v105, v5, v6
    v_cvt_pk_bf16_f32 v121, v7, v8
    v_mul_f32 v5, v68, v196
    v_mul_f32 v7, v84, v196
    v_fma_f32 v5, v84, v212, v5
    v_fma_f32 v7, -v68, v212, v7
    v_mul_f32 v6, v69, v197
    v_mul_f32 v8, v85, v197
    v_fma_f32 v6, v85, v213, v6
    v_fma_f32 v8, -v69, v213, v8
    v_cvt_pk_bf16_f32 v106, v5, v6
    v_cvt_pk_bf16_f32 v122, v7, v8
    v_mul_f32 v5, v70, v198
    v_mul_f32 v7, v86, v198
    v_fma_f32 v5, v86, v214, v5
    v_fma_f32 v7, -v70, v214, v7
    v_mul_f32 v6, v71, v199
    v_mul_f32 v8, v87, v199
    v_fma_f32 v6, v87, v215, v6
    v_fma_f32 v8, -v71, v215, v8
    v_cvt_pk_bf16_f32 v107, v5, v6
    v_cvt_pk_bf16_f32 v123, v7, v8
    v_mul_f32 v5, v72, v200
    v_mul_f32 v7, v88, v200
    v_fma_f32 v5, v88, v216, v5
    v_fma_f32 v7, -v72, v216, v7
    v_mul_f32 v6, v73, v201
    v_mul_f32 v8, v89, v201
    v_fma_f32 v6, v89, v217, v6
    v_fma_f32 v8, -v73, v217, v8
    v_cvt_pk_bf16_f32 v108, v5, v6
    v_cvt_pk_bf16_f32 v124, v7, v8
    v_mul_f32 v5, v74, v202
    v_mul_f32 v7, v90, v202
    v_fma_f32 v5, v90, v218, v5
    v_fma_f32 v7, -v74, v218, v7
    v_mul_f32 v6, v75, v203
    v_mul_f32 v8, v91, v203
    v_fma_f32 v6, v91, v219, v6
    v_fma_f32 v8, -v75, v219, v8
    v_cvt_pk_bf16_f32 v109, v5, v6
    v_cvt_pk_bf16_f32 v125, v7, v8
    v_mul_f32 v5, v76, v204
    v_mul_f32 v7, v92, v204
    v_fma_f32 v5, v92, v220, v5
    v_fma_f32 v7, -v76, v220, v7
    v_mul_f32 v6, v77, v205
    v_mul_f32 v8, v93, v205
    v_fma_f32 v6, v93, v221, v6
    v_fma_f32 v8, -v77, v221, v8
    v_cvt_pk_bf16_f32 v110, v5, v6
    v_cvt_pk_bf16_f32 v126, v7, v8
    v_mul_f32 v5, v78, v206
    v_mul_f32 v7, v94, v206
    v_fma_f32 v5, v94, v222, v5
    v_fma_f32 v7, -v78, v222, v7
    v_mul_f32 v6, v79, v207
    v_mul_f32 v8, v95, v207
    v_fma_f32 v6, v95, v223, v6
    v_fma_f32 v8, -v79, v223, v8
    v_cvt_pk_bf16_f32 v111, v5, v6
    v_cvt_pk_bf16_f32 v127, v7, v8
    v_mfma_f32_32x32x16_bf16 v[32:47], a[96:99], v[96:99], 0
    v_mfma_f32_32x32x16_bf16 v[48:63], a[96:99], v[112:115], 0
    v_mfma_f32_32x32x16_bf16 v[32:47], a[104:107], v[112:115], v[32:47]
    v_mfma_f32_32x32x16_bf16 v[48:63], a[112:115], v[96:99], v[48:63]
    v_mfma_f32_32x32x16_bf16 v[32:47], a[100:103], v[100:103], v[32:47]
    v_mfma_f32_32x32x16_bf16 v[48:63], a[100:103], v[116:119], v[48:63]
    v_mfma_f32_32x32x16_bf16 v[32:47], a[108:111], v[116:119], v[32:47]
    v_mfma_f32_32x32x16_bf16 v[48:63], a[116:119], v[100:103], v[48:63]
    v_mfma_f32_32x32x16_bf16 v[64:79], a[96:99], v[104:107], 0
    v_mfma_f32_32x32x16_bf16 v[80:95], a[96:99], v[120:123], 0
    v_mfma_f32_32x32x16_bf16 v[64:79], a[104:107], v[120:123], v[64:79]
    v_mfma_f32_32x32x16_bf16 v[80:95], a[112:115], v[104:107], v[80:95]
    v_mfma_f32_32x32x16_bf16 v[64:79], a[100:103], v[108:111], v[64:79]
    v_mfma_f32_32x32x16_bf16 v[80:95], a[100:103], v[124:127], v[80:95]
    v_mfma_f32_32x32x16_bf16 v[64:79], a[108:111], v[124:127], v[64:79]
    v_mfma_f32_32x32x16_bf16 v[80:95], a[116:119], v[108:111], v[80:95]
    s_waitcnt vmcnt(0)
    v_lshlrev_b32 v20, 16, v128
    v_and_b32 v22, s38, v128
    v_mul_f32 v5, v32, v20
    v_mul_f32 v7, v48, v20
    v_fma_f32 v5, -v48, v22, v5
    v_fma_f32 v7, v32, v22, v7
    v_lshlrev_b32 v21, 16, v129
    v_and_b32 v23, s38, v129
    v_mul_f32 v6, v33, v21
    v_mul_f32 v8, v49, v21
    v_fma_f32 v6, -v49, v23, v6
    v_fma_f32 v8, v33, v23, v8
    v_cvt_pk_bf16_f32 v96, v5, v6
    v_cvt_pk_bf16_f32 v112, v7, v8
    v_lshlrev_b32 v20, 16, v130
    v_and_b32 v22, s38, v130
    v_mul_f32 v5, v34, v20
    v_mul_f32 v7, v50, v20
    v_fma_f32 v5, -v50, v22, v5
    v_fma_f32 v7, v34, v22, v7
    v_lshlrev_b32 v21, 16, v131
    v_and_b32 v23, s38, v131
    v_mul_f32 v6, v35, v21
    v_mul_f32 v8, v51, v21
    v_fma_f32 v6, -v51, v23, v6
    v_fma_f32 v8, v35, v23, v8
    v_cvt_pk_bf16_f32 v97, v5, v6
    v_cvt_pk_bf16_f32 v113, v7, v8
    v_lshlrev_b32 v20, 16, v132
    v_and_b32 v22, s38, v132
    v_mul_f32 v5, v36, v20
    v_mul_f32 v7, v52, v20
    v_fma_f32 v5, -v52, v22, v5
    v_fma_f32 v7, v36, v22, v7
    v_lshlrev_b32 v21, 16, v133
    v_and_b32 v23, s38, v133
    v_mul_f32 v6, v37, v21
    v_mul_f32 v8, v53, v21
    v_fma_f32 v6, -v53, v23, v6
    v_fma_f32 v8, v37, v23, v8
    v_cvt_pk_bf16_f32 v98, v5, v6
    v_cvt_pk_bf16_f32 v114, v7, v8
    v_lshlrev_b32 v20, 16, v134
    v_and_b32 v22, s38, v134
    v_mul_f32 v5, v38, v20
    v_mul_f32 v7, v54, v20
    v_fma_f32 v5, -v54, v22, v5
    v_fma_f32 v7, v38, v22, v7
    v_lshlrev_b32 v21, 16, v135
    v_and_b32 v23, s38, v135
    v_mul_f32 v6, v39, v21
    v_mul_f32 v8, v55, v21
    v_fma_f32 v6, -v55, v23, v6
    v_fma_f32 v8, v39, v23, v8
    v_cvt_pk_bf16_f32 v99, v5, v6
    v_cvt_pk_bf16_f32 v115, v7, v8
    v_lshlrev_b32 v20, 16, v136
    v_and_b32 v22, s38, v136
    v_mul_f32 v5, v40, v20
    v_mul_f32 v7, v56, v20
    v_fma_f32 v5, -v56, v22, v5
    v_fma_f32 v7, v40, v22, v7
    v_lshlrev_b32 v21, 16, v137
    v_and_b32 v23, s38, v137
    v_mul_f32 v6, v41, v21
    v_mul_f32 v8, v57, v21
    v_fma_f32 v6, -v57, v23, v6
    v_fma_f32 v8, v41, v23, v8
    v_cvt_pk_bf16_f32 v100, v5, v6
    v_cvt_pk_bf16_f32 v116, v7, v8
    v_lshlrev_b32 v20, 16, v138
    v_and_b32 v22, s38, v138
    v_mul_f32 v5, v42, v20
    v_mul_f32 v7, v58, v20
    v_fma_f32 v5, -v58, v22, v5
    v_fma_f32 v7, v42, v22, v7
    v_lshlrev_b32 v21, 16, v139
    v_and_b32 v23, s38, v139
    v_mul_f32 v6, v43, v21
    v_mul_f32 v8, v59, v21
    v_fma_f32 v6, -v59, v23, v6
    v_fma_f32 v8, v43, v23, v8
    v_cvt_pk_bf16_f32 v101, v5, v6
    v_cvt_pk_bf16_f32 v117, v7, v8
    v_lshlrev_b32 v20, 16, v140
    v_and_b32 v22, s38, v140
    v_mul_f32 v5, v44, v20
    v_mul_f32 v7, v60, v20
    v_fma_f32 v5, -v60, v22, v5
    v_fma_f32 v7, v44, v22, v7
    v_lshlrev_b32 v21, 16, v141
    v_and_b32 v23, s38, v141
    v_mul_f32 v6, v45, v21
    v_mul_f32 v8, v61, v21
    v_fma_f32 v6, -v61, v23, v6
    v_fma_f32 v8, v45, v23, v8
    v_cvt_pk_bf16_f32 v102, v5, v6
    v_cvt_pk_bf16_f32 v118, v7, v8
    v_lshlrev_b32 v20, 16, v142
    v_and_b32 v22, s38, v142
    v_mul_f32 v5, v46, v20
    v_mul_f32 v7, v62, v20
    v_fma_f32 v5, -v62, v22, v5
    v_fma_f32 v7, v46, v22, v7
    v_lshlrev_b32 v21, 16, v143
    v_and_b32 v23, s38, v143
    v_mul_f32 v6, v47, v21
    v_mul_f32 v8, v63, v21
    v_fma_f32 v6, -v63, v23, v6
    v_fma_f32 v8, v47, v23, v8
    v_cvt_pk_bf16_f32 v103, v5, v6
    v_cvt_pk_bf16_f32 v119, v7, v8
    v_lshlrev_b32 v20, 16, v144
    v_and_b32 v22, s38, v144
    v_mul_f32 v5, v64, v20
    v_mul_f32 v7, v80, v20
    v_fma_f32 v5, -v80, v22, v5
    v_fma_f32 v7, v64, v22, v7
    v_lshlrev_b32 v21, 16, v145
    v_and_b32 v23, s38, v145
    v_mul_f32 v6, v65, v21
    v_mul_f32 v8, v81, v21
    v_fma_f32 v6, -v81, v23, v6
    v_fma_f32 v8, v65, v23, v8
    v_cvt_pk_bf16_f32 v104, v5, v6
    v_cvt_pk_bf16_f32 v120, v7, v8
    v_lshlrev_b32 v20, 16, v146
    v_and_b32 v22, s38, v146
    v_mul_f32 v5, v66, v20
    v_mul_f32 v7, v82, v20
    v_fma_f32 v5, -v82, v22, v5
    v_fma_f32 v7, v66, v22, v7
    v_lshlrev_b32 v21, 16, v147
    v_and_b32 v23, s38, v147
    v_mul_f32 v6, v67, v21
    v_mul_f32 v8, v83, v21
    v_fma_f32 v6, -v83, v23, v6
    v_fma_f32 v8, v67, v23, v8
    v_cvt_pk_bf16_f32 v105, v5, v6
    v_cvt_pk_bf16_f32 v121, v7, v8
    v_lshlrev_b32 v20, 16, v148
    v_and_b32 v22, s38, v148
    v_mul_f32 v5, v68, v20
    v_mul_f32 v7, v84, v20
    v_fma_f32 v5, -v84, v22, v5
    v_fma_f32 v7, v68, v22, v7
    v_lshlrev_b32 v21, 16, v149
    v_and_b32 v23, s38, v149
    v_mul_f32 v6, v69, v21
    v_mul_f32 v8, v85, v21
    v_fma_f32 v6, -v85, v23, v6
    v_fma_f32 v8, v69, v23, v8
    v_cvt_pk_bf16_f32 v106, v5, v6
    v_cvt_pk_bf16_f32 v122, v7, v8
    v_lshlrev_b32 v20, 16, v150
    v_and_b32 v22, s38, v150
    v_mul_f32 v5, v70, v20
    v_mul_f32 v7, v86, v20
    v_fma_f32 v5, -v86, v22, v5
    v_fma_f32 v7, v70, v22, v7
    v_lshlrev_b32 v21, 16, v151
    v_and_b32 v23, s38, v151
    v_mul_f32 v6, v71, v21
    v_mul_f32 v8, v87, v21
    v_fma_f32 v6, -v87, v23, v6
    v_fma_f32 v8, v71, v23, v8
    v_cvt_pk_bf16_f32 v107, v5, v6
    v_cvt_pk_bf16_f32 v123, v7, v8
    v_lshlrev_b32 v20, 16, v152
    v_and_b32 v22, s38, v152
    v_mul_f32 v5, v72, v20
    v_mul_f32 v7, v88, v20
    v_fma_f32 v5, -v88, v22, v5
    v_fma_f32 v7, v72, v22, v7
    v_lshlrev_b32 v21, 16, v153
    v_and_b32 v23, s38, v153
    v_mul_f32 v6, v73, v21
    v_mul_f32 v8, v89, v21
    v_fma_f32 v6, -v89, v23, v6
    v_fma_f32 v8, v73, v23, v8
    v_cvt_pk_bf16_f32 v108, v5, v6
    v_cvt_pk_bf16_f32 v124, v7, v8
    v_lshlrev_b32 v20, 16, v154
    v_and_b32 v22, s38, v154
    v_mul_f32 v5, v74, v20
    v_mul_f32 v7, v90, v20
    v_fma_f32 v5, -v90, v22, v5
    v_fma_f32 v7, v74, v22, v7
    v_lshlrev_b32 v21, 16, v155
    v_and_b32 v23, s38, v155
    v_mul_f32 v6, v75, v21
    v_mul_f32 v8, v91, v21
    v_fma_f32 v6, -v91, v23, v6
    v_fma_f32 v8, v75, v23, v8
    v_cvt_pk_bf16_f32 v109, v5, v6
    v_cvt_pk_bf16_f32 v125, v7, v8
    v_lshlrev_b32 v20, 16, v156
    v_and_b32 v22, s38, v156
    v_mul_f32 v5, v76, v20
    v_mul_f32 v7, v92, v20
    v_fma_f32 v5, -v92, v22, v5
    v_fma_f32 v7, v76, v22, v7
    v_lshlrev_b32 v21, 16, v157
    v_and_b32 v23, s38, v157
    v_mul_f32 v6, v77, v21
    v_mul_f32 v8, v93, v21
    v_fma_f32 v6, -v93, v23, v6
    v_fma_f32 v8, v77, v23, v8
    v_cvt_pk_bf16_f32 v110, v5, v6
    v_cvt_pk_bf16_f32 v126, v7, v8
    v_lshlrev_b32 v20, 16, v158
    v_and_b32 v22, s38, v158
    v_mul_f32 v5, v78, v20
    v_mul_f32 v7, v94, v20
    v_fma_f32 v5, -v94, v22, v5
    v_fma_f32 v7, v78, v22, v7
    v_lshlrev_b32 v21, 16, v159
    v_and_b32 v23, s38, v159
    v_mul_f32 v6, v79, v21
    v_mul_f32 v8, v95, v21
    v_fma_f32 v6, -v95, v23, v6
    v_fma_f32 v8, v79, v23, v8
    v_cvt_pk_bf16_f32 v111, v5, v6
    v_cvt_pk_bf16_f32 v127, v7, v8
    v_mfma_f32_32x32x16_bf16 v[32:47], v[96:99], a[96:99], 0
    v_mfma_f32_32x32x16_bf16 v[48:63], v[112:115], a[96:99], 0
    v_mfma_f32_32x32x16_bf16 v[32:47], v[112:115], a[112:115], v[32:47]
    v_mfma_f32_32x32x16_bf16 v[48:63], v[96:99], a[104:107], v[48:63]
    v_mfma_f32_32x32x16_bf16 v[32:47], v[100:103], a[100:103], v[32:47]
    v_mfma_f32_32x32x16_bf16 v[48:63], v[116:119], a[100:103], v[48:63]
    v_mfma_f32_32x32x16_bf16 v[32:47], v[116:119], a[116:119], v[32:47]
    v_mfma_f32_32x32x16_bf16 v[48:63], v[100:103], a[108:111], v[48:63]
    v_mfma_f32_32x32x16_bf16 v[64:79], v[104:107], a[96:99], 0
    v_mfma_f32_32x32x16_bf16 v[80:95], v[120:123], a[96:99], 0
    v_mfma_f32_32x32x16_bf16 v[64:79], v[120:123], a[112:115], v[64:79]
    v_mfma_f32_32x32x16_bf16 v[80:95], v[104:107], a[104:107], v[80:95]
    v_mfma_f32_32x32x16_bf16 v[64:79], v[108:111], a[100:103], v[64:79]
    v_mfma_f32_32x32x16_bf16 v[80:95], v[124:127], a[100:103], v[80:95]
    v_mfma_f32_32x32x16_bf16 v[64:79], v[124:127], a[116:119], v[64:79]
    v_mfma_f32_32x32x16_bf16 v[80:95], v[108:111], a[108:111], v[80:95]
    v_mul_f32 v5, v32, v160
    v_mul_f32 v7, v48, v160
    v_fma_f32 v5, -v48, v176, v5
    v_fma_f32 v7, v32, v176, v7
    v_mul_f32 v6, v33, v161
    v_mul_f32 v8, v49, v161
    v_fma_f32 v6, -v49, v177, v6
    v_fma_f32 v8, v33, v177, v8
    v_cvt_pk_bf16_f32 v96, v5, v6
    v_cvt_pk_bf16_f32 v112, v7, v8
    v_mul_f32 v5, v34, v162
    v_mul_f32 v7, v50, v162
    v_fma_f32 v5, -v50, v178, v5
    v_fma_f32 v7, v34, v178, v7
    v_mul_f32 v6, v35, v163
    v_mul_f32 v8, v51, v163
    v_fma_f32 v6, -v51, v179, v6
    v_fma_f32 v8, v35, v179, v8
    v_cvt_pk_bf16_f32 v97, v5, v6
    v_cvt_pk_bf16_f32 v113, v7, v8
    v_mul_f32 v5, v36, v164
    v_mul_f32 v7, v52, v164
    v_fma_f32 v5, -v52, v180, v5
    v_fma_f32 v7, v36, v180, v7
    v_mul_f32 v6, v37, v165
    v_mul_f32 v8, v53, v165
    v_fma_f32 v6, -v53, v181, v6
    v_fma_f32 v8, v37, v181, v8
    v_cvt_pk_bf16_f32 v98, v5, v6
    v_cvt_pk_bf16_f32 v114, v7, v8
    v_mul_f32 v5, v38, v166
    v_mul_f32 v7, v54, v166
    v_fma_f32 v5, -v54, v182, v5
    v_fma_f32 v7, v38, v182, v7
    v_mul_f32 v6, v39, v167
    v_mul_f32 v8, v55, v167
    v_fma_f32 v6, -v55, v183, v6
    v_fma_f32 v8, v39, v183, v8
    v_cvt_pk_bf16_f32 v99, v5, v6
    v_cvt_pk_bf16_f32 v115, v7, v8
    v_mul_f32 v5, v40, v168
    v_mul_f32 v7, v56, v168
    v_fma_f32 v5, -v56, v184, v5
    v_fma_f32 v7, v40, v184, v7
    v_mul_f32 v6, v41, v169
    v_mul_f32 v8, v57, v169
    v_fma_f32 v6, -v57, v185, v6
    v_fma_f32 v8, v41, v185, v8
    v_cvt_pk_bf16_f32 v100, v5, v6
    v_cvt_pk_bf16_f32 v116, v7, v8
    v_mul_f32 v5, v42, v170
    v_mul_f32 v7, v58, v170
    v_fma_f32 v5, -v58, v186, v5
    v_fma_f32 v7, v42, v186, v7
    v_mul_f32 v6, v43, v171
    v_mul_f32 v8, v59, v171
    v_fma_f32 v6, -v59, v187, v6
    v_fma_f32 v8, v43, v187, v8
    v_cvt_pk_bf16_f32 v101, v5, v6
    v_cvt_pk_bf16_f32 v117, v7, v8
    v_mul_f32 v5, v44, v172
    v_mul_f32 v7, v60, v172
    v_fma_f32 v5, -v60, v188, v5
    v_fma_f32 v7, v44, v188, v7
    v_mul_f32 v6, v45, v173
    v_mul_f32 v8, v61, v173
    v_fma_f32 v6, -v61, v189, v6
    v_fma_f32 v8, v45, v189, v8
    v_cvt_pk_bf16_f32 v102, v5, v6
    v_cvt_pk_bf16_f32 v118, v7, v8
    v_mul_f32 v5, v46, v174
    v_mul_f32 v7, v62, v174
    v_fma_f32 v5, -v62, v190, v5
    v_fma_f32 v7, v46, v190, v7
    v_mul_f32 v6, v47, v175
    v_mul_f32 v8, v63, v175
    v_fma_f32 v6, -v63, v191, v6
    v_fma_f32 v8, v47, v191, v8
    v_cvt_pk_bf16_f32 v103, v5, v6
    v_cvt_pk_bf16_f32 v119, v7, v8
    v_mul_f32 v5, v64, v224
    v_mul_f32 v7, v80, v224
    v_fma_f32 v5, -v80, v240, v5
    v_fma_f32 v7, v64, v240, v7
    v_mul_f32 v6, v65, v225
    v_mul_f32 v8, v81, v225
    v_fma_f32 v6, -v81, v241, v6
    v_fma_f32 v8, v65, v241, v8
    v_cvt_pk_bf16_f32 v104, v5, v6
    v_cvt_pk_bf16_f32 v120, v7, v8
    v_mul_f32 v5, v66, v226
    v_mul_f32 v7, v82, v226
    v_fma_f32 v5, -v82, v242, v5
    v_fma_f32 v7, v66, v242, v7
    v_mul_f32 v6, v67, v227
    v_mul_f32 v8, v83, v227
    v_fma_f32 v6, -v83, v243, v6
    v_fma_f32 v8, v67, v243, v8
    v_cvt_pk_bf16_f32 v105, v5, v6
    v_cvt_pk_bf16_f32 v121, v7, v8
    v_mul_f32 v5, v68, v228
    v_mul_f32 v7, v84, v228
    v_fma_f32 v5, -v84, v244, v5
    v_fma_f32 v7, v68, v244, v7
    v_mul_f32 v6, v69, v229
    v_mul_f32 v8, v85, v229
    v_fma_f32 v6, -v85, v245, v6
    v_fma_f32 v8, v69, v245, v8
    v_cvt_pk_bf16_f32 v106, v5, v6
    v_cvt_pk_bf16_f32 v122, v7, v8
    v_mul_f32 v5, v70, v230
    v_mul_f32 v7, v86, v230
    v_fma_f32 v5, -v86, v246, v5
    v_fma_f32 v7, v70, v246, v7
    v_mul_f32 v6, v71, v231
    v_mul_f32 v8, v87, v231
    v_fma_f32 v6, -v87, v247, v6
    v_fma_f32 v8, v71, v247, v8
    v_cvt_pk_bf16_f32 v107, v5, v6
    v_cvt_pk_bf16_f32 v123, v7, v8
    v_mul_f32 v5, v72, v232
    v_mul_f32 v7, v88, v232
    v_fma_f32 v5, -v88, v248, v5
    v_fma_f32 v7, v72, v248, v7
    v_mul_f32 v6, v73, v233
    v_mul_f32 v8, v89, v233
    v_fma_f32 v6, -v89, v249, v6
    v_fma_f32 v8, v73, v249, v8
    v_cvt_pk_bf16_f32 v108, v5, v6
    v_cvt_pk_bf16_f32 v124, v7, v8
    v_mul_f32 v5, v74, v234
    v_mul_f32 v7, v90, v234
    v_fma_f32 v5, -v90, v250, v5
    v_fma_f32 v7, v74, v250, v7
    v_mul_f32 v6, v75, v235
    v_mul_f32 v8, v91, v235
    v_fma_f32 v6, -v91, v251, v6
    v_fma_f32 v8, v75, v251, v8
    v_cvt_pk_bf16_f32 v109, v5, v6
    v_cvt_pk_bf16_f32 v125, v7, v8
    v_mul_f32 v5, v76, v236
    v_mul_f32 v7, v92, v236
    v_fma_f32 v5, -v92, v252, v5
    v_fma_f32 v7, v76, v252, v7
    v_mul_f32 v6, v77, v237
    v_mul_f32 v8, v93, v237
    v_fma_f32 v6, -v93, v253, v6
    v_fma_f32 v8, v77, v253, v8
    v_cvt_pk_bf16_f32 v110, v5, v6
    v_cvt_pk_bf16_f32 v126, v7, v8
    v_mul_f32 v5, v78, v238
    v_mul_f32 v7, v94, v238
    v_fma_f32 v5, -v94, v254, v5
    v_fma_f32 v7, v78, v254, v7
    v_mul_f32 v6, v79, v239
    v_mul_f32 v8, v95, v239
    v_fma_f32 v6, -v95, v255, v6
    v_fma_f32 v8, v79, v255, v8
    v_cvt_pk_bf16_f32 v111, v5, v6
    v_cvt_pk_bf16_f32 v127, v7, v8
    v_mfma_f32_32x32x16_bf16 v[32:47], a[0:3], v[96:99], 0
    v_mfma_f32_32x32x16_bf16 v[48:63], a[0:3], v[112:115], 0
    v_mfma_f32_32x32x16_bf16 v[32:47], a[64:67], v[112:115], v[32:47]
    v_mfma_f32_32x32x16_bf16 v[48:63], a[32:35], v[96:99], v[48:63]
    v_mfma_f32_32x32x16_bf16 v[32:47], a[4:7], v[100:103], v[32:47]
    v_mfma_f32_32x32x16_bf16 v[48:63], a[4:7], v[116:119], v[48:63]
    v_mfma_f32_32x32x16_bf16 v[32:47], a[68:71], v[116:119], v[32:47]
    v_mfma_f32_32x32x16_bf16 v[48:63], a[36:39], v[100:103], v[48:63]
    v_mfma_f32_32x32x16_bf16 v[32:47], a[8:11], v[104:107], v[32:47]
    v_mfma_f32_32x32x16_bf16 v[48:63], a[8:11], v[120:123], v[48:63]
    v_mfma_f32_32x32x16_bf16 v[32:47], a[72:75], v[120:123], v[32:47]
    v_mfma_f32_32x32x16_bf16 v[48:63], a[40:43], v[104:107], v[48:63]
    v_mfma_f32_32x32x16_bf16 v[32:47], a[12:15], v[108:111], v[32:47]
    v_mfma_f32_32x32x16_bf16 v[48:63], a[12:15], v[124:127], v[48:63]
    v_mfma_f32_32x32x16_bf16 v[32:47], a[76:79], v[124:127], v[32:47]
    v_mfma_f32_32x32x16_bf16 v[48:63], a[44:47], v[108:111], v[48:63]
    v_mfma_f32_32x32x16_bf16 v[64:79], a[16:19], v[96:99], 0
    v_mfma_f32_32x32x16_bf16 v[80:95], a[16:19], v[112:115], 0
    v_mfma_f32_32x32x16_bf16 v[64:79], a[80:83], v[112:115], v[64:79]
    v_mfma_f32_32x32x16_bf16 v[80:95], a[48:51], v[96:99], v[80:95]
    v_mfma_f32_32x32x16_bf16 v[64:79], a[20:23], v[100:103], v[64:79]
    v_mfma_f32_32x32x16_bf16 v[80:95], a[20:23], v[116:119], v[80:95]
    v_mfma_f32_32x32x16_bf16 v[64:79], a[84:87], v[116:119], v[64:79]
    v_mfma_f32_32x32x16_bf16 v[80:95], a[52:55], v[100:103], v[80:95]
    v_mfma_f32_32x32x16_bf16 v[64:79], a[24:27], v[104:107], v[64:79]
    v_mfma_f32_32x32x16_bf16 v[80:95], a[24:27], v[120:123], v[80:95]
    v_mfma_f32_32x32x16_bf16 v[64:79], a[88:91], v[120:123], v[64:79]
    v_mfma_f32_32x32x16_bf16 v[80:95], a[56:59], v[104:107], v[80:95]
    v_mfma_f32_32x32x16_bf16 v[64:79], a[28:31], v[108:111], v[64:79]
    v_mfma_f32_32x32x16_bf16 v[80:95], a[28:31], v[124:127], v[80:95]
    v_mfma_f32_32x32x16_bf16 v[64:79], a[92:95], v[124:127], v[64:79]
    v_mfma_f32_32x32x16_bf16 v[80:95], a[60:63], v[108:111], v[80:95]
    v_mul_f32 v32, s35, v32
    v_mul_f32 v48, s35, v48
    v_cvt_pk_bf16_f32 v128, v32, v48
    v_mul_f32 v33, s35, v33
    v_mul_f32 v49, s35, v49
    v_cvt_pk_bf16_f32 v129, v33, v49
    v_mul_f32 v34, s35, v34
    v_mul_f32 v50, s35, v50
    v_cvt_pk_bf16_f32 v130, v34, v50
    v_mul_f32 v35, s35, v35
    v_mul_f32 v51, s35, v51
    v_cvt_pk_bf16_f32 v131, v35, v51
    v_mul_f32 v36, s35, v36
    v_mul_f32 v52, s35, v52
    v_cvt_pk_bf16_f32 v132, v36, v52
    v_mul_f32 v37, s35, v37
    v_mul_f32 v53, s35, v53
    v_cvt_pk_bf16_f32 v133, v37, v53
    v_mul_f32 v38, s35, v38
    v_mul_f32 v54, s35, v54
    v_cvt_pk_bf16_f32 v134, v38, v54
    v_mul_f32 v39, s35, v39
    v_mul_f32 v55, s35, v55
    v_cvt_pk_bf16_f32 v135, v39, v55
    v_mul_f32 v40, s35, v40
    v_mul_f32 v56, s35, v56
    v_cvt_pk_bf16_f32 v136, v40, v56
    v_mul_f32 v41, s35, v41
    v_mul_f32 v57, s35, v57
    v_cvt_pk_bf16_f32 v137, v41, v57
    v_mul_f32 v42, s35, v42
    v_mul_f32 v58, s35, v58
    v_cvt_pk_bf16_f32 v138, v42, v58
    v_mul_f32 v43, s35, v43
    v_mul_f32 v59, s35, v59
    v_cvt_pk_bf16_f32 v139, v43, v59
    v_mul_f32 v44, s35, v44
    v_mul_f32 v60, s35, v60
    v_cvt_pk_bf16_f32 v140, v44, v60
    v_mul_f32 v45, s35, v45
    v_mul_f32 v61, s35, v61
    v_cvt_pk_bf16_f32 v141, v45, v61
    v_mul_f32 v46, s35, v46
    v_mul_f32 v62, s35, v62
    v_cvt_pk_bf16_f32 v142, v46, v62
    v_mul_f32 v47, s35, v47
    v_mul_f32 v63, s35, v63
    v_cvt_pk_bf16_f32 v143, v47, v63
    v_mul_f32 v64, s35, v64
    v_mul_f32 v80, s35, v80
    v_cvt_pk_bf16_f32 v144, v64, v80
    v_mul_f32 v65, s35, v65
    v_mul_f32 v81, s35, v81
    v_cvt_pk_bf16_f32 v145, v65, v81
    v_mul_f32 v66, s35, v66
    v_mul_f32 v82, s35, v82
    v_cvt_pk_bf16_f32 v146, v66, v82
    v_mul_f32 v67, s35, v67
    v_mul_f32 v83, s35, v83
    v_cvt_pk_bf16_f32 v147, v67, v83
    v_mul_f32 v68, s35, v68
    v_mul_f32 v84, s35, v84
    v_cvt_pk_bf16_f32 v148, v68, v84
    v_mul_f32 v69, s35, v69
    v_mul_f32 v85, s35, v85
    v_cvt_pk_bf16_f32 v149, v69, v85
    v_mul_f32 v70, s35, v70
    v_mul_f32 v86, s35, v86
    v_cvt_pk_bf16_f32 v150, v70, v86
    v_mul_f32 v71, s35, v71
    v_mul_f32 v87, s35, v87
    v_cvt_pk_bf16_f32 v151, v71, v87
    v_mul_f32 v72, s35, v72
    v_mul_f32 v88, s35, v88
    v_cvt_pk_bf16_f32 v152, v72, v88
    v_mul_f32 v73, s35, v73
    v_mul_f32 v89, s35, v89
    v_cvt_pk_bf16_f32 v153, v73, v89
    v_mul_f32 v74, s35, v74
    v_mul_f32 v90, s35, v90
    v_cvt_pk_bf16_f32 v154, v74, v90
    v_mul_f32 v75, s35, v75
    v_mul_f32 v91, s35, v91
    v_cvt_pk_bf16_f32 v155, v75, v91
    v_mul_f32 v76, s35, v76
    v_mul_f32 v92, s35, v92
    v_cvt_pk_bf16_f32 v156, v76, v92
    v_mul_f32 v77, s35, v77
    v_mul_f32 v93, s35, v93
    v_cvt_pk_bf16_f32 v157, v77, v93
    v_mul_f32 v78, s35, v78
    v_mul_f32 v94, s35, v94
    v_cvt_pk_bf16_f32 v158, v78, v94
    v_mul_f32 v79, s35, v79
    v_mul_f32 v95, s35, v95
    v_cvt_pk_bf16_f32 v159, v79, v95
    s_cmp_eq_u32 s36, 1
    s_cbranch_scc1 F2_o1
    s_cmp_eq_u32 s36, 2
    s_cbranch_scc1 F2_o2
    s_cmp_eq_u32 s36, 3
    s_cbranch_scc1 F2_o3
    s_cmp_eq_u32 s36, 4
    s_cbranch_scc1 F2_o4
    v_accvgpr_write_b32 a120, v128
    v_accvgpr_write_b32 a124, v129
    v_accvgpr_write_b32 a128, v130
    v_accvgpr_write_b32 a132, v131
    v_accvgpr_write_b32 a136, v132
    v_accvgpr_write_b32 a140, v133
    v_accvgpr_write_b32 a144, v134
    v_accvgpr_write_b32 a148, v135
    v_accvgpr_write_b32 a152, v136
    v_accvgpr_write_b32 a156, v137
    v_accvgpr_write_b32 a160, v138
    v_accvgpr_write_b32 a164, v139
    v_accvgpr_write_b32 a168, v140
    v_accvgpr_write_b32 a172, v141
    v_accvgpr_write_b32 a176, v142
    v_accvgpr_write_b32 a180, v143
    v_accvgpr_write_b32 a184, v144
    v_accvgpr_write_b32 a188, v145
    v_accvgpr_write_b32 a192, v146
    v_accvgpr_write_b32 a196, v147
    v_accvgpr_write_b32 a200, v148
    v_accvgpr_write_b32 a204, v149
    v_accvgpr_write_b32 a208, v150
    v_accvgpr_write_b32 a212, v151
    v_accvgpr_write_b32 a216, v152
    v_accvgpr_write_b32 a220, v153
    v_accvgpr_write_b32 a224, v154
    v_accvgpr_write_b32 a228, v155
    v_accvgpr_write_b32 a232, v156
    v_accvgpr_write_b32 a236, v157
    v_accvgpr_write_b32 a240, v158
    v_accvgpr_write_b32 a244, v159
    s_branch F2_nx
F2_o1:
    v_accvgpr_write_b32 a121, v128
    v_accvgpr_write_b32 a125, v129
    v_accvgpr_write_b32 a129, v130
    v_accvgpr_write_b32 a133, v131
    v_accvgpr_write_b32 a137, v132
    v_accvgpr_write_b32 a141, v133
    v_accvgpr_write_b32 a145, v134
    v_accvgpr_write_b32 a149, v135
    v_accvgpr_write_b32 a153, v136
    v_accvgpr_write_b32 a157, v137
    v_accvgpr_write_b32 a161, v138
    v_accvgpr_write_b32 a165, v139
    v_accvgpr_write_b32 a169, v140
    v_accvgpr_write_b32 a173, v141
    v_accvgpr_write_b32 a177, v142
    v_accvgpr_write_b32 a181, v143
    v_accvgpr_write_b32 a185, v144
    v_accvgpr_write_b32 a189, v145
    v_accvgpr_write_b32 a193, v146
    v_accvgpr_write_b32 a197, v147
    v_accvgpr_write_b32 a201, v148
    v_accvgpr_write_b32 a205, v149
    v_accvgpr_write_b32 a209, v150
    v_accvgpr_write_b32 a213, v151
    v_accvgpr_write_b32 a217, v152
    v_accvgpr_write_b32 a221, v153
    v_accvgpr_write_b32 a225, v154
    v_accvgpr_write_b32 a229, v155
    v_accvgpr_write_b32 a233, v156
    v_accvgpr_write_b32 a237, v157
    v_accvgpr_write_b32 a241, v158
    v_accvgpr_write_b32 a245, v159
    s_branch F2_nx
F2_o2:
    v_accvgpr_write_b32 a122, v128
    v_accvgpr_write_b32 a126, v129
    v_accvgpr_write_b32 a130, v130
    v_accvgpr_write_b32 a134, v131
    v_accvgpr_write_b32 a138, v132
    v_accvgpr_write_b32 a142, v133
    v_accvgpr_write_b32 a146, v134
    v_accvgpr_write_b32 a150, v135
    v_accvgpr_write_b32 a154, v136
    v_accvgpr_write_b32 a158, v137
    v_accvgpr_write_b32 a162, v138
    v_accvgpr_write_b32 a166, v139
    v_accvgpr_write_b32 a170, v140
    v_accvgpr_write_b32 a174, v141
    v_accvgpr_write_b32 a178, v142
    v_accvgpr_write_b32 a182, v143
    v_accvgpr_write_b32 a186, v144
    v_accvgpr_write_b32 a190, v145
    v_accvgpr_write_b32 a194, v146
    v_accvgpr_write_b32 a198, v147
    v_accvgpr_write_b32 a202, v148
    v_accvgpr_write_b32 a206, v149
    v_accvgpr_write_b32 a210, v150
    v_accvgpr_write_b32 a214, v151
    v_accvgpr_write_b32 a218, v152
    v_accvgpr_write_b32 a222, v153
    v_accvgpr_write_b32 a226, v154
    v_accvgpr_write_b32 a230, v155
    v_accvgpr_write_b32 a234, v156
    v_accvgpr_write_b32 a238, v157
    v_accvgpr_write_b32 a242, v158
    v_accvgpr_write_b32 a246, v159
    s_branch F2_nx
F2_o3:
    v_accvgpr_write_b32 a123, v128
    v_accvgpr_write_b32 a127, v129
    v_accvgpr_write_b32 a131, v130
    v_accvgpr_write_b32 a135, v131
    v_accvgpr_write_b32 a139, v132
    v_accvgpr_write_b32 a143, v133
    v_accvgpr_write_b32 a147, v134
    v_accvgpr_write_b32 a151, v135
    v_accvgpr_write_b32 a155, v136
    v_accvgpr_write_b32 a159, v137
    v_accvgpr_write_b32 a163, v138
    v_accvgpr_write_b32 a167, v139
    v_accvgpr_write_b32 a171, v140
    v_accvgpr_write_b32 a175, v141
    v_accvgpr_write_b32 a179, v142
    v_accvgpr_write_b32 a183, v143
    v_accvgpr_write_b32 a187, v144
    v_accvgpr_write_b32 a191, v145
    v_accvgpr_write_b32 a195, v146
    v_accvgpr_write_b32 a199, v147
    v_accvgpr_write_b32 a203, v148
    v_accvgpr_write_b32 a207, v149
    v_accvgpr_write_b32 a211, v150
    v_accvgpr_write_b32 a215, v151
    v_accvgpr_write_b32 a219, v152
    v_accvgpr_write_b32 a223, v153
    v_accvgpr_write_b32 a227, v154
    v_accvgpr_write_b32 a231, v155
    v_accvgpr_write_b32 a235, v156
    v_accvgpr_write_b32 a239, v157
    v_accvgpr_write_b32 a243, v158
    v_accvgpr_write_b32 a247, v159
    s_branch F2_nx
F2_o4:
    v_accvgpr_read_b32 v5, a120
    v_lshlrev_b32 v6, 16, v128
    v_bfi_b32 v5, s38, v6, v5
    v_accvgpr_write_b32 a120, v5
    v_accvgpr_read_b32 v5, a124
    v_lshlrev_b32 v6, 16, v129
    v_bfi_b32 v5, s38, v6, v5
    v_accvgpr_write_b32 a124, v5
    v_accvgpr_read_b32 v5, a128
    v_lshlrev_b32 v6, 16, v130
    v_bfi_b32 v5, s38, v6, v5
    v_accvgpr_write_b32 a128, v5
    v_accvgpr_read_b32 v5, a132
    v_lshlrev_b32 v6, 16, v131
    v_bfi_b32 v5, s38, v6, v5
    v_accvgpr_write_b32 a132, v5
    v_accvgpr_read_b32 v5, a136
    v_lshlrev_b32 v6, 16, v132
    v_bfi_b32 v5, s38, v6, v5
    v_accvgpr_write_b32 a136, v5
    v_accvgpr_read_b32 v5, a140
    v_lshlrev_b32 v6, 16, v133
    v_bfi_b32 v5, s38, v6, v5
    v_accvgpr_write_b32 a140, v5
    v_accvgpr_read_b32 v5, a144
    v_lshlrev_b32 v6, 16, v134
    v_bfi_b32 v5, s38, v6, v5
    v_accvgpr_write_b32 a144, v5
    v_accvgpr_read_b32 v5, a148
    v_lshlrev_b32 v6, 16, v135
    v_bfi_b32 v5, s38, v6, v5
    v_accvgpr_write_b32 a148, v5
    v_accvgpr_read_b32 v5, a152
    v_lshlrev_b32 v6, 16, v136
    v_bfi_b32 v5, s38, v6, v5
    v_accvgpr_write_b32 a152, v5
    v_accvgpr_read_b32 v5, a156
    v_lshlrev_b32 v6, 16, v137
    v_bfi_b32 v5, s38, v6, v5
    v_accvgpr_write_b32 a156, v5
    v_accvgpr_read_b32 v5, a160
    v_lshlrev_b32 v6, 16, v138
    v_bfi_b32 v5, s38, v6, v5
    v_accvgpr_write_b32 a160, v5
    v_accvgpr_read_b32 v5, a164
    v_lshlrev_b32 v6, 16, v139
    v_bfi_b32 v5, s38, v6, v5
    v_accvgpr_write_b32 a164, v5
    v_accvgpr_read_b32 v5, a168
    v_lshlrev_b32 v6, 16, v140
    v_bfi_b32 v5, s38, v6, v5
    v_accvgpr_write_b32 a168, v5
    v_accvgpr_read_b32 v5, a172
    v_lshlrev_b32 v6, 16, v141
    v_bfi_b32 v5, s38, v6, v5
    v_accvgpr_write_b32 a172, v5
    v_accvgpr_read_b32 v5, a176
    v_lshlrev_b32 v6, 16, v142
    v_bfi_b32 v5, s38, v6, v5
    v_accvgpr_write_b32 a176, v5
    v_accvgpr_read_b32 v5, a180
    v_lshlrev_b32 v6, 16, v143
    v_bfi_b32 v5, s38, v6, v5
    v_accvgpr_write_b32 a180, v5
    v_accvgpr_read_b32 v5, a184
    v_lshlrev_b32 v6, 16, v144
    v_bfi_b32 v5, s38, v6, v5
    v_accvgpr_write_b32 a184, v5
    v_accvgpr_read_b32 v5, a188
    v_lshlrev_b32 v6, 16, v145
    v_bfi_b32 v5, s38, v6, v5
    v_accvgpr_write_b32 a188, v5
    v_accvgpr_read_b32 v5, a192
    v_lshlrev_b32 v6, 16, v146
    v_bfi_b32 v5, s38, v6, v5
    v_accvgpr_write_b32 a192, v5
    v_accvgpr_read_b32 v5, a196
    v_lshlrev_b32 v6, 16, v147
    v_bfi_b32 v5, s38, v6, v5
    v_accvgpr_write_b32 a196, v5
    v_accvgpr_read_b32 v5, a200
    v_lshlrev_b32 v6, 16, v148
    v_bfi_b32 v5, s38, v6, v5
    v_accvgpr_write_b32 a200, v5
    v_accvgpr_read_b32 v5, a204
    v_lshlrev_b32 v6, 16, v149
    v_bfi_b32 v5, s38, v6, v5
    v_accvgpr_write_b32 a204, v5
    v_accvgpr_read_b32 v5, a208
    v_lshlrev_b32 v6, 16, v150
    v_bfi_b32 v5, s38, v6, v5
    v_accvgpr_write_b32 a208, v5
    v_accvgpr_read_b32 v5, a212
    v_lshlrev_b32 v6, 16, v151
    v_bfi_b32 v5, s38, v6, v5
    v_accvgpr_write_b32 a212, v5
    v_accvgpr_read_b32 v5, a216
    v_lshlrev_b32 v6, 16, v152
    v_bfi_b32 v5, s38, v6, v5
    v_accvgpr_write_b32 a216, v5
    v_accvgpr_read_b32 v5, a220
    v_lshlrev_b32 v6, 16, v153
    v_bfi_b32 v5, s38, v6, v5
    v_accvgpr_write_b32 a220, v5
    v_accvgpr_read_b32 v5, a224
    v_lshlrev_b32 v6, 16, v154
    v_bfi_b32 v5, s38, v6, v5
    v_accvgpr_write_b32 a224, v5
    v_accvgpr_read_b32 v5, a228
    v_lshlrev_b32 v6, 16, v155
    v_bfi_b32 v5, s38, v6, v5
    v_accvgpr_write_b32 a228, v5
    v_accvgpr_read_b32 v5, a232
    v_lshlrev_b32 v6, 16, v156
    v_bfi_b32 v5, s38, v6, v5
    v_accvgpr_write_b32 a232, v5
    v_accvgpr_read_b32 v5, a236
    v_lshlrev_b32 v6, 16, v157
    v_bfi_b32 v5, s38, v6, v5
    v_accvgpr_write_b32 a236, v5
    v_accvgpr_read_b32 v5, a240
    v_lshlrev_b32 v6, 16, v158
    v_bfi_b32 v5, s38, v6, v5
    v_accvgpr_write_b32 a240, v5
    v_accvgpr_read_b32 v5, a244
    v_lshlrev_b32 v6, 16, v159
    v_bfi_b32 v5, s38, v6, v5
    v_accvgpr_write_b32 a244, v5
F2_nx:
    s_add_u32 s36, s36, 1
    s_add_u32 s32, s32, 128
    s_add_u32 s33, s32, 64
    s_add_u32 s34, s34, 8192
    s_mov_b32 s35, 897581056
    s_cmp_eq_u32 s36, 4
    s_cselect_b32 s32, 104857664, s32
    s_cselect_b32 s33, 1073741824, s33
    s_cselect_b32 s34, 121634816, s34
    s_cselect_b32 s35, 889192448, s35
    s_cmp_lt_u32 s36, s37
    s_cbranch_scc1 F2_top
    s_mul_i32 s21, s31, 33024
    s_add_u32 s21, s21, 111149056
    s_add_u32 s17, s21, 0
    buffer_store_dwordx4 a[120:123], v18, s[4:7], s17 offen offset:0 sc1
    buffer_store_dwordx4 a[124:127], v18, s[4:7], s17 offen offset:512 sc1
    buffer_store_dwordx4 a[128:131], v18, s[4:7], s17 offen offset:1024 sc1
    buffer_store_dwordx4 a[132:135], v18, s[4:7], s17 offen offset:1536 sc1
    buffer_store_dwordx4 a[136:139], v18, s[4:7], s17 offen offset:2048 sc1
    buffer_store_dwordx4 a[140:143], v18, s[4:7], s17 offen offset:2560 sc1
    buffer_store_dwordx4 a[144:147], v18, s[4:7], s17 offen offset:3072 sc1
    buffer_store_dwordx4 a[148:151], v18, s[4:7], s17 offen offset:3584 sc1
    s_add_u32 s17, s21, 8192
    buffer_store_dwordx4 a[152:155], v18, s[4:7], s17 offen offset:0 sc1
    buffer_store_dwordx4 a[156:159], v18, s[4:7], s17 offen offset:512 sc1
    buffer_store_dwordx4 a[160:163], v18, s[4:7], s17 offen offset:1024 sc1
    buffer_store_dwordx4 a[164:167], v18, s[4:7], s17 offen offset:1536 sc1
    buffer_store_dwordx4 a[168:171], v18, s[4:7], s17 offen offset:2048 sc1
    buffer_store_dwordx4 a[172:175], v18, s[4:7], s17 offen offset:2560 sc1
    buffer_store_dwordx4 a[176:179], v18, s[4:7], s17 offen offset:3072 sc1
    buffer_store_dwordx4 a[180:183], v18, s[4:7], s17 offen offset:3584 sc1
    s_add_u32 s17, s21, 16384
    buffer_store_dwordx4 a[184:187], v18, s[4:7], s17 offen offset:0 sc1
    buffer_store_dwordx4 a[188:191], v18, s[4:7], s17 offen offset:512 sc1
    buffer_store_dwordx4 a[192:195], v18, s[4:7], s17 offen offset:1024 sc1
    buffer_store_dwordx4 a[196:199], v18, s[4:7], s17 offen offset:1536 sc1
    buffer_store_dwordx4 a[200:203], v18, s[4:7], s17 offen offset:2048 sc1
    buffer_store_dwordx4 a[204:207], v18, s[4:7], s17 offen offset:2560 sc1
    buffer_store_dwordx4 a[208:211], v18, s[4:7], s17 offen offset:3072 sc1
    buffer_store_dwordx4 a[212:215], v18, s[4:7], s17 offen offset:3584 sc1
    s_add_u32 s17, s21, 24576
    buffer_store_dwordx4 a[216:219], v18, s[4:7], s17 offen offset:0 sc1
    buffer_store_dwordx4 a[220:223], v18, s[4:7], s17 offen offset:512 sc1
    buffer_store_dwordx4 a[224:227], v18, s[4:7], s17 offen offset:1024 sc1
    buffer_store_dwordx4 a[228:231], v18, s[4:7], s17 offen offset:1536 sc1
    buffer_store_dwordx4 a[232:235], v18, s[4:7], s17 offen offset:2048 sc1
    buffer_store_dwordx4 a[236:239], v18, s[4:7], s17 offen offset:2560 sc1
    buffer_store_dwordx4 a[240:243], v18, s[4:7], s17 offen offset:3072 sc1
    buffer_store_dwordx4 a[244:247], v18, s[4:7], s17 offen offset:3584 sc1
    s_waitcnt vmcnt(0)
    s_lshl_b32 s17, s31, 7
    s_add_u32 s17, s17, 100761600
    v_lshl_add_u32 v5, v1, 2, s17
    v_mov_b32 v6, 1
    s_mov_b64 exec, 0xffffffff
    buffer_store_dword v6, v5, s[4:7], 0 offen sc1
    s_mov_b64 exec, -1
    v_bfe_u32 v5, v1, 2, 2
    v_and_b32 v7, 3, v1
    v_lshl_add_u32 v7, v5, 3, v7
    s_lshl_b32 s17, s29, 5
    v_add_u32 v7, s17, v7
    v_lshrrev_b32 v8, 4, v1
    v_cvt_f32_u32 v8, v8
    s_mov_b32 s31, 981467136
    v_and_b32 v38, 1, v7
    v_add_u32 v5, 0, v7
    v_cvt_f32_u32 v6, v5
    v_mul_f32 v6, s31, v6
    v_mov_b32 v32, 0x3e800000
    v_sub_f32 v34, v6, v32
    v_mul_f32 v36, 0x41800000, v6
    v_mul_f32 v5, 4.0, v6
    v_mul_f32 v30, v5, v8
    v_add_u32 v5, 4, v7
    v_cvt_f32_u32 v6, v5
    v_mul_f32 v6, s31, v6
    v_mov_b32 v33, 0x3e800000
    v_sub_f32 v35, v6, v33
    v_mul_f32 v37, 0x41800000, v6
    v_mul_f32 v5, 4.0, v6
    v_mul_f32 v31, v5, v8
    v_lshlrev_b32 v40, 4, v38
    v_bfe_u32 v5, v7, 1, 1
    v_add_u32 v6, 1, v7
    v_bfe_u32 v6, v6, 1, 1
    v_lshlrev_b32 v5, 15, v5
    v_lshl_or_b32 v41, v6, 31, v5
    v_fract_f32 v48, v30
    v_add_f32 v49, v48, v32
    v_cos_f32 v56, v48
    v_add_f32 v50, v49, v34
    v_cos_f32 v57, v49
    v_add_f32 v51, v50, v32
    v_cos_f32 v58, v50
    v_add_f32 v52, v51, v34
    v_cos_f32 v59, v51
    v_add_f32 v53, v52, v32
    v_cos_f32 v60, v52
    v_add_f32 v54, v53, v34
    v_cos_f32 v61, v53
    v_add_f32 v55, v54, v32
    v_cos_f32 v62, v54
    v_cos_f32 v63, v55
    v_add_f32 v30, v48, v36
    v_cvt_pk_bf16_f32 v64, v56, v57
    v_cvt_pk_bf16_f32 v65, v58, v59
    v_cvt_pk_bf16_f32 v66, v60, v61
    v_cvt_pk_bf16_f32 v67, v62, v63
    v_accvgpr_write_b32 a0, v64
    v_accvgpr_write_b32 a1, v65
    v_accvgpr_write_b32 a2, v66
    v_accvgpr_write_b32 a3, v67
    v_alignbit_b32 v68, v64, v64, v40
    v_xor_b32 v68, v68, v41
    v_alignbit_b32 v69, v65, v65, v40
    v_xor_b32 v69, v69, v41
    v_alignbit_b32 v70, v66, v66, v40
    v_xor_b32 v70, v70, v41
    v_alignbit_b32 v71, v67, v67, v40
    v_xor_b32 v71, v71, v41
    v_accvgpr_write_b32 a128, v68
    v_accvgpr_write_b32 a129, v69
    v_accvgpr_write_b32 a130, v70
    v_accvgpr_write_b32 a131, v71
    v_fract_f32 v48, v31
    v_add_f32 v49, v48, v33
    v_cos_f32 v56, v48
    v_add_f32 v50, v49, v35
    v_cos_f32 v57, v49
    v_add_f32 v51, v50, v33
    v_cos_f32 v58, v50
    v_add_f32 v52, v51, v35
    v_cos_f32 v59, v51
    v_add_f32 v53, v52, v33
    v_cos_f32 v60, v52
    v_add_f32 v54, v53, v35
    v_cos_f32 v61, v53
    v_add_f32 v55, v54, v33
    v_cos_f32 v62, v54
    v_cos_f32 v63, v55
    v_add_f32 v31, v48, v37
    v_cvt_pk_bf16_f32 v64, v56, v57
    v_cvt_pk_bf16_f32 v65, v58, v59
    v_cvt_pk_bf16_f32 v66, v60, v61
    v_cvt_pk_bf16_f32 v67, v62, v63
    v_accvgpr_write_b32 a4, v64
    v_accvgpr_write_b32 a5, v65
    v_accvgpr_write_b32 a6, v66
    v_accvgpr_write_b32 a7, v67
    v_alignbit_b32 v68, v64, v64, v40
    v_xor_b32 v68, v68, v41
    v_alignbit_b32 v69, v65, v65, v40
    v_xor_b32 v69, v69, v41
    v_alignbit_b32 v70, v66, v66, v40
    v_xor_b32 v70, v70, v41
    v_alignbit_b32 v71, v67, v67, v40
    v_xor_b32 v71, v71, v41
    v_accvgpr_write_b32 a132, v68
    v_accvgpr_write_b32 a133, v69
    v_accvgpr_write_b32 a134, v70
    v_accvgpr_write_b32 a135, v71
    v_fract_f32 v48, v30
    v_add_f32 v49, v48, v32
    v_cos_f32 v56, v48
    v_add_f32 v50, v49, v34
    v_cos_f32 v57, v49
    v_add_f32 v51, v50, v32
    v_cos_f32 v58, v50
    v_add_f32 v52, v51, v34
    v_cos_f32 v59, v51
    v_add_f32 v53, v52, v32
    v_cos_f32 v60, v52
    v_add_f32 v54, v53, v34
    v_cos_f32 v61, v53
    v_add_f32 v55, v54, v32
    v_cos_f32 v62, v54
    v_cos_f32 v63, v55
    v_add_f32 v30, v48, v36
    v_cvt_pk_bf16_f32 v64, v56, v57
    v_cvt_pk_bf16_f32 v65, v58, v59
    v_cvt_pk_bf16_f32 v66, v60, v61
    v_cvt_pk_bf16_f32 v67, v62, v63
    v_accvgpr_write_b32 a8, v64
    v_accvgpr_write_b32 a9, v65
    v_accvgpr_write_b32 a10, v66
    v_accvgpr_write_b32 a11, v67
    v_alignbit_b32 v68, v64, v64, v40
    v_xor_b32 v68, v68, v41
    v_alignbit_b32 v69, v65, v65, v40
    v_xor_b32 v69, v69, v41
    v_alignbit_b32 v70, v66, v66, v40
    v_xor_b32 v70, v70, v41
    v_alignbit_b32 v71, v67, v67, v40
    v_xor_b32 v71, v71, v41
    v_accvgpr_write_b32 a136, v68
    v_accvgpr_write_b32 a137, v69
    v_accvgpr_write_b32 a138, v70
    v_accvgpr_write_b32 a139, v71
    v_fract_f32 v48, v31
    v_add_f32 v49, v48, v33
    v_cos_f32 v56, v48
    v_add_f32 v50, v49, v35
    v_cos_f32 v57, v49
    v_add_f32 v51, v50, v33
    v_cos_f32 v58, v50
    v_add_f32 v52, v51, v35
    v_cos_f32 v59, v51
    v_add_f32 v53, v52, v33
    v_cos_f32 v60, v52
    v_add_f32 v54, v53, v35
    v_cos_f32 v61, v53
    v_add_f32 v55, v54, v33
    v_cos_f32 v62, v54
    v_cos_f32 v63, v55
    v_add_f32 v31, v48, v37
    v_cvt_pk_bf16_f32 v64, v56, v57
    v_cvt_pk_bf16_f32 v65, v58, v59
    v_cvt_pk_bf16_f32 v66, v60, v61
    v_cvt_pk_bf16_f32 v67, v62, v63
    v_accvgpr_write_b32 a12, v64
    v_accvgpr_write_b32 a13, v65
    v_accvgpr_write_b32 a14, v66
    v_accvgpr_write_b32 a15, v67
    v_alignbit_b32 v68, v64, v64, v40
    v_xor_b32 v68, v68, v41
    v_alignbit_b32 v69, v65, v65, v40
    v_xor_b32 v69, v69, v41
    v_alignbit_b32 v70, v66, v66, v40
    v_xor_b32 v70, v70, v41
    v_alignbit_b32 v71, v67, v67, v40
    v_xor_b32 v71, v71, v41
    v_accvgpr_write_b32 a140, v68
    v_accvgpr_write_b32 a141, v69
    v_accvgpr_write_b32 a142, v70
    v_accvgpr_write_b32 a143, v71
    v_fract_f32 v48, v30
    v_add_f32 v49, v48, v32
    v_cos_f32 v56, v48
    v_add_f32 v50, v49, v34
    v_cos_f32 v57, v49
    v_add_f32 v51, v50, v32
    v_cos_f32 v58, v50
    v_add_f32 v52, v51, v34
    v_cos_f32 v59, v51
    v_add_f32 v53, v52, v32
    v_cos_f32 v60, v52
    v_add_f32 v54, v53, v34
    v_cos_f32 v61, v53
    v_add_f32 v55, v54, v32
    v_cos_f32 v62, v54
    v_cos_f32 v63, v55
    v_add_f32 v30, v48, v36
    v_cvt_pk_bf16_f32 v64, v56, v57
    v_cvt_pk_bf16_f32 v65, v58, v59
    v_cvt_pk_bf16_f32 v66, v60, v61
    v_cvt_pk_bf16_f32 v67, v62, v63
    v_accvgpr_write_b32 a16, v64
    v_accvgpr_write_b32 a17, v65
    v_accvgpr_write_b32 a18, v66
    v_accvgpr_write_b32 a19, v67
    v_alignbit_b32 v68, v64, v64, v40
    v_xor_b32 v68, v68, v41
    v_alignbit_b32 v69, v65, v65, v40
    v_xor_b32 v69, v69, v41
    v_alignbit_b32 v70, v66, v66, v40
    v_xor_b32 v70, v70, v41
    v_alignbit_b32 v71, v67, v67, v40
    v_xor_b32 v71, v71, v41
    v_accvgpr_write_b32 a144, v68
    v_accvgpr_write_b32 a145, v69
    v_accvgpr_write_b32 a146, v70
    v_accvgpr_write_b32 a147, v71
    v_fract_f32 v48, v31
    v_add_f32 v49, v48, v33
    v_cos_f32 v56, v48
    v_add_f32 v50, v49, v35
    v_cos_f32 v57, v49
    v_add_f32 v51, v50, v33
    v_cos_f32 v58, v50
    v_add_f32 v52, v51, v35
    v_cos_f32 v59, v51
    v_add_f32 v53, v52, v33
    v_cos_f32 v60, v52
    v_add_f32 v54, v53, v35
    v_cos_f32 v61, v53
    v_add_f32 v55, v54, v33
    v_cos_f32 v62, v54
    v_cos_f32 v63, v55
    v_add_f32 v31, v48, v37
    v_cvt_pk_bf16_f32 v64, v56, v57
    v_cvt_pk_bf16_f32 v65, v58, v59
    v_cvt_pk_bf16_f32 v66, v60, v61
    v_cvt_pk_bf16_f32 v67, v62, v63
    v_accvgpr_write_b32 a20, v64
    v_accvgpr_write_b32 a21, v65
    v_accvgpr_write_b32 a22, v66
    v_accvgpr_write_b32 a23, v67
    v_alignbit_b32 v68, v64, v64, v40
    v_xor_b32 v68, v68, v41
    v_alignbit_b32 v69, v65, v65, v40
    v_xor_b32 v69, v69, v41
    v_alignbit_b32 v70, v66, v66, v40
    v_xor_b32 v70, v70, v41
    v_alignbit_b32 v71, v67, v67, v40
    v_xor_b32 v71, v71, v41
    v_accvgpr_write_b32 a148, v68
    v_accvgpr_write_b32 a149, v69
    v_accvgpr_write_b32 a150, v70
    v_accvgpr_write_b32 a151, v71
    v_fract_f32 v48, v30
    v_add_f32 v49, v48, v32
    v_cos_f32 v56, v48
    v_add_f32 v50, v49, v34
    v_cos_f32 v57, v49
    v_add_f32 v51, v50, v32
    v_cos_f32 v58, v50
    v_add_f32 v52, v51, v34
    v_cos_f32 v59, v51
    v_add_f32 v53, v52, v32
    v_cos_f32 v60, v52
    v_add_f32 v54, v53, v34
    v_cos_f32 v61, v53
    v_add_f32 v55, v54, v32
    v_cos_f32 v62, v54
    v_cos_f32 v63, v55
    v_add_f32 v30, v48, v36
    v_cvt_pk_bf16_f32 v64, v56, v57
    v_cvt_pk_bf16_f32 v65, v58, v59
    v_cvt_pk_bf16_f32 v66, v60, v61
    v_cvt_pk_bf16_f32 v67, v62, v63
    v_accvgpr_write_b32 a24, v64
    v_accvgpr_write_b32 a25, v65
    v_accvgpr_write_b32 a26, v66
    v_accvgpr_write_b32 a27, v67
    v_alignbit_b32 v68, v64, v64, v40
    v_xor_b32 v68, v68, v41
    v_alignbit_b32 v69, v65, v65, v40
    v_xor_b32 v69, v69, v41
    v_alignbit_b32 v70, v66, v66, v40
    v_xor_b32 v70, v70, v41
    v_alignbit_b32 v71, v67, v67, v40
    v_xor_b32 v71, v71, v41
    v_accvgpr_write_b32 a152, v68
    v_accvgpr_write_b32 a153, v69
    v_accvgpr_write_b32 a154, v70
    v_accvgpr_write_b32 a155, v71
    v_fract_f32 v48, v31
    v_add_f32 v49, v48, v33
    v_cos_f32 v56, v48
    v_add_f32 v50, v49, v35
    v_cos_f32 v57, v49
    v_add_f32 v51, v50, v33
    v_cos_f32 v58, v50
    v_add_f32 v52, v51, v35
    v_cos_f32 v59, v51
    v_add_f32 v53, v52, v33
    v_cos_f32 v60, v52
    v_add_f32 v54, v53, v35
    v_cos_f32 v61, v53
    v_add_f32 v55, v54, v33
    v_cos_f32 v62, v54
    v_cos_f32 v63, v55
    v_add_f32 v31, v48, v37
    v_cvt_pk_bf16_f32 v64, v56, v57
    v_cvt_pk_bf16_f32 v65, v58, v59
    v_cvt_pk_bf16_f32 v66, v60, v61
    v_cvt_pk_bf16_f32 v67, v62, v63
    v_accvgpr_write_b32 a28, v64
    v_accvgpr_write_b32 a29, v65
    v_accvgpr_write_b32 a30, v66
    v_accvgpr_write_b32 a31, v67
    v_alignbit_b32 v68, v64, v64, v40
    v_xor_b32 v68, v68, v41
    v_alignbit_b32 v69, v65, v65, v40
    v_xor_b32 v69, v69, v41
    v_alignbit_b32 v70, v66, v66, v40
    v_xor_b32 v70, v70, v41
    v_alignbit_b32 v71, v67, v67, v40
    v_xor_b32 v71, v71, v41
    v_accvgpr_write_b32 a156, v68
    v_accvgpr_write_b32 a157, v69
    v_accvgpr_write_b32 a158, v70
    v_accvgpr_write_b32 a159, v71
    v_fract_f32 v48, v30
    v_add_f32 v49, v48, v32
    v_cos_f32 v56, v48
    v_add_f32 v50, v49, v34
    v_cos_f32 v57, v49
    v_add_f32 v51, v50, v32
    v_cos_f32 v58, v50
    v_add_f32 v52, v51, v34
    v_cos_f32 v59, v51
    v_add_f32 v53, v52, v32
    v_cos_f32 v60, v52
    v_add_f32 v54, v53, v34
    v_cos_f32 v61, v53
    v_add_f32 v55, v54, v32
    v_cos_f32 v62, v54
    v_cos_f32 v63, v55
    v_add_f32 v30, v48, v36
    v_cvt_pk_bf16_f32 v64, v56, v57
    v_cvt_pk_bf16_f32 v65, v58, v59
    v_cvt_pk_bf16_f32 v66, v60, v61
    v_cvt_pk_bf16_f32 v67, v62, v63
    v_accvgpr_write_b32 a32, v64
    v_accvgpr_write_b32 a33, v65
    v_accvgpr_write_b32 a34, v66
    v_accvgpr_write_b32 a35, v67
    v_alignbit_b32 v68, v64, v64, v40
    v_xor_b32 v68, v68, v41
    v_alignbit_b32 v69, v65, v65, v40
    v_xor_b32 v69, v69, v41
    v_alignbit_b32 v70, v66, v66, v40
    v_xor_b32 v70, v70, v41
    v_alignbit_b32 v71, v67, v67, v40
    v_xor_b32 v71, v71, v41
    v_accvgpr_write_b32 a160, v68
    v_accvgpr_write_b32 a161, v69
    v_accvgpr_write_b32 a162, v70
    v_accvgpr_write_b32 a163, v71
    v_fract_f32 v48, v31
    v_add_f32 v49, v48, v33
    v_cos_f32 v56, v48
    v_add_f32 v50, v49, v35
    v_cos_f32 v57, v49
    v_add_f32 v51, v50, v33
    v_cos_f32 v58, v50
    v_add_f32 v52, v51, v35
    v_cos_f32 v59, v51
    v_add_f32 v53, v52, v33
    v_cos_f32 v60, v52
    v_add_f32 v54, v53, v35
    v_cos_f32 v61, v53
    v_add_f32 v55, v54, v33
    v_cos_f32 v62, v54
    v_cos_f32 v63, v55
    v_add_f32 v31, v48, v37
    v_cvt_pk_bf16_f32 v64, v56, v57
    v_cvt_pk_bf16_f32 v65, v58, v59
    v_cvt_pk_bf16_f32 v66, v60, v61
    v_cvt_pk_bf16_f32 v67, v62, v63
    v_accvgpr_write_b32 a36, v64
    v_accvgpr_write_b32 a37, v65
    v_accvgpr_write_b32 a38, v66
    v_accvgpr_write_b32 a39, v67
    v_alignbit_b32 v68, v64, v64, v40
    v_xor_b32 v68, v68, v41
    v_alignbit_b32 v69, v65, v65, v40
    v_xor_b32 v69, v69, v41
    v_alignbit_b32 v70, v66, v66, v40
    v_xor_b32 v70, v70, v41
    v_alignbit_b32 v71, v67, v67, v40
    v_xor_b32 v71, v71, v41
    v_accvgpr_write_b32 a164, v68
    v_accvgpr_write_b32 a165, v69
    v_accvgpr_write_b32 a166, v70
    v_accvgpr_write_b32 a167, v71
    v_fract_f32 v48, v30
    v_add_f32 v49, v48, v32
    v_cos_f32 v56, v48
    v_add_f32 v50, v49, v34
    v_cos_f32 v57, v49
    v_add_f32 v51, v50, v32
    v_cos_f32 v58, v50
    v_add_f32 v52, v51, v34
    v_cos_f32 v59, v51
    v_add_f32 v53, v52, v32
    v_cos_f32 v60, v52
    v_add_f32 v54, v53, v34
    v_cos_f32 v61, v53
    v_add_f32 v55, v54, v32
    v_cos_f32 v62, v54
    v_cos_f32 v63, v55
    v_add_f32 v30, v48, v36
    v_cvt_pk_bf16_f32 v64, v56, v57
    v_cvt_pk_bf16_f32 v65, v58, v59
    v_cvt_pk_bf16_f32 v66, v60, v61
    v_cvt_pk_bf16_f32 v67, v62, v63
    v_accvgpr_write_b32 a40, v64
    v_accvgpr_write_b32 a41, v65
    v_accvgpr_write_b32 a42, v66
    v_accvgpr_write_b32 a43, v67
    v_alignbit_b32 v68, v64, v64, v40
    v_xor_b32 v68, v68, v41
    v_alignbit_b32 v69, v65, v65, v40
    v_xor_b32 v69, v69, v41
    v_alignbit_b32 v70, v66, v66, v40
    v_xor_b32 v70, v70, v41
    v_alignbit_b32 v71, v67, v67, v40
    v_xor_b32 v71, v71, v41
    v_accvgpr_write_b32 a168, v68
    v_accvgpr_write_b32 a169, v69
    v_accvgpr_write_b32 a170, v70
    v_accvgpr_write_b32 a171, v71
    v_fract_f32 v48, v31
    v_add_f32 v49, v48, v33
    v_cos_f32 v56, v48
    v_add_f32 v50, v49, v35
    v_cos_f32 v57, v49
    v_add_f32 v51, v50, v33
    v_cos_f32 v58, v50
    v_add_f32 v52, v51, v35
    v_cos_f32 v59, v51
    v_add_f32 v53, v52, v33
    v_cos_f32 v60, v52
    v_add_f32 v54, v53, v35
    v_cos_f32 v61, v53
    v_add_f32 v55, v54, v33
    v_cos_f32 v62, v54
    v_cos_f32 v63, v55
    v_add_f32 v31, v48, v37
    v_cvt_pk_bf16_f32 v64, v56, v57
    v_cvt_pk_bf16_f32 v65, v58, v59
    v_cvt_pk_bf16_f32 v66, v60, v61
    v_cvt_pk_bf16_f32 v67, v62, v63
    v_accvgpr_write_b32 a44, v64
    v_accvgpr_write_b32 a45, v65
    v_accvgpr_write_b32 a46, v66
    v_accvgpr_write_b32 a47, v67
    v_alignbit_b32 v68, v64, v64, v40
    v_xor_b32 v68, v68, v41
    v_alignbit_b32 v69, v65, v65, v40
    v_xor_b32 v69, v69, v41
    v_alignbit_b32 v70, v66, v66, v40
    v_xor_b32 v70, v70, v41
    v_alignbit_b32 v71, v67, v67, v40
    v_xor_b32 v71, v71, v41
    v_accvgpr_write_b32 a172, v68
    v_accvgpr_write_b32 a173, v69
    v_accvgpr_write_b32 a174, v70
    v_accvgpr_write_b32 a175, v71
    v_fract_f32 v48, v30
    v_add_f32 v49, v48, v32
    v_cos_f32 v56, v48
    v_add_f32 v50, v49, v34
    v_cos_f32 v57, v49
    v_add_f32 v51, v50, v32
    v_cos_f32 v58, v50
    v_add_f32 v52, v51, v34
    v_cos_f32 v59, v51
    v_add_f32 v53, v52, v32
    v_cos_f32 v60, v52
    v_add_f32 v54, v53, v34
    v_cos_f32 v61, v53
    v_add_f32 v55, v54, v32
    v_cos_f32 v62, v54
    v_cos_f32 v63, v55
    v_add_f32 v30, v48, v36
    v_cvt_pk_bf16_f32 v64, v56, v57
    v_cvt_pk_bf16_f32 v65, v58, v59
    v_cvt_pk_bf16_f32 v66, v60, v61
    v_cvt_pk_bf16_f32 v67, v62, v63
    v_accvgpr_write_b32 a48, v64
    v_accvgpr_write_b32 a49, v65
    v_accvgpr_write_b32 a50, v66
    v_accvgpr_write_b32 a51, v67
    v_alignbit_b32 v68, v64, v64, v40
    v_xor_b32 v68, v68, v41
    v_alignbit_b32 v69, v65, v65, v40
    v_xor_b32 v69, v69, v41
    v_alignbit_b32 v70, v66, v66, v40
    v_xor_b32 v70, v70, v41
    v_alignbit_b32 v71, v67, v67, v40
    v_xor_b32 v71, v71, v41
    v_accvgpr_write_b32 a176, v68
    v_accvgpr_write_b32 a177, v69
    v_accvgpr_write_b32 a178, v70
    v_accvgpr_write_b32 a179, v71
    v_fract_f32 v48, v31
    v_add_f32 v49, v48, v33
    v_cos_f32 v56, v48
    v_add_f32 v50, v49, v35
    v_cos_f32 v57, v49
    v_add_f32 v51, v50, v33
    v_cos_f32 v58, v50
    v_add_f32 v52, v51, v35
    v_cos_f32 v59, v51
    v_add_f32 v53, v52, v33
    v_cos_f32 v60, v52
    v_add_f32 v54, v53, v35
    v_cos_f32 v61, v53
    v_add_f32 v55, v54, v33
    v_cos_f32 v62, v54
    v_cos_f32 v63, v55
    v_add_f32 v31, v48, v37
    v_cvt_pk_bf16_f32 v64, v56, v57
    v_cvt_pk_bf16_f32 v65, v58, v59
    v_cvt_pk_bf16_f32 v66, v60, v61
    v_cvt_pk_bf16_f32 v67, v62, v63
    v_accvgpr_write_b32 a52, v64
    v_accvgpr_write_b32 a53, v65
    v_accvgpr_write_b32 a54, v66
    v_accvgpr_write_b32 a55, v67
    v_alignbit_b32 v68, v64, v64, v40
    v_xor_b32 v68, v68, v41
    v_alignbit_b32 v69, v65, v65, v40
    v_xor_b32 v69, v69, v41
    v_alignbit_b32 v70, v66, v66, v40
    v_xor_b32 v70, v70, v41
    v_alignbit_b32 v71, v67, v67, v40
    v_xor_b32 v71, v71, v41
    v_accvgpr_write_b32 a180, v68
    v_accvgpr_write_b32 a181, v69
    v_accvgpr_write_b32 a182, v70
    v_accvgpr_write_b32 a183, v71
    v_fract_f32 v48, v30
    v_add_f32 v49, v48, v32
    v_cos_f32 v56, v48
    v_add_f32 v50, v49, v34
    v_cos_f32 v57, v49
    v_add_f32 v51, v50, v32
    v_cos_f32 v58, v50
    v_add_f32 v52, v51, v34
    v_cos_f32 v59, v51
    v_add_f32 v53, v52, v32
    v_cos_f32 v60, v52
    v_add_f32 v54, v53, v34
    v_cos_f32 v61, v53
    v_add_f32 v55, v54, v32
    v_cos_f32 v62, v54
    v_cos_f32 v63, v55
    v_add_f32 v30, v48, v36
    v_cvt_pk_bf16_f32 v64, v56, v57
    v_cvt_pk_bf16_f32 v65, v58, v59
    v_cvt_pk_bf16_f32 v66, v60, v61
    v_cvt_pk_bf16_f32 v67, v62, v63
    v_accvgpr_write_b32 a56, v64
    v_accvgpr_write_b32 a57, v65
    v_accvgpr_write_b32 a58, v66
    v_accvgpr_write_b32 a59, v67
    v_alignbit_b32 v68, v64, v64, v40
    v_xor_b32 v68, v68, v41
    v_alignbit_b32 v69, v65, v65, v40
    v_xor_b32 v69, v69, v41
    v_alignbit_b32 v70, v66, v66, v40
    v_xor_b32 v70, v70, v41
    v_alignbit_b32 v71, v67, v67, v40
    v_xor_b32 v71, v71, v41
    v_accvgpr_write_b32 a184, v68
    v_accvgpr_write_b32 a185, v69
    v_accvgpr_write_b32 a186, v70
    v_accvgpr_write_b32 a187, v71
    v_fract_f32 v48, v31
    v_add_f32 v49, v48, v33
    v_cos_f32 v56, v48
    v_add_f32 v50, v49, v35
    v_cos_f32 v57, v49
    v_add_f32 v51, v50, v33
    v_cos_f32 v58, v50
    v_add_f32 v52, v51, v35
    v_cos_f32 v59, v51
    v_add_f32 v53, v52, v33
    v_cos_f32 v60, v52
    v_add_f32 v54, v53, v35
    v_cos_f32 v61, v53
    v_add_f32 v55, v54, v33
    v_cos_f32 v62, v54
    v_cos_f32 v63, v55
    v_add_f32 v31, v48, v37
    v_cvt_pk_bf16_f32 v64, v56, v57
    v_cvt_pk_bf16_f32 v65, v58, v59
    v_cvt_pk_bf16_f32 v66, v60, v61
    v_cvt_pk_bf16_f32 v67, v62, v63
    v_accvgpr_write_b32 a60, v64
    v_accvgpr_write_b32 a61, v65
    v_accvgpr_write_b32 a62, v66
    v_accvgpr_write_b32 a63, v67
    v_alignbit_b32 v68, v64, v64, v40
    v_xor_b32 v68, v68, v41
    v_alignbit_b32 v69, v65, v65, v40
    v_xor_b32 v69, v69, v41
    v_alignbit_b32 v70, v66, v66, v40
    v_xor_b32 v70, v70, v41
    v_alignbit_b32 v71, v67, v67, v40
    v_xor_b32 v71, v71, v41
    v_accvgpr_write_b32 a188, v68
    v_accvgpr_write_b32 a189, v69
    v_accvgpr_write_b32 a190, v70
    v_accvgpr_write_b32 a191, v71
    v_fract_f32 v48, v30
    v_add_f32 v49, v48, v32
    v_cos_f32 v56, v48
    v_add_f32 v50, v49, v34
    v_cos_f32 v57, v49
    v_add_f32 v51, v50, v32
    v_cos_f32 v58, v50
    v_add_f32 v52, v51, v34
    v_cos_f32 v59, v51
    v_add_f32 v53, v52, v32
    v_cos_f32 v60, v52
    v_add_f32 v54, v53, v34
    v_cos_f32 v61, v53
    v_add_f32 v55, v54, v32
    v_cos_f32 v62, v54
    v_cos_f32 v63, v55
    v_add_f32 v30, v48, v36
    v_cvt_pk_bf16_f32 v64, v56, v57
    v_cvt_pk_bf16_f32 v65, v58, v59
    v_cvt_pk_bf16_f32 v66, v60, v61
    v_cvt_pk_bf16_f32 v67, v62, v63
    v_accvgpr_write_b32 a64, v64
    v_accvgpr_write_b32 a65, v65
    v_accvgpr_write_b32 a66, v66
    v_accvgpr_write_b32 a67, v67
    v_alignbit_b32 v68, v64, v64, v40
    v_xor_b32 v68, v68, v41
    v_alignbit_b32 v69, v65, v65, v40
    v_xor_b32 v69, v69, v41
    v_alignbit_b32 v70, v66, v66, v40
    v_xor_b32 v70, v70, v41
    v_alignbit_b32 v71, v67, v67, v40
    v_xor_b32 v71, v71, v41
    v_accvgpr_write_b32 a192, v68
    v_accvgpr_write_b32 a193, v69
    v_accvgpr_write_b32 a194, v70
    v_accvgpr_write_b32 a195, v71
    v_fract_f32 v48, v31
    v_add_f32 v49, v48, v33
    v_cos_f32 v56, v48
    v_add_f32 v50, v49, v35
    v_cos_f32 v57, v49
    v_add_f32 v51, v50, v33
    v_cos_f32 v58, v50
    v_add_f32 v52, v51, v35
    v_cos_f32 v59, v51
    v_add_f32 v53, v52, v33
    v_cos_f32 v60, v52
    v_add_f32 v54, v53, v35
    v_cos_f32 v61, v53
    v_add_f32 v55, v54, v33
    v_cos_f32 v62, v54
    v_cos_f32 v63, v55
    v_add_f32 v31, v48, v37
    v_cvt_pk_bf16_f32 v64, v56, v57
    v_cvt_pk_bf16_f32 v65, v58, v59
    v_cvt_pk_bf16_f32 v66, v60, v61
    v_cvt_pk_bf16_f32 v67, v62, v63
    v_accvgpr_write_b32 a68, v64
    v_accvgpr_write_b32 a69, v65
    v_accvgpr_write_b32 a70, v66
    v_accvgpr_write_b32 a71, v67
    v_alignbit_b32 v68, v64, v64, v40
    v_xor_b32 v68, v68, v41
    v_alignbit_b32 v69, v65, v65, v40
    v_xor_b32 v69, v69, v41
    v_alignbit_b32 v70, v66, v66, v40
    v_xor_b32 v70, v70, v41
    v_alignbit_b32 v71, v67, v67, v40
    v_xor_b32 v71, v71, v41
    v_accvgpr_write_b32 a196, v68
    v_accvgpr_write_b32 a197, v69
    v_accvgpr_write_b32 a198, v70
    v_accvgpr_write_b32 a199, v71
    v_fract_f32 v48, v30
    v_add_f32 v49, v48, v32
    v_cos_f32 v56, v48
    v_add_f32 v50, v49, v34
    v_cos_f32 v57, v49
    v_add_f32 v51, v50, v32
    v_cos_f32 v58, v50
    v_add_f32 v52, v51, v34
    v_cos_f32 v59, v51
    v_add_f32 v53, v52, v32
    v_cos_f32 v60, v52
    v_add_f32 v54, v53, v34
    v_cos_f32 v61, v53
    v_add_f32 v55, v54, v32
    v_cos_f32 v62, v54
    v_cos_f32 v63, v55
    v_add_f32 v30, v48, v36
    v_cvt_pk_bf16_f32 v64, v56, v57
    v_cvt_pk_bf16_f32 v65, v58, v59
    v_cvt_pk_bf16_f32 v66, v60, v61
    v_cvt_pk_bf16_f32 v67, v62, v63
    v_accvgpr_write_b32 a72, v64
    v_accvgpr_write_b32 a73, v65
    v_accvgpr_write_b32 a74, v66
    v_accvgpr_write_b32 a75, v67
    v_alignbit_b32 v68, v64, v64, v40
    v_xor_b32 v68, v68, v41
    v_alignbit_b32 v69, v65, v65, v40
    v_xor_b32 v69, v69, v41
    v_alignbit_b32 v70, v66, v66, v40
    v_xor_b32 v70, v70, v41
    v_alignbit_b32 v71, v67, v67, v40
    v_xor_b32 v71, v71, v41
    v_accvgpr_write_b32 a200, v68
    v_accvgpr_write_b32 a201, v69
    v_accvgpr_write_b32 a202, v70
    v_accvgpr_write_b32 a203, v71
    v_fract_f32 v48, v31
    v_add_f32 v49, v48, v33
    v_cos_f32 v56, v48
    v_add_f32 v50, v49, v35
    v_cos_f32 v57, v49
    v_add_f32 v51, v50, v33
    v_cos_f32 v58, v50
    v_add_f32 v52, v51, v35
    v_cos_f32 v59, v51
    v_add_f32 v53, v52, v33
    v_cos_f32 v60, v52
    v_add_f32 v54, v53, v35
    v_cos_f32 v61, v53
    v_add_f32 v55, v54, v33
    v_cos_f32 v62, v54
    v_cos_f32 v63, v55
    v_add_f32 v31, v48, v37
    v_cvt_pk_bf16_f32 v64, v56, v57
    v_cvt_pk_bf16_f32 v65, v58, v59
    v_cvt_pk_bf16_f32 v66, v60, v61
    v_cvt_pk_bf16_f32 v67, v62, v63
    v_accvgpr_write_b32 a76, v64
    v_accvgpr_write_b32 a77, v65
    v_accvgpr_write_b32 a78, v66
    v_accvgpr_write_b32 a79, v67
    v_alignbit_b32 v68, v64, v64, v40
    v_xor_b32 v68, v68, v41
    v_alignbit_b32 v69, v65, v65, v40
    v_xor_b32 v69, v69, v41
    v_alignbit_b32 v70, v66, v66, v40
    v_xor_b32 v70, v70, v41
    v_alignbit_b32 v71, v67, v67, v40
    v_xor_b32 v71, v71, v41
    v_accvgpr_write_b32 a204, v68
    v_accvgpr_write_b32 a205, v69
    v_accvgpr_write_b32 a206, v70
    v_accvgpr_write_b32 a207, v71
    v_fract_f32 v48, v30
    v_add_f32 v49, v48, v32
    v_cos_f32 v56, v48
    v_add_f32 v50, v49, v34
    v_cos_f32 v57, v49
    v_add_f32 v51, v50, v32
    v_cos_f32 v58, v50
    v_add_f32 v52, v51, v34
    v_cos_f32 v59, v51
    v_add_f32 v53, v52, v32
    v_cos_f32 v60, v52
    v_add_f32 v54, v53, v34
    v_cos_f32 v61, v53
    v_add_f32 v55, v54, v32
    v_cos_f32 v62, v54
    v_cos_f32 v63, v55
    v_add_f32 v30, v48, v36
    v_cvt_pk_bf16_f32 v64, v56, v57
    v_cvt_pk_bf16_f32 v65, v58, v59
    v_cvt_pk_bf16_f32 v66, v60, v61
    v_cvt_pk_bf16_f32 v67, v62, v63
    v_accvgpr_write_b32 a80, v64
    v_accvgpr_write_b32 a81, v65
    v_accvgpr_write_b32 a82, v66
    v_accvgpr_write_b32 a83, v67
    v_alignbit_b32 v68, v64, v64, v40
    v_xor_b32 v68, v68, v41
    v_alignbit_b32 v69, v65, v65, v40
    v_xor_b32 v69, v69, v41
    v_alignbit_b32 v70, v66, v66, v40
    v_xor_b32 v70, v70, v41
    v_alignbit_b32 v71, v67, v67, v40
    v_xor_b32 v71, v71, v41
    v_accvgpr_write_b32 a208, v68
    v_accvgpr_write_b32 a209, v69
    v_accvgpr_write_b32 a210, v70
    v_accvgpr_write_b32 a211, v71
    v_fract_f32 v48, v31
    v_add_f32 v49, v48, v33
    v_cos_f32 v56, v48
    v_add_f32 v50, v49, v35
    v_cos_f32 v57, v49
    v_add_f32 v51, v50, v33
    v_cos_f32 v58, v50
    v_add_f32 v52, v51, v35
    v_cos_f32 v59, v51
    v_add_f32 v53, v52, v33
    v_cos_f32 v60, v52
    v_add_f32 v54, v53, v35
    v_cos_f32 v61, v53
    v_add_f32 v55, v54, v33
    v_cos_f32 v62, v54
    v_cos_f32 v63, v55
    v_add_f32 v31, v48, v37
    v_cvt_pk_bf16_f32 v64, v56, v57
    v_cvt_pk_bf16_f32 v65, v58, v59
    v_cvt_pk_bf16_f32 v66, v60, v61
    v_cvt_pk_bf16_f32 v67, v62, v63
    v_accvgpr_write_b32 a84, v64
    v_accvgpr_write_b32 a85, v65
    v_accvgpr_write_b32 a86, v66
    v_accvgpr_write_b32 a87, v67
    v_alignbit_b32 v68, v64, v64, v40
    v_xor_b32 v68, v68, v41
    v_alignbit_b32 v69, v65, v65, v40
    v_xor_b32 v69, v69, v41
    v_alignbit_b32 v70, v66, v66, v40
    v_xor_b32 v70, v70, v41
    v_alignbit_b32 v71, v67, v67, v40
    v_xor_b32 v71, v71, v41
    v_accvgpr_write_b32 a212, v68
    v_accvgpr_write_b32 a213, v69
    v_accvgpr_write_b32 a214, v70
    v_accvgpr_write_b32 a215, v71
    v_fract_f32 v48, v30
    v_add_f32 v49, v48, v32
    v_cos_f32 v56, v48
    v_add_f32 v50, v49, v34
    v_cos_f32 v57, v49
    v_add_f32 v51, v50, v32
    v_cos_f32 v58, v50
    v_add_f32 v52, v51, v34
    v_cos_f32 v59, v51
    v_add_f32 v53, v52, v32
    v_cos_f32 v60, v52
    v_add_f32 v54, v53, v34
    v_cos_f32 v61, v53
    v_add_f32 v55, v54, v32
    v_cos_f32 v62, v54
    v_cos_f32 v63, v55
    v_add_f32 v30, v48, v36
    v_cvt_pk_bf16_f32 v64, v56, v57
    v_cvt_pk_bf16_f32 v65, v58, v59
    v_cvt_pk_bf16_f32 v66, v60, v61
    v_cvt_pk_bf16_f32 v67, v62, v63
    v_accvgpr_write_b32 a88, v64
    v_accvgpr_write_b32 a89, v65
    v_accvgpr_write_b32 a90, v66
    v_accvgpr_write_b32 a91, v67
    v_alignbit_b32 v68, v64, v64, v40
    v_xor_b32 v68, v68, v41
    v_alignbit_b32 v69, v65, v65, v40
    v_xor_b32 v69, v69, v41
    v_alignbit_b32 v70, v66, v66, v40
    v_xor_b32 v70, v70, v41
    v_alignbit_b32 v71, v67, v67, v40
    v_xor_b32 v71, v71, v41
    v_accvgpr_write_b32 a216, v68
    v_accvgpr_write_b32 a217, v69
    v_accvgpr_write_b32 a218, v70
    v_accvgpr_write_b32 a219, v71
    v_fract_f32 v48, v31
    v_add_f32 v49, v48, v33
    v_cos_f32 v56, v48
    v_add_f32 v50, v49, v35
    v_cos_f32 v57, v49
    v_add_f32 v51, v50, v33
    v_cos_f32 v58, v50
    v_add_f32 v52, v51, v35
    v_cos_f32 v59, v51
    v_add_f32 v53, v52, v33
    v_cos_f32 v60, v52
    v_add_f32 v54, v53, v35
    v_cos_f32 v61, v53
    v_add_f32 v55, v54, v33
    v_cos_f32 v62, v54
    v_cos_f32 v63, v55
    v_add_f32 v31, v48, v37
    v_cvt_pk_bf16_f32 v64, v56, v57
    v_cvt_pk_bf16_f32 v65, v58, v59
    v_cvt_pk_bf16_f32 v66, v60, v61
    v_cvt_pk_bf16_f32 v67, v62, v63
    v_accvgpr_write_b32 a92, v64
    v_accvgpr_write_b32 a93, v65
    v_accvgpr_write_b32 a94, v66
    v_accvgpr_write_b32 a95, v67
    v_alignbit_b32 v68, v64, v64, v40
    v_xor_b32 v68, v68, v41
    v_alignbit_b32 v69, v65, v65, v40
    v_xor_b32 v69, v69, v41
    v_alignbit_b32 v70, v66, v66, v40
    v_xor_b32 v70, v70, v41
    v_alignbit_b32 v71, v67, v67, v40
    v_xor_b32 v71, v71, v41
    v_accvgpr_write_b32 a220, v68
    v_accvgpr_write_b32 a221, v69
    v_accvgpr_write_b32 a222, v70
    v_accvgpr_write_b32 a223, v71
    v_fract_f32 v48, v30
    v_add_f32 v49, v48, v32
    v_cos_f32 v56, v48
    v_add_f32 v50, v49, v34
    v_cos_f32 v57, v49
    v_add_f32 v51, v50, v32
    v_cos_f32 v58, v50
    v_add_f32 v52, v51, v34
    v_cos_f32 v59, v51
    v_add_f32 v53, v52, v32
    v_cos_f32 v60, v52
    v_add_f32 v54, v53, v34
    v_cos_f32 v61, v53
    v_add_f32 v55, v54, v32
    v_cos_f32 v62, v54
    v_cos_f32 v63, v55
    v_add_f32 v30, v48, v36
    v_cvt_pk_bf16_f32 v64, v56, v57
    v_cvt_pk_bf16_f32 v65, v58, v59
    v_cvt_pk_bf16_f32 v66, v60, v61
    v_cvt_pk_bf16_f32 v67, v62, v63
    v_accvgpr_write_b32 a96, v64
    v_accvgpr_write_b32 a97, v65
    v_accvgpr_write_b32 a98, v66
    v_accvgpr_write_b32 a99, v67
    v_alignbit_b32 v68, v64, v64, v40
    v_xor_b32 v68, v68, v41
    v_alignbit_b32 v69, v65, v65, v40
    v_xor_b32 v69, v69, v41
    v_alignbit_b32 v70, v66, v66, v40
    v_xor_b32 v70, v70, v41
    v_alignbit_b32 v71, v67, v67, v40
    v_xor_b32 v71, v71, v41
    v_accvgpr_write_b32 a224, v68
    v_accvgpr_write_b32 a225, v69
    v_accvgpr_write_b32 a226, v70
    v_accvgpr_write_b32 a227, v71
    v_fract_f32 v48, v31
    v_add_f32 v49, v48, v33
    v_cos_f32 v56, v48
    v_add_f32 v50, v49, v35
    v_cos_f32 v57, v49
    v_add_f32 v51, v50, v33
    v_cos_f32 v58, v50
    v_add_f32 v52, v51, v35
    v_cos_f32 v59, v51
    v_add_f32 v53, v52, v33
    v_cos_f32 v60, v52
    v_add_f32 v54, v53, v35
    v_cos_f32 v61, v53
    v_add_f32 v55, v54, v33
    v_cos_f32 v62, v54
    v_cos_f32 v63, v55
    v_add_f32 v31, v48, v37
    v_cvt_pk_bf16_f32 v64, v56, v57
    v_cvt_pk_bf16_f32 v65, v58, v59
    v_cvt_pk_bf16_f32 v66, v60, v61
    v_cvt_pk_bf16_f32 v67, v62, v63
    v_accvgpr_write_b32 a100, v64
    v_accvgpr_write_b32 a101, v65
    v_accvgpr_write_b32 a102, v66
    v_accvgpr_write_b32 a103, v67
    v_alignbit_b32 v68, v64, v64, v40
    v_xor_b32 v68, v68, v41
    v_alignbit_b32 v69, v65, v65, v40
    v_xor_b32 v69, v69, v41
    v_alignbit_b32 v70, v66, v66, v40
    v_xor_b32 v70, v70, v41
    v_alignbit_b32 v71, v67, v67, v40
    v_xor_b32 v71, v71, v41
    v_accvgpr_write_b32 a228, v68
    v_accvgpr_write_b32 a229, v69
    v_accvgpr_write_b32 a230, v70
    v_accvgpr_write_b32 a231, v71
    v_fract_f32 v48, v30
    v_add_f32 v49, v48, v32
    v_cos_f32 v56, v48
    v_add_f32 v50, v49, v34
    v_cos_f32 v57, v49
    v_add_f32 v51, v50, v32
    v_cos_f32 v58, v50
    v_add_f32 v52, v51, v34
    v_cos_f32 v59, v51
    v_add_f32 v53, v52, v32
    v_cos_f32 v60, v52
    v_add_f32 v54, v53, v34
    v_cos_f32 v61, v53
    v_add_f32 v55, v54, v32
    v_cos_f32 v62, v54
    v_cos_f32 v63, v55
    v_add_f32 v30, v48, v36
    v_cvt_pk_bf16_f32 v64, v56, v57
    v_cvt_pk_bf16_f32 v65, v58, v59
    v_cvt_pk_bf16_f32 v66, v60, v61
    v_cvt_pk_bf16_f32 v67, v62, v63
    v_accvgpr_write_b32 a104, v64
    v_accvgpr_write_b32 a105, v65
    v_accvgpr_write_b32 a106, v66
    v_accvgpr_write_b32 a107, v67
    v_alignbit_b32 v68, v64, v64, v40
    v_xor_b32 v68, v68, v41
    v_alignbit_b32 v69, v65, v65, v40
    v_xor_b32 v69, v69, v41
    v_alignbit_b32 v70, v66, v66, v40
    v_xor_b32 v70, v70, v41
    v_alignbit_b32 v71, v67, v67, v40
    v_xor_b32 v71, v71, v41
    v_accvgpr_write_b32 a232, v68
    v_accvgpr_write_b32 a233, v69
    v_accvgpr_write_b32 a234, v70
    v_accvgpr_write_b32 a235, v71
    v_fract_f32 v48, v31
    v_add_f32 v49, v48, v33
    v_cos_f32 v56, v48
    v_add_f32 v50, v49, v35
    v_cos_f32 v57, v49
    v_add_f32 v51, v50, v33
    v_cos_f32 v58, v50
    v_add_f32 v52, v51, v35
    v_cos_f32 v59, v51
    v_add_f32 v53, v52, v33
    v_cos_f32 v60, v52
    v_add_f32 v54, v53, v35
    v_cos_f32 v61, v53
    v_add_f32 v55, v54, v33
    v_cos_f32 v62, v54
    v_cos_f32 v63, v55
    v_add_f32 v31, v48, v37
    v_cvt_pk_bf16_f32 v64, v56, v57
    v_cvt_pk_bf16_f32 v65, v58, v59
    v_cvt_pk_bf16_f32 v66, v60, v61
    v_cvt_pk_bf16_f32 v67, v62, v63
    v_accvgpr_write_b32 a108, v64
    v_accvgpr_write_b32 a109, v65
    v_accvgpr_write_b32 a110, v66
    v_accvgpr_write_b32 a111, v67
    v_alignbit_b32 v68, v64, v64, v40
    v_xor_b32 v68, v68, v41
    v_alignbit_b32 v69, v65, v65, v40
    v_xor_b32 v69, v69, v41
    v_alignbit_b32 v70, v66, v66, v40
    v_xor_b32 v70, v70, v41
    v_alignbit_b32 v71, v67, v67, v40
    v_xor_b32 v71, v71, v41
    v_accvgpr_write_b32 a236, v68
    v_accvgpr_write_b32 a237, v69
    v_accvgpr_write_b32 a238, v70
    v_accvgpr_write_b32 a239, v71
    v_fract_f32 v48, v30
    v_add_f32 v49, v48, v32
    v_cos_f32 v56, v48
    v_add_f32 v50, v49, v34
    v_cos_f32 v57, v49
    v_add_f32 v51, v50, v32
    v_cos_f32 v58, v50
    v_add_f32 v52, v51, v34
    v_cos_f32 v59, v51
    v_add_f32 v53, v52, v32
    v_cos_f32 v60, v52
    v_add_f32 v54, v53, v34
    v_cos_f32 v61, v53
    v_add_f32 v55, v54, v32
    v_cos_f32 v62, v54
    v_cos_f32 v63, v55
    v_add_f32 v30, v48, v36
    v_cvt_pk_bf16_f32 v64, v56, v57
    v_cvt_pk_bf16_f32 v65, v58, v59
    v_cvt_pk_bf16_f32 v66, v60, v61
    v_cvt_pk_bf16_f32 v67, v62, v63
    v_accvgpr_write_b32 a112, v64
    v_accvgpr_write_b32 a113, v65
    v_accvgpr_write_b32 a114, v66
    v_accvgpr_write_b32 a115, v67
    v_alignbit_b32 v68, v64, v64, v40
    v_xor_b32 v68, v68, v41
    v_alignbit_b32 v69, v65, v65, v40
    v_xor_b32 v69, v69, v41
    v_alignbit_b32 v70, v66, v66, v40
    v_xor_b32 v70, v70, v41
    v_alignbit_b32 v71, v67, v67, v40
    v_xor_b32 v71, v71, v41
    v_accvgpr_write_b32 a240, v68
    v_accvgpr_write_b32 a241, v69
    v_accvgpr_write_b32 a242, v70
    v_accvgpr_write_b32 a243, v71
    v_fract_f32 v48, v31
    v_add_f32 v49, v48, v33
    v_cos_f32 v56, v48
    v_add_f32 v50, v49, v35
    v_cos_f32 v57, v49
    v_add_f32 v51, v50, v33
    v_cos_f32 v58, v50
    v_add_f32 v52, v51, v35
    v_cos_f32 v59, v51
    v_add_f32 v53, v52, v33
    v_cos_f32 v60, v52
    v_add_f32 v54, v53, v35
    v_cos_f32 v61, v53
    v_add_f32 v55, v54, v33
    v_cos_f32 v62, v54
    v_cos_f32 v63, v55
    v_add_f32 v31, v48, v37
    v_cvt_pk_bf16_f32 v64, v56, v57
    v_cvt_pk_bf16_f32 v65, v58, v59
    v_cvt_pk_bf16_f32 v66, v60, v61
    v_cvt_pk_bf16_f32 v67, v62, v63
    v_accvgpr_write_b32 a116, v64
    v_accvgpr_write_b32 a117, v65
    v_accvgpr_write_b32 a118, v66
    v_accvgpr_write_b32 a119, v67
    v_alignbit_b32 v68, v64, v64, v40
    v_xor_b32 v68, v68, v41
    v_alignbit_b32 v69, v65, v65, v40
    v_xor_b32 v69, v69, v41
    v_alignbit_b32 v70, v66, v66, v40
    v_xor_b32 v70, v70, v41
    v_alignbit_b32 v71, v67, v67, v40
    v_xor_b32 v71, v71, v41
    v_accvgpr_write_b32 a244, v68
    v_accvgpr_write_b32 a245, v69
    v_accvgpr_write_b32 a246, v70
    v_accvgpr_write_b32 a247, v71
    v_fract_f32 v48, v30
    v_add_f32 v49, v48, v32
    v_cos_f32 v56, v48
    v_add_f32 v50, v49, v34
    v_cos_f32 v57, v49
    v_add_f32 v51, v50, v32
    v_cos_f32 v58, v50
    v_add_f32 v52, v51, v34
    v_cos_f32 v59, v51
    v_add_f32 v53, v52, v32
    v_cos_f32 v60, v52
    v_add_f32 v54, v53, v34
    v_cos_f32 v61, v53
    v_add_f32 v55, v54, v32
    v_cos_f32 v62, v54
    v_cos_f32 v63, v55
    v_add_f32 v30, v48, v36
    v_cvt_pk_bf16_f32 v64, v56, v57
    v_cvt_pk_bf16_f32 v65, v58, v59
    v_cvt_pk_bf16_f32 v66, v60, v61
    v_cvt_pk_bf16_f32 v67, v62, v63
    v_accvgpr_write_b32 a120, v64
    v_accvgpr_write_b32 a121, v65
    v_accvgpr_write_b32 a122, v66
    v_accvgpr_write_b32 a123, v67
    v_alignbit_b32 v68, v64, v64, v40
    v_xor_b32 v68, v68, v41
    v_alignbit_b32 v69, v65, v65, v40
    v_xor_b32 v69, v69, v41
    v_alignbit_b32 v70, v66, v66, v40
    v_xor_b32 v70, v70, v41
    v_alignbit_b32 v71, v67, v67, v40
    v_xor_b32 v71, v71, v41
    v_accvgpr_write_b32 a248, v68
    v_accvgpr_write_b32 a249, v69
    v_accvgpr_write_b32 a250, v70
    v_accvgpr_write_b32 a251, v71
    v_fract_f32 v48, v31
    v_add_f32 v49, v48, v33
    v_cos_f32 v56, v48
    v_add_f32 v50, v49, v35
    v_cos_f32 v57, v49
    v_add_f32 v51, v50, v33
    v_cos_f32 v58, v50
    v_add_f32 v52, v51, v35
    v_cos_f32 v59, v51
    v_add_f32 v53, v52, v33
    v_cos_f32 v60, v52
    v_add_f32 v54, v53, v35
    v_cos_f32 v61, v53
    v_add_f32 v55, v54, v33
    v_cos_f32 v62, v54
    v_cos_f32 v63, v55
    v_add_f32 v31, v48, v37
    v_cvt_pk_bf16_f32 v64, v56, v57
    v_cvt_pk_bf16_f32 v65, v58, v59
    v_cvt_pk_bf16_f32 v66, v60, v61
    v_cvt_pk_bf16_f32 v67, v62, v63
    v_accvgpr_write_b32 a124, v64
    v_accvgpr_write_b32 a125, v65
    v_accvgpr_write_b32 a126, v66
    v_accvgpr_write_b32 a127, v67
    v_alignbit_b32 v68, v64, v64, v40
    v_xor_b32 v68, v68, v41
    v_alignbit_b32 v69, v65, v65, v40
    v_xor_b32 v69, v69, v41
    v_alignbit_b32 v70, v66, v66, v40
    v_xor_b32 v70, v70, v41
    v_alignbit_b32 v71, v67, v67, v40
    v_xor_b32 v71, v71, v41
    v_accvgpr_write_b32 a252, v68
    v_accvgpr_write_b32 a253, v69
    v_accvgpr_write_b32 a254, v70
    v_accvgpr_write_b32 a255, v71
    v_lshlrev_b32 v6, 31, v38
    v_or_b32 v6, 0x3f803f80, v6
    v_cmp_gt_u32 vcc, 16, v1
    v_accvgpr_read_b32 v5, a0
    s_nop 0
    v_cndmask_b32 v5, v5, v6, vcc
    v_accvgpr_write_b32 a0, v5
    v_accvgpr_read_b32 v5, a4
    v_cndmask_b32 v5, v5, v6, vcc
    v_accvgpr_write_b32 a4, v5
    v_and_b32 v5, 15, v1
    v_lshrrev_b32 v6, 4, v1
    v_lshlrev_b32 v5, 4, v5
    v_lshl_add_u32 v10, v6, 9, v5
    v_add_u32 v11, 2048, v10
    v_add_u32 v12, 0x10000, v10
    v_add_u32 v13, 0x10000, v11
    s_lshl_b32 s19, s16, 10
    s_lshl_b32 s17, s16, 1
    v_lshrrev_b32 v8, 5, v1
    v_add_u32 v8, s17, v8
    v_and_b32 v7, 31, v1
    v_mul_u32_u24 v2, 33024, v8
    v_lshl_add_u32 v2, v7, 4, v2
    v_and_b32 v3, 15, v1
    v_and_b32 v5, 48, v1
    v_lshl_add_u32 v3, v3, 12, v5
    v_add_u32 v4, 0x10000, v3
    s_lshl_b32 s21, s28, 21
    s_lshl_b32 s17, s29, 6
    s_add_u32 s21, s21, s17
    s_lshl_b32 s20, s28, 13
    s_add_u32 s20, s20, 111149056
    s_mov_b32 s24, 512
    s_mov_b32 s25, 131072
    v_and_b32 v7, 31, v1
    v_lshlrev_b32 v7, 7, v7
    s_lshl_b32 s17, s16, 12
    s_add_u32 s17, s17, 100761600
    v_add_u32 v7, s17, v7
    s_mov_b32 s30, s92
F3_w0:
    buffer_load_dword v5, v7, s[4:7], 0 offen sc1
    s_waitcnt vmcnt(0)
    v_cmp_gt_u32 vcc, 1, v5
    s_nop 0
    s_cmp_lg_u64 vcc, 0
    s_cbranch_scc0 F3_w0_ok
    s_cmp_ge_u32 s30, 1048576
    s_cselect_b32 s92, 1048576, s92
    s_cbranch_scc1 F3_w0_ok
    s_add_u32 s30, s30, 1
    s_sleep 8
    s_branch F3_w0
F3_w0_ok:
    s_barrier
    s_mov_b32 s26, s25
    s_sub_u32 s25, s21, 1073741824
    s_mov_b32 s21, 1073741824
    s_mov_b32 s23, 0
    s_mov_b32 s22, 0
    s_add_u32 m0, s19, 0
    s_add_u32 s17, s20, 0
    buffer_load_dwordx4 v2, s[4:7], s17 offen lds
    s_add_u32 m0, s19, 4096
    s_add_u32 s17, s20, 264192
    buffer_load_dwordx4 v2, s[4:7], s17 offen lds
    s_add_u32 m0, s19, 8192
    s_add_u32 s17, s20, 528384
    buffer_load_dwordx4 v2, s[4:7], s17 offen lds
    s_add_u32 m0, s19, 12288
    s_add_u32 s17, s20, 792576
    buffer_load_dwordx4 v2, s[4:7], s17 offen lds
    s_add_u32 m0, s19, 16384
    s_add_u32 s17, s20, 1056768
    buffer_load_dwordx4 v2, s[4:7], s17 offen lds
    s_add_u32 m0, s19, 20480
    s_add_u32 s17, s20, 1320960
    buffer_load_dwordx4 v2, s[4:7], s17 offen lds
    s_add_u32 m0, s19, 24576
    s_add_u32 s17, s20, 1585152
    buffer_load_dwordx4 v2, s[4:7], s17 offen lds
    s_add_u32 m0, s19, 28672
    s_add_u32 s17, s20, 1849344
    buffer_load_dwordx4 v2, s[4:7], s17 offen lds
    s_add_u32 m0, s19, 32768
    s_add_u32 s17, s20, 2113536
    buffer_load_dwordx4 v2, s[4:7], s17 offen lds
    s_add_u32 m0, s19, 36864
    s_add_u32 s17, s20, 2377728
    buffer_load_dwordx4 v2, s[4:7], s17 offen lds
    s_add_u32 m0, s19, 40960
    s_add_u32 s17, s20, 2641920
    buffer_load_dwordx4 v2, s[4:7], s17 offen lds
    s_add_u32 m0, s19, 45056
    s_add_u32 s17, s20, 2906112
    buffer_load_dwordx4 v2, s[4:7], s17 offen lds
    s_add_u32 m0, s19, 49152
    s_add_u32 s17, s20, 3170304
    buffer_load_dwordx4 v2, s[4:7], s17 offen lds
    s_add_u32 m0, s19, 53248
    s_add_u32 s17, s20, 3434496
    buffer_load_dwordx4 v2, s[4:7], s17 offen lds
    s_add_u32 m0, s19, 57344
    s_add_u32 s17, s20, 3698688
    buffer_load_dwordx4 v2, s[4:7], s17 offen lds
    s_add_u32 m0, s19, 61440
    s_add_u32 s17, s20, 3962880
    buffer_load_dwordx4 v2, s[4:7], s17 offen lds
    s_add_u32 s20, s20, s24
    s_add_u32 m0, s19, 65536
    s_add_u32 s17, s20, 0
    buffer_load_dwordx4 v2, s[4:7], s17 offen lds
    s_add_u32 m0, s19, 69632
    s_add_u32 s17, s20, 264192
    buffer_load_dwordx4 v2, s[4:7], s17 offen lds
    s_add_u32 m0, s19, 73728
    s_add_u32 s17, s20, 528384
    buffer_load_dwordx4 v2, s[4:7], s17 offen lds
    s_waitcnt vmcnt(11)
    s_barrier
    ds_read_b128 v[20:23], v10 offset:0
    ds_read_b128 v[24:27], v10 offset:256
    ds_read_b128 v[28:31], v11 offset:0
    ds_read_b128 v[32:35], v11 offset:256
    ds_read_b128 v[36:39], v10 offset:4096
    ds_read_b128 v[40:43], v10 offset:4352
    ds_read_b128 v[44:47], v11 offset:4096
.p2align 6
F3_top:
    s_waitcnt lgkmcnt(6)
    v_mfma_f32_16x16x32_bf16 v[52:55], a[0:3], v[20:23], 0
    ds_read_b128 v[48:51], v11 offset:4352
    v_mfma_f32_16x16x32_bf16 v[56:59], a[4:7], v[20:23], 0
    s_waitcnt lgkmcnt(6)
    v_mfma_f32_16x16x32_bf16 v[60:63], a[0:3], v[24:27], 0
    ds_read_b128 v[20:23], v10 offset:8192
    s_add_u32 m0, s19, 77824
    v_mfma_f32_16x16x32_bf16 v[64:67], a[4:7], v[24:27], 0
    s_add_u32 s17, s20, 792576
    buffer_load_dwordx4 v2, s[4:7], s17 offen lds
    s_waitcnt lgkmcnt(6)
    v_mfma_f32_16x16x32_bf16 v[52:55], a[8:11], v[28:31], v[52:55]
    ds_read_b128 v[24:27], v10 offset:8448
    v_mfma_f32_16x16x32_bf16 v[56:59], a[12:15], v[28:31], v[56:59]
    s_waitcnt lgkmcnt(6)
    v_mfma_f32_16x16x32_bf16 v[60:63], a[8:11], v[32:35], v[60:63]
    ds_read_b128 v[28:31], v11 offset:8192
    s_add_u32 m0, s19, 81920
    v_mfma_f32_16x16x32_bf16 v[64:67], a[12:15], v[32:35], v[64:67]
    s_add_u32 s17, s20, 1056768
    buffer_load_dwordx4 v2, s[4:7], s17 offen lds
    s_waitcnt lgkmcnt(6)
    v_mfma_f32_16x16x32_bf16 v[52:55], a[16:19], v[36:39], v[52:55]
    ds_read_b128 v[32:35], v11 offset:8448
    v_mfma_f32_16x16x32_bf16 v[56:59], a[20:23], v[36:39], v[56:59]
    s_waitcnt lgkmcnt(6)
    v_mfma_f32_16x16x32_bf16 v[60:63], a[16:19], v[40:43], v[60:63]
    ds_read_b128 v[36:39], v10 offset:12288
    s_add_u32 m0, s19, 86016
    v_mfma_f32_16x16x32_bf16 v[64:67], a[20:23], v[40:43], v[64:67]
    s_add_u32 s17, s20, 1320960
    buffer_load_dwordx4 v2, s[4:7], s17 offen lds
    s_waitcnt lgkmcnt(6)
    v_mfma_f32_16x16x32_bf16 v[52:55], a[24:27], v[44:47], v[52:55]
    ds_read_b128 v[40:43], v10 offset:12544
    v_mfma_f32_16x16x32_bf16 v[56:59], a[28:31], v[44:47], v[56:59]
    s_waitcnt lgkmcnt(6)
    v_mfma_f32_16x16x32_bf16 v[60:63], a[24:27], v[48:51], v[60:63]
    ds_read_b128 v[44:47], v11 offset:12288
    s_add_u32 m0, s19, 90112
    v_mfma_f32_16x16x32_bf16 v[64:67], a[28:31], v[48:51], v[64:67]
    s_add_u32 s17, s20, 1585152
    buffer_load_dwordx4 v2, s[4:7], s17 offen lds
    s_waitcnt lgkmcnt(6)
    v_mfma_f32_16x16x32_bf16 v[52:55], a[32:35], v[20:23], v[52:55]
    ds_read_b128 v[48:51], v11 offset:12544
    v_mfma_f32_16x16x32_bf16 v[56:59], a[36:39], v[20:23], v[56:59]
    s_waitcnt lgkmcnt(6)
    v_mfma_f32_16x16x32_bf16 v[60:63], a[32:35], v[24:27], v[60:63]
    ds_read_b128 v[20:23], v10 offset:16384
    s_add_u32 m0, s19, 94208
    v_mfma_f32_16x16x32_bf16 v[64:67], a[36:39], v[24:27], v[64:67]
    s_add_u32 s17, s20, 1849344
    buffer_load_dwordx4 v2, s[4:7], s17 offen lds
    s_waitcnt lgkmcnt(6)
    v_mfma_f32_16x16x32_bf16 v[52:55], a[40:43], v[28:31], v[52:55]
    ds_read_b128 v[24:27], v10 offset:16640
    v_mfma_f32_16x16x32_bf16 v[56:59], a[44:47], v[28:31], v[56:59]
    v_cvt_pk_bf16_f32 v84, v68, v69
    s_waitcnt lgkmcnt(6)
    v_mfma_f32_16x16x32_bf16 v[60:63], a[40:43], v[32:35], v[60:63]
    ds_read_b128 v[28:31], v11 offset:16384
    v_mfma_f32_16x16x32_bf16 v[64:67], a[44:47], v[32:35], v[64:67]
    v_cvt_pk_bf16_f32 v85, v70, v71
    s_waitcnt lgkmcnt(6)
    v_mfma_f32_16x16x32_bf16 v[52:55], a[48:51], v[36:39], v[52:55]
    ds_read_b128 v[32:35], v11 offset:16640
    v_mfma_f32_16x16x32_bf16 v[56:59], a[52:55], v[36:39], v[56:59]
    v_cvt_pk_bf16_f32 v86, v72, v73
    s_waitcnt lgkmcnt(6)
    v_mfma_f32_16x16x32_bf16 v[60:63], a[48:51], v[40:43], v[60:63]
    ds_read_b128 v[36:39], v10 offset:20480
    v_mfma_f32_16x16x32_bf16 v[64:67], a[52:55], v[40:43], v[64:67]
    v_cvt_pk_bf16_f32 v87, v74, v75
    s_waitcnt lgkmcnt(6)
    v_mfma_f32_16x16x32_bf16 v[52:55], a[56:59], v[44:47], v[52:55]
    ds_read_b128 v[40:43], v10 offset:20736
    v_mfma_f32_16x16x32_bf16 v[56:59], a[60:63], v[44:47], v[56:59]
    v_cvt_pk_bf16_f32 v88, v76, v77
    s_waitcnt lgkmcnt(6)
    v_mfma_f32_16x16x32_bf16 v[60:63], a[56:59], v[48:51], v[60:63]
    ds_read_b128 v[44:47], v11 offset:20480
    v_mfma_f32_16x16x32_bf16 v[64:67], a[60:63], v[48:51], v[64:67]
    v_cvt_pk_bf16_f32 v89, v78, v79
    buffer_store_dwordx4 v[84:87], v3, s[12:15], s21 offen
    s_waitcnt lgkmcnt(6)
    v_mfma_f32_16x16x32_bf16 v[52:55], a[64:67], v[20:23], v[52:55]
    ds_read_b128 v[48:51], v11 offset:20736
    v_mfma_f32_16x16x32_bf16 v[56:59], a[68:71], v[20:23], v[56:59]
    v_cvt_pk_bf16_f32 v90, v80, v81
    s_waitcnt lgkmcnt(6)
    v_mfma_f32_16x16x32_bf16 v[60:63], a[64:67], v[24:27], v[60:63]
    ds_read_b128 v[20:23], v10 offset:24576
    v_mfma_f32_16x16x32_bf16 v[64:67], a[68:71], v[24:27], v[64:67]
    v_cvt_pk_bf16_f32 v91, v82, v83
    s_waitcnt lgkmcnt(6)
    v_mfma_f32_16x16x32_bf16 v[52:55], a[72:75], v[28:31], v[52:55]
    ds_read_b128 v[24:27], v10 offset:24832
    v_mfma_f32_16x16x32_bf16 v[56:59], a[76:79], v[28:31], v[56:59]
    s_waitcnt lgkmcnt(6)
    v_mfma_f32_16x16x32_bf16 v[60:63], a[72:75], v[32:35], v[60:63]
    ds_read_b128 v[28:31], v11 offset:24576
    v_mfma_f32_16x16x32_bf16 v[64:67], a[76:79], v[32:35], v[64:67]
    buffer_store_dwordx4 v[88:91], v4, s[12:15], s21 offen
    s_waitcnt lgkmcnt(6)
    v_mfma_f32_16x16x32_bf16 v[52:55], a[80:83], v[36:39], v[52:55]
    ds_read_b128 v[32:35], v11 offset:24832
    v_mfma_f32_16x16x32_bf16 v[56:59], a[84:87], v[36:39], v[56:59]
    s_add_u32 s21, s21, s25
    s_mov_b32 s25, s26
    s_waitcnt lgkmcnt(6)
    v_mfma_f32_16x16x32_bf16 v[60:63], a[80:83], v[40:43], v[60:63]
    ds_read_b128 v[36:39], v10 offset:28672
    v_mfma_f32_16x16x32_bf16 v[64:67], a[84:87], v[40:43], v[64:67]
    s_waitcnt lgkmcnt(6)
    v_mfma_f32_16x16x32_bf16 v[52:55], a[88:91], v[44:47], v[52:55]
    ds_read_b128 v[40:43], v10 offset:28928
    v_mfma_f32_16x16x32_bf16 v[56:59], a[92:95], v[44:47], v[56:59]
    s_waitcnt lgkmcnt(6)
    v_mfma_f32_16x16x32_bf16 v[60:63], a[88:91], v[48:51], v[60:63]
    ds_read_b128 v[44:47], v11 offset:28672
    v_mfma_f32_16x16x32_bf16 v[64:67], a[92:95], v[48:51], v[64:67]
    s_waitcnt lgkmcnt(6)
    v_mfma_f32_16x16x32_bf16 v[52:55], a[96:99], v[20:23], v[52:55]
    ds_read_b128 v[48:51], v11 offset:28928
    v_mfma_f32_16x16x32_bf16 v[56:59], a[100:103], v[20:23], v[56:59]
    s_waitcnt lgkmcnt(6)
    v_mfma_f32_16x16x32_bf16 v[60:63], a[96:99], v[24:27], v[60:63]
    s_waitcnt vmcnt(10)
    s_barrier
    ds_read_b128 v[20:23], v10 offset:32768
    v_mfma_f32_16x16x32_bf16 v[64:67], a[100:103], v[24:27], v[64:67]
    s_waitcnt lgkmcnt(6)
    v_mfma_f32_16x16x32_bf16 v[52:55], a[104:107], v[28:31], v[52:55]
    ds_read_b128 v[24:27], v10 offset:33024
    s_add_u32 m0, s19, 98304
    v_mfma_f32_16x16x32_bf16 v[56:59], a[108:111], v[28:31], v[56:59]
    s_add_u32 s17, s20, 2113536
    buffer_load_dwordx4 v2, s[4:7], s17 offen lds
    s_waitcnt lgkmcnt(6)
    v_mfma_f32_16x16x32_bf16 v[60:63], a[104:107], v[32:35], v[60:63]
    ds_read_b128 v[28:31], v11 offset:32768
    v_mfma_f32_16x16x32_bf16 v[64:67], a[108:111], v[32:35], v[64:67]
    s_waitcnt lgkmcnt(6)
    v_mfma_f32_16x16x32_bf16 v[52:55], a[112:115], v[36:39], v[52:55]
    ds_read_b128 v[32:35], v11 offset:33024
    s_add_u32 m0, s19, 102400
    v_mfma_f32_16x16x32_bf16 v[56:59], a[116:119], v[36:39], v[56:59]
    s_add_u32 s17, s20, 2377728
    buffer_load_dwordx4 v2, s[4:7], s17 offen lds
    s_waitcnt lgkmcnt(6)
    v_mfma_f32_16x16x32_bf16 v[60:63], a[112:115], v[40:43], v[60:63]
    ds_read_b128 v[36:39], v10 offset:36864
    v_mfma_f32_16x16x32_bf16 v[64:67], a[116:119], v[40:43], v[64:67]
    s_waitcnt lgkmcnt(6)
    v_mfma_f32_16x16x32_bf16 v[52:55], a[120:123], v[44:47], v[52:55]
    ds_read_b128 v[40:43], v10 offset:37120
    s_add_u32 m0, s19, 106496
    v_mfma_f32_16x16x32_bf16 v[56:59], a[124:127], v[44:47], v[56:59]
    s_add_u32 s17, s20, 2641920
    buffer_load_dwordx4 v2, s[4:7], s17 offen lds
    s_waitcnt lgkmcnt(6)
    v_mfma_f32_16x16x32_bf16 v[60:63], a[120:123], v[48:51], v[60:63]
    ds_read_b128 v[44:47], v11 offset:36864
    v_mfma_f32_16x16x32_bf16 v[64:67], a[124:127], v[48:51], v[64:67]
    s_waitcnt lgkmcnt(6)
    v_mfma_f32_16x16x32_bf16 v[52:55], a[128:131], v[20:23], v[52:55]
    ds_read_b128 v[48:51], v11 offset:37120
    v_mfma_f32_16x16x32_bf16 v[56:59], a[132:135], v[20:23], v[56:59]
    s_waitcnt lgkmcnt(6)
    v_mfma_f32_16x16x32_bf16 v[60:63], a[128:131], v[24:27], v[60:63]
    ds_read_b128 v[20:23], v10 offset:40960
    s_add_u32 m0, s19, 110592
    v_mfma_f32_16x16x32_bf16 v[64:67], a[132:135], v[24:27], v[64:67]
    s_add_u32 s17, s20, 2906112
    buffer_load_dwordx4 v2, s[4:7], s17 offen lds
    s_waitcnt lgkmcnt(6)
    v_mfma_f32_16x16x32_bf16 v[52:55], a[136:139], v[28:31], v[52:55]
    ds_read_b128 v[24:27], v10 offset:41216
    v_mfma_f32_16x16x32_bf16 v[56:59], a[140:143], v[28:31], v[56:59]
    s_waitcnt lgkmcnt(6)
    v_mfma_f32_16x16x32_bf16 v[60:63], a[136:139], v[32:35], v[60:63]
    ds_read_b128 v[28:31], v11 offset:40960
    s_add_u32 m0, s19, 114688
    v_mfma_f32_16x16x32_bf16 v[64:67], a[140:143], v[32:35], v[64:67]
    s_add_u32 s17, s20, 3170304
    buffer_load_dwordx4 v2, s[4:7], s17 offen lds
    s_waitcnt lgkmcnt(6)
    v_mfma_f32_16x16x32_bf16 v[52:55], a[144:147], v[36:39], v[52:55]
    ds_read_b128 v[32:35], v11 offset:41216
    v_mfma_f32_16x16x32_bf16 v[56:59], a[148:151], v[36:39], v[56:59]
    s_waitcnt lgkmcnt(6)
    v_mfma_f32_16x16x32_bf16 v[60:63], a[144:147], v[40:43], v[60:63]
    ds_read_b128 v[36:39], v10 offset:45056
    s_add_u32 m0, s19, 118784
    v_mfma_f32_16x16x32_bf16 v[64:67], a[148:151], v[40:43], v[64:67]
    s_add_u32 s17, s20, 3434496
    buffer_load_dwordx4 v2, s[4:7], s17 offen lds
    s_waitcnt lgkmcnt(6)
    v_mfma_f32_16x16x32_bf16 v[52:55], a[152:155], v[44:47], v[52:55]
    ds_read_b128 v[40:43], v10 offset:45312
    v_mfma_f32_16x16x32_bf16 v[56:59], a[156:159], v[44:47], v[56:59]
    s_waitcnt lgkmcnt(6)
    v_mfma_f32_16x16x32_bf16 v[60:63], a[152:155], v[48:51], v[60:63]
    ds_read_b128 v[44:47], v11 offset:45056
    s_add_u32 m0, s19, 122880
    v_mfma_f32_16x16x32_bf16 v[64:67], a[156:159], v[48:51], v[64:67]
    s_add_u32 s17, s20, 3698688
    buffer_load_dwordx4 v2, s[4:7], s17 offen lds
    s_waitcnt lgkmcnt(6)
    v_mfma_f32_16x16x32_bf16 v[52:55], a[160:163], v[20:23], v[52:55]
    ds_read_b128 v[48:51], v11 offset:45312
    v_mfma_f32_16x16x32_bf16 v[56:59], a[164:167], v[20:23], v[56:59]
    s_waitcnt lgkmcnt(6)
    v_mfma_f32_16x16x32_bf16 v[60:63], a[160:163], v[24:27], v[60:63]
    ds_read_b128 v[20:23], v10 offset:49152
    s_add_u32 m0, s19, 126976
    v_mfma_f32_16x16x32_bf16 v[64:67], a[164:167], v[24:27], v[64:67]
    s_add_u32 s17, s20, 3962880
    buffer_load_dwordx4 v2, s[4:7], s17 offen lds
    s_waitcnt lgkmcnt(6)
    v_mfma_f32_16x16x32_bf16 v[52:55], a[168:171], v[28:31], v[52:55]
    ds_read_b128 v[24:27], v10 offset:49408
    v_mfma_f32_16x16x32_bf16 v[56:59], a[172:175], v[28:31], v[56:59]
    s_add_u32 s20, s20, s24
    s_waitcnt lgkmcnt(6)
    v_mfma_f32_16x16x32_bf16 v[60:63], a[168:171], v[32:35], v[60:63]
    ds_read_b128 v[28:31], v11 offset:49152
    v_mfma_f32_16x16x32_bf16 v[64:67], a[172:175], v[32:35], v[64:67]
    s_waitcnt lgkmcnt(6)
    v_mfma_f32_16x16x32_bf16 v[52:55], a[176:179], v[36:39], v[52:55]
    ds_read_b128 v[32:35], v11 offset:49408
    v_mfma_f32_16x16x32_bf16 v[56:59], a[180:183], v[36:39], v[56:59]
    s_waitcnt lgkmcnt(6)
    v_mfma_f32_16x16x32_bf16 v[60:63], a[176:179], v[40:43], v[60:63]
    ds_read_b128 v[36:39], v10 offset:53248
    v_mfma_f32_16x16x32_bf16 v[64:67], a[180:183], v[40:43], v[64:67]
    s_waitcnt lgkmcnt(6)
    v_mfma_f32_16x16x32_bf16 v[52:55], a[184:187], v[44:47], v[52:55]
    ds_read_b128 v[40:43], v10 offset:53504
    v_mfma_f32_16x16x32_bf16 v[56:59], a[188:191], v[44:47], v[56:59]
    s_waitcnt lgkmcnt(6)
    v_mfma_f32_16x16x32_bf16 v[60:63], a[184:187], v[48:51], v[60:63]
    ds_read_b128 v[44:47], v11 offset:53248
    v_mfma_f32_16x16x32_bf16 v[64:67], a[188:191], v[48:51], v[64:67]
    s_waitcnt lgkmcnt(6)
    v_mfma_f32_16x16x32_bf16 v[52:55], a[192:195], v[20:23], v[52:55]
    ds_read_b128 v[48:51], v11 offset:53504
    v_mfma_f32_16x16x32_bf16 v[56:59], a[196:199], v[20:23], v[56:59]
    s_waitcnt lgkmcnt(6)
    v_mfma_f32_16x16x32_bf16 v[60:63], a[192:195], v[24:27], v[60:63]
    ds_read_b128 v[20:23], v10 offset:57344
    v_mfma_f32_16x16x32_bf16 v[64:67], a[196:199], v[24:27], v[64:67]
    s_waitcnt lgkmcnt(6)
    v_mfma_f32_16x16x32_bf16 v[52:55], a[200:203], v[28:31], v[52:55]
    ds_read_b128 v[24:27], v10 offset:57600
    v_mfma_f32_16x16x32_bf16 v[56:59], a[204:207], v[28:31], v[56:59]
    s_waitcnt lgkmcnt(6)
    v_mfma_f32_16x16x32_bf16 v[60:63], a[200:203], v[32:35], v[60:63]
    ds_read_b128 v[28:31], v11 offset:57344
    v_mfma_f32_16x16x32_bf16 v[64:67], a[204:207], v[32:35], v[64:67]
    s_waitcnt lgkmcnt(6)
    v_mfma_f32_16x16x32_bf16 v[52:55], a[208:211], v[36:39], v[52:55]
    ds_read_b128 v[32:35], v11 offset:57600
    v_mfma_f32_16x16x32_bf16 v[56:59], a[212:215], v[36:39], v[56:59]
    s_waitcnt lgkmcnt(6)
    v_mfma_f32_16x16x32_bf16 v[60:63], a[208:211], v[40:43], v[60:63]
    ds_read_b128 v[36:39], v10 offset:61440
    v_mfma_f32_16x16x32_bf16 v[64:67], a[212:215], v[40:43], v[64:67]
    s_waitcnt lgkmcnt(6)
    v_mfma_f32_16x16x32_bf16 v[52:55], a[216:219], v[44:47], v[52:55]
    ds_read_b128 v[40:43], v10 offset:61696
    v_mfma_f32_16x16x32_bf16 v[56:59], a[220:223], v[44:47], v[56:59]
    s_waitcnt lgkmcnt(6)
    v_mfma_f32_16x16x32_bf16 v[60:63], a[216:219], v[48:51], v[60:63]
    ds_read_b128 v[44:47], v11 offset:61440
    v_mfma_f32_16x16x32_bf16 v[64:67], a[220:223], v[48:51], v[64:67]
    s_waitcnt lgkmcnt(6)
    v_mfma_f32_16x16x32_bf16 v[52:55], a[224:227], v[20:23], v[52:55]
    ds_read_b128 v[48:51], v11 offset:61696
    v_mfma_f32_16x16x32_bf16 v[56:59], a[228:231], v[20:23], v[56:59]
    s_waitcnt lgkmcnt(6)
    v_mfma_f32_16x16x32_bf16 v[60:63], a[224:227], v[24:27], v[60:63]
    s_waitcnt vmcnt(8)
    s_barrier
    ds_read_b128 v[20:23], v12 offset:0
    v_mfma_f32_16x16x32_bf16 v[64:67], a[228:231], v[24:27], v[64:67]
    s_waitcnt lgkmcnt(6)
    v_mfma_f32_16x16x32_bf16 v[52:55], a[232:235], v[28:31], v[52:55]
    ds_read_b128 v[24:27], v12 offset:256
    s_add_u32 m0, s19, 0
    v_mfma_f32_16x16x32_bf16 v[56:59], a[236:239], v[28:31], v[56:59]
    s_add_u32 s17, s20, 0
    buffer_load_dwordx4 v2, s[4:7], s17 offen lds
    s_waitcnt lgkmcnt(6)
    v_mfma_f32_16x16x32_bf16 v[60:63], a[232:235], v[32:35], v[60:63]
    ds_read_b128 v[28:31], v13 offset:0
    v_mfma_f32_16x16x32_bf16 v[64:67], a[236:239], v[32:35], v[64:67]
    s_waitcnt lgkmcnt(6)
    v_mfma_f32_16x16x32_bf16 v[52:55], a[240:243], v[36:39], v[52:55]
    ds_read_b128 v[32:35], v13 offset:256
    s_add_u32 m0, s19, 4096
    v_mfma_f32_16x16x32_bf16 v[56:59], a[244:247], v[36:39], v[56:59]
    s_add_u32 s17, s20, 264192
    buffer_load_dwordx4 v2, s[4:7], s17 offen lds
    s_waitcnt lgkmcnt(6)
    v_mfma_f32_16x16x32_bf16 v[60:63], a[240:243], v[40:43], v[60:63]
    ds_read_b128 v[36:39], v12 offset:4096
    v_mfma_f32_16x16x32_bf16 v[64:67], a[244:247], v[40:43], v[64:67]
    s_waitcnt lgkmcnt(6)
    v_mfma_f32_16x16x32_bf16 v[52:55], a[248:251], v[44:47], v[52:55]
    ds_read_b128 v[40:43], v12 offset:4352
    s_add_u32 m0, s19, 8192
    v_mfma_f32_16x16x32_bf16 v[56:59], a[252:255], v[44:47], v[56:59]
    s_add_u32 s17, s20, 528384
    buffer_load_dwordx4 v2, s[4:7], s17 offen lds
    s_waitcnt lgkmcnt(6)
    v_mfma_f32_16x16x32_bf16 v[60:63], a[248:251], v[48:51], v[60:63]
    ds_read_b128 v[44:47], v13 offset:4096
    v_mfma_f32_16x16x32_bf16 v[64:67], a[252:255], v[48:51], v[64:67]
    s_waitcnt lgkmcnt(6)
    v_mfma_f32_16x16x32_bf16 v[68:71], a[0:3], v[20:23], 0
    ds_read_b128 v[48:51], v13 offset:4352
    v_mfma_f32_16x16x32_bf16 v[72:75], a[4:7], v[20:23], 0
    s_waitcnt lgkmcnt(6)
    v_mfma_f32_16x16x32_bf16 v[76:79], a[0:3], v[24:27], 0
    ds_read_b128 v[20:23], v12 offset:8192
    s_add_u32 m0, s19, 12288
    v_mfma_f32_16x16x32_bf16 v[80:83], a[4:7], v[24:27], 0
    s_add_u32 s17, s20, 792576
    buffer_load_dwordx4 v2, s[4:7], s17 offen lds
    s_waitcnt lgkmcnt(6)
    v_mfma_f32_16x16x32_bf16 v[68:71], a[8:11], v[28:31], v[68:71]
    ds_read_b128 v[24:27], v12 offset:8448
    v_mfma_f32_16x16x32_bf16 v[72:75], a[12:15], v[28:31], v[72:75]
    s_waitcnt lgkmcnt(6)
    v_mfma_f32_16x16x32_bf16 v[76:79], a[8:11], v[32:35], v[76:79]
    ds_read_b128 v[28:31], v13 offset:8192
    s_add_u32 m0, s19, 16384
    v_mfma_f32_16x16x32_bf16 v[80:83], a[12:15], v[32:35], v[80:83]
    s_add_u32 s17, s20, 1056768
    buffer_load_dwordx4 v2, s[4:7], s17 offen lds
    s_waitcnt lgkmcnt(6)
    v_mfma_f32_16x16x32_bf16 v[68:71], a[16:19], v[36:39], v[68:71]
    ds_read_b128 v[32:35], v13 offset:8448
    v_mfma_f32_16x16x32_bf16 v[72:75], a[20:23], v[36:39], v[72:75]
    s_waitcnt lgkmcnt(6)
    v_mfma_f32_16x16x32_bf16 v[76:79], a[16:19], v[40:43], v[76:79]
    ds_read_b128 v[36:39], v12 offset:12288
    s_add_u32 m0, s19, 20480
    v_mfma_f32_16x16x32_bf16 v[80:83], a[20:23], v[40:43], v[80:83]
    s_add_u32 s17, s20, 1320960
    buffer_load_dwordx4 v2, s[4:7], s17 offen lds
    s_waitcnt lgkmcnt(6)
    v_mfma_f32_16x16x32_bf16 v[68:71], a[24:27], v[44:47], v[68:71]
    ds_read_b128 v[40:43], v12 offset:12544
    v_mfma_f32_16x16x32_bf16 v[72:75], a[28:31], v[44:47], v[72:75]
    s_waitcnt lgkmcnt(6)
    v_mfma_f32_16x16x32_bf16 v[76:79], a[24:27], v[48:51], v[76:79]
    ds_read_b128 v[44:47], v13 offset:12288
    s_add_u32 m0, s19, 24576
    v_mfma_f32_16x16x32_bf16 v[80:83], a[28:31], v[48:51], v[80:83]
    s_add_u32 s17, s20, 1585152
    buffer_load_dwordx4 v2, s[4:7], s17 offen lds
    s_waitcnt lgkmcnt(6)
    v_mfma_f32_16x16x32_bf16 v[68:71], a[32:35], v[20:23], v[68:71]
    ds_read_b128 v[48:51], v13 offset:12544
    v_mfma_f32_16x16x32_bf16 v[72:75], a[36:39], v[20:23], v[72:75]
    s_waitcnt lgkmcnt(6)
    v_mfma_f32_16x16x32_bf16 v[76:79], a[32:35], v[24:27], v[76:79]
    ds_read_b128 v[20:23], v12 offset:16384
    s_add_u32 m0, s19, 28672
    v_mfma_f32_16x16x32_bf16 v[80:83], a[36:39], v[24:27], v[80:83]
    s_add_u32 s17, s20, 1849344
    buffer_load_dwordx4 v2, s[4:7], s17 offen lds
    s_waitcnt lgkmcnt(6)
    v_mfma_f32_16x16x32_bf16 v[68:71], a[40:43], v[28:31], v[68:71]
    ds_read_b128 v[24:27], v12 offset:16640
    v_mfma_f32_16x16x32_bf16 v[72:75], a[44:47], v[28:31], v[72:75]
    v_cvt_pk_bf16_f32 v84, v52, v53
    s_waitcnt lgkmcnt(6)
    v_mfma_f32_16x16x32_bf16 v[76:79], a[40:43], v[32:35], v[76:79]
    ds_read_b128 v[28:31], v13 offset:16384
    v_mfma_f32_16x16x32_bf16 v[80:83], a[44:47], v[32:35], v[80:83]
    v_cvt_pk_bf16_f32 v85, v54, v55
    s_waitcnt lgkmcnt(6)
    v_mfma_f32_16x16x32_bf16 v[68:71], a[48:51], v[36:39], v[68:71]
    ds_read_b128 v[32:35], v13 offset:16640
    v_mfma_f32_16x16x32_bf16 v[72:75], a[52:55], v[36:39], v[72:75]
    v_cvt_pk_bf16_f32 v86, v56, v57
    s_waitcnt lgkmcnt(6)
    v_mfma_f32_16x16x32_bf16 v[76:79], a[48:51], v[40:43], v[76:79]
    ds_read_b128 v[36:39], v12 offset:20480
    v_mfma_f32_16x16x32_bf16 v[80:83], a[52:55], v[40:43], v[80:83]
    v_cvt_pk_bf16_f32 v87, v58, v59
    s_waitcnt lgkmcnt(6)
    v_mfma_f32_16x16x32_bf16 v[68:71], a[56:59], v[44:47], v[68:71]
    ds_read_b128 v[40:43], v12 offset:20736
    v_mfma_f32_16x16x32_bf16 v[72:75], a[60:63], v[44:47], v[72:75]
    v_cvt_pk_bf16_f32 v88, v60, v61
    s_waitcnt lgkmcnt(6)
    v_mfma_f32_16x16x32_bf16 v[76:79], a[56:59], v[48:51], v[76:79]
    ds_read_b128 v[44:47], v13 offset:20480
    v_mfma_f32_16x16x32_bf16 v[80:83], a[60:63], v[48:51], v[80:83]
    v_cvt_pk_bf16_f32 v89, v62, v63
    buffer_store_dwordx4 v[84:87], v3, s[12:15], s21 offen
    s_waitcnt lgkmcnt(6)
    v_mfma_f32_16x16x32_bf16 v[68:71], a[64:67], v[20:23], v[68:71]
    ds_read_b128 v[48:51], v13 offset:20736
    v_mfma_f32_16x16x32_bf16 v[72:75], a[68:71], v[20:23], v[72:75]
    v_cvt_pk_bf16_f32 v90, v64, v65
    s_waitcnt lgkmcnt(6)
    v_mfma_f32_16x16x32_bf16 v[76:79], a[64:67], v[24:27], v[76:79]
    ds_read_b128 v[20:23], v12 offset:24576
    v_mfma_f32_16x16x32_bf16 v[80:83], a[68:71], v[24:27], v[80:83]
    v_cvt_pk_bf16_f32 v91, v66, v67
    s_waitcnt lgkmcnt(6)
    v_mfma_f32_16x16x32_bf16 v[68:71], a[72:75], v[28:31], v[68:71]
    ds_read_b128 v[24:27], v12 offset:24832
    v_mfma_f32_16x16x32_bf16 v[72:75], a[76:79], v[28:31], v[72:75]
    s_waitcnt lgkmcnt(6)
    v_mfma_f32_16x16x32_bf16 v[76:79], a[72:75], v[32:35], v[76:79]
    ds_read_b128 v[28:31], v13 offset:24576
    v_mfma_f32_16x16x32_bf16 v[80:83], a[76:79], v[32:35], v[80:83]
    buffer_store_dwordx4 v[88:91], v4, s[12:15], s21 offen
    s_waitcnt lgkmcnt(6)
    v_mfma_f32_16x16x32_bf16 v[68:71], a[80:83], v[36:39], v[68:71]
    ds_read_b128 v[32:35], v13 offset:24832
    v_mfma_f32_16x16x32_bf16 v[72:75], a[84:87], v[36:39], v[72:75]
    s_add_u32 s21, s21, s25
    s_mov_b32 s25, s26
    s_waitcnt lgkmcnt(6)
    v_mfma_f32_16x16x32_bf16 v[76:79], a[80:83], v[40:43], v[76:79]
    ds_read_b128 v[36:39], v12 offset:28672
    v_mfma_f32_16x16x32_bf16 v[80:83], a[84:87], v[40:43], v[80:83]
    s_waitcnt lgkmcnt(6)
    v_mfma_f32_16x16x32_bf16 v[68:71], a[88:91], v[44:47], v[68:71]
    ds_read_b128 v[40:43], v12 offset:28928
    v_mfma_f32_16x16x32_bf16 v[72:75], a[92:95], v[44:47], v[72:75]
    s_waitcnt lgkmcnt(6)
    v_mfma_f32_16x16x32_bf16 v[76:79], a[88:91], v[48:51], v[76:79]
    ds_read_b128 v[44:47], v13 offset:28672
    v_mfma_f32_16x16x32_bf16 v[80:83], a[92:95], v[48:51], v[80:83]
    s_waitcnt lgkmcnt(6)
    v_mfma_f32_16x16x32_bf16 v[68:71], a[96:99], v[20:23], v[68:71]
    ds_read_b128 v[48:51], v13 offset:28928
    v_mfma_f32_16x16x32_bf16 v[72:75], a[100:103], v[20:23], v[72:75]
    s_waitcnt lgkmcnt(6)
    v_mfma_f32_16x16x32_bf16 v[76:79], a[96:99], v[24:27], v[76:79]
    s_waitcnt vmcnt(10)
    s_barrier
    ds_read_b128 v[20:23], v12 offset:32768
    v_mfma_f32_16x16x32_bf16 v[80:83], a[100:103], v[24:27], v[80:83]
    s_waitcnt lgkmcnt(6)
    v_mfma_f32_16x16x32_bf16 v[68:71], a[104:107], v[28:31], v[68:71]
    ds_read_b128 v[24:27], v12 offset:33024
    s_add_u32 m0, s19, 32768
    v_mfma_f32_16x16x32_bf16 v[72:75], a[108:111], v[28:31], v[72:75]
    s_add_u32 s17, s20, 2113536
    buffer_load_dwordx4 v2, s[4:7], s17 offen lds
    s_waitcnt lgkmcnt(6)
    v_mfma_f32_16x16x32_bf16 v[76:79], a[104:107], v[32:35], v[76:79]
    ds_read_b128 v[28:31], v13 offset:32768
    v_mfma_f32_16x16x32_bf16 v[80:83], a[108:111], v[32:35], v[80:83]
    s_waitcnt lgkmcnt(6)
    v_mfma_f32_16x16x32_bf16 v[68:71], a[112:115], v[36:39], v[68:71]
    ds_read_b128 v[32:35], v13 offset:33024
    s_add_u32 m0, s19, 36864
    v_mfma_f32_16x16x32_bf16 v[72:75], a[116:119], v[36:39], v[72:75]
    s_add_u32 s17, s20, 2377728
    buffer_load_dwordx4 v2, s[4:7], s17 offen lds
    s_waitcnt lgkmcnt(6)
    v_mfma_f32_16x16x32_bf16 v[76:79], a[112:115], v[40:43], v[76:79]
    ds_read_b128 v[36:39], v12 offset:36864
    v_mfma_f32_16x16x32_bf16 v[80:83], a[116:119], v[40:43], v[80:83]
    s_waitcnt lgkmcnt(6)
    v_mfma_f32_16x16x32_bf16 v[68:71], a[120:123], v[44:47], v[68:71]
    ds_read_b128 v[40:43], v12 offset:37120
    s_add_u32 m0, s19, 40960
    v_mfma_f32_16x16x32_bf16 v[72:75], a[124:127], v[44:47], v[72:75]
    s_add_u32 s17, s20, 2641920
    buffer_load_dwordx4 v2, s[4:7], s17 offen lds
    s_waitcnt lgkmcnt(6)
    v_mfma_f32_16x16x32_bf16 v[76:79], a[120:123], v[48:51], v[76:79]
    ds_read_b128 v[44:47], v13 offset:36864
    v_mfma_f32_16x16x32_bf16 v[80:83], a[124:127], v[48:51], v[80:83]
    s_waitcnt lgkmcnt(6)
    v_mfma_f32_16x16x32_bf16 v[68:71], a[128:131], v[20:23], v[68:71]
    ds_read_b128 v[48:51], v13 offset:37120
    v_mfma_f32_16x16x32_bf16 v[72:75], a[132:135], v[20:23], v[72:75]
    s_waitcnt lgkmcnt(6)
    v_mfma_f32_16x16x32_bf16 v[76:79], a[128:131], v[24:27], v[76:79]
    ds_read_b128 v[20:23], v12 offset:40960
    s_add_u32 m0, s19, 45056
    v_mfma_f32_16x16x32_bf16 v[80:83], a[132:135], v[24:27], v[80:83]
    s_add_u32 s17, s20, 2906112
    buffer_load_dwordx4 v2, s[4:7], s17 offen lds
    s_waitcnt lgkmcnt(6)
    v_mfma_f32_16x16x32_bf16 v[68:71], a[136:139], v[28:31], v[68:71]
    ds_read_b128 v[24:27], v12 offset:41216
    v_mfma_f32_16x16x32_bf16 v[72:75], a[140:143], v[28:31], v[72:75]
    s_waitcnt lgkmcnt(6)
    v_mfma_f32_16x16x32_bf16 v[76:79], a[136:139], v[32:35], v[76:79]
    ds_read_b128 v[28:31], v13 offset:40960
    s_add_u32 m0, s19, 49152
    v_mfma_f32_16x16x32_bf16 v[80:83], a[140:143], v[32:35], v[80:83]
    s_add_u32 s17, s20, 3170304
    buffer_load_dwordx4 v2, s[4:7], s17 offen lds
    s_waitcnt lgkmcnt(6)
    v_mfma_f32_16x16x32_bf16 v[68:71], a[144:147], v[36:39], v[68:71]
    ds_read_b128 v[32:35], v13 offset:41216
    v_mfma_f32_16x16x32_bf16 v[72:75], a[148:151], v[36:39], v[72:75]
    s_waitcnt lgkmcnt(6)
    v_mfma_f32_16x16x32_bf16 v[76:79], a[144:147], v[40:43], v[76:79]
    ds_read_b128 v[36:39], v12 offset:45056
    s_add_u32 m0, s19, 53248
    v_mfma_f32_16x16x32_bf16 v[80:83], a[148:151], v[40:43], v[80:83]
    s_add_u32 s17, s20, 3434496
    buffer_load_dwordx4 v2, s[4:7], s17 offen lds
    s_waitcnt lgkmcnt(6)
    v_mfma_f32_16x16x32_bf16 v[68:71], a[152:155], v[44:47], v[68:71]
    ds_read_b128 v[40:43], v12 offset:45312
    v_mfma_f32_16x16x32_bf16 v[72:75], a[156:159], v[44:47], v[72:75]
    s_waitcnt lgkmcnt(6)
    v_mfma_f32_16x16x32_bf16 v[76:79], a[152:155], v[48:51], v[76:79]
    ds_read_b128 v[44:47], v13 offset:45056
    s_add_u32 m0, s19, 57344
    v_mfma_f32_16x16x32_bf16 v[80:83], a[156:159], v[48:51], v[80:83]
    s_add_u32 s17, s20, 3698688
    buffer_load_dwordx4 v2, s[4:7], s17 offen lds
    s_waitcnt lgkmcnt(6)
    v_mfma_f32_16x16x32_bf16 v[68:71], a[160:163], v[20:23], v[68:71]
    ds_read_b128 v[48:51], v13 offset:45312
    v_mfma_f32_16x16x32_bf16 v[72:75], a[164:167], v[20:23], v[72:75]
    s_waitcnt lgkmcnt(6)
    v_mfma_f32_16x16x32_bf16 v[76:79], a[160:163], v[24:27], v[76:79]
    ds_read_b128 v[20:23], v12 offset:49152
    s_add_u32 m0, s19, 61440
    v_mfma_f32_16x16x32_bf16 v[80:83], a[164:167], v[24:27], v[80:83]
    s_add_u32 s17, s20, 3962880
    buffer_load_dwordx4 v2, s[4:7], s17 offen lds
    s_waitcnt lgkmcnt(6)
    v_mfma_f32_16x16x32_bf16 v[68:71], a[168:171], v[28:31], v[68:71]
    ds_read_b128 v[24:27], v12 offset:49408
    v_mfma_f32_16x16x32_bf16 v[72:75], a[172:175], v[28:31], v[72:75]
    s_add_u32 s20, s20, s24
    s_waitcnt lgkmcnt(6)
    v_mfma_f32_16x16x32_bf16 v[76:79], a[168:171], v[32:35], v[76:79]
    ds_read_b128 v[28:31], v13 offset:49152
    v_mfma_f32_16x16x32_bf16 v[80:83], a[172:175], v[32:35], v[80:83]
    s_waitcnt lgkmcnt(6)
    v_mfma_f32_16x16x32_bf16 v[68:71], a[176:179], v[36:39], v[68:71]
    ds_read_b128 v[32:35], v13 offset:49408
    v_mfma_f32_16x16x32_bf16 v[72:75], a[180:183], v[36:39], v[72:75]
    s_waitcnt lgkmcnt(6)
    v_mfma_f32_16x16x32_bf16 v[76:79], a[176:179], v[40:43], v[76:79]
    ds_read_b128 v[36:39], v12 offset:53248
    v_mfma_f32_16x16x32_bf16 v[80:83], a[180:183], v[40:43], v[80:83]
    s_waitcnt lgkmcnt(6)
    v_mfma_f32_16x16x32_bf16 v[68:71], a[184:187], v[44:47], v[68:71]
    ds_read_b128 v[40:43], v12 offset:53504
    v_mfma_f32_16x16x32_bf16 v[72:75], a[188:191], v[44:47], v[72:75]
    s_waitcnt lgkmcnt(6)
    v_mfma_f32_16x16x32_bf16 v[76:79], a[184:187], v[48:51], v[76:79]
    ds_read_b128 v[44:47], v13 offset:53248
    v_mfma_f32_16x16x32_bf16 v[80:83], a[188:191], v[48:51], v[80:83]
    s_waitcnt lgkmcnt(6)
    v_mfma_f32_16x16x32_bf16 v[68:71], a[192:195], v[20:23], v[68:71]
    ds_read_b128 v[48:51], v13 offset:53504
    v_mfma_f32_16x16x32_bf16 v[72:75], a[196:199], v[20:23], v[72:75]
    s_waitcnt lgkmcnt(6)
    v_mfma_f32_16x16x32_bf16 v[76:79], a[192:195], v[24:27], v[76:79]
    ds_read_b128 v[20:23], v12 offset:57344
    v_mfma_f32_16x16x32_bf16 v[80:83], a[196:199], v[24:27], v[80:83]
    s_waitcnt lgkmcnt(6)
    v_mfma_f32_16x16x32_bf16 v[68:71], a[200:203], v[28:31], v[68:71]
    ds_read_b128 v[24:27], v12 offset:57600
    v_mfma_f32_16x16x32_bf16 v[72:75], a[204:207], v[28:31], v[72:75]
    s_waitcnt lgkmcnt(6)
    v_mfma_f32_16x16x32_bf16 v[76:79], a[200:203], v[32:35], v[76:79]
    ds_read_b128 v[28:31], v13 offset:57344
    v_mfma_f32_16x16x32_bf16 v[80:83], a[204:207], v[32:35], v[80:83]
    s_waitcnt lgkmcnt(6)
    v_mfma_f32_16x16x32_bf16 v[68:71], a[208:211], v[36:39], v[68:71]
    ds_read_b128 v[32:35], v13 offset:57600
    v_mfma_f32_16x16x32_bf16 v[72:75], a[212:215], v[36:39], v[72:75]
    s_waitcnt lgkmcnt(6)
    v_mfma_f32_16x16x32_bf16 v[76:79], a[208:211], v[40:43], v[76:79]
    ds_read_b128 v[36:39], v12 offset:61440
    v_mfma_f32_16x16x32_bf16 v[80:83], a[212:215], v[40:43], v[80:83]
    s_waitcnt lgkmcnt(6)
    v_mfma_f32_16x16x32_bf16 v[68:71], a[216:219], v[44:47], v[68:71]
    ds_read_b128 v[40:43], v12 offset:61696
    v_mfma_f32_16x16x32_bf16 v[72:75], a[220:223], v[44:47], v[72:75]
    s_waitcnt lgkmcnt(6)
    v_mfma_f32_16x16x32_bf16 v[76:79], a[216:219], v[48:51], v[76:79]
    ds_read_b128 v[44:47], v13 offset:61440
    v_mfma_f32_16x16x32_bf16 v[80:83], a[220:223], v[48:51], v[80:83]
    s_waitcnt lgkmcnt(6)
    v_mfma_f32_16x16x32_bf16 v[68:71], a[224:227], v[20:23], v[68:71]
    ds_read_b128 v[48:51], v13 offset:61696
    v_mfma_f32_16x16x32_bf16 v[72:75], a[228:231], v[20:23], v[72:75]
    s_waitcnt lgkmcnt(6)
    v_mfma_f32_16x16x32_bf16 v[76:79], a[224:227], v[24:27], v[76:79]
    s_waitcnt vmcnt(8)
    s_barrier
    ds_read_b128 v[20:23], v10 offset:0
    v_mfma_f32_16x16x32_bf16 v[80:83], a[228:231], v[24:27], v[80:83]
    s_waitcnt lgkmcnt(6)
    v_mfma_f32_16x16x32_bf16 v[68:71], a[232:235], v[28:31], v[68:71]
    ds_read_b128 v[24:27], v10 offset:256
    s_add_u32 m0, s19, 65536
    v_mfma_f32_16x16x32_bf16 v[72:75], a[236:239], v[28:31], v[72:75]
    s_add_u32 s17, s20, 0
    buffer_load_dwordx4 v2, s[4:7], s17 offen lds
    s_waitcnt lgkmcnt(6)
    v_mfma_f32_16x16x32_bf16 v[76:79], a[232:235], v[32:35], v[76:79]
    ds_read_b128 v[28:31], v11 offset:0
    v_mfma_f32_16x16x32_bf16 v[80:83], a[236:239], v[32:35], v[80:83]
    s_waitcnt lgkmcnt(6)
    v_mfma_f32_16x16x32_bf16 v[68:71], a[240:243], v[36:39], v[68:71]
    ds_read_b128 v[32:35], v11 offset:256
    s_add_u32 m0, s19, 69632
    v_mfma_f32_16x16x32_bf16 v[72:75], a[244:247], v[36:39], v[72:75]
    s_add_u32 s17, s20, 264192
    buffer_load_dwordx4 v2, s[4:7], s17 offen lds
    s_waitcnt lgkmcnt(6)
    v_mfma_f32_16x16x32_bf16 v[76:79], a[240:243], v[40:43], v[76:79]
    ds_read_b128 v[36:39], v10 offset:4096
    v_mfma_f32_16x16x32_bf16 v[80:83], a[244:247], v[40:43], v[80:83]
    s_waitcnt lgkmcnt(6)
    v_mfma_f32_16x16x32_bf16 v[68:71], a[248:251], v[44:47], v[68:71]
    ds_read_b128 v[40:43], v10 offset:4352
    s_add_u32 m0, s19, 73728
    v_mfma_f32_16x16x32_bf16 v[72:75], a[252:255], v[44:47], v[72:75]
    s_add_u32 s17, s20, 528384
    buffer_load_dwordx4 v2, s[4:7], s17 offen lds
    s_waitcnt lgkmcnt(6)
    v_mfma_f32_16x16x32_bf16 v[76:79], a[248:251], v[48:51], v[76:79]
    ds_read_b128 v[44:47], v11 offset:4096
    v_mfma_f32_16x16x32_bf16 v[80:83], a[252:255], v[48:51], v[80:83]
    s_add_u32 s22, s22, 2
    s_cmp_lt_u32 s22, 16
    s_cbranch_scc1 F3_top
    v_cvt_pk_bf16_f32 v84, v68, v69
    v_cvt_pk_bf16_f32 v85, v70, v71
    v_cvt_pk_bf16_f32 v86, v72, v73
    v_cvt_pk_bf16_f32 v87, v74, v75
    v_cvt_pk_bf16_f32 v88, v76, v77
    v_cvt_pk_bf16_f32 v89, v78, v79
    v_cvt_pk_bf16_f32 v90, v80, v81
    v_cvt_pk_bf16_f32 v91, v82, v83
    buffer_store_dwordx4 v[84:87], v3, s[12:15], s21 offen
    buffer_store_dwordx4 v[88:91], v4, s[12:15], s21 offen
    s_waitcnt vmcnt(0) lgkmcnt(0)
    s_branch W_T
W_T:
    v_and_b32 v7, 19, v1
    v_bfe_u32 v5, v1, 2, 1
    v_bfe_u32 v6, v1, 3, 1
    v_lshl_add_u32 v7, v5, 3, v7
    v_lshl_add_u32 v7, v6, 2, v7
    v_lshrrev_b32 v5, 5, v1
    v_and_b32 v6, 31, v1
    v_lshlrev_b32 v8, 4, v5
    v_lshl_add_u32 v10, v6, 6, v8
    v_lshl_add_u32 v11, v7, 6, v8
    v_mov_b32 v17, 1073741824
    v_cmp_gt_u32 vcc, 8, v6
    s_nop 1
    v_cndmask_b32 v12, v17, v10, vcc
    v_lshlrev_b32 v13, 3, v5
    v_lshl_add_u32 v13, v7, 4, v13
    v_and_b32 v14, 15, v1
    v_lshlrev_b32 v14, 4, v14
    v_lshl_add_u32 v14, v5, 8, v14
    v_bfe_u32 v8, v1, 4, 1
    v_lshl_add_u32 v14, v8, 17, v14
    v_lshrrev_b32 v15, 2, v1
    v_and_b32 v8, 3, v1
    v_lshl_add_u32 v15, v15, 7, v8
    s_lshl_b32 s17, s93, 2
    v_add_u32 v15, s17, v15
    v_lshlrev_b32 v15, 7, v15
    v_add_u32 v15, 100663296, v15
    v_cmp_gt_u32 vcc, 16, v1
    s_nop 1
    v_cndmask_b32 v15, v17, v15, vcc
    v_mov_b32 v16, 0
    s_add_u32 s18, s16, s17
    s_lshl_b32 s18, s18, 7
    s_add_u32 s18, s18, 100728832
    v_lshl_add_u32 v4, v1, 2, s18
    v_cmp_gt_u32 vcc, 32, v1
    s_nop 1
    v_cndmask_b32 v4, v17, v4, vcc
    v_lshlrev_b32 v5, 3, v5
    v_sub_u32 v6, v6, v5
    s_mov_b32 s29, 1040356334
    s_mov_b32 s28, s16
    s_mul_i32 s31, s17, 133120
    s_lshl_b32 s18, s28, 11
    s_add_u32 s31, s31, s18
    s_mul_i32 s32, s17, 33280
    s_lshl_b32 s18, s28, 9
    s_add_u32 s32, s32, s18
    s_add_u32 s32, s32, 71303168
    s_lshl_b32 s33, s28, 18
    s_lshl_b32 s18, s93, 12
    s_add_u32 s33, s33, s18
    s_add_u32 s33, s33, 54525952
    v_mov_b32 v17, 0xff800000
    s_mov_b32 s35, 0
    v_mov_b32 v9, 0
    v_cmp_le_i32 s[36:37], 0, v6
    v_cmp_le_i32 s[38:39], 1, v6
    v_cmp_le_i32 s[40:41], 2, v6
    v_cmp_le_i32 s[42:43], 3, v6
    v_cmp_le_i32 s[44:45], 4, v6
    v_cmp_le_i32 s[46:47], 5, v6
    v_cmp_le_i32 s[48:49], 6, v6
    v_cmp_le_i32 s[50:51], 7, v6
    v_cmp_le_i32 s[52:53], 16, v6
    v_cmp_le_i32 s[54:55], 17, v6
    v_cmp_le_i32 s[56:57], 18, v6
    v_cmp_le_i32 s[58:59], 19, v6
    v_cmp_le_i32 s[60:61], 20, v6
    v_cmp_le_i32 s[62:63], 21, v6
    v_cmp_le_i32 s[64:65], 22, v6
    v_cmp_le_i32 s[66:67], 23, v6
    v_mov_b32 v54, 0
    v_mov_b32 v55, 0
    v_mov_b32 v58, 0
    v_mov_b32 v59, 0
    v_mov_b32 v62, 0
    v_mov_b32 v63, 0
    v_mov_b32 v66, 0
    v_mov_b32 v67, 0
    v_mov_b32 v102, 0
    v_mov_b32 v103, 0
    v_mov_b32 v106, 0
    v_mov_b32 v107, 0
    v_mov_b32 v110, 0
    v_mov_b32 v111, 0
    v_mov_b32 v114, 0
    v_mov_b32 v115, 0
    v_mov_b32 v158, 0
    v_mov_b32 v159, 0
    s_mov_b32 s30, s92
T_p:
    v_cmp_ge_u32 vcc, s28, v16
    s_nop 0
    s_and_b32 s17, vcc_lo, 4095
    s_cbranch_scc0 T_pk
    s_cmp_ge_u32 s30, 1048576
    s_cselect_b32 s92, 1048576, s92
    s_cbranch_scc1 T_pk
    s_add_u32 s30, s30, 1
    buffer_load_dword v16, v15, s[4:7], 0 offen sc1
    s_sleep 8
    s_waitcnt vmcnt(0)
    s_branch T_p
T_pk:
    s_add_u32 s17, s31, 0
    buffer_load_dwordx4 a[0:3], v10, s[4:7], s17 offen offset:0
    buffer_load_dwordx4 a[4:7], v10, s[4:7], s17 offen offset:32
    s_add_u32 s17, s31, 133120
    buffer_load_dwordx4 a[8:11], v10, s[4:7], s17 offen offset:0
    buffer_load_dwordx4 a[12:15], v10, s[4:7], s17 offen offset:32
    s_add_u32 s17, s31, 266240
    buffer_load_dwordx4 a[16:19], v10, s[4:7], s17 offen offset:0
    buffer_load_dwordx4 a[20:23], v10, s[4:7], s17 offen offset:32
    s_add_u32 s17, s31, 399360
    buffer_load_dwordx4 a[24:27], v10, s[4:7], s17 offen offset:0
    buffer_load_dwordx4 a[28:31], v10, s[4:7], s17 offen offset:32
    s_add_u32 s17, s31, 17825792
    buffer_load_dwordx4 a[32:35], v11, s[4:7], s17 offen offset:0
    buffer_load_dwordx4 a[36:39], v11, s[4:7], s17 offen offset:32
    s_add_u32 s17, s31, 17958912
    buffer_load_dwordx4 a[40:43], v11, s[4:7], s17 offen offset:0
    buffer_load_dwordx4 a[44:47], v11, s[4:7], s17 offen offset:32
    s_add_u32 s17, s31, 18092032
    buffer_load_dwordx4 a[48:51], v11, s[4:7], s17 offen offset:0
    buffer_load_dwordx4 a[52:55], v11, s[4:7], s17 offen offset:32
    s_add_u32 s17, s31, 18225152
    buffer_load_dwordx4 a[56:59], v11, s[4:7], s17 offen offset:0
    buffer_load_dwordx4 a[60:63], v11, s[4:7], s17 offen offset:32
    s_add_u32 s17, s31, 35651584
    buffer_load_dwordx4 a[64:67], v11, s[4:7], s17 offen offset:0
    buffer_load_dwordx4 a[68:71], v11, s[4:7], s17 offen offset:32
    s_add_u32 s17, s31, 35784704
    buffer_load_dwordx4 a[72:75], v11, s[4:7], s17 offen offset:0
    buffer_load_dwordx4 a[76:79], v11, s[4:7], s17 offen offset:32
    s_add_u32 s17, s31, 35917824
    buffer_load_dwordx4 a[80:83], v11, s[4:7], s17 offen offset:0
    buffer_load_dwordx4 a[84:87], v11, s[4:7], s17 offen offset:32
    s_add_u32 s17, s31, 36050944
    buffer_load_dwordx4 a[88:91], v11, s[4:7], s17 offen offset:0
    buffer_load_dwordx4 a[92:95], v11, s[4:7], s17 offen offset:32
T_top0:
    s_cmp_eq_u32 s35, 0
    s_cbranch_scc1 T_slow0
T_go0:
    s_add_u32 s34, s28, 4
    s_min_u32 s68, s34, 63
    s_waitcnt vmcnt(8)
    v_cmp_ge_u32 vcc, s68, v16
    s_nop 0
    s_and_b32 s17, vcc_lo, 0xfff
    s_cbranch_scc1 T_pw0
T_pok0:
    s_add_u32 s31, s31, 8192
    s_add_u32 s32, s32, 2048
    s_and_b32 s17, vcc_lo, 0xf000
    s_cselect_b32 s35, 0, 1
    s_cselect_b32 s69, 1073741824, s32
    s_cmp_lt_u32 s34, 64
    s_cselect_b32 s68, s31, 1073741824
    s_cselect_b32 s69, s69, 1073741824
    buffer_load_dword v16, v15, s[4:7], 0 offen sc1
    v_mfma_f32_32x32x16_bf16 v[116:131], a[32:35], a[0:3], 0
    s_add_u32 s17, s68, 0
    buffer_load_dwordx4 a[96:99], v10, s[4:7], s17 offen offset:0
    buffer_load_dwordx4 a[100:103], v10, s[4:7], s17 offen offset:32
    v_mfma_f32_32x32x16_bf16 v[116:131], a[36:39], a[4:7], v[116:131]
    s_add_u32 s17, s68, 133120
    buffer_load_dwordx4 a[104:107], v10, s[4:7], s17 offen offset:0
    buffer_load_dwordx4 a[108:111], v10, s[4:7], s17 offen offset:32
    v_mfma_f32_32x32x16_bf16 v[116:131], a[40:43], a[8:11], v[116:131]
    s_add_u32 s17, s68, 266240
    buffer_load_dwordx4 a[112:115], v10, s[4:7], s17 offen offset:0
    buffer_load_dwordx4 a[116:119], v10, s[4:7], s17 offen offset:32
    v_mfma_f32_32x32x16_bf16 v[116:131], a[44:47], a[12:15], v[116:131]
    s_add_u32 s17, s68, 399360
    buffer_load_dwordx4 a[120:123], v10, s[4:7], s17 offen offset:0
    buffer_load_dwordx4 a[124:127], v10, s[4:7], s17 offen offset:32
    v_mfma_f32_32x32x16_bf16 v[116:131], a[48:51], a[16:19], v[116:131]
    s_add_u32 s17, s68, 17825792
    buffer_load_dwordx4 a[128:131], v11, s[4:7], s17 offen offset:0
    buffer_load_dwordx4 a[132:135], v11, s[4:7], s17 offen offset:32
    v_mfma_f32_32x32x16_bf16 v[116:131], a[52:55], a[20:23], v[116:131]
    s_add_u32 s17, s68, 17958912
    buffer_load_dwordx4 a[136:139], v11, s[4:7], s17 offen offset:0
    buffer_load_dwordx4 a[140:143], v11, s[4:7], s17 offen offset:32
    v_mfma_f32_32x32x16_bf16 v[116:131], a[56:59], a[24:27], v[116:131]
    s_add_u32 s17, s68, 18092032
    buffer_load_dwordx4 a[144:147], v11, s[4:7], s17 offen offset:0
    buffer_load_dwordx4 a[148:151], v11, s[4:7], s17 offen offset:32
    v_mfma_f32_32x32x16_bf16 v[116:131], a[60:63], a[28:31], v[116:131]
    s_add_u32 s17, s68, 18225152
    buffer_load_dwordx4 a[152:155], v11, s[4:7], s17 offen offset:0
    buffer_load_dwordx4 a[156:159], v11, s[4:7], s17 offen offset:32
    v_mfma_f32_32x32x16_bf16 v[132:147], v[20:23], a[0:3], 0
    s_add_u32 s17, s68, 35651584
    buffer_load_dwordx4 a[160:163], v11, s[4:7], s17 offen offset:0
    buffer_load_dwordx4 a[164:167], v11, s[4:7], s17 offen offset:32
    v_mfma_f32_32x32x16_bf16 v[132:147], v[24:27], a[4:7], v[132:147]
    s_add_u32 s17, s68, 35784704
    buffer_load_dwordx4 a[168:171], v11, s[4:7], s17 offen offset:0
    buffer_load_dwordx4 a[172:175], v11, s[4:7], s17 offen offset:32
    v_mfma_f32_32x32x16_bf16 v[132:147], v[28:31], a[8:11], v[132:147]
    s_add_u32 s17, s68, 35917824
    buffer_load_dwordx4 a[176:179], v11, s[4:7], s17 offen offset:0
    buffer_load_dwordx4 a[180:183], v11, s[4:7], s17 offen offset:32
    v_mfma_f32_32x32x16_bf16 v[132:147], v[32:35], a[12:15], v[132:147]
    s_add_u32 s17, s68, 36050944
    buffer_load_dwordx4 a[184:187], v11, s[4:7], s17 offen offset:0
    buffer_load_dwordx4 a[188:191], v11, s[4:7], s17 offen offset:32
    v_mfma_f32_32x32x16_bf16 v[132:147], v[36:39], a[16:19], v[132:147]
    s_add_u32 s17, s69, 0
    s_add_u32 s18, s69, 5242880
    buffer_load_dwordx4 v[68:71], v12, s[4:7], s17 offen offset:0
    buffer_load_dwordx4 v[72:75], v12, s[4:7], s17 offen offset:32
    buffer_load_dwordx2 v[100:101], v13, s[4:7], s18 offen
    v_mfma_f32_32x32x16_bf16 v[132:147], v[40:43], a[20:23], v[132:147]
    s_add_u32 s17, s69, 33280
    s_add_u32 s18, s69, 5276160
    buffer_load_dwordx4 v[76:79], v12, s[4:7], s17 offen offset:0
    buffer_load_dwordx4 v[80:83], v12, s[4:7], s17 offen offset:32
    buffer_load_dwordx2 v[104:105], v13, s[4:7], s18 offen
    v_mfma_f32_32x32x16_bf16 v[132:147], v[44:47], a[24:27], v[132:147]
    s_add_u32 s17, s69, 66560
    s_add_u32 s18, s69, 5309440
    buffer_load_dwordx4 v[84:87], v12, s[4:7], s17 offen offset:0
    buffer_load_dwordx4 v[88:91], v12, s[4:7], s17 offen offset:32
    buffer_load_dwordx2 v[108:109], v13, s[4:7], s18 offen
    v_mfma_f32_32x32x16_bf16 v[132:147], v[48:51], a[28:31], v[132:147]
    s_add_u32 s17, s69, 99840
    s_add_u32 s18, s69, 5342720
    buffer_load_dwordx4 v[92:95], v12, s[4:7], s17 offen offset:0
    buffer_load_dwordx4 v[96:99], v12, s[4:7], s17 offen offset:32
    buffer_load_dwordx2 v[112:113], v13, s[4:7], s18 offen
    v_cndmask_b32 v116, v17, v116, s[36:37]
    v_cndmask_b32 v117, v17, v117, s[38:39]
    v_cndmask_b32 v118, v17, v118, s[40:41]
    v_cndmask_b32 v119, v17, v119, s[42:43]
    v_cndmask_b32 v120, v17, v120, s[44:45]
    v_cndmask_b32 v121, v17, v121, s[46:47]
    v_cndmask_b32 v122, v17, v122, s[48:49]
    v_cndmask_b32 v123, v17, v123, s[50:51]
    v_cndmask_b32 v124, v17, v124, s[52:53]
    v_cndmask_b32 v125, v17, v125, s[54:55]
    v_cndmask_b32 v126, v17, v126, s[56:57]
    v_cndmask_b32 v127, v17, v127, s[58:59]
    v_cndmask_b32 v128, v17, v128, s[60:61]
    v_cndmask_b32 v129, v17, v129, s[62:63]
    v_cndmask_b32 v130, v17, v130, s[64:65]
    v_cndmask_b32 v131, v17, v131, s[66:67]
    v_max3_f32 v18, v116, v117, v118
    v_max3_f32 v18, v18, v119, v120
    v_max3_f32 v18, v18, v121, v122
    v_max3_f32 v18, v18, v123, v124
    v_max3_f32 v18, v18, v125, v126
    v_max3_f32 v18, v18, v127, v128
    v_max3_f32 v18, v18, v129, v130
    v_max3_f32 v18, v18, v131, v132
    v_max3_f32 v18, v18, v133, v134
    v_max_f32 v18, v18, v135
    v_mov_b32 v5, v18
    s_nop 1
    v_permlane32_swap_b32 v18, v5
    v_max_f32 v18, v18, v5
    v_mul_f32 v18, s29, v18
    v_fma_f32 v116, v116, s29, -v18
    v_fma_f32 v117, v117, s29, -v18
    v_fma_f32 v118, v118, s29, -v18
    v_fma_f32 v119, v119, s29, -v18
    v_fma_f32 v120, v120, s29, -v18
    v_fma_f32 v121, v121, s29, -v18
    v_fma_f32 v122, v122, s29, -v18
    v_fma_f32 v123, v123, s29, -v18
    v_fma_f32 v124, v124, s29, -v18
    v_fma_f32 v125, v125, s29, -v18
    v_fma_f32 v126, v126, s29, -v18
    v_fma_f32 v127, v127, s29, -v18
    v_fma_f32 v128, v128, s29, -v18
    v_fma_f32 v129, v129, s29, -v18
    v_fma_f32 v130, v130, s29, -v18
    v_fma_f32 v131, v131, s29, -v18
    v_fma_f32 v132, v132, s29, -v18
    v_fma_f32 v133, v133, s29, -v18
    v_fma_f32 v134, v134, s29, -v18
    v_fma_f32 v135, v135, s29, -v18
    v_exp_f32 v116, v116
    v_exp_f32 v117, v117
    v_exp_f32 v118, v118
    v_exp_f32 v119, v119
    v_exp_f32 v120, v120
    v_exp_f32 v121, v121
    v_exp_f32 v122, v122
    v_exp_f32 v123, v123
    v_exp_f32 v124, v124
    v_exp_f32 v125, v125
    v_exp_f32 v126, v126
    v_exp_f32 v127, v127
    v_exp_f32 v128, v128
    v_exp_f32 v129, v129
    v_exp_f32 v130, v130
    v_exp_f32 v131, v131
    v_exp_f32 v132, v132
    v_exp_f32 v133, v133
    v_exp_f32 v134, v134
    v_exp_f32 v135, v135
    s_waitcnt vmcnt(37)
    buffer_store_dword v9, v4, s[4:7], 0 offen sc1
    v_add_f32 v19, v116, v117
    v_add_f32 v6, v118, v119
    v_add_f32 v19, v19, v120
    v_add_f32 v6, v6, v121
    v_add_f32 v19, v19, v122
    v_add_f32 v6, v6, v123
    v_add_f32 v19, v19, v124
    v_add_f32 v6, v6, v125
    v_add_f32 v19, v19, v126
    v_add_f32 v6, v6, v127
    v_add_f32 v19, v19, v128
    v_add_f32 v6, v6, v129
    v_add_f32 v19, v19, v130
    v_add_f32 v6, v6, v131
    v_add_f32 v19, v19, v132
    v_add_f32 v6, v6, v133
    v_add_f32 v19, v19, v134
    v_add_f32 v6, v6, v135
    v_add_f32 v19, v19, v6
    v_mov_b32 v5, v19
    s_nop 1
    v_permlane32_swap_b32 v19, v5
    v_add_f32 v19, v19, v5
    v_rcp_f32 v19, v19
    s_nop 0
    v_mul_f32 v116, v116, v19
    v_mul_f32 v117, v117, v19
    v_mul_f32 v118, v118, v19
    v_mul_f32 v119, v119, v19
    v_mul_f32 v120, v120, v19
    v_mul_f32 v121, v121, v19
    v_mul_f32 v122, v122, v19
    v_mul_f32 v123, v123, v19
    v_mul_f32 v124, v124, v19
    v_mul_f32 v125, v125, v19
    v_mul_f32 v126, v126, v19
    v_mul_f32 v127, v127, v19
    v_mul_f32 v128, v128, v19
    v_mul_f32 v129, v129, v19
    v_mul_f32 v130, v130, v19
    v_mul_f32 v131, v131, v19
    v_mul_f32 v132, v132, v19
    v_mul_f32 v133, v133, v19
    v_mul_f32 v134, v134, v19
    v_mul_f32 v135, v135, v19
    v_cvt_pk_bf16_f32 v148, v116, v117
    v_cvt_pk_bf16_f32 v149, v118, v119
    v_cvt_pk_bf16_f32 v150, v120, v121
    v_cvt_pk_bf16_f32 v151, v122, v123
    v_cvt_pk_bf16_f32 v152, v124, v125
    v_cvt_pk_bf16_f32 v153, v126, v127
    v_cvt_pk_bf16_f32 v154, v128, v129
    v_cvt_pk_bf16_f32 v155, v130, v131
    v_cvt_pk_bf16_f32 v156, v132, v133
    v_cvt_pk_bf16_f32 v157, v134, v135
    v_mfma_f32_32x32x16_bf16 v[160:175], a[64:67], v[148:151], 0
    v_mfma_f32_32x32x16_bf16 v[160:175], a[68:71], v[152:155], v[160:175]
    v_mfma_f32_32x32x16_bf16 v[160:175], v[52:55], v[156:159], v[160:175]
    v_mfma_f32_32x32x16_bf16 v[176:191], a[72:75], v[148:151], 0
    v_mfma_f32_32x32x16_bf16 v[176:191], a[76:79], v[152:155], v[176:191]
    v_mfma_f32_32x32x16_bf16 v[176:191], v[56:59], v[156:159], v[176:191]
    s_nop 2
    v_cvt_pk_bf16_f32 v224, v160, v161
    v_cvt_pk_bf16_f32 v225, v162, v163
    v_cvt_pk_bf16_f32 v226, v164, v165
    v_cvt_pk_bf16_f32 v227, v166, v167
    v_cvt_pk_bf16_f32 v228, v168, v169
    v_cvt_pk_bf16_f32 v229, v170, v171
    v_cvt_pk_bf16_f32 v230, v172, v173
    v_cvt_pk_bf16_f32 v231, v174, v175
    buffer_store_dwordx4 v[224:227], v14, s[4:7], s33 offen offset:0 sc1
    buffer_store_dwordx4 v[228:231], v14, s[4:7], s33 offen offset:512 sc1
    v_mfma_f32_32x32x16_bf16 v[192:207], a[80:83], v[148:151], 0
    v_mfma_f32_32x32x16_bf16 v[192:207], a[84:87], v[152:155], v[192:207]
    v_mfma_f32_32x32x16_bf16 v[192:207], v[60:63], v[156:159], v[192:207]
    v_cvt_pk_bf16_f32 v232, v176, v177
    v_cvt_pk_bf16_f32 v233, v178, v179
    v_cvt_pk_bf16_f32 v234, v180, v181
    v_cvt_pk_bf16_f32 v235, v182, v183
    v_cvt_pk_bf16_f32 v236, v184, v185
    v_cvt_pk_bf16_f32 v237, v186, v187
    v_cvt_pk_bf16_f32 v238, v188, v189
    v_cvt_pk_bf16_f32 v239, v190, v191
    buffer_store_dwordx4 v[232:235], v14, s[4:7], s33 offen offset:1024 sc1
    buffer_store_dwordx4 v[236:239], v14, s[4:7], s33 offen offset:1536 sc1
    v_mfma_f32_32x32x16_bf16 v[208:223], a[88:91], v[148:151], 0
    v_mfma_f32_32x32x16_bf16 v[208:223], a[92:95], v[152:155], v[208:223]
    v_mfma_f32_32x32x16_bf16 v[208:223], v[64:67], v[156:159], v[208:223]
    v_cvt_pk_bf16_f32 v240, v192, v193
    v_cvt_pk_bf16_f32 v241, v194, v195
    v_cvt_pk_bf16_f32 v242, v196, v197
    v_cvt_pk_bf16_f32 v243, v198, v199
    v_cvt_pk_bf16_f32 v244, v200, v201
    v_cvt_pk_bf16_f32 v245, v202, v203
    v_cvt_pk_bf16_f32 v246, v204, v205
    v_cvt_pk_bf16_f32 v247, v206, v207
    buffer_store_dwordx4 v[240:243], v14, s[4:7], s33 offen offset:2048 sc1
    buffer_store_dwordx4 v[244:247], v14, s[4:7], s33 offen offset:2560 sc1
    v_add_u32 v9, 1, v9
    s_nop 0
    v_cvt_pk_bf16_f32 v248, v208, v209
    v_cvt_pk_bf16_f32 v249, v210, v211
    v_cvt_pk_bf16_f32 v250, v212, v213
    v_cvt_pk_bf16_f32 v251, v214, v215
    v_cvt_pk_bf16_f32 v252, v216, v217
    v_cvt_pk_bf16_f32 v253, v218, v219
    v_cvt_pk_bf16_f32 v254, v220, v221
    v_cvt_pk_bf16_f32 v255, v222, v223
    buffer_store_dwordx4 v[248:251], v14, s[4:7], s33 offen offset:3072 sc1
    buffer_store_dwordx4 v[252:255], v14, s[4:7], s33 offen offset:3584 sc1
    s_mov_b32 s28, s34
    s_add_u32 s33, s33, 1048576
T_top1:
    s_cmp_eq_u32 s35, 0
    s_cbranch_scc1 T_slow1
T_go1:
    s_add_u32 s34, s28, 4
    s_min_u32 s68, s34, 63
    s_waitcnt vmcnt(8)
    v_cmp_ge_u32 vcc, s68, v16
    s_nop 0
    s_and_b32 s17, vcc_lo, 0xfff
    s_cbranch_scc1 T_pw1
T_pok1:
    s_add_u32 s31, s31, 8192
    s_add_u32 s32, s32, 2048
    s_and_b32 s17, vcc_lo, 0xf000
    s_cselect_b32 s35, 0, 1
    s_cselect_b32 s69, 1073741824, s32
    s_cmp_lt_u32 s34, 64
    s_cselect_b32 s68, s31, 1073741824
    s_cselect_b32 s69, s69, 1073741824
    buffer_load_dword v16, v15, s[4:7], 0 offen sc1
    v_mfma_f32_32x32x16_bf16 v[116:131], a[128:131], a[96:99], 0
    s_add_u32 s17, s68, 0
    buffer_load_dwordx4 a[0:3], v10, s[4:7], s17 offen offset:0
    buffer_load_dwordx4 a[4:7], v10, s[4:7], s17 offen offset:32
    v_mfma_f32_32x32x16_bf16 v[116:131], a[132:135], a[100:103], v[116:131]
    s_add_u32 s17, s68, 133120
    buffer_load_dwordx4 a[8:11], v10, s[4:7], s17 offen offset:0
    buffer_load_dwordx4 a[12:15], v10, s[4:7], s17 offen offset:32
    v_mfma_f32_32x32x16_bf16 v[116:131], a[136:139], a[104:107], v[116:131]
    s_add_u32 s17, s68, 266240
    buffer_load_dwordx4 a[16:19], v10, s[4:7], s17 offen offset:0
    buffer_load_dwordx4 a[20:23], v10, s[4:7], s17 offen offset:32
    v_mfma_f32_32x32x16_bf16 v[116:131], a[140:143], a[108:111], v[116:131]
    s_add_u32 s17, s68, 399360
    buffer_load_dwordx4 a[24:27], v10, s[4:7], s17 offen offset:0
    buffer_load_dwordx4 a[28:31], v10, s[4:7], s17 offen offset:32
    v_mfma_f32_32x32x16_bf16 v[116:131], a[144:147], a[112:115], v[116:131]
    s_add_u32 s17, s68, 17825792
    buffer_load_dwordx4 a[32:35], v11, s[4:7], s17 offen offset:0
    buffer_load_dwordx4 a[36:39], v11, s[4:7], s17 offen offset:32
    v_mfma_f32_32x32x16_bf16 v[116:131], a[148:151], a[116:119], v[116:131]
    s_add_u32 s17, s68, 17958912
    buffer_load_dwordx4 a[40:43], v11, s[4:7], s17 offen offset:0
    buffer_load_dwordx4 a[44:47], v11, s[4:7], s17 offen offset:32
    v_mfma_f32_32x32x16_bf16 v[116:131], a[152:155], a[120:123], v[116:131]
    s_add_u32 s17, s68, 18092032
    buffer_load_dwordx4 a[48:51], v11, s[4:7], s17 offen offset:0
    buffer_load_dwordx4 a[52:55], v11, s[4:7], s17 offen offset:32
    v_mfma_f32_32x32x16_bf16 v[116:131], a[156:159], a[124:127], v[116:131]
    s_add_u32 s17, s68, 18225152
    buffer_load_dwordx4 a[56:59], v11, s[4:7], s17 offen offset:0
    buffer_load_dwordx4 a[60:63], v11, s[4:7], s17 offen offset:32
    v_mfma_f32_32x32x16_bf16 v[132:147], v[68:71], a[96:99], 0
    s_add_u32 s17, s68, 35651584
    buffer_load_dwordx4 a[64:67], v11, s[4:7], s17 offen offset:0
    buffer_load_dwordx4 a[68:71], v11, s[4:7], s17 offen offset:32
    v_mfma_f32_32x32x16_bf16 v[132:147], v[72:75], a[100:103], v[132:147]
    s_add_u32 s17, s68, 35784704
    buffer_load_dwordx4 a[72:75], v11, s[4:7], s17 offen offset:0
    buffer_load_dwordx4 a[76:79], v11, s[4:7], s17 offen offset:32
    v_mfma_f32_32x32x16_bf16 v[132:147], v[76:79], a[104:107], v[132:147]
    s_add_u32 s17, s68, 35917824
    buffer_load_dwordx4 a[80:83], v11, s[4:7], s17 offen offset:0
    buffer_load_dwordx4 a[84:87], v11, s[4:7], s17 offen offset:32
    v_mfma_f32_32x32x16_bf16 v[132:147], v[80:83], a[108:111], v[132:147]
    s_add_u32 s17, s68, 36050944
    buffer_load_dwordx4 a[88:91], v11, s[4:7], s17 offen offset:0
    buffer_load_dwordx4 a[92:95], v11, s[4:7], s17 offen offset:32
    v_mfma_f32_32x32x16_bf16 v[132:147], v[84:87], a[112:115], v[132:147]
    s_add_u32 s17, s69, 0
    s_add_u32 s18, s69, 5242880
    buffer_load_dwordx4 v[20:23], v12, s[4:7], s17 offen offset:0
    buffer_load_dwordx4 v[24:27], v12, s[4:7], s17 offen offset:32
    buffer_load_dwordx2 v[52:53], v13, s[4:7], s18 offen
    v_mfma_f32_32x32x16_bf16 v[132:147], v[88:91], a[116:119], v[132:147]
    s_add_u32 s17, s69, 33280
    s_add_u32 s18, s69, 5276160
    buffer_load_dwordx4 v[28:31], v12, s[4:7], s17 offen offset:0
    buffer_load_dwordx4 v[32:35], v12, s[4:7], s17 offen offset:32
    buffer_load_dwordx2 v[56:57], v13, s[4:7], s18 offen
    v_mfma_f32_32x32x16_bf16 v[132:147], v[92:95], a[120:123], v[132:147]
    s_add_u32 s17, s69, 66560
    s_add_u32 s18, s69, 5309440
    buffer_load_dwordx4 v[36:39], v12, s[4:7], s17 offen offset:0
    buffer_load_dwordx4 v[40:43], v12, s[4:7], s17 offen offset:32
    buffer_load_dwordx2 v[60:61], v13, s[4:7], s18 offen
    v_mfma_f32_32x32x16_bf16 v[132:147], v[96:99], a[124:127], v[132:147]
    s_add_u32 s17, s69, 99840
    s_add_u32 s18, s69, 5342720
    buffer_load_dwordx4 v[44:47], v12, s[4:7], s17 offen offset:0
    buffer_load_dwordx4 v[48:51], v12, s[4:7], s17 offen offset:32
    buffer_load_dwordx2 v[64:65], v13, s[4:7], s18 offen
    v_cndmask_b32 v116, v17, v116, s[36:37]
    v_cndmask_b32 v117, v17, v117, s[38:39]
    v_cndmask_b32 v118, v17, v118, s[40:41]
    v_cndmask_b32 v119, v17, v119, s[42:43]
    v_cndmask_b32 v120, v17, v120, s[44:45]
    v_cndmask_b32 v121, v17, v121, s[46:47]
    v_cndmask_b32 v122, v17, v122, s[48:49]
    v_cndmask_b32 v123, v17, v123, s[50:51]
    v_cndmask_b32 v124, v17, v124, s[52:53]
    v_cndmask_b32 v125, v17, v125, s[54:55]
    v_cndmask_b32 v126, v17, v126, s[56:57]
    v_cndmask_b32 v127, v17, v127, s[58:59]
    v_cndmask_b32 v128, v17, v128, s[60:61]
    v_cndmask_b32 v129, v17, v129, s[62:63]
    v_cndmask_b32 v130, v17, v130, s[64:65]
    v_cndmask_b32 v131, v17, v131, s[66:67]
    v_max3_f32 v18, v116, v117, v118
    v_max3_f32 v18, v18, v119, v120
    v_max3_f32 v18, v18, v121, v122
    v_max3_f32 v18, v18, v123, v124
    v_max3_f32 v18, v18, v125, v126
    v_max3_f32 v18, v18, v127, v128
    v_max3_f32 v18, v18, v129, v130
    v_max3_f32 v18, v18, v131, v132
    v_max3_f32 v18, v18, v133, v134
    v_max_f32 v18, v18, v135
    v_mov_b32 v5, v18
    s_nop 1
    v_permlane32_swap_b32 v18, v5
    v_max_f32 v18, v18, v5
    v_mul_f32 v18, s29, v18
    v_fma_f32 v116, v116, s29, -v18
    v_fma_f32 v117, v117, s29, -v18
    v_fma_f32 v118, v118, s29, -v18
    v_fma_f32 v119, v119, s29, -v18
    v_fma_f32 v120, v120, s29, -v18
    v_fma_f32 v121, v121, s29, -v18
    v_fma_f32 v122, v122, s29, -v18
    v_fma_f32 v123, v123, s29, -v18
    v_fma_f32 v124, v124, s29, -v18
    v_fma_f32 v125, v125, s29, -v18
    v_fma_f32 v126, v126, s29, -v18
    v_fma_f32 v127, v127, s29, -v18
    v_fma_f32 v128, v128, s29, -v18
    v_fma_f32 v129, v129, s29, -v18
    v_fma_f32 v130, v130, s29, -v18
    v_fma_f32 v131, v131, s29, -v18
    v_fma_f32 v132, v132, s29, -v18
    v_fma_f32 v133, v133, s29, -v18
    v_fma_f32 v134, v134, s29, -v18
    v_fma_f32 v135, v135, s29, -v18
    v_exp_f32 v116, v116
    v_exp_f32 v117, v117
    v_exp_f32 v118, v118
    v_exp_f32 v119, v119
    v_exp_f32 v120, v120
    v_exp_f32 v121, v121
    v_exp_f32 v122, v122
    v_exp_f32 v123, v123
    v_exp_f32 v124, v124
    v_exp_f32 v125, v125
    v_exp_f32 v126, v126
    v_exp_f32 v127, v127
    v_exp_f32 v128, v128
    v_exp_f32 v129, v129
    v_exp_f32 v130, v130
    v_exp_f32 v131, v131
    v_exp_f32 v132, v132
    v_exp_f32 v133, v133
    v_exp_f32 v134, v134
    v_exp_f32 v135, v135
    s_waitcnt vmcnt(37)
    buffer_store_dword v9, v4, s[4:7], 0 offen sc1
    v_add_f32 v19, v116, v117
    v_add_f32 v6, v118, v119
    v_add_f32 v19, v19, v120
    v_add_f32 v6, v6, v121
    v_add_f32 v19, v19, v122
    v_add_f32 v6, v6, v123
    v_add_f32 v19, v19, v124
    v_add_f32 v6, v6, v125
    v_add_f32 v19, v19, v126
    v_add_f32 v6, v6, v127
    v_add_f32 v19, v19, v128
    v_add_f32 v6, v6, v129
    v_add_f32 v19, v19, v130
    v_add_f32 v6, v6, v131
    v_add_f32 v19, v19, v132
    v_add_f32 v6, v6, v133
    v_add_f32 v19, v19, v134
    v_add_f32 v6, v6, v135
    v_add_f32 v19, v19, v6
    v_mov_b32 v5, v19
    s_nop 1
    v_permlane32_swap_b32 v19, v5
    v_add_f32 v19, v19, v5
    v_rcp_f32 v19, v19
    s_nop 0
    v_mul_f32 v116, v116, v19
    v_mul_f32 v117, v117, v19
    v_mul_f32 v118, v118, v19
    v_mul_f32 v119, v119, v19
    v_mul_f32 v120, v120, v19
    v_mul_f32 v121, v121, v19
    v_mul_f32 v122, v122, v19
    v_mul_f32 v123, v123, v19
    v_mul_f32 v124, v124, v19
    v_mul_f32 v125, v125, v19
    v_mul_f32 v126, v126, v19
    v_mul_f32 v127, v127, v19
    v_mul_f32 v128, v128, v19
    v_mul_f32 v129, v129, v19
    v_mul_f32 v130, v130, v19
    v_mul_f32 v131, v131, v19
    v_mul_f32 v132, v132, v19
    v_mul_f32 v133, v133, v19
    v_mul_f32 v134, v134, v19
    v_mul_f32 v135, v135, v19
    v_cvt_pk_bf16_f32 v148, v116, v117
    v_cvt_pk_bf16_f32 v149, v118, v119
    v_cvt_pk_bf16_f32 v150, v120, v121
    v_cvt_pk_bf16_f32 v151, v122, v123
    v_cvt_pk_bf16_f32 v152, v124, v125
    v_cvt_pk_bf16_f32 v153, v126, v127
    v_cvt_pk_bf16_f32 v154, v128, v129
    v_cvt_pk_bf16_f32 v155, v130, v131
    v_cvt_pk_bf16_f32 v156, v132, v133
    v_cvt_pk_bf16_f32 v157, v134, v135
    v_mfma_f32_32x32x16_bf16 v[160:175], a[160:163], v[148:151], 0
    v_mfma_f32_32x32x16_bf16 v[160:175], a[164:167], v[152:155], v[160:175]
    v_mfma_f32_32x32x16_bf16 v[160:175], v[100:103], v[156:159], v[160:175]
    v_mfma_f32_32x32x16_bf16 v[176:191], a[168:171], v[148:151], 0
    v_mfma_f32_32x32x16_bf16 v[176:191], a[172:175], v[152:155], v[176:191]
    v_mfma_f32_32x32x16_bf16 v[176:191], v[104:107], v[156:159], v[176:191]
    s_nop 2
    v_cvt_pk_bf16_f32 v224, v160, v161
    v_cvt_pk_bf16_f32 v225, v162, v163
    v_cvt_pk_bf16_f32 v226, v164, v165
    v_cvt_pk_bf16_f32 v227, v166, v167
    v_cvt_pk_bf16_f32 v228, v168, v169
    v_cvt_pk_bf16_f32 v229, v170, v171
    v_cvt_pk_bf16_f32 v230, v172, v173
    v_cvt_pk_bf16_f32 v231, v174, v175
    buffer_store_dwordx4 v[224:227], v14, s[4:7], s33 offen offset:0 sc1
    buffer_store_dwordx4 v[228:231], v14, s[4:7], s33 offen offset:512 sc1
    v_mfma_f32_32x32x16_bf16 v[192:207], a[176:179], v[148:151], 0
    v_mfma_f32_32x32x16_bf16 v[192:207], a[180:183], v[152:155], v[192:207]
    v_mfma_f32_32x32x16_bf16 v[192:207], v[108:111], v[156:159], v[192:207]
    v_cvt_pk_bf16_f32 v232, v176, v177
    v_cvt_pk_bf16_f32 v233, v178, v179
    v_cvt_pk_bf16_f32 v234, v180, v181
    v_cvt_pk_bf16_f32 v235, v182, v183
    v_cvt_pk_bf16_f32 v236, v184, v185
    v_cvt_pk_bf16_f32 v237, v186, v187
    v_cvt_pk_bf16_f32 v238, v188, v189
    v_cvt_pk_bf16_f32 v239, v190, v191
    buffer_store_dwordx4 v[232:235], v14, s[4:7], s33 offen offset:1024 sc1
    buffer_store_dwordx4 v[236:239], v14, s[4:7], s33 offen offset:1536 sc1
    v_mfma_f32_32x32x16_bf16 v[208:223], a[184:187], v[148:151], 0
    v_mfma_f32_32x32x16_bf16 v[208:223], a[188:191], v[152:155], v[208:223]
    v_mfma_f32_32x32x16_bf16 v[208:223], v[112:115], v[156:159], v[208:223]
    v_cvt_pk_bf16_f32 v240, v192, v193
    v_cvt_pk_bf16_f32 v241, v194, v195
    v_cvt_pk_bf16_f32 v242, v196, v197
    v_cvt_pk_bf16_f32 v243, v198, v199
    v_cvt_pk_bf16_f32 v244, v200, v201
    v_cvt_pk_bf16_f32 v245, v202, v203
    v_cvt_pk_bf16_f32 v246, v204, v205
    v_cvt_pk_bf16_f32 v247, v206, v207
    buffer_store_dwordx4 v[240:243], v14, s[4:7], s33 offen offset:2048 sc1
    buffer_store_dwordx4 v[244:247], v14, s[4:7], s33 offen offset:2560 sc1
    v_add_u32 v9, 1, v9
    s_nop 0
    v_cvt_pk_bf16_f32 v248, v208, v209
    v_cvt_pk_bf16_f32 v249, v210, v211
    v_cvt_pk_bf16_f32 v250, v212, v213
    v_cvt_pk_bf16_f32 v251, v214, v215
    v_cvt_pk_bf16_f32 v252, v216, v217
    v_cvt_pk_bf16_f32 v253, v218, v219
    v_cvt_pk_bf16_f32 v254, v220, v221
    v_cvt_pk_bf16_f32 v255, v222, v223
    buffer_store_dwordx4 v[248:251], v14, s[4:7], s33 offen offset:3072 sc1
    buffer_store_dwordx4 v[252:255], v14, s[4:7], s33 offen offset:3584 sc1
    s_mov_b32 s28, s34
    s_add_u32 s33, s33, 1048576
    s_cmp_lt_u32 s28, 64
    s_cbranch_scc1 T_top0
    s_waitcnt vmcnt(0)
    buffer_store_dword v9, v4, s[4:7], 0 offen sc1
    s_branch W_fin
T_slow0:
    s_waitcnt vmcnt(0)
    buffer_store_dword v9, v4, s[4:7], 0 offen sc1
    s_mov_b32 s30, s92
T_s0:
    v_cmp_ge_u32 vcc, s28, v16
    s_nop 0
    s_and_b32 s17, vcc_lo, 61440
    s_cbranch_scc0 T_sk0
    s_cmp_ge_u32 s30, 1048576
    s_cselect_b32 s92, 1048576, s92
    s_cbranch_scc1 T_sk0
    s_add_u32 s30, s30, 1
    buffer_load_dword v16, v15, s[4:7], 0 offen sc1
    s_sleep 2
    s_waitcnt vmcnt(0)
    s_branch T_s0
T_sk0:
    s_add_u32 s17, s32, 0
    s_add_u32 s18, s32, 5242880
    buffer_load_dwordx4 v[20:23], v12, s[4:7], s17 offen offset:0
    buffer_load_dwordx4 v[24:27], v12, s[4:7], s17 offen offset:32
    buffer_load_dwordx2 v[52:53], v13, s[4:7], s18 offen
    s_add_u32 s17, s32, 33280
    s_add_u32 s18, s32, 5276160
    buffer_load_dwordx4 v[28:31], v12, s[4:7], s17 offen offset:0
    buffer_load_dwordx4 v[32:35], v12, s[4:7], s17 offen offset:32
    buffer_load_dwordx2 v[56:57], v13, s[4:7], s18 offen
    s_add_u32 s17, s32, 66560
    s_add_u32 s18, s32, 5309440
    buffer_load_dwordx4 v[36:39], v12, s[4:7], s17 offen offset:0
    buffer_load_dwordx4 v[40:43], v12, s[4:7], s17 offen offset:32
    buffer_load_dwordx2 v[60:61], v13, s[4:7], s18 offen
    s_add_u32 s17, s32, 99840
    s_add_u32 s18, s32, 5342720
    buffer_load_dwordx4 v[44:47], v12, s[4:7], s17 offen offset:0
    buffer_load_dwordx4 v[48:51], v12, s[4:7], s17 offen offset:32
    buffer_load_dwordx2 v[64:65], v13, s[4:7], s18 offen
    s_waitcnt vmcnt(0)
    s_branch T_go0
T_pw0:
    s_mov_b32 s30, s92
T_q0:
    v_cmp_ge_u32 vcc, s68, v16
    s_nop 0
    s_and_b32 s17, vcc_lo, 4095
    s_cbranch_scc0 T_pok0
    s_cmp_ge_u32 s30, 1048576
    s_cselect_b32 s92, 1048576, s92
    s_cbranch_scc1 T_pok0
    s_add_u32 s30, s30, 1
    buffer_load_dword v16, v15, s[4:7], 0 offen sc1
    s_sleep 8
    s_waitcnt vmcnt(0)
    s_branch T_q0
T_slow1:
    s_waitcnt vmcnt(0)
    buffer_store_dword v9, v4, s[4:7], 0 offen sc1
    s_mov_b32 s30, s92
T_s1:
    v_cmp_ge_u32 vcc, s28, v16
    s_nop 0
    s_and_b32 s17, vcc_lo, 61440
    s_cbranch_scc0 T_sk1
    s_cmp_ge_u32 s30, 1048576
    s_cselect_b32 s92, 1048576, s92
    s_cbranch_scc1 T_sk1
    s_add_u32 s30, s30, 1
    buffer_load_dword v16, v15, s[4:7], 0 offen sc1
    s_sleep 2
    s_waitcnt vmcnt(0)
    s_branch T_s1
T_sk1:
    s_add_u32 s17, s32, 0
    s_add_u32 s18, s32, 5242880
    buffer_load_dwordx4 v[68:71], v12, s[4:7], s17 offen offset:0
    buffer_load_dwordx4 v[72:75], v12, s[4:7], s17 offen offset:32
    buffer_load_dwordx2 v[100:101], v13, s[4:7], s18 offen
    s_add_u32 s17, s32, 33280
    s_add_u32 s18, s32, 5276160
    buffer_load_dwordx4 v[76:79], v12, s[4:7], s17 offen offset:0
    buffer_load_dwordx4 v[80:83], v12, s[4:7], s17 offen offset:32
    buffer_load_dwordx2 v[104:105], v13, s[4:7], s18 offen
    s_add_u32 s17, s32, 66560
    s_add_u32 s18, s32, 5309440
    buffer_load_dwordx4 v[84:87], v12, s[4:7], s17 offen offset:0
    buffer_load_dwordx4 v[88:91], v12, s[4:7], s17 offen offset:32
    buffer_load_dwordx2 v[108:109], v13, s[4:7], s18 offen
    s_add_u32 s17, s32, 99840
    s_add_u32 s18, s32, 5342720
    buffer_load_dwordx4 v[92:95], v12, s[4:7], s17 offen offset:0
    buffer_load_dwordx4 v[96:99], v12, s[4:7], s17 offen offset:32
    buffer_load_dwordx2 v[112:113], v13, s[4:7], s18 offen
    s_waitcnt vmcnt(0)
    s_branch T_go1
T_pw1:
    s_mov_b32 s30, s92
T_q1:
    v_cmp_ge_u32 vcc, s68, v16
    s_nop 0
    s_and_b32 s17, vcc_lo, 4095
    s_cbranch_scc0 T_pok1
    s_cmp_ge_u32 s30, 1048576
    s_cselect_b32 s92, 1048576, s92
    s_cbranch_scc1 T_pok1
    s_add_u32 s30, s30, 1
    buffer_load_dword v16, v15, s[4:7], 0 offen sc1
    s_sleep 8
    s_waitcnt vmcnt(0)
    s_branch T_q1
W_fin:
W_end:
    s_endpgm
R_entry:
    s_mov_b32 s12, s3
    s_lshr_b32 s13, s2, 3
    s_load_dwordx2 s[4:5], s[0:1], 96
    s_load_dwordx2 s[28:29], s[0:1], 32
    s_load_dwordx2 s[30:31], s[0:1], 40
    s_load_dwordx2 s[32:33], s[0:1], 48
    s_load_dwordx2 s[34:35], s[0:1], 56
    s_load_dwordx2 s[36:37], s[0:1], 64
    v_lshrrev_b32 v19, 6, v0
    v_and_b32 v1, 63, v0
    v_readfirstlane_b32 s14, v19
    s_mov_b32 s6, 268435456
    s_mov_b32 s7, 0x20000
    s_mov_b32 s10, 8388608
    s_mov_b32 s11, 0x20000
    s_mov_b32 s25, 0
    s_mov_b32 s24, 1040356334
    s_waitcnt lgkmcnt(0)
    v_and_b32 v96, 7, v1
    v_bfe_u32 v97, v1, 3, 1
    v_lshrrev_b32 v98, 4, v1
    v_lshlrev_b32 v19, 4, v1
    s_lshl_b32 s21, s12, 14
    s_lshl_b32 s22, s14, 12
    s_add_u32 s21, s21, s22
    s_add_u32 s22, s21, 0
    v_add_u32 v2, s22, v19
    s_add_u32 s22, s21, 229376
    v_add_u32 v8, s22, v19
    s_lshr_b32 s21, s13, 1
    s_lshl_b32 s21, s21, 10
    s_and_b32 s22, s13, 1
    s_lshl_b32 s22, s22, 7
    s_add_u32 s21, s21, s22
    s_lshl_b32 s22, s12, 14
    s_add_u32 s21, s21, s22
    v_lshlrev_b32 v20, 8, v98
    v_lshl_add_u32 v20, v96, 4, v20
    v_lshl_add_u32 v20, v97, 3, v20
    s_add_u32 s22, s21, 229376
    v_add_u32 v7, s22, v20
    s_add_u32 s22, s21, 0
    v_add_u32 v11, s22, v20
    s_lshr_b32 s21, s13, 1
    s_lshl_b32 s21, s21, 14
    s_and_b32 s22, s13, 1
    s_lshl_b32 s22, s22, 12
    s_add_u32 s21, s21, s22
    s_lshl_b32 s22, s12, 10
    s_add_u32 s22, s21, s22
    v_add_u32 v9, s22, v19
    v_xor_b32 v10, 1024, v9
    v_xor_b32 v23, 2048, v9
    v_xor_b32 v244, 3072, v9
    s_mov_b32 s95, 167772160
    s_lshr_b32 s40, s13, 2
    s_lshl_b32 s21, s12, 3
    s_add_u32 s40, s40, s21
    s_and_b32 s41, s13, 3
    s_mul_i32 s21, s40, 5120
    s_add_u32 s21, s21, 65536
    v_add_u32 v5, s21, v19
    v_lshlrev_b32 v20, 2, v1
    s_add_u32 s22, s21, 4096
    v_add_u32 v6, s22, v20
    s_lshl_b32 s22, s41, 10
    s_add_u32 s22, s22, s21
    v_add_u32 v3, s22, v19
    v_mov_b32 v21, 1073741824
    v_cmp_eq_u32 vcc, 0, v97
    s_nop 1
    v_cndmask_b32 v3, v21, v3, vcc
    s_lshl_b32 s22, s41, 8
    s_add_u32 s22, s22, s21
    s_add_u32 s22, s22, 4096
    v_lshlrev_b32 v20, 4, v98
    v_lshl_add_u32 v20, v96, 5, v20
    v_add_u32 v4, s22, v20
    v_cndmask_b32 v4, v4, v21, vcc
    v_cmp_gt_u32 vcc, 2, v98
    s_nop 1
    v_cndmask_b32 v4, v21, v4, vcc
    s_lshl_b32 s27, s40, 7
    s_lshl_b32 s21, s41, 5
    s_add_u32 s27, s27, s21
    v_bfe_u32 v20, v1, 2, 2
    v_and_b32 v22, 3, v1
    v_lshl_add_u32 v20, v20, 3, v22
    v_lshlrev_b32 v12, 6, v20
    v_lshl_add_u32 v12, v98, 4, v12
    s_and_b32 s21, s14, 1
    s_lshl_b32 s21, s21, 14
    s_lshl_b32 s22, s27, 2
    s_add_u32 s21, s21, s22
    s_add_u32 s21, s21, 100679680
    v_mov_b32 v245, s21
    s_mov_b32 s85, 0
    s_mul_i32 s21, s27, 4160
    v_add_u32 v12, s21, v12
    v_mov_b32 v13, v12
    v_lshlrev_b32 v15, 4, v20
    v_lshl_add_u32 v15, v98, 5, v15
    s_mul_i32 s21, s27, 1040
    v_add_u32 v15, s21, v15
    v_and_b32 v22, 1, v98
    v_cmp_eq_u32 vcc, 0, v22
    s_nop 1
    v_cndmask_b32 v15, v21, v15, vcc
    v_lshlrev_b32 v14, 6, v96
    v_lshl_add_u32 v14, v98, 4, v14
    v_add_u32 v14, s21, v14
    v_cmp_eq_u32 vcc, 1, v97
    s_nop 1
    v_cndmask_b32 v14, v21, v14, vcc
    v_mov_b32 v16, v19
    s_lshl_b32 s21, s14, 11
    v_add_u32 v17, s21, v19
    v_and_b32 v20, 15, v1
    v_bfe_u32 v22, v1, 2, 2
    v_and_b32 v18, 1, v1
    v_lshl_add_u32 v18, v22, 1, v18
    v_bfe_u32 v22, v1, 1, 1
    v_lshl_add_u32 v18, v22, 3, v18
    s_cmp_eq_u32 s14, 1
    s_cselect_b64 vcc, -1, 0
    v_cndmask_b32 v20, v20, v18, vcc
    v_and_b32 v22, 1, v98
    v_lshlrev_b32 v22, 2, v22
    v_sub_u32 v20, v20, v22
    v_mov_b32 v22, 0x3f80
    v_mov_b32 v18, 0x3f800000
    v_mov_b32 v172, 0x4444
    v_mov_b32 v84, 0xeeee
    v_cmp_eq_u32 vcc, 1, v97
    s_nop 1
    v_cndmask_b32 v172, v172, v84, vcc
    v_cmp_eq_u32 vcc, 0, v20
    s_nop 1
    v_cndmask_b32 v84, 0, v22, vcc
    v_cmp_eq_u32 vcc, 1, v20
    s_nop 1
    v_cndmask_b32 v84, v84, v18, vcc
    v_cmp_eq_u32 vcc, 2, v20
    s_nop 1
    v_cndmask_b32 v85, 0, v22, vcc
    v_cmp_eq_u32 vcc, 3, v20
    s_nop 1
    v_cndmask_b32 v85, v85, v18, vcc
    v_cmp_eq_u32 vcc, 8, v20
    s_nop 1
    v_cndmask_b32 v86, 0, v22, vcc
    v_cmp_eq_u32 vcc, 9, v20
    s_nop 1
    v_cndmask_b32 v86, v86, v18, vcc
    v_cmp_eq_u32 vcc, 10, v20
    s_nop 1
    v_cndmask_b32 v87, 0, v22, vcc
    v_cmp_eq_u32 vcc, 11, v20
    s_nop 1
    v_cndmask_b32 v87, v87, v18, vcc
    s_mov_b32 s16, 81788928
    s_mov_b32 s42, 82083840
    s_mov_b32 s43, 82378752
    s_mov_b32 s44, 82673664
    s_mov_b32 s17, 17825792
    s_mov_b32 s18, 35651584
    s_mov_b32 s19, 71303168
    s_mov_b32 s20, 76546048
    s_mov_b32 s15, 0
    v_mov_b32 v204, -1
    v_mov_b32 v205, -1
    v_mov_b32 v206, -1
    v_mov_b32 v207, -1
    v_mov_b32 v236, 0x3f803f80
    v_mov_b32 v237, 0x3f803f80
    v_mov_b32 v238, 0x3f803f80
    v_mov_b32 v239, 0x3f803f80
    s_mul_i32 s22, s14, 294912
    s_add_u32 s22, s22, 81788928
    buffer_store_dwordx4 v[204:207], v3, s[4:7], s22 offen sc1
    buffer_store_dwordx4 v[204:207], v3, s[4:7], s22 offen offset:128 sc1
    buffer_store_dwordx4 v[204:207], v4, s[4:7], s22 offen sc1
    buffer_store_dwordx2 v[204:205], v7, s[4:7], s22 offen sc1
    buffer_store_dwordx2 v[204:205], v11, s[4:7], s22 offen sc1
    s_lshl_b32 s22, s14, 18
    s_add_u32 s22, s22, 167772160
    buffer_store_dwordx4 v[204:207], v9, s[4:7], s22 offen sc1
    s_add_u32 s22, s22, 8192
    buffer_store_dwordx4 v[204:207], v9, s[4:7], s22 offen sc1
    s_lshl_b32 s22, s27, 2
    s_add_u32 s22, s22, 100712448
    v_lshlrev_b32 v246, 2, v1
    v_add_u32 v246, s22, v246
    v_cmp_gt_u32 vcc, 32, v1
    s_nop 1
    v_cndmask_b32 v246, v21, v246, vcc
    v_mov_b32 v247, 0
    buffer_store_dword v247, v246, s[4:7], 0 offen sc1
    v_lshrrev_b32 v19, 2, v1
    v_and_b32 v22, 3, v1
    v_lshlrev_b32 v22, 4, v22
    v_lshl_add_u32 v140, v19, 13, v22
    v_lshl_add_u32 v141, v19, 11, v22
    s_mul_i32 s86, s14, 40960
    s_lshr_b32 s21, s13, 3
    s_cmp_eq_u32 s21, 1
    s_cselect_b64 s[8:9], s[32:33], s[30:31]
    s_cmp_eq_u32 s21, 2
    s_cselect_b64 s[8:9], s[34:35], s[8:9]
    s_cmp_eq_u32 s21, 3
    s_cselect_b64 s[8:9], s[36:37], s[8:9]
    s_cselect_b32 s21, 11, 13
    s_cselect_b32 s87, 21, 11
    s_lshl_b32 s87, s12, s87
    s_and_b32 s22, s13, 3
    s_lshl_b32 s22, s22, 8
    v_add_u32 v142, s22, v0
    v_lshlrev_b32 v142, s21, v142
    s_and_b32 s22, s13, 4
    s_lshl_b32 s22, s22, 8
    s_add_u32 s87, s87, s22
    buffer_load_dword v143, v142, s[8:11], s87 offen offset:384
    s_cmp_eq_u32 s87, 7168
    s_cselect_b32 s87, s87, 1073741824
    buffer_load_dword v144, v142, s[8:11], s87 offen offset:896
    s_mov_b32 s8, s32
    s_mov_b32 s9, s33
    s_lshl_b32 s87, s14, 21
    s_lshl_b32 s22, s27, 1
    s_add_u32 s87, s87, s22
    s_add_u32 m0, s86, 0
    s_nop 0
    buffer_load_dwordx4 v140, s[8:11], s87 offen lds
    s_add_u32 s87, s87, 131072
    s_add_u32 m0, s86, 1024
    s_nop 0
    buffer_load_dwordx4 v140, s[8:11], s87 offen lds
    s_add_u32 s87, s87, 131072
    s_add_u32 m0, s86, 2048
    s_nop 0
    buffer_load_dwordx4 v140, s[8:11], s87 offen lds
    s_add_u32 s87, s87, 131072
    s_add_u32 m0, s86, 3072
    s_nop 0
    buffer_load_dwordx4 v140, s[8:11], s87 offen lds
    s_add_u32 s87, s87, 131072
    v_bfe_u32 v19, v1, 2, 1
    v_lshl_add_u32 v19, v98, 2, v19
    v_lshl_add_u32 v19, v97, 5, v19
    v_lshl_add_u32 v22, v19, 6, v22
    v_add_u32 v22, s86, v22
    s_waitcnt vmcnt(6)
    s_barrier
    s_cmp_lg_u32 s14, 0
    s_cbranch_scc1 reg_20
    s_and_b32 s21, s2, 3
    s_lshl_b32 s21, s21, 3
    s_lshl_b32 s22, s98, 2
    s_add_u32 s21, s21, s22
    s_lshl_b32 s21, 1, s21
    s_andn2_b32 s22, s2, 3
    v_mov_b32 v20, s22
    v_mov_b32 v21, s21
    s_mov_b64 exec, 1
    global_atomic_add v20, v21, s[100:101] sc1
    s_mov_b64 exec, -1
reg_20:
    s_barrier
    s_add_u32 m0, s86, 4096
    s_nop 0
    buffer_load_dwordx4 v140, s[8:11], s87 offen lds
    s_add_u32 s87, s87, 131072
    s_add_u32 m0, s86, 5120
    s_nop 0
    buffer_load_dwordx4 v140, s[8:11], s87 offen lds
    s_add_u32 s87, s87, 131072
    s_add_u32 m0, s86, 6144
    s_nop 0
    buffer_load_dwordx4 v140, s[8:11], s87 offen lds
    s_add_u32 s87, s87, 131072
    s_add_u32 m0, s86, 7168
    s_nop 0
    buffer_load_dwordx4 v140, s[8:11], s87 offen lds
    s_add_u32 s87, s87, 131072
    s_add_u32 m0, s86, 8192
    s_nop 0
    buffer_load_dwordx4 v140, s[8:11], s87 offen lds
    s_add_u32 s87, s87, 131072
    s_add_u32 m0, s86, 9216
    s_nop 0
    buffer_load_dwordx4 v140, s[8:11], s87 offen lds
    s_add_u32 s87, s87, 131072
    s_add_u32 m0, s86, 10240
    s_nop 0
    buffer_load_dwordx4 v140, s[8:11], s87 offen lds
    s_add_u32 s87, s87, 131072
    s_add_u32 m0, s86, 11264
    s_nop 0
    buffer_load_dwordx4 v140, s[8:11], s87 offen lds
    s_add_u32 s87, s87, 131072
    s_add_u32 m0, s86, 12288
    s_nop 0
    buffer_load_dwordx4 v140, s[8:11], s87 offen lds
    s_add_u32 s87, s87, 131072
    s_add_u32 m0, s86, 13312
    s_nop 0
    buffer_load_dwordx4 v140, s[8:11], s87 offen lds
    s_add_u32 s87, s87, 131072
    s_add_u32 m0, s86, 14336
    s_nop 0
    buffer_load_dwordx4 v140, s[8:11], s87 offen lds
    s_add_u32 s87, s87, 131072
    s_add_u32 m0, s86, 15360
    s_nop 0
    buffer_load_dwordx4 v140, s[8:11], s87 offen lds
    s_add_u32 s87, s87, 131072
    s_mov_b32 s8, s34
    s_mov_b32 s9, s35
    s_lshl_b32 s87, s14, 21
    s_lshl_b32 s22, s27, 1
    s_add_u32 s87, s87, s22
    s_add_u32 m0, s86, 16384
    s_nop 0
    buffer_load_dwordx4 v140, s[8:11], s87 offen lds
    s_add_u32 s87, s87, 131072
    s_add_u32 m0, s86, 17408
    s_nop 0
    buffer_load_dwordx4 v140, s[8:11], s87 offen lds
    s_add_u32 s87, s87, 131072
    s_add_u32 m0, s86, 18432
    s_nop 0
    buffer_load_dwordx4 v140, s[8:11], s87 offen lds
    s_add_u32 s87, s87, 131072
    s_add_u32 m0, s86, 19456
    s_nop 0
    buffer_load_dwordx4 v140, s[8:11], s87 offen lds
    s_add_u32 s87, s87, 131072
    s_add_u32 m0, s86, 20480
    s_nop 0
    buffer_load_dwordx4 v140, s[8:11], s87 offen lds
    s_add_u32 s87, s87, 131072
    s_add_u32 m0, s86, 21504
    s_nop 0
    buffer_load_dwordx4 v140, s[8:11], s87 offen lds
    s_add_u32 s87, s87, 131072
    s_add_u32 m0, s86, 22528
    s_nop 0
    buffer_load_dwordx4 v140, s[8:11], s87 offen lds
    s_add_u32 s87, s87, 131072
    s_add_u32 m0, s86, 23552
    s_nop 0
    buffer_load_dwordx4 v140, s[8:11], s87 offen lds
    s_add_u32 s87, s87, 131072
    s_add_u32 m0, s86, 24576
    s_nop 0
    buffer_load_dwordx4 v140, s[8:11], s87 offen lds
    s_add_u32 s87, s87, 131072
    s_add_u32 m0, s86, 25600
    s_nop 0
    buffer_load_dwordx4 v140, s[8:11], s87 offen lds
    s_add_u32 s87, s87, 131072
    s_add_u32 m0, s86, 26624
    s_nop 0
    buffer_load_dwordx4 v140, s[8:11], s87 offen lds
    s_add_u32 s87, s87, 131072
    s_add_u32 m0, s86, 27648
    s_nop 0
    buffer_load_dwordx4 v140, s[8:11], s87 offen lds
    s_add_u32 s87, s87, 131072
    s_add_u32 m0, s86, 28672
    s_nop 0
    buffer_load_dwordx4 v140, s[8:11], s87 offen lds
    s_add_u32 s87, s87, 131072
    s_add_u32 m0, s86, 29696
    s_nop 0
    buffer_load_dwordx4 v140, s[8:11], s87 offen lds
    s_add_u32 s87, s87, 131072
    s_add_u32 m0, s86, 30720
    s_nop 0
    buffer_load_dwordx4 v140, s[8:11], s87 offen lds
    s_add_u32 s87, s87, 131072
    s_add_u32 m0, s86, 31744
    s_nop 0
    buffer_load_dwordx4 v140, s[8:11], s87 offen lds
    s_add_u32 s87, s87, 131072
    s_mov_b32 s8, s30
    s_mov_b32 s9, s31
    s_lshl_b32 s87, s14, 21
    s_lshl_b32 s22, s27, 1
    s_add_u32 s87, s87, s22
    s_add_u32 m0, s86, 32768
    s_nop 0
    buffer_load_dwordx4 v140, s[8:11], s87 offen lds
    s_add_u32 s87, s87, 131072
    s_add_u32 m0, s86, 33792
    s_nop 0
    buffer_load_dwordx4 v140, s[8:11], s87 offen lds
    s_add_u32 s87, s87, 131072
    s_add_u32 m0, s86, 34816
    s_nop 0
    buffer_load_dwordx4 v140, s[8:11], s87 offen lds
    s_add_u32 s87, s87, 131072
    s_add_u32 m0, s86, 35840
    s_nop 0
    buffer_load_dwordx4 v140, s[8:11], s87 offen lds
    s_add_u32 s87, s87, 131072
    s_add_u32 m0, s86, 36864
    s_nop 0
    buffer_load_dwordx4 v140, s[8:11], s87 offen lds
    s_add_u32 s87, s87, 131072
    s_add_u32 m0, s86, 37888
    s_nop 0
    buffer_load_dwordx4 v140, s[8:11], s87 offen lds
    s_add_u32 s87, s87, 131072
    s_add_u32 m0, s86, 38912
    s_nop 0
    buffer_load_dwordx4 v140, s[8:11], s87 offen lds
    s_add_u32 s87, s87, 131072
    s_add_u32 m0, s86, 39936
    s_nop 0
    buffer_load_dwordx4 v140, s[8:11], s87 offen lds
    s_add_u32 s87, s87, 131072
    s_waitcnt vmcnt(36)
    ds_read_b64_tr_b16 a[64:65], v22 offset:0
    ds_read_b64_tr_b16 a[66:67], v22 offset:128
    ds_read_b64_tr_b16 a[68:69], v22 offset:1024
    ds_read_b64_tr_b16 a[70:71], v22 offset:1152
    s_waitcnt lgkmcnt(4)
    ds_read_b64_tr_b16 a[96:97], v22 offset:8
    ds_read_b64_tr_b16 a[98:99], v22 offset:136
    ds_read_b64_tr_b16 a[100:101], v22 offset:1032
    ds_read_b64_tr_b16 a[102:103], v22 offset:1160
    s_waitcnt vmcnt(32)
    ds_read_b64_tr_b16 a[72:73], v22 offset:4096
    ds_read_b64_tr_b16 a[74:75], v22 offset:4224
    ds_read_b64_tr_b16 a[76:77], v22 offset:5120
    ds_read_b64_tr_b16 a[78:79], v22 offset:5248
    s_waitcnt lgkmcnt(4)
    ds_read_b64_tr_b16 a[104:105], v22 offset:4104
    ds_read_b64_tr_b16 a[106:107], v22 offset:4232
    ds_read_b64_tr_b16 a[108:109], v22 offset:5128
    ds_read_b64_tr_b16 a[110:111], v22 offset:5256
    s_add_u32 m0, s86, 0
    s_nop 0
    buffer_load_dwordx4 v140, s[8:11], s87 offen lds
    s_add_u32 s87, s87, 131072
    s_add_u32 m0, s86, 1024
    s_nop 0
    buffer_load_dwordx4 v140, s[8:11], s87 offen lds
    s_add_u32 s87, s87, 131072
    s_add_u32 m0, s86, 2048
    s_nop 0
    buffer_load_dwordx4 v140, s[8:11], s87 offen lds
    s_add_u32 s87, s87, 131072
    s_add_u32 m0, s86, 3072
    s_nop 0
    buffer_load_dwordx4 v140, s[8:11], s87 offen lds
    s_add_u32 s87, s87, 131072
    s_waitcnt vmcnt(32)
    ds_read_b64_tr_b16 a[80:81], v22 offset:8192
    ds_read_b64_tr_b16 a[82:83], v22 offset:8320
    ds_read_b64_tr_b16 a[84:85], v22 offset:9216
    ds_read_b64_tr_b16 a[86:87], v22 offset:9344
    s_waitcnt lgkmcnt(4)
    ds_read_b64_tr_b16 a[112:113], v22 offset:8200
    ds_read_b64_tr_b16 a[114:115], v22 offset:8328
    ds_read_b64_tr_b16 a[116:117], v22 offset:9224
    ds_read_b64_tr_b16 a[118:119], v22 offset:9352
    s_add_u32 m0, s86, 4096
    s_nop 0
    buffer_load_dwordx4 v140, s[8:11], s87 offen lds
    s_add_u32 s87, s87, 131072
    s_add_u32 m0, s86, 5120
    s_nop 0
    buffer_load_dwordx4 v140, s[8:11], s87 offen lds
    s_add_u32 s87, s87, 131072
    s_add_u32 m0, s86, 6144
    s_nop 0
    buffer_load_dwordx4 v140, s[8:11], s87 offen lds
    s_add_u32 s87, s87, 131072
    s_add_u32 m0, s86, 7168
    s_nop 0
    buffer_load_dwordx4 v140, s[8:11], s87 offen lds
    s_add_u32 s87, s87, 131072
    s_waitcnt vmcnt(32)
    ds_read_b64_tr_b16 a[88:89], v22 offset:12288
    ds_read_b64_tr_b16 a[90:91], v22 offset:12416
    ds_read_b64_tr_b16 a[92:93], v22 offset:13312
    ds_read_b64_tr_b16 a[94:95], v22 offset:13440
    s_waitcnt lgkmcnt(4)
    ds_read_b64_tr_b16 a[120:121], v22 offset:12296
    ds_read_b64_tr_b16 a[122:123], v22 offset:12424
    ds_read_b64_tr_b16 a[124:125], v22 offset:13320
    ds_read_b64_tr_b16 a[126:127], v22 offset:13448
    s_mov_b32 s8, s36
    s_mov_b32 s9, s37
    s_lshl_b32 s87, s12, 21
    s_lshl_b32 s22, s14, 19
    s_add_u32 s87, s87, s22
    s_lshl_b32 s22, s13, 6
    s_add_u32 s87, s87, s22
    s_add_u32 m0, s86, 8192
    s_nop 0
    buffer_load_dwordx4 v141, s[8:11], s87 offen lds
    s_add_u32 s87, s87, 32768
    s_add_u32 m0, s86, 9216
    s_nop 0
    buffer_load_dwordx4 v141, s[8:11], s87 offen lds
    s_add_u32 s87, s87, 32768
    s_add_u32 m0, s86, 10240
    s_nop 0
    buffer_load_dwordx4 v141, s[8:11], s87 offen lds
    s_add_u32 s87, s87, 32768
    s_add_u32 m0, s86, 11264
    s_nop 0
    buffer_load_dwordx4 v141, s[8:11], s87 offen lds
    s_add_u32 s87, s87, 32768
    s_waitcnt vmcnt(32)
    ds_read_b64_tr_b16 a[128:129], v22 offset:16384
    ds_read_b64_tr_b16 a[130:131], v22 offset:16512
    ds_read_b64_tr_b16 a[132:133], v22 offset:17408
    ds_read_b64_tr_b16 a[134:135], v22 offset:17536
    s_waitcnt lgkmcnt(4)
    ds_read_b64_tr_b16 a[160:161], v22 offset:16392
    ds_read_b64_tr_b16 a[162:163], v22 offset:16520
    ds_read_b64_tr_b16 a[164:165], v22 offset:17416
    ds_read_b64_tr_b16 a[166:167], v22 offset:17544
    s_add_u32 m0, s86, 12288
    s_nop 0
    buffer_load_dwordx4 v141, s[8:11], s87 offen lds
    s_add_u32 s87, s87, 32768
    s_add_u32 m0, s86, 13312
    s_nop 0
    buffer_load_dwordx4 v141, s[8:11], s87 offen lds
    s_add_u32 s87, s87, 32768
    s_add_u32 m0, s86, 14336
    s_nop 0
    buffer_load_dwordx4 v141, s[8:11], s87 offen lds
    s_add_u32 s87, s87, 32768
    s_add_u32 m0, s86, 15360
    s_nop 0
    buffer_load_dwordx4 v141, s[8:11], s87 offen lds
    s_add_u32 s87, s87, 32768
    s_waitcnt vmcnt(32)
    ds_read_b64_tr_b16 a[136:137], v22 offset:20480
    ds_read_b64_tr_b16 a[138:139], v22 offset:20608
    ds_read_b64_tr_b16 a[140:141], v22 offset:21504
    ds_read_b64_tr_b16 a[142:143], v22 offset:21632
    s_waitcnt lgkmcnt(4)
    ds_read_b64_tr_b16 a[168:169], v22 offset:20488
    ds_read_b64_tr_b16 a[170:171], v22 offset:20616
    ds_read_b64_tr_b16 a[172:173], v22 offset:21512
    ds_read_b64_tr_b16 a[174:175], v22 offset:21640
    s_add_u32 m0, s86, 16384
    s_nop 0
    buffer_load_dwordx4 v141, s[8:11], s87 offen lds
    s_add_u32 s87, s87, 32768
    s_add_u32 m0, s86, 17408
    s_nop 0
    buffer_load_dwordx4 v141, s[8:11], s87 offen lds
    s_add_u32 s87, s87, 32768
    s_add_u32 m0, s86, 18432
    s_nop 0
    buffer_load_dwordx4 v141, s[8:11], s87 offen lds
    s_add_u32 s87, s87, 32768
    s_add_u32 m0, s86, 19456
    s_nop 0
    buffer_load_dwordx4 v141, s[8:11], s87 offen lds
    s_add_u32 s87, s87, 32768
    s_waitcnt vmcnt(32)
    ds_read_b64_tr_b16 a[144:145], v22 offset:24576
    ds_read_b64_tr_b16 a[146:147], v22 offset:24704
    ds_read_b64_tr_b16 a[148:149], v22 offset:25600
    ds_read_b64_tr_b16 a[150:151], v22 offset:25728
    s_waitcnt lgkmcnt(4)
    ds_read_b64_tr_b16 a[176:177], v22 offset:24584
    ds_read_b64_tr_b16 a[178:179], v22 offset:24712
    ds_read_b64_tr_b16 a[180:181], v22 offset:25608
    ds_read_b64_tr_b16 a[182:183], v22 offset:25736
    s_add_u32 m0, s86, 20480
    s_nop 0
    buffer_load_dwordx4 v141, s[8:11], s87 offen lds
    s_add_u32 s87, s87, 32768
    s_add_u32 m0, s86, 21504
    s_nop 0
    buffer_load_dwordx4 v141, s[8:11], s87 offen lds
    s_add_u32 s87, s87, 32768
    s_add_u32 m0, s86, 22528
    s_nop 0
    buffer_load_dwordx4 v141, s[8:11], s87 offen lds
    s_add_u32 s87, s87, 32768
    s_add_u32 m0, s86, 23552
    s_nop 0
    buffer_load_dwordx4 v141, s[8:11], s87 offen lds
    s_add_u32 s87, s87, 32768
    s_waitcnt vmcnt(32)
    ds_read_b64_tr_b16 a[152:153], v22 offset:28672
    ds_read_b64_tr_b16 a[154:155], v22 offset:28800
    ds_read_b64_tr_b16 a[156:157], v22 offset:29696
    ds_read_b64_tr_b16 a[158:159], v22 offset:29824
    s_waitcnt lgkmcnt(4)
    ds_read_b64_tr_b16 a[184:185], v22 offset:28680
    ds_read_b64_tr_b16 a[186:187], v22 offset:28808
    ds_read_b64_tr_b16 a[188:189], v22 offset:29704
    ds_read_b64_tr_b16 a[190:191], v22 offset:29832
    s_waitcnt vmcnt(28)
    ds_read_b64_tr_b16 a[0:1], v22 offset:32768
    ds_read_b64_tr_b16 a[2:3], v22 offset:32896
    ds_read_b64_tr_b16 a[4:5], v22 offset:33792
    ds_read_b64_tr_b16 a[6:7], v22 offset:33920
    s_waitcnt lgkmcnt(4)
    ds_read_b64_tr_b16 a[32:33], v22 offset:32776
    ds_read_b64_tr_b16 a[34:35], v22 offset:32904
    ds_read_b64_tr_b16 a[36:37], v22 offset:33800
    ds_read_b64_tr_b16 a[38:39], v22 offset:33928
    s_waitcnt vmcnt(24)
    ds_read_b64_tr_b16 a[8:9], v22 offset:36864
    ds_read_b64_tr_b16 a[10:11], v22 offset:36992
    ds_read_b64_tr_b16 a[12:13], v22 offset:37888
    ds_read_b64_tr_b16 a[14:15], v22 offset:38016
    s_waitcnt lgkmcnt(4)
    ds_read_b64_tr_b16 a[40:41], v22 offset:36872
    ds_read_b64_tr_b16 a[42:43], v22 offset:37000
    ds_read_b64_tr_b16 a[44:45], v22 offset:37896
    ds_read_b64_tr_b16 a[46:47], v22 offset:38024
    s_waitcnt vmcnt(20)
    ds_read_b64_tr_b16 a[16:17], v22 offset:0
    ds_read_b64_tr_b16 a[18:19], v22 offset:128
    ds_read_b64_tr_b16 a[20:21], v22 offset:1024
    ds_read_b64_tr_b16 a[22:23], v22 offset:1152
    s_waitcnt lgkmcnt(4)
    ds_read_b64_tr_b16 a[48:49], v22 offset:8
    ds_read_b64_tr_b16 a[50:51], v22 offset:136
    ds_read_b64_tr_b16 a[52:53], v22 offset:1032
    ds_read_b64_tr_b16 a[54:55], v22 offset:1160
    s_waitcnt vmcnt(16)
    ds_read_b64_tr_b16 a[24:25], v22 offset:4096
    ds_read_b64_tr_b16 a[26:27], v22 offset:4224
    ds_read_b64_tr_b16 a[28:29], v22 offset:5120
    ds_read_b64_tr_b16 a[30:31], v22 offset:5248
    s_waitcnt lgkmcnt(4)
    ds_read_b64_tr_b16 a[56:57], v22 offset:4104
    ds_read_b64_tr_b16 a[58:59], v22 offset:4232
    ds_read_b64_tr_b16 a[60:61], v22 offset:5128
    ds_read_b64_tr_b16 a[62:63], v22 offset:5256
    s_waitcnt vmcnt(12)
    ds_read_b64_tr_b16 a[192:193], v22 offset:8192
    ds_read_b64_tr_b16 a[194:195], v22 offset:8320
    ds_read_b64_tr_b16 a[196:197], v22 offset:9216
    ds_read_b64_tr_b16 a[198:199], v22 offset:9344
    s_waitcnt lgkmcnt(4)
    ds_read_b64_tr_b16 a[224:225], v22 offset:8200
    ds_read_b64_tr_b16 a[226:227], v22 offset:8328
    ds_read_b64_tr_b16 a[228:229], v22 offset:9224
    ds_read_b64_tr_b16 a[230:231], v22 offset:9352
    s_waitcnt vmcnt(8)
    ds_read_b64_tr_b16 a[200:201], v22 offset:12288
    ds_read_b64_tr_b16 a[202:203], v22 offset:12416
    ds_read_b64_tr_b16 a[204:205], v22 offset:13312
    ds_read_b64_tr_b16 a[206:207], v22 offset:13440
    s_waitcnt lgkmcnt(4)
    ds_read_b64_tr_b16 a[232:233], v22 offset:12296
    ds_read_b64_tr_b16 a[234:235], v22 offset:12424
    ds_read_b64_tr_b16 a[236:237], v22 offset:13320
    ds_read_b64_tr_b16 a[238:239], v22 offset:13448
    s_waitcnt vmcnt(4)
    ds_read_b64_tr_b16 a[208:209], v22 offset:16384
    ds_read_b64_tr_b16 a[210:211], v22 offset:16512
    ds_read_b64_tr_b16 a[212:213], v22 offset:17408
    ds_read_b64_tr_b16 a[214:215], v22 offset:17536
    s_waitcnt lgkmcnt(4)
    ds_read_b64_tr_b16 a[240:241], v22 offset:16392
    ds_read_b64_tr_b16 a[242:243], v22 offset:16520
    ds_read_b64_tr_b16 a[244:245], v22 offset:17416
    ds_read_b64_tr_b16 a[246:247], v22 offset:17544
    s_waitcnt vmcnt(0)
    ds_read_b64_tr_b16 a[216:217], v22 offset:20480
    ds_read_b64_tr_b16 a[218:219], v22 offset:20608
    ds_read_b64_tr_b16 a[220:221], v22 offset:21504
    ds_read_b64_tr_b16 a[222:223], v22 offset:21632
    s_waitcnt lgkmcnt(4)
    ds_read_b64_tr_b16 a[248:249], v22 offset:20488
    ds_read_b64_tr_b16 a[250:251], v22 offset:20616
    ds_read_b64_tr_b16 a[252:253], v22 offset:21512
    ds_read_b64_tr_b16 a[254:255], v22 offset:21640
    s_waitcnt lgkmcnt(0)
    v_mov_b32 v155, 0
    v_mov_b32 v159, 0
    v_mov_b32 v163, 0
    v_mov_b32 v167, 0
    v_mov_b32 v179, 0
    s_mov_b32 s8, s28
    s_mov_b32 s9, s29
    s_mov_b32 s10, 16384
    v_lshlrev_b32 v20, 11, v96
    v_lshl_add_u32 v20, v98, 4, v20
    v_lshl_add_u32 v20, v97, 3, v20
    s_lshl_b32 s21, s13, 6
    buffer_load_dwordx2 v[88:89], v20, s[8:11], s21 offen
    v_lshlrev_b32 v20, 2, v1
    s_mov_b32 s22, 0
rdv_21:
    global_load_dword v21, v20, s[100:101] sc1
    s_lshl_b32 s21, s98, 2
    s_waitcnt vmcnt(0)
    v_lshrrev_b32 v22, s21, v21
    s_cmp_eq_u32 s98, 0
    s_cselect_b32 s21, 0x0f0f0f0f, s21
    s_cselect_b32 s21, s21, 0x01010101
    v_and_b32 v22, s21, v22
    v_cmp_ne_u32 vcc, 0x01010101, v22
    s_nop 0
    s_cbranch_vccz rdvok_22
    v_sad_u8 v22, v22, 0, 0
    s_nop 1
    v_add_u32_dpp v22, v22, v22 quad_perm:[1,0,3,2] row_mask:0xf bank_mask:0xf
    v_cmp_ne_u32 vcc, 8, v22
    s_nop 0
    s_cbranch_vccnz rdvw_23
    s_mov_b32 s98, 1
    s_and_b32 s3, s97, 7
    s_barrier
    s_branch role_start
rdvw_23:
    s_sleep 4
    s_add_u32 s22, s22, 1
    s_cmp_lt_u32 s22, 262144
    s_cbranch_scc1 rdv_21
    s_mov_b32 s25, 200000
rdvok_22:
    v_and_b32 v22, 0x40404040, v21
    v_bcnt_u32_b32 v22, v22, 0
    s_mov_b32 s46, 0
    v_cmp_le_u32 vcc, 1, v22
    s_nop 0
    s_bcnt1_i32_b64 s21, vcc
    s_add_u32 s46, s46, s21
    v_cmp_le_u32 vcc, 2, v22
    s_nop 0
    s_bcnt1_i32_b64 s21, vcc
    s_add_u32 s46, s46, s21
    v_cmp_le_u32 vcc, 3, v22
    s_nop 0
    s_bcnt1_i32_b64 s21, vcc
    s_add_u32 s46, s46, s21
    v_cmp_le_u32 vcc, 4, v22
    s_nop 0
    s_bcnt1_i32_b64 s21, vcc
    s_add_u32 s46, s46, s21
    s_cmp_gt_u32 s46, 16
    s_cselect_b32 s46, 8192, 0
    s_add_u32 s84, s95, s46
    s_xor_b32 s45, s98, 1
    v_min_u32 v88, -2, v88
    v_min_u32 v89, -2, v89
    buffer_store_dwordx2 v[88:89], v11, s[4:7], s16 offen sc1
    v_mov_b32 v40, 0
    v_mov_b32 v41, 0
    v_mov_b32 v42, 0
    v_mov_b32 v43, 0
    v_mov_b32 v44, 0
    v_mov_b32 v45, 0
    v_mov_b32 v46, 0
    v_mov_b32 v47, 0
    v_mov_b32 v48, 0
    v_mov_b32 v49, 0
    v_mov_b32 v50, 0
    v_mov_b32 v51, 0
    v_mov_b32 v52, 0
    v_mov_b32 v53, 0
    v_mov_b32 v54, 0
    v_mov_b32 v55, 0
    v_mov_b32 v56, 0
    v_mov_b32 v57, 0
    v_mov_b32 v58, 0
    v_mov_b32 v59, 0
    v_mov_b32 v60, 0
    v_mov_b32 v61, 0
    v_mov_b32 v62, 0
    v_mov_b32 v63, 0
    v_mov_b32 v64, 0
    v_mov_b32 v65, 0
    v_mov_b32 v66, 0
    v_mov_b32 v67, 0
    v_mov_b32 v68, 0
    v_mov_b32 v69, 0
    v_mov_b32 v70, 0
    v_mov_b32 v71, 0
    s_cmp_ge_u32 s14, 2
    s_cbranch_scc1 kv_24
    s_mov_b32 s94, 1
    s_mov_b32 s23, s25
fw_26:
    s_cmp_ge_u32 s85, s94
    s_cbranch_scc1 fo_27
    buffer_load_dword v247, v245, s[4:7], 0 offen sc1
    s_add_u32 s23, s23, 1
    s_waitcnt vmcnt(0)
    v_readfirstlane_b32 s85, v247
    s_cmp_lt_u32 s23, 200000
    s_cbranch_scc1 fw_26
    s_mov_b32 s25, 200000
fo_27:
    s_cmp_eq_u32 s14, 1
    s_cbranch_scc1 kv_25
    buffer_load_dwordx4 v[132:135], v12, s[4:7], s17 offen sc1
    buffer_load_dwordx4 v[136:139], v12, s[4:7], s17 offen offset:256 sc1
    s_add_u32 s17, s17, 2048
    s_min_u32 s17, s17, 17954816
    s_branch kv_24
kv_25:
    buffer_load_dwordx4 v[228:231], v13, s[4:7], s18 offen offset:0 sc1
    buffer_load_dwordx4 v[232:235], v13, s[4:7], s18 offen offset:256 sc1
    s_add_u32 s18, s18, 2048
    s_min_u32 s18, s18, 35780608
kv_24:
    s_mov_b32 s23, s25
    s_barrier
    s_cmp_eq_u32 s45, 0
    s_cbranch_scc1 recur_slow_disp
    s_cmp_eq_u32 s14, 1
    s_cbranch_scc1 recur_fast_w1
    s_cmp_eq_u32 s14, 2
    s_cbranch_scc1 recur_fast_w2
    s_cmp_eq_u32 s14, 3
    s_cbranch_scc1 recur_fast_w3
    s_branch recur_fast_w0
recur_slow_disp:
    s_cmp_eq_u32 s14, 1
    s_cbranch_scc1 recur_slow_w1
    s_cmp_eq_u32 s14, 2
    s_cbranch_scc1 recur_slow_w2
    s_cmp_eq_u32 s14, 3
    s_cbranch_scc1 recur_slow_w3
    s_branch recur_slow_w0
.p2align 6
recur_fast_w0:
    s_nop 15
    s_mov_b32 s23, s25
    buffer_load_dwordx4 v[24:27], v2, s[4:7], s16 offen offset:0 sc1
    s_nop 11
    buffer_load_dwordx4 v[28:31], v2, s[4:7], s16 offen offset:1024 sc1
    s_nop 11
    buffer_load_dwordx4 v[32:35], v2, s[4:7], s16 offen offset:2048 sc1
    s_nop 11
    buffer_load_dwordx4 v[36:39], v2, s[4:7], s16 offen offset:3072 sc1
    s_waitcnt vmcnt(3)
    v_max3_u32 v19, v24, v25, v26
    v_max_u32 v19, v19, v27
    v_cmp_eq_u32 vcc, -1, v19
    s_nop 0
    s_cbranch_vccnz g_28F15_0
    v_smfmac_f32_16x16x64_bf16 v[40:43], v[24:27], a[0:7], v172
    s_waitcnt vmcnt(2)
    v_max3_u32 v19, v28, v29, v30
    v_max_u32 v19, v19, v31
    v_smfmac_f32_16x16x64_bf16 v[44:47], v[24:27], a[64:71], v172
    v_cmp_eq_u32 vcc, -1, v19
    v_smfmac_f32_16x16x64_bf16 v[48:51], v[24:27], a[32:39], v172
    v_smfmac_f32_16x16x64_bf16 v[52:55], v[24:27], a[96:103], v172
    s_cbranch_vccnz g_28F14_1
    v_smfmac_f32_16x16x64_bf16 v[40:43], v[28:31], a[8:15], v172
    s_waitcnt vmcnt(1)
    v_max3_u32 v19, v32, v33, v34
    v_max_u32 v19, v19, v35
    v_smfmac_f32_16x16x64_bf16 v[44:47], v[28:31], a[72:79], v172
    v_cmp_eq_u32 vcc, -1, v19
    v_smfmac_f32_16x16x64_bf16 v[48:51], v[28:31], a[40:47], v172
    v_smfmac_f32_16x16x64_bf16 v[52:55], v[28:31], a[104:111], v172
    s_cbranch_vccnz g_28F12_2
    v_smfmac_f32_16x16x64_bf16 v[40:43], v[32:35], a[16:23], v172
    s_waitcnt vmcnt(0)
    v_max3_u32 v19, v36, v37, v38
    v_max_u32 v19, v19, v39
    v_smfmac_f32_16x16x64_bf16 v[44:47], v[32:35], a[80:87], v172
    v_cmp_eq_u32 vcc, -1, v19
    v_smfmac_f32_16x16x64_bf16 v[48:51], v[32:35], a[48:55], v172
    v_smfmac_f32_16x16x64_bf16 v[52:55], v[32:35], a[112:119], v172
    s_cbranch_vccnz g_28F8_3
    v_smfmac_f32_16x16x64_bf16 v[40:43], v[36:39], a[24:31], v172
    v_smfmac_f32_16x16x64_bf16 v[44:47], v[36:39], a[88:95], v172
    v_smfmac_f32_16x16x64_bf16 v[48:51], v[36:39], a[56:63], v172
    v_smfmac_f32_16x16x64_bf16 v[52:55], v[36:39], a[120:127], v172
gc_29:
    v_cvt_pk_bf16_f32 v72, v40, v41
    v_cvt_pk_bf16_f32 v73, v42, v43
    v_cvt_pk_bf16_f32 v74, v44, v45
    v_cvt_pk_bf16_f32 v75, v46, v47
    v_smfmac_f32_16x16x64_bf16 v[56:59], v[24:27], a[128:135], v172
    v_cvt_pk_bf16_f32 v76, v48, v49
    v_cvt_pk_bf16_f32 v77, v50, v51
    s_nop 0
    v_cvt_pk_bf16_f32 v78, v52, v53
    v_cvt_pk_bf16_f32 v79, v54, v55
    v_smfmac_f32_16x16x64_bf16 v[60:63], v[24:27], a[160:167], v172
    v_mfma_f32_16x16x32_bf16 v[88:91], v[72:75], v[84:87], 0
    v_mfma_f32_16x16x32_bf16 v[92:95], v[76:79], v[84:87], 0
    v_smfmac_f32_16x16x64_bf16 v[56:59], v[28:31], a[136:143], v172
    v_smfmac_f32_16x16x64_bf16 v[60:63], v[28:31], a[168:175], v172
    s_barrier
    ds_read_b128 v[104:107], v16 offset:2048
    ds_read_b128 v[108:111], v16 offset:3072
    ds_read_b128 v[112:115], v16 offset:4096
    ds_read_b128 v[116:119], v16 offset:5120
    ds_read_b128 v[120:123], v16 offset:6144
    ds_read_b128 v[124:127], v16 offset:7168
    v_smfmac_f32_16x16x64_bf16 v[56:59], v[32:35], a[144:151], v172
    v_smfmac_f32_16x16x64_bf16 v[60:63], v[32:35], a[176:183], v172
    v_smfmac_f32_16x16x64_bf16 v[56:59], v[36:39], a[152:159], v172
    v_smfmac_f32_16x16x64_bf16 v[60:63], v[36:39], a[184:191], v172
    s_waitcnt lgkmcnt(5)
    v_mfma_f32_16x16x32_bf16 v[88:91], v[104:107], v[84:87], v[88:91]
    s_waitcnt lgkmcnt(4)
    v_mfma_f32_16x16x32_bf16 v[92:95], v[108:111], v[84:87], v[92:95]
    s_waitcnt lgkmcnt(3)
    v_mfma_f32_16x16x32_bf16 v[88:91], v[112:115], v[84:87], v[88:91]
    s_waitcnt lgkmcnt(2)
    v_mfma_f32_16x16x32_bf16 v[92:95], v[116:119], v[84:87], v[92:95]
    s_waitcnt lgkmcnt(1)
    v_mfma_f32_16x16x32_bf16 v[88:91], v[120:123], v[84:87], v[88:91]
    s_waitcnt lgkmcnt(0)
    v_mfma_f32_16x16x32_bf16 v[92:95], v[124:127], v[84:87], v[92:95]
    v_cvt_pk_bf16_f32 v80, v56, v57
    v_cvt_pk_bf16_f32 v81, v58, v59
    v_cvt_pk_bf16_f32 v82, v60, v61
    v_cvt_pk_bf16_f32 v83, v62, v63
    ds_write_b128 v17, v[80:83] offset:8192
    s_nop 0
    v_cvt_pk_bf16_f32 v128, v88, v89
    v_cvt_pk_bf16_f32 v129, v90, v91
    v_cvt_pk_bf16_f32 v130, v92, v93
    v_cvt_pk_bf16_f32 v131, v94, v95
    s_nop 1
    v_mfma_f32_16x16x32_bf16 v[144:147], v[132:135], v[128:131], 0
    v_mfma_f32_16x16x32_bf16 v[148:151], v[136:139], v[128:131], 0
    v_mfma_f32_16x16x32_bf16 v[140:143], v[128:131], v[128:131], 0
    s_nop 1
    buffer_store_dwordx4 v[144:147], v3, s[4:7], s16 offen
    s_nop 1
    buffer_store_dwordx4 v[148:151], v3, s[4:7], s16 offen offset:128
    s_nop 1
    buffer_store_dwordx4 v[140:143], v4, s[4:7], s16 offen
    s_cmp_eq_u32 s15, 63
    s_waitcnt lgkmcnt(0)
    s_barrier
    s_cbranch_scc1 recur_fast_last0
    v_readfirstlane_b32 s85, v247
    s_add_u32 s94, s15, 2
    s_barrier
    s_nop 15
    s_mov_b32 s23, s25
    buffer_load_dwordx4 v[24:27], v8, s[4:7], s16 offen offset:0 sc1
    s_nop 11
    buffer_load_dwordx4 v[28:31], v8, s[4:7], s16 offen offset:1024 sc1
    s_nop 11
    buffer_load_dwordx4 v[32:35], v8, s[4:7], s16 offen offset:2048 sc1
    s_nop 11
    buffer_load_dwordx4 v[36:39], v8, s[4:7], s16 offen offset:3072 sc1
    s_waitcnt vmcnt(3)
    v_max3_u32 v19, v24, v25, v26
    v_max_u32 v19, v19, v27
    v_cmp_eq_u32 vcc, -1, v19
    s_nop 0
    s_cbranch_vccnz g_30F15_0
    v_smfmac_f32_16x16x64_bf16 v[64:67], v[24:27], a[192:199], v172
    v_smfmac_f32_16x16x64_bf16 v[68:71], v[24:27], a[224:231], v172
    s_waitcnt vmcnt(2)
    v_max3_u32 v19, v28, v29, v30
    v_max_u32 v19, v19, v31
    v_cmp_eq_u32 vcc, -1, v19
    s_nop 0
    s_cbranch_vccnz g_30F14_1
    v_smfmac_f32_16x16x64_bf16 v[64:67], v[28:31], a[200:207], v172
    v_smfmac_f32_16x16x64_bf16 v[68:71], v[28:31], a[232:239], v172
    s_waitcnt vmcnt(1)
    v_max3_u32 v19, v32, v33, v34
    v_max_u32 v19, v19, v35
    v_cmp_eq_u32 vcc, -1, v19
    s_nop 0
    s_cbranch_vccnz g_30F12_2
    v_smfmac_f32_16x16x64_bf16 v[64:67], v[32:35], a[208:215], v172
    v_smfmac_f32_16x16x64_bf16 v[68:71], v[32:35], a[240:247], v172
    s_waitcnt vmcnt(0)
    v_max3_u32 v19, v36, v37, v38
    v_max_u32 v19, v19, v39
    v_cmp_eq_u32 vcc, -1, v19
    s_nop 0
    s_cbranch_vccnz g_30F8_3
    v_smfmac_f32_16x16x64_bf16 v[64:67], v[36:39], a[216:223], v172
    v_smfmac_f32_16x16x64_bf16 v[68:71], v[36:39], a[248:255], v172
    s_nop 4
    v_cvt_pk_bf16_f32 v80, v64, v65
    v_cvt_pk_bf16_f32 v81, v66, v67
    s_nop 0
    v_cvt_pk_bf16_f32 v82, v68, v69
    v_cvt_pk_bf16_f32 v83, v70, v71
    ds_write_b128 v17, v[80:83] offset:9216
gc_31:
    s_waitcnt lgkmcnt(0)
    s_barrier
    s_nop 15
    s_nop 15
    s_nop 15
    s_nop 15
    buffer_store_dwordx4 v[128:131], v14, s[4:7], s19 offen sc1
    s_add_u32 s19, s19, 512
    s_mov_b32 s23, s25
fw_32:
    s_cmp_ge_u32 s85, s94
    s_cbranch_scc1 fo_33
    buffer_load_dword v247, v245, s[4:7], 0 offen sc1
    s_add_u32 s23, s23, 1
    s_waitcnt vmcnt(0)
    v_readfirstlane_b32 s85, v247
    s_cmp_lt_u32 s23, 200000
    s_cbranch_scc1 fw_32
    s_mov_b32 s25, 200000
fo_33:
    buffer_load_dwordx4 v[132:135], v12, s[4:7], s17 offen sc1
    buffer_load_dwordx4 v[136:139], v12, s[4:7], s17 offen offset:256 sc1
    s_add_u32 s17, s17, 2048
    s_min_u32 s17, s17, 17954816
    buffer_load_dword v247, v245, s[4:7], 0 offen sc1
    v_mov_b32 v40, 0
    v_mov_b32 v41, 0
    v_mov_b32 v42, 0
    v_mov_b32 v43, 0
    v_mov_b32 v44, 0
    v_mov_b32 v45, 0
    v_mov_b32 v46, 0
    v_mov_b32 v47, 0
    v_mov_b32 v48, 0
    v_mov_b32 v49, 0
    v_mov_b32 v50, 0
    v_mov_b32 v51, 0
    v_mov_b32 v52, 0
    v_mov_b32 v53, 0
    v_mov_b32 v54, 0
    v_mov_b32 v55, 0
    v_mov_b32 v56, 0
    v_mov_b32 v57, 0
    v_mov_b32 v58, 0
    v_mov_b32 v59, 0
    v_mov_b32 v60, 0
    v_mov_b32 v61, 0
    v_mov_b32 v62, 0
    v_mov_b32 v63, 0
    v_mov_b32 v64, 0
    v_mov_b32 v65, 0
    v_mov_b32 v66, 0
    v_mov_b32 v67, 0
    v_mov_b32 v68, 0
    v_mov_b32 v69, 0
    v_mov_b32 v70, 0
    v_mov_b32 v71, 0
    s_mov_b32 s21, s16
    s_mov_b32 s16, s42
    s_mov_b32 s42, s43
    s_mov_b32 s43, s44
    s_mov_b32 s44, s21
    s_add_u32 s95, s95, 524288
    s_lshr_b32 s84, s95, 8
    s_and_b32 s84, s84, 8192
    s_xor_b32 s84, s84, s46
    s_add_u32 s84, s84, s95
    s_add_u32 s15, s15, 1
    s_barrier
    s_branch recur_fast_w0
g_28L15_0:
    s_waitcnt vmcnt(3)
    v_max3_u32 v19, v24, v25, v26
    v_max_u32 v19, v19, v27
    v_cmp_eq_u32 vcc, -1, v19
    s_nop 0
    s_cbranch_vccnz g_28F15_0
    v_smfmac_f32_16x16x64_bf16 v[40:43], v[24:27], a[0:7], v172
    v_smfmac_f32_16x16x64_bf16 v[44:47], v[24:27], a[64:71], v172
    v_smfmac_f32_16x16x64_bf16 v[48:51], v[24:27], a[32:39], v172
    v_smfmac_f32_16x16x64_bf16 v[52:55], v[24:27], a[96:103], v172
g_28L14_1:
    s_waitcnt vmcnt(2)
    v_max3_u32 v19, v28, v29, v30
    v_max_u32 v19, v19, v31
    v_cmp_eq_u32 vcc, -1, v19
    s_nop 0
    s_cbranch_vccnz g_28F14_1
    v_smfmac_f32_16x16x64_bf16 v[40:43], v[28:31], a[8:15], v172
    v_smfmac_f32_16x16x64_bf16 v[44:47], v[28:31], a[72:79], v172
    v_smfmac_f32_16x16x64_bf16 v[48:51], v[28:31], a[40:47], v172
    v_smfmac_f32_16x16x64_bf16 v[52:55], v[28:31], a[104:111], v172
g_28L12_2:
    s_waitcnt vmcnt(1)
    v_max3_u32 v19, v32, v33, v34
    v_max_u32 v19, v19, v35
    v_cmp_eq_u32 vcc, -1, v19
    s_nop 0
    s_cbranch_vccnz g_28F12_2
    v_smfmac_f32_16x16x64_bf16 v[40:43], v[32:35], a[16:23], v172
    v_smfmac_f32_16x16x64_bf16 v[44:47], v[32:35], a[80:87], v172
    v_smfmac_f32_16x16x64_bf16 v[48:51], v[32:35], a[48:55], v172
    v_smfmac_f32_16x16x64_bf16 v[52:55], v[32:35], a[112:119], v172
g_28L8_3:
    s_waitcnt vmcnt(0)
    v_max3_u32 v19, v36, v37, v38
    v_max_u32 v19, v19, v39
    v_cmp_eq_u32 vcc, -1, v19
    s_nop 0
    s_cbranch_vccnz g_28F8_3
    v_smfmac_f32_16x16x64_bf16 v[40:43], v[36:39], a[24:31], v172
    v_smfmac_f32_16x16x64_bf16 v[44:47], v[36:39], a[88:95], v172
    v_smfmac_f32_16x16x64_bf16 v[48:51], v[36:39], a[56:63], v172
    v_smfmac_f32_16x16x64_bf16 v[52:55], v[36:39], a[120:127], v172
    s_branch gc_29
g_28L15_1:
    s_waitcnt vmcnt(3)
    v_max3_u32 v19, v28, v29, v30
    v_max_u32 v19, v19, v31
    v_cmp_eq_u32 vcc, -1, v19
    s_nop 0
    s_cbranch_vccnz g_28F15_1
    v_smfmac_f32_16x16x64_bf16 v[40:43], v[28:31], a[8:15], v172
    v_smfmac_f32_16x16x64_bf16 v[44:47], v[28:31], a[72:79], v172
    v_smfmac_f32_16x16x64_bf16 v[48:51], v[28:31], a[40:47], v172
    v_smfmac_f32_16x16x64_bf16 v[52:55], v[28:31], a[104:111], v172
g_28L13_2:
    s_waitcnt vmcnt(2)
    v_max3_u32 v19, v32, v33, v34
    v_max_u32 v19, v19, v35
    v_cmp_eq_u32 vcc, -1, v19
    s_nop 0
    s_cbranch_vccnz g_28F13_2
    v_smfmac_f32_16x16x64_bf16 v[40:43], v[32:35], a[16:23], v172
    v_smfmac_f32_16x16x64_bf16 v[44:47], v[32:35], a[80:87], v172
    v_smfmac_f32_16x16x64_bf16 v[48:51], v[32:35], a[48:55], v172
    v_smfmac_f32_16x16x64_bf16 v[52:55], v[32:35], a[112:119], v172
g_28L9_3:
    s_waitcnt vmcnt(1)
    v_max3_u32 v19, v36, v37, v38
    v_max_u32 v19, v19, v39
    v_cmp_eq_u32 vcc, -1, v19
    s_nop 0
    s_cbranch_vccnz g_28F9_3
    v_smfmac_f32_16x16x64_bf16 v[40:43], v[36:39], a[24:31], v172
    v_smfmac_f32_16x16x64_bf16 v[44:47], v[36:39], a[88:95], v172
    v_smfmac_f32_16x16x64_bf16 v[48:51], v[36:39], a[56:63], v172
    v_smfmac_f32_16x16x64_bf16 v[52:55], v[36:39], a[120:127], v172
g_28L1_0:
    s_waitcnt vmcnt(0)
    v_max3_u32 v19, v24, v25, v26
    v_max_u32 v19, v19, v27
    v_cmp_eq_u32 vcc, -1, v19
    s_nop 0
    s_cbranch_vccnz g_28F1_0
    v_smfmac_f32_16x16x64_bf16 v[40:43], v[24:27], a[0:7], v172
    v_smfmac_f32_16x16x64_bf16 v[44:47], v[24:27], a[64:71], v172
    v_smfmac_f32_16x16x64_bf16 v[48:51], v[24:27], a[32:39], v172
    v_smfmac_f32_16x16x64_bf16 v[52:55], v[24:27], a[96:103], v172
    s_branch gc_29
g_28L15_2:
    s_waitcnt vmcnt(3)
    v_max3_u32 v19, v32, v33, v34
    v_max_u32 v19, v19, v35
    v_cmp_eq_u32 vcc, -1, v19
    s_nop 0
    s_cbranch_vccnz g_28F15_2
    v_smfmac_f32_16x16x64_bf16 v[40:43], v[32:35], a[16:23], v172
    v_smfmac_f32_16x16x64_bf16 v[44:47], v[32:35], a[80:87], v172
    v_smfmac_f32_16x16x64_bf16 v[48:51], v[32:35], a[48:55], v172
    v_smfmac_f32_16x16x64_bf16 v[52:55], v[32:35], a[112:119], v172
g_28L11_3:
    s_waitcnt vmcnt(2)
    v_max3_u32 v19, v36, v37, v38
    v_max_u32 v19, v19, v39
    v_cmp_eq_u32 vcc, -1, v19
    s_nop 0
    s_cbranch_vccnz g_28F11_3
    v_smfmac_f32_16x16x64_bf16 v[40:43], v[36:39], a[24:31], v172
    v_smfmac_f32_16x16x64_bf16 v[44:47], v[36:39], a[88:95], v172
    v_smfmac_f32_16x16x64_bf16 v[48:51], v[36:39], a[56:63], v172
    v_smfmac_f32_16x16x64_bf16 v[52:55], v[36:39], a[120:127], v172
g_28L3_0:
    s_waitcnt vmcnt(1)
    v_max3_u32 v19, v24, v25, v26
    v_max_u32 v19, v19, v27
    v_cmp_eq_u32 vcc, -1, v19
    s_nop 0
    s_cbranch_vccnz g_28F3_0
    v_smfmac_f32_16x16x64_bf16 v[40:43], v[24:27], a[0:7], v172
    v_smfmac_f32_16x16x64_bf16 v[44:47], v[24:27], a[64:71], v172
    v_smfmac_f32_16x16x64_bf16 v[48:51], v[24:27], a[32:39], v172
    v_smfmac_f32_16x16x64_bf16 v[52:55], v[24:27], a[96:103], v172
g_28L2_1:
    s_waitcnt vmcnt(0)
    v_max3_u32 v19, v28, v29, v30
    v_max_u32 v19, v19, v31
    v_cmp_eq_u32 vcc, -1, v19
    s_nop 0
    s_cbranch_vccnz g_28F2_1
    v_smfmac_f32_16x16x64_bf16 v[40:43], v[28:31], a[8:15], v172
    v_smfmac_f32_16x16x64_bf16 v[44:47], v[28:31], a[72:79], v172
    v_smfmac_f32_16x16x64_bf16 v[48:51], v[28:31], a[40:47], v172
    v_smfmac_f32_16x16x64_bf16 v[52:55], v[28:31], a[104:111], v172
    s_branch gc_29
g_28L15_3:
    s_waitcnt vmcnt(3)
    v_max3_u32 v19, v36, v37, v38
    v_max_u32 v19, v19, v39
    v_cmp_eq_u32 vcc, -1, v19
    s_nop 0
    s_cbranch_vccnz g_28F15_3
    v_smfmac_f32_16x16x64_bf16 v[40:43], v[36:39], a[24:31], v172
    v_smfmac_f32_16x16x64_bf16 v[44:47], v[36:39], a[88:95], v172
    v_smfmac_f32_16x16x64_bf16 v[48:51], v[36:39], a[56:63], v172
    v_smfmac_f32_16x16x64_bf16 v[52:55], v[36:39], a[120:127], v172
g_28L7_0:
    s_waitcnt vmcnt(2)
    v_max3_u32 v19, v24, v25, v26
    v_max_u32 v19, v19, v27
    v_cmp_eq_u32 vcc, -1, v19
    s_nop 0
    s_cbranch_vccnz g_28F7_0
    v_smfmac_f32_16x16x64_bf16 v[40:43], v[24:27], a[0:7], v172
    v_smfmac_f32_16x16x64_bf16 v[44:47], v[24:27], a[64:71], v172
    v_smfmac_f32_16x16x64_bf16 v[48:51], v[24:27], a[32:39], v172
    v_smfmac_f32_16x16x64_bf16 v[52:55], v[24:27], a[96:103], v172
g_28L6_1:
    s_waitcnt vmcnt(1)
    v_max3_u32 v19, v28, v29, v30
    v_max_u32 v19, v19, v31
    v_cmp_eq_u32 vcc, -1, v19
    s_nop 0
    s_cbranch_vccnz g_28F6_1
    v_smfmac_f32_16x16x64_bf16 v[40:43], v[28:31], a[8:15], v172
    v_smfmac_f32_16x16x64_bf16 v[44:47], v[28:31], a[72:79], v172
    v_smfmac_f32_16x16x64_bf16 v[48:51], v[28:31], a[40:47], v172
    v_smfmac_f32_16x16x64_bf16 v[52:55], v[28:31], a[104:111], v172
g_28L4_2:
    s_waitcnt vmcnt(0)
    v_max3_u32 v19, v32, v33, v34
    v_max_u32 v19, v19, v35
    v_cmp_eq_u32 vcc, -1, v19
    s_nop 0
    s_cbranch_vccnz g_28F4_2
    v_smfmac_f32_16x16x64_bf16 v[40:43], v[32:35], a[16:23], v172
    v_smfmac_f32_16x16x64_bf16 v[44:47], v[32:35], a[80:87], v172
    v_smfmac_f32_16x16x64_bf16 v[48:51], v[32:35], a[48:55], v172
    v_smfmac_f32_16x16x64_bf16 v[52:55], v[32:35], a[112:119], v172
    s_branch gc_29
g_28L7_1:
    s_waitcnt vmcnt(2)
    v_max3_u32 v19, v28, v29, v30
    v_max_u32 v19, v19, v31
    v_cmp_eq_u32 vcc, -1, v19
    s_nop 0
    s_cbranch_vccnz g_28F7_1
    v_smfmac_f32_16x16x64_bf16 v[40:43], v[28:31], a[8:15], v172
    v_smfmac_f32_16x16x64_bf16 v[44:47], v[28:31], a[72:79], v172
    v_smfmac_f32_16x16x64_bf16 v[48:51], v[28:31], a[40:47], v172
    v_smfmac_f32_16x16x64_bf16 v[52:55], v[28:31], a[104:111], v172
g_28L5_2:
    s_waitcnt vmcnt(1)
    v_max3_u32 v19, v32, v33, v34
    v_max_u32 v19, v19, v35
    v_cmp_eq_u32 vcc, -1, v19
    s_nop 0
    s_cbranch_vccnz g_28F5_2
    v_smfmac_f32_16x16x64_bf16 v[40:43], v[32:35], a[16:23], v172
    v_smfmac_f32_16x16x64_bf16 v[44:47], v[32:35], a[80:87], v172
    v_smfmac_f32_16x16x64_bf16 v[48:51], v[32:35], a[48:55], v172
    v_smfmac_f32_16x16x64_bf16 v[52:55], v[32:35], a[112:119], v172
    s_branch g_28L1_0
g_28L7_2:
    s_waitcnt vmcnt(2)
    v_max3_u32 v19, v32, v33, v34
    v_max_u32 v19, v19, v35
    v_cmp_eq_u32 vcc, -1, v19
    s_nop 0
    s_cbranch_vccnz g_28F7_2
    v_smfmac_f32_16x16x64_bf16 v[40:43], v[32:35], a[16:23], v172
    v_smfmac_f32_16x16x64_bf16 v[44:47], v[32:35], a[80:87], v172
    v_smfmac_f32_16x16x64_bf16 v[48:51], v[32:35], a[48:55], v172
    v_smfmac_f32_16x16x64_bf16 v[52:55], v[32:35], a[112:119], v172
    s_branch g_28L3_0
g_28L11_0:
    s_waitcnt vmcnt(2)
    v_max3_u32 v19, v24, v25, v26
    v_max_u32 v19, v19, v27
    v_cmp_eq_u32 vcc, -1, v19
    s_nop 0
    s_cbranch_vccnz g_28F11_0
    v_smfmac_f32_16x16x64_bf16 v[40:43], v[24:27], a[0:7], v172
    v_smfmac_f32_16x16x64_bf16 v[44:47], v[24:27], a[64:71], v172
    v_smfmac_f32_16x16x64_bf16 v[48:51], v[24:27], a[32:39], v172
    v_smfmac_f32_16x16x64_bf16 v[52:55], v[24:27], a[96:103], v172
g_28L10_1:
    s_waitcnt vmcnt(1)
    v_max3_u32 v19, v28, v29, v30
    v_max_u32 v19, v19, v31
    v_cmp_eq_u32 vcc, -1, v19
    s_nop 0
    s_cbranch_vccnz g_28F10_1
    v_smfmac_f32_16x16x64_bf16 v[40:43], v[28:31], a[8:15], v172
    v_smfmac_f32_16x16x64_bf16 v[44:47], v[28:31], a[72:79], v172
    v_smfmac_f32_16x16x64_bf16 v[48:51], v[28:31], a[40:47], v172
    v_smfmac_f32_16x16x64_bf16 v[52:55], v[28:31], a[104:111], v172
    s_branch g_28L8_3
g_28L11_1:
    s_waitcnt vmcnt(2)
    v_max3_u32 v19, v28, v29, v30
    v_max_u32 v19, v19, v31
    v_cmp_eq_u32 vcc, -1, v19
    s_nop 0
    s_cbranch_vccnz g_28F11_1
    v_smfmac_f32_16x16x64_bf16 v[40:43], v[28:31], a[8:15], v172
    v_smfmac_f32_16x16x64_bf16 v[44:47], v[28:31], a[72:79], v172
    v_smfmac_f32_16x16x64_bf16 v[48:51], v[28:31], a[40:47], v172
    v_smfmac_f32_16x16x64_bf16 v[52:55], v[28:31], a[104:111], v172
    s_branch g_28L9_3
g_28L13_0:
    s_waitcnt vmcnt(2)
    v_max3_u32 v19, v24, v25, v26
    v_max_u32 v19, v19, v27
    v_cmp_eq_u32 vcc, -1, v19
    s_nop 0
    s_cbranch_vccnz g_28F13_0
    v_smfmac_f32_16x16x64_bf16 v[40:43], v[24:27], a[0:7], v172
    v_smfmac_f32_16x16x64_bf16 v[44:47], v[24:27], a[64:71], v172
    v_smfmac_f32_16x16x64_bf16 v[48:51], v[24:27], a[32:39], v172
    v_smfmac_f32_16x16x64_bf16 v[52:55], v[24:27], a[96:103], v172
    s_branch g_28L12_2
g_28L13_3:
    s_waitcnt vmcnt(2)
    v_max3_u32 v19, v36, v37, v38
    v_max_u32 v19, v19, v39
    v_cmp_eq_u32 vcc, -1, v19
    s_nop 0
    s_cbranch_vccnz g_28F13_3
    v_smfmac_f32_16x16x64_bf16 v[40:43], v[36:39], a[24:31], v172
    v_smfmac_f32_16x16x64_bf16 v[44:47], v[36:39], a[88:95], v172
    v_smfmac_f32_16x16x64_bf16 v[48:51], v[36:39], a[56:63], v172
    v_smfmac_f32_16x16x64_bf16 v[52:55], v[36:39], a[120:127], v172
g_28L5_0:
    s_waitcnt vmcnt(1)
    v_max3_u32 v19, v24, v25, v26
    v_max_u32 v19, v19, v27
    v_cmp_eq_u32 vcc, -1, v19
    s_nop 0
    s_cbranch_vccnz g_28F5_0
    v_smfmac_f32_16x16x64_bf16 v[40:43], v[24:27], a[0:7], v172
    v_smfmac_f32_16x16x64_bf16 v[44:47], v[24:27], a[64:71], v172
    v_smfmac_f32_16x16x64_bf16 v[48:51], v[24:27], a[32:39], v172
    v_smfmac_f32_16x16x64_bf16 v[52:55], v[24:27], a[96:103], v172
    s_branch g_28L4_2
g_28L14_2:
    s_waitcnt vmcnt(2)
    v_max3_u32 v19, v32, v33, v34
    v_max_u32 v19, v19, v35
    v_cmp_eq_u32 vcc, -1, v19
    s_nop 0
    s_cbranch_vccnz g_28F14_2
    v_smfmac_f32_16x16x64_bf16 v[40:43], v[32:35], a[16:23], v172
    v_smfmac_f32_16x16x64_bf16 v[44:47], v[32:35], a[80:87], v172
    v_smfmac_f32_16x16x64_bf16 v[48:51], v[32:35], a[48:55], v172
    v_smfmac_f32_16x16x64_bf16 v[52:55], v[32:35], a[112:119], v172
g_28L10_3:
    s_waitcnt vmcnt(1)
    v_max3_u32 v19, v36, v37, v38
    v_max_u32 v19, v19, v39
    v_cmp_eq_u32 vcc, -1, v19
    s_nop 0
    s_cbranch_vccnz g_28F10_3
    v_smfmac_f32_16x16x64_bf16 v[40:43], v[36:39], a[24:31], v172
    v_smfmac_f32_16x16x64_bf16 v[44:47], v[36:39], a[88:95], v172
    v_smfmac_f32_16x16x64_bf16 v[48:51], v[36:39], a[56:63], v172
    v_smfmac_f32_16x16x64_bf16 v[52:55], v[36:39], a[120:127], v172
    s_branch g_28L2_1
g_28L14_3:
    s_waitcnt vmcnt(2)
    v_max3_u32 v19, v36, v37, v38
    v_max_u32 v19, v19, v39
    v_cmp_eq_u32 vcc, -1, v19
    s_nop 0
    s_cbranch_vccnz g_28F14_3
    v_smfmac_f32_16x16x64_bf16 v[40:43], v[36:39], a[24:31], v172
    v_smfmac_f32_16x16x64_bf16 v[44:47], v[36:39], a[88:95], v172
    v_smfmac_f32_16x16x64_bf16 v[48:51], v[36:39], a[56:63], v172
    v_smfmac_f32_16x16x64_bf16 v[52:55], v[36:39], a[120:127], v172
    s_branch g_28L6_1
g_28L3_1:
    s_waitcnt vmcnt(1)
    v_max3_u32 v19, v28, v29, v30
    v_max_u32 v19, v19, v31
    v_cmp_eq_u32 vcc, -1, v19
    s_nop 0
    s_cbranch_vccnz g_28F3_1
    v_smfmac_f32_16x16x64_bf16 v[40:43], v[28:31], a[8:15], v172
    v_smfmac_f32_16x16x64_bf16 v[44:47], v[28:31], a[72:79], v172
    v_smfmac_f32_16x16x64_bf16 v[48:51], v[28:31], a[40:47], v172
    v_smfmac_f32_16x16x64_bf16 v[52:55], v[28:31], a[104:111], v172
    s_branch g_28L1_0
g_28L6_2:
    s_waitcnt vmcnt(1)
    v_max3_u32 v19, v32, v33, v34
    v_max_u32 v19, v19, v35
    v_cmp_eq_u32 vcc, -1, v19
    s_nop 0
    s_cbranch_vccnz g_28F6_2
    v_smfmac_f32_16x16x64_bf16 v[40:43], v[32:35], a[16:23], v172
    v_smfmac_f32_16x16x64_bf16 v[44:47], v[32:35], a[80:87], v172
    v_smfmac_f32_16x16x64_bf16 v[48:51], v[32:35], a[48:55], v172
    v_smfmac_f32_16x16x64_bf16 v[52:55], v[32:35], a[112:119], v172
    s_branch g_28L2_1
g_28L9_0:
    s_waitcnt vmcnt(1)
    v_max3_u32 v19, v24, v25, v26
    v_max_u32 v19, v19, v27
    v_cmp_eq_u32 vcc, -1, v19
    s_nop 0
    s_cbranch_vccnz g_28F9_0
    v_smfmac_f32_16x16x64_bf16 v[40:43], v[24:27], a[0:7], v172
    v_smfmac_f32_16x16x64_bf16 v[44:47], v[24:27], a[64:71], v172
    v_smfmac_f32_16x16x64_bf16 v[48:51], v[24:27], a[32:39], v172
    v_smfmac_f32_16x16x64_bf16 v[52:55], v[24:27], a[96:103], v172
    s_branch g_28L8_3
g_28L12_3:
    s_waitcnt vmcnt(1)
    v_max3_u32 v19, v36, v37, v38
    v_max_u32 v19, v19, v39
    v_cmp_eq_u32 vcc, -1, v19
    s_nop 0
    s_cbranch_vccnz g_28F12_3
    v_smfmac_f32_16x16x64_bf16 v[40:43], v[36:39], a[24:31], v172
    v_smfmac_f32_16x16x64_bf16 v[44:47], v[36:39], a[88:95], v172
    v_smfmac_f32_16x16x64_bf16 v[48:51], v[36:39], a[56:63], v172
    v_smfmac_f32_16x16x64_bf16 v[52:55], v[36:39], a[120:127], v172
    s_branch g_28L4_2
g_28F15_0:
    s_mov_b64 exec, vcc
    buffer_load_dwordx4 v[24:27], v2, s[4:7], s16 offen offset:0 sc1
    s_mov_b64 exec, -1
    s_add_u32 s23, s23, 1
    s_cmp_lt_u32 s23, 200000
    s_cbranch_scc1 g_28L15_1
    s_mov_b32 s25, 200000
    s_branch gc_29
g_28F15_1:
    s_mov_b64 exec, vcc
    buffer_load_dwordx4 v[28:31], v2, s[4:7], s16 offen offset:1024 sc1
    s_mov_b64 exec, -1
    s_add_u32 s23, s23, 1
    s_cmp_lt_u32 s23, 200000
    s_cbranch_scc1 g_28L15_2
    s_mov_b32 s25, 200000
    s_branch gc_29
g_28F15_2:
    s_mov_b64 exec, vcc
    buffer_load_dwordx4 v[32:35], v2, s[4:7], s16 offen offset:2048 sc1
    s_mov_b64 exec, -1
    s_add_u32 s23, s23, 1
    s_cmp_lt_u32 s23, 200000
    s_cbranch_scc1 g_28L15_3
    s_mov_b32 s25, 200000
    s_branch gc_29
g_28F15_3:
    s_mov_b64 exec, vcc
    buffer_load_dwordx4 v[36:39], v2, s[4:7], s16 offen offset:3072 sc1
    s_mov_b64 exec, -1
    s_add_u32 s23, s23, 1
    s_cmp_lt_u32 s23, 200000
    s_cbranch_scc1 g_28L15_0
    s_mov_b32 s25, 200000
    s_branch gc_29
g_28F7_0:
    s_mov_b64 exec, vcc
    buffer_load_dwordx4 v[24:27], v2, s[4:7], s16 offen offset:0 sc1
    s_mov_b64 exec, -1
    s_add_u32 s23, s23, 1
    s_cmp_lt_u32 s23, 200000
    s_cbranch_scc1 g_28L7_1
    s_mov_b32 s25, 200000
    s_branch gc_29
g_28F7_1:
    s_mov_b64 exec, vcc
    buffer_load_dwordx4 v[28:31], v2, s[4:7], s16 offen offset:1024 sc1
    s_mov_b64 exec, -1
    s_add_u32 s23, s23, 1
    s_cmp_lt_u32 s23, 200000
    s_cbranch_scc1 g_28L7_2
    s_mov_b32 s25, 200000
    s_branch gc_29
g_28F7_2:
    s_mov_b64 exec, vcc
    buffer_load_dwordx4 v[32:35], v2, s[4:7], s16 offen offset:2048 sc1
    s_mov_b64 exec, -1
    s_add_u32 s23, s23, 1
    s_cmp_lt_u32 s23, 200000
    s_cbranch_scc1 g_28L7_0
    s_mov_b32 s25, 200000
    s_branch gc_29
g_28F11_0:
    s_mov_b64 exec, vcc
    buffer_load_dwordx4 v[24:27], v2, s[4:7], s16 offen offset:0 sc1
    s_mov_b64 exec, -1
    s_add_u32 s23, s23, 1
    s_cmp_lt_u32 s23, 200000
    s_cbranch_scc1 g_28L11_1
    s_mov_b32 s25, 200000
    s_branch gc_29
g_28F11_1:
    s_mov_b64 exec, vcc
    buffer_load_dwordx4 v[28:31], v2, s[4:7], s16 offen offset:1024 sc1
    s_mov_b64 exec, -1
    s_add_u32 s23, s23, 1
    s_cmp_lt_u32 s23, 200000
    s_cbranch_scc1 g_28L11_3
    s_mov_b32 s25, 200000
    s_branch gc_29
g_28F11_3:
    s_mov_b64 exec, vcc
    buffer_load_dwordx4 v[36:39], v2, s[4:7], s16 offen offset:3072 sc1
    s_mov_b64 exec, -1
    s_add_u32 s23, s23, 1
    s_cmp_lt_u32 s23, 200000
    s_cbranch_scc1 g_28L11_0
    s_mov_b32 s25, 200000
    s_branch gc_29
g_28F13_0:
    s_mov_b64 exec, vcc
    buffer_load_dwordx4 v[24:27], v2, s[4:7], s16 offen offset:0 sc1
    s_mov_b64 exec, -1
    s_add_u32 s23, s23, 1
    s_cmp_lt_u32 s23, 200000
    s_cbranch_scc1 g_28L13_2
    s_mov_b32 s25, 200000
    s_branch gc_29
g_28F13_2:
    s_mov_b64 exec, vcc
    buffer_load_dwordx4 v[32:35], v2, s[4:7], s16 offen offset:2048 sc1
    s_mov_b64 exec, -1
    s_add_u32 s23, s23, 1
    s_cmp_lt_u32 s23, 200000
    s_cbranch_scc1 g_28L13_3
    s_mov_b32 s25, 200000
    s_branch gc_29
g_28F13_3:
    s_mov_b64 exec, vcc
    buffer_load_dwordx4 v[36:39], v2, s[4:7], s16 offen offset:3072 sc1
    s_mov_b64 exec, -1
    s_add_u32 s23, s23, 1
    s_cmp_lt_u32 s23, 200000
    s_cbranch_scc1 g_28L13_0
    s_mov_b32 s25, 200000
    s_branch gc_29
g_28F14_1:
    s_mov_b64 exec, vcc
    buffer_load_dwordx4 v[28:31], v2, s[4:7], s16 offen offset:1024 sc1
    s_mov_b64 exec, -1
    s_add_u32 s23, s23, 1
    s_cmp_lt_u32 s23, 200000
    s_cbranch_scc1 g_28L14_2
    s_mov_b32 s25, 200000
    s_branch gc_29
g_28F14_2:
    s_mov_b64 exec, vcc
    buffer_load_dwordx4 v[32:35], v2, s[4:7], s16 offen offset:2048 sc1
    s_mov_b64 exec, -1
    s_add_u32 s23, s23, 1
    s_cmp_lt_u32 s23, 200000
    s_cbranch_scc1 g_28L14_3
    s_mov_b32 s25, 200000
    s_branch gc_29
g_28F14_3:
    s_mov_b64 exec, vcc
    buffer_load_dwordx4 v[36:39], v2, s[4:7], s16 offen offset:3072 sc1
    s_mov_b64 exec, -1
    s_add_u32 s23, s23, 1
    s_cmp_lt_u32 s23, 200000
    s_cbranch_scc1 g_28L14_1
    s_mov_b32 s25, 200000
    s_branch gc_29
g_28F3_0:
    s_mov_b64 exec, vcc
    buffer_load_dwordx4 v[24:27], v2, s[4:7], s16 offen offset:0 sc1
    s_mov_b64 exec, -1
    s_add_u32 s23, s23, 1
    s_cmp_lt_u32 s23, 200000
    s_cbranch_scc1 g_28L3_1
    s_mov_b32 s25, 200000
    s_branch gc_29
g_28F3_1:
    s_mov_b64 exec, vcc
    buffer_load_dwordx4 v[28:31], v2, s[4:7], s16 offen offset:1024 sc1
    s_mov_b64 exec, -1
    s_add_u32 s23, s23, 1
    s_cmp_lt_u32 s23, 200000
    s_cbranch_scc1 g_28L3_0
    s_mov_b32 s25, 200000
    s_branch gc_29
g_28F5_0:
    s_mov_b64 exec, vcc
    buffer_load_dwordx4 v[24:27], v2, s[4:7], s16 offen offset:0 sc1
    s_mov_b64 exec, -1
    s_add_u32 s23, s23, 1
    s_cmp_lt_u32 s23, 200000
    s_cbranch_scc1 g_28L5_2
    s_mov_b32 s25, 200000
    s_branch gc_29
g_28F5_2:
    s_mov_b64 exec, vcc
    buffer_load_dwordx4 v[32:35], v2, s[4:7], s16 offen offset:2048 sc1
    s_mov_b64 exec, -1
    s_add_u32 s23, s23, 1
    s_cmp_lt_u32 s23, 200000
    s_cbranch_scc1 g_28L5_0
    s_mov_b32 s25, 200000
    s_branch gc_29
g_28F6_1:
    s_mov_b64 exec, vcc
    buffer_load_dwordx4 v[28:31], v2, s[4:7], s16 offen offset:1024 sc1
    s_mov_b64 exec, -1
    s_add_u32 s23, s23, 1
    s_cmp_lt_u32 s23, 200000
    s_cbranch_scc1 g_28L6_2
    s_mov_b32 s25, 200000
    s_branch gc_29
g_28F6_2:
    s_mov_b64 exec, vcc
    buffer_load_dwordx4 v[32:35], v2, s[4:7], s16 offen offset:2048 sc1
    s_mov_b64 exec, -1
    s_add_u32 s23, s23, 1
    s_cmp_lt_u32 s23, 200000
    s_cbranch_scc1 g_28L6_1
    s_mov_b32 s25, 200000
    s_branch gc_29
g_28F9_0:
    s_mov_b64 exec, vcc
    buffer_load_dwordx4 v[24:27], v2, s[4:7], s16 offen offset:0 sc1
    s_mov_b64 exec, -1
    s_add_u32 s23, s23, 1
    s_cmp_lt_u32 s23, 200000
    s_cbranch_scc1 g_28L9_3
    s_mov_b32 s25, 200000
    s_branch gc_29
g_28F9_3:
    s_mov_b64 exec, vcc
    buffer_load_dwordx4 v[36:39], v2, s[4:7], s16 offen offset:3072 sc1
    s_mov_b64 exec, -1
    s_add_u32 s23, s23, 1
    s_cmp_lt_u32 s23, 200000
    s_cbranch_scc1 g_28L9_0
    s_mov_b32 s25, 200000
    s_branch gc_29
g_28F10_1:
    s_mov_b64 exec, vcc
    buffer_load_dwordx4 v[28:31], v2, s[4:7], s16 offen offset:1024 sc1
    s_mov_b64 exec, -1
    s_add_u32 s23, s23, 1
    s_cmp_lt_u32 s23, 200000
    s_cbranch_scc1 g_28L10_3
    s_mov_b32 s25, 200000
    s_branch gc_29
g_28F10_3:
    s_mov_b64 exec, vcc
    buffer_load_dwordx4 v[36:39], v2, s[4:7], s16 offen offset:3072 sc1
    s_mov_b64 exec, -1
    s_add_u32 s23, s23, 1
    s_cmp_lt_u32 s23, 200000
    s_cbranch_scc1 g_28L10_1
    s_mov_b32 s25, 200000
    s_branch gc_29
g_28F12_2:
    s_mov_b64 exec, vcc
    buffer_load_dwordx4 v[32:35], v2, s[4:7], s16 offen offset:2048 sc1
    s_mov_b64 exec, -1
    s_add_u32 s23, s23, 1
    s_cmp_lt_u32 s23, 200000
    s_cbranch_scc1 g_28L12_3
    s_mov_b32 s25, 200000
    s_branch gc_29
g_28F12_3:
    s_mov_b64 exec, vcc
    buffer_load_dwordx4 v[36:39], v2, s[4:7], s16 offen offset:3072 sc1
    s_mov_b64 exec, -1
    s_add_u32 s23, s23, 1
    s_cmp_lt_u32 s23, 200000
    s_cbranch_scc1 g_28L12_2
    s_mov_b32 s25, 200000
    s_branch gc_29
g_28F1_0:
    s_mov_b64 exec, vcc
    buffer_load_dwordx4 v[24:27], v2, s[4:7], s16 offen offset:0 sc1
    s_mov_b64 exec, -1
    s_add_u32 s23, s23, 1
    s_cmp_lt_u32 s23, 200000
    s_cbranch_scc1 g_28L1_0
    s_mov_b32 s25, 200000
    s_branch gc_29
g_28F2_1:
    s_mov_b64 exec, vcc
    buffer_load_dwordx4 v[28:31], v2, s[4:7], s16 offen offset:1024 sc1
    s_mov_b64 exec, -1
    s_add_u32 s23, s23, 1
    s_cmp_lt_u32 s23, 200000
    s_cbranch_scc1 g_28L2_1
    s_mov_b32 s25, 200000
    s_branch gc_29
g_28F4_2:
    s_mov_b64 exec, vcc
    buffer_load_dwordx4 v[32:35], v2, s[4:7], s16 offen offset:2048 sc1
    s_mov_b64 exec, -1
    s_add_u32 s23, s23, 1
    s_cmp_lt_u32 s23, 200000
    s_cbranch_scc1 g_28L4_2
    s_mov_b32 s25, 200000
    s_branch gc_29
g_28F8_3:
    s_mov_b64 exec, vcc
    buffer_load_dwordx4 v[36:39], v2, s[4:7], s16 offen offset:3072 sc1
    s_mov_b64 exec, -1
    s_add_u32 s23, s23, 1
    s_cmp_lt_u32 s23, 200000
    s_cbranch_scc1 g_28L8_3
    s_mov_b32 s25, 200000
    s_branch gc_29
recur_fast_last0:
    buffer_store_dwordx4 v[128:131], v14, s[4:7], s19 offen sc1
    s_waitcnt vmcnt(0)
    s_branch recur_end
g_30L15_0:
    s_waitcnt vmcnt(3)
    v_max3_u32 v19, v24, v25, v26
    v_max_u32 v19, v19, v27
    v_cmp_eq_u32 vcc, -1, v19
    s_nop 0
    s_cbranch_vccnz g_30F15_0
    v_smfmac_f32_16x16x64_bf16 v[64:67], v[24:27], a[192:199], v172
    v_smfmac_f32_16x16x64_bf16 v[68:71], v[24:27], a[224:231], v172
g_30L14_1:
    s_waitcnt vmcnt(2)
    v_max3_u32 v19, v28, v29, v30
    v_max_u32 v19, v19, v31
    v_cmp_eq_u32 vcc, -1, v19
    s_nop 0
    s_cbranch_vccnz g_30F14_1
    v_smfmac_f32_16x16x64_bf16 v[64:67], v[28:31], a[200:207], v172
    v_smfmac_f32_16x16x64_bf16 v[68:71], v[28:31], a[232:239], v172
g_30L12_2:
    s_waitcnt vmcnt(1)
    v_max3_u32 v19, v32, v33, v34
    v_max_u32 v19, v19, v35
    v_cmp_eq_u32 vcc, -1, v19
    s_nop 0
    s_cbranch_vccnz g_30F12_2
    v_smfmac_f32_16x16x64_bf16 v[64:67], v[32:35], a[208:215], v172
    v_smfmac_f32_16x16x64_bf16 v[68:71], v[32:35], a[240:247], v172
g_30L8_3:
    s_waitcnt vmcnt(0)
    v_max3_u32 v19, v36, v37, v38
    v_max_u32 v19, v19, v39
    v_cmp_eq_u32 vcc, -1, v19
    s_nop 0
    s_cbranch_vccnz g_30F8_3
    v_smfmac_f32_16x16x64_bf16 v[64:67], v[36:39], a[216:223], v172
    v_smfmac_f32_16x16x64_bf16 v[68:71], v[36:39], a[248:255], v172
    s_nop 4
    v_cvt_pk_bf16_f32 v80, v64, v65
    v_cvt_pk_bf16_f32 v81, v66, v67
    s_nop 0
    v_cvt_pk_bf16_f32 v82, v68, v69
    v_cvt_pk_bf16_f32 v83, v70, v71
    ds_write_b128 v17, v[80:83] offset:9216
    s_branch gc_31
g_30L15_1:
    s_waitcnt vmcnt(3)
    v_max3_u32 v19, v28, v29, v30
    v_max_u32 v19, v19, v31
    v_cmp_eq_u32 vcc, -1, v19
    s_nop 0
    s_cbranch_vccnz g_30F15_1
    v_smfmac_f32_16x16x64_bf16 v[64:67], v[28:31], a[200:207], v172
    v_smfmac_f32_16x16x64_bf16 v[68:71], v[28:31], a[232:239], v172
g_30L13_2:
    s_waitcnt vmcnt(2)
    v_max3_u32 v19, v32, v33, v34
    v_max_u32 v19, v19, v35
    v_cmp_eq_u32 vcc, -1, v19
    s_nop 0
    s_cbranch_vccnz g_30F13_2
    v_smfmac_f32_16x16x64_bf16 v[64:67], v[32:35], a[208:215], v172
    v_smfmac_f32_16x16x64_bf16 v[68:71], v[32:35], a[240:247], v172
g_30L9_3:
    s_waitcnt vmcnt(1)
    v_max3_u32 v19, v36, v37, v38
    v_max_u32 v19, v19, v39
    v_cmp_eq_u32 vcc, -1, v19
    s_nop 0
    s_cbranch_vccnz g_30F9_3
    v_smfmac_f32_16x16x64_bf16 v[64:67], v[36:39], a[216:223], v172
    v_smfmac_f32_16x16x64_bf16 v[68:71], v[36:39], a[248:255], v172
g_30L1_0:
    s_waitcnt vmcnt(0)
    v_max3_u32 v19, v24, v25, v26
    v_max_u32 v19, v19, v27
    v_cmp_eq_u32 vcc, -1, v19
    s_nop 0
    s_cbranch_vccnz g_30F1_0
    v_smfmac_f32_16x16x64_bf16 v[64:67], v[24:27], a[192:199], v172
    v_smfmac_f32_16x16x64_bf16 v[68:71], v[24:27], a[224:231], v172
    s_nop 4
    v_cvt_pk_bf16_f32 v80, v64, v65
    v_cvt_pk_bf16_f32 v81, v66, v67
    s_nop 0
    v_cvt_pk_bf16_f32 v82, v68, v69
    v_cvt_pk_bf16_f32 v83, v70, v71
    ds_write_b128 v17, v[80:83] offset:9216
    s_branch gc_31
g_30L15_2:
    s_waitcnt vmcnt(3)
    v_max3_u32 v19, v32, v33, v34
    v_max_u32 v19, v19, v35
    v_cmp_eq_u32 vcc, -1, v19
    s_nop 0
    s_cbranch_vccnz g_30F15_2
    v_smfmac_f32_16x16x64_bf16 v[64:67], v[32:35], a[208:215], v172
    v_smfmac_f32_16x16x64_bf16 v[68:71], v[32:35], a[240:247], v172
g_30L11_3:
    s_waitcnt vmcnt(2)
    v_max3_u32 v19, v36, v37, v38
    v_max_u32 v19, v19, v39
    v_cmp_eq_u32 vcc, -1, v19
    s_nop 0
    s_cbranch_vccnz g_30F11_3
    v_smfmac_f32_16x16x64_bf16 v[64:67], v[36:39], a[216:223], v172
    v_smfmac_f32_16x16x64_bf16 v[68:71], v[36:39], a[248:255], v172
g_30L3_0:
    s_waitcnt vmcnt(1)
    v_max3_u32 v19, v24, v25, v26
    v_max_u32 v19, v19, v27
    v_cmp_eq_u32 vcc, -1, v19
    s_nop 0
    s_cbranch_vccnz g_30F3_0
    v_smfmac_f32_16x16x64_bf16 v[64:67], v[24:27], a[192:199], v172
    v_smfmac_f32_16x16x64_bf16 v[68:71], v[24:27], a[224:231], v172
g_30L2_1:
    s_waitcnt vmcnt(0)
    v_max3_u32 v19, v28, v29, v30
    v_max_u32 v19, v19, v31
    v_cmp_eq_u32 vcc, -1, v19
    s_nop 0
    s_cbranch_vccnz g_30F2_1
    v_smfmac_f32_16x16x64_bf16 v[64:67], v[28:31], a[200:207], v172
    v_smfmac_f32_16x16x64_bf16 v[68:71], v[28:31], a[232:239], v172
    s_nop 4
    v_cvt_pk_bf16_f32 v80, v64, v65
    v_cvt_pk_bf16_f32 v81, v66, v67
    s_nop 0
    v_cvt_pk_bf16_f32 v82, v68, v69
    v_cvt_pk_bf16_f32 v83, v70, v71
    ds_write_b128 v17, v[80:83] offset:9216
    s_branch gc_31
g_30L15_3:
    s_waitcnt vmcnt(3)
    v_max3_u32 v19, v36, v37, v38
    v_max_u32 v19, v19, v39
    v_cmp_eq_u32 vcc, -1, v19
    s_nop 0
    s_cbranch_vccnz g_30F15_3
    v_smfmac_f32_16x16x64_bf16 v[64:67], v[36:39], a[216:223], v172
    v_smfmac_f32_16x16x64_bf16 v[68:71], v[36:39], a[248:255], v172
g_30L7_0:
    s_waitcnt vmcnt(2)
    v_max3_u32 v19, v24, v25, v26
    v_max_u32 v19, v19, v27
    v_cmp_eq_u32 vcc, -1, v19
    s_nop 0
    s_cbranch_vccnz g_30F7_0
    v_smfmac_f32_16x16x64_bf16 v[64:67], v[24:27], a[192:199], v172
    v_smfmac_f32_16x16x64_bf16 v[68:71], v[24:27], a[224:231], v172
g_30L6_1:
    s_waitcnt vmcnt(1)
    v_max3_u32 v19, v28, v29, v30
    v_max_u32 v19, v19, v31
    v_cmp_eq_u32 vcc, -1, v19
    s_nop 0
    s_cbranch_vccnz g_30F6_1
    v_smfmac_f32_16x16x64_bf16 v[64:67], v[28:31], a[200:207], v172
    v_smfmac_f32_16x16x64_bf16 v[68:71], v[28:31], a[232:239], v172
g_30L4_2:
    s_waitcnt vmcnt(0)
    v_max3_u32 v19, v32, v33, v34
    v_max_u32 v19, v19, v35
    v_cmp_eq_u32 vcc, -1, v19
    s_nop 0
    s_cbranch_vccnz g_30F4_2
    v_smfmac_f32_16x16x64_bf16 v[64:67], v[32:35], a[208:215], v172
    v_smfmac_f32_16x16x64_bf16 v[68:71], v[32:35], a[240:247], v172
    s_nop 4
    v_cvt_pk_bf16_f32 v80, v64, v65
    v_cvt_pk_bf16_f32 v81, v66, v67
    s_nop 0
    v_cvt_pk_bf16_f32 v82, v68, v69
    v_cvt_pk_bf16_f32 v83, v70, v71
    ds_write_b128 v17, v[80:83] offset:9216
    s_branch gc_31
g_30L7_1:
    s_waitcnt vmcnt(2)
    v_max3_u32 v19, v28, v29, v30
    v_max_u32 v19, v19, v31
    v_cmp_eq_u32 vcc, -1, v19
    s_nop 0
    s_cbranch_vccnz g_30F7_1
    v_smfmac_f32_16x16x64_bf16 v[64:67], v[28:31], a[200:207], v172
    v_smfmac_f32_16x16x64_bf16 v[68:71], v[28:31], a[232:239], v172
g_30L5_2:
    s_waitcnt vmcnt(1)
    v_max3_u32 v19, v32, v33, v34
    v_max_u32 v19, v19, v35
    v_cmp_eq_u32 vcc, -1, v19
    s_nop 0
    s_cbranch_vccnz g_30F5_2
    v_smfmac_f32_16x16x64_bf16 v[64:67], v[32:35], a[208:215], v172
    v_smfmac_f32_16x16x64_bf16 v[68:71], v[32:35], a[240:247], v172
    s_branch g_30L1_0
g_30L7_2:
    s_waitcnt vmcnt(2)
    v_max3_u32 v19, v32, v33, v34
    v_max_u32 v19, v19, v35
    v_cmp_eq_u32 vcc, -1, v19
    s_nop 0
    s_cbranch_vccnz g_30F7_2
    v_smfmac_f32_16x16x64_bf16 v[64:67], v[32:35], a[208:215], v172
    v_smfmac_f32_16x16x64_bf16 v[68:71], v[32:35], a[240:247], v172
    s_branch g_30L3_0
g_30L11_0:
    s_waitcnt vmcnt(2)
    v_max3_u32 v19, v24, v25, v26
    v_max_u32 v19, v19, v27
    v_cmp_eq_u32 vcc, -1, v19
    s_nop 0
    s_cbranch_vccnz g_30F11_0
    v_smfmac_f32_16x16x64_bf16 v[64:67], v[24:27], a[192:199], v172
    v_smfmac_f32_16x16x64_bf16 v[68:71], v[24:27], a[224:231], v172
g_30L10_1:
    s_waitcnt vmcnt(1)
    v_max3_u32 v19, v28, v29, v30
    v_max_u32 v19, v19, v31
    v_cmp_eq_u32 vcc, -1, v19
    s_nop 0
    s_cbranch_vccnz g_30F10_1
    v_smfmac_f32_16x16x64_bf16 v[64:67], v[28:31], a[200:207], v172
    v_smfmac_f32_16x16x64_bf16 v[68:71], v[28:31], a[232:239], v172
    s_branch g_30L8_3
g_30L11_1:
    s_waitcnt vmcnt(2)
    v_max3_u32 v19, v28, v29, v30
    v_max_u32 v19, v19, v31
    v_cmp_eq_u32 vcc, -1, v19
    s_nop 0
    s_cbranch_vccnz g_30F11_1
    v_smfmac_f32_16x16x64_bf16 v[64:67], v[28:31], a[200:207], v172
    v_smfmac_f32_16x16x64_bf16 v[68:71], v[28:31], a[232:239], v172
    s_branch g_30L9_3
g_30L13_0:
    s_waitcnt vmcnt(2)
    v_max3_u32 v19, v24, v25, v26
    v_max_u32 v19, v19, v27
    v_cmp_eq_u32 vcc, -1, v19
    s_nop 0
    s_cbranch_vccnz g_30F13_0
    v_smfmac_f32_16x16x64_bf16 v[64:67], v[24:27], a[192:199], v172
    v_smfmac_f32_16x16x64_bf16 v[68:71], v[24:27], a[224:231], v172
    s_branch g_30L12_2
g_30L13_3:
    s_waitcnt vmcnt(2)
    v_max3_u32 v19, v36, v37, v38
    v_max_u32 v19, v19, v39
    v_cmp_eq_u32 vcc, -1, v19
    s_nop 0
    s_cbranch_vccnz g_30F13_3
    v_smfmac_f32_16x16x64_bf16 v[64:67], v[36:39], a[216:223], v172
    v_smfmac_f32_16x16x64_bf16 v[68:71], v[36:39], a[248:255], v172
g_30L5_0:
    s_waitcnt vmcnt(1)
    v_max3_u32 v19, v24, v25, v26
    v_max_u32 v19, v19, v27
    v_cmp_eq_u32 vcc, -1, v19
    s_nop 0
    s_cbranch_vccnz g_30F5_0
    v_smfmac_f32_16x16x64_bf16 v[64:67], v[24:27], a[192:199], v172
    v_smfmac_f32_16x16x64_bf16 v[68:71], v[24:27], a[224:231], v172
    s_branch g_30L4_2
g_30L14_2:
    s_waitcnt vmcnt(2)
    v_max3_u32 v19, v32, v33, v34
    v_max_u32 v19, v19, v35
    v_cmp_eq_u32 vcc, -1, v19
    s_nop 0
    s_cbranch_vccnz g_30F14_2
    v_smfmac_f32_16x16x64_bf16 v[64:67], v[32:35], a[208:215], v172
    v_smfmac_f32_16x16x64_bf16 v[68:71], v[32:35], a[240:247], v172
g_30L10_3:
    s_waitcnt vmcnt(1)
    v_max3_u32 v19, v36, v37, v38
    v_max_u32 v19, v19, v39
    v_cmp_eq_u32 vcc, -1, v19
    s_nop 0
    s_cbranch_vccnz g_30F10_3
    v_smfmac_f32_16x16x64_bf16 v[64:67], v[36:39], a[216:223], v172
    v_smfmac_f32_16x16x64_bf16 v[68:71], v[36:39], a[248:255], v172
    s_branch g_30L2_1
g_30L14_3:
    s_waitcnt vmcnt(2)
    v_max3_u32 v19, v36, v37, v38
    v_max_u32 v19, v19, v39
    v_cmp_eq_u32 vcc, -1, v19
    s_nop 0
    s_cbranch_vccnz g_30F14_3
    v_smfmac_f32_16x16x64_bf16 v[64:67], v[36:39], a[216:223], v172
    v_smfmac_f32_16x16x64_bf16 v[68:71], v[36:39], a[248:255], v172
    s_branch g_30L6_1
g_30L3_1:
    s_waitcnt vmcnt(1)
    v_max3_u32 v19, v28, v29, v30
    v_max_u32 v19, v19, v31
    v_cmp_eq_u32 vcc, -1, v19
    s_nop 0
    s_cbranch_vccnz g_30F3_1
    v_smfmac_f32_16x16x64_bf16 v[64:67], v[28:31], a[200:207], v172
    v_smfmac_f32_16x16x64_bf16 v[68:71], v[28:31], a[232:239], v172
    s_branch g_30L1_0
g_30L6_2:
    s_waitcnt vmcnt(1)
    v_max3_u32 v19, v32, v33, v34
    v_max_u32 v19, v19, v35
    v_cmp_eq_u32 vcc, -1, v19
    s_nop 0
    s_cbranch_vccnz g_30F6_2
    v_smfmac_f32_16x16x64_bf16 v[64:67], v[32:35], a[208:215], v172
    v_smfmac_f32_16x16x64_bf16 v[68:71], v[32:35], a[240:247], v172
    s_branch g_30L2_1
g_30L9_0:
    s_waitcnt vmcnt(1)
    v_max3_u32 v19, v24, v25, v26
    v_max_u32 v19, v19, v27
    v_cmp_eq_u32 vcc, -1, v19
    s_nop 0
    s_cbranch_vccnz g_30F9_0
    v_smfmac_f32_16x16x64_bf16 v[64:67], v[24:27], a[192:199], v172
    v_smfmac_f32_16x16x64_bf16 v[68:71], v[24:27], a[224:231], v172
    s_branch g_30L8_3
g_30L12_3:
    s_waitcnt vmcnt(1)
    v_max3_u32 v19, v36, v37, v38
    v_max_u32 v19, v19, v39
    v_cmp_eq_u32 vcc, -1, v19
    s_nop 0
    s_cbranch_vccnz g_30F12_3
    v_smfmac_f32_16x16x64_bf16 v[64:67], v[36:39], a[216:223], v172
    v_smfmac_f32_16x16x64_bf16 v[68:71], v[36:39], a[248:255], v172
    s_branch g_30L4_2
g_30F15_0:
    s_mov_b64 exec, vcc
    buffer_load_dwordx4 v[24:27], v8, s[4:7], s16 offen offset:0 sc1
    s_mov_b64 exec, -1
    s_add_u32 s23, s23, 1
    s_cmp_lt_u32 s23, 200000
    s_cbranch_scc1 g_30L15_1
    s_mov_b32 s25, 200000
    s_branch gc_31
g_30F15_1:
    s_mov_b64 exec, vcc
    buffer_load_dwordx4 v[28:31], v8, s[4:7], s16 offen offset:1024 sc1
    s_mov_b64 exec, -1
    s_add_u32 s23, s23, 1
    s_cmp_lt_u32 s23, 200000
    s_cbranch_scc1 g_30L15_2
    s_mov_b32 s25, 200000
    s_branch gc_31
g_30F15_2:
    s_mov_b64 exec, vcc
    buffer_load_dwordx4 v[32:35], v8, s[4:7], s16 offen offset:2048 sc1
    s_mov_b64 exec, -1
    s_add_u32 s23, s23, 1
    s_cmp_lt_u32 s23, 200000
    s_cbranch_scc1 g_30L15_3
    s_mov_b32 s25, 200000
    s_branch gc_31
g_30F15_3:
    s_mov_b64 exec, vcc
    buffer_load_dwordx4 v[36:39], v8, s[4:7], s16 offen offset:3072 sc1
    s_mov_b64 exec, -1
    s_add_u32 s23, s23, 1
    s_cmp_lt_u32 s23, 200000
    s_cbranch_scc1 g_30L15_0
    s_mov_b32 s25, 200000
    s_branch gc_31
g_30F7_0:
    s_mov_b64 exec, vcc
    buffer_load_dwordx4 v[24:27], v8, s[4:7], s16 offen offset:0 sc1
    s_mov_b64 exec, -1
    s_add_u32 s23, s23, 1
    s_cmp_lt_u32 s23, 200000
    s_cbranch_scc1 g_30L7_1
    s_mov_b32 s25, 200000
    s_branch gc_31
g_30F7_1:
    s_mov_b64 exec, vcc
    buffer_load_dwordx4 v[28:31], v8, s[4:7], s16 offen offset:1024 sc1
    s_mov_b64 exec, -1
    s_add_u32 s23, s23, 1
    s_cmp_lt_u32 s23, 200000
    s_cbranch_scc1 g_30L7_2
    s_mov_b32 s25, 200000
    s_branch gc_31
g_30F7_2:
    s_mov_b64 exec, vcc
    buffer_load_dwordx4 v[32:35], v8, s[4:7], s16 offen offset:2048 sc1
    s_mov_b64 exec, -1
    s_add_u32 s23, s23, 1
    s_cmp_lt_u32 s23, 200000
    s_cbranch_scc1 g_30L7_0
    s_mov_b32 s25, 200000
    s_branch gc_31
g_30F11_0:
    s_mov_b64 exec, vcc
    buffer_load_dwordx4 v[24:27], v8, s[4:7], s16 offen offset:0 sc1
    s_mov_b64 exec, -1
    s_add_u32 s23, s23, 1
    s_cmp_lt_u32 s23, 200000
    s_cbranch_scc1 g_30L11_1
    s_mov_b32 s25, 200000
    s_branch gc_31
g_30F11_1:
    s_mov_b64 exec, vcc
    buffer_load_dwordx4 v[28:31], v8, s[4:7], s16 offen offset:1024 sc1
    s_mov_b64 exec, -1
    s_add_u32 s23, s23, 1
    s_cmp_lt_u32 s23, 200000
    s_cbranch_scc1 g_30L11_3
    s_mov_b32 s25, 200000
    s_branch gc_31
g_30F11_3:
    s_mov_b64 exec, vcc
    buffer_load_dwordx4 v[36:39], v8, s[4:7], s16 offen offset:3072 sc1
    s_mov_b64 exec, -1
    s_add_u32 s23, s23, 1
    s_cmp_lt_u32 s23, 200000
    s_cbranch_scc1 g_30L11_0
    s_mov_b32 s25, 200000
    s_branch gc_31
g_30F13_0:
    s_mov_b64 exec, vcc
    buffer_load_dwordx4 v[24:27], v8, s[4:7], s16 offen offset:0 sc1
    s_mov_b64 exec, -1
    s_add_u32 s23, s23, 1
    s_cmp_lt_u32 s23, 200000
    s_cbranch_scc1 g_30L13_2
    s_mov_b32 s25, 200000
    s_branch gc_31
g_30F13_2:
    s_mov_b64 exec, vcc
    buffer_load_dwordx4 v[32:35], v8, s[4:7], s16 offen offset:2048 sc1
    s_mov_b64 exec, -1
    s_add_u32 s23, s23, 1
    s_cmp_lt_u32 s23, 200000
    s_cbranch_scc1 g_30L13_3
    s_mov_b32 s25, 200000
    s_branch gc_31
g_30F13_3:
    s_mov_b64 exec, vcc
    buffer_load_dwordx4 v[36:39], v8, s[4:7], s16 offen offset:3072 sc1
    s_mov_b64 exec, -1
    s_add_u32 s23, s23, 1
    s_cmp_lt_u32 s23, 200000
    s_cbranch_scc1 g_30L13_0
    s_mov_b32 s25, 200000
    s_branch gc_31
g_30F14_1:
    s_mov_b64 exec, vcc
    buffer_load_dwordx4 v[28:31], v8, s[4:7], s16 offen offset:1024 sc1
    s_mov_b64 exec, -1
    s_add_u32 s23, s23, 1
    s_cmp_lt_u32 s23, 200000
    s_cbranch_scc1 g_30L14_2
    s_mov_b32 s25, 200000
    s_branch gc_31
g_30F14_2:
    s_mov_b64 exec, vcc
    buffer_load_dwordx4 v[32:35], v8, s[4:7], s16 offen offset:2048 sc1
    s_mov_b64 exec, -1
    s_add_u32 s23, s23, 1
    s_cmp_lt_u32 s23, 200000
    s_cbranch_scc1 g_30L14_3
    s_mov_b32 s25, 200000
    s_branch gc_31
g_30F14_3:
    s_mov_b64 exec, vcc
    buffer_load_dwordx4 v[36:39], v8, s[4:7], s16 offen offset:3072 sc1
    s_mov_b64 exec, -1
    s_add_u32 s23, s23, 1
    s_cmp_lt_u32 s23, 200000
    s_cbranch_scc1 g_30L14_1
    s_mov_b32 s25, 200000
    s_branch gc_31
g_30F3_0:
    s_mov_b64 exec, vcc
    buffer_load_dwordx4 v[24:27], v8, s[4:7], s16 offen offset:0 sc1
    s_mov_b64 exec, -1
    s_add_u32 s23, s23, 1
    s_cmp_lt_u32 s23, 200000
    s_cbranch_scc1 g_30L3_1
    s_mov_b32 s25, 200000
    s_branch gc_31
g_30F3_1:
    s_mov_b64 exec, vcc
    buffer_load_dwordx4 v[28:31], v8, s[4:7], s16 offen offset:1024 sc1
    s_mov_b64 exec, -1
    s_add_u32 s23, s23, 1
    s_cmp_lt_u32 s23, 200000
    s_cbranch_scc1 g_30L3_0
    s_mov_b32 s25, 200000
    s_branch gc_31
g_30F5_0:
    s_mov_b64 exec, vcc
    buffer_load_dwordx4 v[24:27], v8, s[4:7], s16 offen offset:0 sc1
    s_mov_b64 exec, -1
    s_add_u32 s23, s23, 1
    s_cmp_lt_u32 s23, 200000
    s_cbranch_scc1 g_30L5_2
    s_mov_b32 s25, 200000
    s_branch gc_31
g_30F5_2:
    s_mov_b64 exec, vcc
    buffer_load_dwordx4 v[32:35], v8, s[4:7], s16 offen offset:2048 sc1
    s_mov_b64 exec, -1
    s_add_u32 s23, s23, 1
    s_cmp_lt_u32 s23, 200000
    s_cbranch_scc1 g_30L5_0
    s_mov_b32 s25, 200000
    s_branch gc_31
g_30F6_1:
    s_mov_b64 exec, vcc
    buffer_load_dwordx4 v[28:31], v8, s[4:7], s16 offen offset:1024 sc1
    s_mov_b64 exec, -1
    s_add_u32 s23, s23, 1
    s_cmp_lt_u32 s23, 200000
    s_cbranch_scc1 g_30L6_2
    s_mov_b32 s25, 200000
    s_branch gc_31
g_30F6_2:
    s_mov_b64 exec, vcc
    buffer_load_dwordx4 v[32:35], v8, s[4:7], s16 offen offset:2048 sc1
    s_mov_b64 exec, -1
    s_add_u32 s23, s23, 1
    s_cmp_lt_u32 s23, 200000
    s_cbranch_scc1 g_30L6_1
    s_mov_b32 s25, 200000
    s_branch gc_31
g_30F9_0:
    s_mov_b64 exec, vcc
    buffer_load_dwordx4 v[24:27], v8, s[4:7], s16 offen offset:0 sc1
    s_mov_b64 exec, -1
    s_add_u32 s23, s23, 1
    s_cmp_lt_u32 s23, 200000
    s_cbranch_scc1 g_30L9_3
    s_mov_b32 s25, 200000
    s_branch gc_31
g_30F9_3:
    s_mov_b64 exec, vcc
    buffer_load_dwordx4 v[36:39], v8, s[4:7], s16 offen offset:3072 sc1
    s_mov_b64 exec, -1
    s_add_u32 s23, s23, 1
    s_cmp_lt_u32 s23, 200000
    s_cbranch_scc1 g_30L9_0
    s_mov_b32 s25, 200000
    s_branch gc_31
g_30F10_1:
    s_mov_b64 exec, vcc
    buffer_load_dwordx4 v[28:31], v8, s[4:7], s16 offen offset:1024 sc1
    s_mov_b64 exec, -1
    s_add_u32 s23, s23, 1
    s_cmp_lt_u32 s23, 200000
    s_cbranch_scc1 g_30L10_3
    s_mov_b32 s25, 200000
    s_branch gc_31
g_30F10_3:
    s_mov_b64 exec, vcc
    buffer_load_dwordx4 v[36:39], v8, s[4:7], s16 offen offset:3072 sc1
    s_mov_b64 exec, -1
    s_add_u32 s23, s23, 1
    s_cmp_lt_u32 s23, 200000
    s_cbranch_scc1 g_30L10_1
    s_mov_b32 s25, 200000
    s_branch gc_31
g_30F12_2:
    s_mov_b64 exec, vcc
    buffer_load_dwordx4 v[32:35], v8, s[4:7], s16 offen offset:2048 sc1
    s_mov_b64 exec, -1
    s_add_u32 s23, s23, 1
    s_cmp_lt_u32 s23, 200000
    s_cbranch_scc1 g_30L12_3
    s_mov_b32 s25, 200000
    s_branch gc_31
g_30F12_3:
    s_mov_b64 exec, vcc
    buffer_load_dwordx4 v[36:39], v8, s[4:7], s16 offen offset:3072 sc1
    s_mov_b64 exec, -1
    s_add_u32 s23, s23, 1
    s_cmp_lt_u32 s23, 200000
    s_cbranch_scc1 g_30L12_2
    s_mov_b32 s25, 200000
    s_branch gc_31
g_30F1_0:
    s_mov_b64 exec, vcc
    buffer_load_dwordx4 v[24:27], v8, s[4:7], s16 offen offset:0 sc1
    s_mov_b64 exec, -1
    s_add_u32 s23, s23, 1
    s_cmp_lt_u32 s23, 200000
    s_cbranch_scc1 g_30L1_0
    s_mov_b32 s25, 200000
    s_branch gc_31
g_30F2_1:
    s_mov_b64 exec, vcc
    buffer_load_dwordx4 v[28:31], v8, s[4:7], s16 offen offset:1024 sc1
    s_mov_b64 exec, -1
    s_add_u32 s23, s23, 1
    s_cmp_lt_u32 s23, 200000
    s_cbranch_scc1 g_30L2_1
    s_mov_b32 s25, 200000
    s_branch gc_31
g_30F4_2:
    s_mov_b64 exec, vcc
    buffer_load_dwordx4 v[32:35], v8, s[4:7], s16 offen offset:2048 sc1
    s_mov_b64 exec, -1
    s_add_u32 s23, s23, 1
    s_cmp_lt_u32 s23, 200000
    s_cbranch_scc1 g_30L4_2
    s_mov_b32 s25, 200000
    s_branch gc_31
g_30F8_3:
    s_mov_b64 exec, vcc
    buffer_load_dwordx4 v[36:39], v8, s[4:7], s16 offen offset:3072 sc1
    s_mov_b64 exec, -1
    s_add_u32 s23, s23, 1
    s_cmp_lt_u32 s23, 200000
    s_cbranch_scc1 g_30L8_3
    s_mov_b32 s25, 200000
    s_branch gc_31
.p2align 6
recur_fast_w1:
    s_nop 15
    s_mov_b32 s23, s25
    buffer_load_dwordx4 v[24:27], v2, s[4:7], s16 offen offset:0 sc1
    s_nop 11
    buffer_load_dwordx4 v[28:31], v2, s[4:7], s16 offen offset:1024 sc1
    s_nop 11
    buffer_load_dwordx4 v[32:35], v2, s[4:7], s16 offen offset:2048 sc1
    s_nop 11
    buffer_load_dwordx4 v[36:39], v2, s[4:7], s16 offen offset:3072 sc1
    s_waitcnt vmcnt(3)
    v_max3_u32 v19, v24, v25, v26
    v_max_u32 v19, v19, v27
    v_cmp_eq_u32 vcc, -1, v19
    s_nop 0
    s_cbranch_vccnz g_34F15_0
    v_smfmac_f32_16x16x64_bf16 v[40:43], v[24:27], a[0:7], v172
    s_waitcnt vmcnt(2)
    v_max3_u32 v19, v28, v29, v30
    v_max_u32 v19, v19, v31
    v_smfmac_f32_16x16x64_bf16 v[44:47], v[24:27], a[64:71], v172
    v_cmp_eq_u32 vcc, -1, v19
    v_smfmac_f32_16x16x64_bf16 v[48:51], v[24:27], a[32:39], v172
    v_smfmac_f32_16x16x64_bf16 v[52:55], v[24:27], a[96:103], v172
    s_cbranch_vccnz g_34F14_1
    v_smfmac_f32_16x16x64_bf16 v[40:43], v[28:31], a[8:15], v172
    s_waitcnt vmcnt(1)
    v_max3_u32 v19, v32, v33, v34
    v_max_u32 v19, v19, v35
    v_smfmac_f32_16x16x64_bf16 v[44:47], v[28:31], a[72:79], v172
    v_cmp_eq_u32 vcc, -1, v19
    v_smfmac_f32_16x16x64_bf16 v[48:51], v[28:31], a[40:47], v172
    v_smfmac_f32_16x16x64_bf16 v[52:55], v[28:31], a[104:111], v172
    s_cbranch_vccnz g_34F12_2
    v_smfmac_f32_16x16x64_bf16 v[40:43], v[32:35], a[16:23], v172
    s_waitcnt vmcnt(0)
    v_max3_u32 v19, v36, v37, v38
    v_max_u32 v19, v19, v39
    v_smfmac_f32_16x16x64_bf16 v[44:47], v[32:35], a[80:87], v172
    v_cmp_eq_u32 vcc, -1, v19
    v_smfmac_f32_16x16x64_bf16 v[48:51], v[32:35], a[48:55], v172
    v_smfmac_f32_16x16x64_bf16 v[52:55], v[32:35], a[112:119], v172
    s_cbranch_vccnz g_34F8_3
    v_smfmac_f32_16x16x64_bf16 v[40:43], v[36:39], a[24:31], v172
    v_smfmac_f32_16x16x64_bf16 v[44:47], v[36:39], a[88:95], v172
    v_smfmac_f32_16x16x64_bf16 v[48:51], v[36:39], a[56:63], v172
    v_smfmac_f32_16x16x64_bf16 v[52:55], v[36:39], a[120:127], v172
gc_35:
    v_cvt_pk_bf16_f32 v72, v40, v41
    v_cvt_pk_bf16_f32 v73, v42, v43
    v_cvt_pk_bf16_f32 v74, v44, v45
    v_cvt_pk_bf16_f32 v75, v46, v47
    ds_write_b128 v17, v[72:75] offset:0
    v_cvt_pk_bf16_f32 v76, v48, v49
    v_cvt_pk_bf16_f32 v77, v50, v51
    s_nop 0
    v_cvt_pk_bf16_f32 v78, v52, v53
    v_cvt_pk_bf16_f32 v79, v54, v55
    ds_write_b128 v17, v[76:79] offset:1024
    v_smfmac_f32_16x16x64_bf16 v[56:59], v[24:27], a[128:135], v172
    v_smfmac_f32_16x16x64_bf16 v[60:63], v[24:27], a[160:167], v172
    v_smfmac_f32_16x16x64_bf16 v[56:59], v[28:31], a[136:143], v172
    s_waitcnt lgkmcnt(0)
    s_barrier
    v_smfmac_f32_16x16x64_bf16 v[60:63], v[28:31], a[168:175], v172
    v_smfmac_f32_16x16x64_bf16 v[56:59], v[32:35], a[144:151], v172
    v_smfmac_f32_16x16x64_bf16 v[60:63], v[32:35], a[176:183], v172
    v_smfmac_f32_16x16x64_bf16 v[56:59], v[36:39], a[152:159], v172
    v_smfmac_f32_16x16x64_bf16 v[60:63], v[36:39], a[184:191], v172
    s_nop 4
    v_cvt_pk_bf16_f32 v80, v56, v57
    v_cvt_pk_bf16_f32 v81, v58, v59
    s_nop 0
    v_cvt_pk_bf16_f32 v82, v60, v61
    v_cvt_pk_bf16_f32 v83, v62, v63
    ds_write_b128 v17, v[80:83] offset:8192
    v_mov_b32 v152, v228
    v_mov_b32 v153, v229
    v_mov_b32 v156, v230
    v_mov_b32 v157, v231
    v_mov_b32 v160, v232
    v_mov_b32 v161, v233
    v_mov_b32 v164, v234
    v_mov_b32 v165, v235
    s_cmp_eq_u32 s15, 63
    s_waitcnt lgkmcnt(0)
    s_barrier
    s_cbranch_scc1 recur_end
    s_nop 15
    s_nop 15
    s_nop 7
    buffer_load_dwordx4 v[208:211], v5, s[4:7], s16 offen offset:0 sc1
    buffer_load_dwordx4 v[212:215], v5, s[4:7], s16 offen offset:1024 sc1
    buffer_load_dwordx4 v[216:219], v5, s[4:7], s16 offen offset:2048 sc1
    buffer_load_dwordx4 v[220:223], v5, s[4:7], s16 offen offset:3072 sc1
    buffer_load_dword v224, v6, s[4:7], s16 offen offset:0 sc1
    buffer_load_dword v225, v6, s[4:7], s16 offen offset:256 sc1
    buffer_load_dword v226, v6, s[4:7], s16 offen offset:512 sc1
    buffer_load_dword v227, v6, s[4:7], s16 offen offset:768 sc1
    s_mov_b32 s23, s25
    ds_read_b128 v[96:99], v16 offset:8192
    ds_read_b128 v[104:107], v16 offset:12288
    ds_read_b128 v[108:111], v16 offset:14336
    v_mfma_f32_16x16x32_bf16 v[140:143], v[84:87], v[80:83], 0
    s_waitcnt lgkmcnt(2)
    v_mfma_f32_16x16x32_bf16 v[140:143], v[84:87], v[96:99], v[140:143]
    s_waitcnt lgkmcnt(1)
    v_mfma_f32_16x16x32_bf16 v[140:143], v[84:87], v[104:107], v[140:143]
    s_waitcnt lgkmcnt(0)
    v_mfma_f32_16x16x32_bf16 v[140:143], v[84:87], v[108:111], v[140:143]
    buffer_load_dwordx4 v[24:27], v5, s[4:7], s16 offen offset:0 sc1
    buffer_load_dwordx4 v[28:31], v5, s[4:7], s16 offen offset:1024 sc1
    buffer_load_dwordx4 v[32:35], v5, s[4:7], s16 offen offset:2048 sc1
    buffer_load_dwordx4 v[36:39], v5, s[4:7], s16 offen offset:3072 sc1
    buffer_load_dword v40, v6, s[4:7], s16 offen offset:0 sc1
    buffer_load_dword v41, v6, s[4:7], s16 offen offset:256 sc1
    buffer_load_dword v42, v6, s[4:7], s16 offen offset:512 sc1
    buffer_load_dword v43, v6, s[4:7], s16 offen offset:768 sc1
    v_cvt_pk_bf16_f32 v154, v140, v179
    v_cvt_pk_bf16_f32 v158, v141, v179
    v_cvt_pk_bf16_f32 v162, v142, v179
    v_cvt_pk_bf16_f32 v166, v143, v179
    s_waitcnt vmcnt(14)
    v_pk_add_f32 v[180:181], v[208:209], v[212:213]
    v_pk_add_f32 v[182:183], v[210:211], v[214:215]
    s_waitcnt vmcnt(12)
    v_pk_add_f32 v[188:189], v[216:217], v[220:221]
    v_pk_add_f32 v[190:191], v[218:219], v[222:223]
    v_pk_add_f32 v[180:181], v[180:181], v[188:189]
    v_pk_add_f32 v[182:183], v[182:183], v[190:191]
    v_pk_add_f32 v[188:189], v[180:181], v[182:183]
    v_max3_f32 v185, v180, v181, v182
    s_waitcnt vmcnt(8)
    v_pk_add_f32 v[192:193], v[224:225], v[226:227]
    v_add_f32 v188, v188, v189
    v_add_f32 v184, v192, v193
    v_max3_f32 v185, v185, v183, v184
    v_cmp_u_f32 vcc, v188, v184
    s_nop 0
    v_max_f32_dpp v185, v185, v185 row_ror:8 row_mask:0xf bank_mask:0xf
    v_mov_b32 v186, v185
    s_nop 1
    v_permlane16_swap_b32 v185, v186
    v_max_f32 v185, v185, v186
    v_mov_b32 v186, v185
    s_cbranch_vccnz ss_36
sg_38:
    s_nop 0
    v_permlane32_swap_b32 v185, v186
    v_max_f32 v185, v185, v186
    v_mul_f32 v185, s24, v185
    v_fma_f32 v180, v180, s24, -v185
    v_fma_f32 v181, v181, s24, -v185
    v_fma_f32 v182, v182, s24, -v185
    v_fma_f32 v183, v183, s24, -v185
    v_fma_f32 v184, v184, s24, -v185
    v_exp_f32 v180, v180
    v_exp_f32 v181, v181
    v_exp_f32 v182, v182
    v_exp_f32 v183, v183
    v_exp_f32 v184, v184
    v_cvt_pk_bf16_f32 v176, v180, v181
    v_cvt_pk_bf16_f32 v177, v182, v183
    v_cvt_pk_bf16_f32 v178, v184, v179
    s_nop 1
    v_mfma_f32_16x16x32_bf16 v[240:243], v[236:239], v[176:179], 0
    v_mfma_f32_16x16x32_bf16 v[188:191], v[152:155], v[176:179], 0
    v_mfma_f32_16x16x32_bf16 v[192:195], v[156:159], v[176:179], 0
    v_mfma_f32_16x16x32_bf16 v[196:199], v[160:163], v[176:179], 0
    v_mfma_f32_16x16x32_bf16 v[200:203], v[164:167], v[176:179], 0
    v_add_f32_dpp v185, v240, v240 row_ror:8 row_mask:0xf bank_mask:0xf
    v_rcp_f32 v185, v185
    v_add_f32_dpp v88, v192, v188 row_ror:8 row_mask:0xf bank_mask:0x3
    v_add_f32_dpp v89, v193, v189 row_ror:8 row_mask:0xf bank_mask:0x3
    v_add_f32_dpp v90, v194, v190 row_ror:8 row_mask:0xf bank_mask:0x3
    v_add_f32_dpp v91, v195, v191 row_ror:8 row_mask:0xf bank_mask:0x3
    s_nop 1
    v_add_f32_dpp v88, v196, v200 row_ror:8 row_mask:0xf bank_mask:0xc
    v_add_f32_dpp v89, v197, v201 row_ror:8 row_mask:0xf bank_mask:0xc
    v_add_f32_dpp v90, v198, v202 row_ror:8 row_mask:0xf bank_mask:0xc
    v_add_f32_dpp v91, v199, v203 row_ror:8 row_mask:0xf bank_mask:0xc
    v_mul_f32 v88, v88, v185
    v_mul_f32 v89, v89, v185
    v_mul_f32 v90, v90, v185
    v_mul_f32 v91, v91, v185
    v_cvt_pk_bf16_f32 v88, v88, v89
    v_cvt_pk_bf16_f32 v89, v90, v91
    buffer_store_dwordx2 v[88:89], v7, s[4:7], s16 offen
    v_readfirstlane_b32 s85, v247
    s_add_u32 s94, s15, 2
    s_barrier
    s_nop 15
    s_mov_b32 s23, s25
    buffer_load_dwordx4 v[24:27], v8, s[4:7], s16 offen offset:0 sc1
    s_nop 11
    buffer_load_dwordx4 v[28:31], v8, s[4:7], s16 offen offset:1024 sc1
    s_nop 11
    buffer_load_dwordx4 v[32:35], v8, s[4:7], s16 offen offset:2048 sc1
    s_nop 11
    buffer_load_dwordx4 v[36:39], v8, s[4:7], s16 offen offset:3072 sc1
    s_waitcnt vmcnt(3)
    v_max3_u32 v19, v24, v25, v26
    v_max_u32 v19, v19, v27
    v_cmp_eq_u32 vcc, -1, v19
    s_nop 0
    s_cbranch_vccnz g_39F15_0
    v_smfmac_f32_16x16x64_bf16 v[64:67], v[24:27], a[192:199], v172
    v_smfmac_f32_16x16x64_bf16 v[68:71], v[24:27], a[224:231], v172
    s_waitcnt vmcnt(2)
    v_max3_u32 v19, v28, v29, v30
    v_max_u32 v19, v19, v31
    v_cmp_eq_u32 vcc, -1, v19
    s_nop 0
    s_cbranch_vccnz g_39F14_1
    v_smfmac_f32_16x16x64_bf16 v[64:67], v[28:31], a[200:207], v172
    v_smfmac_f32_16x16x64_bf16 v[68:71], v[28:31], a[232:239], v172
    s_waitcnt vmcnt(1)
    v_max3_u32 v19, v32, v33, v34
    v_max_u32 v19, v19, v35
    v_cmp_eq_u32 vcc, -1, v19
    s_nop 0
    s_cbranch_vccnz g_39F12_2
    v_smfmac_f32_16x16x64_bf16 v[64:67], v[32:35], a[208:215], v172
    v_smfmac_f32_16x16x64_bf16 v[68:71], v[32:35], a[240:247], v172
    s_waitcnt vmcnt(0)
    v_max3_u32 v19, v36, v37, v38
    v_max_u32 v19, v19, v39
    v_cmp_eq_u32 vcc, -1, v19
    s_nop 0
    s_cbranch_vccnz g_39F8_3
    v_smfmac_f32_16x16x64_bf16 v[64:67], v[36:39], a[216:223], v172
    v_smfmac_f32_16x16x64_bf16 v[68:71], v[36:39], a[248:255], v172
    s_nop 4
    v_cvt_pk_bf16_f32 v80, v64, v65
    v_cvt_pk_bf16_f32 v81, v66, v67
    s_nop 0
    v_cvt_pk_bf16_f32 v82, v68, v69
    v_cvt_pk_bf16_f32 v83, v70, v71
    ds_write_b128 v17, v[80:83] offset:9216
gc_40:
    s_waitcnt lgkmcnt(0)
    s_barrier
    s_nop 15
    s_nop 15
    s_nop 15
    s_nop 15
    s_mov_b32 s23, s25
fw_41:
    s_cmp_ge_u32 s85, s94
    s_cbranch_scc1 fo_42
    buffer_load_dword v247, v245, s[4:7], 0 offen sc1
    s_add_u32 s23, s23, 1
    s_waitcnt vmcnt(0)
    v_readfirstlane_b32 s85, v247
    s_cmp_lt_u32 s23, 200000
    s_cbranch_scc1 fw_41
    s_mov_b32 s25, 200000
fo_42:
    buffer_load_dwordx4 v[228:231], v13, s[4:7], s18 offen offset:0 sc1
    buffer_load_dwordx4 v[232:235], v13, s[4:7], s18 offen offset:256 sc1
    s_add_u32 s18, s18, 2048
    s_min_u32 s18, s18, 35780608
    buffer_load_dword v247, v245, s[4:7], 0 offen sc1
    v_mov_b32 v40, 0
    v_mov_b32 v41, 0
    v_mov_b32 v42, 0
    v_mov_b32 v43, 0
    v_mov_b32 v44, 0
    v_mov_b32 v45, 0
    v_mov_b32 v46, 0
    v_mov_b32 v47, 0
    v_mov_b32 v48, 0
    v_mov_b32 v49, 0
    v_mov_b32 v50, 0
    v_mov_b32 v51, 0
    v_mov_b32 v52, 0
    v_mov_b32 v53, 0
    v_mov_b32 v54, 0
    v_mov_b32 v55, 0
    v_mov_b32 v56, 0
    v_mov_b32 v57, 0
    v_mov_b32 v58, 0
    v_mov_b32 v59, 0
    v_mov_b32 v60, 0
    v_mov_b32 v61, 0
    v_mov_b32 v62, 0
    v_mov_b32 v63, 0
    v_mov_b32 v64, 0
    v_mov_b32 v65, 0
    v_mov_b32 v66, 0
    v_mov_b32 v67, 0
    v_mov_b32 v68, 0
    v_mov_b32 v69, 0
    v_mov_b32 v70, 0
    v_mov_b32 v71, 0
    s_mov_b32 s21, s16
    s_mov_b32 s16, s42
    s_mov_b32 s42, s43
    s_mov_b32 s43, s44
    s_mov_b32 s44, s21
    s_add_u32 s95, s95, 524288
    s_lshr_b32 s84, s95, 8
    s_and_b32 s84, s84, 8192
    s_xor_b32 s84, s84, s46
    s_add_u32 s84, s84, s95
    s_add_u32 s15, s15, 1
    s_barrier
    s_branch recur_fast_w1
g_34L15_0:
    s_waitcnt vmcnt(3)
    v_max3_u32 v19, v24, v25, v26
    v_max_u32 v19, v19, v27
    v_cmp_eq_u32 vcc, -1, v19
    s_nop 0
    s_cbranch_vccnz g_34F15_0
    v_smfmac_f32_16x16x64_bf16 v[40:43], v[24:27], a[0:7], v172
    v_smfmac_f32_16x16x64_bf16 v[44:47], v[24:27], a[64:71], v172
    v_smfmac_f32_16x16x64_bf16 v[48:51], v[24:27], a[32:39], v172
    v_smfmac_f32_16x16x64_bf16 v[52:55], v[24:27], a[96:103], v172
g_34L14_1:
    s_waitcnt vmcnt(2)
    v_max3_u32 v19, v28, v29, v30
    v_max_u32 v19, v19, v31
    v_cmp_eq_u32 vcc, -1, v19
    s_nop 0
    s_cbranch_vccnz g_34F14_1
    v_smfmac_f32_16x16x64_bf16 v[40:43], v[28:31], a[8:15], v172
    v_smfmac_f32_16x16x64_bf16 v[44:47], v[28:31], a[72:79], v172
    v_smfmac_f32_16x16x64_bf16 v[48:51], v[28:31], a[40:47], v172
    v_smfmac_f32_16x16x64_bf16 v[52:55], v[28:31], a[104:111], v172
g_34L12_2:
    s_waitcnt vmcnt(1)
    v_max3_u32 v19, v32, v33, v34
    v_max_u32 v19, v19, v35
    v_cmp_eq_u32 vcc, -1, v19
    s_nop 0
    s_cbranch_vccnz g_34F12_2
    v_smfmac_f32_16x16x64_bf16 v[40:43], v[32:35], a[16:23], v172
    v_smfmac_f32_16x16x64_bf16 v[44:47], v[32:35], a[80:87], v172
    v_smfmac_f32_16x16x64_bf16 v[48:51], v[32:35], a[48:55], v172
    v_smfmac_f32_16x16x64_bf16 v[52:55], v[32:35], a[112:119], v172
g_34L8_3:
    s_waitcnt vmcnt(0)
    v_max3_u32 v19, v36, v37, v38
    v_max_u32 v19, v19, v39
    v_cmp_eq_u32 vcc, -1, v19
    s_nop 0
    s_cbranch_vccnz g_34F8_3
    v_smfmac_f32_16x16x64_bf16 v[40:43], v[36:39], a[24:31], v172
    v_smfmac_f32_16x16x64_bf16 v[44:47], v[36:39], a[88:95], v172
    v_smfmac_f32_16x16x64_bf16 v[48:51], v[36:39], a[56:63], v172
    v_smfmac_f32_16x16x64_bf16 v[52:55], v[36:39], a[120:127], v172
    s_branch gc_35
g_34L15_1:
    s_waitcnt vmcnt(3)
    v_max3_u32 v19, v28, v29, v30
    v_max_u32 v19, v19, v31
    v_cmp_eq_u32 vcc, -1, v19
    s_nop 0
    s_cbranch_vccnz g_34F15_1
    v_smfmac_f32_16x16x64_bf16 v[40:43], v[28:31], a[8:15], v172
    v_smfmac_f32_16x16x64_bf16 v[44:47], v[28:31], a[72:79], v172
    v_smfmac_f32_16x16x64_bf16 v[48:51], v[28:31], a[40:47], v172
    v_smfmac_f32_16x16x64_bf16 v[52:55], v[28:31], a[104:111], v172
g_34L13_2:
    s_waitcnt vmcnt(2)
    v_max3_u32 v19, v32, v33, v34
    v_max_u32 v19, v19, v35
    v_cmp_eq_u32 vcc, -1, v19
    s_nop 0
    s_cbranch_vccnz g_34F13_2
    v_smfmac_f32_16x16x64_bf16 v[40:43], v[32:35], a[16:23], v172
    v_smfmac_f32_16x16x64_bf16 v[44:47], v[32:35], a[80:87], v172
    v_smfmac_f32_16x16x64_bf16 v[48:51], v[32:35], a[48:55], v172
    v_smfmac_f32_16x16x64_bf16 v[52:55], v[32:35], a[112:119], v172
g_34L9_3:
    s_waitcnt vmcnt(1)
    v_max3_u32 v19, v36, v37, v38
    v_max_u32 v19, v19, v39
    v_cmp_eq_u32 vcc, -1, v19
    s_nop 0
    s_cbranch_vccnz g_34F9_3
    v_smfmac_f32_16x16x64_bf16 v[40:43], v[36:39], a[24:31], v172
    v_smfmac_f32_16x16x64_bf16 v[44:47], v[36:39], a[88:95], v172
    v_smfmac_f32_16x16x64_bf16 v[48:51], v[36:39], a[56:63], v172
    v_smfmac_f32_16x16x64_bf16 v[52:55], v[36:39], a[120:127], v172
g_34L1_0:
    s_waitcnt vmcnt(0)
    v_max3_u32 v19, v24, v25, v26
    v_max_u32 v19, v19, v27
    v_cmp_eq_u32 vcc, -1, v19
    s_nop 0
    s_cbranch_vccnz g_34F1_0
    v_smfmac_f32_16x16x64_bf16 v[40:43], v[24:27], a[0:7], v172
    v_smfmac_f32_16x16x64_bf16 v[44:47], v[24:27], a[64:71], v172
    v_smfmac_f32_16x16x64_bf16 v[48:51], v[24:27], a[32:39], v172
    v_smfmac_f32_16x16x64_bf16 v[52:55], v[24:27], a[96:103], v172
    s_branch gc_35
g_34L15_2:
    s_waitcnt vmcnt(3)
    v_max3_u32 v19, v32, v33, v34
    v_max_u32 v19, v19, v35
    v_cmp_eq_u32 vcc, -1, v19
    s_nop 0
    s_cbranch_vccnz g_34F15_2
    v_smfmac_f32_16x16x64_bf16 v[40:43], v[32:35], a[16:23], v172
    v_smfmac_f32_16x16x64_bf16 v[44:47], v[32:35], a[80:87], v172
    v_smfmac_f32_16x16x64_bf16 v[48:51], v[32:35], a[48:55], v172
    v_smfmac_f32_16x16x64_bf16 v[52:55], v[32:35], a[112:119], v172
g_34L11_3:
    s_waitcnt vmcnt(2)
    v_max3_u32 v19, v36, v37, v38
    v_max_u32 v19, v19, v39
    v_cmp_eq_u32 vcc, -1, v19
    s_nop 0
    s_cbranch_vccnz g_34F11_3
    v_smfmac_f32_16x16x64_bf16 v[40:43], v[36:39], a[24:31], v172
    v_smfmac_f32_16x16x64_bf16 v[44:47], v[36:39], a[88:95], v172
    v_smfmac_f32_16x16x64_bf16 v[48:51], v[36:39], a[56:63], v172
    v_smfmac_f32_16x16x64_bf16 v[52:55], v[36:39], a[120:127], v172
g_34L3_0:
    s_waitcnt vmcnt(1)
    v_max3_u32 v19, v24, v25, v26
    v_max_u32 v19, v19, v27
    v_cmp_eq_u32 vcc, -1, v19
    s_nop 0
    s_cbranch_vccnz g_34F3_0
    v_smfmac_f32_16x16x64_bf16 v[40:43], v[24:27], a[0:7], v172
    v_smfmac_f32_16x16x64_bf16 v[44:47], v[24:27], a[64:71], v172
    v_smfmac_f32_16x16x64_bf16 v[48:51], v[24:27], a[32:39], v172
    v_smfmac_f32_16x16x64_bf16 v[52:55], v[24:27], a[96:103], v172
g_34L2_1:
    s_waitcnt vmcnt(0)
    v_max3_u32 v19, v28, v29, v30
    v_max_u32 v19, v19, v31
    v_cmp_eq_u32 vcc, -1, v19
    s_nop 0
    s_cbranch_vccnz g_34F2_1
    v_smfmac_f32_16x16x64_bf16 v[40:43], v[28:31], a[8:15], v172
    v_smfmac_f32_16x16x64_bf16 v[44:47], v[28:31], a[72:79], v172
    v_smfmac_f32_16x16x64_bf16 v[48:51], v[28:31], a[40:47], v172
    v_smfmac_f32_16x16x64_bf16 v[52:55], v[28:31], a[104:111], v172
    s_branch gc_35
g_34L15_3:
    s_waitcnt vmcnt(3)
    v_max3_u32 v19, v36, v37, v38
    v_max_u32 v19, v19, v39
    v_cmp_eq_u32 vcc, -1, v19
    s_nop 0
    s_cbranch_vccnz g_34F15_3
    v_smfmac_f32_16x16x64_bf16 v[40:43], v[36:39], a[24:31], v172
    v_smfmac_f32_16x16x64_bf16 v[44:47], v[36:39], a[88:95], v172
    v_smfmac_f32_16x16x64_bf16 v[48:51], v[36:39], a[56:63], v172
    v_smfmac_f32_16x16x64_bf16 v[52:55], v[36:39], a[120:127], v172
g_34L7_0:
    s_waitcnt vmcnt(2)
    v_max3_u32 v19, v24, v25, v26
    v_max_u32 v19, v19, v27
    v_cmp_eq_u32 vcc, -1, v19
    s_nop 0
    s_cbranch_vccnz g_34F7_0
    v_smfmac_f32_16x16x64_bf16 v[40:43], v[24:27], a[0:7], v172
    v_smfmac_f32_16x16x64_bf16 v[44:47], v[24:27], a[64:71], v172
    v_smfmac_f32_16x16x64_bf16 v[48:51], v[24:27], a[32:39], v172
    v_smfmac_f32_16x16x64_bf16 v[52:55], v[24:27], a[96:103], v172
g_34L6_1:
    s_waitcnt vmcnt(1)
    v_max3_u32 v19, v28, v29, v30
    v_max_u32 v19, v19, v31
    v_cmp_eq_u32 vcc, -1, v19
    s_nop 0
    s_cbranch_vccnz g_34F6_1
    v_smfmac_f32_16x16x64_bf16 v[40:43], v[28:31], a[8:15], v172
    v_smfmac_f32_16x16x64_bf16 v[44:47], v[28:31], a[72:79], v172
    v_smfmac_f32_16x16x64_bf16 v[48:51], v[28:31], a[40:47], v172
    v_smfmac_f32_16x16x64_bf16 v[52:55], v[28:31], a[104:111], v172
g_34L4_2:
    s_waitcnt vmcnt(0)
    v_max3_u32 v19, v32, v33, v34
    v_max_u32 v19, v19, v35
    v_cmp_eq_u32 vcc, -1, v19
    s_nop 0
    s_cbranch_vccnz g_34F4_2
    v_smfmac_f32_16x16x64_bf16 v[40:43], v[32:35], a[16:23], v172
    v_smfmac_f32_16x16x64_bf16 v[44:47], v[32:35], a[80:87], v172
    v_smfmac_f32_16x16x64_bf16 v[48:51], v[32:35], a[48:55], v172
    v_smfmac_f32_16x16x64_bf16 v[52:55], v[32:35], a[112:119], v172
    s_branch gc_35
g_34L7_1:
    s_waitcnt vmcnt(2)
    v_max3_u32 v19, v28, v29, v30
    v_max_u32 v19, v19, v31
    v_cmp_eq_u32 vcc, -1, v19
    s_nop 0
    s_cbranch_vccnz g_34F7_1
    v_smfmac_f32_16x16x64_bf16 v[40:43], v[28:31], a[8:15], v172
    v_smfmac_f32_16x16x64_bf16 v[44:47], v[28:31], a[72:79], v172
    v_smfmac_f32_16x16x64_bf16 v[48:51], v[28:31], a[40:47], v172
    v_smfmac_f32_16x16x64_bf16 v[52:55], v[28:31], a[104:111], v172
g_34L5_2:
    s_waitcnt vmcnt(1)
    v_max3_u32 v19, v32, v33, v34
    v_max_u32 v19, v19, v35
    v_cmp_eq_u32 vcc, -1, v19
    s_nop 0
    s_cbranch_vccnz g_34F5_2
    v_smfmac_f32_16x16x64_bf16 v[40:43], v[32:35], a[16:23], v172
    v_smfmac_f32_16x16x64_bf16 v[44:47], v[32:35], a[80:87], v172
    v_smfmac_f32_16x16x64_bf16 v[48:51], v[32:35], a[48:55], v172
    v_smfmac_f32_16x16x64_bf16 v[52:55], v[32:35], a[112:119], v172
    s_branch g_34L1_0
g_34L7_2:
    s_waitcnt vmcnt(2)
    v_max3_u32 v19, v32, v33, v34
    v_max_u32 v19, v19, v35
    v_cmp_eq_u32 vcc, -1, v19
    s_nop 0
    s_cbranch_vccnz g_34F7_2
    v_smfmac_f32_16x16x64_bf16 v[40:43], v[32:35], a[16:23], v172
    v_smfmac_f32_16x16x64_bf16 v[44:47], v[32:35], a[80:87], v172
    v_smfmac_f32_16x16x64_bf16 v[48:51], v[32:35], a[48:55], v172
    v_smfmac_f32_16x16x64_bf16 v[52:55], v[32:35], a[112:119], v172
    s_branch g_34L3_0
g_34L11_0:
    s_waitcnt vmcnt(2)
    v_max3_u32 v19, v24, v25, v26
    v_max_u32 v19, v19, v27
    v_cmp_eq_u32 vcc, -1, v19
    s_nop 0
    s_cbranch_vccnz g_34F11_0
    v_smfmac_f32_16x16x64_bf16 v[40:43], v[24:27], a[0:7], v172
    v_smfmac_f32_16x16x64_bf16 v[44:47], v[24:27], a[64:71], v172
    v_smfmac_f32_16x16x64_bf16 v[48:51], v[24:27], a[32:39], v172
    v_smfmac_f32_16x16x64_bf16 v[52:55], v[24:27], a[96:103], v172
g_34L10_1:
    s_waitcnt vmcnt(1)
    v_max3_u32 v19, v28, v29, v30
    v_max_u32 v19, v19, v31
    v_cmp_eq_u32 vcc, -1, v19
    s_nop 0
    s_cbranch_vccnz g_34F10_1
    v_smfmac_f32_16x16x64_bf16 v[40:43], v[28:31], a[8:15], v172
    v_smfmac_f32_16x16x64_bf16 v[44:47], v[28:31], a[72:79], v172
    v_smfmac_f32_16x16x64_bf16 v[48:51], v[28:31], a[40:47], v172
    v_smfmac_f32_16x16x64_bf16 v[52:55], v[28:31], a[104:111], v172
    s_branch g_34L8_3
g_34L11_1:
    s_waitcnt vmcnt(2)
    v_max3_u32 v19, v28, v29, v30
    v_max_u32 v19, v19, v31
    v_cmp_eq_u32 vcc, -1, v19
    s_nop 0
    s_cbranch_vccnz g_34F11_1
    v_smfmac_f32_16x16x64_bf16 v[40:43], v[28:31], a[8:15], v172
    v_smfmac_f32_16x16x64_bf16 v[44:47], v[28:31], a[72:79], v172
    v_smfmac_f32_16x16x64_bf16 v[48:51], v[28:31], a[40:47], v172
    v_smfmac_f32_16x16x64_bf16 v[52:55], v[28:31], a[104:111], v172
    s_branch g_34L9_3
g_34L13_0:
    s_waitcnt vmcnt(2)
    v_max3_u32 v19, v24, v25, v26
    v_max_u32 v19, v19, v27
    v_cmp_eq_u32 vcc, -1, v19
    s_nop 0
    s_cbranch_vccnz g_34F13_0
    v_smfmac_f32_16x16x64_bf16 v[40:43], v[24:27], a[0:7], v172
    v_smfmac_f32_16x16x64_bf16 v[44:47], v[24:27], a[64:71], v172
    v_smfmac_f32_16x16x64_bf16 v[48:51], v[24:27], a[32:39], v172
    v_smfmac_f32_16x16x64_bf16 v[52:55], v[24:27], a[96:103], v172
    s_branch g_34L12_2
g_34L13_3:
    s_waitcnt vmcnt(2)
    v_max3_u32 v19, v36, v37, v38
    v_max_u32 v19, v19, v39
    v_cmp_eq_u32 vcc, -1, v19
    s_nop 0
    s_cbranch_vccnz g_34F13_3
    v_smfmac_f32_16x16x64_bf16 v[40:43], v[36:39], a[24:31], v172
    v_smfmac_f32_16x16x64_bf16 v[44:47], v[36:39], a[88:95], v172
    v_smfmac_f32_16x16x64_bf16 v[48:51], v[36:39], a[56:63], v172
    v_smfmac_f32_16x16x64_bf16 v[52:55], v[36:39], a[120:127], v172
g_34L5_0:
    s_waitcnt vmcnt(1)
    v_max3_u32 v19, v24, v25, v26
    v_max_u32 v19, v19, v27
    v_cmp_eq_u32 vcc, -1, v19
    s_nop 0
    s_cbranch_vccnz g_34F5_0
    v_smfmac_f32_16x16x64_bf16 v[40:43], v[24:27], a[0:7], v172
    v_smfmac_f32_16x16x64_bf16 v[44:47], v[24:27], a[64:71], v172
    v_smfmac_f32_16x16x64_bf16 v[48:51], v[24:27], a[32:39], v172
    v_smfmac_f32_16x16x64_bf16 v[52:55], v[24:27], a[96:103], v172
    s_branch g_34L4_2
g_34L14_2:
    s_waitcnt vmcnt(2)
    v_max3_u32 v19, v32, v33, v34
    v_max_u32 v19, v19, v35
    v_cmp_eq_u32 vcc, -1, v19
    s_nop 0
    s_cbranch_vccnz g_34F14_2
    v_smfmac_f32_16x16x64_bf16 v[40:43], v[32:35], a[16:23], v172
    v_smfmac_f32_16x16x64_bf16 v[44:47], v[32:35], a[80:87], v172
    v_smfmac_f32_16x16x64_bf16 v[48:51], v[32:35], a[48:55], v172
    v_smfmac_f32_16x16x64_bf16 v[52:55], v[32:35], a[112:119], v172
g_34L10_3:
    s_waitcnt vmcnt(1)
    v_max3_u32 v19, v36, v37, v38
    v_max_u32 v19, v19, v39
    v_cmp_eq_u32 vcc, -1, v19
    s_nop 0
    s_cbranch_vccnz g_34F10_3
    v_smfmac_f32_16x16x64_bf16 v[40:43], v[36:39], a[24:31], v172
    v_smfmac_f32_16x16x64_bf16 v[44:47], v[36:39], a[88:95], v172
    v_smfmac_f32_16x16x64_bf16 v[48:51], v[36:39], a[56:63], v172
    v_smfmac_f32_16x16x64_bf16 v[52:55], v[36:39], a[120:127], v172
    s_branch g_34L2_1
g_34L14_3:
    s_waitcnt vmcnt(2)
    v_max3_u32 v19, v36, v37, v38
    v_max_u32 v19, v19, v39
    v_cmp_eq_u32 vcc, -1, v19
    s_nop 0
    s_cbranch_vccnz g_34F14_3
    v_smfmac_f32_16x16x64_bf16 v[40:43], v[36:39], a[24:31], v172
    v_smfmac_f32_16x16x64_bf16 v[44:47], v[36:39], a[88:95], v172
    v_smfmac_f32_16x16x64_bf16 v[48:51], v[36:39], a[56:63], v172
    v_smfmac_f32_16x16x64_bf16 v[52:55], v[36:39], a[120:127], v172
    s_branch g_34L6_1
g_34L3_1:
    s_waitcnt vmcnt(1)
    v_max3_u32 v19, v28, v29, v30
    v_max_u32 v19, v19, v31
    v_cmp_eq_u32 vcc, -1, v19
    s_nop 0
    s_cbranch_vccnz g_34F3_1
    v_smfmac_f32_16x16x64_bf16 v[40:43], v[28:31], a[8:15], v172
    v_smfmac_f32_16x16x64_bf16 v[44:47], v[28:31], a[72:79], v172
    v_smfmac_f32_16x16x64_bf16 v[48:51], v[28:31], a[40:47], v172
    v_smfmac_f32_16x16x64_bf16 v[52:55], v[28:31], a[104:111], v172
    s_branch g_34L1_0
g_34L6_2:
    s_waitcnt vmcnt(1)
    v_max3_u32 v19, v32, v33, v34
    v_max_u32 v19, v19, v35
    v_cmp_eq_u32 vcc, -1, v19
    s_nop 0
    s_cbranch_vccnz g_34F6_2
    v_smfmac_f32_16x16x64_bf16 v[40:43], v[32:35], a[16:23], v172
    v_smfmac_f32_16x16x64_bf16 v[44:47], v[32:35], a[80:87], v172
    v_smfmac_f32_16x16x64_bf16 v[48:51], v[32:35], a[48:55], v172
    v_smfmac_f32_16x16x64_bf16 v[52:55], v[32:35], a[112:119], v172
    s_branch g_34L2_1
g_34L9_0:
    s_waitcnt vmcnt(1)
    v_max3_u32 v19, v24, v25, v26
    v_max_u32 v19, v19, v27
    v_cmp_eq_u32 vcc, -1, v19
    s_nop 0
    s_cbranch_vccnz g_34F9_0
    v_smfmac_f32_16x16x64_bf16 v[40:43], v[24:27], a[0:7], v172
    v_smfmac_f32_16x16x64_bf16 v[44:47], v[24:27], a[64:71], v172
    v_smfmac_f32_16x16x64_bf16 v[48:51], v[24:27], a[32:39], v172
    v_smfmac_f32_16x16x64_bf16 v[52:55], v[24:27], a[96:103], v172
    s_branch g_34L8_3
g_34L12_3:
    s_waitcnt vmcnt(1)
    v_max3_u32 v19, v36, v37, v38
    v_max_u32 v19, v19, v39
    v_cmp_eq_u32 vcc, -1, v19
    s_nop 0
    s_cbranch_vccnz g_34F12_3
    v_smfmac_f32_16x16x64_bf16 v[40:43], v[36:39], a[24:31], v172
    v_smfmac_f32_16x16x64_bf16 v[44:47], v[36:39], a[88:95], v172
    v_smfmac_f32_16x16x64_bf16 v[48:51], v[36:39], a[56:63], v172
    v_smfmac_f32_16x16x64_bf16 v[52:55], v[36:39], a[120:127], v172
    s_branch g_34L4_2
g_34F15_0:
    s_mov_b64 exec, vcc
    buffer_load_dwordx4 v[24:27], v2, s[4:7], s16 offen offset:0 sc1
    s_mov_b64 exec, -1
    s_add_u32 s23, s23, 1
    s_cmp_lt_u32 s23, 200000
    s_cbranch_scc1 g_34L15_1
    s_mov_b32 s25, 200000
    s_branch gc_35
g_34F15_1:
    s_mov_b64 exec, vcc
    buffer_load_dwordx4 v[28:31], v2, s[4:7], s16 offen offset:1024 sc1
    s_mov_b64 exec, -1
    s_add_u32 s23, s23, 1
    s_cmp_lt_u32 s23, 200000
    s_cbranch_scc1 g_34L15_2
    s_mov_b32 s25, 200000
    s_branch gc_35
g_34F15_2:
    s_mov_b64 exec, vcc
    buffer_load_dwordx4 v[32:35], v2, s[4:7], s16 offen offset:2048 sc1
    s_mov_b64 exec, -1
    s_add_u32 s23, s23, 1
    s_cmp_lt_u32 s23, 200000
    s_cbranch_scc1 g_34L15_3
    s_mov_b32 s25, 200000
    s_branch gc_35
g_34F15_3:
    s_mov_b64 exec, vcc
    buffer_load_dwordx4 v[36:39], v2, s[4:7], s16 offen offset:3072 sc1
    s_mov_b64 exec, -1
    s_add_u32 s23, s23, 1
    s_cmp_lt_u32 s23, 200000
    s_cbranch_scc1 g_34L15_0
    s_mov_b32 s25, 200000
    s_branch gc_35
g_34F7_0:
    s_mov_b64 exec, vcc
    buffer_load_dwordx4 v[24:27], v2, s[4:7], s16 offen offset:0 sc1
    s_mov_b64 exec, -1
    s_add_u32 s23, s23, 1
    s_cmp_lt_u32 s23, 200000
    s_cbranch_scc1 g_34L7_1
    s_mov_b32 s25, 200000
    s_branch gc_35
g_34F7_1:
    s_mov_b64 exec, vcc
    buffer_load_dwordx4 v[28:31], v2, s[4:7], s16 offen offset:1024 sc1
    s_mov_b64 exec, -1
    s_add_u32 s23, s23, 1
    s_cmp_lt_u32 s23, 200000
    s_cbranch_scc1 g_34L7_2
    s_mov_b32 s25, 200000
    s_branch gc_35
g_34F7_2:
    s_mov_b64 exec, vcc
    buffer_load_dwordx4 v[32:35], v2, s[4:7], s16 offen offset:2048 sc1
    s_mov_b64 exec, -1
    s_add_u32 s23, s23, 1
    s_cmp_lt_u32 s23, 200000
    s_cbranch_scc1 g_34L7_0
    s_mov_b32 s25, 200000
    s_branch gc_35
g_34F11_0:
    s_mov_b64 exec, vcc
    buffer_load_dwordx4 v[24:27], v2, s[4:7], s16 offen offset:0 sc1
    s_mov_b64 exec, -1
    s_add_u32 s23, s23, 1
    s_cmp_lt_u32 s23, 200000
    s_cbranch_scc1 g_34L11_1
    s_mov_b32 s25, 200000
    s_branch gc_35
g_34F11_1:
    s_mov_b64 exec, vcc
    buffer_load_dwordx4 v[28:31], v2, s[4:7], s16 offen offset:1024 sc1
    s_mov_b64 exec, -1
    s_add_u32 s23, s23, 1
    s_cmp_lt_u32 s23, 200000
    s_cbranch_scc1 g_34L11_3
    s_mov_b32 s25, 200000
    s_branch gc_35
g_34F11_3:
    s_mov_b64 exec, vcc
    buffer_load_dwordx4 v[36:39], v2, s[4:7], s16 offen offset:3072 sc1
    s_mov_b64 exec, -1
    s_add_u32 s23, s23, 1
    s_cmp_lt_u32 s23, 200000
    s_cbranch_scc1 g_34L11_0
    s_mov_b32 s25, 200000
    s_branch gc_35
g_34F13_0:
    s_mov_b64 exec, vcc
    buffer_load_dwordx4 v[24:27], v2, s[4:7], s16 offen offset:0 sc1
    s_mov_b64 exec, -1
    s_add_u32 s23, s23, 1
    s_cmp_lt_u32 s23, 200000
    s_cbranch_scc1 g_34L13_2
    s_mov_b32 s25, 200000
    s_branch gc_35
g_34F13_2:
    s_mov_b64 exec, vcc
    buffer_load_dwordx4 v[32:35], v2, s[4:7], s16 offen offset:2048 sc1
    s_mov_b64 exec, -1
    s_add_u32 s23, s23, 1
    s_cmp_lt_u32 s23, 200000
    s_cbranch_scc1 g_34L13_3
    s_mov_b32 s25, 200000
    s_branch gc_35
g_34F13_3:
    s_mov_b64 exec, vcc
    buffer_load_dwordx4 v[36:39], v2, s[4:7], s16 offen offset:3072 sc1
    s_mov_b64 exec, -1
    s_add_u32 s23, s23, 1
    s_cmp_lt_u32 s23, 200000
    s_cbranch_scc1 g_34L13_0
    s_mov_b32 s25, 200000
    s_branch gc_35
g_34F14_1:
    s_mov_b64 exec, vcc
    buffer_load_dwordx4 v[28:31], v2, s[4:7], s16 offen offset:1024 sc1
    s_mov_b64 exec, -1
    s_add_u32 s23, s23, 1
    s_cmp_lt_u32 s23, 200000
    s_cbranch_scc1 g_34L14_2
    s_mov_b32 s25, 200000
    s_branch gc_35
g_34F14_2:
    s_mov_b64 exec, vcc
    buffer_load_dwordx4 v[32:35], v2, s[4:7], s16 offen offset:2048 sc1
    s_mov_b64 exec, -1
    s_add_u32 s23, s23, 1
    s_cmp_lt_u32 s23, 200000
    s_cbranch_scc1 g_34L14_3
    s_mov_b32 s25, 200000
    s_branch gc_35
g_34F14_3:
    s_mov_b64 exec, vcc
    buffer_load_dwordx4 v[36:39], v2, s[4:7], s16 offen offset:3072 sc1
    s_mov_b64 exec, -1
    s_add_u32 s23, s23, 1
    s_cmp_lt_u32 s23, 200000
    s_cbranch_scc1 g_34L14_1
    s_mov_b32 s25, 200000
    s_branch gc_35
g_34F3_0:
    s_mov_b64 exec, vcc
    buffer_load_dwordx4 v[24:27], v2, s[4:7], s16 offen offset:0 sc1
    s_mov_b64 exec, -1
    s_add_u32 s23, s23, 1
    s_cmp_lt_u32 s23, 200000
    s_cbranch_scc1 g_34L3_1
    s_mov_b32 s25, 200000
    s_branch gc_35
g_34F3_1:
    s_mov_b64 exec, vcc
    buffer_load_dwordx4 v[28:31], v2, s[4:7], s16 offen offset:1024 sc1
    s_mov_b64 exec, -1
    s_add_u32 s23, s23, 1
    s_cmp_lt_u32 s23, 200000
    s_cbranch_scc1 g_34L3_0
    s_mov_b32 s25, 200000
    s_branch gc_35
g_34F5_0:
    s_mov_b64 exec, vcc
    buffer_load_dwordx4 v[24:27], v2, s[4:7], s16 offen offset:0 sc1
    s_mov_b64 exec, -1
    s_add_u32 s23, s23, 1
    s_cmp_lt_u32 s23, 200000
    s_cbranch_scc1 g_34L5_2
    s_mov_b32 s25, 200000
    s_branch gc_35
g_34F5_2:
    s_mov_b64 exec, vcc
    buffer_load_dwordx4 v[32:35], v2, s[4:7], s16 offen offset:2048 sc1
    s_mov_b64 exec, -1
    s_add_u32 s23, s23, 1
    s_cmp_lt_u32 s23, 200000
    s_cbranch_scc1 g_34L5_0
    s_mov_b32 s25, 200000
    s_branch gc_35
g_34F6_1:
    s_mov_b64 exec, vcc
    buffer_load_dwordx4 v[28:31], v2, s[4:7], s16 offen offset:1024 sc1
    s_mov_b64 exec, -1
    s_add_u32 s23, s23, 1
    s_cmp_lt_u32 s23, 200000
    s_cbranch_scc1 g_34L6_2
    s_mov_b32 s25, 200000
    s_branch gc_35
g_34F6_2:
    s_mov_b64 exec, vcc
    buffer_load_dwordx4 v[32:35], v2, s[4:7], s16 offen offset:2048 sc1
    s_mov_b64 exec, -1
    s_add_u32 s23, s23, 1
    s_cmp_lt_u32 s23, 200000
    s_cbranch_scc1 g_34L6_1
    s_mov_b32 s25, 200000
    s_branch gc_35
g_34F9_0:
    s_mov_b64 exec, vcc
    buffer_load_dwordx4 v[24:27], v2, s[4:7], s16 offen offset:0 sc1
    s_mov_b64 exec, -1
    s_add_u32 s23, s23, 1
    s_cmp_lt_u32 s23, 200000
    s_cbranch_scc1 g_34L9_3
    s_mov_b32 s25, 200000
    s_branch gc_35
g_34F9_3:
    s_mov_b64 exec, vcc
    buffer_load_dwordx4 v[36:39], v2, s[4:7], s16 offen offset:3072 sc1
    s_mov_b64 exec, -1
    s_add_u32 s23, s23, 1
    s_cmp_lt_u32 s23, 200000
    s_cbranch_scc1 g_34L9_0
    s_mov_b32 s25, 200000
    s_branch gc_35
g_34F10_1:
    s_mov_b64 exec, vcc
    buffer_load_dwordx4 v[28:31], v2, s[4:7], s16 offen offset:1024 sc1
    s_mov_b64 exec, -1
    s_add_u32 s23, s23, 1
    s_cmp_lt_u32 s23, 200000
    s_cbranch_scc1 g_34L10_3
    s_mov_b32 s25, 200000
    s_branch gc_35
g_34F10_3:
    s_mov_b64 exec, vcc
    buffer_load_dwordx4 v[36:39], v2, s[4:7], s16 offen offset:3072 sc1
    s_mov_b64 exec, -1
    s_add_u32 s23, s23, 1
    s_cmp_lt_u32 s23, 200000
    s_cbranch_scc1 g_34L10_1
    s_mov_b32 s25, 200000
    s_branch gc_35
g_34F12_2:
    s_mov_b64 exec, vcc
    buffer_load_dwordx4 v[32:35], v2, s[4:7], s16 offen offset:2048 sc1
    s_mov_b64 exec, -1
    s_add_u32 s23, s23, 1
    s_cmp_lt_u32 s23, 200000
    s_cbranch_scc1 g_34L12_3
    s_mov_b32 s25, 200000
    s_branch gc_35
g_34F12_3:
    s_mov_b64 exec, vcc
    buffer_load_dwordx4 v[36:39], v2, s[4:7], s16 offen offset:3072 sc1
    s_mov_b64 exec, -1
    s_add_u32 s23, s23, 1
    s_cmp_lt_u32 s23, 200000
    s_cbranch_scc1 g_34L12_2
    s_mov_b32 s25, 200000
    s_branch gc_35
g_34F1_0:
    s_mov_b64 exec, vcc
    buffer_load_dwordx4 v[24:27], v2, s[4:7], s16 offen offset:0 sc1
    s_mov_b64 exec, -1
    s_add_u32 s23, s23, 1
    s_cmp_lt_u32 s23, 200000
    s_cbranch_scc1 g_34L1_0
    s_mov_b32 s25, 200000
    s_branch gc_35
g_34F2_1:
    s_mov_b64 exec, vcc
    buffer_load_dwordx4 v[28:31], v2, s[4:7], s16 offen offset:1024 sc1
    s_mov_b64 exec, -1
    s_add_u32 s23, s23, 1
    s_cmp_lt_u32 s23, 200000
    s_cbranch_scc1 g_34L2_1
    s_mov_b32 s25, 200000
    s_branch gc_35
g_34F4_2:
    s_mov_b64 exec, vcc
    buffer_load_dwordx4 v[32:35], v2, s[4:7], s16 offen offset:2048 sc1
    s_mov_b64 exec, -1
    s_add_u32 s23, s23, 1
    s_cmp_lt_u32 s23, 200000
    s_cbranch_scc1 g_34L4_2
    s_mov_b32 s25, 200000
    s_branch gc_35
g_34F8_3:
    s_mov_b64 exec, vcc
    buffer_load_dwordx4 v[36:39], v2, s[4:7], s16 offen offset:3072 sc1
    s_mov_b64 exec, -1
    s_add_u32 s23, s23, 1
    s_cmp_lt_u32 s23, 200000
    s_cbranch_scc1 g_34L8_3
    s_mov_b32 s25, 200000
    s_branch gc_35
sb_37:
    v_max3_u32 v19, v24, v25, v26
    v_max3_u32 v19, v19, v27, v28
    v_max3_u32 v19, v19, v29, v30
    v_max3_u32 v19, v19, v31, v32
    v_max3_u32 v19, v19, v33, v34
    v_max3_u32 v19, v19, v35, v36
    v_max3_u32 v19, v19, v37, v38
    v_max3_u32 v19, v19, v39, v40
    v_max3_u32 v19, v19, v41, v42
    v_max_u32 v19, v19, v43
    v_cmp_eq_u32 vcc, -1, v19
    s_nop 0
    s_cbranch_vccz sg_38
    buffer_load_dwordx4 v[24:27], v5, s[4:7], s16 offen offset:0 sc1
    buffer_load_dwordx4 v[28:31], v5, s[4:7], s16 offen offset:1024 sc1
    buffer_load_dwordx4 v[32:35], v5, s[4:7], s16 offen offset:2048 sc1
    buffer_load_dwordx4 v[36:39], v5, s[4:7], s16 offen offset:3072 sc1
    buffer_load_dword v40, v6, s[4:7], s16 offen offset:0 sc1
    buffer_load_dword v41, v6, s[4:7], s16 offen offset:256 sc1
    buffer_load_dword v42, v6, s[4:7], s16 offen offset:512 sc1
    buffer_load_dword v43, v6, s[4:7], s16 offen offset:768 sc1
    s_add_u32 s23, s23, 1
    s_cmp_lt_u32 s23, 200000
    s_cbranch_scc1 ss_36
    s_mov_b32 s25, 200000
    s_branch sg_38
ss_36:
    s_waitcnt vmcnt(6)
    v_pk_add_f32 v[180:181], v[24:25], v[28:29]
    v_pk_add_f32 v[182:183], v[26:27], v[30:31]
    s_waitcnt vmcnt(4)
    v_pk_add_f32 v[188:189], v[32:33], v[36:37]
    v_pk_add_f32 v[190:191], v[34:35], v[38:39]
    v_pk_add_f32 v[180:181], v[180:181], v[188:189]
    v_pk_add_f32 v[182:183], v[182:183], v[190:191]
    v_pk_add_f32 v[188:189], v[180:181], v[182:183]
    v_max3_f32 v185, v180, v181, v182
    s_waitcnt vmcnt(0)
    v_pk_add_f32 v[192:193], v[40:41], v[42:43]
    v_add_f32 v188, v188, v189
    v_add_f32 v184, v192, v193
    v_max3_f32 v185, v185, v183, v184
    v_cmp_u_f32 vcc, v188, v184
    s_nop 0
    v_max_f32_dpp v185, v185, v185 row_ror:8 row_mask:0xf bank_mask:0xf
    v_mov_b32 v186, v185
    s_nop 1
    v_permlane16_swap_b32 v185, v186
    v_max_f32 v185, v185, v186
    v_mov_b32 v186, v185
    s_cbranch_vccnz sb_37
    s_branch sg_38
g_39L15_0:
    s_waitcnt vmcnt(3)
    v_max3_u32 v19, v24, v25, v26
    v_max_u32 v19, v19, v27
    v_cmp_eq_u32 vcc, -1, v19
    s_nop 0
    s_cbranch_vccnz g_39F15_0
    v_smfmac_f32_16x16x64_bf16 v[64:67], v[24:27], a[192:199], v172
    v_smfmac_f32_16x16x64_bf16 v[68:71], v[24:27], a[224:231], v172
g_39L14_1:
    s_waitcnt vmcnt(2)
    v_max3_u32 v19, v28, v29, v30
    v_max_u32 v19, v19, v31
    v_cmp_eq_u32 vcc, -1, v19
    s_nop 0
    s_cbranch_vccnz g_39F14_1
    v_smfmac_f32_16x16x64_bf16 v[64:67], v[28:31], a[200:207], v172
    v_smfmac_f32_16x16x64_bf16 v[68:71], v[28:31], a[232:239], v172
g_39L12_2:
    s_waitcnt vmcnt(1)
    v_max3_u32 v19, v32, v33, v34
    v_max_u32 v19, v19, v35
    v_cmp_eq_u32 vcc, -1, v19
    s_nop 0
    s_cbranch_vccnz g_39F12_2
    v_smfmac_f32_16x16x64_bf16 v[64:67], v[32:35], a[208:215], v172
    v_smfmac_f32_16x16x64_bf16 v[68:71], v[32:35], a[240:247], v172
g_39L8_3:
    s_waitcnt vmcnt(0)
    v_max3_u32 v19, v36, v37, v38
    v_max_u32 v19, v19, v39
    v_cmp_eq_u32 vcc, -1, v19
    s_nop 0
    s_cbranch_vccnz g_39F8_3
    v_smfmac_f32_16x16x64_bf16 v[64:67], v[36:39], a[216:223], v172
    v_smfmac_f32_16x16x64_bf16 v[68:71], v[36:39], a[248:255], v172
    s_nop 4
    v_cvt_pk_bf16_f32 v80, v64, v65
    v_cvt_pk_bf16_f32 v81, v66, v67
    s_nop 0
    v_cvt_pk_bf16_f32 v82, v68, v69
    v_cvt_pk_bf16_f32 v83, v70, v71
    ds_write_b128 v17, v[80:83] offset:9216
    s_branch gc_40
g_39L15_1:
    s_waitcnt vmcnt(3)
    v_max3_u32 v19, v28, v29, v30
    v_max_u32 v19, v19, v31
    v_cmp_eq_u32 vcc, -1, v19
    s_nop 0
    s_cbranch_vccnz g_39F15_1
    v_smfmac_f32_16x16x64_bf16 v[64:67], v[28:31], a[200:207], v172
    v_smfmac_f32_16x16x64_bf16 v[68:71], v[28:31], a[232:239], v172
g_39L13_2:
    s_waitcnt vmcnt(2)
    v_max3_u32 v19, v32, v33, v34
    v_max_u32 v19, v19, v35
    v_cmp_eq_u32 vcc, -1, v19
    s_nop 0
    s_cbranch_vccnz g_39F13_2
    v_smfmac_f32_16x16x64_bf16 v[64:67], v[32:35], a[208:215], v172
    v_smfmac_f32_16x16x64_bf16 v[68:71], v[32:35], a[240:247], v172
g_39L9_3:
    s_waitcnt vmcnt(1)
    v_max3_u32 v19, v36, v37, v38
    v_max_u32 v19, v19, v39
    v_cmp_eq_u32 vcc, -1, v19
    s_nop 0
    s_cbranch_vccnz g_39F9_3
    v_smfmac_f32_16x16x64_bf16 v[64:67], v[36:39], a[216:223], v172
    v_smfmac_f32_16x16x64_bf16 v[68:71], v[36:39], a[248:255], v172
g_39L1_0:
    s_waitcnt vmcnt(0)
    v_max3_u32 v19, v24, v25, v26
    v_max_u32 v19, v19, v27
    v_cmp_eq_u32 vcc, -1, v19
    s_nop 0
    s_cbranch_vccnz g_39F1_0
    v_smfmac_f32_16x16x64_bf16 v[64:67], v[24:27], a[192:199], v172
    v_smfmac_f32_16x16x64_bf16 v[68:71], v[24:27], a[224:231], v172
    s_nop 4
    v_cvt_pk_bf16_f32 v80, v64, v65
    v_cvt_pk_bf16_f32 v81, v66, v67
    s_nop 0
    v_cvt_pk_bf16_f32 v82, v68, v69
    v_cvt_pk_bf16_f32 v83, v70, v71
    ds_write_b128 v17, v[80:83] offset:9216
    s_branch gc_40
g_39L15_2:
    s_waitcnt vmcnt(3)
    v_max3_u32 v19, v32, v33, v34
    v_max_u32 v19, v19, v35
    v_cmp_eq_u32 vcc, -1, v19
    s_nop 0
    s_cbranch_vccnz g_39F15_2
    v_smfmac_f32_16x16x64_bf16 v[64:67], v[32:35], a[208:215], v172
    v_smfmac_f32_16x16x64_bf16 v[68:71], v[32:35], a[240:247], v172
g_39L11_3:
    s_waitcnt vmcnt(2)
    v_max3_u32 v19, v36, v37, v38
    v_max_u32 v19, v19, v39
    v_cmp_eq_u32 vcc, -1, v19
    s_nop 0
    s_cbranch_vccnz g_39F11_3
    v_smfmac_f32_16x16x64_bf16 v[64:67], v[36:39], a[216:223], v172
    v_smfmac_f32_16x16x64_bf16 v[68:71], v[36:39], a[248:255], v172
g_39L3_0:
    s_waitcnt vmcnt(1)
    v_max3_u32 v19, v24, v25, v26
    v_max_u32 v19, v19, v27
    v_cmp_eq_u32 vcc, -1, v19
    s_nop 0
    s_cbranch_vccnz g_39F3_0
    v_smfmac_f32_16x16x64_bf16 v[64:67], v[24:27], a[192:199], v172
    v_smfmac_f32_16x16x64_bf16 v[68:71], v[24:27], a[224:231], v172
g_39L2_1:
    s_waitcnt vmcnt(0)
    v_max3_u32 v19, v28, v29, v30
    v_max_u32 v19, v19, v31
    v_cmp_eq_u32 vcc, -1, v19
    s_nop 0
    s_cbranch_vccnz g_39F2_1
    v_smfmac_f32_16x16x64_bf16 v[64:67], v[28:31], a[200:207], v172
    v_smfmac_f32_16x16x64_bf16 v[68:71], v[28:31], a[232:239], v172
    s_nop 4
    v_cvt_pk_bf16_f32 v80, v64, v65
    v_cvt_pk_bf16_f32 v81, v66, v67
    s_nop 0
    v_cvt_pk_bf16_f32 v82, v68, v69
    v_cvt_pk_bf16_f32 v83, v70, v71
    ds_write_b128 v17, v[80:83] offset:9216
    s_branch gc_40
g_39L15_3:
    s_waitcnt vmcnt(3)
    v_max3_u32 v19, v36, v37, v38
    v_max_u32 v19, v19, v39
    v_cmp_eq_u32 vcc, -1, v19
    s_nop 0
    s_cbranch_vccnz g_39F15_3
    v_smfmac_f32_16x16x64_bf16 v[64:67], v[36:39], a[216:223], v172
    v_smfmac_f32_16x16x64_bf16 v[68:71], v[36:39], a[248:255], v172
g_39L7_0:
    s_waitcnt vmcnt(2)
    v_max3_u32 v19, v24, v25, v26
    v_max_u32 v19, v19, v27
    v_cmp_eq_u32 vcc, -1, v19
    s_nop 0
    s_cbranch_vccnz g_39F7_0
    v_smfmac_f32_16x16x64_bf16 v[64:67], v[24:27], a[192:199], v172
    v_smfmac_f32_16x16x64_bf16 v[68:71], v[24:27], a[224:231], v172
g_39L6_1:
    s_waitcnt vmcnt(1)
    v_max3_u32 v19, v28, v29, v30
    v_max_u32 v19, v19, v31
    v_cmp_eq_u32 vcc, -1, v19
    s_nop 0
    s_cbranch_vccnz g_39F6_1
    v_smfmac_f32_16x16x64_bf16 v[64:67], v[28:31], a[200:207], v172
    v_smfmac_f32_16x16x64_bf16 v[68:71], v[28:31], a[232:239], v172
g_39L4_2:
    s_waitcnt vmcnt(0)
    v_max3_u32 v19, v32, v33, v34
    v_max_u32 v19, v19, v35
    v_cmp_eq_u32 vcc, -1, v19
    s_nop 0
    s_cbranch_vccnz g_39F4_2
    v_smfmac_f32_16x16x64_bf16 v[64:67], v[32:35], a[208:215], v172
    v_smfmac_f32_16x16x64_bf16 v[68:71], v[32:35], a[240:247], v172
    s_nop 4
    v_cvt_pk_bf16_f32 v80, v64, v65
    v_cvt_pk_bf16_f32 v81, v66, v67
    s_nop 0
    v_cvt_pk_bf16_f32 v82, v68, v69
    v_cvt_pk_bf16_f32 v83, v70, v71
    ds_write_b128 v17, v[80:83] offset:9216
    s_branch gc_40
g_39L7_1:
    s_waitcnt vmcnt(2)
    v_max3_u32 v19, v28, v29, v30
    v_max_u32 v19, v19, v31
    v_cmp_eq_u32 vcc, -1, v19
    s_nop 0
    s_cbranch_vccnz g_39F7_1
    v_smfmac_f32_16x16x64_bf16 v[64:67], v[28:31], a[200:207], v172
    v_smfmac_f32_16x16x64_bf16 v[68:71], v[28:31], a[232:239], v172
g_39L5_2:
    s_waitcnt vmcnt(1)
    v_max3_u32 v19, v32, v33, v34
    v_max_u32 v19, v19, v35
    v_cmp_eq_u32 vcc, -1, v19
    s_nop 0
    s_cbranch_vccnz g_39F5_2
    v_smfmac_f32_16x16x64_bf16 v[64:67], v[32:35], a[208:215], v172
    v_smfmac_f32_16x16x64_bf16 v[68:71], v[32:35], a[240:247], v172
    s_branch g_39L1_0
g_39L7_2:
    s_waitcnt vmcnt(2)
    v_max3_u32 v19, v32, v33, v34
    v_max_u32 v19, v19, v35
    v_cmp_eq_u32 vcc, -1, v19
    s_nop 0
    s_cbranch_vccnz g_39F7_2
    v_smfmac_f32_16x16x64_bf16 v[64:67], v[32:35], a[208:215], v172
    v_smfmac_f32_16x16x64_bf16 v[68:71], v[32:35], a[240:247], v172
    s_branch g_39L3_0
g_39L11_0:
    s_waitcnt vmcnt(2)
    v_max3_u32 v19, v24, v25, v26
    v_max_u32 v19, v19, v27
    v_cmp_eq_u32 vcc, -1, v19
    s_nop 0
    s_cbranch_vccnz g_39F11_0
    v_smfmac_f32_16x16x64_bf16 v[64:67], v[24:27], a[192:199], v172
    v_smfmac_f32_16x16x64_bf16 v[68:71], v[24:27], a[224:231], v172
g_39L10_1:
    s_waitcnt vmcnt(1)
    v_max3_u32 v19, v28, v29, v30
    v_max_u32 v19, v19, v31
    v_cmp_eq_u32 vcc, -1, v19
    s_nop 0
    s_cbranch_vccnz g_39F10_1
    v_smfmac_f32_16x16x64_bf16 v[64:67], v[28:31], a[200:207], v172
    v_smfmac_f32_16x16x64_bf16 v[68:71], v[28:31], a[232:239], v172
    s_branch g_39L8_3
g_39L11_1:
    s_waitcnt vmcnt(2)
    v_max3_u32 v19, v28, v29, v30
    v_max_u32 v19, v19, v31
    v_cmp_eq_u32 vcc, -1, v19
    s_nop 0
    s_cbranch_vccnz g_39F11_1
    v_smfmac_f32_16x16x64_bf16 v[64:67], v[28:31], a[200:207], v172
    v_smfmac_f32_16x16x64_bf16 v[68:71], v[28:31], a[232:239], v172
    s_branch g_39L9_3
g_39L13_0:
    s_waitcnt vmcnt(2)
    v_max3_u32 v19, v24, v25, v26
    v_max_u32 v19, v19, v27
    v_cmp_eq_u32 vcc, -1, v19
    s_nop 0
    s_cbranch_vccnz g_39F13_0
    v_smfmac_f32_16x16x64_bf16 v[64:67], v[24:27], a[192:199], v172
    v_smfmac_f32_16x16x64_bf16 v[68:71], v[24:27], a[224:231], v172
    s_branch g_39L12_2
g_39L13_3:
    s_waitcnt vmcnt(2)
    v_max3_u32 v19, v36, v37, v38
    v_max_u32 v19, v19, v39
    v_cmp_eq_u32 vcc, -1, v19
    s_nop 0
    s_cbranch_vccnz g_39F13_3
    v_smfmac_f32_16x16x64_bf16 v[64:67], v[36:39], a[216:223], v172
    v_smfmac_f32_16x16x64_bf16 v[68:71], v[36:39], a[248:255], v172
g_39L5_0:
    s_waitcnt vmcnt(1)
    v_max3_u32 v19, v24, v25, v26
    v_max_u32 v19, v19, v27
    v_cmp_eq_u32 vcc, -1, v19
    s_nop 0
    s_cbranch_vccnz g_39F5_0
    v_smfmac_f32_16x16x64_bf16 v[64:67], v[24:27], a[192:199], v172
    v_smfmac_f32_16x16x64_bf16 v[68:71], v[24:27], a[224:231], v172
    s_branch g_39L4_2
g_39L14_2:
    s_waitcnt vmcnt(2)
    v_max3_u32 v19, v32, v33, v34
    v_max_u32 v19, v19, v35
    v_cmp_eq_u32 vcc, -1, v19
    s_nop 0
    s_cbranch_vccnz g_39F14_2
    v_smfmac_f32_16x16x64_bf16 v[64:67], v[32:35], a[208:215], v172
    v_smfmac_f32_16x16x64_bf16 v[68:71], v[32:35], a[240:247], v172
g_39L10_3:
    s_waitcnt vmcnt(1)
    v_max3_u32 v19, v36, v37, v38
    v_max_u32 v19, v19, v39
    v_cmp_eq_u32 vcc, -1, v19
    s_nop 0
    s_cbranch_vccnz g_39F10_3
    v_smfmac_f32_16x16x64_bf16 v[64:67], v[36:39], a[216:223], v172
    v_smfmac_f32_16x16x64_bf16 v[68:71], v[36:39], a[248:255], v172
    s_branch g_39L2_1
g_39L14_3:
    s_waitcnt vmcnt(2)
    v_max3_u32 v19, v36, v37, v38
    v_max_u32 v19, v19, v39
    v_cmp_eq_u32 vcc, -1, v19
    s_nop 0
    s_cbranch_vccnz g_39F14_3
    v_smfmac_f32_16x16x64_bf16 v[64:67], v[36:39], a[216:223], v172
    v_smfmac_f32_16x16x64_bf16 v[68:71], v[36:39], a[248:255], v172
    s_branch g_39L6_1
g_39L3_1:
    s_waitcnt vmcnt(1)
    v_max3_u32 v19, v28, v29, v30
    v_max_u32 v19, v19, v31
    v_cmp_eq_u32 vcc, -1, v19
    s_nop 0
    s_cbranch_vccnz g_39F3_1
    v_smfmac_f32_16x16x64_bf16 v[64:67], v[28:31], a[200:207], v172
    v_smfmac_f32_16x16x64_bf16 v[68:71], v[28:31], a[232:239], v172
    s_branch g_39L1_0
g_39L6_2:
    s_waitcnt vmcnt(1)
    v_max3_u32 v19, v32, v33, v34
    v_max_u32 v19, v19, v35
    v_cmp_eq_u32 vcc, -1, v19
    s_nop 0
    s_cbranch_vccnz g_39F6_2
    v_smfmac_f32_16x16x64_bf16 v[64:67], v[32:35], a[208:215], v172
    v_smfmac_f32_16x16x64_bf16 v[68:71], v[32:35], a[240:247], v172
    s_branch g_39L2_1
g_39L9_0:
    s_waitcnt vmcnt(1)
    v_max3_u32 v19, v24, v25, v26
    v_max_u32 v19, v19, v27
    v_cmp_eq_u32 vcc, -1, v19
    s_nop 0
    s_cbranch_vccnz g_39F9_0
    v_smfmac_f32_16x16x64_bf16 v[64:67], v[24:27], a[192:199], v172
    v_smfmac_f32_16x16x64_bf16 v[68:71], v[24:27], a[224:231], v172
    s_branch g_39L8_3
g_39L12_3:
    s_waitcnt vmcnt(1)
    v_max3_u32 v19, v36, v37, v38
    v_max_u32 v19, v19, v39
    v_cmp_eq_u32 vcc, -1, v19
    s_nop 0
    s_cbranch_vccnz g_39F12_3
    v_smfmac_f32_16x16x64_bf16 v[64:67], v[36:39], a[216:223], v172
    v_smfmac_f32_16x16x64_bf16 v[68:71], v[36:39], a[248:255], v172
    s_branch g_39L4_2
g_39F15_0:
    s_mov_b64 exec, vcc
    buffer_load_dwordx4 v[24:27], v8, s[4:7], s16 offen offset:0 sc1
    s_mov_b64 exec, -1
    s_add_u32 s23, s23, 1
    s_cmp_lt_u32 s23, 200000
    s_cbranch_scc1 g_39L15_1
    s_mov_b32 s25, 200000
    s_branch gc_40
g_39F15_1:
    s_mov_b64 exec, vcc
    buffer_load_dwordx4 v[28:31], v8, s[4:7], s16 offen offset:1024 sc1
    s_mov_b64 exec, -1
    s_add_u32 s23, s23, 1
    s_cmp_lt_u32 s23, 200000
    s_cbranch_scc1 g_39L15_2
    s_mov_b32 s25, 200000
    s_branch gc_40
g_39F15_2:
    s_mov_b64 exec, vcc
    buffer_load_dwordx4 v[32:35], v8, s[4:7], s16 offen offset:2048 sc1
    s_mov_b64 exec, -1
    s_add_u32 s23, s23, 1
    s_cmp_lt_u32 s23, 200000
    s_cbranch_scc1 g_39L15_3
    s_mov_b32 s25, 200000
    s_branch gc_40
g_39F15_3:
    s_mov_b64 exec, vcc
    buffer_load_dwordx4 v[36:39], v8, s[4:7], s16 offen offset:3072 sc1
    s_mov_b64 exec, -1
    s_add_u32 s23, s23, 1
    s_cmp_lt_u32 s23, 200000
    s_cbranch_scc1 g_39L15_0
    s_mov_b32 s25, 200000
    s_branch gc_40
g_39F7_0:
    s_mov_b64 exec, vcc
    buffer_load_dwordx4 v[24:27], v8, s[4:7], s16 offen offset:0 sc1
    s_mov_b64 exec, -1
    s_add_u32 s23, s23, 1
    s_cmp_lt_u32 s23, 200000
    s_cbranch_scc1 g_39L7_1
    s_mov_b32 s25, 200000
    s_branch gc_40
g_39F7_1:
    s_mov_b64 exec, vcc
    buffer_load_dwordx4 v[28:31], v8, s[4:7], s16 offen offset:1024 sc1
    s_mov_b64 exec, -1
    s_add_u32 s23, s23, 1
    s_cmp_lt_u32 s23, 200000
    s_cbranch_scc1 g_39L7_2
    s_mov_b32 s25, 200000
    s_branch gc_40
g_39F7_2:
    s_mov_b64 exec, vcc
    buffer_load_dwordx4 v[32:35], v8, s[4:7], s16 offen offset:2048 sc1
    s_mov_b64 exec, -1
    s_add_u32 s23, s23, 1
    s_cmp_lt_u32 s23, 200000
    s_cbranch_scc1 g_39L7_0
    s_mov_b32 s25, 200000
    s_branch gc_40
g_39F11_0:
    s_mov_b64 exec, vcc
    buffer_load_dwordx4 v[24:27], v8, s[4:7], s16 offen offset:0 sc1
    s_mov_b64 exec, -1
    s_add_u32 s23, s23, 1
    s_cmp_lt_u32 s23, 200000
    s_cbranch_scc1 g_39L11_1
    s_mov_b32 s25, 200000
    s_branch gc_40
g_39F11_1:
    s_mov_b64 exec, vcc
    buffer_load_dwordx4 v[28:31], v8, s[4:7], s16 offen offset:1024 sc1
    s_mov_b64 exec, -1
    s_add_u32 s23, s23, 1
    s_cmp_lt_u32 s23, 200000
    s_cbranch_scc1 g_39L11_3
    s_mov_b32 s25, 200000
    s_branch gc_40
g_39F11_3:
    s_mov_b64 exec, vcc
    buffer_load_dwordx4 v[36:39], v8, s[4:7], s16 offen offset:3072 sc1
    s_mov_b64 exec, -1
    s_add_u32 s23, s23, 1
    s_cmp_lt_u32 s23, 200000
    s_cbranch_scc1 g_39L11_0
    s_mov_b32 s25, 200000
    s_branch gc_40
g_39F13_0:
    s_mov_b64 exec, vcc
    buffer_load_dwordx4 v[24:27], v8, s[4:7], s16 offen offset:0 sc1
    s_mov_b64 exec, -1
    s_add_u32 s23, s23, 1
    s_cmp_lt_u32 s23, 200000
    s_cbranch_scc1 g_39L13_2
    s_mov_b32 s25, 200000
    s_branch gc_40
g_39F13_2:
    s_mov_b64 exec, vcc
    buffer_load_dwordx4 v[32:35], v8, s[4:7], s16 offen offset:2048 sc1
    s_mov_b64 exec, -1
    s_add_u32 s23, s23, 1
    s_cmp_lt_u32 s23, 200000
    s_cbranch_scc1 g_39L13_3
    s_mov_b32 s25, 200000
    s_branch gc_40
g_39F13_3:
    s_mov_b64 exec, vcc
    buffer_load_dwordx4 v[36:39], v8, s[4:7], s16 offen offset:3072 sc1
    s_mov_b64 exec, -1
    s_add_u32 s23, s23, 1
    s_cmp_lt_u32 s23, 200000
    s_cbranch_scc1 g_39L13_0
    s_mov_b32 s25, 200000
    s_branch gc_40
g_39F14_1:
    s_mov_b64 exec, vcc
    buffer_load_dwordx4 v[28:31], v8, s[4:7], s16 offen offset:1024 sc1
    s_mov_b64 exec, -1
    s_add_u32 s23, s23, 1
    s_cmp_lt_u32 s23, 200000
    s_cbranch_scc1 g_39L14_2
    s_mov_b32 s25, 200000
    s_branch gc_40
g_39F14_2:
    s_mov_b64 exec, vcc
    buffer_load_dwordx4 v[32:35], v8, s[4:7], s16 offen offset:2048 sc1
    s_mov_b64 exec, -1
    s_add_u32 s23, s23, 1
    s_cmp_lt_u32 s23, 200000
    s_cbranch_scc1 g_39L14_3
    s_mov_b32 s25, 200000
    s_branch gc_40
g_39F14_3:
    s_mov_b64 exec, vcc
    buffer_load_dwordx4 v[36:39], v8, s[4:7], s16 offen offset:3072 sc1
    s_mov_b64 exec, -1
    s_add_u32 s23, s23, 1
    s_cmp_lt_u32 s23, 200000
    s_cbranch_scc1 g_39L14_1
    s_mov_b32 s25, 200000
    s_branch gc_40
g_39F3_0:
    s_mov_b64 exec, vcc
    buffer_load_dwordx4 v[24:27], v8, s[4:7], s16 offen offset:0 sc1
    s_mov_b64 exec, -1
    s_add_u32 s23, s23, 1
    s_cmp_lt_u32 s23, 200000
    s_cbranch_scc1 g_39L3_1
    s_mov_b32 s25, 200000
    s_branch gc_40
g_39F3_1:
    s_mov_b64 exec, vcc
    buffer_load_dwordx4 v[28:31], v8, s[4:7], s16 offen offset:1024 sc1
    s_mov_b64 exec, -1
    s_add_u32 s23, s23, 1
    s_cmp_lt_u32 s23, 200000
    s_cbranch_scc1 g_39L3_0
    s_mov_b32 s25, 200000
    s_branch gc_40
g_39F5_0:
    s_mov_b64 exec, vcc
    buffer_load_dwordx4 v[24:27], v8, s[4:7], s16 offen offset:0 sc1
    s_mov_b64 exec, -1
    s_add_u32 s23, s23, 1
    s_cmp_lt_u32 s23, 200000
    s_cbranch_scc1 g_39L5_2
    s_mov_b32 s25, 200000
    s_branch gc_40
g_39F5_2:
    s_mov_b64 exec, vcc
    buffer_load_dwordx4 v[32:35], v8, s[4:7], s16 offen offset:2048 sc1
    s_mov_b64 exec, -1
    s_add_u32 s23, s23, 1
    s_cmp_lt_u32 s23, 200000
    s_cbranch_scc1 g_39L5_0
    s_mov_b32 s25, 200000
    s_branch gc_40
g_39F6_1:
    s_mov_b64 exec, vcc
    buffer_load_dwordx4 v[28:31], v8, s[4:7], s16 offen offset:1024 sc1
    s_mov_b64 exec, -1
    s_add_u32 s23, s23, 1
    s_cmp_lt_u32 s23, 200000
    s_cbranch_scc1 g_39L6_2
    s_mov_b32 s25, 200000
    s_branch gc_40
g_39F6_2:
    s_mov_b64 exec, vcc
    buffer_load_dwordx4 v[32:35], v8, s[4:7], s16 offen offset:2048 sc1
    s_mov_b64 exec, -1
    s_add_u32 s23, s23, 1
    s_cmp_lt_u32 s23, 200000
    s_cbranch_scc1 g_39L6_1
    s_mov_b32 s25, 200000
    s_branch gc_40
g_39F9_0:
    s_mov_b64 exec, vcc
    buffer_load_dwordx4 v[24:27], v8, s[4:7], s16 offen offset:0 sc1
    s_mov_b64 exec, -1
    s_add_u32 s23, s23, 1
    s_cmp_lt_u32 s23, 200000
    s_cbranch_scc1 g_39L9_3
    s_mov_b32 s25, 200000
    s_branch gc_40
g_39F9_3:
    s_mov_b64 exec, vcc
    buffer_load_dwordx4 v[36:39], v8, s[4:7], s16 offen offset:3072 sc1
    s_mov_b64 exec, -1
    s_add_u32 s23, s23, 1
    s_cmp_lt_u32 s23, 200000
    s_cbranch_scc1 g_39L9_0
    s_mov_b32 s25, 200000
    s_branch gc_40
g_39F10_1:
    s_mov_b64 exec, vcc
    buffer_load_dwordx4 v[28:31], v8, s[4:7], s16 offen offset:1024 sc1
    s_mov_b64 exec, -1
    s_add_u32 s23, s23, 1
    s_cmp_lt_u32 s23, 200000
    s_cbranch_scc1 g_39L10_3
    s_mov_b32 s25, 200000
    s_branch gc_40
g_39F10_3:
    s_mov_b64 exec, vcc
    buffer_load_dwordx4 v[36:39], v8, s[4:7], s16 offen offset:3072 sc1
    s_mov_b64 exec, -1
    s_add_u32 s23, s23, 1
    s_cmp_lt_u32 s23, 200000
    s_cbranch_scc1 g_39L10_1
    s_mov_b32 s25, 200000
    s_branch gc_40
g_39F12_2:
    s_mov_b64 exec, vcc
    buffer_load_dwordx4 v[32:35], v8, s[4:7], s16 offen offset:2048 sc1
    s_mov_b64 exec, -1
    s_add_u32 s23, s23, 1
    s_cmp_lt_u32 s23, 200000
    s_cbranch_scc1 g_39L12_3
    s_mov_b32 s25, 200000
    s_branch gc_40
g_39F12_3:
    s_mov_b64 exec, vcc
    buffer_load_dwordx4 v[36:39], v8, s[4:7], s16 offen offset:3072 sc1
    s_mov_b64 exec, -1
    s_add_u32 s23, s23, 1
    s_cmp_lt_u32 s23, 200000
    s_cbranch_scc1 g_39L12_2
    s_mov_b32 s25, 200000
    s_branch gc_40
g_39F1_0:
    s_mov_b64 exec, vcc
    buffer_load_dwordx4 v[24:27], v8, s[4:7], s16 offen offset:0 sc1
    s_mov_b64 exec, -1
    s_add_u32 s23, s23, 1
    s_cmp_lt_u32 s23, 200000
    s_cbranch_scc1 g_39L1_0
    s_mov_b32 s25, 200000
    s_branch gc_40
g_39F2_1:
    s_mov_b64 exec, vcc
    buffer_load_dwordx4 v[28:31], v8, s[4:7], s16 offen offset:1024 sc1
    s_mov_b64 exec, -1
    s_add_u32 s23, s23, 1
    s_cmp_lt_u32 s23, 200000
    s_cbranch_scc1 g_39L2_1
    s_mov_b32 s25, 200000
    s_branch gc_40
g_39F4_2:
    s_mov_b64 exec, vcc
    buffer_load_dwordx4 v[32:35], v8, s[4:7], s16 offen offset:2048 sc1
    s_mov_b64 exec, -1
    s_add_u32 s23, s23, 1
    s_cmp_lt_u32 s23, 200000
    s_cbranch_scc1 g_39L4_2
    s_mov_b32 s25, 200000
    s_branch gc_40
g_39F8_3:
    s_mov_b64 exec, vcc
    buffer_load_dwordx4 v[36:39], v8, s[4:7], s16 offen offset:3072 sc1
    s_mov_b64 exec, -1
    s_add_u32 s23, s23, 1
    s_cmp_lt_u32 s23, 200000
    s_cbranch_scc1 g_39L8_3
    s_mov_b32 s25, 200000
    s_branch gc_40
.p2align 6
recur_fast_w2:
    s_nop 15
    s_mov_b32 s23, s25
    buffer_load_dwordx4 v[24:27], v2, s[4:7], s16 offen offset:0 sc1
    s_nop 11
    buffer_load_dwordx4 v[28:31], v2, s[4:7], s16 offen offset:1024 sc1
    s_nop 11
    buffer_load_dwordx4 v[32:35], v2, s[4:7], s16 offen offset:2048 sc1
    s_nop 11
    buffer_load_dwordx4 v[36:39], v2, s[4:7], s16 offen offset:3072 sc1
    s_waitcnt vmcnt(3)
    v_max3_u32 v19, v24, v25, v26
    v_max_u32 v19, v19, v27
    v_cmp_eq_u32 vcc, -1, v19
    s_nop 0
    s_cbranch_vccnz g_43F15_0
    v_smfmac_f32_16x16x64_bf16 v[40:43], v[24:27], a[0:7], v172
    s_waitcnt vmcnt(2)
    v_max3_u32 v19, v28, v29, v30
    v_max_u32 v19, v19, v31
    v_smfmac_f32_16x16x64_bf16 v[44:47], v[24:27], a[64:71], v172
    v_cmp_eq_u32 vcc, -1, v19
    v_smfmac_f32_16x16x64_bf16 v[48:51], v[24:27], a[32:39], v172
    v_smfmac_f32_16x16x64_bf16 v[52:55], v[24:27], a[96:103], v172
    s_cbranch_vccnz g_43F14_1
    v_smfmac_f32_16x16x64_bf16 v[40:43], v[28:31], a[8:15], v172
    s_waitcnt vmcnt(1)
    v_max3_u32 v19, v32, v33, v34
    v_max_u32 v19, v19, v35
    v_smfmac_f32_16x16x64_bf16 v[44:47], v[28:31], a[72:79], v172
    v_cmp_eq_u32 vcc, -1, v19
    v_smfmac_f32_16x16x64_bf16 v[48:51], v[28:31], a[40:47], v172
    v_smfmac_f32_16x16x64_bf16 v[52:55], v[28:31], a[104:111], v172
    s_cbranch_vccnz g_43F12_2
    v_smfmac_f32_16x16x64_bf16 v[40:43], v[32:35], a[16:23], v172
    s_waitcnt vmcnt(0)
    v_max3_u32 v19, v36, v37, v38
    v_max_u32 v19, v19, v39
    v_smfmac_f32_16x16x64_bf16 v[44:47], v[32:35], a[80:87], v172
    v_cmp_eq_u32 vcc, -1, v19
    v_smfmac_f32_16x16x64_bf16 v[48:51], v[32:35], a[48:55], v172
    v_smfmac_f32_16x16x64_bf16 v[52:55], v[32:35], a[112:119], v172
    s_cbranch_vccnz g_43F8_3
    v_smfmac_f32_16x16x64_bf16 v[40:43], v[36:39], a[24:31], v172
    v_smfmac_f32_16x16x64_bf16 v[44:47], v[36:39], a[88:95], v172
    v_smfmac_f32_16x16x64_bf16 v[48:51], v[36:39], a[56:63], v172
    v_smfmac_f32_16x16x64_bf16 v[52:55], v[36:39], a[120:127], v172
gc_44:
    v_cvt_pk_bf16_f32 v72, v40, v41
    v_cvt_pk_bf16_f32 v73, v42, v43
    v_cvt_pk_bf16_f32 v74, v44, v45
    v_cvt_pk_bf16_f32 v75, v46, v47
    ds_write_b128 v17, v[72:75] offset:0
    v_cvt_pk_bf16_f32 v76, v48, v49
    v_cvt_pk_bf16_f32 v77, v50, v51
    s_nop 0
    v_cvt_pk_bf16_f32 v78, v52, v53
    v_cvt_pk_bf16_f32 v79, v54, v55
    ds_write_b128 v17, v[76:79] offset:1024
    v_smfmac_f32_16x16x64_bf16 v[56:59], v[24:27], a[128:135], v172
    v_smfmac_f32_16x16x64_bf16 v[60:63], v[24:27], a[160:167], v172
    v_smfmac_f32_16x16x64_bf16 v[56:59], v[28:31], a[136:143], v172
    s_waitcnt lgkmcnt(0)
    s_barrier
    v_smfmac_f32_16x16x64_bf16 v[60:63], v[28:31], a[168:175], v172
    v_smfmac_f32_16x16x64_bf16 v[56:59], v[32:35], a[144:151], v172
    v_smfmac_f32_16x16x64_bf16 v[60:63], v[32:35], a[176:183], v172
    v_smfmac_f32_16x16x64_bf16 v[56:59], v[36:39], a[152:159], v172
    v_smfmac_f32_16x16x64_bf16 v[60:63], v[36:39], a[184:191], v172
    s_nop 4
    v_cvt_pk_bf16_f32 v80, v56, v57
    v_cvt_pk_bf16_f32 v81, v58, v59
    s_nop 0
    v_cvt_pk_bf16_f32 v82, v60, v61
    v_cvt_pk_bf16_f32 v83, v62, v63
    ds_write_b128 v17, v[80:83] offset:8192
    s_cmp_eq_u32 s15, 63
    s_waitcnt lgkmcnt(0)
    s_barrier
    ds_read_b128 v[96:99], v16 offset:8192
    ds_read_b128 v[100:103], v16 offset:10240
    ds_read_b128 v[108:111], v16 offset:14336
    v_mfma_f32_16x16x32_bf16 v[140:143], v[84:87], v[80:83], 0
    s_waitcnt lgkmcnt(2)
    v_mfma_f32_16x16x32_bf16 v[140:143], v[84:87], v[96:99], v[140:143]
    s_waitcnt lgkmcnt(1)
    v_mfma_f32_16x16x32_bf16 v[140:143], v[84:87], v[100:103], v[140:143]
    s_waitcnt lgkmcnt(0)
    v_mfma_f32_16x16x32_bf16 v[140:143], v[84:87], v[108:111], v[140:143]
    s_nop 7
    v_cvt_pk_bf16_f32 v168, v140, v141
    v_cvt_pk_bf16_f32 v169, v142, v143
    v_mov_b32 v170, v168
    v_mov_b32 v171, v169
    s_nop 0
    v_permlane16_swap_b32 v168, v170
    v_permlane16_swap_b32 v169, v171
    v_mov_b32 v247, s15
    s_cbranch_scc1 recur_fast_last2
    s_barrier
    s_nop 15
    s_mov_b32 s23, s25
    buffer_load_dwordx4 v[24:27], v8, s[4:7], s16 offen offset:0 sc1
    s_nop 11
    buffer_load_dwordx4 v[28:31], v8, s[4:7], s16 offen offset:1024 sc1
    s_nop 11
    buffer_load_dwordx4 v[32:35], v8, s[4:7], s16 offen offset:2048 sc1
    s_nop 11
    buffer_load_dwordx4 v[36:39], v8, s[4:7], s16 offen offset:3072 sc1
    s_waitcnt vmcnt(3)
    v_max3_u32 v19, v24, v25, v26
    v_max_u32 v19, v19, v27
    v_cmp_eq_u32 vcc, -1, v19
    s_nop 0
    s_cbranch_vccnz g_45F15_0
    v_smfmac_f32_16x16x64_bf16 v[64:67], v[24:27], a[192:199], v172
    v_smfmac_f32_16x16x64_bf16 v[68:71], v[24:27], a[224:231], v172
    s_waitcnt vmcnt(2)
    v_max3_u32 v19, v28, v29, v30
    v_max_u32 v19, v19, v31
    v_cmp_eq_u32 vcc, -1, v19
    s_nop 0
    s_cbranch_vccnz g_45F14_1
    v_smfmac_f32_16x16x64_bf16 v[64:67], v[28:31], a[200:207], v172
    v_smfmac_f32_16x16x64_bf16 v[68:71], v[28:31], a[232:239], v172
    s_waitcnt vmcnt(1)
    v_max3_u32 v19, v32, v33, v34
    v_max_u32 v19, v19, v35
    v_cmp_eq_u32 vcc, -1, v19
    s_nop 0
    s_cbranch_vccnz g_45F12_2
    v_smfmac_f32_16x16x64_bf16 v[64:67], v[32:35], a[208:215], v172
    v_smfmac_f32_16x16x64_bf16 v[68:71], v[32:35], a[240:247], v172
    s_waitcnt vmcnt(0)
    v_max3_u32 v19, v36, v37, v38
    v_max_u32 v19, v19, v39
    v_cmp_eq_u32 vcc, -1, v19
    s_nop 0
    s_cbranch_vccnz g_45F8_3
    v_smfmac_f32_16x16x64_bf16 v[64:67], v[36:39], a[216:223], v172
    v_smfmac_f32_16x16x64_bf16 v[68:71], v[36:39], a[248:255], v172
    s_nop 4
    v_cvt_pk_bf16_f32 v80, v64, v65
    v_cvt_pk_bf16_f32 v81, v66, v67
    s_nop 0
    v_cvt_pk_bf16_f32 v82, v68, v69
    v_cvt_pk_bf16_f32 v83, v70, v71
    ds_write_b128 v17, v[80:83] offset:9216
gc_46:
    s_waitcnt lgkmcnt(0)
    s_barrier
    s_nop 15
    s_nop 15
    s_nop 15
    s_nop 15
    buffer_store_dwordx4 v[168:171], v15, s[4:7], s20 offen sc1
    s_add_u32 s20, s20, 512
    s_add_u32 s21, s95, 1048576
    s_lshr_b32 s22, s21, 8
    s_and_b32 s22, s22, 8192
    s_xor_b32 s22, s22, s46
    s_add_u32 s21, s21, s22
    buffer_store_dwordx4 v[204:207], v9, s[4:7], s21 offen sc1
    s_add_u32 s21, s21, 262144
    buffer_store_dword v247, v246, s[4:7], 0 offen sc1
    v_mov_b32 v40, 0
    v_mov_b32 v41, 0
    v_mov_b32 v42, 0
    v_mov_b32 v43, 0
    v_mov_b32 v44, 0
    v_mov_b32 v45, 0
    v_mov_b32 v46, 0
    v_mov_b32 v47, 0
    v_mov_b32 v48, 0
    v_mov_b32 v49, 0
    v_mov_b32 v50, 0
    v_mov_b32 v51, 0
    v_mov_b32 v52, 0
    v_mov_b32 v53, 0
    v_mov_b32 v54, 0
    v_mov_b32 v55, 0
    v_mov_b32 v56, 0
    v_mov_b32 v57, 0
    v_mov_b32 v58, 0
    v_mov_b32 v59, 0
    v_mov_b32 v60, 0
    v_mov_b32 v61, 0
    v_mov_b32 v62, 0
    v_mov_b32 v63, 0
    v_mov_b32 v64, 0
    v_mov_b32 v65, 0
    v_mov_b32 v66, 0
    v_mov_b32 v67, 0
    v_mov_b32 v68, 0
    v_mov_b32 v69, 0
    v_mov_b32 v70, 0
    v_mov_b32 v71, 0
    s_mov_b32 s21, s16
    s_mov_b32 s16, s42
    s_mov_b32 s42, s43
    s_mov_b32 s43, s44
    s_mov_b32 s44, s21
    s_add_u32 s95, s95, 524288
    s_lshr_b32 s84, s95, 8
    s_and_b32 s84, s84, 8192
    s_xor_b32 s84, s84, s46
    s_add_u32 s84, s84, s95
    s_add_u32 s15, s15, 1
    s_barrier
    s_branch recur_fast_w2
g_43L15_0:
    s_waitcnt vmcnt(3)
    v_max3_u32 v19, v24, v25, v26
    v_max_u32 v19, v19, v27
    v_cmp_eq_u32 vcc, -1, v19
    s_nop 0
    s_cbranch_vccnz g_43F15_0
    v_smfmac_f32_16x16x64_bf16 v[40:43], v[24:27], a[0:7], v172
    v_smfmac_f32_16x16x64_bf16 v[44:47], v[24:27], a[64:71], v172
    v_smfmac_f32_16x16x64_bf16 v[48:51], v[24:27], a[32:39], v172
    v_smfmac_f32_16x16x64_bf16 v[52:55], v[24:27], a[96:103], v172
g_43L14_1:
    s_waitcnt vmcnt(2)
    v_max3_u32 v19, v28, v29, v30
    v_max_u32 v19, v19, v31
    v_cmp_eq_u32 vcc, -1, v19
    s_nop 0
    s_cbranch_vccnz g_43F14_1
    v_smfmac_f32_16x16x64_bf16 v[40:43], v[28:31], a[8:15], v172
    v_smfmac_f32_16x16x64_bf16 v[44:47], v[28:31], a[72:79], v172
    v_smfmac_f32_16x16x64_bf16 v[48:51], v[28:31], a[40:47], v172
    v_smfmac_f32_16x16x64_bf16 v[52:55], v[28:31], a[104:111], v172
g_43L12_2:
    s_waitcnt vmcnt(1)
    v_max3_u32 v19, v32, v33, v34
    v_max_u32 v19, v19, v35
    v_cmp_eq_u32 vcc, -1, v19
    s_nop 0
    s_cbranch_vccnz g_43F12_2
    v_smfmac_f32_16x16x64_bf16 v[40:43], v[32:35], a[16:23], v172
    v_smfmac_f32_16x16x64_bf16 v[44:47], v[32:35], a[80:87], v172
    v_smfmac_f32_16x16x64_bf16 v[48:51], v[32:35], a[48:55], v172
    v_smfmac_f32_16x16x64_bf16 v[52:55], v[32:35], a[112:119], v172
g_43L8_3:
    s_waitcnt vmcnt(0)
    v_max3_u32 v19, v36, v37, v38
    v_max_u32 v19, v19, v39
    v_cmp_eq_u32 vcc, -1, v19
    s_nop 0
    s_cbranch_vccnz g_43F8_3
    v_smfmac_f32_16x16x64_bf16 v[40:43], v[36:39], a[24:31], v172
    v_smfmac_f32_16x16x64_bf16 v[44:47], v[36:39], a[88:95], v172
    v_smfmac_f32_16x16x64_bf16 v[48:51], v[36:39], a[56:63], v172
    v_smfmac_f32_16x16x64_bf16 v[52:55], v[36:39], a[120:127], v172
    s_branch gc_44
g_43L15_1:
    s_waitcnt vmcnt(3)
    v_max3_u32 v19, v28, v29, v30
    v_max_u32 v19, v19, v31
    v_cmp_eq_u32 vcc, -1, v19
    s_nop 0
    s_cbranch_vccnz g_43F15_1
    v_smfmac_f32_16x16x64_bf16 v[40:43], v[28:31], a[8:15], v172
    v_smfmac_f32_16x16x64_bf16 v[44:47], v[28:31], a[72:79], v172
    v_smfmac_f32_16x16x64_bf16 v[48:51], v[28:31], a[40:47], v172
    v_smfmac_f32_16x16x64_bf16 v[52:55], v[28:31], a[104:111], v172
g_43L13_2:
    s_waitcnt vmcnt(2)
    v_max3_u32 v19, v32, v33, v34
    v_max_u32 v19, v19, v35
    v_cmp_eq_u32 vcc, -1, v19
    s_nop 0
    s_cbranch_vccnz g_43F13_2
    v_smfmac_f32_16x16x64_bf16 v[40:43], v[32:35], a[16:23], v172
    v_smfmac_f32_16x16x64_bf16 v[44:47], v[32:35], a[80:87], v172
    v_smfmac_f32_16x16x64_bf16 v[48:51], v[32:35], a[48:55], v172
    v_smfmac_f32_16x16x64_bf16 v[52:55], v[32:35], a[112:119], v172
g_43L9_3:
    s_waitcnt vmcnt(1)
    v_max3_u32 v19, v36, v37, v38
    v_max_u32 v19, v19, v39
    v_cmp_eq_u32 vcc, -1, v19
    s_nop 0
    s_cbranch_vccnz g_43F9_3
    v_smfmac_f32_16x16x64_bf16 v[40:43], v[36:39], a[24:31], v172
    v_smfmac_f32_16x16x64_bf16 v[44:47], v[36:39], a[88:95], v172
    v_smfmac_f32_16x16x64_bf16 v[48:51], v[36:39], a[56:63], v172
    v_smfmac_f32_16x16x64_bf16 v[52:55], v[36:39], a[120:127], v172
g_43L1_0:
    s_waitcnt vmcnt(0)
    v_max3_u32 v19, v24, v25, v26
    v_max_u32 v19, v19, v27
    v_cmp_eq_u32 vcc, -1, v19
    s_nop 0
    s_cbranch_vccnz g_43F1_0
    v_smfmac_f32_16x16x64_bf16 v[40:43], v[24:27], a[0:7], v172
    v_smfmac_f32_16x16x64_bf16 v[44:47], v[24:27], a[64:71], v172
    v_smfmac_f32_16x16x64_bf16 v[48:51], v[24:27], a[32:39], v172
    v_smfmac_f32_16x16x64_bf16 v[52:55], v[24:27], a[96:103], v172
    s_branch gc_44
g_43L15_2:
    s_waitcnt vmcnt(3)
    v_max3_u32 v19, v32, v33, v34
    v_max_u32 v19, v19, v35
    v_cmp_eq_u32 vcc, -1, v19
    s_nop 0
    s_cbranch_vccnz g_43F15_2
    v_smfmac_f32_16x16x64_bf16 v[40:43], v[32:35], a[16:23], v172
    v_smfmac_f32_16x16x64_bf16 v[44:47], v[32:35], a[80:87], v172
    v_smfmac_f32_16x16x64_bf16 v[48:51], v[32:35], a[48:55], v172
    v_smfmac_f32_16x16x64_bf16 v[52:55], v[32:35], a[112:119], v172
g_43L11_3:
    s_waitcnt vmcnt(2)
    v_max3_u32 v19, v36, v37, v38
    v_max_u32 v19, v19, v39
    v_cmp_eq_u32 vcc, -1, v19
    s_nop 0
    s_cbranch_vccnz g_43F11_3
    v_smfmac_f32_16x16x64_bf16 v[40:43], v[36:39], a[24:31], v172
    v_smfmac_f32_16x16x64_bf16 v[44:47], v[36:39], a[88:95], v172
    v_smfmac_f32_16x16x64_bf16 v[48:51], v[36:39], a[56:63], v172
    v_smfmac_f32_16x16x64_bf16 v[52:55], v[36:39], a[120:127], v172
g_43L3_0:
    s_waitcnt vmcnt(1)
    v_max3_u32 v19, v24, v25, v26
    v_max_u32 v19, v19, v27
    v_cmp_eq_u32 vcc, -1, v19
    s_nop 0
    s_cbranch_vccnz g_43F3_0
    v_smfmac_f32_16x16x64_bf16 v[40:43], v[24:27], a[0:7], v172
    v_smfmac_f32_16x16x64_bf16 v[44:47], v[24:27], a[64:71], v172
    v_smfmac_f32_16x16x64_bf16 v[48:51], v[24:27], a[32:39], v172
    v_smfmac_f32_16x16x64_bf16 v[52:55], v[24:27], a[96:103], v172
g_43L2_1:
    s_waitcnt vmcnt(0)
    v_max3_u32 v19, v28, v29, v30
    v_max_u32 v19, v19, v31
    v_cmp_eq_u32 vcc, -1, v19
    s_nop 0
    s_cbranch_vccnz g_43F2_1
    v_smfmac_f32_16x16x64_bf16 v[40:43], v[28:31], a[8:15], v172
    v_smfmac_f32_16x16x64_bf16 v[44:47], v[28:31], a[72:79], v172
    v_smfmac_f32_16x16x64_bf16 v[48:51], v[28:31], a[40:47], v172
    v_smfmac_f32_16x16x64_bf16 v[52:55], v[28:31], a[104:111], v172
    s_branch gc_44
g_43L15_3:
    s_waitcnt vmcnt(3)
    v_max3_u32 v19, v36, v37, v38
    v_max_u32 v19, v19, v39
    v_cmp_eq_u32 vcc, -1, v19
    s_nop 0
    s_cbranch_vccnz g_43F15_3
    v_smfmac_f32_16x16x64_bf16 v[40:43], v[36:39], a[24:31], v172
    v_smfmac_f32_16x16x64_bf16 v[44:47], v[36:39], a[88:95], v172
    v_smfmac_f32_16x16x64_bf16 v[48:51], v[36:39], a[56:63], v172
    v_smfmac_f32_16x16x64_bf16 v[52:55], v[36:39], a[120:127], v172
g_43L7_0:
    s_waitcnt vmcnt(2)
    v_max3_u32 v19, v24, v25, v26
    v_max_u32 v19, v19, v27
    v_cmp_eq_u32 vcc, -1, v19
    s_nop 0
    s_cbranch_vccnz g_43F7_0
    v_smfmac_f32_16x16x64_bf16 v[40:43], v[24:27], a[0:7], v172
    v_smfmac_f32_16x16x64_bf16 v[44:47], v[24:27], a[64:71], v172
    v_smfmac_f32_16x16x64_bf16 v[48:51], v[24:27], a[32:39], v172
    v_smfmac_f32_16x16x64_bf16 v[52:55], v[24:27], a[96:103], v172
g_43L6_1:
    s_waitcnt vmcnt(1)
    v_max3_u32 v19, v28, v29, v30
    v_max_u32 v19, v19, v31
    v_cmp_eq_u32 vcc, -1, v19
    s_nop 0
    s_cbranch_vccnz g_43F6_1
    v_smfmac_f32_16x16x64_bf16 v[40:43], v[28:31], a[8:15], v172
    v_smfmac_f32_16x16x64_bf16 v[44:47], v[28:31], a[72:79], v172
    v_smfmac_f32_16x16x64_bf16 v[48:51], v[28:31], a[40:47], v172
    v_smfmac_f32_16x16x64_bf16 v[52:55], v[28:31], a[104:111], v172
g_43L4_2:
    s_waitcnt vmcnt(0)
    v_max3_u32 v19, v32, v33, v34
    v_max_u32 v19, v19, v35
    v_cmp_eq_u32 vcc, -1, v19
    s_nop 0
    s_cbranch_vccnz g_43F4_2
    v_smfmac_f32_16x16x64_bf16 v[40:43], v[32:35], a[16:23], v172
    v_smfmac_f32_16x16x64_bf16 v[44:47], v[32:35], a[80:87], v172
    v_smfmac_f32_16x16x64_bf16 v[48:51], v[32:35], a[48:55], v172
    v_smfmac_f32_16x16x64_bf16 v[52:55], v[32:35], a[112:119], v172
    s_branch gc_44
g_43L7_1:
    s_waitcnt vmcnt(2)
    v_max3_u32 v19, v28, v29, v30
    v_max_u32 v19, v19, v31
    v_cmp_eq_u32 vcc, -1, v19
    s_nop 0
    s_cbranch_vccnz g_43F7_1
    v_smfmac_f32_16x16x64_bf16 v[40:43], v[28:31], a[8:15], v172
    v_smfmac_f32_16x16x64_bf16 v[44:47], v[28:31], a[72:79], v172
    v_smfmac_f32_16x16x64_bf16 v[48:51], v[28:31], a[40:47], v172
    v_smfmac_f32_16x16x64_bf16 v[52:55], v[28:31], a[104:111], v172
g_43L5_2:
    s_waitcnt vmcnt(1)
    v_max3_u32 v19, v32, v33, v34
    v_max_u32 v19, v19, v35
    v_cmp_eq_u32 vcc, -1, v19
    s_nop 0
    s_cbranch_vccnz g_43F5_2
    v_smfmac_f32_16x16x64_bf16 v[40:43], v[32:35], a[16:23], v172
    v_smfmac_f32_16x16x64_bf16 v[44:47], v[32:35], a[80:87], v172
    v_smfmac_f32_16x16x64_bf16 v[48:51], v[32:35], a[48:55], v172
    v_smfmac_f32_16x16x64_bf16 v[52:55], v[32:35], a[112:119], v172
    s_branch g_43L1_0
g_43L7_2:
    s_waitcnt vmcnt(2)
    v_max3_u32 v19, v32, v33, v34
    v_max_u32 v19, v19, v35
    v_cmp_eq_u32 vcc, -1, v19
    s_nop 0
    s_cbranch_vccnz g_43F7_2
    v_smfmac_f32_16x16x64_bf16 v[40:43], v[32:35], a[16:23], v172
    v_smfmac_f32_16x16x64_bf16 v[44:47], v[32:35], a[80:87], v172
    v_smfmac_f32_16x16x64_bf16 v[48:51], v[32:35], a[48:55], v172
    v_smfmac_f32_16x16x64_bf16 v[52:55], v[32:35], a[112:119], v172
    s_branch g_43L3_0
g_43L11_0:
    s_waitcnt vmcnt(2)
    v_max3_u32 v19, v24, v25, v26
    v_max_u32 v19, v19, v27
    v_cmp_eq_u32 vcc, -1, v19
    s_nop 0
    s_cbranch_vccnz g_43F11_0
    v_smfmac_f32_16x16x64_bf16 v[40:43], v[24:27], a[0:7], v172
    v_smfmac_f32_16x16x64_bf16 v[44:47], v[24:27], a[64:71], v172
    v_smfmac_f32_16x16x64_bf16 v[48:51], v[24:27], a[32:39], v172
    v_smfmac_f32_16x16x64_bf16 v[52:55], v[24:27], a[96:103], v172
g_43L10_1:
    s_waitcnt vmcnt(1)
    v_max3_u32 v19, v28, v29, v30
    v_max_u32 v19, v19, v31
    v_cmp_eq_u32 vcc, -1, v19
    s_nop 0
    s_cbranch_vccnz g_43F10_1
    v_smfmac_f32_16x16x64_bf16 v[40:43], v[28:31], a[8:15], v172
    v_smfmac_f32_16x16x64_bf16 v[44:47], v[28:31], a[72:79], v172
    v_smfmac_f32_16x16x64_bf16 v[48:51], v[28:31], a[40:47], v172
    v_smfmac_f32_16x16x64_bf16 v[52:55], v[28:31], a[104:111], v172
    s_branch g_43L8_3
g_43L11_1:
    s_waitcnt vmcnt(2)
    v_max3_u32 v19, v28, v29, v30
    v_max_u32 v19, v19, v31
    v_cmp_eq_u32 vcc, -1, v19
    s_nop 0
    s_cbranch_vccnz g_43F11_1
    v_smfmac_f32_16x16x64_bf16 v[40:43], v[28:31], a[8:15], v172
    v_smfmac_f32_16x16x64_bf16 v[44:47], v[28:31], a[72:79], v172
    v_smfmac_f32_16x16x64_bf16 v[48:51], v[28:31], a[40:47], v172
    v_smfmac_f32_16x16x64_bf16 v[52:55], v[28:31], a[104:111], v172
    s_branch g_43L9_3
g_43L13_0:
    s_waitcnt vmcnt(2)
    v_max3_u32 v19, v24, v25, v26
    v_max_u32 v19, v19, v27
    v_cmp_eq_u32 vcc, -1, v19
    s_nop 0
    s_cbranch_vccnz g_43F13_0
    v_smfmac_f32_16x16x64_bf16 v[40:43], v[24:27], a[0:7], v172
    v_smfmac_f32_16x16x64_bf16 v[44:47], v[24:27], a[64:71], v172
    v_smfmac_f32_16x16x64_bf16 v[48:51], v[24:27], a[32:39], v172
    v_smfmac_f32_16x16x64_bf16 v[52:55], v[24:27], a[96:103], v172
    s_branch g_43L12_2
g_43L13_3:
    s_waitcnt vmcnt(2)
    v_max3_u32 v19, v36, v37, v38
    v_max_u32 v19, v19, v39
    v_cmp_eq_u32 vcc, -1, v19
    s_nop 0
    s_cbranch_vccnz g_43F13_3
    v_smfmac_f32_16x16x64_bf16 v[40:43], v[36:39], a[24:31], v172
    v_smfmac_f32_16x16x64_bf16 v[44:47], v[36:39], a[88:95], v172
    v_smfmac_f32_16x16x64_bf16 v[48:51], v[36:39], a[56:63], v172
    v_smfmac_f32_16x16x64_bf16 v[52:55], v[36:39], a[120:127], v172
g_43L5_0:
    s_waitcnt vmcnt(1)
    v_max3_u32 v19, v24, v25, v26
    v_max_u32 v19, v19, v27
    v_cmp_eq_u32 vcc, -1, v19
    s_nop 0
    s_cbranch_vccnz g_43F5_0
    v_smfmac_f32_16x16x64_bf16 v[40:43], v[24:27], a[0:7], v172
    v_smfmac_f32_16x16x64_bf16 v[44:47], v[24:27], a[64:71], v172
    v_smfmac_f32_16x16x64_bf16 v[48:51], v[24:27], a[32:39], v172
    v_smfmac_f32_16x16x64_bf16 v[52:55], v[24:27], a[96:103], v172
    s_branch g_43L4_2
g_43L14_2:
    s_waitcnt vmcnt(2)
    v_max3_u32 v19, v32, v33, v34
    v_max_u32 v19, v19, v35
    v_cmp_eq_u32 vcc, -1, v19
    s_nop 0
    s_cbranch_vccnz g_43F14_2
    v_smfmac_f32_16x16x64_bf16 v[40:43], v[32:35], a[16:23], v172
    v_smfmac_f32_16x16x64_bf16 v[44:47], v[32:35], a[80:87], v172
    v_smfmac_f32_16x16x64_bf16 v[48:51], v[32:35], a[48:55], v172
    v_smfmac_f32_16x16x64_bf16 v[52:55], v[32:35], a[112:119], v172
g_43L10_3:
    s_waitcnt vmcnt(1)
    v_max3_u32 v19, v36, v37, v38
    v_max_u32 v19, v19, v39
    v_cmp_eq_u32 vcc, -1, v19
    s_nop 0
    s_cbranch_vccnz g_43F10_3
    v_smfmac_f32_16x16x64_bf16 v[40:43], v[36:39], a[24:31], v172
    v_smfmac_f32_16x16x64_bf16 v[44:47], v[36:39], a[88:95], v172
    v_smfmac_f32_16x16x64_bf16 v[48:51], v[36:39], a[56:63], v172
    v_smfmac_f32_16x16x64_bf16 v[52:55], v[36:39], a[120:127], v172
    s_branch g_43L2_1
g_43L14_3:
    s_waitcnt vmcnt(2)
    v_max3_u32 v19, v36, v37, v38
    v_max_u32 v19, v19, v39
    v_cmp_eq_u32 vcc, -1, v19
    s_nop 0
    s_cbranch_vccnz g_43F14_3
    v_smfmac_f32_16x16x64_bf16 v[40:43], v[36:39], a[24:31], v172
    v_smfmac_f32_16x16x64_bf16 v[44:47], v[36:39], a[88:95], v172
    v_smfmac_f32_16x16x64_bf16 v[48:51], v[36:39], a[56:63], v172
    v_smfmac_f32_16x16x64_bf16 v[52:55], v[36:39], a[120:127], v172
    s_branch g_43L6_1
g_43L3_1:
    s_waitcnt vmcnt(1)
    v_max3_u32 v19, v28, v29, v30
    v_max_u32 v19, v19, v31
    v_cmp_eq_u32 vcc, -1, v19
    s_nop 0
    s_cbranch_vccnz g_43F3_1
    v_smfmac_f32_16x16x64_bf16 v[40:43], v[28:31], a[8:15], v172
    v_smfmac_f32_16x16x64_bf16 v[44:47], v[28:31], a[72:79], v172
    v_smfmac_f32_16x16x64_bf16 v[48:51], v[28:31], a[40:47], v172
    v_smfmac_f32_16x16x64_bf16 v[52:55], v[28:31], a[104:111], v172
    s_branch g_43L1_0
g_43L6_2:
    s_waitcnt vmcnt(1)
    v_max3_u32 v19, v32, v33, v34
    v_max_u32 v19, v19, v35
    v_cmp_eq_u32 vcc, -1, v19
    s_nop 0
    s_cbranch_vccnz g_43F6_2
    v_smfmac_f32_16x16x64_bf16 v[40:43], v[32:35], a[16:23], v172
    v_smfmac_f32_16x16x64_bf16 v[44:47], v[32:35], a[80:87], v172
    v_smfmac_f32_16x16x64_bf16 v[48:51], v[32:35], a[48:55], v172
    v_smfmac_f32_16x16x64_bf16 v[52:55], v[32:35], a[112:119], v172
    s_branch g_43L2_1
g_43L9_0:
    s_waitcnt vmcnt(1)
    v_max3_u32 v19, v24, v25, v26
    v_max_u32 v19, v19, v27
    v_cmp_eq_u32 vcc, -1, v19
    s_nop 0
    s_cbranch_vccnz g_43F9_0
    v_smfmac_f32_16x16x64_bf16 v[40:43], v[24:27], a[0:7], v172
    v_smfmac_f32_16x16x64_bf16 v[44:47], v[24:27], a[64:71], v172
    v_smfmac_f32_16x16x64_bf16 v[48:51], v[24:27], a[32:39], v172
    v_smfmac_f32_16x16x64_bf16 v[52:55], v[24:27], a[96:103], v172
    s_branch g_43L8_3
g_43L12_3:
    s_waitcnt vmcnt(1)
    v_max3_u32 v19, v36, v37, v38
    v_max_u32 v19, v19, v39
    v_cmp_eq_u32 vcc, -1, v19
    s_nop 0
    s_cbranch_vccnz g_43F12_3
    v_smfmac_f32_16x16x64_bf16 v[40:43], v[36:39], a[24:31], v172
    v_smfmac_f32_16x16x64_bf16 v[44:47], v[36:39], a[88:95], v172
    v_smfmac_f32_16x16x64_bf16 v[48:51], v[36:39], a[56:63], v172
    v_smfmac_f32_16x16x64_bf16 v[52:55], v[36:39], a[120:127], v172
    s_branch g_43L4_2
g_43F15_0:
    s_mov_b64 exec, vcc
    buffer_load_dwordx4 v[24:27], v2, s[4:7], s16 offen offset:0 sc1
    s_mov_b64 exec, -1
    s_add_u32 s23, s23, 1
    s_cmp_lt_u32 s23, 200000
    s_cbranch_scc1 g_43L15_1
    s_mov_b32 s25, 200000
    s_branch gc_44
g_43F15_1:
    s_mov_b64 exec, vcc
    buffer_load_dwordx4 v[28:31], v2, s[4:7], s16 offen offset:1024 sc1
    s_mov_b64 exec, -1
    s_add_u32 s23, s23, 1
    s_cmp_lt_u32 s23, 200000
    s_cbranch_scc1 g_43L15_2
    s_mov_b32 s25, 200000
    s_branch gc_44
g_43F15_2:
    s_mov_b64 exec, vcc
    buffer_load_dwordx4 v[32:35], v2, s[4:7], s16 offen offset:2048 sc1
    s_mov_b64 exec, -1
    s_add_u32 s23, s23, 1
    s_cmp_lt_u32 s23, 200000
    s_cbranch_scc1 g_43L15_3
    s_mov_b32 s25, 200000
    s_branch gc_44
g_43F15_3:
    s_mov_b64 exec, vcc
    buffer_load_dwordx4 v[36:39], v2, s[4:7], s16 offen offset:3072 sc1
    s_mov_b64 exec, -1
    s_add_u32 s23, s23, 1
    s_cmp_lt_u32 s23, 200000
    s_cbranch_scc1 g_43L15_0
    s_mov_b32 s25, 200000
    s_branch gc_44
g_43F7_0:
    s_mov_b64 exec, vcc
    buffer_load_dwordx4 v[24:27], v2, s[4:7], s16 offen offset:0 sc1
    s_mov_b64 exec, -1
    s_add_u32 s23, s23, 1
    s_cmp_lt_u32 s23, 200000
    s_cbranch_scc1 g_43L7_1
    s_mov_b32 s25, 200000
    s_branch gc_44
g_43F7_1:
    s_mov_b64 exec, vcc
    buffer_load_dwordx4 v[28:31], v2, s[4:7], s16 offen offset:1024 sc1
    s_mov_b64 exec, -1
    s_add_u32 s23, s23, 1
    s_cmp_lt_u32 s23, 200000
    s_cbranch_scc1 g_43L7_2
    s_mov_b32 s25, 200000
    s_branch gc_44
g_43F7_2:
    s_mov_b64 exec, vcc
    buffer_load_dwordx4 v[32:35], v2, s[4:7], s16 offen offset:2048 sc1
    s_mov_b64 exec, -1
    s_add_u32 s23, s23, 1
    s_cmp_lt_u32 s23, 200000
    s_cbranch_scc1 g_43L7_0
    s_mov_b32 s25, 200000
    s_branch gc_44
g_43F11_0:
    s_mov_b64 exec, vcc
    buffer_load_dwordx4 v[24:27], v2, s[4:7], s16 offen offset:0 sc1
    s_mov_b64 exec, -1
    s_add_u32 s23, s23, 1
    s_cmp_lt_u32 s23, 200000
    s_cbranch_scc1 g_43L11_1
    s_mov_b32 s25, 200000
    s_branch gc_44
g_43F11_1:
    s_mov_b64 exec, vcc
    buffer_load_dwordx4 v[28:31], v2, s[4:7], s16 offen offset:1024 sc1
    s_mov_b64 exec, -1
    s_add_u32 s23, s23, 1
    s_cmp_lt_u32 s23, 200000
    s_cbranch_scc1 g_43L11_3
    s_mov_b32 s25, 200000
    s_branch gc_44
g_43F11_3:
    s_mov_b64 exec, vcc
    buffer_load_dwordx4 v[36:39], v2, s[4:7], s16 offen offset:3072 sc1
    s_mov_b64 exec, -1
    s_add_u32 s23, s23, 1
    s_cmp_lt_u32 s23, 200000
    s_cbranch_scc1 g_43L11_0
    s_mov_b32 s25, 200000
    s_branch gc_44
g_43F13_0:
    s_mov_b64 exec, vcc
    buffer_load_dwordx4 v[24:27], v2, s[4:7], s16 offen offset:0 sc1
    s_mov_b64 exec, -1
    s_add_u32 s23, s23, 1
    s_cmp_lt_u32 s23, 200000
    s_cbranch_scc1 g_43L13_2
    s_mov_b32 s25, 200000
    s_branch gc_44
g_43F13_2:
    s_mov_b64 exec, vcc
    buffer_load_dwordx4 v[32:35], v2, s[4:7], s16 offen offset:2048 sc1
    s_mov_b64 exec, -1
    s_add_u32 s23, s23, 1
    s_cmp_lt_u32 s23, 200000
    s_cbranch_scc1 g_43L13_3
    s_mov_b32 s25, 200000
    s_branch gc_44
g_43F13_3:
    s_mov_b64 exec, vcc
    buffer_load_dwordx4 v[36:39], v2, s[4:7], s16 offen offset:3072 sc1
    s_mov_b64 exec, -1
    s_add_u32 s23, s23, 1
    s_cmp_lt_u32 s23, 200000
    s_cbranch_scc1 g_43L13_0
    s_mov_b32 s25, 200000
    s_branch gc_44
g_43F14_1:
    s_mov_b64 exec, vcc
    buffer_load_dwordx4 v[28:31], v2, s[4:7], s16 offen offset:1024 sc1
    s_mov_b64 exec, -1
    s_add_u32 s23, s23, 1
    s_cmp_lt_u32 s23, 200000
    s_cbranch_scc1 g_43L14_2
    s_mov_b32 s25, 200000
    s_branch gc_44
g_43F14_2:
    s_mov_b64 exec, vcc
    buffer_load_dwordx4 v[32:35], v2, s[4:7], s16 offen offset:2048 sc1
    s_mov_b64 exec, -1
    s_add_u32 s23, s23, 1
    s_cmp_lt_u32 s23, 200000
    s_cbranch_scc1 g_43L14_3
    s_mov_b32 s25, 200000
    s_branch gc_44
g_43F14_3:
    s_mov_b64 exec, vcc
    buffer_load_dwordx4 v[36:39], v2, s[4:7], s16 offen offset:3072 sc1
    s_mov_b64 exec, -1
    s_add_u32 s23, s23, 1
    s_cmp_lt_u32 s23, 200000
    s_cbranch_scc1 g_43L14_1
    s_mov_b32 s25, 200000
    s_branch gc_44
g_43F3_0:
    s_mov_b64 exec, vcc
    buffer_load_dwordx4 v[24:27], v2, s[4:7], s16 offen offset:0 sc1
    s_mov_b64 exec, -1
    s_add_u32 s23, s23, 1
    s_cmp_lt_u32 s23, 200000
    s_cbranch_scc1 g_43L3_1
    s_mov_b32 s25, 200000
    s_branch gc_44
g_43F3_1:
    s_mov_b64 exec, vcc
    buffer_load_dwordx4 v[28:31], v2, s[4:7], s16 offen offset:1024 sc1
    s_mov_b64 exec, -1
    s_add_u32 s23, s23, 1
    s_cmp_lt_u32 s23, 200000
    s_cbranch_scc1 g_43L3_0
    s_mov_b32 s25, 200000
    s_branch gc_44
g_43F5_0:
    s_mov_b64 exec, vcc
    buffer_load_dwordx4 v[24:27], v2, s[4:7], s16 offen offset:0 sc1
    s_mov_b64 exec, -1
    s_add_u32 s23, s23, 1
    s_cmp_lt_u32 s23, 200000
    s_cbranch_scc1 g_43L5_2
    s_mov_b32 s25, 200000
    s_branch gc_44
g_43F5_2:
    s_mov_b64 exec, vcc
    buffer_load_dwordx4 v[32:35], v2, s[4:7], s16 offen offset:2048 sc1
    s_mov_b64 exec, -1
    s_add_u32 s23, s23, 1
    s_cmp_lt_u32 s23, 200000
    s_cbranch_scc1 g_43L5_0
    s_mov_b32 s25, 200000
    s_branch gc_44
g_43F6_1:
    s_mov_b64 exec, vcc
    buffer_load_dwordx4 v[28:31], v2, s[4:7], s16 offen offset:1024 sc1
    s_mov_b64 exec, -1
    s_add_u32 s23, s23, 1
    s_cmp_lt_u32 s23, 200000
    s_cbranch_scc1 g_43L6_2
    s_mov_b32 s25, 200000
    s_branch gc_44
g_43F6_2:
    s_mov_b64 exec, vcc
    buffer_load_dwordx4 v[32:35], v2, s[4:7], s16 offen offset:2048 sc1
    s_mov_b64 exec, -1
    s_add_u32 s23, s23, 1
    s_cmp_lt_u32 s23, 200000
    s_cbranch_scc1 g_43L6_1
    s_mov_b32 s25, 200000
    s_branch gc_44
g_43F9_0:
    s_mov_b64 exec, vcc
    buffer_load_dwordx4 v[24:27], v2, s[4:7], s16 offen offset:0 sc1
    s_mov_b64 exec, -1
    s_add_u32 s23, s23, 1
    s_cmp_lt_u32 s23, 200000
    s_cbranch_scc1 g_43L9_3
    s_mov_b32 s25, 200000
    s_branch gc_44
g_43F9_3:
    s_mov_b64 exec, vcc
    buffer_load_dwordx4 v[36:39], v2, s[4:7], s16 offen offset:3072 sc1
    s_mov_b64 exec, -1
    s_add_u32 s23, s23, 1
    s_cmp_lt_u32 s23, 200000
    s_cbranch_scc1 g_43L9_0
    s_mov_b32 s25, 200000
    s_branch gc_44
g_43F10_1:
    s_mov_b64 exec, vcc
    buffer_load_dwordx4 v[28:31], v2, s[4:7], s16 offen offset:1024 sc1
    s_mov_b64 exec, -1
    s_add_u32 s23, s23, 1
    s_cmp_lt_u32 s23, 200000
    s_cbranch_scc1 g_43L10_3
    s_mov_b32 s25, 200000
    s_branch gc_44
g_43F10_3:
    s_mov_b64 exec, vcc
    buffer_load_dwordx4 v[36:39], v2, s[4:7], s16 offen offset:3072 sc1
    s_mov_b64 exec, -1
    s_add_u32 s23, s23, 1
    s_cmp_lt_u32 s23, 200000
    s_cbranch_scc1 g_43L10_1
    s_mov_b32 s25, 200000
    s_branch gc_44
g_43F12_2:
    s_mov_b64 exec, vcc
    buffer_load_dwordx4 v[32:35], v2, s[4:7], s16 offen offset:2048 sc1
    s_mov_b64 exec, -1
    s_add_u32 s23, s23, 1
    s_cmp_lt_u32 s23, 200000
    s_cbranch_scc1 g_43L12_3
    s_mov_b32 s25, 200000
    s_branch gc_44
g_43F12_3:
    s_mov_b64 exec, vcc
    buffer_load_dwordx4 v[36:39], v2, s[4:7], s16 offen offset:3072 sc1
    s_mov_b64 exec, -1
    s_add_u32 s23, s23, 1
    s_cmp_lt_u32 s23, 200000
    s_cbranch_scc1 g_43L12_2
    s_mov_b32 s25, 200000
    s_branch gc_44
g_43F1_0:
    s_mov_b64 exec, vcc
    buffer_load_dwordx4 v[24:27], v2, s[4:7], s16 offen offset:0 sc1
    s_mov_b64 exec, -1
    s_add_u32 s23, s23, 1
    s_cmp_lt_u32 s23, 200000
    s_cbranch_scc1 g_43L1_0
    s_mov_b32 s25, 200000
    s_branch gc_44
g_43F2_1:
    s_mov_b64 exec, vcc
    buffer_load_dwordx4 v[28:31], v2, s[4:7], s16 offen offset:1024 sc1
    s_mov_b64 exec, -1
    s_add_u32 s23, s23, 1
    s_cmp_lt_u32 s23, 200000
    s_cbranch_scc1 g_43L2_1
    s_mov_b32 s25, 200000
    s_branch gc_44
g_43F4_2:
    s_mov_b64 exec, vcc
    buffer_load_dwordx4 v[32:35], v2, s[4:7], s16 offen offset:2048 sc1
    s_mov_b64 exec, -1
    s_add_u32 s23, s23, 1
    s_cmp_lt_u32 s23, 200000
    s_cbranch_scc1 g_43L4_2
    s_mov_b32 s25, 200000
    s_branch gc_44
g_43F8_3:
    s_mov_b64 exec, vcc
    buffer_load_dwordx4 v[36:39], v2, s[4:7], s16 offen offset:3072 sc1
    s_mov_b64 exec, -1
    s_add_u32 s23, s23, 1
    s_cmp_lt_u32 s23, 200000
    s_cbranch_scc1 g_43L8_3
    s_mov_b32 s25, 200000
    s_branch gc_44
recur_fast_last2:
    buffer_store_dwordx4 v[168:171], v15, s[4:7], s20 offen sc1
    s_waitcnt vmcnt(0)
    s_branch recur_end
g_45L15_0:
    s_waitcnt vmcnt(3)
    v_max3_u32 v19, v24, v25, v26
    v_max_u32 v19, v19, v27
    v_cmp_eq_u32 vcc, -1, v19
    s_nop 0
    s_cbranch_vccnz g_45F15_0
    v_smfmac_f32_16x16x64_bf16 v[64:67], v[24:27], a[192:199], v172
    v_smfmac_f32_16x16x64_bf16 v[68:71], v[24:27], a[224:231], v172
g_45L14_1:
    s_waitcnt vmcnt(2)
    v_max3_u32 v19, v28, v29, v30
    v_max_u32 v19, v19, v31
    v_cmp_eq_u32 vcc, -1, v19
    s_nop 0
    s_cbranch_vccnz g_45F14_1
    v_smfmac_f32_16x16x64_bf16 v[64:67], v[28:31], a[200:207], v172
    v_smfmac_f32_16x16x64_bf16 v[68:71], v[28:31], a[232:239], v172
g_45L12_2:
    s_waitcnt vmcnt(1)
    v_max3_u32 v19, v32, v33, v34
    v_max_u32 v19, v19, v35
    v_cmp_eq_u32 vcc, -1, v19
    s_nop 0
    s_cbranch_vccnz g_45F12_2
    v_smfmac_f32_16x16x64_bf16 v[64:67], v[32:35], a[208:215], v172
    v_smfmac_f32_16x16x64_bf16 v[68:71], v[32:35], a[240:247], v172
g_45L8_3:
    s_waitcnt vmcnt(0)
    v_max3_u32 v19, v36, v37, v38
    v_max_u32 v19, v19, v39
    v_cmp_eq_u32 vcc, -1, v19
    s_nop 0
    s_cbranch_vccnz g_45F8_3
    v_smfmac_f32_16x16x64_bf16 v[64:67], v[36:39], a[216:223], v172
    v_smfmac_f32_16x16x64_bf16 v[68:71], v[36:39], a[248:255], v172
    s_nop 4
    v_cvt_pk_bf16_f32 v80, v64, v65
    v_cvt_pk_bf16_f32 v81, v66, v67
    s_nop 0
    v_cvt_pk_bf16_f32 v82, v68, v69
    v_cvt_pk_bf16_f32 v83, v70, v71
    ds_write_b128 v17, v[80:83] offset:9216
    s_branch gc_46
g_45L15_1:
    s_waitcnt vmcnt(3)
    v_max3_u32 v19, v28, v29, v30
    v_max_u32 v19, v19, v31
    v_cmp_eq_u32 vcc, -1, v19
    s_nop 0
    s_cbranch_vccnz g_45F15_1
    v_smfmac_f32_16x16x64_bf16 v[64:67], v[28:31], a[200:207], v172
    v_smfmac_f32_16x16x64_bf16 v[68:71], v[28:31], a[232:239], v172
g_45L13_2:
    s_waitcnt vmcnt(2)
    v_max3_u32 v19, v32, v33, v34
    v_max_u32 v19, v19, v35
    v_cmp_eq_u32 vcc, -1, v19
    s_nop 0
    s_cbranch_vccnz g_45F13_2
    v_smfmac_f32_16x16x64_bf16 v[64:67], v[32:35], a[208:215], v172
    v_smfmac_f32_16x16x64_bf16 v[68:71], v[32:35], a[240:247], v172
g_45L9_3:
    s_waitcnt vmcnt(1)
    v_max3_u32 v19, v36, v37, v38
    v_max_u32 v19, v19, v39
    v_cmp_eq_u32 vcc, -1, v19
    s_nop 0
    s_cbranch_vccnz g_45F9_3
    v_smfmac_f32_16x16x64_bf16 v[64:67], v[36:39], a[216:223], v172
    v_smfmac_f32_16x16x64_bf16 v[68:71], v[36:39], a[248:255], v172
g_45L1_0:
    s_waitcnt vmcnt(0)
    v_max3_u32 v19, v24, v25, v26
    v_max_u32 v19, v19, v27
    v_cmp_eq_u32 vcc, -1, v19
    s_nop 0
    s_cbranch_vccnz g_45F1_0
    v_smfmac_f32_16x16x64_bf16 v[64:67], v[24:27], a[192:199], v172
    v_smfmac_f32_16x16x64_bf16 v[68:71], v[24:27], a[224:231], v172
    s_nop 4
    v_cvt_pk_bf16_f32 v80, v64, v65
    v_cvt_pk_bf16_f32 v81, v66, v67
    s_nop 0
    v_cvt_pk_bf16_f32 v82, v68, v69
    v_cvt_pk_bf16_f32 v83, v70, v71
    ds_write_b128 v17, v[80:83] offset:9216
    s_branch gc_46
g_45L15_2:
    s_waitcnt vmcnt(3)
    v_max3_u32 v19, v32, v33, v34
    v_max_u32 v19, v19, v35
    v_cmp_eq_u32 vcc, -1, v19
    s_nop 0
    s_cbranch_vccnz g_45F15_2
    v_smfmac_f32_16x16x64_bf16 v[64:67], v[32:35], a[208:215], v172
    v_smfmac_f32_16x16x64_bf16 v[68:71], v[32:35], a[240:247], v172
g_45L11_3:
    s_waitcnt vmcnt(2)
    v_max3_u32 v19, v36, v37, v38
    v_max_u32 v19, v19, v39
    v_cmp_eq_u32 vcc, -1, v19
    s_nop 0
    s_cbranch_vccnz g_45F11_3
    v_smfmac_f32_16x16x64_bf16 v[64:67], v[36:39], a[216:223], v172
    v_smfmac_f32_16x16x64_bf16 v[68:71], v[36:39], a[248:255], v172
g_45L3_0:
    s_waitcnt vmcnt(1)
    v_max3_u32 v19, v24, v25, v26
    v_max_u32 v19, v19, v27
    v_cmp_eq_u32 vcc, -1, v19
    s_nop 0
    s_cbranch_vccnz g_45F3_0
    v_smfmac_f32_16x16x64_bf16 v[64:67], v[24:27], a[192:199], v172
    v_smfmac_f32_16x16x64_bf16 v[68:71], v[24:27], a[224:231], v172
g_45L2_1:
    s_waitcnt vmcnt(0)
    v_max3_u32 v19, v28, v29, v30
    v_max_u32 v19, v19, v31
    v_cmp_eq_u32 vcc, -1, v19
    s_nop 0
    s_cbranch_vccnz g_45F2_1
    v_smfmac_f32_16x16x64_bf16 v[64:67], v[28:31], a[200:207], v172
    v_smfmac_f32_16x16x64_bf16 v[68:71], v[28:31], a[232:239], v172
    s_nop 4
    v_cvt_pk_bf16_f32 v80, v64, v65
    v_cvt_pk_bf16_f32 v81, v66, v67
    s_nop 0
    v_cvt_pk_bf16_f32 v82, v68, v69
    v_cvt_pk_bf16_f32 v83, v70, v71
    ds_write_b128 v17, v[80:83] offset:9216
    s_branch gc_46
g_45L15_3:
    s_waitcnt vmcnt(3)
    v_max3_u32 v19, v36, v37, v38
    v_max_u32 v19, v19, v39
    v_cmp_eq_u32 vcc, -1, v19
    s_nop 0
    s_cbranch_vccnz g_45F15_3
    v_smfmac_f32_16x16x64_bf16 v[64:67], v[36:39], a[216:223], v172
    v_smfmac_f32_16x16x64_bf16 v[68:71], v[36:39], a[248:255], v172
g_45L7_0:
    s_waitcnt vmcnt(2)
    v_max3_u32 v19, v24, v25, v26
    v_max_u32 v19, v19, v27
    v_cmp_eq_u32 vcc, -1, v19
    s_nop 0
    s_cbranch_vccnz g_45F7_0
    v_smfmac_f32_16x16x64_bf16 v[64:67], v[24:27], a[192:199], v172
    v_smfmac_f32_16x16x64_bf16 v[68:71], v[24:27], a[224:231], v172
g_45L6_1:
    s_waitcnt vmcnt(1)
    v_max3_u32 v19, v28, v29, v30
    v_max_u32 v19, v19, v31
    v_cmp_eq_u32 vcc, -1, v19
    s_nop 0
    s_cbranch_vccnz g_45F6_1
    v_smfmac_f32_16x16x64_bf16 v[64:67], v[28:31], a[200:207], v172
    v_smfmac_f32_16x16x64_bf16 v[68:71], v[28:31], a[232:239], v172
g_45L4_2:
    s_waitcnt vmcnt(0)
    v_max3_u32 v19, v32, v33, v34
    v_max_u32 v19, v19, v35
    v_cmp_eq_u32 vcc, -1, v19
    s_nop 0
    s_cbranch_vccnz g_45F4_2
    v_smfmac_f32_16x16x64_bf16 v[64:67], v[32:35], a[208:215], v172
    v_smfmac_f32_16x16x64_bf16 v[68:71], v[32:35], a[240:247], v172
    s_nop 4
    v_cvt_pk_bf16_f32 v80, v64, v65
    v_cvt_pk_bf16_f32 v81, v66, v67
    s_nop 0
    v_cvt_pk_bf16_f32 v82, v68, v69
    v_cvt_pk_bf16_f32 v83, v70, v71
    ds_write_b128 v17, v[80:83] offset:9216
    s_branch gc_46
g_45L7_1:
    s_waitcnt vmcnt(2)
    v_max3_u32 v19, v28, v29, v30
    v_max_u32 v19, v19, v31
    v_cmp_eq_u32 vcc, -1, v19
    s_nop 0
    s_cbranch_vccnz g_45F7_1
    v_smfmac_f32_16x16x64_bf16 v[64:67], v[28:31], a[200:207], v172
    v_smfmac_f32_16x16x64_bf16 v[68:71], v[28:31], a[232:239], v172
g_45L5_2:
    s_waitcnt vmcnt(1)
    v_max3_u32 v19, v32, v33, v34
    v_max_u32 v19, v19, v35
    v_cmp_eq_u32 vcc, -1, v19
    s_nop 0
    s_cbranch_vccnz g_45F5_2
    v_smfmac_f32_16x16x64_bf16 v[64:67], v[32:35], a[208:215], v172
    v_smfmac_f32_16x16x64_bf16 v[68:71], v[32:35], a[240:247], v172
    s_branch g_45L1_0
g_45L7_2:
    s_waitcnt vmcnt(2)
    v_max3_u32 v19, v32, v33, v34
    v_max_u32 v19, v19, v35
    v_cmp_eq_u32 vcc, -1, v19
    s_nop 0
    s_cbranch_vccnz g_45F7_2
    v_smfmac_f32_16x16x64_bf16 v[64:67], v[32:35], a[208:215], v172
    v_smfmac_f32_16x16x64_bf16 v[68:71], v[32:35], a[240:247], v172
    s_branch g_45L3_0
g_45L11_0:
    s_waitcnt vmcnt(2)
    v_max3_u32 v19, v24, v25, v26
    v_max_u32 v19, v19, v27
    v_cmp_eq_u32 vcc, -1, v19
    s_nop 0
    s_cbranch_vccnz g_45F11_0
    v_smfmac_f32_16x16x64_bf16 v[64:67], v[24:27], a[192:199], v172
    v_smfmac_f32_16x16x64_bf16 v[68:71], v[24:27], a[224:231], v172
g_45L10_1:
    s_waitcnt vmcnt(1)
    v_max3_u32 v19, v28, v29, v30
    v_max_u32 v19, v19, v31
    v_cmp_eq_u32 vcc, -1, v19
    s_nop 0
    s_cbranch_vccnz g_45F10_1
    v_smfmac_f32_16x16x64_bf16 v[64:67], v[28:31], a[200:207], v172
    v_smfmac_f32_16x16x64_bf16 v[68:71], v[28:31], a[232:239], v172
    s_branch g_45L8_3
g_45L11_1:
    s_waitcnt vmcnt(2)
    v_max3_u32 v19, v28, v29, v30
    v_max_u32 v19, v19, v31
    v_cmp_eq_u32 vcc, -1, v19
    s_nop 0
    s_cbranch_vccnz g_45F11_1
    v_smfmac_f32_16x16x64_bf16 v[64:67], v[28:31], a[200:207], v172
    v_smfmac_f32_16x16x64_bf16 v[68:71], v[28:31], a[232:239], v172
    s_branch g_45L9_3
g_45L13_0:
    s_waitcnt vmcnt(2)
    v_max3_u32 v19, v24, v25, v26
    v_max_u32 v19, v19, v27
    v_cmp_eq_u32 vcc, -1, v19
    s_nop 0
    s_cbranch_vccnz g_45F13_0
    v_smfmac_f32_16x16x64_bf16 v[64:67], v[24:27], a[192:199], v172
    v_smfmac_f32_16x16x64_bf16 v[68:71], v[24:27], a[224:231], v172
    s_branch g_45L12_2
g_45L13_3:
    s_waitcnt vmcnt(2)
    v_max3_u32 v19, v36, v37, v38
    v_max_u32 v19, v19, v39
    v_cmp_eq_u32 vcc, -1, v19
    s_nop 0
    s_cbranch_vccnz g_45F13_3
    v_smfmac_f32_16x16x64_bf16 v[64:67], v[36:39], a[216:223], v172
    v_smfmac_f32_16x16x64_bf16 v[68:71], v[36:39], a[248:255], v172
g_45L5_0:
    s_waitcnt vmcnt(1)
    v_max3_u32 v19, v24, v25, v26
    v_max_u32 v19, v19, v27
    v_cmp_eq_u32 vcc, -1, v19
    s_nop 0
    s_cbranch_vccnz g_45F5_0
    v_smfmac_f32_16x16x64_bf16 v[64:67], v[24:27], a[192:199], v172
    v_smfmac_f32_16x16x64_bf16 v[68:71], v[24:27], a[224:231], v172
    s_branch g_45L4_2
g_45L14_2:
    s_waitcnt vmcnt(2)
    v_max3_u32 v19, v32, v33, v34
    v_max_u32 v19, v19, v35
    v_cmp_eq_u32 vcc, -1, v19
    s_nop 0
    s_cbranch_vccnz g_45F14_2
    v_smfmac_f32_16x16x64_bf16 v[64:67], v[32:35], a[208:215], v172
    v_smfmac_f32_16x16x64_bf16 v[68:71], v[32:35], a[240:247], v172
g_45L10_3:
    s_waitcnt vmcnt(1)
    v_max3_u32 v19, v36, v37, v38
    v_max_u32 v19, v19, v39
    v_cmp_eq_u32 vcc, -1, v19
    s_nop 0
    s_cbranch_vccnz g_45F10_3
    v_smfmac_f32_16x16x64_bf16 v[64:67], v[36:39], a[216:223], v172
    v_smfmac_f32_16x16x64_bf16 v[68:71], v[36:39], a[248:255], v172
    s_branch g_45L2_1
g_45L14_3:
    s_waitcnt vmcnt(2)
    v_max3_u32 v19, v36, v37, v38
    v_max_u32 v19, v19, v39
    v_cmp_eq_u32 vcc, -1, v19
    s_nop 0
    s_cbranch_vccnz g_45F14_3
    v_smfmac_f32_16x16x64_bf16 v[64:67], v[36:39], a[216:223], v172
    v_smfmac_f32_16x16x64_bf16 v[68:71], v[36:39], a[248:255], v172
    s_branch g_45L6_1
g_45L3_1:
    s_waitcnt vmcnt(1)
    v_max3_u32 v19, v28, v29, v30
    v_max_u32 v19, v19, v31
    v_cmp_eq_u32 vcc, -1, v19
    s_nop 0
    s_cbranch_vccnz g_45F3_1
    v_smfmac_f32_16x16x64_bf16 v[64:67], v[28:31], a[200:207], v172
    v_smfmac_f32_16x16x64_bf16 v[68:71], v[28:31], a[232:239], v172
    s_branch g_45L1_0
g_45L6_2:
    s_waitcnt vmcnt(1)
    v_max3_u32 v19, v32, v33, v34
    v_max_u32 v19, v19, v35
    v_cmp_eq_u32 vcc, -1, v19
    s_nop 0
    s_cbranch_vccnz g_45F6_2
    v_smfmac_f32_16x16x64_bf16 v[64:67], v[32:35], a[208:215], v172
    v_smfmac_f32_16x16x64_bf16 v[68:71], v[32:35], a[240:247], v172
    s_branch g_45L2_1
g_45L9_0:
    s_waitcnt vmcnt(1)
    v_max3_u32 v19, v24, v25, v26
    v_max_u32 v19, v19, v27
    v_cmp_eq_u32 vcc, -1, v19
    s_nop 0
    s_cbranch_vccnz g_45F9_0
    v_smfmac_f32_16x16x64_bf16 v[64:67], v[24:27], a[192:199], v172
    v_smfmac_f32_16x16x64_bf16 v[68:71], v[24:27], a[224:231], v172
    s_branch g_45L8_3
g_45L12_3:
    s_waitcnt vmcnt(1)
    v_max3_u32 v19, v36, v37, v38
    v_max_u32 v19, v19, v39
    v_cmp_eq_u32 vcc, -1, v19
    s_nop 0
    s_cbranch_vccnz g_45F12_3
    v_smfmac_f32_16x16x64_bf16 v[64:67], v[36:39], a[216:223], v172
    v_smfmac_f32_16x16x64_bf16 v[68:71], v[36:39], a[248:255], v172
    s_branch g_45L4_2
g_45F15_0:
    s_mov_b64 exec, vcc
    buffer_load_dwordx4 v[24:27], v8, s[4:7], s16 offen offset:0 sc1
    s_mov_b64 exec, -1
    s_add_u32 s23, s23, 1
    s_cmp_lt_u32 s23, 200000
    s_cbranch_scc1 g_45L15_1
    s_mov_b32 s25, 200000
    s_branch gc_46
g_45F15_1:
    s_mov_b64 exec, vcc
    buffer_load_dwordx4 v[28:31], v8, s[4:7], s16 offen offset:1024 sc1
    s_mov_b64 exec, -1
    s_add_u32 s23, s23, 1
    s_cmp_lt_u32 s23, 200000
    s_cbranch_scc1 g_45L15_2
    s_mov_b32 s25, 200000
    s_branch gc_46
g_45F15_2:
    s_mov_b64 exec, vcc
    buffer_load_dwordx4 v[32:35], v8, s[4:7], s16 offen offset:2048 sc1
    s_mov_b64 exec, -1
    s_add_u32 s23, s23, 1
    s_cmp_lt_u32 s23, 200000
    s_cbranch_scc1 g_45L15_3
    s_mov_b32 s25, 200000
    s_branch gc_46
g_45F15_3:
    s_mov_b64 exec, vcc
    buffer_load_dwordx4 v[36:39], v8, s[4:7], s16 offen offset:3072 sc1
    s_mov_b64 exec, -1
    s_add_u32 s23, s23, 1
    s_cmp_lt_u32 s23, 200000
    s_cbranch_scc1 g_45L15_0
    s_mov_b32 s25, 200000
    s_branch gc_46
g_45F7_0:
    s_mov_b64 exec, vcc
    buffer_load_dwordx4 v[24:27], v8, s[4:7], s16 offen offset:0 sc1
    s_mov_b64 exec, -1
    s_add_u32 s23, s23, 1
    s_cmp_lt_u32 s23, 200000
    s_cbranch_scc1 g_45L7_1
    s_mov_b32 s25, 200000
    s_branch gc_46
g_45F7_1:
    s_mov_b64 exec, vcc
    buffer_load_dwordx4 v[28:31], v8, s[4:7], s16 offen offset:1024 sc1
    s_mov_b64 exec, -1
    s_add_u32 s23, s23, 1
    s_cmp_lt_u32 s23, 200000
    s_cbranch_scc1 g_45L7_2
    s_mov_b32 s25, 200000
    s_branch gc_46
g_45F7_2:
    s_mov_b64 exec, vcc
    buffer_load_dwordx4 v[32:35], v8, s[4:7], s16 offen offset:2048 sc1
    s_mov_b64 exec, -1
    s_add_u32 s23, s23, 1
    s_cmp_lt_u32 s23, 200000
    s_cbranch_scc1 g_45L7_0
    s_mov_b32 s25, 200000
    s_branch gc_46
g_45F11_0:
    s_mov_b64 exec, vcc
    buffer_load_dwordx4 v[24:27], v8, s[4:7], s16 offen offset:0 sc1
    s_mov_b64 exec, -1
    s_add_u32 s23, s23, 1
    s_cmp_lt_u32 s23, 200000
    s_cbranch_scc1 g_45L11_1
    s_mov_b32 s25, 200000
    s_branch gc_46
g_45F11_1:
    s_mov_b64 exec, vcc
    buffer_load_dwordx4 v[28:31], v8, s[4:7], s16 offen offset:1024 sc1
    s_mov_b64 exec, -1
    s_add_u32 s23, s23, 1
    s_cmp_lt_u32 s23, 200000
    s_cbranch_scc1 g_45L11_3
    s_mov_b32 s25, 200000
    s_branch gc_46
g_45F11_3:
    s_mov_b64 exec, vcc
    buffer_load_dwordx4 v[36:39], v8, s[4:7], s16 offen offset:3072 sc1
    s_mov_b64 exec, -1
    s_add_u32 s23, s23, 1
    s_cmp_lt_u32 s23, 200000
    s_cbranch_scc1 g_45L11_0
    s_mov_b32 s25, 200000
    s_branch gc_46
g_45F13_0:
    s_mov_b64 exec, vcc
    buffer_load_dwordx4 v[24:27], v8, s[4:7], s16 offen offset:0 sc1
    s_mov_b64 exec, -1
    s_add_u32 s23, s23, 1
    s_cmp_lt_u32 s23, 200000
    s_cbranch_scc1 g_45L13_2
    s_mov_b32 s25, 200000
    s_branch gc_46
g_45F13_2:
    s_mov_b64 exec, vcc
    buffer_load_dwordx4 v[32:35], v8, s[4:7], s16 offen offset:2048 sc1
    s_mov_b64 exec, -1
    s_add_u32 s23, s23, 1
    s_cmp_lt_u32 s23, 200000
    s_cbranch_scc1 g_45L13_3
    s_mov_b32 s25, 200000
    s_branch gc_46
g_45F13_3:
    s_mov_b64 exec, vcc
    buffer_load_dwordx4 v[36:39], v8, s[4:7], s16 offen offset:3072 sc1
    s_mov_b64 exec, -1
    s_add_u32 s23, s23, 1
    s_cmp_lt_u32 s23, 200000
    s_cbranch_scc1 g_45L13_0
    s_mov_b32 s25, 200000
    s_branch gc_46
g_45F14_1:
    s_mov_b64 exec, vcc
    buffer_load_dwordx4 v[28:31], v8, s[4:7], s16 offen offset:1024 sc1
    s_mov_b64 exec, -1
    s_add_u32 s23, s23, 1
    s_cmp_lt_u32 s23, 200000
    s_cbranch_scc1 g_45L14_2
    s_mov_b32 s25, 200000
    s_branch gc_46
g_45F14_2:
    s_mov_b64 exec, vcc
    buffer_load_dwordx4 v[32:35], v8, s[4:7], s16 offen offset:2048 sc1
    s_mov_b64 exec, -1
    s_add_u32 s23, s23, 1
    s_cmp_lt_u32 s23, 200000
    s_cbranch_scc1 g_45L14_3
    s_mov_b32 s25, 200000
    s_branch gc_46
g_45F14_3:
    s_mov_b64 exec, vcc
    buffer_load_dwordx4 v[36:39], v8, s[4:7], s16 offen offset:3072 sc1
    s_mov_b64 exec, -1
    s_add_u32 s23, s23, 1
    s_cmp_lt_u32 s23, 200000
    s_cbranch_scc1 g_45L14_1
    s_mov_b32 s25, 200000
    s_branch gc_46
g_45F3_0:
    s_mov_b64 exec, vcc
    buffer_load_dwordx4 v[24:27], v8, s[4:7], s16 offen offset:0 sc1
    s_mov_b64 exec, -1
    s_add_u32 s23, s23, 1
    s_cmp_lt_u32 s23, 200000
    s_cbranch_scc1 g_45L3_1
    s_mov_b32 s25, 200000
    s_branch gc_46
g_45F3_1:
    s_mov_b64 exec, vcc
    buffer_load_dwordx4 v[28:31], v8, s[4:7], s16 offen offset:1024 sc1
    s_mov_b64 exec, -1
    s_add_u32 s23, s23, 1
    s_cmp_lt_u32 s23, 200000
    s_cbranch_scc1 g_45L3_0
    s_mov_b32 s25, 200000
    s_branch gc_46
g_45F5_0:
    s_mov_b64 exec, vcc
    buffer_load_dwordx4 v[24:27], v8, s[4:7], s16 offen offset:0 sc1
    s_mov_b64 exec, -1
    s_add_u32 s23, s23, 1
    s_cmp_lt_u32 s23, 200000
    s_cbranch_scc1 g_45L5_2
    s_mov_b32 s25, 200000
    s_branch gc_46
g_45F5_2:
    s_mov_b64 exec, vcc
    buffer_load_dwordx4 v[32:35], v8, s[4:7], s16 offen offset:2048 sc1
    s_mov_b64 exec, -1
    s_add_u32 s23, s23, 1
    s_cmp_lt_u32 s23, 200000
    s_cbranch_scc1 g_45L5_0
    s_mov_b32 s25, 200000
    s_branch gc_46
g_45F6_1:
    s_mov_b64 exec, vcc
    buffer_load_dwordx4 v[28:31], v8, s[4:7], s16 offen offset:1024 sc1
    s_mov_b64 exec, -1
    s_add_u32 s23, s23, 1
    s_cmp_lt_u32 s23, 200000
    s_cbranch_scc1 g_45L6_2
    s_mov_b32 s25, 200000
    s_branch gc_46
g_45F6_2:
    s_mov_b64 exec, vcc
    buffer_load_dwordx4 v[32:35], v8, s[4:7], s16 offen offset:2048 sc1
    s_mov_b64 exec, -1
    s_add_u32 s23, s23, 1
    s_cmp_lt_u32 s23, 200000
    s_cbranch_scc1 g_45L6_1
    s_mov_b32 s25, 200000
    s_branch gc_46
g_45F9_0:
    s_mov_b64 exec, vcc
    buffer_load_dwordx4 v[24:27], v8, s[4:7], s16 offen offset:0 sc1
    s_mov_b64 exec, -1
    s_add_u32 s23, s23, 1
    s_cmp_lt_u32 s23, 200000
    s_cbranch_scc1 g_45L9_3
    s_mov_b32 s25, 200000
    s_branch gc_46
g_45F9_3:
    s_mov_b64 exec, vcc
    buffer_load_dwordx4 v[36:39], v8, s[4:7], s16 offen offset:3072 sc1
    s_mov_b64 exec, -1
    s_add_u32 s23, s23, 1
    s_cmp_lt_u32 s23, 200000
    s_cbranch_scc1 g_45L9_0
    s_mov_b32 s25, 200000
    s_branch gc_46
g_45F10_1:
    s_mov_b64 exec, vcc
    buffer_load_dwordx4 v[28:31], v8, s[4:7], s16 offen offset:1024 sc1
    s_mov_b64 exec, -1
    s_add_u32 s23, s23, 1
    s_cmp_lt_u32 s23, 200000
    s_cbranch_scc1 g_45L10_3
    s_mov_b32 s25, 200000
    s_branch gc_46
g_45F10_3:
    s_mov_b64 exec, vcc
    buffer_load_dwordx4 v[36:39], v8, s[4:7], s16 offen offset:3072 sc1
    s_mov_b64 exec, -1
    s_add_u32 s23, s23, 1
    s_cmp_lt_u32 s23, 200000
    s_cbranch_scc1 g_45L10_1
    s_mov_b32 s25, 200000
    s_branch gc_46
g_45F12_2:
    s_mov_b64 exec, vcc
    buffer_load_dwordx4 v[32:35], v8, s[4:7], s16 offen offset:2048 sc1
    s_mov_b64 exec, -1
    s_add_u32 s23, s23, 1
    s_cmp_lt_u32 s23, 200000
    s_cbranch_scc1 g_45L12_3
    s_mov_b32 s25, 200000
    s_branch gc_46
g_45F12_3:
    s_mov_b64 exec, vcc
    buffer_load_dwordx4 v[36:39], v8, s[4:7], s16 offen offset:3072 sc1
    s_mov_b64 exec, -1
    s_add_u32 s23, s23, 1
    s_cmp_lt_u32 s23, 200000
    s_cbranch_scc1 g_45L12_2
    s_mov_b32 s25, 200000
    s_branch gc_46
g_45F1_0:
    s_mov_b64 exec, vcc
    buffer_load_dwordx4 v[24:27], v8, s[4:7], s16 offen offset:0 sc1
    s_mov_b64 exec, -1
    s_add_u32 s23, s23, 1
    s_cmp_lt_u32 s23, 200000
    s_cbranch_scc1 g_45L1_0
    s_mov_b32 s25, 200000
    s_branch gc_46
g_45F2_1:
    s_mov_b64 exec, vcc
    buffer_load_dwordx4 v[28:31], v8, s[4:7], s16 offen offset:1024 sc1
    s_mov_b64 exec, -1
    s_add_u32 s23, s23, 1
    s_cmp_lt_u32 s23, 200000
    s_cbranch_scc1 g_45L2_1
    s_mov_b32 s25, 200000
    s_branch gc_46
g_45F4_2:
    s_mov_b64 exec, vcc
    buffer_load_dwordx4 v[32:35], v8, s[4:7], s16 offen offset:2048 sc1
    s_mov_b64 exec, -1
    s_add_u32 s23, s23, 1
    s_cmp_lt_u32 s23, 200000
    s_cbranch_scc1 g_45L4_2
    s_mov_b32 s25, 200000
    s_branch gc_46
g_45F8_3:
    s_mov_b64 exec, vcc
    buffer_load_dwordx4 v[36:39], v8, s[4:7], s16 offen offset:3072 sc1
    s_mov_b64 exec, -1
    s_add_u32 s23, s23, 1
    s_cmp_lt_u32 s23, 200000
    s_cbranch_scc1 g_45L8_3
    s_mov_b32 s25, 200000
    s_branch gc_46
.p2align 6
recur_fast_w3:
    s_nop 15
    s_mov_b32 s23, s25
    buffer_load_dwordx4 v[24:27], v2, s[4:7], s16 offen offset:0 sc1
    s_nop 11
    buffer_load_dwordx4 v[28:31], v2, s[4:7], s16 offen offset:1024 sc1
    s_nop 11
    buffer_load_dwordx4 v[32:35], v2, s[4:7], s16 offen offset:2048 sc1
    s_nop 11
    buffer_load_dwordx4 v[36:39], v2, s[4:7], s16 offen offset:3072 sc1
    s_waitcnt vmcnt(3)
    v_max3_u32 v19, v24, v25, v26
    v_max_u32 v19, v19, v27
    v_cmp_eq_u32 vcc, -1, v19
    s_nop 0
    s_cbranch_vccnz g_47F15_0
    v_smfmac_f32_16x16x64_bf16 v[40:43], v[24:27], a[0:7], v172
    s_waitcnt vmcnt(2)
    v_max3_u32 v19, v28, v29, v30
    v_max_u32 v19, v19, v31
    v_smfmac_f32_16x16x64_bf16 v[44:47], v[24:27], a[64:71], v172
    v_cmp_eq_u32 vcc, -1, v19
    v_smfmac_f32_16x16x64_bf16 v[48:51], v[24:27], a[32:39], v172
    v_smfmac_f32_16x16x64_bf16 v[52:55], v[24:27], a[96:103], v172
    s_cbranch_vccnz g_47F14_1
    v_smfmac_f32_16x16x64_bf16 v[40:43], v[28:31], a[8:15], v172
    s_waitcnt vmcnt(1)
    v_max3_u32 v19, v32, v33, v34
    v_max_u32 v19, v19, v35
    v_smfmac_f32_16x16x64_bf16 v[44:47], v[28:31], a[72:79], v172
    v_cmp_eq_u32 vcc, -1, v19
    v_smfmac_f32_16x16x64_bf16 v[48:51], v[28:31], a[40:47], v172
    v_smfmac_f32_16x16x64_bf16 v[52:55], v[28:31], a[104:111], v172
    s_cbranch_vccnz g_47F12_2
    v_smfmac_f32_16x16x64_bf16 v[40:43], v[32:35], a[16:23], v172
    s_waitcnt vmcnt(0)
    v_max3_u32 v19, v36, v37, v38
    v_max_u32 v19, v19, v39
    v_smfmac_f32_16x16x64_bf16 v[44:47], v[32:35], a[80:87], v172
    v_cmp_eq_u32 vcc, -1, v19
    v_smfmac_f32_16x16x64_bf16 v[48:51], v[32:35], a[48:55], v172
    v_smfmac_f32_16x16x64_bf16 v[52:55], v[32:35], a[112:119], v172
    s_cbranch_vccnz g_47F8_3
    v_smfmac_f32_16x16x64_bf16 v[40:43], v[36:39], a[24:31], v172
    v_smfmac_f32_16x16x64_bf16 v[44:47], v[36:39], a[88:95], v172
    v_smfmac_f32_16x16x64_bf16 v[48:51], v[36:39], a[56:63], v172
    v_smfmac_f32_16x16x64_bf16 v[52:55], v[36:39], a[120:127], v172
gc_48:
    v_cvt_pk_bf16_f32 v72, v40, v41
    v_cvt_pk_bf16_f32 v73, v42, v43
    v_cvt_pk_bf16_f32 v74, v44, v45
    v_cvt_pk_bf16_f32 v75, v46, v47
    ds_write_b128 v17, v[72:75] offset:0
    v_cvt_pk_bf16_f32 v76, v48, v49
    v_cvt_pk_bf16_f32 v77, v50, v51
    s_nop 0
    v_cvt_pk_bf16_f32 v78, v52, v53
    v_cvt_pk_bf16_f32 v79, v54, v55
    ds_write_b128 v17, v[76:79] offset:1024
    v_smfmac_f32_16x16x64_bf16 v[56:59], v[24:27], a[128:135], v172
    v_smfmac_f32_16x16x64_bf16 v[60:63], v[24:27], a[160:167], v172
    v_smfmac_f32_16x16x64_bf16 v[56:59], v[28:31], a[136:143], v172
    s_waitcnt lgkmcnt(0)
    s_barrier
    v_smfmac_f32_16x16x64_bf16 v[60:63], v[28:31], a[168:175], v172
    v_smfmac_f32_16x16x64_bf16 v[56:59], v[32:35], a[144:151], v172
    v_smfmac_f32_16x16x64_bf16 v[60:63], v[32:35], a[176:183], v172
    v_smfmac_f32_16x16x64_bf16 v[56:59], v[36:39], a[152:159], v172
    v_smfmac_f32_16x16x64_bf16 v[60:63], v[36:39], a[184:191], v172
    s_nop 4
    v_cvt_pk_bf16_f32 v80, v56, v57
    v_cvt_pk_bf16_f32 v81, v58, v59
    s_nop 0
    v_cvt_pk_bf16_f32 v82, v60, v61
    v_cvt_pk_bf16_f32 v83, v62, v63
    ds_write_b128 v17, v[80:83] offset:8192
    buffer_store_dwordx4 v[204:207], v3, s[4:7], s43 offen
    buffer_store_dwordx4 v[204:207], v3, s[4:7], s43 offen offset:128
    buffer_store_dwordx4 v[204:207], v4, s[4:7], s43 offen
    buffer_store_dwordx2 v[204:205], v7, s[4:7], s43 offen
    buffer_store_dwordx2 v[204:205], v11, s[4:7], s43 offen
    s_cmp_eq_u32 s15, 63
    s_waitcnt lgkmcnt(0)
    s_barrier
    s_cbranch_scc1 recur_end
    s_barrier
    s_nop 15
    s_mov_b32 s23, s25
    buffer_load_dwordx4 v[24:27], v8, s[4:7], s16 offen offset:0 sc1
    s_nop 11
    buffer_load_dwordx4 v[28:31], v8, s[4:7], s16 offen offset:1024 sc1
    s_nop 11
    buffer_load_dwordx4 v[32:35], v8, s[4:7], s16 offen offset:2048 sc1
    s_nop 11
    buffer_load_dwordx4 v[36:39], v8, s[4:7], s16 offen offset:3072 sc1
    s_waitcnt vmcnt(3)
    v_max3_u32 v19, v24, v25, v26
    v_max_u32 v19, v19, v27
    v_cmp_eq_u32 vcc, -1, v19
    s_nop 0
    s_cbranch_vccnz g_49F15_0
    v_smfmac_f32_16x16x64_bf16 v[64:67], v[24:27], a[192:199], v172
    v_smfmac_f32_16x16x64_bf16 v[68:71], v[24:27], a[224:231], v172
    s_waitcnt vmcnt(2)
    v_max3_u32 v19, v28, v29, v30
    v_max_u32 v19, v19, v31
    v_cmp_eq_u32 vcc, -1, v19
    s_nop 0
    s_cbranch_vccnz g_49F14_1
    v_smfmac_f32_16x16x64_bf16 v[64:67], v[28:31], a[200:207], v172
    v_smfmac_f32_16x16x64_bf16 v[68:71], v[28:31], a[232:239], v172
    s_waitcnt vmcnt(1)
    v_max3_u32 v19, v32, v33, v34
    v_max_u32 v19, v19, v35
    v_cmp_eq_u32 vcc, -1, v19
    s_nop 0
    s_cbranch_vccnz g_49F12_2
    v_smfmac_f32_16x16x64_bf16 v[64:67], v[32:35], a[208:215], v172
    v_smfmac_f32_16x16x64_bf16 v[68:71], v[32:35], a[240:247], v172
    s_waitcnt vmcnt(0)
    v_max3_u32 v19, v36, v37, v38
    v_max_u32 v19, v19, v39
    v_cmp_eq_u32 vcc, -1, v19
    s_nop 0
    s_cbranch_vccnz g_49F8_3
    v_smfmac_f32_16x16x64_bf16 v[64:67], v[36:39], a[216:223], v172
    v_smfmac_f32_16x16x64_bf16 v[68:71], v[36:39], a[248:255], v172
    s_nop 4
    v_cvt_pk_bf16_f32 v80, v64, v65
    v_cvt_pk_bf16_f32 v81, v66, v67
    s_nop 0
    v_cvt_pk_bf16_f32 v82, v68, v69
    v_cvt_pk_bf16_f32 v83, v70, v71
    s_nop 1
    v_mfma_f32_16x16x32_bf16 v[88:91], v[80:83], v[84:87], 0
gc_50:
    s_barrier
    ds_read_b128 v[96:99], v16 offset:9216
    ds_read_b128 v[100:103], v16 offset:11264
    ds_read_b128 v[104:107], v16 offset:13312
    s_waitcnt lgkmcnt(2)
    v_mfma_f32_16x16x32_bf16 v[88:91], v[96:99], v[84:87], v[88:91]
    s_waitcnt lgkmcnt(1)
    v_mfma_f32_16x16x32_bf16 v[88:91], v[100:103], v[84:87], v[88:91]
    s_waitcnt lgkmcnt(0)
    v_mfma_f32_16x16x32_bf16 v[88:91], v[104:107], v[84:87], v[88:91]
    s_nop 7
    buffer_store_dwordx4 v[88:91], v9, s[4:7], s84 offen sc1
    s_add_u32 s22, s84, 262144
    s_nop 15
    s_nop 15
    s_nop 15
    s_nop 15
    s_nop 15
    s_nop 15
    s_nop 15
    s_nop 15
    s_mov_b32 s23, s25
    buffer_load_dwordx4 v[96:99], v10, s[4:7], s84 offen sc1
    buffer_load_dwordx4 v[100:103], v23, s[4:7], s84 offen sc1
    buffer_load_dwordx4 v[104:107], v244, s[4:7], s84 offen sc1
    v_mov_b32 v40, 0
    v_mov_b32 v41, 0
    v_mov_b32 v42, 0
    v_mov_b32 v43, 0
    v_mov_b32 v44, 0
    v_mov_b32 v45, 0
    v_mov_b32 v46, 0
    v_mov_b32 v47, 0
    v_mov_b32 v48, 0
    v_mov_b32 v49, 0
    v_mov_b32 v50, 0
    v_mov_b32 v51, 0
    v_mov_b32 v52, 0
    v_mov_b32 v53, 0
    v_mov_b32 v54, 0
    v_mov_b32 v55, 0
    v_mov_b32 v56, 0
    v_mov_b32 v57, 0
    v_mov_b32 v58, 0
    v_mov_b32 v59, 0
    v_mov_b32 v60, 0
    v_mov_b32 v61, 0
    v_mov_b32 v62, 0
    v_mov_b32 v63, 0
    v_mov_b32 v64, 0
    v_mov_b32 v65, 0
    v_mov_b32 v66, 0
    v_mov_b32 v67, 0
    v_mov_b32 v68, 0
    v_mov_b32 v69, 0
    v_mov_b32 v70, 0
    v_mov_b32 v71, 0
pb_53:
    s_waitcnt vmcnt(2)
    v_pk_add_f32 v[120:121], v[88:89], v[96:97]
    v_pk_add_f32 v[122:123], v[90:91], v[98:99]
    s_waitcnt vmcnt(1)
    v_pk_add_f32 v[120:121], v[120:121], v[100:101]
    v_pk_add_f32 v[122:123], v[122:123], v[102:103]
    s_waitcnt vmcnt(0)
    v_pk_add_f32 v[120:121], v[120:121], v[104:105]
    v_pk_add_f32 v[122:123], v[122:123], v[106:107]
    v_cvt_pk_bf16_f32 v180, v120, v121
    v_pk_add_f32 v[124:125], v[120:121], v[122:123]
    v_cvt_pk_bf16_f32 v181, v122, v123
    v_cmpx_o_f32 vcc, v124, v125
    buffer_store_dwordx2 v[180:181], v11, s[4:7], s42 offen
    s_cmp_eq_u64 vcc, -1
    s_mov_b64 exec, -1
    s_cbranch_scc0 pr_51
pg_52:
    s_barrier
    s_mov_b32 s21, s16
    s_mov_b32 s16, s42
    s_mov_b32 s42, s43
    s_mov_b32 s43, s44
    s_mov_b32 s44, s21
    s_add_u32 s95, s95, 524288
    s_lshr_b32 s84, s95, 8
    s_and_b32 s84, s84, 8192
    s_xor_b32 s84, s84, s46
    s_add_u32 s84, s84, s95
    s_add_u32 s15, s15, 1
    s_branch recur_fast_w3
g_47L15_0:
    s_waitcnt vmcnt(3)
    v_max3_u32 v19, v24, v25, v26
    v_max_u32 v19, v19, v27
    v_cmp_eq_u32 vcc, -1, v19
    s_nop 0
    s_cbranch_vccnz g_47F15_0
    v_smfmac_f32_16x16x64_bf16 v[40:43], v[24:27], a[0:7], v172
    v_smfmac_f32_16x16x64_bf16 v[44:47], v[24:27], a[64:71], v172
    v_smfmac_f32_16x16x64_bf16 v[48:51], v[24:27], a[32:39], v172
    v_smfmac_f32_16x16x64_bf16 v[52:55], v[24:27], a[96:103], v172
g_47L14_1:
    s_waitcnt vmcnt(2)
    v_max3_u32 v19, v28, v29, v30
    v_max_u32 v19, v19, v31
    v_cmp_eq_u32 vcc, -1, v19
    s_nop 0
    s_cbranch_vccnz g_47F14_1
    v_smfmac_f32_16x16x64_bf16 v[40:43], v[28:31], a[8:15], v172
    v_smfmac_f32_16x16x64_bf16 v[44:47], v[28:31], a[72:79], v172
    v_smfmac_f32_16x16x64_bf16 v[48:51], v[28:31], a[40:47], v172
    v_smfmac_f32_16x16x64_bf16 v[52:55], v[28:31], a[104:111], v172
g_47L12_2:
    s_waitcnt vmcnt(1)
    v_max3_u32 v19, v32, v33, v34
    v_max_u32 v19, v19, v35
    v_cmp_eq_u32 vcc, -1, v19
    s_nop 0
    s_cbranch_vccnz g_47F12_2
    v_smfmac_f32_16x16x64_bf16 v[40:43], v[32:35], a[16:23], v172
    v_smfmac_f32_16x16x64_bf16 v[44:47], v[32:35], a[80:87], v172
    v_smfmac_f32_16x16x64_bf16 v[48:51], v[32:35], a[48:55], v172
    v_smfmac_f32_16x16x64_bf16 v[52:55], v[32:35], a[112:119], v172
g_47L8_3:
    s_waitcnt vmcnt(0)
    v_max3_u32 v19, v36, v37, v38
    v_max_u32 v19, v19, v39
    v_cmp_eq_u32 vcc, -1, v19
    s_nop 0
    s_cbranch_vccnz g_47F8_3
    v_smfmac_f32_16x16x64_bf16 v[40:43], v[36:39], a[24:31], v172
    v_smfmac_f32_16x16x64_bf16 v[44:47], v[36:39], a[88:95], v172
    v_smfmac_f32_16x16x64_bf16 v[48:51], v[36:39], a[56:63], v172
    v_smfmac_f32_16x16x64_bf16 v[52:55], v[36:39], a[120:127], v172
    s_branch gc_48
g_47L15_1:
    s_waitcnt vmcnt(3)
    v_max3_u32 v19, v28, v29, v30
    v_max_u32 v19, v19, v31
    v_cmp_eq_u32 vcc, -1, v19
    s_nop 0
    s_cbranch_vccnz g_47F15_1
    v_smfmac_f32_16x16x64_bf16 v[40:43], v[28:31], a[8:15], v172
    v_smfmac_f32_16x16x64_bf16 v[44:47], v[28:31], a[72:79], v172
    v_smfmac_f32_16x16x64_bf16 v[48:51], v[28:31], a[40:47], v172
    v_smfmac_f32_16x16x64_bf16 v[52:55], v[28:31], a[104:111], v172
g_47L13_2:
    s_waitcnt vmcnt(2)
    v_max3_u32 v19, v32, v33, v34
    v_max_u32 v19, v19, v35
    v_cmp_eq_u32 vcc, -1, v19
    s_nop 0
    s_cbranch_vccnz g_47F13_2
    v_smfmac_f32_16x16x64_bf16 v[40:43], v[32:35], a[16:23], v172
    v_smfmac_f32_16x16x64_bf16 v[44:47], v[32:35], a[80:87], v172
    v_smfmac_f32_16x16x64_bf16 v[48:51], v[32:35], a[48:55], v172
    v_smfmac_f32_16x16x64_bf16 v[52:55], v[32:35], a[112:119], v172
g_47L9_3:
    s_waitcnt vmcnt(1)
    v_max3_u32 v19, v36, v37, v38
    v_max_u32 v19, v19, v39
    v_cmp_eq_u32 vcc, -1, v19
    s_nop 0
    s_cbranch_vccnz g_47F9_3
    v_smfmac_f32_16x16x64_bf16 v[40:43], v[36:39], a[24:31], v172
    v_smfmac_f32_16x16x64_bf16 v[44:47], v[36:39], a[88:95], v172
    v_smfmac_f32_16x16x64_bf16 v[48:51], v[36:39], a[56:63], v172
    v_smfmac_f32_16x16x64_bf16 v[52:55], v[36:39], a[120:127], v172
g_47L1_0:
    s_waitcnt vmcnt(0)
    v_max3_u32 v19, v24, v25, v26
    v_max_u32 v19, v19, v27
    v_cmp_eq_u32 vcc, -1, v19
    s_nop 0
    s_cbranch_vccnz g_47F1_0
    v_smfmac_f32_16x16x64_bf16 v[40:43], v[24:27], a[0:7], v172
    v_smfmac_f32_16x16x64_bf16 v[44:47], v[24:27], a[64:71], v172
    v_smfmac_f32_16x16x64_bf16 v[48:51], v[24:27], a[32:39], v172
    v_smfmac_f32_16x16x64_bf16 v[52:55], v[24:27], a[96:103], v172
    s_branch gc_48
g_47L15_2:
    s_waitcnt vmcnt(3)
    v_max3_u32 v19, v32, v33, v34
    v_max_u32 v19, v19, v35
    v_cmp_eq_u32 vcc, -1, v19
    s_nop 0
    s_cbranch_vccnz g_47F15_2
    v_smfmac_f32_16x16x64_bf16 v[40:43], v[32:35], a[16:23], v172
    v_smfmac_f32_16x16x64_bf16 v[44:47], v[32:35], a[80:87], v172
    v_smfmac_f32_16x16x64_bf16 v[48:51], v[32:35], a[48:55], v172
    v_smfmac_f32_16x16x64_bf16 v[52:55], v[32:35], a[112:119], v172
g_47L11_3:
    s_waitcnt vmcnt(2)
    v_max3_u32 v19, v36, v37, v38
    v_max_u32 v19, v19, v39
    v_cmp_eq_u32 vcc, -1, v19
    s_nop 0
    s_cbranch_vccnz g_47F11_3
    v_smfmac_f32_16x16x64_bf16 v[40:43], v[36:39], a[24:31], v172
    v_smfmac_f32_16x16x64_bf16 v[44:47], v[36:39], a[88:95], v172
    v_smfmac_f32_16x16x64_bf16 v[48:51], v[36:39], a[56:63], v172
    v_smfmac_f32_16x16x64_bf16 v[52:55], v[36:39], a[120:127], v172
g_47L3_0:
    s_waitcnt vmcnt(1)
    v_max3_u32 v19, v24, v25, v26
    v_max_u32 v19, v19, v27
    v_cmp_eq_u32 vcc, -1, v19
    s_nop 0
    s_cbranch_vccnz g_47F3_0
    v_smfmac_f32_16x16x64_bf16 v[40:43], v[24:27], a[0:7], v172
    v_smfmac_f32_16x16x64_bf16 v[44:47], v[24:27], a[64:71], v172
    v_smfmac_f32_16x16x64_bf16 v[48:51], v[24:27], a[32:39], v172
    v_smfmac_f32_16x16x64_bf16 v[52:55], v[24:27], a[96:103], v172
g_47L2_1:
    s_waitcnt vmcnt(0)
    v_max3_u32 v19, v28, v29, v30
    v_max_u32 v19, v19, v31
    v_cmp_eq_u32 vcc, -1, v19
    s_nop 0
    s_cbranch_vccnz g_47F2_1
    v_smfmac_f32_16x16x64_bf16 v[40:43], v[28:31], a[8:15], v172
    v_smfmac_f32_16x16x64_bf16 v[44:47], v[28:31], a[72:79], v172
    v_smfmac_f32_16x16x64_bf16 v[48:51], v[28:31], a[40:47], v172
    v_smfmac_f32_16x16x64_bf16 v[52:55], v[28:31], a[104:111], v172
    s_branch gc_48
g_47L15_3:
    s_waitcnt vmcnt(3)
    v_max3_u32 v19, v36, v37, v38
    v_max_u32 v19, v19, v39
    v_cmp_eq_u32 vcc, -1, v19
    s_nop 0
    s_cbranch_vccnz g_47F15_3
    v_smfmac_f32_16x16x64_bf16 v[40:43], v[36:39], a[24:31], v172
    v_smfmac_f32_16x16x64_bf16 v[44:47], v[36:39], a[88:95], v172
    v_smfmac_f32_16x16x64_bf16 v[48:51], v[36:39], a[56:63], v172
    v_smfmac_f32_16x16x64_bf16 v[52:55], v[36:39], a[120:127], v172
g_47L7_0:
    s_waitcnt vmcnt(2)
    v_max3_u32 v19, v24, v25, v26
    v_max_u32 v19, v19, v27
    v_cmp_eq_u32 vcc, -1, v19
    s_nop 0
    s_cbranch_vccnz g_47F7_0
    v_smfmac_f32_16x16x64_bf16 v[40:43], v[24:27], a[0:7], v172
    v_smfmac_f32_16x16x64_bf16 v[44:47], v[24:27], a[64:71], v172
    v_smfmac_f32_16x16x64_bf16 v[48:51], v[24:27], a[32:39], v172
    v_smfmac_f32_16x16x64_bf16 v[52:55], v[24:27], a[96:103], v172
g_47L6_1:
    s_waitcnt vmcnt(1)
    v_max3_u32 v19, v28, v29, v30
    v_max_u32 v19, v19, v31
    v_cmp_eq_u32 vcc, -1, v19
    s_nop 0
    s_cbranch_vccnz g_47F6_1
    v_smfmac_f32_16x16x64_bf16 v[40:43], v[28:31], a[8:15], v172
    v_smfmac_f32_16x16x64_bf16 v[44:47], v[28:31], a[72:79], v172
    v_smfmac_f32_16x16x64_bf16 v[48:51], v[28:31], a[40:47], v172
    v_smfmac_f32_16x16x64_bf16 v[52:55], v[28:31], a[104:111], v172
g_47L4_2:
    s_waitcnt vmcnt(0)
    v_max3_u32 v19, v32, v33, v34
    v_max_u32 v19, v19, v35
    v_cmp_eq_u32 vcc, -1, v19
    s_nop 0
    s_cbranch_vccnz g_47F4_2
    v_smfmac_f32_16x16x64_bf16 v[40:43], v[32:35], a[16:23], v172
    v_smfmac_f32_16x16x64_bf16 v[44:47], v[32:35], a[80:87], v172
    v_smfmac_f32_16x16x64_bf16 v[48:51], v[32:35], a[48:55], v172
    v_smfmac_f32_16x16x64_bf16 v[52:55], v[32:35], a[112:119], v172
    s_branch gc_48
g_47L7_1:
    s_waitcnt vmcnt(2)
    v_max3_u32 v19, v28, v29, v30
    v_max_u32 v19, v19, v31
    v_cmp_eq_u32 vcc, -1, v19
    s_nop 0
    s_cbranch_vccnz g_47F7_1
    v_smfmac_f32_16x16x64_bf16 v[40:43], v[28:31], a[8:15], v172
    v_smfmac_f32_16x16x64_bf16 v[44:47], v[28:31], a[72:79], v172
    v_smfmac_f32_16x16x64_bf16 v[48:51], v[28:31], a[40:47], v172
    v_smfmac_f32_16x16x64_bf16 v[52:55], v[28:31], a[104:111], v172
g_47L5_2:
    s_waitcnt vmcnt(1)
    v_max3_u32 v19, v32, v33, v34
    v_max_u32 v19, v19, v35
    v_cmp_eq_u32 vcc, -1, v19
    s_nop 0
    s_cbranch_vccnz g_47F5_2
    v_smfmac_f32_16x16x64_bf16 v[40:43], v[32:35], a[16:23], v172
    v_smfmac_f32_16x16x64_bf16 v[44:47], v[32:35], a[80:87], v172
    v_smfmac_f32_16x16x64_bf16 v[48:51], v[32:35], a[48:55], v172
    v_smfmac_f32_16x16x64_bf16 v[52:55], v[32:35], a[112:119], v172
    s_branch g_47L1_0
g_47L7_2:
    s_waitcnt vmcnt(2)
    v_max3_u32 v19, v32, v33, v34
    v_max_u32 v19, v19, v35
    v_cmp_eq_u32 vcc, -1, v19
    s_nop 0
    s_cbranch_vccnz g_47F7_2
    v_smfmac_f32_16x16x64_bf16 v[40:43], v[32:35], a[16:23], v172
    v_smfmac_f32_16x16x64_bf16 v[44:47], v[32:35], a[80:87], v172
    v_smfmac_f32_16x16x64_bf16 v[48:51], v[32:35], a[48:55], v172
    v_smfmac_f32_16x16x64_bf16 v[52:55], v[32:35], a[112:119], v172
    s_branch g_47L3_0
g_47L11_0:
    s_waitcnt vmcnt(2)
    v_max3_u32 v19, v24, v25, v26
    v_max_u32 v19, v19, v27
    v_cmp_eq_u32 vcc, -1, v19
    s_nop 0
    s_cbranch_vccnz g_47F11_0
    v_smfmac_f32_16x16x64_bf16 v[40:43], v[24:27], a[0:7], v172
    v_smfmac_f32_16x16x64_bf16 v[44:47], v[24:27], a[64:71], v172
    v_smfmac_f32_16x16x64_bf16 v[48:51], v[24:27], a[32:39], v172
    v_smfmac_f32_16x16x64_bf16 v[52:55], v[24:27], a[96:103], v172
g_47L10_1:
    s_waitcnt vmcnt(1)
    v_max3_u32 v19, v28, v29, v30
    v_max_u32 v19, v19, v31
    v_cmp_eq_u32 vcc, -1, v19
    s_nop 0
    s_cbranch_vccnz g_47F10_1
    v_smfmac_f32_16x16x64_bf16 v[40:43], v[28:31], a[8:15], v172
    v_smfmac_f32_16x16x64_bf16 v[44:47], v[28:31], a[72:79], v172
    v_smfmac_f32_16x16x64_bf16 v[48:51], v[28:31], a[40:47], v172
    v_smfmac_f32_16x16x64_bf16 v[52:55], v[28:31], a[104:111], v172
    s_branch g_47L8_3
g_47L11_1:
    s_waitcnt vmcnt(2)
    v_max3_u32 v19, v28, v29, v30
    v_max_u32 v19, v19, v31
    v_cmp_eq_u32 vcc, -1, v19
    s_nop 0
    s_cbranch_vccnz g_47F11_1
    v_smfmac_f32_16x16x64_bf16 v[40:43], v[28:31], a[8:15], v172
    v_smfmac_f32_16x16x64_bf16 v[44:47], v[28:31], a[72:79], v172
    v_smfmac_f32_16x16x64_bf16 v[48:51], v[28:31], a[40:47], v172
    v_smfmac_f32_16x16x64_bf16 v[52:55], v[28:31], a[104:111], v172
    s_branch g_47L9_3
g_47L13_0:
    s_waitcnt vmcnt(2)
    v_max3_u32 v19, v24, v25, v26
    v_max_u32 v19, v19, v27
    v_cmp_eq_u32 vcc, -1, v19
    s_nop 0
    s_cbranch_vccnz g_47F13_0
    v_smfmac_f32_16x16x64_bf16 v[40:43], v[24:27], a[0:7], v172
    v_smfmac_f32_16x16x64_bf16 v[44:47], v[24:27], a[64:71], v172
    v_smfmac_f32_16x16x64_bf16 v[48:51], v[24:27], a[32:39], v172
    v_smfmac_f32_16x16x64_bf16 v[52:55], v[24:27], a[96:103], v172
    s_branch g_47L12_2
g_47L13_3:
    s_waitcnt vmcnt(2)
    v_max3_u32 v19, v36, v37, v38
    v_max_u32 v19, v19, v39
    v_cmp_eq_u32 vcc, -1, v19
    s_nop 0
    s_cbranch_vccnz g_47F13_3
    v_smfmac_f32_16x16x64_bf16 v[40:43], v[36:39], a[24:31], v172
    v_smfmac_f32_16x16x64_bf16 v[44:47], v[36:39], a[88:95], v172
    v_smfmac_f32_16x16x64_bf16 v[48:51], v[36:39], a[56:63], v172
    v_smfmac_f32_16x16x64_bf16 v[52:55], v[36:39], a[120:127], v172
g_47L5_0:
    s_waitcnt vmcnt(1)
    v_max3_u32 v19, v24, v25, v26
    v_max_u32 v19, v19, v27
    v_cmp_eq_u32 vcc, -1, v19
    s_nop 0
    s_cbranch_vccnz g_47F5_0
    v_smfmac_f32_16x16x64_bf16 v[40:43], v[24:27], a[0:7], v172
    v_smfmac_f32_16x16x64_bf16 v[44:47], v[24:27], a[64:71], v172
    v_smfmac_f32_16x16x64_bf16 v[48:51], v[24:27], a[32:39], v172
    v_smfmac_f32_16x16x64_bf16 v[52:55], v[24:27], a[96:103], v172
    s_branch g_47L4_2
g_47L14_2:
    s_waitcnt vmcnt(2)
    v_max3_u32 v19, v32, v33, v34
    v_max_u32 v19, v19, v35
    v_cmp_eq_u32 vcc, -1, v19
    s_nop 0
    s_cbranch_vccnz g_47F14_2
    v_smfmac_f32_16x16x64_bf16 v[40:43], v[32:35], a[16:23], v172
    v_smfmac_f32_16x16x64_bf16 v[44:47], v[32:35], a[80:87], v172
    v_smfmac_f32_16x16x64_bf16 v[48:51], v[32:35], a[48:55], v172
    v_smfmac_f32_16x16x64_bf16 v[52:55], v[32:35], a[112:119], v172
g_47L10_3:
    s_waitcnt vmcnt(1)
    v_max3_u32 v19, v36, v37, v38
    v_max_u32 v19, v19, v39
    v_cmp_eq_u32 vcc, -1, v19
    s_nop 0
    s_cbranch_vccnz g_47F10_3
    v_smfmac_f32_16x16x64_bf16 v[40:43], v[36:39], a[24:31], v172
    v_smfmac_f32_16x16x64_bf16 v[44:47], v[36:39], a[88:95], v172
    v_smfmac_f32_16x16x64_bf16 v[48:51], v[36:39], a[56:63], v172
    v_smfmac_f32_16x16x64_bf16 v[52:55], v[36:39], a[120:127], v172
    s_branch g_47L2_1
g_47L14_3:
    s_waitcnt vmcnt(2)
    v_max3_u32 v19, v36, v37, v38
    v_max_u32 v19, v19, v39
    v_cmp_eq_u32 vcc, -1, v19
    s_nop 0
    s_cbranch_vccnz g_47F14_3
    v_smfmac_f32_16x16x64_bf16 v[40:43], v[36:39], a[24:31], v172
    v_smfmac_f32_16x16x64_bf16 v[44:47], v[36:39], a[88:95], v172
    v_smfmac_f32_16x16x64_bf16 v[48:51], v[36:39], a[56:63], v172
    v_smfmac_f32_16x16x64_bf16 v[52:55], v[36:39], a[120:127], v172
    s_branch g_47L6_1
g_47L3_1:
    s_waitcnt vmcnt(1)
    v_max3_u32 v19, v28, v29, v30
    v_max_u32 v19, v19, v31
    v_cmp_eq_u32 vcc, -1, v19
    s_nop 0
    s_cbranch_vccnz g_47F3_1
    v_smfmac_f32_16x16x64_bf16 v[40:43], v[28:31], a[8:15], v172
    v_smfmac_f32_16x16x64_bf16 v[44:47], v[28:31], a[72:79], v172
    v_smfmac_f32_16x16x64_bf16 v[48:51], v[28:31], a[40:47], v172
    v_smfmac_f32_16x16x64_bf16 v[52:55], v[28:31], a[104:111], v172
    s_branch g_47L1_0
g_47L6_2:
    s_waitcnt vmcnt(1)
    v_max3_u32 v19, v32, v33, v34
    v_max_u32 v19, v19, v35
    v_cmp_eq_u32 vcc, -1, v19
    s_nop 0
    s_cbranch_vccnz g_47F6_2
    v_smfmac_f32_16x16x64_bf16 v[40:43], v[32:35], a[16:23], v172
    v_smfmac_f32_16x16x64_bf16 v[44:47], v[32:35], a[80:87], v172
    v_smfmac_f32_16x16x64_bf16 v[48:51], v[32:35], a[48:55], v172
    v_smfmac_f32_16x16x64_bf16 v[52:55], v[32:35], a[112:119], v172
    s_branch g_47L2_1
g_47L9_0:
    s_waitcnt vmcnt(1)
    v_max3_u32 v19, v24, v25, v26
    v_max_u32 v19, v19, v27
    v_cmp_eq_u32 vcc, -1, v19
    s_nop 0
    s_cbranch_vccnz g_47F9_0
    v_smfmac_f32_16x16x64_bf16 v[40:43], v[24:27], a[0:7], v172
    v_smfmac_f32_16x16x64_bf16 v[44:47], v[24:27], a[64:71], v172
    v_smfmac_f32_16x16x64_bf16 v[48:51], v[24:27], a[32:39], v172
    v_smfmac_f32_16x16x64_bf16 v[52:55], v[24:27], a[96:103], v172
    s_branch g_47L8_3
g_47L12_3:
    s_waitcnt vmcnt(1)
    v_max3_u32 v19, v36, v37, v38
    v_max_u32 v19, v19, v39
    v_cmp_eq_u32 vcc, -1, v19
    s_nop 0
    s_cbranch_vccnz g_47F12_3
    v_smfmac_f32_16x16x64_bf16 v[40:43], v[36:39], a[24:31], v172
    v_smfmac_f32_16x16x64_bf16 v[44:47], v[36:39], a[88:95], v172
    v_smfmac_f32_16x16x64_bf16 v[48:51], v[36:39], a[56:63], v172
    v_smfmac_f32_16x16x64_bf16 v[52:55], v[36:39], a[120:127], v172
    s_branch g_47L4_2
g_47F15_0:
    s_mov_b64 exec, vcc
    buffer_load_dwordx4 v[24:27], v2, s[4:7], s16 offen offset:0 sc1
    s_mov_b64 exec, -1
    s_add_u32 s23, s23, 1
    s_cmp_lt_u32 s23, 200000
    s_cbranch_scc1 g_47L15_1
    s_mov_b32 s25, 200000
    s_branch gc_48
g_47F15_1:
    s_mov_b64 exec, vcc
    buffer_load_dwordx4 v[28:31], v2, s[4:7], s16 offen offset:1024 sc1
    s_mov_b64 exec, -1
    s_add_u32 s23, s23, 1
    s_cmp_lt_u32 s23, 200000
    s_cbranch_scc1 g_47L15_2
    s_mov_b32 s25, 200000
    s_branch gc_48
g_47F15_2:
    s_mov_b64 exec, vcc
    buffer_load_dwordx4 v[32:35], v2, s[4:7], s16 offen offset:2048 sc1
    s_mov_b64 exec, -1
    s_add_u32 s23, s23, 1
    s_cmp_lt_u32 s23, 200000
    s_cbranch_scc1 g_47L15_3
    s_mov_b32 s25, 200000
    s_branch gc_48
g_47F15_3:
    s_mov_b64 exec, vcc
    buffer_load_dwordx4 v[36:39], v2, s[4:7], s16 offen offset:3072 sc1
    s_mov_b64 exec, -1
    s_add_u32 s23, s23, 1
    s_cmp_lt_u32 s23, 200000
    s_cbranch_scc1 g_47L15_0
    s_mov_b32 s25, 200000
    s_branch gc_48
g_47F7_0:
    s_mov_b64 exec, vcc
    buffer_load_dwordx4 v[24:27], v2, s[4:7], s16 offen offset:0 sc1
    s_mov_b64 exec, -1
    s_add_u32 s23, s23, 1
    s_cmp_lt_u32 s23, 200000
    s_cbranch_scc1 g_47L7_1
    s_mov_b32 s25, 200000
    s_branch gc_48
g_47F7_1:
    s_mov_b64 exec, vcc
    buffer_load_dwordx4 v[28:31], v2, s[4:7], s16 offen offset:1024 sc1
    s_mov_b64 exec, -1
    s_add_u32 s23, s23, 1
    s_cmp_lt_u32 s23, 200000
    s_cbranch_scc1 g_47L7_2
    s_mov_b32 s25, 200000
    s_branch gc_48
g_47F7_2:
    s_mov_b64 exec, vcc
    buffer_load_dwordx4 v[32:35], v2, s[4:7], s16 offen offset:2048 sc1
    s_mov_b64 exec, -1
    s_add_u32 s23, s23, 1
    s_cmp_lt_u32 s23, 200000
    s_cbranch_scc1 g_47L7_0
    s_mov_b32 s25, 200000
    s_branch gc_48
g_47F11_0:
    s_mov_b64 exec, vcc
    buffer_load_dwordx4 v[24:27], v2, s[4:7], s16 offen offset:0 sc1
    s_mov_b64 exec, -1
    s_add_u32 s23, s23, 1
    s_cmp_lt_u32 s23, 200000
    s_cbranch_scc1 g_47L11_1
    s_mov_b32 s25, 200000
    s_branch gc_48
g_47F11_1:
    s_mov_b64 exec, vcc
    buffer_load_dwordx4 v[28:31], v2, s[4:7], s16 offen offset:1024 sc1
    s_mov_b64 exec, -1
    s_add_u32 s23, s23, 1
    s_cmp_lt_u32 s23, 200000
    s_cbranch_scc1 g_47L11_3
    s_mov_b32 s25, 200000
    s_branch gc_48
g_47F11_3:
    s_mov_b64 exec, vcc
    buffer_load_dwordx4 v[36:39], v2, s[4:7], s16 offen offset:3072 sc1
    s_mov_b64 exec, -1
    s_add_u32 s23, s23, 1
    s_cmp_lt_u32 s23, 200000
    s_cbranch_scc1 g_47L11_0
    s_mov_b32 s25, 200000
    s_branch gc_48
g_47F13_0:
    s_mov_b64 exec, vcc
    buffer_load_dwordx4 v[24:27], v2, s[4:7], s16 offen offset:0 sc1
    s_mov_b64 exec, -1
    s_add_u32 s23, s23, 1
    s_cmp_lt_u32 s23, 200000
    s_cbranch_scc1 g_47L13_2
    s_mov_b32 s25, 200000
    s_branch gc_48
g_47F13_2:
    s_mov_b64 exec, vcc
    buffer_load_dwordx4 v[32:35], v2, s[4:7], s16 offen offset:2048 sc1
    s_mov_b64 exec, -1
    s_add_u32 s23, s23, 1
    s_cmp_lt_u32 s23, 200000
    s_cbranch_scc1 g_47L13_3
    s_mov_b32 s25, 200000
    s_branch gc_48
g_47F13_3:
    s_mov_b64 exec, vcc
    buffer_load_dwordx4 v[36:39], v2, s[4:7], s16 offen offset:3072 sc1
    s_mov_b64 exec, -1
    s_add_u32 s23, s23, 1
    s_cmp_lt_u32 s23, 200000
    s_cbranch_scc1 g_47L13_0
    s_mov_b32 s25, 200000
    s_branch gc_48
g_47F14_1:
    s_mov_b64 exec, vcc
    buffer_load_dwordx4 v[28:31], v2, s[4:7], s16 offen offset:1024 sc1
    s_mov_b64 exec, -1
    s_add_u32 s23, s23, 1
    s_cmp_lt_u32 s23, 200000
    s_cbranch_scc1 g_47L14_2
    s_mov_b32 s25, 200000
    s_branch gc_48
g_47F14_2:
    s_mov_b64 exec, vcc
    buffer_load_dwordx4 v[32:35], v2, s[4:7], s16 offen offset:2048 sc1
    s_mov_b64 exec, -1
    s_add_u32 s23, s23, 1
    s_cmp_lt_u32 s23, 200000
    s_cbranch_scc1 g_47L14_3
    s_mov_b32 s25, 200000
    s_branch gc_48
g_47F14_3:
    s_mov_b64 exec, vcc
    buffer_load_dwordx4 v[36:39], v2, s[4:7], s16 offen offset:3072 sc1
    s_mov_b64 exec, -1
    s_add_u32 s23, s23, 1
    s_cmp_lt_u32 s23, 200000
    s_cbranch_scc1 g_47L14_1
    s_mov_b32 s25, 200000
    s_branch gc_48
g_47F3_0:
    s_mov_b64 exec, vcc
    buffer_load_dwordx4 v[24:27], v2, s[4:7], s16 offen offset:0 sc1
    s_mov_b64 exec, -1
    s_add_u32 s23, s23, 1
    s_cmp_lt_u32 s23, 200000
    s_cbranch_scc1 g_47L3_1
    s_mov_b32 s25, 200000
    s_branch gc_48
g_47F3_1:
    s_mov_b64 exec, vcc
    buffer_load_dwordx4 v[28:31], v2, s[4:7], s16 offen offset:1024 sc1
    s_mov_b64 exec, -1
    s_add_u32 s23, s23, 1
    s_cmp_lt_u32 s23, 200000
    s_cbranch_scc1 g_47L3_0
    s_mov_b32 s25, 200000
    s_branch gc_48
g_47F5_0:
    s_mov_b64 exec, vcc
    buffer_load_dwordx4 v[24:27], v2, s[4:7], s16 offen offset:0 sc1
    s_mov_b64 exec, -1
    s_add_u32 s23, s23, 1
    s_cmp_lt_u32 s23, 200000
    s_cbranch_scc1 g_47L5_2
    s_mov_b32 s25, 200000
    s_branch gc_48
g_47F5_2:
    s_mov_b64 exec, vcc
    buffer_load_dwordx4 v[32:35], v2, s[4:7], s16 offen offset:2048 sc1
    s_mov_b64 exec, -1
    s_add_u32 s23, s23, 1
    s_cmp_lt_u32 s23, 200000
    s_cbranch_scc1 g_47L5_0
    s_mov_b32 s25, 200000
    s_branch gc_48
g_47F6_1:
    s_mov_b64 exec, vcc
    buffer_load_dwordx4 v[28:31], v2, s[4:7], s16 offen offset:1024 sc1
    s_mov_b64 exec, -1
    s_add_u32 s23, s23, 1
    s_cmp_lt_u32 s23, 200000
    s_cbranch_scc1 g_47L6_2
    s_mov_b32 s25, 200000
    s_branch gc_48
g_47F6_2:
    s_mov_b64 exec, vcc
    buffer_load_dwordx4 v[32:35], v2, s[4:7], s16 offen offset:2048 sc1
    s_mov_b64 exec, -1
    s_add_u32 s23, s23, 1
    s_cmp_lt_u32 s23, 200000
    s_cbranch_scc1 g_47L6_1
    s_mov_b32 s25, 200000
    s_branch gc_48
g_47F9_0:
    s_mov_b64 exec, vcc
    buffer_load_dwordx4 v[24:27], v2, s[4:7], s16 offen offset:0 sc1
    s_mov_b64 exec, -1
    s_add_u32 s23, s23, 1
    s_cmp_lt_u32 s23, 200000
    s_cbranch_scc1 g_47L9_3
    s_mov_b32 s25, 200000
    s_branch gc_48
g_47F9_3:
    s_mov_b64 exec, vcc
    buffer_load_dwordx4 v[36:39], v2, s[4:7], s16 offen offset:3072 sc1
    s_mov_b64 exec, -1
    s_add_u32 s23, s23, 1
    s_cmp_lt_u32 s23, 200000
    s_cbranch_scc1 g_47L9_0
    s_mov_b32 s25, 200000
    s_branch gc_48
g_47F10_1:
    s_mov_b64 exec, vcc
    buffer_load_dwordx4 v[28:31], v2, s[4:7], s16 offen offset:1024 sc1
    s_mov_b64 exec, -1
    s_add_u32 s23, s23, 1
    s_cmp_lt_u32 s23, 200000
    s_cbranch_scc1 g_47L10_3
    s_mov_b32 s25, 200000
    s_branch gc_48
g_47F10_3:
    s_mov_b64 exec, vcc
    buffer_load_dwordx4 v[36:39], v2, s[4:7], s16 offen offset:3072 sc1
    s_mov_b64 exec, -1
    s_add_u32 s23, s23, 1
    s_cmp_lt_u32 s23, 200000
    s_cbranch_scc1 g_47L10_1
    s_mov_b32 s25, 200000
    s_branch gc_48
g_47F12_2:
    s_mov_b64 exec, vcc
    buffer_load_dwordx4 v[32:35], v2, s[4:7], s16 offen offset:2048 sc1
    s_mov_b64 exec, -1
    s_add_u32 s23, s23, 1
    s_cmp_lt_u32 s23, 200000
    s_cbranch_scc1 g_47L12_3
    s_mov_b32 s25, 200000
    s_branch gc_48
g_47F12_3:
    s_mov_b64 exec, vcc
    buffer_load_dwordx4 v[36:39], v2, s[4:7], s16 offen offset:3072 sc1
    s_mov_b64 exec, -1
    s_add_u32 s23, s23, 1
    s_cmp_lt_u32 s23, 200000
    s_cbranch_scc1 g_47L12_2
    s_mov_b32 s25, 200000
    s_branch gc_48
g_47F1_0:
    s_mov_b64 exec, vcc
    buffer_load_dwordx4 v[24:27], v2, s[4:7], s16 offen offset:0 sc1
    s_mov_b64 exec, -1
    s_add_u32 s23, s23, 1
    s_cmp_lt_u32 s23, 200000
    s_cbranch_scc1 g_47L1_0
    s_mov_b32 s25, 200000
    s_branch gc_48
g_47F2_1:
    s_mov_b64 exec, vcc
    buffer_load_dwordx4 v[28:31], v2, s[4:7], s16 offen offset:1024 sc1
    s_mov_b64 exec, -1
    s_add_u32 s23, s23, 1
    s_cmp_lt_u32 s23, 200000
    s_cbranch_scc1 g_47L2_1
    s_mov_b32 s25, 200000
    s_branch gc_48
g_47F4_2:
    s_mov_b64 exec, vcc
    buffer_load_dwordx4 v[32:35], v2, s[4:7], s16 offen offset:2048 sc1
    s_mov_b64 exec, -1
    s_add_u32 s23, s23, 1
    s_cmp_lt_u32 s23, 200000
    s_cbranch_scc1 g_47L4_2
    s_mov_b32 s25, 200000
    s_branch gc_48
g_47F8_3:
    s_mov_b64 exec, vcc
    buffer_load_dwordx4 v[36:39], v2, s[4:7], s16 offen offset:3072 sc1
    s_mov_b64 exec, -1
    s_add_u32 s23, s23, 1
    s_cmp_lt_u32 s23, 200000
    s_cbranch_scc1 g_47L8_3
    s_mov_b32 s25, 200000
    s_branch gc_48
g_49L15_0:
    s_waitcnt vmcnt(3)
    v_max3_u32 v19, v24, v25, v26
    v_max_u32 v19, v19, v27
    v_cmp_eq_u32 vcc, -1, v19
    s_nop 0
    s_cbranch_vccnz g_49F15_0
    v_smfmac_f32_16x16x64_bf16 v[64:67], v[24:27], a[192:199], v172
    v_smfmac_f32_16x16x64_bf16 v[68:71], v[24:27], a[224:231], v172
g_49L14_1:
    s_waitcnt vmcnt(2)
    v_max3_u32 v19, v28, v29, v30
    v_max_u32 v19, v19, v31
    v_cmp_eq_u32 vcc, -1, v19
    s_nop 0
    s_cbranch_vccnz g_49F14_1
    v_smfmac_f32_16x16x64_bf16 v[64:67], v[28:31], a[200:207], v172
    v_smfmac_f32_16x16x64_bf16 v[68:71], v[28:31], a[232:239], v172
g_49L12_2:
    s_waitcnt vmcnt(1)
    v_max3_u32 v19, v32, v33, v34
    v_max_u32 v19, v19, v35
    v_cmp_eq_u32 vcc, -1, v19
    s_nop 0
    s_cbranch_vccnz g_49F12_2
    v_smfmac_f32_16x16x64_bf16 v[64:67], v[32:35], a[208:215], v172
    v_smfmac_f32_16x16x64_bf16 v[68:71], v[32:35], a[240:247], v172
g_49L8_3:
    s_waitcnt vmcnt(0)
    v_max3_u32 v19, v36, v37, v38
    v_max_u32 v19, v19, v39
    v_cmp_eq_u32 vcc, -1, v19
    s_nop 0
    s_cbranch_vccnz g_49F8_3
    v_smfmac_f32_16x16x64_bf16 v[64:67], v[36:39], a[216:223], v172
    v_smfmac_f32_16x16x64_bf16 v[68:71], v[36:39], a[248:255], v172
    s_nop 4
    v_cvt_pk_bf16_f32 v80, v64, v65
    v_cvt_pk_bf16_f32 v81, v66, v67
    s_nop 0
    v_cvt_pk_bf16_f32 v82, v68, v69
    v_cvt_pk_bf16_f32 v83, v70, v71
    s_nop 1
    v_mfma_f32_16x16x32_bf16 v[88:91], v[80:83], v[84:87], 0
    s_branch gc_50
g_49L15_1:
    s_waitcnt vmcnt(3)
    v_max3_u32 v19, v28, v29, v30
    v_max_u32 v19, v19, v31
    v_cmp_eq_u32 vcc, -1, v19
    s_nop 0
    s_cbranch_vccnz g_49F15_1
    v_smfmac_f32_16x16x64_bf16 v[64:67], v[28:31], a[200:207], v172
    v_smfmac_f32_16x16x64_bf16 v[68:71], v[28:31], a[232:239], v172
g_49L13_2:
    s_waitcnt vmcnt(2)
    v_max3_u32 v19, v32, v33, v34
    v_max_u32 v19, v19, v35
    v_cmp_eq_u32 vcc, -1, v19
    s_nop 0
    s_cbranch_vccnz g_49F13_2
    v_smfmac_f32_16x16x64_bf16 v[64:67], v[32:35], a[208:215], v172
    v_smfmac_f32_16x16x64_bf16 v[68:71], v[32:35], a[240:247], v172
g_49L9_3:
    s_waitcnt vmcnt(1)
    v_max3_u32 v19, v36, v37, v38
    v_max_u32 v19, v19, v39
    v_cmp_eq_u32 vcc, -1, v19
    s_nop 0
    s_cbranch_vccnz g_49F9_3
    v_smfmac_f32_16x16x64_bf16 v[64:67], v[36:39], a[216:223], v172
    v_smfmac_f32_16x16x64_bf16 v[68:71], v[36:39], a[248:255], v172
g_49L1_0:
    s_waitcnt vmcnt(0)
    v_max3_u32 v19, v24, v25, v26
    v_max_u32 v19, v19, v27
    v_cmp_eq_u32 vcc, -1, v19
    s_nop 0
    s_cbranch_vccnz g_49F1_0
    v_smfmac_f32_16x16x64_bf16 v[64:67], v[24:27], a[192:199], v172
    v_smfmac_f32_16x16x64_bf16 v[68:71], v[24:27], a[224:231], v172
    s_nop 4
    v_cvt_pk_bf16_f32 v80, v64, v65
    v_cvt_pk_bf16_f32 v81, v66, v67
    s_nop 0
    v_cvt_pk_bf16_f32 v82, v68, v69
    v_cvt_pk_bf16_f32 v83, v70, v71
    s_nop 1
    v_mfma_f32_16x16x32_bf16 v[88:91], v[80:83], v[84:87], 0
    s_branch gc_50
g_49L15_2:
    s_waitcnt vmcnt(3)
    v_max3_u32 v19, v32, v33, v34
    v_max_u32 v19, v19, v35
    v_cmp_eq_u32 vcc, -1, v19
    s_nop 0
    s_cbranch_vccnz g_49F15_2
    v_smfmac_f32_16x16x64_bf16 v[64:67], v[32:35], a[208:215], v172
    v_smfmac_f32_16x16x64_bf16 v[68:71], v[32:35], a[240:247], v172
g_49L11_3:
    s_waitcnt vmcnt(2)
    v_max3_u32 v19, v36, v37, v38
    v_max_u32 v19, v19, v39
    v_cmp_eq_u32 vcc, -1, v19
    s_nop 0
    s_cbranch_vccnz g_49F11_3
    v_smfmac_f32_16x16x64_bf16 v[64:67], v[36:39], a[216:223], v172
    v_smfmac_f32_16x16x64_bf16 v[68:71], v[36:39], a[248:255], v172
g_49L3_0:
    s_waitcnt vmcnt(1)
    v_max3_u32 v19, v24, v25, v26
    v_max_u32 v19, v19, v27
    v_cmp_eq_u32 vcc, -1, v19
    s_nop 0
    s_cbranch_vccnz g_49F3_0
    v_smfmac_f32_16x16x64_bf16 v[64:67], v[24:27], a[192:199], v172
    v_smfmac_f32_16x16x64_bf16 v[68:71], v[24:27], a[224:231], v172
g_49L2_1:
    s_waitcnt vmcnt(0)
    v_max3_u32 v19, v28, v29, v30
    v_max_u32 v19, v19, v31
    v_cmp_eq_u32 vcc, -1, v19
    s_nop 0
    s_cbranch_vccnz g_49F2_1
    v_smfmac_f32_16x16x64_bf16 v[64:67], v[28:31], a[200:207], v172
    v_smfmac_f32_16x16x64_bf16 v[68:71], v[28:31], a[232:239], v172
    s_nop 4
    v_cvt_pk_bf16_f32 v80, v64, v65
    v_cvt_pk_bf16_f32 v81, v66, v67
    s_nop 0
    v_cvt_pk_bf16_f32 v82, v68, v69
    v_cvt_pk_bf16_f32 v83, v70, v71
    s_nop 1
    v_mfma_f32_16x16x32_bf16 v[88:91], v[80:83], v[84:87], 0
    s_branch gc_50
g_49L15_3:
    s_waitcnt vmcnt(3)
    v_max3_u32 v19, v36, v37, v38
    v_max_u32 v19, v19, v39
    v_cmp_eq_u32 vcc, -1, v19
    s_nop 0
    s_cbranch_vccnz g_49F15_3
    v_smfmac_f32_16x16x64_bf16 v[64:67], v[36:39], a[216:223], v172
    v_smfmac_f32_16x16x64_bf16 v[68:71], v[36:39], a[248:255], v172
g_49L7_0:
    s_waitcnt vmcnt(2)
    v_max3_u32 v19, v24, v25, v26
    v_max_u32 v19, v19, v27
    v_cmp_eq_u32 vcc, -1, v19
    s_nop 0
    s_cbranch_vccnz g_49F7_0
    v_smfmac_f32_16x16x64_bf16 v[64:67], v[24:27], a[192:199], v172
    v_smfmac_f32_16x16x64_bf16 v[68:71], v[24:27], a[224:231], v172
g_49L6_1:
    s_waitcnt vmcnt(1)
    v_max3_u32 v19, v28, v29, v30
    v_max_u32 v19, v19, v31
    v_cmp_eq_u32 vcc, -1, v19
    s_nop 0
    s_cbranch_vccnz g_49F6_1
    v_smfmac_f32_16x16x64_bf16 v[64:67], v[28:31], a[200:207], v172
    v_smfmac_f32_16x16x64_bf16 v[68:71], v[28:31], a[232:239], v172
g_49L4_2:
    s_waitcnt vmcnt(0)
    v_max3_u32 v19, v32, v33, v34
    v_max_u32 v19, v19, v35
    v_cmp_eq_u32 vcc, -1, v19
    s_nop 0
    s_cbranch_vccnz g_49F4_2
    v_smfmac_f32_16x16x64_bf16 v[64:67], v[32:35], a[208:215], v172
    v_smfmac_f32_16x16x64_bf16 v[68:71], v[32:35], a[240:247], v172
    s_nop 4
    v_cvt_pk_bf16_f32 v80, v64, v65
    v_cvt_pk_bf16_f32 v81, v66, v67
    s_nop 0
    v_cvt_pk_bf16_f32 v82, v68, v69
    v_cvt_pk_bf16_f32 v83, v70, v71
    s_nop 1
    v_mfma_f32_16x16x32_bf16 v[88:91], v[80:83], v[84:87], 0
    s_branch gc_50
g_49L7_1:
    s_waitcnt vmcnt(2)
    v_max3_u32 v19, v28, v29, v30
    v_max_u32 v19, v19, v31
    v_cmp_eq_u32 vcc, -1, v19
    s_nop 0
    s_cbranch_vccnz g_49F7_1
    v_smfmac_f32_16x16x64_bf16 v[64:67], v[28:31], a[200:207], v172
    v_smfmac_f32_16x16x64_bf16 v[68:71], v[28:31], a[232:239], v172
g_49L5_2:
    s_waitcnt vmcnt(1)
    v_max3_u32 v19, v32, v33, v34
    v_max_u32 v19, v19, v35
    v_cmp_eq_u32 vcc, -1, v19
    s_nop 0
    s_cbranch_vccnz g_49F5_2
    v_smfmac_f32_16x16x64_bf16 v[64:67], v[32:35], a[208:215], v172
    v_smfmac_f32_16x16x64_bf16 v[68:71], v[32:35], a[240:247], v172
    s_branch g_49L1_0
g_49L7_2:
    s_waitcnt vmcnt(2)
    v_max3_u32 v19, v32, v33, v34
    v_max_u32 v19, v19, v35
    v_cmp_eq_u32 vcc, -1, v19
    s_nop 0
    s_cbranch_vccnz g_49F7_2
    v_smfmac_f32_16x16x64_bf16 v[64:67], v[32:35], a[208:215], v172
    v_smfmac_f32_16x16x64_bf16 v[68:71], v[32:35], a[240:247], v172
    s_branch g_49L3_0
g_49L11_0:
    s_waitcnt vmcnt(2)
    v_max3_u32 v19, v24, v25, v26
    v_max_u32 v19, v19, v27
    v_cmp_eq_u32 vcc, -1, v19
    s_nop 0
    s_cbranch_vccnz g_49F11_0
    v_smfmac_f32_16x16x64_bf16 v[64:67], v[24:27], a[192:199], v172
    v_smfmac_f32_16x16x64_bf16 v[68:71], v[24:27], a[224:231], v172
g_49L10_1:
    s_waitcnt vmcnt(1)
    v_max3_u32 v19, v28, v29, v30
    v_max_u32 v19, v19, v31
    v_cmp_eq_u32 vcc, -1, v19
    s_nop 0
    s_cbranch_vccnz g_49F10_1
    v_smfmac_f32_16x16x64_bf16 v[64:67], v[28:31], a[200:207], v172
    v_smfmac_f32_16x16x64_bf16 v[68:71], v[28:31], a[232:239], v172
    s_branch g_49L8_3
g_49L11_1:
    s_waitcnt vmcnt(2)
    v_max3_u32 v19, v28, v29, v30
    v_max_u32 v19, v19, v31
    v_cmp_eq_u32 vcc, -1, v19
    s_nop 0
    s_cbranch_vccnz g_49F11_1
    v_smfmac_f32_16x16x64_bf16 v[64:67], v[28:31], a[200:207], v172
    v_smfmac_f32_16x16x64_bf16 v[68:71], v[28:31], a[232:239], v172
    s_branch g_49L9_3
g_49L13_0:
    s_waitcnt vmcnt(2)
    v_max3_u32 v19, v24, v25, v26
    v_max_u32 v19, v19, v27
    v_cmp_eq_u32 vcc, -1, v19
    s_nop 0
    s_cbranch_vccnz g_49F13_0
    v_smfmac_f32_16x16x64_bf16 v[64:67], v[24:27], a[192:199], v172
    v_smfmac_f32_16x16x64_bf16 v[68:71], v[24:27], a[224:231], v172
    s_branch g_49L12_2
g_49L13_3:
    s_waitcnt vmcnt(2)
    v_max3_u32 v19, v36, v37, v38
    v_max_u32 v19, v19, v39
    v_cmp_eq_u32 vcc, -1, v19
    s_nop 0
    s_cbranch_vccnz g_49F13_3
    v_smfmac_f32_16x16x64_bf16 v[64:67], v[36:39], a[216:223], v172
    v_smfmac_f32_16x16x64_bf16 v[68:71], v[36:39], a[248:255], v172
g_49L5_0:
    s_waitcnt vmcnt(1)
    v_max3_u32 v19, v24, v25, v26
    v_max_u32 v19, v19, v27
    v_cmp_eq_u32 vcc, -1, v19
    s_nop 0
    s_cbranch_vccnz g_49F5_0
    v_smfmac_f32_16x16x64_bf16 v[64:67], v[24:27], a[192:199], v172
    v_smfmac_f32_16x16x64_bf16 v[68:71], v[24:27], a[224:231], v172
    s_branch g_49L4_2
g_49L14_2:
    s_waitcnt vmcnt(2)
    v_max3_u32 v19, v32, v33, v34
    v_max_u32 v19, v19, v35
    v_cmp_eq_u32 vcc, -1, v19
    s_nop 0
    s_cbranch_vccnz g_49F14_2
    v_smfmac_f32_16x16x64_bf16 v[64:67], v[32:35], a[208:215], v172
    v_smfmac_f32_16x16x64_bf16 v[68:71], v[32:35], a[240:247], v172
g_49L10_3:
    s_waitcnt vmcnt(1)
    v_max3_u32 v19, v36, v37, v38
    v_max_u32 v19, v19, v39
    v_cmp_eq_u32 vcc, -1, v19
    s_nop 0
    s_cbranch_vccnz g_49F10_3
    v_smfmac_f32_16x16x64_bf16 v[64:67], v[36:39], a[216:223], v172
    v_smfmac_f32_16x16x64_bf16 v[68:71], v[36:39], a[248:255], v172
    s_branch g_49L2_1
g_49L14_3:
    s_waitcnt vmcnt(2)
    v_max3_u32 v19, v36, v37, v38
    v_max_u32 v19, v19, v39
    v_cmp_eq_u32 vcc, -1, v19
    s_nop 0
    s_cbranch_vccnz g_49F14_3
    v_smfmac_f32_16x16x64_bf16 v[64:67], v[36:39], a[216:223], v172
    v_smfmac_f32_16x16x64_bf16 v[68:71], v[36:39], a[248:255], v172
    s_branch g_49L6_1
g_49L3_1:
    s_waitcnt vmcnt(1)
    v_max3_u32 v19, v28, v29, v30
    v_max_u32 v19, v19, v31
    v_cmp_eq_u32 vcc, -1, v19
    s_nop 0
    s_cbranch_vccnz g_49F3_1
    v_smfmac_f32_16x16x64_bf16 v[64:67], v[28:31], a[200:207], v172
    v_smfmac_f32_16x16x64_bf16 v[68:71], v[28:31], a[232:239], v172
    s_branch g_49L1_0
g_49L6_2:
    s_waitcnt vmcnt(1)
    v_max3_u32 v19, v32, v33, v34
    v_max_u32 v19, v19, v35
    v_cmp_eq_u32 vcc, -1, v19
    s_nop 0
    s_cbranch_vccnz g_49F6_2
    v_smfmac_f32_16x16x64_bf16 v[64:67], v[32:35], a[208:215], v172
    v_smfmac_f32_16x16x64_bf16 v[68:71], v[32:35], a[240:247], v172
    s_branch g_49L2_1
g_49L9_0:
    s_waitcnt vmcnt(1)
    v_max3_u32 v19, v24, v25, v26
    v_max_u32 v19, v19, v27
    v_cmp_eq_u32 vcc, -1, v19
    s_nop 0
    s_cbranch_vccnz g_49F9_0
    v_smfmac_f32_16x16x64_bf16 v[64:67], v[24:27], a[192:199], v172
    v_smfmac_f32_16x16x64_bf16 v[68:71], v[24:27], a[224:231], v172
    s_branch g_49L8_3
g_49L12_3:
    s_waitcnt vmcnt(1)
    v_max3_u32 v19, v36, v37, v38
    v_max_u32 v19, v19, v39
    v_cmp_eq_u32 vcc, -1, v19
    s_nop 0
    s_cbranch_vccnz g_49F12_3
    v_smfmac_f32_16x16x64_bf16 v[64:67], v[36:39], a[216:223], v172
    v_smfmac_f32_16x16x64_bf16 v[68:71], v[36:39], a[248:255], v172
    s_branch g_49L4_2
g_49F15_0:
    s_mov_b64 exec, vcc
    buffer_load_dwordx4 v[24:27], v8, s[4:7], s16 offen offset:0 sc1
    s_mov_b64 exec, -1
    s_add_u32 s23, s23, 1
    s_cmp_lt_u32 s23, 200000
    s_cbranch_scc1 g_49L15_1
    s_mov_b32 s25, 200000
    s_branch gc_50
g_49F15_1:
    s_mov_b64 exec, vcc
    buffer_load_dwordx4 v[28:31], v8, s[4:7], s16 offen offset:1024 sc1
    s_mov_b64 exec, -1
    s_add_u32 s23, s23, 1
    s_cmp_lt_u32 s23, 200000
    s_cbranch_scc1 g_49L15_2
    s_mov_b32 s25, 200000
    s_branch gc_50
g_49F15_2:
    s_mov_b64 exec, vcc
    buffer_load_dwordx4 v[32:35], v8, s[4:7], s16 offen offset:2048 sc1
    s_mov_b64 exec, -1
    s_add_u32 s23, s23, 1
    s_cmp_lt_u32 s23, 200000
    s_cbranch_scc1 g_49L15_3
    s_mov_b32 s25, 200000
    s_branch gc_50
g_49F15_3:
    s_mov_b64 exec, vcc
    buffer_load_dwordx4 v[36:39], v8, s[4:7], s16 offen offset:3072 sc1
    s_mov_b64 exec, -1
    s_add_u32 s23, s23, 1
    s_cmp_lt_u32 s23, 200000
    s_cbranch_scc1 g_49L15_0
    s_mov_b32 s25, 200000
    s_branch gc_50
g_49F7_0:
    s_mov_b64 exec, vcc
    buffer_load_dwordx4 v[24:27], v8, s[4:7], s16 offen offset:0 sc1
    s_mov_b64 exec, -1
    s_add_u32 s23, s23, 1
    s_cmp_lt_u32 s23, 200000
    s_cbranch_scc1 g_49L7_1
    s_mov_b32 s25, 200000
    s_branch gc_50
g_49F7_1:
    s_mov_b64 exec, vcc
    buffer_load_dwordx4 v[28:31], v8, s[4:7], s16 offen offset:1024 sc1
    s_mov_b64 exec, -1
    s_add_u32 s23, s23, 1
    s_cmp_lt_u32 s23, 200000
    s_cbranch_scc1 g_49L7_2
    s_mov_b32 s25, 200000
    s_branch gc_50
g_49F7_2:
    s_mov_b64 exec, vcc
    buffer_load_dwordx4 v[32:35], v8, s[4:7], s16 offen offset:2048 sc1
    s_mov_b64 exec, -1
    s_add_u32 s23, s23, 1
    s_cmp_lt_u32 s23, 200000
    s_cbranch_scc1 g_49L7_0
    s_mov_b32 s25, 200000
    s_branch gc_50
g_49F11_0:
    s_mov_b64 exec, vcc
    buffer_load_dwordx4 v[24:27], v8, s[4:7], s16 offen offset:0 sc1
    s_mov_b64 exec, -1
    s_add_u32 s23, s23, 1
    s_cmp_lt_u32 s23, 200000
    s_cbranch_scc1 g_49L11_1
    s_mov_b32 s25, 200000
    s_branch gc_50
g_49F11_1:
    s_mov_b64 exec, vcc
    buffer_load_dwordx4 v[28:31], v8, s[4:7], s16 offen offset:1024 sc1
    s_mov_b64 exec, -1
    s_add_u32 s23, s23, 1
    s_cmp_lt_u32 s23, 200000
    s_cbranch_scc1 g_49L11_3
    s_mov_b32 s25, 200000
    s_branch gc_50
g_49F11_3:
    s_mov_b64 exec, vcc
    buffer_load_dwordx4 v[36:39], v8, s[4:7], s16 offen offset:3072 sc1
    s_mov_b64 exec, -1
    s_add_u32 s23, s23, 1
    s_cmp_lt_u32 s23, 200000
    s_cbranch_scc1 g_49L11_0
    s_mov_b32 s25, 200000
    s_branch gc_50
g_49F13_0:
    s_mov_b64 exec, vcc
    buffer_load_dwordx4 v[24:27], v8, s[4:7], s16 offen offset:0 sc1
    s_mov_b64 exec, -1
    s_add_u32 s23, s23, 1
    s_cmp_lt_u32 s23, 200000
    s_cbranch_scc1 g_49L13_2
    s_mov_b32 s25, 200000
    s_branch gc_50
g_49F13_2:
    s_mov_b64 exec, vcc
    buffer_load_dwordx4 v[32:35], v8, s[4:7], s16 offen offset:2048 sc1
    s_mov_b64 exec, -1
    s_add_u32 s23, s23, 1
    s_cmp_lt_u32 s23, 200000
    s_cbranch_scc1 g_49L13_3
    s_mov_b32 s25, 200000
    s_branch gc_50
g_49F13_3:
    s_mov_b64 exec, vcc
    buffer_load_dwordx4 v[36:39], v8, s[4:7], s16 offen offset:3072 sc1
    s_mov_b64 exec, -1
    s_add_u32 s23, s23, 1
    s_cmp_lt_u32 s23, 200000
    s_cbranch_scc1 g_49L13_0
    s_mov_b32 s25, 200000
    s_branch gc_50
g_49F14_1:
    s_mov_b64 exec, vcc
    buffer_load_dwordx4 v[28:31], v8, s[4:7], s16 offen offset:1024 sc1
    s_mov_b64 exec, -1
    s_add_u32 s23, s23, 1
    s_cmp_lt_u32 s23, 200000
    s_cbranch_scc1 g_49L14_2
    s_mov_b32 s25, 200000
    s_branch gc_50
g_49F14_2:
    s_mov_b64 exec, vcc
    buffer_load_dwordx4 v[32:35], v8, s[4:7], s16 offen offset:2048 sc1
    s_mov_b64 exec, -1
    s_add_u32 s23, s23, 1
    s_cmp_lt_u32 s23, 200000
    s_cbranch_scc1 g_49L14_3
    s_mov_b32 s25, 200000
    s_branch gc_50
g_49F14_3:
    s_mov_b64 exec, vcc
    buffer_load_dwordx4 v[36:39], v8, s[4:7], s16 offen offset:3072 sc1
    s_mov_b64 exec, -1
    s_add_u32 s23, s23, 1
    s_cmp_lt_u32 s23, 200000
    s_cbranch_scc1 g_49L14_1
    s_mov_b32 s25, 200000
    s_branch gc_50
g_49F3_0:
    s_mov_b64 exec, vcc
    buffer_load_dwordx4 v[24:27], v8, s[4:7], s16 offen offset:0 sc1
    s_mov_b64 exec, -1
    s_add_u32 s23, s23, 1
    s_cmp_lt_u32 s23, 200000
    s_cbranch_scc1 g_49L3_1
    s_mov_b32 s25, 200000
    s_branch gc_50
g_49F3_1:
    s_mov_b64 exec, vcc
    buffer_load_dwordx4 v[28:31], v8, s[4:7], s16 offen offset:1024 sc1
    s_mov_b64 exec, -1
    s_add_u32 s23, s23, 1
    s_cmp_lt_u32 s23, 200000
    s_cbranch_scc1 g_49L3_0
    s_mov_b32 s25, 200000
    s_branch gc_50
g_49F5_0:
    s_mov_b64 exec, vcc
    buffer_load_dwordx4 v[24:27], v8, s[4:7], s16 offen offset:0 sc1
    s_mov_b64 exec, -1
    s_add_u32 s23, s23, 1
    s_cmp_lt_u32 s23, 200000
    s_cbranch_scc1 g_49L5_2
    s_mov_b32 s25, 200000
    s_branch gc_50
g_49F5_2:
    s_mov_b64 exec, vcc
    buffer_load_dwordx4 v[32:35], v8, s[4:7], s16 offen offset:2048 sc1
    s_mov_b64 exec, -1
    s_add_u32 s23, s23, 1
    s_cmp_lt_u32 s23, 200000
    s_cbranch_scc1 g_49L5_0
    s_mov_b32 s25, 200000
    s_branch gc_50
g_49F6_1:
    s_mov_b64 exec, vcc
    buffer_load_dwordx4 v[28:31], v8, s[4:7], s16 offen offset:1024 sc1
    s_mov_b64 exec, -1
    s_add_u32 s23, s23, 1
    s_cmp_lt_u32 s23, 200000
    s_cbranch_scc1 g_49L6_2
    s_mov_b32 s25, 200000
    s_branch gc_50
g_49F6_2:
    s_mov_b64 exec, vcc
    buffer_load_dwordx4 v[32:35], v8, s[4:7], s16 offen offset:2048 sc1
    s_mov_b64 exec, -1
    s_add_u32 s23, s23, 1
    s_cmp_lt_u32 s23, 200000
    s_cbranch_scc1 g_49L6_1
    s_mov_b32 s25, 200000
    s_branch gc_50
g_49F9_0:
    s_mov_b64 exec, vcc
    buffer_load_dwordx4 v[24:27], v8, s[4:7], s16 offen offset:0 sc1
    s_mov_b64 exec, -1
    s_add_u32 s23, s23, 1
    s_cmp_lt_u32 s23, 200000
    s_cbranch_scc1 g_49L9_3
    s_mov_b32 s25, 200000
    s_branch gc_50
g_49F9_3:
    s_mov_b64 exec, vcc
    buffer_load_dwordx4 v[36:39], v8, s[4:7], s16 offen offset:3072 sc1
    s_mov_b64 exec, -1
    s_add_u32 s23, s23, 1
    s_cmp_lt_u32 s23, 200000
    s_cbranch_scc1 g_49L9_0
    s_mov_b32 s25, 200000
    s_branch gc_50
g_49F10_1:
    s_mov_b64 exec, vcc
    buffer_load_dwordx4 v[28:31], v8, s[4:7], s16 offen offset:1024 sc1
    s_mov_b64 exec, -1
    s_add_u32 s23, s23, 1
    s_cmp_lt_u32 s23, 200000
    s_cbranch_scc1 g_49L10_3
    s_mov_b32 s25, 200000
    s_branch gc_50
g_49F10_3:
    s_mov_b64 exec, vcc
    buffer_load_dwordx4 v[36:39], v8, s[4:7], s16 offen offset:3072 sc1
    s_mov_b64 exec, -1
    s_add_u32 s23, s23, 1
    s_cmp_lt_u32 s23, 200000
    s_cbranch_scc1 g_49L10_1
    s_mov_b32 s25, 200000
    s_branch gc_50
g_49F12_2:
    s_mov_b64 exec, vcc
    buffer_load_dwordx4 v[32:35], v8, s[4:7], s16 offen offset:2048 sc1
    s_mov_b64 exec, -1
    s_add_u32 s23, s23, 1
    s_cmp_lt_u32 s23, 200000
    s_cbranch_scc1 g_49L12_3
    s_mov_b32 s25, 200000
    s_branch gc_50
g_49F12_3:
    s_mov_b64 exec, vcc
    buffer_load_dwordx4 v[36:39], v8, s[4:7], s16 offen offset:3072 sc1
    s_mov_b64 exec, -1
    s_add_u32 s23, s23, 1
    s_cmp_lt_u32 s23, 200000
    s_cbranch_scc1 g_49L12_2
    s_mov_b32 s25, 200000
    s_branch gc_50
g_49F1_0:
    s_mov_b64 exec, vcc
    buffer_load_dwordx4 v[24:27], v8, s[4:7], s16 offen offset:0 sc1
    s_mov_b64 exec, -1
    s_add_u32 s23, s23, 1
    s_cmp_lt_u32 s23, 200000
    s_cbranch_scc1 g_49L1_0
    s_mov_b32 s25, 200000
    s_branch gc_50
g_49F2_1:
    s_mov_b64 exec, vcc
    buffer_load_dwordx4 v[28:31], v8, s[4:7], s16 offen offset:1024 sc1
    s_mov_b64 exec, -1
    s_add_u32 s23, s23, 1
    s_cmp_lt_u32 s23, 200000
    s_cbranch_scc1 g_49L2_1
    s_mov_b32 s25, 200000
    s_branch gc_50
g_49F4_2:
    s_mov_b64 exec, vcc
    buffer_load_dwordx4 v[32:35], v8, s[4:7], s16 offen offset:2048 sc1
    s_mov_b64 exec, -1
    s_add_u32 s23, s23, 1
    s_cmp_lt_u32 s23, 200000
    s_cbranch_scc1 g_49L4_2
    s_mov_b32 s25, 200000
    s_branch gc_50
g_49F8_3:
    s_mov_b64 exec, vcc
    buffer_load_dwordx4 v[36:39], v8, s[4:7], s16 offen offset:3072 sc1
    s_mov_b64 exec, -1
    s_add_u32 s23, s23, 1
    s_cmp_lt_u32 s23, 200000
    s_cbranch_scc1 g_49L8_3
    s_mov_b32 s25, 200000
    s_branch gc_50
pr_51:
    v_max3_u32 v19, v96, v97, v98
    v_max3_u32 v19, v19, v99, v100
    v_max3_u32 v19, v19, v101, v102
    v_max3_u32 v19, v19, v103, v104
    v_max3_u32 v19, v19, v105, v106
    v_max_u32 v19, v19, v107
    v_cmp_eq_u32 vcc, -1, v19
    s_nop 0
    s_cbranch_vccz pf_55
    buffer_load_dwordx4 v[96:99], v10, s[4:7], s84 offen sc1
    buffer_load_dwordx4 v[100:103], v23, s[4:7], s84 offen sc1
    buffer_load_dwordx4 v[104:107], v244, s[4:7], s84 offen sc1
    s_add_u32 s23, s23, 1
    s_cmp_lt_u32 s23, 200000
    s_cbranch_scc1 pb_53
    s_mov_b32 s25, 200000
pf_55:
    buffer_store_dwordx2 v[180:181], v11, s[4:7], s42 offen
    s_branch pg_52
.p2align 6
recur_slow_w0:
    s_nop 15
    s_mov_b32 s23, s25
g_56:
    buffer_load_dwordx4 v[24:27], v2, s[4:7], s16 offen offset:0 sc1
    buffer_load_dwordx4 v[28:31], v2, s[4:7], s16 offen offset:1024 sc1
    buffer_load_dwordx4 v[32:35], v2, s[4:7], s16 offen offset:2048 sc1
    buffer_load_dwordx4 v[36:39], v2, s[4:7], s16 offen offset:3072 sc1
    s_waitcnt vmcnt(0)
    v_max3_u32 v19, v24, v25, v26
    v_max3_u32 v19, v19, v27, v28
    v_max3_u32 v19, v19, v29, v30
    v_max3_u32 v19, v19, v31, v32
    v_max3_u32 v19, v19, v33, v34
    v_max3_u32 v19, v19, v35, v36
    v_max3_u32 v19, v19, v37, v38
    v_max_u32 v19, v19, v39
    v_cmp_eq_u32 vcc, -1, v19
    s_nop 0
    s_cbranch_vccz g_56k
    s_add_u32 s23, s23, 1
    s_cmp_lt_u32 s23, 200000
    s_cbranch_scc1 g_56
    s_mov_b32 s25, 200000
g_56k:
    v_smfmac_f32_16x16x64_bf16 v[40:43], v[24:27], a[0:7], v172
    v_smfmac_f32_16x16x64_bf16 v[44:47], v[24:27], a[64:71], v172
    v_smfmac_f32_16x16x64_bf16 v[48:51], v[24:27], a[32:39], v172
    v_smfmac_f32_16x16x64_bf16 v[52:55], v[24:27], a[96:103], v172
    v_smfmac_f32_16x16x64_bf16 v[40:43], v[28:31], a[8:15], v172
    v_smfmac_f32_16x16x64_bf16 v[44:47], v[28:31], a[72:79], v172
    v_smfmac_f32_16x16x64_bf16 v[48:51], v[28:31], a[40:47], v172
    v_smfmac_f32_16x16x64_bf16 v[52:55], v[28:31], a[104:111], v172
    v_smfmac_f32_16x16x64_bf16 v[40:43], v[32:35], a[16:23], v172
    v_smfmac_f32_16x16x64_bf16 v[44:47], v[32:35], a[80:87], v172
    v_smfmac_f32_16x16x64_bf16 v[48:51], v[32:35], a[48:55], v172
    v_smfmac_f32_16x16x64_bf16 v[52:55], v[32:35], a[112:119], v172
    v_smfmac_f32_16x16x64_bf16 v[40:43], v[36:39], a[24:31], v172
    v_smfmac_f32_16x16x64_bf16 v[44:47], v[36:39], a[88:95], v172
    v_smfmac_f32_16x16x64_bf16 v[48:51], v[36:39], a[56:63], v172
    v_smfmac_f32_16x16x64_bf16 v[52:55], v[36:39], a[120:127], v172
    v_cvt_pk_bf16_f32 v72, v40, v41
    v_cvt_pk_bf16_f32 v73, v42, v43
    v_cvt_pk_bf16_f32 v74, v44, v45
    v_cvt_pk_bf16_f32 v75, v46, v47
    v_smfmac_f32_16x16x64_bf16 v[56:59], v[24:27], a[128:135], v172
    v_cvt_pk_bf16_f32 v76, v48, v49
    v_cvt_pk_bf16_f32 v77, v50, v51
    s_nop 0
    v_cvt_pk_bf16_f32 v78, v52, v53
    v_cvt_pk_bf16_f32 v79, v54, v55
    v_smfmac_f32_16x16x64_bf16 v[60:63], v[24:27], a[160:167], v172
    v_mfma_f32_16x16x32_bf16 v[88:91], v[72:75], v[84:87], 0
    v_mfma_f32_16x16x32_bf16 v[92:95], v[76:79], v[84:87], 0
    v_smfmac_f32_16x16x64_bf16 v[56:59], v[28:31], a[136:143], v172
    v_smfmac_f32_16x16x64_bf16 v[60:63], v[28:31], a[168:175], v172
    s_barrier
    ds_read_b128 v[104:107], v16 offset:2048
    ds_read_b128 v[108:111], v16 offset:3072
    ds_read_b128 v[112:115], v16 offset:4096
    ds_read_b128 v[116:119], v16 offset:5120
    ds_read_b128 v[120:123], v16 offset:6144
    ds_read_b128 v[124:127], v16 offset:7168
    v_smfmac_f32_16x16x64_bf16 v[56:59], v[32:35], a[144:151], v172
    v_smfmac_f32_16x16x64_bf16 v[60:63], v[32:35], a[176:183], v172
    v_smfmac_f32_16x16x64_bf16 v[56:59], v[36:39], a[152:159], v172
    v_smfmac_f32_16x16x64_bf16 v[60:63], v[36:39], a[184:191], v172
    s_waitcnt lgkmcnt(5)
    v_mfma_f32_16x16x32_bf16 v[88:91], v[104:107], v[84:87], v[88:91]
    s_waitcnt lgkmcnt(4)
    v_mfma_f32_16x16x32_bf16 v[92:95], v[108:111], v[84:87], v[92:95]
    s_waitcnt lgkmcnt(3)
    v_mfma_f32_16x16x32_bf16 v[88:91], v[112:115], v[84:87], v[88:91]
    s_waitcnt lgkmcnt(2)
    v_mfma_f32_16x16x32_bf16 v[92:95], v[116:119], v[84:87], v[92:95]
    s_waitcnt lgkmcnt(1)
    v_mfma_f32_16x16x32_bf16 v[88:91], v[120:123], v[84:87], v[88:91]
    s_waitcnt lgkmcnt(0)
    v_mfma_f32_16x16x32_bf16 v[92:95], v[124:127], v[84:87], v[92:95]
    v_cvt_pk_bf16_f32 v80, v56, v57
    v_cvt_pk_bf16_f32 v81, v58, v59
    v_cvt_pk_bf16_f32 v82, v60, v61
    v_cvt_pk_bf16_f32 v83, v62, v63
    ds_write_b128 v17, v[80:83] offset:8192
    s_nop 0
    v_cvt_pk_bf16_f32 v128, v88, v89
    v_cvt_pk_bf16_f32 v129, v90, v91
    v_cvt_pk_bf16_f32 v130, v92, v93
    v_cvt_pk_bf16_f32 v131, v94, v95
    s_nop 1
    v_mfma_f32_16x16x32_bf16 v[144:147], v[132:135], v[128:131], 0
    v_mfma_f32_16x16x32_bf16 v[148:151], v[136:139], v[128:131], 0
    v_mfma_f32_16x16x32_bf16 v[140:143], v[128:131], v[128:131], 0
    s_nop 1
    buffer_store_dwordx4 v[144:147], v3, s[4:7], s16 offen sc1
    s_nop 1
    buffer_store_dwordx4 v[148:151], v3, s[4:7], s16 offen offset:128 sc1
    s_nop 1
    buffer_store_dwordx4 v[140:143], v4, s[4:7], s16 offen sc1
    s_cmp_eq_u32 s15, 63
    s_waitcnt lgkmcnt(0)
    s_barrier
    s_cbranch_scc1 recur_slow_last0
    v_readfirstlane_b32 s85, v247
    s_add_u32 s94, s15, 2
    s_barrier
    s_nop 15
    s_mov_b32 s23, s25
g_57:
    buffer_load_dwordx4 v[24:27], v8, s[4:7], s16 offen offset:0 sc1
    buffer_load_dwordx4 v[28:31], v8, s[4:7], s16 offen offset:1024 sc1
    buffer_load_dwordx4 v[32:35], v8, s[4:7], s16 offen offset:2048 sc1
    buffer_load_dwordx4 v[36:39], v8, s[4:7], s16 offen offset:3072 sc1
    s_waitcnt vmcnt(0)
    v_max3_u32 v19, v24, v25, v26
    v_max3_u32 v19, v19, v27, v28
    v_max3_u32 v19, v19, v29, v30
    v_max3_u32 v19, v19, v31, v32
    v_max3_u32 v19, v19, v33, v34
    v_max3_u32 v19, v19, v35, v36
    v_max3_u32 v19, v19, v37, v38
    v_max_u32 v19, v19, v39
    v_cmp_eq_u32 vcc, -1, v19
    s_nop 0
    s_cbranch_vccz g_57k
    s_add_u32 s23, s23, 1
    s_cmp_lt_u32 s23, 200000
    s_cbranch_scc1 g_57
    s_mov_b32 s25, 200000
g_57k:
    v_smfmac_f32_16x16x64_bf16 v[64:67], v[24:27], a[192:199], v172
    v_smfmac_f32_16x16x64_bf16 v[68:71], v[24:27], a[224:231], v172
    v_smfmac_f32_16x16x64_bf16 v[64:67], v[28:31], a[200:207], v172
    v_smfmac_f32_16x16x64_bf16 v[68:71], v[28:31], a[232:239], v172
    v_smfmac_f32_16x16x64_bf16 v[64:67], v[32:35], a[208:215], v172
    v_smfmac_f32_16x16x64_bf16 v[68:71], v[32:35], a[240:247], v172
    v_smfmac_f32_16x16x64_bf16 v[64:67], v[36:39], a[216:223], v172
    v_smfmac_f32_16x16x64_bf16 v[68:71], v[36:39], a[248:255], v172
    s_nop 4
    v_cvt_pk_bf16_f32 v80, v64, v65
    v_cvt_pk_bf16_f32 v81, v66, v67
    s_nop 0
    v_cvt_pk_bf16_f32 v82, v68, v69
    v_cvt_pk_bf16_f32 v83, v70, v71
    ds_write_b128 v17, v[80:83] offset:9216
    s_waitcnt lgkmcnt(0)
    s_barrier
    s_nop 15
    s_nop 15
    s_nop 15
    s_nop 15
    buffer_store_dwordx4 v[128:131], v14, s[4:7], s19 offen sc1
    s_add_u32 s19, s19, 512
    s_mov_b32 s23, s25
fw_58:
    s_cmp_ge_u32 s85, s94
    s_cbranch_scc1 fo_59
    buffer_load_dword v247, v245, s[4:7], 0 offen sc1
    s_add_u32 s23, s23, 1
    s_waitcnt vmcnt(0)
    v_readfirstlane_b32 s85, v247
    s_cmp_lt_u32 s23, 200000
    s_cbranch_scc1 fw_58
    s_mov_b32 s25, 200000
fo_59:
    buffer_load_dwordx4 v[132:135], v12, s[4:7], s17 offen sc1
    buffer_load_dwordx4 v[136:139], v12, s[4:7], s17 offen offset:256 sc1
    s_add_u32 s17, s17, 2048
    s_min_u32 s17, s17, 17954816
    buffer_load_dword v247, v245, s[4:7], 0 offen sc1
    v_mov_b32 v40, 0
    v_mov_b32 v41, 0
    v_mov_b32 v42, 0
    v_mov_b32 v43, 0
    v_mov_b32 v44, 0
    v_mov_b32 v45, 0
    v_mov_b32 v46, 0
    v_mov_b32 v47, 0
    v_mov_b32 v48, 0
    v_mov_b32 v49, 0
    v_mov_b32 v50, 0
    v_mov_b32 v51, 0
    v_mov_b32 v52, 0
    v_mov_b32 v53, 0
    v_mov_b32 v54, 0
    v_mov_b32 v55, 0
    v_mov_b32 v56, 0
    v_mov_b32 v57, 0
    v_mov_b32 v58, 0
    v_mov_b32 v59, 0
    v_mov_b32 v60, 0
    v_mov_b32 v61, 0
    v_mov_b32 v62, 0
    v_mov_b32 v63, 0
    v_mov_b32 v64, 0
    v_mov_b32 v65, 0
    v_mov_b32 v66, 0
    v_mov_b32 v67, 0
    v_mov_b32 v68, 0
    v_mov_b32 v69, 0
    v_mov_b32 v70, 0
    v_mov_b32 v71, 0
    s_mov_b32 s21, s16
    s_mov_b32 s16, s42
    s_mov_b32 s42, s43
    s_mov_b32 s43, s44
    s_mov_b32 s44, s21
    s_add_u32 s95, s95, 524288
    s_lshr_b32 s84, s95, 8
    s_and_b32 s84, s84, 8192
    s_xor_b32 s84, s84, s46
    s_add_u32 s84, s84, s95
    s_add_u32 s15, s15, 1
    s_barrier
    s_branch recur_slow_w0
recur_slow_last0:
    buffer_store_dwordx4 v[128:131], v14, s[4:7], s19 offen sc1
    s_waitcnt vmcnt(0)
    s_branch recur_end
.p2align 6
recur_slow_w1:
    s_nop 15
    s_mov_b32 s23, s25
g_60:
    buffer_load_dwordx4 v[24:27], v2, s[4:7], s16 offen offset:0 sc1
    buffer_load_dwordx4 v[28:31], v2, s[4:7], s16 offen offset:1024 sc1
    buffer_load_dwordx4 v[32:35], v2, s[4:7], s16 offen offset:2048 sc1
    buffer_load_dwordx4 v[36:39], v2, s[4:7], s16 offen offset:3072 sc1
    s_waitcnt vmcnt(0)
    v_max3_u32 v19, v24, v25, v26
    v_max3_u32 v19, v19, v27, v28
    v_max3_u32 v19, v19, v29, v30
    v_max3_u32 v19, v19, v31, v32
    v_max3_u32 v19, v19, v33, v34
    v_max3_u32 v19, v19, v35, v36
    v_max3_u32 v19, v19, v37, v38
    v_max_u32 v19, v19, v39
    v_cmp_eq_u32 vcc, -1, v19
    s_nop 0
    s_cbranch_vccz g_60k
    s_add_u32 s23, s23, 1
    s_cmp_lt_u32 s23, 200000
    s_cbranch_scc1 g_60
    s_mov_b32 s25, 200000
g_60k:
    v_smfmac_f32_16x16x64_bf16 v[40:43], v[24:27], a[0:7], v172
    v_smfmac_f32_16x16x64_bf16 v[44:47], v[24:27], a[64:71], v172
    v_smfmac_f32_16x16x64_bf16 v[48:51], v[24:27], a[32:39], v172
    v_smfmac_f32_16x16x64_bf16 v[52:55], v[24:27], a[96:103], v172
    v_smfmac_f32_16x16x64_bf16 v[40:43], v[28:31], a[8:15], v172
    v_smfmac_f32_16x16x64_bf16 v[44:47], v[28:31], a[72:79], v172
    v_smfmac_f32_16x16x64_bf16 v[48:51], v[28:31], a[40:47], v172
    v_smfmac_f32_16x16x64_bf16 v[52:55], v[28:31], a[104:111], v172
    v_smfmac_f32_16x16x64_bf16 v[40:43], v[32:35], a[16:23], v172
    v_smfmac_f32_16x16x64_bf16 v[44:47], v[32:35], a[80:87], v172
    v_smfmac_f32_16x16x64_bf16 v[48:51], v[32:35], a[48:55], v172
    v_smfmac_f32_16x16x64_bf16 v[52:55], v[32:35], a[112:119], v172
    v_smfmac_f32_16x16x64_bf16 v[40:43], v[36:39], a[24:31], v172
    v_smfmac_f32_16x16x64_bf16 v[44:47], v[36:39], a[88:95], v172
    v_smfmac_f32_16x16x64_bf16 v[48:51], v[36:39], a[56:63], v172
    v_smfmac_f32_16x16x64_bf16 v[52:55], v[36:39], a[120:127], v172
    v_cvt_pk_bf16_f32 v72, v40, v41
    v_cvt_pk_bf16_f32 v73, v42, v43
    v_cvt_pk_bf16_f32 v74, v44, v45
    v_cvt_pk_bf16_f32 v75, v46, v47
    ds_write_b128 v17, v[72:75] offset:0
    v_cvt_pk_bf16_f32 v76, v48, v49
    v_cvt_pk_bf16_f32 v77, v50, v51
    s_nop 0
    v_cvt_pk_bf16_f32 v78, v52, v53
    v_cvt_pk_bf16_f32 v79, v54, v55
    ds_write_b128 v17, v[76:79] offset:1024
    v_smfmac_f32_16x16x64_bf16 v[56:59], v[24:27], a[128:135], v172
    v_smfmac_f32_16x16x64_bf16 v[60:63], v[24:27], a[160:167], v172
    v_smfmac_f32_16x16x64_bf16 v[56:59], v[28:31], a[136:143], v172
    s_waitcnt lgkmcnt(0)
    s_barrier
    v_smfmac_f32_16x16x64_bf16 v[60:63], v[28:31], a[168:175], v172
    v_smfmac_f32_16x16x64_bf16 v[56:59], v[32:35], a[144:151], v172
    v_smfmac_f32_16x16x64_bf16 v[60:63], v[32:35], a[176:183], v172
    v_smfmac_f32_16x16x64_bf16 v[56:59], v[36:39], a[152:159], v172
    v_smfmac_f32_16x16x64_bf16 v[60:63], v[36:39], a[184:191], v172
    s_nop 4
    v_cvt_pk_bf16_f32 v80, v56, v57
    v_cvt_pk_bf16_f32 v81, v58, v59
    s_nop 0
    v_cvt_pk_bf16_f32 v82, v60, v61
    v_cvt_pk_bf16_f32 v83, v62, v63
    ds_write_b128 v17, v[80:83] offset:8192
    v_mov_b32 v152, v228
    v_mov_b32 v153, v229
    v_mov_b32 v156, v230
    v_mov_b32 v157, v231
    v_mov_b32 v160, v232
    v_mov_b32 v161, v233
    v_mov_b32 v164, v234
    v_mov_b32 v165, v235
    s_cmp_eq_u32 s15, 63
    s_waitcnt lgkmcnt(0)
    s_barrier
    s_cbranch_scc1 recur_end
    s_nop 15
    s_nop 15
    s_nop 7
    buffer_load_dwordx4 v[208:211], v5, s[4:7], s16 offen offset:0 sc1
    buffer_load_dwordx4 v[212:215], v5, s[4:7], s16 offen offset:1024 sc1
    buffer_load_dwordx4 v[216:219], v5, s[4:7], s16 offen offset:2048 sc1
    buffer_load_dwordx4 v[220:223], v5, s[4:7], s16 offen offset:3072 sc1
    buffer_load_dword v224, v6, s[4:7], s16 offen offset:0 sc1
    buffer_load_dword v225, v6, s[4:7], s16 offen offset:256 sc1
    buffer_load_dword v226, v6, s[4:7], s16 offen offset:512 sc1
    buffer_load_dword v227, v6, s[4:7], s16 offen offset:768 sc1
    s_mov_b32 s23, s25
    ds_read_b128 v[96:99], v16 offset:8192
    ds_read_b128 v[104:107], v16 offset:12288
    ds_read_b128 v[108:111], v16 offset:14336
    v_mfma_f32_16x16x32_bf16 v[140:143], v[84:87], v[80:83], 0
    s_waitcnt lgkmcnt(2)
    v_mfma_f32_16x16x32_bf16 v[140:143], v[84:87], v[96:99], v[140:143]
    s_waitcnt lgkmcnt(1)
    v_mfma_f32_16x16x32_bf16 v[140:143], v[84:87], v[104:107], v[140:143]
    s_waitcnt lgkmcnt(0)
    v_mfma_f32_16x16x32_bf16 v[140:143], v[84:87], v[108:111], v[140:143]
    buffer_load_dwordx4 v[24:27], v5, s[4:7], s16 offen offset:0 sc1
    buffer_load_dwordx4 v[28:31], v5, s[4:7], s16 offen offset:1024 sc1
    buffer_load_dwordx4 v[32:35], v5, s[4:7], s16 offen offset:2048 sc1
    buffer_load_dwordx4 v[36:39], v5, s[4:7], s16 offen offset:3072 sc1
    buffer_load_dword v40, v6, s[4:7], s16 offen offset:0 sc1
    buffer_load_dword v41, v6, s[4:7], s16 offen offset:256 sc1
    buffer_load_dword v42, v6, s[4:7], s16 offen offset:512 sc1
    buffer_load_dword v43, v6, s[4:7], s16 offen offset:768 sc1
    v_cvt_pk_bf16_f32 v154, v140, v179
    v_cvt_pk_bf16_f32 v158, v141, v179
    v_cvt_pk_bf16_f32 v162, v142, v179
    v_cvt_pk_bf16_f32 v166, v143, v179
    s_waitcnt vmcnt(14)
    v_pk_add_f32 v[180:181], v[208:209], v[212:213]
    v_pk_add_f32 v[182:183], v[210:211], v[214:215]
    s_waitcnt vmcnt(12)
    v_pk_add_f32 v[188:189], v[216:217], v[220:221]
    v_pk_add_f32 v[190:191], v[218:219], v[222:223]
    v_pk_add_f32 v[180:181], v[180:181], v[188:189]
    v_pk_add_f32 v[182:183], v[182:183], v[190:191]
    v_pk_add_f32 v[188:189], v[180:181], v[182:183]
    v_max3_f32 v185, v180, v181, v182
    s_waitcnt vmcnt(8)
    v_pk_add_f32 v[192:193], v[224:225], v[226:227]
    v_add_f32 v188, v188, v189
    v_add_f32 v184, v192, v193
    v_max3_f32 v185, v185, v183, v184
    v_cmp_u_f32 vcc, v188, v184
    s_nop 0
    v_max_f32_dpp v185, v185, v185 row_ror:8 row_mask:0xf bank_mask:0xf
    v_mov_b32 v186, v185
    s_nop 1
    v_permlane16_swap_b32 v185, v186
    v_max_f32 v185, v185, v186
    v_mov_b32 v186, v185
    s_cbranch_vccnz ss_61
sg_63:
    s_nop 0
    v_permlane32_swap_b32 v185, v186
    v_max_f32 v185, v185, v186
    v_mul_f32 v185, s24, v185
    v_fma_f32 v180, v180, s24, -v185
    v_fma_f32 v181, v181, s24, -v185
    v_fma_f32 v182, v182, s24, -v185
    v_fma_f32 v183, v183, s24, -v185
    v_fma_f32 v184, v184, s24, -v185
    v_exp_f32 v180, v180
    v_exp_f32 v181, v181
    v_exp_f32 v182, v182
    v_exp_f32 v183, v183
    v_exp_f32 v184, v184
    v_cvt_pk_bf16_f32 v176, v180, v181
    v_cvt_pk_bf16_f32 v177, v182, v183
    v_cvt_pk_bf16_f32 v178, v184, v179
    s_nop 1
    v_mfma_f32_16x16x32_bf16 v[240:243], v[236:239], v[176:179], 0
    v_mfma_f32_16x16x32_bf16 v[188:191], v[152:155], v[176:179], 0
    v_mfma_f32_16x16x32_bf16 v[192:195], v[156:159], v[176:179], 0
    v_mfma_f32_16x16x32_bf16 v[196:199], v[160:163], v[176:179], 0
    v_mfma_f32_16x16x32_bf16 v[200:203], v[164:167], v[176:179], 0
    v_add_f32_dpp v185, v240, v240 row_ror:8 row_mask:0xf bank_mask:0xf
    v_rcp_f32 v185, v185
    v_add_f32_dpp v88, v192, v188 row_ror:8 row_mask:0xf bank_mask:0x3
    v_add_f32_dpp v89, v193, v189 row_ror:8 row_mask:0xf bank_mask:0x3
    v_add_f32_dpp v90, v194, v190 row_ror:8 row_mask:0xf bank_mask:0x3
    v_add_f32_dpp v91, v195, v191 row_ror:8 row_mask:0xf bank_mask:0x3
    s_nop 1
    v_add_f32_dpp v88, v196, v200 row_ror:8 row_mask:0xf bank_mask:0xc
    v_add_f32_dpp v89, v197, v201 row_ror:8 row_mask:0xf bank_mask:0xc
    v_add_f32_dpp v90, v198, v202 row_ror:8 row_mask:0xf bank_mask:0xc
    v_add_f32_dpp v91, v199, v203 row_ror:8 row_mask:0xf bank_mask:0xc
    v_mul_f32 v88, v88, v185
    v_mul_f32 v89, v89, v185
    v_mul_f32 v90, v90, v185
    v_mul_f32 v91, v91, v185
    v_cvt_pk_bf16_f32 v88, v88, v89
    v_cvt_pk_bf16_f32 v89, v90, v91
    buffer_store_dwordx2 v[88:89], v7, s[4:7], s16 offen sc1
    v_readfirstlane_b32 s85, v247
    s_add_u32 s94, s15, 2
    s_barrier
    s_nop 15
    s_mov_b32 s23, s25
g_64:
    buffer_load_dwordx4 v[24:27], v8, s[4:7], s16 offen offset:0 sc1
    buffer_load_dwordx4 v[28:31], v8, s[4:7], s16 offen offset:1024 sc1
    buffer_load_dwordx4 v[32:35], v8, s[4:7], s16 offen offset:2048 sc1
    buffer_load_dwordx4 v[36:39], v8, s[4:7], s16 offen offset:3072 sc1
    s_waitcnt vmcnt(0)
    v_max3_u32 v19, v24, v25, v26
    v_max3_u32 v19, v19, v27, v28
    v_max3_u32 v19, v19, v29, v30
    v_max3_u32 v19, v19, v31, v32
    v_max3_u32 v19, v19, v33, v34
    v_max3_u32 v19, v19, v35, v36
    v_max3_u32 v19, v19, v37, v38
    v_max_u32 v19, v19, v39
    v_cmp_eq_u32 vcc, -1, v19
    s_nop 0
    s_cbranch_vccz g_64k
    s_add_u32 s23, s23, 1
    s_cmp_lt_u32 s23, 200000
    s_cbranch_scc1 g_64
    s_mov_b32 s25, 200000
g_64k:
    v_smfmac_f32_16x16x64_bf16 v[64:67], v[24:27], a[192:199], v172
    v_smfmac_f32_16x16x64_bf16 v[68:71], v[24:27], a[224:231], v172
    v_smfmac_f32_16x16x64_bf16 v[64:67], v[28:31], a[200:207], v172
    v_smfmac_f32_16x16x64_bf16 v[68:71], v[28:31], a[232:239], v172
    v_smfmac_f32_16x16x64_bf16 v[64:67], v[32:35], a[208:215], v172
    v_smfmac_f32_16x16x64_bf16 v[68:71], v[32:35], a[240:247], v172
    v_smfmac_f32_16x16x64_bf16 v[64:67], v[36:39], a[216:223], v172
    v_smfmac_f32_16x16x64_bf16 v[68:71], v[36:39], a[248:255], v172
    s_nop 4
    v_cvt_pk_bf16_f32 v80, v64, v65
    v_cvt_pk_bf16_f32 v81, v66, v67
    s_nop 0
    v_cvt_pk_bf16_f32 v82, v68, v69
    v_cvt_pk_bf16_f32 v83, v70, v71
    ds_write_b128 v17, v[80:83] offset:9216
    s_waitcnt lgkmcnt(0)
    s_barrier
    s_nop 15
    s_nop 15
    s_nop 15
    s_nop 15
    s_mov_b32 s23, s25
fw_65:
    s_cmp_ge_u32 s85, s94
    s_cbranch_scc1 fo_66
    buffer_load_dword v247, v245, s[4:7], 0 offen sc1
    s_add_u32 s23, s23, 1
    s_waitcnt vmcnt(0)
    v_readfirstlane_b32 s85, v247
    s_cmp_lt_u32 s23, 200000
    s_cbranch_scc1 fw_65
    s_mov_b32 s25, 200000
fo_66:
    buffer_load_dwordx4 v[228:231], v13, s[4:7], s18 offen offset:0 sc1
    buffer_load_dwordx4 v[232:235], v13, s[4:7], s18 offen offset:256 sc1
    s_add_u32 s18, s18, 2048
    s_min_u32 s18, s18, 35780608
    buffer_load_dword v247, v245, s[4:7], 0 offen sc1
    v_mov_b32 v40, 0
    v_mov_b32 v41, 0
    v_mov_b32 v42, 0
    v_mov_b32 v43, 0
    v_mov_b32 v44, 0
    v_mov_b32 v45, 0
    v_mov_b32 v46, 0
    v_mov_b32 v47, 0
    v_mov_b32 v48, 0
    v_mov_b32 v49, 0
    v_mov_b32 v50, 0
    v_mov_b32 v51, 0
    v_mov_b32 v52, 0
    v_mov_b32 v53, 0
    v_mov_b32 v54, 0
    v_mov_b32 v55, 0
    v_mov_b32 v56, 0
    v_mov_b32 v57, 0
    v_mov_b32 v58, 0
    v_mov_b32 v59, 0
    v_mov_b32 v60, 0
    v_mov_b32 v61, 0
    v_mov_b32 v62, 0
    v_mov_b32 v63, 0
    v_mov_b32 v64, 0
    v_mov_b32 v65, 0
    v_mov_b32 v66, 0
    v_mov_b32 v67, 0
    v_mov_b32 v68, 0
    v_mov_b32 v69, 0
    v_mov_b32 v70, 0
    v_mov_b32 v71, 0
    s_mov_b32 s21, s16
    s_mov_b32 s16, s42
    s_mov_b32 s42, s43
    s_mov_b32 s43, s44
    s_mov_b32 s44, s21
    s_add_u32 s95, s95, 524288
    s_lshr_b32 s84, s95, 8
    s_and_b32 s84, s84, 8192
    s_xor_b32 s84, s84, s46
    s_add_u32 s84, s84, s95
    s_add_u32 s15, s15, 1
    s_barrier
    s_branch recur_slow_w1
sb_62:
    v_max3_u32 v19, v24, v25, v26
    v_max3_u32 v19, v19, v27, v28
    v_max3_u32 v19, v19, v29, v30
    v_max3_u32 v19, v19, v31, v32
    v_max3_u32 v19, v19, v33, v34
    v_max3_u32 v19, v19, v35, v36
    v_max3_u32 v19, v19, v37, v38
    v_max3_u32 v19, v19, v39, v40
    v_max3_u32 v19, v19, v41, v42
    v_max_u32 v19, v19, v43
    v_cmp_eq_u32 vcc, -1, v19
    s_nop 0
    s_cbranch_vccz sg_63
    buffer_load_dwordx4 v[24:27], v5, s[4:7], s16 offen offset:0 sc1
    buffer_load_dwordx4 v[28:31], v5, s[4:7], s16 offen offset:1024 sc1
    buffer_load_dwordx4 v[32:35], v5, s[4:7], s16 offen offset:2048 sc1
    buffer_load_dwordx4 v[36:39], v5, s[4:7], s16 offen offset:3072 sc1
    buffer_load_dword v40, v6, s[4:7], s16 offen offset:0 sc1
    buffer_load_dword v41, v6, s[4:7], s16 offen offset:256 sc1
    buffer_load_dword v42, v6, s[4:7], s16 offen offset:512 sc1
    buffer_load_dword v43, v6, s[4:7], s16 offen offset:768 sc1
    s_add_u32 s23, s23, 1
    s_cmp_lt_u32 s23, 200000
    s_cbranch_scc1 ss_61
    s_mov_b32 s25, 200000
    s_branch sg_63
ss_61:
    s_waitcnt vmcnt(6)
    v_pk_add_f32 v[180:181], v[24:25], v[28:29]
    v_pk_add_f32 v[182:183], v[26:27], v[30:31]
    s_waitcnt vmcnt(4)
    v_pk_add_f32 v[188:189], v[32:33], v[36:37]
    v_pk_add_f32 v[190:191], v[34:35], v[38:39]
    v_pk_add_f32 v[180:181], v[180:181], v[188:189]
    v_pk_add_f32 v[182:183], v[182:183], v[190:191]
    v_pk_add_f32 v[188:189], v[180:181], v[182:183]
    v_max3_f32 v185, v180, v181, v182
    s_waitcnt vmcnt(0)
    v_pk_add_f32 v[192:193], v[40:41], v[42:43]
    v_add_f32 v188, v188, v189
    v_add_f32 v184, v192, v193
    v_max3_f32 v185, v185, v183, v184
    v_cmp_u_f32 vcc, v188, v184
    s_nop 0
    v_max_f32_dpp v185, v185, v185 row_ror:8 row_mask:0xf bank_mask:0xf
    v_mov_b32 v186, v185
    s_nop 1
    v_permlane16_swap_b32 v185, v186
    v_max_f32 v185, v185, v186
    v_mov_b32 v186, v185
    s_cbranch_vccnz sb_62
    s_branch sg_63
.p2align 6
recur_slow_w2:
    s_nop 15
    s_mov_b32 s23, s25
g_67:
    buffer_load_dwordx4 v[24:27], v2, s[4:7], s16 offen offset:0 sc1
    buffer_load_dwordx4 v[28:31], v2, s[4:7], s16 offen offset:1024 sc1
    buffer_load_dwordx4 v[32:35], v2, s[4:7], s16 offen offset:2048 sc1
    buffer_load_dwordx4 v[36:39], v2, s[4:7], s16 offen offset:3072 sc1
    s_waitcnt vmcnt(0)
    v_max3_u32 v19, v24, v25, v26
    v_max3_u32 v19, v19, v27, v28
    v_max3_u32 v19, v19, v29, v30
    v_max3_u32 v19, v19, v31, v32
    v_max3_u32 v19, v19, v33, v34
    v_max3_u32 v19, v19, v35, v36
    v_max3_u32 v19, v19, v37, v38
    v_max_u32 v19, v19, v39
    v_cmp_eq_u32 vcc, -1, v19
    s_nop 0
    s_cbranch_vccz g_67k
    s_add_u32 s23, s23, 1
    s_cmp_lt_u32 s23, 200000
    s_cbranch_scc1 g_67
    s_mov_b32 s25, 200000
g_67k:
    v_smfmac_f32_16x16x64_bf16 v[40:43], v[24:27], a[0:7], v172
    v_smfmac_f32_16x16x64_bf16 v[44:47], v[24:27], a[64:71], v172
    v_smfmac_f32_16x16x64_bf16 v[48:51], v[24:27], a[32:39], v172
    v_smfmac_f32_16x16x64_bf16 v[52:55], v[24:27], a[96:103], v172
    v_smfmac_f32_16x16x64_bf16 v[40:43], v[28:31], a[8:15], v172
    v_smfmac_f32_16x16x64_bf16 v[44:47], v[28:31], a[72:79], v172
    v_smfmac_f32_16x16x64_bf16 v[48:51], v[28:31], a[40:47], v172
    v_smfmac_f32_16x16x64_bf16 v[52:55], v[28:31], a[104:111], v172
    v_smfmac_f32_16x16x64_bf16 v[40:43], v[32:35], a[16:23], v172
    v_smfmac_f32_16x16x64_bf16 v[44:47], v[32:35], a[80:87], v172
    v_smfmac_f32_16x16x64_bf16 v[48:51], v[32:35], a[48:55], v172
    v_smfmac_f32_16x16x64_bf16 v[52:55], v[32:35], a[112:119], v172
    v_smfmac_f32_16x16x64_bf16 v[40:43], v[36:39], a[24:31], v172
    v_smfmac_f32_16x16x64_bf16 v[44:47], v[36:39], a[88:95], v172
    v_smfmac_f32_16x16x64_bf16 v[48:51], v[36:39], a[56:63], v172
    v_smfmac_f32_16x16x64_bf16 v[52:55], v[36:39], a[120:127], v172
    v_cvt_pk_bf16_f32 v72, v40, v41
    v_cvt_pk_bf16_f32 v73, v42, v43
    v_cvt_pk_bf16_f32 v74, v44, v45
    v_cvt_pk_bf16_f32 v75, v46, v47
    ds_write_b128 v17, v[72:75] offset:0
    v_cvt_pk_bf16_f32 v76, v48, v49
    v_cvt_pk_bf16_f32 v77, v50, v51
    s_nop 0
    v_cvt_pk_bf16_f32 v78, v52, v53
    v_cvt_pk_bf16_f32 v79, v54, v55
    ds_write_b128 v17, v[76:79] offset:1024
    v_smfmac_f32_16x16x64_bf16 v[56:59], v[24:27], a[128:135], v172
    v_smfmac_f32_16x16x64_bf16 v[60:63], v[24:27], a[160:167], v172
    v_smfmac_f32_16x16x64_bf16 v[56:59], v[28:31], a[136:143], v172
    s_waitcnt lgkmcnt(0)
    s_barrier
    v_smfmac_f32_16x16x64_bf16 v[60:63], v[28:31], a[168:175], v172
    v_smfmac_f32_16x16x64_bf16 v[56:59], v[32:35], a[144:151], v172
    v_smfmac_f32_16x16x64_bf16 v[60:63], v[32:35], a[176:183], v172
    v_smfmac_f32_16x16x64_bf16 v[56:59], v[36:39], a[152:159], v172
    v_smfmac_f32_16x16x64_bf16 v[60:63], v[36:39], a[184:191], v172
    s_nop 4
    v_cvt_pk_bf16_f32 v80, v56, v57
    v_cvt_pk_bf16_f32 v81, v58, v59
    s_nop 0
    v_cvt_pk_bf16_f32 v82, v60, v61
    v_cvt_pk_bf16_f32 v83, v62, v63
    ds_write_b128 v17, v[80:83] offset:8192
    s_cmp_eq_u32 s15, 63
    s_waitcnt lgkmcnt(0)
    s_barrier
    ds_read_b128 v[96:99], v16 offset:8192
    ds_read_b128 v[100:103], v16 offset:10240
    ds_read_b128 v[108:111], v16 offset:14336
    v_mfma_f32_16x16x32_bf16 v[140:143], v[84:87], v[80:83], 0
    s_waitcnt lgkmcnt(2)
    v_mfma_f32_16x16x32_bf16 v[140:143], v[84:87], v[96:99], v[140:143]
    s_waitcnt lgkmcnt(1)
    v_mfma_f32_16x16x32_bf16 v[140:143], v[84:87], v[100:103], v[140:143]
    s_waitcnt lgkmcnt(0)
    v_mfma_f32_16x16x32_bf16 v[140:143], v[84:87], v[108:111], v[140:143]
    s_nop 7
    v_cvt_pk_bf16_f32 v168, v140, v141
    v_cvt_pk_bf16_f32 v169, v142, v143
    v_mov_b32 v170, v168
    v_mov_b32 v171, v169
    s_nop 0
    v_permlane16_swap_b32 v168, v170
    v_permlane16_swap_b32 v169, v171
    v_mov_b32 v247, s15
    s_cbranch_scc1 recur_slow_last2
    s_barrier
    s_nop 15
    s_mov_b32 s23, s25
g_68:
    buffer_load_dwordx4 v[24:27], v8, s[4:7], s16 offen offset:0 sc1
    buffer_load_dwordx4 v[28:31], v8, s[4:7], s16 offen offset:1024 sc1
    buffer_load_dwordx4 v[32:35], v8, s[4:7], s16 offen offset:2048 sc1
    buffer_load_dwordx4 v[36:39], v8, s[4:7], s16 offen offset:3072 sc1
    s_waitcnt vmcnt(0)
    v_max3_u32 v19, v24, v25, v26
    v_max3_u32 v19, v19, v27, v28
    v_max3_u32 v19, v19, v29, v30
    v_max3_u32 v19, v19, v31, v32
    v_max3_u32 v19, v19, v33, v34
    v_max3_u32 v19, v19, v35, v36
    v_max3_u32 v19, v19, v37, v38
    v_max_u32 v19, v19, v39
    v_cmp_eq_u32 vcc, -1, v19
    s_nop 0
    s_cbranch_vccz g_68k
    s_add_u32 s23, s23, 1
    s_cmp_lt_u32 s23, 200000
    s_cbranch_scc1 g_68
    s_mov_b32 s25, 200000
g_68k:
    v_smfmac_f32_16x16x64_bf16 v[64:67], v[24:27], a[192:199], v172
    v_smfmac_f32_16x16x64_bf16 v[68:71], v[24:27], a[224:231], v172
    v_smfmac_f32_16x16x64_bf16 v[64:67], v[28:31], a[200:207], v172
    v_smfmac_f32_16x16x64_bf16 v[68:71], v[28:31], a[232:239], v172
    v_smfmac_f32_16x16x64_bf16 v[64:67], v[32:35], a[208:215], v172
    v_smfmac_f32_16x16x64_bf16 v[68:71], v[32:35], a[240:247], v172
    v_smfmac_f32_16x16x64_bf16 v[64:67], v[36:39], a[216:223], v172
    v_smfmac_f32_16x16x64_bf16 v[68:71], v[36:39], a[248:255], v172
    s_nop 4
    v_cvt_pk_bf16_f32 v80, v64, v65
    v_cvt_pk_bf16_f32 v81, v66, v67
    s_nop 0
    v_cvt_pk_bf16_f32 v82, v68, v69
    v_cvt_pk_bf16_f32 v83, v70, v71
    ds_write_b128 v17, v[80:83] offset:9216
    s_waitcnt lgkmcnt(0)
    s_barrier
    s_nop 15
    s_nop 15
    s_nop 15
    s_nop 15
    buffer_store_dwordx4 v[168:171], v15, s[4:7], s20 offen sc1
    s_add_u32 s20, s20, 512
    s_add_u32 s21, s95, 1048576
    s_lshr_b32 s22, s21, 8
    s_and_b32 s22, s22, 8192
    s_xor_b32 s22, s22, s46
    s_add_u32 s21, s21, s22
    buffer_store_dwordx4 v[204:207], v9, s[4:7], s21 offen sc1
    s_add_u32 s21, s21, 262144
    buffer_store_dword v247, v246, s[4:7], 0 offen sc1
    v_mov_b32 v40, 0
    v_mov_b32 v41, 0
    v_mov_b32 v42, 0
    v_mov_b32 v43, 0
    v_mov_b32 v44, 0
    v_mov_b32 v45, 0
    v_mov_b32 v46, 0
    v_mov_b32 v47, 0
    v_mov_b32 v48, 0
    v_mov_b32 v49, 0
    v_mov_b32 v50, 0
    v_mov_b32 v51, 0
    v_mov_b32 v52, 0
    v_mov_b32 v53, 0
    v_mov_b32 v54, 0
    v_mov_b32 v55, 0
    v_mov_b32 v56, 0
    v_mov_b32 v57, 0
    v_mov_b32 v58, 0
    v_mov_b32 v59, 0
    v_mov_b32 v60, 0
    v_mov_b32 v61, 0
    v_mov_b32 v62, 0
    v_mov_b32 v63, 0
    v_mov_b32 v64, 0
    v_mov_b32 v65, 0
    v_mov_b32 v66, 0
    v_mov_b32 v67, 0
    v_mov_b32 v68, 0
    v_mov_b32 v69, 0
    v_mov_b32 v70, 0
    v_mov_b32 v71, 0
    s_mov_b32 s21, s16
    s_mov_b32 s16, s42
    s_mov_b32 s42, s43
    s_mov_b32 s43, s44
    s_mov_b32 s44, s21
    s_add_u32 s95, s95, 524288
    s_lshr_b32 s84, s95, 8
    s_and_b32 s84, s84, 8192
    s_xor_b32 s84, s84, s46
    s_add_u32 s84, s84, s95
    s_add_u32 s15, s15, 1
    s_barrier
    s_branch recur_slow_w2
recur_slow_last2:
    buffer_store_dwordx4 v[168:171], v15, s[4:7], s20 offen sc1
    s_waitcnt vmcnt(0)
    s_branch recur_end
.p2align 6
recur_slow_w3:
    s_nop 15
    s_mov_b32 s23, s25
g_69:
    buffer_load_dwordx4 v[24:27], v2, s[4:7], s16 offen offset:0 sc1
    buffer_load_dwordx4 v[28:31], v2, s[4:7], s16 offen offset:1024 sc1
    buffer_load_dwordx4 v[32:35], v2, s[4:7], s16 offen offset:2048 sc1
    buffer_load_dwordx4 v[36:39], v2, s[4:7], s16 offen offset:3072 sc1
    s_waitcnt vmcnt(0)
    v_max3_u32 v19, v24, v25, v26
    v_max3_u32 v19, v19, v27, v28
    v_max3_u32 v19, v19, v29, v30
    v_max3_u32 v19, v19, v31, v32
    v_max3_u32 v19, v19, v33, v34
    v_max3_u32 v19, v19, v35, v36
    v_max3_u32 v19, v19, v37, v38
    v_max_u32 v19, v19, v39
    v_cmp_eq_u32 vcc, -1, v19
    s_nop 0
    s_cbranch_vccz g_69k
    s_add_u32 s23, s23, 1
    s_cmp_lt_u32 s23, 200000
    s_cbranch_scc1 g_69
    s_mov_b32 s25, 200000
g_69k:
    v_smfmac_f32_16x16x64_bf16 v[40:43], v[24:27], a[0:7], v172
    v_smfmac_f32_16x16x64_bf16 v[44:47], v[24:27], a[64:71], v172
    v_smfmac_f32_16x16x64_bf16 v[48:51], v[24:27], a[32:39], v172
    v_smfmac_f32_16x16x64_bf16 v[52:55], v[24:27], a[96:103], v172
    v_smfmac_f32_16x16x64_bf16 v[40:43], v[28:31], a[8:15], v172
    v_smfmac_f32_16x16x64_bf16 v[44:47], v[28:31], a[72:79], v172
    v_smfmac_f32_16x16x64_bf16 v[48:51], v[28:31], a[40:47], v172
    v_smfmac_f32_16x16x64_bf16 v[52:55], v[28:31], a[104:111], v172
    v_smfmac_f32_16x16x64_bf16 v[40:43], v[32:35], a[16:23], v172
    v_smfmac_f32_16x16x64_bf16 v[44:47], v[32:35], a[80:87], v172
    v_smfmac_f32_16x16x64_bf16 v[48:51], v[32:35], a[48:55], v172
    v_smfmac_f32_16x16x64_bf16 v[52:55], v[32:35], a[112:119], v172
    v_smfmac_f32_16x16x64_bf16 v[40:43], v[36:39], a[24:31], v172
    v_smfmac_f32_16x16x64_bf16 v[44:47], v[36:39], a[88:95], v172
    v_smfmac_f32_16x16x64_bf16 v[48:51], v[36:39], a[56:63], v172
    v_smfmac_f32_16x16x64_bf16 v[52:55], v[36:39], a[120:127], v172
    v_cvt_pk_bf16_f32 v72, v40, v41
    v_cvt_pk_bf16_f32 v73, v42, v43
    v_cvt_pk_bf16_f32 v74, v44, v45
    v_cvt_pk_bf16_f32 v75, v46, v47
    ds_write_b128 v17, v[72:75] offset:0
    v_cvt_pk_bf16_f32 v76, v48, v49
    v_cvt_pk_bf16_f32 v77, v50, v51
    s_nop 0
    v_cvt_pk_bf16_f32 v78, v52, v53
    v_cvt_pk_bf16_f32 v79, v54, v55
    ds_write_b128 v17, v[76:79] offset:1024
    v_smfmac_f32_16x16x64_bf16 v[56:59], v[24:27], a[128:135], v172
    v_smfmac_f32_16x16x64_bf16 v[60:63], v[24:27], a[160:167], v172
    v_smfmac_f32_16x16x64_bf16 v[56:59], v[28:31], a[136:143], v172
    s_waitcnt lgkmcnt(0)
    s_barrier
    v_smfmac_f32_16x16x64_bf16 v[60:63], v[28:31], a[168:175], v172
    v_smfmac_f32_16x16x64_bf16 v[56:59], v[32:35], a[144:151], v172
    v_smfmac_f32_16x16x64_bf16 v[60:63], v[32:35], a[176:183], v172
    v_smfmac_f32_16x16x64_bf16 v[56:59], v[36:39], a[152:159], v172
    v_smfmac_f32_16x16x64_bf16 v[60:63], v[36:39], a[184:191], v172
    s_nop 4
    v_cvt_pk_bf16_f32 v80, v56, v57
    v_cvt_pk_bf16_f32 v81, v58, v59
    s_nop 0
    v_cvt_pk_bf16_f32 v82, v60, v61
    v_cvt_pk_bf16_f32 v83, v62, v63
    ds_write_b128 v17, v[80:83] offset:8192
    buffer_store_dwordx4 v[204:207], v3, s[4:7], s43 offen sc1
    buffer_store_dwordx4 v[204:207], v3, s[4:7], s43 offen offset:128 sc1
    buffer_store_dwordx4 v[204:207], v4, s[4:7], s43 offen sc1
    buffer_store_dwordx2 v[204:205], v7, s[4:7], s43 offen sc1
    buffer_store_dwordx2 v[204:205], v11, s[4:7], s43 offen sc1
    s_cmp_eq_u32 s15, 63
    s_waitcnt lgkmcnt(0)
    s_barrier
    s_cbranch_scc1 recur_end
    s_barrier
    s_nop 15
    s_mov_b32 s23, s25
g_70:
    buffer_load_dwordx4 v[24:27], v8, s[4:7], s16 offen offset:0 sc1
    buffer_load_dwordx4 v[28:31], v8, s[4:7], s16 offen offset:1024 sc1
    buffer_load_dwordx4 v[32:35], v8, s[4:7], s16 offen offset:2048 sc1
    buffer_load_dwordx4 v[36:39], v8, s[4:7], s16 offen offset:3072 sc1
    s_waitcnt vmcnt(0)
    v_max3_u32 v19, v24, v25, v26
    v_max3_u32 v19, v19, v27, v28
    v_max3_u32 v19, v19, v29, v30
    v_max3_u32 v19, v19, v31, v32
    v_max3_u32 v19, v19, v33, v34
    v_max3_u32 v19, v19, v35, v36
    v_max3_u32 v19, v19, v37, v38
    v_max_u32 v19, v19, v39
    v_cmp_eq_u32 vcc, -1, v19
    s_nop 0
    s_cbranch_vccz g_70k
    s_add_u32 s23, s23, 1
    s_cmp_lt_u32 s23, 200000
    s_cbranch_scc1 g_70
    s_mov_b32 s25, 200000
g_70k:
    v_smfmac_f32_16x16x64_bf16 v[64:67], v[24:27], a[192:199], v172
    v_smfmac_f32_16x16x64_bf16 v[68:71], v[24:27], a[224:231], v172
    v_smfmac_f32_16x16x64_bf16 v[64:67], v[28:31], a[200:207], v172
    v_smfmac_f32_16x16x64_bf16 v[68:71], v[28:31], a[232:239], v172
    v_smfmac_f32_16x16x64_bf16 v[64:67], v[32:35], a[208:215], v172
    v_smfmac_f32_16x16x64_bf16 v[68:71], v[32:35], a[240:247], v172
    v_smfmac_f32_16x16x64_bf16 v[64:67], v[36:39], a[216:223], v172
    v_smfmac_f32_16x16x64_bf16 v[68:71], v[36:39], a[248:255], v172
    s_nop 4
    v_cvt_pk_bf16_f32 v80, v64, v65
    v_cvt_pk_bf16_f32 v81, v66, v67
    s_nop 0
    v_cvt_pk_bf16_f32 v82, v68, v69
    v_cvt_pk_bf16_f32 v83, v70, v71
    s_nop 1
    v_mfma_f32_16x16x32_bf16 v[88:91], v[80:83], v[84:87], 0
    s_barrier
    ds_read_b128 v[96:99], v16 offset:9216
    ds_read_b128 v[100:103], v16 offset:11264
    ds_read_b128 v[104:107], v16 offset:13312
    s_waitcnt lgkmcnt(2)
    v_mfma_f32_16x16x32_bf16 v[88:91], v[96:99], v[84:87], v[88:91]
    s_waitcnt lgkmcnt(1)
    v_mfma_f32_16x16x32_bf16 v[88:91], v[100:103], v[84:87], v[88:91]
    s_waitcnt lgkmcnt(0)
    v_mfma_f32_16x16x32_bf16 v[88:91], v[104:107], v[84:87], v[88:91]
    s_nop 7
    buffer_store_dwordx4 v[88:91], v9, s[4:7], s84 offen sc1
    s_add_u32 s22, s84, 262144
    s_nop 15
    s_nop 15
    s_nop 15
    s_nop 15
    s_nop 15
    s_nop 15
    s_nop 15
    s_nop 15
    s_mov_b32 s23, s25
    buffer_load_dwordx4 v[96:99], v10, s[4:7], s84 offen sc1
    buffer_load_dwordx4 v[100:103], v23, s[4:7], s84 offen sc1
    buffer_load_dwordx4 v[104:107], v244, s[4:7], s84 offen sc1
    v_mov_b32 v40, 0
    v_mov_b32 v41, 0
    v_mov_b32 v42, 0
    v_mov_b32 v43, 0
    v_mov_b32 v44, 0
    v_mov_b32 v45, 0
    v_mov_b32 v46, 0
    v_mov_b32 v47, 0
    v_mov_b32 v48, 0
    v_mov_b32 v49, 0
    v_mov_b32 v50, 0
    v_mov_b32 v51, 0
    v_mov_b32 v52, 0
    v_mov_b32 v53, 0
    v_mov_b32 v54, 0
    v_mov_b32 v55, 0
    v_mov_b32 v56, 0
    v_mov_b32 v57, 0
    v_mov_b32 v58, 0
    v_mov_b32 v59, 0
    v_mov_b32 v60, 0
    v_mov_b32 v61, 0
    v_mov_b32 v62, 0
    v_mov_b32 v63, 0
    v_mov_b32 v64, 0
    v_mov_b32 v65, 0
    v_mov_b32 v66, 0
    v_mov_b32 v67, 0
    v_mov_b32 v68, 0
    v_mov_b32 v69, 0
    v_mov_b32 v70, 0
    v_mov_b32 v71, 0
pb_73:
    s_waitcnt vmcnt(2)
    v_pk_add_f32 v[120:121], v[88:89], v[96:97]
    v_pk_add_f32 v[122:123], v[90:91], v[98:99]
    s_waitcnt vmcnt(1)
    v_pk_add_f32 v[120:121], v[120:121], v[100:101]
    v_pk_add_f32 v[122:123], v[122:123], v[102:103]
    s_waitcnt vmcnt(0)
    v_pk_add_f32 v[120:121], v[120:121], v[104:105]
    v_pk_add_f32 v[122:123], v[122:123], v[106:107]
    v_cvt_pk_bf16_f32 v180, v120, v121
    v_pk_add_f32 v[124:125], v[120:121], v[122:123]
    v_cvt_pk_bf16_f32 v181, v122, v123
    v_cmpx_o_f32 vcc, v124, v125
    buffer_store_dwordx2 v[180:181], v11, s[4:7], s42 offen sc1
    s_cmp_eq_u64 vcc, -1
    s_mov_b64 exec, -1
    s_cbranch_scc0 pr_71
pg_72:
    s_barrier
    s_mov_b32 s21, s16
    s_mov_b32 s16, s42
    s_mov_b32 s42, s43
    s_mov_b32 s43, s44
    s_mov_b32 s44, s21
    s_add_u32 s95, s95, 524288
    s_lshr_b32 s84, s95, 8
    s_and_b32 s84, s84, 8192
    s_xor_b32 s84, s84, s46
    s_add_u32 s84, s84, s95
    s_add_u32 s15, s15, 1
    s_branch recur_slow_w3
pr_71:
    v_max3_u32 v19, v96, v97, v98
    v_max3_u32 v19, v19, v99, v100
    v_max3_u32 v19, v19, v101, v102
    v_max3_u32 v19, v19, v103, v104
    v_max3_u32 v19, v19, v105, v106
    v_max_u32 v19, v19, v107
    v_cmp_eq_u32 vcc, -1, v19
    s_nop 0
    s_cbranch_vccz pf_75
    buffer_load_dwordx4 v[96:99], v10, s[4:7], s84 offen sc1
    buffer_load_dwordx4 v[100:103], v23, s[4:7], s84 offen sc1
    buffer_load_dwordx4 v[104:107], v244, s[4:7], s84 offen sc1
    s_add_u32 s23, s23, 1
    s_cmp_lt_u32 s23, 200000
    s_cbranch_scc1 pb_73
    s_mov_b32 s25, 200000
pf_75:
    buffer_store_dwordx2 v[180:181], v11, s[4:7], s42 offen sc1
    s_branch pg_72
recur_end:
    s_barrier
    v_mov_b32 v247, 64
    buffer_store_dword v247, v246, s[4:7], 0 offen sc1
    s_endpgm
.section .rodata,"a"
.p2align 6
.amdhsa_kernel concat_heads__spectral_gfnet__memory_aug_recurrent_mem_tr__prompt_kernel
  .amdhsa_next_free_vgpr 512
  .amdhsa_next_free_sgpr 102
  .amdhsa_accum_offset 256
  .amdhsa_group_segment_fixed_size 0
  .amdhsa_kernarg_size 104
  .amdhsa_user_sgpr_count 2
  .amdhsa_user_sgpr_kernarg_segment_ptr 1
  .amdhsa_system_sgpr_workgroup_id_x 1
  .amdhsa_float_denorm_mode_32 3
.end_amdhsa_kernel
```

```asm
; @launch kernel=concat_heads__spectral_gfnet__memory_aug_recurrent_mem_tr__prompt_kernel grid=(256,1,1) block=(256,1,1) lds=163840
.amdgcn_target "amdgcn-amd-amdhsa--gfx950"
.text
.globl concat_heads__spectral_gfnet__memory_aug_recurrent_mem_tr__prompt_kernel
.p2align 8
.type concat_heads__spectral_gfnet__memory_aug_recurrent_mem_tr__prompt_kernel,@function
concat_heads__spectral_gfnet__memory_aug_recurrent_mem_tr__prompt_kernel:
    s_cmp_ge_u32 s2, 256
    s_cbranch_scc1 W_end
    s_load_dwordx2 s[100:101], s[0:1], 88
    s_mov_b32 s97, s2
    s_mov_b32 s98, 0
    s_getreg_b32 s3, hwreg(HW_REG_XCC_ID, 0, 3)
role_start:
    s_andn2_b32 s2, s97, 7
    s_or_b32 s2, s2, s3
    s_bitcmp1_b32 s3, 2
    s_cbranch_scc0 R_entry
    s_cmp_ge_u32 s2, 256
    s_cbranch_scc1 W_end
    s_load_dwordx2 s[4:5], s[0:1], 96
    v_lshrrev_b32 v5, 6, v0
    v_and_b32 v1, 63, v0
    v_readfirstlane_b32 s16, v5
    s_mov_b32 s6, 268435456
    s_mov_b32 s7, 0x20000
    s_waitcnt lgkmcnt(0)
    s_lshr_b32 s90, s2, 6
    s_bfe_u32 s91, s2, 0x30003
    s_lshl_b32 s91, s91, 2
    s_and_b32 s17, s3, 3
    s_add_u32 s91, s91, s17
    s_lshl_b32 s93, s17, 3
    s_lshr_b32 s17, s91, 2
    s_add_u32 s93, s93, s17
    s_mov_b32 s92, 0
    s_lshl_b32 s17, s93, 2
    s_add_u32 s17, s17, s16
    s_lshl_b32 s18, s90, 7
    s_add_u32 s18, s18, s17
    s_lshl_b32 s18, s18, 7
    s_add_u32 s18, s18, 100663296
    s_lshl_b32 s20, s17, 7
    s_add_u32 s20, s20, 100728832
    s_cmp_eq_u32 s90, 3
    s_cselect_b32 s18, s20, s18
    s_cselect_b64 exec, 7, 1
    v_mov_b32 v5, s18
    s_and_b32 s18, s17, 31
    s_lshl_b32 s18, s18, 2
    s_lshr_b32 s20, s93, 3
    s_add_u32 s18, s18, s20
    s_lshl_b32 s18, s18, 7
    s_add_u32 s18, s18, 100745216
    v_writelane_b32 v5, s18, 1
    s_lshl_b32 s18, s17, 7
    s_add_u32 s18, s18, 100761600
    v_writelane_b32 v5, s18, 2
    v_mov_b32 v6, 0
    buffer_store_dword v6, v5, s[4:7], 0 offen sc1
    s_mov_b64 exec, -1
    s_cmp_eq_u32 s90, 3
    s_cbranch_scc1 W_F
    s_load_dwordx2 s[8:9], s[0:1], 24
    s_mov_b32 s10, 4194304
    s_mov_b32 s11, 0x20000
    s_lshr_b32 s17, s2, 3
    s_lshl_b32 s17, s17, 15
    v_lshlrev_b32 v5, 7, v0
    s_waitcnt lgkmcnt(0)
    buffer_load_dword v254, v5, s[8:11], s17 offen
    s_cmp_lg_u32 s90, 0
    s_cbranch_scc1 W_P
    s_waitcnt vmcnt(0)
    s_barrier
    s_or_b32 s17, s16, s98
    s_cmp_lg_u32 s17, 0
    s_cbranch_scc1 vote_1
    s_lshl_b32 s17, s91, 14
    s_add_u32 s17, s17, 239075328
    v_lshlrev_b32 v5, 2, v1
    v_add_u32 v5, s17, v5
    v_add_u32 v6, 8192, v5
    s_mov_b32 s20, -1
    s_mov_b32 s21, -1
    s_mov_b64 exec, 1
    buffer_store_dword v1, v5, s[4:7], 0 offen sc1
    s_mov_b32 s22, 0
vp_2:
    s_add_u32 s22, s22, 1
    s_getreg_b32 s18, hwreg(HW_REG_IB_STS, 0, 4)
    s_cmp_lt_u32 s22, 2048
    s_cselect_b32 s18, s18, 0
    s_cmp_lg_u32 s18, 0
    s_cbranch_scc1 vp_2
    s_min_u32 s20, s20, s22
    buffer_store_dword v1, v6, s[4:7], 0 offen sc1
    s_mov_b32 s22, 0
vp_3:
    s_add_u32 s22, s22, 1
    s_getreg_b32 s18, hwreg(HW_REG_IB_STS, 0, 4)
    s_cmp_lt_u32 s22, 2048
    s_cselect_b32 s18, s18, 0
    s_cmp_lg_u32 s18, 0
    s_cbranch_scc1 vp_3
    s_min_u32 s21, s21, s22
    buffer_store_dword v1, v5, s[4:7], 0 offen sc1
    s_mov_b32 s22, 0
vp_4:
    s_add_u32 s22, s22, 1
    s_getreg_b32 s18, hwreg(HW_REG_IB_STS, 0, 4)
    s_cmp_lt_u32 s22, 2048
    s_cselect_b32 s18, s18, 0
    s_cmp_lg_u32 s18, 0
    s_cbranch_scc1 vp_4
    s_min_u32 s20, s20, s22
    buffer_store_dword v1, v6, s[4:7], 0 offen sc1
    s_mov_b32 s22, 0
vp_5:
    s_add_u32 s22, s22, 1
    s_getreg_b32 s18, hwreg(HW_REG_IB_STS, 0, 4)
    s_cmp_lt_u32 s22, 2048
    s_cselect_b32 s18, s18, 0
    s_cmp_lg_u32 s18, 0
    s_cbranch_scc1 vp_5
    s_min_u32 s21, s21, s22
    buffer_store_dword v1, v5, s[4:7], 0 offen sc1
    s_mov_b32 s22, 0
vp_6:
    s_add_u32 s22, s22, 1
    s_getreg_b32 s18, hwreg(HW_REG_IB_STS, 0, 4)
    s_cmp_lt_u32 s22, 2048
    s_cselect_b32 s18, s18, 0
    s_cmp_lg_u32 s18, 0
    s_cbranch_scc1 vp_6
    s_min_u32 s20, s20, s22
    buffer_store_dword v1, v6, s[4:7], 0 offen sc1
    s_mov_b32 s22, 0
vp_7:
    s_add_u32 s22, s22, 1
    s_getreg_b32 s18, hwreg(HW_REG_IB_STS, 0, 4)
    s_cmp_lt_u32 s22, 2048
    s_cselect_b32 s18, s18, 0
    s_cmp_lg_u32 s18, 0
    s_cbranch_scc1 vp_7
    s_min_u32 s21, s21, s22
    buffer_store_dword v1, v5, s[4:7], 0 offen sc1
    s_mov_b32 s22, 0
vp_8:
    s_add_u32 s22, s22, 1
    s_getreg_b32 s18, hwreg(HW_REG_IB_STS, 0, 4)
    s_cmp_lt_u32 s22, 2048
    s_cselect_b32 s18, s18, 0
    s_cmp_lg_u32 s18, 0
    s_cbranch_scc1 vp_8
    s_min_u32 s20, s20, s22
    buffer_store_dword v1, v6, s[4:7], 0 offen sc1
    s_mov_b32 s22, 0
vp_9:
    s_add_u32 s22, s22, 1
    s_getreg_b32 s18, hwreg(HW_REG_IB_STS, 0, 4)
    s_cmp_lt_u32 s22, 2048
    s_cselect_b32 s18, s18, 0
    s_cmp_lg_u32 s18, 0
    s_cbranch_scc1 vp_9
    s_min_u32 s21, s21, s22
    s_and_b32 s17, s97, 3
    s_lshl_b32 s17, s17, 3
    s_lshl_b32 s17, 0x40, s17
    s_cmp_lt_u32 s20, s21
    s_cselect_b32 s17, s17, 0
    s_andn2_b32 s18, s97, 3
    v_mov_b32 v5, s18
    v_mov_b32 v6, s17
    global_atomic_add v5, v6, s[100:101] sc1
    s_mov_b64 exec, -1
    s_waitcnt vmcnt(0)
vote_1:
    s_waitcnt vmcnt(0)
    s_barrier
    s_cmp_lg_u32 s16, 0
    s_cbranch_scc1 reg_10
    s_and_b32 s17, s2, 3
    s_lshl_b32 s17, s17, 3
    s_lshl_b32 s18, s98, 2
    s_add_u32 s17, s17, s18
    s_lshl_b32 s17, 1, s17
    s_andn2_b32 s18, s2, 3
    v_mov_b32 v5, s18
    v_mov_b32 v6, s17
    s_mov_b64 exec, 1
    global_atomic_add v5, v6, s[100:101] sc1
    s_mov_b64 exec, -1
reg_10:
W_P:
    s_load_dwordx2 s[12:13], s[0:1], 40
    s_load_dwordx2 s[28:29], s[0:1], 48
    s_load_dwordx2 s[30:31], s[0:1], 56
    s_load_dwordx2 s[8:9], s[0:1], 24
    s_mov_b32 s10, 4194304
    s_mov_b32 s11, 0x20000
    s_mov_b32 s14, 8388608
    s_mov_b32 s15, 0x20000
    s_waitcnt lgkmcnt(0)
    s_cmp_eq_u32 s90, 1
    s_cselect_b64 s[12:13], s[28:29], s[12:13]
    s_cmp_eq_u32 s90, 2
    s_cselect_b64 s[12:13], s[30:31], s[12:13]
    s_lshl_b32 s28, s93, 2
    s_add_u32 s28, s28, s16
    s_lshl_b32 s20, s28, 6
    v_lshrrev_b32 v5, 2, v1
    v_and_b32 v6, 3, v1
    v_lshlrev_b32 v8, 4, v6
    v_lshl_add_u32 v7, v5, 13, v8
    s_mul_i32 s19, s16, 40960
    s_and_b32 s17, s93, 3
    s_lshl_b32 s17, s17, 8
    v_add_lshl_u32 v2, v0, s17, 13
    s_andn2_b32 s17, s93, 3
    s_lshl_b32 s17, s17, 8
    buffer_load_dword v253, v2, s[12:15], s17 offen offset:384
    s_add_u32 m0, s19, 0
    s_nop 0
    buffer_load_dwordx4 v7, s[12:15], s20 offen lds
    s_add_u32 s20, s20, 131072
    s_add_u32 m0, s19, 1024
    s_nop 0
    buffer_load_dwordx4 v7, s[12:15], s20 offen lds
    s_add_u32 s20, s20, 131072
    s_add_u32 m0, s19, 2048
    s_nop 0
    buffer_load_dwordx4 v7, s[12:15], s20 offen lds
    s_add_u32 s20, s20, 131072
    s_add_u32 m0, s19, 3072
    s_nop 0
    buffer_load_dwordx4 v7, s[12:15], s20 offen lds
    s_add_u32 s20, s20, 131072
    v_bfe_u32 v5, v1, 2, 2
    v_lshrrev_b32 v6, 4, v1
    v_lshl_add_u32 v5, v6, 3, v5
    v_lshl_add_u32 v8, v5, 6, v8
    v_add_u32 v8, s19, v8
    s_cmp_eq_u32 s90, 0
    s_cbranch_scc1 nq_11
    s_waitcnt vmcnt(6)
    s_barrier
    s_cmp_lg_u32 s16, 0
    s_cbranch_scc1 reg_12
    s_and_b32 s17, s2, 3
    s_lshl_b32 s17, s17, 3
    s_lshl_b32 s18, s98, 2
    s_add_u32 s17, s17, s18
    s_lshl_b32 s17, 1, s17
    s_andn2_b32 s18, s2, 3
    v_mov_b32 v5, s18
    v_mov_b32 v6, s17
    s_mov_b64 exec, 1
    global_atomic_add v5, v6, s[100:101] sc1
    s_mov_b64 exec, -1
reg_12:
    s_barrier
nq_11:
    s_add_u32 m0, s19, 4096
    s_nop 0
    buffer_load_dwordx4 v7, s[12:15], s20 offen lds
    s_add_u32 s20, s20, 131072
    s_add_u32 m0, s19, 5120
    s_nop 0
    buffer_load_dwordx4 v7, s[12:15], s20 offen lds
    s_add_u32 s20, s20, 131072
    s_add_u32 m0, s19, 6144
    s_nop 0
    buffer_load_dwordx4 v7, s[12:15], s20 offen lds
    s_add_u32 s20, s20, 131072
    s_add_u32 m0, s19, 7168
    s_nop 0
    buffer_load_dwordx4 v7, s[12:15], s20 offen lds
    s_add_u32 s20, s20, 131072
    s_add_u32 m0, s19, 8192
    s_nop 0
    buffer_load_dwordx4 v7, s[12:15], s20 offen lds
    s_add_u32 s20, s20, 131072
    s_add_u32 m0, s19, 9216
    s_nop 0
    buffer_load_dwordx4 v7, s[12:15], s20 offen lds
    s_add_u32 s20, s20, 131072
    s_add_u32 m0, s19, 10240
    s_nop 0
    buffer_load_dwordx4 v7, s[12:15], s20 offen lds
    s_add_u32 s20, s20, 131072
    s_add_u32 m0, s19, 11264
    s_nop 0
    buffer_load_dwordx4 v7, s[12:15], s20 offen lds
    s_add_u32 s20, s20, 131072
    s_add_u32 m0, s19, 12288
    s_nop 0
    buffer_load_dwordx4 v7, s[12:15], s20 offen lds
    s_add_u32 s20, s20, 131072
    s_add_u32 m0, s19, 13312
    s_nop 0
    buffer_load_dwordx4 v7, s[12:15], s20 offen lds
    s_add_u32 s20, s20, 131072
    s_add_u32 m0, s19, 14336
    s_nop 0
    buffer_load_dwordx4 v7, s[12:15], s20 offen lds
    s_add_u32 s20, s20, 131072
    s_add_u32 m0, s19, 15360
    s_nop 0
    buffer_load_dwordx4 v7, s[12:15], s20 offen lds
    s_add_u32 s20, s20, 131072
    s_add_u32 m0, s19, 16384
    s_nop 0
    buffer_load_dwordx4 v7, s[12:15], s20 offen lds
    s_add_u32 s20, s20, 131072
    s_add_u32 m0, s19, 17408
    s_nop 0
    buffer_load_dwordx4 v7, s[12:15], s20 offen lds
    s_add_u32 s20, s20, 131072
    s_add_u32 m0, s19, 18432
    s_nop 0
    buffer_load_dwordx4 v7, s[12:15], s20 offen lds
    s_add_u32 s20, s20, 131072
    s_add_u32 m0, s19, 19456
    s_nop 0
    buffer_load_dwordx4 v7, s[12:15], s20 offen lds
    s_add_u32 s20, s20, 131072
    s_add_u32 m0, s19, 20480
    s_nop 0
    buffer_load_dwordx4 v7, s[12:15], s20 offen lds
    s_add_u32 s20, s20, 131072
    s_add_u32 m0, s19, 21504
    s_nop 0
    buffer_load_dwordx4 v7, s[12:15], s20 offen lds
    s_add_u32 s20, s20, 131072
    s_add_u32 m0, s19, 22528
    s_nop 0
    buffer_load_dwordx4 v7, s[12:15], s20 offen lds
    s_add_u32 s20, s20, 131072
    s_add_u32 m0, s19, 23552
    s_nop 0
    buffer_load_dwordx4 v7, s[12:15], s20 offen lds
    s_add_u32 s20, s20, 131072
    s_add_u32 m0, s19, 24576
    s_nop 0
    buffer_load_dwordx4 v7, s[12:15], s20 offen lds
    s_add_u32 s20, s20, 131072
    s_add_u32 m0, s19, 25600
    s_nop 0
    buffer_load_dwordx4 v7, s[12:15], s20 offen lds
    s_add_u32 s20, s20, 131072
    s_add_u32 m0, s19, 26624
    s_nop 0
    buffer_load_dwordx4 v7, s[12:15], s20 offen lds
    s_add_u32 s20, s20, 131072
    s_add_u32 m0, s19, 27648
    s_nop 0
    buffer_load_dwordx4 v7, s[12:15], s20 offen lds
    s_add_u32 s20, s20, 131072
    s_add_u32 m0, s19, 28672
    s_nop 0
    buffer_load_dwordx4 v7, s[12:15], s20 offen lds
    s_add_u32 s20, s20, 131072
    s_add_u32 m0, s19, 29696
    s_nop 0
    buffer_load_dwordx4 v7, s[12:15], s20 offen lds
    s_add_u32 s20, s20, 131072
    s_add_u32 m0, s19, 30720
    s_nop 0
    buffer_load_dwordx4 v7, s[12:15], s20 offen lds
    s_add_u32 s20, s20, 131072
    s_add_u32 m0, s19, 31744
    s_nop 0
    buffer_load_dwordx4 v7, s[12:15], s20 offen lds
    s_add_u32 s20, s20, 131072
    s_add_u32 m0, s19, 32768
    s_nop 0
    buffer_load_dwordx4 v7, s[12:15], s20 offen lds
    s_add_u32 s20, s20, 131072
    s_add_u32 m0, s19, 33792
    s_nop 0
    buffer_load_dwordx4 v7, s[12:15], s20 offen lds
    s_add_u32 s20, s20, 131072
    s_add_u32 m0, s19, 34816
    s_nop 0
    buffer_load_dwordx4 v7, s[12:15], s20 offen lds
    s_add_u32 s20, s20, 131072
    s_add_u32 m0, s19, 35840
    s_nop 0
    buffer_load_dwordx4 v7, s[12:15], s20 offen lds
    s_add_u32 s20, s20, 131072
    s_add_u32 m0, s19, 36864
    s_nop 0
    buffer_load_dwordx4 v7, s[12:15], s20 offen lds
    s_add_u32 s20, s20, 131072
    s_add_u32 m0, s19, 37888
    s_nop 0
    buffer_load_dwordx4 v7, s[12:15], s20 offen lds
    s_add_u32 s20, s20, 131072
    s_add_u32 m0, s19, 38912
    s_nop 0
    buffer_load_dwordx4 v7, s[12:15], s20 offen lds
    s_add_u32 s20, s20, 131072
    s_add_u32 m0, s19, 39936
    s_nop 0
    buffer_load_dwordx4 v7, s[12:15], s20 offen lds
    s_add_u32 s20, s20, 131072
    s_waitcnt vmcnt(38)
    ds_read_b64_tr_b16 a[0:1], v8 offset:0
    ds_read_b64_tr_b16 a[2:3], v8 offset:256
    ds_read_b64_tr_b16 a[4:5], v8 offset:8
    ds_read_b64_tr_b16 a[6:7], v8 offset:264
    s_waitcnt vmcnt(36)
    ds_read_b64_tr_b16 a[8:9], v8 offset:2048
    ds_read_b64_tr_b16 a[10:11], v8 offset:2304
    ds_read_b64_tr_b16 a[12:13], v8 offset:2056
    ds_read_b64_tr_b16 a[14:15], v8 offset:2312
    s_waitcnt lgkmcnt(4)
    s_add_u32 m0, s19, 0
    s_nop 0
    buffer_load_dwordx4 v7, s[12:15], s20 offen lds
    s_add_u32 s20, s20, 131072
    s_add_u32 m0, s19, 1024
    s_nop 0
    buffer_load_dwordx4 v7, s[12:15], s20 offen lds
    s_add_u32 s20, s20, 131072
    s_waitcnt vmcnt(36)
    ds_read_b64_tr_b16 a[16:17], v8 offset:4096
    ds_read_b64_tr_b16 a[18:19], v8 offset:4352
    ds_read_b64_tr_b16 a[20:21], v8 offset:4104
    ds_read_b64_tr_b16 a[22:23], v8 offset:4360
    s_waitcnt lgkmcnt(4)
    s_add_u32 m0, s19, 2048
    s_nop 0
    buffer_load_dwordx4 v7, s[12:15], s20 offen lds
    s_add_u32 s20, s20, 131072
    s_add_u32 m0, s19, 3072
    s_nop 0
    buffer_load_dwordx4 v7, s[12:15], s20 offen lds
    s_add_u32 s20, s20, 131072
    s_waitcnt vmcnt(36)
    ds_read_b64_tr_b16 a[24:25], v8 offset:6144
    ds_read_b64_tr_b16 a[26:27], v8 offset:6400
    ds_read_b64_tr_b16 a[28:29], v8 offset:6152
    ds_read_b64_tr_b16 a[30:31], v8 offset:6408
    s_waitcnt lgkmcnt(4)
    s_add_u32 m0, s19, 4096
    s_nop 0
    buffer_load_dwordx4 v7, s[12:15], s20 offen lds
    s_add_u32 s20, s20, 131072
    s_add_u32 m0, s19, 5120
    s_nop 0
    buffer_load_dwordx4 v7, s[12:15], s20 offen lds
    s_add_u32 s20, s20, 131072
    s_waitcnt vmcnt(36)
    ds_read_b64_tr_b16 a[32:33], v8 offset:8192
    ds_read_b64_tr_b16 a[34:35], v8 offset:8448
    ds_read_b64_tr_b16 a[36:37], v8 offset:8200
    ds_read_b64_tr_b16 a[38:39], v8 offset:8456
    s_waitcnt lgkmcnt(4)
    s_add_u32 m0, s19, 6144
    s_nop 0
    buffer_load_dwordx4 v7, s[12:15], s20 offen lds
    s_add_u32 s20, s20, 131072
    s_add_u32 m0, s19, 7168
    s_nop 0
    buffer_load_dwordx4 v7, s[12:15], s20 offen lds
    s_add_u32 s20, s20, 131072
    s_waitcnt vmcnt(36)
    ds_read_b64_tr_b16 a[40:41], v8 offset:10240
    ds_read_b64_tr_b16 a[42:43], v8 offset:10496
    ds_read_b64_tr_b16 a[44:45], v8 offset:10248
    ds_read_b64_tr_b16 a[46:47], v8 offset:10504
    s_waitcnt lgkmcnt(4)
    s_add_u32 m0, s19, 8192
    s_nop 0
    buffer_load_dwordx4 v7, s[12:15], s20 offen lds
    s_add_u32 s20, s20, 131072
    s_add_u32 m0, s19, 9216
    s_nop 0
    buffer_load_dwordx4 v7, s[12:15], s20 offen lds
    s_add_u32 s20, s20, 131072
    s_waitcnt vmcnt(36)
    ds_read_b64_tr_b16 a[48:49], v8 offset:12288
    ds_read_b64_tr_b16 a[50:51], v8 offset:12544
    ds_read_b64_tr_b16 a[52:53], v8 offset:12296
    ds_read_b64_tr_b16 a[54:55], v8 offset:12552
    s_waitcnt lgkmcnt(4)
    s_add_u32 m0, s19, 10240
    s_nop 0
    buffer_load_dwordx4 v7, s[12:15], s20 offen lds
    s_add_u32 s20, s20, 131072
    s_add_u32 m0, s19, 11264
    s_nop 0
    buffer_load_dwordx4 v7, s[12:15], s20 offen lds
    s_add_u32 s20, s20, 131072
    s_waitcnt vmcnt(36)
    ds_read_b64_tr_b16 a[56:57], v8 offset:14336
    ds_read_b64_tr_b16 a[58:59], v8 offset:14592
    ds_read_b64_tr_b16 a[60:61], v8 offset:14344
    ds_read_b64_tr_b16 a[62:63], v8 offset:14600
    s_waitcnt lgkmcnt(4)
    s_add_u32 m0, s19, 12288
    s_nop 0
    buffer_load_dwordx4 v7, s[12:15], s20 offen lds
    s_add_u32 s20, s20, 131072
    s_add_u32 m0, s19, 13312
    s_nop 0
    buffer_load_dwordx4 v7, s[12:15], s20 offen lds
    s_add_u32 s20, s20, 131072
    s_waitcnt vmcnt(36)
    ds_read_b64_tr_b16 a[64:65], v8 offset:16384
    ds_read_b64_tr_b16 a[66:67], v8 offset:16640
    ds_read_b64_tr_b16 a[68:69], v8 offset:16392
    ds_read_b64_tr_b16 a[70:71], v8 offset:16648
    s_waitcnt lgkmcnt(4)
    s_add_u32 m0, s19, 14336
    s_nop 0
    buffer_load_dwordx4 v7, s[12:15], s20 offen lds
    s_add_u32 s20, s20, 131072
    s_add_u32 m0, s19, 15360
    s_nop 0
    buffer_load_dwordx4 v7, s[12:15], s20 offen lds
    s_add_u32 s20, s20, 131072
    s_waitcnt vmcnt(36)
    ds_read_b64_tr_b16 a[72:73], v8 offset:18432
    ds_read_b64_tr_b16 a[74:75], v8 offset:18688
    ds_read_b64_tr_b16 a[76:77], v8 offset:18440
    ds_read_b64_tr_b16 a[78:79], v8 offset:18696
    s_waitcnt lgkmcnt(4)
    s_add_u32 m0, s19, 16384
    s_nop 0
    buffer_load_dwordx4 v7, s[12:15], s20 offen lds
    s_add_u32 s20, s20, 131072
    s_add_u32 m0, s19, 17408
    s_nop 0
    buffer_load_dwordx4 v7, s[12:15], s20 offen lds
    s_add_u32 s20, s20, 131072
    s_waitcnt vmcnt(36)
    ds_read_b64_tr_b16 a[80:81], v8 offset:20480
    ds_read_b64_tr_b16 a[82:83], v8 offset:20736
    ds_read_b64_tr_b16 a[84:85], v8 offset:20488
    ds_read_b64_tr_b16 a[86:87], v8 offset:20744
    s_waitcnt lgkmcnt(4)
    s_add_u32 m0, s19, 18432
    s_nop 0
    buffer_load_dwordx4 v7, s[12:15], s20 offen lds
    s_add_u32 s20, s20, 131072
    s_add_u32 m0, s19, 19456
    s_nop 0
    buffer_load_dwordx4 v7, s[12:15], s20 offen lds
    s_add_u32 s20, s20, 131072
    s_waitcnt vmcnt(36)
    ds_read_b64_tr_b16 a[88:89], v8 offset:22528
    ds_read_b64_tr_b16 a[90:91], v8 offset:22784
    ds_read_b64_tr_b16 a[92:93], v8 offset:22536
    ds_read_b64_tr_b16 a[94:95], v8 offset:22792
    s_waitcnt lgkmcnt(4)
    s_add_u32 m0, s19, 20480
    s_nop 0
    buffer_load_dwordx4 v7, s[12:15], s20 offen lds
    s_add_u32 s20, s20, 131072
    s_add_u32 m0, s19, 21504
    s_nop 0
    buffer_load_dwordx4 v7, s[12:15], s20 offen lds
    s_add_u32 s20, s20, 131072
    s_waitcnt vmcnt(36)
    ds_read_b64_tr_b16 a[96:97], v8 offset:24576
    ds_read_b64_tr_b16 a[98:99], v8 offset:24832
    ds_read_b64_tr_b16 a[100:101], v8 offset:24584
    ds_read_b64_tr_b16 a[102:103], v8 offset:24840
    s_waitcnt lgkmcnt(4)
    s_add_u32 m0, s19, 22528
    s_nop 0
    buffer_load_dwordx4 v7, s[12:15], s20 offen lds
    s_add_u32 s20, s20, 131072
    s_add_u32 m0, s19, 23552
    s_nop 0
    buffer_load_dwordx4 v7, s[12:15], s20 offen lds
    s_add_u32 s20, s20, 131072
    s_waitcnt vmcnt(36)
    ds_read_b64_tr_b16 a[104:105], v8 offset:26624
    ds_read_b64_tr_b16 a[106:107], v8 offset:26880
    ds_read_b64_tr_b16 a[108:109], v8 offset:26632
    ds_read_b64_tr_b16 a[110:111], v8 offset:26888
    s_waitcnt lgkmcnt(7)
    s_waitcnt vmcnt(34)
    ds_read_b64_tr_b16 a[112:113], v8 offset:28672
    ds_read_b64_tr_b16 a[114:115], v8 offset:28928
    ds_read_b64_tr_b16 a[116:117], v8 offset:28680
    ds_read_b64_tr_b16 a[118:119], v8 offset:28936
    s_waitcnt vmcnt(32)
    ds_read_b64_tr_b16 a[120:121], v8 offset:30720
    ds_read_b64_tr_b16 a[122:123], v8 offset:30976
    ds_read_b64_tr_b16 a[124:125], v8 offset:30728
    ds_read_b64_tr_b16 a[126:127], v8 offset:30984
    s_waitcnt lgkmcnt(7)
    s_waitcnt vmcnt(30)
    ds_read_b64_tr_b16 a[128:129], v8 offset:32768
    ds_read_b64_tr_b16 a[130:131], v8 offset:33024
    ds_read_b64_tr_b16 a[132:133], v8 offset:32776
    ds_read_b64_tr_b16 a[134:135], v8 offset:33032
    s_waitcnt vmcnt(28)
    ds_read_b64_tr_b16 a[136:137], v8 offset:34816
    ds_read_b64_tr_b16 a[138:139], v8 offset:35072
    ds_read_b64_tr_b16 a[140:141], v8 offset:34824
    ds_read_b64_tr_b16 a[142:143], v8 offset:35080
    s_waitcnt lgkmcnt(7)
    s_waitcnt vmcnt(26)
    ds_read_b64_tr_b16 a[144:145], v8 offset:36864
    ds_read_b64_tr_b16 a[146:147], v8 offset:37120
    ds_read_b64_tr_b16 a[148:149], v8 offset:36872
    ds_read_b64_tr_b16 a[150:151], v8 offset:37128
    s_waitcnt vmcnt(24)
    ds_read_b64_tr_b16 a[152:153], v8 offset:38912
    ds_read_b64_tr_b16 a[154:155], v8 offset:39168
    ds_read_b64_tr_b16 a[156:157], v8 offset:38920
    ds_read_b64_tr_b16 a[158:159], v8 offset:39176
    s_waitcnt lgkmcnt(7)
    s_waitcnt vmcnt(22)
    ds_read_b64_tr_b16 a[160:161], v8 offset:0
    ds_read_b64_tr_b16 a[162:163], v8 offset:256
    ds_read_b64_tr_b16 a[164:165], v8 offset:8
    ds_read_b64_tr_b16 a[166:167], v8 offset:264
    s_waitcnt vmcnt(20)
    ds_read_b64_tr_b16 a[168:169], v8 offset:2048
    ds_read_b64_tr_b16 a[170:171], v8 offset:2304
    ds_read_b64_tr_b16 a[172:173], v8 offset:2056
    ds_read_b64_tr_b16 a[174:175], v8 offset:2312
    s_waitcnt lgkmcnt(7)
    s_waitcnt vmcnt(18)
    ds_read_b64_tr_b16 a[176:177], v8 offset:4096
    ds_read_b64_tr_b16 a[178:179], v8 offset:4352
    ds_read_b64_tr_b16 a[180:181], v8 offset:4104
    ds_read_b64_tr_b16 a[182:183], v8 offset:4360
    s_waitcnt vmcnt(16)
    ds_read_b64_tr_b16 a[184:185], v8 offset:6144
    ds_read_b64_tr_b16 a[186:187], v8 offset:6400
    ds_read_b64_tr_b16 a[188:189], v8 offset:6152
    ds_read_b64_tr_b16 a[190:191], v8 offset:6408
    s_waitcnt lgkmcnt(7)
    s_waitcnt vmcnt(14)
    ds_read_b64_tr_b16 a[192:193], v8 offset:8192
    ds_read_b64_tr_b16 a[194:195], v8 offset:8448
    ds_read_b64_tr_b16 a[196:197], v8 offset:8200
    ds_read_b64_tr_b16 a[198:199], v8 offset:8456
    s_waitcnt vmcnt(12)
    ds_read_b64_tr_b16 a[200:201], v8 offset:10240
    ds_read_b64_tr_b16 a[202:203], v8 offset:10496
    ds_read_b64_tr_b16 a[204:205], v8 offset:10248
    ds_read_b64_tr_b16 a[206:207], v8 offset:10504
    s_waitcnt lgkmcnt(7)
    s_waitcnt vmcnt(10)
    ds_read_b64_tr_b16 a[208:209], v8 offset:12288
    ds_read_b64_tr_b16 a[210:211], v8 offset:12544
    ds_read_b64_tr_b16 a[212:213], v8 offset:12296
    ds_read_b64_tr_b16 a[214:215], v8 offset:12552
    s_waitcnt vmcnt(8)
    ds_read_b64_tr_b16 a[216:217], v8 offset:14336
    ds_read_b64_tr_b16 a[218:219], v8 offset:14592
    ds_read_b64_tr_b16 a[220:221], v8 offset:14344
    ds_read_b64_tr_b16 a[222:223], v8 offset:14600
    s_waitcnt lgkmcnt(7)
    s_waitcnt vmcnt(6)
    ds_read_b64_tr_b16 a[224:225], v8 offset:16384
    ds_read_b64_tr_b16 a[226:227], v8 offset:16640
    ds_read_b64_tr_b16 a[228:229], v8 offset:16392
    ds_read_b64_tr_b16 a[230:231], v8 offset:16648
    s_waitcnt vmcnt(4)
    ds_read_b64_tr_b16 a[232:233], v8 offset:18432
    ds_read_b64_tr_b16 a[234:235], v8 offset:18688
    ds_read_b64_tr_b16 a[236:237], v8 offset:18440
    ds_read_b64_tr_b16 a[238:239], v8 offset:18696
    s_waitcnt lgkmcnt(7)
    s_waitcnt vmcnt(2)
    ds_read_b64_tr_b16 a[240:241], v8 offset:20480
    ds_read_b64_tr_b16 a[242:243], v8 offset:20736
    ds_read_b64_tr_b16 a[244:245], v8 offset:20488
    ds_read_b64_tr_b16 a[246:247], v8 offset:20744
    s_waitcnt vmcnt(0)
    ds_read_b64_tr_b16 a[248:249], v8 offset:22528
    ds_read_b64_tr_b16 a[250:251], v8 offset:22784
    ds_read_b64_tr_b16 a[252:253], v8 offset:22536
    ds_read_b64_tr_b16 a[254:255], v8 offset:22792
    s_waitcnt lgkmcnt(7)
    s_waitcnt lgkmcnt(0)
    v_and_b32 v5, 15, v1
    v_bfe_u32 v6, v1, 1, 3
    v_lshrrev_b32 v7, 4, v1
    v_xor_b32 v6, v6, v7
    v_lshlrev_b32 v6, 4, v6
    v_lshl_add_u32 v10, v5, 7, v6
    s_lshl_b32 s19, s16, 10
    v_xor_b32 v11, 64, v10
    v_add_u32 v12, 0x10000, v10
    v_add_u32 v13, 0x10000, v11
    v_lshrrev_b32 v7, 3, v1
    s_lshl_b32 s17, s16, 3
    v_add_u32 v7, s17, v7
    v_bfe_u32 v8, v7, 1, 3
    v_xor_b32 v8, v8, v1
    v_and_b32 v8, 7, v8
    v_bfe_u32 v5, v7, 2, 2
    v_and_b32 v2, 3, v7
    v_lshl_add_u32 v2, v5, 3, v2
    v_bfe_u32 v5, v7, 4, 1
    v_lshl_add_u32 v2, v5, 2, v2
    v_bfe_u32 v5, v1, 2, 2
    v_and_b32 v3, 3, v1
    v_lshl_add_u32 v3, v5, 3, v3
    v_lshlrev_b32 v2, 11, v2
    v_lshl_add_u32 v2, v8, 4, v2
    v_and_b32 v5, 48, v1
    v_lshl_add_u32 v3, v3, 6, v5
    s_mul_i32 s21, s28, 133120
    s_mul_i32 s18, s90, 17825792
    s_add_u32 s21, s21, s18
    s_lshl_b32 s18, s90, 7
    s_add_u32 s17, s28, s18
    s_lshl_b32 s17, s17, 7
    s_add_u32 s17, s17, 100663296
    v_mov_b32 v4, s17
    v_mov_b32 v5, 1073741824
    v_cmp_eq_u32 vcc, 0, v1
    s_nop 1
    v_cndmask_b32 v4, v5, v4, vcc
    s_mov_b32 s20, 0
    s_mov_b32 s24, 65536
    s_mov_b32 s25, 2048
    s_barrier
    s_cmp_eq_u32 s90, 2
    s_cbranch_scc1 P_v
    s_mov_b32 s26, s25
    s_sub_u32 s25, s21, 1073741824
    s_mov_b32 s21, 1073741824
    s_mov_b32 s23, 0
    s_mov_b32 s22, 0
    s_add_u32 m0, s19, 0
    s_nop 0
    buffer_load_dwordx4 v2, s[8:11], s20 offen offset:0 lds
    s_add_u32 m0, s19, 3968
    s_nop 0
    buffer_load_dwordx4 v2, s[8:11], s20 offen offset:128 lds
    s_add_u32 m0, s19, 7936
    s_nop 0
    buffer_load_dwordx4 v2, s[8:11], s20 offen offset:256 lds
    s_add_u32 m0, s19, 11904
    s_nop 0
    buffer_load_dwordx4 v2, s[8:11], s20 offen offset:384 lds
    s_add_u32 m0, s19, 15872
    s_nop 0
    buffer_load_dwordx4 v2, s[8:11], s20 offen offset:512 lds
    s_add_u32 m0, s19, 19840
    s_nop 0
    buffer_load_dwordx4 v2, s[8:11], s20 offen offset:640 lds
    s_add_u32 m0, s19, 23808
    s_nop 0
    buffer_load_dwordx4 v2, s[8:11], s20 offen offset:768 lds
    s_add_u32 m0, s19, 27776
    s_nop 0
    buffer_load_dwordx4 v2, s[8:11], s20 offen offset:896 lds
    s_add_u32 m0, s19, 31744
    s_nop 0
    buffer_load_dwordx4 v2, s[8:11], s20 offen offset:1024 lds
    s_add_u32 m0, s19, 35712
    s_nop 0
    buffer_load_dwordx4 v2, s[8:11], s20 offen offset:1152 lds
    s_add_u32 m0, s19, 39680
    s_nop 0
    buffer_load_dwordx4 v2, s[8:11], s20 offen offset:1280 lds
    s_add_u32 m0, s19, 43648
    s_nop 0
    buffer_load_dwordx4 v2, s[8:11], s20 offen offset:1408 lds
    s_add_u32 m0, s19, 47616
    s_nop 0
    buffer_load_dwordx4 v2, s[8:11], s20 offen offset:1536 lds
    s_add_u32 m0, s19, 51584
    s_nop 0
    buffer_load_dwordx4 v2, s[8:11], s20 offen offset:1664 lds
    s_add_u32 m0, s19, 55552
    s_nop 0
    buffer_load_dwordx4 v2, s[8:11], s20 offen offset:1792 lds
    s_add_u32 m0, s19, 59520
    s_nop 0
    buffer_load_dwordx4 v2, s[8:11], s20 offen offset:1920 lds
    s_add_u32 s20, s20, s24
    s_add_u32 m0, s19, 65536
    s_nop 0
    buffer_load_dwordx4 v2, s[8:11], s20 offen offset:0 lds
    s_add_u32 m0, s19, 69504
    s_nop 0
    buffer_load_dwordx4 v2, s[8:11], s20 offen offset:128 lds
    s_add_u32 m0, s19, 73472
    s_nop 0
    buffer_load_dwordx4 v2, s[8:11], s20 offen offset:256 lds
    v_mov_b32 v9, s23
    s_add_u32 s23, s23, 1
    buffer_store_dword v9, v4, s[4:7], 0 offen sc1
    s_mov_b32 s23, 0
    s_waitcnt vmcnt(12)
    s_barrier
    ds_read_b128 v[20:23], v10 offset:0
    ds_read_b128 v[24:27], v10 offset:2048
    ds_read_b128 v[28:31], v11 offset:0
    ds_read_b128 v[32:35], v11 offset:2048
    ds_read_b128 v[36:39], v10 offset:4096
    ds_read_b128 v[40:43], v10 offset:6144
    ds_read_b128 v[44:47], v11 offset:4096
.p2align 6
P_qk_top:
    s_waitcnt lgkmcnt(6)
    v_mfma_f32_16x16x32_bf16 v[52:55], a[0:3], v[20:23], 0
    ds_read_b128 v[48:51], v11 offset:6144
    v_mfma_f32_16x16x32_bf16 v[56:59], a[4:7], v[20:23], 0
    s_waitcnt lgkmcnt(6)
    v_mfma_f32_16x16x32_bf16 v[60:63], a[0:3], v[24:27], 0
    ds_read_b128 v[20:23], v10 offset:8192
    s_add_u32 m0, s19, 77440
    v_mfma_f32_16x16x32_bf16 v[64:67], a[4:7], v[24:27], 0
    buffer_load_dwordx4 v2, s[8:11], s20 offen offset:384 lds
    s_waitcnt lgkmcnt(6)
    v_mfma_f32_16x16x32_bf16 v[52:55], a[8:11], v[28:31], v[52:55]
    ds_read_b128 v[24:27], v10 offset:10240
    v_mfma_f32_16x16x32_bf16 v[56:59], a[12:15], v[28:31], v[56:59]
    s_waitcnt lgkmcnt(6)
    v_mfma_f32_16x16x32_bf16 v[60:63], a[8:11], v[32:35], v[60:63]
    ds_read_b128 v[28:31], v11 offset:8192
    s_add_u32 m0, s19, 81408
    v_mfma_f32_16x16x32_bf16 v[64:67], a[12:15], v[32:35], v[64:67]
    buffer_load_dwordx4 v2, s[8:11], s20 offen offset:512 lds
    s_waitcnt lgkmcnt(6)
    v_mfma_f32_16x16x32_bf16 v[52:55], a[16:19], v[36:39], v[52:55]
    ds_read_b128 v[32:35], v11 offset:10240
    v_mfma_f32_16x16x32_bf16 v[56:59], a[20:23], v[36:39], v[56:59]
    s_waitcnt lgkmcnt(6)
    v_mfma_f32_16x16x32_bf16 v[60:63], a[16:19], v[40:43], v[60:63]
    ds_read_b128 v[36:39], v10 offset:12288
    s_add_u32 m0, s19, 85376
    v_mfma_f32_16x16x32_bf16 v[64:67], a[20:23], v[40:43], v[64:67]
    buffer_load_dwordx4 v2, s[8:11], s20 offen offset:640 lds
    s_waitcnt lgkmcnt(6)
    v_mfma_f32_16x16x32_bf16 v[52:55], a[24:27], v[44:47], v[52:55]
    ds_read_b128 v[40:43], v10 offset:14336
    v_mfma_f32_16x16x32_bf16 v[56:59], a[28:31], v[44:47], v[56:59]
    s_waitcnt lgkmcnt(6)
    v_mfma_f32_16x16x32_bf16 v[60:63], a[24:27], v[48:51], v[60:63]
    ds_read_b128 v[44:47], v11 offset:12288
    s_add_u32 m0, s19, 89344
    v_mfma_f32_16x16x32_bf16 v[64:67], a[28:31], v[48:51], v[64:67]
    buffer_load_dwordx4 v2, s[8:11], s20 offen offset:768 lds
    s_waitcnt lgkmcnt(6)
    v_mfma_f32_16x16x32_bf16 v[52:55], a[32:35], v[20:23], v[52:55]
    ds_read_b128 v[48:51], v11 offset:14336
    v_mfma_f32_16x16x32_bf16 v[56:59], a[36:39], v[20:23], v[56:59]
    s_waitcnt lgkmcnt(6)
    v_mfma_f32_16x16x32_bf16 v[60:63], a[32:35], v[24:27], v[60:63]
    ds_read_b128 v[20:23], v10 offset:16384
    s_add_u32 m0, s19, 93312
    v_mfma_f32_16x16x32_bf16 v[64:67], a[36:39], v[24:27], v[64:67]
    buffer_load_dwordx4 v2, s[8:11], s20 offen offset:896 lds
    s_waitcnt lgkmcnt(6)
    v_mfma_f32_16x16x32_bf16 v[52:55], a[40:43], v[28:31], v[52:55]
    ds_read_b128 v[24:27], v10 offset:18432
    v_mfma_f32_16x16x32_bf16 v[56:59], a[44:47], v[28:31], v[56:59]
    v_cvt_pk_bf16_f32 v84, v68, v69
    s_waitcnt lgkmcnt(6)
    v_mfma_f32_16x16x32_bf16 v[60:63], a[40:43], v[32:35], v[60:63]
    ds_read_b128 v[28:31], v11 offset:16384
    v_mfma_f32_16x16x32_bf16 v[64:67], a[44:47], v[32:35], v[64:67]
    v_cvt_pk_bf16_f32 v85, v70, v71
    s_waitcnt lgkmcnt(6)
    v_mfma_f32_16x16x32_bf16 v[52:55], a[48:51], v[36:39], v[52:55]
    ds_read_b128 v[32:35], v11 offset:18432
    v_mfma_f32_16x16x32_bf16 v[56:59], a[52:55], v[36:39], v[56:59]
    v_cvt_pk_bf16_f32 v86, v72, v73
    s_waitcnt lgkmcnt(6)
    v_mfma_f32_16x16x32_bf16 v[60:63], a[48:51], v[40:43], v[60:63]
    ds_read_b128 v[36:39], v10 offset:20480
    v_mfma_f32_16x16x32_bf16 v[64:67], a[52:55], v[40:43], v[64:67]
    v_cvt_pk_bf16_f32 v87, v74, v75
    s_waitcnt lgkmcnt(6)
    v_mfma_f32_16x16x32_bf16 v[52:55], a[56:59], v[44:47], v[52:55]
    ds_read_b128 v[40:43], v10 offset:22528
    v_mfma_f32_16x16x32_bf16 v[56:59], a[60:63], v[44:47], v[56:59]
    v_cvt_pk_bf16_f32 v88, v76, v77
    s_waitcnt lgkmcnt(6)
    v_mfma_f32_16x16x32_bf16 v[60:63], a[56:59], v[48:51], v[60:63]
    ds_read_b128 v[44:47], v11 offset:20480
    v_mfma_f32_16x16x32_bf16 v[64:67], a[60:63], v[48:51], v[64:67]
    v_cvt_pk_bf16_f32 v89, v78, v79
    buffer_store_dwordx4 v[84:87], v3, s[4:7], s21 offen offset:0 sc1
    s_waitcnt lgkmcnt(6)
    v_mfma_f32_16x16x32_bf16 v[52:55], a[64:67], v[20:23], v[52:55]
    ds_read_b128 v[48:51], v11 offset:22528
    v_mfma_f32_16x16x32_bf16 v[56:59], a[68:71], v[20:23], v[56:59]
    v_cvt_pk_bf16_f32 v90, v80, v81
    s_waitcnt lgkmcnt(6)
    v_mfma_f32_16x16x32_bf16 v[60:63], a[64:67], v[24:27], v[60:63]
    ds_read_b128 v[20:23], v10 offset:24576
    v_mfma_f32_16x16x32_bf16 v[64:67], a[68:71], v[24:27], v[64:67]
    v_cvt_pk_bf16_f32 v91, v82, v83
    s_waitcnt lgkmcnt(6)
    v_mfma_f32_16x16x32_bf16 v[52:55], a[72:75], v[28:31], v[52:55]
    ds_read_b128 v[24:27], v10 offset:26624
    v_mfma_f32_16x16x32_bf16 v[56:59], a[76:79], v[28:31], v[56:59]
    s_waitcnt lgkmcnt(6)
    v_mfma_f32_16x16x32_bf16 v[60:63], a[72:75], v[32:35], v[60:63]
    ds_read_b128 v[28:31], v11 offset:24576
    v_mfma_f32_16x16x32_bf16 v[64:67], a[76:79], v[32:35], v[64:67]
    buffer_store_dwordx4 v[88:91], v3, s[4:7], s21 offen offset:256 sc1
    s_waitcnt lgkmcnt(6)
    v_mfma_f32_16x16x32_bf16 v[52:55], a[80:83], v[36:39], v[52:55]
    ds_read_b128 v[32:35], v11 offset:26624
    v_mfma_f32_16x16x32_bf16 v[56:59], a[84:87], v[36:39], v[56:59]
    s_add_u32 s21, s21, s25
    s_mov_b32 s25, s26
    s_waitcnt lgkmcnt(6)
    v_mfma_f32_16x16x32_bf16 v[60:63], a[80:83], v[40:43], v[60:63]
    ds_read_b128 v[36:39], v10 offset:28672
    v_mfma_f32_16x16x32_bf16 v[64:67], a[84:87], v[40:43], v[64:67]
    s_waitcnt lgkmcnt(6)
    v_mfma_f32_16x16x32_bf16 v[52:55], a[88:91], v[44:47], v[52:55]
    ds_read_b128 v[40:43], v10 offset:30720
    v_mfma_f32_16x16x32_bf16 v[56:59], a[92:95], v[44:47], v[56:59]
    s_waitcnt lgkmcnt(6)
    v_mfma_f32_16x16x32_bf16 v[60:63], a[88:91], v[48:51], v[60:63]
    ds_read_b128 v[44:47], v11 offset:28672
    v_mfma_f32_16x16x32_bf16 v[64:67], a[92:95], v[48:51], v[64:67]
    s_waitcnt lgkmcnt(6)
    v_mfma_f32_16x16x32_bf16 v[52:55], a[96:99], v[20:23], v[52:55]
    ds_read_b128 v[48:51], v11 offset:30720
    v_mfma_f32_16x16x32_bf16 v[56:59], a[100:103], v[20:23], v[56:59]
    s_waitcnt lgkmcnt(6)
    v_mfma_f32_16x16x32_bf16 v[60:63], a[96:99], v[24:27], v[60:63]
    s_waitcnt vmcnt(11)
    s_barrier
    ds_read_b128 v[20:23], v10 offset:32768
    v_mfma_f32_16x16x32_bf16 v[64:67], a[100:103], v[24:27], v[64:67]
    s_waitcnt lgkmcnt(6)
    v_mfma_f32_16x16x32_bf16 v[52:55], a[104:107], v[28:31], v[52:55]
    ds_read_b128 v[24:27], v10 offset:34816
    s_add_u32 m0, s19, 97280
    v_mfma_f32_16x16x32_bf16 v[56:59], a[108:111], v[28:31], v[56:59]
    buffer_load_dwordx4 v2, s[8:11], s20 offen offset:1024 lds
    s_waitcnt lgkmcnt(6)
    v_mfma_f32_16x16x32_bf16 v[60:63], a[104:107], v[32:35], v[60:63]
    ds_read_b128 v[28:31], v11 offset:32768
    v_mfma_f32_16x16x32_bf16 v[64:67], a[108:111], v[32:35], v[64:67]
    s_waitcnt lgkmcnt(6)
    v_mfma_f32_16x16x32_bf16 v[52:55], a[112:115], v[36:39], v[52:55]
    ds_read_b128 v[32:35], v11 offset:34816
    s_add_u32 m0, s19, 101248
    v_mfma_f32_16x16x32_bf16 v[56:59], a[116:119], v[36:39], v[56:59]
    buffer_load_dwordx4 v2, s[8:11], s20 offen offset:1152 lds
    s_waitcnt lgkmcnt(6)
    v_mfma_f32_16x16x32_bf16 v[60:63], a[112:115], v[40:43], v[60:63]
    ds_read_b128 v[36:39], v10 offset:36864
    v_mfma_f32_16x16x32_bf16 v[64:67], a[116:119], v[40:43], v[64:67]
    s_waitcnt lgkmcnt(6)
    v_mfma_f32_16x16x32_bf16 v[52:55], a[120:123], v[44:47], v[52:55]
    ds_read_b128 v[40:43], v10 offset:38912
    s_add_u32 m0, s19, 105216
    v_mfma_f32_16x16x32_bf16 v[56:59], a[124:127], v[44:47], v[56:59]
    buffer_load_dwordx4 v2, s[8:11], s20 offen offset:1280 lds
    s_waitcnt lgkmcnt(6)
    v_mfma_f32_16x16x32_bf16 v[60:63], a[120:123], v[48:51], v[60:63]
    ds_read_b128 v[44:47], v11 offset:36864
    v_mfma_f32_16x16x32_bf16 v[64:67], a[124:127], v[48:51], v[64:67]
    s_waitcnt lgkmcnt(6)
    v_mfma_f32_16x16x32_bf16 v[52:55], a[128:131], v[20:23], v[52:55]
    ds_read_b128 v[48:51], v11 offset:38912
    v_mfma_f32_16x16x32_bf16 v[56:59], a[132:135], v[20:23], v[56:59]
    s_waitcnt lgkmcnt(6)
    v_mfma_f32_16x16x32_bf16 v[60:63], a[128:131], v[24:27], v[60:63]
    ds_read_b128 v[20:23], v10 offset:40960
    s_add_u32 m0, s19, 109184
    v_mfma_f32_16x16x32_bf16 v[64:67], a[132:135], v[24:27], v[64:67]
    buffer_load_dwordx4 v2, s[8:11], s20 offen offset:1408 lds
    s_waitcnt lgkmcnt(6)
    v_mfma_f32_16x16x32_bf16 v[52:55], a[136:139], v[28:31], v[52:55]
    ds_read_b128 v[24:27], v10 offset:43008
    v_mfma_f32_16x16x32_bf16 v[56:59], a[140:143], v[28:31], v[56:59]
    s_waitcnt lgkmcnt(6)
    v_mfma_f32_16x16x32_bf16 v[60:63], a[136:139], v[32:35], v[60:63]
    ds_read_b128 v[28:31], v11 offset:40960
    s_add_u32 m0, s19, 113152
    v_mfma_f32_16x16x32_bf16 v[64:67], a[140:143], v[32:35], v[64:67]
    buffer_load_dwordx4 v2, s[8:11], s20 offen offset:1536 lds
    s_waitcnt lgkmcnt(6)
    v_mfma_f32_16x16x32_bf16 v[52:55], a[144:147], v[36:39], v[52:55]
    ds_read_b128 v[32:35], v11 offset:43008
    v_mfma_f32_16x16x32_bf16 v[56:59], a[148:151], v[36:39], v[56:59]
    s_waitcnt lgkmcnt(6)
    v_mfma_f32_16x16x32_bf16 v[60:63], a[144:147], v[40:43], v[60:63]
    ds_read_b128 v[36:39], v10 offset:45056
    s_add_u32 m0, s19, 117120
    v_mfma_f32_16x16x32_bf16 v[64:67], a[148:151], v[40:43], v[64:67]
    buffer_load_dwordx4 v2, s[8:11], s20 offen offset:1664 lds
    s_waitcnt lgkmcnt(6)
    v_mfma_f32_16x16x32_bf16 v[52:55], a[152:155], v[44:47], v[52:55]
    ds_read_b128 v[40:43], v10 offset:47104
    v_mfma_f32_16x16x32_bf16 v[56:59], a[156:159], v[44:47], v[56:59]
    s_waitcnt lgkmcnt(6)
    v_mfma_f32_16x16x32_bf16 v[60:63], a[152:155], v[48:51], v[60:63]
    ds_read_b128 v[44:47], v11 offset:45056
    s_add_u32 m0, s19, 121088
    v_mfma_f32_16x16x32_bf16 v[64:67], a[156:159], v[48:51], v[64:67]
    buffer_load_dwordx4 v2, s[8:11], s20 offen offset:1792 lds
    s_waitcnt lgkmcnt(6)
    v_mfma_f32_16x16x32_bf16 v[52:55], a[160:163], v[20:23], v[52:55]
    ds_read_b128 v[48:51], v11 offset:47104
    v_mfma_f32_16x16x32_bf16 v[56:59], a[164:167], v[20:23], v[56:59]
    s_waitcnt lgkmcnt(6)
    v_mfma_f32_16x16x32_bf16 v[60:63], a[160:163], v[24:27], v[60:63]
    ds_read_b128 v[20:23], v10 offset:49152
    s_add_u32 m0, s19, 125056
    v_mfma_f32_16x16x32_bf16 v[64:67], a[164:167], v[24:27], v[64:67]
    buffer_load_dwordx4 v2, s[8:11], s20 offen offset:1920 lds
    s_waitcnt lgkmcnt(6)
    v_mfma_f32_16x16x32_bf16 v[52:55], a[168:171], v[28:31], v[52:55]
    ds_read_b128 v[24:27], v10 offset:51200
    v_mfma_f32_16x16x32_bf16 v[56:59], a[172:175], v[28:31], v[56:59]
    s_add_u32 s20, s20, s24
    s_waitcnt lgkmcnt(6)
    v_mfma_f32_16x16x32_bf16 v[60:63], a[168:171], v[32:35], v[60:63]
    ds_read_b128 v[28:31], v11 offset:49152
    v_mfma_f32_16x16x32_bf16 v[64:67], a[172:175], v[32:35], v[64:67]
    s_waitcnt lgkmcnt(6)
    v_mfma_f32_16x16x32_bf16 v[52:55], a[176:179], v[36:39], v[52:55]
    ds_read_b128 v[32:35], v11 offset:51200
    v_mfma_f32_16x16x32_bf16 v[56:59], a[180:183], v[36:39], v[56:59]
    s_waitcnt lgkmcnt(6)
    v_mfma_f32_16x16x32_bf16 v[60:63], a[176:179], v[40:43], v[60:63]
    ds_read_b128 v[36:39], v10 offset:53248
    v_mfma_f32_16x16x32_bf16 v[64:67], a[180:183], v[40:43], v[64:67]
    s_waitcnt lgkmcnt(6)
    v_mfma_f32_16x16x32_bf16 v[52:55], a[184:187], v[44:47], v[52:55]
    ds_read_b128 v[40:43], v10 offset:55296
    v_mfma_f32_16x16x32_bf16 v[56:59], a[188:191], v[44:47], v[56:59]
    s_waitcnt lgkmcnt(6)
    v_mfma_f32_16x16x32_bf16 v[60:63], a[184:187], v[48:51], v[60:63]
    ds_read_b128 v[44:47], v11 offset:53248
    v_mfma_f32_16x16x32_bf16 v[64:67], a[188:191], v[48:51], v[64:67]
    s_waitcnt lgkmcnt(6)
    v_mfma_f32_16x16x32_bf16 v[52:55], a[192:195], v[20:23], v[52:55]
    ds_read_b128 v[48:51], v11 offset:55296
    v_mfma_f32_16x16x32_bf16 v[56:59], a[196:199], v[20:23], v[56:59]
    s_waitcnt lgkmcnt(6)
    v_mfma_f32_16x16x32_bf16 v[60:63], a[192:195], v[24:27], v[60:63]
    ds_read_b128 v[20:23], v10 offset:57344
    v_mfma_f32_16x16x32_bf16 v[64:67], a[196:199], v[24:27], v[64:67]
    s_waitcnt lgkmcnt(6)
    v_mfma_f32_16x16x32_bf16 v[52:55], a[200:203], v[28:31], v[52:55]
    ds_read_b128 v[24:27], v10 offset:59392
    v_mfma_f32_16x16x32_bf16 v[56:59], a[204:207], v[28:31], v[56:59]
    s_waitcnt lgkmcnt(6)
    v_mfma_f32_16x16x32_bf16 v[60:63], a[200:203], v[32:35], v[60:63]
    ds_read_b128 v[28:31], v11 offset:57344
    v_mfma_f32_16x16x32_bf16 v[64:67], a[204:207], v[32:35], v[64:67]
    s_waitcnt lgkmcnt(6)
    v_mfma_f32_16x16x32_bf16 v[52:55], a[208:211], v[36:39], v[52:55]
    ds_read_b128 v[32:35], v11 offset:59392
    v_mfma_f32_16x16x32_bf16 v[56:59], a[212:215], v[36:39], v[56:59]
    s_waitcnt lgkmcnt(6)
    v_mfma_f32_16x16x32_bf16 v[60:63], a[208:211], v[40:43], v[60:63]
    ds_read_b128 v[36:39], v10 offset:61440
    v_mfma_f32_16x16x32_bf16 v[64:67], a[212:215], v[40:43], v[64:67]
    s_waitcnt lgkmcnt(6)
    v_mfma_f32_16x16x32_bf16 v[52:55], a[216:219], v[44:47], v[52:55]
    ds_read_b128 v[40:43], v10 offset:63488
    v_mfma_f32_16x16x32_bf16 v[56:59], a[220:223], v[44:47], v[56:59]
    s_waitcnt lgkmcnt(6)
    v_mfma_f32_16x16x32_bf16 v[60:63], a[216:219], v[48:51], v[60:63]
    ds_read_b128 v[44:47], v11 offset:61440
    v_mfma_f32_16x16x32_bf16 v[64:67], a[220:223], v[48:51], v[64:67]
    s_waitcnt lgkmcnt(6)
    v_mfma_f32_16x16x32_bf16 v[52:55], a[224:227], v[20:23], v[52:55]
    ds_read_b128 v[48:51], v11 offset:63488
    v_mfma_f32_16x16x32_bf16 v[56:59], a[228:231], v[20:23], v[56:59]
    s_waitcnt lgkmcnt(6)
    v_mfma_f32_16x16x32_bf16 v[60:63], a[224:227], v[24:27], v[60:63]
    s_waitcnt vmcnt(8)
    s_barrier
    ds_read_b128 v[20:23], v12 offset:0
    v_mfma_f32_16x16x32_bf16 v[64:67], a[228:231], v[24:27], v[64:67]
    s_waitcnt lgkmcnt(6)
    v_mfma_f32_16x16x32_bf16 v[52:55], a[232:235], v[28:31], v[52:55]
    ds_read_b128 v[24:27], v12 offset:2048
    s_add_u32 m0, s19, 0
    v_mfma_f32_16x16x32_bf16 v[56:59], a[236:239], v[28:31], v[56:59]
    buffer_load_dwordx4 v2, s[8:11], s20 offen offset:0 lds
    s_waitcnt lgkmcnt(6)
    v_mfma_f32_16x16x32_bf16 v[60:63], a[232:235], v[32:35], v[60:63]
    ds_read_b128 v[28:31], v13 offset:0
    v_mfma_f32_16x16x32_bf16 v[64:67], a[236:239], v[32:35], v[64:67]
    v_mov_b32 v9, s23
    s_add_u32 s23, s23, 1
    buffer_store_dword v9, v4, s[4:7], 0 offen sc1
    s_waitcnt lgkmcnt(6)
    v_mfma_f32_16x16x32_bf16 v[52:55], a[240:243], v[36:39], v[52:55]
    ds_read_b128 v[32:35], v13 offset:2048
    s_add_u32 m0, s19, 3968
    v_mfma_f32_16x16x32_bf16 v[56:59], a[244:247], v[36:39], v[56:59]
    buffer_load_dwordx4 v2, s[8:11], s20 offen offset:128 lds
    s_waitcnt lgkmcnt(6)
    v_mfma_f32_16x16x32_bf16 v[60:63], a[240:243], v[40:43], v[60:63]
    ds_read_b128 v[36:39], v12 offset:4096
    v_mfma_f32_16x16x32_bf16 v[64:67], a[244:247], v[40:43], v[64:67]
    s_waitcnt lgkmcnt(6)
    v_mfma_f32_16x16x32_bf16 v[52:55], a[248:251], v[44:47], v[52:55]
    ds_read_b128 v[40:43], v12 offset:6144
    s_add_u32 m0, s19, 7936
    v_mfma_f32_16x16x32_bf16 v[56:59], a[252:255], v[44:47], v[56:59]
    buffer_load_dwordx4 v2, s[8:11], s20 offen offset:256 lds
    s_waitcnt lgkmcnt(6)
    v_mfma_f32_16x16x32_bf16 v[60:63], a[248:251], v[48:51], v[60:63]
    ds_read_b128 v[44:47], v13 offset:4096
    v_mfma_f32_16x16x32_bf16 v[64:67], a[252:255], v[48:51], v[64:67]
    s_waitcnt lgkmcnt(6)
    v_mfma_f32_16x16x32_bf16 v[68:71], a[0:3], v[20:23], 0
    ds_read_b128 v[48:51], v13 offset:6144
    v_mfma_f32_16x16x32_bf16 v[72:75], a[4:7], v[20:23], 0
    s_waitcnt lgkmcnt(6)
    v_mfma_f32_16x16x32_bf16 v[76:79], a[0:3], v[24:27], 0
    ds_read_b128 v[20:23], v12 offset:8192
    s_add_u32 m0, s19, 11904
    v_mfma_f32_16x16x32_bf16 v[80:83], a[4:7], v[24:27], 0
    buffer_load_dwordx4 v2, s[8:11], s20 offen offset:384 lds
    s_waitcnt lgkmcnt(6)
    v_mfma_f32_16x16x32_bf16 v[68:71], a[8:11], v[28:31], v[68:71]
    ds_read_b128 v[24:27], v12 offset:10240
    v_mfma_f32_16x16x32_bf16 v[72:75], a[12:15], v[28:31], v[72:75]
    s_waitcnt lgkmcnt(6)
    v_mfma_f32_16x16x32_bf16 v[76:79], a[8:11], v[32:35], v[76:79]
    ds_read_b128 v[28:31], v13 offset:8192
    s_add_u32 m0, s19, 15872
    v_mfma_f32_16x16x32_bf16 v[80:83], a[12:15], v[32:35], v[80:83]
    buffer_load_dwordx4 v2, s[8:11], s20 offen offset:512 lds
    s_waitcnt lgkmcnt(6)
    v_mfma_f32_16x16x32_bf16 v[68:71], a[16:19], v[36:39], v[68:71]
    ds_read_b128 v[32:35], v13 offset:10240
    v_mfma_f32_16x16x32_bf16 v[72:75], a[20:23], v[36:39], v[72:75]
    s_waitcnt lgkmcnt(6)
    v_mfma_f32_16x16x32_bf16 v[76:79], a[16:19], v[40:43], v[76:79]
    ds_read_b128 v[36:39], v12 offset:12288
    s_add_u32 m0, s19, 19840
    v_mfma_f32_16x16x32_bf16 v[80:83], a[20:23], v[40:43], v[80:83]
    buffer_load_dwordx4 v2, s[8:11], s20 offen offset:640 lds
    s_waitcnt lgkmcnt(6)
    v_mfma_f32_16x16x32_bf16 v[68:71], a[24:27], v[44:47], v[68:71]
    ds_read_b128 v[40:43], v12 offset:14336
    v_mfma_f32_16x16x32_bf16 v[72:75], a[28:31], v[44:47], v[72:75]
    s_waitcnt lgkmcnt(6)
    v_mfma_f32_16x16x32_bf16 v[76:79], a[24:27], v[48:51], v[76:79]
    ds_read_b128 v[44:47], v13 offset:12288
    s_add_u32 m0, s19, 23808
    v_mfma_f32_16x16x32_bf16 v[80:83], a[28:31], v[48:51], v[80:83]
    buffer_load_dwordx4 v2, s[8:11], s20 offen offset:768 lds
    s_waitcnt lgkmcnt(6)
    v_mfma_f32_16x16x32_bf16 v[68:71], a[32:35], v[20:23], v[68:71]
    ds_read_b128 v[48:51], v13 offset:14336
    v_mfma_f32_16x16x32_bf16 v[72:75], a[36:39], v[20:23], v[72:75]
    s_waitcnt lgkmcnt(6)
    v_mfma_f32_16x16x32_bf16 v[76:79], a[32:35], v[24:27], v[76:79]
    ds_read_b128 v[20:23], v12 offset:16384
    s_add_u32 m0, s19, 27776
    v_mfma_f32_16x16x32_bf16 v[80:83], a[36:39], v[24:27], v[80:83]
    buffer_load_dwordx4 v2, s[8:11], s20 offen offset:896 lds
    s_waitcnt lgkmcnt(6)
    v_mfma_f32_16x16x32_bf16 v[68:71], a[40:43], v[28:31], v[68:71]
    ds_read_b128 v[24:27], v12 offset:18432
    v_mfma_f32_16x16x32_bf16 v[72:75], a[44:47], v[28:31], v[72:75]
    v_cvt_pk_bf16_f32 v84, v52, v53
    s_waitcnt lgkmcnt(6)
    v_mfma_f32_16x16x32_bf16 v[76:79], a[40:43], v[32:35], v[76:79]
    ds_read_b128 v[28:31], v13 offset:16384
    v_mfma_f32_16x16x32_bf16 v[80:83], a[44:47], v[32:35], v[80:83]
    v_cvt_pk_bf16_f32 v85, v54, v55
    s_waitcnt lgkmcnt(6)
    v_mfma_f32_16x16x32_bf16 v[68:71], a[48:51], v[36:39], v[68:71]
    ds_read_b128 v[32:35], v13 offset:18432
    v_mfma_f32_16x16x32_bf16 v[72:75], a[52:55], v[36:39], v[72:75]
    v_cvt_pk_bf16_f32 v86, v56, v57
    s_waitcnt lgkmcnt(6)
    v_mfma_f32_16x16x32_bf16 v[76:79], a[48:51], v[40:43], v[76:79]
    ds_read_b128 v[36:39], v12 offset:20480
    v_mfma_f32_16x16x32_bf16 v[80:83], a[52:55], v[40:43], v[80:83]
    v_cvt_pk_bf16_f32 v87, v58, v59
    s_waitcnt lgkmcnt(6)
    v_mfma_f32_16x16x32_bf16 v[68:71], a[56:59], v[44:47], v[68:71]
    ds_read_b128 v[40:43], v12 offset:22528
    v_mfma_f32_16x16x32_bf16 v[72:75], a[60:63], v[44:47], v[72:75]
    v_cvt_pk_bf16_f32 v88, v60, v61
    s_waitcnt lgkmcnt(6)
    v_mfma_f32_16x16x32_bf16 v[76:79], a[56:59], v[48:51], v[76:79]
    ds_read_b128 v[44:47], v13 offset:20480
    v_mfma_f32_16x16x32_bf16 v[80:83], a[60:63], v[48:51], v[80:83]
    v_cvt_pk_bf16_f32 v89, v62, v63
    buffer_store_dwordx4 v[84:87], v3, s[4:7], s21 offen offset:0 sc1
    s_waitcnt lgkmcnt(6)
    v_mfma_f32_16x16x32_bf16 v[68:71], a[64:67], v[20:23], v[68:71]
    ds_read_b128 v[48:51], v13 offset:22528
    v_mfma_f32_16x16x32_bf16 v[72:75], a[68:71], v[20:23], v[72:75]
    v_cvt_pk_bf16_f32 v90, v64, v65
    s_waitcnt lgkmcnt(6)
    v_mfma_f32_16x16x32_bf16 v[76:79], a[64:67], v[24:27], v[76:79]
    ds_read_b128 v[20:23], v12 offset:24576
    v_mfma_f32_16x16x32_bf16 v[80:83], a[68:71], v[24:27], v[80:83]
    v_cvt_pk_bf16_f32 v91, v66, v67
    s_waitcnt lgkmcnt(6)
    v_mfma_f32_16x16x32_bf16 v[68:71], a[72:75], v[28:31], v[68:71]
    ds_read_b128 v[24:27], v12 offset:26624
    v_mfma_f32_16x16x32_bf16 v[72:75], a[76:79], v[28:31], v[72:75]
    s_waitcnt lgkmcnt(6)
    v_mfma_f32_16x16x32_bf16 v[76:79], a[72:75], v[32:35], v[76:79]
    ds_read_b128 v[28:31], v13 offset:24576
    v_mfma_f32_16x16x32_bf16 v[80:83], a[76:79], v[32:35], v[80:83]
    buffer_store_dwordx4 v[88:91], v3, s[4:7], s21 offen offset:256 sc1
    s_waitcnt lgkmcnt(6)
    v_mfma_f32_16x16x32_bf16 v[68:71], a[80:83], v[36:39], v[68:71]
    ds_read_b128 v[32:35], v13 offset:26624
    v_mfma_f32_16x16x32_bf16 v[72:75], a[84:87], v[36:39], v[72:75]
    s_add_u32 s21, s21, s25
    s_mov_b32 s25, s26
    s_waitcnt lgkmcnt(6)
    v_mfma_f32_16x16x32_bf16 v[76:79], a[80:83], v[40:43], v[76:79]
    ds_read_b128 v[36:39], v12 offset:28672
    v_mfma_f32_16x16x32_bf16 v[80:83], a[84:87], v[40:43], v[80:83]
    s_waitcnt lgkmcnt(6)
    v_mfma_f32_16x16x32_bf16 v[68:71], a[88:91], v[44:47], v[68:71]
    ds_read_b128 v[40:43], v12 offset:30720
    v_mfma_f32_16x16x32_bf16 v[72:75], a[92:95], v[44:47], v[72:75]
    s_waitcnt lgkmcnt(6)
    v_mfma_f32_16x16x32_bf16 v[76:79], a[88:91], v[48:51], v[76:79]
    ds_read_b128 v[44:47], v13 offset:28672
    v_mfma_f32_16x16x32_bf16 v[80:83], a[92:95], v[48:51], v[80:83]
    s_waitcnt lgkmcnt(6)
    v_mfma_f32_16x16x32_bf16 v[68:71], a[96:99], v[20:23], v[68:71]
    ds_read_b128 v[48:51], v13 offset:30720
    v_mfma_f32_16x16x32_bf16 v[72:75], a[100:103], v[20:23], v[72:75]
    s_waitcnt lgkmcnt(6)
    v_mfma_f32_16x16x32_bf16 v[76:79], a[96:99], v[24:27], v[76:79]
    s_waitcnt vmcnt(11)
    s_barrier
    ds_read_b128 v[20:23], v12 offset:32768
    v_mfma_f32_16x16x32_bf16 v[80:83], a[100:103], v[24:27], v[80:83]
    s_waitcnt lgkmcnt(6)
    v_mfma_f32_16x16x32_bf16 v[68:71], a[104:107], v[28:31], v[68:71]
    ds_read_b128 v[24:27], v12 offset:34816
    s_add_u32 m0, s19, 31744
    v_mfma_f32_16x16x32_bf16 v[72:75], a[108:111], v[28:31], v[72:75]
    buffer_load_dwordx4 v2, s[8:11], s20 offen offset:1024 lds
    s_waitcnt lgkmcnt(6)
    v_mfma_f32_16x16x32_bf16 v[76:79], a[104:107], v[32:35], v[76:79]
    ds_read_b128 v[28:31], v13 offset:32768
    v_mfma_f32_16x16x32_bf16 v[80:83], a[108:111], v[32:35], v[80:83]
    s_waitcnt lgkmcnt(6)
    v_mfma_f32_16x16x32_bf16 v[68:71], a[112:115], v[36:39], v[68:71]
    ds_read_b128 v[32:35], v13 offset:34816
    s_add_u32 m0, s19, 35712
    v_mfma_f32_16x16x32_bf16 v[72:75], a[116:119], v[36:39], v[72:75]
    buffer_load_dwordx4 v2, s[8:11], s20 offen offset:1152 lds
    s_waitcnt lgkmcnt(6)
    v_mfma_f32_16x16x32_bf16 v[76:79], a[112:115], v[40:43], v[76:79]
    ds_read_b128 v[36:39], v12 offset:36864
    v_mfma_f32_16x16x32_bf16 v[80:83], a[116:119], v[40:43], v[80:83]
    s_waitcnt lgkmcnt(6)
    v_mfma_f32_16x16x32_bf16 v[68:71], a[120:123], v[44:47], v[68:71]
    ds_read_b128 v[40:43], v12 offset:38912
    s_add_u32 m0, s19, 39680
    v_mfma_f32_16x16x32_bf16 v[72:75], a[124:127], v[44:47], v[72:75]
    buffer_load_dwordx4 v2, s[8:11], s20 offen offset:1280 lds
    s_waitcnt lgkmcnt(6)
    v_mfma_f32_16x16x32_bf16 v[76:79], a[120:123], v[48:51], v[76:79]
    ds_read_b128 v[44:47], v13 offset:36864
    v_mfma_f32_16x16x32_bf16 v[80:83], a[124:127], v[48:51], v[80:83]
    s_waitcnt lgkmcnt(6)
    v_mfma_f32_16x16x32_bf16 v[68:71], a[128:131], v[20:23], v[68:71]
    ds_read_b128 v[48:51], v13 offset:38912
    v_mfma_f32_16x16x32_bf16 v[72:75], a[132:135], v[20:23], v[72:75]
    s_waitcnt lgkmcnt(6)
    v_mfma_f32_16x16x32_bf16 v[76:79], a[128:131], v[24:27], v[76:79]
    ds_read_b128 v[20:23], v12 offset:40960
    s_add_u32 m0, s19, 43648
    v_mfma_f32_16x16x32_bf16 v[80:83], a[132:135], v[24:27], v[80:83]
    buffer_load_dwordx4 v2, s[8:11], s20 offen offset:1408 lds
    s_waitcnt lgkmcnt(6)
    v_mfma_f32_16x16x32_bf16 v[68:71], a[136:139], v[28:31], v[68:71]
    ds_read_b128 v[24:27], v12 offset:43008
    v_mfma_f32_16x16x32_bf16 v[72:75], a[140:143], v[28:31], v[72:75]
    s_waitcnt lgkmcnt(6)
    v_mfma_f32_16x16x32_bf16 v[76:79], a[136:139], v[32:35], v[76:79]
    ds_read_b128 v[28:31], v13 offset:40960
    s_add_u32 m0, s19, 47616
    v_mfma_f32_16x16x32_bf16 v[80:83], a[140:143], v[32:35], v[80:83]
    buffer_load_dwordx4 v2, s[8:11], s20 offen offset:1536 lds
    s_waitcnt lgkmcnt(6)
    v_mfma_f32_16x16x32_bf16 v[68:71], a[144:147], v[36:39], v[68:71]
    ds_read_b128 v[32:35], v13 offset:43008
    v_mfma_f32_16x16x32_bf16 v[72:75], a[148:151], v[36:39], v[72:75]
    s_waitcnt lgkmcnt(6)
    v_mfma_f32_16x16x32_bf16 v[76:79], a[144:147], v[40:43], v[76:79]
    ds_read_b128 v[36:39], v12 offset:45056
    s_add_u32 m0, s19, 51584
    v_mfma_f32_16x16x32_bf16 v[80:83], a[148:151], v[40:43], v[80:83]
    buffer_load_dwordx4 v2, s[8:11], s20 offen offset:1664 lds
    s_waitcnt lgkmcnt(6)
    v_mfma_f32_16x16x32_bf16 v[68:71], a[152:155], v[44:47], v[68:71]
    ds_read_b128 v[40:43], v12 offset:47104
    v_mfma_f32_16x16x32_bf16 v[72:75], a[156:159], v[44:47], v[72:75]
    s_waitcnt lgkmcnt(6)
    v_mfma_f32_16x16x32_bf16 v[76:79], a[152:155], v[48:51], v[76:79]
    ds_read_b128 v[44:47], v13 offset:45056
    s_add_u32 m0, s19, 55552
    v_mfma_f32_16x16x32_bf16 v[80:83], a[156:159], v[48:51], v[80:83]
    buffer_load_dwordx4 v2, s[8:11], s20 offen offset:1792 lds
    s_waitcnt lgkmcnt(6)
    v_mfma_f32_16x16x32_bf16 v[68:71], a[160:163], v[20:23], v[68:71]
    ds_read_b128 v[48:51], v13 offset:47104
    v_mfma_f32_16x16x32_bf16 v[72:75], a[164:167], v[20:23], v[72:75]
    s_waitcnt lgkmcnt(6)
    v_mfma_f32_16x16x32_bf16 v[76:79], a[160:163], v[24:27], v[76:79]
    ds_read_b128 v[20:23], v12 offset:49152
    s_add_u32 m0, s19, 59520
    v_mfma_f32_16x16x32_bf16 v[80:83], a[164:167], v[24:27], v[80:83]
    buffer_load_dwordx4 v2, s[8:11], s20 offen offset:1920 lds
    s_waitcnt lgkmcnt(6)
    v_mfma_f32_16x16x32_bf16 v[68:71], a[168:171], v[28:31], v[68:71]
    ds_read_b128 v[24:27], v12 offset:51200
    v_mfma_f32_16x16x32_bf16 v[72:75], a[172:175], v[28:31], v[72:75]
    s_add_u32 s20, s20, s24
    s_waitcnt lgkmcnt(6)
    v_mfma_f32_16x16x32_bf16 v[76:79], a[168:171], v[32:35], v[76:79]
    ds_read_b128 v[28:31], v13 offset:49152
    v_mfma_f32_16x16x32_bf16 v[80:83], a[172:175], v[32:35], v[80:83]
    s_waitcnt lgkmcnt(6)
    v_mfma_f32_16x16x32_bf16 v[68:71], a[176:179], v[36:39], v[68:71]
    ds_read_b128 v[32:35], v13 offset:51200
    v_mfma_f32_16x16x32_bf16 v[72:75], a[180:183], v[36:39], v[72:75]
    s_waitcnt lgkmcnt(6)
    v_mfma_f32_16x16x32_bf16 v[76:79], a[176:179], v[40:43], v[76:79]
    ds_read_b128 v[36:39], v12 offset:53248
    v_mfma_f32_16x16x32_bf16 v[80:83], a[180:183], v[40:43], v[80:83]
    s_waitcnt lgkmcnt(6)
    v_mfma_f32_16x16x32_bf16 v[68:71], a[184:187], v[44:47], v[68:71]
    ds_read_b128 v[40:43], v12 offset:55296
    v_mfma_f32_16x16x32_bf16 v[72:75], a[188:191], v[44:47], v[72:75]
    s_waitcnt lgkmcnt(6)
    v_mfma_f32_16x16x32_bf16 v[76:79], a[184:187], v[48:51], v[76:79]
    ds_read_b128 v[44:47], v13 offset:53248
    v_mfma_f32_16x16x32_bf16 v[80:83], a[188:191], v[48:51], v[80:83]
    s_waitcnt lgkmcnt(6)
    v_mfma_f32_16x16x32_bf16 v[68:71], a[192:195], v[20:23], v[68:71]
    ds_read_b128 v[48:51], v13 offset:55296
    v_mfma_f32_16x16x32_bf16 v[72:75], a[196:199], v[20:23], v[72:75]
    s_waitcnt lgkmcnt(6)
    v_mfma_f32_16x16x32_bf16 v[76:79], a[192:195], v[24:27], v[76:79]
    ds_read_b128 v[20:23], v12 offset:57344
    v_mfma_f32_16x16x32_bf16 v[80:83], a[196:199], v[24:27], v[80:83]
    s_waitcnt lgkmcnt(6)
    v_mfma_f32_16x16x32_bf16 v[68:71], a[200:203], v[28:31], v[68:71]
    ds_read_b128 v[24:27], v12 offset:59392
    v_mfma_f32_16x16x32_bf16 v[72:75], a[204:207], v[28:31], v[72:75]
    s_waitcnt lgkmcnt(6)
    v_mfma_f32_16x16x32_bf16 v[76:79], a[200:203], v[32:35], v[76:79]
    ds_read_b128 v[28:31], v13 offset:57344
    v_mfma_f32_16x16x32_bf16 v[80:83], a[204:207], v[32:35], v[80:83]
    s_waitcnt lgkmcnt(6)
    v_mfma_f32_16x16x32_bf16 v[68:71], a[208:211], v[36:39], v[68:71]
    ds_read_b128 v[32:35], v13 offset:59392
    v_mfma_f32_16x16x32_bf16 v[72:75], a[212:215], v[36:39], v[72:75]
    s_waitcnt lgkmcnt(6)
    v_mfma_f32_16x16x32_bf16 v[76:79], a[208:211], v[40:43], v[76:79]
    ds_read_b128 v[36:39], v12 offset:61440
    v_mfma_f32_16x16x32_bf16 v[80:83], a[212:215], v[40:43], v[80:83]
    s_waitcnt lgkmcnt(6)
    v_mfma_f32_16x16x32_bf16 v[68:71], a[216:219], v[44:47], v[68:71]
    ds_read_b128 v[40:43], v12 offset:63488
    v_mfma_f32_16x16x32_bf16 v[72:75], a[220:223], v[44:47], v[72:75]
    s_waitcnt lgkmcnt(6)
    v_mfma_f32_16x16x32_bf16 v[76:79], a[216:219], v[48:51], v[76:79]
    ds_read_b128 v[44:47], v13 offset:61440
    v_mfma_f32_16x16x32_bf16 v[80:83], a[220:223], v[48:51], v[80:83]
    s_waitcnt lgkmcnt(6)
    v_mfma_f32_16x16x32_bf16 v[68:71], a[224:227], v[20:23], v[68:71]
    ds_read_b128 v[48:51], v13 offset:63488
    v_mfma_f32_16x16x32_bf16 v[72:75], a[228:231], v[20:23], v[72:75]
    s_waitcnt lgkmcnt(6)
    v_mfma_f32_16x16x32_bf16 v[76:79], a[224:227], v[24:27], v[76:79]
    s_waitcnt vmcnt(8)
    s_barrier
    ds_read_b128 v[20:23], v10 offset:0
    v_mfma_f32_16x16x32_bf16 v[80:83], a[228:231], v[24:27], v[80:83]
    s_waitcnt lgkmcnt(6)
    v_mfma_f32_16x16x32_bf16 v[68:71], a[232:235], v[28:31], v[68:71]
    ds_read_b128 v[24:27], v10 offset:2048
    s_add_u32 m0, s19, 65536
    v_mfma_f32_16x16x32_bf16 v[72:75], a[236:239], v[28:31], v[72:75]
    buffer_load_dwordx4 v2, s[8:11], s20 offen offset:0 lds
    s_waitcnt lgkmcnt(6)
    v_mfma_f32_16x16x32_bf16 v[76:79], a[232:235], v[32:35], v[76:79]
    ds_read_b128 v[28:31], v11 offset:0
    v_mfma_f32_16x16x32_bf16 v[80:83], a[236:239], v[32:35], v[80:83]
    v_mov_b32 v9, s23
    s_add_u32 s23, s23, 1
    buffer_store_dword v9, v4, s[4:7], 0 offen sc1
    s_waitcnt lgkmcnt(6)
    v_mfma_f32_16x16x32_bf16 v[68:71], a[240:243], v[36:39], v[68:71]
    ds_read_b128 v[32:35], v11 offset:2048
    s_add_u32 m0, s19, 69504
    v_mfma_f32_16x16x32_bf16 v[72:75], a[244:247], v[36:39], v[72:75]
    buffer_load_dwordx4 v2, s[8:11], s20 offen offset:128 lds
    s_waitcnt lgkmcnt(6)
    v_mfma_f32_16x16x32_bf16 v[76:79], a[240:243], v[40:43], v[76:79]
    ds_read_b128 v[36:39], v10 offset:4096
    v_mfma_f32_16x16x32_bf16 v[80:83], a[244:247], v[40:43], v[80:83]
    s_waitcnt lgkmcnt(6)
    v_mfma_f32_16x16x32_bf16 v[68:71], a[248:251], v[44:47], v[68:71]
    ds_read_b128 v[40:43], v10 offset:6144
    s_add_u32 m0, s19, 73472
    v_mfma_f32_16x16x32_bf16 v[72:75], a[252:255], v[44:47], v[72:75]
    buffer_load_dwordx4 v2, s[8:11], s20 offen offset:256 lds
    s_waitcnt lgkmcnt(6)
    v_mfma_f32_16x16x32_bf16 v[76:79], a[248:251], v[48:51], v[76:79]
    ds_read_b128 v[44:47], v11 offset:4096
    v_mfma_f32_16x16x32_bf16 v[80:83], a[252:255], v[48:51], v[80:83]
    s_add_u32 s22, s22, 2
    s_cmp_lt_u32 s22, 64
    s_cbranch_scc1 P_qk_top
    v_cvt_pk_bf16_f32 v84, v68, v69
    v_cvt_pk_bf16_f32 v85, v70, v71
    v_cvt_pk_bf16_f32 v86, v72, v73
    v_cvt_pk_bf16_f32 v87, v74, v75
    v_cvt_pk_bf16_f32 v88, v76, v77
    v_cvt_pk_bf16_f32 v89, v78, v79
    v_cvt_pk_bf16_f32 v90, v80, v81
    v_cvt_pk_bf16_f32 v91, v82, v83
    buffer_store_dwordx4 v[84:87], v3, s[4:7], s21 offen offset:0 sc1
    buffer_store_dwordx4 v[88:91], v3, s[4:7], s21 offen offset:256 sc1
    s_waitcnt vmcnt(0) lgkmcnt(0)
    v_mov_b32 v9, s23
    s_add_u32 s23, s23, 1
    buffer_store_dword v9, v4, s[4:7], 0 offen sc1
    s_branch W_U
P_v:
    s_mov_b32 s26, s25
    s_sub_u32 s25, s21, 1073741824
    s_mov_b32 s21, 1073741824
    s_mov_b32 s23, 0
    s_mov_b32 s22, 0
    s_add_u32 m0, s19, 0
    s_nop 0
    buffer_load_dwordx4 v2, s[8:11], s20 offen offset:0 lds
    s_add_u32 m0, s19, 3968
    s_nop 0
    buffer_load_dwordx4 v2, s[8:11], s20 offen offset:128 lds
    s_add_u32 m0, s19, 7936
    s_nop 0
    buffer_load_dwordx4 v2, s[8:11], s20 offen offset:256 lds
    s_add_u32 m0, s19, 11904
    s_nop 0
    buffer_load_dwordx4 v2, s[8:11], s20 offen offset:384 lds
    s_add_u32 m0, s19, 15872
    s_nop 0
    buffer_load_dwordx4 v2, s[8:11], s20 offen offset:512 lds
    s_add_u32 m0, s19, 19840
    s_nop 0
    buffer_load_dwordx4 v2, s[8:11], s20 offen offset:640 lds
    s_add_u32 m0, s19, 23808
    s_nop 0
    buffer_load_dwordx4 v2, s[8:11], s20 offen offset:768 lds
    s_add_u32 m0, s19, 27776
    s_nop 0
    buffer_load_dwordx4 v2, s[8:11], s20 offen offset:896 lds
    s_add_u32 m0, s19, 31744
    s_nop 0
    buffer_load_dwordx4 v2, s[8:11], s20 offen offset:1024 lds
    s_add_u32 m0, s19, 35712
    s_nop 0
    buffer_load_dwordx4 v2, s[8:11], s20 offen offset:1152 lds
    s_add_u32 m0, s19, 39680
    s_nop 0
    buffer_load_dwordx4 v2, s[8:11], s20 offen offset:1280 lds
    s_add_u32 m0, s19, 43648
    s_nop 0
    buffer_load_dwordx4 v2, s[8:11], s20 offen offset:1408 lds
    s_add_u32 m0, s19, 47616
    s_nop 0
    buffer_load_dwordx4 v2, s[8:11], s20 offen offset:1536 lds
    s_add_u32 m0, s19, 51584
    s_nop 0
    buffer_load_dwordx4 v2, s[8:11], s20 offen offset:1664 lds
    s_add_u32 m0, s19, 55552
    s_nop 0
    buffer_load_dwordx4 v2, s[8:11], s20 offen offset:1792 lds
    s_add_u32 m0, s19, 59520
    s_nop 0
    buffer_load_dwordx4 v2, s[8:11], s20 offen offset:1920 lds
    s_add_u32 s20, s20, s24
    s_add_u32 m0, s19, 65536
    s_nop 0
    buffer_load_dwordx4 v2, s[8:11], s20 offen offset:0 lds
    s_add_u32 m0, s19, 69504
    s_nop 0
    buffer_load_dwordx4 v2, s[8:11], s20 offen offset:128 lds
    s_add_u32 m0, s19, 73472
    s_nop 0
    buffer_load_dwordx4 v2, s[8:11], s20 offen offset:256 lds
    v_mov_b32 v9, s23
    s_add_u32 s23, s23, 1
    buffer_store_dword v9, v4, s[4:7], 0 offen sc1
    s_mov_b32 s23, 0
    s_waitcnt vmcnt(12)
    s_barrier
    ds_read_b128 v[20:23], v10 offset:0
    ds_read_b128 v[24:27], v10 offset:2048
    ds_read_b128 v[28:31], v11 offset:0
    ds_read_b128 v[32:35], v11 offset:2048
    ds_read_b128 v[36:39], v10 offset:4096
    ds_read_b128 v[40:43], v10 offset:6144
    ds_read_b128 v[44:47], v11 offset:4096
.p2align 6
P_v_top:
    s_waitcnt lgkmcnt(6)
    v_mfma_f32_16x16x32_bf16 v[52:55], v[20:23], a[0:3], 0
    ds_read_b128 v[48:51], v11 offset:6144
    v_mfma_f32_16x16x32_bf16 v[60:63], v[20:23], a[4:7], 0
    s_waitcnt lgkmcnt(6)
    v_mfma_f32_16x16x32_bf16 v[56:59], v[24:27], a[0:3], 0
    ds_read_b128 v[20:23], v10 offset:8192
    s_add_u32 m0, s19, 77440
    v_mfma_f32_16x16x32_bf16 v[64:67], v[24:27], a[4:7], 0
    buffer_load_dwordx4 v2, s[8:11], s20 offen offset:384 lds
    s_waitcnt lgkmcnt(6)
    v_mfma_f32_16x16x32_bf16 v[52:55], v[28:31], a[8:11], v[52:55]
    ds_read_b128 v[24:27], v10 offset:10240
    v_mfma_f32_16x16x32_bf16 v[60:63], v[28:31], a[12:15], v[60:63]
    s_waitcnt lgkmcnt(6)
    v_mfma_f32_16x16x32_bf16 v[56:59], v[32:35], a[8:11], v[56:59]
    ds_read_b128 v[28:31], v11 offset:8192
    s_add_u32 m0, s19, 81408
    v_mfma_f32_16x16x32_bf16 v[64:67], v[32:35], a[12:15], v[64:67]
    buffer_load_dwordx4 v2, s[8:11], s20 offen offset:512 lds
    s_waitcnt lgkmcnt(6)
    v_mfma_f32_16x16x32_bf16 v[52:55], v[36:39], a[16:19], v[52:55]
    ds_read_b128 v[32:35], v11 offset:10240
    v_mfma_f32_16x16x32_bf16 v[60:63], v[36:39], a[20:23], v[60:63]
    s_waitcnt lgkmcnt(6)
    v_mfma_f32_16x16x32_bf16 v[56:59], v[40:43], a[16:19], v[56:59]
    ds_read_b128 v[36:39], v10 offset:12288
    s_add_u32 m0, s19, 85376
    v_mfma_f32_16x16x32_bf16 v[64:67], v[40:43], a[20:23], v[64:67]
    buffer_load_dwordx4 v2, s[8:11], s20 offen offset:640 lds
    s_waitcnt lgkmcnt(6)
    v_mfma_f32_16x16x32_bf16 v[52:55], v[44:47], a[24:27], v[52:55]
    ds_read_b128 v[40:43], v10 offset:14336
    v_mfma_f32_16x16x32_bf16 v[60:63], v[44:47], a[28:31], v[60:63]
    s_waitcnt lgkmcnt(6)
    v_mfma_f32_16x16x32_bf16 v[56:59], v[48:51], a[24:27], v[56:59]
    ds_read_b128 v[44:47], v11 offset:12288
    s_add_u32 m0, s19, 89344
    v_mfma_f32_16x16x32_bf16 v[64:67], v[48:51], a[28:31], v[64:67]
    buffer_load_dwordx4 v2, s[8:11], s20 offen offset:768 lds
    s_waitcnt lgkmcnt(6)
    v_mfma_f32_16x16x32_bf16 v[52:55], v[20:23], a[32:35], v[52:55]
    ds_read_b128 v[48:51], v11 offset:14336
    v_mfma_f32_16x16x32_bf16 v[60:63], v[20:23], a[36:39], v[60:63]
    s_waitcnt lgkmcnt(6)
    v_mfma_f32_16x16x32_bf16 v[56:59], v[24:27], a[32:35], v[56:59]
    ds_read_b128 v[20:23], v10 offset:16384
    s_add_u32 m0, s19, 93312
    v_mfma_f32_16x16x32_bf16 v[64:67], v[24:27], a[36:39], v[64:67]
    buffer_load_dwordx4 v2, s[8:11], s20 offen offset:896 lds
    s_waitcnt lgkmcnt(6)
    v_mfma_f32_16x16x32_bf16 v[52:55], v[28:31], a[40:43], v[52:55]
    ds_read_b128 v[24:27], v10 offset:18432
    v_mfma_f32_16x16x32_bf16 v[60:63], v[28:31], a[44:47], v[60:63]
    v_cvt_pk_bf16_f32 v84, v68, v69
    s_waitcnt lgkmcnt(6)
    v_mfma_f32_16x16x32_bf16 v[56:59], v[32:35], a[40:43], v[56:59]
    ds_read_b128 v[28:31], v11 offset:16384
    v_mfma_f32_16x16x32_bf16 v[64:67], v[32:35], a[44:47], v[64:67]
    v_cvt_pk_bf16_f32 v85, v70, v71
    s_waitcnt lgkmcnt(6)
    v_mfma_f32_16x16x32_bf16 v[52:55], v[36:39], a[48:51], v[52:55]
    ds_read_b128 v[32:35], v11 offset:18432
    v_mfma_f32_16x16x32_bf16 v[60:63], v[36:39], a[52:55], v[60:63]
    v_cvt_pk_bf16_f32 v86, v72, v73
    s_waitcnt lgkmcnt(6)
    v_mfma_f32_16x16x32_bf16 v[56:59], v[40:43], a[48:51], v[56:59]
    ds_read_b128 v[36:39], v10 offset:20480
    v_mfma_f32_16x16x32_bf16 v[64:67], v[40:43], a[52:55], v[64:67]
    v_cvt_pk_bf16_f32 v87, v74, v75
    s_waitcnt lgkmcnt(6)
    v_mfma_f32_16x16x32_bf16 v[52:55], v[44:47], a[56:59], v[52:55]
    ds_read_b128 v[40:43], v10 offset:22528
    v_mfma_f32_16x16x32_bf16 v[60:63], v[44:47], a[60:63], v[60:63]
    v_cvt_pk_bf16_f32 v88, v76, v77
    s_waitcnt lgkmcnt(6)
    v_mfma_f32_16x16x32_bf16 v[56:59], v[48:51], a[56:59], v[56:59]
    ds_read_b128 v[44:47], v11 offset:20480
    v_mfma_f32_16x16x32_bf16 v[64:67], v[48:51], a[60:63], v[64:67]
    v_cvt_pk_bf16_f32 v89, v78, v79
    buffer_store_dwordx4 v[84:87], v3, s[4:7], s21 offen offset:0 sc1
    s_waitcnt lgkmcnt(6)
    v_mfma_f32_16x16x32_bf16 v[52:55], v[20:23], a[64:67], v[52:55]
    ds_read_b128 v[48:51], v11 offset:22528
    v_mfma_f32_16x16x32_bf16 v[60:63], v[20:23], a[68:71], v[60:63]
    v_cvt_pk_bf16_f32 v90, v80, v81
    s_waitcnt lgkmcnt(6)
    v_mfma_f32_16x16x32_bf16 v[56:59], v[24:27], a[64:67], v[56:59]
    ds_read_b128 v[20:23], v10 offset:24576
    v_mfma_f32_16x16x32_bf16 v[64:67], v[24:27], a[68:71], v[64:67]
    v_cvt_pk_bf16_f32 v91, v82, v83
    s_waitcnt lgkmcnt(6)
    v_mfma_f32_16x16x32_bf16 v[52:55], v[28:31], a[72:75], v[52:55]
    ds_read_b128 v[24:27], v10 offset:26624
    v_mfma_f32_16x16x32_bf16 v[60:63], v[28:31], a[76:79], v[60:63]
    s_waitcnt lgkmcnt(6)
    v_mfma_f32_16x16x32_bf16 v[56:59], v[32:35], a[72:75], v[56:59]
    ds_read_b128 v[28:31], v11 offset:24576
    v_mfma_f32_16x16x32_bf16 v[64:67], v[32:35], a[76:79], v[64:67]
    buffer_store_dwordx4 v[88:91], v3, s[4:7], s21 offen offset:256 sc1
    s_waitcnt lgkmcnt(6)
    v_mfma_f32_16x16x32_bf16 v[52:55], v[36:39], a[80:83], v[52:55]
    ds_read_b128 v[32:35], v11 offset:26624
    v_mfma_f32_16x16x32_bf16 v[60:63], v[36:39], a[84:87], v[60:63]
    s_add_u32 s21, s21, s25
    s_mov_b32 s25, s26
    s_waitcnt lgkmcnt(6)
    v_mfma_f32_16x16x32_bf16 v[56:59], v[40:43], a[80:83], v[56:59]
    ds_read_b128 v[36:39], v10 offset:28672
    v_mfma_f32_16x16x32_bf16 v[64:67], v[40:43], a[84:87], v[64:67]
    s_waitcnt lgkmcnt(6)
    v_mfma_f32_16x16x32_bf16 v[52:55], v[44:47], a[88:91], v[52:55]
    ds_read_b128 v[40:43], v10 offset:30720
    v_mfma_f32_16x16x32_bf16 v[60:63], v[44:47], a[92:95], v[60:63]
    s_waitcnt lgkmcnt(6)
    v_mfma_f32_16x16x32_bf16 v[56:59], v[48:51], a[88:91], v[56:59]
    ds_read_b128 v[44:47], v11 offset:28672
    v_mfma_f32_16x16x32_bf16 v[64:67], v[48:51], a[92:95], v[64:67]
    s_waitcnt lgkmcnt(6)
    v_mfma_f32_16x16x32_bf16 v[52:55], v[20:23], a[96:99], v[52:55]
    ds_read_b128 v[48:51], v11 offset:30720
    v_mfma_f32_16x16x32_bf16 v[60:63], v[20:23], a[100:103], v[60:63]
    s_waitcnt lgkmcnt(6)
    v_mfma_f32_16x16x32_bf16 v[56:59], v[24:27], a[96:99], v[56:59]
    s_waitcnt vmcnt(11)
    s_barrier
    ds_read_b128 v[20:23], v10 offset:32768
    v_mfma_f32_16x16x32_bf16 v[64:67], v[24:27], a[100:103], v[64:67]
    s_waitcnt lgkmcnt(6)
    v_mfma_f32_16x16x32_bf16 v[52:55], v[28:31], a[104:107], v[52:55]
    ds_read_b128 v[24:27], v10 offset:34816
    s_add_u32 m0, s19, 97280
    v_mfma_f32_16x16x32_bf16 v[60:63], v[28:31], a[108:111], v[60:63]
    buffer_load_dwordx4 v2, s[8:11], s20 offen offset:1024 lds
    s_waitcnt lgkmcnt(6)
    v_mfma_f32_16x16x32_bf16 v[56:59], v[32:35], a[104:107], v[56:59]
    ds_read_b128 v[28:31], v11 offset:32768
    v_mfma_f32_16x16x32_bf16 v[64:67], v[32:35], a[108:111], v[64:67]
    s_waitcnt lgkmcnt(6)
    v_mfma_f32_16x16x32_bf16 v[52:55], v[36:39], a[112:115], v[52:55]
    ds_read_b128 v[32:35], v11 offset:34816
    s_add_u32 m0, s19, 101248
    v_mfma_f32_16x16x32_bf16 v[60:63], v[36:39], a[116:119], v[60:63]
    buffer_load_dwordx4 v2, s[8:11], s20 offen offset:1152 lds
    s_waitcnt lgkmcnt(6)
    v_mfma_f32_16x16x32_bf16 v[56:59], v[40:43], a[112:115], v[56:59]
    ds_read_b128 v[36:39], v10 offset:36864
    v_mfma_f32_16x16x32_bf16 v[64:67], v[40:43], a[116:119], v[64:67]
    s_waitcnt lgkmcnt(6)
    v_mfma_f32_16x16x32_bf16 v[52:55], v[44:47], a[120:123], v[52:55]
    ds_read_b128 v[40:43], v10 offset:38912
    s_add_u32 m0, s19, 105216
    v_mfma_f32_16x16x32_bf16 v[60:63], v[44:47], a[124:127], v[60:63]
    buffer_load_dwordx4 v2, s[8:11], s20 offen offset:1280 lds
    s_waitcnt lgkmcnt(6)
    v_mfma_f32_16x16x32_bf16 v[56:59], v[48:51], a[120:123], v[56:59]
    ds_read_b128 v[44:47], v11 offset:36864
    v_mfma_f32_16x16x32_bf16 v[64:67], v[48:51], a[124:127], v[64:67]
    s_waitcnt lgkmcnt(6)
    v_mfma_f32_16x16x32_bf16 v[52:55], v[20:23], a[128:131], v[52:55]
    ds_read_b128 v[48:51], v11 offset:38912
    v_mfma_f32_16x16x32_bf16 v[60:63], v[20:23], a[132:135], v[60:63]
    s_waitcnt lgkmcnt(6)
    v_mfma_f32_16x16x32_bf16 v[56:59], v[24:27], a[128:131], v[56:59]
    ds_read_b128 v[20:23], v10 offset:40960
    s_add_u32 m0, s19, 109184
    v_mfma_f32_16x16x32_bf16 v[64:67], v[24:27], a[132:135], v[64:67]
    buffer_load_dwordx4 v2, s[8:11], s20 offen offset:1408 lds
    s_waitcnt lgkmcnt(6)
    v_mfma_f32_16x16x32_bf16 v[52:55], v[28:31], a[136:139], v[52:55]
    ds_read_b128 v[24:27], v10 offset:43008
    v_mfma_f32_16x16x32_bf16 v[60:63], v[28:31], a[140:143], v[60:63]
    s_waitcnt lgkmcnt(6)
    v_mfma_f32_16x16x32_bf16 v[56:59], v[32:35], a[136:139], v[56:59]
    ds_read_b128 v[28:31], v11 offset:40960
    s_add_u32 m0, s19, 113152
    v_mfma_f32_16x16x32_bf16 v[64:67], v[32:35], a[140:143], v[64:67]
    buffer_load_dwordx4 v2, s[8:11], s20 offen offset:1536 lds
    s_waitcnt lgkmcnt(6)
    v_mfma_f32_16x16x32_bf16 v[52:55], v[36:39], a[144:147], v[52:55]
    ds_read_b128 v[32:35], v11 offset:43008
    v_mfma_f32_16x16x32_bf16 v[60:63], v[36:39], a[148:151], v[60:63]
    s_waitcnt lgkmcnt(6)
    v_mfma_f32_16x16x32_bf16 v[56:59], v[40:43], a[144:147], v[56:59]
    ds_read_b128 v[36:39], v10 offset:45056
    s_add_u32 m0, s19, 117120
    v_mfma_f32_16x16x32_bf16 v[64:67], v[40:43], a[148:151], v[64:67]
    buffer_load_dwordx4 v2, s[8:11], s20 offen offset:1664 lds
    s_waitcnt lgkmcnt(6)
    v_mfma_f32_16x16x32_bf16 v[52:55], v[44:47], a[152:155], v[52:55]
    ds_read_b128 v[40:43], v10 offset:47104
    v_mfma_f32_16x16x32_bf16 v[60:63], v[44:47], a[156:159], v[60:63]
    s_waitcnt lgkmcnt(6)
    v_mfma_f32_16x16x32_bf16 v[56:59], v[48:51], a[152:155], v[56:59]
    ds_read_b128 v[44:47], v11 offset:45056
    s_add_u32 m0, s19, 121088
    v_mfma_f32_16x16x32_bf16 v[64:67], v[48:51], a[156:159], v[64:67]
    buffer_load_dwordx4 v2, s[8:11], s20 offen offset:1792 lds
    s_waitcnt lgkmcnt(6)
    v_mfma_f32_16x16x32_bf16 v[52:55], v[20:23], a[160:163], v[52:55]
    ds_read_b128 v[48:51], v11 offset:47104
    v_mfma_f32_16x16x32_bf16 v[60:63], v[20:23], a[164:167], v[60:63]
    s_waitcnt lgkmcnt(6)
    v_mfma_f32_16x16x32_bf16 v[56:59], v[24:27], a[160:163], v[56:59]
    ds_read_b128 v[20:23], v10 offset:49152
    s_add_u32 m0, s19, 125056
    v_mfma_f32_16x16x32_bf16 v[64:67], v[24:27], a[164:167], v[64:67]
    buffer_load_dwordx4 v2, s[8:11], s20 offen offset:1920 lds
    s_waitcnt lgkmcnt(6)
    v_mfma_f32_16x16x32_bf16 v[52:55], v[28:31], a[168:171], v[52:55]
    ds_read_b128 v[24:27], v10 offset:51200
    v_mfma_f32_16x16x32_bf16 v[60:63], v[28:31], a[172:175], v[60:63]
    s_add_u32 s20, s20, s24
    s_waitcnt lgkmcnt(6)
    v_mfma_f32_16x16x32_bf16 v[56:59], v[32:35], a[168:171], v[56:59]
    ds_read_b128 v[28:31], v11 offset:49152
    v_mfma_f32_16x16x32_bf16 v[64:67], v[32:35], a[172:175], v[64:67]
    s_waitcnt lgkmcnt(6)
    v_mfma_f32_16x16x32_bf16 v[52:55], v[36:39], a[176:179], v[52:55]
    ds_read_b128 v[32:35], v11 offset:51200
    v_mfma_f32_16x16x32_bf16 v[60:63], v[36:39], a[180:183], v[60:63]
    s_waitcnt lgkmcnt(6)
    v_mfma_f32_16x16x32_bf16 v[56:59], v[40:43], a[176:179], v[56:59]
    ds_read_b128 v[36:39], v10 offset:53248
    v_mfma_f32_16x16x32_bf16 v[64:67], v[40:43], a[180:183], v[64:67]
    s_waitcnt lgkmcnt(6)
    v_mfma_f32_16x16x32_bf16 v[52:55], v[44:47], a[184:187], v[52:55]
    ds_read_b128 v[40:43], v10 offset:55296
    v_mfma_f32_16x16x32_bf16 v[60:63], v[44:47], a[188:191], v[60:63]
    s_waitcnt lgkmcnt(6)
    v_mfma_f32_16x16x32_bf16 v[56:59], v[48:51], a[184:187], v[56:59]
    ds_read_b128 v[44:47], v11 offset:53248
    v_mfma_f32_16x16x32_bf16 v[64:67], v[48:51], a[188:191], v[64:67]
    s_waitcnt lgkmcnt(6)
    v_mfma_f32_16x16x32_bf16 v[52:55], v[20:23], a[192:195], v[52:55]
    ds_read_b128 v[48:51], v11 offset:55296
    v_mfma_f32_16x16x32_bf16 v[60:63], v[20:23], a[196:199], v[60:63]
    s_waitcnt lgkmcnt(6)
    v_mfma_f32_16x16x32_bf16 v[56:59], v[24:27], a[192:195], v[56:59]
    ds_read_b128 v[20:23], v10 offset:57344
    v_mfma_f32_16x16x32_bf16 v[64:67], v[24:27], a[196:199], v[64:67]
    s_waitcnt lgkmcnt(6)
    v_mfma_f32_16x16x32_bf16 v[52:55], v[28:31], a[200:203], v[52:55]
    ds_read_b128 v[24:27], v10 offset:59392
    v_mfma_f32_16x16x32_bf16 v[60:63], v[28:31], a[204:207], v[60:63]
    s_waitcnt lgkmcnt(6)
    v_mfma_f32_16x16x32_bf16 v[56:59], v[32:35], a[200:203], v[56:59]
    ds_read_b128 v[28:31], v11 offset:57344
    v_mfma_f32_16x16x32_bf16 v[64:67], v[32:35], a[204:207], v[64:67]
    s_waitcnt lgkmcnt(6)
    v_mfma_f32_16x16x32_bf16 v[52:55], v[36:39], a[208:211], v[52:55]
    ds_read_b128 v[32:35], v11 offset:59392
    v_mfma_f32_16x16x32_bf16 v[60:63], v[36:39], a[212:215], v[60:63]
    s_waitcnt lgkmcnt(6)
    v_mfma_f32_16x16x32_bf16 v[56:59], v[40:43], a[208:211], v[56:59]
    ds_read_b128 v[36:39], v10 offset:61440
    v_mfma_f32_16x16x32_bf16 v[64:67], v[40:43], a[212:215], v[64:67]
    s_waitcnt lgkmcnt(6)
    v_mfma_f32_16x16x32_bf16 v[52:55], v[44:47], a[216:219], v[52:55]
    ds_read_b128 v[40:43], v10 offset:63488
    v_mfma_f32_16x16x32_bf16 v[60:63], v[44:47], a[220:223], v[60:63]
    s_waitcnt lgkmcnt(6)
    v_mfma_f32_16x16x32_bf16 v[56:59], v[48:51], a[216:219], v[56:59]
    ds_read_b128 v[44:47], v11 offset:61440
    v_mfma_f32_16x16x32_bf16 v[64:67], v[48:51], a[220:223], v[64:67]
    s_waitcnt lgkmcnt(6)
    v_mfma_f32_16x16x32_bf16 v[52:55], v[20:23], a[224:227], v[52:55]
    ds_read_b128 v[48:51], v11 offset:63488
    v_mfma_f32_16x16x32_bf16 v[60:63], v[20:23], a[228:231], v[60:63]
    s_waitcnt lgkmcnt(6)
    v_mfma_f32_16x16x32_bf16 v[56:59], v[24:27], a[224:227], v[56:59]
    s_waitcnt vmcnt(8)
    s_barrier
    ds_read_b128 v[20:23], v12 offset:0
    v_mfma_f32_16x16x32_bf16 v[64:67], v[24:27], a[228:231], v[64:67]
    s_waitcnt lgkmcnt(6)
    v_mfma_f32_16x16x32_bf16 v[52:55], v[28:31], a[232:235], v[52:55]
    ds_read_b128 v[24:27], v12 offset:2048
    s_add_u32 m0, s19, 0
    v_mfma_f32_16x16x32_bf16 v[60:63], v[28:31], a[236:239], v[60:63]
    buffer_load_dwordx4 v2, s[8:11], s20 offen offset:0 lds
    s_waitcnt lgkmcnt(6)
    v_mfma_f32_16x16x32_bf16 v[56:59], v[32:35], a[232:235], v[56:59]
    ds_read_b128 v[28:31], v13 offset:0
    v_mfma_f32_16x16x32_bf16 v[64:67], v[32:35], a[236:239], v[64:67]
    v_mov_b32 v9, s23
    s_add_u32 s23, s23, 1
    buffer_store_dword v9, v4, s[4:7], 0 offen sc1
    s_waitcnt lgkmcnt(6)
    v_mfma_f32_16x16x32_bf16 v[52:55], v[36:39], a[240:243], v[52:55]
    ds_read_b128 v[32:35], v13 offset:2048
    s_add_u32 m0, s19, 3968
    v_mfma_f32_16x16x32_bf16 v[60:63], v[36:39], a[244:247], v[60:63]
    buffer_load_dwordx4 v2, s[8:11], s20 offen offset:128 lds
    s_waitcnt lgkmcnt(6)
    v_mfma_f32_16x16x32_bf16 v[56:59], v[40:43], a[240:243], v[56:59]
    ds_read_b128 v[36:39], v12 offset:4096
    v_mfma_f32_16x16x32_bf16 v[64:67], v[40:43], a[244:247], v[64:67]
    s_waitcnt lgkmcnt(6)
    v_mfma_f32_16x16x32_bf16 v[52:55], v[44:47], a[248:251], v[52:55]
    ds_read_b128 v[40:43], v12 offset:6144
    s_add_u32 m0, s19, 7936
    v_mfma_f32_16x16x32_bf16 v[60:63], v[44:47], a[252:255], v[60:63]
    buffer_load_dwordx4 v2, s[8:11], s20 offen offset:256 lds
    s_waitcnt lgkmcnt(6)
    v_mfma_f32_16x16x32_bf16 v[56:59], v[48:51], a[248:251], v[56:59]
    ds_read_b128 v[44:47], v13 offset:4096
    v_mfma_f32_16x16x32_bf16 v[64:67], v[48:51], a[252:255], v[64:67]
    s_waitcnt lgkmcnt(6)
    v_mfma_f32_16x16x32_bf16 v[68:71], v[20:23], a[0:3], 0
    ds_read_b128 v[48:51], v13 offset:6144
    v_mfma_f32_16x16x32_bf16 v[76:79], v[20:23], a[4:7], 0
    s_waitcnt lgkmcnt(6)
    v_mfma_f32_16x16x32_bf16 v[72:75], v[24:27], a[0:3], 0
    ds_read_b128 v[20:23], v12 offset:8192
    s_add_u32 m0, s19, 11904
    v_mfma_f32_16x16x32_bf16 v[80:83], v[24:27], a[4:7], 0
    buffer_load_dwordx4 v2, s[8:11], s20 offen offset:384 lds
    s_waitcnt lgkmcnt(6)
    v_mfma_f32_16x16x32_bf16 v[68:71], v[28:31], a[8:11], v[68:71]
    ds_read_b128 v[24:27], v12 offset:10240
    v_mfma_f32_16x16x32_bf16 v[76:79], v[28:31], a[12:15], v[76:79]
    s_waitcnt lgkmcnt(6)
    v_mfma_f32_16x16x32_bf16 v[72:75], v[32:35], a[8:11], v[72:75]
    ds_read_b128 v[28:31], v13 offset:8192
    s_add_u32 m0, s19, 15872
    v_mfma_f32_16x16x32_bf16 v[80:83], v[32:35], a[12:15], v[80:83]
    buffer_load_dwordx4 v2, s[8:11], s20 offen offset:512 lds
    s_waitcnt lgkmcnt(6)
    v_mfma_f32_16x16x32_bf16 v[68:71], v[36:39], a[16:19], v[68:71]
    ds_read_b128 v[32:35], v13 offset:10240
    v_mfma_f32_16x16x32_bf16 v[76:79], v[36:39], a[20:23], v[76:79]
    s_waitcnt lgkmcnt(6)
    v_mfma_f32_16x16x32_bf16 v[72:75], v[40:43], a[16:19], v[72:75]
    ds_read_b128 v[36:39], v12 offset:12288
    s_add_u32 m0, s19, 19840
    v_mfma_f32_16x16x32_bf16 v[80:83], v[40:43], a[20:23], v[80:83]
    buffer_load_dwordx4 v2, s[8:11], s20 offen offset:640 lds
    s_waitcnt lgkmcnt(6)
    v_mfma_f32_16x16x32_bf16 v[68:71], v[44:47], a[24:27], v[68:71]
    ds_read_b128 v[40:43], v12 offset:14336
    v_mfma_f32_16x16x32_bf16 v[76:79], v[44:47], a[28:31], v[76:79]
    s_waitcnt lgkmcnt(6)
    v_mfma_f32_16x16x32_bf16 v[72:75], v[48:51], a[24:27], v[72:75]
    ds_read_b128 v[44:47], v13 offset:12288
    s_add_u32 m0, s19, 23808
    v_mfma_f32_16x16x32_bf16 v[80:83], v[48:51], a[28:31], v[80:83]
    buffer_load_dwordx4 v2, s[8:11], s20 offen offset:768 lds
    s_waitcnt lgkmcnt(6)
    v_mfma_f32_16x16x32_bf16 v[68:71], v[20:23], a[32:35], v[68:71]
    ds_read_b128 v[48:51], v13 offset:14336
    v_mfma_f32_16x16x32_bf16 v[76:79], v[20:23], a[36:39], v[76:79]
    s_waitcnt lgkmcnt(6)
    v_mfma_f32_16x16x32_bf16 v[72:75], v[24:27], a[32:35], v[72:75]
    ds_read_b128 v[20:23], v12 offset:16384
    s_add_u32 m0, s19, 27776
    v_mfma_f32_16x16x32_bf16 v[80:83], v[24:27], a[36:39], v[80:83]
    buffer_load_dwordx4 v2, s[8:11], s20 offen offset:896 lds
    s_waitcnt lgkmcnt(6)
    v_mfma_f32_16x16x32_bf16 v[68:71], v[28:31], a[40:43], v[68:71]
    ds_read_b128 v[24:27], v12 offset:18432
    v_mfma_f32_16x16x32_bf16 v[76:79], v[28:31], a[44:47], v[76:79]
    v_cvt_pk_bf16_f32 v84, v52, v53
    s_waitcnt lgkmcnt(6)
    v_mfma_f32_16x16x32_bf16 v[72:75], v[32:35], a[40:43], v[72:75]
    ds_read_b128 v[28:31], v13 offset:16384
    v_mfma_f32_16x16x32_bf16 v[80:83], v[32:35], a[44:47], v[80:83]
    v_cvt_pk_bf16_f32 v85, v54, v55
    s_waitcnt lgkmcnt(6)
    v_mfma_f32_16x16x32_bf16 v[68:71], v[36:39], a[48:51], v[68:71]
    ds_read_b128 v[32:35], v13 offset:18432
    v_mfma_f32_16x16x32_bf16 v[76:79], v[36:39], a[52:55], v[76:79]
    v_cvt_pk_bf16_f32 v86, v56, v57
    s_waitcnt lgkmcnt(6)
    v_mfma_f32_16x16x32_bf16 v[72:75], v[40:43], a[48:51], v[72:75]
    ds_read_b128 v[36:39], v12 offset:20480
    v_mfma_f32_16x16x32_bf16 v[80:83], v[40:43], a[52:55], v[80:83]
    v_cvt_pk_bf16_f32 v87, v58, v59
    s_waitcnt lgkmcnt(6)
    v_mfma_f32_16x16x32_bf16 v[68:71], v[44:47], a[56:59], v[68:71]
    ds_read_b128 v[40:43], v12 offset:22528
    v_mfma_f32_16x16x32_bf16 v[76:79], v[44:47], a[60:63], v[76:79]
    v_cvt_pk_bf16_f32 v88, v60, v61
    s_waitcnt lgkmcnt(6)
    v_mfma_f32_16x16x32_bf16 v[72:75], v[48:51], a[56:59], v[72:75]
    ds_read_b128 v[44:47], v13 offset:20480
    v_mfma_f32_16x16x32_bf16 v[80:83], v[48:51], a[60:63], v[80:83]
    v_cvt_pk_bf16_f32 v89, v62, v63
    buffer_store_dwordx4 v[84:87], v3, s[4:7], s21 offen offset:0 sc1
    s_waitcnt lgkmcnt(6)
    v_mfma_f32_16x16x32_bf16 v[68:71], v[20:23], a[64:67], v[68:71]
    ds_read_b128 v[48:51], v13 offset:22528
    v_mfma_f32_16x16x32_bf16 v[76:79], v[20:23], a[68:71], v[76:79]
    v_cvt_pk_bf16_f32 v90, v64, v65
    s_waitcnt lgkmcnt(6)
    v_mfma_f32_16x16x32_bf16 v[72:75], v[24:27], a[64:67], v[72:75]
    ds_read_b128 v[20:23], v12 offset:24576
    v_mfma_f32_16x16x32_bf16 v[80:83], v[24:27], a[68:71], v[80:83]
    v_cvt_pk_bf16_f32 v91, v66, v67
    s_waitcnt lgkmcnt(6)
    v_mfma_f32_16x16x32_bf16 v[68:71], v[28:31], a[72:75], v[68:71]
    ds_read_b128 v[24:27], v12 offset:26624
    v_mfma_f32_16x16x32_bf16 v[76:79], v[28:31], a[76:79], v[76:79]
    s_waitcnt lgkmcnt(6)
    v_mfma_f32_16x16x32_bf16 v[72:75], v[32:35], a[72:75], v[72:75]
    ds_read_b128 v[28:31], v13 offset:24576
    v_mfma_f32_16x16x32_bf16 v[80:83], v[32:35], a[76:79], v[80:83]
    buffer_store_dwordx4 v[88:91], v3, s[4:7], s21 offen offset:256 sc1
    s_waitcnt lgkmcnt(6)
    v_mfma_f32_16x16x32_bf16 v[68:71], v[36:39], a[80:83], v[68:71]
    ds_read_b128 v[32:35], v13 offset:26624
    v_mfma_f32_16x16x32_bf16 v[76:79], v[36:39], a[84:87], v[76:79]
    s_add_u32 s21, s21, s25
    s_mov_b32 s25, s26
    s_waitcnt lgkmcnt(6)
    v_mfma_f32_16x16x32_bf16 v[72:75], v[40:43], a[80:83], v[72:75]
    ds_read_b128 v[36:39], v12 offset:28672
    v_mfma_f32_16x16x32_bf16 v[80:83], v[40:43], a[84:87], v[80:83]
    s_waitcnt lgkmcnt(6)
    v_mfma_f32_16x16x32_bf16 v[68:71], v[44:47], a[88:91], v[68:71]
    ds_read_b128 v[40:43], v12 offset:30720
    v_mfma_f32_16x16x32_bf16 v[76:79], v[44:47], a[92:95], v[76:79]
    s_waitcnt lgkmcnt(6)
    v_mfma_f32_16x16x32_bf16 v[72:75], v[48:51], a[88:91], v[72:75]
    ds_read_b128 v[44:47], v13 offset:28672
    v_mfma_f32_16x16x32_bf16 v[80:83], v[48:51], a[92:95], v[80:83]
    s_waitcnt lgkmcnt(6)
    v_mfma_f32_16x16x32_bf16 v[68:71], v[20:23], a[96:99], v[68:71]
    ds_read_b128 v[48:51], v13 offset:30720
    v_mfma_f32_16x16x32_bf16 v[76:79], v[20:23], a[100:103], v[76:79]
    s_waitcnt lgkmcnt(6)
    v_mfma_f32_16x16x32_bf16 v[72:75], v[24:27], a[96:99], v[72:75]
    s_waitcnt vmcnt(11)
    s_barrier
    ds_read_b128 v[20:23], v12 offset:32768
    v_mfma_f32_16x16x32_bf16 v[80:83], v[24:27], a[100:103], v[80:83]
    s_waitcnt lgkmcnt(6)
    v_mfma_f32_16x16x32_bf16 v[68:71], v[28:31], a[104:107], v[68:71]
    ds_read_b128 v[24:27], v12 offset:34816
    s_add_u32 m0, s19, 31744
    v_mfma_f32_16x16x32_bf16 v[76:79], v[28:31], a[108:111], v[76:79]
    buffer_load_dwordx4 v2, s[8:11], s20 offen offset:1024 lds
    s_waitcnt lgkmcnt(6)
    v_mfma_f32_16x16x32_bf16 v[72:75], v[32:35], a[104:107], v[72:75]
    ds_read_b128 v[28:31], v13 offset:32768
    v_mfma_f32_16x16x32_bf16 v[80:83], v[32:35], a[108:111], v[80:83]
    s_waitcnt lgkmcnt(6)
    v_mfma_f32_16x16x32_bf16 v[68:71], v[36:39], a[112:115], v[68:71]
    ds_read_b128 v[32:35], v13 offset:34816
    s_add_u32 m0, s19, 35712
    v_mfma_f32_16x16x32_bf16 v[76:79], v[36:39], a[116:119], v[76:79]
    buffer_load_dwordx4 v2, s[8:11], s20 offen offset:1152 lds
    s_waitcnt lgkmcnt(6)
    v_mfma_f32_16x16x32_bf16 v[72:75], v[40:43], a[112:115], v[72:75]
    ds_read_b128 v[36:39], v12 offset:36864
    v_mfma_f32_16x16x32_bf16 v[80:83], v[40:43], a[116:119], v[80:83]
    s_waitcnt lgkmcnt(6)
    v_mfma_f32_16x16x32_bf16 v[68:71], v[44:47], a[120:123], v[68:71]
    ds_read_b128 v[40:43], v12 offset:38912
    s_add_u32 m0, s19, 39680
    v_mfma_f32_16x16x32_bf16 v[76:79], v[44:47], a[124:127], v[76:79]
    buffer_load_dwordx4 v2, s[8:11], s20 offen offset:1280 lds
    s_waitcnt lgkmcnt(6)
    v_mfma_f32_16x16x32_bf16 v[72:75], v[48:51], a[120:123], v[72:75]
    ds_read_b128 v[44:47], v13 offset:36864
    v_mfma_f32_16x16x32_bf16 v[80:83], v[48:51], a[124:127], v[80:83]
    s_waitcnt lgkmcnt(6)
    v_mfma_f32_16x16x32_bf16 v[68:71], v[20:23], a[128:131], v[68:71]
    ds_read_b128 v[48:51], v13 offset:38912
    v_mfma_f32_16x16x32_bf16 v[76:79], v[20:23], a[132:135], v[76:79]
    s_waitcnt lgkmcnt(6)
    v_mfma_f32_16x16x32_bf16 v[72:75], v[24:27], a[128:131], v[72:75]
    ds_read_b128 v[20:23], v12 offset:40960
    s_add_u32 m0, s19, 43648
    v_mfma_f32_16x16x32_bf16 v[80:83], v[24:27], a[132:135], v[80:83]
    buffer_load_dwordx4 v2, s[8:11], s20 offen offset:1408 lds
    s_waitcnt lgkmcnt(6)
    v_mfma_f32_16x16x32_bf16 v[68:71], v[28:31], a[136:139], v[68:71]
    ds_read_b128 v[24:27], v12 offset:43008
    v_mfma_f32_16x16x32_bf16 v[76:79], v[28:31], a[140:143], v[76:79]
    s_waitcnt lgkmcnt(6)
    v_mfma_f32_16x16x32_bf16 v[72:75], v[32:35], a[136:139], v[72:75]
    ds_read_b128 v[28:31], v13 offset:40960
    s_add_u32 m0, s19, 47616
    v_mfma_f32_16x16x32_bf16 v[80:83], v[32:35], a[140:143], v[80:83]
    buffer_load_dwordx4 v2, s[8:11], s20 offen offset:1536 lds
    s_waitcnt lgkmcnt(6)
    v_mfma_f32_16x16x32_bf16 v[68:71], v[36:39], a[144:147], v[68:71]
    ds_read_b128 v[32:35], v13 offset:43008
    v_mfma_f32_16x16x32_bf16 v[76:79], v[36:39], a[148:151], v[76:79]
    s_waitcnt lgkmcnt(6)
    v_mfma_f32_16x16x32_bf16 v[72:75], v[40:43], a[144:147], v[72:75]
    ds_read_b128 v[36:39], v12 offset:45056
    s_add_u32 m0, s19, 51584
    v_mfma_f32_16x16x32_bf16 v[80:83], v[40:43], a[148:151], v[80:83]
    buffer_load_dwordx4 v2, s[8:11], s20 offen offset:1664 lds
    s_waitcnt lgkmcnt(6)
    v_mfma_f32_16x16x32_bf16 v[68:71], v[44:47], a[152:155], v[68:71]
    ds_read_b128 v[40:43], v12 offset:47104
    v_mfma_f32_16x16x32_bf16 v[76:79], v[44:47], a[156:159], v[76:79]
    s_waitcnt lgkmcnt(6)
    v_mfma_f32_16x16x32_bf16 v[72:75], v[48:51], a[152:155], v[72:75]
    ds_read_b128 v[44:47], v13 offset:45056
    s_add_u32 m0, s19, 55552
    v_mfma_f32_16x16x32_bf16 v[80:83], v[48:51], a[156:159], v[80:83]
    buffer_load_dwordx4 v2, s[8:11], s20 offen offset:1792 lds
    s_waitcnt lgkmcnt(6)
    v_mfma_f32_16x16x32_bf16 v[68:71], v[20:23], a[160:163], v[68:71]
    ds_read_b128 v[48:51], v13 offset:47104
    v_mfma_f32_16x16x32_bf16 v[76:79], v[20:23], a[164:167], v[76:79]
    s_waitcnt lgkmcnt(6)
    v_mfma_f32_16x16x32_bf16 v[72:75], v[24:27], a[160:163], v[72:75]
    ds_read_b128 v[20:23], v12 offset:49152
    s_add_u32 m0, s19, 59520
    v_mfma_f32_16x16x32_bf16 v[80:83], v[24:27], a[164:167], v[80:83]
    buffer_load_dwordx4 v2, s[8:11], s20 offen offset:1920 lds
    s_waitcnt lgkmcnt(6)
    v_mfma_f32_16x16x32_bf16 v[68:71], v[28:31], a[168:171], v[68:71]
    ds_read_b128 v[24:27], v12 offset:51200
    v_mfma_f32_16x16x32_bf16 v[76:79], v[28:31], a[172:175], v[76:79]
    s_add_u32 s20, s20, s24
    s_waitcnt lgkmcnt(6)
    v_mfma_f32_16x16x32_bf16 v[72:75], v[32:35], a[168:171], v[72:75]
    ds_read_b128 v[28:31], v13 offset:49152
    v_mfma_f32_16x16x32_bf16 v[80:83], v[32:35], a[172:175], v[80:83]
    s_waitcnt lgkmcnt(6)
    v_mfma_f32_16x16x32_bf16 v[68:71], v[36:39], a[176:179], v[68:71]
    ds_read_b128 v[32:35], v13 offset:51200
    v_mfma_f32_16x16x32_bf16 v[76:79], v[36:39], a[180:183], v[76:79]
    s_waitcnt lgkmcnt(6)
    v_mfma_f32_16x16x32_bf16 v[72:75], v[40:43], a[176:179], v[72:75]
    ds_read_b128 v[36:39], v12 offset:53248
    v_mfma_f32_16x16x32_bf16 v[80:83], v[40:43], a[180:183], v[80:83]
    s_waitcnt lgkmcnt(6)
    v_mfma_f32_16x16x32_bf16 v[68:71], v[44:47], a[184:187], v[68:71]
    ds_read_b128 v[40:43], v12 offset:55296
    v_mfma_f32_16x16x32_bf16 v[76:79], v[44:47], a[188:191], v[76:79]
    s_waitcnt lgkmcnt(6)
    v_mfma_f32_16x16x32_bf16 v[72:75], v[48:51], a[184:187], v[72:75]
    ds_read_b128 v[44:47], v13 offset:53248
    v_mfma_f32_16x16x32_bf16 v[80:83], v[48:51], a[188:191], v[80:83]
    s_waitcnt lgkmcnt(6)
    v_mfma_f32_16x16x32_bf16 v[68:71], v[20:23], a[192:195], v[68:71]
    ds_read_b128 v[48:51], v13 offset:55296
    v_mfma_f32_16x16x32_bf16 v[76:79], v[20:23], a[196:199], v[76:79]
    s_waitcnt lgkmcnt(6)
    v_mfma_f32_16x16x32_bf16 v[72:75], v[24:27], a[192:195], v[72:75]
    ds_read_b128 v[20:23], v12 offset:57344
    v_mfma_f32_16x16x32_bf16 v[80:83], v[24:27], a[196:199], v[80:83]
    s_waitcnt lgkmcnt(6)
    v_mfma_f32_16x16x32_bf16 v[68:71], v[28:31], a[200:203], v[68:71]
    ds_read_b128 v[24:27], v12 offset:59392
    v_mfma_f32_16x16x32_bf16 v[76:79], v[28:31], a[204:207], v[76:79]
    s_waitcnt lgkmcnt(6)
    v_mfma_f32_16x16x32_bf16 v[72:75], v[32:35], a[200:203], v[72:75]
    ds_read_b128 v[28:31], v13 offset:57344
    v_mfma_f32_16x16x32_bf16 v[80:83], v[32:35], a[204:207], v[80:83]
    s_waitcnt lgkmcnt(6)
    v_mfma_f32_16x16x32_bf16 v[68:71], v[36:39], a[208:211], v[68:71]
    ds_read_b128 v[32:35], v13 offset:59392
    v_mfma_f32_16x16x32_bf16 v[76:79], v[36:39], a[212:215], v[76:79]
    s_waitcnt lgkmcnt(6)
    v_mfma_f32_16x16x32_bf16 v[72:75], v[40:43], a[208:211], v[72:75]
    ds_read_b128 v[36:39], v12 offset:61440
    v_mfma_f32_16x16x32_bf16 v[80:83], v[40:43], a[212:215], v[80:83]
    s_waitcnt lgkmcnt(6)
    v_mfma_f32_16x16x32_bf16 v[68:71], v[44:47], a[216:219], v[68:71]
    ds_read_b128 v[40:43], v12 offset:63488
    v_mfma_f32_16x16x32_bf16 v[76:79], v[44:47], a[220:223], v[76:79]
    s_waitcnt lgkmcnt(6)
    v_mfma_f32_16x16x32_bf16 v[72:75], v[48:51], a[216:219], v[72:75]
    ds_read_b128 v[44:47], v13 offset:61440
    v_mfma_f32_16x16x32_bf16 v[80:83], v[48:51], a[220:223], v[80:83]
    s_waitcnt lgkmcnt(6)
    v_mfma_f32_16x16x32_bf16 v[68:71], v[20:23], a[224:227], v[68:71]
    ds_read_b128 v[48:51], v13 offset:63488
    v_mfma_f32_16x16x32_bf16 v[76:79], v[20:23], a[228:231], v[76:79]
    s_waitcnt lgkmcnt(6)
    v_mfma_f32_16x16x32_bf16 v[72:75], v[24:27], a[224:227], v[72:75]
    s_waitcnt vmcnt(8)
    s_barrier
    ds_read_b128 v[20:23], v10 offset:0
    v_mfma_f32_16x16x32_bf16 v[80:83], v[24:27], a[228:231], v[80:83]
    s_waitcnt lgkmcnt(6)
    v_mfma_f32_16x16x32_bf16 v[68:71], v[28:31], a[232:235], v[68:71]
    ds_read_b128 v[24:27], v10 offset:2048
    s_add_u32 m0, s19, 65536
    v_mfma_f32_16x16x32_bf16 v[76:79], v[28:31], a[236:239], v[76:79]
    buffer_load_dwordx4 v2, s[8:11], s20 offen offset:0 lds
    s_waitcnt lgkmcnt(6)
    v_mfma_f32_16x16x32_bf16 v[72:75], v[32:35], a[232:235], v[72:75]
    ds_read_b128 v[28:31], v11 offset:0
    v_mfma_f32_16x16x32_bf16 v[80:83], v[32:35], a[236:239], v[80:83]
    v_mov_b32 v9, s23
    s_add_u32 s23, s23, 1
    buffer_store_dword v9, v4, s[4:7], 0 offen sc1
    s_waitcnt lgkmcnt(6)
    v_mfma_f32_16x16x32_bf16 v[68:71], v[36:39], a[240:243], v[68:71]
    ds_read_b128 v[32:35], v11 offset:2048
    s_add_u32 m0, s19, 69504
    v_mfma_f32_16x16x32_bf16 v[76:79], v[36:39], a[244:247], v[76:79]
    buffer_load_dwordx4 v2, s[8:11], s20 offen offset:128 lds
    s_waitcnt lgkmcnt(6)
    v_mfma_f32_16x16x32_bf16 v[72:75], v[40:43], a[240:243], v[72:75]
    ds_read_b128 v[36:39], v10 offset:4096
    v_mfma_f32_16x16x32_bf16 v[80:83], v[40:43], a[244:247], v[80:83]
    s_waitcnt lgkmcnt(6)
    v_mfma_f32_16x16x32_bf16 v[68:71], v[44:47], a[248:251], v[68:71]
    ds_read_b128 v[40:43], v10 offset:6144
    s_add_u32 m0, s19, 73472
    v_mfma_f32_16x16x32_bf16 v[76:79], v[44:47], a[252:255], v[76:79]
    buffer_load_dwordx4 v2, s[8:11], s20 offen offset:256 lds
    s_waitcnt lgkmcnt(6)
    v_mfma_f32_16x16x32_bf16 v[72:75], v[48:51], a[248:251], v[72:75]
    ds_read_b128 v[44:47], v11 offset:4096
    v_mfma_f32_16x16x32_bf16 v[80:83], v[48:51], a[252:255], v[80:83]
    s_add_u32 s22, s22, 2
    s_cmp_lt_u32 s22, 64
    s_cbranch_scc1 P_v_top
    v_cvt_pk_bf16_f32 v84, v68, v69
    v_cvt_pk_bf16_f32 v85, v70, v71
    s_nop 0
    v_cvt_pk_bf16_f32 v86, v72, v73
    v_cvt_pk_bf16_f32 v87, v74, v75
    v_cvt_pk_bf16_f32 v88, v76, v77
    v_cvt_pk_bf16_f32 v89, v78, v79
    v_cvt_pk_bf16_f32 v90, v80, v81
    v_cvt_pk_bf16_f32 v91, v82, v83
    buffer_store_dwordx4 v[84:87], v3, s[4:7], s21 offen offset:0 sc1
    buffer_store_dwordx4 v[88:91], v3, s[4:7], s21 offen offset:256 sc1
    s_waitcnt vmcnt(0) lgkmcnt(0)
    v_mov_b32 v9, s23
    s_add_u32 s23, s23, 1
    buffer_store_dword v9, v4, s[4:7], 0 offen sc1
    s_branch W_U
W_U:
    v_lshlrev_b32 v5, 2, v1
    s_mov_b32 s18, 0
rdv_13:
    global_load_dword v6, v5, s[100:101] sc1
    s_lshl_b32 s17, s98, 2
    s_waitcnt vmcnt(0)
    v_lshrrev_b32 v9, s17, v6
    s_cmp_eq_u32 s98, 0
    s_cselect_b32 s17, 0x0f0f0f0f, s17
    s_cselect_b32 s17, s17, 0x01010101
    v_and_b32 v9, s17, v9
    v_cmp_ne_u32 vcc, 0x01010101, v9
    s_nop 0
    s_cbranch_vccz rdvok_14
    v_sad_u8 v9, v9, 0, 0
    s_nop 1
    v_add_u32_dpp v9, v9, v9 quad_perm:[1,0,3,2] row_mask:0xf bank_mask:0xf
    v_cmp_ne_u32 vcc, 8, v9
    s_nop 0
    s_cbranch_vccnz rdvw_15
    s_mov_b32 s98, 1
    s_and_b32 s3, s97, 7
    s_barrier
    s_branch role_start
rdvw_15:
    s_sleep 4
    s_add_u32 s18, s18, 1
    s_cmp_lt_u32 s18, 262144
    s_cbranch_scc1 rdv_13
    s_mov_b32 s92, 1048576
rdvok_14:
    s_load_dwordx2 s[8:9], s[0:1], 64
    s_load_dwordx2 s[12:13], s[0:1], 80
    s_mov_b32 s10, 8388608
    s_mov_b32 s11, 0x20000
    s_mov_b32 s14, 8388608
    s_mov_b32 s15, 0x20000
    s_and_b32 s35, s93, 15
    s_lshr_b32 s28, s93, 4
    s_lshl_b32 s17, s90, 1
    s_add_u32 s28, s28, s17
    s_lshl_b32 s20, s16, 21
    s_lshl_b32 s17, s35, 7
    s_add_u32 s20, s20, s17
    v_lshrrev_b32 v5, 2, v1
    v_and_b32 v6, 3, v1
    v_lshlrev_b32 v7, 4, v6
    v_lshl_add_u32 v7, v5, 11, v7
    v_lshlrev_b32 v8, 3, v6
    v_bfe_u32 v5, v1, 2, 2
    v_lshrrev_b32 v6, 4, v1
    v_lshl_add_u32 v5, v6, 3, v5
    v_lshl_add_u32 v8, v5, 6, v8
    s_lshl_b32 s19, s16, 15
    v_add_u32 v8, s19, v8
    s_and_b32 s37, s93, 0
    s_lshl_b32 s37, s37, 18
    s_waitcnt lgkmcnt(0)
    s_barrier
    s_sub_u32 s17, s90, 1
    s_and_b32 s17, s17, 3
    s_lshl_b32 s17, s17, 3
    s_and_b32 s18, s93, 7
    s_add_u32 s17, s17, s18
    s_lshl_b32 s17, s17, 8
    v_add_lshl_u32 v5, v0, s17, 11
    s_and_b32 s17, s93, 8
    s_lshl_b32 s17, s17, 7
    buffer_load_dword v48, v5, s[8:11], s17 offen offset:384
    s_add_u32 m0, s19, 0
    s_add_u32 s17, s37, 0
    s_bitset0_b32 s17, 21
    s_add_u32 s17, s17, s20
    buffer_load_dwordx4 v7, s[8:11], s17 offen lds
    s_add_u32 m0, s19, 1024
    s_add_u32 s17, s37, 32768
    s_bitset0_b32 s17, 21
    s_add_u32 s17, s17, s20
    buffer_load_dwordx4 v7, s[8:11], s17 offen lds
    s_add_u32 m0, s19, 2048
    s_add_u32 s17, s37, 65536
    s_bitset0_b32 s17, 21
    s_add_u32 s17, s17, s20
    buffer_load_dwordx4 v7, s[8:11], s17 offen lds
    s_add_u32 m0, s19, 3072
    s_add_u32 s17, s37, 98304
    s_bitset0_b32 s17, 21
    s_add_u32 s17, s17, s20
    buffer_load_dwordx4 v7, s[8:11], s17 offen lds
    s_add_u32 m0, s19, 4096
    s_add_u32 s17, s37, 131072
    s_bitset0_b32 s17, 21
    s_add_u32 s17, s17, s20
    buffer_load_dwordx4 v7, s[8:11], s17 offen lds
    s_add_u32 m0, s19, 5120
    s_add_u32 s17, s37, 163840
    s_bitset0_b32 s17, 21
    s_add_u32 s17, s17, s20
    buffer_load_dwordx4 v7, s[8:11], s17 offen lds
    s_add_u32 m0, s19, 6144
    s_add_u32 s17, s37, 196608
    s_bitset0_b32 s17, 21
    s_add_u32 s17, s17, s20
    buffer_load_dwordx4 v7, s[8:11], s17 offen lds
    s_add_u32 m0, s19, 7168
    s_add_u32 s17, s37, 229376
    s_bitset0_b32 s17, 21
    s_add_u32 s17, s17, s20
    buffer_load_dwordx4 v7, s[8:11], s17 offen lds
    s_add_u32 m0, s19, 8192
    s_add_u32 s17, s37, 262144
    s_bitset0_b32 s17, 21
    s_add_u32 s17, s17, s20
    buffer_load_dwordx4 v7, s[8:11], s17 offen lds
    s_add_u32 m0, s19, 9216
    s_add_u32 s17, s37, 294912
    s_bitset0_b32 s17, 21
    s_add_u32 s17, s17, s20
    buffer_load_dwordx4 v7, s[8:11], s17 offen lds
    s_add_u32 m0, s19, 10240
    s_add_u32 s17, s37, 327680
    s_bitset0_b32 s17, 21
    s_add_u32 s17, s17, s20
    buffer_load_dwordx4 v7, s[8:11], s17 offen lds
    s_add_u32 m0, s19, 11264
    s_add_u32 s17, s37, 360448
    s_bitset0_b32 s17, 21
    s_add_u32 s17, s17, s20
    buffer_load_dwordx4 v7, s[8:11], s17 offen lds
    s_add_u32 m0, s19, 12288
    s_add_u32 s17, s37, 393216
    s_bitset0_b32 s17, 21
    s_add_u32 s17, s17, s20
    buffer_load_dwordx4 v7, s[8:11], s17 offen lds
    s_add_u32 m0, s19, 13312
    s_add_u32 s17, s37, 425984
    s_bitset0_b32 s17, 21
    s_add_u32 s17, s17, s20
    buffer_load_dwordx4 v7, s[8:11], s17 offen lds
    s_add_u32 m0, s19, 14336
    s_add_u32 s17, s37, 458752
    s_bitset0_b32 s17, 21
    s_add_u32 s17, s17, s20
    buffer_load_dwordx4 v7, s[8:11], s17 offen lds
    s_add_u32 m0, s19, 15360
    s_add_u32 s17, s37, 491520
    s_bitset0_b32 s17, 21
    s_add_u32 s17, s17, s20
    buffer_load_dwordx4 v7, s[8:11], s17 offen lds
    s_add_u32 m0, s19, 16384
    s_add_u32 s17, s37, 524288
    s_bitset0_b32 s17, 21
    s_add_u32 s17, s17, s20
    buffer_load_dwordx4 v7, s[8:11], s17 offen lds
    s_add_u32 m0, s19, 17408
    s_add_u32 s17, s37, 557056
    s_bitset0_b32 s17, 21
    s_add_u32 s17, s17, s20
    buffer_load_dwordx4 v7, s[8:11], s17 offen lds
    s_add_u32 m0, s19, 18432
    s_add_u32 s17, s37, 589824
    s_bitset0_b32 s17, 21
    s_add_u32 s17, s17, s20
    buffer_load_dwordx4 v7, s[8:11], s17 offen lds
    s_add_u32 m0, s19, 19456
    s_add_u32 s17, s37, 622592
    s_bitset0_b32 s17, 21
    s_add_u32 s17, s17, s20
    buffer_load_dwordx4 v7, s[8:11], s17 offen lds
    s_add_u32 m0, s19, 20480
    s_add_u32 s17, s37, 655360
    s_bitset0_b32 s17, 21
    s_add_u32 s17, s17, s20
    buffer_load_dwordx4 v7, s[8:11], s17 offen lds
    s_add_u32 m0, s19, 21504
    s_add_u32 s17, s37, 688128
    s_bitset0_b32 s17, 21
    s_add_u32 s17, s17, s20
    buffer_load_dwordx4 v7, s[8:11], s17 offen lds
    s_add_u32 m0, s19, 22528
    s_add_u32 s17, s37, 720896
    s_bitset0_b32 s17, 21
    s_add_u32 s17, s17, s20
    buffer_load_dwordx4 v7, s[8:11], s17 offen lds
    s_add_u32 m0, s19, 23552
    s_add_u32 s17, s37, 753664
    s_bitset0_b32 s17, 21
    s_add_u32 s17, s17, s20
    buffer_load_dwordx4 v7, s[8:11], s17 offen lds
    s_add_u32 m0, s19, 24576
    s_add_u32 s17, s37, 786432
    s_bitset0_b32 s17, 21
    s_add_u32 s17, s17, s20
    buffer_load_dwordx4 v7, s[8:11], s17 offen lds
    s_add_u32 m0, s19, 25600
    s_add_u32 s17, s37, 819200
    s_bitset0_b32 s17, 21
    s_add_u32 s17, s17, s20
    buffer_load_dwordx4 v7, s[8:11], s17 offen lds
    s_add_u32 m0, s19, 26624
    s_add_u32 s17, s37, 851968
    s_bitset0_b32 s17, 21
    s_add_u32 s17, s17, s20
    buffer_load_dwordx4 v7, s[8:11], s17 offen lds
    s_add_u32 m0, s19, 27648
    s_add_u32 s17, s37, 884736
    s_bitset0_b32 s17, 21
    s_add_u32 s17, s17, s20
    buffer_load_dwordx4 v7, s[8:11], s17 offen lds
    s_add_u32 m0, s19, 28672
    s_add_u32 s17, s37, 917504
    s_bitset0_b32 s17, 21
    s_add_u32 s17, s17, s20
    buffer_load_dwordx4 v7, s[8:11], s17 offen lds
    s_add_u32 m0, s19, 29696
    s_add_u32 s17, s37, 950272
    s_bitset0_b32 s17, 21
    s_add_u32 s17, s17, s20
    buffer_load_dwordx4 v7, s[8:11], s17 offen lds
    s_add_u32 m0, s19, 30720
    s_add_u32 s17, s37, 983040
    s_bitset0_b32 s17, 21
    s_add_u32 s17, s17, s20
    buffer_load_dwordx4 v7, s[8:11], s17 offen lds
    s_add_u32 m0, s19, 31744
    s_add_u32 s17, s37, 1015808
    s_bitset0_b32 s17, 21
    s_add_u32 s17, s17, s20
    buffer_load_dwordx4 v7, s[8:11], s17 offen lds
    s_waitcnt vmcnt(30)
    ds_read_b64_tr_b16 a[0:1], v8 offset:0
    ds_read_b64_tr_b16 a[2:3], v8 offset:256
    ds_read_b64_tr_b16 a[4:5], v8 offset:32
    ds_read_b64_tr_b16 a[6:7], v8 offset:288
    s_waitcnt vmcnt(28)
    ds_read_b64_tr_b16 a[8:9], v8 offset:2048
    ds_read_b64_tr_b16 a[10:11], v8 offset:2304
    ds_read_b64_tr_b16 a[12:13], v8 offset:2080
    ds_read_b64_tr_b16 a[14:15], v8 offset:2336
    s_waitcnt lgkmcnt(4)
    s_add_u32 m0, s19, 0
    s_add_u32 s17, s37, 1048576
    s_bitset0_b32 s17, 21
    s_add_u32 s17, s17, s20
    buffer_load_dwordx4 v7, s[8:11], s17 offen lds
    s_add_u32 m0, s19, 1024
    s_add_u32 s17, s37, 1081344
    s_bitset0_b32 s17, 21
    s_add_u32 s17, s17, s20
    buffer_load_dwordx4 v7, s[8:11], s17 offen lds
    s_waitcnt vmcnt(28)
    ds_read_b64_tr_b16 a[16:17], v8 offset:4096
    ds_read_b64_tr_b16 a[18:19], v8 offset:4352
    ds_read_b64_tr_b16 a[20:21], v8 offset:4128
    ds_read_b64_tr_b16 a[22:23], v8 offset:4384
    s_waitcnt lgkmcnt(4)
    s_add_u32 m0, s19, 2048
    s_add_u32 s17, s37, 1114112
    s_bitset0_b32 s17, 21
    s_add_u32 s17, s17, s20
    buffer_load_dwordx4 v7, s[8:11], s17 offen lds
    s_add_u32 m0, s19, 3072
    s_add_u32 s17, s37, 1146880
    s_bitset0_b32 s17, 21
    s_add_u32 s17, s17, s20
    buffer_load_dwordx4 v7, s[8:11], s17 offen lds
    s_waitcnt vmcnt(28)
    ds_read_b64_tr_b16 a[24:25], v8 offset:6144
    ds_read_b64_tr_b16 a[26:27], v8 offset:6400
    ds_read_b64_tr_b16 a[28:29], v8 offset:6176
    ds_read_b64_tr_b16 a[30:31], v8 offset:6432
    s_waitcnt lgkmcnt(4)
    s_add_u32 m0, s19, 4096
    s_add_u32 s17, s37, 1179648
    s_bitset0_b32 s17, 21
    s_add_u32 s17, s17, s20
    buffer_load_dwordx4 v7, s[8:11], s17 offen lds
    s_add_u32 m0, s19, 5120
    s_add_u32 s17, s37, 1212416
    s_bitset0_b32 s17, 21
    s_add_u32 s17, s17, s20
    buffer_load_dwordx4 v7, s[8:11], s17 offen lds
    s_waitcnt vmcnt(28)
    ds_read_b64_tr_b16 a[32:33], v8 offset:8192
    ds_read_b64_tr_b16 a[34:35], v8 offset:8448
    ds_read_b64_tr_b16 a[36:37], v8 offset:8224
    ds_read_b64_tr_b16 a[38:39], v8 offset:8480
    s_waitcnt lgkmcnt(4)
    s_add_u32 m0, s19, 6144
    s_add_u32 s17, s37, 1245184
    s_bitset0_b32 s17, 21
    s_add_u32 s17, s17, s20
    buffer_load_dwordx4 v7, s[8:11], s17 offen lds
    s_add_u32 m0, s19, 7168
    s_add_u32 s17, s37, 1277952
    s_bitset0_b32 s17, 21
    s_add_u32 s17, s17, s20
    buffer_load_dwordx4 v7, s[8:11], s17 offen lds
    s_waitcnt vmcnt(28)
    ds_read_b64_tr_b16 a[40:41], v8 offset:10240
    ds_read_b64_tr_b16 a[42:43], v8 offset:10496
    ds_read_b64_tr_b16 a[44:45], v8 offset:10272
    ds_read_b64_tr_b16 a[46:47], v8 offset:10528
    s_waitcnt lgkmcnt(4)
    s_add_u32 m0, s19, 8192
    s_add_u32 s17, s37, 1310720
    s_bitset0_b32 s17, 21
    s_add_u32 s17, s17, s20
    buffer_load_dwordx4 v7, s[8:11], s17 offen lds
    s_add_u32 m0, s19, 9216
    s_add_u32 s17, s37, 1343488
    s_bitset0_b32 s17, 21
    s_add_u32 s17, s17, s20
    buffer_load_dwordx4 v7, s[8:11], s17 offen lds
    s_waitcnt vmcnt(28)
    ds_read_b64_tr_b16 a[48:49], v8 offset:12288
    ds_read_b64_tr_b16 a[50:51], v8 offset:12544
    ds_read_b64_tr_b16 a[52:53], v8 offset:12320
    ds_read_b64_tr_b16 a[54:55], v8 offset:12576
    s_waitcnt lgkmcnt(4)
    s_add_u32 m0, s19, 10240
    s_add_u32 s17, s37, 1376256
    s_bitset0_b32 s17, 21
    s_add_u32 s17, s17, s20
    buffer_load_dwordx4 v7, s[8:11], s17 offen lds
    s_add_u32 m0, s19, 11264
    s_add_u32 s17, s37, 1409024
    s_bitset0_b32 s17, 21
    s_add_u32 s17, s17, s20
    buffer_load_dwordx4 v7, s[8:11], s17 offen lds
    s_waitcnt vmcnt(28)
    ds_read_b64_tr_b16 a[56:57], v8 offset:14336
    ds_read_b64_tr_b16 a[58:59], v8 offset:14592
    ds_read_b64_tr_b16 a[60:61], v8 offset:14368
    ds_read_b64_tr_b16 a[62:63], v8 offset:14624
    s_waitcnt lgkmcnt(4)
    s_add_u32 m0, s19, 12288
    s_add_u32 s17, s37, 1441792
    s_bitset0_b32 s17, 21
    s_add_u32 s17, s17, s20
    buffer_load_dwordx4 v7, s[8:11], s17 offen lds
    s_add_u32 m0, s19, 13312
    s_add_u32 s17, s37, 1474560
    s_bitset0_b32 s17, 21
    s_add_u32 s17, s17, s20
    buffer_load_dwordx4 v7, s[8:11], s17 offen lds
    s_waitcnt vmcnt(28)
    ds_read_b64_tr_b16 a[64:65], v8 offset:16384
    ds_read_b64_tr_b16 a[66:67], v8 offset:16640
    ds_read_b64_tr_b16 a[68:69], v8 offset:16416
    ds_read_b64_tr_b16 a[70:71], v8 offset:16672
    s_waitcnt lgkmcnt(4)
    s_add_u32 m0, s19, 14336
    s_add_u32 s17, s37, 1507328
    s_bitset0_b32 s17, 21
    s_add_u32 s17, s17, s20
    buffer_load_dwordx4 v7, s[8:11], s17 offen lds
    s_add_u32 m0, s19, 15360
    s_add_u32 s17, s37, 1540096
    s_bitset0_b32 s17, 21
    s_add_u32 s17, s17, s20
    buffer_load_dwordx4 v7, s[8:11], s17 offen lds
    s_waitcnt vmcnt(28)
    ds_read_b64_tr_b16 a[72:73], v8 offset:18432
    ds_read_b64_tr_b16 a[74:75], v8 offset:18688
    ds_read_b64_tr_b16 a[76:77], v8 offset:18464
    ds_read_b64_tr_b16 a[78:79], v8 offset:18720
    s_waitcnt lgkmcnt(4)
    s_add_u32 m0, s19, 16384
    s_add_u32 s17, s37, 1572864
    s_bitset0_b32 s17, 21
    s_add_u32 s17, s17, s20
    buffer_load_dwordx4 v7, s[8:11], s17 offen lds
    s_add_u32 m0, s19, 17408
    s_add_u32 s17, s37, 1605632
    s_bitset0_b32 s17, 21
    s_add_u32 s17, s17, s20
    buffer_load_dwordx4 v7, s[8:11], s17 offen lds
    s_waitcnt vmcnt(28)
    ds_read_b64_tr_b16 a[80:81], v8 offset:20480
    ds_read_b64_tr_b16 a[82:83], v8 offset:20736
    ds_read_b64_tr_b16 a[84:85], v8 offset:20512
    ds_read_b64_tr_b16 a[86:87], v8 offset:20768
    s_waitcnt lgkmcnt(4)
    s_add_u32 m0, s19, 18432
    s_add_u32 s17, s37, 1638400
    s_bitset0_b32 s17, 21
    s_add_u32 s17, s17, s20
    buffer_load_dwordx4 v7, s[8:11], s17 offen lds
    s_add_u32 m0, s19, 19456
    s_add_u32 s17, s37, 1671168
    s_bitset0_b32 s17, 21
    s_add_u32 s17, s17, s20
    buffer_load_dwordx4 v7, s[8:11], s17 offen lds
    s_waitcnt vmcnt(28)
    ds_read_b64_tr_b16 a[88:89], v8 offset:22528
    ds_read_b64_tr_b16 a[90:91], v8 offset:22784
    ds_read_b64_tr_b16 a[92:93], v8 offset:22560
    ds_read_b64_tr_b16 a[94:95], v8 offset:22816
    s_waitcnt lgkmcnt(4)
    s_add_u32 m0, s19, 20480
    s_add_u32 s17, s37, 1703936
    s_bitset0_b32 s17, 21
    s_add_u32 s17, s17, s20
    buffer_load_dwordx4 v7, s[8:11], s17 offen lds
    s_add_u32 m0, s19, 21504
    s_add_u32 s17, s37, 1736704
    s_bitset0_b32 s17, 21
    s_add_u32 s17, s17, s20
    buffer_load_dwordx4 v7, s[8:11], s17 offen lds
    s_waitcnt vmcnt(28)
    ds_read_b64_tr_b16 a[96:97], v8 offset:24576
    ds_read_b64_tr_b16 a[98:99], v8 offset:24832
    ds_read_b64_tr_b16 a[100:101], v8 offset:24608
    ds_read_b64_tr_b16 a[102:103], v8 offset:24864
    s_waitcnt lgkmcnt(4)
    s_add_u32 m0, s19, 22528
    s_add_u32 s17, s37, 1769472
    s_bitset0_b32 s17, 21
    s_add_u32 s17, s17, s20
    buffer_load_dwordx4 v7, s[8:11], s17 offen lds
    s_add_u32 m0, s19, 23552
    s_add_u32 s17, s37, 1802240
    s_bitset0_b32 s17, 21
    s_add_u32 s17, s17, s20
    buffer_load_dwordx4 v7, s[8:11], s17 offen lds
    s_waitcnt vmcnt(28)
    ds_read_b64_tr_b16 a[104:105], v8 offset:26624
    ds_read_b64_tr_b16 a[106:107], v8 offset:26880
    ds_read_b64_tr_b16 a[108:109], v8 offset:26656
    ds_read_b64_tr_b16 a[110:111], v8 offset:26912
    s_waitcnt lgkmcnt(4)
    s_add_u32 m0, s19, 24576
    s_add_u32 s17, s37, 1835008
    s_bitset0_b32 s17, 21
    s_add_u32 s17, s17, s20
    buffer_load_dwordx4 v7, s[8:11], s17 offen lds
    s_add_u32 m0, s19, 25600
    s_add_u32 s17, s37, 1867776
    s_bitset0_b32 s17, 21
    s_add_u32 s17, s17, s20
    buffer_load_dwordx4 v7, s[8:11], s17 offen lds
    s_waitcnt vmcnt(28)
    ds_read_b64_tr_b16 a[112:113], v8 offset:28672
    ds_read_b64_tr_b16 a[114:115], v8 offset:28928
    ds_read_b64_tr_b16 a[116:117], v8 offset:28704
    ds_read_b64_tr_b16 a[118:119], v8 offset:28960
    s_waitcnt lgkmcnt(4)
    s_add_u32 m0, s19, 26624
    s_add_u32 s17, s37, 1900544
    s_bitset0_b32 s17, 21
    s_add_u32 s17, s17, s20
    buffer_load_dwordx4 v7, s[8:11], s17 offen lds
    s_add_u32 m0, s19, 27648
    s_add_u32 s17, s37, 1933312
    s_bitset0_b32 s17, 21
    s_add_u32 s17, s17, s20
    buffer_load_dwordx4 v7, s[8:11], s17 offen lds
    s_waitcnt vmcnt(28)
    ds_read_b64_tr_b16 a[120:121], v8 offset:30720
    ds_read_b64_tr_b16 a[122:123], v8 offset:30976
    ds_read_b64_tr_b16 a[124:125], v8 offset:30752
    ds_read_b64_tr_b16 a[126:127], v8 offset:31008
    s_waitcnt lgkmcnt(4)
    s_add_u32 m0, s19, 28672
    s_add_u32 s17, s37, 1966080
    s_bitset0_b32 s17, 21
    s_add_u32 s17, s17, s20
    buffer_load_dwordx4 v7, s[8:11], s17 offen lds
    s_add_u32 m0, s19, 29696
    s_add_u32 s17, s37, 1998848
    s_bitset0_b32 s17, 21
    s_add_u32 s17, s17, s20
    buffer_load_dwordx4 v7, s[8:11], s17 offen lds
    s_waitcnt vmcnt(28)
    ds_read_b64_tr_b16 a[128:129], v8 offset:0
    ds_read_b64_tr_b16 a[130:131], v8 offset:256
    ds_read_b64_tr_b16 a[132:133], v8 offset:32
    ds_read_b64_tr_b16 a[134:135], v8 offset:288
    s_waitcnt lgkmcnt(4)
    s_add_u32 m0, s19, 30720
    s_add_u32 s17, s37, 2031616
    s_bitset0_b32 s17, 21
    s_add_u32 s17, s17, s20
    buffer_load_dwordx4 v7, s[8:11], s17 offen lds
    s_add_u32 m0, s19, 31744
    s_add_u32 s17, s37, 2064384
    s_bitset0_b32 s17, 21
    s_add_u32 s17, s17, s20
    buffer_load_dwordx4 v7, s[8:11], s17 offen lds
    s_waitcnt vmcnt(28)
    ds_read_b64_tr_b16 a[136:137], v8 offset:2048
    ds_read_b64_tr_b16 a[138:139], v8 offset:2304
    ds_read_b64_tr_b16 a[140:141], v8 offset:2080
    ds_read_b64_tr_b16 a[142:143], v8 offset:2336
    s_waitcnt lgkmcnt(4)
    s_add_u32 m0, s19, 0
    s_add_u32 s17, s37, 64
    s_bitset0_b32 s17, 21
    s_add_u32 s17, s17, s20
    buffer_load_dwordx4 v7, s[8:11], s17 offen lds
    s_add_u32 m0, s19, 1024
    s_add_u32 s17, s37, 32832
    s_bitset0_b32 s17, 21
    s_add_u32 s17, s17, s20
    buffer_load_dwordx4 v7, s[8:11], s17 offen lds
    s_waitcnt vmcnt(28)
    ds_read_b64_tr_b16 a[144:145], v8 offset:4096
    ds_read_b64_tr_b16 a[146:147], v8 offset:4352
    ds_read_b64_tr_b16 a[148:149], v8 offset:4128
    ds_read_b64_tr_b16 a[150:151], v8 offset:4384
    s_waitcnt lgkmcnt(4)
    s_add_u32 m0, s19, 2048
    s_add_u32 s17, s37, 131136
    s_bitset0_b32 s17, 21
    s_add_u32 s17, s17, s20
    buffer_load_dwordx4 v7, s[8:11], s17 offen lds
    s_add_u32 m0, s19, 3072
    s_add_u32 s17, s37, 163904
    s_bitset0_b32 s17, 21
    s_add_u32 s17, s17, s20
    buffer_load_dwordx4 v7, s[8:11], s17 offen lds
    s_waitcnt vmcnt(28)
    ds_read_b64_tr_b16 a[152:153], v8 offset:6144
    ds_read_b64_tr_b16 a[154:155], v8 offset:6400
    ds_read_b64_tr_b16 a[156:157], v8 offset:6176
    ds_read_b64_tr_b16 a[158:159], v8 offset:6432
    s_waitcnt lgkmcnt(4)
    s_add_u32 m0, s19, 4096
    s_add_u32 s17, s37, 262208
    s_bitset0_b32 s17, 21
    s_add_u32 s17, s17, s20
    buffer_load_dwordx4 v7, s[8:11], s17 offen lds
    s_add_u32 m0, s19, 5120
    s_add_u32 s17, s37, 294976
    s_bitset0_b32 s17, 21
    s_add_u32 s17, s17, s20
    buffer_load_dwordx4 v7, s[8:11], s17 offen lds
    s_waitcnt vmcnt(28)
    ds_read_b64_tr_b16 a[160:161], v8 offset:8192
    ds_read_b64_tr_b16 a[162:163], v8 offset:8448
    ds_read_b64_tr_b16 a[164:165], v8 offset:8224
    ds_read_b64_tr_b16 a[166:167], v8 offset:8480
    s_waitcnt lgkmcnt(4)
    s_add_u32 m0, s19, 6144
    s_add_u32 s17, s37, 393280
    s_bitset0_b32 s17, 21
    s_add_u32 s17, s17, s20
    buffer_load_dwordx4 v7, s[8:11], s17 offen lds
    s_add_u32 m0, s19, 7168
    s_add_u32 s17, s37, 426048
    s_bitset0_b32 s17, 21
    s_add_u32 s17, s17, s20
    buffer_load_dwordx4 v7, s[8:11], s17 offen lds
    s_waitcnt vmcnt(28)
    ds_read_b64_tr_b16 a[168:169], v8 offset:10240
    ds_read_b64_tr_b16 a[170:171], v8 offset:10496
    ds_read_b64_tr_b16 a[172:173], v8 offset:10272
    ds_read_b64_tr_b16 a[174:175], v8 offset:10528
    s_waitcnt lgkmcnt(4)
    s_add_u32 m0, s19, 8192
    s_add_u32 s17, s37, 524352
    s_bitset0_b32 s17, 21
    s_add_u32 s17, s17, s20
    buffer_load_dwordx4 v7, s[8:11], s17 offen lds
    s_add_u32 m0, s19, 9216
    s_add_u32 s17, s37, 557120
    s_bitset0_b32 s17, 21
    s_add_u32 s17, s17, s20
    buffer_load_dwordx4 v7, s[8:11], s17 offen lds
    s_waitcnt vmcnt(28)
    ds_read_b64_tr_b16 a[176:177], v8 offset:12288
    ds_read_b64_tr_b16 a[178:179], v8 offset:12544
    ds_read_b64_tr_b16 a[180:181], v8 offset:12320
    ds_read_b64_tr_b16 a[182:183], v8 offset:12576
    s_waitcnt lgkmcnt(4)
    s_add_u32 m0, s19, 10240
    s_add_u32 s17, s37, 655424
    s_bitset0_b32 s17, 21
    s_add_u32 s17, s17, s20
    buffer_load_dwordx4 v7, s[8:11], s17 offen lds
    s_add_u32 m0, s19, 11264
    s_add_u32 s17, s37, 688192
    s_bitset0_b32 s17, 21
    s_add_u32 s17, s17, s20
    buffer_load_dwordx4 v7, s[8:11], s17 offen lds
    s_waitcnt vmcnt(28)
    ds_read_b64_tr_b16 a[184:185], v8 offset:14336
    ds_read_b64_tr_b16 a[186:187], v8 offset:14592
    ds_read_b64_tr_b16 a[188:189], v8 offset:14368
    ds_read_b64_tr_b16 a[190:191], v8 offset:14624
    s_waitcnt lgkmcnt(4)
    s_add_u32 m0, s19, 12288
    s_add_u32 s17, s37, 786496
    s_bitset0_b32 s17, 21
    s_add_u32 s17, s17, s20
    buffer_load_dwordx4 v7, s[8:11], s17 offen lds
    s_add_u32 m0, s19, 13312
    s_add_u32 s17, s37, 819264
    s_bitset0_b32 s17, 21
    s_add_u32 s17, s17, s20
    buffer_load_dwordx4 v7, s[8:11], s17 offen lds
    s_waitcnt vmcnt(28)
    ds_read_b64_tr_b16 a[192:193], v8 offset:16384
    ds_read_b64_tr_b16 a[194:195], v8 offset:16640
    ds_read_b64_tr_b16 a[196:197], v8 offset:16416
    ds_read_b64_tr_b16 a[198:199], v8 offset:16672
    s_waitcnt lgkmcnt(4)
    s_add_u32 m0, s19, 14336
    s_add_u32 s17, s37, 917568
    s_bitset0_b32 s17, 21
    s_add_u32 s17, s17, s20
    buffer_load_dwordx4 v7, s[8:11], s17 offen lds
    s_add_u32 m0, s19, 15360
    s_add_u32 s17, s37, 950336
    s_bitset0_b32 s17, 21
    s_add_u32 s17, s17, s20
    buffer_load_dwordx4 v7, s[8:11], s17 offen lds
    s_waitcnt vmcnt(28)
    ds_read_b64_tr_b16 a[200:201], v8 offset:18432
    ds_read_b64_tr_b16 a[202:203], v8 offset:18688
    ds_read_b64_tr_b16 a[204:205], v8 offset:18464
    ds_read_b64_tr_b16 a[206:207], v8 offset:18720
    s_waitcnt lgkmcnt(4)
    s_add_u32 m0, s19, 16384
    s_add_u32 s17, s37, 1048640
    s_bitset0_b32 s17, 21
    s_add_u32 s17, s17, s20
    buffer_load_dwordx4 v7, s[8:11], s17 offen lds
    s_add_u32 m0, s19, 17408
    s_add_u32 s17, s37, 1081408
    s_bitset0_b32 s17, 21
    s_add_u32 s17, s17, s20
    buffer_load_dwordx4 v7, s[8:11], s17 offen lds
    s_waitcnt vmcnt(28)
    ds_read_b64_tr_b16 a[208:209], v8 offset:20480
    ds_read_b64_tr_b16 a[210:211], v8 offset:20736
    ds_read_b64_tr_b16 a[212:213], v8 offset:20512
    ds_read_b64_tr_b16 a[214:215], v8 offset:20768
    s_waitcnt lgkmcnt(4)
    s_add_u32 m0, s19, 18432
    s_add_u32 s17, s37, 1179712
    s_bitset0_b32 s17, 21
    s_add_u32 s17, s17, s20
    buffer_load_dwordx4 v7, s[8:11], s17 offen lds
    s_add_u32 m0, s19, 19456
    s_add_u32 s17, s37, 1212480
    s_bitset0_b32 s17, 21
    s_add_u32 s17, s17, s20
    buffer_load_dwordx4 v7, s[8:11], s17 offen lds
    s_waitcnt vmcnt(28)
    ds_read_b64_tr_b16 a[216:217], v8 offset:22528
    ds_read_b64_tr_b16 a[218:219], v8 offset:22784
    ds_read_b64_tr_b16 a[220:221], v8 offset:22560
    ds_read_b64_tr_b16 a[222:223], v8 offset:22816
    s_waitcnt lgkmcnt(4)
    s_add_u32 m0, s19, 20480
    s_add_u32 s17, s37, 1310784
    s_bitset0_b32 s17, 21
    s_add_u32 s17, s17, s20
    buffer_load_dwordx4 v7, s[8:11], s17 offen lds
    s_add_u32 m0, s19, 21504
    s_add_u32 s17, s37, 1343552
    s_bitset0_b32 s17, 21
    s_add_u32 s17, s17, s20
    buffer_load_dwordx4 v7, s[8:11], s17 offen lds
    s_waitcnt vmcnt(28)
    ds_read_b64_tr_b16 a[224:225], v8 offset:24576
    ds_read_b64_tr_b16 a[226:227], v8 offset:24832
    ds_read_b64_tr_b16 a[228:229], v8 offset:24608
    ds_read_b64_tr_b16 a[230:231], v8 offset:24864
    s_waitcnt lgkmcnt(4)
    s_add_u32 m0, s19, 22528
    s_add_u32 s17, s37, 1441856
    s_bitset0_b32 s17, 21
    s_add_u32 s17, s17, s20
    buffer_load_dwordx4 v7, s[8:11], s17 offen lds
    s_add_u32 m0, s19, 23552
    s_add_u32 s17, s37, 1474624
    s_bitset0_b32 s17, 21
    s_add_u32 s17, s17, s20
    buffer_load_dwordx4 v7, s[8:11], s17 offen lds
    s_waitcnt vmcnt(28)
    ds_read_b64_tr_b16 a[232:233], v8 offset:26624
    ds_read_b64_tr_b16 a[234:235], v8 offset:26880
    ds_read_b64_tr_b16 a[236:237], v8 offset:26656
    ds_read_b64_tr_b16 a[238:239], v8 offset:26912
    s_waitcnt lgkmcnt(4)
    s_add_u32 m0, s19, 24576
    s_add_u32 s17, s37, 1572928
    s_bitset0_b32 s17, 21
    s_add_u32 s17, s17, s20
    buffer_load_dwordx4 v7, s[8:11], s17 offen lds
    s_add_u32 m0, s19, 25600
    s_add_u32 s17, s37, 1605696
    s_bitset0_b32 s17, 21
    s_add_u32 s17, s17, s20
    buffer_load_dwordx4 v7, s[8:11], s17 offen lds
    s_waitcnt vmcnt(28)
    ds_read_b64_tr_b16 a[240:241], v8 offset:28672
    ds_read_b64_tr_b16 a[242:243], v8 offset:28928
    ds_read_b64_tr_b16 a[244:245], v8 offset:28704
    ds_read_b64_tr_b16 a[246:247], v8 offset:28960
    s_waitcnt lgkmcnt(4)
    s_add_u32 m0, s19, 26624
    s_add_u32 s17, s37, 1704000
    s_bitset0_b32 s17, 21
    s_add_u32 s17, s17, s20
    buffer_load_dwordx4 v7, s[8:11], s17 offen lds
    s_add_u32 m0, s19, 27648
    s_add_u32 s17, s37, 1736768
    s_bitset0_b32 s17, 21
    s_add_u32 s17, s17, s20
    buffer_load_dwordx4 v7, s[8:11], s17 offen lds
    s_waitcnt vmcnt(28)
    ds_read_b64_tr_b16 a[248:249], v8 offset:30720
    ds_read_b64_tr_b16 a[250:251], v8 offset:30976
    ds_read_b64_tr_b16 a[252:253], v8 offset:30752
    ds_read_b64_tr_b16 a[254:255], v8 offset:31008
    s_waitcnt lgkmcnt(4)
    s_add_u32 m0, s19, 28672
    s_add_u32 s17, s37, 1835072
    s_bitset0_b32 s17, 21
    s_add_u32 s17, s17, s20
    buffer_load_dwordx4 v7, s[8:11], s17 offen lds
    s_add_u32 m0, s19, 29696
    s_add_u32 s17, s37, 1867840
    s_bitset0_b32 s17, 21
    s_add_u32 s17, s17, s20
    buffer_load_dwordx4 v7, s[8:11], s17 offen lds
    s_waitcnt vmcnt(28)
    ds_read_b64_tr_b16 v[128:129], v8 offset:0
    ds_read_b64_tr_b16 v[130:131], v8 offset:256
    ds_read_b64_tr_b16 v[132:133], v8 offset:32
    ds_read_b64_tr_b16 v[134:135], v8 offset:288
    s_waitcnt lgkmcnt(4)
    s_add_u32 m0, s19, 30720
    s_add_u32 s17, s37, 1966144
    s_bitset0_b32 s17, 21
    s_add_u32 s17, s17, s20
    buffer_load_dwordx4 v7, s[8:11], s17 offen lds
    s_add_u32 m0, s19, 31744
    s_add_u32 s17, s37, 1998912
    s_bitset0_b32 s17, 21
    s_add_u32 s17, s17, s20
    buffer_load_dwordx4 v7, s[8:11], s17 offen lds
    s_waitcnt vmcnt(28)
    ds_read_b64_tr_b16 v[136:137], v8 offset:2048
    ds_read_b64_tr_b16 v[138:139], v8 offset:2304
    ds_read_b64_tr_b16 v[140:141], v8 offset:2080
    ds_read_b64_tr_b16 v[142:143], v8 offset:2336
    s_waitcnt lgkmcnt(4)
    s_add_u32 m0, s19, 0
    s_add_u32 s17, s37, 65600
    s_bitset0_b32 s17, 21
    s_add_u32 s17, s17, s20
    buffer_load_dwordx4 v7, s[8:11], s17 offen lds
    s_add_u32 m0, s19, 1024
    s_add_u32 s17, s37, 98368
    s_bitset0_b32 s17, 21
    s_add_u32 s17, s17, s20
    buffer_load_dwordx4 v7, s[8:11], s17 offen lds
    s_waitcnt vmcnt(28)
    ds_read_b64_tr_b16 v[144:145], v8 offset:4096
    ds_read_b64_tr_b16 v[146:147], v8 offset:4352
    ds_read_b64_tr_b16 v[148:149], v8 offset:4128
    ds_read_b64_tr_b16 v[150:151], v8 offset:4384
    s_waitcnt lgkmcnt(4)
    s_add_u32 m0, s19, 2048
    s_add_u32 s17, s37, 196672
    s_bitset0_b32 s17, 21
    s_add_u32 s17, s17, s20
    buffer_load_dwordx4 v7, s[8:11], s17 offen lds
    s_add_u32 m0, s19, 3072
    s_add_u32 s17, s37, 229440
    s_bitset0_b32 s17, 21
    s_add_u32 s17, s17, s20
    buffer_load_dwordx4 v7, s[8:11], s17 offen lds
    s_waitcnt vmcnt(28)
    ds_read_b64_tr_b16 v[152:153], v8 offset:6144
    ds_read_b64_tr_b16 v[154:155], v8 offset:6400
    ds_read_b64_tr_b16 v[156:157], v8 offset:6176
    ds_read_b64_tr_b16 v[158:159], v8 offset:6432
    s_waitcnt lgkmcnt(4)
    s_add_u32 m0, s19, 4096
    s_add_u32 s17, s37, 327744
    s_bitset0_b32 s17, 21
    s_add_u32 s17, s17, s20
    buffer_load_dwordx4 v7, s[8:11], s17 offen lds
    s_add_u32 m0, s19, 5120
    s_add_u32 s17, s37, 360512
    s_bitset0_b32 s17, 21
    s_add_u32 s17, s17, s20
    buffer_load_dwordx4 v7, s[8:11], s17 offen lds
    s_waitcnt vmcnt(28)
    ds_read_b64_tr_b16 v[160:161], v8 offset:8192
    ds_read_b64_tr_b16 v[162:163], v8 offset:8448
    ds_read_b64_tr_b16 v[164:165], v8 offset:8224
    ds_read_b64_tr_b16 v[166:167], v8 offset:8480
    s_waitcnt lgkmcnt(4)
    s_add_u32 m0, s19, 6144
    s_add_u32 s17, s37, 458816
    s_bitset0_b32 s17, 21
    s_add_u32 s17, s17, s20
    buffer_load_dwordx4 v7, s[8:11], s17 offen lds
    s_add_u32 m0, s19, 7168
    s_add_u32 s17, s37, 491584
    s_bitset0_b32 s17, 21
    s_add_u32 s17, s17, s20
    buffer_load_dwordx4 v7, s[8:11], s17 offen lds
    s_waitcnt vmcnt(28)
    ds_read_b64_tr_b16 v[168:169], v8 offset:10240
    ds_read_b64_tr_b16 v[170:171], v8 offset:10496
    ds_read_b64_tr_b16 v[172:173], v8 offset:10272
    ds_read_b64_tr_b16 v[174:175], v8 offset:10528
    s_waitcnt lgkmcnt(4)
    s_add_u32 m0, s19, 8192
    s_add_u32 s17, s37, 589888
    s_bitset0_b32 s17, 21
    s_add_u32 s17, s17, s20
    buffer_load_dwordx4 v7, s[8:11], s17 offen lds
    s_add_u32 m0, s19, 9216
    s_add_u32 s17, s37, 622656
    s_bitset0_b32 s17, 21
    s_add_u32 s17, s17, s20
    buffer_load_dwordx4 v7, s[8:11], s17 offen lds
    s_waitcnt vmcnt(28)
    ds_read_b64_tr_b16 v[176:177], v8 offset:12288
    ds_read_b64_tr_b16 v[178:179], v8 offset:12544
    ds_read_b64_tr_b16 v[180:181], v8 offset:12320
    ds_read_b64_tr_b16 v[182:183], v8 offset:12576
    s_waitcnt lgkmcnt(4)
    s_add_u32 m0, s19, 10240
    s_add_u32 s17, s37, 720960
    s_bitset0_b32 s17, 21
    s_add_u32 s17, s17, s20
    buffer_load_dwordx4 v7, s[8:11], s17 offen lds
    s_add_u32 m0, s19, 11264
    s_add_u32 s17, s37, 753728
    s_bitset0_b32 s17, 21
    s_add_u32 s17, s17, s20
    buffer_load_dwordx4 v7, s[8:11], s17 offen lds
    s_waitcnt vmcnt(28)
    ds_read_b64_tr_b16 v[184:185], v8 offset:14336
    ds_read_b64_tr_b16 v[186:187], v8 offset:14592
    ds_read_b64_tr_b16 v[188:189], v8 offset:14368
    ds_read_b64_tr_b16 v[190:191], v8 offset:14624
    s_waitcnt lgkmcnt(4)
    s_add_u32 m0, s19, 12288
    s_add_u32 s17, s37, 852032
    s_bitset0_b32 s17, 21
    s_add_u32 s17, s17, s20
    buffer_load_dwordx4 v7, s[8:11], s17 offen lds
    s_add_u32 m0, s19, 13312
    s_add_u32 s17, s37, 884800
    s_bitset0_b32 s17, 21
    s_add_u32 s17, s17, s20
    buffer_load_dwordx4 v7, s[8:11], s17 offen lds
    s_waitcnt vmcnt(28)
    ds_read_b64_tr_b16 v[192:193], v8 offset:16384
    ds_read_b64_tr_b16 v[194:195], v8 offset:16640
    ds_read_b64_tr_b16 v[196:197], v8 offset:16416
    ds_read_b64_tr_b16 v[198:199], v8 offset:16672
    s_waitcnt lgkmcnt(4)
    s_add_u32 m0, s19, 14336
    s_add_u32 s17, s37, 983104
    s_bitset0_b32 s17, 21
    s_add_u32 s17, s17, s20
    buffer_load_dwordx4 v7, s[8:11], s17 offen lds
    s_add_u32 m0, s19, 15360
    s_add_u32 s17, s37, 1015872
    s_bitset0_b32 s17, 21
    s_add_u32 s17, s17, s20
    buffer_load_dwordx4 v7, s[8:11], s17 offen lds
    s_waitcnt vmcnt(28)
    ds_read_b64_tr_b16 v[200:201], v8 offset:18432
    ds_read_b64_tr_b16 v[202:203], v8 offset:18688
    ds_read_b64_tr_b16 v[204:205], v8 offset:18464
    ds_read_b64_tr_b16 v[206:207], v8 offset:18720
    s_waitcnt lgkmcnt(4)
    s_add_u32 m0, s19, 16384
    s_add_u32 s17, s37, 1114176
    s_bitset0_b32 s17, 21
    s_add_u32 s17, s17, s20
    buffer_load_dwordx4 v7, s[8:11], s17 offen lds
    s_add_u32 m0, s19, 17408
    s_add_u32 s17, s37, 1146944
    s_bitset0_b32 s17, 21
    s_add_u32 s17, s17, s20
    buffer_load_dwordx4 v7, s[8:11], s17 offen lds
    s_waitcnt vmcnt(28)
    ds_read_b64_tr_b16 v[208:209], v8 offset:20480
    ds_read_b64_tr_b16 v[210:211], v8 offset:20736
    ds_read_b64_tr_b16 v[212:213], v8 offset:20512
    ds_read_b64_tr_b16 v[214:215], v8 offset:20768
    s_waitcnt lgkmcnt(4)
    s_add_u32 m0, s19, 18432
    s_add_u32 s17, s37, 1245248
    s_bitset0_b32 s17, 21
    s_add_u32 s17, s17, s20
    buffer_load_dwordx4 v7, s[8:11], s17 offen lds
    s_add_u32 m0, s19, 19456
    s_add_u32 s17, s37, 1278016
    s_bitset0_b32 s17, 21
    s_add_u32 s17, s17, s20
    buffer_load_dwordx4 v7, s[8:11], s17 offen lds
    s_waitcnt vmcnt(28)
    ds_read_b64_tr_b16 v[216:217], v8 offset:22528
    ds_read_b64_tr_b16 v[218:219], v8 offset:22784
    ds_read_b64_tr_b16 v[220:221], v8 offset:22560
    ds_read_b64_tr_b16 v[222:223], v8 offset:22816
    s_waitcnt lgkmcnt(4)
    s_add_u32 m0, s19, 20480
    s_add_u32 s17, s37, 1376320
    s_bitset0_b32 s17, 21
    s_add_u32 s17, s17, s20
    buffer_load_dwordx4 v7, s[8:11], s17 offen lds
    s_add_u32 m0, s19, 21504
    s_add_u32 s17, s37, 1409088
    s_bitset0_b32 s17, 21
    s_add_u32 s17, s17, s20
    buffer_load_dwordx4 v7, s[8:11], s17 offen lds
    s_waitcnt vmcnt(28)
    ds_read_b64_tr_b16 v[224:225], v8 offset:24576
    ds_read_b64_tr_b16 v[226:227], v8 offset:24832
    ds_read_b64_tr_b16 v[228:229], v8 offset:24608
    ds_read_b64_tr_b16 v[230:231], v8 offset:24864
    s_waitcnt lgkmcnt(4)
    s_add_u32 m0, s19, 22528
    s_add_u32 s17, s37, 1507392
    s_bitset0_b32 s17, 21
    s_add_u32 s17, s17, s20
    buffer_load_dwordx4 v7, s[8:11], s17 offen lds
    s_add_u32 m0, s19, 23552
    s_add_u32 s17, s37, 1540160
    s_bitset0_b32 s17, 21
    s_add_u32 s17, s17, s20
    buffer_load_dwordx4 v7, s[8:11], s17 offen lds
    s_waitcnt vmcnt(28)
    ds_read_b64_tr_b16 v[232:233], v8 offset:26624
    ds_read_b64_tr_b16 v[234:235], v8 offset:26880
    ds_read_b64_tr_b16 v[236:237], v8 offset:26656
    ds_read_b64_tr_b16 v[238:239], v8 offset:26912
    s_waitcnt lgkmcnt(4)
    s_add_u32 m0, s19, 24576
    s_add_u32 s17, s37, 1638464
    s_bitset0_b32 s17, 21
    s_add_u32 s17, s17, s20
    buffer_load_dwordx4 v7, s[8:11], s17 offen lds
    s_add_u32 m0, s19, 25600
    s_add_u32 s17, s37, 1671232
    s_bitset0_b32 s17, 21
    s_add_u32 s17, s17, s20
    buffer_load_dwordx4 v7, s[8:11], s17 offen lds
    s_waitcnt vmcnt(28)
    ds_read_b64_tr_b16 v[240:241], v8 offset:28672
    ds_read_b64_tr_b16 v[242:243], v8 offset:28928
    ds_read_b64_tr_b16 v[244:245], v8 offset:28704
    ds_read_b64_tr_b16 v[246:247], v8 offset:28960
    s_waitcnt lgkmcnt(4)
    s_add_u32 m0, s19, 26624
    s_add_u32 s17, s37, 1769536
    s_bitset0_b32 s17, 21
    s_add_u32 s17, s17, s20
    buffer_load_dwordx4 v7, s[8:11], s17 offen lds
    s_add_u32 m0, s19, 27648
    s_add_u32 s17, s37, 1802304
    s_bitset0_b32 s17, 21
    s_add_u32 s17, s17, s20
    buffer_load_dwordx4 v7, s[8:11], s17 offen lds
    s_waitcnt vmcnt(28)
    ds_read_b64_tr_b16 v[248:249], v8 offset:30720
    ds_read_b64_tr_b16 v[250:251], v8 offset:30976
    ds_read_b64_tr_b16 v[252:253], v8 offset:30752
    ds_read_b64_tr_b16 v[254:255], v8 offset:31008
    s_waitcnt lgkmcnt(4)
    s_add_u32 m0, s19, 28672
    s_add_u32 s17, s37, 1900608
    s_bitset0_b32 s17, 21
    s_add_u32 s17, s17, s20
    buffer_load_dwordx4 v7, s[8:11], s17 offen lds
    s_add_u32 m0, s19, 29696
    s_add_u32 s17, s37, 1933376
    s_bitset0_b32 s17, 21
    s_add_u32 s17, s17, s20
    buffer_load_dwordx4 v7, s[8:11], s17 offen lds
    s_waitcnt lgkmcnt(0)
    s_add_u32 m0, s19, 30720
    s_add_u32 s17, s37, 2031680
    s_bitset0_b32 s17, 21
    s_add_u32 s17, s17, s20
    buffer_load_dwordx4 v7, s[8:11], s17 offen lds
    s_add_u32 m0, s19, 31744
    s_add_u32 s17, s37, 2064448
    s_bitset0_b32 s17, 21
    s_add_u32 s17, s17, s20
    buffer_load_dwordx4 v7, s[8:11], s17 offen lds
    s_lshr_b32 s37, s37, 6
    s_add_u32 s37, s37, 54525952
    v_lshlrev_b32 v15, 4, v1
    v_add_u32 v10, s19, v15
    s_lshl_b32 s17, s16, 10
    s_add_u32 s17, s17, 131072
    v_add_u32 v14, s17, v15
    s_lshl_b32 s17, s16, 12
    s_add_u32 s18, s17, 147456
    v_add_u32 v15, s18, v15
    v_bfe_u32 v11, v1, 3, 2
    v_and_b32 v5, 7, v1
    v_lshlrev_b32 v5, 9, v5
    v_lshl_add_u32 v11, v11, 7, v5
    s_add_u32 s17, s17, 100728832
    v_add_u32 v11, s17, v11
    v_mov_b32 v12, 0
    v_and_b32 v13, 15, v1
    v_lshrrev_b32 v5, 4, v1
    v_lshlrev_b32 v5, 3, v5
    v_lshl_add_u32 v13, v13, 12, v5
    s_lshl_b32 s17, s35, 7
    s_lshl_b32 s18, s16, 5
    s_add_u32 s17, s17, s18
    s_add_u32 s17, s17, 2048
    v_add_u32 v13, s17, v13
    s_waitcnt vmcnt(0)
U_wait:
    s_mov_b32 s29, s92
U_fl:
    s_lshr_b32 s17, s28, 3
    v_cmp_ge_u32 vcc, s17, v12
    s_lshl_b32 s18, s28, 2
    s_and_b32 s18, s18, 24
    s_lshr_b32 s17, vcc_lo, s18
    s_and_b32 s17, s17, 0xff
    s_cbranch_scc0 U_go
    s_cmp_ge_u32 s29, 1048576
    s_cselect_b32 s92, 1048576, s92
    s_cbranch_scc1 U_go
    s_lshl_b32 s17, s17, s18
    s_cmp_eq_u32 s29, 0
    s_cselect_b32 exec_lo, -1, s17
    s_mov_b32 exec_hi, 0
    s_add_u32 s29, s29, 1
    buffer_load_dword v12, v11, s[4:7], 0 offen sc1
    s_mov_b64 exec, -1
    s_sleep 2
    s_waitcnt vmcnt(0)
    s_branch U_fl
U_go:
    s_lshl_b32 s30, s28, 17
    s_add_u32 s30, s30, s37
    buffer_load_dwordx4 v[64:67], v10, s[4:7], s30 offen offset:0
    buffer_load_dwordx4 v[68:71], v10, s[4:7], s30 offen offset:1024
    buffer_load_dwordx4 v[72:75], v10, s[4:7], s30 offen offset:2048
    buffer_load_dwordx4 v[76:79], v10, s[4:7], s30 offen offset:3072
    s_add_u32 s30, s30, 4096
    s_bitset0_b32 s30, 15
    buffer_load_dwordx4 v[80:83], v10, s[4:7], s30 offen offset:0
    buffer_load_dwordx4 v[84:87], v10, s[4:7], s30 offen offset:1024
    buffer_load_dwordx4 v[88:91], v10, s[4:7], s30 offen offset:2048
    buffer_load_dwordx4 v[92:95], v10, s[4:7], s30 offen offset:3072
    s_add_u32 s30, s30, 4096
    s_bitset0_b32 s30, 15
    buffer_load_dwordx4 v[96:99], v10, s[4:7], s30 offen offset:0
    buffer_load_dwordx4 v[100:103], v10, s[4:7], s30 offen offset:1024
    buffer_load_dwordx4 v[104:107], v10, s[4:7], s30 offen offset:2048
    buffer_load_dwordx4 v[108:111], v10, s[4:7], s30 offen offset:3072
    s_add_u32 s30, s30, 4096
    s_bitset0_b32 s30, 15
    buffer_load_dwordx4 v[112:115], v10, s[4:7], s30 offen offset:0
    buffer_load_dwordx4 v[116:119], v10, s[4:7], s30 offen offset:1024
    buffer_load_dwordx4 v[120:123], v10, s[4:7], s30 offen offset:2048
    s_mov_b32 s34, 0
    s_mov_b32 s31, 1073741824
    ds_read_b64_tr_b16 v[32:33], v8 offset:0
    ds_read_b64_tr_b16 v[34:35], v8 offset:256
    ds_read_b64_tr_b16 v[36:37], v8 offset:32
    ds_read_b64_tr_b16 v[38:39], v8 offset:288
    ds_read_b128 v[48:51], v15 offset:0
    ds_read_b128 v[52:55], v15 offset:1024
    ds_read_b128 v[56:59], v15 offset:2048
    ds_read_b128 v[60:63], v15 offset:3072
.p2align 6
U_item:
    s_waitcnt vmcnt(14)
    v_mfma_f32_16x16x32_bf16 v[16:19], a[0:3], v[64:67], 0
    buffer_load_dwordx4 v[124:127], v10, s[4:7], s30 offen offset:3072
    v_mfma_f32_16x16x32_bf16 v[20:23], a[4:7], v[64:67], 0
    s_add_u32 s33, s28, 6
    s_lshr_b32 s17, s33, 3
    v_cmp_ge_u32 vcc, s17, v12
    s_lshl_b32 s18, s33, 2
    s_and_b32 s18, s18, 24
    v_mfma_f32_16x16x32_bf16 v[24:27], v[128:131], v[64:67], 0
    s_lshr_b32 s17, vcc_lo, s18
    s_and_b32 s17, s17, 0xff
    s_lshl_b32 exec_lo, s17, s18
    s_mov_b32 exec_hi, 0
    buffer_load_dword v12, v11, s[4:7], 0 offen sc1
    s_mov_b64 exec, -1
    v_mfma_f32_16x16x32_bf16 v[28:31], v[132:135], v[64:67], 0
    s_waitcnt vmcnt(15)
    s_waitcnt lgkmcnt(4)
    v_mfma_f32_16x16x32_bf16 v[16:19], a[8:11], v[68:71], v[16:19]
    s_add_u32 s30, s30, 4096
    s_bitset0_b32 s30, 15
    buffer_load_dwordx4 v[64:67], v10, s[4:7], s30 offen offset:0
    ds_read_b64_tr_b16 v[40:41], v8 offset:2048
    ds_read_b64_tr_b16 v[42:43], v8 offset:2304
    v_mfma_f32_16x16x32_bf16 v[20:23], a[12:15], v[68:71], v[20:23]
    ds_read_b64_tr_b16 v[44:45], v8 offset:2080
    ds_read_b64_tr_b16 v[46:47], v8 offset:2336
    v_mfma_f32_16x16x32_bf16 v[24:27], v[32:35], v[68:71], v[24:27]
    v_mfma_f32_16x16x32_bf16 v[28:31], v[36:39], v[68:71], v[28:31]
    s_waitcnt vmcnt(15)
    v_mfma_f32_16x16x32_bf16 v[16:19], a[16:19], v[72:75], v[16:19]
    buffer_load_dwordx4 v[68:71], v10, s[4:7], s30 offen offset:1024
    v_mfma_f32_16x16x32_bf16 v[20:23], a[20:23], v[72:75], v[20:23]
    s_waitcnt lgkmcnt(4)
    s_cmp_eq_u32 s34, 0
    s_cbranch_scc1 U_nb
    s_barrier
U_nb:
    v_mfma_f32_16x16x32_bf16 v[24:27], v[136:139], v[72:75], v[24:27]
    ds_read_b128 v[48:51], v15 offset:0
    ds_read_b128 v[52:55], v15 offset:1024
    v_mfma_f32_16x16x32_bf16 v[28:31], v[140:143], v[72:75], v[28:31]
    ds_read_b128 v[56:59], v15 offset:2048
    ds_read_b128 v[60:63], v15 offset:3072
    s_waitcnt vmcnt(15)
    s_waitcnt lgkmcnt(4)
    v_mfma_f32_16x16x32_bf16 v[16:19], a[24:27], v[76:79], v[16:19]
    buffer_load_dwordx4 v[72:75], v10, s[4:7], s30 offen offset:2048
    ds_read_b64_tr_b16 v[32:33], v8 offset:4096
    ds_read_b64_tr_b16 v[34:35], v8 offset:4352
    v_mfma_f32_16x16x32_bf16 v[20:23], a[28:31], v[76:79], v[20:23]
    ds_read_b64_tr_b16 v[36:37], v8 offset:4128
    ds_read_b64_tr_b16 v[38:39], v8 offset:4384
    v_mfma_f32_16x16x32_bf16 v[24:27], v[40:43], v[76:79], v[24:27]
    v_mfma_f32_16x16x32_bf16 v[28:31], v[44:47], v[76:79], v[28:31]
    s_waitcnt vmcnt(15)
    v_mfma_f32_16x16x32_bf16 v[16:19], a[32:35], v[80:83], v[16:19]
    buffer_load_dwordx4 v[76:79], v10, s[4:7], s30 offen offset:3072
    s_waitcnt lgkmcnt(4)
    v_mfma_f32_16x16x32_bf16 v[20:23], a[36:39], v[80:83], v[20:23]
    v_add_f32 v48, v48, v52
    v_add_f32 v49, v49, v53
    v_mfma_f32_16x16x32_bf16 v[24:27], v[144:147], v[80:83], v[24:27]
    v_add_f32 v50, v50, v54
    v_add_f32 v51, v51, v55
    v_mfma_f32_16x16x32_bf16 v[28:31], v[148:151], v[80:83], v[28:31]
    s_waitcnt vmcnt(15)
    s_waitcnt lgkmcnt(0)
    v_mfma_f32_16x16x32_bf16 v[16:19], a[40:43], v[84:87], v[16:19]
    s_add_u32 s30, s30, 4096
    s_bitset0_b32 s30, 15
    buffer_load_dwordx4 v[80:83], v10, s[4:7], s30 offen offset:0
    ds_read_b64_tr_b16 v[40:41], v8 offset:6144
    ds_read_b64_tr_b16 v[42:43], v8 offset:6400
    v_mfma_f32_16x16x32_bf16 v[20:23], a[44:47], v[84:87], v[20:23]
    v_add_f32 v56, v56, v60
    v_add_f32 v57, v57, v61
    ds_read_b64_tr_b16 v[44:45], v8 offset:6176
    ds_read_b64_tr_b16 v[46:47], v8 offset:6432
    v_mfma_f32_16x16x32_bf16 v[24:27], v[32:35], v[84:87], v[24:27]
    v_add_f32 v58, v58, v62
    v_add_f32 v59, v59, v63
    v_mfma_f32_16x16x32_bf16 v[28:31], v[36:39], v[84:87], v[28:31]
    s_waitcnt vmcnt(15)
    v_mfma_f32_16x16x32_bf16 v[16:19], a[48:51], v[88:91], v[16:19]
    buffer_load_dwordx4 v[84:87], v10, s[4:7], s30 offen offset:1024
    v_mfma_f32_16x16x32_bf16 v[20:23], a[52:55], v[88:91], v[20:23]
    v_add_f32 v48, v48, v56
    v_add_f32 v49, v49, v57
    v_mfma_f32_16x16x32_bf16 v[24:27], v[152:155], v[88:91], v[24:27]
    v_add_f32 v50, v50, v58
    v_add_f32 v51, v51, v59
    v_mfma_f32_16x16x32_bf16 v[28:31], v[156:159], v[88:91], v[28:31]
    s_waitcnt vmcnt(15)
    s_waitcnt lgkmcnt(0)
    v_mfma_f32_16x16x32_bf16 v[16:19], a[56:59], v[92:95], v[16:19]
    buffer_load_dwordx4 v[88:91], v10, s[4:7], s30 offen offset:2048
    ds_read_b64_tr_b16 v[32:33], v8 offset:8192
    ds_read_b64_tr_b16 v[34:35], v8 offset:8448
    v_mfma_f32_16x16x32_bf16 v[20:23], a[60:63], v[92:95], v[20:23]
    v_cvt_pk_bf16_f32 v52, v48, v49
    v_cvt_pk_bf16_f32 v53, v50, v51
    ds_read_b64_tr_b16 v[36:37], v8 offset:8224
    ds_read_b64_tr_b16 v[38:39], v8 offset:8480
    v_mfma_f32_16x16x32_bf16 v[24:27], v[40:43], v[92:95], v[24:27]
    v_mfma_f32_16x16x32_bf16 v[28:31], v[44:47], v[92:95], v[28:31]
    s_waitcnt vmcnt(15)
    v_mfma_f32_16x16x32_bf16 v[16:19], a[64:67], v[96:99], v[16:19]
    buffer_load_dwordx4 v[92:95], v10, s[4:7], s30 offen offset:3072
    v_mfma_f32_16x16x32_bf16 v[20:23], a[68:71], v[96:99], v[20:23]
    buffer_store_dwordx2 v[52:53], v13, s[12:15], s31 offen
    v_xor_b32 v15, 0x4000, v15
    v_mfma_f32_16x16x32_bf16 v[24:27], v[160:163], v[96:99], v[24:27]
    v_mfma_f32_16x16x32_bf16 v[28:31], v[164:167], v[96:99], v[28:31]
    s_waitcnt vmcnt(16)
    s_waitcnt lgkmcnt(0)
    v_mfma_f32_16x16x32_bf16 v[16:19], a[72:75], v[100:103], v[16:19]
    s_add_u32 s30, s30, 4096
    s_bitset0_b32 s30, 15
    buffer_load_dwordx4 v[96:99], v10, s[4:7], s30 offen offset:0
    ds_read_b64_tr_b16 v[40:41], v8 offset:10240
    ds_read_b64_tr_b16 v[42:43], v8 offset:10496
    v_mfma_f32_16x16x32_bf16 v[20:23], a[76:79], v[100:103], v[20:23]
    ds_read_b64_tr_b16 v[44:45], v8 offset:10272
    ds_read_b64_tr_b16 v[46:47], v8 offset:10528
    v_mfma_f32_16x16x32_bf16 v[24:27], v[32:35], v[100:103], v[24:27]
    v_mfma_f32_16x16x32_bf16 v[28:31], v[36:39], v[100:103], v[28:31]
    s_waitcnt vmcnt(16)
    v_mfma_f32_16x16x32_bf16 v[16:19], a[80:83], v[104:107], v[16:19]
    buffer_load_dwordx4 v[100:103], v10, s[4:7], s30 offen offset:1024
    v_mfma_f32_16x16x32_bf16 v[20:23], a[84:87], v[104:107], v[20:23]
    v_mfma_f32_16x16x32_bf16 v[24:27], v[168:171], v[104:107], v[24:27]
    v_mfma_f32_16x16x32_bf16 v[28:31], v[172:175], v[104:107], v[28:31]
    s_waitcnt vmcnt(16)
    s_waitcnt lgkmcnt(0)
    v_mfma_f32_16x16x32_bf16 v[16:19], a[88:91], v[108:111], v[16:19]
    buffer_load_dwordx4 v[104:107], v10, s[4:7], s30 offen offset:2048
    ds_read_b64_tr_b16 v[32:33], v8 offset:12288
    ds_read_b64_tr_b16 v[34:35], v8 offset:12544
    v_mfma_f32_16x16x32_bf16 v[20:23], a[92:95], v[108:111], v[20:23]
    ds_read_b64_tr_b16 v[36:37], v8 offset:12320
    ds_read_b64_tr_b16 v[38:39], v8 offset:12576
    v_mfma_f32_16x16x32_bf16 v[24:27], v[40:43], v[108:111], v[24:27]
    v_mfma_f32_16x16x32_bf16 v[28:31], v[44:47], v[108:111], v[28:31]
    s_waitcnt vmcnt(16)
    v_mfma_f32_16x16x32_bf16 v[16:19], a[96:99], v[112:115], v[16:19]
    buffer_load_dwordx4 v[108:111], v10, s[4:7], s30 offen offset:3072
    v_mfma_f32_16x16x32_bf16 v[20:23], a[100:103], v[112:115], v[20:23]
    v_mfma_f32_16x16x32_bf16 v[24:27], v[176:179], v[112:115], v[24:27]
    v_mfma_f32_16x16x32_bf16 v[28:31], v[180:183], v[112:115], v[28:31]
    s_waitcnt vmcnt(16)
    s_waitcnt lgkmcnt(0)
    v_mfma_f32_16x16x32_bf16 v[16:19], a[104:107], v[116:119], v[16:19]
    s_add_u32 s30, s30, 4096
    s_bitset0_b32 s30, 15
    buffer_load_dwordx4 v[112:115], v10, s[4:7], s30 offen offset:0
    ds_read_b64_tr_b16 v[40:41], v8 offset:14336
    ds_read_b64_tr_b16 v[42:43], v8 offset:14592
    v_mfma_f32_16x16x32_bf16 v[20:23], a[108:111], v[116:119], v[20:23]
    ds_read_b64_tr_b16 v[44:45], v8 offset:14368
    ds_read_b64_tr_b16 v[46:47], v8 offset:14624
    v_mfma_f32_16x16x32_bf16 v[24:27], v[32:35], v[116:119], v[24:27]
    v_mfma_f32_16x16x32_bf16 v[28:31], v[36:39], v[116:119], v[28:31]
    s_waitcnt vmcnt(16)
    v_mfma_f32_16x16x32_bf16 v[16:19], a[112:115], v[120:123], v[16:19]
    buffer_load_dwordx4 v[116:119], v10, s[4:7], s30 offen offset:1024
    v_mfma_f32_16x16x32_bf16 v[20:23], a[116:119], v[120:123], v[20:23]
    v_mfma_f32_16x16x32_bf16 v[24:27], v[184:187], v[120:123], v[24:27]
    v_mfma_f32_16x16x32_bf16 v[28:31], v[188:191], v[120:123], v[28:31]
    s_waitcnt vmcnt(16)
    s_waitcnt lgkmcnt(0)
    v_mfma_f32_16x16x32_bf16 v[16:19], a[120:123], v[124:127], v[16:19]
    buffer_load_dwordx4 v[120:123], v10, s[4:7], s30 offen offset:2048
    ds_read_b64_tr_b16 v[32:33], v8 offset:16384
    ds_read_b64_tr_b16 v[34:35], v8 offset:16640
    v_mfma_f32_16x16x32_bf16 v[20:23], a[124:127], v[124:127], v[20:23]
    ds_read_b64_tr_b16 v[36:37], v8 offset:16416
    ds_read_b64_tr_b16 v[38:39], v8 offset:16672
    v_mfma_f32_16x16x32_bf16 v[24:27], v[40:43], v[124:127], v[24:27]
    v_mfma_f32_16x16x32_bf16 v[28:31], v[44:47], v[124:127], v[28:31]
    s_waitcnt vmcnt(15)
    v_mfma_f32_16x16x32_bf16 v[16:19], a[128:131], v[64:67], v[16:19]
    buffer_load_dwordx4 v[124:127], v10, s[4:7], s30 offen offset:3072
    v_mfma_f32_16x16x32_bf16 v[20:23], a[132:135], v[64:67], v[20:23]
    s_lshr_b32 s17, s33, 3
    v_cmp_ge_u32 vcc, s17, v12
    s_lshl_b32 s18, s33, 2
    s_and_b32 s18, s18, 24
    v_mfma_f32_16x16x32_bf16 v[24:27], v[192:195], v[64:67], v[24:27]
    s_lshl_b32 s30, s33, 17
    s_add_u32 s30, s30, s37
    s_lshr_b32 s17, vcc_lo, s18
    s_and_b32 s17, s17, 0xff
    s_cselect_b32 s34, 0, 1
    s_cselect_b32 s30, 1073741824, s30
    v_mfma_f32_16x16x32_bf16 v[28:31], v[196:199], v[64:67], v[28:31]
    s_waitcnt vmcnt(15)
    s_waitcnt lgkmcnt(0)
    v_mfma_f32_16x16x32_bf16 v[16:19], a[136:139], v[68:71], v[16:19]
    buffer_load_dwordx4 v[64:67], v10, s[4:7], s30 offen offset:0
    ds_read_b64_tr_b16 v[40:41], v8 offset:18432
    ds_read_b64_tr_b16 v[42:43], v8 offset:18688
    v_mfma_f32_16x16x32_bf16 v[20:23], a[140:143], v[68:71], v[20:23]
    ds_read_b64_tr_b16 v[44:45], v8 offset:18464
    ds_read_b64_tr_b16 v[46:47], v8 offset:18720
    v_mfma_f32_16x16x32_bf16 v[24:27], v[32:35], v[68:71], v[24:27]
    v_mfma_f32_16x16x32_bf16 v[28:31], v[36:39], v[68:71], v[28:31]
    s_waitcnt vmcnt(15)
    v_mfma_f32_16x16x32_bf16 v[16:19], a[144:147], v[72:75], v[16:19]
    buffer_load_dwordx4 v[68:71], v10, s[4:7], s30 offen offset:1024
    v_mfma_f32_16x16x32_bf16 v[20:23], a[148:151], v[72:75], v[20:23]
    v_mfma_f32_16x16x32_bf16 v[24:27], v[200:203], v[72:75], v[24:27]
    v_mfma_f32_16x16x32_bf16 v[28:31], v[204:207], v[72:75], v[28:31]
    s_waitcnt vmcnt(15)
    s_waitcnt lgkmcnt(0)
    v_mfma_f32_16x16x32_bf16 v[16:19], a[152:155], v[76:79], v[16:19]
    buffer_load_dwordx4 v[72:75], v10, s[4:7], s30 offen offset:2048
    ds_read_b64_tr_b16 v[32:33], v8 offset:20480
    ds_read_b64_tr_b16 v[34:35], v8 offset:20736
    v_mfma_f32_16x16x32_bf16 v[20:23], a[156:159], v[76:79], v[20:23]
    ds_read_b64_tr_b16 v[36:37], v8 offset:20512
    ds_read_b64_tr_b16 v[38:39], v8 offset:20768
    v_mfma_f32_16x16x32_bf16 v[24:27], v[40:43], v[76:79], v[24:27]
    v_mfma_f32_16x16x32_bf16 v[28:31], v[44:47], v[76:79], v[28:31]
    s_waitcnt vmcnt(15)
    v_mfma_f32_16x16x32_bf16 v[16:19], a[160:163], v[80:83], v[16:19]
    buffer_load_dwordx4 v[76:79], v10, s[4:7], s30 offen offset:3072
    v_mfma_f32_16x16x32_bf16 v[20:23], a[164:167], v[80:83], v[20:23]
    v_mfma_f32_16x16x32_bf16 v[24:27], v[208:211], v[80:83], v[24:27]
    v_mfma_f32_16x16x32_bf16 v[28:31], v[212:215], v[80:83], v[28:31]
    s_waitcnt vmcnt(15)
    s_waitcnt lgkmcnt(0)
    v_mfma_f32_16x16x32_bf16 v[16:19], a[168:171], v[84:87], v[16:19]
    s_add_u32 s30, s30, 4096
    s_bitset0_b32 s30, 15
    buffer_load_dwordx4 v[80:83], v10, s[4:7], s30 offen offset:0
    ds_read_b64_tr_b16 v[40:41], v8 offset:22528
    ds_read_b64_tr_b16 v[42:43], v8 offset:22784
    v_mfma_f32_16x16x32_bf16 v[20:23], a[172:175], v[84:87], v[20:23]
    ds_read_b64_tr_b16 v[44:45], v8 offset:22560
    ds_read_b64_tr_b16 v[46:47], v8 offset:22816
    v_mfma_f32_16x16x32_bf16 v[24:27], v[32:35], v[84:87], v[24:27]
    v_mfma_f32_16x16x32_bf16 v[28:31], v[36:39], v[84:87], v[28:31]
    s_waitcnt vmcnt(15)
    v_mfma_f32_16x16x32_bf16 v[16:19], a[176:179], v[88:91], v[16:19]
    buffer_load_dwordx4 v[84:87], v10, s[4:7], s30 offen offset:1024
    v_mfma_f32_16x16x32_bf16 v[20:23], a[180:183], v[88:91], v[20:23]
    v_mfma_f32_16x16x32_bf16 v[24:27], v[216:219], v[88:91], v[24:27]
    v_mfma_f32_16x16x32_bf16 v[28:31], v[220:223], v[88:91], v[28:31]
    s_waitcnt vmcnt(15)
    s_waitcnt lgkmcnt(0)
    v_mfma_f32_16x16x32_bf16 v[16:19], a[184:187], v[92:95], v[16:19]
    buffer_load_dwordx4 v[88:91], v10, s[4:7], s30 offen offset:2048
    ds_read_b64_tr_b16 v[32:33], v8 offset:24576
    ds_read_b64_tr_b16 v[34:35], v8 offset:24832
    v_mfma_f32_16x16x32_bf16 v[20:23], a[188:191], v[92:95], v[20:23]
    ds_read_b64_tr_b16 v[36:37], v8 offset:24608
    ds_read_b64_tr_b16 v[38:39], v8 offset:24864
    v_mfma_f32_16x16x32_bf16 v[24:27], v[40:43], v[92:95], v[24:27]
    v_mfma_f32_16x16x32_bf16 v[28:31], v[44:47], v[92:95], v[28:31]
    s_waitcnt vmcnt(14)
    v_mfma_f32_16x16x32_bf16 v[16:19], a[192:195], v[96:99], v[16:19]
    buffer_load_dwordx4 v[92:95], v10, s[4:7], s30 offen offset:3072
    v_mfma_f32_16x16x32_bf16 v[20:23], a[196:199], v[96:99], v[20:23]
    v_mfma_f32_16x16x32_bf16 v[24:27], v[224:227], v[96:99], v[24:27]
    v_mfma_f32_16x16x32_bf16 v[28:31], v[228:231], v[96:99], v[28:31]
    s_waitcnt vmcnt(14)
    s_waitcnt lgkmcnt(0)
    v_mfma_f32_16x16x32_bf16 v[16:19], a[200:203], v[100:103], v[16:19]
    s_add_u32 s30, s30, 4096
    s_bitset0_b32 s30, 15
    buffer_load_dwordx4 v[96:99], v10, s[4:7], s30 offen offset:0
    ds_read_b64_tr_b16 v[40:41], v8 offset:26624
    ds_read_b64_tr_b16 v[42:43], v8 offset:26880
    v_mfma_f32_16x16x32_bf16 v[20:23], a[204:207], v[100:103], v[20:23]
    ds_read_b64_tr_b16 v[44:45], v8 offset:26656
    ds_read_b64_tr_b16 v[46:47], v8 offset:26912
    v_mfma_f32_16x16x32_bf16 v[24:27], v[32:35], v[100:103], v[24:27]
    v_mfma_f32_16x16x32_bf16 v[28:31], v[36:39], v[100:103], v[28:31]
    s_waitcnt vmcnt(14)
    v_mfma_f32_16x16x32_bf16 v[16:19], a[208:211], v[104:107], v[16:19]
    buffer_load_dwordx4 v[100:103], v10, s[4:7], s30 offen offset:1024
    v_mfma_f32_16x16x32_bf16 v[20:23], a[212:215], v[104:107], v[20:23]
    v_mfma_f32_16x16x32_bf16 v[24:27], v[232:235], v[104:107], v[24:27]
    v_mfma_f32_16x16x32_bf16 v[28:31], v[236:239], v[104:107], v[28:31]
    s_waitcnt vmcnt(14)
    s_waitcnt lgkmcnt(0)
    v_mfma_f32_16x16x32_bf16 v[16:19], a[216:219], v[108:111], v[16:19]
    buffer_load_dwordx4 v[104:107], v10, s[4:7], s30 offen offset:2048
    ds_read_b64_tr_b16 v[32:33], v8 offset:28672
    ds_read_b64_tr_b16 v[34:35], v8 offset:28928
    v_mfma_f32_16x16x32_bf16 v[20:23], a[220:223], v[108:111], v[20:23]
    ds_read_b64_tr_b16 v[36:37], v8 offset:28704
    ds_read_b64_tr_b16 v[38:39], v8 offset:28960
    v_mfma_f32_16x16x32_bf16 v[24:27], v[40:43], v[108:111], v[24:27]
    v_mfma_f32_16x16x32_bf16 v[28:31], v[44:47], v[108:111], v[28:31]
    s_waitcnt vmcnt(14)
    v_mfma_f32_16x16x32_bf16 v[16:19], a[224:227], v[112:115], v[16:19]
    buffer_load_dwordx4 v[108:111], v10, s[4:7], s30 offen offset:3072
    v_mfma_f32_16x16x32_bf16 v[20:23], a[228:231], v[112:115], v[20:23]
    v_mfma_f32_16x16x32_bf16 v[24:27], v[240:243], v[112:115], v[24:27]
    v_mfma_f32_16x16x32_bf16 v[28:31], v[244:247], v[112:115], v[28:31]
    s_waitcnt vmcnt(14)
    s_waitcnt lgkmcnt(0)
    v_mfma_f32_16x16x32_bf16 v[16:19], a[232:235], v[116:119], v[16:19]
    s_add_u32 s30, s30, 4096
    s_bitset0_b32 s30, 15
    buffer_load_dwordx4 v[112:115], v10, s[4:7], s30 offen offset:0
    ds_read_b64_tr_b16 v[40:41], v8 offset:30720
    ds_read_b64_tr_b16 v[42:43], v8 offset:30976
    v_mfma_f32_16x16x32_bf16 v[20:23], a[236:239], v[116:119], v[20:23]
    ds_read_b64_tr_b16 v[44:45], v8 offset:30752
    ds_read_b64_tr_b16 v[46:47], v8 offset:31008
    v_mfma_f32_16x16x32_bf16 v[24:27], v[32:35], v[116:119], v[24:27]
    v_mfma_f32_16x16x32_bf16 v[28:31], v[36:39], v[116:119], v[28:31]
    s_waitcnt vmcnt(14)
    v_mfma_f32_16x16x32_bf16 v[16:19], a[240:243], v[120:123], v[16:19]
    buffer_load_dwordx4 v[116:119], v10, s[4:7], s30 offen offset:1024
    v_mfma_f32_16x16x32_bf16 v[20:23], a[244:247], v[120:123], v[20:23]
    v_mfma_f32_16x16x32_bf16 v[24:27], v[248:251], v[120:123], v[24:27]
    v_mfma_f32_16x16x32_bf16 v[28:31], v[252:255], v[120:123], v[28:31]
    s_waitcnt vmcnt(14)
    s_waitcnt lgkmcnt(0)
    v_mfma_f32_16x16x32_bf16 v[16:19], a[248:251], v[124:127], v[16:19]
    buffer_load_dwordx4 v[120:123], v10, s[4:7], s30 offen offset:2048
    ds_read_b64_tr_b16 v[32:33], v8 offset:0
    ds_read_b64_tr_b16 v[34:35], v8 offset:256
    v_mfma_f32_16x16x32_bf16 v[20:23], a[252:255], v[124:127], v[20:23]
    ds_read_b64_tr_b16 v[36:37], v8 offset:32
    ds_read_b64_tr_b16 v[38:39], v8 offset:288
    v_mfma_f32_16x16x32_bf16 v[24:27], v[40:43], v[124:127], v[24:27]
    v_mfma_f32_16x16x32_bf16 v[28:31], v[44:47], v[124:127], v[28:31]
    s_lshl_b32 s31, s28, 16
    s_mov_b32 s28, s33
    s_cmp_eq_u32 s34, 1
    ds_write_b128 v14, v[16:19] offset:0
    ds_write_b128 v14, v[20:23] offset:4096
    ds_write_b128 v14, v[24:27] offset:8192
    s_nop 1
    ds_write_b128 v14, v[28:31] offset:12288
    v_xor_b32 v14, 0x4000, v14
    s_cbranch_scc1 U_item
    s_waitcnt lgkmcnt(0)
    s_barrier
    ds_read_b128 v[48:51], v15 offset:0
    ds_read_b128 v[52:55], v15 offset:1024
    ds_read_b128 v[56:59], v15 offset:2048
    ds_read_b128 v[60:63], v15 offset:3072
    s_waitcnt lgkmcnt(0)
    v_add_f32 v48, v48, v52
    v_add_f32 v49, v49, v53
    v_add_f32 v50, v50, v54
    v_add_f32 v51, v51, v55
    v_add_f32 v56, v56, v60
    v_add_f32 v57, v57, v61
    v_add_f32 v58, v58, v62
    v_add_f32 v59, v59, v63
    v_add_f32 v48, v48, v56
    v_add_f32 v49, v49, v57
    v_add_f32 v50, v50, v58
    v_add_f32 v51, v51, v59
    v_cvt_pk_bf16_f32 v52, v48, v49
    v_cvt_pk_bf16_f32 v53, v50, v51
    buffer_store_dwordx2 v[52:53], v13, s[12:15], s31 offen
    s_cmp_lt_u32 s28, 128
    s_cbranch_scc1 U_wait
    s_branch W_fin
W_F:
    s_waitcnt vmcnt(0)
    s_barrier
    s_cmp_lg_u32 s16, 0
    s_cbranch_scc1 reg_16
    s_and_b32 s17, s2, 3
    s_lshl_b32 s17, s17, 3
    s_lshl_b32 s18, s98, 2
    s_add_u32 s17, s17, s18
    s_lshl_b32 s17, 1, s17
    s_andn2_b32 s18, s2, 3
    v_mov_b32 v5, s18
    v_mov_b32 v6, s17
    s_mov_b64 exec, 1
    global_atomic_add v5, v6, s[100:101] sc1
    s_mov_b64 exec, -1
reg_16:
    s_load_dwordx2 s[48:49], s[0:1], 8
    s_load_dwordx2 s[52:53], s[0:1], 16
    s_mov_b32 s50, 2101248
    s_mov_b32 s51, 0x20000
    s_mov_b32 s54, 2101248
    s_mov_b32 s55, 0x20000
    s_load_dwordx2 s[40:41], s[0:1], 0
    s_load_dwordx2 s[44:45], s[0:1], 24
    s_mov_b32 s42, 4194304
    s_mov_b32 s43, 0x20000
    s_mov_b32 s46, 4194304
    s_mov_b32 s47, 0x20000
    s_lshr_b32 s28, s93, 3
    s_and_b32 s29, s93, 7
    s_lshl_b32 s29, s29, 2
    s_add_u32 s29, s29, s16
    v_bfe_u32 v5, v1, 2, 2
    v_and_b32 v7, 3, v1
    v_lshl_add_u32 v7, v5, 3, v7
    s_lshl_b32 s17, s29, 5
    v_add_u32 v7, s17, v7
    v_lshrrev_b32 v8, 4, v1
    v_cvt_f32_u32 v8, v8
    s_mov_b32 s31, 981467136
    v_add_u32 v5, 0, v7
    v_lshrrev_b32 v6, 1, v5
    v_and_b32 v30, 1, v5
    v_cmp_eq_u32 vcc, 1, v5
    v_mov_b32 v5, 512
    s_nop 0
    v_cndmask_b32 v6, v6, v5, vcc
    v_cndmask_b32 v30, v30, 0, vcc
    v_add_u32 v5, v6, v30
    v_bfe_i32 v40, v5, 1, 1
    v_add_u32 v5, v6, v5
    v_bfe_i32 v42, v5, 1, 1
    v_add_u32 v5, v6, v5
    v_bfe_i32 v44, v5, 1, 1
    v_and_b32 v40, 0x80008000, v40
    v_and_b32 v42, 0x80008000, v42
    v_and_b32 v44, 0x80008000, v44
    v_cvt_f32_u32 v6, v6
    v_cvt_f32_u32 v30, v30
    v_mul_f32 v32, s31, v6
    v_mul_f32 v30, 0x3e800000, v30
    v_mov_b32 v34, v32
    v_mul_f32 v36, 0x42000000, v32
    v_mul_f32 v5, 0x41000000, v32
    v_fma_f32 v30, v5, v8, v30
    v_add_u32 v5, 4, v7
    v_lshrrev_b32 v6, 1, v5
    v_and_b32 v31, 1, v5
    v_cmp_eq_u32 vcc, 1, v5
    v_mov_b32 v5, 512
    s_nop 0
    v_cndmask_b32 v6, v6, v5, vcc
    v_cndmask_b32 v31, v31, 0, vcc
    v_add_u32 v5, v6, v31
    v_bfe_i32 v41, v5, 1, 1
    v_add_u32 v5, v6, v5
    v_bfe_i32 v43, v5, 1, 1
    v_add_u32 v5, v6, v5
    v_bfe_i32 v45, v5, 1, 1
    v_and_b32 v41, 0x80008000, v41
    v_and_b32 v43, 0x80008000, v43
    v_and_b32 v45, 0x80008000, v45
    v_cvt_f32_u32 v6, v6
    v_cvt_f32_u32 v31, v31
    v_mul_f32 v33, s31, v6
    v_mul_f32 v31, 0x3e800000, v31
    v_mov_b32 v35, v33
    v_mul_f32 v37, 0x42000000, v33
    v_mul_f32 v5, 0x41000000, v33
    v_fma_f32 v31, v5, v8, v31
    v_fract_f32 v48, v30
    v_add_f32 v49, v48, v32
    v_cos_f32 v56, v48
    v_add_f32 v50, v49, v34
    v_cos_f32 v57, v49
    v_add_f32 v51, v50, v32
    v_cos_f32 v58, v50
    v_add_f32 v52, v51, v34
    v_cos_f32 v59, v51
    v_add_f32 v53, v52, v32
    v_cos_f32 v60, v52
    v_add_f32 v54, v53, v34
    v_cos_f32 v61, v53
    v_add_f32 v55, v54, v32
    v_cos_f32 v62, v54
    v_cos_f32 v63, v55
    v_add_f32 v30, v48, v36
    v_cvt_pk_bf16_f32 v64, v56, v57
    v_cvt_pk_bf16_f32 v65, v58, v59
    v_cvt_pk_bf16_f32 v66, v60, v61
    v_cvt_pk_bf16_f32 v67, v62, v63
    v_accvgpr_write_b32 a0, v64
    v_accvgpr_write_b32 a1, v65
    v_accvgpr_write_b32 a2, v66
    v_accvgpr_write_b32 a3, v67
    v_xor_b32_dpp v68, v64, v40 quad_perm:[0,1,3,2] row_mask:0xf bank_mask:0xf
    v_xor_b32_dpp v69, v65, v40 quad_perm:[0,1,3,2] row_mask:0xf bank_mask:0xf
    v_xor_b32_dpp v70, v66, v40 quad_perm:[0,1,3,2] row_mask:0xf bank_mask:0xf
    v_xor_b32_dpp v71, v67, v40 quad_perm:[0,1,3,2] row_mask:0xf bank_mask:0xf
    v_accvgpr_write_b32 a64, v68
    v_accvgpr_write_b32 a65, v69
    v_accvgpr_write_b32 a66, v70
    v_accvgpr_write_b32 a67, v71
    v_xor_b32 v68, v64, v42
    v_xor_b32 v69, v65, v42
    v_xor_b32 v70, v66, v42
    v_xor_b32 v71, v67, v42
    v_accvgpr_write_b32 a128, v68
    v_accvgpr_write_b32 a129, v69
    v_accvgpr_write_b32 a130, v70
    v_accvgpr_write_b32 a131, v71
    v_xor_b32_dpp v68, v64, v44 quad_perm:[0,1,3,2] row_mask:0xf bank_mask:0xf
    v_xor_b32_dpp v69, v65, v44 quad_perm:[0,1,3,2] row_mask:0xf bank_mask:0xf
    v_xor_b32_dpp v70, v66, v44 quad_perm:[0,1,3,2] row_mask:0xf bank_mask:0xf
    v_xor_b32_dpp v71, v67, v44 quad_perm:[0,1,3,2] row_mask:0xf bank_mask:0xf
    v_accvgpr_write_b32 a192, v68
    v_accvgpr_write_b32 a193, v69
    v_accvgpr_write_b32 a194, v70
    v_accvgpr_write_b32 a195, v71
    v_fract_f32 v48, v31
    v_add_f32 v49, v48, v33
    v_cos_f32 v56, v48
    v_add_f32 v50, v49, v35
    v_cos_f32 v57, v49
    v_add_f32 v51, v50, v33
    v_cos_f32 v58, v50
    v_add_f32 v52, v51, v35
    v_cos_f32 v59, v51
    v_add_f32 v53, v52, v33
    v_cos_f32 v60, v52
    v_add_f32 v54, v53, v35
    v_cos_f32 v61, v53
    v_add_f32 v55, v54, v33
    v_cos_f32 v62, v54
    v_cos_f32 v63, v55
    v_add_f32 v31, v48, v37
    v_cvt_pk_bf16_f32 v64, v56, v57
    v_cvt_pk_bf16_f32 v65, v58, v59
    v_cvt_pk_bf16_f32 v66, v60, v61
    v_cvt_pk_bf16_f32 v67, v62, v63
    v_accvgpr_write_b32 a4, v64
    v_accvgpr_write_b32 a5, v65
    v_accvgpr_write_b32 a6, v66
    v_accvgpr_write_b32 a7, v67
    v_xor_b32_dpp v68, v64, v41 quad_perm:[0,1,3,2] row_mask:0xf bank_mask:0xf
    v_xor_b32_dpp v69, v65, v41 quad_perm:[0,1,3,2] row_mask:0xf bank_mask:0xf
    v_xor_b32_dpp v70, v66, v41 quad_perm:[0,1,3,2] row_mask:0xf bank_mask:0xf
    v_xor_b32_dpp v71, v67, v41 quad_perm:[0,1,3,2] row_mask:0xf bank_mask:0xf
    v_accvgpr_write_b32 a68, v68
    v_accvgpr_write_b32 a69, v69
    v_accvgpr_write_b32 a70, v70
    v_accvgpr_write_b32 a71, v71
    v_xor_b32 v68, v64, v43
    v_xor_b32 v69, v65, v43
    v_xor_b32 v70, v66, v43
    v_xor_b32 v71, v67, v43
    v_accvgpr_write_b32 a132, v68
    v_accvgpr_write_b32 a133, v69
    v_accvgpr_write_b32 a134, v70
    v_accvgpr_write_b32 a135, v71
    v_xor_b32_dpp v68, v64, v45 quad_perm:[0,1,3,2] row_mask:0xf bank_mask:0xf
    v_xor_b32_dpp v69, v65, v45 quad_perm:[0,1,3,2] row_mask:0xf bank_mask:0xf
    v_xor_b32_dpp v70, v66, v45 quad_perm:[0,1,3,2] row_mask:0xf bank_mask:0xf
    v_xor_b32_dpp v71, v67, v45 quad_perm:[0,1,3,2] row_mask:0xf bank_mask:0xf
    v_accvgpr_write_b32 a196, v68
    v_accvgpr_write_b32 a197, v69
    v_accvgpr_write_b32 a198, v70
    v_accvgpr_write_b32 a199, v71
    v_fract_f32 v48, v30
    v_add_f32 v49, v48, v32
    v_cos_f32 v56, v48
    v_add_f32 v50, v49, v34
    v_cos_f32 v57, v49
    v_add_f32 v51, v50, v32
    v_cos_f32 v58, v50
    v_add_f32 v52, v51, v34
    v_cos_f32 v59, v51
    v_add_f32 v53, v52, v32
    v_cos_f32 v60, v52
    v_add_f32 v54, v53, v34
    v_cos_f32 v61, v53
    v_add_f32 v55, v54, v32
    v_cos_f32 v62, v54
    v_cos_f32 v63, v55
    v_add_f32 v30, v48, v36
    v_cvt_pk_bf16_f32 v64, v56, v57
    v_cvt_pk_bf16_f32 v65, v58, v59
    v_cvt_pk_bf16_f32 v66, v60, v61
    v_cvt_pk_bf16_f32 v67, v62, v63
    v_accvgpr_write_b32 a8, v64
    v_accvgpr_write_b32 a9, v65
    v_accvgpr_write_b32 a10, v66
    v_accvgpr_write_b32 a11, v67
    v_xor_b32_dpp v68, v64, v40 quad_perm:[0,1,3,2] row_mask:0xf bank_mask:0xf
    v_xor_b32_dpp v69, v65, v40 quad_perm:[0,1,3,2] row_mask:0xf bank_mask:0xf
    v_xor_b32_dpp v70, v66, v40 quad_perm:[0,1,3,2] row_mask:0xf bank_mask:0xf
    v_xor_b32_dpp v71, v67, v40 quad_perm:[0,1,3,2] row_mask:0xf bank_mask:0xf
    v_accvgpr_write_b32 a72, v68
    v_accvgpr_write_b32 a73, v69
    v_accvgpr_write_b32 a74, v70
    v_accvgpr_write_b32 a75, v71
    v_xor_b32 v68, v64, v42
    v_xor_b32 v69, v65, v42
    v_xor_b32 v70, v66, v42
    v_xor_b32 v71, v67, v42
    v_accvgpr_write_b32 a136, v68
    v_accvgpr_write_b32 a137, v69
    v_accvgpr_write_b32 a138, v70
    v_accvgpr_write_b32 a139, v71
    v_xor_b32_dpp v68, v64, v44 quad_perm:[0,1,3,2] row_mask:0xf bank_mask:0xf
    v_xor_b32_dpp v69, v65, v44 quad_perm:[0,1,3,2] row_mask:0xf bank_mask:0xf
    v_xor_b32_dpp v70, v66, v44 quad_perm:[0,1,3,2] row_mask:0xf bank_mask:0xf
    v_xor_b32_dpp v71, v67, v44 quad_perm:[0,1,3,2] row_mask:0xf bank_mask:0xf
    v_accvgpr_write_b32 a200, v68
    v_accvgpr_write_b32 a201, v69
    v_accvgpr_write_b32 a202, v70
    v_accvgpr_write_b32 a203, v71
    v_fract_f32 v48, v31
    v_add_f32 v49, v48, v33
    v_cos_f32 v56, v48
    v_add_f32 v50, v49, v35
    v_cos_f32 v57, v49
    v_add_f32 v51, v50, v33
    v_cos_f32 v58, v50
    v_add_f32 v52, v51, v35
    v_cos_f32 v59, v51
    v_add_f32 v53, v52, v33
    v_cos_f32 v60, v52
    v_add_f32 v54, v53, v35
    v_cos_f32 v61, v53
    v_add_f32 v55, v54, v33
    v_cos_f32 v62, v54
    v_cos_f32 v63, v55
    v_add_f32 v31, v48, v37
    v_cvt_pk_bf16_f32 v64, v56, v57
    v_cvt_pk_bf16_f32 v65, v58, v59
    v_cvt_pk_bf16_f32 v66, v60, v61
    v_cvt_pk_bf16_f32 v67, v62, v63
    v_accvgpr_write_b32 a12, v64
    v_accvgpr_write_b32 a13, v65
    v_accvgpr_write_b32 a14, v66
    v_accvgpr_write_b32 a15, v67
    v_xor_b32_dpp v68, v64, v41 quad_perm:[0,1,3,2] row_mask:0xf bank_mask:0xf
    v_xor_b32_dpp v69, v65, v41 quad_perm:[0,1,3,2] row_mask:0xf bank_mask:0xf
    v_xor_b32_dpp v70, v66, v41 quad_perm:[0,1,3,2] row_mask:0xf bank_mask:0xf
    v_xor_b32_dpp v71, v67, v41 quad_perm:[0,1,3,2] row_mask:0xf bank_mask:0xf
    v_accvgpr_write_b32 a76, v68
    v_accvgpr_write_b32 a77, v69
    v_accvgpr_write_b32 a78, v70
    v_accvgpr_write_b32 a79, v71
    v_xor_b32 v68, v64, v43
    v_xor_b32 v69, v65, v43
    v_xor_b32 v70, v66, v43
    v_xor_b32 v71, v67, v43
    v_accvgpr_write_b32 a140, v68
    v_accvgpr_write_b32 a141, v69
    v_accvgpr_write_b32 a142, v70
    v_accvgpr_write_b32 a143, v71
    v_xor_b32_dpp v68, v64, v45 quad_perm:[0,1,3,2] row_mask:0xf bank_mask:0xf
    v_xor_b32_dpp v69, v65, v45 quad_perm:[0,1,3,2] row_mask:0xf bank_mask:0xf
    v_xor_b32_dpp v70, v66, v45 quad_perm:[0,1,3,2] row_mask:0xf bank_mask:0xf
    v_xor_b32_dpp v71, v67, v45 quad_perm:[0,1,3,2] row_mask:0xf bank_mask:0xf
    v_accvgpr_write_b32 a204, v68
    v_accvgpr_write_b32 a205, v69
    v_accvgpr_write_b32 a206, v70
    v_accvgpr_write_b32 a207, v71
    v_fract_f32 v48, v30
    v_add_f32 v49, v48, v32
    v_cos_f32 v56, v48
    v_add_f32 v50, v49, v34
    v_cos_f32 v57, v49
    v_add_f32 v51, v50, v32
    v_cos_f32 v58, v50
    v_add_f32 v52, v51, v34
    v_cos_f32 v59, v51
    v_add_f32 v53, v52, v32
    v_cos_f32 v60, v52
    v_add_f32 v54, v53, v34
    v_cos_f32 v61, v53
    v_add_f32 v55, v54, v32
    v_cos_f32 v62, v54
    v_cos_f32 v63, v55
    v_add_f32 v30, v48, v36
    v_cvt_pk_bf16_f32 v64, v56, v57
    v_cvt_pk_bf16_f32 v65, v58, v59
    v_cvt_pk_bf16_f32 v66, v60, v61
    v_cvt_pk_bf16_f32 v67, v62, v63
    v_accvgpr_write_b32 a16, v64
    v_accvgpr_write_b32 a17, v65
    v_accvgpr_write_b32 a18, v66
    v_accvgpr_write_b32 a19, v67
    v_xor_b32_dpp v68, v64, v40 quad_perm:[0,1,3,2] row_mask:0xf bank_mask:0xf
    v_xor_b32_dpp v69, v65, v40 quad_perm:[0,1,3,2] row_mask:0xf bank_mask:0xf
    v_xor_b32_dpp v70, v66, v40 quad_perm:[0,1,3,2] row_mask:0xf bank_mask:0xf
    v_xor_b32_dpp v71, v67, v40 quad_perm:[0,1,3,2] row_mask:0xf bank_mask:0xf
    v_accvgpr_write_b32 a80, v68
    v_accvgpr_write_b32 a81, v69
    v_accvgpr_write_b32 a82, v70
    v_accvgpr_write_b32 a83, v71
    v_xor_b32 v68, v64, v42
    v_xor_b32 v69, v65, v42
    v_xor_b32 v70, v66, v42
    v_xor_b32 v71, v67, v42
    v_accvgpr_write_b32 a144, v68
    v_accvgpr_write_b32 a145, v69
    v_accvgpr_write_b32 a146, v70
    v_accvgpr_write_b32 a147, v71
    v_xor_b32_dpp v68, v64, v44 quad_perm:[0,1,3,2] row_mask:0xf bank_mask:0xf
    v_xor_b32_dpp v69, v65, v44 quad_perm:[0,1,3,2] row_mask:0xf bank_mask:0xf
    v_xor_b32_dpp v70, v66, v44 quad_perm:[0,1,3,2] row_mask:0xf bank_mask:0xf
    v_xor_b32_dpp v71, v67, v44 quad_perm:[0,1,3,2] row_mask:0xf bank_mask:0xf
    v_accvgpr_write_b32 a208, v68
    v_accvgpr_write_b32 a209, v69
    v_accvgpr_write_b32 a210, v70
    v_accvgpr_write_b32 a211, v71
    v_fract_f32 v48, v31
    v_add_f32 v49, v48, v33
    v_cos_f32 v56, v48
    v_add_f32 v50, v49, v35
    v_cos_f32 v57, v49
    v_add_f32 v51, v50, v33
    v_cos_f32 v58, v50
    v_add_f32 v52, v51, v35
    v_cos_f32 v59, v51
    v_add_f32 v53, v52, v33
    v_cos_f32 v60, v52
    v_add_f32 v54, v53, v35
    v_cos_f32 v61, v53
    v_add_f32 v55, v54, v33
    v_cos_f32 v62, v54
    v_cos_f32 v63, v55
    v_add_f32 v31, v48, v37
    v_cvt_pk_bf16_f32 v64, v56, v57
    v_cvt_pk_bf16_f32 v65, v58, v59
    v_cvt_pk_bf16_f32 v66, v60, v61
    v_cvt_pk_bf16_f32 v67, v62, v63
    v_accvgpr_write_b32 a20, v64
    v_accvgpr_write_b32 a21, v65
    v_accvgpr_write_b32 a22, v66
    v_accvgpr_write_b32 a23, v67
    v_xor_b32_dpp v68, v64, v41 quad_perm:[0,1,3,2] row_mask:0xf bank_mask:0xf
    v_xor_b32_dpp v69, v65, v41 quad_perm:[0,1,3,2] row_mask:0xf bank_mask:0xf
    v_xor_b32_dpp v70, v66, v41 quad_perm:[0,1,3,2] row_mask:0xf bank_mask:0xf
    v_xor_b32_dpp v71, v67, v41 quad_perm:[0,1,3,2] row_mask:0xf bank_mask:0xf
    v_accvgpr_write_b32 a84, v68
    v_accvgpr_write_b32 a85, v69
    v_accvgpr_write_b32 a86, v70
    v_accvgpr_write_b32 a87, v71
    v_xor_b32 v68, v64, v43
    v_xor_b32 v69, v65, v43
    v_xor_b32 v70, v66, v43
    v_xor_b32 v71, v67, v43
    v_accvgpr_write_b32 a148, v68
    v_accvgpr_write_b32 a149, v69
    v_accvgpr_write_b32 a150, v70
    v_accvgpr_write_b32 a151, v71
    v_xor_b32_dpp v68, v64, v45 quad_perm:[0,1,3,2] row_mask:0xf bank_mask:0xf
    v_xor_b32_dpp v69, v65, v45 quad_perm:[0,1,3,2] row_mask:0xf bank_mask:0xf
    v_xor_b32_dpp v70, v66, v45 quad_perm:[0,1,3,2] row_mask:0xf bank_mask:0xf
    v_xor_b32_dpp v71, v67, v45 quad_perm:[0,1,3,2] row_mask:0xf bank_mask:0xf
    v_accvgpr_write_b32 a212, v68
    v_accvgpr_write_b32 a213, v69
    v_accvgpr_write_b32 a214, v70
    v_accvgpr_write_b32 a215, v71
    v_fract_f32 v48, v30
    v_add_f32 v49, v48, v32
    v_cos_f32 v56, v48
    v_add_f32 v50, v49, v34
    v_cos_f32 v57, v49
    v_add_f32 v51, v50, v32
    v_cos_f32 v58, v50
    v_add_f32 v52, v51, v34
    v_cos_f32 v59, v51
    v_add_f32 v53, v52, v32
    v_cos_f32 v60, v52
    v_add_f32 v54, v53, v34
    v_cos_f32 v61, v53
    v_add_f32 v55, v54, v32
    v_cos_f32 v62, v54
    v_cos_f32 v63, v55
    v_add_f32 v30, v48, v36
    v_cvt_pk_bf16_f32 v64, v56, v57
    v_cvt_pk_bf16_f32 v65, v58, v59
    v_cvt_pk_bf16_f32 v66, v60, v61
    v_cvt_pk_bf16_f32 v67, v62, v63
    v_accvgpr_write_b32 a24, v64
    v_accvgpr_write_b32 a25, v65
    v_accvgpr_write_b32 a26, v66
    v_accvgpr_write_b32 a27, v67
    v_xor_b32_dpp v68, v64, v40 quad_perm:[0,1,3,2] row_mask:0xf bank_mask:0xf
    v_xor_b32_dpp v69, v65, v40 quad_perm:[0,1,3,2] row_mask:0xf bank_mask:0xf
    v_xor_b32_dpp v70, v66, v40 quad_perm:[0,1,3,2] row_mask:0xf bank_mask:0xf
    v_xor_b32_dpp v71, v67, v40 quad_perm:[0,1,3,2] row_mask:0xf bank_mask:0xf
    v_accvgpr_write_b32 a88, v68
    v_accvgpr_write_b32 a89, v69
    v_accvgpr_write_b32 a90, v70
    v_accvgpr_write_b32 a91, v71
    v_xor_b32 v68, v64, v42
    v_xor_b32 v69, v65, v42
    v_xor_b32 v70, v66, v42
    v_xor_b32 v71, v67, v42
    v_accvgpr_write_b32 a152, v68
    v_accvgpr_write_b32 a153, v69
    v_accvgpr_write_b32 a154, v70
    v_accvgpr_write_b32 a155, v71
    v_xor_b32_dpp v68, v64, v44 quad_perm:[0,1,3,2] row_mask:0xf bank_mask:0xf
    v_xor_b32_dpp v69, v65, v44 quad_perm:[0,1,3,2] row_mask:0xf bank_mask:0xf
    v_xor_b32_dpp v70, v66, v44 quad_perm:[0,1,3,2] row_mask:0xf bank_mask:0xf
    v_xor_b32_dpp v71, v67, v44 quad_perm:[0,1,3,2] row_mask:0xf bank_mask:0xf
    v_accvgpr_write_b32 a216, v68
    v_accvgpr_write_b32 a217, v69
    v_accvgpr_write_b32 a218, v70
    v_accvgpr_write_b32 a219, v71
    v_fract_f32 v48, v31
    v_add_f32 v49, v48, v33
    v_cos_f32 v56, v48
    v_add_f32 v50, v49, v35
    v_cos_f32 v57, v49
    v_add_f32 v51, v50, v33
    v_cos_f32 v58, v50
    v_add_f32 v52, v51, v35
    v_cos_f32 v59, v51
    v_add_f32 v53, v52, v33
    v_cos_f32 v60, v52
    v_add_f32 v54, v53, v35
    v_cos_f32 v61, v53
    v_add_f32 v55, v54, v33
    v_cos_f32 v62, v54
    v_cos_f32 v63, v55
    v_add_f32 v31, v48, v37
    v_cvt_pk_bf16_f32 v64, v56, v57
    v_cvt_pk_bf16_f32 v65, v58, v59
    v_cvt_pk_bf16_f32 v66, v60, v61
    v_cvt_pk_bf16_f32 v67, v62, v63
    v_accvgpr_write_b32 a28, v64
    v_accvgpr_write_b32 a29, v65
    v_accvgpr_write_b32 a30, v66
    v_accvgpr_write_b32 a31, v67
    v_xor_b32_dpp v68, v64, v41 quad_perm:[0,1,3,2] row_mask:0xf bank_mask:0xf
    v_xor_b32_dpp v69, v65, v41 quad_perm:[0,1,3,2] row_mask:0xf bank_mask:0xf
    v_xor_b32_dpp v70, v66, v41 quad_perm:[0,1,3,2] row_mask:0xf bank_mask:0xf
    v_xor_b32_dpp v71, v67, v41 quad_perm:[0,1,3,2] row_mask:0xf bank_mask:0xf
    v_accvgpr_write_b32 a92, v68
    v_accvgpr_write_b32 a93, v69
    v_accvgpr_write_b32 a94, v70
    v_accvgpr_write_b32 a95, v71
    v_xor_b32 v68, v64, v43
    v_xor_b32 v69, v65, v43
    v_xor_b32 v70, v66, v43
    v_xor_b32 v71, v67, v43
    v_accvgpr_write_b32 a156, v68
    v_accvgpr_write_b32 a157, v69
    v_accvgpr_write_b32 a158, v70
    v_accvgpr_write_b32 a159, v71
    v_xor_b32_dpp v68, v64, v45 quad_perm:[0,1,3,2] row_mask:0xf bank_mask:0xf
    v_xor_b32_dpp v69, v65, v45 quad_perm:[0,1,3,2] row_mask:0xf bank_mask:0xf
    v_xor_b32_dpp v70, v66, v45 quad_perm:[0,1,3,2] row_mask:0xf bank_mask:0xf
    v_xor_b32_dpp v71, v67, v45 quad_perm:[0,1,3,2] row_mask:0xf bank_mask:0xf
    v_accvgpr_write_b32 a220, v68
    v_accvgpr_write_b32 a221, v69
    v_accvgpr_write_b32 a222, v70
    v_accvgpr_write_b32 a223, v71
    v_fract_f32 v48, v30
    v_add_f32 v49, v48, v32
    v_cos_f32 v56, v48
    v_add_f32 v50, v49, v34
    v_cos_f32 v57, v49
    v_add_f32 v51, v50, v32
    v_cos_f32 v58, v50
    v_add_f32 v52, v51, v34
    v_cos_f32 v59, v51
    v_add_f32 v53, v52, v32
    v_cos_f32 v60, v52
    v_add_f32 v54, v53, v34
    v_cos_f32 v61, v53
    v_add_f32 v55, v54, v32
    v_cos_f32 v62, v54
    v_cos_f32 v63, v55
    v_add_f32 v30, v48, v36
    v_cvt_pk_bf16_f32 v64, v56, v57
    v_cvt_pk_bf16_f32 v65, v58, v59
    v_cvt_pk_bf16_f32 v66, v60, v61
    v_cvt_pk_bf16_f32 v67, v62, v63
    v_accvgpr_write_b32 a32, v64
    v_accvgpr_write_b32 a33, v65
    v_accvgpr_write_b32 a34, v66
    v_accvgpr_write_b32 a35, v67
    v_xor_b32_dpp v68, v64, v40 quad_perm:[0,1,3,2] row_mask:0xf bank_mask:0xf
    v_xor_b32_dpp v69, v65, v40 quad_perm:[0,1,3,2] row_mask:0xf bank_mask:0xf
    v_xor_b32_dpp v70, v66, v40 quad_perm:[0,1,3,2] row_mask:0xf bank_mask:0xf
    v_xor_b32_dpp v71, v67, v40 quad_perm:[0,1,3,2] row_mask:0xf bank_mask:0xf
    v_accvgpr_write_b32 a96, v68
    v_accvgpr_write_b32 a97, v69
    v_accvgpr_write_b32 a98, v70
    v_accvgpr_write_b32 a99, v71
    v_xor_b32 v68, v64, v42
    v_xor_b32 v69, v65, v42
    v_xor_b32 v70, v66, v42
    v_xor_b32 v71, v67, v42
    v_accvgpr_write_b32 a160, v68
    v_accvgpr_write_b32 a161, v69
    v_accvgpr_write_b32 a162, v70
    v_accvgpr_write_b32 a163, v71
    v_xor_b32_dpp v68, v64, v44 quad_perm:[0,1,3,2] row_mask:0xf bank_mask:0xf
    v_xor_b32_dpp v69, v65, v44 quad_perm:[0,1,3,2] row_mask:0xf bank_mask:0xf
    v_xor_b32_dpp v70, v66, v44 quad_perm:[0,1,3,2] row_mask:0xf bank_mask:0xf
    v_xor_b32_dpp v71, v67, v44 quad_perm:[0,1,3,2] row_mask:0xf bank_mask:0xf
    v_accvgpr_write_b32 a224, v68
    v_accvgpr_write_b32 a225, v69
    v_accvgpr_write_b32 a226, v70
    v_accvgpr_write_b32 a227, v71
    v_fract_f32 v48, v31
    v_add_f32 v49, v48, v33
    v_cos_f32 v56, v48
    v_add_f32 v50, v49, v35
    v_cos_f32 v57, v49
    v_add_f32 v51, v50, v33
    v_cos_f32 v58, v50
    v_add_f32 v52, v51, v35
    v_cos_f32 v59, v51
    v_add_f32 v53, v52, v33
    v_cos_f32 v60, v52
    v_add_f32 v54, v53, v35
    v_cos_f32 v61, v53
    v_add_f32 v55, v54, v33
    v_cos_f32 v62, v54
    v_cos_f32 v63, v55
    v_add_f32 v31, v48, v37
    v_cvt_pk_bf16_f32 v64, v56, v57
    v_cvt_pk_bf16_f32 v65, v58, v59
    v_cvt_pk_bf16_f32 v66, v60, v61
    v_cvt_pk_bf16_f32 v67, v62, v63
    v_accvgpr_write_b32 a36, v64
    v_accvgpr_write_b32 a37, v65
    v_accvgpr_write_b32 a38, v66
    v_accvgpr_write_b32 a39, v67
    v_xor_b32_dpp v68, v64, v41 quad_perm:[0,1,3,2] row_mask:0xf bank_mask:0xf
    v_xor_b32_dpp v69, v65, v41 quad_perm:[0,1,3,2] row_mask:0xf bank_mask:0xf
    v_xor_b32_dpp v70, v66, v41 quad_perm:[0,1,3,2] row_mask:0xf bank_mask:0xf
    v_xor_b32_dpp v71, v67, v41 quad_perm:[0,1,3,2] row_mask:0xf bank_mask:0xf
    v_accvgpr_write_b32 a100, v68
    v_accvgpr_write_b32 a101, v69
    v_accvgpr_write_b32 a102, v70
    v_accvgpr_write_b32 a103, v71
    v_xor_b32 v68, v64, v43
    v_xor_b32 v69, v65, v43
    v_xor_b32 v70, v66, v43
    v_xor_b32 v71, v67, v43
    v_accvgpr_write_b32 a164, v68
    v_accvgpr_write_b32 a165, v69
    v_accvgpr_write_b32 a166, v70
    v_accvgpr_write_b32 a167, v71
    v_xor_b32_dpp v68, v64, v45 quad_perm:[0,1,3,2] row_mask:0xf bank_mask:0xf
    v_xor_b32_dpp v69, v65, v45 quad_perm:[0,1,3,2] row_mask:0xf bank_mask:0xf
    v_xor_b32_dpp v70, v66, v45 quad_perm:[0,1,3,2] row_mask:0xf bank_mask:0xf
    v_xor_b32_dpp v71, v67, v45 quad_perm:[0,1,3,2] row_mask:0xf bank_mask:0xf
    v_accvgpr_write_b32 a228, v68
    v_accvgpr_write_b32 a229, v69
    v_accvgpr_write_b32 a230, v70
    v_accvgpr_write_b32 a231, v71
    v_fract_f32 v48, v30
    v_add_f32 v49, v48, v32
    v_cos_f32 v56, v48
    v_add_f32 v50, v49, v34
    v_cos_f32 v57, v49
    v_add_f32 v51, v50, v32
    v_cos_f32 v58, v50
    v_add_f32 v52, v51, v34
    v_cos_f32 v59, v51
    v_add_f32 v53, v52, v32
    v_cos_f32 v60, v52
    v_add_f32 v54, v53, v34
    v_cos_f32 v61, v53
    v_add_f32 v55, v54, v32
    v_cos_f32 v62, v54
    v_cos_f32 v63, v55
    v_add_f32 v30, v48, v36
    v_cvt_pk_bf16_f32 v64, v56, v57
    v_cvt_pk_bf16_f32 v65, v58, v59
    v_cvt_pk_bf16_f32 v66, v60, v61
    v_cvt_pk_bf16_f32 v67, v62, v63
    v_accvgpr_write_b32 a40, v64
    v_accvgpr_write_b32 a41, v65
    v_accvgpr_write_b32 a42, v66
    v_accvgpr_write_b32 a43, v67
    v_xor_b32_dpp v68, v64, v40 quad_perm:[0,1,3,2] row_mask:0xf bank_mask:0xf
    v_xor_b32_dpp v69, v65, v40 quad_perm:[0,1,3,2] row_mask:0xf bank_mask:0xf
    v_xor_b32_dpp v70, v66, v40 quad_perm:[0,1,3,2] row_mask:0xf bank_mask:0xf
    v_xor_b32_dpp v71, v67, v40 quad_perm:[0,1,3,2] row_mask:0xf bank_mask:0xf
    v_accvgpr_write_b32 a104, v68
    v_accvgpr_write_b32 a105, v69
    v_accvgpr_write_b32 a106, v70
    v_accvgpr_write_b32 a107, v71
    v_xor_b32 v68, v64, v42
    v_xor_b32 v69, v65, v42
    v_xor_b32 v70, v66, v42
    v_xor_b32 v71, v67, v42
    v_accvgpr_write_b32 a168, v68
    v_accvgpr_write_b32 a169, v69
    v_accvgpr_write_b32 a170, v70
    v_accvgpr_write_b32 a171, v71
    v_xor_b32_dpp v68, v64, v44 quad_perm:[0,1,3,2] row_mask:0xf bank_mask:0xf
    v_xor_b32_dpp v69, v65, v44 quad_perm:[0,1,3,2] row_mask:0xf bank_mask:0xf
    v_xor_b32_dpp v70, v66, v44 quad_perm:[0,1,3,2] row_mask:0xf bank_mask:0xf
    v_xor_b32_dpp v71, v67, v44 quad_perm:[0,1,3,2] row_mask:0xf bank_mask:0xf
    v_accvgpr_write_b32 a232, v68
    v_accvgpr_write_b32 a233, v69
    v_accvgpr_write_b32 a234, v70
    v_accvgpr_write_b32 a235, v71
    v_fract_f32 v48, v31
    v_add_f32 v49, v48, v33
    v_cos_f32 v56, v48
    v_add_f32 v50, v49, v35
    v_cos_f32 v57, v49
    v_add_f32 v51, v50, v33
    v_cos_f32 v58, v50
    v_add_f32 v52, v51, v35
    v_cos_f32 v59, v51
    v_add_f32 v53, v52, v33
    v_cos_f32 v60, v52
    v_add_f32 v54, v53, v35
    v_cos_f32 v61, v53
    v_add_f32 v55, v54, v33
    v_cos_f32 v62, v54
    v_cos_f32 v63, v55
    v_add_f32 v31, v48, v37
    v_cvt_pk_bf16_f32 v64, v56, v57
    v_cvt_pk_bf16_f32 v65, v58, v59
    v_cvt_pk_bf16_f32 v66, v60, v61
    v_cvt_pk_bf16_f32 v67, v62, v63
    v_accvgpr_write_b32 a44, v64
    v_accvgpr_write_b32 a45, v65
    v_accvgpr_write_b32 a46, v66
    v_accvgpr_write_b32 a47, v67
    v_xor_b32_dpp v68, v64, v41 quad_perm:[0,1,3,2] row_mask:0xf bank_mask:0xf
    v_xor_b32_dpp v69, v65, v41 quad_perm:[0,1,3,2] row_mask:0xf bank_mask:0xf
    v_xor_b32_dpp v70, v66, v41 quad_perm:[0,1,3,2] row_mask:0xf bank_mask:0xf
    v_xor_b32_dpp v71, v67, v41 quad_perm:[0,1,3,2] row_mask:0xf bank_mask:0xf
    v_accvgpr_write_b32 a108, v68
    v_accvgpr_write_b32 a109, v69
    v_accvgpr_write_b32 a110, v70
    v_accvgpr_write_b32 a111, v71
    v_xor_b32 v68, v64, v43
    v_xor_b32 v69, v65, v43
    v_xor_b32 v70, v66, v43
    v_xor_b32 v71, v67, v43
    v_accvgpr_write_b32 a172, v68
    v_accvgpr_write_b32 a173, v69
    v_accvgpr_write_b32 a174, v70
    v_accvgpr_write_b32 a175, v71
    v_xor_b32_dpp v68, v64, v45 quad_perm:[0,1,3,2] row_mask:0xf bank_mask:0xf
    v_xor_b32_dpp v69, v65, v45 quad_perm:[0,1,3,2] row_mask:0xf bank_mask:0xf
    v_xor_b32_dpp v70, v66, v45 quad_perm:[0,1,3,2] row_mask:0xf bank_mask:0xf
    v_xor_b32_dpp v71, v67, v45 quad_perm:[0,1,3,2] row_mask:0xf bank_mask:0xf
    v_accvgpr_write_b32 a236, v68
    v_accvgpr_write_b32 a237, v69
    v_accvgpr_write_b32 a238, v70
    v_accvgpr_write_b32 a239, v71
    v_fract_f32 v48, v30
    v_add_f32 v49, v48, v32
    v_cos_f32 v56, v48
    v_add_f32 v50, v49, v34
    v_cos_f32 v57, v49
    v_add_f32 v51, v50, v32
    v_cos_f32 v58, v50
    v_add_f32 v52, v51, v34
    v_cos_f32 v59, v51
    v_add_f32 v53, v52, v32
    v_cos_f32 v60, v52
    v_add_f32 v54, v53, v34
    v_cos_f32 v61, v53
    v_add_f32 v55, v54, v32
    v_cos_f32 v62, v54
    v_cos_f32 v63, v55
    v_add_f32 v30, v48, v36
    v_cvt_pk_bf16_f32 v64, v56, v57
    v_cvt_pk_bf16_f32 v65, v58, v59
    v_cvt_pk_bf16_f32 v66, v60, v61
    v_cvt_pk_bf16_f32 v67, v62, v63
    v_accvgpr_write_b32 a48, v64
    v_accvgpr_write_b32 a49, v65
    v_accvgpr_write_b32 a50, v66
    v_accvgpr_write_b32 a51, v67
    v_xor_b32_dpp v68, v64, v40 quad_perm:[0,1,3,2] row_mask:0xf bank_mask:0xf
    v_xor_b32_dpp v69, v65, v40 quad_perm:[0,1,3,2] row_mask:0xf bank_mask:0xf
    v_xor_b32_dpp v70, v66, v40 quad_perm:[0,1,3,2] row_mask:0xf bank_mask:0xf
    v_xor_b32_dpp v71, v67, v40 quad_perm:[0,1,3,2] row_mask:0xf bank_mask:0xf
    v_accvgpr_write_b32 a112, v68
    v_accvgpr_write_b32 a113, v69
    v_accvgpr_write_b32 a114, v70
    v_accvgpr_write_b32 a115, v71
    v_xor_b32 v68, v64, v42
    v_xor_b32 v69, v65, v42
    v_xor_b32 v70, v66, v42
    v_xor_b32 v71, v67, v42
    v_accvgpr_write_b32 a176, v68
    v_accvgpr_write_b32 a177, v69
    v_accvgpr_write_b32 a178, v70
    v_accvgpr_write_b32 a179, v71
    v_xor_b32_dpp v68, v64, v44 quad_perm:[0,1,3,2] row_mask:0xf bank_mask:0xf
    v_xor_b32_dpp v69, v65, v44 quad_perm:[0,1,3,2] row_mask:0xf bank_mask:0xf
    v_xor_b32_dpp v70, v66, v44 quad_perm:[0,1,3,2] row_mask:0xf bank_mask:0xf
    v_xor_b32_dpp v71, v67, v44 quad_perm:[0,1,3,2] row_mask:0xf bank_mask:0xf
    v_accvgpr_write_b32 a240, v68
    v_accvgpr_write_b32 a241, v69
    v_accvgpr_write_b32 a242, v70
    v_accvgpr_write_b32 a243, v71
    v_fract_f32 v48, v31
    v_add_f32 v49, v48, v33
    v_cos_f32 v56, v48
    v_add_f32 v50, v49, v35
    v_cos_f32 v57, v49
    v_add_f32 v51, v50, v33
    v_cos_f32 v58, v50
    v_add_f32 v52, v51, v35
    v_cos_f32 v59, v51
    v_add_f32 v53, v52, v33
    v_cos_f32 v60, v52
    v_add_f32 v54, v53, v35
    v_cos_f32 v61, v53
    v_add_f32 v55, v54, v33
    v_cos_f32 v62, v54
    v_cos_f32 v63, v55
    v_add_f32 v31, v48, v37
    v_cvt_pk_bf16_f32 v64, v56, v57
    v_cvt_pk_bf16_f32 v65, v58, v59
    v_cvt_pk_bf16_f32 v66, v60, v61
    v_cvt_pk_bf16_f32 v67, v62, v63
    v_accvgpr_write_b32 a52, v64
    v_accvgpr_write_b32 a53, v65
    v_accvgpr_write_b32 a54, v66
    v_accvgpr_write_b32 a55, v67
    v_xor_b32_dpp v68, v64, v41 quad_perm:[0,1,3,2] row_mask:0xf bank_mask:0xf
    v_xor_b32_dpp v69, v65, v41 quad_perm:[0,1,3,2] row_mask:0xf bank_mask:0xf
    v_xor_b32_dpp v70, v66, v41 quad_perm:[0,1,3,2] row_mask:0xf bank_mask:0xf
    v_xor_b32_dpp v71, v67, v41 quad_perm:[0,1,3,2] row_mask:0xf bank_mask:0xf
    v_accvgpr_write_b32 a116, v68
    v_accvgpr_write_b32 a117, v69
    v_accvgpr_write_b32 a118, v70
    v_accvgpr_write_b32 a119, v71
    v_xor_b32 v68, v64, v43
    v_xor_b32 v69, v65, v43
    v_xor_b32 v70, v66, v43
    v_xor_b32 v71, v67, v43
    v_accvgpr_write_b32 a180, v68
    v_accvgpr_write_b32 a181, v69
    v_accvgpr_write_b32 a182, v70
    v_accvgpr_write_b32 a183, v71
    v_xor_b32_dpp v68, v64, v45 quad_perm:[0,1,3,2] row_mask:0xf bank_mask:0xf
    v_xor_b32_dpp v69, v65, v45 quad_perm:[0,1,3,2] row_mask:0xf bank_mask:0xf
    v_xor_b32_dpp v70, v66, v45 quad_perm:[0,1,3,2] row_mask:0xf bank_mask:0xf
    v_xor_b32_dpp v71, v67, v45 quad_perm:[0,1,3,2] row_mask:0xf bank_mask:0xf
    v_accvgpr_write_b32 a244, v68
    v_accvgpr_write_b32 a245, v69
    v_accvgpr_write_b32 a246, v70
    v_accvgpr_write_b32 a247, v71
    v_fract_f32 v48, v30
    v_add_f32 v49, v48, v32
    v_cos_f32 v56, v48
    v_add_f32 v50, v49, v34
    v_cos_f32 v57, v49
    v_add_f32 v51, v50, v32
    v_cos_f32 v58, v50
    v_add_f32 v52, v51, v34
    v_cos_f32 v59, v51
    v_add_f32 v53, v52, v32
    v_cos_f32 v60, v52
    v_add_f32 v54, v53, v34
    v_cos_f32 v61, v53
    v_add_f32 v55, v54, v32
    v_cos_f32 v62, v54
    v_cos_f32 v63, v55
    v_add_f32 v30, v48, v36
    v_cvt_pk_bf16_f32 v64, v56, v57
    v_cvt_pk_bf16_f32 v65, v58, v59
    v_cvt_pk_bf16_f32 v66, v60, v61
    v_cvt_pk_bf16_f32 v67, v62, v63
    v_accvgpr_write_b32 a56, v64
    v_accvgpr_write_b32 a57, v65
    v_accvgpr_write_b32 a58, v66
    v_accvgpr_write_b32 a59, v67
    v_xor_b32_dpp v68, v64, v40 quad_perm:[0,1,3,2] row_mask:0xf bank_mask:0xf
    v_xor_b32_dpp v69, v65, v40 quad_perm:[0,1,3,2] row_mask:0xf bank_mask:0xf
    v_xor_b32_dpp v70, v66, v40 quad_perm:[0,1,3,2] row_mask:0xf bank_mask:0xf
    v_xor_b32_dpp v71, v67, v40 quad_perm:[0,1,3,2] row_mask:0xf bank_mask:0xf
    v_accvgpr_write_b32 a120, v68
    v_accvgpr_write_b32 a121, v69
    v_accvgpr_write_b32 a122, v70
    v_accvgpr_write_b32 a123, v71
    v_xor_b32 v68, v64, v42
    v_xor_b32 v69, v65, v42
    v_xor_b32 v70, v66, v42
    v_xor_b32 v71, v67, v42
    v_accvgpr_write_b32 a184, v68
    v_accvgpr_write_b32 a185, v69
    v_accvgpr_write_b32 a186, v70
    v_accvgpr_write_b32 a187, v71
    v_xor_b32_dpp v68, v64, v44 quad_perm:[0,1,3,2] row_mask:0xf bank_mask:0xf
    v_xor_b32_dpp v69, v65, v44 quad_perm:[0,1,3,2] row_mask:0xf bank_mask:0xf
    v_xor_b32_dpp v70, v66, v44 quad_perm:[0,1,3,2] row_mask:0xf bank_mask:0xf
    v_xor_b32_dpp v71, v67, v44 quad_perm:[0,1,3,2] row_mask:0xf bank_mask:0xf
    v_accvgpr_write_b32 a248, v68
    v_accvgpr_write_b32 a249, v69
    v_accvgpr_write_b32 a250, v70
    v_accvgpr_write_b32 a251, v71
    v_fract_f32 v48, v31
    v_add_f32 v49, v48, v33
    v_cos_f32 v56, v48
    v_add_f32 v50, v49, v35
    v_cos_f32 v57, v49
    v_add_f32 v51, v50, v33
    v_cos_f32 v58, v50
    v_add_f32 v52, v51, v35
    v_cos_f32 v59, v51
    v_add_f32 v53, v52, v33
    v_cos_f32 v60, v52
    v_add_f32 v54, v53, v35
    v_cos_f32 v61, v53
    v_add_f32 v55, v54, v33
    v_cos_f32 v62, v54
    v_cos_f32 v63, v55
    v_add_f32 v31, v48, v37
    v_cvt_pk_bf16_f32 v64, v56, v57
    v_cvt_pk_bf16_f32 v65, v58, v59
    v_cvt_pk_bf16_f32 v66, v60, v61
    v_cvt_pk_bf16_f32 v67, v62, v63
    v_accvgpr_write_b32 a60, v64
    v_accvgpr_write_b32 a61, v65
    v_accvgpr_write_b32 a62, v66
    v_accvgpr_write_b32 a63, v67
    v_xor_b32_dpp v68, v64, v41 quad_perm:[0,1,3,2] row_mask:0xf bank_mask:0xf
    v_xor_b32_dpp v69, v65, v41 quad_perm:[0,1,3,2] row_mask:0xf bank_mask:0xf
    v_xor_b32_dpp v70, v66, v41 quad_perm:[0,1,3,2] row_mask:0xf bank_mask:0xf
    v_xor_b32_dpp v71, v67, v41 quad_perm:[0,1,3,2] row_mask:0xf bank_mask:0xf
    v_accvgpr_write_b32 a124, v68
    v_accvgpr_write_b32 a125, v69
    v_accvgpr_write_b32 a126, v70
    v_accvgpr_write_b32 a127, v71
    v_xor_b32 v68, v64, v43
    v_xor_b32 v69, v65, v43
    v_xor_b32 v70, v66, v43
    v_xor_b32 v71, v67, v43
    v_accvgpr_write_b32 a188, v68
    v_accvgpr_write_b32 a189, v69
    v_accvgpr_write_b32 a190, v70
    v_accvgpr_write_b32 a191, v71
    v_xor_b32_dpp v68, v64, v45 quad_perm:[0,1,3,2] row_mask:0xf bank_mask:0xf
    v_xor_b32_dpp v69, v65, v45 quad_perm:[0,1,3,2] row_mask:0xf bank_mask:0xf
    v_xor_b32_dpp v70, v66, v45 quad_perm:[0,1,3,2] row_mask:0xf bank_mask:0xf
    v_xor_b32_dpp v71, v67, v45 quad_perm:[0,1,3,2] row_mask:0xf bank_mask:0xf
    v_accvgpr_write_b32 a252, v68
    v_accvgpr_write_b32 a253, v69
    v_accvgpr_write_b32 a254, v70
    v_accvgpr_write_b32 a255, v71
    s_and_b32 s17, s28, 1
    s_lshl_b32 s17, s17, 15
    s_lshr_b32 s18, s28, 1
    s_lshl_b32 s18, s18, 21
    s_add_u32 s17, s17, s18
    s_lshl_b32 s18, s29, 16
    s_add_u32 s17, s17, s18
    v_lshlrev_b32 v15, 7, v1
    s_waitcnt lgkmcnt(0)
    buffer_load_dword v248, v15, s[40:43], s17 offen
    s_add_u32 s17, s17, 8192
    buffer_load_dword v249, v15, s[40:43], s17 offen
    s_add_u32 s17, s17, 8192
    buffer_load_dword v250, v15, s[40:43], s17 offen
    s_add_u32 s17, s17, 8192
    buffer_load_dword v251, v15, s[40:43], s17 offen
    s_add_u32 s17, s17, 8192
    s_lshl_b32 s34, s93, 2
    s_add_u32 s34, s34, s16
    s_lshl_b32 s34, s34, 13
    s_sub_u32 s34, s34, 262144
    v_mov_b32 v247, v15
    s_lshl_b32 s17, s29, 6
    v_add_u32 v246, s17, v1
    v_mul_u32_u24 v246, 1026, v246
    s_lshl_b32 s17, s28, 8
    v_add_u32 v246, s17, v246
    v_and_b32 v246, -4, v246
    s_load_dwordx2 s[8:9], s[0:1], 0
    s_mov_b32 s10, 4194304
    s_mov_b32 s11, 0x20000
    s_waitcnt lgkmcnt(0)
    v_and_b32 v5, 15, v1
    v_bfe_u32 v6, v1, 1, 3
    v_lshrrev_b32 v7, 4, v1
    v_xor_b32 v6, v6, v7
    v_lshlrev_b32 v6, 4, v6
    v_lshl_add_u32 v10, v5, 7, v6
    s_lshl_b32 s19, s16, 10
    v_xor_b32 v11, 64, v10
    v_add_u32 v12, 0x10000, v10
    v_add_u32 v13, 0x10000, v11
    v_lshrrev_b32 v7, 3, v1
    s_lshl_b32 s17, s16, 3
    v_add_u32 v7, s17, v7
    v_bfe_u32 v8, v7, 1, 3
    v_xor_b32 v8, v8, v1
    v_and_b32 v8, 7, v8
    v_bfe_u32 v5, v7, 2, 2
    v_and_b32 v2, 3, v7
    v_lshl_add_u32 v2, v5, 3, v2
    v_bfe_u32 v5, v7, 4, 1
    v_lshl_add_u32 v2, v5, 2, v2
    v_bfe_u32 v5, v1, 2, 2
    v_and_b32 v3, 3, v1
    v_lshl_add_u32 v3, v5, 3, v3
    v_lshlrev_b32 v2, 16, v2
    v_lshl_add_u32 v2, v8, 4, v2
    v_and_b32 v5, 48, v1
    v_lshl_add_u32 v3, v3, 6, v5
    s_mul_i32 s21, s29, 139776
    s_mul_i32 s17, s28, 34816
    s_add_u32 s21, s21, s17
    s_add_u32 s21, s21, 104857600
    s_and_b32 s20, s28, 1
    s_lshl_b32 s20, s20, 15
    s_lshr_b32 s17, s28, 1
    s_lshl_b32 s17, s17, 21
    s_add_u32 s20, s20, s17
    s_mov_b32 s24, 2048
    s_mov_b32 s25, 2176
    s_barrier
    s_mov_b32 s26, s25
    s_sub_u32 s25, s21, 1073741824
    s_mov_b32 s21, 1073741824
    s_mov_b32 s23, 0
    s_mov_b32 s22, 0
    s_add_u32 m0, s19, 0
    s_nop 0
    buffer_load_dwordx4 v2, s[8:11], s20 offen offset:0 lds
    s_add_u32 m0, s19, 3968
    s_nop 0
    buffer_load_dwordx4 v2, s[8:11], s20 offen offset:128 lds
    s_add_u32 m0, s19, 7936
    s_nop 0
    buffer_load_dwordx4 v2, s[8:11], s20 offen offset:256 lds
    s_add_u32 m0, s19, 11904
    s_nop 0
    buffer_load_dwordx4 v2, s[8:11], s20 offen offset:384 lds
    s_add_u32 m0, s19, 15872
    s_nop 0
    buffer_load_dwordx4 v2, s[8:11], s20 offen offset:512 lds
    s_add_u32 m0, s19, 19840
    s_nop 0
    buffer_load_dwordx4 v2, s[8:11], s20 offen offset:640 lds
    s_add_u32 m0, s19, 23808
    s_nop 0
    buffer_load_dwordx4 v2, s[8:11], s20 offen offset:768 lds
    s_add_u32 m0, s19, 27776
    s_nop 0
    buffer_load_dwordx4 v2, s[8:11], s20 offen offset:896 lds
    s_add_u32 m0, s19, 31744
    s_nop 0
    buffer_load_dwordx4 v2, s[8:11], s20 offen offset:1024 lds
    s_add_u32 m0, s19, 35712
    s_nop 0
    buffer_load_dwordx4 v2, s[8:11], s20 offen offset:1152 lds
    s_add_u32 m0, s19, 39680
    s_nop 0
    buffer_load_dwordx4 v2, s[8:11], s20 offen offset:1280 lds
    s_add_u32 m0, s19, 43648
    s_nop 0
    buffer_load_dwordx4 v2, s[8:11], s20 offen offset:1408 lds
    s_add_u32 m0, s19, 47616
    s_nop 0
    buffer_load_dwordx4 v2, s[8:11], s20 offen offset:1536 lds
    s_add_u32 m0, s19, 51584
    s_nop 0
    buffer_load_dwordx4 v2, s[8:11], s20 offen offset:1664 lds
    s_add_u32 m0, s19, 55552
    s_nop 0
    buffer_load_dwordx4 v2, s[8:11], s20 offen offset:1792 lds
    s_add_u32 m0, s19, 59520
    s_nop 0
    buffer_load_dwordx4 v2, s[8:11], s20 offen offset:1920 lds
    s_add_u32 s20, s20, s24
    s_add_u32 m0, s19, 65536
    s_nop 0
    buffer_load_dwordx4 v2, s[8:11], s20 offen offset:0 lds
    s_add_u32 m0, s19, 69504
    s_nop 0
    buffer_load_dwordx4 v2, s[8:11], s20 offen offset:128 lds
    s_add_u32 m0, s19, 73472
    s_nop 0
    buffer_load_dwordx4 v2, s[8:11], s20 offen offset:256 lds
    s_waitcnt vmcnt(11)
    s_barrier
    ds_read_b128 v[20:23], v10 offset:0
    ds_read_b128 v[24:27], v10 offset:2048
    ds_read_b128 v[28:31], v11 offset:0
    ds_read_b128 v[32:35], v11 offset:2048
    ds_read_b128 v[36:39], v10 offset:4096
    ds_read_b128 v[40:43], v10 offset:6144
    ds_read_b128 v[44:47], v11 offset:4096
.p2align 6
F1_top:
    s_waitcnt lgkmcnt(6)
    v_mfma_f32_16x16x32_bf16 v[52:55], v[20:23], a[0:3], 0
    ds_read_b128 v[48:51], v11 offset:6144
    v_mfma_f32_16x16x32_bf16 v[60:63], v[20:23], a[4:7], 0
    s_waitcnt lgkmcnt(6)
    v_mfma_f32_16x16x32_bf16 v[56:59], v[24:27], a[0:3], 0
    ds_read_b128 v[20:23], v10 offset:8192
    s_add_u32 m0, s19, 77440
    v_mfma_f32_16x16x32_bf16 v[64:67], v[24:27], a[4:7], 0
    buffer_load_dwordx4 v2, s[8:11], s20 offen offset:384 lds
    s_waitcnt lgkmcnt(6)
    v_mfma_f32_16x16x32_bf16 v[52:55], v[28:31], a[8:11], v[52:55]
    ds_read_b128 v[24:27], v10 offset:10240
    v_mfma_f32_16x16x32_bf16 v[60:63], v[28:31], a[12:15], v[60:63]
    s_waitcnt lgkmcnt(6)
    v_mfma_f32_16x16x32_bf16 v[56:59], v[32:35], a[8:11], v[56:59]
    ds_read_b128 v[28:31], v11 offset:8192
    s_add_u32 m0, s19, 81408
    v_mfma_f32_16x16x32_bf16 v[64:67], v[32:35], a[12:15], v[64:67]
    buffer_load_dwordx4 v2, s[8:11], s20 offen offset:512 lds
    s_waitcnt lgkmcnt(6)
    v_mfma_f32_16x16x32_bf16 v[52:55], v[36:39], a[16:19], v[52:55]
    ds_read_b128 v[32:35], v11 offset:10240
    v_mfma_f32_16x16x32_bf16 v[60:63], v[36:39], a[20:23], v[60:63]
    s_waitcnt lgkmcnt(6)
    v_mfma_f32_16x16x32_bf16 v[56:59], v[40:43], a[16:19], v[56:59]
    ds_read_b128 v[36:39], v10 offset:12288
    s_add_u32 m0, s19, 85376
    v_mfma_f32_16x16x32_bf16 v[64:67], v[40:43], a[20:23], v[64:67]
    buffer_load_dwordx4 v2, s[8:11], s20 offen offset:640 lds
    s_waitcnt lgkmcnt(6)
    v_mfma_f32_16x16x32_bf16 v[52:55], v[44:47], a[24:27], v[52:55]
    ds_read_b128 v[40:43], v10 offset:14336
    v_mfma_f32_16x16x32_bf16 v[60:63], v[44:47], a[28:31], v[60:63]
    s_waitcnt lgkmcnt(6)
    v_mfma_f32_16x16x32_bf16 v[56:59], v[48:51], a[24:27], v[56:59]
    ds_read_b128 v[44:47], v11 offset:12288
    s_add_u32 m0, s19, 89344
    v_mfma_f32_16x16x32_bf16 v[64:67], v[48:51], a[28:31], v[64:67]
    buffer_load_dwordx4 v2, s[8:11], s20 offen offset:768 lds
    s_waitcnt lgkmcnt(6)
    v_mfma_f32_16x16x32_bf16 v[52:55], v[20:23], a[32:35], v[52:55]
    ds_read_b128 v[48:51], v11 offset:14336
    v_mfma_f32_16x16x32_bf16 v[60:63], v[20:23], a[36:39], v[60:63]
    s_waitcnt lgkmcnt(6)
    v_mfma_f32_16x16x32_bf16 v[56:59], v[24:27], a[32:35], v[56:59]
    ds_read_b128 v[20:23], v10 offset:16384
    s_add_u32 m0, s19, 93312
    v_mfma_f32_16x16x32_bf16 v[64:67], v[24:27], a[36:39], v[64:67]
    buffer_load_dwordx4 v2, s[8:11], s20 offen offset:896 lds
    s_waitcnt lgkmcnt(6)
    v_mfma_f32_16x16x32_bf16 v[52:55], v[28:31], a[40:43], v[52:55]
    ds_read_b128 v[24:27], v10 offset:18432
    v_mfma_f32_16x16x32_bf16 v[60:63], v[28:31], a[44:47], v[60:63]
    v_cvt_pk_bf16_f32 v84, v68, v69
    s_waitcnt lgkmcnt(6)
    v_mfma_f32_16x16x32_bf16 v[56:59], v[32:35], a[40:43], v[56:59]
    ds_read_b128 v[28:31], v11 offset:16384
    v_mfma_f32_16x16x32_bf16 v[64:67], v[32:35], a[44:47], v[64:67]
    v_cvt_pk_bf16_f32 v85, v70, v71
    s_waitcnt lgkmcnt(6)
    v_mfma_f32_16x16x32_bf16 v[52:55], v[36:39], a[48:51], v[52:55]
    ds_read_b128 v[32:35], v11 offset:18432
    v_mfma_f32_16x16x32_bf16 v[60:63], v[36:39], a[52:55], v[60:63]
    v_cvt_pk_bf16_f32 v86, v72, v73
    s_waitcnt lgkmcnt(6)
    v_mfma_f32_16x16x32_bf16 v[56:59], v[40:43], a[48:51], v[56:59]
    ds_read_b128 v[36:39], v10 offset:20480
    v_mfma_f32_16x16x32_bf16 v[64:67], v[40:43], a[52:55], v[64:67]
    v_cvt_pk_bf16_f32 v87, v74, v75
    s_waitcnt lgkmcnt(6)
    v_mfma_f32_16x16x32_bf16 v[52:55], v[44:47], a[56:59], v[52:55]
    ds_read_b128 v[40:43], v10 offset:22528
    v_mfma_f32_16x16x32_bf16 v[60:63], v[44:47], a[60:63], v[60:63]
    v_cvt_pk_bf16_f32 v88, v76, v77
    s_waitcnt lgkmcnt(6)
    v_mfma_f32_16x16x32_bf16 v[56:59], v[48:51], a[56:59], v[56:59]
    ds_read_b128 v[44:47], v11 offset:20480
    v_mfma_f32_16x16x32_bf16 v[64:67], v[48:51], a[60:63], v[64:67]
    v_cvt_pk_bf16_f32 v89, v78, v79
    buffer_store_dwordx4 v[84:87], v3, s[4:7], s21 offen offset:0 sc1
    s_waitcnt lgkmcnt(6)
    v_mfma_f32_16x16x32_bf16 v[52:55], v[20:23], a[64:67], v[52:55]
    ds_read_b128 v[48:51], v11 offset:22528
    v_mfma_f32_16x16x32_bf16 v[60:63], v[20:23], a[68:71], v[60:63]
    v_cvt_pk_bf16_f32 v90, v80, v81
    s_waitcnt lgkmcnt(6)
    v_mfma_f32_16x16x32_bf16 v[56:59], v[24:27], a[64:67], v[56:59]
    ds_read_b128 v[20:23], v10 offset:24576
    v_mfma_f32_16x16x32_bf16 v[64:67], v[24:27], a[68:71], v[64:67]
    v_cvt_pk_bf16_f32 v91, v82, v83
    s_waitcnt lgkmcnt(6)
    v_mfma_f32_16x16x32_bf16 v[52:55], v[28:31], a[72:75], v[52:55]
    ds_read_b128 v[24:27], v10 offset:26624
    v_mfma_f32_16x16x32_bf16 v[60:63], v[28:31], a[76:79], v[60:63]
    s_waitcnt lgkmcnt(6)
    v_mfma_f32_16x16x32_bf16 v[56:59], v[32:35], a[72:75], v[56:59]
    ds_read_b128 v[28:31], v11 offset:24576
    v_mfma_f32_16x16x32_bf16 v[64:67], v[32:35], a[76:79], v[64:67]
    buffer_store_dwordx4 v[88:91], v3, s[4:7], s21 offen offset:256 sc1
    s_waitcnt lgkmcnt(6)
    v_mfma_f32_16x16x32_bf16 v[52:55], v[36:39], a[80:83], v[52:55]
    ds_read_b128 v[32:35], v11 offset:26624
    v_mfma_f32_16x16x32_bf16 v[60:63], v[36:39], a[84:87], v[60:63]
    s_add_u32 s21, s21, s25
    s_mov_b32 s25, s26
    s_waitcnt lgkmcnt(6)
    v_mfma_f32_16x16x32_bf16 v[56:59], v[40:43], a[80:83], v[56:59]
    ds_read_b128 v[36:39], v10 offset:28672
    v_mfma_f32_16x16x32_bf16 v[64:67], v[40:43], a[84:87], v[64:67]
    s_waitcnt lgkmcnt(6)
    v_mfma_f32_16x16x32_bf16 v[52:55], v[44:47], a[88:91], v[52:55]
    ds_read_b128 v[40:43], v10 offset:30720
    v_mfma_f32_16x16x32_bf16 v[60:63], v[44:47], a[92:95], v[60:63]
    buffer_load_dword v248, v247, s[44:47], s34 offen
    s_add_u32 s34, s34, 1048576
    s_sub_u32 s31, s22, 10
    s_lshl_b32 s31, s31, 6
    s_cmp_lt_u32 s31, 384
    s_cselect_b32 s31, s31, 1073741824
    buffer_load_dword v249, v246, s[48:51], s31 offen
    buffer_load_dword v250, v246, s[52:55], s31 offen
    s_waitcnt lgkmcnt(6)
    v_mfma_f32_16x16x32_bf16 v[56:59], v[48:51], a[88:91], v[56:59]
    ds_read_b128 v[44:47], v11 offset:28672
    v_mfma_f32_16x16x32_bf16 v[64:67], v[48:51], a[92:95], v[64:67]
    s_waitcnt lgkmcnt(6)
    v_mfma_f32_16x16x32_bf16 v[52:55], v[20:23], a[96:99], v[52:55]
    ds_read_b128 v[48:51], v11 offset:30720
    v_mfma_f32_16x16x32_bf16 v[60:63], v[20:23], a[100:103], v[60:63]
    s_waitcnt lgkmcnt(6)
    v_mfma_f32_16x16x32_bf16 v[56:59], v[24:27], a[96:99], v[56:59]
    s_waitcnt vmcnt(13)
    s_barrier
    ds_read_b128 v[20:23], v10 offset:32768
    v_mfma_f32_16x16x32_bf16 v[64:67], v[24:27], a[100:103], v[64:67]
    s_waitcnt lgkmcnt(6)
    v_mfma_f32_16x16x32_bf16 v[52:55], v[28:31], a[104:107], v[52:55]
    ds_read_b128 v[24:27], v10 offset:34816
    s_add_u32 m0, s19, 97280
    v_mfma_f32_16x16x32_bf16 v[60:63], v[28:31], a[108:111], v[60:63]
    buffer_load_dwordx4 v2, s[8:11], s20 offen offset:1024 lds
    s_waitcnt lgkmcnt(6)
    v_mfma_f32_16x16x32_bf16 v[56:59], v[32:35], a[104:107], v[56:59]
    ds_read_b128 v[28:31], v11 offset:32768
    v_mfma_f32_16x16x32_bf16 v[64:67], v[32:35], a[108:111], v[64:67]
    s_waitcnt lgkmcnt(6)
    v_mfma_f32_16x16x32_bf16 v[52:55], v[36:39], a[112:115], v[52:55]
    ds_read_b128 v[32:35], v11 offset:34816
    s_add_u32 m0, s19, 101248
    v_mfma_f32_16x16x32_bf16 v[60:63], v[36:39], a[116:119], v[60:63]
    buffer_load_dwordx4 v2, s[8:11], s20 offen offset:1152 lds
    s_waitcnt lgkmcnt(6)
    v_mfma_f32_16x16x32_bf16 v[56:59], v[40:43], a[112:115], v[56:59]
    ds_read_b128 v[36:39], v10 offset:36864
    v_mfma_f32_16x16x32_bf16 v[64:67], v[40:43], a[116:119], v[64:67]
    s_waitcnt lgkmcnt(6)
    v_mfma_f32_16x16x32_bf16 v[52:55], v[44:47], a[120:123], v[52:55]
    ds_read_b128 v[40:43], v10 offset:38912
    s_add_u32 m0, s19, 105216
    v_mfma_f32_16x16x32_bf16 v[60:63], v[44:47], a[124:127], v[60:63]
    buffer_load_dwordx4 v2, s[8:11], s20 offen offset:1280 lds
    s_waitcnt lgkmcnt(6)
    v_mfma_f32_16x16x32_bf16 v[56:59], v[48:51], a[120:123], v[56:59]
    ds_read_b128 v[44:47], v11 offset:36864
    v_mfma_f32_16x16x32_bf16 v[64:67], v[48:51], a[124:127], v[64:67]
    s_waitcnt lgkmcnt(6)
    v_mfma_f32_16x16x32_bf16 v[52:55], v[20:23], a[128:131], v[52:55]
    ds_read_b128 v[48:51], v11 offset:38912
    v_mfma_f32_16x16x32_bf16 v[60:63], v[20:23], a[132:135], v[60:63]
    s_waitcnt lgkmcnt(6)
    v_mfma_f32_16x16x32_bf16 v[56:59], v[24:27], a[128:131], v[56:59]
    ds_read_b128 v[20:23], v10 offset:40960
    s_add_u32 m0, s19, 109184
    v_mfma_f32_16x16x32_bf16 v[64:67], v[24:27], a[132:135], v[64:67]
    buffer_load_dwordx4 v2, s[8:11], s20 offen offset:1408 lds
    s_waitcnt lgkmcnt(6)
    v_mfma_f32_16x16x32_bf16 v[52:55], v[28:31], a[136:139], v[52:55]
    ds_read_b128 v[24:27], v10 offset:43008
    v_mfma_f32_16x16x32_bf16 v[60:63], v[28:31], a[140:143], v[60:63]
    s_waitcnt lgkmcnt(6)
    v_mfma_f32_16x16x32_bf16 v[56:59], v[32:35], a[136:139], v[56:59]
    ds_read_b128 v[28:31], v11 offset:40960
    s_add_u32 m0, s19, 113152
    v_mfma_f32_16x16x32_bf16 v[64:67], v[32:35], a[140:143], v[64:67]
    buffer_load_dwordx4 v2, s[8:11], s20 offen offset:1536 lds
    s_waitcnt lgkmcnt(6)
    v_mfma_f32_16x16x32_bf16 v[52:55], v[36:39], a[144:147], v[52:55]
    ds_read_b128 v[32:35], v11 offset:43008
    v_mfma_f32_16x16x32_bf16 v[60:63], v[36:39], a[148:151], v[60:63]
    s_waitcnt lgkmcnt(6)
    v_mfma_f32_16x16x32_bf16 v[56:59], v[40:43], a[144:147], v[56:59]
    ds_read_b128 v[36:39], v10 offset:45056
    s_add_u32 m0, s19, 117120
    v_mfma_f32_16x16x32_bf16 v[64:67], v[40:43], a[148:151], v[64:67]
    buffer_load_dwordx4 v2, s[8:11], s20 offen offset:1664 lds
    s_waitcnt lgkmcnt(6)
    v_mfma_f32_16x16x32_bf16 v[52:55], v[44:47], a[152:155], v[52:55]
    ds_read_b128 v[40:43], v10 offset:47104
    v_mfma_f32_16x16x32_bf16 v[60:63], v[44:47], a[156:159], v[60:63]
    s_waitcnt lgkmcnt(6)
    v_mfma_f32_16x16x32_bf16 v[56:59], v[48:51], a[152:155], v[56:59]
    ds_read_b128 v[44:47], v11 offset:45056
    s_add_u32 m0, s19, 121088
    v_mfma_f32_16x16x32_bf16 v[64:67], v[48:51], a[156:159], v[64:67]
    buffer_load_dwordx4 v2, s[8:11], s20 offen offset:1792 lds
    s_waitcnt lgkmcnt(6)
    v_mfma_f32_16x16x32_bf16 v[52:55], v[20:23], a[160:163], v[52:55]
    ds_read_b128 v[48:51], v11 offset:47104
    v_mfma_f32_16x16x32_bf16 v[60:63], v[20:23], a[164:167], v[60:63]
    s_waitcnt lgkmcnt(6)
    v_mfma_f32_16x16x32_bf16 v[56:59], v[24:27], a[160:163], v[56:59]
    ds_read_b128 v[20:23], v10 offset:49152
    s_add_u32 m0, s19, 125056
    v_mfma_f32_16x16x32_bf16 v[64:67], v[24:27], a[164:167], v[64:67]
    buffer_load_dwordx4 v2, s[8:11], s20 offen offset:1920 lds
    s_waitcnt lgkmcnt(6)
    v_mfma_f32_16x16x32_bf16 v[52:55], v[28:31], a[168:171], v[52:55]
    ds_read_b128 v[24:27], v10 offset:51200
    v_mfma_f32_16x16x32_bf16 v[60:63], v[28:31], a[172:175], v[60:63]
    s_add_u32 s20, s20, s24
    s_waitcnt lgkmcnt(6)
    v_mfma_f32_16x16x32_bf16 v[56:59], v[32:35], a[168:171], v[56:59]
    ds_read_b128 v[28:31], v11 offset:49152
    v_mfma_f32_16x16x32_bf16 v[64:67], v[32:35], a[172:175], v[64:67]
    s_waitcnt lgkmcnt(6)
    v_mfma_f32_16x16x32_bf16 v[52:55], v[36:39], a[176:179], v[52:55]
    ds_read_b128 v[32:35], v11 offset:51200
    v_mfma_f32_16x16x32_bf16 v[60:63], v[36:39], a[180:183], v[60:63]
    s_waitcnt lgkmcnt(6)
    v_mfma_f32_16x16x32_bf16 v[56:59], v[40:43], a[176:179], v[56:59]
    ds_read_b128 v[36:39], v10 offset:53248
    v_mfma_f32_16x16x32_bf16 v[64:67], v[40:43], a[180:183], v[64:67]
    s_waitcnt lgkmcnt(6)
    v_mfma_f32_16x16x32_bf16 v[52:55], v[44:47], a[184:187], v[52:55]
    ds_read_b128 v[40:43], v10 offset:55296
    v_mfma_f32_16x16x32_bf16 v[60:63], v[44:47], a[188:191], v[60:63]
    s_waitcnt lgkmcnt(6)
    v_mfma_f32_16x16x32_bf16 v[56:59], v[48:51], a[184:187], v[56:59]
    ds_read_b128 v[44:47], v11 offset:53248
    v_mfma_f32_16x16x32_bf16 v[64:67], v[48:51], a[188:191], v[64:67]
    s_waitcnt lgkmcnt(6)
    v_mfma_f32_16x16x32_bf16 v[52:55], v[20:23], a[192:195], v[52:55]
    ds_read_b128 v[48:51], v11 offset:55296
    v_mfma_f32_16x16x32_bf16 v[60:63], v[20:23], a[196:199], v[60:63]
    s_waitcnt lgkmcnt(6)
    v_mfma_f32_16x16x32_bf16 v[56:59], v[24:27], a[192:195], v[56:59]
    ds_read_b128 v[20:23], v10 offset:57344
    v_mfma_f32_16x16x32_bf16 v[64:67], v[24:27], a[196:199], v[64:67]
    s_waitcnt lgkmcnt(6)
    v_mfma_f32_16x16x32_bf16 v[52:55], v[28:31], a[200:203], v[52:55]
    ds_read_b128 v[24:27], v10 offset:59392
    v_mfma_f32_16x16x32_bf16 v[60:63], v[28:31], a[204:207], v[60:63]
    s_waitcnt lgkmcnt(6)
    v_mfma_f32_16x16x32_bf16 v[56:59], v[32:35], a[200:203], v[56:59]
    ds_read_b128 v[28:31], v11 offset:57344
    v_mfma_f32_16x16x32_bf16 v[64:67], v[32:35], a[204:207], v[64:67]
    s_waitcnt lgkmcnt(6)
    v_mfma_f32_16x16x32_bf16 v[52:55], v[36:39], a[208:211], v[52:55]
    ds_read_b128 v[32:35], v11 offset:59392
    v_mfma_f32_16x16x32_bf16 v[60:63], v[36:39], a[212:215], v[60:63]
    s_waitcnt lgkmcnt(6)
    v_mfma_f32_16x16x32_bf16 v[56:59], v[40:43], a[208:211], v[56:59]
    ds_read_b128 v[36:39], v10 offset:61440
    v_mfma_f32_16x16x32_bf16 v[64:67], v[40:43], a[212:215], v[64:67]
    s_waitcnt lgkmcnt(6)
    v_mfma_f32_16x16x32_bf16 v[52:55], v[44:47], a[216:219], v[52:55]
    ds_read_b128 v[40:43], v10 offset:63488
    v_mfma_f32_16x16x32_bf16 v[60:63], v[44:47], a[220:223], v[60:63]
    s_waitcnt lgkmcnt(6)
    v_mfma_f32_16x16x32_bf16 v[56:59], v[48:51], a[216:219], v[56:59]
    ds_read_b128 v[44:47], v11 offset:61440
    v_mfma_f32_16x16x32_bf16 v[64:67], v[48:51], a[220:223], v[64:67]
    s_waitcnt lgkmcnt(6)
    v_mfma_f32_16x16x32_bf16 v[52:55], v[20:23], a[224:227], v[52:55]
    ds_read_b128 v[48:51], v11 offset:63488
    v_mfma_f32_16x16x32_bf16 v[60:63], v[20:23], a[228:231], v[60:63]
    s_waitcnt lgkmcnt(6)
    v_mfma_f32_16x16x32_bf16 v[56:59], v[24:27], a[224:227], v[56:59]
    s_waitcnt vmcnt(8)
    s_barrier
    ds_read_b128 v[20:23], v12 offset:0
    v_mfma_f32_16x16x32_bf16 v[64:67], v[24:27], a[228:231], v[64:67]
    s_waitcnt lgkmcnt(6)
    v_mfma_f32_16x16x32_bf16 v[52:55], v[28:31], a[232:235], v[52:55]
    ds_read_b128 v[24:27], v12 offset:2048
    s_add_u32 m0, s19, 0
    v_mfma_f32_16x16x32_bf16 v[60:63], v[28:31], a[236:239], v[60:63]
    buffer_load_dwordx4 v2, s[8:11], s20 offen offset:0 lds
    s_waitcnt lgkmcnt(6)
    v_mfma_f32_16x16x32_bf16 v[56:59], v[32:35], a[232:235], v[56:59]
    ds_read_b128 v[28:31], v13 offset:0
    v_mfma_f32_16x16x32_bf16 v[64:67], v[32:35], a[236:239], v[64:67]
    s_waitcnt lgkmcnt(6)
    v_mfma_f32_16x16x32_bf16 v[52:55], v[36:39], a[240:243], v[52:55]
    ds_read_b128 v[32:35], v13 offset:2048
    s_add_u32 m0, s19, 3968
    v_mfma_f32_16x16x32_bf16 v[60:63], v[36:39], a[244:247], v[60:63]
    buffer_load_dwordx4 v2, s[8:11], s20 offen offset:128 lds
    s_waitcnt lgkmcnt(6)
    v_mfma_f32_16x16x32_bf16 v[56:59], v[40:43], a[240:243], v[56:59]
    ds_read_b128 v[36:39], v12 offset:4096
    v_mfma_f32_16x16x32_bf16 v[64:67], v[40:43], a[244:247], v[64:67]
    s_waitcnt lgkmcnt(6)
    v_mfma_f32_16x16x32_bf16 v[52:55], v[44:47], a[248:251], v[52:55]
    ds_read_b128 v[40:43], v12 offset:6144
    s_add_u32 m0, s19, 7936
    v_mfma_f32_16x16x32_bf16 v[60:63], v[44:47], a[252:255], v[60:63]
    buffer_load_dwordx4 v2, s[8:11], s20 offen offset:256 lds
    s_waitcnt lgkmcnt(6)
    v_mfma_f32_16x16x32_bf16 v[56:59], v[48:51], a[248:251], v[56:59]
    ds_read_b128 v[44:47], v13 offset:4096
    v_mfma_f32_16x16x32_bf16 v[64:67], v[48:51], a[252:255], v[64:67]
    s_waitcnt lgkmcnt(6)
    v_mfma_f32_16x16x32_bf16 v[68:71], v[20:23], a[0:3], 0
    ds_read_b128 v[48:51], v13 offset:6144
    v_mfma_f32_16x16x32_bf16 v[76:79], v[20:23], a[4:7], 0
    s_waitcnt lgkmcnt(6)
    v_mfma_f32_16x16x32_bf16 v[72:75], v[24:27], a[0:3], 0
    ds_read_b128 v[20:23], v12 offset:8192
    s_add_u32 m0, s19, 11904
    v_mfma_f32_16x16x32_bf16 v[80:83], v[24:27], a[4:7], 0
    buffer_load_dwordx4 v2, s[8:11], s20 offen offset:384 lds
    s_waitcnt lgkmcnt(6)
    v_mfma_f32_16x16x32_bf16 v[68:71], v[28:31], a[8:11], v[68:71]
    ds_read_b128 v[24:27], v12 offset:10240
    v_mfma_f32_16x16x32_bf16 v[76:79], v[28:31], a[12:15], v[76:79]
    s_waitcnt lgkmcnt(6)
    v_mfma_f32_16x16x32_bf16 v[72:75], v[32:35], a[8:11], v[72:75]
    ds_read_b128 v[28:31], v13 offset:8192
    s_add_u32 m0, s19, 15872
    v_mfma_f32_16x16x32_bf16 v[80:83], v[32:35], a[12:15], v[80:83]
    buffer_load_dwordx4 v2, s[8:11], s20 offen offset:512 lds
    s_waitcnt lgkmcnt(6)
    v_mfma_f32_16x16x32_bf16 v[68:71], v[36:39], a[16:19], v[68:71]
    ds_read_b128 v[32:35], v13 offset:10240
    v_mfma_f32_16x16x32_bf16 v[76:79], v[36:39], a[20:23], v[76:79]
    s_waitcnt lgkmcnt(6)
    v_mfma_f32_16x16x32_bf16 v[72:75], v[40:43], a[16:19], v[72:75]
    ds_read_b128 v[36:39], v12 offset:12288
    s_add_u32 m0, s19, 19840
    v_mfma_f32_16x16x32_bf16 v[80:83], v[40:43], a[20:23], v[80:83]
    buffer_load_dwordx4 v2, s[8:11], s20 offen offset:640 lds
    s_waitcnt lgkmcnt(6)
    v_mfma_f32_16x16x32_bf16 v[68:71], v[44:47], a[24:27], v[68:71]
    ds_read_b128 v[40:43], v12 offset:14336
    v_mfma_f32_16x16x32_bf16 v[76:79], v[44:47], a[28:31], v[76:79]
    s_waitcnt lgkmcnt(6)
    v_mfma_f32_16x16x32_bf16 v[72:75], v[48:51], a[24:27], v[72:75]
    ds_read_b128 v[44:47], v13 offset:12288
    s_add_u32 m0, s19, 23808
    v_mfma_f32_16x16x32_bf16 v[80:83], v[48:51], a[28:31], v[80:83]
    buffer_load_dwordx4 v2, s[8:11], s20 offen offset:768 lds
    s_waitcnt lgkmcnt(6)
    v_mfma_f32_16x16x32_bf16 v[68:71], v[20:23], a[32:35], v[68:71]
    ds_read_b128 v[48:51], v13 offset:14336
    v_mfma_f32_16x16x32_bf16 v[76:79], v[20:23], a[36:39], v[76:79]
    s_waitcnt lgkmcnt(6)
    v_mfma_f32_16x16x32_bf16 v[72:75], v[24:27], a[32:35], v[72:75]
    ds_read_b128 v[20:23], v12 offset:16384
    s_add_u32 m0, s19, 27776
    v_mfma_f32_16x16x32_bf16 v[80:83], v[24:27], a[36:39], v[80:83]
    buffer_load_dwordx4 v2, s[8:11], s20 offen offset:896 lds
    s_waitcnt lgkmcnt(6)
    v_mfma_f32_16x16x32_bf16 v[68:71], v[28:31], a[40:43], v[68:71]
    ds_read_b128 v[24:27], v12 offset:18432
    v_mfma_f32_16x16x32_bf16 v[76:79], v[28:31], a[44:47], v[76:79]
    v_cvt_pk_bf16_f32 v84, v52, v53
    s_waitcnt lgkmcnt(6)
    v_mfma_f32_16x16x32_bf16 v[72:75], v[32:35], a[40:43], v[72:75]
    ds_read_b128 v[28:31], v13 offset:16384
    v_mfma_f32_16x16x32_bf16 v[80:83], v[32:35], a[44:47], v[80:83]
    v_cvt_pk_bf16_f32 v85, v54, v55
    s_waitcnt lgkmcnt(6)
    v_mfma_f32_16x16x32_bf16 v[68:71], v[36:39], a[48:51], v[68:71]
    ds_read_b128 v[32:35], v13 offset:18432
    v_mfma_f32_16x16x32_bf16 v[76:79], v[36:39], a[52:55], v[76:79]
    v_cvt_pk_bf16_f32 v86, v56, v57
    s_waitcnt lgkmcnt(6)
    v_mfma_f32_16x16x32_bf16 v[72:75], v[40:43], a[48:51], v[72:75]
    ds_read_b128 v[36:39], v12 offset:20480
    v_mfma_f32_16x16x32_bf16 v[80:83], v[40:43], a[52:55], v[80:83]
    v_cvt_pk_bf16_f32 v87, v58, v59
    s_waitcnt lgkmcnt(6)
    v_mfma_f32_16x16x32_bf16 v[68:71], v[44:47], a[56:59], v[68:71]
    ds_read_b128 v[40:43], v12 offset:22528
    v_mfma_f32_16x16x32_bf16 v[76:79], v[44:47], a[60:63], v[76:79]
    v_cvt_pk_bf16_f32 v88, v60, v61
    s_waitcnt lgkmcnt(6)
    v_mfma_f32_16x16x32_bf16 v[72:75], v[48:51], a[56:59], v[72:75]
    ds_read_b128 v[44:47], v13 offset:20480
    v_mfma_f32_16x16x32_bf16 v[80:83], v[48:51], a[60:63], v[80:83]
    v_cvt_pk_bf16_f32 v89, v62, v63
    buffer_store_dwordx4 v[84:87], v3, s[4:7], s21 offen offset:0 sc1
    s_waitcnt lgkmcnt(6)
    v_mfma_f32_16x16x32_bf16 v[68:71], v[20:23], a[64:67], v[68:71]
    ds_read_b128 v[48:51], v13 offset:22528
    v_mfma_f32_16x16x32_bf16 v[76:79], v[20:23], a[68:71], v[76:79]
    v_cvt_pk_bf16_f32 v90, v64, v65
    s_waitcnt lgkmcnt(6)
    v_mfma_f32_16x16x32_bf16 v[72:75], v[24:27], a[64:67], v[72:75]
    ds_read_b128 v[20:23], v12 offset:24576
    v_mfma_f32_16x16x32_bf16 v[80:83], v[24:27], a[68:71], v[80:83]
    v_cvt_pk_bf16_f32 v91, v66, v67
    s_waitcnt lgkmcnt(6)
    v_mfma_f32_16x16x32_bf16 v[68:71], v[28:31], a[72:75], v[68:71]
    ds_read_b128 v[24:27], v12 offset:26624
    v_mfma_f32_16x16x32_bf16 v[76:79], v[28:31], a[76:79], v[76:79]
    s_waitcnt lgkmcnt(6)
    v_mfma_f32_16x16x32_bf16 v[72:75], v[32:35], a[72:75], v[72:75]
    ds_read_b128 v[28:31], v13 offset:24576
    v_mfma_f32_16x16x32_bf16 v[80:83], v[32:35], a[76:79], v[80:83]
    buffer_store_dwordx4 v[88:91], v3, s[4:7], s21 offen offset:256 sc1
    s_waitcnt lgkmcnt(6)
    v_mfma_f32_16x16x32_bf16 v[68:71], v[36:39], a[80:83], v[68:71]
    ds_read_b128 v[32:35], v13 offset:26624
    v_mfma_f32_16x16x32_bf16 v[76:79], v[36:39], a[84:87], v[76:79]
    s_add_u32 s21, s21, s25
    s_mov_b32 s25, s26
    s_waitcnt lgkmcnt(6)
    v_mfma_f32_16x16x32_bf16 v[72:75], v[40:43], a[80:83], v[72:75]
    ds_read_b128 v[36:39], v12 offset:28672
    v_mfma_f32_16x16x32_bf16 v[80:83], v[40:43], a[84:87], v[80:83]
    s_waitcnt lgkmcnt(6)
    v_mfma_f32_16x16x32_bf16 v[68:71], v[44:47], a[88:91], v[68:71]
    ds_read_b128 v[40:43], v12 offset:30720
    v_mfma_f32_16x16x32_bf16 v[76:79], v[44:47], a[92:95], v[76:79]
    s_waitcnt lgkmcnt(6)
    v_mfma_f32_16x16x32_bf16 v[72:75], v[48:51], a[88:91], v[72:75]
    ds_read_b128 v[44:47], v13 offset:28672
    v_mfma_f32_16x16x32_bf16 v[80:83], v[48:51], a[92:95], v[80:83]
    s_waitcnt lgkmcnt(6)
    v_mfma_f32_16x16x32_bf16 v[68:71], v[20:23], a[96:99], v[68:71]
    ds_read_b128 v[48:51], v13 offset:30720
    v_mfma_f32_16x16x32_bf16 v[76:79], v[20:23], a[100:103], v[76:79]
    s_waitcnt lgkmcnt(6)
    v_mfma_f32_16x16x32_bf16 v[72:75], v[24:27], a[96:99], v[72:75]
    s_waitcnt vmcnt(10)
    s_barrier
    ds_read_b128 v[20:23], v12 offset:32768
    v_mfma_f32_16x16x32_bf16 v[80:83], v[24:27], a[100:103], v[80:83]
    s_waitcnt lgkmcnt(6)
    v_mfma_f32_16x16x32_bf16 v[68:71], v[28:31], a[104:107], v[68:71]
    ds_read_b128 v[24:27], v12 offset:34816
    s_add_u32 m0, s19, 31744
    v_mfma_f32_16x16x32_bf16 v[76:79], v[28:31], a[108:111], v[76:79]
    buffer_load_dwordx4 v2, s[8:11], s20 offen offset:1024 lds
    s_waitcnt lgkmcnt(6)
    v_mfma_f32_16x16x32_bf16 v[72:75], v[32:35], a[104:107], v[72:75]
    ds_read_b128 v[28:31], v13 offset:32768
    v_mfma_f32_16x16x32_bf16 v[80:83], v[32:35], a[108:111], v[80:83]
    s_waitcnt lgkmcnt(6)
    v_mfma_f32_16x16x32_bf16 v[68:71], v[36:39], a[112:115], v[68:71]
    ds_read_b128 v[32:35], v13 offset:34816
    s_add_u32 m0, s19, 35712
    v_mfma_f32_16x16x32_bf16 v[76:79], v[36:39], a[116:119], v[76:79]
    buffer_load_dwordx4 v2, s[8:11], s20 offen offset:1152 lds
    s_waitcnt lgkmcnt(6)
    v_mfma_f32_16x16x32_bf16 v[72:75], v[40:43], a[112:115], v[72:75]
    ds_read_b128 v[36:39], v12 offset:36864
    v_mfma_f32_16x16x32_bf16 v[80:83], v[40:43], a[116:119], v[80:83]
    s_waitcnt lgkmcnt(6)
    v_mfma_f32_16x16x32_bf16 v[68:71], v[44:47], a[120:123], v[68:71]
    ds_read_b128 v[40:43], v12 offset:38912
    s_add_u32 m0, s19, 39680
    v_mfma_f32_16x16x32_bf16 v[76:79], v[44:47], a[124:127], v[76:79]
    buffer_load_dwordx4 v2, s[8:11], s20 offen offset:1280 lds
    s_waitcnt lgkmcnt(6)
    v_mfma_f32_16x16x32_bf16 v[72:75], v[48:51], a[120:123], v[72:75]
    ds_read_b128 v[44:47], v13 offset:36864
    v_mfma_f32_16x16x32_bf16 v[80:83], v[48:51], a[124:127], v[80:83]
    s_waitcnt lgkmcnt(6)
    v_mfma_f32_16x16x32_bf16 v[68:71], v[20:23], a[128:131], v[68:71]
    ds_read_b128 v[48:51], v13 offset:38912
    v_mfma_f32_16x16x32_bf16 v[76:79], v[20:23], a[132:135], v[76:79]
    s_waitcnt lgkmcnt(6)
    v_mfma_f32_16x16x32_bf16 v[72:75], v[24:27], a[128:131], v[72:75]
    ds_read_b128 v[20:23], v12 offset:40960
    s_add_u32 m0, s19, 43648
    v_mfma_f32_16x16x32_bf16 v[80:83], v[24:27], a[132:135], v[80:83]
    buffer_load_dwordx4 v2, s[8:11], s20 offen offset:1408 lds
    s_waitcnt lgkmcnt(6)
    v_mfma_f32_16x16x32_bf16 v[68:71], v[28:31], a[136:139], v[68:71]
    ds_read_b128 v[24:27], v12 offset:43008
    v_mfma_f32_16x16x32_bf16 v[76:79], v[28:31], a[140:143], v[76:79]
    s_waitcnt lgkmcnt(6)
    v_mfma_f32_16x16x32_bf16 v[72:75], v[32:35], a[136:139], v[72:75]
    ds_read_b128 v[28:31], v13 offset:40960
    s_add_u32 m0, s19, 47616
    v_mfma_f32_16x16x32_bf16 v[80:83], v[32:35], a[140:143], v[80:83]
    buffer_load_dwordx4 v2, s[8:11], s20 offen offset:1536 lds
    s_waitcnt lgkmcnt(6)
    v_mfma_f32_16x16x32_bf16 v[68:71], v[36:39], a[144:147], v[68:71]
    ds_read_b128 v[32:35], v13 offset:43008
    v_mfma_f32_16x16x32_bf16 v[76:79], v[36:39], a[148:151], v[76:79]
    s_waitcnt lgkmcnt(6)
    v_mfma_f32_16x16x32_bf16 v[72:75], v[40:43], a[144:147], v[72:75]
    ds_read_b128 v[36:39], v12 offset:45056
    s_add_u32 m0, s19, 51584
    v_mfma_f32_16x16x32_bf16 v[80:83], v[40:43], a[148:151], v[80:83]
    buffer_load_dwordx4 v2, s[8:11], s20 offen offset:1664 lds
    s_waitcnt lgkmcnt(6)
    v_mfma_f32_16x16x32_bf16 v[68:71], v[44:47], a[152:155], v[68:71]
    ds_read_b128 v[40:43], v12 offset:47104
    v_mfma_f32_16x16x32_bf16 v[76:79], v[44:47], a[156:159], v[76:79]
    s_waitcnt lgkmcnt(6)
    v_mfma_f32_16x16x32_bf16 v[72:75], v[48:51], a[152:155], v[72:75]
    ds_read_b128 v[44:47], v13 offset:45056
    s_add_u32 m0, s19, 55552
    v_mfma_f32_16x16x32_bf16 v[80:83], v[48:51], a[156:159], v[80:83]
    buffer_load_dwordx4 v2, s[8:11], s20 offen offset:1792 lds
    s_waitcnt lgkmcnt(6)
    v_mfma_f32_16x16x32_bf16 v[68:71], v[20:23], a[160:163], v[68:71]
    ds_read_b128 v[48:51], v13 offset:47104
    v_mfma_f32_16x16x32_bf16 v[76:79], v[20:23], a[164:167], v[76:79]
    s_waitcnt lgkmcnt(6)
    v_mfma_f32_16x16x32_bf16 v[72:75], v[24:27], a[160:163], v[72:75]
    ds_read_b128 v[20:23], v12 offset:49152
    s_add_u32 m0, s19, 59520
    v_mfma_f32_16x16x32_bf16 v[80:83], v[24:27], a[164:167], v[80:83]
    buffer_load_dwordx4 v2, s[8:11], s20 offen offset:1920 lds
    s_waitcnt lgkmcnt(6)
    v_mfma_f32_16x16x32_bf16 v[68:71], v[28:31], a[168:171], v[68:71]
    ds_read_b128 v[24:27], v12 offset:51200
    v_mfma_f32_16x16x32_bf16 v[76:79], v[28:31], a[172:175], v[76:79]
    s_add_u32 s20, s20, s24
    s_waitcnt lgkmcnt(6)
    v_mfma_f32_16x16x32_bf16 v[72:75], v[32:35], a[168:171], v[72:75]
    ds_read_b128 v[28:31], v13 offset:49152
    v_mfma_f32_16x16x32_bf16 v[80:83], v[32:35], a[172:175], v[80:83]
    s_waitcnt lgkmcnt(6)
    v_mfma_f32_16x16x32_bf16 v[68:71], v[36:39], a[176:179], v[68:71]
    ds_read_b128 v[32:35], v13 offset:51200
    v_mfma_f32_16x16x32_bf16 v[76:79], v[36:39], a[180:183], v[76:79]
    s_waitcnt lgkmcnt(6)
    v_mfma_f32_16x16x32_bf16 v[72:75], v[40:43], a[176:179], v[72:75]
    ds_read_b128 v[36:39], v12 offset:53248
    v_mfma_f32_16x16x32_bf16 v[80:83], v[40:43], a[180:183], v[80:83]
    s_waitcnt lgkmcnt(6)
    v_mfma_f32_16x16x32_bf16 v[68:71], v[44:47], a[184:187], v[68:71]
    ds_read_b128 v[40:43], v12 offset:55296
    v_mfma_f32_16x16x32_bf16 v[76:79], v[44:47], a[188:191], v[76:79]
    s_waitcnt lgkmcnt(6)
    v_mfma_f32_16x16x32_bf16 v[72:75], v[48:51], a[184:187], v[72:75]
    ds_read_b128 v[44:47], v13 offset:53248
    v_mfma_f32_16x16x32_bf16 v[80:83], v[48:51], a[188:191], v[80:83]
    s_waitcnt lgkmcnt(6)
    v_mfma_f32_16x16x32_bf16 v[68:71], v[20:23], a[192:195], v[68:71]
    ds_read_b128 v[48:51], v13 offset:55296
    v_mfma_f32_16x16x32_bf16 v[76:79], v[20:23], a[196:199], v[76:79]
    s_waitcnt lgkmcnt(6)
    v_mfma_f32_16x16x32_bf16 v[72:75], v[24:27], a[192:195], v[72:75]
    ds_read_b128 v[20:23], v12 offset:57344
    v_mfma_f32_16x16x32_bf16 v[80:83], v[24:27], a[196:199], v[80:83]
    s_waitcnt lgkmcnt(6)
    v_mfma_f32_16x16x32_bf16 v[68:71], v[28:31], a[200:203], v[68:71]
    ds_read_b128 v[24:27], v12 offset:59392
    v_mfma_f32_16x16x32_bf16 v[76:79], v[28:31], a[204:207], v[76:79]
    s_waitcnt lgkmcnt(6)
    v_mfma_f32_16x16x32_bf16 v[72:75], v[32:35], a[200:203], v[72:75]
    ds_read_b128 v[28:31], v13 offset:57344
    v_mfma_f32_16x16x32_bf16 v[80:83], v[32:35], a[204:207], v[80:83]
    s_waitcnt lgkmcnt(6)
    v_mfma_f32_16x16x32_bf16 v[68:71], v[36:39], a[208:211], v[68:71]
    ds_read_b128 v[32:35], v13 offset:59392
    v_mfma_f32_16x16x32_bf16 v[76:79], v[36:39], a[212:215], v[76:79]
    s_waitcnt lgkmcnt(6)
    v_mfma_f32_16x16x32_bf16 v[72:75], v[40:43], a[208:211], v[72:75]
    ds_read_b128 v[36:39], v12 offset:61440
    v_mfma_f32_16x16x32_bf16 v[80:83], v[40:43], a[212:215], v[80:83]
    s_waitcnt lgkmcnt(6)
    v_mfma_f32_16x16x32_bf16 v[68:71], v[44:47], a[216:219], v[68:71]
    ds_read_b128 v[40:43], v12 offset:63488
    v_mfma_f32_16x16x32_bf16 v[76:79], v[44:47], a[220:223], v[76:79]
    s_waitcnt lgkmcnt(6)
    v_mfma_f32_16x16x32_bf16 v[72:75], v[48:51], a[216:219], v[72:75]
    ds_read_b128 v[44:47], v13 offset:61440
    v_mfma_f32_16x16x32_bf16 v[80:83], v[48:51], a[220:223], v[80:83]
    s_waitcnt lgkmcnt(6)
    v_mfma_f32_16x16x32_bf16 v[68:71], v[20:23], a[224:227], v[68:71]
    ds_read_b128 v[48:51], v13 offset:63488
    v_mfma_f32_16x16x32_bf16 v[76:79], v[20:23], a[228:231], v[76:79]
    s_waitcnt lgkmcnt(6)
    v_mfma_f32_16x16x32_bf16 v[72:75], v[24:27], a[224:227], v[72:75]
    s_waitcnt vmcnt(8)
    s_barrier
    ds_read_b128 v[20:23], v10 offset:0
    v_mfma_f32_16x16x32_bf16 v[80:83], v[24:27], a[228:231], v[80:83]
    s_waitcnt lgkmcnt(6)
    v_mfma_f32_16x16x32_bf16 v[68:71], v[28:31], a[232:235], v[68:71]
    ds_read_b128 v[24:27], v10 offset:2048
    s_add_u32 m0, s19, 65536
    v_mfma_f32_16x16x32_bf16 v[76:79], v[28:31], a[236:239], v[76:79]
    buffer_load_dwordx4 v2, s[8:11], s20 offen offset:0 lds
    s_waitcnt lgkmcnt(6)
    v_mfma_f32_16x16x32_bf16 v[72:75], v[32:35], a[232:235], v[72:75]
    ds_read_b128 v[28:31], v11 offset:0
    v_mfma_f32_16x16x32_bf16 v[80:83], v[32:35], a[236:239], v[80:83]
    s_waitcnt lgkmcnt(6)
    v_mfma_f32_16x16x32_bf16 v[68:71], v[36:39], a[240:243], v[68:71]
    ds_read_b128 v[32:35], v11 offset:2048
    s_add_u32 m0, s19, 69504
    v_mfma_f32_16x16x32_bf16 v[76:79], v[36:39], a[244:247], v[76:79]
    buffer_load_dwordx4 v2, s[8:11], s20 offen offset:128 lds
    s_waitcnt lgkmcnt(6)
    v_mfma_f32_16x16x32_bf16 v[72:75], v[40:43], a[240:243], v[72:75]
    ds_read_b128 v[36:39], v10 offset:4096
    v_mfma_f32_16x16x32_bf16 v[80:83], v[40:43], a[244:247], v[80:83]
    s_waitcnt lgkmcnt(6)
    v_mfma_f32_16x16x32_bf16 v[68:71], v[44:47], a[248:251], v[68:71]
    ds_read_b128 v[40:43], v10 offset:6144
    s_add_u32 m0, s19, 73472
    v_mfma_f32_16x16x32_bf16 v[76:79], v[44:47], a[252:255], v[76:79]
    buffer_load_dwordx4 v2, s[8:11], s20 offen offset:256 lds
    s_waitcnt lgkmcnt(6)
    v_mfma_f32_16x16x32_bf16 v[72:75], v[48:51], a[248:251], v[72:75]
    ds_read_b128 v[44:47], v11 offset:4096
    v_mfma_f32_16x16x32_bf16 v[80:83], v[48:51], a[252:255], v[80:83]
    s_add_u32 s22, s22, 2
    s_cmp_lt_u32 s22, 16
    s_cbranch_scc1 F1_top
    v_cvt_pk_bf16_f32 v84, v68, v69
    v_cvt_pk_bf16_f32 v85, v70, v71
    s_nop 0
    v_cvt_pk_bf16_f32 v86, v72, v73
    v_cvt_pk_bf16_f32 v87, v74, v75
    v_cvt_pk_bf16_f32 v88, v76, v77
    v_cvt_pk_bf16_f32 v89, v78, v79
    v_cvt_pk_bf16_f32 v90, v80, v81
    v_cvt_pk_bf16_f32 v91, v82, v83
    buffer_store_dwordx4 v[84:87], v3, s[4:7], s21 offen offset:0 sc1
    buffer_store_dwordx4 v[88:91], v3, s[4:7], s21 offen offset:256 sc1
    s_waitcnt vmcnt(0) lgkmcnt(0)
    v_lshlrev_b32 v5, 2, v1
    s_mov_b32 s18, 0
rdv_17:
    global_load_dword v6, v5, s[100:101] sc1
    s_lshl_b32 s17, s98, 2
    s_waitcnt vmcnt(0)
    v_lshrrev_b32 v9, s17, v6
    s_cmp_eq_u32 s98, 0
    s_cselect_b32 s17, 0x0f0f0f0f, s17
    s_cselect_b32 s17, s17, 0x01010101
    v_and_b32 v9, s17, v9
    v_cmp_ne_u32 vcc, 0x01010101, v9
    s_nop 0
    s_cbranch_vccz rdvok_18
    v_sad_u8 v9, v9, 0, 0
    s_nop 1
    v_add_u32_dpp v9, v9, v9 quad_perm:[1,0,3,2] row_mask:0xf bank_mask:0xf
    v_cmp_ne_u32 vcc, 8, v9
    s_nop 0
    s_cbranch_vccnz rdvw_19
    s_mov_b32 s98, 1
    s_and_b32 s3, s97, 7
    s_barrier
    s_branch role_start
rdvw_19:
    s_sleep 4
    s_add_u32 s18, s18, 1
    s_cmp_lt_u32 s18, 262144
    s_cbranch_scc1 rdv_17
    s_mov_b32 s92, 1048576
rdvok_18:
    s_barrier
    s_lshl_b32 s31, s29, 2
    s_add_u32 s31, s31, s28
    s_lshl_b32 s17, s31, 7
    s_add_u32 s17, s17, 100745216
    v_lshl_add_u32 v5, v1, 2, s17
    v_mov_b32 v6, 1
    s_mov_b64 exec, 0xffffffff
    buffer_store_dword v6, v5, s[4:7], 0 offen sc1
    s_mov_b64 exec, -1
    v_and_b32 v10, 19, v1
    v_bfe_u32 v5, v1, 2, 1
    v_bfe_u32 v6, v1, 3, 1
    v_lshl_add_u32 v10, v5, 3, v10
    v_lshl_add_u32 v10, v6, 2, v10
    v_lshrrev_b32 v8, 1, v1
    v_and_b32 v19, 19, v8
    v_bfe_u32 v5, v8, 2, 1
    v_bfe_u32 v6, v8, 3, 1
    v_lshl_add_u32 v19, v5, 3, v19
    v_lshl_add_u32 v19, v6, 2, v19
    s_load_dwordx2 s[12:13], s[0:1], 80
    s_mov_b32 s14, 8388608
    s_mov_b32 s15, 0x20000
    v_lshrrev_b32 v11, 5, v1
    v_lshl_add_u32 v12, v11, 9, v10
    v_mul_u32_u24 v12, 1026, v12
    v_and_b32 v13, 1, v1
    v_lshlrev_b32 v13, 4, v13
    v_lshlrev_b32 v14, 4, v1
    s_lshr_b32 s17, s16, 1
    s_and_b32 s18, s16, 1
    s_lshl_b32 s17, s17, 5
    s_lshl_b32 s18, s18, 10
    s_add_u32 s17, s17, s18
    s_mul_i32 s20, s17, 1026
    s_lshl_b32 s17, s93, 5
    s_add_u32 s20, s20, s17
    v_mul_u32_u24 v19, 1026, v19
    v_add_u32 v19, v19, v13
    s_mov_b32 s32, 0x05040100
    s_mov_b32 s33, 0x07060302
    v_cvt_f32_u32 v16, v10
    v_lshlrev_b32 v17, 3, v11
    v_cvt_f32_u32 v17, v17
    s_add_u32 s17, s20, 0
    buffer_load_dwordx4 v[60:63], v19, s[48:51], s17 offen
    v_add_f32 v5, 0, v16
    v_mul_f32 v5, 1015021568, v5
    v_mul_f32 v6, v5, v17
    v_mul_f32 v7, 0x41800000, v5
    v_fract_f32 v32, v6
    v_add_f32 v33, v32, v5
    v_add_f32 v34, v33, v5
    v_add_f32 v35, v34, v5
    v_add_f32 v36, v35, v5
    v_add_f32 v37, v36, v5
    v_add_f32 v38, v37, v5
    v_add_f32 v39, v38, v5
    v_add_f32 v6, v32, v7
    v_cos_f32 v40, v32
    v_sin_f32 v48, v32
    v_cos_f32 v41, v33
    buffer_load_dwordx4 v[64:67], v19, s[52:55], s17 offen
    v_sin_f32 v49, v33
    v_cos_f32 v42, v34
    v_sin_f32 v50, v34
    v_cos_f32 v43, v35
    v_sin_f32 v51, v35
    v_cos_f32 v44, v36
    v_sin_f32 v52, v36
    v_cos_f32 v45, v37
    v_sin_f32 v53, v37
    v_cos_f32 v46, v38
    v_sin_f32 v54, v38
    v_cos_f32 v47, v39
    v_sin_f32 v55, v39
    v_cvt_pk_bf16_f32 v56, v40, v41
    v_cvt_pk_bf16_f32 v57, v48, v49
    v_accvgpr_write_b32 a0, v56
    v_xor_b32 v58, 0x80008000, v57
    s_add_u32 s17, s20, 131328
    buffer_load_dwordx4 v[68:71], v19, s[48:51], s17 offen
    v_accvgpr_write_b32 a32, v57
    v_accvgpr_write_b32 a64, v58
    v_cvt_pk_bf16_f32 v56, v42, v43
    v_cvt_pk_bf16_f32 v57, v50, v51
    v_accvgpr_write_b32 a1, v56
    v_xor_b32 v58, 0x80008000, v57
    v_accvgpr_write_b32 a33, v57
    v_accvgpr_write_b32 a65, v58
    v_cvt_pk_bf16_f32 v56, v44, v45
    v_cvt_pk_bf16_f32 v57, v52, v53
    v_accvgpr_write_b32 a2, v56
    v_xor_b32 v58, 0x80008000, v57
    v_accvgpr_write_b32 a34, v57
    v_accvgpr_write_b32 a66, v58
    v_cvt_pk_bf16_f32 v56, v46, v47
    v_cvt_pk_bf16_f32 v57, v54, v55
    v_accvgpr_write_b32 a3, v56
    buffer_load_dwordx4 v[72:75], v19, s[52:55], s17 offen
    v_xor_b32 v58, 0x80008000, v57
    v_accvgpr_write_b32 a35, v57
    v_accvgpr_write_b32 a67, v58
    v_fract_f32 v32, v6
    v_add_f32 v33, v32, v5
    v_add_f32 v34, v33, v5
    v_add_f32 v35, v34, v5
    v_add_f32 v36, v35, v5
    v_add_f32 v37, v36, v5
    v_add_f32 v38, v37, v5
    v_add_f32 v39, v38, v5
    v_add_f32 v6, v32, v7
    v_cos_f32 v40, v32
    v_sin_f32 v48, v32
    v_cos_f32 v41, v33
    v_sin_f32 v49, v33
    s_add_u32 s17, s20, 262656
    buffer_load_dwordx4 v[76:79], v19, s[48:51], s17 offen
    v_cos_f32 v42, v34
    v_sin_f32 v50, v34
    v_cos_f32 v43, v35
    v_sin_f32 v51, v35
    v_cos_f32 v44, v36
    v_sin_f32 v52, v36
    v_cos_f32 v45, v37
    v_sin_f32 v53, v37
    v_cos_f32 v46, v38
    v_sin_f32 v54, v38
    v_cos_f32 v47, v39
    v_sin_f32 v55, v39
    v_cvt_pk_bf16_f32 v56, v40, v41
    v_cvt_pk_bf16_f32 v57, v48, v49
    v_accvgpr_write_b32 a4, v56
    v_xor_b32 v58, 0x80008000, v57
    v_accvgpr_write_b32 a36, v57
    buffer_load_dwordx4 v[80:83], v19, s[52:55], s17 offen
    v_accvgpr_write_b32 a68, v58
    v_cvt_pk_bf16_f32 v56, v42, v43
    v_cvt_pk_bf16_f32 v57, v50, v51
    v_accvgpr_write_b32 a5, v56
    v_xor_b32 v58, 0x80008000, v57
    v_accvgpr_write_b32 a37, v57
    v_accvgpr_write_b32 a69, v58
    v_cvt_pk_bf16_f32 v56, v44, v45
    v_cvt_pk_bf16_f32 v57, v52, v53
    v_accvgpr_write_b32 a6, v56
    v_xor_b32 v58, 0x80008000, v57
    v_accvgpr_write_b32 a38, v57
    v_accvgpr_write_b32 a70, v58
    v_cvt_pk_bf16_f32 v56, v46, v47
    v_cvt_pk_bf16_f32 v57, v54, v55
    v_accvgpr_write_b32 a7, v56
    v_xor_b32 v58, 0x80008000, v57
    s_add_u32 s17, s20, 393984
    buffer_load_dwordx4 v[84:87], v19, s[48:51], s17 offen
    v_accvgpr_write_b32 a39, v57
    v_accvgpr_write_b32 a71, v58
    v_fract_f32 v32, v6
    v_add_f32 v33, v32, v5
    v_add_f32 v34, v33, v5
    v_add_f32 v35, v34, v5
    v_add_f32 v36, v35, v5
    v_add_f32 v37, v36, v5
    v_add_f32 v38, v37, v5
    v_add_f32 v39, v38, v5
    v_add_f32 v6, v32, v7
    v_cos_f32 v40, v32
    v_sin_f32 v48, v32
    v_cos_f32 v41, v33
    v_sin_f32 v49, v33
    v_cos_f32 v42, v34
    buffer_load_dwordx4 v[88:91], v19, s[52:55], s17 offen
    v_sin_f32 v50, v34
    v_cos_f32 v43, v35
    v_sin_f32 v51, v35
    v_cos_f32 v44, v36
    v_sin_f32 v52, v36
    v_cos_f32 v45, v37
    v_sin_f32 v53, v37
    v_cos_f32 v46, v38
    v_sin_f32 v54, v38
    v_cos_f32 v47, v39
    v_sin_f32 v55, v39
    v_cvt_pk_bf16_f32 v56, v40, v41
    v_cvt_pk_bf16_f32 v57, v48, v49
    v_accvgpr_write_b32 a8, v56
    v_xor_b32 v58, 0x80008000, v57
    v_accvgpr_write_b32 a40, v57
    v_accvgpr_write_b32 a72, v58
    s_add_u32 s17, s20, 525312
    buffer_load_dwordx4 v[92:95], v19, s[48:51], s17 offen
    v_cvt_pk_bf16_f32 v56, v42, v43
    v_cvt_pk_bf16_f32 v57, v50, v51
    v_accvgpr_write_b32 a9, v56
    v_xor_b32 v58, 0x80008000, v57
    v_accvgpr_write_b32 a41, v57
    v_accvgpr_write_b32 a73, v58
    v_cvt_pk_bf16_f32 v56, v44, v45
    v_cvt_pk_bf16_f32 v57, v52, v53
    v_accvgpr_write_b32 a10, v56
    v_xor_b32 v58, 0x80008000, v57
    v_accvgpr_write_b32 a42, v57
    v_accvgpr_write_b32 a74, v58
    v_cvt_pk_bf16_f32 v56, v46, v47
    v_cvt_pk_bf16_f32 v57, v54, v55
    v_accvgpr_write_b32 a11, v56
    v_xor_b32 v58, 0x80008000, v57
    v_accvgpr_write_b32 a43, v57
    buffer_load_dwordx4 v[96:99], v19, s[52:55], s17 offen
    v_accvgpr_write_b32 a75, v58
    v_fract_f32 v32, v6
    v_add_f32 v33, v32, v5
    v_add_f32 v34, v33, v5
    v_add_f32 v35, v34, v5
    v_add_f32 v36, v35, v5
    v_add_f32 v37, v36, v5
    v_add_f32 v38, v37, v5
    v_add_f32 v39, v38, v5
    v_add_f32 v6, v32, v7
    v_cos_f32 v40, v32
    v_sin_f32 v48, v32
    v_cos_f32 v41, v33
    v_sin_f32 v49, v33
    v_cos_f32 v42, v34
    v_sin_f32 v50, v34
    s_add_u32 s17, s20, 656640
    buffer_load_dwordx4 v[100:103], v19, s[48:51], s17 offen
    v_cos_f32 v43, v35
    v_sin_f32 v51, v35
    v_cos_f32 v44, v36
    v_sin_f32 v52, v36
    v_cos_f32 v45, v37
    v_sin_f32 v53, v37
    v_cos_f32 v46, v38
    v_sin_f32 v54, v38
    v_cos_f32 v47, v39
    v_sin_f32 v55, v39
    v_cvt_pk_bf16_f32 v56, v40, v41
    v_cvt_pk_bf16_f32 v57, v48, v49
    v_accvgpr_write_b32 a12, v56
    v_xor_b32 v58, 0x80008000, v57
    v_accvgpr_write_b32 a44, v57
    v_accvgpr_write_b32 a76, v58
    v_cvt_pk_bf16_f32 v56, v42, v43
    buffer_load_dwordx4 v[104:107], v19, s[52:55], s17 offen
    v_cvt_pk_bf16_f32 v57, v50, v51
    v_accvgpr_write_b32 a13, v56
    v_xor_b32 v58, 0x80008000, v57
    v_accvgpr_write_b32 a45, v57
    v_accvgpr_write_b32 a77, v58
    v_cvt_pk_bf16_f32 v56, v44, v45
    v_cvt_pk_bf16_f32 v57, v52, v53
    v_accvgpr_write_b32 a14, v56
    v_xor_b32 v58, 0x80008000, v57
    v_accvgpr_write_b32 a46, v57
    v_accvgpr_write_b32 a78, v58
    v_cvt_pk_bf16_f32 v56, v46, v47
    v_cvt_pk_bf16_f32 v57, v54, v55
    v_accvgpr_write_b32 a15, v56
    v_xor_b32 v58, 0x80008000, v57
    v_accvgpr_write_b32 a47, v57
    v_accvgpr_write_b32 a79, v58
    s_add_u32 s17, s20, 787968
    buffer_load_dwordx4 v[108:111], v19, s[48:51], s17 offen
    v_add_f32 v5, 1107296256, v16
    v_mul_f32 v5, 1015021568, v5
    v_mul_f32 v6, v5, v17
    v_mul_f32 v7, 0x41800000, v5
    v_fract_f32 v32, v6
    v_add_f32 v33, v32, v5
    v_add_f32 v34, v33, v5
    v_add_f32 v35, v34, v5
    v_add_f32 v36, v35, v5
    v_add_f32 v37, v36, v5
    v_add_f32 v38, v37, v5
    v_add_f32 v39, v38, v5
    v_add_f32 v6, v32, v7
    v_cos_f32 v40, v32
    v_sin_f32 v48, v32
    v_cos_f32 v41, v33
    buffer_load_dwordx4 v[112:115], v19, s[52:55], s17 offen
    v_sin_f32 v49, v33
    v_cos_f32 v42, v34
    v_sin_f32 v50, v34
    v_cos_f32 v43, v35
    v_sin_f32 v51, v35
    v_cos_f32 v44, v36
    v_sin_f32 v52, v36
    v_cos_f32 v45, v37
    v_sin_f32 v53, v37
    v_cos_f32 v46, v38
    v_sin_f32 v54, v38
    v_cos_f32 v47, v39
    v_sin_f32 v55, v39
    v_cvt_pk_bf16_f32 v56, v40, v41
    v_cvt_pk_bf16_f32 v57, v48, v49
    v_accvgpr_write_b32 a16, v56
    v_xor_b32 v58, 0x80008000, v57
    s_add_u32 s17, s20, 919296
    buffer_load_dwordx4 v[116:119], v19, s[48:51], s17 offen
    v_accvgpr_write_b32 a48, v57
    v_accvgpr_write_b32 a80, v58
    v_cvt_pk_bf16_f32 v56, v42, v43
    v_cvt_pk_bf16_f32 v57, v50, v51
    v_accvgpr_write_b32 a17, v56
    v_xor_b32 v58, 0x80008000, v57
    v_accvgpr_write_b32 a49, v57
    v_accvgpr_write_b32 a81, v58
    v_cvt_pk_bf16_f32 v56, v44, v45
    v_cvt_pk_bf16_f32 v57, v52, v53
    v_accvgpr_write_b32 a18, v56
    v_xor_b32 v58, 0x80008000, v57
    v_accvgpr_write_b32 a50, v57
    v_accvgpr_write_b32 a82, v58
    v_cvt_pk_bf16_f32 v56, v46, v47
    v_cvt_pk_bf16_f32 v57, v54, v55
    v_accvgpr_write_b32 a19, v56
    buffer_load_dwordx4 v[120:123], v19, s[52:55], s17 offen
    v_xor_b32 v58, 0x80008000, v57
    v_accvgpr_write_b32 a51, v57
    v_accvgpr_write_b32 a83, v58
    v_fract_f32 v32, v6
    v_add_f32 v33, v32, v5
    v_add_f32 v34, v33, v5
    v_add_f32 v35, v34, v5
    v_add_f32 v36, v35, v5
    v_add_f32 v37, v36, v5
    v_add_f32 v38, v37, v5
    v_add_f32 v39, v38, v5
    v_add_f32 v6, v32, v7
    v_cos_f32 v40, v32
    v_sin_f32 v48, v32
    v_cos_f32 v41, v33
    v_sin_f32 v49, v33
    v_cos_f32 v42, v34
    s_add_u32 s17, s20, 65664
    buffer_load_dwordx4 v[124:127], v19, s[48:51], s17 offen
    v_sin_f32 v50, v34
    v_cos_f32 v43, v35
    v_sin_f32 v51, v35
    v_cos_f32 v44, v36
    v_sin_f32 v52, v36
    v_cos_f32 v45, v37
    v_sin_f32 v53, v37
    v_cos_f32 v46, v38
    v_sin_f32 v54, v38
    v_cos_f32 v47, v39
    v_sin_f32 v55, v39
    v_cvt_pk_bf16_f32 v56, v40, v41
    v_cvt_pk_bf16_f32 v57, v48, v49
    v_accvgpr_write_b32 a20, v56
    v_xor_b32 v58, 0x80008000, v57
    v_accvgpr_write_b32 a52, v57
    buffer_load_dwordx4 v[128:131], v19, s[52:55], s17 offen
    v_accvgpr_write_b32 a84, v58
    v_cvt_pk_bf16_f32 v56, v42, v43
    v_cvt_pk_bf16_f32 v57, v50, v51
    v_accvgpr_write_b32 a21, v56
    v_xor_b32 v58, 0x80008000, v57
    v_accvgpr_write_b32 a53, v57
    v_accvgpr_write_b32 a85, v58
    v_cvt_pk_bf16_f32 v56, v44, v45
    v_cvt_pk_bf16_f32 v57, v52, v53
    v_accvgpr_write_b32 a22, v56
    v_xor_b32 v58, 0x80008000, v57
    v_accvgpr_write_b32 a54, v57
    v_accvgpr_write_b32 a86, v58
    v_cvt_pk_bf16_f32 v56, v46, v47
    v_cvt_pk_bf16_f32 v57, v54, v55
    v_accvgpr_write_b32 a23, v56
    v_xor_b32 v58, 0x80008000, v57
    s_add_u32 s17, s20, 196992
    buffer_load_dwordx4 v[132:135], v19, s[48:51], s17 offen
    v_accvgpr_write_b32 a55, v57
    v_accvgpr_write_b32 a87, v58
    v_fract_f32 v32, v6
    v_add_f32 v33, v32, v5
    v_add_f32 v34, v33, v5
    v_add_f32 v35, v34, v5
    v_add_f32 v36, v35, v5
    v_add_f32 v37, v36, v5
    v_add_f32 v38, v37, v5
    v_add_f32 v39, v38, v5
    v_add_f32 v6, v32, v7
    v_cos_f32 v40, v32
    v_sin_f32 v48, v32
    v_cos_f32 v41, v33
    v_sin_f32 v49, v33
    v_cos_f32 v42, v34
    v_sin_f32 v50, v34
    buffer_load_dwordx4 v[136:139], v19, s[52:55], s17 offen
    v_cos_f32 v43, v35
    v_sin_f32 v51, v35
    v_cos_f32 v44, v36
    v_sin_f32 v52, v36
    v_cos_f32 v45, v37
    v_sin_f32 v53, v37
    v_cos_f32 v46, v38
    v_sin_f32 v54, v38
    v_cos_f32 v47, v39
    v_sin_f32 v55, v39
    v_cvt_pk_bf16_f32 v56, v40, v41
    v_cvt_pk_bf16_f32 v57, v48, v49
    v_accvgpr_write_b32 a24, v56
    v_xor_b32 v58, 0x80008000, v57
    v_accvgpr_write_b32 a56, v57
    v_accvgpr_write_b32 a88, v58
    s_add_u32 s17, s20, 328320
    buffer_load_dwordx4 v[140:143], v19, s[48:51], s17 offen
    v_cvt_pk_bf16_f32 v56, v42, v43
    v_cvt_pk_bf16_f32 v57, v50, v51
    v_accvgpr_write_b32 a25, v56
    v_xor_b32 v58, 0x80008000, v57
    v_accvgpr_write_b32 a57, v57
    v_accvgpr_write_b32 a89, v58
    v_cvt_pk_bf16_f32 v56, v44, v45
    v_cvt_pk_bf16_f32 v57, v52, v53
    v_accvgpr_write_b32 a26, v56
    v_xor_b32 v58, 0x80008000, v57
    v_accvgpr_write_b32 a58, v57
    v_accvgpr_write_b32 a90, v58
    v_cvt_pk_bf16_f32 v56, v46, v47
    v_cvt_pk_bf16_f32 v57, v54, v55
    v_accvgpr_write_b32 a27, v56
    v_xor_b32 v58, 0x80008000, v57
    v_accvgpr_write_b32 a59, v57
    buffer_load_dwordx4 v[144:147], v19, s[52:55], s17 offen
    v_accvgpr_write_b32 a91, v58
    v_fract_f32 v32, v6
    v_add_f32 v33, v32, v5
    v_add_f32 v34, v33, v5
    v_add_f32 v35, v34, v5
    v_add_f32 v36, v35, v5
    v_add_f32 v37, v36, v5
    v_add_f32 v38, v37, v5
    v_add_f32 v39, v38, v5
    v_add_f32 v6, v32, v7
    v_cos_f32 v40, v32
    v_sin_f32 v48, v32
    v_cos_f32 v41, v33
    v_sin_f32 v49, v33
    v_cos_f32 v42, v34
    v_sin_f32 v50, v34
    v_cos_f32 v43, v35
    s_add_u32 s17, s20, 459648
    buffer_load_dwordx4 v[148:151], v19, s[48:51], s17 offen
    v_sin_f32 v51, v35
    v_cos_f32 v44, v36
    v_sin_f32 v52, v36
    v_cos_f32 v45, v37
    v_sin_f32 v53, v37
    v_cos_f32 v46, v38
    v_sin_f32 v54, v38
    v_cos_f32 v47, v39
    v_sin_f32 v55, v39
    v_cvt_pk_bf16_f32 v56, v40, v41
    v_cvt_pk_bf16_f32 v57, v48, v49
    v_accvgpr_write_b32 a28, v56
    v_xor_b32 v58, 0x80008000, v57
    v_accvgpr_write_b32 a60, v57
    v_accvgpr_write_b32 a92, v58
    v_cvt_pk_bf16_f32 v56, v42, v43
    buffer_load_dwordx4 v[152:155], v19, s[52:55], s17 offen
    v_cvt_pk_bf16_f32 v57, v50, v51
    v_accvgpr_write_b32 a29, v56
    v_xor_b32 v58, 0x80008000, v57
    v_accvgpr_write_b32 a61, v57
    v_accvgpr_write_b32 a93, v58
    v_cvt_pk_bf16_f32 v56, v44, v45
    v_cvt_pk_bf16_f32 v57, v52, v53
    v_accvgpr_write_b32 a30, v56
    v_xor_b32 v58, 0x80008000, v57
    v_accvgpr_write_b32 a62, v57
    v_accvgpr_write_b32 a94, v58
    v_cvt_pk_bf16_f32 v56, v46, v47
    v_cvt_pk_bf16_f32 v57, v54, v55
    v_accvgpr_write_b32 a31, v56
    v_xor_b32 v58, 0x80008000, v57
    v_accvgpr_write_b32 a63, v57
    v_accvgpr_write_b32 a95, v58
    s_add_u32 s17, s20, 590976
    buffer_load_dwordx4 v[156:159], v19, s[48:51], s17 offen
    v_add_f32 v5, 0, v16
    v_mul_f32 v5, 1023410176, v5
    v_mul_f32 v6, v5, v17
    v_mul_f32 v7, 0x41800000, v5
    v_fract_f32 v32, v6
    v_add_f32 v33, v32, v5
    v_add_f32 v34, v33, v5
    v_add_f32 v35, v34, v5
    v_add_f32 v36, v35, v5
    v_add_f32 v37, v36, v5
    v_add_f32 v38, v37, v5
    v_add_f32 v39, v38, v5
    v_add_f32 v6, v32, v7
    v_cos_f32 v40, v32
    v_sin_f32 v48, v32
    v_cos_f32 v41, v33
    v_sin_f32 v49, v33
    buffer_load_dwordx4 v[160:163], v19, s[52:55], s17 offen
    v_cos_f32 v42, v34
    v_sin_f32 v50, v34
    v_cos_f32 v43, v35
    v_sin_f32 v51, v35
    v_cos_f32 v44, v36
    v_sin_f32 v52, v36
    v_cos_f32 v45, v37
    v_sin_f32 v53, v37
    v_cos_f32 v46, v38
    v_sin_f32 v54, v38
    v_cos_f32 v47, v39
    v_sin_f32 v55, v39
    v_mul_f32 v40, 981467136, v40
    v_mul_f32 v41, 981467136, v41
    v_mul_f32 v42, 981467136, v42
    v_mul_f32 v43, 981467136, v43
    s_add_u32 s17, s20, 722304
    buffer_load_dwordx4 v[164:167], v19, s[48:51], s17 offen
    v_mul_f32 v44, 981467136, v44
    v_mul_f32 v45, 981467136, v45
    v_mul_f32 v46, 981467136, v46
    v_mul_f32 v47, 981467136, v47
    v_mul_f32 v48, 981467136, v48
    v_mul_f32 v49, 981467136, v49
    v_mul_f32 v50, 981467136, v50
    v_mul_f32 v51, 981467136, v51
    v_mul_f32 v52, 981467136, v52
    v_mul_f32 v53, 981467136, v53
    v_mul_f32 v54, 981467136, v54
    v_mul_f32 v55, 981467136, v55
    v_cvt_pk_bf16_f32 v56, v40, v41
    v_cvt_pk_bf16_f32 v57, v48, v49
    v_accvgpr_write_b32 a96, v56
    v_xor_b32 v58, 0x80008000, v57
    v_accvgpr_write_b32 a104, v57
    buffer_load_dwordx4 v[168:171], v19, s[52:55], s17 offen
    v_accvgpr_write_b32 a112, v58
    v_cvt_pk_bf16_f32 v56, v42, v43
    v_cvt_pk_bf16_f32 v57, v50, v51
    v_accvgpr_write_b32 a97, v56
    v_xor_b32 v58, 0x80008000, v57
    v_accvgpr_write_b32 a105, v57
    v_accvgpr_write_b32 a113, v58
    v_cvt_pk_bf16_f32 v56, v44, v45
    v_cvt_pk_bf16_f32 v57, v52, v53
    v_accvgpr_write_b32 a98, v56
    v_xor_b32 v58, 0x80008000, v57
    v_accvgpr_write_b32 a106, v57
    v_accvgpr_write_b32 a114, v58
    v_cvt_pk_bf16_f32 v56, v46, v47
    v_cvt_pk_bf16_f32 v57, v54, v55
    v_accvgpr_write_b32 a99, v56
    v_xor_b32 v58, 0x80008000, v57
    s_add_u32 s17, s20, 853632
    buffer_load_dwordx4 v[172:175], v19, s[48:51], s17 offen
    v_accvgpr_write_b32 a107, v57
    v_accvgpr_write_b32 a115, v58
    v_fract_f32 v32, v6
    v_add_f32 v33, v32, v5
    v_add_f32 v34, v33, v5
    v_add_f32 v35, v34, v5
    v_add_f32 v36, v35, v5
    v_add_f32 v37, v36, v5
    v_add_f32 v38, v37, v5
    v_add_f32 v39, v38, v5
    v_add_f32 v6, v32, v7
    v_cos_f32 v40, v32
    v_sin_f32 v48, v32
    v_cos_f32 v41, v33
    v_sin_f32 v49, v33
    v_cos_f32 v42, v34
    buffer_load_dwordx4 v[176:179], v19, s[52:55], s17 offen
    v_sin_f32 v50, v34
    v_cos_f32 v43, v35
    v_sin_f32 v51, v35
    v_cos_f32 v44, v36
    v_sin_f32 v52, v36
    v_cos_f32 v45, v37
    v_sin_f32 v53, v37
    v_cos_f32 v46, v38
    v_sin_f32 v54, v38
    v_cos_f32 v47, v39
    v_sin_f32 v55, v39
    v_mul_f32 v40, 981467136, v40
    v_mul_f32 v41, 981467136, v41
    v_mul_f32 v42, 981467136, v42
    v_mul_f32 v43, 981467136, v43
    v_mul_f32 v44, 981467136, v44
    v_mul_f32 v45, 981467136, v45
    s_add_u32 s17, s20, 984960
    buffer_load_dwordx4 v[180:183], v19, s[48:51], s17 offen
    v_mul_f32 v46, 981467136, v46
    v_mul_f32 v47, 981467136, v47
    v_mul_f32 v48, 981467136, v48
    v_mul_f32 v49, 981467136, v49
    v_mul_f32 v50, 981467136, v50
    v_mul_f32 v51, 981467136, v51
    v_mul_f32 v52, 981467136, v52
    v_mul_f32 v53, 981467136, v53
    v_mul_f32 v54, 981467136, v54
    v_mul_f32 v55, 981467136, v55
    v_cvt_pk_bf16_f32 v56, v40, v41
    v_cvt_pk_bf16_f32 v57, v48, v49
    v_accvgpr_write_b32 a100, v56
    v_xor_b32 v58, 0x80008000, v57
    v_accvgpr_write_b32 a108, v57
    v_accvgpr_write_b32 a116, v58
    v_cvt_pk_bf16_f32 v56, v42, v43
    buffer_load_dwordx4 v[184:187], v19, s[52:55], s17 offen
    v_cvt_pk_bf16_f32 v57, v50, v51
    v_accvgpr_write_b32 a101, v56
    v_xor_b32 v58, 0x80008000, v57
    v_accvgpr_write_b32 a109, v57
    v_accvgpr_write_b32 a117, v58
    v_cvt_pk_bf16_f32 v56, v44, v45
    v_cvt_pk_bf16_f32 v57, v52, v53
    v_accvgpr_write_b32 a102, v56
    v_xor_b32 v58, 0x80008000, v57
    v_accvgpr_write_b32 a110, v57
    v_accvgpr_write_b32 a118, v58
    v_cvt_pk_bf16_f32 v56, v46, v47
    v_cvt_pk_bf16_f32 v57, v54, v55
    v_accvgpr_write_b32 a103, v56
    v_xor_b32 v58, 0x80008000, v57
    v_accvgpr_write_b32 a111, v57
    v_accvgpr_write_b32 a119, v58
    s_lshl_b32 s17, s16, 11
    v_lshlrev_b32 v5, 12, v13
    v_lshl_add_u32 v5, v8, 4, v5
    v_add_u32 v5, s17, v5
    s_cmp_eq_u32 s16, 0
    s_cselect_b32 s17, 0, 10240
    s_add_u32 s17, s17, 0x20000
    v_add_u32 v13, s17, v14
    s_waitcnt vmcnt(24)
    v_perm_b32 v236, v64, v60, s32
    v_perm_b32 v237, v72, v68, s32
    v_perm_b32 v238, v80, v76, s32
    v_perm_b32 v239, v88, v84, s32
    ds_write_b128 v5, v[236:239] offset:0
    v_perm_b32 v240, v64, v60, s33
    v_perm_b32 v241, v72, v68, s33
    v_perm_b32 v242, v80, v76, s33
    v_perm_b32 v243, v88, v84, s33
    ds_write_b128 v5, v[240:243] offset:8192
    v_perm_b32 v244, v65, v61, s32
    v_perm_b32 v245, v73, v69, s32
    v_perm_b32 v246, v81, v77, s32
    v_perm_b32 v247, v89, v85, s32
    ds_write_b128 v5, v[244:247] offset:16384
    v_perm_b32 v248, v65, v61, s33
    v_perm_b32 v249, v73, v69, s33
    v_perm_b32 v250, v81, v77, s33
    v_perm_b32 v251, v89, v85, s33
    ds_write_b128 v5, v[248:251] offset:24576
    v_perm_b32 v236, v66, v62, s32
    v_perm_b32 v237, v74, v70, s32
    v_perm_b32 v238, v82, v78, s32
    v_perm_b32 v239, v90, v86, s32
    ds_write_b128 v5, v[236:239] offset:32768
    v_perm_b32 v240, v66, v62, s33
    v_perm_b32 v241, v74, v70, s33
    v_perm_b32 v242, v82, v78, s33
    v_perm_b32 v243, v90, v86, s33
    ds_write_b128 v5, v[240:243] offset:40960
    v_perm_b32 v244, v67, v63, s32
    v_perm_b32 v245, v75, v71, s32
    v_perm_b32 v246, v83, v79, s32
    v_perm_b32 v247, v91, v87, s32
    ds_write_b128 v5, v[244:247] offset:49152
    v_perm_b32 v248, v67, v63, s33
    v_perm_b32 v249, v75, v71, s33
    v_perm_b32 v250, v83, v79, s33
    v_perm_b32 v251, v91, v87, s33
    ds_write_b128 v5, v[248:251] offset:57344
    s_waitcnt vmcnt(16)
    v_perm_b32 v236, v96, v92, s32
    v_perm_b32 v237, v104, v100, s32
    v_perm_b32 v238, v112, v108, s32
    v_perm_b32 v239, v120, v116, s32
    ds_write_b128 v5, v[236:239] offset:512
    v_perm_b32 v240, v96, v92, s33
    v_perm_b32 v241, v104, v100, s33
    v_perm_b32 v242, v112, v108, s33
    v_perm_b32 v243, v120, v116, s33
    ds_write_b128 v5, v[240:243] offset:8704
    v_perm_b32 v244, v97, v93, s32
    v_perm_b32 v245, v105, v101, s32
    v_perm_b32 v246, v113, v109, s32
    v_perm_b32 v247, v121, v117, s32
    ds_write_b128 v5, v[244:247] offset:16896
    v_perm_b32 v248, v97, v93, s33
    v_perm_b32 v249, v105, v101, s33
    v_perm_b32 v250, v113, v109, s33
    v_perm_b32 v251, v121, v117, s33
    ds_write_b128 v5, v[248:251] offset:25088
    v_perm_b32 v236, v98, v94, s32
    v_perm_b32 v237, v106, v102, s32
    v_perm_b32 v238, v114, v110, s32
    v_perm_b32 v239, v122, v118, s32
    ds_write_b128 v5, v[236:239] offset:33280
    v_perm_b32 v240, v98, v94, s33
    v_perm_b32 v241, v106, v102, s33
    v_perm_b32 v242, v114, v110, s33
    v_perm_b32 v243, v122, v118, s33
    ds_write_b128 v5, v[240:243] offset:41472
    v_perm_b32 v244, v99, v95, s32
    v_perm_b32 v245, v107, v103, s32
    v_perm_b32 v246, v115, v111, s32
    v_perm_b32 v247, v123, v119, s32
    ds_write_b128 v5, v[244:247] offset:49664
    v_perm_b32 v248, v99, v95, s33
    v_perm_b32 v249, v107, v103, s33
    v_perm_b32 v250, v115, v111, s33
    v_perm_b32 v251, v123, v119, s33
    ds_write_b128 v5, v[248:251] offset:57856
    s_waitcnt vmcnt(8)
    v_perm_b32 v236, v128, v124, s32
    v_perm_b32 v237, v136, v132, s32
    v_perm_b32 v238, v144, v140, s32
    v_perm_b32 v239, v152, v148, s32
    ds_write_b128 v5, v[236:239] offset:1024
    v_perm_b32 v240, v128, v124, s33
    v_perm_b32 v241, v136, v132, s33
    v_perm_b32 v242, v144, v140, s33
    v_perm_b32 v243, v152, v148, s33
    ds_write_b128 v5, v[240:243] offset:9216
    v_perm_b32 v244, v129, v125, s32
    v_perm_b32 v245, v137, v133, s32
    v_perm_b32 v246, v145, v141, s32
    v_perm_b32 v247, v153, v149, s32
    ds_write_b128 v5, v[244:247] offset:17408
    v_perm_b32 v248, v129, v125, s33
    v_perm_b32 v249, v137, v133, s33
    v_perm_b32 v250, v145, v141, s33
    v_perm_b32 v251, v153, v149, s33
    ds_write_b128 v5, v[248:251] offset:25600
    v_perm_b32 v236, v130, v126, s32
    v_perm_b32 v237, v138, v134, s32
    v_perm_b32 v238, v146, v142, s32
    v_perm_b32 v239, v154, v150, s32
    ds_write_b128 v5, v[236:239] offset:33792
    v_perm_b32 v240, v130, v126, s33
    v_perm_b32 v241, v138, v134, s33
    v_perm_b32 v242, v146, v142, s33
    v_perm_b32 v243, v154, v150, s33
    ds_write_b128 v5, v[240:243] offset:41984
    v_perm_b32 v244, v131, v127, s32
    v_perm_b32 v245, v139, v135, s32
    v_perm_b32 v246, v147, v143, s32
    v_perm_b32 v247, v155, v151, s32
    ds_write_b128 v5, v[244:247] offset:50176
    v_perm_b32 v248, v131, v127, s33
    v_perm_b32 v249, v139, v135, s33
    v_perm_b32 v250, v147, v143, s33
    v_perm_b32 v251, v155, v151, s33
    ds_write_b128 v5, v[248:251] offset:58368
    s_waitcnt vmcnt(0)
    v_perm_b32 v236, v160, v156, s32
    v_perm_b32 v237, v168, v164, s32
    v_perm_b32 v238, v176, v172, s32
    v_perm_b32 v239, v184, v180, s32
    ds_write_b128 v5, v[236:239] offset:1536
    v_perm_b32 v240, v160, v156, s33
    v_perm_b32 v241, v168, v164, s33
    v_perm_b32 v242, v176, v172, s33
    v_perm_b32 v243, v184, v180, s33
    ds_write_b128 v5, v[240:243] offset:9728
    v_perm_b32 v244, v161, v157, s32
    v_perm_b32 v245, v169, v165, s32
    v_perm_b32 v246, v177, v173, s32
    v_perm_b32 v247, v185, v181, s32
    ds_write_b128 v5, v[244:247] offset:17920
    v_perm_b32 v248, v161, v157, s33
    v_perm_b32 v249, v169, v165, s33
    v_perm_b32 v250, v177, v173, s33
    v_perm_b32 v251, v185, v181, s33
    ds_write_b128 v5, v[248:251] offset:26112
    v_perm_b32 v236, v162, v158, s32
    v_perm_b32 v237, v170, v166, s32
    v_perm_b32 v238, v178, v174, s32
    v_perm_b32 v239, v186, v182, s32
    ds_write_b128 v5, v[236:239] offset:34304
    v_perm_b32 v240, v162, v158, s33
    v_perm_b32 v241, v170, v166, s33
    v_perm_b32 v242, v178, v174, s33
    v_perm_b32 v243, v186, v182, s33
    ds_write_b128 v5, v[240:243] offset:42496
    v_perm_b32 v244, v163, v159, s32
    v_perm_b32 v245, v171, v167, s32
    v_perm_b32 v246, v179, v175, s32
    v_perm_b32 v247, v187, v183, s32
    ds_write_b128 v5, v[244:247] offset:50688
    v_perm_b32 v248, v163, v159, s33
    v_perm_b32 v249, v171, v167, s33
    v_perm_b32 v250, v179, v175, s33
    v_perm_b32 v251, v187, v183, s33
    ds_write_b128 v5, v[248:251] offset:58880
    v_mul_u32_u24 v15, 2176, v10
    v_lshl_add_u32 v15, v11, 4, v15
    v_lshlrev_b32 v18, 12, v11
    v_lshl_add_u32 v18, v10, 4, v18
    s_mul_i32 s32, s93, 139776
    s_lshl_b32 s17, s16, 9
    s_add_u32 s32, s32, s17
    s_add_u32 s32, s32, 104857600
    s_add_u32 s33, s32, 64
    s_lshl_b32 s31, s93, 2
    s_add_u32 s31, s31, s16
    s_lshl_b32 s35, s16, 15
    s_mov_b32 s38, 0xffff0000
    s_mov_b32 s36, 0
    s_cmp_eq_u32 s31, 0
    s_cselect_b32 s37, 5, 4
    s_cselect_b32 s33, 1073741824, s33
    s_cselect_b32 s34, 1024, 1073741824
    v_and_b32 v8, 3, v1
    v_lshlrev_b32 v8, 7, v8
    s_lshl_b32 s17, s93, 9
    s_add_u32 s17, s17, 100745216
    v_add_u32 v8, s17, v8
    s_waitcnt lgkmcnt(0)
    s_mov_b32 s30, s92
F2_w:
    buffer_load_dword v5, v8, s[4:7], 0 offen sc1
    s_waitcnt vmcnt(0)
    v_cmp_gt_u32 vcc, 1, v5
    s_nop 0
    s_and_b32 s17, vcc_lo, 15
    s_cbranch_scc0 F2_w_ok
    s_cmp_ge_u32 s30, 1048576
    s_cselect_b32 s92, 1048576, s92
    s_cbranch_scc1 F2_w_ok
    s_add_u32 s30, s30, 1
    s_sleep 8
    s_branch F2_w
F2_w_ok:
    buffer_load_dwordx4 v[128:131], v15, s[4:7], s32 offen offset:0
    buffer_load_dwordx4 v[132:135], v15, s[4:7], s32 offen offset:32
    s_add_u32 s17, s32, 69632
    buffer_load_dwordx4 v[136:139], v15, s[4:7], s17 offen offset:0
    buffer_load_dwordx4 v[140:143], v15, s[4:7], s17 offen offset:32
    buffer_load_dwordx4 v[144:147], v15, s[4:7], s33 offen offset:0
    buffer_load_dwordx4 v[148:151], v15, s[4:7], s33 offen offset:32
    s_add_u32 s17, s33, 69632
    buffer_load_dwordx4 v[152:155], v15, s[4:7], s17 offen offset:0
    buffer_load_dwordx4 v[156:159], v15, s[4:7], s17 offen offset:32
    v_add_f32 v5, 0, v16
    v_mul_f32 v5, 973078528, v5
    v_add_f32 v6, 0, v17
    v_mul_f32 v6, v6, v5
    v_cos_f32 v160, v6
    v_sin_f32 v176, v6
    v_add_f32 v6, 1065353216, v17
    v_mul_f32 v6, v6, v5
    v_cos_f32 v161, v6
    v_sin_f32 v177, v6
    v_add_f32 v6, 1073741824, v17
    v_mul_f32 v6, v6, v5
    v_cos_f32 v162, v6
    v_sin_f32 v178, v6
    v_add_f32 v6, 1077936128, v17
    v_mul_f32 v6, v6, v5
    v_cos_f32 v163, v6
    v_sin_f32 v179, v6
    v_add_f32 v6, 1082130432, v17
    v_mul_f32 v6, v6, v5
    v_cos_f32 v164, v6
    v_sin_f32 v180, v6
    v_add_f32 v6, 1084227584, v17
    v_mul_f32 v6, v6, v5
    v_cos_f32 v165, v6
    v_sin_f32 v181, v6
    v_add_f32 v6, 1086324736, v17
    v_mul_f32 v6, v6, v5
    v_cos_f32 v166, v6
    v_sin_f32 v182, v6
    v_add_f32 v6, 1088421888, v17
    v_mul_f32 v6, v6, v5
    v_cos_f32 v167, v6
    v_sin_f32 v183, v6
    v_add_f32 v6, 1098907648, v17
    v_mul_f32 v6, v6, v5
    v_cos_f32 v168, v6
    v_sin_f32 v184, v6
    v_add_f32 v6, 1099431936, v17
    v_mul_f32 v6, v6, v5
    v_cos_f32 v169, v6
    v_sin_f32 v185, v6
    v_add_f32 v6, 1099956224, v17
    v_mul_f32 v6, v6, v5
    v_cos_f32 v170, v6
    v_sin_f32 v186, v6
    v_add_f32 v6, 1100480512, v17
    v_mul_f32 v6, v6, v5
    v_cos_f32 v171, v6
    v_sin_f32 v187, v6
    v_add_f32 v6, 1101004800, v17
    v_mul_f32 v6, v6, v5
    v_cos_f32 v172, v6
    v_sin_f32 v188, v6
    v_add_f32 v6, 1101529088, v17
    v_mul_f32 v6, v6, v5
    v_cos_f32 v173, v6
    v_sin_f32 v189, v6
    v_add_f32 v6, 1102053376, v17
    v_mul_f32 v6, v6, v5
    v_cos_f32 v174, v6
    v_sin_f32 v190, v6
    v_add_f32 v6, 1102577664, v17
    v_mul_f32 v6, v6, v5
    v_cos_f32 v175, v6
    v_sin_f32 v191, v6
    v_add_f32 v5, 1107296256, v16
    v_mul_f32 v5, 973078528, v5
    v_add_f32 v6, 0, v17
    v_mul_f32 v6, v6, v5
    v_cos_f32 v192, v6
    v_sin_f32 v208, v6
    v_add_f32 v6, 1065353216, v17
    v_mul_f32 v6, v6, v5
    v_cos_f32 v193, v6
    v_sin_f32 v209, v6
    v_add_f32 v6, 1073741824, v17
    v_mul_f32 v6, v6, v5
    v_cos_f32 v194, v6
    v_sin_f32 v210, v6
    v_add_f32 v6, 1077936128, v17
    v_mul_f32 v6, v6, v5
    v_cos_f32 v195, v6
    v_sin_f32 v211, v6
    v_add_f32 v6, 1082130432, v17
    v_mul_f32 v6, v6, v5
    v_cos_f32 v196, v6
    v_sin_f32 v212, v6
    v_add_f32 v6, 1084227584, v17
    v_mul_f32 v6, v6, v5
    v_cos_f32 v197, v6
    v_sin_f32 v213, v6
    v_add_f32 v6, 1086324736, v17
    v_mul_f32 v6, v6, v5
    v_cos_f32 v198, v6
    v_sin_f32 v214, v6
    v_add_f32 v6, 1088421888, v17
    v_mul_f32 v6, v6, v5
    v_cos_f32 v199, v6
    v_sin_f32 v215, v6
    v_add_f32 v6, 1098907648, v17
    v_mul_f32 v6, v6, v5
    v_cos_f32 v200, v6
    v_sin_f32 v216, v6
    v_add_f32 v6, 1099431936, v17
    v_mul_f32 v6, v6, v5
    v_cos_f32 v201, v6
    v_sin_f32 v217, v6
    v_add_f32 v6, 1099956224, v17
    v_mul_f32 v6, v6, v5
    v_cos_f32 v202, v6
    v_sin_f32 v218, v6
    v_add_f32 v6, 1100480512, v17
    v_mul_f32 v6, v6, v5
    v_cos_f32 v203, v6
    v_sin_f32 v219, v6
    v_add_f32 v6, 1101004800, v17
    v_mul_f32 v6, v6, v5
    v_cos_f32 v204, v6
    v_sin_f32 v220, v6
    v_add_f32 v6, 1101529088, v17
    v_mul_f32 v6, v6, v5
    v_cos_f32 v205, v6
    v_sin_f32 v221, v6
    v_add_f32 v6, 1102053376, v17
    v_mul_f32 v6, v6, v5
    v_cos_f32 v206, v6
    v_sin_f32 v222, v6
    v_add_f32 v6, 1102577664, v17
    v_mul_f32 v6, v6, v5
    v_cos_f32 v207, v6
    v_sin_f32 v223, v6
    v_add_f32 v5, 0, v16
    v_mul_f32 v5, 973078528, v5
    v_add_f32 v6, 1107296256, v17
    v_mul_f32 v6, v6, v5
    v_cos_f32 v224, v6
    v_sin_f32 v240, v6
    v_add_f32 v6, 1107558400, v17
    v_mul_f32 v6, v6, v5
    v_cos_f32 v225, v6
    v_sin_f32 v241, v6
    v_add_f32 v6, 1107820544, v17
    v_mul_f32 v6, v6, v5
    v_cos_f32 v226, v6
    v_sin_f32 v242, v6
    v_add_f32 v6, 1108082688, v17
    v_mul_f32 v6, v6, v5
    v_cos_f32 v227, v6
    v_sin_f32 v243, v6
    v_add_f32 v6, 1108344832, v17
    v_mul_f32 v6, v6, v5
    v_cos_f32 v228, v6
    v_sin_f32 v244, v6
    v_add_f32 v6, 1108606976, v17
    v_mul_f32 v6, v6, v5
    v_cos_f32 v229, v6
    v_sin_f32 v245, v6
    v_add_f32 v6, 1108869120, v17
    v_mul_f32 v6, v6, v5
    v_cos_f32 v230, v6
    v_sin_f32 v246, v6
    v_add_f32 v6, 1109131264, v17
    v_mul_f32 v6, v6, v5
    v_cos_f32 v231, v6
    v_sin_f32 v247, v6
    v_add_f32 v6, 1111490560, v17
    v_mul_f32 v6, v6, v5
    v_cos_f32 v232, v6
    v_sin_f32 v248, v6
    v_add_f32 v6, 1111752704, v17
    v_mul_f32 v6, v6, v5
    v_cos_f32 v233, v6
    v_sin_f32 v249, v6
    v_add_f32 v6, 1112014848, v17
    v_mul_f32 v6, v6, v5
    v_cos_f32 v234, v6
    v_sin_f32 v250, v6
    v_add_f32 v6, 1112276992, v17
    v_mul_f32 v6, v6, v5
    v_cos_f32 v235, v6
    v_sin_f32 v251, v6
    v_add_f32 v6, 1112539136, v17
    v_mul_f32 v6, v6, v5
    v_cos_f32 v236, v6
    v_sin_f32 v252, v6
    v_add_f32 v6, 1112801280, v17
    v_mul_f32 v6, v6, v5
    v_cos_f32 v237, v6
    v_sin_f32 v253, v6
    v_add_f32 v6, 1113063424, v17
    v_mul_f32 v6, v6, v5
    v_cos_f32 v238, v6
    v_sin_f32 v254, v6
    v_add_f32 v6, 1113325568, v17
    v_mul_f32 v6, v6, v5
    v_cos_f32 v239, v6
    v_sin_f32 v255, v6
    s_barrier
.p2align 6
F2_top:
    s_waitcnt vmcnt(0)
    v_mfma_f32_32x32x16_bf16 v[32:47], v[128:131], a[0:3], 0
    v_mfma_f32_32x32x16_bf16 v[48:63], v[144:147], a[0:3], 0
    v_mfma_f32_32x32x16_bf16 v[32:47], v[144:147], a[32:35], v[32:47]
    ds_write_b128 v13, a[248:251]
    v_mfma_f32_32x32x16_bf16 v[48:63], v[128:131], a[64:67], v[48:63]
    ds_write_b128 v13, a[252:255] offset:1024
    ds_write_b16 v13, v2 offset:2
    v_mfma_f32_32x32x16_bf16 v[32:47], v[132:135], a[4:7], v[32:47]
    ds_write_b16 v13, v3 offset:1026
    v_mfma_f32_32x32x16_bf16 v[48:63], v[148:151], a[4:7], v[48:63]
    ds_write_b16 v13, v4 offset:6
    ds_write_b16 v13, v7 offset:1030
    v_mfma_f32_32x32x16_bf16 v[32:47], v[148:151], a[36:39], v[32:47]
    ds_write_b16 v13, v8 offset:10
    v_mfma_f32_32x32x16_bf16 v[48:63], v[132:135], a[68:71], v[48:63]
    ds_write_b16 v13, v10 offset:1034
    ds_write_b16 v13, v11 offset:14
    v_mfma_f32_32x32x16_bf16 v[32:47], v[136:139], a[8:11], v[32:47]
    ds_write_b16 v13, v16 offset:1038
    v_mfma_f32_32x32x16_bf16 v[48:63], v[152:155], a[8:11], v[48:63]
    v_add_u32 v13, 2048, v13
    s_add_u32 s36, s36, 1
    v_mfma_f32_32x32x16_bf16 v[32:47], v[152:155], a[40:43], v[32:47]
    s_add_u32 s32, s32, 128
    v_mfma_f32_32x32x16_bf16 v[48:63], v[136:139], a[72:75], v[48:63]
    s_add_u32 s33, s32, 64
    s_cmp_eq_u32 s36, 4
    v_mfma_f32_32x32x16_bf16 v[32:47], v[140:143], a[12:15], v[32:47]
    s_cselect_b32 s32, 104857664, s32
    v_mfma_f32_32x32x16_bf16 v[48:63], v[156:159], a[12:15], v[48:63]
    s_cselect_b32 s33, 1073741824, s33
    s_cmp_lt_u32 s36, s37
    v_mfma_f32_32x32x16_bf16 v[32:47], v[156:159], a[44:47], v[32:47]
    s_cselect_b32 s32, s32, 1073741824
    v_mfma_f32_32x32x16_bf16 v[48:63], v[140:143], a[76:79], v[48:63]
    s_cselect_b32 s33, s33, 1073741824
    v_add_u32 v19, s35, v14
    v_mfma_f32_32x32x16_bf16 v[64:79], v[128:131], a[16:19], 0
    v_mfma_f32_32x32x16_bf16 v[80:95], v[144:147], a[16:19], 0
    s_add_u32 s18, s34, 0
    buffer_load_ushort a248, v12, s[48:51], s18 offen
    buffer_load_ushort v2, v12, s[52:55], s18 offen
    v_mfma_f32_32x32x16_bf16 v[64:79], v[144:147], a[48:51], v[64:79]
    v_mul_f32 v20, v32, v160
    s_nop 0
    v_mul_f32 v22, v48, v160
    v_mul_f32 v21, v33, v161
    v_mul_f32 v23, v49, v161
    v_fma_f32 v20, v48, v176, v20
    v_mfma_f32_32x32x16_bf16 v[80:95], v[128:131], a[80:83], v[80:95]
    v_fma_f32 v22, -v32, v176, v22
    v_fma_f32 v21, v49, v177, v21
    v_fma_f32 v23, -v33, v177, v23
    v_cvt_pk_bf16_f32 v96, v20, v21
    v_cvt_pk_bf16_f32 v112, v22, v23
    v_mul_f32 v24, v34, v162
    v_mfma_f32_32x32x16_bf16 v[64:79], v[132:135], a[20:23], v[64:79]
    v_mul_f32 v26, v50, v162
    v_mul_f32 v25, v35, v163
    v_mul_f32 v27, v51, v163
    v_fma_f32 v24, v50, v178, v24
    v_fma_f32 v26, -v34, v178, v26
    v_fma_f32 v25, v51, v179, v25
    v_mfma_f32_32x32x16_bf16 v[80:95], v[148:151], a[20:23], v[80:95]
    v_fma_f32 v27, -v35, v179, v27
    v_cvt_pk_bf16_f32 v97, v24, v25
    v_cvt_pk_bf16_f32 v113, v26, v27
    v_mul_f32 v20, v36, v164
    v_mul_f32 v22, v52, v164
    v_mfma_f32_32x32x16_bf16 v[64:79], v[148:151], a[52:55], v[64:79]
    v_mul_f32 v21, v37, v165
    v_mul_f32 v23, v53, v165
    v_fma_f32 v20, v52, v180, v20
    v_fma_f32 v22, -v36, v180, v22
    v_fma_f32 v21, v53, v181, v21
    v_fma_f32 v23, -v37, v181, v23
    v_mfma_f32_32x32x16_bf16 v[80:95], v[132:135], a[84:87], v[80:95]
    v_cvt_pk_bf16_f32 v98, v20, v21
    v_cvt_pk_bf16_f32 v114, v22, v23
    v_mul_f32 v24, v38, v166
    v_mul_f32 v26, v54, v166
    v_mul_f32 v25, v39, v167
    v_mul_f32 v27, v55, v167
    v_mfma_f32_32x32x16_bf16 v[64:79], v[136:139], a[24:27], v[64:79]
    v_fma_f32 v24, v54, v182, v24
    v_fma_f32 v26, -v38, v182, v26
    v_fma_f32 v25, v55, v183, v25
    v_fma_f32 v27, -v39, v183, v27
    v_cvt_pk_bf16_f32 v99, v24, v25
    v_cvt_pk_bf16_f32 v115, v26, v27
    v_mfma_f32_32x32x16_bf16 v[80:95], v[152:155], a[24:27], v[80:95]
    v_mul_f32 v20, v40, v168
    v_mul_f32 v22, v56, v168
    v_mul_f32 v21, v41, v169
    v_mul_f32 v23, v57, v169
    v_fma_f32 v20, v56, v184, v20
    v_mfma_f32_32x32x16_bf16 v[64:79], v[152:155], a[56:59], v[64:79]
    v_fma_f32 v22, -v40, v184, v22
    v_fma_f32 v21, v57, v185, v21
    v_fma_f32 v23, -v41, v185, v23
    v_cvt_pk_bf16_f32 v100, v20, v21
    v_cvt_pk_bf16_f32 v116, v22, v23
    v_mul_f32 v24, v42, v170
    v_mfma_f32_32x32x16_bf16 v[80:95], v[136:139], a[88:91], v[80:95]
    v_mul_f32 v26, v58, v170
    v_mul_f32 v25, v43, v171
    v_mul_f32 v27, v59, v171
    v_fma_f32 v24, v58, v186, v24
    v_fma_f32 v26, -v42, v186, v26
    v_fma_f32 v25, v59, v187, v25
    v_mfma_f32_32x32x16_bf16 v[64:79], v[140:143], a[28:31], v[64:79]
    v_fma_f32 v27, -v43, v187, v27
    v_cvt_pk_bf16_f32 v101, v24, v25
    v_cvt_pk_bf16_f32 v117, v26, v27
    v_mul_f32 v20, v44, v172
    v_mul_f32 v22, v60, v172
    v_mfma_f32_32x32x16_bf16 v[80:95], v[156:159], a[28:31], v[80:95]
    v_mul_f32 v21, v45, v173
    v_mul_f32 v23, v61, v173
    v_fma_f32 v20, v60, v188, v20
    v_fma_f32 v22, -v44, v188, v22
    v_fma_f32 v21, v61, v189, v21
    v_fma_f32 v23, -v45, v189, v23
    v_mfma_f32_32x32x16_bf16 v[64:79], v[156:159], a[60:63], v[64:79]
    v_cvt_pk_bf16_f32 v102, v20, v21
    v_cvt_pk_bf16_f32 v118, v22, v23
    v_mul_f32 v24, v46, v174
    v_mul_f32 v26, v62, v174
    v_mul_f32 v25, v47, v175
    v_mul_f32 v27, v63, v175
    v_mfma_f32_32x32x16_bf16 v[80:95], v[140:143], a[92:95], v[80:95]
    v_fma_f32 v24, v62, v190, v24
    v_fma_f32 v26, -v46, v190, v26
    v_fma_f32 v25, v63, v191, v25
    v_fma_f32 v27, -v47, v191, v27
    v_cvt_pk_bf16_f32 v103, v24, v25
    v_cvt_pk_bf16_f32 v119, v26, v27
    v_mfma_f32_32x32x16_bf16 v[32:47], a[96:99], v[96:99], 0
    buffer_load_dwordx4 v[128:131], v15, s[4:7], s32 offen offset:0
    v_mfma_f32_32x32x16_bf16 v[48:63], a[96:99], v[112:115], 0
    buffer_load_dwordx4 v[132:135], v15, s[4:7], s32 offen offset:32
    v_mfma_f32_32x32x16_bf16 v[32:47], a[104:107], v[112:115], v[32:47]
    s_add_u32 s17, s32, 69632
    buffer_load_dwordx4 v[136:139], v15, s[4:7], s17 offen offset:0
    v_mul_f32 v20, v64, v192
    v_mul_f32 v22, v80, v192
    v_mul_f32 v21, v65, v193
    v_mul_f32 v23, v81, v193
    v_fma_f32 v20, v80, v208, v20
    v_fma_f32 v22, -v64, v208, v22
    v_fma_f32 v21, v81, v209, v21
    v_fma_f32 v23, -v65, v209, v23
    v_cvt_pk_bf16_f32 v104, v20, v21
    v_cvt_pk_bf16_f32 v120, v22, v23
    v_mul_f32 v24, v66, v194
    v_mul_f32 v26, v82, v194
    v_mul_f32 v25, v67, v195
    v_mfma_f32_32x32x16_bf16 v[48:63], a[112:115], v[96:99], v[48:63]
    buffer_load_dwordx4 v[140:143], v15, s[4:7], s17 offen offset:32
    v_mul_f32 v27, v83, v195
    v_fma_f32 v24, v82, v210, v24
    v_fma_f32 v26, -v66, v210, v26
    v_fma_f32 v25, v83, v211, v25
    v_fma_f32 v27, -v67, v211, v27
    v_cvt_pk_bf16_f32 v105, v24, v25
    v_cvt_pk_bf16_f32 v121, v26, v27
    v_mul_f32 v20, v68, v196
    v_mul_f32 v22, v84, v196
    v_mul_f32 v21, v69, v197
    v_mul_f32 v23, v85, v197
    v_fma_f32 v20, v84, v212, v20
    v_fma_f32 v22, -v68, v212, v22
    v_mfma_f32_32x32x16_bf16 v[32:47], a[100:103], v[100:103], v[32:47]
    buffer_load_dwordx4 v[144:147], v15, s[4:7], s33 offen offset:0
    v_fma_f32 v21, v85, v213, v21
    v_fma_f32 v23, -v69, v213, v23
    v_cvt_pk_bf16_f32 v106, v20, v21
    v_cvt_pk_bf16_f32 v122, v22, v23
    v_mul_f32 v24, v70, v198
    v_mul_f32 v26, v86, v198
    v_mul_f32 v25, v71, v199
    v_mul_f32 v27, v87, v199
    v_fma_f32 v24, v86, v214, v24
    v_fma_f32 v26, -v70, v214, v26
    v_fma_f32 v25, v87, v215, v25
    v_fma_f32 v27, -v71, v215, v27
    v_cvt_pk_bf16_f32 v107, v24, v25
    v_cvt_pk_bf16_f32 v123, v26, v27
    v_mfma_f32_32x32x16_bf16 v[48:63], a[100:103], v[116:119], v[48:63]
    buffer_load_dwordx4 v[148:151], v15, s[4:7], s33 offen offset:32
    v_mul_f32 v20, v72, v200
    v_mul_f32 v22, v88, v200
    v_mul_f32 v21, v73, v201
    v_mul_f32 v23, v89, v201
    v_fma_f32 v20, v88, v216, v20
    v_fma_f32 v22, -v72, v216, v22
    v_fma_f32 v21, v89, v217, v21
    v_fma_f32 v23, -v73, v217, v23
    v_cvt_pk_bf16_f32 v108, v20, v21
    v_cvt_pk_bf16_f32 v124, v22, v23
    v_mul_f32 v24, v74, v202
    v_mul_f32 v26, v90, v202
    v_mul_f32 v25, v75, v203
    v_mfma_f32_32x32x16_bf16 v[32:47], a[108:111], v[116:119], v[32:47]
    s_add_u32 s17, s33, 69632
    buffer_load_dwordx4 v[152:155], v15, s[4:7], s17 offen offset:0
    v_mul_f32 v27, v91, v203
    v_fma_f32 v24, v90, v218, v24
    v_fma_f32 v26, -v74, v218, v26
    v_fma_f32 v25, v91, v219, v25
    v_fma_f32 v27, -v75, v219, v27
    v_cvt_pk_bf16_f32 v109, v24, v25
    v_cvt_pk_bf16_f32 v125, v26, v27
    v_mul_f32 v20, v76, v204
    v_mul_f32 v22, v92, v204
    v_mul_f32 v21, v77, v205
    v_mul_f32 v23, v93, v205
    v_fma_f32 v20, v92, v220, v20
    v_fma_f32 v22, -v76, v220, v22
    v_mfma_f32_32x32x16_bf16 v[48:63], a[116:119], v[100:103], v[48:63]
    buffer_load_dwordx4 v[156:159], v15, s[4:7], s17 offen offset:32
    s_nop 1
    ds_read_b128 v[96:99], v19 offset:0
    ds_read_b128 v[112:115], v19 offset:1024
    ds_read_b128 v[100:103], v19 offset:2048
    ds_read_b128 v[116:119], v19 offset:3072
    v_fma_f32 v21, v93, v221, v21
    v_fma_f32 v23, -v77, v221, v23
    v_cvt_pk_bf16_f32 v110, v20, v21
    v_cvt_pk_bf16_f32 v126, v22, v23
    v_mul_f32 v24, v78, v206
    v_mul_f32 v26, v94, v206
    v_mul_f32 v25, v79, v207
    v_mul_f32 v27, v95, v207
    v_fma_f32 v24, v94, v222, v24
    v_fma_f32 v26, -v78, v222, v26
    v_fma_f32 v25, v95, v223, v25
    v_fma_f32 v27, -v79, v223, v27
    v_cvt_pk_bf16_f32 v111, v24, v25
    v_cvt_pk_bf16_f32 v127, v26, v27
    v_mfma_f32_32x32x16_bf16 v[64:79], a[96:99], v[104:107], 0
    v_mfma_f32_32x32x16_bf16 v[80:95], a[96:99], v[120:123], 0
    s_add_u32 s18, s34, 65664
    buffer_load_ushort a252, v12, s[48:51], s18 offen
    buffer_load_ushort v3, v12, s[52:55], s18 offen
    v_mfma_f32_32x32x16_bf16 v[64:79], a[104:107], v[120:123], v[64:79]
    s_waitcnt lgkmcnt(0)
    v_lshlrev_b32 v28, 16, v96
    v_and_b32 v30, s38, v96
    v_lshlrev_b32 v29, 16, v112
    v_and_b32 v31, s38, v112
    v_mul_f32 v20, v32, v28
    v_mul_f32 v22, v48, v28
    v_mul_f32 v21, v33, v29
    v_mul_f32 v23, v49, v29
    v_fma_f32 v20, -v48, v30, v20
    v_fma_f32 v22, v32, v30, v22
    v_fma_f32 v21, -v49, v31, v21
    v_fma_f32 v23, v33, v31, v23
    v_cvt_pk_bf16_f32 v96, v20, v21
    v_cvt_pk_bf16_f32 v112, v22, v23
    v_lshlrev_b32 v28, 16, v97
    v_and_b32 v30, s38, v97
    v_lshlrev_b32 v29, 16, v113
    v_mfma_f32_32x32x16_bf16 v[80:95], a[112:115], v[104:107], v[80:95]
    v_and_b32 v31, s38, v113
    v_mul_f32 v24, v34, v28
    v_mul_f32 v26, v50, v28
    v_mul_f32 v25, v35, v29
    v_mul_f32 v27, v51, v29
    v_fma_f32 v24, -v50, v30, v24
    v_fma_f32 v26, v34, v30, v26
    v_fma_f32 v25, -v51, v31, v25
    v_fma_f32 v27, v35, v31, v27
    v_cvt_pk_bf16_f32 v97, v24, v25
    v_cvt_pk_bf16_f32 v113, v26, v27
    v_lshlrev_b32 v28, 16, v98
    v_and_b32 v30, s38, v98
    v_lshlrev_b32 v29, 16, v114
    v_and_b32 v31, s38, v114
    v_mul_f32 v20, v36, v28
    v_mul_f32 v22, v52, v28
    v_mul_f32 v21, v37, v29
    v_mul_f32 v23, v53, v29
    v_mfma_f32_32x32x16_bf16 v[64:79], a[100:103], v[108:111], v[64:79]
    v_fma_f32 v20, -v52, v30, v20
    v_fma_f32 v22, v36, v30, v22
    v_fma_f32 v21, -v53, v31, v21
    v_fma_f32 v23, v37, v31, v23
    v_cvt_pk_bf16_f32 v98, v20, v21
    v_cvt_pk_bf16_f32 v114, v22, v23
    v_lshlrev_b32 v28, 16, v99
    v_and_b32 v30, s38, v99
    v_lshlrev_b32 v29, 16, v115
    v_and_b32 v31, s38, v115
    v_mul_f32 v24, v38, v28
    v_mul_f32 v26, v54, v28
    v_mul_f32 v25, v39, v29
    v_mul_f32 v27, v55, v29
    v_fma_f32 v24, -v54, v30, v24
    v_fma_f32 v26, v38, v30, v26
    v_fma_f32 v25, -v55, v31, v25
    v_fma_f32 v27, v39, v31, v27
    v_cvt_pk_bf16_f32 v99, v24, v25
    v_mfma_f32_32x32x16_bf16 v[80:95], a[100:103], v[124:127], v[80:95]
    v_cvt_pk_bf16_f32 v115, v26, v27
    v_lshlrev_b32 v28, 16, v100
    v_and_b32 v30, s38, v100
    v_lshlrev_b32 v29, 16, v116
    v_and_b32 v31, s38, v116
    v_mul_f32 v20, v40, v28
    v_mul_f32 v22, v56, v28
    v_mul_f32 v21, v41, v29
    v_mul_f32 v23, v57, v29
    v_fma_f32 v20, -v56, v30, v20
    v_fma_f32 v22, v40, v30, v22
    v_fma_f32 v21, -v57, v31, v21
    v_fma_f32 v23, v41, v31, v23
    v_cvt_pk_bf16_f32 v100, v20, v21
    v_cvt_pk_bf16_f32 v116, v22, v23
    v_lshlrev_b32 v28, 16, v101
    v_and_b32 v30, s38, v101
    v_lshlrev_b32 v29, 16, v117
    v_and_b32 v31, s38, v117
    v_mfma_f32_32x32x16_bf16 v[64:79], a[108:111], v[124:127], v[64:79]
    v_mul_f32 v24, v42, v28
    v_mul_f32 v26, v58, v28
    v_mul_f32 v25, v43, v29
    v_mul_f32 v27, v59, v29
    v_fma_f32 v24, -v58, v30, v24
    v_fma_f32 v26, v42, v30, v26
    v_fma_f32 v25, -v59, v31, v25
    v_fma_f32 v27, v43, v31, v27
    v_cvt_pk_bf16_f32 v101, v24, v25
    v_cvt_pk_bf16_f32 v117, v26, v27
    v_lshlrev_b32 v28, 16, v102
    v_and_b32 v30, s38, v102
    v_lshlrev_b32 v29, 16, v118
    v_and_b32 v31, s38, v118
    v_mul_f32 v20, v44, v28
    v_mul_f32 v22, v60, v28
    v_mul_f32 v21, v45, v29
    v_mul_f32 v23, v61, v29
    v_fma_f32 v20, -v60, v30, v20
    v_mfma_f32_32x32x16_bf16 v[80:95], a[116:119], v[108:111], v[80:95]
    s_nop 1
    ds_read_b128 v[104:107], v19 offset:4096
    ds_read_b128 v[120:123], v19 offset:5120
    ds_read_b128 v[108:111], v19 offset:6144
    ds_read_b128 v[124:127], v19 offset:7168
    v_fma_f32 v22, v44, v30, v22
    v_fma_f32 v21, -v61, v31, v21
    v_fma_f32 v23, v45, v31, v23
    v_cvt_pk_bf16_f32 v102, v20, v21
    v_cvt_pk_bf16_f32 v118, v22, v23
    v_lshlrev_b32 v28, 16, v103
    v_and_b32 v30, s38, v103
    v_lshlrev_b32 v29, 16, v119
    v_and_b32 v31, s38, v119
    v_mul_f32 v24, v46, v28
    v_mul_f32 v26, v62, v28
    v_mul_f32 v25, v47, v29
    v_mul_f32 v27, v63, v29
    v_fma_f32 v24, -v62, v30, v24
    v_fma_f32 v26, v46, v30, v26
    v_fma_f32 v25, -v63, v31, v25
    v_fma_f32 v27, v47, v31, v27
    v_cvt_pk_bf16_f32 v103, v24, v25
    v_cvt_pk_bf16_f32 v119, v26, v27
    v_mfma_f32_32x32x16_bf16 v[32:47], v[96:99], a[96:99], 0
    v_mfma_f32_32x32x16_bf16 v[48:63], v[112:115], a[96:99], 0
    s_add_u32 s18, s34, 131328
    buffer_load_ushort a249, v12, s[48:51], s18 offen
    buffer_load_ushort v4, v12, s[52:55], s18 offen
    v_mfma_f32_32x32x16_bf16 v[32:47], v[112:115], a[112:115], v[32:47]
    s_waitcnt lgkmcnt(0)
    v_lshlrev_b32 v28, 16, v104
    v_and_b32 v30, s38, v104
    v_lshlrev_b32 v29, 16, v120
    v_and_b32 v31, s38, v120
    v_mul_f32 v20, v64, v28
    v_mul_f32 v22, v80, v28
    v_mul_f32 v21, v65, v29
    v_mul_f32 v23, v81, v29
    v_fma_f32 v20, -v80, v30, v20
    v_fma_f32 v22, v64, v30, v22
    v_fma_f32 v21, -v81, v31, v21
    v_fma_f32 v23, v65, v31, v23
    v_cvt_pk_bf16_f32 v104, v20, v21
    v_cvt_pk_bf16_f32 v120, v22, v23
    v_lshlrev_b32 v28, 16, v105
    v_and_b32 v30, s38, v105
    v_lshlrev_b32 v29, 16, v121
    v_mfma_f32_32x32x16_bf16 v[48:63], v[96:99], a[104:107], v[48:63]
    v_and_b32 v31, s38, v121
    v_mul_f32 v24, v66, v28
    v_mul_f32 v26, v82, v28
    v_mul_f32 v25, v67, v29
    v_mul_f32 v27, v83, v29
    v_fma_f32 v24, -v82, v30, v24
    v_fma_f32 v26, v66, v30, v26
    v_fma_f32 v25, -v83, v31, v25
    v_fma_f32 v27, v67, v31, v27
    v_cvt_pk_bf16_f32 v105, v24, v25
    v_cvt_pk_bf16_f32 v121, v26, v27
    v_lshlrev_b32 v28, 16, v106
    v_and_b32 v30, s38, v106
    v_lshlrev_b32 v29, 16, v122
    v_and_b32 v31, s38, v122
    v_mul_f32 v20, v68, v28
    v_mul_f32 v22, v84, v28
    v_mul_f32 v21, v69, v29
    v_mul_f32 v23, v85, v29
    v_mfma_f32_32x32x16_bf16 v[32:47], v[100:103], a[100:103], v[32:47]
    v_fma_f32 v20, -v84, v30, v20
    v_fma_f32 v22, v68, v30, v22
    v_fma_f32 v21, -v85, v31, v21
    v_fma_f32 v23, v69, v31, v23
    v_cvt_pk_bf16_f32 v106, v20, v21
    v_cvt_pk_bf16_f32 v122, v22, v23
    v_lshlrev_b32 v28, 16, v107
    v_and_b32 v30, s38, v107
    v_lshlrev_b32 v29, 16, v123
    v_and_b32 v31, s38, v123
    v_mul_f32 v24, v70, v28
    v_mul_f32 v26, v86, v28
    v_mul_f32 v25, v71, v29
    v_mul_f32 v27, v87, v29
    v_fma_f32 v24, -v86, v30, v24
    v_fma_f32 v26, v70, v30, v26
    v_fma_f32 v25, -v87, v31, v25
    v_fma_f32 v27, v71, v31, v27
    v_cvt_pk_bf16_f32 v107, v24, v25
    v_mfma_f32_32x32x16_bf16 v[48:63], v[116:119], a[100:103], v[48:63]
    v_cvt_pk_bf16_f32 v123, v26, v27
    v_lshlrev_b32 v28, 16, v108
    v_and_b32 v30, s38, v108
    v_lshlrev_b32 v29, 16, v124
    v_and_b32 v31, s38, v124
    v_mul_f32 v20, v72, v28
    v_mul_f32 v22, v88, v28
    v_mul_f32 v21, v73, v29
    v_mul_f32 v23, v89, v29
    v_fma_f32 v20, -v88, v30, v20
    v_fma_f32 v22, v72, v30, v22
    v_fma_f32 v21, -v89, v31, v21
    v_fma_f32 v23, v73, v31, v23
    v_cvt_pk_bf16_f32 v108, v20, v21
    v_cvt_pk_bf16_f32 v124, v22, v23
    v_lshlrev_b32 v28, 16, v109
    v_and_b32 v30, s38, v109
    v_lshlrev_b32 v29, 16, v125
    v_and_b32 v31, s38, v125
    v_mfma_f32_32x32x16_bf16 v[32:47], v[116:119], a[116:119], v[32:47]
    v_mul_f32 v24, v74, v28
    v_mul_f32 v26, v90, v28
    v_mul_f32 v25, v75, v29
    v_mul_f32 v27, v91, v29
    v_fma_f32 v24, -v90, v30, v24
    v_fma_f32 v26, v74, v30, v26
    v_fma_f32 v25, -v91, v31, v25
    v_fma_f32 v27, v75, v31, v27
    v_cvt_pk_bf16_f32 v109, v24, v25
    v_cvt_pk_bf16_f32 v125, v26, v27
    v_lshlrev_b32 v28, 16, v110
    v_and_b32 v30, s38, v110
    v_lshlrev_b32 v29, 16, v126
    v_and_b32 v31, s38, v126
    v_mul_f32 v20, v76, v28
    v_mul_f32 v22, v92, v28
    v_mul_f32 v21, v77, v29
    v_mul_f32 v23, v93, v29
    v_fma_f32 v20, -v92, v30, v20
    v_mfma_f32_32x32x16_bf16 v[48:63], v[100:103], a[108:111], v[48:63]
    v_fma_f32 v22, v76, v30, v22
    v_fma_f32 v21, -v93, v31, v21
    v_fma_f32 v23, v77, v31, v23
    v_cvt_pk_bf16_f32 v110, v20, v21
    v_cvt_pk_bf16_f32 v126, v22, v23
    v_lshlrev_b32 v28, 16, v111
    v_and_b32 v30, s38, v111
    v_lshlrev_b32 v29, 16, v127
    v_and_b32 v31, s38, v127
    v_mul_f32 v24, v78, v28
    v_mul_f32 v26, v94, v28
    v_mul_f32 v25, v79, v29
    v_mul_f32 v27, v95, v29
    v_fma_f32 v24, -v94, v30, v24
    v_fma_f32 v26, v78, v30, v26
    v_fma_f32 v25, -v95, v31, v25
    v_fma_f32 v27, v79, v31, v27
    v_cvt_pk_bf16_f32 v111, v24, v25
    v_cvt_pk_bf16_f32 v127, v26, v27
    v_mfma_f32_32x32x16_bf16 v[64:79], v[104:107], a[96:99], 0
    v_mfma_f32_32x32x16_bf16 v[80:95], v[120:123], a[96:99], 0
    s_add_u32 s18, s34, 196992
    buffer_load_ushort a253, v12, s[48:51], s18 offen
    buffer_load_ushort v7, v12, s[52:55], s18 offen
    v_mfma_f32_32x32x16_bf16 v[64:79], v[120:123], a[112:115], v[64:79]
    v_mul_f32 v20, v32, v160
    v_mul_f32 v22, v48, v160
    v_mul_f32 v21, v33, v161
    v_mul_f32 v23, v49, v161
    v_fma_f32 v20, -v48, v176, v20
    v_fma_f32 v22, v32, v176, v22
    v_fma_f32 v21, -v49, v177, v21
    v_fma_f32 v23, v33, v177, v23
    v_cvt_pk_bf16_f32 v96, v20, v21
    v_cvt_pk_bf16_f32 v112, v22, v23
    v_mul_f32 v24, v34, v162
    v_mul_f32 v26, v50, v162
    v_mul_f32 v25, v35, v163
    v_mfma_f32_32x32x16_bf16 v[80:95], v[104:107], a[104:107], v[80:95]
    v_mul_f32 v27, v51, v163
    v_fma_f32 v24, -v50, v178, v24
    v_fma_f32 v26, v34, v178, v26
    v_fma_f32 v25, -v51, v179, v25
    v_fma_f32 v27, v35, v179, v27
    v_cvt_pk_bf16_f32 v97, v24, v25
    v_cvt_pk_bf16_f32 v113, v26, v27
    v_mul_f32 v20, v36, v164
    v_mul_f32 v22, v52, v164
    v_mul_f32 v21, v37, v165
    v_mul_f32 v23, v53, v165
    v_fma_f32 v20, -v52, v180, v20
    v_fma_f32 v22, v36, v180, v22
    v_mfma_f32_32x32x16_bf16 v[64:79], v[108:111], a[100:103], v[64:79]
    v_fma_f32 v21, -v53, v181, v21
    v_fma_f32 v23, v37, v181, v23
    v_cvt_pk_bf16_f32 v98, v20, v21
    v_cvt_pk_bf16_f32 v114, v22, v23
    v_mul_f32 v24, v38, v166
    v_mul_f32 v26, v54, v166
    v_mul_f32 v25, v39, v167
    v_mul_f32 v27, v55, v167
    v_fma_f32 v24, -v54, v182, v24
    v_fma_f32 v26, v38, v182, v26
    v_fma_f32 v25, -v55, v183, v25
    v_fma_f32 v27, v39, v183, v27
    v_cvt_pk_bf16_f32 v99, v24, v25
    v_cvt_pk_bf16_f32 v115, v26, v27
    v_mfma_f32_32x32x16_bf16 v[80:95], v[124:127], a[100:103], v[80:95]
    v_mul_f32 v20, v40, v168
    v_mul_f32 v22, v56, v168
    v_mul_f32 v21, v41, v169
    v_mul_f32 v23, v57, v169
    v_fma_f32 v20, -v56, v184, v20
    v_fma_f32 v22, v40, v184, v22
    v_fma_f32 v21, -v57, v185, v21
    v_fma_f32 v23, v41, v185, v23
    v_cvt_pk_bf16_f32 v100, v20, v21
    v_cvt_pk_bf16_f32 v116, v22, v23
    v_mul_f32 v24, v42, v170
    v_mul_f32 v26, v58, v170
    v_mul_f32 v25, v43, v171
    v_mfma_f32_32x32x16_bf16 v[64:79], v[124:127], a[116:119], v[64:79]
    v_mul_f32 v27, v59, v171
    v_fma_f32 v24, -v58, v186, v24
    v_fma_f32 v26, v42, v186, v26
    v_fma_f32 v25, -v59, v187, v25
    v_fma_f32 v27, v43, v187, v27
    v_cvt_pk_bf16_f32 v101, v24, v25
    v_cvt_pk_bf16_f32 v117, v26, v27
    v_mul_f32 v20, v44, v172
    v_mul_f32 v22, v60, v172
    v_mul_f32 v21, v45, v173
    v_mul_f32 v23, v61, v173
    v_fma_f32 v20, -v60, v188, v20
    v_fma_f32 v22, v44, v188, v22
    v_mfma_f32_32x32x16_bf16 v[80:95], v[108:111], a[108:111], v[80:95]
    v_fma_f32 v21, -v61, v189, v21
    v_fma_f32 v23, v45, v189, v23
    v_cvt_pk_bf16_f32 v102, v20, v21
    v_cvt_pk_bf16_f32 v118, v22, v23
    v_mul_f32 v24, v46, v174
    v_mul_f32 v26, v62, v174
    v_mul_f32 v25, v47, v175
    v_mul_f32 v27, v63, v175
    v_fma_f32 v24, -v62, v190, v24
    v_fma_f32 v26, v46, v190, v26
    v_fma_f32 v25, -v63, v191, v25
    v_fma_f32 v27, v47, v191, v27
    v_cvt_pk_bf16_f32 v103, v24, v25
    v_cvt_pk_bf16_f32 v119, v26, v27
    v_mfma_f32_32x32x16_bf16 v[32:47], a[0:3], v[96:99], 0
    v_mfma_f32_32x32x16_bf16 v[48:63], a[0:3], v[112:115], 0
    s_add_u32 s18, s34, 262656
    buffer_load_ushort a250, v12, s[48:51], s18 offen
    buffer_load_ushort v8, v12, s[52:55], s18 offen
    v_mfma_f32_32x32x16_bf16 v[32:47], a[64:67], v[112:115], v[32:47]
    v_mul_f32 v20, v64, v224
    v_mul_f32 v22, v80, v224
    v_mul_f32 v21, v65, v225
    v_mul_f32 v23, v81, v225
    v_fma_f32 v20, -v80, v240, v20
    v_fma_f32 v22, v64, v240, v22
    v_fma_f32 v21, -v81, v241, v21
    v_fma_f32 v23, v65, v241, v23
    v_cvt_pk_bf16_f32 v104, v20, v21
    v_cvt_pk_bf16_f32 v120, v22, v23
    v_mul_f32 v24, v66, v226
    v_mul_f32 v26, v82, v226
    v_mul_f32 v25, v67, v227
    v_mfma_f32_32x32x16_bf16 v[48:63], a[32:35], v[96:99], v[48:63]
    v_mul_f32 v27, v83, v227
    v_fma_f32 v24, -v82, v242, v24
    v_fma_f32 v26, v66, v242, v26
    v_fma_f32 v25, -v83, v243, v25
    v_fma_f32 v27, v67, v243, v27
    v_cvt_pk_bf16_f32 v105, v24, v25
    v_cvt_pk_bf16_f32 v121, v26, v27
    v_mul_f32 v20, v68, v228
    v_mul_f32 v22, v84, v228
    v_mul_f32 v21, v69, v229
    v_mul_f32 v23, v85, v229
    v_fma_f32 v20, -v84, v244, v20
    v_fma_f32 v22, v68, v244, v22
    v_mfma_f32_32x32x16_bf16 v[32:47], a[4:7], v[100:103], v[32:47]
    v_fma_f32 v21, -v85, v245, v21
    v_fma_f32 v23, v69, v245, v23
    v_cvt_pk_bf16_f32 v106, v20, v21
    v_cvt_pk_bf16_f32 v122, v22, v23
    v_mul_f32 v24, v70, v230
    v_mul_f32 v26, v86, v230
    v_mul_f32 v25, v71, v231
    v_mul_f32 v27, v87, v231
    v_fma_f32 v24, -v86, v246, v24
    v_fma_f32 v26, v70, v246, v26
    v_fma_f32 v25, -v87, v247, v25
    v_fma_f32 v27, v71, v247, v27
    v_cvt_pk_bf16_f32 v107, v24, v25
    v_cvt_pk_bf16_f32 v123, v26, v27
    v_mfma_f32_32x32x16_bf16 v[48:63], a[4:7], v[116:119], v[48:63]
    v_mul_f32 v20, v72, v232
    v_mul_f32 v22, v88, v232
    v_mul_f32 v21, v73, v233
    v_mul_f32 v23, v89, v233
    v_fma_f32 v20, -v88, v248, v20
    v_fma_f32 v22, v72, v248, v22
    v_fma_f32 v21, -v89, v249, v21
    v_fma_f32 v23, v73, v249, v23
    v_cvt_pk_bf16_f32 v108, v20, v21
    v_cvt_pk_bf16_f32 v124, v22, v23
    v_mul_f32 v24, v74, v234
    v_mul_f32 v26, v90, v234
    v_mul_f32 v25, v75, v235
    v_mfma_f32_32x32x16_bf16 v[32:47], a[68:71], v[116:119], v[32:47]
    v_mul_f32 v27, v91, v235
    v_fma_f32 v24, -v90, v250, v24
    v_fma_f32 v26, v74, v250, v26
    v_fma_f32 v25, -v91, v251, v25
    v_fma_f32 v27, v75, v251, v27
    v_cvt_pk_bf16_f32 v109, v24, v25
    v_cvt_pk_bf16_f32 v125, v26, v27
    v_mul_f32 v20, v76, v236
    v_mul_f32 v22, v92, v236
    v_mul_f32 v21, v77, v237
    v_mul_f32 v23, v93, v237
    v_fma_f32 v20, -v92, v252, v20
    v_fma_f32 v22, v76, v252, v22
    v_mfma_f32_32x32x16_bf16 v[48:63], a[36:39], v[100:103], v[48:63]
    v_fma_f32 v21, -v93, v253, v21
    v_fma_f32 v23, v77, v253, v23
    v_cvt_pk_bf16_f32 v110, v20, v21
    v_cvt_pk_bf16_f32 v126, v22, v23
    v_mul_f32 v24, v78, v238
    v_mul_f32 v26, v94, v238
    v_mul_f32 v25, v79, v239
    v_mul_f32 v27, v95, v239
    v_fma_f32 v24, -v94, v254, v24
    v_fma_f32 v26, v78, v254, v26
    v_fma_f32 v25, -v95, v255, v25
    v_fma_f32 v27, v79, v255, v27
    v_cvt_pk_bf16_f32 v111, v24, v25
    v_cvt_pk_bf16_f32 v127, v26, v27
    v_mfma_f32_32x32x16_bf16 v[32:47], a[8:11], v[104:107], v[32:47]
    s_add_u32 s18, s34, 328320
    buffer_load_ushort a254, v12, s[48:51], s18 offen
    buffer_load_ushort v10, v12, s[52:55], s18 offen
    v_mfma_f32_32x32x16_bf16 v[48:63], a[8:11], v[120:123], v[48:63]
    v_mfma_f32_32x32x16_bf16 v[32:47], a[72:75], v[120:123], v[32:47]
    v_mfma_f32_32x32x16_bf16 v[48:63], a[40:43], v[104:107], v[48:63]
    v_mfma_f32_32x32x16_bf16 v[32:47], a[12:15], v[108:111], v[32:47]
    s_add_u32 s18, s34, 393984
    buffer_load_ushort a251, v12, s[48:51], s18 offen
    buffer_load_ushort v11, v12, s[52:55], s18 offen
    v_mfma_f32_32x32x16_bf16 v[48:63], a[12:15], v[124:127], v[48:63]
    v_mfma_f32_32x32x16_bf16 v[32:47], a[76:79], v[124:127], v[32:47]
    v_mfma_f32_32x32x16_bf16 v[48:63], a[44:47], v[108:111], v[48:63]
    v_mfma_f32_32x32x16_bf16 v[64:79], a[16:19], v[96:99], 0
    s_add_u32 s18, s34, 459648
    buffer_load_ushort a255, v12, s[48:51], s18 offen
    buffer_load_ushort v16, v12, s[52:55], s18 offen
    v_mfma_f32_32x32x16_bf16 v[80:95], a[16:19], v[112:115], 0
    v_mfma_f32_32x32x16_bf16 v[64:79], a[80:83], v[112:115], v[64:79]
    s_nop 1
    v_cvt_pk_bf16_f32 v32, v32, v48
    v_mfma_f32_32x32x16_bf16 v[80:95], a[48:51], v[96:99], v[80:95]
    v_cvt_pk_bf16_f32 v33, v33, v49
    v_mfma_f32_32x32x16_bf16 v[64:79], a[20:23], v[100:103], v[64:79]
    v_cvt_pk_bf16_f32 v34, v34, v50
    v_mfma_f32_32x32x16_bf16 v[80:95], a[20:23], v[116:119], v[80:95]
    v_cvt_pk_bf16_f32 v35, v35, v51
    v_mfma_f32_32x32x16_bf16 v[64:79], a[84:87], v[116:119], v[64:79]
    v_cvt_pk_bf16_f32 v36, v36, v52
    v_mfma_f32_32x32x16_bf16 v[80:95], a[52:55], v[100:103], v[80:95]
    v_cvt_pk_bf16_f32 v37, v37, v53
    v_mfma_f32_32x32x16_bf16 v[64:79], a[24:27], v[104:107], v[64:79]
    v_cvt_pk_bf16_f32 v38, v38, v54
    v_cvt_pk_bf16_f32 v39, v39, v55
    v_mfma_f32_32x32x16_bf16 v[80:95], a[24:27], v[120:123], v[80:95]
    v_cvt_pk_bf16_f32 v40, v40, v56
    v_mfma_f32_32x32x16_bf16 v[64:79], a[88:91], v[120:123], v[64:79]
    v_cvt_pk_bf16_f32 v41, v41, v57
    v_mfma_f32_32x32x16_bf16 v[80:95], a[56:59], v[104:107], v[80:95]
    v_cvt_pk_bf16_f32 v42, v42, v58
    v_mfma_f32_32x32x16_bf16 v[64:79], a[28:31], v[108:111], v[64:79]
    v_cvt_pk_bf16_f32 v43, v43, v59
    v_mfma_f32_32x32x16_bf16 v[80:95], a[28:31], v[124:127], v[80:95]
    v_cvt_pk_bf16_f32 v44, v44, v60
    v_mfma_f32_32x32x16_bf16 v[64:79], a[92:95], v[124:127], v[64:79]
    v_cvt_pk_bf16_f32 v45, v45, v61
    v_mfma_f32_32x32x16_bf16 v[80:95], a[60:63], v[108:111], v[80:95]
    v_cvt_pk_bf16_f32 v46, v46, v62
    v_cvt_pk_bf16_f32 v47, v47, v63
    s_nop 9
    v_cvt_pk_bf16_f32 v64, v64, v80
    v_cvt_pk_bf16_f32 v65, v65, v81
    v_cvt_pk_bf16_f32 v66, v66, v82
    v_cvt_pk_bf16_f32 v67, v67, v83
    v_cvt_pk_bf16_f32 v68, v68, v84
    v_cvt_pk_bf16_f32 v69, v69, v85
    v_cvt_pk_bf16_f32 v70, v70, v86
    v_cvt_pk_bf16_f32 v71, v71, v87
    v_cvt_pk_bf16_f32 v72, v72, v88
    v_cvt_pk_bf16_f32 v73, v73, v89
    v_cvt_pk_bf16_f32 v74, v74, v90
    v_cvt_pk_bf16_f32 v75, v75, v91
    v_cvt_pk_bf16_f32 v76, v76, v92
    v_cvt_pk_bf16_f32 v77, v77, v93
    v_cvt_pk_bf16_f32 v78, v78, v94
    v_cvt_pk_bf16_f32 v79, v79, v95
    s_cmp_eq_u32 s36, 2
    s_cbranch_scc1 F2_o1
    s_cmp_eq_u32 s36, 3
    s_cbranch_scc1 F2_o2
    s_cmp_eq_u32 s36, 4
    s_cbranch_scc1 F2_o3
    s_cmp_eq_u32 s36, 5
    s_cbranch_scc1 F2_o4
    v_accvgpr_write_b32 a120, v32
    v_accvgpr_write_b32 a124, v33
    v_accvgpr_write_b32 a128, v34
    v_accvgpr_write_b32 a132, v35
    v_accvgpr_write_b32 a136, v36
    v_accvgpr_write_b32 a140, v37
    v_accvgpr_write_b32 a144, v38
    v_accvgpr_write_b32 a148, v39
    v_accvgpr_write_b32 a152, v40
    v_accvgpr_write_b32 a156, v41
    v_accvgpr_write_b32 a160, v42
    v_accvgpr_write_b32 a164, v43
    v_accvgpr_write_b32 a168, v44
    v_accvgpr_write_b32 a172, v45
    v_accvgpr_write_b32 a176, v46
    v_accvgpr_write_b32 a180, v47
    v_accvgpr_write_b32 a184, v64
    v_accvgpr_write_b32 a188, v65
    v_accvgpr_write_b32 a192, v66
    v_accvgpr_write_b32 a196, v67
    v_accvgpr_write_b32 a200, v68
    v_accvgpr_write_b32 a204, v69
    v_accvgpr_write_b32 a208, v70
    v_accvgpr_write_b32 a212, v71
    v_accvgpr_write_b32 a216, v72
    v_accvgpr_write_b32 a220, v73
    v_accvgpr_write_b32 a224, v74
    v_accvgpr_write_b32 a228, v75
    v_accvgpr_write_b32 a232, v76
    v_accvgpr_write_b32 a236, v77
    v_accvgpr_write_b32 a240, v78
    v_accvgpr_write_b32 a244, v79
    s_branch F2_nx
F2_o1:
    v_accvgpr_write_b32 a121, v32
    v_accvgpr_write_b32 a125, v33
    v_accvgpr_write_b32 a129, v34
    v_accvgpr_write_b32 a133, v35
    v_accvgpr_write_b32 a137, v36
    v_accvgpr_write_b32 a141, v37
    v_accvgpr_write_b32 a145, v38
    v_accvgpr_write_b32 a149, v39
    v_accvgpr_write_b32 a153, v40
    v_accvgpr_write_b32 a157, v41
    v_accvgpr_write_b32 a161, v42
    v_accvgpr_write_b32 a165, v43
    v_accvgpr_write_b32 a169, v44
    v_accvgpr_write_b32 a173, v45
    v_accvgpr_write_b32 a177, v46
    v_accvgpr_write_b32 a181, v47
    v_accvgpr_write_b32 a185, v64
    v_accvgpr_write_b32 a189, v65
    v_accvgpr_write_b32 a193, v66
    v_accvgpr_write_b32 a197, v67
    v_accvgpr_write_b32 a201, v68
    v_accvgpr_write_b32 a205, v69
    v_accvgpr_write_b32 a209, v70
    v_accvgpr_write_b32 a213, v71
    v_accvgpr_write_b32 a217, v72
    v_accvgpr_write_b32 a221, v73
    v_accvgpr_write_b32 a225, v74
    v_accvgpr_write_b32 a229, v75
    v_accvgpr_write_b32 a233, v76
    v_accvgpr_write_b32 a237, v77
    v_accvgpr_write_b32 a241, v78
    v_accvgpr_write_b32 a245, v79
    s_branch F2_nx
F2_o2:
    v_accvgpr_write_b32 a122, v32
    v_accvgpr_write_b32 a126, v33
    v_accvgpr_write_b32 a130, v34
    v_accvgpr_write_b32 a134, v35
    v_accvgpr_write_b32 a138, v36
    v_accvgpr_write_b32 a142, v37
    v_accvgpr_write_b32 a146, v38
    v_accvgpr_write_b32 a150, v39
    v_accvgpr_write_b32 a154, v40
    v_accvgpr_write_b32 a158, v41
    v_accvgpr_write_b32 a162, v42
    v_accvgpr_write_b32 a166, v43
    v_accvgpr_write_b32 a170, v44
    v_accvgpr_write_b32 a174, v45
    v_accvgpr_write_b32 a178, v46
    v_accvgpr_write_b32 a182, v47
    v_accvgpr_write_b32 a186, v64
    v_accvgpr_write_b32 a190, v65
    v_accvgpr_write_b32 a194, v66
    v_accvgpr_write_b32 a198, v67
    v_accvgpr_write_b32 a202, v68
    v_accvgpr_write_b32 a206, v69
    v_accvgpr_write_b32 a210, v70
    v_accvgpr_write_b32 a214, v71
    v_accvgpr_write_b32 a218, v72
    v_accvgpr_write_b32 a222, v73
    v_accvgpr_write_b32 a226, v74
    v_accvgpr_write_b32 a230, v75
    v_accvgpr_write_b32 a234, v76
    v_accvgpr_write_b32 a238, v77
    v_accvgpr_write_b32 a242, v78
    v_accvgpr_write_b32 a246, v79
    s_branch F2_nx
F2_o3:
    v_accvgpr_write_b32 a123, v32
    v_accvgpr_write_b32 a127, v33
    v_accvgpr_write_b32 a131, v34
    v_accvgpr_write_b32 a135, v35
    v_accvgpr_write_b32 a139, v36
    v_accvgpr_write_b32 a143, v37
    v_accvgpr_write_b32 a147, v38
    v_accvgpr_write_b32 a151, v39
    v_accvgpr_write_b32 a155, v40
    v_accvgpr_write_b32 a159, v41
    v_accvgpr_write_b32 a163, v42
    v_accvgpr_write_b32 a167, v43
    v_accvgpr_write_b32 a171, v44
    v_accvgpr_write_b32 a175, v45
    v_accvgpr_write_b32 a179, v46
    v_accvgpr_write_b32 a183, v47
    v_accvgpr_write_b32 a187, v64
    v_accvgpr_write_b32 a191, v65
    v_accvgpr_write_b32 a195, v66
    v_accvgpr_write_b32 a199, v67
    v_accvgpr_write_b32 a203, v68
    v_accvgpr_write_b32 a207, v69
    v_accvgpr_write_b32 a211, v70
    v_accvgpr_write_b32 a215, v71
    v_accvgpr_write_b32 a219, v72
    v_accvgpr_write_b32 a223, v73
    v_accvgpr_write_b32 a227, v74
    v_accvgpr_write_b32 a231, v75
    v_accvgpr_write_b32 a235, v76
    v_accvgpr_write_b32 a239, v77
    v_accvgpr_write_b32 a243, v78
    v_accvgpr_write_b32 a247, v79
    s_branch F2_nx
F2_o4:
    v_accvgpr_read_b32 v5, a120
    v_lshlrev_b32 v6, 16, v32
    v_bfi_b32 v5, s38, v6, v5
    v_accvgpr_write_b32 a120, v5
    v_accvgpr_read_b32 v5, a124
    v_lshlrev_b32 v6, 16, v33
    v_bfi_b32 v5, s38, v6, v5
    v_accvgpr_write_b32 a124, v5
    v_accvgpr_read_b32 v5, a128
    v_lshlrev_b32 v6, 16, v34
    v_bfi_b32 v5, s38, v6, v5
    v_accvgpr_write_b32 a128, v5
    v_accvgpr_read_b32 v5, a132
    v_lshlrev_b32 v6, 16, v35
    v_bfi_b32 v5, s38, v6, v5
    v_accvgpr_write_b32 a132, v5
    v_accvgpr_read_b32 v5, a136
    v_lshlrev_b32 v6, 16, v36
    v_bfi_b32 v5, s38, v6, v5
    v_accvgpr_write_b32 a136, v5
    v_accvgpr_read_b32 v5, a140
    v_lshlrev_b32 v6, 16, v37
    v_bfi_b32 v5, s38, v6, v5
    v_accvgpr_write_b32 a140, v5
    v_accvgpr_read_b32 v5, a144
    v_lshlrev_b32 v6, 16, v38
    v_bfi_b32 v5, s38, v6, v5
    v_accvgpr_write_b32 a144, v5
    v_accvgpr_read_b32 v5, a148
    v_lshlrev_b32 v6, 16, v39
    v_bfi_b32 v5, s38, v6, v5
    v_accvgpr_write_b32 a148, v5
    v_accvgpr_read_b32 v5, a152
    v_lshlrev_b32 v6, 16, v40
    v_bfi_b32 v5, s38, v6, v5
    v_accvgpr_write_b32 a152, v5
    v_accvgpr_read_b32 v5, a156
    v_lshlrev_b32 v6, 16, v41
    v_bfi_b32 v5, s38, v6, v5
    v_accvgpr_write_b32 a156, v5
    v_accvgpr_read_b32 v5, a160
    v_lshlrev_b32 v6, 16, v42
    v_bfi_b32 v5, s38, v6, v5
    v_accvgpr_write_b32 a160, v5
    v_accvgpr_read_b32 v5, a164
    v_lshlrev_b32 v6, 16, v43
    v_bfi_b32 v5, s38, v6, v5
    v_accvgpr_write_b32 a164, v5
    v_accvgpr_read_b32 v5, a168
    v_lshlrev_b32 v6, 16, v44
    v_bfi_b32 v5, s38, v6, v5
    v_accvgpr_write_b32 a168, v5
    v_accvgpr_read_b32 v5, a172
    v_lshlrev_b32 v6, 16, v45
    v_bfi_b32 v5, s38, v6, v5
    v_accvgpr_write_b32 a172, v5
    v_accvgpr_read_b32 v5, a176
    v_lshlrev_b32 v6, 16, v46
    v_bfi_b32 v5, s38, v6, v5
    v_accvgpr_write_b32 a176, v5
    v_accvgpr_read_b32 v5, a180
    v_lshlrev_b32 v6, 16, v47
    v_bfi_b32 v5, s38, v6, v5
    v_accvgpr_write_b32 a180, v5
    v_accvgpr_read_b32 v5, a184
    v_lshlrev_b32 v6, 16, v64
    v_bfi_b32 v5, s38, v6, v5
    v_accvgpr_write_b32 a184, v5
    v_accvgpr_read_b32 v5, a188
    v_lshlrev_b32 v6, 16, v65
    v_bfi_b32 v5, s38, v6, v5
    v_accvgpr_write_b32 a188, v5
    v_accvgpr_read_b32 v5, a192
    v_lshlrev_b32 v6, 16, v66
    v_bfi_b32 v5, s38, v6, v5
    v_accvgpr_write_b32 a192, v5
    v_accvgpr_read_b32 v5, a196
    v_lshlrev_b32 v6, 16, v67
    v_bfi_b32 v5, s38, v6, v5
    v_accvgpr_write_b32 a196, v5
    v_accvgpr_read_b32 v5, a200
    v_lshlrev_b32 v6, 16, v68
    v_bfi_b32 v5, s38, v6, v5
    v_accvgpr_write_b32 a200, v5
    v_accvgpr_read_b32 v5, a204
    v_lshlrev_b32 v6, 16, v69
    v_bfi_b32 v5, s38, v6, v5
    v_accvgpr_write_b32 a204, v5
    v_accvgpr_read_b32 v5, a208
    v_lshlrev_b32 v6, 16, v70
    v_bfi_b32 v5, s38, v6, v5
    v_accvgpr_write_b32 a208, v5
    v_accvgpr_read_b32 v5, a212
    v_lshlrev_b32 v6, 16, v71
    v_bfi_b32 v5, s38, v6, v5
    v_accvgpr_write_b32 a212, v5
    v_accvgpr_read_b32 v5, a216
    v_lshlrev_b32 v6, 16, v72
    v_bfi_b32 v5, s38, v6, v5
    v_accvgpr_write_b32 a216, v5
    v_accvgpr_read_b32 v5, a220
    v_lshlrev_b32 v6, 16, v73
    v_bfi_b32 v5, s38, v6, v5
    v_accvgpr_write_b32 a220, v5
    v_accvgpr_read_b32 v5, a224
    v_lshlrev_b32 v6, 16, v74
    v_bfi_b32 v5, s38, v6, v5
    v_accvgpr_write_b32 a224, v5
    v_accvgpr_read_b32 v5, a228
    v_lshlrev_b32 v6, 16, v75
    v_bfi_b32 v5, s38, v6, v5
    v_accvgpr_write_b32 a228, v5
    v_accvgpr_read_b32 v5, a232
    v_lshlrev_b32 v6, 16, v76
    v_bfi_b32 v5, s38, v6, v5
    v_accvgpr_write_b32 a232, v5
    v_accvgpr_read_b32 v5, a236
    v_lshlrev_b32 v6, 16, v77
    v_bfi_b32 v5, s38, v6, v5
    v_accvgpr_write_b32 a236, v5
    v_accvgpr_read_b32 v5, a240
    v_lshlrev_b32 v6, 16, v78
    v_bfi_b32 v5, s38, v6, v5
    v_accvgpr_write_b32 a240, v5
    v_accvgpr_read_b32 v5, a244
    v_lshlrev_b32 v6, 16, v79
    v_bfi_b32 v5, s38, v6, v5
    v_accvgpr_write_b32 a244, v5
F2_nx:
    s_add_u32 s35, s35, 8192
    s_bitcmp1_b32 s36, 0
    s_cselect_b32 s17, 0, 2068416
    s_add_u32 s34, s34, 1050624
    s_sub_u32 s34, s34, s17
    s_cmp_eq_u32 s36, 4
    s_cselect_b32 s35, 133120, s35
    s_cselect_b32 s34, 1073741824, s34
    s_cmp_lt_u32 s36, s37
    s_cbranch_scc1 F2_top
    s_mul_i32 s21, s31, 33024
    s_add_u32 s21, s21, 111149056
    s_add_u32 s17, s21, 0
    buffer_store_dwordx4 a[120:123], v18, s[4:7], s17 offen offset:0 sc1
    buffer_store_dwordx4 a[124:127], v18, s[4:7], s17 offen offset:512 sc1
    buffer_store_dwordx4 a[128:131], v18, s[4:7], s17 offen offset:1024 sc1
    buffer_store_dwordx4 a[132:135], v18, s[4:7], s17 offen offset:1536 sc1
    buffer_store_dwordx4 a[136:139], v18, s[4:7], s17 offen offset:2048 sc1
    buffer_store_dwordx4 a[140:143], v18, s[4:7], s17 offen offset:2560 sc1
    buffer_store_dwordx4 a[144:147], v18, s[4:7], s17 offen offset:3072 sc1
    buffer_store_dwordx4 a[148:151], v18, s[4:7], s17 offen offset:3584 sc1
    s_add_u32 s17, s21, 8192
    buffer_store_dwordx4 a[152:155], v18, s[4:7], s17 offen offset:0 sc1
    buffer_store_dwordx4 a[156:159], v18, s[4:7], s17 offen offset:512 sc1
    buffer_store_dwordx4 a[160:163], v18, s[4:7], s17 offen offset:1024 sc1
    buffer_store_dwordx4 a[164:167], v18, s[4:7], s17 offen offset:1536 sc1
    buffer_store_dwordx4 a[168:171], v18, s[4:7], s17 offen offset:2048 sc1
    buffer_store_dwordx4 a[172:175], v18, s[4:7], s17 offen offset:2560 sc1
    buffer_store_dwordx4 a[176:179], v18, s[4:7], s17 offen offset:3072 sc1
    buffer_store_dwordx4 a[180:183], v18, s[4:7], s17 offen offset:3584 sc1
    s_add_u32 s17, s21, 16384
    buffer_store_dwordx4 a[184:187], v18, s[4:7], s17 offen offset:0 sc1
    buffer_store_dwordx4 a[188:191], v18, s[4:7], s17 offen offset:512 sc1
    buffer_store_dwordx4 a[192:195], v18, s[4:7], s17 offen offset:1024 sc1
    buffer_store_dwordx4 a[196:199], v18, s[4:7], s17 offen offset:1536 sc1
    buffer_store_dwordx4 a[200:203], v18, s[4:7], s17 offen offset:2048 sc1
    buffer_store_dwordx4 a[204:207], v18, s[4:7], s17 offen offset:2560 sc1
    buffer_store_dwordx4 a[208:211], v18, s[4:7], s17 offen offset:3072 sc1
    buffer_store_dwordx4 a[212:215], v18, s[4:7], s17 offen offset:3584 sc1
    s_add_u32 s17, s21, 24576
    buffer_store_dwordx4 a[216:219], v18, s[4:7], s17 offen offset:0 sc1
    buffer_store_dwordx4 a[220:223], v18, s[4:7], s17 offen offset:512 sc1
    buffer_store_dwordx4 a[224:227], v18, s[4:7], s17 offen offset:1024 sc1
    buffer_store_dwordx4 a[228:231], v18, s[4:7], s17 offen offset:1536 sc1
    buffer_store_dwordx4 a[232:235], v18, s[4:7], s17 offen offset:2048 sc1
    buffer_store_dwordx4 a[236:239], v18, s[4:7], s17 offen offset:2560 sc1
    buffer_store_dwordx4 a[240:243], v18, s[4:7], s17 offen offset:3072 sc1
    buffer_store_dwordx4 a[244:247], v18, s[4:7], s17 offen offset:3584 sc1
    s_waitcnt vmcnt(0)
    s_lshl_b32 s17, s31, 7
    s_add_u32 s17, s17, 100761600
    v_lshl_add_u32 v5, v1, 2, s17
    v_mov_b32 v6, 1
    s_mov_b64 exec, 0xffffffff
    buffer_store_dword v6, v5, s[4:7], 0 offen sc1
    s_mov_b64 exec, -1
    v_bfe_u32 v5, v1, 2, 2
    v_and_b32 v7, 3, v1
    v_lshl_add_u32 v7, v5, 3, v7
    s_lshl_b32 s17, s29, 5
    v_add_u32 v7, s17, v7
    v_lshrrev_b32 v8, 4, v1
    v_cvt_f32_u32 v8, v8
    s_mov_b32 s31, 981467136
    v_and_b32 v38, 1, v7
    v_add_u32 v5, 0, v7
    v_cvt_f32_u32 v6, v5
    v_mul_f32 v6, s31, v6
    v_mov_b32 v32, 0x3e800000
    v_sub_f32 v34, v6, v32
    v_mul_f32 v36, 0x41800000, v6
    v_mul_f32 v5, 4.0, v6
    v_mul_f32 v30, v5, v8
    v_add_u32 v5, 4, v7
    v_cvt_f32_u32 v6, v5
    v_mul_f32 v6, s31, v6
    v_mov_b32 v33, 0x3e800000
    v_sub_f32 v35, v6, v33
    v_mul_f32 v37, 0x41800000, v6
    v_mul_f32 v5, 4.0, v6
    v_mul_f32 v31, v5, v8
    v_lshlrev_b32 v40, 4, v38
    v_bfe_u32 v5, v7, 1, 1
    v_add_u32 v6, 1, v7
    v_bfe_u32 v6, v6, 1, 1
    v_lshlrev_b32 v5, 15, v5
    v_lshl_or_b32 v41, v6, 31, v5
    v_fract_f32 v48, v30
    v_add_f32 v49, v48, v32
    v_cos_f32 v56, v48
    v_add_f32 v50, v49, v34
    v_cos_f32 v57, v49
    v_add_f32 v51, v50, v32
    v_cos_f32 v58, v50
    v_add_f32 v52, v51, v34
    v_cos_f32 v59, v51
    v_add_f32 v53, v52, v32
    v_cos_f32 v60, v52
    v_add_f32 v54, v53, v34
    v_cos_f32 v61, v53
    v_add_f32 v55, v54, v32
    v_cos_f32 v62, v54
    v_cos_f32 v63, v55
    v_add_f32 v30, v48, v36
    v_cvt_pk_bf16_f32 v64, v56, v57
    v_cvt_pk_bf16_f32 v65, v58, v59
    v_cvt_pk_bf16_f32 v66, v60, v61
    v_cvt_pk_bf16_f32 v67, v62, v63
    v_accvgpr_write_b32 a0, v64
    v_accvgpr_write_b32 a1, v65
    v_accvgpr_write_b32 a2, v66
    v_accvgpr_write_b32 a3, v67
    v_alignbit_b32 v68, v64, v64, v40
    v_xor_b32 v68, v68, v41
    v_alignbit_b32 v69, v65, v65, v40
    v_xor_b32 v69, v69, v41
    v_alignbit_b32 v70, v66, v66, v40
    v_xor_b32 v70, v70, v41
    v_alignbit_b32 v71, v67, v67, v40
    v_xor_b32 v71, v71, v41
    v_accvgpr_write_b32 a128, v68
    v_accvgpr_write_b32 a129, v69
    v_accvgpr_write_b32 a130, v70
    v_accvgpr_write_b32 a131, v71
    v_fract_f32 v48, v31
    v_add_f32 v49, v48, v33
    v_cos_f32 v56, v48
    v_add_f32 v50, v49, v35
    v_cos_f32 v57, v49
    v_add_f32 v51, v50, v33
    v_cos_f32 v58, v50
    v_add_f32 v52, v51, v35
    v_cos_f32 v59, v51
    v_add_f32 v53, v52, v33
    v_cos_f32 v60, v52
    v_add_f32 v54, v53, v35
    v_cos_f32 v61, v53
    v_add_f32 v55, v54, v33
    v_cos_f32 v62, v54
    v_cos_f32 v63, v55
    v_add_f32 v31, v48, v37
    v_cvt_pk_bf16_f32 v64, v56, v57
    v_cvt_pk_bf16_f32 v65, v58, v59
    v_cvt_pk_bf16_f32 v66, v60, v61
    v_cvt_pk_bf16_f32 v67, v62, v63
    v_accvgpr_write_b32 a4, v64
    v_accvgpr_write_b32 a5, v65
    v_accvgpr_write_b32 a6, v66
    v_accvgpr_write_b32 a7, v67
    v_alignbit_b32 v68, v64, v64, v40
    v_xor_b32 v68, v68, v41
    v_alignbit_b32 v69, v65, v65, v40
    v_xor_b32 v69, v69, v41
    v_alignbit_b32 v70, v66, v66, v40
    v_xor_b32 v70, v70, v41
    v_alignbit_b32 v71, v67, v67, v40
    v_xor_b32 v71, v71, v41
    v_accvgpr_write_b32 a132, v68
    v_accvgpr_write_b32 a133, v69
    v_accvgpr_write_b32 a134, v70
    v_accvgpr_write_b32 a135, v71
    v_fract_f32 v48, v30
    v_add_f32 v49, v48, v32
    v_cos_f32 v56, v48
    v_add_f32 v50, v49, v34
    v_cos_f32 v57, v49
    v_add_f32 v51, v50, v32
    v_cos_f32 v58, v50
    v_add_f32 v52, v51, v34
    v_cos_f32 v59, v51
    v_add_f32 v53, v52, v32
    v_cos_f32 v60, v52
    v_add_f32 v54, v53, v34
    v_cos_f32 v61, v53
    v_add_f32 v55, v54, v32
    v_cos_f32 v62, v54
    v_cos_f32 v63, v55
    v_add_f32 v30, v48, v36
    v_cvt_pk_bf16_f32 v64, v56, v57
    v_cvt_pk_bf16_f32 v65, v58, v59
    v_cvt_pk_bf16_f32 v66, v60, v61
    v_cvt_pk_bf16_f32 v67, v62, v63
    v_accvgpr_write_b32 a8, v64
    v_accvgpr_write_b32 a9, v65
    v_accvgpr_write_b32 a10, v66
    v_accvgpr_write_b32 a11, v67
    v_alignbit_b32 v68, v64, v64, v40
    v_xor_b32 v68, v68, v41
    v_alignbit_b32 v69, v65, v65, v40
    v_xor_b32 v69, v69, v41
    v_alignbit_b32 v70, v66, v66, v40
    v_xor_b32 v70, v70, v41
    v_alignbit_b32 v71, v67, v67, v40
    v_xor_b32 v71, v71, v41
    v_accvgpr_write_b32 a136, v68
    v_accvgpr_write_b32 a137, v69
    v_accvgpr_write_b32 a138, v70
    v_accvgpr_write_b32 a139, v71
    v_fract_f32 v48, v31
    v_add_f32 v49, v48, v33
    v_cos_f32 v56, v48
    v_add_f32 v50, v49, v35
    v_cos_f32 v57, v49
    v_add_f32 v51, v50, v33
    v_cos_f32 v58, v50
    v_add_f32 v52, v51, v35
    v_cos_f32 v59, v51
    v_add_f32 v53, v52, v33
    v_cos_f32 v60, v52
    v_add_f32 v54, v53, v35
    v_cos_f32 v61, v53
    v_add_f32 v55, v54, v33
    v_cos_f32 v62, v54
    v_cos_f32 v63, v55
    v_add_f32 v31, v48, v37
    v_cvt_pk_bf16_f32 v64, v56, v57
    v_cvt_pk_bf16_f32 v65, v58, v59
    v_cvt_pk_bf16_f32 v66, v60, v61
    v_cvt_pk_bf16_f32 v67, v62, v63
    v_accvgpr_write_b32 a12, v64
    v_accvgpr_write_b32 a13, v65
    v_accvgpr_write_b32 a14, v66
    v_accvgpr_write_b32 a15, v67
    v_alignbit_b32 v68, v64, v64, v40
    v_xor_b32 v68, v68, v41
    v_alignbit_b32 v69, v65, v65, v40
    v_xor_b32 v69, v69, v41
    v_alignbit_b32 v70, v66, v66, v40
    v_xor_b32 v70, v70, v41
    v_alignbit_b32 v71, v67, v67, v40
    v_xor_b32 v71, v71, v41
    v_accvgpr_write_b32 a140, v68
    v_accvgpr_write_b32 a141, v69
    v_accvgpr_write_b32 a142, v70
    v_accvgpr_write_b32 a143, v71
    v_fract_f32 v48, v30
    v_add_f32 v49, v48, v32
    v_cos_f32 v56, v48
    v_add_f32 v50, v49, v34
    v_cos_f32 v57, v49
    v_add_f32 v51, v50, v32
    v_cos_f32 v58, v50
    v_add_f32 v52, v51, v34
    v_cos_f32 v59, v51
    v_add_f32 v53, v52, v32
    v_cos_f32 v60, v52
    v_add_f32 v54, v53, v34
    v_cos_f32 v61, v53
    v_add_f32 v55, v54, v32
    v_cos_f32 v62, v54
    v_cos_f32 v63, v55
    v_add_f32 v30, v48, v36
    v_cvt_pk_bf16_f32 v64, v56, v57
    v_cvt_pk_bf16_f32 v65, v58, v59
    v_cvt_pk_bf16_f32 v66, v60, v61
    v_cvt_pk_bf16_f32 v67, v62, v63
    v_accvgpr_write_b32 a16, v64
    v_accvgpr_write_b32 a17, v65
    v_accvgpr_write_b32 a18, v66
    v_accvgpr_write_b32 a19, v67
    v_alignbit_b32 v68, v64, v64, v40
    v_xor_b32 v68, v68, v41
    v_alignbit_b32 v69, v65, v65, v40
    v_xor_b32 v69, v69, v41
    v_alignbit_b32 v70, v66, v66, v40
    v_xor_b32 v70, v70, v41
    v_alignbit_b32 v71, v67, v67, v40
    v_xor_b32 v71, v71, v41
    v_accvgpr_write_b32 a144, v68
    v_accvgpr_write_b32 a145, v69
    v_accvgpr_write_b32 a146, v70
    v_accvgpr_write_b32 a147, v71
    v_fract_f32 v48, v31
    v_add_f32 v49, v48, v33
    v_cos_f32 v56, v48
    v_add_f32 v50, v49, v35
    v_cos_f32 v57, v49
    v_add_f32 v51, v50, v33
    v_cos_f32 v58, v50
    v_add_f32 v52, v51, v35
    v_cos_f32 v59, v51
    v_add_f32 v53, v52, v33
    v_cos_f32 v60, v52
    v_add_f32 v54, v53, v35
    v_cos_f32 v61, v53
    v_add_f32 v55, v54, v33
    v_cos_f32 v62, v54
    v_cos_f32 v63, v55
    v_add_f32 v31, v48, v37
    v_cvt_pk_bf16_f32 v64, v56, v57
    v_cvt_pk_bf16_f32 v65, v58, v59
    v_cvt_pk_bf16_f32 v66, v60, v61
    v_cvt_pk_bf16_f32 v67, v62, v63
    v_accvgpr_write_b32 a20, v64
    v_accvgpr_write_b32 a21, v65
    v_accvgpr_write_b32 a22, v66
    v_accvgpr_write_b32 a23, v67
    v_alignbit_b32 v68, v64, v64, v40
    v_xor_b32 v68, v68, v41
    v_alignbit_b32 v69, v65, v65, v40
    v_xor_b32 v69, v69, v41
    v_alignbit_b32 v70, v66, v66, v40
    v_xor_b32 v70, v70, v41
    v_alignbit_b32 v71, v67, v67, v40
    v_xor_b32 v71, v71, v41
    v_accvgpr_write_b32 a148, v68
    v_accvgpr_write_b32 a149, v69
    v_accvgpr_write_b32 a150, v70
    v_accvgpr_write_b32 a151, v71
    v_fract_f32 v48, v30
    v_add_f32 v49, v48, v32
    v_cos_f32 v56, v48
    v_add_f32 v50, v49, v34
    v_cos_f32 v57, v49
    v_add_f32 v51, v50, v32
    v_cos_f32 v58, v50
    v_add_f32 v52, v51, v34
    v_cos_f32 v59, v51
    v_add_f32 v53, v52, v32
    v_cos_f32 v60, v52
    v_add_f32 v54, v53, v34
    v_cos_f32 v61, v53
    v_add_f32 v55, v54, v32
    v_cos_f32 v62, v54
    v_cos_f32 v63, v55
    v_add_f32 v30, v48, v36
    v_cvt_pk_bf16_f32 v64, v56, v57
    v_cvt_pk_bf16_f32 v65, v58, v59
    v_cvt_pk_bf16_f32 v66, v60, v61
    v_cvt_pk_bf16_f32 v67, v62, v63
    v_accvgpr_write_b32 a24, v64
    v_accvgpr_write_b32 a25, v65
    v_accvgpr_write_b32 a26, v66
    v_accvgpr_write_b32 a27, v67
    v_alignbit_b32 v68, v64, v64, v40
    v_xor_b32 v68, v68, v41
    v_alignbit_b32 v69, v65, v65, v40
    v_xor_b32 v69, v69, v41
    v_alignbit_b32 v70, v66, v66, v40
    v_xor_b32 v70, v70, v41
    v_alignbit_b32 v71, v67, v67, v40
    v_xor_b32 v71, v71, v41
    v_accvgpr_write_b32 a152, v68
    v_accvgpr_write_b32 a153, v69
    v_accvgpr_write_b32 a154, v70
    v_accvgpr_write_b32 a155, v71
    v_fract_f32 v48, v31
    v_add_f32 v49, v48, v33
    v_cos_f32 v56, v48
    v_add_f32 v50, v49, v35
    v_cos_f32 v57, v49
    v_add_f32 v51, v50, v33
    v_cos_f32 v58, v50
    v_add_f32 v52, v51, v35
    v_cos_f32 v59, v51
    v_add_f32 v53, v52, v33
    v_cos_f32 v60, v52
    v_add_f32 v54, v53, v35
    v_cos_f32 v61, v53
    v_add_f32 v55, v54, v33
    v_cos_f32 v62, v54
    v_cos_f32 v63, v55
    v_add_f32 v31, v48, v37
    v_cvt_pk_bf16_f32 v64, v56, v57
    v_cvt_pk_bf16_f32 v65, v58, v59
    v_cvt_pk_bf16_f32 v66, v60, v61
    v_cvt_pk_bf16_f32 v67, v62, v63
    v_accvgpr_write_b32 a28, v64
    v_accvgpr_write_b32 a29, v65
    v_accvgpr_write_b32 a30, v66
    v_accvgpr_write_b32 a31, v67
    v_alignbit_b32 v68, v64, v64, v40
    v_xor_b32 v68, v68, v41
    v_alignbit_b32 v69, v65, v65, v40
    v_xor_b32 v69, v69, v41
    v_alignbit_b32 v70, v66, v66, v40
    v_xor_b32 v70, v70, v41
    v_alignbit_b32 v71, v67, v67, v40
    v_xor_b32 v71, v71, v41
    v_accvgpr_write_b32 a156, v68
    v_accvgpr_write_b32 a157, v69
    v_accvgpr_write_b32 a158, v70
    v_accvgpr_write_b32 a159, v71
    v_fract_f32 v48, v30
    v_add_f32 v49, v48, v32
    v_cos_f32 v56, v48
    v_add_f32 v50, v49, v34
    v_cos_f32 v57, v49
    v_add_f32 v51, v50, v32
    v_cos_f32 v58, v50
    v_add_f32 v52, v51, v34
    v_cos_f32 v59, v51
    v_add_f32 v53, v52, v32
    v_cos_f32 v60, v52
    v_add_f32 v54, v53, v34
    v_cos_f32 v61, v53
    v_add_f32 v55, v54, v32
    v_cos_f32 v62, v54
    v_cos_f32 v63, v55
    v_add_f32 v30, v48, v36
    v_cvt_pk_bf16_f32 v64, v56, v57
    v_cvt_pk_bf16_f32 v65, v58, v59
    v_cvt_pk_bf16_f32 v66, v60, v61
    v_cvt_pk_bf16_f32 v67, v62, v63
    v_accvgpr_write_b32 a32, v64
    v_accvgpr_write_b32 a33, v65
    v_accvgpr_write_b32 a34, v66
    v_accvgpr_write_b32 a35, v67
    v_alignbit_b32 v68, v64, v64, v40
    v_xor_b32 v68, v68, v41
    v_alignbit_b32 v69, v65, v65, v40
    v_xor_b32 v69, v69, v41
    v_alignbit_b32 v70, v66, v66, v40
    v_xor_b32 v70, v70, v41
    v_alignbit_b32 v71, v67, v67, v40
    v_xor_b32 v71, v71, v41
    v_accvgpr_write_b32 a160, v68
    v_accvgpr_write_b32 a161, v69
    v_accvgpr_write_b32 a162, v70
    v_accvgpr_write_b32 a163, v71
    v_fract_f32 v48, v31
    v_add_f32 v49, v48, v33
    v_cos_f32 v56, v48
    v_add_f32 v50, v49, v35
    v_cos_f32 v57, v49
    v_add_f32 v51, v50, v33
    v_cos_f32 v58, v50
    v_add_f32 v52, v51, v35
    v_cos_f32 v59, v51
    v_add_f32 v53, v52, v33
    v_cos_f32 v60, v52
    v_add_f32 v54, v53, v35
    v_cos_f32 v61, v53
    v_add_f32 v55, v54, v33
    v_cos_f32 v62, v54
    v_cos_f32 v63, v55
    v_add_f32 v31, v48, v37
    v_cvt_pk_bf16_f32 v64, v56, v57
    v_cvt_pk_bf16_f32 v65, v58, v59
    v_cvt_pk_bf16_f32 v66, v60, v61
    v_cvt_pk_bf16_f32 v67, v62, v63
    v_accvgpr_write_b32 a36, v64
    v_accvgpr_write_b32 a37, v65
    v_accvgpr_write_b32 a38, v66
    v_accvgpr_write_b32 a39, v67
    v_alignbit_b32 v68, v64, v64, v40
    v_xor_b32 v68, v68, v41
    v_alignbit_b32 v69, v65, v65, v40
    v_xor_b32 v69, v69, v41
    v_alignbit_b32 v70, v66, v66, v40
    v_xor_b32 v70, v70, v41
    v_alignbit_b32 v71, v67, v67, v40
    v_xor_b32 v71, v71, v41
    v_accvgpr_write_b32 a164, v68
    v_accvgpr_write_b32 a165, v69
    v_accvgpr_write_b32 a166, v70
    v_accvgpr_write_b32 a167, v71
    v_fract_f32 v48, v30
    v_add_f32 v49, v48, v32
    v_cos_f32 v56, v48
    v_add_f32 v50, v49, v34
    v_cos_f32 v57, v49
    v_add_f32 v51, v50, v32
    v_cos_f32 v58, v50
    v_add_f32 v52, v51, v34
    v_cos_f32 v59, v51
    v_add_f32 v53, v52, v32
    v_cos_f32 v60, v52
    v_add_f32 v54, v53, v34
    v_cos_f32 v61, v53
    v_add_f32 v55, v54, v32
    v_cos_f32 v62, v54
    v_cos_f32 v63, v55
    v_add_f32 v30, v48, v36
    v_cvt_pk_bf16_f32 v64, v56, v57
    v_cvt_pk_bf16_f32 v65, v58, v59
    v_cvt_pk_bf16_f32 v66, v60, v61
    v_cvt_pk_bf16_f32 v67, v62, v63
    v_accvgpr_write_b32 a40, v64
    v_accvgpr_write_b32 a41, v65
    v_accvgpr_write_b32 a42, v66
    v_accvgpr_write_b32 a43, v67
    v_alignbit_b32 v68, v64, v64, v40
    v_xor_b32 v68, v68, v41
    v_alignbit_b32 v69, v65, v65, v40
    v_xor_b32 v69, v69, v41
    v_alignbit_b32 v70, v66, v66, v40
    v_xor_b32 v70, v70, v41
    v_alignbit_b32 v71, v67, v67, v40
    v_xor_b32 v71, v71, v41
    v_accvgpr_write_b32 a168, v68
    v_accvgpr_write_b32 a169, v69
    v_accvgpr_write_b32 a170, v70
    v_accvgpr_write_b32 a171, v71
    v_fract_f32 v48, v31
    v_add_f32 v49, v48, v33
    v_cos_f32 v56, v48
    v_add_f32 v50, v49, v35
    v_cos_f32 v57, v49
    v_add_f32 v51, v50, v33
    v_cos_f32 v58, v50
    v_add_f32 v52, v51, v35
    v_cos_f32 v59, v51
    v_add_f32 v53, v52, v33
    v_cos_f32 v60, v52
    v_add_f32 v54, v53, v35
    v_cos_f32 v61, v53
    v_add_f32 v55, v54, v33
    v_cos_f32 v62, v54
    v_cos_f32 v63, v55
    v_add_f32 v31, v48, v37
    v_cvt_pk_bf16_f32 v64, v56, v57
    v_cvt_pk_bf16_f32 v65, v58, v59
    v_cvt_pk_bf16_f32 v66, v60, v61
    v_cvt_pk_bf16_f32 v67, v62, v63
    v_accvgpr_write_b32 a44, v64
    v_accvgpr_write_b32 a45, v65
    v_accvgpr_write_b32 a46, v66
    v_accvgpr_write_b32 a47, v67
    v_alignbit_b32 v68, v64, v64, v40
    v_xor_b32 v68, v68, v41
    v_alignbit_b32 v69, v65, v65, v40
    v_xor_b32 v69, v69, v41
    v_alignbit_b32 v70, v66, v66, v40
    v_xor_b32 v70, v70, v41
    v_alignbit_b32 v71, v67, v67, v40
    v_xor_b32 v71, v71, v41
    v_accvgpr_write_b32 a172, v68
    v_accvgpr_write_b32 a173, v69
    v_accvgpr_write_b32 a174, v70
    v_accvgpr_write_b32 a175, v71
    v_fract_f32 v48, v30
    v_add_f32 v49, v48, v32
    v_cos_f32 v56, v48
    v_add_f32 v50, v49, v34
    v_cos_f32 v57, v49
    v_add_f32 v51, v50, v32
    v_cos_f32 v58, v50
    v_add_f32 v52, v51, v34
    v_cos_f32 v59, v51
    v_add_f32 v53, v52, v32
    v_cos_f32 v60, v52
    v_add_f32 v54, v53, v34
    v_cos_f32 v61, v53
    v_add_f32 v55, v54, v32
    v_cos_f32 v62, v54
    v_cos_f32 v63, v55
    v_add_f32 v30, v48, v36
    v_cvt_pk_bf16_f32 v64, v56, v57
    v_cvt_pk_bf16_f32 v65, v58, v59
    v_cvt_pk_bf16_f32 v66, v60, v61
    v_cvt_pk_bf16_f32 v67, v62, v63
    v_accvgpr_write_b32 a48, v64
    v_accvgpr_write_b32 a49, v65
    v_accvgpr_write_b32 a50, v66
    v_accvgpr_write_b32 a51, v67
    v_alignbit_b32 v68, v64, v64, v40
    v_xor_b32 v68, v68, v41
    v_alignbit_b32 v69, v65, v65, v40
    v_xor_b32 v69, v69, v41
    v_alignbit_b32 v70, v66, v66, v40
    v_xor_b32 v70, v70, v41
    v_alignbit_b32 v71, v67, v67, v40
    v_xor_b32 v71, v71, v41
    v_accvgpr_write_b32 a176, v68
    v_accvgpr_write_b32 a177, v69
    v_accvgpr_write_b32 a178, v70
    v_accvgpr_write_b32 a179, v71
    v_fract_f32 v48, v31
    v_add_f32 v49, v48, v33
    v_cos_f32 v56, v48
    v_add_f32 v50, v49, v35
    v_cos_f32 v57, v49
    v_add_f32 v51, v50, v33
    v_cos_f32 v58, v50
    v_add_f32 v52, v51, v35
    v_cos_f32 v59, v51
    v_add_f32 v53, v52, v33
    v_cos_f32 v60, v52
    v_add_f32 v54, v53, v35
    v_cos_f32 v61, v53
    v_add_f32 v55, v54, v33
    v_cos_f32 v62, v54
    v_cos_f32 v63, v55
    v_add_f32 v31, v48, v37
    v_cvt_pk_bf16_f32 v64, v56, v57
    v_cvt_pk_bf16_f32 v65, v58, v59
    v_cvt_pk_bf16_f32 v66, v60, v61
    v_cvt_pk_bf16_f32 v67, v62, v63
    v_accvgpr_write_b32 a52, v64
    v_accvgpr_write_b32 a53, v65
    v_accvgpr_write_b32 a54, v66
    v_accvgpr_write_b32 a55, v67
    v_alignbit_b32 v68, v64, v64, v40
    v_xor_b32 v68, v68, v41
    v_alignbit_b32 v69, v65, v65, v40
    v_xor_b32 v69, v69, v41
    v_alignbit_b32 v70, v66, v66, v40
    v_xor_b32 v70, v70, v41
    v_alignbit_b32 v71, v67, v67, v40
    v_xor_b32 v71, v71, v41
    v_accvgpr_write_b32 a180, v68
    v_accvgpr_write_b32 a181, v69
    v_accvgpr_write_b32 a182, v70
    v_accvgpr_write_b32 a183, v71
    v_fract_f32 v48, v30
    v_add_f32 v49, v48, v32
    v_cos_f32 v56, v48
    v_add_f32 v50, v49, v34
    v_cos_f32 v57, v49
    v_add_f32 v51, v50, v32
    v_cos_f32 v58, v50
    v_add_f32 v52, v51, v34
    v_cos_f32 v59, v51
    v_add_f32 v53, v52, v32
    v_cos_f32 v60, v52
    v_add_f32 v54, v53, v34
    v_cos_f32 v61, v53
    v_add_f32 v55, v54, v32
    v_cos_f32 v62, v54
    v_cos_f32 v63, v55
    v_add_f32 v30, v48, v36
    v_cvt_pk_bf16_f32 v64, v56, v57
    v_cvt_pk_bf16_f32 v65, v58, v59
    v_cvt_pk_bf16_f32 v66, v60, v61
    v_cvt_pk_bf16_f32 v67, v62, v63
    v_accvgpr_write_b32 a56, v64
    v_accvgpr_write_b32 a57, v65
    v_accvgpr_write_b32 a58, v66
    v_accvgpr_write_b32 a59, v67
    v_alignbit_b32 v68, v64, v64, v40
    v_xor_b32 v68, v68, v41
    v_alignbit_b32 v69, v65, v65, v40
    v_xor_b32 v69, v69, v41
    v_alignbit_b32 v70, v66, v66, v40
    v_xor_b32 v70, v70, v41
    v_alignbit_b32 v71, v67, v67, v40
    v_xor_b32 v71, v71, v41
    v_accvgpr_write_b32 a184, v68
    v_accvgpr_write_b32 a185, v69
    v_accvgpr_write_b32 a186, v70
    v_accvgpr_write_b32 a187, v71
    v_fract_f32 v48, v31
    v_add_f32 v49, v48, v33
    v_cos_f32 v56, v48
    v_add_f32 v50, v49, v35
    v_cos_f32 v57, v49
    v_add_f32 v51, v50, v33
    v_cos_f32 v58, v50
    v_add_f32 v52, v51, v35
    v_cos_f32 v59, v51
    v_add_f32 v53, v52, v33
    v_cos_f32 v60, v52
    v_add_f32 v54, v53, v35
    v_cos_f32 v61, v53
    v_add_f32 v55, v54, v33
    v_cos_f32 v62, v54
    v_cos_f32 v63, v55
    v_add_f32 v31, v48, v37
    v_cvt_pk_bf16_f32 v64, v56, v57
    v_cvt_pk_bf16_f32 v65, v58, v59
    v_cvt_pk_bf16_f32 v66, v60, v61
    v_cvt_pk_bf16_f32 v67, v62, v63
    v_accvgpr_write_b32 a60, v64
    v_accvgpr_write_b32 a61, v65
    v_accvgpr_write_b32 a62, v66
    v_accvgpr_write_b32 a63, v67
    v_alignbit_b32 v68, v64, v64, v40
    v_xor_b32 v68, v68, v41
    v_alignbit_b32 v69, v65, v65, v40
    v_xor_b32 v69, v69, v41
    v_alignbit_b32 v70, v66, v66, v40
    v_xor_b32 v70, v70, v41
    v_alignbit_b32 v71, v67, v67, v40
    v_xor_b32 v71, v71, v41
    v_accvgpr_write_b32 a188, v68
    v_accvgpr_write_b32 a189, v69
    v_accvgpr_write_b32 a190, v70
    v_accvgpr_write_b32 a191, v71
    v_fract_f32 v48, v30
    v_add_f32 v49, v48, v32
    v_cos_f32 v56, v48
    v_add_f32 v50, v49, v34
    v_cos_f32 v57, v49
    v_add_f32 v51, v50, v32
    v_cos_f32 v58, v50
    v_add_f32 v52, v51, v34
    v_cos_f32 v59, v51
    v_add_f32 v53, v52, v32
    v_cos_f32 v60, v52
    v_add_f32 v54, v53, v34
    v_cos_f32 v61, v53
    v_add_f32 v55, v54, v32
    v_cos_f32 v62, v54
    v_cos_f32 v63, v55
    v_add_f32 v30, v48, v36
    v_cvt_pk_bf16_f32 v64, v56, v57
    v_cvt_pk_bf16_f32 v65, v58, v59
    v_cvt_pk_bf16_f32 v66, v60, v61
    v_cvt_pk_bf16_f32 v67, v62, v63
    v_accvgpr_write_b32 a64, v64
    v_accvgpr_write_b32 a65, v65
    v_accvgpr_write_b32 a66, v66
    v_accvgpr_write_b32 a67, v67
    v_alignbit_b32 v68, v64, v64, v40
    v_xor_b32 v68, v68, v41
    v_alignbit_b32 v69, v65, v65, v40
    v_xor_b32 v69, v69, v41
    v_alignbit_b32 v70, v66, v66, v40
    v_xor_b32 v70, v70, v41
    v_alignbit_b32 v71, v67, v67, v40
    v_xor_b32 v71, v71, v41
    v_accvgpr_write_b32 a192, v68
    v_accvgpr_write_b32 a193, v69
    v_accvgpr_write_b32 a194, v70
    v_accvgpr_write_b32 a195, v71
    v_fract_f32 v48, v31
    v_add_f32 v49, v48, v33
    v_cos_f32 v56, v48
    v_add_f32 v50, v49, v35
    v_cos_f32 v57, v49
    v_add_f32 v51, v50, v33
    v_cos_f32 v58, v50
    v_add_f32 v52, v51, v35
    v_cos_f32 v59, v51
    v_add_f32 v53, v52, v33
    v_cos_f32 v60, v52
    v_add_f32 v54, v53, v35
    v_cos_f32 v61, v53
    v_add_f32 v55, v54, v33
    v_cos_f32 v62, v54
    v_cos_f32 v63, v55
    v_add_f32 v31, v48, v37
    v_cvt_pk_bf16_f32 v64, v56, v57
    v_cvt_pk_bf16_f32 v65, v58, v59
    v_cvt_pk_bf16_f32 v66, v60, v61
    v_cvt_pk_bf16_f32 v67, v62, v63
    v_accvgpr_write_b32 a68, v64
    v_accvgpr_write_b32 a69, v65
    v_accvgpr_write_b32 a70, v66
    v_accvgpr_write_b32 a71, v67
    v_alignbit_b32 v68, v64, v64, v40
    v_xor_b32 v68, v68, v41
    v_alignbit_b32 v69, v65, v65, v40
    v_xor_b32 v69, v69, v41
    v_alignbit_b32 v70, v66, v66, v40
    v_xor_b32 v70, v70, v41
    v_alignbit_b32 v71, v67, v67, v40
    v_xor_b32 v71, v71, v41
    v_accvgpr_write_b32 a196, v68
    v_accvgpr_write_b32 a197, v69
    v_accvgpr_write_b32 a198, v70
    v_accvgpr_write_b32 a199, v71
    v_fract_f32 v48, v30
    v_add_f32 v49, v48, v32
    v_cos_f32 v56, v48
    v_add_f32 v50, v49, v34
    v_cos_f32 v57, v49
    v_add_f32 v51, v50, v32
    v_cos_f32 v58, v50
    v_add_f32 v52, v51, v34
    v_cos_f32 v59, v51
    v_add_f32 v53, v52, v32
    v_cos_f32 v60, v52
    v_add_f32 v54, v53, v34
    v_cos_f32 v61, v53
    v_add_f32 v55, v54, v32
    v_cos_f32 v62, v54
    v_cos_f32 v63, v55
    v_add_f32 v30, v48, v36
    v_cvt_pk_bf16_f32 v64, v56, v57
    v_cvt_pk_bf16_f32 v65, v58, v59
    v_cvt_pk_bf16_f32 v66, v60, v61
    v_cvt_pk_bf16_f32 v67, v62, v63
    v_accvgpr_write_b32 a72, v64
    v_accvgpr_write_b32 a73, v65
    v_accvgpr_write_b32 a74, v66
    v_accvgpr_write_b32 a75, v67
    v_alignbit_b32 v68, v64, v64, v40
    v_xor_b32 v68, v68, v41
    v_alignbit_b32 v69, v65, v65, v40
    v_xor_b32 v69, v69, v41
    v_alignbit_b32 v70, v66, v66, v40
    v_xor_b32 v70, v70, v41
    v_alignbit_b32 v71, v67, v67, v40
    v_xor_b32 v71, v71, v41
    v_accvgpr_write_b32 a200, v68
    v_accvgpr_write_b32 a201, v69
    v_accvgpr_write_b32 a202, v70
    v_accvgpr_write_b32 a203, v71
    v_fract_f32 v48, v31
    v_add_f32 v49, v48, v33
    v_cos_f32 v56, v48
    v_add_f32 v50, v49, v35
    v_cos_f32 v57, v49
    v_add_f32 v51, v50, v33
    v_cos_f32 v58, v50
    v_add_f32 v52, v51, v35
    v_cos_f32 v59, v51
    v_add_f32 v53, v52, v33
    v_cos_f32 v60, v52
    v_add_f32 v54, v53, v35
    v_cos_f32 v61, v53
    v_add_f32 v55, v54, v33
    v_cos_f32 v62, v54
    v_cos_f32 v63, v55
    v_add_f32 v31, v48, v37
    v_cvt_pk_bf16_f32 v64, v56, v57
    v_cvt_pk_bf16_f32 v65, v58, v59
    v_cvt_pk_bf16_f32 v66, v60, v61
    v_cvt_pk_bf16_f32 v67, v62, v63
    v_accvgpr_write_b32 a76, v64
    v_accvgpr_write_b32 a77, v65
    v_accvgpr_write_b32 a78, v66
    v_accvgpr_write_b32 a79, v67
    v_alignbit_b32 v68, v64, v64, v40
    v_xor_b32 v68, v68, v41
    v_alignbit_b32 v69, v65, v65, v40
    v_xor_b32 v69, v69, v41
    v_alignbit_b32 v70, v66, v66, v40
    v_xor_b32 v70, v70, v41
    v_alignbit_b32 v71, v67, v67, v40
    v_xor_b32 v71, v71, v41
    v_accvgpr_write_b32 a204, v68
    v_accvgpr_write_b32 a205, v69
    v_accvgpr_write_b32 a206, v70
    v_accvgpr_write_b32 a207, v71
    v_fract_f32 v48, v30
    v_add_f32 v49, v48, v32
    v_cos_f32 v56, v48
    v_add_f32 v50, v49, v34
    v_cos_f32 v57, v49
    v_add_f32 v51, v50, v32
    v_cos_f32 v58, v50
    v_add_f32 v52, v51, v34
    v_cos_f32 v59, v51
    v_add_f32 v53, v52, v32
    v_cos_f32 v60, v52
    v_add_f32 v54, v53, v34
    v_cos_f32 v61, v53
    v_add_f32 v55, v54, v32
    v_cos_f32 v62, v54
    v_cos_f32 v63, v55
    v_add_f32 v30, v48, v36
    v_cvt_pk_bf16_f32 v64, v56, v57
    v_cvt_pk_bf16_f32 v65, v58, v59
    v_cvt_pk_bf16_f32 v66, v60, v61
    v_cvt_pk_bf16_f32 v67, v62, v63
    v_accvgpr_write_b32 a80, v64
    v_accvgpr_write_b32 a81, v65
    v_accvgpr_write_b32 a82, v66
    v_accvgpr_write_b32 a83, v67
    v_alignbit_b32 v68, v64, v64, v40
    v_xor_b32 v68, v68, v41
    v_alignbit_b32 v69, v65, v65, v40
    v_xor_b32 v69, v69, v41
    v_alignbit_b32 v70, v66, v66, v40
    v_xor_b32 v70, v70, v41
    v_alignbit_b32 v71, v67, v67, v40
    v_xor_b32 v71, v71, v41
    v_accvgpr_write_b32 a208, v68
    v_accvgpr_write_b32 a209, v69
    v_accvgpr_write_b32 a210, v70
    v_accvgpr_write_b32 a211, v71
    v_fract_f32 v48, v31
    v_add_f32 v49, v48, v33
    v_cos_f32 v56, v48
    v_add_f32 v50, v49, v35
    v_cos_f32 v57, v49
    v_add_f32 v51, v50, v33
    v_cos_f32 v58, v50
    v_add_f32 v52, v51, v35
    v_cos_f32 v59, v51
    v_add_f32 v53, v52, v33
    v_cos_f32 v60, v52
    v_add_f32 v54, v53, v35
    v_cos_f32 v61, v53
    v_add_f32 v55, v54, v33
    v_cos_f32 v62, v54
    v_cos_f32 v63, v55
    v_add_f32 v31, v48, v37
    v_cvt_pk_bf16_f32 v64, v56, v57
    v_cvt_pk_bf16_f32 v65, v58, v59
    v_cvt_pk_bf16_f32 v66, v60, v61
    v_cvt_pk_bf16_f32 v67, v62, v63
    v_accvgpr_write_b32 a84, v64
    v_accvgpr_write_b32 a85, v65
    v_accvgpr_write_b32 a86, v66
    v_accvgpr_write_b32 a87, v67
    v_alignbit_b32 v68, v64, v64, v40
    v_xor_b32 v68, v68, v41
    v_alignbit_b32 v69, v65, v65, v40
    v_xor_b32 v69, v69, v41
    v_alignbit_b32 v70, v66, v66, v40
    v_xor_b32 v70, v70, v41
    v_alignbit_b32 v71, v67, v67, v40
    v_xor_b32 v71, v71, v41
    v_accvgpr_write_b32 a212, v68
    v_accvgpr_write_b32 a213, v69
    v_accvgpr_write_b32 a214, v70
    v_accvgpr_write_b32 a215, v71
    v_fract_f32 v48, v30
    v_add_f32 v49, v48, v32
    v_cos_f32 v56, v48
    v_add_f32 v50, v49, v34
    v_cos_f32 v57, v49
    v_add_f32 v51, v50, v32
    v_cos_f32 v58, v50
    v_add_f32 v52, v51, v34
    v_cos_f32 v59, v51
    v_add_f32 v53, v52, v32
    v_cos_f32 v60, v52
    v_add_f32 v54, v53, v34
    v_cos_f32 v61, v53
    v_add_f32 v55, v54, v32
    v_cos_f32 v62, v54
    v_cos_f32 v63, v55
    v_add_f32 v30, v48, v36
    v_cvt_pk_bf16_f32 v64, v56, v57
    v_cvt_pk_bf16_f32 v65, v58, v59
    v_cvt_pk_bf16_f32 v66, v60, v61
    v_cvt_pk_bf16_f32 v67, v62, v63
    v_accvgpr_write_b32 a88, v64
    v_accvgpr_write_b32 a89, v65
    v_accvgpr_write_b32 a90, v66
    v_accvgpr_write_b32 a91, v67
    v_alignbit_b32 v68, v64, v64, v40
    v_xor_b32 v68, v68, v41
    v_alignbit_b32 v69, v65, v65, v40
    v_xor_b32 v69, v69, v41
    v_alignbit_b32 v70, v66, v66, v40
    v_xor_b32 v70, v70, v41
    v_alignbit_b32 v71, v67, v67, v40
    v_xor_b32 v71, v71, v41
    v_accvgpr_write_b32 a216, v68
    v_accvgpr_write_b32 a217, v69
    v_accvgpr_write_b32 a218, v70
    v_accvgpr_write_b32 a219, v71
    v_fract_f32 v48, v31
    v_add_f32 v49, v48, v33
    v_cos_f32 v56, v48
    v_add_f32 v50, v49, v35
    v_cos_f32 v57, v49
    v_add_f32 v51, v50, v33
    v_cos_f32 v58, v50
    v_add_f32 v52, v51, v35
    v_cos_f32 v59, v51
    v_add_f32 v53, v52, v33
    v_cos_f32 v60, v52
    v_add_f32 v54, v53, v35
    v_cos_f32 v61, v53
    v_add_f32 v55, v54, v33
    v_cos_f32 v62, v54
    v_cos_f32 v63, v55
    v_add_f32 v31, v48, v37
    v_cvt_pk_bf16_f32 v64, v56, v57
    v_cvt_pk_bf16_f32 v65, v58, v59
    v_cvt_pk_bf16_f32 v66, v60, v61
    v_cvt_pk_bf16_f32 v67, v62, v63
    v_accvgpr_write_b32 a92, v64
    v_accvgpr_write_b32 a93, v65
    v_accvgpr_write_b32 a94, v66
    v_accvgpr_write_b32 a95, v67
    v_alignbit_b32 v68, v64, v64, v40
    v_xor_b32 v68, v68, v41
    v_alignbit_b32 v69, v65, v65, v40
    v_xor_b32 v69, v69, v41
    v_alignbit_b32 v70, v66, v66, v40
    v_xor_b32 v70, v70, v41
    v_alignbit_b32 v71, v67, v67, v40
    v_xor_b32 v71, v71, v41
    v_accvgpr_write_b32 a220, v68
    v_accvgpr_write_b32 a221, v69
    v_accvgpr_write_b32 a222, v70
    v_accvgpr_write_b32 a223, v71
    v_fract_f32 v48, v30
    v_add_f32 v49, v48, v32
    v_cos_f32 v56, v48
    v_add_f32 v50, v49, v34
    v_cos_f32 v57, v49
    v_add_f32 v51, v50, v32
    v_cos_f32 v58, v50
    v_add_f32 v52, v51, v34
    v_cos_f32 v59, v51
    v_add_f32 v53, v52, v32
    v_cos_f32 v60, v52
    v_add_f32 v54, v53, v34
    v_cos_f32 v61, v53
    v_add_f32 v55, v54, v32
    v_cos_f32 v62, v54
    v_cos_f32 v63, v55
    v_add_f32 v30, v48, v36
    v_cvt_pk_bf16_f32 v64, v56, v57
    v_cvt_pk_bf16_f32 v65, v58, v59
    v_cvt_pk_bf16_f32 v66, v60, v61
    v_cvt_pk_bf16_f32 v67, v62, v63
    v_accvgpr_write_b32 a96, v64
    v_accvgpr_write_b32 a97, v65
    v_accvgpr_write_b32 a98, v66
    v_accvgpr_write_b32 a99, v67
    v_alignbit_b32 v68, v64, v64, v40
    v_xor_b32 v68, v68, v41
    v_alignbit_b32 v69, v65, v65, v40
    v_xor_b32 v69, v69, v41
    v_alignbit_b32 v70, v66, v66, v40
    v_xor_b32 v70, v70, v41
    v_alignbit_b32 v71, v67, v67, v40
    v_xor_b32 v71, v71, v41
    v_accvgpr_write_b32 a224, v68
    v_accvgpr_write_b32 a225, v69
    v_accvgpr_write_b32 a226, v70
    v_accvgpr_write_b32 a227, v71
    v_fract_f32 v48, v31
    v_add_f32 v49, v48, v33
    v_cos_f32 v56, v48
    v_add_f32 v50, v49, v35
    v_cos_f32 v57, v49
    v_add_f32 v51, v50, v33
    v_cos_f32 v58, v50
    v_add_f32 v52, v51, v35
    v_cos_f32 v59, v51
    v_add_f32 v53, v52, v33
    v_cos_f32 v60, v52
    v_add_f32 v54, v53, v35
    v_cos_f32 v61, v53
    v_add_f32 v55, v54, v33
    v_cos_f32 v62, v54
    v_cos_f32 v63, v55
    v_add_f32 v31, v48, v37
    v_cvt_pk_bf16_f32 v64, v56, v57
    v_cvt_pk_bf16_f32 v65, v58, v59
    v_cvt_pk_bf16_f32 v66, v60, v61
    v_cvt_pk_bf16_f32 v67, v62, v63
    v_accvgpr_write_b32 a100, v64
    v_accvgpr_write_b32 a101, v65
    v_accvgpr_write_b32 a102, v66
    v_accvgpr_write_b32 a103, v67
    v_alignbit_b32 v68, v64, v64, v40
    v_xor_b32 v68, v68, v41
    v_alignbit_b32 v69, v65, v65, v40
    v_xor_b32 v69, v69, v41
    v_alignbit_b32 v70, v66, v66, v40
    v_xor_b32 v70, v70, v41
    v_alignbit_b32 v71, v67, v67, v40
    v_xor_b32 v71, v71, v41
    v_accvgpr_write_b32 a228, v68
    v_accvgpr_write_b32 a229, v69
    v_accvgpr_write_b32 a230, v70
    v_accvgpr_write_b32 a231, v71
    v_fract_f32 v48, v30
    v_add_f32 v49, v48, v32
    v_cos_f32 v56, v48
    v_add_f32 v50, v49, v34
    v_cos_f32 v57, v49
    v_add_f32 v51, v50, v32
    v_cos_f32 v58, v50
    v_add_f32 v52, v51, v34
    v_cos_f32 v59, v51
    v_add_f32 v53, v52, v32
    v_cos_f32 v60, v52
    v_add_f32 v54, v53, v34
    v_cos_f32 v61, v53
    v_add_f32 v55, v54, v32
    v_cos_f32 v62, v54
    v_cos_f32 v63, v55
    v_add_f32 v30, v48, v36
    v_cvt_pk_bf16_f32 v64, v56, v57
    v_cvt_pk_bf16_f32 v65, v58, v59
    v_cvt_pk_bf16_f32 v66, v60, v61
    v_cvt_pk_bf16_f32 v67, v62, v63
    v_accvgpr_write_b32 a104, v64
    v_accvgpr_write_b32 a105, v65
    v_accvgpr_write_b32 a106, v66
    v_accvgpr_write_b32 a107, v67
    v_alignbit_b32 v68, v64, v64, v40
    v_xor_b32 v68, v68, v41
    v_alignbit_b32 v69, v65, v65, v40
    v_xor_b32 v69, v69, v41
    v_alignbit_b32 v70, v66, v66, v40
    v_xor_b32 v70, v70, v41
    v_alignbit_b32 v71, v67, v67, v40
    v_xor_b32 v71, v71, v41
    v_accvgpr_write_b32 a232, v68
    v_accvgpr_write_b32 a233, v69
    v_accvgpr_write_b32 a234, v70
    v_accvgpr_write_b32 a235, v71
    v_fract_f32 v48, v31
    v_add_f32 v49, v48, v33
    v_cos_f32 v56, v48
    v_add_f32 v50, v49, v35
    v_cos_f32 v57, v49
    v_add_f32 v51, v50, v33
    v_cos_f32 v58, v50
    v_add_f32 v52, v51, v35
    v_cos_f32 v59, v51
    v_add_f32 v53, v52, v33
    v_cos_f32 v60, v52
    v_add_f32 v54, v53, v35
    v_cos_f32 v61, v53
    v_add_f32 v55, v54, v33
    v_cos_f32 v62, v54
    v_cos_f32 v63, v55
    v_add_f32 v31, v48, v37
    v_cvt_pk_bf16_f32 v64, v56, v57
    v_cvt_pk_bf16_f32 v65, v58, v59
    v_cvt_pk_bf16_f32 v66, v60, v61
    v_cvt_pk_bf16_f32 v67, v62, v63
    v_accvgpr_write_b32 a108, v64
    v_accvgpr_write_b32 a109, v65
    v_accvgpr_write_b32 a110, v66
    v_accvgpr_write_b32 a111, v67
    v_alignbit_b32 v68, v64, v64, v40
    v_xor_b32 v68, v68, v41
    v_alignbit_b32 v69, v65, v65, v40
    v_xor_b32 v69, v69, v41
    v_alignbit_b32 v70, v66, v66, v40
    v_xor_b32 v70, v70, v41
    v_alignbit_b32 v71, v67, v67, v40
    v_xor_b32 v71, v71, v41
    v_accvgpr_write_b32 a236, v68
    v_accvgpr_write_b32 a237, v69
    v_accvgpr_write_b32 a238, v70
    v_accvgpr_write_b32 a239, v71
    v_fract_f32 v48, v30
    v_add_f32 v49, v48, v32
    v_cos_f32 v56, v48
    v_add_f32 v50, v49, v34
    v_cos_f32 v57, v49
    v_add_f32 v51, v50, v32
    v_cos_f32 v58, v50
    v_add_f32 v52, v51, v34
    v_cos_f32 v59, v51
    v_add_f32 v53, v52, v32
    v_cos_f32 v60, v52
    v_add_f32 v54, v53, v34
    v_cos_f32 v61, v53
    v_add_f32 v55, v54, v32
    v_cos_f32 v62, v54
    v_cos_f32 v63, v55
    v_add_f32 v30, v48, v36
    v_cvt_pk_bf16_f32 v64, v56, v57
    v_cvt_pk_bf16_f32 v65, v58, v59
    v_cvt_pk_bf16_f32 v66, v60, v61
    v_cvt_pk_bf16_f32 v67, v62, v63
    v_accvgpr_write_b32 a112, v64
    v_accvgpr_write_b32 a113, v65
    v_accvgpr_write_b32 a114, v66
    v_accvgpr_write_b32 a115, v67
    v_alignbit_b32 v68, v64, v64, v40
    v_xor_b32 v68, v68, v41
    v_alignbit_b32 v69, v65, v65, v40
    v_xor_b32 v69, v69, v41
    v_alignbit_b32 v70, v66, v66, v40
    v_xor_b32 v70, v70, v41
    v_alignbit_b32 v71, v67, v67, v40
    v_xor_b32 v71, v71, v41
    v_accvgpr_write_b32 a240, v68
    v_accvgpr_write_b32 a241, v69
    v_accvgpr_write_b32 a242, v70
    v_accvgpr_write_b32 a243, v71
    v_fract_f32 v48, v31
    v_add_f32 v49, v48, v33
    v_cos_f32 v56, v48
    v_add_f32 v50, v49, v35
    v_cos_f32 v57, v49
    v_add_f32 v51, v50, v33
    v_cos_f32 v58, v50
    v_add_f32 v52, v51, v35
    v_cos_f32 v59, v51
    v_add_f32 v53, v52, v33
    v_cos_f32 v60, v52
    v_add_f32 v54, v53, v35
    v_cos_f32 v61, v53
    v_add_f32 v55, v54, v33
    v_cos_f32 v62, v54
    v_cos_f32 v63, v55
    v_add_f32 v31, v48, v37
    v_cvt_pk_bf16_f32 v64, v56, v57
    v_cvt_pk_bf16_f32 v65, v58, v59
    v_cvt_pk_bf16_f32 v66, v60, v61
    v_cvt_pk_bf16_f32 v67, v62, v63
    v_accvgpr_write_b32 a116, v64
    v_accvgpr_write_b32 a117, v65
    v_accvgpr_write_b32 a118, v66
    v_accvgpr_write_b32 a119, v67
    v_alignbit_b32 v68, v64, v64, v40
    v_xor_b32 v68, v68, v41
    v_alignbit_b32 v69, v65, v65, v40
    v_xor_b32 v69, v69, v41
    v_alignbit_b32 v70, v66, v66, v40
    v_xor_b32 v70, v70, v41
    v_alignbit_b32 v71, v67, v67, v40
    v_xor_b32 v71, v71, v41
    v_accvgpr_write_b32 a244, v68
    v_accvgpr_write_b32 a245, v69
    v_accvgpr_write_b32 a246, v70
    v_accvgpr_write_b32 a247, v71
    v_fract_f32 v48, v30
    v_add_f32 v49, v48, v32
    v_cos_f32 v56, v48
    v_add_f32 v50, v49, v34
    v_cos_f32 v57, v49
    v_add_f32 v51, v50, v32
    v_cos_f32 v58, v50
    v_add_f32 v52, v51, v34
    v_cos_f32 v59, v51
    v_add_f32 v53, v52, v32
    v_cos_f32 v60, v52
    v_add_f32 v54, v53, v34
    v_cos_f32 v61, v53
    v_add_f32 v55, v54, v32
    v_cos_f32 v62, v54
    v_cos_f32 v63, v55
    v_add_f32 v30, v48, v36
    v_cvt_pk_bf16_f32 v64, v56, v57
    v_cvt_pk_bf16_f32 v65, v58, v59
    v_cvt_pk_bf16_f32 v66, v60, v61
    v_cvt_pk_bf16_f32 v67, v62, v63
    v_accvgpr_write_b32 a120, v64
    v_accvgpr_write_b32 a121, v65
    v_accvgpr_write_b32 a122, v66
    v_accvgpr_write_b32 a123, v67
    v_alignbit_b32 v68, v64, v64, v40
    v_xor_b32 v68, v68, v41
    v_alignbit_b32 v69, v65, v65, v40
    v_xor_b32 v69, v69, v41
    v_alignbit_b32 v70, v66, v66, v40
    v_xor_b32 v70, v70, v41
    v_alignbit_b32 v71, v67, v67, v40
    v_xor_b32 v71, v71, v41
    v_accvgpr_write_b32 a248, v68
    v_accvgpr_write_b32 a249, v69
    v_accvgpr_write_b32 a250, v70
    v_accvgpr_write_b32 a251, v71
    v_fract_f32 v48, v31
    v_add_f32 v49, v48, v33
    v_cos_f32 v56, v48
    v_add_f32 v50, v49, v35
    v_cos_f32 v57, v49
    v_add_f32 v51, v50, v33
    v_cos_f32 v58, v50
    v_add_f32 v52, v51, v35
    v_cos_f32 v59, v51
    v_add_f32 v53, v52, v33
    v_cos_f32 v60, v52
    v_add_f32 v54, v53, v35
    v_cos_f32 v61, v53
    v_add_f32 v55, v54, v33
    v_cos_f32 v62, v54
    v_cos_f32 v63, v55
    v_add_f32 v31, v48, v37
    v_cvt_pk_bf16_f32 v64, v56, v57
    v_cvt_pk_bf16_f32 v65, v58, v59
    v_cvt_pk_bf16_f32 v66, v60, v61
    v_cvt_pk_bf16_f32 v67, v62, v63
    v_accvgpr_write_b32 a124, v64
    v_accvgpr_write_b32 a125, v65
    v_accvgpr_write_b32 a126, v66
    v_accvgpr_write_b32 a127, v67
    v_alignbit_b32 v68, v64, v64, v40
    v_xor_b32 v68, v68, v41
    v_alignbit_b32 v69, v65, v65, v40
    v_xor_b32 v69, v69, v41
    v_alignbit_b32 v70, v66, v66, v40
    v_xor_b32 v70, v70, v41
    v_alignbit_b32 v71, v67, v67, v40
    v_xor_b32 v71, v71, v41
    v_accvgpr_write_b32 a252, v68
    v_accvgpr_write_b32 a253, v69
    v_accvgpr_write_b32 a254, v70
    v_accvgpr_write_b32 a255, v71
    v_lshlrev_b32 v6, 31, v38
    v_or_b32 v6, 0x3f003f00, v6
    v_cmp_gt_u32 vcc, 16, v1
    v_accvgpr_read_b32 v5, a0
    s_nop 0
    v_cndmask_b32 v5, v5, v6, vcc
    v_accvgpr_write_b32 a0, v5
    v_accvgpr_read_b32 v5, a4
    v_cndmask_b32 v5, v5, v6, vcc
    v_accvgpr_write_b32 a4, v5
    v_and_b32 v5, 15, v1
    v_lshrrev_b32 v6, 4, v1
    v_lshlrev_b32 v5, 4, v5
    v_lshl_add_u32 v10, v6, 9, v5
    v_add_u32 v11, 2048, v10
    v_add_u32 v12, 0x10000, v10
    v_add_u32 v13, 0x10000, v11
    s_lshl_b32 s19, s16, 10
    s_lshl_b32 s17, s16, 1
    v_lshrrev_b32 v8, 5, v1
    v_add_u32 v8, s17, v8
    v_and_b32 v7, 31, v1
    v_mul_u32_u24 v2, 33024, v8
    v_lshl_add_u32 v2, v7, 4, v2
    v_and_b32 v3, 15, v1
    v_and_b32 v5, 48, v1
    v_lshl_add_u32 v3, v3, 12, v5
    v_add_u32 v4, 0x10000, v3
    s_lshl_b32 s21, s28, 21
    s_lshl_b32 s17, s29, 6
    s_add_u32 s21, s21, s17
    s_lshl_b32 s20, s28, 13
    s_add_u32 s20, s20, 111149056
    s_mov_b32 s24, 512
    s_mov_b32 s25, 131072
    v_and_b32 v7, 31, v1
    v_lshlrev_b32 v7, 7, v7
    s_lshl_b32 s17, s16, 12
    s_add_u32 s17, s17, 100761600
    v_add_u32 v7, s17, v7
    s_mov_b32 s30, s92
F3_w0:
    buffer_load_dword v5, v7, s[4:7], 0 offen sc1
    s_waitcnt vmcnt(0)
    v_cmp_gt_u32 vcc, 1, v5
    s_nop 0
    s_cmp_lg_u64 vcc, 0
    s_cbranch_scc0 F3_w0_ok
    s_cmp_ge_u32 s30, 1048576
    s_cselect_b32 s92, 1048576, s92
    s_cbranch_scc1 F3_w0_ok
    s_add_u32 s30, s30, 1
    s_sleep 8
    s_branch F3_w0
F3_w0_ok:
    s_barrier
    s_mov_b32 s26, s25
    s_sub_u32 s25, s21, 1073741824
    s_mov_b32 s21, 1073741824
    s_mov_b32 s23, 0
    s_mov_b32 s22, 0
    s_add_u32 m0, s19, 0
    s_add_u32 s17, s20, 0
    buffer_load_dwordx4 v2, s[4:7], s17 offen lds
    s_add_u32 m0, s19, 4096
    s_add_u32 s17, s20, 264192
    buffer_load_dwordx4 v2, s[4:7], s17 offen lds
    s_add_u32 m0, s19, 8192
    s_add_u32 s17, s20, 528384
    buffer_load_dwordx4 v2, s[4:7], s17 offen lds
    s_add_u32 m0, s19, 12288
    s_add_u32 s17, s20, 792576
    buffer_load_dwordx4 v2, s[4:7], s17 offen lds
    s_add_u32 m0, s19, 16384
    s_add_u32 s17, s20, 1056768
    buffer_load_dwordx4 v2, s[4:7], s17 offen lds
    s_add_u32 m0, s19, 20480
    s_add_u32 s17, s20, 1320960
    buffer_load_dwordx4 v2, s[4:7], s17 offen lds
    s_add_u32 m0, s19, 24576
    s_add_u32 s17, s20, 1585152
    buffer_load_dwordx4 v2, s[4:7], s17 offen lds
    s_add_u32 m0, s19, 28672
    s_add_u32 s17, s20, 1849344
    buffer_load_dwordx4 v2, s[4:7], s17 offen lds
    s_add_u32 m0, s19, 32768
    s_add_u32 s17, s20, 2113536
    buffer_load_dwordx4 v2, s[4:7], s17 offen lds
    s_add_u32 m0, s19, 36864
    s_add_u32 s17, s20, 2377728
    buffer_load_dwordx4 v2, s[4:7], s17 offen lds
    s_add_u32 m0, s19, 40960
    s_add_u32 s17, s20, 2641920
    buffer_load_dwordx4 v2, s[4:7], s17 offen lds
    s_add_u32 m0, s19, 45056
    s_add_u32 s17, s20, 2906112
    buffer_load_dwordx4 v2, s[4:7], s17 offen lds
    s_add_u32 m0, s19, 49152
    s_add_u32 s17, s20, 3170304
    buffer_load_dwordx4 v2, s[4:7], s17 offen lds
    s_add_u32 m0, s19, 53248
    s_add_u32 s17, s20, 3434496
    buffer_load_dwordx4 v2, s[4:7], s17 offen lds
    s_add_u32 m0, s19, 57344
    s_add_u32 s17, s20, 3698688
    buffer_load_dwordx4 v2, s[4:7], s17 offen lds
    s_add_u32 m0, s19, 61440
    s_add_u32 s17, s20, 3962880
    buffer_load_dwordx4 v2, s[4:7], s17 offen lds
    s_add_u32 s20, s20, s24
    s_add_u32 m0, s19, 65536
    s_add_u32 s17, s20, 0
    buffer_load_dwordx4 v2, s[4:7], s17 offen lds
    s_add_u32 m0, s19, 69632
    s_add_u32 s17, s20, 264192
    buffer_load_dwordx4 v2, s[4:7], s17 offen lds
    s_add_u32 m0, s19, 73728
    s_add_u32 s17, s20, 528384
    buffer_load_dwordx4 v2, s[4:7], s17 offen lds
    s_waitcnt vmcnt(11)
    s_barrier
    ds_read_b128 v[20:23], v10 offset:0
    ds_read_b128 v[24:27], v10 offset:256
    ds_read_b128 v[28:31], v11 offset:0
    ds_read_b128 v[32:35], v11 offset:256
    ds_read_b128 v[36:39], v10 offset:4096
    ds_read_b128 v[40:43], v10 offset:4352
    ds_read_b128 v[44:47], v11 offset:4096
.p2align 6
F3_top:
    s_waitcnt lgkmcnt(6)
    v_mfma_f32_16x16x32_bf16 v[52:55], a[0:3], v[20:23], 0
    ds_read_b128 v[48:51], v11 offset:4352
    v_mfma_f32_16x16x32_bf16 v[56:59], a[4:7], v[20:23], 0
    s_waitcnt lgkmcnt(6)
    v_mfma_f32_16x16x32_bf16 v[60:63], a[0:3], v[24:27], 0
    ds_read_b128 v[20:23], v10 offset:8192
    s_add_u32 m0, s19, 77824
    v_mfma_f32_16x16x32_bf16 v[64:67], a[4:7], v[24:27], 0
    s_add_u32 s17, s20, 792576
    buffer_load_dwordx4 v2, s[4:7], s17 offen lds
    s_waitcnt lgkmcnt(6)
    v_mfma_f32_16x16x32_bf16 v[52:55], a[8:11], v[28:31], v[52:55]
    ds_read_b128 v[24:27], v10 offset:8448
    v_mfma_f32_16x16x32_bf16 v[56:59], a[12:15], v[28:31], v[56:59]
    s_waitcnt lgkmcnt(6)
    v_mfma_f32_16x16x32_bf16 v[60:63], a[8:11], v[32:35], v[60:63]
    ds_read_b128 v[28:31], v11 offset:8192
    s_add_u32 m0, s19, 81920
    v_mfma_f32_16x16x32_bf16 v[64:67], a[12:15], v[32:35], v[64:67]
    s_add_u32 s17, s20, 1056768
    buffer_load_dwordx4 v2, s[4:7], s17 offen lds
    s_waitcnt lgkmcnt(6)
    v_mfma_f32_16x16x32_bf16 v[52:55], a[16:19], v[36:39], v[52:55]
    ds_read_b128 v[32:35], v11 offset:8448
    v_mfma_f32_16x16x32_bf16 v[56:59], a[20:23], v[36:39], v[56:59]
    s_waitcnt lgkmcnt(6)
    v_mfma_f32_16x16x32_bf16 v[60:63], a[16:19], v[40:43], v[60:63]
    ds_read_b128 v[36:39], v10 offset:12288
    s_add_u32 m0, s19, 86016
    v_mfma_f32_16x16x32_bf16 v[64:67], a[20:23], v[40:43], v[64:67]
    s_add_u32 s17, s20, 1320960
    buffer_load_dwordx4 v2, s[4:7], s17 offen lds
    s_waitcnt lgkmcnt(6)
    v_mfma_f32_16x16x32_bf16 v[52:55], a[24:27], v[44:47], v[52:55]
    ds_read_b128 v[40:43], v10 offset:12544
    v_mfma_f32_16x16x32_bf16 v[56:59], a[28:31], v[44:47], v[56:59]
    s_waitcnt lgkmcnt(6)
    v_mfma_f32_16x16x32_bf16 v[60:63], a[24:27], v[48:51], v[60:63]
    ds_read_b128 v[44:47], v11 offset:12288
    s_add_u32 m0, s19, 90112
    v_mfma_f32_16x16x32_bf16 v[64:67], a[28:31], v[48:51], v[64:67]
    s_add_u32 s17, s20, 1585152
    buffer_load_dwordx4 v2, s[4:7], s17 offen lds
    s_waitcnt lgkmcnt(6)
    v_mfma_f32_16x16x32_bf16 v[52:55], a[32:35], v[20:23], v[52:55]
    ds_read_b128 v[48:51], v11 offset:12544
    v_mfma_f32_16x16x32_bf16 v[56:59], a[36:39], v[20:23], v[56:59]
    s_waitcnt lgkmcnt(6)
    v_mfma_f32_16x16x32_bf16 v[60:63], a[32:35], v[24:27], v[60:63]
    ds_read_b128 v[20:23], v10 offset:16384
    s_add_u32 m0, s19, 94208
    v_mfma_f32_16x16x32_bf16 v[64:67], a[36:39], v[24:27], v[64:67]
    s_add_u32 s17, s20, 1849344
    buffer_load_dwordx4 v2, s[4:7], s17 offen lds
    s_waitcnt lgkmcnt(6)
    v_mfma_f32_16x16x32_bf16 v[52:55], a[40:43], v[28:31], v[52:55]
    ds_read_b128 v[24:27], v10 offset:16640
    v_mfma_f32_16x16x32_bf16 v[56:59], a[44:47], v[28:31], v[56:59]
    v_cvt_pk_bf16_f32 v84, v68, v69
    s_waitcnt lgkmcnt(6)
    v_mfma_f32_16x16x32_bf16 v[60:63], a[40:43], v[32:35], v[60:63]
    ds_read_b128 v[28:31], v11 offset:16384
    v_mfma_f32_16x16x32_bf16 v[64:67], a[44:47], v[32:35], v[64:67]
    v_cvt_pk_bf16_f32 v85, v70, v71
    s_waitcnt lgkmcnt(6)
    v_mfma_f32_16x16x32_bf16 v[52:55], a[48:51], v[36:39], v[52:55]
    ds_read_b128 v[32:35], v11 offset:16640
    v_mfma_f32_16x16x32_bf16 v[56:59], a[52:55], v[36:39], v[56:59]
    v_cvt_pk_bf16_f32 v86, v72, v73
    s_waitcnt lgkmcnt(6)
    v_mfma_f32_16x16x32_bf16 v[60:63], a[48:51], v[40:43], v[60:63]
    ds_read_b128 v[36:39], v10 offset:20480
    v_mfma_f32_16x16x32_bf16 v[64:67], a[52:55], v[40:43], v[64:67]
    v_cvt_pk_bf16_f32 v87, v74, v75
    s_waitcnt lgkmcnt(6)
    v_mfma_f32_16x16x32_bf16 v[52:55], a[56:59], v[44:47], v[52:55]
    ds_read_b128 v[40:43], v10 offset:20736
    v_mfma_f32_16x16x32_bf16 v[56:59], a[60:63], v[44:47], v[56:59]
    v_cvt_pk_bf16_f32 v88, v76, v77
    s_waitcnt lgkmcnt(6)
    v_mfma_f32_16x16x32_bf16 v[60:63], a[56:59], v[48:51], v[60:63]
    ds_read_b128 v[44:47], v11 offset:20480
    v_mfma_f32_16x16x32_bf16 v[64:67], a[60:63], v[48:51], v[64:67]
    v_cvt_pk_bf16_f32 v89, v78, v79
    buffer_store_dwordx4 v[84:87], v3, s[12:15], s21 offen
    s_waitcnt lgkmcnt(6)
    v_mfma_f32_16x16x32_bf16 v[52:55], a[64:67], v[20:23], v[52:55]
    ds_read_b128 v[48:51], v11 offset:20736
    v_mfma_f32_16x16x32_bf16 v[56:59], a[68:71], v[20:23], v[56:59]
    v_cvt_pk_bf16_f32 v90, v80, v81
    s_waitcnt lgkmcnt(6)
    v_mfma_f32_16x16x32_bf16 v[60:63], a[64:67], v[24:27], v[60:63]
    ds_read_b128 v[20:23], v10 offset:24576
    v_mfma_f32_16x16x32_bf16 v[64:67], a[68:71], v[24:27], v[64:67]
    v_cvt_pk_bf16_f32 v91, v82, v83
    s_waitcnt lgkmcnt(6)
    v_mfma_f32_16x16x32_bf16 v[52:55], a[72:75], v[28:31], v[52:55]
    ds_read_b128 v[24:27], v10 offset:24832
    v_mfma_f32_16x16x32_bf16 v[56:59], a[76:79], v[28:31], v[56:59]
    s_waitcnt lgkmcnt(6)
    v_mfma_f32_16x16x32_bf16 v[60:63], a[72:75], v[32:35], v[60:63]
    ds_read_b128 v[28:31], v11 offset:24576
    v_mfma_f32_16x16x32_bf16 v[64:67], a[76:79], v[32:35], v[64:67]
    buffer_store_dwordx4 v[88:91], v4, s[12:15], s21 offen
    s_waitcnt lgkmcnt(6)
    v_mfma_f32_16x16x32_bf16 v[52:55], a[80:83], v[36:39], v[52:55]
    ds_read_b128 v[32:35], v11 offset:24832
    v_mfma_f32_16x16x32_bf16 v[56:59], a[84:87], v[36:39], v[56:59]
    s_add_u32 s21, s21, s25
    s_mov_b32 s25, s26
    s_waitcnt lgkmcnt(6)
    v_mfma_f32_16x16x32_bf16 v[60:63], a[80:83], v[40:43], v[60:63]
    ds_read_b128 v[36:39], v10 offset:28672
    v_mfma_f32_16x16x32_bf16 v[64:67], a[84:87], v[40:43], v[64:67]
    s_waitcnt lgkmcnt(6)
    v_mfma_f32_16x16x32_bf16 v[52:55], a[88:91], v[44:47], v[52:55]
    ds_read_b128 v[40:43], v10 offset:28928
    v_mfma_f32_16x16x32_bf16 v[56:59], a[92:95], v[44:47], v[56:59]
    s_waitcnt lgkmcnt(6)
    v_mfma_f32_16x16x32_bf16 v[60:63], a[88:91], v[48:51], v[60:63]
    ds_read_b128 v[44:47], v11 offset:28672
    v_mfma_f32_16x16x32_bf16 v[64:67], a[92:95], v[48:51], v[64:67]
    s_waitcnt lgkmcnt(6)
    v_mfma_f32_16x16x32_bf16 v[52:55], a[96:99], v[20:23], v[52:55]
    ds_read_b128 v[48:51], v11 offset:28928
    v_mfma_f32_16x16x32_bf16 v[56:59], a[100:103], v[20:23], v[56:59]
    s_waitcnt lgkmcnt(6)
    v_mfma_f32_16x16x32_bf16 v[60:63], a[96:99], v[24:27], v[60:63]
    s_waitcnt vmcnt(10)
    s_barrier
    ds_read_b128 v[20:23], v10 offset:32768
    v_mfma_f32_16x16x32_bf16 v[64:67], a[100:103], v[24:27], v[64:67]
    s_waitcnt lgkmcnt(6)
    v_mfma_f32_16x16x32_bf16 v[52:55], a[104:107], v[28:31], v[52:55]
    ds_read_b128 v[24:27], v10 offset:33024
    s_add_u32 m0, s19, 98304
    v_mfma_f32_16x16x32_bf16 v[56:59], a[108:111], v[28:31], v[56:59]
    s_add_u32 s17, s20, 2113536
    buffer_load_dwordx4 v2, s[4:7], s17 offen lds
    s_waitcnt lgkmcnt(6)
    v_mfma_f32_16x16x32_bf16 v[60:63], a[104:107], v[32:35], v[60:63]
    ds_read_b128 v[28:31], v11 offset:32768
    v_mfma_f32_16x16x32_bf16 v[64:67], a[108:111], v[32:35], v[64:67]
    s_waitcnt lgkmcnt(6)
    v_mfma_f32_16x16x32_bf16 v[52:55], a[112:115], v[36:39], v[52:55]
    ds_read_b128 v[32:35], v11 offset:33024
    s_add_u32 m0, s19, 102400
    v_mfma_f32_16x16x32_bf16 v[56:59], a[116:119], v[36:39], v[56:59]
    s_add_u32 s17, s20, 2377728
    buffer_load_dwordx4 v2, s[4:7], s17 offen lds
    s_waitcnt lgkmcnt(6)
    v_mfma_f32_16x16x32_bf16 v[60:63], a[112:115], v[40:43], v[60:63]
    ds_read_b128 v[36:39], v10 offset:36864
    v_mfma_f32_16x16x32_bf16 v[64:67], a[116:119], v[40:43], v[64:67]
    s_waitcnt lgkmcnt(6)
    v_mfma_f32_16x16x32_bf16 v[52:55], a[120:123], v[44:47], v[52:55]
    ds_read_b128 v[40:43], v10 offset:37120
    s_add_u32 m0, s19, 106496
    v_mfma_f32_16x16x32_bf16 v[56:59], a[124:127], v[44:47], v[56:59]
    s_add_u32 s17, s20, 2641920
    buffer_load_dwordx4 v2, s[4:7], s17 offen lds
    s_waitcnt lgkmcnt(6)
    v_mfma_f32_16x16x32_bf16 v[60:63], a[120:123], v[48:51], v[60:63]
    ds_read_b128 v[44:47], v11 offset:36864
    v_mfma_f32_16x16x32_bf16 v[64:67], a[124:127], v[48:51], v[64:67]
    s_waitcnt lgkmcnt(6)
    v_mfma_f32_16x16x32_bf16 v[52:55], a[128:131], v[20:23], v[52:55]
    ds_read_b128 v[48:51], v11 offset:37120
    v_mfma_f32_16x16x32_bf16 v[56:59], a[132:135], v[20:23], v[56:59]
    s_waitcnt lgkmcnt(6)
    v_mfma_f32_16x16x32_bf16 v[60:63], a[128:131], v[24:27], v[60:63]
    ds_read_b128 v[20:23], v10 offset:40960
    s_add_u32 m0, s19, 110592
    v_mfma_f32_16x16x32_bf16 v[64:67], a[132:135], v[24:27], v[64:67]
    s_add_u32 s17, s20, 2906112
    buffer_load_dwordx4 v2, s[4:7], s17 offen lds
    s_waitcnt lgkmcnt(6)
    v_mfma_f32_16x16x32_bf16 v[52:55], a[136:139], v[28:31], v[52:55]
    ds_read_b128 v[24:27], v10 offset:41216
    v_mfma_f32_16x16x32_bf16 v[56:59], a[140:143], v[28:31], v[56:59]
    s_waitcnt lgkmcnt(6)
    v_mfma_f32_16x16x32_bf16 v[60:63], a[136:139], v[32:35], v[60:63]
    ds_read_b128 v[28:31], v11 offset:40960
    s_add_u32 m0, s19, 114688
    v_mfma_f32_16x16x32_bf16 v[64:67], a[140:143], v[32:35], v[64:67]
    s_add_u32 s17, s20, 3170304
    buffer_load_dwordx4 v2, s[4:7], s17 offen lds
    s_waitcnt lgkmcnt(6)
    v_mfma_f32_16x16x32_bf16 v[52:55], a[144:147], v[36:39], v[52:55]
    ds_read_b128 v[32:35], v11 offset:41216
    v_mfma_f32_16x16x32_bf16 v[56:59], a[148:151], v[36:39], v[56:59]
    s_waitcnt lgkmcnt(6)
    v_mfma_f32_16x16x32_bf16 v[60:63], a[144:147], v[40:43], v[60:63]
    ds_read_b128 v[36:39], v10 offset:45056
    s_add_u32 m0, s19, 118784
    v_mfma_f32_16x16x32_bf16 v[64:67], a[148:151], v[40:43], v[64:67]
    s_add_u32 s17, s20, 3434496
    buffer_load_dwordx4 v2, s[4:7], s17 offen lds
    s_waitcnt lgkmcnt(6)
    v_mfma_f32_16x16x32_bf16 v[52:55], a[152:155], v[44:47], v[52:55]
    ds_read_b128 v[40:43], v10 offset:45312
    v_mfma_f32_16x16x32_bf16 v[56:59], a[156:159], v[44:47], v[56:59]
    s_waitcnt lgkmcnt(6)
    v_mfma_f32_16x16x32_bf16 v[60:63], a[152:155], v[48:51], v[60:63]
    ds_read_b128 v[44:47], v11 offset:45056
    s_add_u32 m0, s19, 122880
    v_mfma_f32_16x16x32_bf16 v[64:67], a[156:159], v[48:51], v[64:67]
    s_add_u32 s17, s20, 3698688
    buffer_load_dwordx4 v2, s[4:7], s17 offen lds
    s_waitcnt lgkmcnt(6)
    v_mfma_f32_16x16x32_bf16 v[52:55], a[160:163], v[20:23], v[52:55]
    ds_read_b128 v[48:51], v11 offset:45312
    v_mfma_f32_16x16x32_bf16 v[56:59], a[164:167], v[20:23], v[56:59]
    s_waitcnt lgkmcnt(6)
    v_mfma_f32_16x16x32_bf16 v[60:63], a[160:163], v[24:27], v[60:63]
    ds_read_b128 v[20:23], v10 offset:49152
    s_add_u32 m0, s19, 126976
    v_mfma_f32_16x16x32_bf16 v[64:67], a[164:167], v[24:27], v[64:67]
    s_add_u32 s17, s20, 3962880
    buffer_load_dwordx4 v2, s[4:7], s17 offen lds
    s_waitcnt lgkmcnt(6)
    v_mfma_f32_16x16x32_bf16 v[52:55], a[168:171], v[28:31], v[52:55]
    ds_read_b128 v[24:27], v10 offset:49408
    v_mfma_f32_16x16x32_bf16 v[56:59], a[172:175], v[28:31], v[56:59]
    s_add_u32 s20, s20, s24
    s_waitcnt lgkmcnt(6)
    v_mfma_f32_16x16x32_bf16 v[60:63], a[168:171], v[32:35], v[60:63]
    ds_read_b128 v[28:31], v11 offset:49152
    v_mfma_f32_16x16x32_bf16 v[64:67], a[172:175], v[32:35], v[64:67]
    s_waitcnt lgkmcnt(6)
    v_mfma_f32_16x16x32_bf16 v[52:55], a[176:179], v[36:39], v[52:55]
    ds_read_b128 v[32:35], v11 offset:49408
    v_mfma_f32_16x16x32_bf16 v[56:59], a[180:183], v[36:39], v[56:59]
    s_waitcnt lgkmcnt(6)
    v_mfma_f32_16x16x32_bf16 v[60:63], a[176:179], v[40:43], v[60:63]
    ds_read_b128 v[36:39], v10 offset:53248
    v_mfma_f32_16x16x32_bf16 v[64:67], a[180:183], v[40:43], v[64:67]
    s_waitcnt lgkmcnt(6)
    v_mfma_f32_16x16x32_bf16 v[52:55], a[184:187], v[44:47], v[52:55]
    ds_read_b128 v[40:43], v10 offset:53504
    v_mfma_f32_16x16x32_bf16 v[56:59], a[188:191], v[44:47], v[56:59]
    s_waitcnt lgkmcnt(6)
    v_mfma_f32_16x16x32_bf16 v[60:63], a[184:187], v[48:51], v[60:63]
    ds_read_b128 v[44:47], v11 offset:53248
    v_mfma_f32_16x16x32_bf16 v[64:67], a[188:191], v[48:51], v[64:67]
    s_waitcnt lgkmcnt(6)
    v_mfma_f32_16x16x32_bf16 v[52:55], a[192:195], v[20:23], v[52:55]
    ds_read_b128 v[48:51], v11 offset:53504
    v_mfma_f32_16x16x32_bf16 v[56:59], a[196:199], v[20:23], v[56:59]
    s_waitcnt lgkmcnt(6)
    v_mfma_f32_16x16x32_bf16 v[60:63], a[192:195], v[24:27], v[60:63]
    ds_read_b128 v[20:23], v10 offset:57344
    v_mfma_f32_16x16x32_bf16 v[64:67], a[196:199], v[24:27], v[64:67]
    s_waitcnt lgkmcnt(6)
    v_mfma_f32_16x16x32_bf16 v[52:55], a[200:203], v[28:31], v[52:55]
    ds_read_b128 v[24:27], v10 offset:57600
    v_mfma_f32_16x16x32_bf16 v[56:59], a[204:207], v[28:31], v[56:59]
    s_waitcnt lgkmcnt(6)
    v_mfma_f32_16x16x32_bf16 v[60:63], a[200:203], v[32:35], v[60:63]
    ds_read_b128 v[28:31], v11 offset:57344
    v_mfma_f32_16x16x32_bf16 v[64:67], a[204:207], v[32:35], v[64:67]
    s_waitcnt lgkmcnt(6)
    v_mfma_f32_16x16x32_bf16 v[52:55], a[208:211], v[36:39], v[52:55]
    ds_read_b128 v[32:35], v11 offset:57600
    v_mfma_f32_16x16x32_bf16 v[56:59], a[212:215], v[36:39], v[56:59]
    s_waitcnt lgkmcnt(6)
    v_mfma_f32_16x16x32_bf16 v[60:63], a[208:211], v[40:43], v[60:63]
    ds_read_b128 v[36:39], v10 offset:61440
    v_mfma_f32_16x16x32_bf16 v[64:67], a[212:215], v[40:43], v[64:67]
    s_waitcnt lgkmcnt(6)
    v_mfma_f32_16x16x32_bf16 v[52:55], a[216:219], v[44:47], v[52:55]
    ds_read_b128 v[40:43], v10 offset:61696
    v_mfma_f32_16x16x32_bf16 v[56:59], a[220:223], v[44:47], v[56:59]
    s_waitcnt lgkmcnt(6)
    v_mfma_f32_16x16x32_bf16 v[60:63], a[216:219], v[48:51], v[60:63]
    ds_read_b128 v[44:47], v11 offset:61440
    v_mfma_f32_16x16x32_bf16 v[64:67], a[220:223], v[48:51], v[64:67]
    s_waitcnt lgkmcnt(6)
    v_mfma_f32_16x16x32_bf16 v[52:55], a[224:227], v[20:23], v[52:55]
    ds_read_b128 v[48:51], v11 offset:61696
    v_mfma_f32_16x16x32_bf16 v[56:59], a[228:231], v[20:23], v[56:59]
    s_waitcnt lgkmcnt(6)
    v_mfma_f32_16x16x32_bf16 v[60:63], a[224:227], v[24:27], v[60:63]
    s_waitcnt vmcnt(8)
    s_barrier
    ds_read_b128 v[20:23], v12 offset:0
    v_mfma_f32_16x16x32_bf16 v[64:67], a[228:231], v[24:27], v[64:67]
    s_waitcnt lgkmcnt(6)
    v_mfma_f32_16x16x32_bf16 v[52:55], a[232:235], v[28:31], v[52:55]
    ds_read_b128 v[24:27], v12 offset:256
    s_add_u32 m0, s19, 0
    v_mfma_f32_16x16x32_bf16 v[56:59], a[236:239], v[28:31], v[56:59]
    s_add_u32 s17, s20, 0
    buffer_load_dwordx4 v2, s[4:7], s17 offen lds
    s_waitcnt lgkmcnt(6)
    v_mfma_f32_16x16x32_bf16 v[60:63], a[232:235], v[32:35], v[60:63]
    ds_read_b128 v[28:31], v13 offset:0
    v_mfma_f32_16x16x32_bf16 v[64:67], a[236:239], v[32:35], v[64:67]
    s_waitcnt lgkmcnt(6)
    v_mfma_f32_16x16x32_bf16 v[52:55], a[240:243], v[36:39], v[52:55]
    ds_read_b128 v[32:35], v13 offset:256
    s_add_u32 m0, s19, 4096
    v_mfma_f32_16x16x32_bf16 v[56:59], a[244:247], v[36:39], v[56:59]
    s_add_u32 s17, s20, 264192
    buffer_load_dwordx4 v2, s[4:7], s17 offen lds
    s_waitcnt lgkmcnt(6)
    v_mfma_f32_16x16x32_bf16 v[60:63], a[240:243], v[40:43], v[60:63]
    ds_read_b128 v[36:39], v12 offset:4096
    v_mfma_f32_16x16x32_bf16 v[64:67], a[244:247], v[40:43], v[64:67]
    s_waitcnt lgkmcnt(6)
    v_mfma_f32_16x16x32_bf16 v[52:55], a[248:251], v[44:47], v[52:55]
    ds_read_b128 v[40:43], v12 offset:4352
    s_add_u32 m0, s19, 8192
    v_mfma_f32_16x16x32_bf16 v[56:59], a[252:255], v[44:47], v[56:59]
    s_add_u32 s17, s20, 528384
    buffer_load_dwordx4 v2, s[4:7], s17 offen lds
    s_waitcnt lgkmcnt(6)
    v_mfma_f32_16x16x32_bf16 v[60:63], a[248:251], v[48:51], v[60:63]
    ds_read_b128 v[44:47], v13 offset:4096
    v_mfma_f32_16x16x32_bf16 v[64:67], a[252:255], v[48:51], v[64:67]
    s_waitcnt lgkmcnt(6)
    v_mfma_f32_16x16x32_bf16 v[68:71], a[0:3], v[20:23], 0
    ds_read_b128 v[48:51], v13 offset:4352
    v_mfma_f32_16x16x32_bf16 v[72:75], a[4:7], v[20:23], 0
    s_waitcnt lgkmcnt(6)
    v_mfma_f32_16x16x32_bf16 v[76:79], a[0:3], v[24:27], 0
    ds_read_b128 v[20:23], v12 offset:8192
    s_add_u32 m0, s19, 12288
    v_mfma_f32_16x16x32_bf16 v[80:83], a[4:7], v[24:27], 0
    s_add_u32 s17, s20, 792576
    buffer_load_dwordx4 v2, s[4:7], s17 offen lds
    s_waitcnt lgkmcnt(6)
    v_mfma_f32_16x16x32_bf16 v[68:71], a[8:11], v[28:31], v[68:71]
    ds_read_b128 v[24:27], v12 offset:8448
    v_mfma_f32_16x16x32_bf16 v[72:75], a[12:15], v[28:31], v[72:75]
    s_waitcnt lgkmcnt(6)
    v_mfma_f32_16x16x32_bf16 v[76:79], a[8:11], v[32:35], v[76:79]
    ds_read_b128 v[28:31], v13 offset:8192
    s_add_u32 m0, s19, 16384
    v_mfma_f32_16x16x32_bf16 v[80:83], a[12:15], v[32:35], v[80:83]
    s_add_u32 s17, s20, 1056768
    buffer_load_dwordx4 v2, s[4:7], s17 offen lds
    s_waitcnt lgkmcnt(6)
    v_mfma_f32_16x16x32_bf16 v[68:71], a[16:19], v[36:39], v[68:71]
    ds_read_b128 v[32:35], v13 offset:8448
    v_mfma_f32_16x16x32_bf16 v[72:75], a[20:23], v[36:39], v[72:75]
    s_waitcnt lgkmcnt(6)
    v_mfma_f32_16x16x32_bf16 v[76:79], a[16:19], v[40:43], v[76:79]
    ds_read_b128 v[36:39], v12 offset:12288
    s_add_u32 m0, s19, 20480
    v_mfma_f32_16x16x32_bf16 v[80:83], a[20:23], v[40:43], v[80:83]
    s_add_u32 s17, s20, 1320960
    buffer_load_dwordx4 v2, s[4:7], s17 offen lds
    s_waitcnt lgkmcnt(6)
    v_mfma_f32_16x16x32_bf16 v[68:71], a[24:27], v[44:47], v[68:71]
    ds_read_b128 v[40:43], v12 offset:12544
    v_mfma_f32_16x16x32_bf16 v[72:75], a[28:31], v[44:47], v[72:75]
    s_waitcnt lgkmcnt(6)
    v_mfma_f32_16x16x32_bf16 v[76:79], a[24:27], v[48:51], v[76:79]
    ds_read_b128 v[44:47], v13 offset:12288
    s_add_u32 m0, s19, 24576
    v_mfma_f32_16x16x32_bf16 v[80:83], a[28:31], v[48:51], v[80:83]
    s_add_u32 s17, s20, 1585152
    buffer_load_dwordx4 v2, s[4:7], s17 offen lds
    s_waitcnt lgkmcnt(6)
    v_mfma_f32_16x16x32_bf16 v[68:71], a[32:35], v[20:23], v[68:71]
    ds_read_b128 v[48:51], v13 offset:12544
    v_mfma_f32_16x16x32_bf16 v[72:75], a[36:39], v[20:23], v[72:75]
    s_waitcnt lgkmcnt(6)
    v_mfma_f32_16x16x32_bf16 v[76:79], a[32:35], v[24:27], v[76:79]
    ds_read_b128 v[20:23], v12 offset:16384
    s_add_u32 m0, s19, 28672
    v_mfma_f32_16x16x32_bf16 v[80:83], a[36:39], v[24:27], v[80:83]
    s_add_u32 s17, s20, 1849344
    buffer_load_dwordx4 v2, s[4:7], s17 offen lds
    s_waitcnt lgkmcnt(6)
    v_mfma_f32_16x16x32_bf16 v[68:71], a[40:43], v[28:31], v[68:71]
    ds_read_b128 v[24:27], v12 offset:16640
    v_mfma_f32_16x16x32_bf16 v[72:75], a[44:47], v[28:31], v[72:75]
    v_cvt_pk_bf16_f32 v84, v52, v53
    s_waitcnt lgkmcnt(6)
    v_mfma_f32_16x16x32_bf16 v[76:79], a[40:43], v[32:35], v[76:79]
    ds_read_b128 v[28:31], v13 offset:16384
    v_mfma_f32_16x16x32_bf16 v[80:83], a[44:47], v[32:35], v[80:83]
    v_cvt_pk_bf16_f32 v85, v54, v55
    s_waitcnt lgkmcnt(6)
    v_mfma_f32_16x16x32_bf16 v[68:71], a[48:51], v[36:39], v[68:71]
    ds_read_b128 v[32:35], v13 offset:16640
    v_mfma_f32_16x16x32_bf16 v[72:75], a[52:55], v[36:39], v[72:75]
    v_cvt_pk_bf16_f32 v86, v56, v57
    s_waitcnt lgkmcnt(6)
    v_mfma_f32_16x16x32_bf16 v[76:79], a[48:51], v[40:43], v[76:79]
    ds_read_b128 v[36:39], v12 offset:20480
    v_mfma_f32_16x16x32_bf16 v[80:83], a[52:55], v[40:43], v[80:83]
    v_cvt_pk_bf16_f32 v87, v58, v59
    s_waitcnt lgkmcnt(6)
    v_mfma_f32_16x16x32_bf16 v[68:71], a[56:59], v[44:47], v[68:71]
    ds_read_b128 v[40:43], v12 offset:20736
    v_mfma_f32_16x16x32_bf16 v[72:75], a[60:63], v[44:47], v[72:75]
    v_cvt_pk_bf16_f32 v88, v60, v61
    s_waitcnt lgkmcnt(6)
    v_mfma_f32_16x16x32_bf16 v[76:79], a[56:59], v[48:51], v[76:79]
    ds_read_b128 v[44:47], v13 offset:20480
    v_mfma_f32_16x16x32_bf16 v[80:83], a[60:63], v[48:51], v[80:83]
    v_cvt_pk_bf16_f32 v89, v62, v63
    buffer_store_dwordx4 v[84:87], v3, s[12:15], s21 offen
    s_waitcnt lgkmcnt(6)
    v_mfma_f32_16x16x32_bf16 v[68:71], a[64:67], v[20:23], v[68:71]
    ds_read_b128 v[48:51], v13 offset:20736
    v_mfma_f32_16x16x32_bf16 v[72:75], a[68:71], v[20:23], v[72:75]
    v_cvt_pk_bf16_f32 v90, v64, v65
    s_waitcnt lgkmcnt(6)
    v_mfma_f32_16x16x32_bf16 v[76:79], a[64:67], v[24:27], v[76:79]
    ds_read_b128 v[20:23], v12 offset:24576
    v_mfma_f32_16x16x32_bf16 v[80:83], a[68:71], v[24:27], v[80:83]
    v_cvt_pk_bf16_f32 v91, v66, v67
    s_waitcnt lgkmcnt(6)
    v_mfma_f32_16x16x32_bf16 v[68:71], a[72:75], v[28:31], v[68:71]
    ds_read_b128 v[24:27], v12 offset:24832
    v_mfma_f32_16x16x32_bf16 v[72:75], a[76:79], v[28:31], v[72:75]
    s_waitcnt lgkmcnt(6)
    v_mfma_f32_16x16x32_bf16 v[76:79], a[72:75], v[32:35], v[76:79]
    ds_read_b128 v[28:31], v13 offset:24576
    v_mfma_f32_16x16x32_bf16 v[80:83], a[76:79], v[32:35], v[80:83]
    buffer_store_dwordx4 v[88:91], v4, s[12:15], s21 offen
    s_waitcnt lgkmcnt(6)
    v_mfma_f32_16x16x32_bf16 v[68:71], a[80:83], v[36:39], v[68:71]
    ds_read_b128 v[32:35], v13 offset:24832
    v_mfma_f32_16x16x32_bf16 v[72:75], a[84:87], v[36:39], v[72:75]
    s_add_u32 s21, s21, s25
    s_mov_b32 s25, s26
    s_waitcnt lgkmcnt(6)
    v_mfma_f32_16x16x32_bf16 v[76:79], a[80:83], v[40:43], v[76:79]
    ds_read_b128 v[36:39], v12 offset:28672
    v_mfma_f32_16x16x32_bf16 v[80:83], a[84:87], v[40:43], v[80:83]
    s_waitcnt lgkmcnt(6)
    v_mfma_f32_16x16x32_bf16 v[68:71], a[88:91], v[44:47], v[68:71]
    ds_read_b128 v[40:43], v12 offset:28928
    v_mfma_f32_16x16x32_bf16 v[72:75], a[92:95], v[44:47], v[72:75]
    s_waitcnt lgkmcnt(6)
    v_mfma_f32_16x16x32_bf16 v[76:79], a[88:91], v[48:51], v[76:79]
    ds_read_b128 v[44:47], v13 offset:28672
    v_mfma_f32_16x16x32_bf16 v[80:83], a[92:95], v[48:51], v[80:83]
    s_waitcnt lgkmcnt(6)
    v_mfma_f32_16x16x32_bf16 v[68:71], a[96:99], v[20:23], v[68:71]
    ds_read_b128 v[48:51], v13 offset:28928
    v_mfma_f32_16x16x32_bf16 v[72:75], a[100:103], v[20:23], v[72:75]
    s_waitcnt lgkmcnt(6)
    v_mfma_f32_16x16x32_bf16 v[76:79], a[96:99], v[24:27], v[76:79]
    s_waitcnt vmcnt(10)
    s_barrier
    ds_read_b128 v[20:23], v12 offset:32768
    v_mfma_f32_16x16x32_bf16 v[80:83], a[100:103], v[24:27], v[80:83]
    s_waitcnt lgkmcnt(6)
    v_mfma_f32_16x16x32_bf16 v[68:71], a[104:107], v[28:31], v[68:71]
    ds_read_b128 v[24:27], v12 offset:33024
    s_add_u32 m0, s19, 32768
    v_mfma_f32_16x16x32_bf16 v[72:75], a[108:111], v[28:31], v[72:75]
    s_add_u32 s17, s20, 2113536
    buffer_load_dwordx4 v2, s[4:7], s17 offen lds
    s_waitcnt lgkmcnt(6)
    v_mfma_f32_16x16x32_bf16 v[76:79], a[104:107], v[32:35], v[76:79]
    ds_read_b128 v[28:31], v13 offset:32768
    v_mfma_f32_16x16x32_bf16 v[80:83], a[108:111], v[32:35], v[80:83]
    s_waitcnt lgkmcnt(6)
    v_mfma_f32_16x16x32_bf16 v[68:71], a[112:115], v[36:39], v[68:71]
    ds_read_b128 v[32:35], v13 offset:33024
    s_add_u32 m0, s19, 36864
    v_mfma_f32_16x16x32_bf16 v[72:75], a[116:119], v[36:39], v[72:75]
    s_add_u32 s17, s20, 2377728
    buffer_load_dwordx4 v2, s[4:7], s17 offen lds
    s_waitcnt lgkmcnt(6)
    v_mfma_f32_16x16x32_bf16 v[76:79], a[112:115], v[40:43], v[76:79]
    ds_read_b128 v[36:39], v12 offset:36864
    v_mfma_f32_16x16x32_bf16 v[80:83], a[116:119], v[40:43], v[80:83]
    s_waitcnt lgkmcnt(6)
    v_mfma_f32_16x16x32_bf16 v[68:71], a[120:123], v[44:47], v[68:71]
    ds_read_b128 v[40:43], v12 offset:37120
    s_add_u32 m0, s19, 40960
    v_mfma_f32_16x16x32_bf16 v[72:75], a[124:127], v[44:47], v[72:75]
    s_add_u32 s17, s20, 2641920
    buffer_load_dwordx4 v2, s[4:7], s17 offen lds
    s_waitcnt lgkmcnt(6)
    v_mfma_f32_16x16x32_bf16 v[76:79], a[120:123], v[48:51], v[76:79]
    ds_read_b128 v[44:47], v13 offset:36864
    v_mfma_f32_16x16x32_bf16 v[80:83], a[124:127], v[48:51], v[80:83]
    s_waitcnt lgkmcnt(6)
    v_mfma_f32_16x16x32_bf16 v[68:71], a[128:131], v[20:23], v[68:71]
    ds_read_b128 v[48:51], v13 offset:37120
    v_mfma_f32_16x16x32_bf16 v[72:75], a[132:135], v[20:23], v[72:75]
    s_waitcnt lgkmcnt(6)
    v_mfma_f32_16x16x32_bf16 v[76:79], a[128:131], v[24:27], v[76:79]
    ds_read_b128 v[20:23], v12 offset:40960
    s_add_u32 m0, s19, 45056
    v_mfma_f32_16x16x32_bf16 v[80:83], a[132:135], v[24:27], v[80:83]
    s_add_u32 s17, s20, 2906112
    buffer_load_dwordx4 v2, s[4:7], s17 offen lds
    s_waitcnt lgkmcnt(6)
    v_mfma_f32_16x16x32_bf16 v[68:71], a[136:139], v[28:31], v[68:71]
    ds_read_b128 v[24:27], v12 offset:41216
    v_mfma_f32_16x16x32_bf16 v[72:75], a[140:143], v[28:31], v[72:75]
    s_waitcnt lgkmcnt(6)
    v_mfma_f32_16x16x32_bf16 v[76:79], a[136:139], v[32:35], v[76:79]
    ds_read_b128 v[28:31], v13 offset:40960
    s_add_u32 m0, s19, 49152
    v_mfma_f32_16x16x32_bf16 v[80:83], a[140:143], v[32:35], v[80:83]
    s_add_u32 s17, s20, 3170304
    buffer_load_dwordx4 v2, s[4:7], s17 offen lds
    s_waitcnt lgkmcnt(6)
    v_mfma_f32_16x16x32_bf16 v[68:71], a[144:147], v[36:39], v[68:71]
    ds_read_b128 v[32:35], v13 offset:41216
    v_mfma_f32_16x16x32_bf16 v[72:75], a[148:151], v[36:39], v[72:75]
    s_waitcnt lgkmcnt(6)
    v_mfma_f32_16x16x32_bf16 v[76:79], a[144:147], v[40:43], v[76:79]
    ds_read_b128 v[36:39], v12 offset:45056
    s_add_u32 m0, s19, 53248
    v_mfma_f32_16x16x32_bf16 v[80:83], a[148:151], v[40:43], v[80:83]
    s_add_u32 s17, s20, 3434496
    buffer_load_dwordx4 v2, s[4:7], s17 offen lds
    s_waitcnt lgkmcnt(6)
    v_mfma_f32_16x16x32_bf16 v[68:71], a[152:155], v[44:47], v[68:71]
    ds_read_b128 v[40:43], v12 offset:45312
    v_mfma_f32_16x16x32_bf16 v[72:75], a[156:159], v[44:47], v[72:75]
    s_waitcnt lgkmcnt(6)
    v_mfma_f32_16x16x32_bf16 v[76:79], a[152:155], v[48:51], v[76:79]
    ds_read_b128 v[44:47], v13 offset:45056
    s_add_u32 m0, s19, 57344
    v_mfma_f32_16x16x32_bf16 v[80:83], a[156:159], v[48:51], v[80:83]
    s_add_u32 s17, s20, 3698688
    buffer_load_dwordx4 v2, s[4:7], s17 offen lds
    s_waitcnt lgkmcnt(6)
    v_mfma_f32_16x16x32_bf16 v[68:71], a[160:163], v[20:23], v[68:71]
    ds_read_b128 v[48:51], v13 offset:45312
    v_mfma_f32_16x16x32_bf16 v[72:75], a[164:167], v[20:23], v[72:75]
    s_waitcnt lgkmcnt(6)
    v_mfma_f32_16x16x32_bf16 v[76:79], a[160:163], v[24:27], v[76:79]
    ds_read_b128 v[20:23], v12 offset:49152
    s_add_u32 m0, s19, 61440
    v_mfma_f32_16x16x32_bf16 v[80:83], a[164:167], v[24:27], v[80:83]
    s_add_u32 s17, s20, 3962880
    buffer_load_dwordx4 v2, s[4:7], s17 offen lds
    s_waitcnt lgkmcnt(6)
    v_mfma_f32_16x16x32_bf16 v[68:71], a[168:171], v[28:31], v[68:71]
    ds_read_b128 v[24:27], v12 offset:49408
    v_mfma_f32_16x16x32_bf16 v[72:75], a[172:175], v[28:31], v[72:75]
    s_add_u32 s20, s20, s24
    s_waitcnt lgkmcnt(6)
    v_mfma_f32_16x16x32_bf16 v[76:79], a[168:171], v[32:35], v[76:79]
    ds_read_b128 v[28:31], v13 offset:49152
    v_mfma_f32_16x16x32_bf16 v[80:83], a[172:175], v[32:35], v[80:83]
    s_waitcnt lgkmcnt(6)
    v_mfma_f32_16x16x32_bf16 v[68:71], a[176:179], v[36:39], v[68:71]
    ds_read_b128 v[32:35], v13 offset:49408
    v_mfma_f32_16x16x32_bf16 v[72:75], a[180:183], v[36:39], v[72:75]
    s_waitcnt lgkmcnt(6)
    v_mfma_f32_16x16x32_bf16 v[76:79], a[176:179], v[40:43], v[76:79]
    ds_read_b128 v[36:39], v12 offset:53248
    v_mfma_f32_16x16x32_bf16 v[80:83], a[180:183], v[40:43], v[80:83]
    s_waitcnt lgkmcnt(6)
    v_mfma_f32_16x16x32_bf16 v[68:71], a[184:187], v[44:47], v[68:71]
    ds_read_b128 v[40:43], v12 offset:53504
    v_mfma_f32_16x16x32_bf16 v[72:75], a[188:191], v[44:47], v[72:75]
    s_waitcnt lgkmcnt(6)
    v_mfma_f32_16x16x32_bf16 v[76:79], a[184:187], v[48:51], v[76:79]
    ds_read_b128 v[44:47], v13 offset:53248
    v_mfma_f32_16x16x32_bf16 v[80:83], a[188:191], v[48:51], v[80:83]
    s_waitcnt lgkmcnt(6)
    v_mfma_f32_16x16x32_bf16 v[68:71], a[192:195], v[20:23], v[68:71]
    ds_read_b128 v[48:51], v13 offset:53504
    v_mfma_f32_16x16x32_bf16 v[72:75], a[196:199], v[20:23], v[72:75]
    s_waitcnt lgkmcnt(6)
    v_mfma_f32_16x16x32_bf16 v[76:79], a[192:195], v[24:27], v[76:79]
    ds_read_b128 v[20:23], v12 offset:57344
    v_mfma_f32_16x16x32_bf16 v[80:83], a[196:199], v[24:27], v[80:83]
    s_waitcnt lgkmcnt(6)
    v_mfma_f32_16x16x32_bf16 v[68:71], a[200:203], v[28:31], v[68:71]
    ds_read_b128 v[24:27], v12 offset:57600
    v_mfma_f32_16x16x32_bf16 v[72:75], a[204:207], v[28:31], v[72:75]
    s_waitcnt lgkmcnt(6)
    v_mfma_f32_16x16x32_bf16 v[76:79], a[200:203], v[32:35], v[76:79]
    ds_read_b128 v[28:31], v13 offset:57344
    v_mfma_f32_16x16x32_bf16 v[80:83], a[204:207], v[32:35], v[80:83]
    s_waitcnt lgkmcnt(6)
    v_mfma_f32_16x16x32_bf16 v[68:71], a[208:211], v[36:39], v[68:71]
    ds_read_b128 v[32:35], v13 offset:57600
    v_mfma_f32_16x16x32_bf16 v[72:75], a[212:215], v[36:39], v[72:75]
    s_waitcnt lgkmcnt(6)
    v_mfma_f32_16x16x32_bf16 v[76:79], a[208:211], v[40:43], v[76:79]
    ds_read_b128 v[36:39], v12 offset:61440
    v_mfma_f32_16x16x32_bf16 v[80:83], a[212:215], v[40:43], v[80:83]
    s_waitcnt lgkmcnt(6)
    v_mfma_f32_16x16x32_bf16 v[68:71], a[216:219], v[44:47], v[68:71]
    ds_read_b128 v[40:43], v12 offset:61696
    v_mfma_f32_16x16x32_bf16 v[72:75], a[220:223], v[44:47], v[72:75]
    s_waitcnt lgkmcnt(6)
    v_mfma_f32_16x16x32_bf16 v[76:79], a[216:219], v[48:51], v[76:79]
    ds_read_b128 v[44:47], v13 offset:61440
    v_mfma_f32_16x16x32_bf16 v[80:83], a[220:223], v[48:51], v[80:83]
    s_waitcnt lgkmcnt(6)
    v_mfma_f32_16x16x32_bf16 v[68:71], a[224:227], v[20:23], v[68:71]
    ds_read_b128 v[48:51], v13 offset:61696
    v_mfma_f32_16x16x32_bf16 v[72:75], a[228:231], v[20:23], v[72:75]
    s_waitcnt lgkmcnt(6)
    v_mfma_f32_16x16x32_bf16 v[76:79], a[224:227], v[24:27], v[76:79]
    s_waitcnt vmcnt(8)
    s_barrier
    ds_read_b128 v[20:23], v10 offset:0
    v_mfma_f32_16x16x32_bf16 v[80:83], a[228:231], v[24:27], v[80:83]
    s_waitcnt lgkmcnt(6)
    v_mfma_f32_16x16x32_bf16 v[68:71], a[232:235], v[28:31], v[68:71]
    ds_read_b128 v[24:27], v10 offset:256
    s_add_u32 m0, s19, 65536
    v_mfma_f32_16x16x32_bf16 v[72:75], a[236:239], v[28:31], v[72:75]
    s_add_u32 s17, s20, 0
    buffer_load_dwordx4 v2, s[4:7], s17 offen lds
    s_waitcnt lgkmcnt(6)
    v_mfma_f32_16x16x32_bf16 v[76:79], a[232:235], v[32:35], v[76:79]
    ds_read_b128 v[28:31], v11 offset:0
    v_mfma_f32_16x16x32_bf16 v[80:83], a[236:239], v[32:35], v[80:83]
    s_waitcnt lgkmcnt(6)
    v_mfma_f32_16x16x32_bf16 v[68:71], a[240:243], v[36:39], v[68:71]
    ds_read_b128 v[32:35], v11 offset:256
    s_add_u32 m0, s19, 69632
    v_mfma_f32_16x16x32_bf16 v[72:75], a[244:247], v[36:39], v[72:75]
    s_add_u32 s17, s20, 264192
    buffer_load_dwordx4 v2, s[4:7], s17 offen lds
    s_waitcnt lgkmcnt(6)
    v_mfma_f32_16x16x32_bf16 v[76:79], a[240:243], v[40:43], v[76:79]
    ds_read_b128 v[36:39], v10 offset:4096
    v_mfma_f32_16x16x32_bf16 v[80:83], a[244:247], v[40:43], v[80:83]
    s_waitcnt lgkmcnt(6)
    v_mfma_f32_16x16x32_bf16 v[68:71], a[248:251], v[44:47], v[68:71]
    ds_read_b128 v[40:43], v10 offset:4352
    s_add_u32 m0, s19, 73728
    v_mfma_f32_16x16x32_bf16 v[72:75], a[252:255], v[44:47], v[72:75]
    s_add_u32 s17, s20, 528384
    buffer_load_dwordx4 v2, s[4:7], s17 offen lds
    s_waitcnt lgkmcnt(6)
    v_mfma_f32_16x16x32_bf16 v[76:79], a[248:251], v[48:51], v[76:79]
    ds_read_b128 v[44:47], v11 offset:4096
    v_mfma_f32_16x16x32_bf16 v[80:83], a[252:255], v[48:51], v[80:83]
    s_add_u32 s22, s22, 2
    s_cmp_lt_u32 s22, 16
    s_cbranch_scc1 F3_top
    v_cvt_pk_bf16_f32 v84, v68, v69
    v_cvt_pk_bf16_f32 v85, v70, v71
    v_cvt_pk_bf16_f32 v86, v72, v73
    v_cvt_pk_bf16_f32 v87, v74, v75
    v_cvt_pk_bf16_f32 v88, v76, v77
    v_cvt_pk_bf16_f32 v89, v78, v79
    v_cvt_pk_bf16_f32 v90, v80, v81
    v_cvt_pk_bf16_f32 v91, v82, v83
    buffer_store_dwordx4 v[84:87], v3, s[12:15], s21 offen
    buffer_store_dwordx4 v[88:91], v4, s[12:15], s21 offen
    s_waitcnt vmcnt(0) lgkmcnt(0)
    s_branch W_T
W_T:
    v_and_b32 v7, 19, v1
    v_bfe_u32 v5, v1, 2, 1
    v_bfe_u32 v6, v1, 3, 1
    v_lshl_add_u32 v7, v5, 3, v7
    v_lshl_add_u32 v7, v6, 2, v7
    v_lshrrev_b32 v5, 5, v1
    v_and_b32 v6, 31, v1
    v_lshlrev_b32 v8, 4, v5
    v_lshl_add_u32 v10, v6, 6, v8
    v_lshl_add_u32 v11, v7, 6, v8
    v_mov_b32 v17, 1073741824
    v_cmp_gt_u32 vcc, 8, v6
    s_nop 1
    v_cndmask_b32 v12, v17, v10, vcc
    v_lshlrev_b32 v13, 3, v5
    v_lshl_add_u32 v13, v7, 4, v13
    v_and_b32 v14, 15, v1
    v_lshlrev_b32 v14, 4, v14
    v_lshl_add_u32 v14, v5, 8, v14
    v_bfe_u32 v8, v1, 4, 1
    v_lshl_add_u32 v14, v8, 17, v14
    v_lshrrev_b32 v15, 2, v1
    v_and_b32 v8, 3, v1
    v_lshl_add_u32 v15, v15, 7, v8
    s_lshl_b32 s17, s93, 2
    v_add_u32 v15, s17, v15
    v_lshlrev_b32 v15, 7, v15
    v_add_u32 v15, 100663296, v15
    v_cmp_gt_u32 vcc, 16, v1
    s_nop 1
    v_cndmask_b32 v15, v17, v15, vcc
    v_mov_b32 v16, 0
    s_add_u32 s18, s16, s17
    s_lshl_b32 s18, s18, 7
    s_add_u32 s18, s18, 100728832
    v_lshl_add_u32 v4, v1, 2, s18
    v_cmp_gt_u32 vcc, 32, v1
    s_nop 1
    v_cndmask_b32 v4, v17, v4, vcc
    v_lshlrev_b32 v5, 3, v5
    v_sub_u32 v6, v6, v5
    s_mov_b32 s29, 1040356334
    s_mov_b32 s28, s16
    s_mul_i32 s31, s17, 133120
    s_lshl_b32 s18, s28, 11
    s_add_u32 s31, s31, s18
    s_mul_i32 s32, s17, 33280
    s_lshl_b32 s18, s28, 9
    s_add_u32 s32, s32, s18
    s_add_u32 s32, s32, 71303168
    s_lshl_b32 s33, s28, 18
    s_lshl_b32 s18, s93, 12
    s_add_u32 s33, s33, s18
    s_add_u32 s33, s33, 54525952
    v_mov_b32 v17, 0xff800000
    s_mov_b32 s35, 0
    v_mov_b32 v9, 0
    v_cmp_le_i32 s[36:37], 0, v6
    v_cmp_le_i32 s[38:39], 1, v6
    v_cmp_le_i32 s[40:41], 2, v6
    v_cmp_le_i32 s[42:43], 3, v6
    v_cmp_le_i32 s[44:45], 4, v6
    v_cmp_le_i32 s[46:47], 5, v6
    v_cmp_le_i32 s[48:49], 6, v6
    v_cmp_le_i32 s[50:51], 7, v6
    v_cmp_le_i32 s[52:53], 16, v6
    v_cmp_le_i32 s[54:55], 17, v6
    v_cmp_le_i32 s[56:57], 18, v6
    v_cmp_le_i32 s[58:59], 19, v6
    v_cmp_le_i32 s[60:61], 20, v6
    v_cmp_le_i32 s[62:63], 21, v6
    v_cmp_le_i32 s[64:65], 22, v6
    v_cmp_le_i32 s[66:67], 23, v6
    v_mov_b32 v54, 0
    v_mov_b32 v55, 0
    v_mov_b32 v58, 0
    v_mov_b32 v59, 0
    v_mov_b32 v62, 0
    v_mov_b32 v63, 0
    v_mov_b32 v66, 0
    v_mov_b32 v67, 0
    v_mov_b32 v102, 0
    v_mov_b32 v103, 0
    v_mov_b32 v106, 0
    v_mov_b32 v107, 0
    v_mov_b32 v110, 0
    v_mov_b32 v111, 0
    v_mov_b32 v114, 0
    v_mov_b32 v115, 0
    v_mov_b32 v158, 0
    v_mov_b32 v159, 0
    s_mov_b32 s30, s92
T_p:
    v_cmp_ge_u32 vcc, s28, v16
    s_nop 0
    s_and_b32 s17, vcc_lo, 4095
    s_cbranch_scc0 T_pk
    s_cmp_ge_u32 s30, 1048576
    s_cselect_b32 s92, 1048576, s92
    s_cbranch_scc1 T_pk
    s_add_u32 s30, s30, 1
    buffer_load_dword v16, v15, s[4:7], 0 offen sc1
    s_sleep 8
    s_waitcnt vmcnt(0)
    s_branch T_p
T_pk:
    s_add_u32 s17, s31, 0
    buffer_load_dwordx4 a[0:3], v10, s[4:7], s17 offen offset:0
    buffer_load_dwordx4 a[4:7], v10, s[4:7], s17 offen offset:32
    s_add_u32 s17, s31, 133120
    buffer_load_dwordx4 a[8:11], v10, s[4:7], s17 offen offset:0
    buffer_load_dwordx4 a[12:15], v10, s[4:7], s17 offen offset:32
    s_add_u32 s17, s31, 266240
    buffer_load_dwordx4 a[16:19], v10, s[4:7], s17 offen offset:0
    buffer_load_dwordx4 a[20:23], v10, s[4:7], s17 offen offset:32
    s_add_u32 s17, s31, 399360
    buffer_load_dwordx4 a[24:27], v10, s[4:7], s17 offen offset:0
    buffer_load_dwordx4 a[28:31], v10, s[4:7], s17 offen offset:32
    s_add_u32 s17, s31, 17825792
    buffer_load_dwordx4 a[32:35], v11, s[4:7], s17 offen offset:0
    buffer_load_dwordx4 a[36:39], v11, s[4:7], s17 offen offset:32
    s_add_u32 s17, s31, 17958912
    buffer_load_dwordx4 a[40:43], v11, s[4:7], s17 offen offset:0
    buffer_load_dwordx4 a[44:47], v11, s[4:7], s17 offen offset:32
    s_add_u32 s17, s31, 18092032
    buffer_load_dwordx4 a[48:51], v11, s[4:7], s17 offen offset:0
    buffer_load_dwordx4 a[52:55], v11, s[4:7], s17 offen offset:32
    s_add_u32 s17, s31, 18225152
    buffer_load_dwordx4 a[56:59], v11, s[4:7], s17 offen offset:0
    buffer_load_dwordx4 a[60:63], v11, s[4:7], s17 offen offset:32
    s_add_u32 s17, s31, 35651584
    buffer_load_dwordx4 a[64:67], v11, s[4:7], s17 offen offset:0
    buffer_load_dwordx4 a[68:71], v11, s[4:7], s17 offen offset:32
    s_add_u32 s17, s31, 35784704
    buffer_load_dwordx4 a[72:75], v11, s[4:7], s17 offen offset:0
    buffer_load_dwordx4 a[76:79], v11, s[4:7], s17 offen offset:32
    s_add_u32 s17, s31, 35917824
    buffer_load_dwordx4 a[80:83], v11, s[4:7], s17 offen offset:0
    buffer_load_dwordx4 a[84:87], v11, s[4:7], s17 offen offset:32
    s_add_u32 s17, s31, 36050944
    buffer_load_dwordx4 a[88:91], v11, s[4:7], s17 offen offset:0
    buffer_load_dwordx4 a[92:95], v11, s[4:7], s17 offen offset:32
T_top0:
    s_cmp_eq_u32 s35, 0
    s_cbranch_scc1 T_slow0
T_go0:
    s_add_u32 s34, s28, 4
    s_min_u32 s68, s34, 63
    s_waitcnt vmcnt(8)
    v_cmp_ge_u32 vcc, s68, v16
    s_nop 0
    s_and_b32 s17, vcc_lo, 0xfff
    s_cbranch_scc1 T_pw0
T_pok0:
    s_add_u32 s31, s31, 8192
    s_add_u32 s32, s32, 2048
    s_and_b32 s17, vcc_lo, 61440
    s_cselect_b32 s35, 0, 1
    s_cselect_b32 s69, 1073741824, s32
    s_cmp_lt_u32 s34, 64
    s_cselect_b32 s68, s31, 1073741824
    s_cselect_b32 s69, s69, 1073741824
    buffer_load_dword v16, v15, s[4:7], 0 offen sc1
    v_mfma_f32_32x32x16_bf16 v[116:131], a[32:35], a[0:3], 0
    s_add_u32 s17, s68, 0
    buffer_load_dwordx4 a[96:99], v10, s[4:7], s17 offen offset:0
    buffer_load_dwordx4 a[100:103], v10, s[4:7], s17 offen offset:32
    v_mfma_f32_32x32x16_bf16 v[116:131], a[36:39], a[4:7], v[116:131]
    s_add_u32 s17, s68, 133120
    buffer_load_dwordx4 a[104:107], v10, s[4:7], s17 offen offset:0
    buffer_load_dwordx4 a[108:111], v10, s[4:7], s17 offen offset:32
    v_mfma_f32_32x32x16_bf16 v[116:131], a[40:43], a[8:11], v[116:131]
    s_add_u32 s17, s68, 266240
    buffer_load_dwordx4 a[112:115], v10, s[4:7], s17 offen offset:0
    buffer_load_dwordx4 a[116:119], v10, s[4:7], s17 offen offset:32
    v_mfma_f32_32x32x16_bf16 v[116:131], a[44:47], a[12:15], v[116:131]
    s_add_u32 s17, s68, 399360
    buffer_load_dwordx4 a[120:123], v10, s[4:7], s17 offen offset:0
    buffer_load_dwordx4 a[124:127], v10, s[4:7], s17 offen offset:32
    v_mfma_f32_32x32x16_bf16 v[116:131], a[48:51], a[16:19], v[116:131]
    s_add_u32 s17, s68, 17825792
    buffer_load_dwordx4 a[128:131], v11, s[4:7], s17 offen offset:0
    buffer_load_dwordx4 a[132:135], v11, s[4:7], s17 offen offset:32
    v_mfma_f32_32x32x16_bf16 v[116:131], a[52:55], a[20:23], v[116:131]
    s_add_u32 s17, s68, 17958912
    buffer_load_dwordx4 a[136:139], v11, s[4:7], s17 offen offset:0
    buffer_load_dwordx4 a[140:143], v11, s[4:7], s17 offen offset:32
    v_mfma_f32_32x32x16_bf16 v[116:131], a[56:59], a[24:27], v[116:131]
    s_add_u32 s17, s68, 18092032
    buffer_load_dwordx4 a[144:147], v11, s[4:7], s17 offen offset:0
    buffer_load_dwordx4 a[148:151], v11, s[4:7], s17 offen offset:32
    v_mfma_f32_32x32x16_bf16 v[116:131], a[60:63], a[28:31], v[116:131]
    s_add_u32 s17, s68, 18225152
    buffer_load_dwordx4 a[152:155], v11, s[4:7], s17 offen offset:0
    buffer_load_dwordx4 a[156:159], v11, s[4:7], s17 offen offset:32
    v_mfma_f32_32x32x16_bf16 v[132:147], v[20:23], a[0:3], 0
    s_add_u32 s17, s68, 35651584
    buffer_load_dwordx4 a[160:163], v11, s[4:7], s17 offen offset:0
    buffer_load_dwordx4 a[164:167], v11, s[4:7], s17 offen offset:32
    v_mfma_f32_32x32x16_bf16 v[132:147], v[24:27], a[4:7], v[132:147]
    s_add_u32 s17, s68, 35784704
    buffer_load_dwordx4 a[168:171], v11, s[4:7], s17 offen offset:0
    buffer_load_dwordx4 a[172:175], v11, s[4:7], s17 offen offset:32
    v_mfma_f32_32x32x16_bf16 v[132:147], v[28:31], a[8:11], v[132:147]
    s_add_u32 s17, s68, 35917824
    buffer_load_dwordx4 a[176:179], v11, s[4:7], s17 offen offset:0
    buffer_load_dwordx4 a[180:183], v11, s[4:7], s17 offen offset:32
    v_mfma_f32_32x32x16_bf16 v[132:147], v[32:35], a[12:15], v[132:147]
    s_add_u32 s17, s68, 36050944
    buffer_load_dwordx4 a[184:187], v11, s[4:7], s17 offen offset:0
    buffer_load_dwordx4 a[188:191], v11, s[4:7], s17 offen offset:32
    v_mfma_f32_32x32x16_bf16 v[132:147], v[36:39], a[16:19], v[132:147]
    s_add_u32 s17, s69, 0
    s_add_u32 s18, s69, 5242880
    buffer_load_dwordx4 v[68:71], v12, s[4:7], s17 offen offset:0
    buffer_load_dwordx4 v[72:75], v12, s[4:7], s17 offen offset:32
    buffer_load_dwordx2 v[100:101], v13, s[4:7], s18 offen
    v_mfma_f32_32x32x16_bf16 v[132:147], v[40:43], a[20:23], v[132:147]
    s_add_u32 s17, s69, 33280
    s_add_u32 s18, s69, 5276160
    buffer_load_dwordx4 v[76:79], v12, s[4:7], s17 offen offset:0
    buffer_load_dwordx4 v[80:83], v12, s[4:7], s17 offen offset:32
    buffer_load_dwordx2 v[104:105], v13, s[4:7], s18 offen
    v_mfma_f32_32x32x16_bf16 v[132:147], v[44:47], a[24:27], v[132:147]
    s_add_u32 s17, s69, 66560
    s_add_u32 s18, s69, 5309440
    buffer_load_dwordx4 v[84:87], v12, s[4:7], s17 offen offset:0
    buffer_load_dwordx4 v[88:91], v12, s[4:7], s17 offen offset:32
    buffer_load_dwordx2 v[108:109], v13, s[4:7], s18 offen
    v_mfma_f32_32x32x16_bf16 v[132:147], v[48:51], a[28:31], v[132:147]
    s_add_u32 s17, s69, 99840
    s_add_u32 s18, s69, 5342720
    buffer_load_dwordx4 v[92:95], v12, s[4:7], s17 offen offset:0
    buffer_load_dwordx4 v[96:99], v12, s[4:7], s17 offen offset:32
    buffer_load_dwordx2 v[112:113], v13, s[4:7], s18 offen
    v_cndmask_b32 v116, v17, v116, s[36:37]
    v_cndmask_b32 v117, v17, v117, s[38:39]
    v_cndmask_b32 v118, v17, v118, s[40:41]
    v_cndmask_b32 v119, v17, v119, s[42:43]
    v_cndmask_b32 v120, v17, v120, s[44:45]
    v_cndmask_b32 v121, v17, v121, s[46:47]
    v_cndmask_b32 v122, v17, v122, s[48:49]
    v_cndmask_b32 v123, v17, v123, s[50:51]
    v_cndmask_b32 v124, v17, v124, s[52:53]
    v_cndmask_b32 v125, v17, v125, s[54:55]
    v_cndmask_b32 v126, v17, v126, s[56:57]
    v_cndmask_b32 v127, v17, v127, s[58:59]
    v_cndmask_b32 v128, v17, v128, s[60:61]
    v_cndmask_b32 v129, v17, v129, s[62:63]
    v_cndmask_b32 v130, v17, v130, s[64:65]
    v_cndmask_b32 v131, v17, v131, s[66:67]
    v_max3_f32 v18, v116, v117, v118
    v_max3_f32 v18, v18, v119, v120
    v_max3_f32 v18, v18, v121, v122
    v_max3_f32 v18, v18, v123, v124
    v_max3_f32 v18, v18, v125, v126
    v_max3_f32 v18, v18, v127, v128
    v_max3_f32 v18, v18, v129, v130
    v_max3_f32 v18, v18, v131, v132
    v_max3_f32 v18, v18, v133, v134
    v_max_f32 v18, v18, v135
    v_mov_b32 v5, v18
    s_nop 1
    v_permlane32_swap_b32 v18, v5
    v_max_f32 v18, v18, v5
    v_mul_f32 v18, s29, v18
    v_fma_f32 v116, v116, s29, -v18
    v_fma_f32 v117, v117, s29, -v18
    v_fma_f32 v118, v118, s29, -v18
    v_fma_f32 v119, v119, s29, -v18
    v_fma_f32 v120, v120, s29, -v18
    v_fma_f32 v121, v121, s29, -v18
    v_fma_f32 v122, v122, s29, -v18
    v_fma_f32 v123, v123, s29, -v18
    v_fma_f32 v124, v124, s29, -v18
    v_fma_f32 v125, v125, s29, -v18
    v_fma_f32 v126, v126, s29, -v18
    v_fma_f32 v127, v127, s29, -v18
    v_fma_f32 v128, v128, s29, -v18
    v_fma_f32 v129, v129, s29, -v18
    v_fma_f32 v130, v130, s29, -v18
    v_fma_f32 v131, v131, s29, -v18
    v_fma_f32 v132, v132, s29, -v18
    v_fma_f32 v133, v133, s29, -v18
    v_fma_f32 v134, v134, s29, -v18
    v_fma_f32 v135, v135, s29, -v18
    v_exp_f32 v116, v116
    v_exp_f32 v117, v117
    v_exp_f32 v118, v118
    v_exp_f32 v119, v119
    v_exp_f32 v120, v120
    v_exp_f32 v121, v121
    v_exp_f32 v122, v122
    v_exp_f32 v123, v123
    v_exp_f32 v124, v124
    v_exp_f32 v125, v125
    v_exp_f32 v126, v126
    v_exp_f32 v127, v127
    v_exp_f32 v128, v128
    v_exp_f32 v129, v129
    v_exp_f32 v130, v130
    v_exp_f32 v131, v131
    v_exp_f32 v132, v132
    v_exp_f32 v133, v133
    v_exp_f32 v134, v134
    v_exp_f32 v135, v135
    s_waitcnt vmcnt(37)
    buffer_store_dword v9, v4, s[4:7], 0 offen sc1
    v_add_f32 v19, v116, v117
    v_add_f32 v6, v118, v119
    v_add_f32 v19, v19, v120
    v_add_f32 v6, v6, v121
    v_add_f32 v19, v19, v122
    v_add_f32 v6, v6, v123
    v_add_f32 v19, v19, v124
    v_add_f32 v6, v6, v125
    v_add_f32 v19, v19, v126
    v_add_f32 v6, v6, v127
    v_add_f32 v19, v19, v128
    v_add_f32 v6, v6, v129
    v_add_f32 v19, v19, v130
    v_add_f32 v6, v6, v131
    v_add_f32 v19, v19, v132
    v_add_f32 v6, v6, v133
    v_add_f32 v19, v19, v134
    v_add_f32 v6, v6, v135
    v_add_f32 v19, v19, v6
    v_mov_b32 v5, v19
    s_nop 1
    v_permlane32_swap_b32 v19, v5
    v_add_f32 v19, v19, v5
    v_rcp_f32 v19, v19
    s_nop 0
    v_mul_f32 v116, v116, v19
    v_mul_f32 v117, v117, v19
    v_mul_f32 v118, v118, v19
    v_mul_f32 v119, v119, v19
    v_mul_f32 v120, v120, v19
    v_mul_f32 v121, v121, v19
    v_mul_f32 v122, v122, v19
    v_mul_f32 v123, v123, v19
    v_mul_f32 v124, v124, v19
    v_mul_f32 v125, v125, v19
    v_mul_f32 v126, v126, v19
    v_mul_f32 v127, v127, v19
    v_mul_f32 v128, v128, v19
    v_mul_f32 v129, v129, v19
    v_mul_f32 v130, v130, v19
    v_mul_f32 v131, v131, v19
    v_mul_f32 v132, v132, v19
    v_mul_f32 v133, v133, v19
    v_mul_f32 v134, v134, v19
    v_mul_f32 v135, v135, v19
    v_cvt_pk_bf16_f32 v148, v116, v117
    v_cvt_pk_bf16_f32 v149, v118, v119
    v_cvt_pk_bf16_f32 v150, v120, v121
    v_cvt_pk_bf16_f32 v151, v122, v123
    v_cvt_pk_bf16_f32 v152, v124, v125
    v_cvt_pk_bf16_f32 v153, v126, v127
    v_cvt_pk_bf16_f32 v154, v128, v129
    v_cvt_pk_bf16_f32 v155, v130, v131
    v_cvt_pk_bf16_f32 v156, v132, v133
    v_cvt_pk_bf16_f32 v157, v134, v135
    v_mfma_f32_32x32x16_bf16 v[160:175], a[64:67], v[148:151], 0
    v_mfma_f32_32x32x16_bf16 v[160:175], a[68:71], v[152:155], v[160:175]
    v_mfma_f32_32x32x16_bf16 v[160:175], v[52:55], v[156:159], v[160:175]
    v_mfma_f32_32x32x16_bf16 v[176:191], a[72:75], v[148:151], 0
    v_mfma_f32_32x32x16_bf16 v[176:191], a[76:79], v[152:155], v[176:191]
    v_mfma_f32_32x32x16_bf16 v[176:191], v[56:59], v[156:159], v[176:191]
    s_nop 2
    v_cvt_pk_bf16_f32 v224, v160, v161
    v_cvt_pk_bf16_f32 v225, v162, v163
    v_cvt_pk_bf16_f32 v226, v164, v165
    v_cvt_pk_bf16_f32 v227, v166, v167
    v_cvt_pk_bf16_f32 v228, v168, v169
    v_cvt_pk_bf16_f32 v229, v170, v171
    v_cvt_pk_bf16_f32 v230, v172, v173
    v_cvt_pk_bf16_f32 v231, v174, v175
    buffer_store_dwordx4 v[224:227], v14, s[4:7], s33 offen offset:0 sc1
    buffer_store_dwordx4 v[228:231], v14, s[4:7], s33 offen offset:512 sc1
    v_mfma_f32_32x32x16_bf16 v[192:207], a[80:83], v[148:151], 0
    v_mfma_f32_32x32x16_bf16 v[192:207], a[84:87], v[152:155], v[192:207]
    v_mfma_f32_32x32x16_bf16 v[192:207], v[60:63], v[156:159], v[192:207]
    v_cvt_pk_bf16_f32 v232, v176, v177
    v_cvt_pk_bf16_f32 v233, v178, v179
    v_cvt_pk_bf16_f32 v234, v180, v181
    v_cvt_pk_bf16_f32 v235, v182, v183
    v_cvt_pk_bf16_f32 v236, v184, v185
    v_cvt_pk_bf16_f32 v237, v186, v187
    v_cvt_pk_bf16_f32 v238, v188, v189
    v_cvt_pk_bf16_f32 v239, v190, v191
    buffer_store_dwordx4 v[232:235], v14, s[4:7], s33 offen offset:1024 sc1
    buffer_store_dwordx4 v[236:239], v14, s[4:7], s33 offen offset:1536 sc1
    v_mfma_f32_32x32x16_bf16 v[208:223], a[88:91], v[148:151], 0
    v_mfma_f32_32x32x16_bf16 v[208:223], a[92:95], v[152:155], v[208:223]
    v_mfma_f32_32x32x16_bf16 v[208:223], v[64:67], v[156:159], v[208:223]
    v_cvt_pk_bf16_f32 v240, v192, v193
    v_cvt_pk_bf16_f32 v241, v194, v195
    v_cvt_pk_bf16_f32 v242, v196, v197
    v_cvt_pk_bf16_f32 v243, v198, v199
    v_cvt_pk_bf16_f32 v244, v200, v201
    v_cvt_pk_bf16_f32 v245, v202, v203
    v_cvt_pk_bf16_f32 v246, v204, v205
    v_cvt_pk_bf16_f32 v247, v206, v207
    buffer_store_dwordx4 v[240:243], v14, s[4:7], s33 offen offset:2048 sc1
    buffer_store_dwordx4 v[244:247], v14, s[4:7], s33 offen offset:2560 sc1
    v_add_u32 v9, 1, v9
    s_nop 0
    v_cvt_pk_bf16_f32 v248, v208, v209
    v_cvt_pk_bf16_f32 v249, v210, v211
    v_cvt_pk_bf16_f32 v250, v212, v213
    v_cvt_pk_bf16_f32 v251, v214, v215
    v_cvt_pk_bf16_f32 v252, v216, v217
    v_cvt_pk_bf16_f32 v253, v218, v219
    v_cvt_pk_bf16_f32 v254, v220, v221
    v_cvt_pk_bf16_f32 v255, v222, v223
    buffer_store_dwordx4 v[248:251], v14, s[4:7], s33 offen offset:3072 sc1
    buffer_store_dwordx4 v[252:255], v14, s[4:7], s33 offen offset:3584 sc1
    s_mov_b32 s28, s34
    s_add_u32 s33, s33, 1048576
T_top1:
    s_cmp_eq_u32 s35, 0
    s_cbranch_scc1 T_slow1
T_go1:
    s_add_u32 s34, s28, 4
    s_min_u32 s68, s34, 63
    s_waitcnt vmcnt(8)
    v_cmp_ge_u32 vcc, s68, v16
    s_nop 0
    s_and_b32 s17, vcc_lo, 0xfff
    s_cbranch_scc1 T_pw1
T_pok1:
    s_add_u32 s31, s31, 8192
    s_add_u32 s32, s32, 2048
    s_and_b32 s17, vcc_lo, 61440
    s_cselect_b32 s35, 0, 1
    s_cselect_b32 s69, 1073741824, s32
    s_cmp_lt_u32 s34, 64
    s_cselect_b32 s68, s31, 1073741824
    s_cselect_b32 s69, s69, 1073741824
    buffer_load_dword v16, v15, s[4:7], 0 offen sc1
    v_mfma_f32_32x32x16_bf16 v[116:131], a[128:131], a[96:99], 0
    s_add_u32 s17, s68, 0
    buffer_load_dwordx4 a[0:3], v10, s[4:7], s17 offen offset:0
    buffer_load_dwordx4 a[4:7], v10, s[4:7], s17 offen offset:32
    v_mfma_f32_32x32x16_bf16 v[116:131], a[132:135], a[100:103], v[116:131]
    s_add_u32 s17, s68, 133120
    buffer_load_dwordx4 a[8:11], v10, s[4:7], s17 offen offset:0
    buffer_load_dwordx4 a[12:15], v10, s[4:7], s17 offen offset:32
    v_mfma_f32_32x32x16_bf16 v[116:131], a[136:139], a[104:107], v[116:131]
    s_add_u32 s17, s68, 266240
    buffer_load_dwordx4 a[16:19], v10, s[4:7], s17 offen offset:0
    buffer_load_dwordx4 a[20:23], v10, s[4:7], s17 offen offset:32
    v_mfma_f32_32x32x16_bf16 v[116:131], a[140:143], a[108:111], v[116:131]
    s_add_u32 s17, s68, 399360
    buffer_load_dwordx4 a[24:27], v10, s[4:7], s17 offen offset:0
    buffer_load_dwordx4 a[28:31], v10, s[4:7], s17 offen offset:32
    v_mfma_f32_32x32x16_bf16 v[116:131], a[144:147], a[112:115], v[116:131]
    s_add_u32 s17, s68, 17825792
    buffer_load_dwordx4 a[32:35], v11, s[4:7], s17 offen offset:0
    buffer_load_dwordx4 a[36:39], v11, s[4:7], s17 offen offset:32
    v_mfma_f32_32x32x16_bf16 v[116:131], a[148:151], a[116:119], v[116:131]
    s_add_u32 s17, s68, 17958912
    buffer_load_dwordx4 a[40:43], v11, s[4:7], s17 offen offset:0
    buffer_load_dwordx4 a[44:47], v11, s[4:7], s17 offen offset:32
    v_mfma_f32_32x32x16_bf16 v[116:131], a[152:155], a[120:123], v[116:131]
    s_add_u32 s17, s68, 18092032
    buffer_load_dwordx4 a[48:51], v11, s[4:7], s17 offen offset:0
    buffer_load_dwordx4 a[52:55], v11, s[4:7], s17 offen offset:32
    v_mfma_f32_32x32x16_bf16 v[116:131], a[156:159], a[124:127], v[116:131]
    s_add_u32 s17, s68, 18225152
    buffer_load_dwordx4 a[56:59], v11, s[4:7], s17 offen offset:0
    buffer_load_dwordx4 a[60:63], v11, s[4:7], s17 offen offset:32
    v_mfma_f32_32x32x16_bf16 v[132:147], v[68:71], a[96:99], 0
    s_add_u32 s17, s68, 35651584
    buffer_load_dwordx4 a[64:67], v11, s[4:7], s17 offen offset:0
    buffer_load_dwordx4 a[68:71], v11, s[4:7], s17 offen offset:32
    v_mfma_f32_32x32x16_bf16 v[132:147], v[72:75], a[100:103], v[132:147]
    s_add_u32 s17, s68, 35784704
    buffer_load_dwordx4 a[72:75], v11, s[4:7], s17 offen offset:0
    buffer_load_dwordx4 a[76:79], v11, s[4:7], s17 offen offset:32
    v_mfma_f32_32x32x16_bf16 v[132:147], v[76:79], a[104:107], v[132:147]
    s_add_u32 s17, s68, 35917824
    buffer_load_dwordx4 a[80:83], v11, s[4:7], s17 offen offset:0
    buffer_load_dwordx4 a[84:87], v11, s[4:7], s17 offen offset:32
    v_mfma_f32_32x32x16_bf16 v[132:147], v[80:83], a[108:111], v[132:147]
    s_add_u32 s17, s68, 36050944
    buffer_load_dwordx4 a[88:91], v11, s[4:7], s17 offen offset:0
    buffer_load_dwordx4 a[92:95], v11, s[4:7], s17 offen offset:32
    v_mfma_f32_32x32x16_bf16 v[132:147], v[84:87], a[112:115], v[132:147]
    s_add_u32 s17, s69, 0
    s_add_u32 s18, s69, 5242880
    buffer_load_dwordx4 v[20:23], v12, s[4:7], s17 offen offset:0
    buffer_load_dwordx4 v[24:27], v12, s[4:7], s17 offen offset:32
    buffer_load_dwordx2 v[52:53], v13, s[4:7], s18 offen
    v_mfma_f32_32x32x16_bf16 v[132:147], v[88:91], a[116:119], v[132:147]
    s_add_u32 s17, s69, 33280
    s_add_u32 s18, s69, 5276160
    buffer_load_dwordx4 v[28:31], v12, s[4:7], s17 offen offset:0
    buffer_load_dwordx4 v[32:35], v12, s[4:7], s17 offen offset:32
    buffer_load_dwordx2 v[56:57], v13, s[4:7], s18 offen
    v_mfma_f32_32x32x16_bf16 v[132:147], v[92:95], a[120:123], v[132:147]
    s_add_u32 s17, s69, 66560
    s_add_u32 s18, s69, 5309440
    buffer_load_dwordx4 v[36:39], v12, s[4:7], s17 offen offset:0
    buffer_load_dwordx4 v[40:43], v12, s[4:7], s17 offen offset:32
    buffer_load_dwordx2 v[60:61], v13, s[4:7], s18 offen
    v_mfma_f32_32x32x16_bf16 v[132:147], v[96:99], a[124:127], v[132:147]
    s_add_u32 s17, s69, 99840
    s_add_u32 s18, s69, 5342720
    buffer_load_dwordx4 v[44:47], v12, s[4:7], s17 offen offset:0
    buffer_load_dwordx4 v[48:51], v12, s[4:7], s17 offen offset:32
    buffer_load_dwordx2 v[64:65], v13, s[4:7], s18 offen
    v_cndmask_b32 v116, v17, v116, s[36:37]
    v_cndmask_b32 v117, v17, v117, s[38:39]
    v_cndmask_b32 v118, v17, v118, s[40:41]
    v_cndmask_b32 v119, v17, v119, s[42:43]
    v_cndmask_b32 v120, v17, v120, s[44:45]
    v_cndmask_b32 v121, v17, v121, s[46:47]
    v_cndmask_b32 v122, v17, v122, s[48:49]
    v_cndmask_b32 v123, v17, v123, s[50:51]
    v_cndmask_b32 v124, v17, v124, s[52:53]
    v_cndmask_b32 v125, v17, v125, s[54:55]
    v_cndmask_b32 v126, v17, v126, s[56:57]
    v_cndmask_b32 v127, v17, v127, s[58:59]
    v_cndmask_b32 v128, v17, v128, s[60:61]
    v_cndmask_b32 v129, v17, v129, s[62:63]
    v_cndmask_b32 v130, v17, v130, s[64:65]
    v_cndmask_b32 v131, v17, v131, s[66:67]
    v_max3_f32 v18, v116, v117, v118
    v_max3_f32 v18, v18, v119, v120
    v_max3_f32 v18, v18, v121, v122
    v_max3_f32 v18, v18, v123, v124
    v_max3_f32 v18, v18, v125, v126
    v_max3_f32 v18, v18, v127, v128
    v_max3_f32 v18, v18, v129, v130
    v_max3_f32 v18, v18, v131, v132
    v_max3_f32 v18, v18, v133, v134
    v_max_f32 v18, v18, v135
    v_mov_b32 v5, v18
    s_nop 1
    v_permlane32_swap_b32 v18, v5
    v_max_f32 v18, v18, v5
    v_mul_f32 v18, s29, v18
    v_fma_f32 v116, v116, s29, -v18
    v_fma_f32 v117, v117, s29, -v18
    v_fma_f32 v118, v118, s29, -v18
    v_fma_f32 v119, v119, s29, -v18
    v_fma_f32 v120, v120, s29, -v18
    v_fma_f32 v121, v121, s29, -v18
    v_fma_f32 v122, v122, s29, -v18
    v_fma_f32 v123, v123, s29, -v18
    v_fma_f32 v124, v124, s29, -v18
    v_fma_f32 v125, v125, s29, -v18
    v_fma_f32 v126, v126, s29, -v18
    v_fma_f32 v127, v127, s29, -v18
    v_fma_f32 v128, v128, s29, -v18
    v_fma_f32 v129, v129, s29, -v18
    v_fma_f32 v130, v130, s29, -v18
    v_fma_f32 v131, v131, s29, -v18
    v_fma_f32 v132, v132, s29, -v18
    v_fma_f32 v133, v133, s29, -v18
    v_fma_f32 v134, v134, s29, -v18
    v_fma_f32 v135, v135, s29, -v18
    v_exp_f32 v116, v116
    v_exp_f32 v117, v117
    v_exp_f32 v118, v118
    v_exp_f32 v119, v119
    v_exp_f32 v120, v120
    v_exp_f32 v121, v121
    v_exp_f32 v122, v122
    v_exp_f32 v123, v123
    v_exp_f32 v124, v124
    v_exp_f32 v125, v125
    v_exp_f32 v126, v126
    v_exp_f32 v127, v127
    v_exp_f32 v128, v128
    v_exp_f32 v129, v129
    v_exp_f32 v130, v130
    v_exp_f32 v131, v131
    v_exp_f32 v132, v132
    v_exp_f32 v133, v133
    v_exp_f32 v134, v134
    v_exp_f32 v135, v135
    s_waitcnt vmcnt(37)
    buffer_store_dword v9, v4, s[4:7], 0 offen sc1
    v_add_f32 v19, v116, v117
    v_add_f32 v6, v118, v119
    v_add_f32 v19, v19, v120
    v_add_f32 v6, v6, v121
    v_add_f32 v19, v19, v122
    v_add_f32 v6, v6, v123
    v_add_f32 v19, v19, v124
    v_add_f32 v6, v6, v125
    v_add_f32 v19, v19, v126
    v_add_f32 v6, v6, v127
    v_add_f32 v19, v19, v128
    v_add_f32 v6, v6, v129
    v_add_f32 v19, v19, v130
    v_add_f32 v6, v6, v131
    v_add_f32 v19, v19, v132
    v_add_f32 v6, v6, v133
    v_add_f32 v19, v19, v134
    v_add_f32 v6, v6, v135
    v_add_f32 v19, v19, v6
    v_mov_b32 v5, v19
    s_nop 1
    v_permlane32_swap_b32 v19, v5
    v_add_f32 v19, v19, v5
    v_rcp_f32 v19, v19
    s_nop 0
    v_mul_f32 v116, v116, v19
    v_mul_f32 v117, v117, v19
    v_mul_f32 v118, v118, v19
    v_mul_f32 v119, v119, v19
    v_mul_f32 v120, v120, v19
    v_mul_f32 v121, v121, v19
    v_mul_f32 v122, v122, v19
    v_mul_f32 v123, v123, v19
    v_mul_f32 v124, v124, v19
    v_mul_f32 v125, v125, v19
    v_mul_f32 v126, v126, v19
    v_mul_f32 v127, v127, v19
    v_mul_f32 v128, v128, v19
    v_mul_f32 v129, v129, v19
    v_mul_f32 v130, v130, v19
    v_mul_f32 v131, v131, v19
    v_mul_f32 v132, v132, v19
    v_mul_f32 v133, v133, v19
    v_mul_f32 v134, v134, v19
    v_mul_f32 v135, v135, v19
    v_cvt_pk_bf16_f32 v148, v116, v117
    v_cvt_pk_bf16_f32 v149, v118, v119
    v_cvt_pk_bf16_f32 v150, v120, v121
    v_cvt_pk_bf16_f32 v151, v122, v123
    v_cvt_pk_bf16_f32 v152, v124, v125
    v_cvt_pk_bf16_f32 v153, v126, v127
    v_cvt_pk_bf16_f32 v154, v128, v129
    v_cvt_pk_bf16_f32 v155, v130, v131
    v_cvt_pk_bf16_f32 v156, v132, v133
    v_cvt_pk_bf16_f32 v157, v134, v135
    v_mfma_f32_32x32x16_bf16 v[160:175], a[160:163], v[148:151], 0
    v_mfma_f32_32x32x16_bf16 v[160:175], a[164:167], v[152:155], v[160:175]
    v_mfma_f32_32x32x16_bf16 v[160:175], v[100:103], v[156:159], v[160:175]
    v_mfma_f32_32x32x16_bf16 v[176:191], a[168:171], v[148:151], 0
    v_mfma_f32_32x32x16_bf16 v[176:191], a[172:175], v[152:155], v[176:191]
    v_mfma_f32_32x32x16_bf16 v[176:191], v[104:107], v[156:159], v[176:191]
    s_nop 2
    v_cvt_pk_bf16_f32 v224, v160, v161
    v_cvt_pk_bf16_f32 v225, v162, v163
    v_cvt_pk_bf16_f32 v226, v164, v165
    v_cvt_pk_bf16_f32 v227, v166, v167
    v_cvt_pk_bf16_f32 v228, v168, v169
    v_cvt_pk_bf16_f32 v229, v170, v171
    v_cvt_pk_bf16_f32 v230, v172, v173
    v_cvt_pk_bf16_f32 v231, v174, v175
    buffer_store_dwordx4 v[224:227], v14, s[4:7], s33 offen offset:0 sc1
    buffer_store_dwordx4 v[228:231], v14, s[4:7], s33 offen offset:512 sc1
    v_mfma_f32_32x32x16_bf16 v[192:207], a[176:179], v[148:151], 0
    v_mfma_f32_32x32x16_bf16 v[192:207], a[180:183], v[152:155], v[192:207]
    v_mfma_f32_32x32x16_bf16 v[192:207], v[108:111], v[156:159], v[192:207]
    v_cvt_pk_bf16_f32 v232, v176, v177
    v_cvt_pk_bf16_f32 v233, v178, v179
    v_cvt_pk_bf16_f32 v234, v180, v181
    v_cvt_pk_bf16_f32 v235, v182, v183
    v_cvt_pk_bf16_f32 v236, v184, v185
    v_cvt_pk_bf16_f32 v237, v186, v187
    v_cvt_pk_bf16_f32 v238, v188, v189
    v_cvt_pk_bf16_f32 v239, v190, v191
    buffer_store_dwordx4 v[232:235], v14, s[4:7], s33 offen offset:1024 sc1
    buffer_store_dwordx4 v[236:239], v14, s[4:7], s33 offen offset:1536 sc1
    v_mfma_f32_32x32x16_bf16 v[208:223], a[184:187], v[148:151], 0
    v_mfma_f32_32x32x16_bf16 v[208:223], a[188:191], v[152:155], v[208:223]
    v_mfma_f32_32x32x16_bf16 v[208:223], v[112:115], v[156:159], v[208:223]
    v_cvt_pk_bf16_f32 v240, v192, v193
    v_cvt_pk_bf16_f32 v241, v194, v195
    v_cvt_pk_bf16_f32 v242, v196, v197
    v_cvt_pk_bf16_f32 v243, v198, v199
    v_cvt_pk_bf16_f32 v244, v200, v201
    v_cvt_pk_bf16_f32 v245, v202, v203
    v_cvt_pk_bf16_f32 v246, v204, v205
    v_cvt_pk_bf16_f32 v247, v206, v207
    buffer_store_dwordx4 v[240:243], v14, s[4:7], s33 offen offset:2048 sc1
    buffer_store_dwordx4 v[244:247], v14, s[4:7], s33 offen offset:2560 sc1
    v_add_u32 v9, 1, v9
    s_nop 0
    v_cvt_pk_bf16_f32 v248, v208, v209
    v_cvt_pk_bf16_f32 v249, v210, v211
    v_cvt_pk_bf16_f32 v250, v212, v213
    v_cvt_pk_bf16_f32 v251, v214, v215
    v_cvt_pk_bf16_f32 v252, v216, v217
    v_cvt_pk_bf16_f32 v253, v218, v219
    v_cvt_pk_bf16_f32 v254, v220, v221
    v_cvt_pk_bf16_f32 v255, v222, v223
    buffer_store_dwordx4 v[248:251], v14, s[4:7], s33 offen offset:3072 sc1
    buffer_store_dwordx4 v[252:255], v14, s[4:7], s33 offen offset:3584 sc1
    s_mov_b32 s28, s34
    s_add_u32 s33, s33, 1048576
    s_cmp_lt_u32 s28, 64
    s_cbranch_scc1 T_top0
    s_waitcnt vmcnt(0)
    buffer_store_dword v9, v4, s[4:7], 0 offen sc1
    s_branch W_fin
T_slow0:
    s_waitcnt vmcnt(0)
    buffer_store_dword v9, v4, s[4:7], 0 offen sc1
    s_mov_b32 s30, s92
T_s0:
    v_cmp_ge_u32 vcc, s28, v16
    s_nop 0
    s_and_b32 s17, vcc_lo, 61440
    s_cbranch_scc0 T_sk0
    s_cmp_ge_u32 s30, 1048576
    s_cselect_b32 s92, 1048576, s92
    s_cbranch_scc1 T_sk0
    s_add_u32 s30, s30, 1
    buffer_load_dword v16, v15, s[4:7], 0 offen sc1
    s_sleep 2
    s_waitcnt vmcnt(0)
    s_branch T_s0
T_sk0:
    s_add_u32 s17, s32, 0
    s_add_u32 s18, s32, 5242880
    buffer_load_dwordx4 v[20:23], v12, s[4:7], s17 offen offset:0
    buffer_load_dwordx4 v[24:27], v12, s[4:7], s17 offen offset:32
    buffer_load_dwordx2 v[52:53], v13, s[4:7], s18 offen
    s_add_u32 s17, s32, 33280
    s_add_u32 s18, s32, 5276160
    buffer_load_dwordx4 v[28:31], v12, s[4:7], s17 offen offset:0
    buffer_load_dwordx4 v[32:35], v12, s[4:7], s17 offen offset:32
    buffer_load_dwordx2 v[56:57], v13, s[4:7], s18 offen
    s_add_u32 s17, s32, 66560
    s_add_u32 s18, s32, 5309440
    buffer_load_dwordx4 v[36:39], v12, s[4:7], s17 offen offset:0
    buffer_load_dwordx4 v[40:43], v12, s[4:7], s17 offen offset:32
    buffer_load_dwordx2 v[60:61], v13, s[4:7], s18 offen
    s_add_u32 s17, s32, 99840
    s_add_u32 s18, s32, 5342720
    buffer_load_dwordx4 v[44:47], v12, s[4:7], s17 offen offset:0
    buffer_load_dwordx4 v[48:51], v12, s[4:7], s17 offen offset:32
    buffer_load_dwordx2 v[64:65], v13, s[4:7], s18 offen
    s_waitcnt vmcnt(0)
    s_branch T_go0
T_pw0:
    s_mov_b32 s30, s92
T_q0:
    v_cmp_ge_u32 vcc, s68, v16
    s_nop 0
    s_and_b32 s17, vcc_lo, 4095
    s_cbranch_scc0 T_pok0
    s_cmp_ge_u32 s30, 1048576
    s_cselect_b32 s92, 1048576, s92
    s_cbranch_scc1 T_pok0
    s_add_u32 s30, s30, 1
    buffer_load_dword v16, v15, s[4:7], 0 offen sc1
    s_sleep 8
    s_waitcnt vmcnt(0)
    s_branch T_q0
T_slow1:
    s_waitcnt vmcnt(0)
    buffer_store_dword v9, v4, s[4:7], 0 offen sc1
    s_mov_b32 s30, s92
T_s1:
    v_cmp_ge_u32 vcc, s28, v16
    s_nop 0
    s_and_b32 s17, vcc_lo, 61440
    s_cbranch_scc0 T_sk1
    s_cmp_ge_u32 s30, 1048576
    s_cselect_b32 s92, 1048576, s92
    s_cbranch_scc1 T_sk1
    s_add_u32 s30, s30, 1
    buffer_load_dword v16, v15, s[4:7], 0 offen sc1
    s_sleep 2
    s_waitcnt vmcnt(0)
    s_branch T_s1
T_sk1:
    s_add_u32 s17, s32, 0
    s_add_u32 s18, s32, 5242880
    buffer_load_dwordx4 v[68:71], v12, s[4:7], s17 offen offset:0
    buffer_load_dwordx4 v[72:75], v12, s[4:7], s17 offen offset:32
    buffer_load_dwordx2 v[100:101], v13, s[4:7], s18 offen
    s_add_u32 s17, s32, 33280
    s_add_u32 s18, s32, 5276160
    buffer_load_dwordx4 v[76:79], v12, s[4:7], s17 offen offset:0
    buffer_load_dwordx4 v[80:83], v12, s[4:7], s17 offen offset:32
    buffer_load_dwordx2 v[104:105], v13, s[4:7], s18 offen
    s_add_u32 s17, s32, 66560
    s_add_u32 s18, s32, 5309440
    buffer_load_dwordx4 v[84:87], v12, s[4:7], s17 offen offset:0
    buffer_load_dwordx4 v[88:91], v12, s[4:7], s17 offen offset:32
    buffer_load_dwordx2 v[108:109], v13, s[4:7], s18 offen
    s_add_u32 s17, s32, 99840
    s_add_u32 s18, s32, 5342720
    buffer_load_dwordx4 v[92:95], v12, s[4:7], s17 offen offset:0
    buffer_load_dwordx4 v[96:99], v12, s[4:7], s17 offen offset:32
    buffer_load_dwordx2 v[112:113], v13, s[4:7], s18 offen
    s_waitcnt vmcnt(0)
    s_branch T_go1
T_pw1:
    s_mov_b32 s30, s92
T_q1:
    v_cmp_ge_u32 vcc, s68, v16
    s_nop 0
    s_and_b32 s17, vcc_lo, 4095
    s_cbranch_scc0 T_pok1
    s_cmp_ge_u32 s30, 1048576
    s_cselect_b32 s92, 1048576, s92
    s_cbranch_scc1 T_pok1
    s_add_u32 s30, s30, 1
    buffer_load_dword v16, v15, s[4:7], 0 offen sc1
    s_sleep 8
    s_waitcnt vmcnt(0)
    s_branch T_q1
W_fin:
W_end:
    s_endpgm
R_entry:
    s_mov_b32 s12, s3
    s_lshr_b32 s13, s2, 3
    s_load_dwordx2 s[4:5], s[0:1], 96
    s_load_dwordx2 s[28:29], s[0:1], 32
    s_load_dwordx2 s[30:31], s[0:1], 40
    s_load_dwordx2 s[32:33], s[0:1], 48
    s_load_dwordx2 s[34:35], s[0:1], 56
    s_load_dwordx2 s[36:37], s[0:1], 64
    v_lshrrev_b32 v19, 6, v0
    v_and_b32 v1, 63, v0
    v_readfirstlane_b32 s14, v19
    s_mov_b32 s6, 268435456
    s_mov_b32 s7, 0x20000
    s_mov_b32 s10, 8388608
    s_mov_b32 s11, 0x20000
    s_mov_b32 s25, 0
    s_mov_b32 s24, 1040356334
    s_waitcnt lgkmcnt(0)
    v_and_b32 v96, 7, v1
    v_bfe_u32 v97, v1, 3, 1
    v_lshrrev_b32 v98, 4, v1
    v_lshlrev_b32 v19, 4, v1
    s_lshl_b32 s21, s12, 14
    s_lshl_b32 s22, s14, 12
    s_add_u32 s21, s21, s22
    s_add_u32 s22, s21, 0
    v_add_u32 v2, s22, v19
    s_add_u32 s22, s21, 229376
    v_add_u32 v8, s22, v19
    s_lshr_b32 s21, s13, 1
    s_lshl_b32 s21, s21, 10
    s_and_b32 s22, s13, 1
    s_lshl_b32 s22, s22, 7
    s_add_u32 s21, s21, s22
    s_lshl_b32 s22, s12, 14
    s_add_u32 s21, s21, s22
    v_lshlrev_b32 v20, 8, v98
    v_lshl_add_u32 v20, v96, 4, v20
    v_lshl_add_u32 v20, v97, 3, v20
    s_add_u32 s22, s21, 229376
    v_add_u32 v7, s22, v20
    s_add_u32 s22, s21, 0
    v_add_u32 v11, s22, v20
    s_lshr_b32 s21, s13, 1
    s_lshl_b32 s21, s21, 14
    s_and_b32 s22, s13, 1
    s_lshl_b32 s22, s22, 12
    s_add_u32 s21, s21, s22
    s_lshl_b32 s22, s12, 10
    s_add_u32 s22, s21, s22
    v_add_u32 v9, s22, v19
    v_xor_b32 v10, 1024, v9
    v_xor_b32 v23, 2048, v9
    v_xor_b32 v244, 3072, v9
    s_mov_b32 s95, 167772160
    s_lshr_b32 s40, s13, 2
    s_lshl_b32 s21, s12, 3
    s_add_u32 s40, s40, s21
    s_and_b32 s41, s13, 3
    s_mul_i32 s21, s40, 5120
    s_add_u32 s21, s21, 65536
    v_add_u32 v5, s21, v19
    v_lshlrev_b32 v20, 2, v1
    s_add_u32 s22, s21, 4096
    v_add_u32 v6, s22, v20
    s_lshl_b32 s22, s41, 10
    s_add_u32 s22, s22, s21
    v_add_u32 v3, s22, v19
    v_mov_b32 v21, 1073741824
    v_cmp_eq_u32 vcc, 0, v97
    s_nop 1
    v_cndmask_b32 v3, v21, v3, vcc
    s_lshl_b32 s22, s41, 8
    s_add_u32 s22, s22, s21
    s_add_u32 s22, s22, 4096
    v_lshlrev_b32 v20, 4, v98
    v_lshl_add_u32 v20, v96, 5, v20
    v_add_u32 v4, s22, v20
    v_cndmask_b32 v4, v4, v21, vcc
    v_cmp_gt_u32 vcc, 2, v98
    s_nop 1
    v_cndmask_b32 v4, v21, v4, vcc
    s_lshl_b32 s27, s40, 7
    s_lshl_b32 s21, s41, 5
    s_add_u32 s27, s27, s21
    v_bfe_u32 v20, v1, 2, 2
    v_and_b32 v22, 3, v1
    v_lshl_add_u32 v20, v20, 3, v22
    v_lshlrev_b32 v12, 6, v20
    v_lshl_add_u32 v12, v98, 4, v12
    s_and_b32 s21, s14, 1
    s_lshl_b32 s21, s21, 14
    s_lshl_b32 s22, s27, 2
    s_add_u32 s21, s21, s22
    s_add_u32 s21, s21, 100679680
    v_mov_b32 v245, s21
    s_mov_b32 s85, 0
    s_mul_i32 s21, s27, 4160
    v_add_u32 v12, s21, v12
    v_mov_b32 v13, v12
    v_lshlrev_b32 v15, 4, v20
    v_lshl_add_u32 v15, v98, 5, v15
    s_mul_i32 s21, s27, 1040
    v_add_u32 v15, s21, v15
    v_and_b32 v22, 1, v98
    v_cmp_eq_u32 vcc, 0, v22
    s_nop 1
    v_cndmask_b32 v15, v21, v15, vcc
    v_lshlrev_b32 v14, 6, v96
    v_lshl_add_u32 v14, v98, 4, v14
    v_add_u32 v14, s21, v14
    v_cmp_eq_u32 vcc, 1, v97
    s_nop 1
    v_cndmask_b32 v14, v21, v14, vcc
    v_mov_b32 v16, v19
    s_lshl_b32 s21, s14, 11
    v_add_u32 v17, s21, v19
    v_and_b32 v20, 15, v1
    v_bfe_u32 v22, v1, 2, 2
    v_and_b32 v18, 1, v1
    v_lshl_add_u32 v18, v22, 1, v18
    v_bfe_u32 v22, v1, 1, 1
    v_lshl_add_u32 v18, v22, 3, v18
    s_cmp_eq_u32 s14, 1
    s_cselect_b64 vcc, -1, 0
    v_cndmask_b32 v20, v20, v18, vcc
    v_and_b32 v22, 1, v98
    v_lshlrev_b32 v22, 2, v22
    v_sub_u32 v20, v20, v22
    v_mov_b32 v22, 0x3f80
    v_mov_b32 v18, 0x3f800000
    v_mov_b32 v172, 0x4444
    v_mov_b32 v84, 0xeeee
    v_cmp_eq_u32 vcc, 1, v97
    s_nop 1
    v_cndmask_b32 v172, v172, v84, vcc
    v_cmp_eq_u32 vcc, 0, v20
    s_nop 1
    v_cndmask_b32 v84, 0, v22, vcc
    v_cmp_eq_u32 vcc, 1, v20
    s_nop 1
    v_cndmask_b32 v84, v84, v18, vcc
    v_cmp_eq_u32 vcc, 2, v20
    s_nop 1
    v_cndmask_b32 v85, 0, v22, vcc
    v_cmp_eq_u32 vcc, 3, v20
    s_nop 1
    v_cndmask_b32 v85, v85, v18, vcc
    v_cmp_eq_u32 vcc, 8, v20
    s_nop 1
    v_cndmask_b32 v86, 0, v22, vcc
    v_cmp_eq_u32 vcc, 9, v20
    s_nop 1
    v_cndmask_b32 v86, v86, v18, vcc
    v_cmp_eq_u32 vcc, 10, v20
    s_nop 1
    v_cndmask_b32 v87, 0, v22, vcc
    v_cmp_eq_u32 vcc, 11, v20
    s_nop 1
    v_cndmask_b32 v87, v87, v18, vcc
    s_mov_b32 s16, 81788928
    s_mov_b32 s42, 82083840
    s_mov_b32 s43, 82378752
    s_mov_b32 s44, 82673664
    s_mov_b32 s17, 17825792
    s_mov_b32 s18, 35651584
    s_mov_b32 s19, 71303168
    s_mov_b32 s20, 76546048
    s_mov_b32 s15, 0
    v_mov_b32 v204, -1
    v_mov_b32 v205, -1
    v_mov_b32 v206, -1
    v_mov_b32 v207, -1
    v_mov_b32 v236, 0x3f803f80
    v_mov_b32 v237, 0x3f803f80
    v_mov_b32 v238, 0x3f803f80
    v_mov_b32 v239, 0x3f803f80
    s_mul_i32 s22, s14, 294912
    s_add_u32 s22, s22, 81788928
    buffer_store_dwordx4 v[204:207], v3, s[4:7], s22 offen sc1
    buffer_store_dwordx4 v[204:207], v3, s[4:7], s22 offen offset:128 sc1
    buffer_store_dwordx4 v[204:207], v4, s[4:7], s22 offen sc1
    buffer_store_dwordx2 v[204:205], v7, s[4:7], s22 offen sc1
    buffer_store_dwordx2 v[204:205], v11, s[4:7], s22 offen sc1
    s_lshl_b32 s22, s14, 18
    s_add_u32 s22, s22, 167772160
    buffer_store_dwordx4 v[204:207], v9, s[4:7], s22 offen sc1
    s_add_u32 s22, s22, 8192
    buffer_store_dwordx4 v[204:207], v9, s[4:7], s22 offen sc1
    s_lshl_b32 s22, s27, 2
    s_add_u32 s22, s22, 100712448
    v_lshlrev_b32 v246, 2, v1
    v_add_u32 v246, s22, v246
    v_cmp_gt_u32 vcc, 32, v1
    s_nop 1
    v_cndmask_b32 v246, v21, v246, vcc
    v_mov_b32 v247, 0
    buffer_store_dword v247, v246, s[4:7], 0 offen sc1
    v_lshrrev_b32 v19, 2, v1
    v_and_b32 v22, 3, v1
    v_lshlrev_b32 v22, 4, v22
    v_lshl_add_u32 v140, v19, 13, v22
    v_lshl_add_u32 v141, v19, 11, v22
    s_mul_i32 s86, s14, 40960
    s_lshr_b32 s21, s13, 3
    s_cmp_eq_u32 s21, 1
    s_cselect_b64 s[8:9], s[32:33], s[30:31]
    s_cmp_eq_u32 s21, 2
    s_cselect_b64 s[8:9], s[34:35], s[8:9]
    s_cmp_eq_u32 s21, 3
    s_cselect_b64 s[8:9], s[36:37], s[8:9]
    s_cselect_b32 s21, 11, 13
    s_cselect_b32 s87, 21, 11
    s_lshl_b32 s87, s12, s87
    s_and_b32 s22, s13, 3
    s_lshl_b32 s22, s22, 8
    v_add_u32 v142, s22, v0
    v_lshlrev_b32 v142, s21, v142
    s_and_b32 s22, s13, 4
    s_lshl_b32 s22, s22, 8
    s_add_u32 s87, s87, s22
    buffer_load_dword v143, v142, s[8:11], s87 offen offset:384
    s_cmp_eq_u32 s87, 7168
    s_cselect_b32 s87, s87, 1073741824
    buffer_load_dword v144, v142, s[8:11], s87 offen offset:896
    s_mov_b32 s8, s32
    s_mov_b32 s9, s33
    s_lshl_b32 s87, s14, 21
    s_lshl_b32 s22, s27, 1
    s_add_u32 s87, s87, s22
    s_add_u32 m0, s86, 0
    s_nop 0
    buffer_load_dwordx4 v140, s[8:11], s87 offen lds
    s_add_u32 s87, s87, 131072
    s_add_u32 m0, s86, 1024
    s_nop 0
    buffer_load_dwordx4 v140, s[8:11], s87 offen lds
    s_add_u32 s87, s87, 131072
    s_add_u32 m0, s86, 2048
    s_nop 0
    buffer_load_dwordx4 v140, s[8:11], s87 offen lds
    s_add_u32 s87, s87, 131072
    s_add_u32 m0, s86, 3072
    s_nop 0
    buffer_load_dwordx4 v140, s[8:11], s87 offen lds
    s_add_u32 s87, s87, 131072
    v_bfe_u32 v19, v1, 2, 1
    v_lshl_add_u32 v19, v98, 2, v19
    v_lshl_add_u32 v19, v97, 5, v19
    v_lshl_add_u32 v22, v19, 6, v22
    v_add_u32 v22, s86, v22
    s_waitcnt vmcnt(6)
    s_barrier
    s_cmp_lg_u32 s14, 0
    s_cbranch_scc1 reg_20
    s_and_b32 s21, s2, 3
    s_lshl_b32 s21, s21, 3
    s_lshl_b32 s22, s98, 2
    s_add_u32 s21, s21, s22
    s_lshl_b32 s21, 1, s21
    s_andn2_b32 s22, s2, 3
    v_mov_b32 v20, s22
    v_mov_b32 v21, s21
    s_mov_b64 exec, 1
    global_atomic_add v20, v21, s[100:101] sc1
    s_mov_b64 exec, -1
reg_20:
    s_barrier
    s_add_u32 m0, s86, 4096
    s_nop 0
    buffer_load_dwordx4 v140, s[8:11], s87 offen lds
    s_add_u32 s87, s87, 131072
    s_add_u32 m0, s86, 5120
    s_nop 0
    buffer_load_dwordx4 v140, s[8:11], s87 offen lds
    s_add_u32 s87, s87, 131072
    s_add_u32 m0, s86, 6144
    s_nop 0
    buffer_load_dwordx4 v140, s[8:11], s87 offen lds
    s_add_u32 s87, s87, 131072
    s_add_u32 m0, s86, 7168
    s_nop 0
    buffer_load_dwordx4 v140, s[8:11], s87 offen lds
    s_add_u32 s87, s87, 131072
    s_add_u32 m0, s86, 8192
    s_nop 0
    buffer_load_dwordx4 v140, s[8:11], s87 offen lds
    s_add_u32 s87, s87, 131072
    s_add_u32 m0, s86, 9216
    s_nop 0
    buffer_load_dwordx4 v140, s[8:11], s87 offen lds
    s_add_u32 s87, s87, 131072
    s_add_u32 m0, s86, 10240
    s_nop 0
    buffer_load_dwordx4 v140, s[8:11], s87 offen lds
    s_add_u32 s87, s87, 131072
    s_add_u32 m0, s86, 11264
    s_nop 0
    buffer_load_dwordx4 v140, s[8:11], s87 offen lds
    s_add_u32 s87, s87, 131072
    s_add_u32 m0, s86, 12288
    s_nop 0
    buffer_load_dwordx4 v140, s[8:11], s87 offen lds
    s_add_u32 s87, s87, 131072
    s_add_u32 m0, s86, 13312
    s_nop 0
    buffer_load_dwordx4 v140, s[8:11], s87 offen lds
    s_add_u32 s87, s87, 131072
    s_add_u32 m0, s86, 14336
    s_nop 0
    buffer_load_dwordx4 v140, s[8:11], s87 offen lds
    s_add_u32 s87, s87, 131072
    s_add_u32 m0, s86, 15360
    s_nop 0
    buffer_load_dwordx4 v140, s[8:11], s87 offen lds
    s_add_u32 s87, s87, 131072
    s_mov_b32 s8, s34
    s_mov_b32 s9, s35
    s_lshl_b32 s87, s14, 21
    s_lshl_b32 s22, s27, 1
    s_add_u32 s87, s87, s22
    s_add_u32 m0, s86, 16384
    s_nop 0
    buffer_load_dwordx4 v140, s[8:11], s87 offen lds
    s_add_u32 s87, s87, 131072
    s_add_u32 m0, s86, 17408
    s_nop 0
    buffer_load_dwordx4 v140, s[8:11], s87 offen lds
    s_add_u32 s87, s87, 131072
    s_add_u32 m0, s86, 18432
    s_nop 0
    buffer_load_dwordx4 v140, s[8:11], s87 offen lds
    s_add_u32 s87, s87, 131072
    s_add_u32 m0, s86, 19456
    s_nop 0
    buffer_load_dwordx4 v140, s[8:11], s87 offen lds
    s_add_u32 s87, s87, 131072
    s_add_u32 m0, s86, 20480
    s_nop 0
    buffer_load_dwordx4 v140, s[8:11], s87 offen lds
    s_add_u32 s87, s87, 131072
    s_add_u32 m0, s86, 21504
    s_nop 0
    buffer_load_dwordx4 v140, s[8:11], s87 offen lds
    s_add_u32 s87, s87, 131072
    s_add_u32 m0, s86, 22528
    s_nop 0
    buffer_load_dwordx4 v140, s[8:11], s87 offen lds
    s_add_u32 s87, s87, 131072
    s_add_u32 m0, s86, 23552
    s_nop 0
    buffer_load_dwordx4 v140, s[8:11], s87 offen lds
    s_add_u32 s87, s87, 131072
    s_add_u32 m0, s86, 24576
    s_nop 0
    buffer_load_dwordx4 v140, s[8:11], s87 offen lds
    s_add_u32 s87, s87, 131072
    s_add_u32 m0, s86, 25600
    s_nop 0
    buffer_load_dwordx4 v140, s[8:11], s87 offen lds
    s_add_u32 s87, s87, 131072
    s_add_u32 m0, s86, 26624
    s_nop 0
    buffer_load_dwordx4 v140, s[8:11], s87 offen lds
    s_add_u32 s87, s87, 131072
    s_add_u32 m0, s86, 27648
    s_nop 0
    buffer_load_dwordx4 v140, s[8:11], s87 offen lds
    s_add_u32 s87, s87, 131072
    s_add_u32 m0, s86, 28672
    s_nop 0
    buffer_load_dwordx4 v140, s[8:11], s87 offen lds
    s_add_u32 s87, s87, 131072
    s_add_u32 m0, s86, 29696
    s_nop 0
    buffer_load_dwordx4 v140, s[8:11], s87 offen lds
    s_add_u32 s87, s87, 131072
    s_add_u32 m0, s86, 30720
    s_nop 0
    buffer_load_dwordx4 v140, s[8:11], s87 offen lds
    s_add_u32 s87, s87, 131072
    s_add_u32 m0, s86, 31744
    s_nop 0
    buffer_load_dwordx4 v140, s[8:11], s87 offen lds
    s_add_u32 s87, s87, 131072
    s_mov_b32 s8, s30
    s_mov_b32 s9, s31
    s_lshl_b32 s87, s14, 21
    s_lshl_b32 s22, s27, 1
    s_add_u32 s87, s87, s22
    s_add_u32 m0, s86, 32768
    s_nop 0
    buffer_load_dwordx4 v140, s[8:11], s87 offen lds
    s_add_u32 s87, s87, 131072
    s_add_u32 m0, s86, 33792
    s_nop 0
    buffer_load_dwordx4 v140, s[8:11], s87 offen lds
    s_add_u32 s87, s87, 131072
    s_add_u32 m0, s86, 34816
    s_nop 0
    buffer_load_dwordx4 v140, s[8:11], s87 offen lds
    s_add_u32 s87, s87, 131072
    s_add_u32 m0, s86, 35840
    s_nop 0
    buffer_load_dwordx4 v140, s[8:11], s87 offen lds
    s_add_u32 s87, s87, 131072
    s_add_u32 m0, s86, 36864
    s_nop 0
    buffer_load_dwordx4 v140, s[8:11], s87 offen lds
    s_add_u32 s87, s87, 131072
    s_add_u32 m0, s86, 37888
    s_nop 0
    buffer_load_dwordx4 v140, s[8:11], s87 offen lds
    s_add_u32 s87, s87, 131072
    s_add_u32 m0, s86, 38912
    s_nop 0
    buffer_load_dwordx4 v140, s[8:11], s87 offen lds
    s_add_u32 s87, s87, 131072
    s_add_u32 m0, s86, 39936
    s_nop 0
    buffer_load_dwordx4 v140, s[8:11], s87 offen lds
    s_add_u32 s87, s87, 131072
    s_waitcnt vmcnt(36)
    ds_read_b64_tr_b16 a[64:65], v22 offset:0
    ds_read_b64_tr_b16 a[66:67], v22 offset:128
    ds_read_b64_tr_b16 a[68:69], v22 offset:1024
    ds_read_b64_tr_b16 a[70:71], v22 offset:1152
    s_waitcnt lgkmcnt(4)
    ds_read_b64_tr_b16 a[96:97], v22 offset:8
    ds_read_b64_tr_b16 a[98:99], v22 offset:136
    ds_read_b64_tr_b16 a[100:101], v22 offset:1032
    ds_read_b64_tr_b16 a[102:103], v22 offset:1160
    s_waitcnt vmcnt(32)
    ds_read_b64_tr_b16 a[72:73], v22 offset:4096
    ds_read_b64_tr_b16 a[74:75], v22 offset:4224
    ds_read_b64_tr_b16 a[76:77], v22 offset:5120
    ds_read_b64_tr_b16 a[78:79], v22 offset:5248
    s_waitcnt lgkmcnt(4)
    ds_read_b64_tr_b16 a[104:105], v22 offset:4104
    ds_read_b64_tr_b16 a[106:107], v22 offset:4232
    ds_read_b64_tr_b16 a[108:109], v22 offset:5128
    ds_read_b64_tr_b16 a[110:111], v22 offset:5256
    s_add_u32 m0, s86, 0
    s_nop 0
    buffer_load_dwordx4 v140, s[8:11], s87 offen lds
    s_add_u32 s87, s87, 131072
    s_add_u32 m0, s86, 1024
    s_nop 0
    buffer_load_dwordx4 v140, s[8:11], s87 offen lds
    s_add_u32 s87, s87, 131072
    s_add_u32 m0, s86, 2048
    s_nop 0
    buffer_load_dwordx4 v140, s[8:11], s87 offen lds
    s_add_u32 s87, s87, 131072
    s_add_u32 m0, s86, 3072
    s_nop 0
    buffer_load_dwordx4 v140, s[8:11], s87 offen lds
    s_add_u32 s87, s87, 131072
    s_waitcnt vmcnt(32)
    ds_read_b64_tr_b16 a[80:81], v22 offset:8192
    ds_read_b64_tr_b16 a[82:83], v22 offset:8320
    ds_read_b64_tr_b16 a[84:85], v22 offset:9216
    ds_read_b64_tr_b16 a[86:87], v22 offset:9344
    s_waitcnt lgkmcnt(4)
    ds_read_b64_tr_b16 a[112:113], v22 offset:8200
    ds_read_b64_tr_b16 a[114:115], v22 offset:8328
    ds_read_b64_tr_b16 a[116:117], v22 offset:9224
    ds_read_b64_tr_b16 a[118:119], v22 offset:9352
    s_add_u32 m0, s86, 4096
    s_nop 0
    buffer_load_dwordx4 v140, s[8:11], s87 offen lds
    s_add_u32 s87, s87, 131072
    s_add_u32 m0, s86, 5120
    s_nop 0
    buffer_load_dwordx4 v140, s[8:11], s87 offen lds
    s_add_u32 s87, s87, 131072
    s_add_u32 m0, s86, 6144
    s_nop 0
    buffer_load_dwordx4 v140, s[8:11], s87 offen lds
    s_add_u32 s87, s87, 131072
    s_add_u32 m0, s86, 7168
    s_nop 0
    buffer_load_dwordx4 v140, s[8:11], s87 offen lds
    s_add_u32 s87, s87, 131072
    s_waitcnt vmcnt(32)
    ds_read_b64_tr_b16 a[88:89], v22 offset:12288
    ds_read_b64_tr_b16 a[90:91], v22 offset:12416
    ds_read_b64_tr_b16 a[92:93], v22 offset:13312
    ds_read_b64_tr_b16 a[94:95], v22 offset:13440
    s_waitcnt lgkmcnt(4)
    ds_read_b64_tr_b16 a[120:121], v22 offset:12296
    ds_read_b64_tr_b16 a[122:123], v22 offset:12424
    ds_read_b64_tr_b16 a[124:125], v22 offset:13320
    ds_read_b64_tr_b16 a[126:127], v22 offset:13448
    s_mov_b32 s8, s36
    s_mov_b32 s9, s37
    s_lshl_b32 s87, s12, 21
    s_lshl_b32 s22, s14, 19
    s_add_u32 s87, s87, s22
    s_lshl_b32 s22, s13, 6
    s_add_u32 s87, s87, s22
    s_add_u32 m0, s86, 8192
    s_nop 0
    buffer_load_dwordx4 v141, s[8:11], s87 offen lds
    s_add_u32 s87, s87, 32768
    s_add_u32 m0, s86, 9216
    s_nop 0
    buffer_load_dwordx4 v141, s[8:11], s87 offen lds
    s_add_u32 s87, s87, 32768
    s_add_u32 m0, s86, 10240
    s_nop 0
    buffer_load_dwordx4 v141, s[8:11], s87 offen lds
    s_add_u32 s87, s87, 32768
    s_add_u32 m0, s86, 11264
    s_nop 0
    buffer_load_dwordx4 v141, s[8:11], s87 offen lds
    s_add_u32 s87, s87, 32768
    s_waitcnt vmcnt(32)
    ds_read_b64_tr_b16 a[128:129], v22 offset:16384
    ds_read_b64_tr_b16 a[130:131], v22 offset:16512
    ds_read_b64_tr_b16 a[132:133], v22 offset:17408
    ds_read_b64_tr_b16 a[134:135], v22 offset:17536
    s_waitcnt lgkmcnt(4)
    ds_read_b64_tr_b16 a[160:161], v22 offset:16392
    ds_read_b64_tr_b16 a[162:163], v22 offset:16520
    ds_read_b64_tr_b16 a[164:165], v22 offset:17416
    ds_read_b64_tr_b16 a[166:167], v22 offset:17544
    s_add_u32 m0, s86, 12288
    s_nop 0
    buffer_load_dwordx4 v141, s[8:11], s87 offen lds
    s_add_u32 s87, s87, 32768
    s_add_u32 m0, s86, 13312
    s_nop 0
    buffer_load_dwordx4 v141, s[8:11], s87 offen lds
    s_add_u32 s87, s87, 32768
    s_add_u32 m0, s86, 14336
    s_nop 0
    buffer_load_dwordx4 v141, s[8:11], s87 offen lds
    s_add_u32 s87, s87, 32768
    s_add_u32 m0, s86, 15360
    s_nop 0
    buffer_load_dwordx4 v141, s[8:11], s87 offen lds
    s_add_u32 s87, s87, 32768
    s_waitcnt vmcnt(32)
    ds_read_b64_tr_b16 a[136:137], v22 offset:20480
    ds_read_b64_tr_b16 a[138:139], v22 offset:20608
    ds_read_b64_tr_b16 a[140:141], v22 offset:21504
    ds_read_b64_tr_b16 a[142:143], v22 offset:21632
    s_waitcnt lgkmcnt(4)
    ds_read_b64_tr_b16 a[168:169], v22 offset:20488
    ds_read_b64_tr_b16 a[170:171], v22 offset:20616
    ds_read_b64_tr_b16 a[172:173], v22 offset:21512
    ds_read_b64_tr_b16 a[174:175], v22 offset:21640
    s_add_u32 m0, s86, 16384
    s_nop 0
    buffer_load_dwordx4 v141, s[8:11], s87 offen lds
    s_add_u32 s87, s87, 32768
    s_add_u32 m0, s86, 17408
    s_nop 0
    buffer_load_dwordx4 v141, s[8:11], s87 offen lds
    s_add_u32 s87, s87, 32768
    s_add_u32 m0, s86, 18432
    s_nop 0
    buffer_load_dwordx4 v141, s[8:11], s87 offen lds
    s_add_u32 s87, s87, 32768
    s_add_u32 m0, s86, 19456
    s_nop 0
    buffer_load_dwordx4 v141, s[8:11], s87 offen lds
    s_add_u32 s87, s87, 32768
    s_waitcnt vmcnt(32)
    ds_read_b64_tr_b16 a[144:145], v22 offset:24576
    ds_read_b64_tr_b16 a[146:147], v22 offset:24704
    ds_read_b64_tr_b16 a[148:149], v22 offset:25600
    ds_read_b64_tr_b16 a[150:151], v22 offset:25728
    s_waitcnt lgkmcnt(4)
    ds_read_b64_tr_b16 a[176:177], v22 offset:24584
    ds_read_b64_tr_b16 a[178:179], v22 offset:24712
    ds_read_b64_tr_b16 a[180:181], v22 offset:25608
    ds_read_b64_tr_b16 a[182:183], v22 offset:25736
    s_add_u32 m0, s86, 20480
    s_nop 0
    buffer_load_dwordx4 v141, s[8:11], s87 offen lds
    s_add_u32 s87, s87, 32768
    s_add_u32 m0, s86, 21504
    s_nop 0
    buffer_load_dwordx4 v141, s[8:11], s87 offen lds
    s_add_u32 s87, s87, 32768
    s_add_u32 m0, s86, 22528
    s_nop 0
    buffer_load_dwordx4 v141, s[8:11], s87 offen lds
    s_add_u32 s87, s87, 32768
    s_add_u32 m0, s86, 23552
    s_nop 0
    buffer_load_dwordx4 v141, s[8:11], s87 offen lds
    s_add_u32 s87, s87, 32768
    s_waitcnt vmcnt(32)
    ds_read_b64_tr_b16 a[152:153], v22 offset:28672
    ds_read_b64_tr_b16 a[154:155], v22 offset:28800
    ds_read_b64_tr_b16 a[156:157], v22 offset:29696
    ds_read_b64_tr_b16 a[158:159], v22 offset:29824
    s_waitcnt lgkmcnt(4)
    ds_read_b64_tr_b16 a[184:185], v22 offset:28680
    ds_read_b64_tr_b16 a[186:187], v22 offset:28808
    ds_read_b64_tr_b16 a[188:189], v22 offset:29704
    ds_read_b64_tr_b16 a[190:191], v22 offset:29832
    s_waitcnt vmcnt(28)
    ds_read_b64_tr_b16 a[0:1], v22 offset:32768
    ds_read_b64_tr_b16 a[2:3], v22 offset:32896
    ds_read_b64_tr_b16 a[4:5], v22 offset:33792
    ds_read_b64_tr_b16 a[6:7], v22 offset:33920
    s_waitcnt lgkmcnt(4)
    ds_read_b64_tr_b16 a[32:33], v22 offset:32776
    ds_read_b64_tr_b16 a[34:35], v22 offset:32904
    ds_read_b64_tr_b16 a[36:37], v22 offset:33800
    ds_read_b64_tr_b16 a[38:39], v22 offset:33928
    s_waitcnt vmcnt(24)
    ds_read_b64_tr_b16 a[8:9], v22 offset:36864
    ds_read_b64_tr_b16 a[10:11], v22 offset:36992
    ds_read_b64_tr_b16 a[12:13], v22 offset:37888
    ds_read_b64_tr_b16 a[14:15], v22 offset:38016
    s_waitcnt lgkmcnt(4)
    ds_read_b64_tr_b16 a[40:41], v22 offset:36872
    ds_read_b64_tr_b16 a[42:43], v22 offset:37000
    ds_read_b64_tr_b16 a[44:45], v22 offset:37896
    ds_read_b64_tr_b16 a[46:47], v22 offset:38024
    s_waitcnt vmcnt(20)
    ds_read_b64_tr_b16 a[16:17], v22 offset:0
    ds_read_b64_tr_b16 a[18:19], v22 offset:128
    ds_read_b64_tr_b16 a[20:21], v22 offset:1024
    ds_read_b64_tr_b16 a[22:23], v22 offset:1152
    s_waitcnt lgkmcnt(4)
    ds_read_b64_tr_b16 a[48:49], v22 offset:8
    ds_read_b64_tr_b16 a[50:51], v22 offset:136
    ds_read_b64_tr_b16 a[52:53], v22 offset:1032
    ds_read_b64_tr_b16 a[54:55], v22 offset:1160
    s_waitcnt vmcnt(16)
    ds_read_b64_tr_b16 a[24:25], v22 offset:4096
    ds_read_b64_tr_b16 a[26:27], v22 offset:4224
    ds_read_b64_tr_b16 a[28:29], v22 offset:5120
    ds_read_b64_tr_b16 a[30:31], v22 offset:5248
    s_waitcnt lgkmcnt(4)
    ds_read_b64_tr_b16 a[56:57], v22 offset:4104
    ds_read_b64_tr_b16 a[58:59], v22 offset:4232
    ds_read_b64_tr_b16 a[60:61], v22 offset:5128
    ds_read_b64_tr_b16 a[62:63], v22 offset:5256
    s_waitcnt vmcnt(12)
    ds_read_b64_tr_b16 a[192:193], v22 offset:8192
    ds_read_b64_tr_b16 a[194:195], v22 offset:8320
    ds_read_b64_tr_b16 a[196:197], v22 offset:9216
    ds_read_b64_tr_b16 a[198:199], v22 offset:9344
    s_waitcnt lgkmcnt(4)
    ds_read_b64_tr_b16 a[224:225], v22 offset:8200
    ds_read_b64_tr_b16 a[226:227], v22 offset:8328
    ds_read_b64_tr_b16 a[228:229], v22 offset:9224
    ds_read_b64_tr_b16 a[230:231], v22 offset:9352
    s_waitcnt vmcnt(8)
    ds_read_b64_tr_b16 a[200:201], v22 offset:12288
    ds_read_b64_tr_b16 a[202:203], v22 offset:12416
    ds_read_b64_tr_b16 a[204:205], v22 offset:13312
    ds_read_b64_tr_b16 a[206:207], v22 offset:13440
    s_waitcnt lgkmcnt(4)
    ds_read_b64_tr_b16 a[232:233], v22 offset:12296
    ds_read_b64_tr_b16 a[234:235], v22 offset:12424
    ds_read_b64_tr_b16 a[236:237], v22 offset:13320
    ds_read_b64_tr_b16 a[238:239], v22 offset:13448
    s_waitcnt vmcnt(4)
    ds_read_b64_tr_b16 a[208:209], v22 offset:16384
    ds_read_b64_tr_b16 a[210:211], v22 offset:16512
    ds_read_b64_tr_b16 a[212:213], v22 offset:17408
    ds_read_b64_tr_b16 a[214:215], v22 offset:17536
    s_waitcnt lgkmcnt(4)
    ds_read_b64_tr_b16 a[240:241], v22 offset:16392
    ds_read_b64_tr_b16 a[242:243], v22 offset:16520
    ds_read_b64_tr_b16 a[244:245], v22 offset:17416
    ds_read_b64_tr_b16 a[246:247], v22 offset:17544
    s_waitcnt vmcnt(0)
    ds_read_b64_tr_b16 a[216:217], v22 offset:20480
    ds_read_b64_tr_b16 a[218:219], v22 offset:20608
    ds_read_b64_tr_b16 a[220:221], v22 offset:21504
    ds_read_b64_tr_b16 a[222:223], v22 offset:21632
    s_waitcnt lgkmcnt(4)
    ds_read_b64_tr_b16 a[248:249], v22 offset:20488
    ds_read_b64_tr_b16 a[250:251], v22 offset:20616
    ds_read_b64_tr_b16 a[252:253], v22 offset:21512
    ds_read_b64_tr_b16 a[254:255], v22 offset:21640
    s_waitcnt lgkmcnt(0)
    v_mov_b32 v155, 0
    v_mov_b32 v159, 0
    v_mov_b32 v163, 0
    v_mov_b32 v167, 0
    v_mov_b32 v179, 0
    s_mov_b32 s8, s28
    s_mov_b32 s9, s29
    s_mov_b32 s10, 16384
    v_lshlrev_b32 v20, 11, v96
    v_lshl_add_u32 v20, v98, 4, v20
    v_lshl_add_u32 v20, v97, 3, v20
    s_lshl_b32 s21, s13, 6
    buffer_load_dwordx2 v[88:89], v20, s[8:11], s21 offen
    v_lshlrev_b32 v20, 2, v1
    s_mov_b32 s22, 0
rdv_21:
    global_load_dword v21, v20, s[100:101] sc1
    s_lshl_b32 s21, s98, 2
    s_waitcnt vmcnt(0)
    v_lshrrev_b32 v22, s21, v21
    s_cmp_eq_u32 s98, 0
    s_cselect_b32 s21, 0x0f0f0f0f, s21
    s_cselect_b32 s21, s21, 0x01010101
    v_and_b32 v22, s21, v22
    v_cmp_ne_u32 vcc, 0x01010101, v22
    s_nop 0
    s_cbranch_vccz rdvok_22
    v_sad_u8 v22, v22, 0, 0
    s_nop 1
    v_add_u32_dpp v22, v22, v22 quad_perm:[1,0,3,2] row_mask:0xf bank_mask:0xf
    v_cmp_ne_u32 vcc, 8, v22
    s_nop 0
    s_cbranch_vccnz rdvw_23
    s_mov_b32 s98, 1
    s_and_b32 s3, s97, 7
    s_barrier
    s_branch role_start
rdvw_23:
    s_sleep 4
    s_add_u32 s22, s22, 1
    s_cmp_lt_u32 s22, 262144
    s_cbranch_scc1 rdv_21
    s_mov_b32 s25, 200000
rdvok_22:
    v_and_b32 v22, 0x40404040, v21
    v_bcnt_u32_b32 v22, v22, 0
    s_mov_b32 s46, 0
    v_cmp_le_u32 vcc, 1, v22
    s_nop 0
    s_bcnt1_i32_b64 s21, vcc
    s_add_u32 s46, s46, s21
    v_cmp_le_u32 vcc, 2, v22
    s_nop 0
    s_bcnt1_i32_b64 s21, vcc
    s_add_u32 s46, s46, s21
    v_cmp_le_u32 vcc, 3, v22
    s_nop 0
    s_bcnt1_i32_b64 s21, vcc
    s_add_u32 s46, s46, s21
    v_cmp_le_u32 vcc, 4, v22
    s_nop 0
    s_bcnt1_i32_b64 s21, vcc
    s_add_u32 s46, s46, s21
    s_cmp_gt_u32 s46, 16
    s_cselect_b32 s46, 8192, 0
    s_add_u32 s84, s95, s46
    s_xor_b32 s45, s98, 1
    v_min_u32 v88, -2, v88
    v_min_u32 v89, -2, v89
    buffer_store_dwordx2 v[88:89], v11, s[4:7], s16 offen sc1
    v_mov_b32 v40, 0
    v_mov_b32 v41, 0
    v_mov_b32 v42, 0
    v_mov_b32 v43, 0
    v_mov_b32 v44, 0
    v_mov_b32 v45, 0
    v_mov_b32 v46, 0
    v_mov_b32 v47, 0
    v_mov_b32 v48, 0
    v_mov_b32 v49, 0
    v_mov_b32 v50, 0
    v_mov_b32 v51, 0
    v_mov_b32 v52, 0
    v_mov_b32 v53, 0
    v_mov_b32 v54, 0
    v_mov_b32 v55, 0
    v_mov_b32 v56, 0
    v_mov_b32 v57, 0
    v_mov_b32 v58, 0
    v_mov_b32 v59, 0
    v_mov_b32 v60, 0
    v_mov_b32 v61, 0
    v_mov_b32 v62, 0
    v_mov_b32 v63, 0
    v_mov_b32 v64, 0
    v_mov_b32 v65, 0
    v_mov_b32 v66, 0
    v_mov_b32 v67, 0
    v_mov_b32 v68, 0
    v_mov_b32 v69, 0
    v_mov_b32 v70, 0
    v_mov_b32 v71, 0
    s_cmp_ge_u32 s14, 2
    s_cbranch_scc1 kv_24
    s_mov_b32 s94, 1
    s_mov_b32 s23, s25
fw_26:
    s_cmp_ge_u32 s85, s94
    s_cbranch_scc1 fo_27
    buffer_load_dword v247, v245, s[4:7], 0 offen sc1
    s_add_u32 s23, s23, 1
    s_waitcnt vmcnt(0)
    v_readfirstlane_b32 s85, v247
    s_cmp_lt_u32 s23, 200000
    s_cbranch_scc1 fw_26
    s_mov_b32 s25, 200000
fo_27:
    s_cmp_eq_u32 s14, 1
    s_cbranch_scc1 kv_25
    buffer_load_dwordx4 v[132:135], v12, s[4:7], s17 offen sc1
    buffer_load_dwordx4 v[136:139], v12, s[4:7], s17 offen offset:256 sc1
    s_add_u32 s17, s17, 2048
    s_min_u32 s17, s17, 17954816
    s_branch kv_24
kv_25:
    buffer_load_dwordx4 v[228:231], v13, s[4:7], s18 offen offset:0 sc1
    buffer_load_dwordx4 v[232:235], v13, s[4:7], s18 offen offset:256 sc1
    s_add_u32 s18, s18, 2048
    s_min_u32 s18, s18, 35780608
kv_24:
    s_mov_b32 s23, s25
    s_barrier
    s_cmp_eq_u32 s45, 0
    s_cbranch_scc1 recur_slow_disp
    s_cmp_eq_u32 s14, 1
    s_cbranch_scc1 recur_fast_w1
    s_cmp_eq_u32 s14, 2
    s_cbranch_scc1 recur_fast_w2
    s_cmp_eq_u32 s14, 3
    s_cbranch_scc1 recur_fast_w3
    s_branch recur_fast_w0
recur_slow_disp:
    s_cmp_eq_u32 s14, 1
    s_cbranch_scc1 recur_slow_w1
    s_cmp_eq_u32 s14, 2
    s_cbranch_scc1 recur_slow_w2
    s_cmp_eq_u32 s14, 3
    s_cbranch_scc1 recur_slow_w3
    s_branch recur_slow_w0
.p2align 6
recur_fast_w0:
    s_nop 15
    s_mov_b32 s23, s25
    buffer_load_dwordx4 v[24:27], v2, s[4:7], s16 offen offset:0 sc1
    s_nop 11
    buffer_load_dwordx4 v[28:31], v2, s[4:7], s16 offen offset:1024 sc1
    s_nop 11
    buffer_load_dwordx4 v[32:35], v2, s[4:7], s16 offen offset:2048 sc1
    s_nop 11
    buffer_load_dwordx4 v[36:39], v2, s[4:7], s16 offen offset:3072 sc1
    s_waitcnt vmcnt(3)
    v_max3_u32 v19, v24, v25, v26
    v_max_u32 v19, v19, v27
    v_cmp_eq_u32 vcc, -1, v19
    s_nop 0
    s_cbranch_vccnz g_28F15_0
    v_smfmac_f32_16x16x64_bf16 v[40:43], v[24:27], a[0:7], v172
    s_waitcnt vmcnt(2)
    v_max3_u32 v19, v28, v29, v30
    v_max_u32 v19, v19, v31
    v_smfmac_f32_16x16x64_bf16 v[44:47], v[24:27], a[64:71], v172
    v_cmp_eq_u32 vcc, -1, v19
    v_smfmac_f32_16x16x64_bf16 v[48:51], v[24:27], a[32:39], v172
    v_smfmac_f32_16x16x64_bf16 v[52:55], v[24:27], a[96:103], v172
    s_cbranch_vccnz g_28F14_1
    v_smfmac_f32_16x16x64_bf16 v[40:43], v[28:31], a[8:15], v172
    s_waitcnt vmcnt(1)
    v_max3_u32 v19, v32, v33, v34
    v_max_u32 v19, v19, v35
    v_smfmac_f32_16x16x64_bf16 v[44:47], v[28:31], a[72:79], v172
    v_cmp_eq_u32 vcc, -1, v19
    v_smfmac_f32_16x16x64_bf16 v[48:51], v[28:31], a[40:47], v172
    v_smfmac_f32_16x16x64_bf16 v[52:55], v[28:31], a[104:111], v172
    s_cbranch_vccnz g_28F12_2
    v_smfmac_f32_16x16x64_bf16 v[40:43], v[32:35], a[16:23], v172
    s_waitcnt vmcnt(0)
    v_max3_u32 v19, v36, v37, v38
    v_max_u32 v19, v19, v39
    v_smfmac_f32_16x16x64_bf16 v[44:47], v[32:35], a[80:87], v172
    v_cmp_eq_u32 vcc, -1, v19
    v_smfmac_f32_16x16x64_bf16 v[48:51], v[32:35], a[48:55], v172
    v_smfmac_f32_16x16x64_bf16 v[52:55], v[32:35], a[112:119], v172
    s_cbranch_vccnz g_28F8_3
    v_smfmac_f32_16x16x64_bf16 v[40:43], v[36:39], a[24:31], v172
    v_smfmac_f32_16x16x64_bf16 v[44:47], v[36:39], a[88:95], v172
    v_smfmac_f32_16x16x64_bf16 v[48:51], v[36:39], a[56:63], v172
    v_smfmac_f32_16x16x64_bf16 v[52:55], v[36:39], a[120:127], v172
gc_29:
    v_cvt_pk_bf16_f32 v72, v40, v41
    v_cvt_pk_bf16_f32 v73, v42, v43
    v_cvt_pk_bf16_f32 v74, v44, v45
    v_cvt_pk_bf16_f32 v75, v46, v47
    v_smfmac_f32_16x16x64_bf16 v[56:59], v[24:27], a[128:135], v172
    v_cvt_pk_bf16_f32 v76, v48, v49
    v_cvt_pk_bf16_f32 v77, v50, v51
    s_nop 0
    v_cvt_pk_bf16_f32 v78, v52, v53
    v_cvt_pk_bf16_f32 v79, v54, v55
    v_smfmac_f32_16x16x64_bf16 v[60:63], v[24:27], a[160:167], v172
    v_mfma_f32_16x16x32_bf16 v[88:91], v[72:75], v[84:87], 0
    v_mfma_f32_16x16x32_bf16 v[92:95], v[76:79], v[84:87], 0
    v_smfmac_f32_16x16x64_bf16 v[56:59], v[28:31], a[136:143], v172
    v_smfmac_f32_16x16x64_bf16 v[60:63], v[28:31], a[168:175], v172
    s_barrier
    ds_read_b128 v[104:107], v16 offset:2048
    ds_read_b128 v[108:111], v16 offset:3072
    ds_read_b128 v[112:115], v16 offset:4096
    ds_read_b128 v[116:119], v16 offset:5120
    ds_read_b128 v[120:123], v16 offset:6144
    ds_read_b128 v[124:127], v16 offset:7168
    v_smfmac_f32_16x16x64_bf16 v[56:59], v[32:35], a[144:151], v172
    v_smfmac_f32_16x16x64_bf16 v[60:63], v[32:35], a[176:183], v172
    v_smfmac_f32_16x16x64_bf16 v[56:59], v[36:39], a[152:159], v172
    v_smfmac_f32_16x16x64_bf16 v[60:63], v[36:39], a[184:191], v172
    s_waitcnt lgkmcnt(5)
    v_mfma_f32_16x16x32_bf16 v[88:91], v[104:107], v[84:87], v[88:91]
    s_waitcnt lgkmcnt(4)
    v_mfma_f32_16x16x32_bf16 v[92:95], v[108:111], v[84:87], v[92:95]
    s_waitcnt lgkmcnt(3)
    v_mfma_f32_16x16x32_bf16 v[88:91], v[112:115], v[84:87], v[88:91]
    s_waitcnt lgkmcnt(2)
    v_mfma_f32_16x16x32_bf16 v[92:95], v[116:119], v[84:87], v[92:95]
    s_waitcnt lgkmcnt(1)
    v_mfma_f32_16x16x32_bf16 v[88:91], v[120:123], v[84:87], v[88:91]
    s_waitcnt lgkmcnt(0)
    v_mfma_f32_16x16x32_bf16 v[92:95], v[124:127], v[84:87], v[92:95]
    v_cvt_pk_bf16_f32 v80, v56, v57
    v_cvt_pk_bf16_f32 v81, v58, v59
    v_cvt_pk_bf16_f32 v82, v60, v61
    v_cvt_pk_bf16_f32 v83, v62, v63
    ds_write_b128 v17, v[80:83] offset:8192
    s_nop 0
    v_cvt_pk_bf16_f32 v128, v88, v89
    v_cvt_pk_bf16_f32 v129, v90, v91
    v_cvt_pk_bf16_f32 v130, v92, v93
    v_cvt_pk_bf16_f32 v131, v94, v95
    s_nop 1
    v_mfma_f32_16x16x32_bf16 v[144:147], v[132:135], v[128:131], 0
    v_mfma_f32_16x16x32_bf16 v[148:151], v[136:139], v[128:131], 0
    v_mfma_f32_16x16x32_bf16 v[140:143], v[128:131], v[128:131], 0
    s_nop 1
    buffer_store_dwordx4 v[144:147], v3, s[4:7], s16 offen
    s_nop 1
    buffer_store_dwordx4 v[148:151], v3, s[4:7], s16 offen offset:128
    s_nop 1
    buffer_store_dwordx4 v[140:143], v4, s[4:7], s16 offen
    s_cmp_eq_u32 s15, 63
    s_waitcnt lgkmcnt(0)
    s_barrier
    s_cbranch_scc1 recur_fast_last0
    v_readfirstlane_b32 s85, v247
    s_add_u32 s94, s15, 2
    s_barrier
    s_nop 15
    s_mov_b32 s23, s25
    buffer_load_dwordx4 v[24:27], v8, s[4:7], s16 offen offset:0 sc1
    s_nop 11
    buffer_load_dwordx4 v[28:31], v8, s[4:7], s16 offen offset:1024 sc1
    s_nop 11
    buffer_load_dwordx4 v[32:35], v8, s[4:7], s16 offen offset:2048 sc1
    s_nop 11
    buffer_load_dwordx4 v[36:39], v8, s[4:7], s16 offen offset:3072 sc1
    s_waitcnt vmcnt(3)
    v_max3_u32 v19, v24, v25, v26
    v_max_u32 v19, v19, v27
    v_cmp_eq_u32 vcc, -1, v19
    s_nop 0
    s_cbranch_vccnz g_30F15_0
    v_smfmac_f32_16x16x64_bf16 v[64:67], v[24:27], a[192:199], v172
    v_smfmac_f32_16x16x64_bf16 v[68:71], v[24:27], a[224:231], v172
    s_waitcnt vmcnt(2)
    v_max3_u32 v19, v28, v29, v30
    v_max_u32 v19, v19, v31
    v_cmp_eq_u32 vcc, -1, v19
    s_nop 0
    s_cbranch_vccnz g_30F14_1
    v_smfmac_f32_16x16x64_bf16 v[64:67], v[28:31], a[200:207], v172
    v_smfmac_f32_16x16x64_bf16 v[68:71], v[28:31], a[232:239], v172
    s_waitcnt vmcnt(1)
    v_max3_u32 v19, v32, v33, v34
    v_max_u32 v19, v19, v35
    v_cmp_eq_u32 vcc, -1, v19
    s_nop 0
    s_cbranch_vccnz g_30F12_2
    v_smfmac_f32_16x16x64_bf16 v[64:67], v[32:35], a[208:215], v172
    v_smfmac_f32_16x16x64_bf16 v[68:71], v[32:35], a[240:247], v172
    s_waitcnt vmcnt(0)
    v_max3_u32 v19, v36, v37, v38
    v_max_u32 v19, v19, v39
    v_cmp_eq_u32 vcc, -1, v19
    s_nop 0
    s_cbranch_vccnz g_30F8_3
    v_smfmac_f32_16x16x64_bf16 v[64:67], v[36:39], a[216:223], v172
    v_smfmac_f32_16x16x64_bf16 v[68:71], v[36:39], a[248:255], v172
    s_nop 4
    v_cvt_pk_bf16_f32 v80, v64, v65
    v_cvt_pk_bf16_f32 v81, v66, v67
    s_nop 0
    v_cvt_pk_bf16_f32 v82, v68, v69
    v_cvt_pk_bf16_f32 v83, v70, v71
    ds_write_b128 v17, v[80:83] offset:9216
gc_31:
    s_waitcnt lgkmcnt(0)
    s_barrier
    s_nop 15
    s_nop 15
    s_nop 15
    s_nop 15
    buffer_store_dwordx4 v[128:131], v14, s[4:7], s19 offen sc1
    s_add_u32 s19, s19, 512
    s_mov_b32 s23, s25
fw_32:
    s_cmp_ge_u32 s85, s94
    s_cbranch_scc1 fo_33
    buffer_load_dword v247, v245, s[4:7], 0 offen sc1
    s_add_u32 s23, s23, 1
    s_waitcnt vmcnt(0)
    v_readfirstlane_b32 s85, v247
    s_cmp_lt_u32 s23, 200000
    s_cbranch_scc1 fw_32
    s_mov_b32 s25, 200000
fo_33:
    buffer_load_dwordx4 v[132:135], v12, s[4:7], s17 offen sc1
    buffer_load_dwordx4 v[136:139], v12, s[4:7], s17 offen offset:256 sc1
    s_add_u32 s17, s17, 2048
    s_min_u32 s17, s17, 17954816
    buffer_load_dword v247, v245, s[4:7], 0 offen sc1
    v_mov_b32 v40, 0
    v_mov_b32 v41, 0
    v_mov_b32 v42, 0
    v_mov_b32 v43, 0
    v_mov_b32 v44, 0
    v_mov_b32 v45, 0
    v_mov_b32 v46, 0
    v_mov_b32 v47, 0
    v_mov_b32 v48, 0
    v_mov_b32 v49, 0
    v_mov_b32 v50, 0
    v_mov_b32 v51, 0
    v_mov_b32 v52, 0
    v_mov_b32 v53, 0
    v_mov_b32 v54, 0
    v_mov_b32 v55, 0
    v_mov_b32 v56, 0
    v_mov_b32 v57, 0
    v_mov_b32 v58, 0
    v_mov_b32 v59, 0
    v_mov_b32 v60, 0
    v_mov_b32 v61, 0
    v_mov_b32 v62, 0
    v_mov_b32 v63, 0
    v_mov_b32 v64, 0
    v_mov_b32 v65, 0
    v_mov_b32 v66, 0
    v_mov_b32 v67, 0
    v_mov_b32 v68, 0
    v_mov_b32 v69, 0
    v_mov_b32 v70, 0
    v_mov_b32 v71, 0
    s_mov_b32 s21, s16
    s_mov_b32 s16, s42
    s_mov_b32 s42, s43
    s_mov_b32 s43, s44
    s_mov_b32 s44, s21
    s_add_u32 s95, s95, 524288
    s_lshr_b32 s84, s95, 8
    s_and_b32 s84, s84, 8192
    s_xor_b32 s84, s84, s46
    s_add_u32 s84, s84, s95
    s_add_u32 s15, s15, 1
    s_barrier
    s_branch recur_fast_w0
g_28L15_0:
    s_waitcnt vmcnt(3)
    v_max3_u32 v19, v24, v25, v26
    v_max_u32 v19, v19, v27
    v_cmp_eq_u32 vcc, -1, v19
    s_nop 0
    s_cbranch_vccnz g_28F15_0
    v_smfmac_f32_16x16x64_bf16 v[40:43], v[24:27], a[0:7], v172
    v_smfmac_f32_16x16x64_bf16 v[44:47], v[24:27], a[64:71], v172
    v_smfmac_f32_16x16x64_bf16 v[48:51], v[24:27], a[32:39], v172
    v_smfmac_f32_16x16x64_bf16 v[52:55], v[24:27], a[96:103], v172
g_28L14_1:
    s_waitcnt vmcnt(2)
    v_max3_u32 v19, v28, v29, v30
    v_max_u32 v19, v19, v31
    v_cmp_eq_u32 vcc, -1, v19
    s_nop 0
    s_cbranch_vccnz g_28F14_1
    v_smfmac_f32_16x16x64_bf16 v[40:43], v[28:31], a[8:15], v172
    v_smfmac_f32_16x16x64_bf16 v[44:47], v[28:31], a[72:79], v172
    v_smfmac_f32_16x16x64_bf16 v[48:51], v[28:31], a[40:47], v172
    v_smfmac_f32_16x16x64_bf16 v[52:55], v[28:31], a[104:111], v172
g_28L12_2:
    s_waitcnt vmcnt(1)
    v_max3_u32 v19, v32, v33, v34
    v_max_u32 v19, v19, v35
    v_cmp_eq_u32 vcc, -1, v19
    s_nop 0
    s_cbranch_vccnz g_28F12_2
    v_smfmac_f32_16x16x64_bf16 v[40:43], v[32:35], a[16:23], v172
    v_smfmac_f32_16x16x64_bf16 v[44:47], v[32:35], a[80:87], v172
    v_smfmac_f32_16x16x64_bf16 v[48:51], v[32:35], a[48:55], v172
    v_smfmac_f32_16x16x64_bf16 v[52:55], v[32:35], a[112:119], v172
g_28L8_3:
    s_waitcnt vmcnt(0)
    v_max3_u32 v19, v36, v37, v38
    v_max_u32 v19, v19, v39
    v_cmp_eq_u32 vcc, -1, v19
    s_nop 0
    s_cbranch_vccnz g_28F8_3
    v_smfmac_f32_16x16x64_bf16 v[40:43], v[36:39], a[24:31], v172
    v_smfmac_f32_16x16x64_bf16 v[44:47], v[36:39], a[88:95], v172
    v_smfmac_f32_16x16x64_bf16 v[48:51], v[36:39], a[56:63], v172
    v_smfmac_f32_16x16x64_bf16 v[52:55], v[36:39], a[120:127], v172
    s_branch gc_29
g_28L15_1:
    s_waitcnt vmcnt(3)
    v_max3_u32 v19, v28, v29, v30
    v_max_u32 v19, v19, v31
    v_cmp_eq_u32 vcc, -1, v19
    s_nop 0
    s_cbranch_vccnz g_28F15_1
    v_smfmac_f32_16x16x64_bf16 v[40:43], v[28:31], a[8:15], v172
    v_smfmac_f32_16x16x64_bf16 v[44:47], v[28:31], a[72:79], v172
    v_smfmac_f32_16x16x64_bf16 v[48:51], v[28:31], a[40:47], v172
    v_smfmac_f32_16x16x64_bf16 v[52:55], v[28:31], a[104:111], v172
g_28L13_2:
    s_waitcnt vmcnt(2)
    v_max3_u32 v19, v32, v33, v34
    v_max_u32 v19, v19, v35
    v_cmp_eq_u32 vcc, -1, v19
    s_nop 0
    s_cbranch_vccnz g_28F13_2
    v_smfmac_f32_16x16x64_bf16 v[40:43], v[32:35], a[16:23], v172
    v_smfmac_f32_16x16x64_bf16 v[44:47], v[32:35], a[80:87], v172
    v_smfmac_f32_16x16x64_bf16 v[48:51], v[32:35], a[48:55], v172
    v_smfmac_f32_16x16x64_bf16 v[52:55], v[32:35], a[112:119], v172
g_28L9_3:
    s_waitcnt vmcnt(1)
    v_max3_u32 v19, v36, v37, v38
    v_max_u32 v19, v19, v39
    v_cmp_eq_u32 vcc, -1, v19
    s_nop 0
    s_cbranch_vccnz g_28F9_3
    v_smfmac_f32_16x16x64_bf16 v[40:43], v[36:39], a[24:31], v172
    v_smfmac_f32_16x16x64_bf16 v[44:47], v[36:39], a[88:95], v172
    v_smfmac_f32_16x16x64_bf16 v[48:51], v[36:39], a[56:63], v172
    v_smfmac_f32_16x16x64_bf16 v[52:55], v[36:39], a[120:127], v172
g_28L1_0:
    s_waitcnt vmcnt(0)
    v_max3_u32 v19, v24, v25, v26
    v_max_u32 v19, v19, v27
    v_cmp_eq_u32 vcc, -1, v19
    s_nop 0
    s_cbranch_vccnz g_28F1_0
    v_smfmac_f32_16x16x64_bf16 v[40:43], v[24:27], a[0:7], v172
    v_smfmac_f32_16x16x64_bf16 v[44:47], v[24:27], a[64:71], v172
    v_smfmac_f32_16x16x64_bf16 v[48:51], v[24:27], a[32:39], v172
    v_smfmac_f32_16x16x64_bf16 v[52:55], v[24:27], a[96:103], v172
    s_branch gc_29
g_28L15_2:
    s_waitcnt vmcnt(3)
    v_max3_u32 v19, v32, v33, v34
    v_max_u32 v19, v19, v35
    v_cmp_eq_u32 vcc, -1, v19
    s_nop 0
    s_cbranch_vccnz g_28F15_2
    v_smfmac_f32_16x16x64_bf16 v[40:43], v[32:35], a[16:23], v172
    v_smfmac_f32_16x16x64_bf16 v[44:47], v[32:35], a[80:87], v172
    v_smfmac_f32_16x16x64_bf16 v[48:51], v[32:35], a[48:55], v172
    v_smfmac_f32_16x16x64_bf16 v[52:55], v[32:35], a[112:119], v172
g_28L11_3:
    s_waitcnt vmcnt(2)
    v_max3_u32 v19, v36, v37, v38
    v_max_u32 v19, v19, v39
    v_cmp_eq_u32 vcc, -1, v19
    s_nop 0
    s_cbranch_vccnz g_28F11_3
    v_smfmac_f32_16x16x64_bf16 v[40:43], v[36:39], a[24:31], v172
    v_smfmac_f32_16x16x64_bf16 v[44:47], v[36:39], a[88:95], v172
    v_smfmac_f32_16x16x64_bf16 v[48:51], v[36:39], a[56:63], v172
    v_smfmac_f32_16x16x64_bf16 v[52:55], v[36:39], a[120:127], v172
g_28L3_0:
    s_waitcnt vmcnt(1)
    v_max3_u32 v19, v24, v25, v26
    v_max_u32 v19, v19, v27
    v_cmp_eq_u32 vcc, -1, v19
    s_nop 0
    s_cbranch_vccnz g_28F3_0
    v_smfmac_f32_16x16x64_bf16 v[40:43], v[24:27], a[0:7], v172
    v_smfmac_f32_16x16x64_bf16 v[44:47], v[24:27], a[64:71], v172
    v_smfmac_f32_16x16x64_bf16 v[48:51], v[24:27], a[32:39], v172
    v_smfmac_f32_16x16x64_bf16 v[52:55], v[24:27], a[96:103], v172
g_28L2_1:
    s_waitcnt vmcnt(0)
    v_max3_u32 v19, v28, v29, v30
    v_max_u32 v19, v19, v31
    v_cmp_eq_u32 vcc, -1, v19
    s_nop 0
    s_cbranch_vccnz g_28F2_1
    v_smfmac_f32_16x16x64_bf16 v[40:43], v[28:31], a[8:15], v172
    v_smfmac_f32_16x16x64_bf16 v[44:47], v[28:31], a[72:79], v172
    v_smfmac_f32_16x16x64_bf16 v[48:51], v[28:31], a[40:47], v172
    v_smfmac_f32_16x16x64_bf16 v[52:55], v[28:31], a[104:111], v172
    s_branch gc_29
g_28L15_3:
    s_waitcnt vmcnt(3)
    v_max3_u32 v19, v36, v37, v38
    v_max_u32 v19, v19, v39
    v_cmp_eq_u32 vcc, -1, v19
    s_nop 0
    s_cbranch_vccnz g_28F15_3
    v_smfmac_f32_16x16x64_bf16 v[40:43], v[36:39], a[24:31], v172
    v_smfmac_f32_16x16x64_bf16 v[44:47], v[36:39], a[88:95], v172
    v_smfmac_f32_16x16x64_bf16 v[48:51], v[36:39], a[56:63], v172
    v_smfmac_f32_16x16x64_bf16 v[52:55], v[36:39], a[120:127], v172
g_28L7_0:
    s_waitcnt vmcnt(2)
    v_max3_u32 v19, v24, v25, v26
    v_max_u32 v19, v19, v27
    v_cmp_eq_u32 vcc, -1, v19
    s_nop 0
    s_cbranch_vccnz g_28F7_0
    v_smfmac_f32_16x16x64_bf16 v[40:43], v[24:27], a[0:7], v172
    v_smfmac_f32_16x16x64_bf16 v[44:47], v[24:27], a[64:71], v172
    v_smfmac_f32_16x16x64_bf16 v[48:51], v[24:27], a[32:39], v172
    v_smfmac_f32_16x16x64_bf16 v[52:55], v[24:27], a[96:103], v172
g_28L6_1:
    s_waitcnt vmcnt(1)
    v_max3_u32 v19, v28, v29, v30
    v_max_u32 v19, v19, v31
    v_cmp_eq_u32 vcc, -1, v19
    s_nop 0
    s_cbranch_vccnz g_28F6_1
    v_smfmac_f32_16x16x64_bf16 v[40:43], v[28:31], a[8:15], v172
    v_smfmac_f32_16x16x64_bf16 v[44:47], v[28:31], a[72:79], v172
    v_smfmac_f32_16x16x64_bf16 v[48:51], v[28:31], a[40:47], v172
    v_smfmac_f32_16x16x64_bf16 v[52:55], v[28:31], a[104:111], v172
g_28L4_2:
    s_waitcnt vmcnt(0)
    v_max3_u32 v19, v32, v33, v34
    v_max_u32 v19, v19, v35
    v_cmp_eq_u32 vcc, -1, v19
    s_nop 0
    s_cbranch_vccnz g_28F4_2
    v_smfmac_f32_16x16x64_bf16 v[40:43], v[32:35], a[16:23], v172
    v_smfmac_f32_16x16x64_bf16 v[44:47], v[32:35], a[80:87], v172
    v_smfmac_f32_16x16x64_bf16 v[48:51], v[32:35], a[48:55], v172
    v_smfmac_f32_16x16x64_bf16 v[52:55], v[32:35], a[112:119], v172
    s_branch gc_29
g_28L7_1:
    s_waitcnt vmcnt(2)
    v_max3_u32 v19, v28, v29, v30
    v_max_u32 v19, v19, v31
    v_cmp_eq_u32 vcc, -1, v19
    s_nop 0
    s_cbranch_vccnz g_28F7_1
    v_smfmac_f32_16x16x64_bf16 v[40:43], v[28:31], a[8:15], v172
    v_smfmac_f32_16x16x64_bf16 v[44:47], v[28:31], a[72:79], v172
    v_smfmac_f32_16x16x64_bf16 v[48:51], v[28:31], a[40:47], v172
    v_smfmac_f32_16x16x64_bf16 v[52:55], v[28:31], a[104:111], v172
g_28L5_2:
    s_waitcnt vmcnt(1)
    v_max3_u32 v19, v32, v33, v34
    v_max_u32 v19, v19, v35
    v_cmp_eq_u32 vcc, -1, v19
    s_nop 0
    s_cbranch_vccnz g_28F5_2
    v_smfmac_f32_16x16x64_bf16 v[40:43], v[32:35], a[16:23], v172
    v_smfmac_f32_16x16x64_bf16 v[44:47], v[32:35], a[80:87], v172
    v_smfmac_f32_16x16x64_bf16 v[48:51], v[32:35], a[48:55], v172
    v_smfmac_f32_16x16x64_bf16 v[52:55], v[32:35], a[112:119], v172
    s_branch g_28L1_0
g_28L7_2:
    s_waitcnt vmcnt(2)
    v_max3_u32 v19, v32, v33, v34
    v_max_u32 v19, v19, v35
    v_cmp_eq_u32 vcc, -1, v19
    s_nop 0
    s_cbranch_vccnz g_28F7_2
    v_smfmac_f32_16x16x64_bf16 v[40:43], v[32:35], a[16:23], v172
    v_smfmac_f32_16x16x64_bf16 v[44:47], v[32:35], a[80:87], v172
    v_smfmac_f32_16x16x64_bf16 v[48:51], v[32:35], a[48:55], v172
    v_smfmac_f32_16x16x64_bf16 v[52:55], v[32:35], a[112:119], v172
    s_branch g_28L3_0
g_28L11_0:
    s_waitcnt vmcnt(2)
    v_max3_u32 v19, v24, v25, v26
    v_max_u32 v19, v19, v27
    v_cmp_eq_u32 vcc, -1, v19
    s_nop 0
    s_cbranch_vccnz g_28F11_0
    v_smfmac_f32_16x16x64_bf16 v[40:43], v[24:27], a[0:7], v172
    v_smfmac_f32_16x16x64_bf16 v[44:47], v[24:27], a[64:71], v172
    v_smfmac_f32_16x16x64_bf16 v[48:51], v[24:27], a[32:39], v172
    v_smfmac_f32_16x16x64_bf16 v[52:55], v[24:27], a[96:103], v172
g_28L10_1:
    s_waitcnt vmcnt(1)
    v_max3_u32 v19, v28, v29, v30
    v_max_u32 v19, v19, v31
    v_cmp_eq_u32 vcc, -1, v19
    s_nop 0
    s_cbranch_vccnz g_28F10_1
    v_smfmac_f32_16x16x64_bf16 v[40:43], v[28:31], a[8:15], v172
    v_smfmac_f32_16x16x64_bf16 v[44:47], v[28:31], a[72:79], v172
    v_smfmac_f32_16x16x64_bf16 v[48:51], v[28:31], a[40:47], v172
    v_smfmac_f32_16x16x64_bf16 v[52:55], v[28:31], a[104:111], v172
    s_branch g_28L8_3
g_28L11_1:
    s_waitcnt vmcnt(2)
    v_max3_u32 v19, v28, v29, v30
    v_max_u32 v19, v19, v31
    v_cmp_eq_u32 vcc, -1, v19
    s_nop 0
    s_cbranch_vccnz g_28F11_1
    v_smfmac_f32_16x16x64_bf16 v[40:43], v[28:31], a[8:15], v172
    v_smfmac_f32_16x16x64_bf16 v[44:47], v[28:31], a[72:79], v172
    v_smfmac_f32_16x16x64_bf16 v[48:51], v[28:31], a[40:47], v172
    v_smfmac_f32_16x16x64_bf16 v[52:55], v[28:31], a[104:111], v172
    s_branch g_28L9_3
g_28L13_0:
    s_waitcnt vmcnt(2)
    v_max3_u32 v19, v24, v25, v26
    v_max_u32 v19, v19, v27
    v_cmp_eq_u32 vcc, -1, v19
    s_nop 0
    s_cbranch_vccnz g_28F13_0
    v_smfmac_f32_16x16x64_bf16 v[40:43], v[24:27], a[0:7], v172
    v_smfmac_f32_16x16x64_bf16 v[44:47], v[24:27], a[64:71], v172
    v_smfmac_f32_16x16x64_bf16 v[48:51], v[24:27], a[32:39], v172
    v_smfmac_f32_16x16x64_bf16 v[52:55], v[24:27], a[96:103], v172
    s_branch g_28L12_2
g_28L13_3:
    s_waitcnt vmcnt(2)
    v_max3_u32 v19, v36, v37, v38
    v_max_u32 v19, v19, v39
    v_cmp_eq_u32 vcc, -1, v19
    s_nop 0
    s_cbranch_vccnz g_28F13_3
    v_smfmac_f32_16x16x64_bf16 v[40:43], v[36:39], a[24:31], v172
    v_smfmac_f32_16x16x64_bf16 v[44:47], v[36:39], a[88:95], v172
    v_smfmac_f32_16x16x64_bf16 v[48:51], v[36:39], a[56:63], v172
    v_smfmac_f32_16x16x64_bf16 v[52:55], v[36:39], a[120:127], v172
g_28L5_0:
    s_waitcnt vmcnt(1)
    v_max3_u32 v19, v24, v25, v26
    v_max_u32 v19, v19, v27
    v_cmp_eq_u32 vcc, -1, v19
    s_nop 0
    s_cbranch_vccnz g_28F5_0
    v_smfmac_f32_16x16x64_bf16 v[40:43], v[24:27], a[0:7], v172
    v_smfmac_f32_16x16x64_bf16 v[44:47], v[24:27], a[64:71], v172
    v_smfmac_f32_16x16x64_bf16 v[48:51], v[24:27], a[32:39], v172
    v_smfmac_f32_16x16x64_bf16 v[52:55], v[24:27], a[96:103], v172
    s_branch g_28L4_2
g_28L14_2:
    s_waitcnt vmcnt(2)
    v_max3_u32 v19, v32, v33, v34
    v_max_u32 v19, v19, v35
    v_cmp_eq_u32 vcc, -1, v19
    s_nop 0
    s_cbranch_vccnz g_28F14_2
    v_smfmac_f32_16x16x64_bf16 v[40:43], v[32:35], a[16:23], v172
    v_smfmac_f32_16x16x64_bf16 v[44:47], v[32:35], a[80:87], v172
    v_smfmac_f32_16x16x64_bf16 v[48:51], v[32:35], a[48:55], v172
    v_smfmac_f32_16x16x64_bf16 v[52:55], v[32:35], a[112:119], v172
g_28L10_3:
    s_waitcnt vmcnt(1)
    v_max3_u32 v19, v36, v37, v38
    v_max_u32 v19, v19, v39
    v_cmp_eq_u32 vcc, -1, v19
    s_nop 0
    s_cbranch_vccnz g_28F10_3
    v_smfmac_f32_16x16x64_bf16 v[40:43], v[36:39], a[24:31], v172
    v_smfmac_f32_16x16x64_bf16 v[44:47], v[36:39], a[88:95], v172
    v_smfmac_f32_16x16x64_bf16 v[48:51], v[36:39], a[56:63], v172
    v_smfmac_f32_16x16x64_bf16 v[52:55], v[36:39], a[120:127], v172
    s_branch g_28L2_1
g_28L14_3:
    s_waitcnt vmcnt(2)
    v_max3_u32 v19, v36, v37, v38
    v_max_u32 v19, v19, v39
    v_cmp_eq_u32 vcc, -1, v19
    s_nop 0
    s_cbranch_vccnz g_28F14_3
    v_smfmac_f32_16x16x64_bf16 v[40:43], v[36:39], a[24:31], v172
    v_smfmac_f32_16x16x64_bf16 v[44:47], v[36:39], a[88:95], v172
    v_smfmac_f32_16x16x64_bf16 v[48:51], v[36:39], a[56:63], v172
    v_smfmac_f32_16x16x64_bf16 v[52:55], v[36:39], a[120:127], v172
    s_branch g_28L6_1
g_28L3_1:
    s_waitcnt vmcnt(1)
    v_max3_u32 v19, v28, v29, v30
    v_max_u32 v19, v19, v31
    v_cmp_eq_u32 vcc, -1, v19
    s_nop 0
    s_cbranch_vccnz g_28F3_1
    v_smfmac_f32_16x16x64_bf16 v[40:43], v[28:31], a[8:15], v172
    v_smfmac_f32_16x16x64_bf16 v[44:47], v[28:31], a[72:79], v172
    v_smfmac_f32_16x16x64_bf16 v[48:51], v[28:31], a[40:47], v172
    v_smfmac_f32_16x16x64_bf16 v[52:55], v[28:31], a[104:111], v172
    s_branch g_28L1_0
g_28L6_2:
    s_waitcnt vmcnt(1)
    v_max3_u32 v19, v32, v33, v34
    v_max_u32 v19, v19, v35
    v_cmp_eq_u32 vcc, -1, v19
    s_nop 0
    s_cbranch_vccnz g_28F6_2
    v_smfmac_f32_16x16x64_bf16 v[40:43], v[32:35], a[16:23], v172
    v_smfmac_f32_16x16x64_bf16 v[44:47], v[32:35], a[80:87], v172
    v_smfmac_f32_16x16x64_bf16 v[48:51], v[32:35], a[48:55], v172
    v_smfmac_f32_16x16x64_bf16 v[52:55], v[32:35], a[112:119], v172
    s_branch g_28L2_1
g_28L9_0:
    s_waitcnt vmcnt(1)
    v_max3_u32 v19, v24, v25, v26
    v_max_u32 v19, v19, v27
    v_cmp_eq_u32 vcc, -1, v19
    s_nop 0
    s_cbranch_vccnz g_28F9_0
    v_smfmac_f32_16x16x64_bf16 v[40:43], v[24:27], a[0:7], v172
    v_smfmac_f32_16x16x64_bf16 v[44:47], v[24:27], a[64:71], v172
    v_smfmac_f32_16x16x64_bf16 v[48:51], v[24:27], a[32:39], v172
    v_smfmac_f32_16x16x64_bf16 v[52:55], v[24:27], a[96:103], v172
    s_branch g_28L8_3
g_28L12_3:
    s_waitcnt vmcnt(1)
    v_max3_u32 v19, v36, v37, v38
    v_max_u32 v19, v19, v39
    v_cmp_eq_u32 vcc, -1, v19
    s_nop 0
    s_cbranch_vccnz g_28F12_3
    v_smfmac_f32_16x16x64_bf16 v[40:43], v[36:39], a[24:31], v172
    v_smfmac_f32_16x16x64_bf16 v[44:47], v[36:39], a[88:95], v172
    v_smfmac_f32_16x16x64_bf16 v[48:51], v[36:39], a[56:63], v172
    v_smfmac_f32_16x16x64_bf16 v[52:55], v[36:39], a[120:127], v172
    s_branch g_28L4_2
g_28F15_0:
    s_mov_b64 exec, vcc
    buffer_load_dwordx4 v[24:27], v2, s[4:7], s16 offen offset:0 sc1
    s_mov_b64 exec, -1
    s_add_u32 s23, s23, 1
    s_cmp_lt_u32 s23, 200000
    s_cbranch_scc1 g_28L15_1
    s_mov_b32 s25, 200000
    s_branch gc_29
g_28F15_1:
    s_mov_b64 exec, vcc
    buffer_load_dwordx4 v[28:31], v2, s[4:7], s16 offen offset:1024 sc1
    s_mov_b64 exec, -1
    s_add_u32 s23, s23, 1
    s_cmp_lt_u32 s23, 200000
    s_cbranch_scc1 g_28L15_2
    s_mov_b32 s25, 200000
    s_branch gc_29
g_28F15_2:
    s_mov_b64 exec, vcc
    buffer_load_dwordx4 v[32:35], v2, s[4:7], s16 offen offset:2048 sc1
    s_mov_b64 exec, -1
    s_add_u32 s23, s23, 1
    s_cmp_lt_u32 s23, 200000
    s_cbranch_scc1 g_28L15_3
    s_mov_b32 s25, 200000
    s_branch gc_29
g_28F15_3:
    s_mov_b64 exec, vcc
    buffer_load_dwordx4 v[36:39], v2, s[4:7], s16 offen offset:3072 sc1
    s_mov_b64 exec, -1
    s_add_u32 s23, s23, 1
    s_cmp_lt_u32 s23, 200000
    s_cbranch_scc1 g_28L15_0
    s_mov_b32 s25, 200000
    s_branch gc_29
g_28F7_0:
    s_mov_b64 exec, vcc
    buffer_load_dwordx4 v[24:27], v2, s[4:7], s16 offen offset:0 sc1
    s_mov_b64 exec, -1
    s_add_u32 s23, s23, 1
    s_cmp_lt_u32 s23, 200000
    s_cbranch_scc1 g_28L7_1
    s_mov_b32 s25, 200000
    s_branch gc_29
g_28F7_1:
    s_mov_b64 exec, vcc
    buffer_load_dwordx4 v[28:31], v2, s[4:7], s16 offen offset:1024 sc1
    s_mov_b64 exec, -1
    s_add_u32 s23, s23, 1
    s_cmp_lt_u32 s23, 200000
    s_cbranch_scc1 g_28L7_2
    s_mov_b32 s25, 200000
    s_branch gc_29
g_28F7_2:
    s_mov_b64 exec, vcc
    buffer_load_dwordx4 v[32:35], v2, s[4:7], s16 offen offset:2048 sc1
    s_mov_b64 exec, -1
    s_add_u32 s23, s23, 1
    s_cmp_lt_u32 s23, 200000
    s_cbranch_scc1 g_28L7_0
    s_mov_b32 s25, 200000
    s_branch gc_29
g_28F11_0:
    s_mov_b64 exec, vcc
    buffer_load_dwordx4 v[24:27], v2, s[4:7], s16 offen offset:0 sc1
    s_mov_b64 exec, -1
    s_add_u32 s23, s23, 1
    s_cmp_lt_u32 s23, 200000
    s_cbranch_scc1 g_28L11_1
    s_mov_b32 s25, 200000
    s_branch gc_29
g_28F11_1:
    s_mov_b64 exec, vcc
    buffer_load_dwordx4 v[28:31], v2, s[4:7], s16 offen offset:1024 sc1
    s_mov_b64 exec, -1
    s_add_u32 s23, s23, 1
    s_cmp_lt_u32 s23, 200000
    s_cbranch_scc1 g_28L11_3
    s_mov_b32 s25, 200000
    s_branch gc_29
g_28F11_3:
    s_mov_b64 exec, vcc
    buffer_load_dwordx4 v[36:39], v2, s[4:7], s16 offen offset:3072 sc1
    s_mov_b64 exec, -1
    s_add_u32 s23, s23, 1
    s_cmp_lt_u32 s23, 200000
    s_cbranch_scc1 g_28L11_0
    s_mov_b32 s25, 200000
    s_branch gc_29
g_28F13_0:
    s_mov_b64 exec, vcc
    buffer_load_dwordx4 v[24:27], v2, s[4:7], s16 offen offset:0 sc1
    s_mov_b64 exec, -1
    s_add_u32 s23, s23, 1
    s_cmp_lt_u32 s23, 200000
    s_cbranch_scc1 g_28L13_2
    s_mov_b32 s25, 200000
    s_branch gc_29
g_28F13_2:
    s_mov_b64 exec, vcc
    buffer_load_dwordx4 v[32:35], v2, s[4:7], s16 offen offset:2048 sc1
    s_mov_b64 exec, -1
    s_add_u32 s23, s23, 1
    s_cmp_lt_u32 s23, 200000
    s_cbranch_scc1 g_28L13_3
    s_mov_b32 s25, 200000
    s_branch gc_29
g_28F13_3:
    s_mov_b64 exec, vcc
    buffer_load_dwordx4 v[36:39], v2, s[4:7], s16 offen offset:3072 sc1
    s_mov_b64 exec, -1
    s_add_u32 s23, s23, 1
    s_cmp_lt_u32 s23, 200000
    s_cbranch_scc1 g_28L13_0
    s_mov_b32 s25, 200000
    s_branch gc_29
g_28F14_1:
    s_mov_b64 exec, vcc
    buffer_load_dwordx4 v[28:31], v2, s[4:7], s16 offen offset:1024 sc1
    s_mov_b64 exec, -1
    s_add_u32 s23, s23, 1
    s_cmp_lt_u32 s23, 200000
    s_cbranch_scc1 g_28L14_2
    s_mov_b32 s25, 200000
    s_branch gc_29
g_28F14_2:
    s_mov_b64 exec, vcc
    buffer_load_dwordx4 v[32:35], v2, s[4:7], s16 offen offset:2048 sc1
    s_mov_b64 exec, -1
    s_add_u32 s23, s23, 1
    s_cmp_lt_u32 s23, 200000
    s_cbranch_scc1 g_28L14_3
    s_mov_b32 s25, 200000
    s_branch gc_29
g_28F14_3:
    s_mov_b64 exec, vcc
    buffer_load_dwordx4 v[36:39], v2, s[4:7], s16 offen offset:3072 sc1
    s_mov_b64 exec, -1
    s_add_u32 s23, s23, 1
    s_cmp_lt_u32 s23, 200000
    s_cbranch_scc1 g_28L14_1
    s_mov_b32 s25, 200000
    s_branch gc_29
g_28F3_0:
    s_mov_b64 exec, vcc
    buffer_load_dwordx4 v[24:27], v2, s[4:7], s16 offen offset:0 sc1
    s_mov_b64 exec, -1
    s_add_u32 s23, s23, 1
    s_cmp_lt_u32 s23, 200000
    s_cbranch_scc1 g_28L3_1
    s_mov_b32 s25, 200000
    s_branch gc_29
g_28F3_1:
    s_mov_b64 exec, vcc
    buffer_load_dwordx4 v[28:31], v2, s[4:7], s16 offen offset:1024 sc1
    s_mov_b64 exec, -1
    s_add_u32 s23, s23, 1
    s_cmp_lt_u32 s23, 200000
    s_cbranch_scc1 g_28L3_0
    s_mov_b32 s25, 200000
    s_branch gc_29
g_28F5_0:
    s_mov_b64 exec, vcc
    buffer_load_dwordx4 v[24:27], v2, s[4:7], s16 offen offset:0 sc1
    s_mov_b64 exec, -1
    s_add_u32 s23, s23, 1
    s_cmp_lt_u32 s23, 200000
    s_cbranch_scc1 g_28L5_2
    s_mov_b32 s25, 200000
    s_branch gc_29
g_28F5_2:
    s_mov_b64 exec, vcc
    buffer_load_dwordx4 v[32:35], v2, s[4:7], s16 offen offset:2048 sc1
    s_mov_b64 exec, -1
    s_add_u32 s23, s23, 1
    s_cmp_lt_u32 s23, 200000
    s_cbranch_scc1 g_28L5_0
    s_mov_b32 s25, 200000
    s_branch gc_29
g_28F6_1:
    s_mov_b64 exec, vcc
    buffer_load_dwordx4 v[28:31], v2, s[4:7], s16 offen offset:1024 sc1
    s_mov_b64 exec, -1
    s_add_u32 s23, s23, 1
    s_cmp_lt_u32 s23, 200000
    s_cbranch_scc1 g_28L6_2
    s_mov_b32 s25, 200000
    s_branch gc_29
g_28F6_2:
    s_mov_b64 exec, vcc
    buffer_load_dwordx4 v[32:35], v2, s[4:7], s16 offen offset:2048 sc1
    s_mov_b64 exec, -1
    s_add_u32 s23, s23, 1
    s_cmp_lt_u32 s23, 200000
    s_cbranch_scc1 g_28L6_1
    s_mov_b32 s25, 200000
    s_branch gc_29
g_28F9_0:
    s_mov_b64 exec, vcc
    buffer_load_dwordx4 v[24:27], v2, s[4:7], s16 offen offset:0 sc1
    s_mov_b64 exec, -1
    s_add_u32 s23, s23, 1
    s_cmp_lt_u32 s23, 200000
    s_cbranch_scc1 g_28L9_3
    s_mov_b32 s25, 200000
    s_branch gc_29
g_28F9_3:
    s_mov_b64 exec, vcc
    buffer_load_dwordx4 v[36:39], v2, s[4:7], s16 offen offset:3072 sc1
    s_mov_b64 exec, -1
    s_add_u32 s23, s23, 1
    s_cmp_lt_u32 s23, 200000
    s_cbranch_scc1 g_28L9_0
    s_mov_b32 s25, 200000
    s_branch gc_29
g_28F10_1:
    s_mov_b64 exec, vcc
    buffer_load_dwordx4 v[28:31], v2, s[4:7], s16 offen offset:1024 sc1
    s_mov_b64 exec, -1
    s_add_u32 s23, s23, 1
    s_cmp_lt_u32 s23, 200000
    s_cbranch_scc1 g_28L10_3
    s_mov_b32 s25, 200000
    s_branch gc_29
g_28F10_3:
    s_mov_b64 exec, vcc
    buffer_load_dwordx4 v[36:39], v2, s[4:7], s16 offen offset:3072 sc1
    s_mov_b64 exec, -1
    s_add_u32 s23, s23, 1
    s_cmp_lt_u32 s23, 200000
    s_cbranch_scc1 g_28L10_1
    s_mov_b32 s25, 200000
    s_branch gc_29
g_28F12_2:
    s_mov_b64 exec, vcc
    buffer_load_dwordx4 v[32:35], v2, s[4:7], s16 offen offset:2048 sc1
    s_mov_b64 exec, -1
    s_add_u32 s23, s23, 1
    s_cmp_lt_u32 s23, 200000
    s_cbranch_scc1 g_28L12_3
    s_mov_b32 s25, 200000
    s_branch gc_29
g_28F12_3:
    s_mov_b64 exec, vcc
    buffer_load_dwordx4 v[36:39], v2, s[4:7], s16 offen offset:3072 sc1
    s_mov_b64 exec, -1
    s_add_u32 s23, s23, 1
    s_cmp_lt_u32 s23, 200000
    s_cbranch_scc1 g_28L12_2
    s_mov_b32 s25, 200000
    s_branch gc_29
g_28F1_0:
    s_mov_b64 exec, vcc
    buffer_load_dwordx4 v[24:27], v2, s[4:7], s16 offen offset:0 sc1
    s_mov_b64 exec, -1
    s_add_u32 s23, s23, 1
    s_cmp_lt_u32 s23, 200000
    s_cbranch_scc1 g_28L1_0
    s_mov_b32 s25, 200000
    s_branch gc_29
g_28F2_1:
    s_mov_b64 exec, vcc
    buffer_load_dwordx4 v[28:31], v2, s[4:7], s16 offen offset:1024 sc1
    s_mov_b64 exec, -1
    s_add_u32 s23, s23, 1
    s_cmp_lt_u32 s23, 200000
    s_cbranch_scc1 g_28L2_1
    s_mov_b32 s25, 200000
    s_branch gc_29
g_28F4_2:
    s_mov_b64 exec, vcc
    buffer_load_dwordx4 v[32:35], v2, s[4:7], s16 offen offset:2048 sc1
    s_mov_b64 exec, -1
    s_add_u32 s23, s23, 1
    s_cmp_lt_u32 s23, 200000
    s_cbranch_scc1 g_28L4_2
    s_mov_b32 s25, 200000
    s_branch gc_29
g_28F8_3:
    s_mov_b64 exec, vcc
    buffer_load_dwordx4 v[36:39], v2, s[4:7], s16 offen offset:3072 sc1
    s_mov_b64 exec, -1
    s_add_u32 s23, s23, 1
    s_cmp_lt_u32 s23, 200000
    s_cbranch_scc1 g_28L8_3
    s_mov_b32 s25, 200000
    s_branch gc_29
recur_fast_last0:
    buffer_store_dwordx4 v[128:131], v14, s[4:7], s19 offen sc1
    s_waitcnt vmcnt(0)
    s_branch recur_end
g_30L15_0:
    s_waitcnt vmcnt(3)
    v_max3_u32 v19, v24, v25, v26
    v_max_u32 v19, v19, v27
    v_cmp_eq_u32 vcc, -1, v19
    s_nop 0
    s_cbranch_vccnz g_30F15_0
    v_smfmac_f32_16x16x64_bf16 v[64:67], v[24:27], a[192:199], v172
    v_smfmac_f32_16x16x64_bf16 v[68:71], v[24:27], a[224:231], v172
g_30L14_1:
    s_waitcnt vmcnt(2)
    v_max3_u32 v19, v28, v29, v30
    v_max_u32 v19, v19, v31
    v_cmp_eq_u32 vcc, -1, v19
    s_nop 0
    s_cbranch_vccnz g_30F14_1
    v_smfmac_f32_16x16x64_bf16 v[64:67], v[28:31], a[200:207], v172
    v_smfmac_f32_16x16x64_bf16 v[68:71], v[28:31], a[232:239], v172
g_30L12_2:
    s_waitcnt vmcnt(1)
    v_max3_u32 v19, v32, v33, v34
    v_max_u32 v19, v19, v35
    v_cmp_eq_u32 vcc, -1, v19
    s_nop 0
    s_cbranch_vccnz g_30F12_2
    v_smfmac_f32_16x16x64_bf16 v[64:67], v[32:35], a[208:215], v172
    v_smfmac_f32_16x16x64_bf16 v[68:71], v[32:35], a[240:247], v172
g_30L8_3:
    s_waitcnt vmcnt(0)
    v_max3_u32 v19, v36, v37, v38
    v_max_u32 v19, v19, v39
    v_cmp_eq_u32 vcc, -1, v19
    s_nop 0
    s_cbranch_vccnz g_30F8_3
    v_smfmac_f32_16x16x64_bf16 v[64:67], v[36:39], a[216:223], v172
    v_smfmac_f32_16x16x64_bf16 v[68:71], v[36:39], a[248:255], v172
    s_nop 4
    v_cvt_pk_bf16_f32 v80, v64, v65
    v_cvt_pk_bf16_f32 v81, v66, v67
    s_nop 0
    v_cvt_pk_bf16_f32 v82, v68, v69
    v_cvt_pk_bf16_f32 v83, v70, v71
    ds_write_b128 v17, v[80:83] offset:9216
    s_branch gc_31
g_30L15_1:
    s_waitcnt vmcnt(3)
    v_max3_u32 v19, v28, v29, v30
    v_max_u32 v19, v19, v31
    v_cmp_eq_u32 vcc, -1, v19
    s_nop 0
    s_cbranch_vccnz g_30F15_1
    v_smfmac_f32_16x16x64_bf16 v[64:67], v[28:31], a[200:207], v172
    v_smfmac_f32_16x16x64_bf16 v[68:71], v[28:31], a[232:239], v172
g_30L13_2:
    s_waitcnt vmcnt(2)
    v_max3_u32 v19, v32, v33, v34
    v_max_u32 v19, v19, v35
    v_cmp_eq_u32 vcc, -1, v19
    s_nop 0
    s_cbranch_vccnz g_30F13_2
    v_smfmac_f32_16x16x64_bf16 v[64:67], v[32:35], a[208:215], v172
    v_smfmac_f32_16x16x64_bf16 v[68:71], v[32:35], a[240:247], v172
g_30L9_3:
    s_waitcnt vmcnt(1)
    v_max3_u32 v19, v36, v37, v38
    v_max_u32 v19, v19, v39
    v_cmp_eq_u32 vcc, -1, v19
    s_nop 0
    s_cbranch_vccnz g_30F9_3
    v_smfmac_f32_16x16x64_bf16 v[64:67], v[36:39], a[216:223], v172
    v_smfmac_f32_16x16x64_bf16 v[68:71], v[36:39], a[248:255], v172
g_30L1_0:
    s_waitcnt vmcnt(0)
    v_max3_u32 v19, v24, v25, v26
    v_max_u32 v19, v19, v27
    v_cmp_eq_u32 vcc, -1, v19
    s_nop 0
    s_cbranch_vccnz g_30F1_0
    v_smfmac_f32_16x16x64_bf16 v[64:67], v[24:27], a[192:199], v172
    v_smfmac_f32_16x16x64_bf16 v[68:71], v[24:27], a[224:231], v172
    s_nop 4
    v_cvt_pk_bf16_f32 v80, v64, v65
    v_cvt_pk_bf16_f32 v81, v66, v67
    s_nop 0
    v_cvt_pk_bf16_f32 v82, v68, v69
    v_cvt_pk_bf16_f32 v83, v70, v71
    ds_write_b128 v17, v[80:83] offset:9216
    s_branch gc_31
g_30L15_2:
    s_waitcnt vmcnt(3)
    v_max3_u32 v19, v32, v33, v34
    v_max_u32 v19, v19, v35
    v_cmp_eq_u32 vcc, -1, v19
    s_nop 0
    s_cbranch_vccnz g_30F15_2
    v_smfmac_f32_16x16x64_bf16 v[64:67], v[32:35], a[208:215], v172
    v_smfmac_f32_16x16x64_bf16 v[68:71], v[32:35], a[240:247], v172
g_30L11_3:
    s_waitcnt vmcnt(2)
    v_max3_u32 v19, v36, v37, v38
    v_max_u32 v19, v19, v39
    v_cmp_eq_u32 vcc, -1, v19
    s_nop 0
    s_cbranch_vccnz g_30F11_3
    v_smfmac_f32_16x16x64_bf16 v[64:67], v[36:39], a[216:223], v172
    v_smfmac_f32_16x16x64_bf16 v[68:71], v[36:39], a[248:255], v172
g_30L3_0:
    s_waitcnt vmcnt(1)
    v_max3_u32 v19, v24, v25, v26
    v_max_u32 v19, v19, v27
    v_cmp_eq_u32 vcc, -1, v19
    s_nop 0
    s_cbranch_vccnz g_30F3_0
    v_smfmac_f32_16x16x64_bf16 v[64:67], v[24:27], a[192:199], v172
    v_smfmac_f32_16x16x64_bf16 v[68:71], v[24:27], a[224:231], v172
g_30L2_1:
    s_waitcnt vmcnt(0)
    v_max3_u32 v19, v28, v29, v30
    v_max_u32 v19, v19, v31
    v_cmp_eq_u32 vcc, -1, v19
    s_nop 0
    s_cbranch_vccnz g_30F2_1
    v_smfmac_f32_16x16x64_bf16 v[64:67], v[28:31], a[200:207], v172
    v_smfmac_f32_16x16x64_bf16 v[68:71], v[28:31], a[232:239], v172
    s_nop 4
    v_cvt_pk_bf16_f32 v80, v64, v65
    v_cvt_pk_bf16_f32 v81, v66, v67
    s_nop 0
    v_cvt_pk_bf16_f32 v82, v68, v69
    v_cvt_pk_bf16_f32 v83, v70, v71
    ds_write_b128 v17, v[80:83] offset:9216
    s_branch gc_31
g_30L15_3:
    s_waitcnt vmcnt(3)
    v_max3_u32 v19, v36, v37, v38
    v_max_u32 v19, v19, v39
    v_cmp_eq_u32 vcc, -1, v19
    s_nop 0
    s_cbranch_vccnz g_30F15_3
    v_smfmac_f32_16x16x64_bf16 v[64:67], v[36:39], a[216:223], v172
    v_smfmac_f32_16x16x64_bf16 v[68:71], v[36:39], a[248:255], v172
g_30L7_0:
    s_waitcnt vmcnt(2)
    v_max3_u32 v19, v24, v25, v26
    v_max_u32 v19, v19, v27
    v_cmp_eq_u32 vcc, -1, v19
    s_nop 0
    s_cbranch_vccnz g_30F7_0
    v_smfmac_f32_16x16x64_bf16 v[64:67], v[24:27], a[192:199], v172
    v_smfmac_f32_16x16x64_bf16 v[68:71], v[24:27], a[224:231], v172
g_30L6_1:
    s_waitcnt vmcnt(1)
    v_max3_u32 v19, v28, v29, v30
    v_max_u32 v19, v19, v31
    v_cmp_eq_u32 vcc, -1, v19
    s_nop 0
    s_cbranch_vccnz g_30F6_1
    v_smfmac_f32_16x16x64_bf16 v[64:67], v[28:31], a[200:207], v172
    v_smfmac_f32_16x16x64_bf16 v[68:71], v[28:31], a[232:239], v172
g_30L4_2:
    s_waitcnt vmcnt(0)
    v_max3_u32 v19, v32, v33, v34
    v_max_u32 v19, v19, v35
    v_cmp_eq_u32 vcc, -1, v19
    s_nop 0
    s_cbranch_vccnz g_30F4_2
    v_smfmac_f32_16x16x64_bf16 v[64:67], v[32:35], a[208:215], v172
    v_smfmac_f32_16x16x64_bf16 v[68:71], v[32:35], a[240:247], v172
    s_nop 4
    v_cvt_pk_bf16_f32 v80, v64, v65
    v_cvt_pk_bf16_f32 v81, v66, v67
    s_nop 0
    v_cvt_pk_bf16_f32 v82, v68, v69
    v_cvt_pk_bf16_f32 v83, v70, v71
    ds_write_b128 v17, v[80:83] offset:9216
    s_branch gc_31
g_30L7_1:
    s_waitcnt vmcnt(2)
    v_max3_u32 v19, v28, v29, v30
    v_max_u32 v19, v19, v31
    v_cmp_eq_u32 vcc, -1, v19
    s_nop 0
    s_cbranch_vccnz g_30F7_1
    v_smfmac_f32_16x16x64_bf16 v[64:67], v[28:31], a[200:207], v172
    v_smfmac_f32_16x16x64_bf16 v[68:71], v[28:31], a[232:239], v172
g_30L5_2:
    s_waitcnt vmcnt(1)
    v_max3_u32 v19, v32, v33, v34
    v_max_u32 v19, v19, v35
    v_cmp_eq_u32 vcc, -1, v19
    s_nop 0
    s_cbranch_vccnz g_30F5_2
    v_smfmac_f32_16x16x64_bf16 v[64:67], v[32:35], a[208:215], v172
    v_smfmac_f32_16x16x64_bf16 v[68:71], v[32:35], a[240:247], v172
    s_branch g_30L1_0
g_30L7_2:
    s_waitcnt vmcnt(2)
    v_max3_u32 v19, v32, v33, v34
    v_max_u32 v19, v19, v35
    v_cmp_eq_u32 vcc, -1, v19
    s_nop 0
    s_cbranch_vccnz g_30F7_2
    v_smfmac_f32_16x16x64_bf16 v[64:67], v[32:35], a[208:215], v172
    v_smfmac_f32_16x16x64_bf16 v[68:71], v[32:35], a[240:247], v172
    s_branch g_30L3_0
g_30L11_0:
    s_waitcnt vmcnt(2)
    v_max3_u32 v19, v24, v25, v26
    v_max_u32 v19, v19, v27
    v_cmp_eq_u32 vcc, -1, v19
    s_nop 0
    s_cbranch_vccnz g_30F11_0
    v_smfmac_f32_16x16x64_bf16 v[64:67], v[24:27], a[192:199], v172
    v_smfmac_f32_16x16x64_bf16 v[68:71], v[24:27], a[224:231], v172
g_30L10_1:
    s_waitcnt vmcnt(1)
    v_max3_u32 v19, v28, v29, v30
    v_max_u32 v19, v19, v31
    v_cmp_eq_u32 vcc, -1, v19
    s_nop 0
    s_cbranch_vccnz g_30F10_1
    v_smfmac_f32_16x16x64_bf16 v[64:67], v[28:31], a[200:207], v172
    v_smfmac_f32_16x16x64_bf16 v[68:71], v[28:31], a[232:239], v172
    s_branch g_30L8_3
g_30L11_1:
    s_waitcnt vmcnt(2)
    v_max3_u32 v19, v28, v29, v30
    v_max_u32 v19, v19, v31
    v_cmp_eq_u32 vcc, -1, v19
    s_nop 0
    s_cbranch_vccnz g_30F11_1
    v_smfmac_f32_16x16x64_bf16 v[64:67], v[28:31], a[200:207], v172
    v_smfmac_f32_16x16x64_bf16 v[68:71], v[28:31], a[232:239], v172
    s_branch g_30L9_3
g_30L13_0:
    s_waitcnt vmcnt(2)
    v_max3_u32 v19, v24, v25, v26
    v_max_u32 v19, v19, v27
    v_cmp_eq_u32 vcc, -1, v19
    s_nop 0
    s_cbranch_vccnz g_30F13_0
    v_smfmac_f32_16x16x64_bf16 v[64:67], v[24:27], a[192:199], v172
    v_smfmac_f32_16x16x64_bf16 v[68:71], v[24:27], a[224:231], v172
    s_branch g_30L12_2
g_30L13_3:
    s_waitcnt vmcnt(2)
    v_max3_u32 v19, v36, v37, v38
    v_max_u32 v19, v19, v39
    v_cmp_eq_u32 vcc, -1, v19
    s_nop 0
    s_cbranch_vccnz g_30F13_3
    v_smfmac_f32_16x16x64_bf16 v[64:67], v[36:39], a[216:223], v172
    v_smfmac_f32_16x16x64_bf16 v[68:71], v[36:39], a[248:255], v172
g_30L5_0:
    s_waitcnt vmcnt(1)
    v_max3_u32 v19, v24, v25, v26
    v_max_u32 v19, v19, v27
    v_cmp_eq_u32 vcc, -1, v19
    s_nop 0
    s_cbranch_vccnz g_30F5_0
    v_smfmac_f32_16x16x64_bf16 v[64:67], v[24:27], a[192:199], v172
    v_smfmac_f32_16x16x64_bf16 v[68:71], v[24:27], a[224:231], v172
    s_branch g_30L4_2
g_30L14_2:
    s_waitcnt vmcnt(2)
    v_max3_u32 v19, v32, v33, v34
    v_max_u32 v19, v19, v35
    v_cmp_eq_u32 vcc, -1, v19
    s_nop 0
    s_cbranch_vccnz g_30F14_2
    v_smfmac_f32_16x16x64_bf16 v[64:67], v[32:35], a[208:215], v172
    v_smfmac_f32_16x16x64_bf16 v[68:71], v[32:35], a[240:247], v172
g_30L10_3:
    s_waitcnt vmcnt(1)
    v_max3_u32 v19, v36, v37, v38
    v_max_u32 v19, v19, v39
    v_cmp_eq_u32 vcc, -1, v19
    s_nop 0
    s_cbranch_vccnz g_30F10_3
    v_smfmac_f32_16x16x64_bf16 v[64:67], v[36:39], a[216:223], v172
    v_smfmac_f32_16x16x64_bf16 v[68:71], v[36:39], a[248:255], v172
    s_branch g_30L2_1
g_30L14_3:
    s_waitcnt vmcnt(2)
    v_max3_u32 v19, v36, v37, v38
    v_max_u32 v19, v19, v39
    v_cmp_eq_u32 vcc, -1, v19
    s_nop 0
    s_cbranch_vccnz g_30F14_3
    v_smfmac_f32_16x16x64_bf16 v[64:67], v[36:39], a[216:223], v172
    v_smfmac_f32_16x16x64_bf16 v[68:71], v[36:39], a[248:255], v172
    s_branch g_30L6_1
g_30L3_1:
    s_waitcnt vmcnt(1)
    v_max3_u32 v19, v28, v29, v30
    v_max_u32 v19, v19, v31
    v_cmp_eq_u32 vcc, -1, v19
    s_nop 0
    s_cbranch_vccnz g_30F3_1
    v_smfmac_f32_16x16x64_bf16 v[64:67], v[28:31], a[200:207], v172
    v_smfmac_f32_16x16x64_bf16 v[68:71], v[28:31], a[232:239], v172
    s_branch g_30L1_0
g_30L6_2:
    s_waitcnt vmcnt(1)
    v_max3_u32 v19, v32, v33, v34
    v_max_u32 v19, v19, v35
    v_cmp_eq_u32 vcc, -1, v19
    s_nop 0
    s_cbranch_vccnz g_30F6_2
    v_smfmac_f32_16x16x64_bf16 v[64:67], v[32:35], a[208:215], v172
    v_smfmac_f32_16x16x64_bf16 v[68:71], v[32:35], a[240:247], v172
    s_branch g_30L2_1
g_30L9_0:
    s_waitcnt vmcnt(1)
    v_max3_u32 v19, v24, v25, v26
    v_max_u32 v19, v19, v27
    v_cmp_eq_u32 vcc, -1, v19
    s_nop 0
    s_cbranch_vccnz g_30F9_0
    v_smfmac_f32_16x16x64_bf16 v[64:67], v[24:27], a[192:199], v172
    v_smfmac_f32_16x16x64_bf16 v[68:71], v[24:27], a[224:231], v172
    s_branch g_30L8_3
g_30L12_3:
    s_waitcnt vmcnt(1)
    v_max3_u32 v19, v36, v37, v38
    v_max_u32 v19, v19, v39
    v_cmp_eq_u32 vcc, -1, v19
    s_nop 0
    s_cbranch_vccnz g_30F12_3
    v_smfmac_f32_16x16x64_bf16 v[64:67], v[36:39], a[216:223], v172
    v_smfmac_f32_16x16x64_bf16 v[68:71], v[36:39], a[248:255], v172
    s_branch g_30L4_2
g_30F15_0:
    s_mov_b64 exec, vcc
    buffer_load_dwordx4 v[24:27], v8, s[4:7], s16 offen offset:0 sc1
    s_mov_b64 exec, -1
    s_add_u32 s23, s23, 1
    s_cmp_lt_u32 s23, 200000
    s_cbranch_scc1 g_30L15_1
    s_mov_b32 s25, 200000
    s_branch gc_31
g_30F15_1:
    s_mov_b64 exec, vcc
    buffer_load_dwordx4 v[28:31], v8, s[4:7], s16 offen offset:1024 sc1
    s_mov_b64 exec, -1
    s_add_u32 s23, s23, 1
    s_cmp_lt_u32 s23, 200000
    s_cbranch_scc1 g_30L15_2
    s_mov_b32 s25, 200000
    s_branch gc_31
g_30F15_2:
    s_mov_b64 exec, vcc
    buffer_load_dwordx4 v[32:35], v8, s[4:7], s16 offen offset:2048 sc1
    s_mov_b64 exec, -1
    s_add_u32 s23, s23, 1
    s_cmp_lt_u32 s23, 200000
    s_cbranch_scc1 g_30L15_3
    s_mov_b32 s25, 200000
    s_branch gc_31
g_30F15_3:
    s_mov_b64 exec, vcc
    buffer_load_dwordx4 v[36:39], v8, s[4:7], s16 offen offset:3072 sc1
    s_mov_b64 exec, -1
    s_add_u32 s23, s23, 1
    s_cmp_lt_u32 s23, 200000
    s_cbranch_scc1 g_30L15_0
    s_mov_b32 s25, 200000
    s_branch gc_31
g_30F7_0:
    s_mov_b64 exec, vcc
    buffer_load_dwordx4 v[24:27], v8, s[4:7], s16 offen offset:0 sc1
    s_mov_b64 exec, -1
    s_add_u32 s23, s23, 1
    s_cmp_lt_u32 s23, 200000
    s_cbranch_scc1 g_30L7_1
    s_mov_b32 s25, 200000
    s_branch gc_31
g_30F7_1:
    s_mov_b64 exec, vcc
    buffer_load_dwordx4 v[28:31], v8, s[4:7], s16 offen offset:1024 sc1
    s_mov_b64 exec, -1
    s_add_u32 s23, s23, 1
    s_cmp_lt_u32 s23, 200000
    s_cbranch_scc1 g_30L7_2
    s_mov_b32 s25, 200000
    s_branch gc_31
g_30F7_2:
    s_mov_b64 exec, vcc
    buffer_load_dwordx4 v[32:35], v8, s[4:7], s16 offen offset:2048 sc1
    s_mov_b64 exec, -1
    s_add_u32 s23, s23, 1
    s_cmp_lt_u32 s23, 200000
    s_cbranch_scc1 g_30L7_0
    s_mov_b32 s25, 200000
    s_branch gc_31
g_30F11_0:
    s_mov_b64 exec, vcc
    buffer_load_dwordx4 v[24:27], v8, s[4:7], s16 offen offset:0 sc1
    s_mov_b64 exec, -1
    s_add_u32 s23, s23, 1
    s_cmp_lt_u32 s23, 200000
    s_cbranch_scc1 g_30L11_1
    s_mov_b32 s25, 200000
    s_branch gc_31
g_30F11_1:
    s_mov_b64 exec, vcc
    buffer_load_dwordx4 v[28:31], v8, s[4:7], s16 offen offset:1024 sc1
    s_mov_b64 exec, -1
    s_add_u32 s23, s23, 1
    s_cmp_lt_u32 s23, 200000
    s_cbranch_scc1 g_30L11_3
    s_mov_b32 s25, 200000
    s_branch gc_31
g_30F11_3:
    s_mov_b64 exec, vcc
    buffer_load_dwordx4 v[36:39], v8, s[4:7], s16 offen offset:3072 sc1
    s_mov_b64 exec, -1
    s_add_u32 s23, s23, 1
    s_cmp_lt_u32 s23, 200000
    s_cbranch_scc1 g_30L11_0
    s_mov_b32 s25, 200000
    s_branch gc_31
g_30F13_0:
    s_mov_b64 exec, vcc
    buffer_load_dwordx4 v[24:27], v8, s[4:7], s16 offen offset:0 sc1
    s_mov_b64 exec, -1
    s_add_u32 s23, s23, 1
    s_cmp_lt_u32 s23, 200000
    s_cbranch_scc1 g_30L13_2
    s_mov_b32 s25, 200000
    s_branch gc_31
g_30F13_2:
    s_mov_b64 exec, vcc
    buffer_load_dwordx4 v[32:35], v8, s[4:7], s16 offen offset:2048 sc1
    s_mov_b64 exec, -1
    s_add_u32 s23, s23, 1
    s_cmp_lt_u32 s23, 200000
    s_cbranch_scc1 g_30L13_3
    s_mov_b32 s25, 200000
    s_branch gc_31
g_30F13_3:
    s_mov_b64 exec, vcc
    buffer_load_dwordx4 v[36:39], v8, s[4:7], s16 offen offset:3072 sc1
    s_mov_b64 exec, -1
    s_add_u32 s23, s23, 1
    s_cmp_lt_u32 s23, 200000
    s_cbranch_scc1 g_30L13_0
    s_mov_b32 s25, 200000
    s_branch gc_31
g_30F14_1:
    s_mov_b64 exec, vcc
    buffer_load_dwordx4 v[28:31], v8, s[4:7], s16 offen offset:1024 sc1
    s_mov_b64 exec, -1
    s_add_u32 s23, s23, 1
    s_cmp_lt_u32 s23, 200000
    s_cbranch_scc1 g_30L14_2
    s_mov_b32 s25, 200000
    s_branch gc_31
g_30F14_2:
    s_mov_b64 exec, vcc
    buffer_load_dwordx4 v[32:35], v8, s[4:7], s16 offen offset:2048 sc1
    s_mov_b64 exec, -1
    s_add_u32 s23, s23, 1
    s_cmp_lt_u32 s23, 200000
    s_cbranch_scc1 g_30L14_3
    s_mov_b32 s25, 200000
    s_branch gc_31
g_30F14_3:
    s_mov_b64 exec, vcc
    buffer_load_dwordx4 v[36:39], v8, s[4:7], s16 offen offset:3072 sc1
    s_mov_b64 exec, -1
    s_add_u32 s23, s23, 1
    s_cmp_lt_u32 s23, 200000
    s_cbranch_scc1 g_30L14_1
    s_mov_b32 s25, 200000
    s_branch gc_31
g_30F3_0:
    s_mov_b64 exec, vcc
    buffer_load_dwordx4 v[24:27], v8, s[4:7], s16 offen offset:0 sc1
    s_mov_b64 exec, -1
    s_add_u32 s23, s23, 1
    s_cmp_lt_u32 s23, 200000
    s_cbranch_scc1 g_30L3_1
    s_mov_b32 s25, 200000
    s_branch gc_31
g_30F3_1:
    s_mov_b64 exec, vcc
    buffer_load_dwordx4 v[28:31], v8, s[4:7], s16 offen offset:1024 sc1
    s_mov_b64 exec, -1
    s_add_u32 s23, s23, 1
    s_cmp_lt_u32 s23, 200000
    s_cbranch_scc1 g_30L3_0
    s_mov_b32 s25, 200000
    s_branch gc_31
g_30F5_0:
    s_mov_b64 exec, vcc
    buffer_load_dwordx4 v[24:27], v8, s[4:7], s16 offen offset:0 sc1
    s_mov_b64 exec, -1
    s_add_u32 s23, s23, 1
    s_cmp_lt_u32 s23, 200000
    s_cbranch_scc1 g_30L5_2
    s_mov_b32 s25, 200000
    s_branch gc_31
g_30F5_2:
    s_mov_b64 exec, vcc
    buffer_load_dwordx4 v[32:35], v8, s[4:7], s16 offen offset:2048 sc1
    s_mov_b64 exec, -1
    s_add_u32 s23, s23, 1
    s_cmp_lt_u32 s23, 200000
    s_cbranch_scc1 g_30L5_0
    s_mov_b32 s25, 200000
    s_branch gc_31
g_30F6_1:
    s_mov_b64 exec, vcc
    buffer_load_dwordx4 v[28:31], v8, s[4:7], s16 offen offset:1024 sc1
    s_mov_b64 exec, -1
    s_add_u32 s23, s23, 1
    s_cmp_lt_u32 s23, 200000
    s_cbranch_scc1 g_30L6_2
    s_mov_b32 s25, 200000
    s_branch gc_31
g_30F6_2:
    s_mov_b64 exec, vcc
    buffer_load_dwordx4 v[32:35], v8, s[4:7], s16 offen offset:2048 sc1
    s_mov_b64 exec, -1
    s_add_u32 s23, s23, 1
    s_cmp_lt_u32 s23, 200000
    s_cbranch_scc1 g_30L6_1
    s_mov_b32 s25, 200000
    s_branch gc_31
g_30F9_0:
    s_mov_b64 exec, vcc
    buffer_load_dwordx4 v[24:27], v8, s[4:7], s16 offen offset:0 sc1
    s_mov_b64 exec, -1
    s_add_u32 s23, s23, 1
    s_cmp_lt_u32 s23, 200000
    s_cbranch_scc1 g_30L9_3
    s_mov_b32 s25, 200000
    s_branch gc_31
g_30F9_3:
    s_mov_b64 exec, vcc
    buffer_load_dwordx4 v[36:39], v8, s[4:7], s16 offen offset:3072 sc1
    s_mov_b64 exec, -1
    s_add_u32 s23, s23, 1
    s_cmp_lt_u32 s23, 200000
    s_cbranch_scc1 g_30L9_0
    s_mov_b32 s25, 200000
    s_branch gc_31
g_30F10_1:
    s_mov_b64 exec, vcc
    buffer_load_dwordx4 v[28:31], v8, s[4:7], s16 offen offset:1024 sc1
    s_mov_b64 exec, -1
    s_add_u32 s23, s23, 1
    s_cmp_lt_u32 s23, 200000
    s_cbranch_scc1 g_30L10_3
    s_mov_b32 s25, 200000
    s_branch gc_31
g_30F10_3:
    s_mov_b64 exec, vcc
    buffer_load_dwordx4 v[36:39], v8, s[4:7], s16 offen offset:3072 sc1
    s_mov_b64 exec, -1
    s_add_u32 s23, s23, 1
    s_cmp_lt_u32 s23, 200000
    s_cbranch_scc1 g_30L10_1
    s_mov_b32 s25, 200000
    s_branch gc_31
g_30F12_2:
    s_mov_b64 exec, vcc
    buffer_load_dwordx4 v[32:35], v8, s[4:7], s16 offen offset:2048 sc1
    s_mov_b64 exec, -1
    s_add_u32 s23, s23, 1
    s_cmp_lt_u32 s23, 200000
    s_cbranch_scc1 g_30L12_3
    s_mov_b32 s25, 200000
    s_branch gc_31
g_30F12_3:
    s_mov_b64 exec, vcc
    buffer_load_dwordx4 v[36:39], v8, s[4:7], s16 offen offset:3072 sc1
    s_mov_b64 exec, -1
    s_add_u32 s23, s23, 1
    s_cmp_lt_u32 s23, 200000
    s_cbranch_scc1 g_30L12_2
    s_mov_b32 s25, 200000
    s_branch gc_31
g_30F1_0:
    s_mov_b64 exec, vcc
    buffer_load_dwordx4 v[24:27], v8, s[4:7], s16 offen offset:0 sc1
    s_mov_b64 exec, -1
    s_add_u32 s23, s23, 1
    s_cmp_lt_u32 s23, 200000
    s_cbranch_scc1 g_30L1_0
    s_mov_b32 s25, 200000
    s_branch gc_31
g_30F2_1:
    s_mov_b64 exec, vcc
    buffer_load_dwordx4 v[28:31], v8, s[4:7], s16 offen offset:1024 sc1
    s_mov_b64 exec, -1
    s_add_u32 s23, s23, 1
    s_cmp_lt_u32 s23, 200000
    s_cbranch_scc1 g_30L2_1
    s_mov_b32 s25, 200000
    s_branch gc_31
g_30F4_2:
    s_mov_b64 exec, vcc
    buffer_load_dwordx4 v[32:35], v8, s[4:7], s16 offen offset:2048 sc1
    s_mov_b64 exec, -1
    s_add_u32 s23, s23, 1
    s_cmp_lt_u32 s23, 200000
    s_cbranch_scc1 g_30L4_2
    s_mov_b32 s25, 200000
    s_branch gc_31
g_30F8_3:
    s_mov_b64 exec, vcc
    buffer_load_dwordx4 v[36:39], v8, s[4:7], s16 offen offset:3072 sc1
    s_mov_b64 exec, -1
    s_add_u32 s23, s23, 1
    s_cmp_lt_u32 s23, 200000
    s_cbranch_scc1 g_30L8_3
    s_mov_b32 s25, 200000
    s_branch gc_31
.p2align 6
recur_fast_w1:
    s_nop 15
    s_mov_b32 s23, s25
    buffer_load_dwordx4 v[24:27], v2, s[4:7], s16 offen offset:0 sc1
    s_nop 11
    buffer_load_dwordx4 v[28:31], v2, s[4:7], s16 offen offset:1024 sc1
    s_nop 11
    buffer_load_dwordx4 v[32:35], v2, s[4:7], s16 offen offset:2048 sc1
    s_nop 11
    buffer_load_dwordx4 v[36:39], v2, s[4:7], s16 offen offset:3072 sc1
    s_waitcnt vmcnt(3)
    v_max3_u32 v19, v24, v25, v26
    v_max_u32 v19, v19, v27
    v_cmp_eq_u32 vcc, -1, v19
    s_nop 0
    s_cbranch_vccnz g_34F15_0
    v_smfmac_f32_16x16x64_bf16 v[40:43], v[24:27], a[0:7], v172
    s_waitcnt vmcnt(2)
    v_max3_u32 v19, v28, v29, v30
    v_max_u32 v19, v19, v31
    v_smfmac_f32_16x16x64_bf16 v[44:47], v[24:27], a[64:71], v172
    v_cmp_eq_u32 vcc, -1, v19
    v_smfmac_f32_16x16x64_bf16 v[48:51], v[24:27], a[32:39], v172
    v_smfmac_f32_16x16x64_bf16 v[52:55], v[24:27], a[96:103], v172
    s_cbranch_vccnz g_34F14_1
    v_smfmac_f32_16x16x64_bf16 v[40:43], v[28:31], a[8:15], v172
    s_waitcnt vmcnt(1)
    v_max3_u32 v19, v32, v33, v34
    v_max_u32 v19, v19, v35
    v_smfmac_f32_16x16x64_bf16 v[44:47], v[28:31], a[72:79], v172
    v_cmp_eq_u32 vcc, -1, v19
    v_smfmac_f32_16x16x64_bf16 v[48:51], v[28:31], a[40:47], v172
    v_smfmac_f32_16x16x64_bf16 v[52:55], v[28:31], a[104:111], v172
    s_cbranch_vccnz g_34F12_2
    v_smfmac_f32_16x16x64_bf16 v[40:43], v[32:35], a[16:23], v172
    s_waitcnt vmcnt(0)
    v_max3_u32 v19, v36, v37, v38
    v_max_u32 v19, v19, v39
    v_smfmac_f32_16x16x64_bf16 v[44:47], v[32:35], a[80:87], v172
    v_cmp_eq_u32 vcc, -1, v19
    v_smfmac_f32_16x16x64_bf16 v[48:51], v[32:35], a[48:55], v172
    v_smfmac_f32_16x16x64_bf16 v[52:55], v[32:35], a[112:119], v172
    s_cbranch_vccnz g_34F8_3
    v_smfmac_f32_16x16x64_bf16 v[40:43], v[36:39], a[24:31], v172
    v_smfmac_f32_16x16x64_bf16 v[44:47], v[36:39], a[88:95], v172
    v_smfmac_f32_16x16x64_bf16 v[48:51], v[36:39], a[56:63], v172
    v_smfmac_f32_16x16x64_bf16 v[52:55], v[36:39], a[120:127], v172
gc_35:
    v_cvt_pk_bf16_f32 v72, v40, v41
    v_cvt_pk_bf16_f32 v73, v42, v43
    v_cvt_pk_bf16_f32 v74, v44, v45
    v_cvt_pk_bf16_f32 v75, v46, v47
    ds_write_b128 v17, v[72:75] offset:0
    v_cvt_pk_bf16_f32 v76, v48, v49
    v_cvt_pk_bf16_f32 v77, v50, v51
    s_nop 0
    v_cvt_pk_bf16_f32 v78, v52, v53
    v_cvt_pk_bf16_f32 v79, v54, v55
    ds_write_b128 v17, v[76:79] offset:1024
    v_smfmac_f32_16x16x64_bf16 v[56:59], v[24:27], a[128:135], v172
    v_smfmac_f32_16x16x64_bf16 v[60:63], v[24:27], a[160:167], v172
    v_smfmac_f32_16x16x64_bf16 v[56:59], v[28:31], a[136:143], v172
    s_waitcnt lgkmcnt(0)
    s_barrier
    v_smfmac_f32_16x16x64_bf16 v[60:63], v[28:31], a[168:175], v172
    v_smfmac_f32_16x16x64_bf16 v[56:59], v[32:35], a[144:151], v172
    v_smfmac_f32_16x16x64_bf16 v[60:63], v[32:35], a[176:183], v172
    v_smfmac_f32_16x16x64_bf16 v[56:59], v[36:39], a[152:159], v172
    v_smfmac_f32_16x16x64_bf16 v[60:63], v[36:39], a[184:191], v172
    s_nop 4
    v_cvt_pk_bf16_f32 v80, v56, v57
    v_cvt_pk_bf16_f32 v81, v58, v59
    s_nop 0
    v_cvt_pk_bf16_f32 v82, v60, v61
    v_cvt_pk_bf16_f32 v83, v62, v63
    ds_write_b128 v17, v[80:83] offset:8192
    v_mov_b32 v152, v228
    v_mov_b32 v153, v229
    v_mov_b32 v156, v230
    v_mov_b32 v157, v231
    v_mov_b32 v160, v232
    v_mov_b32 v161, v233
    v_mov_b32 v164, v234
    v_mov_b32 v165, v235
    s_cmp_eq_u32 s15, 63
    s_waitcnt lgkmcnt(0)
    s_barrier
    s_cbranch_scc1 recur_end
    s_nop 15
    s_nop 15
    s_nop 7
    buffer_load_dwordx4 v[208:211], v5, s[4:7], s16 offen offset:0 sc1
    buffer_load_dwordx4 v[212:215], v5, s[4:7], s16 offen offset:1024 sc1
    buffer_load_dwordx4 v[216:219], v5, s[4:7], s16 offen offset:2048 sc1
    buffer_load_dwordx4 v[220:223], v5, s[4:7], s16 offen offset:3072 sc1
    buffer_load_dword v224, v6, s[4:7], s16 offen offset:0 sc1
    buffer_load_dword v225, v6, s[4:7], s16 offen offset:256 sc1
    buffer_load_dword v226, v6, s[4:7], s16 offen offset:512 sc1
    buffer_load_dword v227, v6, s[4:7], s16 offen offset:768 sc1
    s_mov_b32 s23, s25
    ds_read_b128 v[96:99], v16 offset:8192
    ds_read_b128 v[104:107], v16 offset:12288
    ds_read_b128 v[108:111], v16 offset:14336
    v_mfma_f32_16x16x32_bf16 v[140:143], v[84:87], v[80:83], 0
    s_waitcnt lgkmcnt(2)
    v_mfma_f32_16x16x32_bf16 v[140:143], v[84:87], v[96:99], v[140:143]
    s_waitcnt lgkmcnt(1)
    v_mfma_f32_16x16x32_bf16 v[140:143], v[84:87], v[104:107], v[140:143]
    s_waitcnt lgkmcnt(0)
    v_mfma_f32_16x16x32_bf16 v[140:143], v[84:87], v[108:111], v[140:143]
    buffer_load_dwordx4 v[24:27], v5, s[4:7], s16 offen offset:0 sc1
    buffer_load_dwordx4 v[28:31], v5, s[4:7], s16 offen offset:1024 sc1
    buffer_load_dwordx4 v[32:35], v5, s[4:7], s16 offen offset:2048 sc1
    buffer_load_dwordx4 v[36:39], v5, s[4:7], s16 offen offset:3072 sc1
    buffer_load_dword v40, v6, s[4:7], s16 offen offset:0 sc1
    buffer_load_dword v41, v6, s[4:7], s16 offen offset:256 sc1
    buffer_load_dword v42, v6, s[4:7], s16 offen offset:512 sc1
    buffer_load_dword v43, v6, s[4:7], s16 offen offset:768 sc1
    v_cvt_pk_bf16_f32 v154, v140, v179
    v_cvt_pk_bf16_f32 v158, v141, v179
    v_cvt_pk_bf16_f32 v162, v142, v179
    v_cvt_pk_bf16_f32 v166, v143, v179
    s_waitcnt vmcnt(14)
    v_pk_add_f32 v[180:181], v[208:209], v[212:213]
    v_pk_add_f32 v[182:183], v[210:211], v[214:215]
    s_waitcnt vmcnt(12)
    v_pk_add_f32 v[188:189], v[216:217], v[220:221]
    v_pk_add_f32 v[190:191], v[218:219], v[222:223]
    v_pk_add_f32 v[180:181], v[180:181], v[188:189]
    v_pk_add_f32 v[182:183], v[182:183], v[190:191]
    v_pk_add_f32 v[188:189], v[180:181], v[182:183]
    v_max3_f32 v185, v180, v181, v182
    s_waitcnt vmcnt(8)
    v_pk_add_f32 v[192:193], v[224:225], v[226:227]
    v_add_f32 v188, v188, v189
    v_add_f32 v184, v192, v193
    v_max3_f32 v185, v185, v183, v184
    v_cmp_u_f32 vcc, v188, v184
    s_nop 0
    v_max_f32_dpp v185, v185, v185 row_ror:8 row_mask:0xf bank_mask:0xf
    v_mov_b32 v186, v185
    s_nop 1
    v_permlane16_swap_b32 v185, v186
    v_max_f32 v185, v185, v186
    v_mov_b32 v186, v185
    s_cbranch_vccnz ss_36
sg_38:
    s_nop 0
    v_permlane32_swap_b32 v185, v186
    v_max_f32 v185, v185, v186
    v_mul_f32 v185, s24, v185
    v_fma_f32 v180, v180, s24, -v185
    v_fma_f32 v181, v181, s24, -v185
    v_fma_f32 v182, v182, s24, -v185
    v_fma_f32 v183, v183, s24, -v185
    v_fma_f32 v184, v184, s24, -v185
    v_exp_f32 v180, v180
    v_exp_f32 v181, v181
    v_exp_f32 v182, v182
    v_exp_f32 v183, v183
    v_exp_f32 v184, v184
    v_cvt_pk_bf16_f32 v176, v180, v181
    v_cvt_pk_bf16_f32 v177, v182, v183
    v_cvt_pk_bf16_f32 v178, v184, v179
    s_nop 1
    v_mfma_f32_16x16x32_bf16 v[240:243], v[236:239], v[176:179], 0
    v_mfma_f32_16x16x32_bf16 v[188:191], v[152:155], v[176:179], 0
    v_mfma_f32_16x16x32_bf16 v[192:195], v[156:159], v[176:179], 0
    v_mfma_f32_16x16x32_bf16 v[196:199], v[160:163], v[176:179], 0
    v_mfma_f32_16x16x32_bf16 v[200:203], v[164:167], v[176:179], 0
    v_add_f32_dpp v185, v240, v240 row_ror:8 row_mask:0xf bank_mask:0xf
    v_rcp_f32 v185, v185
    v_add_f32_dpp v88, v192, v188 row_ror:8 row_mask:0xf bank_mask:0x3
    v_add_f32_dpp v89, v193, v189 row_ror:8 row_mask:0xf bank_mask:0x3
    v_add_f32_dpp v90, v194, v190 row_ror:8 row_mask:0xf bank_mask:0x3
    v_add_f32_dpp v91, v195, v191 row_ror:8 row_mask:0xf bank_mask:0x3
    s_nop 1
    v_add_f32_dpp v88, v196, v200 row_ror:8 row_mask:0xf bank_mask:0xc
    v_add_f32_dpp v89, v197, v201 row_ror:8 row_mask:0xf bank_mask:0xc
    v_add_f32_dpp v90, v198, v202 row_ror:8 row_mask:0xf bank_mask:0xc
    v_add_f32_dpp v91, v199, v203 row_ror:8 row_mask:0xf bank_mask:0xc
    v_mul_f32 v88, v88, v185
    v_mul_f32 v89, v89, v185
    v_mul_f32 v90, v90, v185
    v_mul_f32 v91, v91, v185
    v_cvt_pk_bf16_f32 v88, v88, v89
    v_cvt_pk_bf16_f32 v89, v90, v91
    buffer_store_dwordx2 v[88:89], v7, s[4:7], s16 offen
    v_readfirstlane_b32 s85, v247
    s_add_u32 s94, s15, 2
    s_barrier
    s_nop 15
    s_mov_b32 s23, s25
    buffer_load_dwordx4 v[24:27], v8, s[4:7], s16 offen offset:0 sc1
    s_nop 11
    buffer_load_dwordx4 v[28:31], v8, s[4:7], s16 offen offset:1024 sc1
    s_nop 11
    buffer_load_dwordx4 v[32:35], v8, s[4:7], s16 offen offset:2048 sc1
    s_nop 11
    buffer_load_dwordx4 v[36:39], v8, s[4:7], s16 offen offset:3072 sc1
    s_waitcnt vmcnt(3)
    v_max3_u32 v19, v24, v25, v26
    v_max_u32 v19, v19, v27
    v_cmp_eq_u32 vcc, -1, v19
    s_nop 0
    s_cbranch_vccnz g_39F15_0
    v_smfmac_f32_16x16x64_bf16 v[64:67], v[24:27], a[192:199], v172
    v_smfmac_f32_16x16x64_bf16 v[68:71], v[24:27], a[224:231], v172
    s_waitcnt vmcnt(2)
    v_max3_u32 v19, v28, v29, v30
    v_max_u32 v19, v19, v31
    v_cmp_eq_u32 vcc, -1, v19
    s_nop 0
    s_cbranch_vccnz g_39F14_1
    v_smfmac_f32_16x16x64_bf16 v[64:67], v[28:31], a[200:207], v172
    v_smfmac_f32_16x16x64_bf16 v[68:71], v[28:31], a[232:239], v172
    s_waitcnt vmcnt(1)
    v_max3_u32 v19, v32, v33, v34
    v_max_u32 v19, v19, v35
    v_cmp_eq_u32 vcc, -1, v19
    s_nop 0
    s_cbranch_vccnz g_39F12_2
    v_smfmac_f32_16x16x64_bf16 v[64:67], v[32:35], a[208:215], v172
    v_smfmac_f32_16x16x64_bf16 v[68:71], v[32:35], a[240:247], v172
    s_waitcnt vmcnt(0)
    v_max3_u32 v19, v36, v37, v38
    v_max_u32 v19, v19, v39
    v_cmp_eq_u32 vcc, -1, v19
    s_nop 0
    s_cbranch_vccnz g_39F8_3
    v_smfmac_f32_16x16x64_bf16 v[64:67], v[36:39], a[216:223], v172
    v_smfmac_f32_16x16x64_bf16 v[68:71], v[36:39], a[248:255], v172
    s_nop 4
    v_cvt_pk_bf16_f32 v80, v64, v65
    v_cvt_pk_bf16_f32 v81, v66, v67
    s_nop 0
    v_cvt_pk_bf16_f32 v82, v68, v69
    v_cvt_pk_bf16_f32 v83, v70, v71
    ds_write_b128 v17, v[80:83] offset:9216
gc_40:
    s_waitcnt lgkmcnt(0)
    s_barrier
    s_nop 15
    s_nop 15
    s_nop 15
    s_nop 15
    s_mov_b32 s23, s25
fw_41:
    s_cmp_ge_u32 s85, s94
    s_cbranch_scc1 fo_42
    buffer_load_dword v247, v245, s[4:7], 0 offen sc1
    s_add_u32 s23, s23, 1
    s_waitcnt vmcnt(0)
    v_readfirstlane_b32 s85, v247
    s_cmp_lt_u32 s23, 200000
    s_cbranch_scc1 fw_41
    s_mov_b32 s25, 200000
fo_42:
    buffer_load_dwordx4 v[228:231], v13, s[4:7], s18 offen offset:0 sc1
    buffer_load_dwordx4 v[232:235], v13, s[4:7], s18 offen offset:256 sc1
    s_add_u32 s18, s18, 2048
    s_min_u32 s18, s18, 35780608
    buffer_load_dword v247, v245, s[4:7], 0 offen sc1
    v_mov_b32 v40, 0
    v_mov_b32 v41, 0
    v_mov_b32 v42, 0
    v_mov_b32 v43, 0
    v_mov_b32 v44, 0
    v_mov_b32 v45, 0
    v_mov_b32 v46, 0
    v_mov_b32 v47, 0
    v_mov_b32 v48, 0
    v_mov_b32 v49, 0
    v_mov_b32 v50, 0
    v_mov_b32 v51, 0
    v_mov_b32 v52, 0
    v_mov_b32 v53, 0
    v_mov_b32 v54, 0
    v_mov_b32 v55, 0
    v_mov_b32 v56, 0
    v_mov_b32 v57, 0
    v_mov_b32 v58, 0
    v_mov_b32 v59, 0
    v_mov_b32 v60, 0
    v_mov_b32 v61, 0
    v_mov_b32 v62, 0
    v_mov_b32 v63, 0
    v_mov_b32 v64, 0
    v_mov_b32 v65, 0
    v_mov_b32 v66, 0
    v_mov_b32 v67, 0
    v_mov_b32 v68, 0
    v_mov_b32 v69, 0
    v_mov_b32 v70, 0
    v_mov_b32 v71, 0
    s_mov_b32 s21, s16
    s_mov_b32 s16, s42
    s_mov_b32 s42, s43
    s_mov_b32 s43, s44
    s_mov_b32 s44, s21
    s_add_u32 s95, s95, 524288
    s_lshr_b32 s84, s95, 8
    s_and_b32 s84, s84, 8192
    s_xor_b32 s84, s84, s46
    s_add_u32 s84, s84, s95
    s_add_u32 s15, s15, 1
    s_barrier
    s_branch recur_fast_w1
g_34L15_0:
    s_waitcnt vmcnt(3)
    v_max3_u32 v19, v24, v25, v26
    v_max_u32 v19, v19, v27
    v_cmp_eq_u32 vcc, -1, v19
    s_nop 0
    s_cbranch_vccnz g_34F15_0
    v_smfmac_f32_16x16x64_bf16 v[40:43], v[24:27], a[0:7], v172
    v_smfmac_f32_16x16x64_bf16 v[44:47], v[24:27], a[64:71], v172
    v_smfmac_f32_16x16x64_bf16 v[48:51], v[24:27], a[32:39], v172
    v_smfmac_f32_16x16x64_bf16 v[52:55], v[24:27], a[96:103], v172
g_34L14_1:
    s_waitcnt vmcnt(2)
    v_max3_u32 v19, v28, v29, v30
    v_max_u32 v19, v19, v31
    v_cmp_eq_u32 vcc, -1, v19
    s_nop 0
    s_cbranch_vccnz g_34F14_1
    v_smfmac_f32_16x16x64_bf16 v[40:43], v[28:31], a[8:15], v172
    v_smfmac_f32_16x16x64_bf16 v[44:47], v[28:31], a[72:79], v172
    v_smfmac_f32_16x16x64_bf16 v[48:51], v[28:31], a[40:47], v172
    v_smfmac_f32_16x16x64_bf16 v[52:55], v[28:31], a[104:111], v172
g_34L12_2:
    s_waitcnt vmcnt(1)
    v_max3_u32 v19, v32, v33, v34
    v_max_u32 v19, v19, v35
    v_cmp_eq_u32 vcc, -1, v19
    s_nop 0
    s_cbranch_vccnz g_34F12_2
    v_smfmac_f32_16x16x64_bf16 v[40:43], v[32:35], a[16:23], v172
    v_smfmac_f32_16x16x64_bf16 v[44:47], v[32:35], a[80:87], v172
    v_smfmac_f32_16x16x64_bf16 v[48:51], v[32:35], a[48:55], v172
    v_smfmac_f32_16x16x64_bf16 v[52:55], v[32:35], a[112:119], v172
g_34L8_3:
    s_waitcnt vmcnt(0)
    v_max3_u32 v19, v36, v37, v38
    v_max_u32 v19, v19, v39
    v_cmp_eq_u32 vcc, -1, v19
    s_nop 0
    s_cbranch_vccnz g_34F8_3
    v_smfmac_f32_16x16x64_bf16 v[40:43], v[36:39], a[24:31], v172
    v_smfmac_f32_16x16x64_bf16 v[44:47], v[36:39], a[88:95], v172
    v_smfmac_f32_16x16x64_bf16 v[48:51], v[36:39], a[56:63], v172
    v_smfmac_f32_16x16x64_bf16 v[52:55], v[36:39], a[120:127], v172
    s_branch gc_35
g_34L15_1:
    s_waitcnt vmcnt(3)
    v_max3_u32 v19, v28, v29, v30
    v_max_u32 v19, v19, v31
    v_cmp_eq_u32 vcc, -1, v19
    s_nop 0
    s_cbranch_vccnz g_34F15_1
    v_smfmac_f32_16x16x64_bf16 v[40:43], v[28:31], a[8:15], v172
    v_smfmac_f32_16x16x64_bf16 v[44:47], v[28:31], a[72:79], v172
    v_smfmac_f32_16x16x64_bf16 v[48:51], v[28:31], a[40:47], v172
    v_smfmac_f32_16x16x64_bf16 v[52:55], v[28:31], a[104:111], v172
g_34L13_2:
    s_waitcnt vmcnt(2)
    v_max3_u32 v19, v32, v33, v34
    v_max_u32 v19, v19, v35
    v_cmp_eq_u32 vcc, -1, v19
    s_nop 0
    s_cbranch_vccnz g_34F13_2
    v_smfmac_f32_16x16x64_bf16 v[40:43], v[32:35], a[16:23], v172
    v_smfmac_f32_16x16x64_bf16 v[44:47], v[32:35], a[80:87], v172
    v_smfmac_f32_16x16x64_bf16 v[48:51], v[32:35], a[48:55], v172
    v_smfmac_f32_16x16x64_bf16 v[52:55], v[32:35], a[112:119], v172
g_34L9_3:
    s_waitcnt vmcnt(1)
    v_max3_u32 v19, v36, v37, v38
    v_max_u32 v19, v19, v39
    v_cmp_eq_u32 vcc, -1, v19
    s_nop 0
    s_cbranch_vccnz g_34F9_3
    v_smfmac_f32_16x16x64_bf16 v[40:43], v[36:39], a[24:31], v172
    v_smfmac_f32_16x16x64_bf16 v[44:47], v[36:39], a[88:95], v172
    v_smfmac_f32_16x16x64_bf16 v[48:51], v[36:39], a[56:63], v172
    v_smfmac_f32_16x16x64_bf16 v[52:55], v[36:39], a[120:127], v172
g_34L1_0:
    s_waitcnt vmcnt(0)
    v_max3_u32 v19, v24, v25, v26
    v_max_u32 v19, v19, v27
    v_cmp_eq_u32 vcc, -1, v19
    s_nop 0
    s_cbranch_vccnz g_34F1_0
    v_smfmac_f32_16x16x64_bf16 v[40:43], v[24:27], a[0:7], v172
    v_smfmac_f32_16x16x64_bf16 v[44:47], v[24:27], a[64:71], v172
    v_smfmac_f32_16x16x64_bf16 v[48:51], v[24:27], a[32:39], v172
    v_smfmac_f32_16x16x64_bf16 v[52:55], v[24:27], a[96:103], v172
    s_branch gc_35
g_34L15_2:
    s_waitcnt vmcnt(3)
    v_max3_u32 v19, v32, v33, v34
    v_max_u32 v19, v19, v35
    v_cmp_eq_u32 vcc, -1, v19
    s_nop 0
    s_cbranch_vccnz g_34F15_2
    v_smfmac_f32_16x16x64_bf16 v[40:43], v[32:35], a[16:23], v172
    v_smfmac_f32_16x16x64_bf16 v[44:47], v[32:35], a[80:87], v172
    v_smfmac_f32_16x16x64_bf16 v[48:51], v[32:35], a[48:55], v172
    v_smfmac_f32_16x16x64_bf16 v[52:55], v[32:35], a[112:119], v172
g_34L11_3:
    s_waitcnt vmcnt(2)
    v_max3_u32 v19, v36, v37, v38
    v_max_u32 v19, v19, v39
    v_cmp_eq_u32 vcc, -1, v19
    s_nop 0
    s_cbranch_vccnz g_34F11_3
    v_smfmac_f32_16x16x64_bf16 v[40:43], v[36:39], a[24:31], v172
    v_smfmac_f32_16x16x64_bf16 v[44:47], v[36:39], a[88:95], v172
    v_smfmac_f32_16x16x64_bf16 v[48:51], v[36:39], a[56:63], v172
    v_smfmac_f32_16x16x64_bf16 v[52:55], v[36:39], a[120:127], v172
g_34L3_0:
    s_waitcnt vmcnt(1)
    v_max3_u32 v19, v24, v25, v26
    v_max_u32 v19, v19, v27
    v_cmp_eq_u32 vcc, -1, v19
    s_nop 0
    s_cbranch_vccnz g_34F3_0
    v_smfmac_f32_16x16x64_bf16 v[40:43], v[24:27], a[0:7], v172
    v_smfmac_f32_16x16x64_bf16 v[44:47], v[24:27], a[64:71], v172
    v_smfmac_f32_16x16x64_bf16 v[48:51], v[24:27], a[32:39], v172
    v_smfmac_f32_16x16x64_bf16 v[52:55], v[24:27], a[96:103], v172
g_34L2_1:
    s_waitcnt vmcnt(0)
    v_max3_u32 v19, v28, v29, v30
    v_max_u32 v19, v19, v31
    v_cmp_eq_u32 vcc, -1, v19
    s_nop 0
    s_cbranch_vccnz g_34F2_1
    v_smfmac_f32_16x16x64_bf16 v[40:43], v[28:31], a[8:15], v172
    v_smfmac_f32_16x16x64_bf16 v[44:47], v[28:31], a[72:79], v172
    v_smfmac_f32_16x16x64_bf16 v[48:51], v[28:31], a[40:47], v172
    v_smfmac_f32_16x16x64_bf16 v[52:55], v[28:31], a[104:111], v172
    s_branch gc_35
g_34L15_3:
    s_waitcnt vmcnt(3)
    v_max3_u32 v19, v36, v37, v38
    v_max_u32 v19, v19, v39
    v_cmp_eq_u32 vcc, -1, v19
    s_nop 0
    s_cbranch_vccnz g_34F15_3
    v_smfmac_f32_16x16x64_bf16 v[40:43], v[36:39], a[24:31], v172
    v_smfmac_f32_16x16x64_bf16 v[44:47], v[36:39], a[88:95], v172
    v_smfmac_f32_16x16x64_bf16 v[48:51], v[36:39], a[56:63], v172
    v_smfmac_f32_16x16x64_bf16 v[52:55], v[36:39], a[120:127], v172
g_34L7_0:
    s_waitcnt vmcnt(2)
    v_max3_u32 v19, v24, v25, v26
    v_max_u32 v19, v19, v27
    v_cmp_eq_u32 vcc, -1, v19
    s_nop 0
    s_cbranch_vccnz g_34F7_0
    v_smfmac_f32_16x16x64_bf16 v[40:43], v[24:27], a[0:7], v172
    v_smfmac_f32_16x16x64_bf16 v[44:47], v[24:27], a[64:71], v172
    v_smfmac_f32_16x16x64_bf16 v[48:51], v[24:27], a[32:39], v172
    v_smfmac_f32_16x16x64_bf16 v[52:55], v[24:27], a[96:103], v172
g_34L6_1:
    s_waitcnt vmcnt(1)
    v_max3_u32 v19, v28, v29, v30
    v_max_u32 v19, v19, v31
    v_cmp_eq_u32 vcc, -1, v19
    s_nop 0
    s_cbranch_vccnz g_34F6_1
    v_smfmac_f32_16x16x64_bf16 v[40:43], v[28:31], a[8:15], v172
    v_smfmac_f32_16x16x64_bf16 v[44:47], v[28:31], a[72:79], v172
    v_smfmac_f32_16x16x64_bf16 v[48:51], v[28:31], a[40:47], v172
    v_smfmac_f32_16x16x64_bf16 v[52:55], v[28:31], a[104:111], v172
g_34L4_2:
    s_waitcnt vmcnt(0)
    v_max3_u32 v19, v32, v33, v34
    v_max_u32 v19, v19, v35
    v_cmp_eq_u32 vcc, -1, v19
    s_nop 0
    s_cbranch_vccnz g_34F4_2
    v_smfmac_f32_16x16x64_bf16 v[40:43], v[32:35], a[16:23], v172
    v_smfmac_f32_16x16x64_bf16 v[44:47], v[32:35], a[80:87], v172
    v_smfmac_f32_16x16x64_bf16 v[48:51], v[32:35], a[48:55], v172
    v_smfmac_f32_16x16x64_bf16 v[52:55], v[32:35], a[112:119], v172
    s_branch gc_35
g_34L7_1:
    s_waitcnt vmcnt(2)
    v_max3_u32 v19, v28, v29, v30
    v_max_u32 v19, v19, v31
    v_cmp_eq_u32 vcc, -1, v19
    s_nop 0
    s_cbranch_vccnz g_34F7_1
    v_smfmac_f32_16x16x64_bf16 v[40:43], v[28:31], a[8:15], v172
    v_smfmac_f32_16x16x64_bf16 v[44:47], v[28:31], a[72:79], v172
    v_smfmac_f32_16x16x64_bf16 v[48:51], v[28:31], a[40:47], v172
    v_smfmac_f32_16x16x64_bf16 v[52:55], v[28:31], a[104:111], v172
g_34L5_2:
    s_waitcnt vmcnt(1)
    v_max3_u32 v19, v32, v33, v34
    v_max_u32 v19, v19, v35
    v_cmp_eq_u32 vcc, -1, v19
    s_nop 0
    s_cbranch_vccnz g_34F5_2
    v_smfmac_f32_16x16x64_bf16 v[40:43], v[32:35], a[16:23], v172
    v_smfmac_f32_16x16x64_bf16 v[44:47], v[32:35], a[80:87], v172
    v_smfmac_f32_16x16x64_bf16 v[48:51], v[32:35], a[48:55], v172
    v_smfmac_f32_16x16x64_bf16 v[52:55], v[32:35], a[112:119], v172
    s_branch g_34L1_0
g_34L7_2:
    s_waitcnt vmcnt(2)
    v_max3_u32 v19, v32, v33, v34
    v_max_u32 v19, v19, v35
    v_cmp_eq_u32 vcc, -1, v19
    s_nop 0
    s_cbranch_vccnz g_34F7_2
    v_smfmac_f32_16x16x64_bf16 v[40:43], v[32:35], a[16:23], v172
    v_smfmac_f32_16x16x64_bf16 v[44:47], v[32:35], a[80:87], v172
    v_smfmac_f32_16x16x64_bf16 v[48:51], v[32:35], a[48:55], v172
    v_smfmac_f32_16x16x64_bf16 v[52:55], v[32:35], a[112:119], v172
    s_branch g_34L3_0
g_34L11_0:
    s_waitcnt vmcnt(2)
    v_max3_u32 v19, v24, v25, v26
    v_max_u32 v19, v19, v27
    v_cmp_eq_u32 vcc, -1, v19
    s_nop 0
    s_cbranch_vccnz g_34F11_0
    v_smfmac_f32_16x16x64_bf16 v[40:43], v[24:27], a[0:7], v172
    v_smfmac_f32_16x16x64_bf16 v[44:47], v[24:27], a[64:71], v172
    v_smfmac_f32_16x16x64_bf16 v[48:51], v[24:27], a[32:39], v172
    v_smfmac_f32_16x16x64_bf16 v[52:55], v[24:27], a[96:103], v172
g_34L10_1:
    s_waitcnt vmcnt(1)
    v_max3_u32 v19, v28, v29, v30
    v_max_u32 v19, v19, v31
    v_cmp_eq_u32 vcc, -1, v19
    s_nop 0
    s_cbranch_vccnz g_34F10_1
    v_smfmac_f32_16x16x64_bf16 v[40:43], v[28:31], a[8:15], v172
    v_smfmac_f32_16x16x64_bf16 v[44:47], v[28:31], a[72:79], v172
    v_smfmac_f32_16x16x64_bf16 v[48:51], v[28:31], a[40:47], v172
    v_smfmac_f32_16x16x64_bf16 v[52:55], v[28:31], a[104:111], v172
    s_branch g_34L8_3
g_34L11_1:
    s_waitcnt vmcnt(2)
    v_max3_u32 v19, v28, v29, v30
    v_max_u32 v19, v19, v31
    v_cmp_eq_u32 vcc, -1, v19
    s_nop 0
    s_cbranch_vccnz g_34F11_1
    v_smfmac_f32_16x16x64_bf16 v[40:43], v[28:31], a[8:15], v172
    v_smfmac_f32_16x16x64_bf16 v[44:47], v[28:31], a[72:79], v172
    v_smfmac_f32_16x16x64_bf16 v[48:51], v[28:31], a[40:47], v172
    v_smfmac_f32_16x16x64_bf16 v[52:55], v[28:31], a[104:111], v172
    s_branch g_34L9_3
g_34L13_0:
    s_waitcnt vmcnt(2)
    v_max3_u32 v19, v24, v25, v26
    v_max_u32 v19, v19, v27
    v_cmp_eq_u32 vcc, -1, v19
    s_nop 0
    s_cbranch_vccnz g_34F13_0
    v_smfmac_f32_16x16x64_bf16 v[40:43], v[24:27], a[0:7], v172
    v_smfmac_f32_16x16x64_bf16 v[44:47], v[24:27], a[64:71], v172
    v_smfmac_f32_16x16x64_bf16 v[48:51], v[24:27], a[32:39], v172
    v_smfmac_f32_16x16x64_bf16 v[52:55], v[24:27], a[96:103], v172
    s_branch g_34L12_2
g_34L13_3:
    s_waitcnt vmcnt(2)
    v_max3_u32 v19, v36, v37, v38
    v_max_u32 v19, v19, v39
    v_cmp_eq_u32 vcc, -1, v19
    s_nop 0
    s_cbranch_vccnz g_34F13_3
    v_smfmac_f32_16x16x64_bf16 v[40:43], v[36:39], a[24:31], v172
    v_smfmac_f32_16x16x64_bf16 v[44:47], v[36:39], a[88:95], v172
    v_smfmac_f32_16x16x64_bf16 v[48:51], v[36:39], a[56:63], v172
    v_smfmac_f32_16x16x64_bf16 v[52:55], v[36:39], a[120:127], v172
g_34L5_0:
    s_waitcnt vmcnt(1)
    v_max3_u32 v19, v24, v25, v26
    v_max_u32 v19, v19, v27
    v_cmp_eq_u32 vcc, -1, v19
    s_nop 0
    s_cbranch_vccnz g_34F5_0
    v_smfmac_f32_16x16x64_bf16 v[40:43], v[24:27], a[0:7], v172
    v_smfmac_f32_16x16x64_bf16 v[44:47], v[24:27], a[64:71], v172
    v_smfmac_f32_16x16x64_bf16 v[48:51], v[24:27], a[32:39], v172
    v_smfmac_f32_16x16x64_bf16 v[52:55], v[24:27], a[96:103], v172
    s_branch g_34L4_2
g_34L14_2:
    s_waitcnt vmcnt(2)
    v_max3_u32 v19, v32, v33, v34
    v_max_u32 v19, v19, v35
    v_cmp_eq_u32 vcc, -1, v19
    s_nop 0
    s_cbranch_vccnz g_34F14_2
    v_smfmac_f32_16x16x64_bf16 v[40:43], v[32:35], a[16:23], v172
    v_smfmac_f32_16x16x64_bf16 v[44:47], v[32:35], a[80:87], v172
    v_smfmac_f32_16x16x64_bf16 v[48:51], v[32:35], a[48:55], v172
    v_smfmac_f32_16x16x64_bf16 v[52:55], v[32:35], a[112:119], v172
g_34L10_3:
    s_waitcnt vmcnt(1)
    v_max3_u32 v19, v36, v37, v38
    v_max_u32 v19, v19, v39
    v_cmp_eq_u32 vcc, -1, v19
    s_nop 0
    s_cbranch_vccnz g_34F10_3
    v_smfmac_f32_16x16x64_bf16 v[40:43], v[36:39], a[24:31], v172
    v_smfmac_f32_16x16x64_bf16 v[44:47], v[36:39], a[88:95], v172
    v_smfmac_f32_16x16x64_bf16 v[48:51], v[36:39], a[56:63], v172
    v_smfmac_f32_16x16x64_bf16 v[52:55], v[36:39], a[120:127], v172
    s_branch g_34L2_1
g_34L14_3:
    s_waitcnt vmcnt(2)
    v_max3_u32 v19, v36, v37, v38
    v_max_u32 v19, v19, v39
    v_cmp_eq_u32 vcc, -1, v19
    s_nop 0
    s_cbranch_vccnz g_34F14_3
    v_smfmac_f32_16x16x64_bf16 v[40:43], v[36:39], a[24:31], v172
    v_smfmac_f32_16x16x64_bf16 v[44:47], v[36:39], a[88:95], v172
    v_smfmac_f32_16x16x64_bf16 v[48:51], v[36:39], a[56:63], v172
    v_smfmac_f32_16x16x64_bf16 v[52:55], v[36:39], a[120:127], v172
    s_branch g_34L6_1
g_34L3_1:
    s_waitcnt vmcnt(1)
    v_max3_u32 v19, v28, v29, v30
    v_max_u32 v19, v19, v31
    v_cmp_eq_u32 vcc, -1, v19
    s_nop 0
    s_cbranch_vccnz g_34F3_1
    v_smfmac_f32_16x16x64_bf16 v[40:43], v[28:31], a[8:15], v172
    v_smfmac_f32_16x16x64_bf16 v[44:47], v[28:31], a[72:79], v172
    v_smfmac_f32_16x16x64_bf16 v[48:51], v[28:31], a[40:47], v172
    v_smfmac_f32_16x16x64_bf16 v[52:55], v[28:31], a[104:111], v172
    s_branch g_34L1_0
g_34L6_2:
    s_waitcnt vmcnt(1)
    v_max3_u32 v19, v32, v33, v34
    v_max_u32 v19, v19, v35
    v_cmp_eq_u32 vcc, -1, v19
    s_nop 0
    s_cbranch_vccnz g_34F6_2
    v_smfmac_f32_16x16x64_bf16 v[40:43], v[32:35], a[16:23], v172
    v_smfmac_f32_16x16x64_bf16 v[44:47], v[32:35], a[80:87], v172
    v_smfmac_f32_16x16x64_bf16 v[48:51], v[32:35], a[48:55], v172
    v_smfmac_f32_16x16x64_bf16 v[52:55], v[32:35], a[112:119], v172
    s_branch g_34L2_1
g_34L9_0:
    s_waitcnt vmcnt(1)
    v_max3_u32 v19, v24, v25, v26
    v_max_u32 v19, v19, v27
    v_cmp_eq_u32 vcc, -1, v19
    s_nop 0
    s_cbranch_vccnz g_34F9_0
    v_smfmac_f32_16x16x64_bf16 v[40:43], v[24:27], a[0:7], v172
    v_smfmac_f32_16x16x64_bf16 v[44:47], v[24:27], a[64:71], v172
    v_smfmac_f32_16x16x64_bf16 v[48:51], v[24:27], a[32:39], v172
    v_smfmac_f32_16x16x64_bf16 v[52:55], v[24:27], a[96:103], v172
    s_branch g_34L8_3
g_34L12_3:
    s_waitcnt vmcnt(1)
    v_max3_u32 v19, v36, v37, v38
    v_max_u32 v19, v19, v39
    v_cmp_eq_u32 vcc, -1, v19
    s_nop 0
    s_cbranch_vccnz g_34F12_3
    v_smfmac_f32_16x16x64_bf16 v[40:43], v[36:39], a[24:31], v172
    v_smfmac_f32_16x16x64_bf16 v[44:47], v[36:39], a[88:95], v172
    v_smfmac_f32_16x16x64_bf16 v[48:51], v[36:39], a[56:63], v172
    v_smfmac_f32_16x16x64_bf16 v[52:55], v[36:39], a[120:127], v172
    s_branch g_34L4_2
g_34F15_0:
    s_mov_b64 exec, vcc
    buffer_load_dwordx4 v[24:27], v2, s[4:7], s16 offen offset:0 sc1
    s_mov_b64 exec, -1
    s_add_u32 s23, s23, 1
    s_cmp_lt_u32 s23, 200000
    s_cbranch_scc1 g_34L15_1
    s_mov_b32 s25, 200000
    s_branch gc_35
g_34F15_1:
    s_mov_b64 exec, vcc
    buffer_load_dwordx4 v[28:31], v2, s[4:7], s16 offen offset:1024 sc1
    s_mov_b64 exec, -1
    s_add_u32 s23, s23, 1
    s_cmp_lt_u32 s23, 200000
    s_cbranch_scc1 g_34L15_2
    s_mov_b32 s25, 200000
    s_branch gc_35
g_34F15_2:
    s_mov_b64 exec, vcc
    buffer_load_dwordx4 v[32:35], v2, s[4:7], s16 offen offset:2048 sc1
    s_mov_b64 exec, -1
    s_add_u32 s23, s23, 1
    s_cmp_lt_u32 s23, 200000
    s_cbranch_scc1 g_34L15_3
    s_mov_b32 s25, 200000
    s_branch gc_35
g_34F15_3:
    s_mov_b64 exec, vcc
    buffer_load_dwordx4 v[36:39], v2, s[4:7], s16 offen offset:3072 sc1
    s_mov_b64 exec, -1
    s_add_u32 s23, s23, 1
    s_cmp_lt_u32 s23, 200000
    s_cbranch_scc1 g_34L15_0
    s_mov_b32 s25, 200000
    s_branch gc_35
g_34F7_0:
    s_mov_b64 exec, vcc
    buffer_load_dwordx4 v[24:27], v2, s[4:7], s16 offen offset:0 sc1
    s_mov_b64 exec, -1
    s_add_u32 s23, s23, 1
    s_cmp_lt_u32 s23, 200000
    s_cbranch_scc1 g_34L7_1
    s_mov_b32 s25, 200000
    s_branch gc_35
g_34F7_1:
    s_mov_b64 exec, vcc
    buffer_load_dwordx4 v[28:31], v2, s[4:7], s16 offen offset:1024 sc1
    s_mov_b64 exec, -1
    s_add_u32 s23, s23, 1
    s_cmp_lt_u32 s23, 200000
    s_cbranch_scc1 g_34L7_2
    s_mov_b32 s25, 200000
    s_branch gc_35
g_34F7_2:
    s_mov_b64 exec, vcc
    buffer_load_dwordx4 v[32:35], v2, s[4:7], s16 offen offset:2048 sc1
    s_mov_b64 exec, -1
    s_add_u32 s23, s23, 1
    s_cmp_lt_u32 s23, 200000
    s_cbranch_scc1 g_34L7_0
    s_mov_b32 s25, 200000
    s_branch gc_35
g_34F11_0:
    s_mov_b64 exec, vcc
    buffer_load_dwordx4 v[24:27], v2, s[4:7], s16 offen offset:0 sc1
    s_mov_b64 exec, -1
    s_add_u32 s23, s23, 1
    s_cmp_lt_u32 s23, 200000
    s_cbranch_scc1 g_34L11_1
    s_mov_b32 s25, 200000
    s_branch gc_35
g_34F11_1:
    s_mov_b64 exec, vcc
    buffer_load_dwordx4 v[28:31], v2, s[4:7], s16 offen offset:1024 sc1
    s_mov_b64 exec, -1
    s_add_u32 s23, s23, 1
    s_cmp_lt_u32 s23, 200000
    s_cbranch_scc1 g_34L11_3
    s_mov_b32 s25, 200000
    s_branch gc_35
g_34F11_3:
    s_mov_b64 exec, vcc
    buffer_load_dwordx4 v[36:39], v2, s[4:7], s16 offen offset:3072 sc1
    s_mov_b64 exec, -1
    s_add_u32 s23, s23, 1
    s_cmp_lt_u32 s23, 200000
    s_cbranch_scc1 g_34L11_0
    s_mov_b32 s25, 200000
    s_branch gc_35
g_34F13_0:
    s_mov_b64 exec, vcc
    buffer_load_dwordx4 v[24:27], v2, s[4:7], s16 offen offset:0 sc1
    s_mov_b64 exec, -1
    s_add_u32 s23, s23, 1
    s_cmp_lt_u32 s23, 200000
    s_cbranch_scc1 g_34L13_2
    s_mov_b32 s25, 200000
    s_branch gc_35
g_34F13_2:
    s_mov_b64 exec, vcc
    buffer_load_dwordx4 v[32:35], v2, s[4:7], s16 offen offset:2048 sc1
    s_mov_b64 exec, -1
    s_add_u32 s23, s23, 1
    s_cmp_lt_u32 s23, 200000
    s_cbranch_scc1 g_34L13_3
    s_mov_b32 s25, 200000
    s_branch gc_35
g_34F13_3:
    s_mov_b64 exec, vcc
    buffer_load_dwordx4 v[36:39], v2, s[4:7], s16 offen offset:3072 sc1
    s_mov_b64 exec, -1
    s_add_u32 s23, s23, 1
    s_cmp_lt_u32 s23, 200000
    s_cbranch_scc1 g_34L13_0
    s_mov_b32 s25, 200000
    s_branch gc_35
g_34F14_1:
    s_mov_b64 exec, vcc
    buffer_load_dwordx4 v[28:31], v2, s[4:7], s16 offen offset:1024 sc1
    s_mov_b64 exec, -1
    s_add_u32 s23, s23, 1
    s_cmp_lt_u32 s23, 200000
    s_cbranch_scc1 g_34L14_2
    s_mov_b32 s25, 200000
    s_branch gc_35
g_34F14_2:
    s_mov_b64 exec, vcc
    buffer_load_dwordx4 v[32:35], v2, s[4:7], s16 offen offset:2048 sc1
    s_mov_b64 exec, -1
    s_add_u32 s23, s23, 1
    s_cmp_lt_u32 s23, 200000
    s_cbranch_scc1 g_34L14_3
    s_mov_b32 s25, 200000
    s_branch gc_35
g_34F14_3:
    s_mov_b64 exec, vcc
    buffer_load_dwordx4 v[36:39], v2, s[4:7], s16 offen offset:3072 sc1
    s_mov_b64 exec, -1
    s_add_u32 s23, s23, 1
    s_cmp_lt_u32 s23, 200000
    s_cbranch_scc1 g_34L14_1
    s_mov_b32 s25, 200000
    s_branch gc_35
g_34F3_0:
    s_mov_b64 exec, vcc
    buffer_load_dwordx4 v[24:27], v2, s[4:7], s16 offen offset:0 sc1
    s_mov_b64 exec, -1
    s_add_u32 s23, s23, 1
    s_cmp_lt_u32 s23, 200000
    s_cbranch_scc1 g_34L3_1
    s_mov_b32 s25, 200000
    s_branch gc_35
g_34F3_1:
    s_mov_b64 exec, vcc
    buffer_load_dwordx4 v[28:31], v2, s[4:7], s16 offen offset:1024 sc1
    s_mov_b64 exec, -1
    s_add_u32 s23, s23, 1
    s_cmp_lt_u32 s23, 200000
    s_cbranch_scc1 g_34L3_0
    s_mov_b32 s25, 200000
    s_branch gc_35
g_34F5_0:
    s_mov_b64 exec, vcc
    buffer_load_dwordx4 v[24:27], v2, s[4:7], s16 offen offset:0 sc1
    s_mov_b64 exec, -1
    s_add_u32 s23, s23, 1
    s_cmp_lt_u32 s23, 200000
    s_cbranch_scc1 g_34L5_2
    s_mov_b32 s25, 200000
    s_branch gc_35
g_34F5_2:
    s_mov_b64 exec, vcc
    buffer_load_dwordx4 v[32:35], v2, s[4:7], s16 offen offset:2048 sc1
    s_mov_b64 exec, -1
    s_add_u32 s23, s23, 1
    s_cmp_lt_u32 s23, 200000
    s_cbranch_scc1 g_34L5_0
    s_mov_b32 s25, 200000
    s_branch gc_35
g_34F6_1:
    s_mov_b64 exec, vcc
    buffer_load_dwordx4 v[28:31], v2, s[4:7], s16 offen offset:1024 sc1
    s_mov_b64 exec, -1
    s_add_u32 s23, s23, 1
    s_cmp_lt_u32 s23, 200000
    s_cbranch_scc1 g_34L6_2
    s_mov_b32 s25, 200000
    s_branch gc_35
g_34F6_2:
    s_mov_b64 exec, vcc
    buffer_load_dwordx4 v[32:35], v2, s[4:7], s16 offen offset:2048 sc1
    s_mov_b64 exec, -1
    s_add_u32 s23, s23, 1
    s_cmp_lt_u32 s23, 200000
    s_cbranch_scc1 g_34L6_1
    s_mov_b32 s25, 200000
    s_branch gc_35
g_34F9_0:
    s_mov_b64 exec, vcc
    buffer_load_dwordx4 v[24:27], v2, s[4:7], s16 offen offset:0 sc1
    s_mov_b64 exec, -1
    s_add_u32 s23, s23, 1
    s_cmp_lt_u32 s23, 200000
    s_cbranch_scc1 g_34L9_3
    s_mov_b32 s25, 200000
    s_branch gc_35
g_34F9_3:
    s_mov_b64 exec, vcc
    buffer_load_dwordx4 v[36:39], v2, s[4:7], s16 offen offset:3072 sc1
    s_mov_b64 exec, -1
    s_add_u32 s23, s23, 1
    s_cmp_lt_u32 s23, 200000
    s_cbranch_scc1 g_34L9_0
    s_mov_b32 s25, 200000
    s_branch gc_35
g_34F10_1:
    s_mov_b64 exec, vcc
    buffer_load_dwordx4 v[28:31], v2, s[4:7], s16 offen offset:1024 sc1
    s_mov_b64 exec, -1
    s_add_u32 s23, s23, 1
    s_cmp_lt_u32 s23, 200000
    s_cbranch_scc1 g_34L10_3
    s_mov_b32 s25, 200000
    s_branch gc_35
g_34F10_3:
    s_mov_b64 exec, vcc
    buffer_load_dwordx4 v[36:39], v2, s[4:7], s16 offen offset:3072 sc1
    s_mov_b64 exec, -1
    s_add_u32 s23, s23, 1
    s_cmp_lt_u32 s23, 200000
    s_cbranch_scc1 g_34L10_1
    s_mov_b32 s25, 200000
    s_branch gc_35
g_34F12_2:
    s_mov_b64 exec, vcc
    buffer_load_dwordx4 v[32:35], v2, s[4:7], s16 offen offset:2048 sc1
    s_mov_b64 exec, -1
    s_add_u32 s23, s23, 1
    s_cmp_lt_u32 s23, 200000
    s_cbranch_scc1 g_34L12_3
    s_mov_b32 s25, 200000
    s_branch gc_35
g_34F12_3:
    s_mov_b64 exec, vcc
    buffer_load_dwordx4 v[36:39], v2, s[4:7], s16 offen offset:3072 sc1
    s_mov_b64 exec, -1
    s_add_u32 s23, s23, 1
    s_cmp_lt_u32 s23, 200000
    s_cbranch_scc1 g_34L12_2
    s_mov_b32 s25, 200000
    s_branch gc_35
g_34F1_0:
    s_mov_b64 exec, vcc
    buffer_load_dwordx4 v[24:27], v2, s[4:7], s16 offen offset:0 sc1
    s_mov_b64 exec, -1
    s_add_u32 s23, s23, 1
    s_cmp_lt_u32 s23, 200000
    s_cbranch_scc1 g_34L1_0
    s_mov_b32 s25, 200000
    s_branch gc_35
g_34F2_1:
    s_mov_b64 exec, vcc
    buffer_load_dwordx4 v[28:31], v2, s[4:7], s16 offen offset:1024 sc1
    s_mov_b64 exec, -1
    s_add_u32 s23, s23, 1
    s_cmp_lt_u32 s23, 200000
    s_cbranch_scc1 g_34L2_1
    s_mov_b32 s25, 200000
    s_branch gc_35
g_34F4_2:
    s_mov_b64 exec, vcc
    buffer_load_dwordx4 v[32:35], v2, s[4:7], s16 offen offset:2048 sc1
    s_mov_b64 exec, -1
    s_add_u32 s23, s23, 1
    s_cmp_lt_u32 s23, 200000
    s_cbranch_scc1 g_34L4_2
    s_mov_b32 s25, 200000
    s_branch gc_35
g_34F8_3:
    s_mov_b64 exec, vcc
    buffer_load_dwordx4 v[36:39], v2, s[4:7], s16 offen offset:3072 sc1
    s_mov_b64 exec, -1
    s_add_u32 s23, s23, 1
    s_cmp_lt_u32 s23, 200000
    s_cbranch_scc1 g_34L8_3
    s_mov_b32 s25, 200000
    s_branch gc_35
sb_37:
    v_max3_u32 v19, v24, v25, v26
    v_max3_u32 v19, v19, v27, v28
    v_max3_u32 v19, v19, v29, v30
    v_max3_u32 v19, v19, v31, v32
    v_max3_u32 v19, v19, v33, v34
    v_max3_u32 v19, v19, v35, v36
    v_max3_u32 v19, v19, v37, v38
    v_max3_u32 v19, v19, v39, v40
    v_max3_u32 v19, v19, v41, v42
    v_max_u32 v19, v19, v43
    v_cmp_eq_u32 vcc, -1, v19
    s_nop 0
    s_cbranch_vccz sg_38
    buffer_load_dwordx4 v[24:27], v5, s[4:7], s16 offen offset:0 sc1
    buffer_load_dwordx4 v[28:31], v5, s[4:7], s16 offen offset:1024 sc1
    buffer_load_dwordx4 v[32:35], v5, s[4:7], s16 offen offset:2048 sc1
    buffer_load_dwordx4 v[36:39], v5, s[4:7], s16 offen offset:3072 sc1
    buffer_load_dword v40, v6, s[4:7], s16 offen offset:0 sc1
    buffer_load_dword v41, v6, s[4:7], s16 offen offset:256 sc1
    buffer_load_dword v42, v6, s[4:7], s16 offen offset:512 sc1
    buffer_load_dword v43, v6, s[4:7], s16 offen offset:768 sc1
    s_add_u32 s23, s23, 1
    s_cmp_lt_u32 s23, 200000
    s_cbranch_scc1 ss_36
    s_mov_b32 s25, 200000
    s_branch sg_38
ss_36:
    s_waitcnt vmcnt(6)
    v_pk_add_f32 v[180:181], v[24:25], v[28:29]
    v_pk_add_f32 v[182:183], v[26:27], v[30:31]
    s_waitcnt vmcnt(4)
    v_pk_add_f32 v[188:189], v[32:33], v[36:37]
    v_pk_add_f32 v[190:191], v[34:35], v[38:39]
    v_pk_add_f32 v[180:181], v[180:181], v[188:189]
    v_pk_add_f32 v[182:183], v[182:183], v[190:191]
    v_pk_add_f32 v[188:189], v[180:181], v[182:183]
    v_max3_f32 v185, v180, v181, v182
    s_waitcnt vmcnt(0)
    v_pk_add_f32 v[192:193], v[40:41], v[42:43]
    v_add_f32 v188, v188, v189
    v_add_f32 v184, v192, v193
    v_max3_f32 v185, v185, v183, v184
    v_cmp_u_f32 vcc, v188, v184
    s_nop 0
    v_max_f32_dpp v185, v185, v185 row_ror:8 row_mask:0xf bank_mask:0xf
    v_mov_b32 v186, v185
    s_nop 1
    v_permlane16_swap_b32 v185, v186
    v_max_f32 v185, v185, v186
    v_mov_b32 v186, v185
    s_cbranch_vccnz sb_37
    s_branch sg_38
g_39L15_0:
    s_waitcnt vmcnt(3)
    v_max3_u32 v19, v24, v25, v26
    v_max_u32 v19, v19, v27
    v_cmp_eq_u32 vcc, -1, v19
    s_nop 0
    s_cbranch_vccnz g_39F15_0
    v_smfmac_f32_16x16x64_bf16 v[64:67], v[24:27], a[192:199], v172
    v_smfmac_f32_16x16x64_bf16 v[68:71], v[24:27], a[224:231], v172
g_39L14_1:
    s_waitcnt vmcnt(2)
    v_max3_u32 v19, v28, v29, v30
    v_max_u32 v19, v19, v31
    v_cmp_eq_u32 vcc, -1, v19
    s_nop 0
    s_cbranch_vccnz g_39F14_1
    v_smfmac_f32_16x16x64_bf16 v[64:67], v[28:31], a[200:207], v172
    v_smfmac_f32_16x16x64_bf16 v[68:71], v[28:31], a[232:239], v172
g_39L12_2:
    s_waitcnt vmcnt(1)
    v_max3_u32 v19, v32, v33, v34
    v_max_u32 v19, v19, v35
    v_cmp_eq_u32 vcc, -1, v19
    s_nop 0
    s_cbranch_vccnz g_39F12_2
    v_smfmac_f32_16x16x64_bf16 v[64:67], v[32:35], a[208:215], v172
    v_smfmac_f32_16x16x64_bf16 v[68:71], v[32:35], a[240:247], v172
g_39L8_3:
    s_waitcnt vmcnt(0)
    v_max3_u32 v19, v36, v37, v38
    v_max_u32 v19, v19, v39
    v_cmp_eq_u32 vcc, -1, v19
    s_nop 0
    s_cbranch_vccnz g_39F8_3
    v_smfmac_f32_16x16x64_bf16 v[64:67], v[36:39], a[216:223], v172
    v_smfmac_f32_16x16x64_bf16 v[68:71], v[36:39], a[248:255], v172
    s_nop 4
    v_cvt_pk_bf16_f32 v80, v64, v65
    v_cvt_pk_bf16_f32 v81, v66, v67
    s_nop 0
    v_cvt_pk_bf16_f32 v82, v68, v69
    v_cvt_pk_bf16_f32 v83, v70, v71
    ds_write_b128 v17, v[80:83] offset:9216
    s_branch gc_40
g_39L15_1:
    s_waitcnt vmcnt(3)
    v_max3_u32 v19, v28, v29, v30
    v_max_u32 v19, v19, v31
    v_cmp_eq_u32 vcc, -1, v19
    s_nop 0
    s_cbranch_vccnz g_39F15_1
    v_smfmac_f32_16x16x64_bf16 v[64:67], v[28:31], a[200:207], v172
    v_smfmac_f32_16x16x64_bf16 v[68:71], v[28:31], a[232:239], v172
g_39L13_2:
    s_waitcnt vmcnt(2)
    v_max3_u32 v19, v32, v33, v34
    v_max_u32 v19, v19, v35
    v_cmp_eq_u32 vcc, -1, v19
    s_nop 0
    s_cbranch_vccnz g_39F13_2
    v_smfmac_f32_16x16x64_bf16 v[64:67], v[32:35], a[208:215], v172
    v_smfmac_f32_16x16x64_bf16 v[68:71], v[32:35], a[240:247], v172
g_39L9_3:
    s_waitcnt vmcnt(1)
    v_max3_u32 v19, v36, v37, v38
    v_max_u32 v19, v19, v39
    v_cmp_eq_u32 vcc, -1, v19
    s_nop 0
    s_cbranch_vccnz g_39F9_3
    v_smfmac_f32_16x16x64_bf16 v[64:67], v[36:39], a[216:223], v172
    v_smfmac_f32_16x16x64_bf16 v[68:71], v[36:39], a[248:255], v172
g_39L1_0:
    s_waitcnt vmcnt(0)
    v_max3_u32 v19, v24, v25, v26
    v_max_u32 v19, v19, v27
    v_cmp_eq_u32 vcc, -1, v19
    s_nop 0
    s_cbranch_vccnz g_39F1_0
    v_smfmac_f32_16x16x64_bf16 v[64:67], v[24:27], a[192:199], v172
    v_smfmac_f32_16x16x64_bf16 v[68:71], v[24:27], a[224:231], v172
    s_nop 4
    v_cvt_pk_bf16_f32 v80, v64, v65
    v_cvt_pk_bf16_f32 v81, v66, v67
    s_nop 0
    v_cvt_pk_bf16_f32 v82, v68, v69
    v_cvt_pk_bf16_f32 v83, v70, v71
    ds_write_b128 v17, v[80:83] offset:9216
    s_branch gc_40
g_39L15_2:
    s_waitcnt vmcnt(3)
    v_max3_u32 v19, v32, v33, v34
    v_max_u32 v19, v19, v35
    v_cmp_eq_u32 vcc, -1, v19
    s_nop 0
    s_cbranch_vccnz g_39F15_2
    v_smfmac_f32_16x16x64_bf16 v[64:67], v[32:35], a[208:215], v172
    v_smfmac_f32_16x16x64_bf16 v[68:71], v[32:35], a[240:247], v172
g_39L11_3:
    s_waitcnt vmcnt(2)
    v_max3_u32 v19, v36, v37, v38
    v_max_u32 v19, v19, v39
    v_cmp_eq_u32 vcc, -1, v19
    s_nop 0
    s_cbranch_vccnz g_39F11_3
    v_smfmac_f32_16x16x64_bf16 v[64:67], v[36:39], a[216:223], v172
    v_smfmac_f32_16x16x64_bf16 v[68:71], v[36:39], a[248:255], v172
g_39L3_0:
    s_waitcnt vmcnt(1)
    v_max3_u32 v19, v24, v25, v26
    v_max_u32 v19, v19, v27
    v_cmp_eq_u32 vcc, -1, v19
    s_nop 0
    s_cbranch_vccnz g_39F3_0
    v_smfmac_f32_16x16x64_bf16 v[64:67], v[24:27], a[192:199], v172
    v_smfmac_f32_16x16x64_bf16 v[68:71], v[24:27], a[224:231], v172
g_39L2_1:
    s_waitcnt vmcnt(0)
    v_max3_u32 v19, v28, v29, v30
    v_max_u32 v19, v19, v31
    v_cmp_eq_u32 vcc, -1, v19
    s_nop 0
    s_cbranch_vccnz g_39F2_1
    v_smfmac_f32_16x16x64_bf16 v[64:67], v[28:31], a[200:207], v172
    v_smfmac_f32_16x16x64_bf16 v[68:71], v[28:31], a[232:239], v172
    s_nop 4
    v_cvt_pk_bf16_f32 v80, v64, v65
    v_cvt_pk_bf16_f32 v81, v66, v67
    s_nop 0
    v_cvt_pk_bf16_f32 v82, v68, v69
    v_cvt_pk_bf16_f32 v83, v70, v71
    ds_write_b128 v17, v[80:83] offset:9216
    s_branch gc_40
g_39L15_3:
    s_waitcnt vmcnt(3)
    v_max3_u32 v19, v36, v37, v38
    v_max_u32 v19, v19, v39
    v_cmp_eq_u32 vcc, -1, v19
    s_nop 0
    s_cbranch_vccnz g_39F15_3
    v_smfmac_f32_16x16x64_bf16 v[64:67], v[36:39], a[216:223], v172
    v_smfmac_f32_16x16x64_bf16 v[68:71], v[36:39], a[248:255], v172
g_39L7_0:
    s_waitcnt vmcnt(2)
    v_max3_u32 v19, v24, v25, v26
    v_max_u32 v19, v19, v27
    v_cmp_eq_u32 vcc, -1, v19
    s_nop 0
    s_cbranch_vccnz g_39F7_0
    v_smfmac_f32_16x16x64_bf16 v[64:67], v[24:27], a[192:199], v172
    v_smfmac_f32_16x16x64_bf16 v[68:71], v[24:27], a[224:231], v172
g_39L6_1:
    s_waitcnt vmcnt(1)
    v_max3_u32 v19, v28, v29, v30
    v_max_u32 v19, v19, v31
    v_cmp_eq_u32 vcc, -1, v19
    s_nop 0
    s_cbranch_vccnz g_39F6_1
    v_smfmac_f32_16x16x64_bf16 v[64:67], v[28:31], a[200:207], v172
    v_smfmac_f32_16x16x64_bf16 v[68:71], v[28:31], a[232:239], v172
g_39L4_2:
    s_waitcnt vmcnt(0)
    v_max3_u32 v19, v32, v33, v34
    v_max_u32 v19, v19, v35
    v_cmp_eq_u32 vcc, -1, v19
    s_nop 0
    s_cbranch_vccnz g_39F4_2
    v_smfmac_f32_16x16x64_bf16 v[64:67], v[32:35], a[208:215], v172
    v_smfmac_f32_16x16x64_bf16 v[68:71], v[32:35], a[240:247], v172
    s_nop 4
    v_cvt_pk_bf16_f32 v80, v64, v65
    v_cvt_pk_bf16_f32 v81, v66, v67
    s_nop 0
    v_cvt_pk_bf16_f32 v82, v68, v69
    v_cvt_pk_bf16_f32 v83, v70, v71
    ds_write_b128 v17, v[80:83] offset:9216
    s_branch gc_40
g_39L7_1:
    s_waitcnt vmcnt(2)
    v_max3_u32 v19, v28, v29, v30
    v_max_u32 v19, v19, v31
    v_cmp_eq_u32 vcc, -1, v19
    s_nop 0
    s_cbranch_vccnz g_39F7_1
    v_smfmac_f32_16x16x64_bf16 v[64:67], v[28:31], a[200:207], v172
    v_smfmac_f32_16x16x64_bf16 v[68:71], v[28:31], a[232:239], v172
g_39L5_2:
    s_waitcnt vmcnt(1)
    v_max3_u32 v19, v32, v33, v34
    v_max_u32 v19, v19, v35
    v_cmp_eq_u32 vcc, -1, v19
    s_nop 0
    s_cbranch_vccnz g_39F5_2
    v_smfmac_f32_16x16x64_bf16 v[64:67], v[32:35], a[208:215], v172
    v_smfmac_f32_16x16x64_bf16 v[68:71], v[32:35], a[240:247], v172
    s_branch g_39L1_0
g_39L7_2:
    s_waitcnt vmcnt(2)
    v_max3_u32 v19, v32, v33, v34
    v_max_u32 v19, v19, v35
    v_cmp_eq_u32 vcc, -1, v19
    s_nop 0
    s_cbranch_vccnz g_39F7_2
    v_smfmac_f32_16x16x64_bf16 v[64:67], v[32:35], a[208:215], v172
    v_smfmac_f32_16x16x64_bf16 v[68:71], v[32:35], a[240:247], v172
    s_branch g_39L3_0
g_39L11_0:
    s_waitcnt vmcnt(2)
    v_max3_u32 v19, v24, v25, v26
    v_max_u32 v19, v19, v27
    v_cmp_eq_u32 vcc, -1, v19
    s_nop 0
    s_cbranch_vccnz g_39F11_0
    v_smfmac_f32_16x16x64_bf16 v[64:67], v[24:27], a[192:199], v172
    v_smfmac_f32_16x16x64_bf16 v[68:71], v[24:27], a[224:231], v172
g_39L10_1:
    s_waitcnt vmcnt(1)
    v_max3_u32 v19, v28, v29, v30
    v_max_u32 v19, v19, v31
    v_cmp_eq_u32 vcc, -1, v19
    s_nop 0
    s_cbranch_vccnz g_39F10_1
    v_smfmac_f32_16x16x64_bf16 v[64:67], v[28:31], a[200:207], v172
    v_smfmac_f32_16x16x64_bf16 v[68:71], v[28:31], a[232:239], v172
    s_branch g_39L8_3
g_39L11_1:
    s_waitcnt vmcnt(2)
    v_max3_u32 v19, v28, v29, v30
    v_max_u32 v19, v19, v31
    v_cmp_eq_u32 vcc, -1, v19
    s_nop 0
    s_cbranch_vccnz g_39F11_1
    v_smfmac_f32_16x16x64_bf16 v[64:67], v[28:31], a[200:207], v172
    v_smfmac_f32_16x16x64_bf16 v[68:71], v[28:31], a[232:239], v172
    s_branch g_39L9_3
g_39L13_0:
    s_waitcnt vmcnt(2)
    v_max3_u32 v19, v24, v25, v26
    v_max_u32 v19, v19, v27
    v_cmp_eq_u32 vcc, -1, v19
    s_nop 0
    s_cbranch_vccnz g_39F13_0
    v_smfmac_f32_16x16x64_bf16 v[64:67], v[24:27], a[192:199], v172
    v_smfmac_f32_16x16x64_bf16 v[68:71], v[24:27], a[224:231], v172
    s_branch g_39L12_2
g_39L13_3:
    s_waitcnt vmcnt(2)
    v_max3_u32 v19, v36, v37, v38
    v_max_u32 v19, v19, v39
    v_cmp_eq_u32 vcc, -1, v19
    s_nop 0
    s_cbranch_vccnz g_39F13_3
    v_smfmac_f32_16x16x64_bf16 v[64:67], v[36:39], a[216:223], v172
    v_smfmac_f32_16x16x64_bf16 v[68:71], v[36:39], a[248:255], v172
g_39L5_0:
    s_waitcnt vmcnt(1)
    v_max3_u32 v19, v24, v25, v26
    v_max_u32 v19, v19, v27
    v_cmp_eq_u32 vcc, -1, v19
    s_nop 0
    s_cbranch_vccnz g_39F5_0
    v_smfmac_f32_16x16x64_bf16 v[64:67], v[24:27], a[192:199], v172
    v_smfmac_f32_16x16x64_bf16 v[68:71], v[24:27], a[224:231], v172
    s_branch g_39L4_2
g_39L14_2:
    s_waitcnt vmcnt(2)
    v_max3_u32 v19, v32, v33, v34
    v_max_u32 v19, v19, v35
    v_cmp_eq_u32 vcc, -1, v19
    s_nop 0
    s_cbranch_vccnz g_39F14_2
    v_smfmac_f32_16x16x64_bf16 v[64:67], v[32:35], a[208:215], v172
    v_smfmac_f32_16x16x64_bf16 v[68:71], v[32:35], a[240:247], v172
g_39L10_3:
    s_waitcnt vmcnt(1)
    v_max3_u32 v19, v36, v37, v38
    v_max_u32 v19, v19, v39
    v_cmp_eq_u32 vcc, -1, v19
    s_nop 0
    s_cbranch_vccnz g_39F10_3
    v_smfmac_f32_16x16x64_bf16 v[64:67], v[36:39], a[216:223], v172
    v_smfmac_f32_16x16x64_bf16 v[68:71], v[36:39], a[248:255], v172
    s_branch g_39L2_1
g_39L14_3:
    s_waitcnt vmcnt(2)
    v_max3_u32 v19, v36, v37, v38
    v_max_u32 v19, v19, v39
    v_cmp_eq_u32 vcc, -1, v19
    s_nop 0
    s_cbranch_vccnz g_39F14_3
    v_smfmac_f32_16x16x64_bf16 v[64:67], v[36:39], a[216:223], v172
    v_smfmac_f32_16x16x64_bf16 v[68:71], v[36:39], a[248:255], v172
    s_branch g_39L6_1
g_39L3_1:
    s_waitcnt vmcnt(1)
    v_max3_u32 v19, v28, v29, v30
    v_max_u32 v19, v19, v31
    v_cmp_eq_u32 vcc, -1, v19
    s_nop 0
    s_cbranch_vccnz g_39F3_1
    v_smfmac_f32_16x16x64_bf16 v[64:67], v[28:31], a[200:207], v172
    v_smfmac_f32_16x16x64_bf16 v[68:71], v[28:31], a[232:239], v172
    s_branch g_39L1_0
g_39L6_2:
    s_waitcnt vmcnt(1)
    v_max3_u32 v19, v32, v33, v34
    v_max_u32 v19, v19, v35
    v_cmp_eq_u32 vcc, -1, v19
    s_nop 0
    s_cbranch_vccnz g_39F6_2
    v_smfmac_f32_16x16x64_bf16 v[64:67], v[32:35], a[208:215], v172
    v_smfmac_f32_16x16x64_bf16 v[68:71], v[32:35], a[240:247], v172
    s_branch g_39L2_1
g_39L9_0:
    s_waitcnt vmcnt(1)
    v_max3_u32 v19, v24, v25, v26
    v_max_u32 v19, v19, v27
    v_cmp_eq_u32 vcc, -1, v19
    s_nop 0
    s_cbranch_vccnz g_39F9_0
    v_smfmac_f32_16x16x64_bf16 v[64:67], v[24:27], a[192:199], v172
    v_smfmac_f32_16x16x64_bf16 v[68:71], v[24:27], a[224:231], v172
    s_branch g_39L8_3
g_39L12_3:
    s_waitcnt vmcnt(1)
    v_max3_u32 v19, v36, v37, v38
    v_max_u32 v19, v19, v39
    v_cmp_eq_u32 vcc, -1, v19
    s_nop 0
    s_cbranch_vccnz g_39F12_3
    v_smfmac_f32_16x16x64_bf16 v[64:67], v[36:39], a[216:223], v172
    v_smfmac_f32_16x16x64_bf16 v[68:71], v[36:39], a[248:255], v172
    s_branch g_39L4_2
g_39F15_0:
    s_mov_b64 exec, vcc
    buffer_load_dwordx4 v[24:27], v8, s[4:7], s16 offen offset:0 sc1
    s_mov_b64 exec, -1
    s_add_u32 s23, s23, 1
    s_cmp_lt_u32 s23, 200000
    s_cbranch_scc1 g_39L15_1
    s_mov_b32 s25, 200000
    s_branch gc_40
g_39F15_1:
    s_mov_b64 exec, vcc
    buffer_load_dwordx4 v[28:31], v8, s[4:7], s16 offen offset:1024 sc1
    s_mov_b64 exec, -1
    s_add_u32 s23, s23, 1
    s_cmp_lt_u32 s23, 200000
    s_cbranch_scc1 g_39L15_2
    s_mov_b32 s25, 200000
    s_branch gc_40
g_39F15_2:
    s_mov_b64 exec, vcc
    buffer_load_dwordx4 v[32:35], v8, s[4:7], s16 offen offset:2048 sc1
    s_mov_b64 exec, -1
    s_add_u32 s23, s23, 1
    s_cmp_lt_u32 s23, 200000
    s_cbranch_scc1 g_39L15_3
    s_mov_b32 s25, 200000
    s_branch gc_40
g_39F15_3:
    s_mov_b64 exec, vcc
    buffer_load_dwordx4 v[36:39], v8, s[4:7], s16 offen offset:3072 sc1
    s_mov_b64 exec, -1
    s_add_u32 s23, s23, 1
    s_cmp_lt_u32 s23, 200000
    s_cbranch_scc1 g_39L15_0
    s_mov_b32 s25, 200000
    s_branch gc_40
g_39F7_0:
    s_mov_b64 exec, vcc
    buffer_load_dwordx4 v[24:27], v8, s[4:7], s16 offen offset:0 sc1
    s_mov_b64 exec, -1
    s_add_u32 s23, s23, 1
    s_cmp_lt_u32 s23, 200000
    s_cbranch_scc1 g_39L7_1
    s_mov_b32 s25, 200000
    s_branch gc_40
g_39F7_1:
    s_mov_b64 exec, vcc
    buffer_load_dwordx4 v[28:31], v8, s[4:7], s16 offen offset:1024 sc1
    s_mov_b64 exec, -1
    s_add_u32 s23, s23, 1
    s_cmp_lt_u32 s23, 200000
    s_cbranch_scc1 g_39L7_2
    s_mov_b32 s25, 200000
    s_branch gc_40
g_39F7_2:
    s_mov_b64 exec, vcc
    buffer_load_dwordx4 v[32:35], v8, s[4:7], s16 offen offset:2048 sc1
    s_mov_b64 exec, -1
    s_add_u32 s23, s23, 1
    s_cmp_lt_u32 s23, 200000
    s_cbranch_scc1 g_39L7_0
    s_mov_b32 s25, 200000
    s_branch gc_40
g_39F11_0:
    s_mov_b64 exec, vcc
    buffer_load_dwordx4 v[24:27], v8, s[4:7], s16 offen offset:0 sc1
    s_mov_b64 exec, -1
    s_add_u32 s23, s23, 1
    s_cmp_lt_u32 s23, 200000
    s_cbranch_scc1 g_39L11_1
    s_mov_b32 s25, 200000
    s_branch gc_40
g_39F11_1:
    s_mov_b64 exec, vcc
    buffer_load_dwordx4 v[28:31], v8, s[4:7], s16 offen offset:1024 sc1
    s_mov_b64 exec, -1
    s_add_u32 s23, s23, 1
    s_cmp_lt_u32 s23, 200000
    s_cbranch_scc1 g_39L11_3
    s_mov_b32 s25, 200000
    s_branch gc_40
g_39F11_3:
    s_mov_b64 exec, vcc
    buffer_load_dwordx4 v[36:39], v8, s[4:7], s16 offen offset:3072 sc1
    s_mov_b64 exec, -1
    s_add_u32 s23, s23, 1
    s_cmp_lt_u32 s23, 200000
    s_cbranch_scc1 g_39L11_0
    s_mov_b32 s25, 200000
    s_branch gc_40
g_39F13_0:
    s_mov_b64 exec, vcc
    buffer_load_dwordx4 v[24:27], v8, s[4:7], s16 offen offset:0 sc1
    s_mov_b64 exec, -1
    s_add_u32 s23, s23, 1
    s_cmp_lt_u32 s23, 200000
    s_cbranch_scc1 g_39L13_2
    s_mov_b32 s25, 200000
    s_branch gc_40
g_39F13_2:
    s_mov_b64 exec, vcc
    buffer_load_dwordx4 v[32:35], v8, s[4:7], s16 offen offset:2048 sc1
    s_mov_b64 exec, -1
    s_add_u32 s23, s23, 1
    s_cmp_lt_u32 s23, 200000
    s_cbranch_scc1 g_39L13_3
    s_mov_b32 s25, 200000
    s_branch gc_40
g_39F13_3:
    s_mov_b64 exec, vcc
    buffer_load_dwordx4 v[36:39], v8, s[4:7], s16 offen offset:3072 sc1
    s_mov_b64 exec, -1
    s_add_u32 s23, s23, 1
    s_cmp_lt_u32 s23, 200000
    s_cbranch_scc1 g_39L13_0
    s_mov_b32 s25, 200000
    s_branch gc_40
g_39F14_1:
    s_mov_b64 exec, vcc
    buffer_load_dwordx4 v[28:31], v8, s[4:7], s16 offen offset:1024 sc1
    s_mov_b64 exec, -1
    s_add_u32 s23, s23, 1
    s_cmp_lt_u32 s23, 200000
    s_cbranch_scc1 g_39L14_2
    s_mov_b32 s25, 200000
    s_branch gc_40
g_39F14_2:
    s_mov_b64 exec, vcc
    buffer_load_dwordx4 v[32:35], v8, s[4:7], s16 offen offset:2048 sc1
    s_mov_b64 exec, -1
    s_add_u32 s23, s23, 1
    s_cmp_lt_u32 s23, 200000
    s_cbranch_scc1 g_39L14_3
    s_mov_b32 s25, 200000
    s_branch gc_40
g_39F14_3:
    s_mov_b64 exec, vcc
    buffer_load_dwordx4 v[36:39], v8, s[4:7], s16 offen offset:3072 sc1
    s_mov_b64 exec, -1
    s_add_u32 s23, s23, 1
    s_cmp_lt_u32 s23, 200000
    s_cbranch_scc1 g_39L14_1
    s_mov_b32 s25, 200000
    s_branch gc_40
g_39F3_0:
    s_mov_b64 exec, vcc
    buffer_load_dwordx4 v[24:27], v8, s[4:7], s16 offen offset:0 sc1
    s_mov_b64 exec, -1
    s_add_u32 s23, s23, 1
    s_cmp_lt_u32 s23, 200000
    s_cbranch_scc1 g_39L3_1
    s_mov_b32 s25, 200000
    s_branch gc_40
g_39F3_1:
    s_mov_b64 exec, vcc
    buffer_load_dwordx4 v[28:31], v8, s[4:7], s16 offen offset:1024 sc1
    s_mov_b64 exec, -1
    s_add_u32 s23, s23, 1
    s_cmp_lt_u32 s23, 200000
    s_cbranch_scc1 g_39L3_0
    s_mov_b32 s25, 200000
    s_branch gc_40
g_39F5_0:
    s_mov_b64 exec, vcc
    buffer_load_dwordx4 v[24:27], v8, s[4:7], s16 offen offset:0 sc1
    s_mov_b64 exec, -1
    s_add_u32 s23, s23, 1
    s_cmp_lt_u32 s23, 200000
    s_cbranch_scc1 g_39L5_2
    s_mov_b32 s25, 200000
    s_branch gc_40
g_39F5_2:
    s_mov_b64 exec, vcc
    buffer_load_dwordx4 v[32:35], v8, s[4:7], s16 offen offset:2048 sc1
    s_mov_b64 exec, -1
    s_add_u32 s23, s23, 1
    s_cmp_lt_u32 s23, 200000
    s_cbranch_scc1 g_39L5_0
    s_mov_b32 s25, 200000
    s_branch gc_40
g_39F6_1:
    s_mov_b64 exec, vcc
    buffer_load_dwordx4 v[28:31], v8, s[4:7], s16 offen offset:1024 sc1
    s_mov_b64 exec, -1
    s_add_u32 s23, s23, 1
    s_cmp_lt_u32 s23, 200000
    s_cbranch_scc1 g_39L6_2
    s_mov_b32 s25, 200000
    s_branch gc_40
g_39F6_2:
    s_mov_b64 exec, vcc
    buffer_load_dwordx4 v[32:35], v8, s[4:7], s16 offen offset:2048 sc1
    s_mov_b64 exec, -1
    s_add_u32 s23, s23, 1
    s_cmp_lt_u32 s23, 200000
    s_cbranch_scc1 g_39L6_1
    s_mov_b32 s25, 200000
    s_branch gc_40
g_39F9_0:
    s_mov_b64 exec, vcc
    buffer_load_dwordx4 v[24:27], v8, s[4:7], s16 offen offset:0 sc1
    s_mov_b64 exec, -1
    s_add_u32 s23, s23, 1
    s_cmp_lt_u32 s23, 200000
    s_cbranch_scc1 g_39L9_3
    s_mov_b32 s25, 200000
    s_branch gc_40
g_39F9_3:
    s_mov_b64 exec, vcc
    buffer_load_dwordx4 v[36:39], v8, s[4:7], s16 offen offset:3072 sc1
    s_mov_b64 exec, -1
    s_add_u32 s23, s23, 1
    s_cmp_lt_u32 s23, 200000
    s_cbranch_scc1 g_39L9_0
    s_mov_b32 s25, 200000
    s_branch gc_40
g_39F10_1:
    s_mov_b64 exec, vcc
    buffer_load_dwordx4 v[28:31], v8, s[4:7], s16 offen offset:1024 sc1
    s_mov_b64 exec, -1
    s_add_u32 s23, s23, 1
    s_cmp_lt_u32 s23, 200000
    s_cbranch_scc1 g_39L10_3
    s_mov_b32 s25, 200000
    s_branch gc_40
g_39F10_3:
    s_mov_b64 exec, vcc
    buffer_load_dwordx4 v[36:39], v8, s[4:7], s16 offen offset:3072 sc1
    s_mov_b64 exec, -1
    s_add_u32 s23, s23, 1
    s_cmp_lt_u32 s23, 200000
    s_cbranch_scc1 g_39L10_1
    s_mov_b32 s25, 200000
    s_branch gc_40
g_39F12_2:
    s_mov_b64 exec, vcc
    buffer_load_dwordx4 v[32:35], v8, s[4:7], s16 offen offset:2048 sc1
    s_mov_b64 exec, -1
    s_add_u32 s23, s23, 1
    s_cmp_lt_u32 s23, 200000
    s_cbranch_scc1 g_39L12_3
    s_mov_b32 s25, 200000
    s_branch gc_40
g_39F12_3:
    s_mov_b64 exec, vcc
    buffer_load_dwordx4 v[36:39], v8, s[4:7], s16 offen offset:3072 sc1
    s_mov_b64 exec, -1
    s_add_u32 s23, s23, 1
    s_cmp_lt_u32 s23, 200000
    s_cbranch_scc1 g_39L12_2
    s_mov_b32 s25, 200000
    s_branch gc_40
g_39F1_0:
    s_mov_b64 exec, vcc
    buffer_load_dwordx4 v[24:27], v8, s[4:7], s16 offen offset:0 sc1
    s_mov_b64 exec, -1
    s_add_u32 s23, s23, 1
    s_cmp_lt_u32 s23, 200000
    s_cbranch_scc1 g_39L1_0
    s_mov_b32 s25, 200000
    s_branch gc_40
g_39F2_1:
    s_mov_b64 exec, vcc
    buffer_load_dwordx4 v[28:31], v8, s[4:7], s16 offen offset:1024 sc1
    s_mov_b64 exec, -1
    s_add_u32 s23, s23, 1
    s_cmp_lt_u32 s23, 200000
    s_cbranch_scc1 g_39L2_1
    s_mov_b32 s25, 200000
    s_branch gc_40
g_39F4_2:
    s_mov_b64 exec, vcc
    buffer_load_dwordx4 v[32:35], v8, s[4:7], s16 offen offset:2048 sc1
    s_mov_b64 exec, -1
    s_add_u32 s23, s23, 1
    s_cmp_lt_u32 s23, 200000
    s_cbranch_scc1 g_39L4_2
    s_mov_b32 s25, 200000
    s_branch gc_40
g_39F8_3:
    s_mov_b64 exec, vcc
    buffer_load_dwordx4 v[36:39], v8, s[4:7], s16 offen offset:3072 sc1
    s_mov_b64 exec, -1
    s_add_u32 s23, s23, 1
    s_cmp_lt_u32 s23, 200000
    s_cbranch_scc1 g_39L8_3
    s_mov_b32 s25, 200000
    s_branch gc_40
.p2align 6
recur_fast_w2:
    s_nop 15
    s_mov_b32 s23, s25
    buffer_load_dwordx4 v[24:27], v2, s[4:7], s16 offen offset:0 sc1
    s_nop 11
    buffer_load_dwordx4 v[28:31], v2, s[4:7], s16 offen offset:1024 sc1
    s_nop 11
    buffer_load_dwordx4 v[32:35], v2, s[4:7], s16 offen offset:2048 sc1
    s_nop 11
    buffer_load_dwordx4 v[36:39], v2, s[4:7], s16 offen offset:3072 sc1
    s_waitcnt vmcnt(3)
    v_max3_u32 v19, v24, v25, v26
    v_max_u32 v19, v19, v27
    v_cmp_eq_u32 vcc, -1, v19
    s_nop 0
    s_cbranch_vccnz g_43F15_0
    v_smfmac_f32_16x16x64_bf16 v[40:43], v[24:27], a[0:7], v172
    s_waitcnt vmcnt(2)
    v_max3_u32 v19, v28, v29, v30
    v_max_u32 v19, v19, v31
    v_smfmac_f32_16x16x64_bf16 v[44:47], v[24:27], a[64:71], v172
    v_cmp_eq_u32 vcc, -1, v19
    v_smfmac_f32_16x16x64_bf16 v[48:51], v[24:27], a[32:39], v172
    v_smfmac_f32_16x16x64_bf16 v[52:55], v[24:27], a[96:103], v172
    s_cbranch_vccnz g_43F14_1
    v_smfmac_f32_16x16x64_bf16 v[40:43], v[28:31], a[8:15], v172
    s_waitcnt vmcnt(1)
    v_max3_u32 v19, v32, v33, v34
    v_max_u32 v19, v19, v35
    v_smfmac_f32_16x16x64_bf16 v[44:47], v[28:31], a[72:79], v172
    v_cmp_eq_u32 vcc, -1, v19
    v_smfmac_f32_16x16x64_bf16 v[48:51], v[28:31], a[40:47], v172
    v_smfmac_f32_16x16x64_bf16 v[52:55], v[28:31], a[104:111], v172
    s_cbranch_vccnz g_43F12_2
    v_smfmac_f32_16x16x64_bf16 v[40:43], v[32:35], a[16:23], v172
    s_waitcnt vmcnt(0)
    v_max3_u32 v19, v36, v37, v38
    v_max_u32 v19, v19, v39
    v_smfmac_f32_16x16x64_bf16 v[44:47], v[32:35], a[80:87], v172
    v_cmp_eq_u32 vcc, -1, v19
    v_smfmac_f32_16x16x64_bf16 v[48:51], v[32:35], a[48:55], v172
    v_smfmac_f32_16x16x64_bf16 v[52:55], v[32:35], a[112:119], v172
    s_cbranch_vccnz g_43F8_3
    v_smfmac_f32_16x16x64_bf16 v[40:43], v[36:39], a[24:31], v172
    v_smfmac_f32_16x16x64_bf16 v[44:47], v[36:39], a[88:95], v172
    v_smfmac_f32_16x16x64_bf16 v[48:51], v[36:39], a[56:63], v172
    v_smfmac_f32_16x16x64_bf16 v[52:55], v[36:39], a[120:127], v172
gc_44:
    v_cvt_pk_bf16_f32 v72, v40, v41
    v_cvt_pk_bf16_f32 v73, v42, v43
    v_cvt_pk_bf16_f32 v74, v44, v45
    v_cvt_pk_bf16_f32 v75, v46, v47
    ds_write_b128 v17, v[72:75] offset:0
    v_cvt_pk_bf16_f32 v76, v48, v49
    v_cvt_pk_bf16_f32 v77, v50, v51
    s_nop 0
    v_cvt_pk_bf16_f32 v78, v52, v53
    v_cvt_pk_bf16_f32 v79, v54, v55
    ds_write_b128 v17, v[76:79] offset:1024
    v_smfmac_f32_16x16x64_bf16 v[56:59], v[24:27], a[128:135], v172
    v_smfmac_f32_16x16x64_bf16 v[60:63], v[24:27], a[160:167], v172
    v_smfmac_f32_16x16x64_bf16 v[56:59], v[28:31], a[136:143], v172
    s_waitcnt lgkmcnt(0)
    s_barrier
    v_smfmac_f32_16x16x64_bf16 v[60:63], v[28:31], a[168:175], v172
    v_smfmac_f32_16x16x64_bf16 v[56:59], v[32:35], a[144:151], v172
    v_smfmac_f32_16x16x64_bf16 v[60:63], v[32:35], a[176:183], v172
    v_smfmac_f32_16x16x64_bf16 v[56:59], v[36:39], a[152:159], v172
    v_smfmac_f32_16x16x64_bf16 v[60:63], v[36:39], a[184:191], v172
    s_nop 4
    v_cvt_pk_bf16_f32 v80, v56, v57
    v_cvt_pk_bf16_f32 v81, v58, v59
    s_nop 0
    v_cvt_pk_bf16_f32 v82, v60, v61
    v_cvt_pk_bf16_f32 v83, v62, v63
    ds_write_b128 v17, v[80:83] offset:8192
    s_cmp_eq_u32 s15, 63
    s_waitcnt lgkmcnt(0)
    s_barrier
    ds_read_b128 v[96:99], v16 offset:8192
    ds_read_b128 v[100:103], v16 offset:10240
    ds_read_b128 v[108:111], v16 offset:14336
    v_mfma_f32_16x16x32_bf16 v[140:143], v[84:87], v[80:83], 0
    s_waitcnt lgkmcnt(2)
    v_mfma_f32_16x16x32_bf16 v[140:143], v[84:87], v[96:99], v[140:143]
    s_waitcnt lgkmcnt(1)
    v_mfma_f32_16x16x32_bf16 v[140:143], v[84:87], v[100:103], v[140:143]
    s_waitcnt lgkmcnt(0)
    v_mfma_f32_16x16x32_bf16 v[140:143], v[84:87], v[108:111], v[140:143]
    s_nop 7
    v_cvt_pk_bf16_f32 v168, v140, v141
    v_cvt_pk_bf16_f32 v169, v142, v143
    v_mov_b32 v170, v168
    v_mov_b32 v171, v169
    s_nop 0
    v_permlane16_swap_b32 v168, v170
    v_permlane16_swap_b32 v169, v171
    v_mov_b32 v247, s15
    s_cbranch_scc1 recur_fast_last2
    s_barrier
    s_nop 15
    s_mov_b32 s23, s25
    buffer_load_dwordx4 v[24:27], v8, s[4:7], s16 offen offset:0 sc1
    s_nop 11
    buffer_load_dwordx4 v[28:31], v8, s[4:7], s16 offen offset:1024 sc1
    s_nop 11
    buffer_load_dwordx4 v[32:35], v8, s[4:7], s16 offen offset:2048 sc1
    s_nop 11
    buffer_load_dwordx4 v[36:39], v8, s[4:7], s16 offen offset:3072 sc1
    s_waitcnt vmcnt(3)
    v_max3_u32 v19, v24, v25, v26
    v_max_u32 v19, v19, v27
    v_cmp_eq_u32 vcc, -1, v19
    s_nop 0
    s_cbranch_vccnz g_45F15_0
    v_smfmac_f32_16x16x64_bf16 v[64:67], v[24:27], a[192:199], v172
    v_smfmac_f32_16x16x64_bf16 v[68:71], v[24:27], a[224:231], v172
    s_waitcnt vmcnt(2)
    v_max3_u32 v19, v28, v29, v30
    v_max_u32 v19, v19, v31
    v_cmp_eq_u32 vcc, -1, v19
    s_nop 0
    s_cbranch_vccnz g_45F14_1
    v_smfmac_f32_16x16x64_bf16 v[64:67], v[28:31], a[200:207], v172
    v_smfmac_f32_16x16x64_bf16 v[68:71], v[28:31], a[232:239], v172
    s_waitcnt vmcnt(1)
    v_max3_u32 v19, v32, v33, v34
    v_max_u32 v19, v19, v35
    v_cmp_eq_u32 vcc, -1, v19
    s_nop 0
    s_cbranch_vccnz g_45F12_2
    v_smfmac_f32_16x16x64_bf16 v[64:67], v[32:35], a[208:215], v172
    v_smfmac_f32_16x16x64_bf16 v[68:71], v[32:35], a[240:247], v172
    s_waitcnt vmcnt(0)
    v_max3_u32 v19, v36, v37, v38
    v_max_u32 v19, v19, v39
    v_cmp_eq_u32 vcc, -1, v19
    s_nop 0
    s_cbranch_vccnz g_45F8_3
    v_smfmac_f32_16x16x64_bf16 v[64:67], v[36:39], a[216:223], v172
    v_smfmac_f32_16x16x64_bf16 v[68:71], v[36:39], a[248:255], v172
    s_nop 4
    v_cvt_pk_bf16_f32 v80, v64, v65
    v_cvt_pk_bf16_f32 v81, v66, v67
    s_nop 0
    v_cvt_pk_bf16_f32 v82, v68, v69
    v_cvt_pk_bf16_f32 v83, v70, v71
    ds_write_b128 v17, v[80:83] offset:9216
gc_46:
    s_waitcnt lgkmcnt(0)
    s_barrier
    s_nop 15
    s_nop 15
    s_nop 15
    s_nop 15
    buffer_store_dwordx4 v[168:171], v15, s[4:7], s20 offen sc1
    s_add_u32 s20, s20, 512
    s_add_u32 s21, s95, 1048576
    s_lshr_b32 s22, s21, 8
    s_and_b32 s22, s22, 8192
    s_xor_b32 s22, s22, s46
    s_add_u32 s21, s21, s22
    buffer_store_dwordx4 v[204:207], v9, s[4:7], s21 offen sc1
    s_add_u32 s21, s21, 262144
    buffer_store_dword v247, v246, s[4:7], 0 offen sc1
    v_mov_b32 v40, 0
    v_mov_b32 v41, 0
    v_mov_b32 v42, 0
    v_mov_b32 v43, 0
    v_mov_b32 v44, 0
    v_mov_b32 v45, 0
    v_mov_b32 v46, 0
    v_mov_b32 v47, 0
    v_mov_b32 v48, 0
    v_mov_b32 v49, 0
    v_mov_b32 v50, 0
    v_mov_b32 v51, 0
    v_mov_b32 v52, 0
    v_mov_b32 v53, 0
    v_mov_b32 v54, 0
    v_mov_b32 v55, 0
    v_mov_b32 v56, 0
    v_mov_b32 v57, 0
    v_mov_b32 v58, 0
    v_mov_b32 v59, 0
    v_mov_b32 v60, 0
    v_mov_b32 v61, 0
    v_mov_b32 v62, 0
    v_mov_b32 v63, 0
    v_mov_b32 v64, 0
    v_mov_b32 v65, 0
    v_mov_b32 v66, 0
    v_mov_b32 v67, 0
    v_mov_b32 v68, 0
    v_mov_b32 v69, 0
    v_mov_b32 v70, 0
    v_mov_b32 v71, 0
    s_mov_b32 s21, s16
    s_mov_b32 s16, s42
    s_mov_b32 s42, s43
    s_mov_b32 s43, s44
    s_mov_b32 s44, s21
    s_add_u32 s95, s95, 524288
    s_lshr_b32 s84, s95, 8
    s_and_b32 s84, s84, 8192
    s_xor_b32 s84, s84, s46
    s_add_u32 s84, s84, s95
    s_add_u32 s15, s15, 1
    s_barrier
    s_branch recur_fast_w2
g_43L15_0:
    s_waitcnt vmcnt(3)
    v_max3_u32 v19, v24, v25, v26
    v_max_u32 v19, v19, v27
    v_cmp_eq_u32 vcc, -1, v19
    s_nop 0
    s_cbranch_vccnz g_43F15_0
    v_smfmac_f32_16x16x64_bf16 v[40:43], v[24:27], a[0:7], v172
    v_smfmac_f32_16x16x64_bf16 v[44:47], v[24:27], a[64:71], v172
    v_smfmac_f32_16x16x64_bf16 v[48:51], v[24:27], a[32:39], v172
    v_smfmac_f32_16x16x64_bf16 v[52:55], v[24:27], a[96:103], v172
g_43L14_1:
    s_waitcnt vmcnt(2)
    v_max3_u32 v19, v28, v29, v30
    v_max_u32 v19, v19, v31
    v_cmp_eq_u32 vcc, -1, v19
    s_nop 0
    s_cbranch_vccnz g_43F14_1
    v_smfmac_f32_16x16x64_bf16 v[40:43], v[28:31], a[8:15], v172
    v_smfmac_f32_16x16x64_bf16 v[44:47], v[28:31], a[72:79], v172
    v_smfmac_f32_16x16x64_bf16 v[48:51], v[28:31], a[40:47], v172
    v_smfmac_f32_16x16x64_bf16 v[52:55], v[28:31], a[104:111], v172
g_43L12_2:
    s_waitcnt vmcnt(1)
    v_max3_u32 v19, v32, v33, v34
    v_max_u32 v19, v19, v35
    v_cmp_eq_u32 vcc, -1, v19
    s_nop 0
    s_cbranch_vccnz g_43F12_2
    v_smfmac_f32_16x16x64_bf16 v[40:43], v[32:35], a[16:23], v172
    v_smfmac_f32_16x16x64_bf16 v[44:47], v[32:35], a[80:87], v172
    v_smfmac_f32_16x16x64_bf16 v[48:51], v[32:35], a[48:55], v172
    v_smfmac_f32_16x16x64_bf16 v[52:55], v[32:35], a[112:119], v172
g_43L8_3:
    s_waitcnt vmcnt(0)
    v_max3_u32 v19, v36, v37, v38
    v_max_u32 v19, v19, v39
    v_cmp_eq_u32 vcc, -1, v19
    s_nop 0
    s_cbranch_vccnz g_43F8_3
    v_smfmac_f32_16x16x64_bf16 v[40:43], v[36:39], a[24:31], v172
    v_smfmac_f32_16x16x64_bf16 v[44:47], v[36:39], a[88:95], v172
    v_smfmac_f32_16x16x64_bf16 v[48:51], v[36:39], a[56:63], v172
    v_smfmac_f32_16x16x64_bf16 v[52:55], v[36:39], a[120:127], v172
    s_branch gc_44
g_43L15_1:
    s_waitcnt vmcnt(3)
    v_max3_u32 v19, v28, v29, v30
    v_max_u32 v19, v19, v31
    v_cmp_eq_u32 vcc, -1, v19
    s_nop 0
    s_cbranch_vccnz g_43F15_1
    v_smfmac_f32_16x16x64_bf16 v[40:43], v[28:31], a[8:15], v172
    v_smfmac_f32_16x16x64_bf16 v[44:47], v[28:31], a[72:79], v172
    v_smfmac_f32_16x16x64_bf16 v[48:51], v[28:31], a[40:47], v172
    v_smfmac_f32_16x16x64_bf16 v[52:55], v[28:31], a[104:111], v172
g_43L13_2:
    s_waitcnt vmcnt(2)
    v_max3_u32 v19, v32, v33, v34
    v_max_u32 v19, v19, v35
    v_cmp_eq_u32 vcc, -1, v19
    s_nop 0
    s_cbranch_vccnz g_43F13_2
    v_smfmac_f32_16x16x64_bf16 v[40:43], v[32:35], a[16:23], v172
    v_smfmac_f32_16x16x64_bf16 v[44:47], v[32:35], a[80:87], v172
    v_smfmac_f32_16x16x64_bf16 v[48:51], v[32:35], a[48:55], v172
    v_smfmac_f32_16x16x64_bf16 v[52:55], v[32:35], a[112:119], v172
g_43L9_3:
    s_waitcnt vmcnt(1)
    v_max3_u32 v19, v36, v37, v38
    v_max_u32 v19, v19, v39
    v_cmp_eq_u32 vcc, -1, v19
    s_nop 0
    s_cbranch_vccnz g_43F9_3
    v_smfmac_f32_16x16x64_bf16 v[40:43], v[36:39], a[24:31], v172
    v_smfmac_f32_16x16x64_bf16 v[44:47], v[36:39], a[88:95], v172
    v_smfmac_f32_16x16x64_bf16 v[48:51], v[36:39], a[56:63], v172
    v_smfmac_f32_16x16x64_bf16 v[52:55], v[36:39], a[120:127], v172
g_43L1_0:
    s_waitcnt vmcnt(0)
    v_max3_u32 v19, v24, v25, v26
    v_max_u32 v19, v19, v27
    v_cmp_eq_u32 vcc, -1, v19
    s_nop 0
    s_cbranch_vccnz g_43F1_0
    v_smfmac_f32_16x16x64_bf16 v[40:43], v[24:27], a[0:7], v172
    v_smfmac_f32_16x16x64_bf16 v[44:47], v[24:27], a[64:71], v172
    v_smfmac_f32_16x16x64_bf16 v[48:51], v[24:27], a[32:39], v172
    v_smfmac_f32_16x16x64_bf16 v[52:55], v[24:27], a[96:103], v172
    s_branch gc_44
g_43L15_2:
    s_waitcnt vmcnt(3)
    v_max3_u32 v19, v32, v33, v34
    v_max_u32 v19, v19, v35
    v_cmp_eq_u32 vcc, -1, v19
    s_nop 0
    s_cbranch_vccnz g_43F15_2
    v_smfmac_f32_16x16x64_bf16 v[40:43], v[32:35], a[16:23], v172
    v_smfmac_f32_16x16x64_bf16 v[44:47], v[32:35], a[80:87], v172
    v_smfmac_f32_16x16x64_bf16 v[48:51], v[32:35], a[48:55], v172
    v_smfmac_f32_16x16x64_bf16 v[52:55], v[32:35], a[112:119], v172
g_43L11_3:
    s_waitcnt vmcnt(2)
    v_max3_u32 v19, v36, v37, v38
    v_max_u32 v19, v19, v39
    v_cmp_eq_u32 vcc, -1, v19
    s_nop 0
    s_cbranch_vccnz g_43F11_3
    v_smfmac_f32_16x16x64_bf16 v[40:43], v[36:39], a[24:31], v172
    v_smfmac_f32_16x16x64_bf16 v[44:47], v[36:39], a[88:95], v172
    v_smfmac_f32_16x16x64_bf16 v[48:51], v[36:39], a[56:63], v172
    v_smfmac_f32_16x16x64_bf16 v[52:55], v[36:39], a[120:127], v172
g_43L3_0:
    s_waitcnt vmcnt(1)
    v_max3_u32 v19, v24, v25, v26
    v_max_u32 v19, v19, v27
    v_cmp_eq_u32 vcc, -1, v19
    s_nop 0
    s_cbranch_vccnz g_43F3_0
    v_smfmac_f32_16x16x64_bf16 v[40:43], v[24:27], a[0:7], v172
    v_smfmac_f32_16x16x64_bf16 v[44:47], v[24:27], a[64:71], v172
    v_smfmac_f32_16x16x64_bf16 v[48:51], v[24:27], a[32:39], v172
    v_smfmac_f32_16x16x64_bf16 v[52:55], v[24:27], a[96:103], v172
g_43L2_1:
    s_waitcnt vmcnt(0)
    v_max3_u32 v19, v28, v29, v30
    v_max_u32 v19, v19, v31
    v_cmp_eq_u32 vcc, -1, v19
    s_nop 0
    s_cbranch_vccnz g_43F2_1
    v_smfmac_f32_16x16x64_bf16 v[40:43], v[28:31], a[8:15], v172
    v_smfmac_f32_16x16x64_bf16 v[44:47], v[28:31], a[72:79], v172
    v_smfmac_f32_16x16x64_bf16 v[48:51], v[28:31], a[40:47], v172
    v_smfmac_f32_16x16x64_bf16 v[52:55], v[28:31], a[104:111], v172
    s_branch gc_44
g_43L15_3:
    s_waitcnt vmcnt(3)
    v_max3_u32 v19, v36, v37, v38
    v_max_u32 v19, v19, v39
    v_cmp_eq_u32 vcc, -1, v19
    s_nop 0
    s_cbranch_vccnz g_43F15_3
    v_smfmac_f32_16x16x64_bf16 v[40:43], v[36:39], a[24:31], v172
    v_smfmac_f32_16x16x64_bf16 v[44:47], v[36:39], a[88:95], v172
    v_smfmac_f32_16x16x64_bf16 v[48:51], v[36:39], a[56:63], v172
    v_smfmac_f32_16x16x64_bf16 v[52:55], v[36:39], a[120:127], v172
g_43L7_0:
    s_waitcnt vmcnt(2)
    v_max3_u32 v19, v24, v25, v26
    v_max_u32 v19, v19, v27
    v_cmp_eq_u32 vcc, -1, v19
    s_nop 0
    s_cbranch_vccnz g_43F7_0
    v_smfmac_f32_16x16x64_bf16 v[40:43], v[24:27], a[0:7], v172
    v_smfmac_f32_16x16x64_bf16 v[44:47], v[24:27], a[64:71], v172
    v_smfmac_f32_16x16x64_bf16 v[48:51], v[24:27], a[32:39], v172
    v_smfmac_f32_16x16x64_bf16 v[52:55], v[24:27], a[96:103], v172
g_43L6_1:
    s_waitcnt vmcnt(1)
    v_max3_u32 v19, v28, v29, v30
    v_max_u32 v19, v19, v31
    v_cmp_eq_u32 vcc, -1, v19
    s_nop 0
    s_cbranch_vccnz g_43F6_1
    v_smfmac_f32_16x16x64_bf16 v[40:43], v[28:31], a[8:15], v172
    v_smfmac_f32_16x16x64_bf16 v[44:47], v[28:31], a[72:79], v172
    v_smfmac_f32_16x16x64_bf16 v[48:51], v[28:31], a[40:47], v172
    v_smfmac_f32_16x16x64_bf16 v[52:55], v[28:31], a[104:111], v172
g_43L4_2:
    s_waitcnt vmcnt(0)
    v_max3_u32 v19, v32, v33, v34
    v_max_u32 v19, v19, v35
    v_cmp_eq_u32 vcc, -1, v19
    s_nop 0
    s_cbranch_vccnz g_43F4_2
    v_smfmac_f32_16x16x64_bf16 v[40:43], v[32:35], a[16:23], v172
    v_smfmac_f32_16x16x64_bf16 v[44:47], v[32:35], a[80:87], v172
    v_smfmac_f32_16x16x64_bf16 v[48:51], v[32:35], a[48:55], v172
    v_smfmac_f32_16x16x64_bf16 v[52:55], v[32:35], a[112:119], v172
    s_branch gc_44
g_43L7_1:
    s_waitcnt vmcnt(2)
    v_max3_u32 v19, v28, v29, v30
    v_max_u32 v19, v19, v31
    v_cmp_eq_u32 vcc, -1, v19
    s_nop 0
    s_cbranch_vccnz g_43F7_1
    v_smfmac_f32_16x16x64_bf16 v[40:43], v[28:31], a[8:15], v172
    v_smfmac_f32_16x16x64_bf16 v[44:47], v[28:31], a[72:79], v172
    v_smfmac_f32_16x16x64_bf16 v[48:51], v[28:31], a[40:47], v172
    v_smfmac_f32_16x16x64_bf16 v[52:55], v[28:31], a[104:111], v172
g_43L5_2:
    s_waitcnt vmcnt(1)
    v_max3_u32 v19, v32, v33, v34
    v_max_u32 v19, v19, v35
    v_cmp_eq_u32 vcc, -1, v19
    s_nop 0
    s_cbranch_vccnz g_43F5_2
    v_smfmac_f32_16x16x64_bf16 v[40:43], v[32:35], a[16:23], v172
    v_smfmac_f32_16x16x64_bf16 v[44:47], v[32:35], a[80:87], v172
    v_smfmac_f32_16x16x64_bf16 v[48:51], v[32:35], a[48:55], v172
    v_smfmac_f32_16x16x64_bf16 v[52:55], v[32:35], a[112:119], v172
    s_branch g_43L1_0
g_43L7_2:
    s_waitcnt vmcnt(2)
    v_max3_u32 v19, v32, v33, v34
    v_max_u32 v19, v19, v35
    v_cmp_eq_u32 vcc, -1, v19
    s_nop 0
    s_cbranch_vccnz g_43F7_2
    v_smfmac_f32_16x16x64_bf16 v[40:43], v[32:35], a[16:23], v172
    v_smfmac_f32_16x16x64_bf16 v[44:47], v[32:35], a[80:87], v172
    v_smfmac_f32_16x16x64_bf16 v[48:51], v[32:35], a[48:55], v172
    v_smfmac_f32_16x16x64_bf16 v[52:55], v[32:35], a[112:119], v172
    s_branch g_43L3_0
g_43L11_0:
    s_waitcnt vmcnt(2)
    v_max3_u32 v19, v24, v25, v26
    v_max_u32 v19, v19, v27
    v_cmp_eq_u32 vcc, -1, v19
    s_nop 0
    s_cbranch_vccnz g_43F11_0
    v_smfmac_f32_16x16x64_bf16 v[40:43], v[24:27], a[0:7], v172
    v_smfmac_f32_16x16x64_bf16 v[44:47], v[24:27], a[64:71], v172
    v_smfmac_f32_16x16x64_bf16 v[48:51], v[24:27], a[32:39], v172
    v_smfmac_f32_16x16x64_bf16 v[52:55], v[24:27], a[96:103], v172
g_43L10_1:
    s_waitcnt vmcnt(1)
    v_max3_u32 v19, v28, v29, v30
    v_max_u32 v19, v19, v31
    v_cmp_eq_u32 vcc, -1, v19
    s_nop 0
    s_cbranch_vccnz g_43F10_1
    v_smfmac_f32_16x16x64_bf16 v[40:43], v[28:31], a[8:15], v172
    v_smfmac_f32_16x16x64_bf16 v[44:47], v[28:31], a[72:79], v172
    v_smfmac_f32_16x16x64_bf16 v[48:51], v[28:31], a[40:47], v172
    v_smfmac_f32_16x16x64_bf16 v[52:55], v[28:31], a[104:111], v172
    s_branch g_43L8_3
g_43L11_1:
    s_waitcnt vmcnt(2)
    v_max3_u32 v19, v28, v29, v30
    v_max_u32 v19, v19, v31
    v_cmp_eq_u32 vcc, -1, v19
    s_nop 0
    s_cbranch_vccnz g_43F11_1
    v_smfmac_f32_16x16x64_bf16 v[40:43], v[28:31], a[8:15], v172
    v_smfmac_f32_16x16x64_bf16 v[44:47], v[28:31], a[72:79], v172
    v_smfmac_f32_16x16x64_bf16 v[48:51], v[28:31], a[40:47], v172
    v_smfmac_f32_16x16x64_bf16 v[52:55], v[28:31], a[104:111], v172
    s_branch g_43L9_3
g_43L13_0:
    s_waitcnt vmcnt(2)
    v_max3_u32 v19, v24, v25, v26
    v_max_u32 v19, v19, v27
    v_cmp_eq_u32 vcc, -1, v19
    s_nop 0
    s_cbranch_vccnz g_43F13_0
    v_smfmac_f32_16x16x64_bf16 v[40:43], v[24:27], a[0:7], v172
    v_smfmac_f32_16x16x64_bf16 v[44:47], v[24:27], a[64:71], v172
    v_smfmac_f32_16x16x64_bf16 v[48:51], v[24:27], a[32:39], v172
    v_smfmac_f32_16x16x64_bf16 v[52:55], v[24:27], a[96:103], v172
    s_branch g_43L12_2
g_43L13_3:
    s_waitcnt vmcnt(2)
    v_max3_u32 v19, v36, v37, v38
    v_max_u32 v19, v19, v39
    v_cmp_eq_u32 vcc, -1, v19
    s_nop 0
    s_cbranch_vccnz g_43F13_3
    v_smfmac_f32_16x16x64_bf16 v[40:43], v[36:39], a[24:31], v172
    v_smfmac_f32_16x16x64_bf16 v[44:47], v[36:39], a[88:95], v172
    v_smfmac_f32_16x16x64_bf16 v[48:51], v[36:39], a[56:63], v172
    v_smfmac_f32_16x16x64_bf16 v[52:55], v[36:39], a[120:127], v172
g_43L5_0:
    s_waitcnt vmcnt(1)
    v_max3_u32 v19, v24, v25, v26
    v_max_u32 v19, v19, v27
    v_cmp_eq_u32 vcc, -1, v19
    s_nop 0
    s_cbranch_vccnz g_43F5_0
    v_smfmac_f32_16x16x64_bf16 v[40:43], v[24:27], a[0:7], v172
    v_smfmac_f32_16x16x64_bf16 v[44:47], v[24:27], a[64:71], v172
    v_smfmac_f32_16x16x64_bf16 v[48:51], v[24:27], a[32:39], v172
    v_smfmac_f32_16x16x64_bf16 v[52:55], v[24:27], a[96:103], v172
    s_branch g_43L4_2
g_43L14_2:
    s_waitcnt vmcnt(2)
    v_max3_u32 v19, v32, v33, v34
    v_max_u32 v19, v19, v35
    v_cmp_eq_u32 vcc, -1, v19
    s_nop 0
    s_cbranch_vccnz g_43F14_2
    v_smfmac_f32_16x16x64_bf16 v[40:43], v[32:35], a[16:23], v172
    v_smfmac_f32_16x16x64_bf16 v[44:47], v[32:35], a[80:87], v172
    v_smfmac_f32_16x16x64_bf16 v[48:51], v[32:35], a[48:55], v172
    v_smfmac_f32_16x16x64_bf16 v[52:55], v[32:35], a[112:119], v172
g_43L10_3:
    s_waitcnt vmcnt(1)
    v_max3_u32 v19, v36, v37, v38
    v_max_u32 v19, v19, v39
    v_cmp_eq_u32 vcc, -1, v19
    s_nop 0
    s_cbranch_vccnz g_43F10_3
    v_smfmac_f32_16x16x64_bf16 v[40:43], v[36:39], a[24:31], v172
    v_smfmac_f32_16x16x64_bf16 v[44:47], v[36:39], a[88:95], v172
    v_smfmac_f32_16x16x64_bf16 v[48:51], v[36:39], a[56:63], v172
    v_smfmac_f32_16x16x64_bf16 v[52:55], v[36:39], a[120:127], v172
    s_branch g_43L2_1
g_43L14_3:
    s_waitcnt vmcnt(2)
    v_max3_u32 v19, v36, v37, v38
    v_max_u32 v19, v19, v39
    v_cmp_eq_u32 vcc, -1, v19
    s_nop 0
    s_cbranch_vccnz g_43F14_3
    v_smfmac_f32_16x16x64_bf16 v[40:43], v[36:39], a[24:31], v172
    v_smfmac_f32_16x16x64_bf16 v[44:47], v[36:39], a[88:95], v172
    v_smfmac_f32_16x16x64_bf16 v[48:51], v[36:39], a[56:63], v172
    v_smfmac_f32_16x16x64_bf16 v[52:55], v[36:39], a[120:127], v172
    s_branch g_43L6_1
g_43L3_1:
    s_waitcnt vmcnt(1)
    v_max3_u32 v19, v28, v29, v30
    v_max_u32 v19, v19, v31
    v_cmp_eq_u32 vcc, -1, v19
    s_nop 0
    s_cbranch_vccnz g_43F3_1
    v_smfmac_f32_16x16x64_bf16 v[40:43], v[28:31], a[8:15], v172
    v_smfmac_f32_16x16x64_bf16 v[44:47], v[28:31], a[72:79], v172
    v_smfmac_f32_16x16x64_bf16 v[48:51], v[28:31], a[40:47], v172
    v_smfmac_f32_16x16x64_bf16 v[52:55], v[28:31], a[104:111], v172
    s_branch g_43L1_0
g_43L6_2:
    s_waitcnt vmcnt(1)
    v_max3_u32 v19, v32, v33, v34
    v_max_u32 v19, v19, v35
    v_cmp_eq_u32 vcc, -1, v19
    s_nop 0
    s_cbranch_vccnz g_43F6_2
    v_smfmac_f32_16x16x64_bf16 v[40:43], v[32:35], a[16:23], v172
    v_smfmac_f32_16x16x64_bf16 v[44:47], v[32:35], a[80:87], v172
    v_smfmac_f32_16x16x64_bf16 v[48:51], v[32:35], a[48:55], v172
    v_smfmac_f32_16x16x64_bf16 v[52:55], v[32:35], a[112:119], v172
    s_branch g_43L2_1
g_43L9_0:
    s_waitcnt vmcnt(1)
    v_max3_u32 v19, v24, v25, v26
    v_max_u32 v19, v19, v27
    v_cmp_eq_u32 vcc, -1, v19
    s_nop 0
    s_cbranch_vccnz g_43F9_0
    v_smfmac_f32_16x16x64_bf16 v[40:43], v[24:27], a[0:7], v172
    v_smfmac_f32_16x16x64_bf16 v[44:47], v[24:27], a[64:71], v172
    v_smfmac_f32_16x16x64_bf16 v[48:51], v[24:27], a[32:39], v172
    v_smfmac_f32_16x16x64_bf16 v[52:55], v[24:27], a[96:103], v172
    s_branch g_43L8_3
g_43L12_3:
    s_waitcnt vmcnt(1)
    v_max3_u32 v19, v36, v37, v38
    v_max_u32 v19, v19, v39
    v_cmp_eq_u32 vcc, -1, v19
    s_nop 0
    s_cbranch_vccnz g_43F12_3
    v_smfmac_f32_16x16x64_bf16 v[40:43], v[36:39], a[24:31], v172
    v_smfmac_f32_16x16x64_bf16 v[44:47], v[36:39], a[88:95], v172
    v_smfmac_f32_16x16x64_bf16 v[48:51], v[36:39], a[56:63], v172
    v_smfmac_f32_16x16x64_bf16 v[52:55], v[36:39], a[120:127], v172
    s_branch g_43L4_2
g_43F15_0:
    s_mov_b64 exec, vcc
    buffer_load_dwordx4 v[24:27], v2, s[4:7], s16 offen offset:0 sc1
    s_mov_b64 exec, -1
    s_add_u32 s23, s23, 1
    s_cmp_lt_u32 s23, 200000
    s_cbranch_scc1 g_43L15_1
    s_mov_b32 s25, 200000
    s_branch gc_44
g_43F15_1:
    s_mov_b64 exec, vcc
    buffer_load_dwordx4 v[28:31], v2, s[4:7], s16 offen offset:1024 sc1
    s_mov_b64 exec, -1
    s_add_u32 s23, s23, 1
    s_cmp_lt_u32 s23, 200000
    s_cbranch_scc1 g_43L15_2
    s_mov_b32 s25, 200000
    s_branch gc_44
g_43F15_2:
    s_mov_b64 exec, vcc
    buffer_load_dwordx4 v[32:35], v2, s[4:7], s16 offen offset:2048 sc1
    s_mov_b64 exec, -1
    s_add_u32 s23, s23, 1
    s_cmp_lt_u32 s23, 200000
    s_cbranch_scc1 g_43L15_3
    s_mov_b32 s25, 200000
    s_branch gc_44
g_43F15_3:
    s_mov_b64 exec, vcc
    buffer_load_dwordx4 v[36:39], v2, s[4:7], s16 offen offset:3072 sc1
    s_mov_b64 exec, -1
    s_add_u32 s23, s23, 1
    s_cmp_lt_u32 s23, 200000
    s_cbranch_scc1 g_43L15_0
    s_mov_b32 s25, 200000
    s_branch gc_44
g_43F7_0:
    s_mov_b64 exec, vcc
    buffer_load_dwordx4 v[24:27], v2, s[4:7], s16 offen offset:0 sc1
    s_mov_b64 exec, -1
    s_add_u32 s23, s23, 1
    s_cmp_lt_u32 s23, 200000
    s_cbranch_scc1 g_43L7_1
    s_mov_b32 s25, 200000
    s_branch gc_44
g_43F7_1:
    s_mov_b64 exec, vcc
    buffer_load_dwordx4 v[28:31], v2, s[4:7], s16 offen offset:1024 sc1
    s_mov_b64 exec, -1
    s_add_u32 s23, s23, 1
    s_cmp_lt_u32 s23, 200000
    s_cbranch_scc1 g_43L7_2
    s_mov_b32 s25, 200000
    s_branch gc_44
g_43F7_2:
    s_mov_b64 exec, vcc
    buffer_load_dwordx4 v[32:35], v2, s[4:7], s16 offen offset:2048 sc1
    s_mov_b64 exec, -1
    s_add_u32 s23, s23, 1
    s_cmp_lt_u32 s23, 200000
    s_cbranch_scc1 g_43L7_0
    s_mov_b32 s25, 200000
    s_branch gc_44
g_43F11_0:
    s_mov_b64 exec, vcc
    buffer_load_dwordx4 v[24:27], v2, s[4:7], s16 offen offset:0 sc1
    s_mov_b64 exec, -1
    s_add_u32 s23, s23, 1
    s_cmp_lt_u32 s23, 200000
    s_cbranch_scc1 g_43L11_1
    s_mov_b32 s25, 200000
    s_branch gc_44
g_43F11_1:
    s_mov_b64 exec, vcc
    buffer_load_dwordx4 v[28:31], v2, s[4:7], s16 offen offset:1024 sc1
    s_mov_b64 exec, -1
    s_add_u32 s23, s23, 1
    s_cmp_lt_u32 s23, 200000
    s_cbranch_scc1 g_43L11_3
    s_mov_b32 s25, 200000
    s_branch gc_44
g_43F11_3:
    s_mov_b64 exec, vcc
    buffer_load_dwordx4 v[36:39], v2, s[4:7], s16 offen offset:3072 sc1
    s_mov_b64 exec, -1
    s_add_u32 s23, s23, 1
    s_cmp_lt_u32 s23, 200000
    s_cbranch_scc1 g_43L11_0
    s_mov_b32 s25, 200000
    s_branch gc_44
g_43F13_0:
    s_mov_b64 exec, vcc
    buffer_load_dwordx4 v[24:27], v2, s[4:7], s16 offen offset:0 sc1
    s_mov_b64 exec, -1
    s_add_u32 s23, s23, 1
    s_cmp_lt_u32 s23, 200000
    s_cbranch_scc1 g_43L13_2
    s_mov_b32 s25, 200000
    s_branch gc_44
g_43F13_2:
    s_mov_b64 exec, vcc
    buffer_load_dwordx4 v[32:35], v2, s[4:7], s16 offen offset:2048 sc1
    s_mov_b64 exec, -1
    s_add_u32 s23, s23, 1
    s_cmp_lt_u32 s23, 200000
    s_cbranch_scc1 g_43L13_3
    s_mov_b32 s25, 200000
    s_branch gc_44
g_43F13_3:
    s_mov_b64 exec, vcc
    buffer_load_dwordx4 v[36:39], v2, s[4:7], s16 offen offset:3072 sc1
    s_mov_b64 exec, -1
    s_add_u32 s23, s23, 1
    s_cmp_lt_u32 s23, 200000
    s_cbranch_scc1 g_43L13_0
    s_mov_b32 s25, 200000
    s_branch gc_44
g_43F14_1:
    s_mov_b64 exec, vcc
    buffer_load_dwordx4 v[28:31], v2, s[4:7], s16 offen offset:1024 sc1
    s_mov_b64 exec, -1
    s_add_u32 s23, s23, 1
    s_cmp_lt_u32 s23, 200000
    s_cbranch_scc1 g_43L14_2
    s_mov_b32 s25, 200000
    s_branch gc_44
g_43F14_2:
    s_mov_b64 exec, vcc
    buffer_load_dwordx4 v[32:35], v2, s[4:7], s16 offen offset:2048 sc1
    s_mov_b64 exec, -1
    s_add_u32 s23, s23, 1
    s_cmp_lt_u32 s23, 200000
    s_cbranch_scc1 g_43L14_3
    s_mov_b32 s25, 200000
    s_branch gc_44
g_43F14_3:
    s_mov_b64 exec, vcc
    buffer_load_dwordx4 v[36:39], v2, s[4:7], s16 offen offset:3072 sc1
    s_mov_b64 exec, -1
    s_add_u32 s23, s23, 1
    s_cmp_lt_u32 s23, 200000
    s_cbranch_scc1 g_43L14_1
    s_mov_b32 s25, 200000
    s_branch gc_44
g_43F3_0:
    s_mov_b64 exec, vcc
    buffer_load_dwordx4 v[24:27], v2, s[4:7], s16 offen offset:0 sc1
    s_mov_b64 exec, -1
    s_add_u32 s23, s23, 1
    s_cmp_lt_u32 s23, 200000
    s_cbranch_scc1 g_43L3_1
    s_mov_b32 s25, 200000
    s_branch gc_44
g_43F3_1:
    s_mov_b64 exec, vcc
    buffer_load_dwordx4 v[28:31], v2, s[4:7], s16 offen offset:1024 sc1
    s_mov_b64 exec, -1
    s_add_u32 s23, s23, 1
    s_cmp_lt_u32 s23, 200000
    s_cbranch_scc1 g_43L3_0
    s_mov_b32 s25, 200000
    s_branch gc_44
g_43F5_0:
    s_mov_b64 exec, vcc
    buffer_load_dwordx4 v[24:27], v2, s[4:7], s16 offen offset:0 sc1
    s_mov_b64 exec, -1
    s_add_u32 s23, s23, 1
    s_cmp_lt_u32 s23, 200000
    s_cbranch_scc1 g_43L5_2
    s_mov_b32 s25, 200000
    s_branch gc_44
g_43F5_2:
    s_mov_b64 exec, vcc
    buffer_load_dwordx4 v[32:35], v2, s[4:7], s16 offen offset:2048 sc1
    s_mov_b64 exec, -1
    s_add_u32 s23, s23, 1
    s_cmp_lt_u32 s23, 200000
    s_cbranch_scc1 g_43L5_0
    s_mov_b32 s25, 200000
    s_branch gc_44
g_43F6_1:
    s_mov_b64 exec, vcc
    buffer_load_dwordx4 v[28:31], v2, s[4:7], s16 offen offset:1024 sc1
    s_mov_b64 exec, -1
    s_add_u32 s23, s23, 1
    s_cmp_lt_u32 s23, 200000
    s_cbranch_scc1 g_43L6_2
    s_mov_b32 s25, 200000
    s_branch gc_44
g_43F6_2:
    s_mov_b64 exec, vcc
    buffer_load_dwordx4 v[32:35], v2, s[4:7], s16 offen offset:2048 sc1
    s_mov_b64 exec, -1
    s_add_u32 s23, s23, 1
    s_cmp_lt_u32 s23, 200000
    s_cbranch_scc1 g_43L6_1
    s_mov_b32 s25, 200000
    s_branch gc_44
g_43F9_0:
    s_mov_b64 exec, vcc
    buffer_load_dwordx4 v[24:27], v2, s[4:7], s16 offen offset:0 sc1
    s_mov_b64 exec, -1
    s_add_u32 s23, s23, 1
    s_cmp_lt_u32 s23, 200000
    s_cbranch_scc1 g_43L9_3
    s_mov_b32 s25, 200000
    s_branch gc_44
g_43F9_3:
    s_mov_b64 exec, vcc
    buffer_load_dwordx4 v[36:39], v2, s[4:7], s16 offen offset:3072 sc1
    s_mov_b64 exec, -1
    s_add_u32 s23, s23, 1
    s_cmp_lt_u32 s23, 200000
    s_cbranch_scc1 g_43L9_0
    s_mov_b32 s25, 200000
    s_branch gc_44
g_43F10_1:
    s_mov_b64 exec, vcc
    buffer_load_dwordx4 v[28:31], v2, s[4:7], s16 offen offset:1024 sc1
    s_mov_b64 exec, -1
    s_add_u32 s23, s23, 1
    s_cmp_lt_u32 s23, 200000
    s_cbranch_scc1 g_43L10_3
    s_mov_b32 s25, 200000
    s_branch gc_44
g_43F10_3:
    s_mov_b64 exec, vcc
    buffer_load_dwordx4 v[36:39], v2, s[4:7], s16 offen offset:3072 sc1
    s_mov_b64 exec, -1
    s_add_u32 s23, s23, 1
    s_cmp_lt_u32 s23, 200000
    s_cbranch_scc1 g_43L10_1
    s_mov_b32 s25, 200000
    s_branch gc_44
g_43F12_2:
    s_mov_b64 exec, vcc
    buffer_load_dwordx4 v[32:35], v2, s[4:7], s16 offen offset:2048 sc1
    s_mov_b64 exec, -1
    s_add_u32 s23, s23, 1
    s_cmp_lt_u32 s23, 200000
    s_cbranch_scc1 g_43L12_3
    s_mov_b32 s25, 200000
    s_branch gc_44
g_43F12_3:
    s_mov_b64 exec, vcc
    buffer_load_dwordx4 v[36:39], v2, s[4:7], s16 offen offset:3072 sc1
    s_mov_b64 exec, -1
    s_add_u32 s23, s23, 1
    s_cmp_lt_u32 s23, 200000
    s_cbranch_scc1 g_43L12_2
    s_mov_b32 s25, 200000
    s_branch gc_44
g_43F1_0:
    s_mov_b64 exec, vcc
    buffer_load_dwordx4 v[24:27], v2, s[4:7], s16 offen offset:0 sc1
    s_mov_b64 exec, -1
    s_add_u32 s23, s23, 1
    s_cmp_lt_u32 s23, 200000
    s_cbranch_scc1 g_43L1_0
    s_mov_b32 s25, 200000
    s_branch gc_44
g_43F2_1:
    s_mov_b64 exec, vcc
    buffer_load_dwordx4 v[28:31], v2, s[4:7], s16 offen offset:1024 sc1
    s_mov_b64 exec, -1
    s_add_u32 s23, s23, 1
    s_cmp_lt_u32 s23, 200000
    s_cbranch_scc1 g_43L2_1
    s_mov_b32 s25, 200000
    s_branch gc_44
g_43F4_2:
    s_mov_b64 exec, vcc
    buffer_load_dwordx4 v[32:35], v2, s[4:7], s16 offen offset:2048 sc1
    s_mov_b64 exec, -1
    s_add_u32 s23, s23, 1
    s_cmp_lt_u32 s23, 200000
    s_cbranch_scc1 g_43L4_2
    s_mov_b32 s25, 200000
    s_branch gc_44
g_43F8_3:
    s_mov_b64 exec, vcc
    buffer_load_dwordx4 v[36:39], v2, s[4:7], s16 offen offset:3072 sc1
    s_mov_b64 exec, -1
    s_add_u32 s23, s23, 1
    s_cmp_lt_u32 s23, 200000
    s_cbranch_scc1 g_43L8_3
    s_mov_b32 s25, 200000
    s_branch gc_44
recur_fast_last2:
    buffer_store_dwordx4 v[168:171], v15, s[4:7], s20 offen sc1
    s_waitcnt vmcnt(0)
    s_branch recur_end
g_45L15_0:
    s_waitcnt vmcnt(3)
    v_max3_u32 v19, v24, v25, v26
    v_max_u32 v19, v19, v27
    v_cmp_eq_u32 vcc, -1, v19
    s_nop 0
    s_cbranch_vccnz g_45F15_0
    v_smfmac_f32_16x16x64_bf16 v[64:67], v[24:27], a[192:199], v172
    v_smfmac_f32_16x16x64_bf16 v[68:71], v[24:27], a[224:231], v172
g_45L14_1:
    s_waitcnt vmcnt(2)
    v_max3_u32 v19, v28, v29, v30
    v_max_u32 v19, v19, v31
    v_cmp_eq_u32 vcc, -1, v19
    s_nop 0
    s_cbranch_vccnz g_45F14_1
    v_smfmac_f32_16x16x64_bf16 v[64:67], v[28:31], a[200:207], v172
    v_smfmac_f32_16x16x64_bf16 v[68:71], v[28:31], a[232:239], v172
g_45L12_2:
    s_waitcnt vmcnt(1)
    v_max3_u32 v19, v32, v33, v34
    v_max_u32 v19, v19, v35
    v_cmp_eq_u32 vcc, -1, v19
    s_nop 0
    s_cbranch_vccnz g_45F12_2
    v_smfmac_f32_16x16x64_bf16 v[64:67], v[32:35], a[208:215], v172
    v_smfmac_f32_16x16x64_bf16 v[68:71], v[32:35], a[240:247], v172
g_45L8_3:
    s_waitcnt vmcnt(0)
    v_max3_u32 v19, v36, v37, v38
    v_max_u32 v19, v19, v39
    v_cmp_eq_u32 vcc, -1, v19
    s_nop 0
    s_cbranch_vccnz g_45F8_3
    v_smfmac_f32_16x16x64_bf16 v[64:67], v[36:39], a[216:223], v172
    v_smfmac_f32_16x16x64_bf16 v[68:71], v[36:39], a[248:255], v172
    s_nop 4
    v_cvt_pk_bf16_f32 v80, v64, v65
    v_cvt_pk_bf16_f32 v81, v66, v67
    s_nop 0
    v_cvt_pk_bf16_f32 v82, v68, v69
    v_cvt_pk_bf16_f32 v83, v70, v71
    ds_write_b128 v17, v[80:83] offset:9216
    s_branch gc_46
g_45L15_1:
    s_waitcnt vmcnt(3)
    v_max3_u32 v19, v28, v29, v30
    v_max_u32 v19, v19, v31
    v_cmp_eq_u32 vcc, -1, v19
    s_nop 0
    s_cbranch_vccnz g_45F15_1
    v_smfmac_f32_16x16x64_bf16 v[64:67], v[28:31], a[200:207], v172
    v_smfmac_f32_16x16x64_bf16 v[68:71], v[28:31], a[232:239], v172
g_45L13_2:
    s_waitcnt vmcnt(2)
    v_max3_u32 v19, v32, v33, v34
    v_max_u32 v19, v19, v35
    v_cmp_eq_u32 vcc, -1, v19
    s_nop 0
    s_cbranch_vccnz g_45F13_2
    v_smfmac_f32_16x16x64_bf16 v[64:67], v[32:35], a[208:215], v172
    v_smfmac_f32_16x16x64_bf16 v[68:71], v[32:35], a[240:247], v172
g_45L9_3:
    s_waitcnt vmcnt(1)
    v_max3_u32 v19, v36, v37, v38
    v_max_u32 v19, v19, v39
    v_cmp_eq_u32 vcc, -1, v19
    s_nop 0
    s_cbranch_vccnz g_45F9_3
    v_smfmac_f32_16x16x64_bf16 v[64:67], v[36:39], a[216:223], v172
    v_smfmac_f32_16x16x64_bf16 v[68:71], v[36:39], a[248:255], v172
g_45L1_0:
    s_waitcnt vmcnt(0)
    v_max3_u32 v19, v24, v25, v26
    v_max_u32 v19, v19, v27
    v_cmp_eq_u32 vcc, -1, v19
    s_nop 0
    s_cbranch_vccnz g_45F1_0
    v_smfmac_f32_16x16x64_bf16 v[64:67], v[24:27], a[192:199], v172
    v_smfmac_f32_16x16x64_bf16 v[68:71], v[24:27], a[224:231], v172
    s_nop 4
    v_cvt_pk_bf16_f32 v80, v64, v65
    v_cvt_pk_bf16_f32 v81, v66, v67
    s_nop 0
    v_cvt_pk_bf16_f32 v82, v68, v69
    v_cvt_pk_bf16_f32 v83, v70, v71
    ds_write_b128 v17, v[80:83] offset:9216
    s_branch gc_46
g_45L15_2:
    s_waitcnt vmcnt(3)
    v_max3_u32 v19, v32, v33, v34
    v_max_u32 v19, v19, v35
    v_cmp_eq_u32 vcc, -1, v19
    s_nop 0
    s_cbranch_vccnz g_45F15_2
    v_smfmac_f32_16x16x64_bf16 v[64:67], v[32:35], a[208:215], v172
    v_smfmac_f32_16x16x64_bf16 v[68:71], v[32:35], a[240:247], v172
g_45L11_3:
    s_waitcnt vmcnt(2)
    v_max3_u32 v19, v36, v37, v38
    v_max_u32 v19, v19, v39
    v_cmp_eq_u32 vcc, -1, v19
    s_nop 0
    s_cbranch_vccnz g_45F11_3
    v_smfmac_f32_16x16x64_bf16 v[64:67], v[36:39], a[216:223], v172
    v_smfmac_f32_16x16x64_bf16 v[68:71], v[36:39], a[248:255], v172
g_45L3_0:
    s_waitcnt vmcnt(1)
    v_max3_u32 v19, v24, v25, v26
    v_max_u32 v19, v19, v27
    v_cmp_eq_u32 vcc, -1, v19
    s_nop 0
    s_cbranch_vccnz g_45F3_0
    v_smfmac_f32_16x16x64_bf16 v[64:67], v[24:27], a[192:199], v172
    v_smfmac_f32_16x16x64_bf16 v[68:71], v[24:27], a[224:231], v172
g_45L2_1:
    s_waitcnt vmcnt(0)
    v_max3_u32 v19, v28, v29, v30
    v_max_u32 v19, v19, v31
    v_cmp_eq_u32 vcc, -1, v19
    s_nop 0
    s_cbranch_vccnz g_45F2_1
    v_smfmac_f32_16x16x64_bf16 v[64:67], v[28:31], a[200:207], v172
    v_smfmac_f32_16x16x64_bf16 v[68:71], v[28:31], a[232:239], v172
    s_nop 4
    v_cvt_pk_bf16_f32 v80, v64, v65
    v_cvt_pk_bf16_f32 v81, v66, v67
    s_nop 0
    v_cvt_pk_bf16_f32 v82, v68, v69
    v_cvt_pk_bf16_f32 v83, v70, v71
    ds_write_b128 v17, v[80:83] offset:9216
    s_branch gc_46
g_45L15_3:
    s_waitcnt vmcnt(3)
    v_max3_u32 v19, v36, v37, v38
    v_max_u32 v19, v19, v39
    v_cmp_eq_u32 vcc, -1, v19
    s_nop 0
    s_cbranch_vccnz g_45F15_3
    v_smfmac_f32_16x16x64_bf16 v[64:67], v[36:39], a[216:223], v172
    v_smfmac_f32_16x16x64_bf16 v[68:71], v[36:39], a[248:255], v172
g_45L7_0:
    s_waitcnt vmcnt(2)
    v_max3_u32 v19, v24, v25, v26
    v_max_u32 v19, v19, v27
    v_cmp_eq_u32 vcc, -1, v19
    s_nop 0
    s_cbranch_vccnz g_45F7_0
    v_smfmac_f32_16x16x64_bf16 v[64:67], v[24:27], a[192:199], v172
    v_smfmac_f32_16x16x64_bf16 v[68:71], v[24:27], a[224:231], v172
g_45L6_1:
    s_waitcnt vmcnt(1)
    v_max3_u32 v19, v28, v29, v30
    v_max_u32 v19, v19, v31
    v_cmp_eq_u32 vcc, -1, v19
    s_nop 0
    s_cbranch_vccnz g_45F6_1
    v_smfmac_f32_16x16x64_bf16 v[64:67], v[28:31], a[200:207], v172
    v_smfmac_f32_16x16x64_bf16 v[68:71], v[28:31], a[232:239], v172
g_45L4_2:
    s_waitcnt vmcnt(0)
    v_max3_u32 v19, v32, v33, v34
    v_max_u32 v19, v19, v35
    v_cmp_eq_u32 vcc, -1, v19
    s_nop 0
    s_cbranch_vccnz g_45F4_2
    v_smfmac_f32_16x16x64_bf16 v[64:67], v[32:35], a[208:215], v172
    v_smfmac_f32_16x16x64_bf16 v[68:71], v[32:35], a[240:247], v172
    s_nop 4
    v_cvt_pk_bf16_f32 v80, v64, v65
    v_cvt_pk_bf16_f32 v81, v66, v67
    s_nop 0
    v_cvt_pk_bf16_f32 v82, v68, v69
    v_cvt_pk_bf16_f32 v83, v70, v71
    ds_write_b128 v17, v[80:83] offset:9216
    s_branch gc_46
g_45L7_1:
    s_waitcnt vmcnt(2)
    v_max3_u32 v19, v28, v29, v30
    v_max_u32 v19, v19, v31
    v_cmp_eq_u32 vcc, -1, v19
    s_nop 0
    s_cbranch_vccnz g_45F7_1
    v_smfmac_f32_16x16x64_bf16 v[64:67], v[28:31], a[200:207], v172
    v_smfmac_f32_16x16x64_bf16 v[68:71], v[28:31], a[232:239], v172
g_45L5_2:
    s_waitcnt vmcnt(1)
    v_max3_u32 v19, v32, v33, v34
    v_max_u32 v19, v19, v35
    v_cmp_eq_u32 vcc, -1, v19
    s_nop 0
    s_cbranch_vccnz g_45F5_2
    v_smfmac_f32_16x16x64_bf16 v[64:67], v[32:35], a[208:215], v172
    v_smfmac_f32_16x16x64_bf16 v[68:71], v[32:35], a[240:247], v172
    s_branch g_45L1_0
g_45L7_2:
    s_waitcnt vmcnt(2)
    v_max3_u32 v19, v32, v33, v34
    v_max_u32 v19, v19, v35
    v_cmp_eq_u32 vcc, -1, v19
    s_nop 0
    s_cbranch_vccnz g_45F7_2
    v_smfmac_f32_16x16x64_bf16 v[64:67], v[32:35], a[208:215], v172
    v_smfmac_f32_16x16x64_bf16 v[68:71], v[32:35], a[240:247], v172
    s_branch g_45L3_0
g_45L11_0:
    s_waitcnt vmcnt(2)
    v_max3_u32 v19, v24, v25, v26
    v_max_u32 v19, v19, v27
    v_cmp_eq_u32 vcc, -1, v19
    s_nop 0
    s_cbranch_vccnz g_45F11_0
    v_smfmac_f32_16x16x64_bf16 v[64:67], v[24:27], a[192:199], v172
    v_smfmac_f32_16x16x64_bf16 v[68:71], v[24:27], a[224:231], v172
g_45L10_1:
    s_waitcnt vmcnt(1)
    v_max3_u32 v19, v28, v29, v30
    v_max_u32 v19, v19, v31
    v_cmp_eq_u32 vcc, -1, v19
    s_nop 0
    s_cbranch_vccnz g_45F10_1
    v_smfmac_f32_16x16x64_bf16 v[64:67], v[28:31], a[200:207], v172
    v_smfmac_f32_16x16x64_bf16 v[68:71], v[28:31], a[232:239], v172
    s_branch g_45L8_3
g_45L11_1:
    s_waitcnt vmcnt(2)
    v_max3_u32 v19, v28, v29, v30
    v_max_u32 v19, v19, v31
    v_cmp_eq_u32 vcc, -1, v19
    s_nop 0
    s_cbranch_vccnz g_45F11_1
    v_smfmac_f32_16x16x64_bf16 v[64:67], v[28:31], a[200:207], v172
    v_smfmac_f32_16x16x64_bf16 v[68:71], v[28:31], a[232:239], v172
    s_branch g_45L9_3
g_45L13_0:
    s_waitcnt vmcnt(2)
    v_max3_u32 v19, v24, v25, v26
    v_max_u32 v19, v19, v27
    v_cmp_eq_u32 vcc, -1, v19
    s_nop 0
    s_cbranch_vccnz g_45F13_0
    v_smfmac_f32_16x16x64_bf16 v[64:67], v[24:27], a[192:199], v172
    v_smfmac_f32_16x16x64_bf16 v[68:71], v[24:27], a[224:231], v172
    s_branch g_45L12_2
g_45L13_3:
    s_waitcnt vmcnt(2)
    v_max3_u32 v19, v36, v37, v38
    v_max_u32 v19, v19, v39
    v_cmp_eq_u32 vcc, -1, v19
    s_nop 0
    s_cbranch_vccnz g_45F13_3
    v_smfmac_f32_16x16x64_bf16 v[64:67], v[36:39], a[216:223], v172
    v_smfmac_f32_16x16x64_bf16 v[68:71], v[36:39], a[248:255], v172
g_45L5_0:
    s_waitcnt vmcnt(1)
    v_max3_u32 v19, v24, v25, v26
    v_max_u32 v19, v19, v27
    v_cmp_eq_u32 vcc, -1, v19
    s_nop 0
    s_cbranch_vccnz g_45F5_0
    v_smfmac_f32_16x16x64_bf16 v[64:67], v[24:27], a[192:199], v172
    v_smfmac_f32_16x16x64_bf16 v[68:71], v[24:27], a[224:231], v172
    s_branch g_45L4_2
g_45L14_2:
    s_waitcnt vmcnt(2)
    v_max3_u32 v19, v32, v33, v34
    v_max_u32 v19, v19, v35
    v_cmp_eq_u32 vcc, -1, v19
    s_nop 0
    s_cbranch_vccnz g_45F14_2
    v_smfmac_f32_16x16x64_bf16 v[64:67], v[32:35], a[208:215], v172
    v_smfmac_f32_16x16x64_bf16 v[68:71], v[32:35], a[240:247], v172
g_45L10_3:
    s_waitcnt vmcnt(1)
    v_max3_u32 v19, v36, v37, v38
    v_max_u32 v19, v19, v39
    v_cmp_eq_u32 vcc, -1, v19
    s_nop 0
    s_cbranch_vccnz g_45F10_3
    v_smfmac_f32_16x16x64_bf16 v[64:67], v[36:39], a[216:223], v172
    v_smfmac_f32_16x16x64_bf16 v[68:71], v[36:39], a[248:255], v172
    s_branch g_45L2_1
g_45L14_3:
    s_waitcnt vmcnt(2)
    v_max3_u32 v19, v36, v37, v38
    v_max_u32 v19, v19, v39
    v_cmp_eq_u32 vcc, -1, v19
    s_nop 0
    s_cbranch_vccnz g_45F14_3
    v_smfmac_f32_16x16x64_bf16 v[64:67], v[36:39], a[216:223], v172
    v_smfmac_f32_16x16x64_bf16 v[68:71], v[36:39], a[248:255], v172
    s_branch g_45L6_1
g_45L3_1:
    s_waitcnt vmcnt(1)
    v_max3_u32 v19, v28, v29, v30
    v_max_u32 v19, v19, v31
    v_cmp_eq_u32 vcc, -1, v19
    s_nop 0
    s_cbranch_vccnz g_45F3_1
    v_smfmac_f32_16x16x64_bf16 v[64:67], v[28:31], a[200:207], v172
    v_smfmac_f32_16x16x64_bf16 v[68:71], v[28:31], a[232:239], v172
    s_branch g_45L1_0
g_45L6_2:
    s_waitcnt vmcnt(1)
    v_max3_u32 v19, v32, v33, v34
    v_max_u32 v19, v19, v35
    v_cmp_eq_u32 vcc, -1, v19
    s_nop 0
    s_cbranch_vccnz g_45F6_2
    v_smfmac_f32_16x16x64_bf16 v[64:67], v[32:35], a[208:215], v172
    v_smfmac_f32_16x16x64_bf16 v[68:71], v[32:35], a[240:247], v172
    s_branch g_45L2_1
g_45L9_0:
    s_waitcnt vmcnt(1)
    v_max3_u32 v19, v24, v25, v26
    v_max_u32 v19, v19, v27
    v_cmp_eq_u32 vcc, -1, v19
    s_nop 0
    s_cbranch_vccnz g_45F9_0
    v_smfmac_f32_16x16x64_bf16 v[64:67], v[24:27], a[192:199], v172
    v_smfmac_f32_16x16x64_bf16 v[68:71], v[24:27], a[224:231], v172
    s_branch g_45L8_3
g_45L12_3:
    s_waitcnt vmcnt(1)
    v_max3_u32 v19, v36, v37, v38
    v_max_u32 v19, v19, v39
    v_cmp_eq_u32 vcc, -1, v19
    s_nop 0
    s_cbranch_vccnz g_45F12_3
    v_smfmac_f32_16x16x64_bf16 v[64:67], v[36:39], a[216:223], v172
    v_smfmac_f32_16x16x64_bf16 v[68:71], v[36:39], a[248:255], v172
    s_branch g_45L4_2
g_45F15_0:
    s_mov_b64 exec, vcc
    buffer_load_dwordx4 v[24:27], v8, s[4:7], s16 offen offset:0 sc1
    s_mov_b64 exec, -1
    s_add_u32 s23, s23, 1
    s_cmp_lt_u32 s23, 200000
    s_cbranch_scc1 g_45L15_1
    s_mov_b32 s25, 200000
    s_branch gc_46
g_45F15_1:
    s_mov_b64 exec, vcc
    buffer_load_dwordx4 v[28:31], v8, s[4:7], s16 offen offset:1024 sc1
    s_mov_b64 exec, -1
    s_add_u32 s23, s23, 1
    s_cmp_lt_u32 s23, 200000
    s_cbranch_scc1 g_45L15_2
    s_mov_b32 s25, 200000
    s_branch gc_46
g_45F15_2:
    s_mov_b64 exec, vcc
    buffer_load_dwordx4 v[32:35], v8, s[4:7], s16 offen offset:2048 sc1
    s_mov_b64 exec, -1
    s_add_u32 s23, s23, 1
    s_cmp_lt_u32 s23, 200000
    s_cbranch_scc1 g_45L15_3
    s_mov_b32 s25, 200000
    s_branch gc_46
g_45F15_3:
    s_mov_b64 exec, vcc
    buffer_load_dwordx4 v[36:39], v8, s[4:7], s16 offen offset:3072 sc1
    s_mov_b64 exec, -1
    s_add_u32 s23, s23, 1
    s_cmp_lt_u32 s23, 200000
    s_cbranch_scc1 g_45L15_0
    s_mov_b32 s25, 200000
    s_branch gc_46
g_45F7_0:
    s_mov_b64 exec, vcc
    buffer_load_dwordx4 v[24:27], v8, s[4:7], s16 offen offset:0 sc1
    s_mov_b64 exec, -1
    s_add_u32 s23, s23, 1
    s_cmp_lt_u32 s23, 200000
    s_cbranch_scc1 g_45L7_1
    s_mov_b32 s25, 200000
    s_branch gc_46
g_45F7_1:
    s_mov_b64 exec, vcc
    buffer_load_dwordx4 v[28:31], v8, s[4:7], s16 offen offset:1024 sc1
    s_mov_b64 exec, -1
    s_add_u32 s23, s23, 1
    s_cmp_lt_u32 s23, 200000
    s_cbranch_scc1 g_45L7_2
    s_mov_b32 s25, 200000
    s_branch gc_46
g_45F7_2:
    s_mov_b64 exec, vcc
    buffer_load_dwordx4 v[32:35], v8, s[4:7], s16 offen offset:2048 sc1
    s_mov_b64 exec, -1
    s_add_u32 s23, s23, 1
    s_cmp_lt_u32 s23, 200000
    s_cbranch_scc1 g_45L7_0
    s_mov_b32 s25, 200000
    s_branch gc_46
g_45F11_0:
    s_mov_b64 exec, vcc
    buffer_load_dwordx4 v[24:27], v8, s[4:7], s16 offen offset:0 sc1
    s_mov_b64 exec, -1
    s_add_u32 s23, s23, 1
    s_cmp_lt_u32 s23, 200000
    s_cbranch_scc1 g_45L11_1
    s_mov_b32 s25, 200000
    s_branch gc_46
g_45F11_1:
    s_mov_b64 exec, vcc
    buffer_load_dwordx4 v[28:31], v8, s[4:7], s16 offen offset:1024 sc1
    s_mov_b64 exec, -1
    s_add_u32 s23, s23, 1
    s_cmp_lt_u32 s23, 200000
    s_cbranch_scc1 g_45L11_3
    s_mov_b32 s25, 200000
    s_branch gc_46
g_45F11_3:
    s_mov_b64 exec, vcc
    buffer_load_dwordx4 v[36:39], v8, s[4:7], s16 offen offset:3072 sc1
    s_mov_b64 exec, -1
    s_add_u32 s23, s23, 1
    s_cmp_lt_u32 s23, 200000
    s_cbranch_scc1 g_45L11_0
    s_mov_b32 s25, 200000
    s_branch gc_46
g_45F13_0:
    s_mov_b64 exec, vcc
    buffer_load_dwordx4 v[24:27], v8, s[4:7], s16 offen offset:0 sc1
    s_mov_b64 exec, -1
    s_add_u32 s23, s23, 1
    s_cmp_lt_u32 s23, 200000
    s_cbranch_scc1 g_45L13_2
    s_mov_b32 s25, 200000
    s_branch gc_46
g_45F13_2:
    s_mov_b64 exec, vcc
    buffer_load_dwordx4 v[32:35], v8, s[4:7], s16 offen offset:2048 sc1
    s_mov_b64 exec, -1
    s_add_u32 s23, s23, 1
    s_cmp_lt_u32 s23, 200000
    s_cbranch_scc1 g_45L13_3
    s_mov_b32 s25, 200000
    s_branch gc_46
g_45F13_3:
    s_mov_b64 exec, vcc
    buffer_load_dwordx4 v[36:39], v8, s[4:7], s16 offen offset:3072 sc1
    s_mov_b64 exec, -1
    s_add_u32 s23, s23, 1
    s_cmp_lt_u32 s23, 200000
    s_cbranch_scc1 g_45L13_0
    s_mov_b32 s25, 200000
    s_branch gc_46
g_45F14_1:
    s_mov_b64 exec, vcc
    buffer_load_dwordx4 v[28:31], v8, s[4:7], s16 offen offset:1024 sc1
    s_mov_b64 exec, -1
    s_add_u32 s23, s23, 1
    s_cmp_lt_u32 s23, 200000
    s_cbranch_scc1 g_45L14_2
    s_mov_b32 s25, 200000
    s_branch gc_46
g_45F14_2:
    s_mov_b64 exec, vcc
    buffer_load_dwordx4 v[32:35], v8, s[4:7], s16 offen offset:2048 sc1
    s_mov_b64 exec, -1
    s_add_u32 s23, s23, 1
    s_cmp_lt_u32 s23, 200000
    s_cbranch_scc1 g_45L14_3
    s_mov_b32 s25, 200000
    s_branch gc_46
g_45F14_3:
    s_mov_b64 exec, vcc
    buffer_load_dwordx4 v[36:39], v8, s[4:7], s16 offen offset:3072 sc1
    s_mov_b64 exec, -1
    s_add_u32 s23, s23, 1
    s_cmp_lt_u32 s23, 200000
    s_cbranch_scc1 g_45L14_1
    s_mov_b32 s25, 200000
    s_branch gc_46
g_45F3_0:
    s_mov_b64 exec, vcc
    buffer_load_dwordx4 v[24:27], v8, s[4:7], s16 offen offset:0 sc1
    s_mov_b64 exec, -1
    s_add_u32 s23, s23, 1
    s_cmp_lt_u32 s23, 200000
    s_cbranch_scc1 g_45L3_1
    s_mov_b32 s25, 200000
    s_branch gc_46
g_45F3_1:
    s_mov_b64 exec, vcc
    buffer_load_dwordx4 v[28:31], v8, s[4:7], s16 offen offset:1024 sc1
    s_mov_b64 exec, -1
    s_add_u32 s23, s23, 1
    s_cmp_lt_u32 s23, 200000
    s_cbranch_scc1 g_45L3_0
    s_mov_b32 s25, 200000
    s_branch gc_46
g_45F5_0:
    s_mov_b64 exec, vcc
    buffer_load_dwordx4 v[24:27], v8, s[4:7], s16 offen offset:0 sc1
    s_mov_b64 exec, -1
    s_add_u32 s23, s23, 1
    s_cmp_lt_u32 s23, 200000
    s_cbranch_scc1 g_45L5_2
    s_mov_b32 s25, 200000
    s_branch gc_46
g_45F5_2:
    s_mov_b64 exec, vcc
    buffer_load_dwordx4 v[32:35], v8, s[4:7], s16 offen offset:2048 sc1
    s_mov_b64 exec, -1
    s_add_u32 s23, s23, 1
    s_cmp_lt_u32 s23, 200000
    s_cbranch_scc1 g_45L5_0
    s_mov_b32 s25, 200000
    s_branch gc_46
g_45F6_1:
    s_mov_b64 exec, vcc
    buffer_load_dwordx4 v[28:31], v8, s[4:7], s16 offen offset:1024 sc1
    s_mov_b64 exec, -1
    s_add_u32 s23, s23, 1
    s_cmp_lt_u32 s23, 200000
    s_cbranch_scc1 g_45L6_2
    s_mov_b32 s25, 200000
    s_branch gc_46
g_45F6_2:
    s_mov_b64 exec, vcc
    buffer_load_dwordx4 v[32:35], v8, s[4:7], s16 offen offset:2048 sc1
    s_mov_b64 exec, -1
    s_add_u32 s23, s23, 1
    s_cmp_lt_u32 s23, 200000
    s_cbranch_scc1 g_45L6_1
    s_mov_b32 s25, 200000
    s_branch gc_46
g_45F9_0:
    s_mov_b64 exec, vcc
    buffer_load_dwordx4 v[24:27], v8, s[4:7], s16 offen offset:0 sc1
    s_mov_b64 exec, -1
    s_add_u32 s23, s23, 1
    s_cmp_lt_u32 s23, 200000
    s_cbranch_scc1 g_45L9_3
    s_mov_b32 s25, 200000
    s_branch gc_46
g_45F9_3:
    s_mov_b64 exec, vcc
    buffer_load_dwordx4 v[36:39], v8, s[4:7], s16 offen offset:3072 sc1
    s_mov_b64 exec, -1
    s_add_u32 s23, s23, 1
    s_cmp_lt_u32 s23, 200000
    s_cbranch_scc1 g_45L9_0
    s_mov_b32 s25, 200000
    s_branch gc_46
g_45F10_1:
    s_mov_b64 exec, vcc
    buffer_load_dwordx4 v[28:31], v8, s[4:7], s16 offen offset:1024 sc1
    s_mov_b64 exec, -1
    s_add_u32 s23, s23, 1
    s_cmp_lt_u32 s23, 200000
    s_cbranch_scc1 g_45L10_3
    s_mov_b32 s25, 200000
    s_branch gc_46
g_45F10_3:
    s_mov_b64 exec, vcc
    buffer_load_dwordx4 v[36:39], v8, s[4:7], s16 offen offset:3072 sc1
    s_mov_b64 exec, -1
    s_add_u32 s23, s23, 1
    s_cmp_lt_u32 s23, 200000
    s_cbranch_scc1 g_45L10_1
    s_mov_b32 s25, 200000
    s_branch gc_46
g_45F12_2:
    s_mov_b64 exec, vcc
    buffer_load_dwordx4 v[32:35], v8, s[4:7], s16 offen offset:2048 sc1
    s_mov_b64 exec, -1
    s_add_u32 s23, s23, 1
    s_cmp_lt_u32 s23, 200000
    s_cbranch_scc1 g_45L12_3
    s_mov_b32 s25, 200000
    s_branch gc_46
g_45F12_3:
    s_mov_b64 exec, vcc
    buffer_load_dwordx4 v[36:39], v8, s[4:7], s16 offen offset:3072 sc1
    s_mov_b64 exec, -1
    s_add_u32 s23, s23, 1
    s_cmp_lt_u32 s23, 200000
    s_cbranch_scc1 g_45L12_2
    s_mov_b32 s25, 200000
    s_branch gc_46
g_45F1_0:
    s_mov_b64 exec, vcc
    buffer_load_dwordx4 v[24:27], v8, s[4:7], s16 offen offset:0 sc1
    s_mov_b64 exec, -1
    s_add_u32 s23, s23, 1
    s_cmp_lt_u32 s23, 200000
    s_cbranch_scc1 g_45L1_0
    s_mov_b32 s25, 200000
    s_branch gc_46
g_45F2_1:
    s_mov_b64 exec, vcc
    buffer_load_dwordx4 v[28:31], v8, s[4:7], s16 offen offset:1024 sc1
    s_mov_b64 exec, -1
    s_add_u32 s23, s23, 1
    s_cmp_lt_u32 s23, 200000
    s_cbranch_scc1 g_45L2_1
    s_mov_b32 s25, 200000
    s_branch gc_46
g_45F4_2:
    s_mov_b64 exec, vcc
    buffer_load_dwordx4 v[32:35], v8, s[4:7], s16 offen offset:2048 sc1
    s_mov_b64 exec, -1
    s_add_u32 s23, s23, 1
    s_cmp_lt_u32 s23, 200000
    s_cbranch_scc1 g_45L4_2
    s_mov_b32 s25, 200000
    s_branch gc_46
g_45F8_3:
    s_mov_b64 exec, vcc
    buffer_load_dwordx4 v[36:39], v8, s[4:7], s16 offen offset:3072 sc1
    s_mov_b64 exec, -1
    s_add_u32 s23, s23, 1
    s_cmp_lt_u32 s23, 200000
    s_cbranch_scc1 g_45L8_3
    s_mov_b32 s25, 200000
    s_branch gc_46
.p2align 6
recur_fast_w3:
    s_nop 15
    s_mov_b32 s23, s25
    buffer_load_dwordx4 v[24:27], v2, s[4:7], s16 offen offset:0 sc1
    s_nop 11
    buffer_load_dwordx4 v[28:31], v2, s[4:7], s16 offen offset:1024 sc1
    s_nop 11
    buffer_load_dwordx4 v[32:35], v2, s[4:7], s16 offen offset:2048 sc1
    s_nop 11
    buffer_load_dwordx4 v[36:39], v2, s[4:7], s16 offen offset:3072 sc1
    s_waitcnt vmcnt(3)
    v_max3_u32 v19, v24, v25, v26
    v_max_u32 v19, v19, v27
    v_cmp_eq_u32 vcc, -1, v19
    s_nop 0
    s_cbranch_vccnz g_47F15_0
    v_smfmac_f32_16x16x64_bf16 v[40:43], v[24:27], a[0:7], v172
    s_waitcnt vmcnt(2)
    v_max3_u32 v19, v28, v29, v30
    v_max_u32 v19, v19, v31
    v_smfmac_f32_16x16x64_bf16 v[44:47], v[24:27], a[64:71], v172
    v_cmp_eq_u32 vcc, -1, v19
    v_smfmac_f32_16x16x64_bf16 v[48:51], v[24:27], a[32:39], v172
    v_smfmac_f32_16x16x64_bf16 v[52:55], v[24:27], a[96:103], v172
    s_cbranch_vccnz g_47F14_1
    v_smfmac_f32_16x16x64_bf16 v[40:43], v[28:31], a[8:15], v172
    s_waitcnt vmcnt(1)
    v_max3_u32 v19, v32, v33, v34
    v_max_u32 v19, v19, v35
    v_smfmac_f32_16x16x64_bf16 v[44:47], v[28:31], a[72:79], v172
    v_cmp_eq_u32 vcc, -1, v19
    v_smfmac_f32_16x16x64_bf16 v[48:51], v[28:31], a[40:47], v172
    v_smfmac_f32_16x16x64_bf16 v[52:55], v[28:31], a[104:111], v172
    s_cbranch_vccnz g_47F12_2
    v_smfmac_f32_16x16x64_bf16 v[40:43], v[32:35], a[16:23], v172
    s_waitcnt vmcnt(0)
    v_max3_u32 v19, v36, v37, v38
    v_max_u32 v19, v19, v39
    v_smfmac_f32_16x16x64_bf16 v[44:47], v[32:35], a[80:87], v172
    v_cmp_eq_u32 vcc, -1, v19
    v_smfmac_f32_16x16x64_bf16 v[48:51], v[32:35], a[48:55], v172
    v_smfmac_f32_16x16x64_bf16 v[52:55], v[32:35], a[112:119], v172
    s_cbranch_vccnz g_47F8_3
    v_smfmac_f32_16x16x64_bf16 v[40:43], v[36:39], a[24:31], v172
    v_smfmac_f32_16x16x64_bf16 v[44:47], v[36:39], a[88:95], v172
    v_smfmac_f32_16x16x64_bf16 v[48:51], v[36:39], a[56:63], v172
    v_smfmac_f32_16x16x64_bf16 v[52:55], v[36:39], a[120:127], v172
gc_48:
    v_cvt_pk_bf16_f32 v72, v40, v41
    v_cvt_pk_bf16_f32 v73, v42, v43
    v_cvt_pk_bf16_f32 v74, v44, v45
    v_cvt_pk_bf16_f32 v75, v46, v47
    ds_write_b128 v17, v[72:75] offset:0
    v_cvt_pk_bf16_f32 v76, v48, v49
    v_cvt_pk_bf16_f32 v77, v50, v51
    s_nop 0
    v_cvt_pk_bf16_f32 v78, v52, v53
    v_cvt_pk_bf16_f32 v79, v54, v55
    ds_write_b128 v17, v[76:79] offset:1024
    v_smfmac_f32_16x16x64_bf16 v[56:59], v[24:27], a[128:135], v172
    v_smfmac_f32_16x16x64_bf16 v[60:63], v[24:27], a[160:167], v172
    v_smfmac_f32_16x16x64_bf16 v[56:59], v[28:31], a[136:143], v172
    s_waitcnt lgkmcnt(0)
    s_barrier
    v_smfmac_f32_16x16x64_bf16 v[60:63], v[28:31], a[168:175], v172
    v_smfmac_f32_16x16x64_bf16 v[56:59], v[32:35], a[144:151], v172
    v_smfmac_f32_16x16x64_bf16 v[60:63], v[32:35], a[176:183], v172
    v_smfmac_f32_16x16x64_bf16 v[56:59], v[36:39], a[152:159], v172
    v_smfmac_f32_16x16x64_bf16 v[60:63], v[36:39], a[184:191], v172
    s_nop 4
    v_cvt_pk_bf16_f32 v80, v56, v57
    v_cvt_pk_bf16_f32 v81, v58, v59
    s_nop 0
    v_cvt_pk_bf16_f32 v82, v60, v61
    v_cvt_pk_bf16_f32 v83, v62, v63
    ds_write_b128 v17, v[80:83] offset:8192
    buffer_store_dwordx4 v[204:207], v3, s[4:7], s43 offen
    buffer_store_dwordx4 v[204:207], v3, s[4:7], s43 offen offset:128
    buffer_store_dwordx4 v[204:207], v4, s[4:7], s43 offen
    buffer_store_dwordx2 v[204:205], v7, s[4:7], s43 offen
    buffer_store_dwordx2 v[204:205], v11, s[4:7], s43 offen
    s_cmp_eq_u32 s15, 63
    s_waitcnt lgkmcnt(0)
    s_barrier
    s_cbranch_scc1 recur_end
    s_barrier
    s_nop 15
    s_mov_b32 s23, s25
    buffer_load_dwordx4 v[24:27], v8, s[4:7], s16 offen offset:0 sc1
    s_nop 11
    buffer_load_dwordx4 v[28:31], v8, s[4:7], s16 offen offset:1024 sc1
    s_nop 11
    buffer_load_dwordx4 v[32:35], v8, s[4:7], s16 offen offset:2048 sc1
    s_nop 11
    buffer_load_dwordx4 v[36:39], v8, s[4:7], s16 offen offset:3072 sc1
    s_waitcnt vmcnt(3)
    v_max3_u32 v19, v24, v25, v26
    v_max_u32 v19, v19, v27
    v_cmp_eq_u32 vcc, -1, v19
    s_nop 0
    s_cbranch_vccnz g_49F15_0
    v_smfmac_f32_16x16x64_bf16 v[64:67], v[24:27], a[192:199], v172
    v_smfmac_f32_16x16x64_bf16 v[68:71], v[24:27], a[224:231], v172
    s_waitcnt vmcnt(2)
    v_max3_u32 v19, v28, v29, v30
    v_max_u32 v19, v19, v31
    v_cmp_eq_u32 vcc, -1, v19
    s_nop 0
    s_cbranch_vccnz g_49F14_1
    v_smfmac_f32_16x16x64_bf16 v[64:67], v[28:31], a[200:207], v172
    v_smfmac_f32_16x16x64_bf16 v[68:71], v[28:31], a[232:239], v172
    s_waitcnt vmcnt(1)
    v_max3_u32 v19, v32, v33, v34
    v_max_u32 v19, v19, v35
    v_cmp_eq_u32 vcc, -1, v19
    s_nop 0
    s_cbranch_vccnz g_49F12_2
    v_smfmac_f32_16x16x64_bf16 v[64:67], v[32:35], a[208:215], v172
    v_smfmac_f32_16x16x64_bf16 v[68:71], v[32:35], a[240:247], v172
    s_waitcnt vmcnt(0)
    v_max3_u32 v19, v36, v37, v38
    v_max_u32 v19, v19, v39
    v_cmp_eq_u32 vcc, -1, v19
    s_nop 0
    s_cbranch_vccnz g_49F8_3
    v_smfmac_f32_16x16x64_bf16 v[64:67], v[36:39], a[216:223], v172
    v_smfmac_f32_16x16x64_bf16 v[68:71], v[36:39], a[248:255], v172
    s_nop 4
    v_cvt_pk_bf16_f32 v80, v64, v65
    v_cvt_pk_bf16_f32 v81, v66, v67
    s_nop 0
    v_cvt_pk_bf16_f32 v82, v68, v69
    v_cvt_pk_bf16_f32 v83, v70, v71
    s_nop 1
    v_mfma_f32_16x16x32_bf16 v[88:91], v[80:83], v[84:87], 0
gc_50:
    s_barrier
    ds_read_b128 v[96:99], v16 offset:9216
    ds_read_b128 v[100:103], v16 offset:11264
    ds_read_b128 v[104:107], v16 offset:13312
    s_waitcnt lgkmcnt(2)
    v_mfma_f32_16x16x32_bf16 v[88:91], v[96:99], v[84:87], v[88:91]
    s_waitcnt lgkmcnt(1)
    v_mfma_f32_16x16x32_bf16 v[88:91], v[100:103], v[84:87], v[88:91]
    s_waitcnt lgkmcnt(0)
    v_mfma_f32_16x16x32_bf16 v[88:91], v[104:107], v[84:87], v[88:91]
    s_nop 7
    buffer_store_dwordx4 v[88:91], v9, s[4:7], s84 offen sc1
    s_add_u32 s22, s84, 262144
    s_nop 15
    s_nop 15
    s_nop 15
    s_nop 15
    s_nop 15
    s_nop 15
    s_nop 15
    s_nop 15
    s_mov_b32 s23, s25
    buffer_load_dwordx4 v[96:99], v10, s[4:7], s84 offen sc1
    buffer_load_dwordx4 v[100:103], v23, s[4:7], s84 offen sc1
    buffer_load_dwordx4 v[104:107], v244, s[4:7], s84 offen sc1
    v_mov_b32 v40, 0
    v_mov_b32 v41, 0
    v_mov_b32 v42, 0
    v_mov_b32 v43, 0
    v_mov_b32 v44, 0
    v_mov_b32 v45, 0
    v_mov_b32 v46, 0
    v_mov_b32 v47, 0
    v_mov_b32 v48, 0
    v_mov_b32 v49, 0
    v_mov_b32 v50, 0
    v_mov_b32 v51, 0
    v_mov_b32 v52, 0
    v_mov_b32 v53, 0
    v_mov_b32 v54, 0
    v_mov_b32 v55, 0
    v_mov_b32 v56, 0
    v_mov_b32 v57, 0
    v_mov_b32 v58, 0
    v_mov_b32 v59, 0
    v_mov_b32 v60, 0
    v_mov_b32 v61, 0
    v_mov_b32 v62, 0
    v_mov_b32 v63, 0
    v_mov_b32 v64, 0
    v_mov_b32 v65, 0
    v_mov_b32 v66, 0
    v_mov_b32 v67, 0
    v_mov_b32 v68, 0
    v_mov_b32 v69, 0
    v_mov_b32 v70, 0
    v_mov_b32 v71, 0
pb_53:
    s_waitcnt vmcnt(2)
    v_pk_add_f32 v[120:121], v[88:89], v[96:97]
    v_pk_add_f32 v[122:123], v[90:91], v[98:99]
    s_waitcnt vmcnt(1)
    v_pk_add_f32 v[120:121], v[120:121], v[100:101]
    v_pk_add_f32 v[122:123], v[122:123], v[102:103]
    s_waitcnt vmcnt(0)
    v_pk_add_f32 v[120:121], v[120:121], v[104:105]
    v_pk_add_f32 v[122:123], v[122:123], v[106:107]
    v_cvt_pk_bf16_f32 v180, v120, v121
    v_pk_add_f32 v[124:125], v[120:121], v[122:123]
    v_cvt_pk_bf16_f32 v181, v122, v123
    v_cmpx_o_f32 vcc, v124, v125
    buffer_store_dwordx2 v[180:181], v11, s[4:7], s42 offen
    s_cmp_eq_u64 vcc, -1
    s_mov_b64 exec, -1
    s_cbranch_scc0 pr_51
pg_52:
    s_barrier
    s_mov_b32 s21, s16
    s_mov_b32 s16, s42
    s_mov_b32 s42, s43
    s_mov_b32 s43, s44
    s_mov_b32 s44, s21
    s_add_u32 s95, s95, 524288
    s_lshr_b32 s84, s95, 8
    s_and_b32 s84, s84, 8192
    s_xor_b32 s84, s84, s46
    s_add_u32 s84, s84, s95
    s_add_u32 s15, s15, 1
    s_branch recur_fast_w3
g_47L15_0:
    s_waitcnt vmcnt(3)
    v_max3_u32 v19, v24, v25, v26
    v_max_u32 v19, v19, v27
    v_cmp_eq_u32 vcc, -1, v19
    s_nop 0
    s_cbranch_vccnz g_47F15_0
    v_smfmac_f32_16x16x64_bf16 v[40:43], v[24:27], a[0:7], v172
    v_smfmac_f32_16x16x64_bf16 v[44:47], v[24:27], a[64:71], v172
    v_smfmac_f32_16x16x64_bf16 v[48:51], v[24:27], a[32:39], v172
    v_smfmac_f32_16x16x64_bf16 v[52:55], v[24:27], a[96:103], v172
g_47L14_1:
    s_waitcnt vmcnt(2)
    v_max3_u32 v19, v28, v29, v30
    v_max_u32 v19, v19, v31
    v_cmp_eq_u32 vcc, -1, v19
    s_nop 0
    s_cbranch_vccnz g_47F14_1
    v_smfmac_f32_16x16x64_bf16 v[40:43], v[28:31], a[8:15], v172
    v_smfmac_f32_16x16x64_bf16 v[44:47], v[28:31], a[72:79], v172
    v_smfmac_f32_16x16x64_bf16 v[48:51], v[28:31], a[40:47], v172
    v_smfmac_f32_16x16x64_bf16 v[52:55], v[28:31], a[104:111], v172
g_47L12_2:
    s_waitcnt vmcnt(1)
    v_max3_u32 v19, v32, v33, v34
    v_max_u32 v19, v19, v35
    v_cmp_eq_u32 vcc, -1, v19
    s_nop 0
    s_cbranch_vccnz g_47F12_2
    v_smfmac_f32_16x16x64_bf16 v[40:43], v[32:35], a[16:23], v172
    v_smfmac_f32_16x16x64_bf16 v[44:47], v[32:35], a[80:87], v172
    v_smfmac_f32_16x16x64_bf16 v[48:51], v[32:35], a[48:55], v172
    v_smfmac_f32_16x16x64_bf16 v[52:55], v[32:35], a[112:119], v172
g_47L8_3:
    s_waitcnt vmcnt(0)
    v_max3_u32 v19, v36, v37, v38
    v_max_u32 v19, v19, v39
    v_cmp_eq_u32 vcc, -1, v19
    s_nop 0
    s_cbranch_vccnz g_47F8_3
    v_smfmac_f32_16x16x64_bf16 v[40:43], v[36:39], a[24:31], v172
    v_smfmac_f32_16x16x64_bf16 v[44:47], v[36:39], a[88:95], v172
    v_smfmac_f32_16x16x64_bf16 v[48:51], v[36:39], a[56:63], v172
    v_smfmac_f32_16x16x64_bf16 v[52:55], v[36:39], a[120:127], v172
    s_branch gc_48
g_47L15_1:
    s_waitcnt vmcnt(3)
    v_max3_u32 v19, v28, v29, v30
    v_max_u32 v19, v19, v31
    v_cmp_eq_u32 vcc, -1, v19
    s_nop 0
    s_cbranch_vccnz g_47F15_1
    v_smfmac_f32_16x16x64_bf16 v[40:43], v[28:31], a[8:15], v172
    v_smfmac_f32_16x16x64_bf16 v[44:47], v[28:31], a[72:79], v172
    v_smfmac_f32_16x16x64_bf16 v[48:51], v[28:31], a[40:47], v172
    v_smfmac_f32_16x16x64_bf16 v[52:55], v[28:31], a[104:111], v172
g_47L13_2:
    s_waitcnt vmcnt(2)
    v_max3_u32 v19, v32, v33, v34
    v_max_u32 v19, v19, v35
    v_cmp_eq_u32 vcc, -1, v19
    s_nop 0
    s_cbranch_vccnz g_47F13_2
    v_smfmac_f32_16x16x64_bf16 v[40:43], v[32:35], a[16:23], v172
    v_smfmac_f32_16x16x64_bf16 v[44:47], v[32:35], a[80:87], v172
    v_smfmac_f32_16x16x64_bf16 v[48:51], v[32:35], a[48:55], v172
    v_smfmac_f32_16x16x64_bf16 v[52:55], v[32:35], a[112:119], v172
g_47L9_3:
    s_waitcnt vmcnt(1)
    v_max3_u32 v19, v36, v37, v38
    v_max_u32 v19, v19, v39
    v_cmp_eq_u32 vcc, -1, v19
    s_nop 0
    s_cbranch_vccnz g_47F9_3
    v_smfmac_f32_16x16x64_bf16 v[40:43], v[36:39], a[24:31], v172
    v_smfmac_f32_16x16x64_bf16 v[44:47], v[36:39], a[88:95], v172
    v_smfmac_f32_16x16x64_bf16 v[48:51], v[36:39], a[56:63], v172
    v_smfmac_f32_16x16x64_bf16 v[52:55], v[36:39], a[120:127], v172
g_47L1_0:
    s_waitcnt vmcnt(0)
    v_max3_u32 v19, v24, v25, v26
    v_max_u32 v19, v19, v27
    v_cmp_eq_u32 vcc, -1, v19
    s_nop 0
    s_cbranch_vccnz g_47F1_0
    v_smfmac_f32_16x16x64_bf16 v[40:43], v[24:27], a[0:7], v172
    v_smfmac_f32_16x16x64_bf16 v[44:47], v[24:27], a[64:71], v172
    v_smfmac_f32_16x16x64_bf16 v[48:51], v[24:27], a[32:39], v172
    v_smfmac_f32_16x16x64_bf16 v[52:55], v[24:27], a[96:103], v172
    s_branch gc_48
g_47L15_2:
    s_waitcnt vmcnt(3)
    v_max3_u32 v19, v32, v33, v34
    v_max_u32 v19, v19, v35
    v_cmp_eq_u32 vcc, -1, v19
    s_nop 0
    s_cbranch_vccnz g_47F15_2
    v_smfmac_f32_16x16x64_bf16 v[40:43], v[32:35], a[16:23], v172
    v_smfmac_f32_16x16x64_bf16 v[44:47], v[32:35], a[80:87], v172
    v_smfmac_f32_16x16x64_bf16 v[48:51], v[32:35], a[48:55], v172
    v_smfmac_f32_16x16x64_bf16 v[52:55], v[32:35], a[112:119], v172
g_47L11_3:
    s_waitcnt vmcnt(2)
    v_max3_u32 v19, v36, v37, v38
    v_max_u32 v19, v19, v39
    v_cmp_eq_u32 vcc, -1, v19
    s_nop 0
    s_cbranch_vccnz g_47F11_3
    v_smfmac_f32_16x16x64_bf16 v[40:43], v[36:39], a[24:31], v172
    v_smfmac_f32_16x16x64_bf16 v[44:47], v[36:39], a[88:95], v172
    v_smfmac_f32_16x16x64_bf16 v[48:51], v[36:39], a[56:63], v172
    v_smfmac_f32_16x16x64_bf16 v[52:55], v[36:39], a[120:127], v172
g_47L3_0:
    s_waitcnt vmcnt(1)
    v_max3_u32 v19, v24, v25, v26
    v_max_u32 v19, v19, v27
    v_cmp_eq_u32 vcc, -1, v19
    s_nop 0
    s_cbranch_vccnz g_47F3_0
    v_smfmac_f32_16x16x64_bf16 v[40:43], v[24:27], a[0:7], v172
    v_smfmac_f32_16x16x64_bf16 v[44:47], v[24:27], a[64:71], v172
    v_smfmac_f32_16x16x64_bf16 v[48:51], v[24:27], a[32:39], v172
    v_smfmac_f32_16x16x64_bf16 v[52:55], v[24:27], a[96:103], v172
g_47L2_1:
    s_waitcnt vmcnt(0)
    v_max3_u32 v19, v28, v29, v30
    v_max_u32 v19, v19, v31
    v_cmp_eq_u32 vcc, -1, v19
    s_nop 0
    s_cbranch_vccnz g_47F2_1
    v_smfmac_f32_16x16x64_bf16 v[40:43], v[28:31], a[8:15], v172
    v_smfmac_f32_16x16x64_bf16 v[44:47], v[28:31], a[72:79], v172
    v_smfmac_f32_16x16x64_bf16 v[48:51], v[28:31], a[40:47], v172
    v_smfmac_f32_16x16x64_bf16 v[52:55], v[28:31], a[104:111], v172
    s_branch gc_48
g_47L15_3:
    s_waitcnt vmcnt(3)
    v_max3_u32 v19, v36, v37, v38
    v_max_u32 v19, v19, v39
    v_cmp_eq_u32 vcc, -1, v19
    s_nop 0
    s_cbranch_vccnz g_47F15_3
    v_smfmac_f32_16x16x64_bf16 v[40:43], v[36:39], a[24:31], v172
    v_smfmac_f32_16x16x64_bf16 v[44:47], v[36:39], a[88:95], v172
    v_smfmac_f32_16x16x64_bf16 v[48:51], v[36:39], a[56:63], v172
    v_smfmac_f32_16x16x64_bf16 v[52:55], v[36:39], a[120:127], v172
g_47L7_0:
    s_waitcnt vmcnt(2)
    v_max3_u32 v19, v24, v25, v26
    v_max_u32 v19, v19, v27
    v_cmp_eq_u32 vcc, -1, v19
    s_nop 0
    s_cbranch_vccnz g_47F7_0
    v_smfmac_f32_16x16x64_bf16 v[40:43], v[24:27], a[0:7], v172
    v_smfmac_f32_16x16x64_bf16 v[44:47], v[24:27], a[64:71], v172
    v_smfmac_f32_16x16x64_bf16 v[48:51], v[24:27], a[32:39], v172
    v_smfmac_f32_16x16x64_bf16 v[52:55], v[24:27], a[96:103], v172
g_47L6_1:
    s_waitcnt vmcnt(1)
    v_max3_u32 v19, v28, v29, v30
    v_max_u32 v19, v19, v31
    v_cmp_eq_u32 vcc, -1, v19
    s_nop 0
    s_cbranch_vccnz g_47F6_1
    v_smfmac_f32_16x16x64_bf16 v[40:43], v[28:31], a[8:15], v172
    v_smfmac_f32_16x16x64_bf16 v[44:47], v[28:31], a[72:79], v172
    v_smfmac_f32_16x16x64_bf16 v[48:51], v[28:31], a[40:47], v172
    v_smfmac_f32_16x16x64_bf16 v[52:55], v[28:31], a[104:111], v172
g_47L4_2:
    s_waitcnt vmcnt(0)
    v_max3_u32 v19, v32, v33, v34
    v_max_u32 v19, v19, v35
    v_cmp_eq_u32 vcc, -1, v19
    s_nop 0
    s_cbranch_vccnz g_47F4_2
    v_smfmac_f32_16x16x64_bf16 v[40:43], v[32:35], a[16:23], v172
    v_smfmac_f32_16x16x64_bf16 v[44:47], v[32:35], a[80:87], v172
    v_smfmac_f32_16x16x64_bf16 v[48:51], v[32:35], a[48:55], v172
    v_smfmac_f32_16x16x64_bf16 v[52:55], v[32:35], a[112:119], v172
    s_branch gc_48
g_47L7_1:
    s_waitcnt vmcnt(2)
    v_max3_u32 v19, v28, v29, v30
    v_max_u32 v19, v19, v31
    v_cmp_eq_u32 vcc, -1, v19
    s_nop 0
    s_cbranch_vccnz g_47F7_1
    v_smfmac_f32_16x16x64_bf16 v[40:43], v[28:31], a[8:15], v172
    v_smfmac_f32_16x16x64_bf16 v[44:47], v[28:31], a[72:79], v172
    v_smfmac_f32_16x16x64_bf16 v[48:51], v[28:31], a[40:47], v172
    v_smfmac_f32_16x16x64_bf16 v[52:55], v[28:31], a[104:111], v172
g_47L5_2:
    s_waitcnt vmcnt(1)
    v_max3_u32 v19, v32, v33, v34
    v_max_u32 v19, v19, v35
    v_cmp_eq_u32 vcc, -1, v19
    s_nop 0
    s_cbranch_vccnz g_47F5_2
    v_smfmac_f32_16x16x64_bf16 v[40:43], v[32:35], a[16:23], v172
    v_smfmac_f32_16x16x64_bf16 v[44:47], v[32:35], a[80:87], v172
    v_smfmac_f32_16x16x64_bf16 v[48:51], v[32:35], a[48:55], v172
    v_smfmac_f32_16x16x64_bf16 v[52:55], v[32:35], a[112:119], v172
    s_branch g_47L1_0
g_47L7_2:
    s_waitcnt vmcnt(2)
    v_max3_u32 v19, v32, v33, v34
    v_max_u32 v19, v19, v35
    v_cmp_eq_u32 vcc, -1, v19
    s_nop 0
    s_cbranch_vccnz g_47F7_2
    v_smfmac_f32_16x16x64_bf16 v[40:43], v[32:35], a[16:23], v172
    v_smfmac_f32_16x16x64_bf16 v[44:47], v[32:35], a[80:87], v172
    v_smfmac_f32_16x16x64_bf16 v[48:51], v[32:35], a[48:55], v172
    v_smfmac_f32_16x16x64_bf16 v[52:55], v[32:35], a[112:119], v172
    s_branch g_47L3_0
g_47L11_0:
    s_waitcnt vmcnt(2)
    v_max3_u32 v19, v24, v25, v26
    v_max_u32 v19, v19, v27
    v_cmp_eq_u32 vcc, -1, v19
    s_nop 0
    s_cbranch_vccnz g_47F11_0
    v_smfmac_f32_16x16x64_bf16 v[40:43], v[24:27], a[0:7], v172
    v_smfmac_f32_16x16x64_bf16 v[44:47], v[24:27], a[64:71], v172
    v_smfmac_f32_16x16x64_bf16 v[48:51], v[24:27], a[32:39], v172
    v_smfmac_f32_16x16x64_bf16 v[52:55], v[24:27], a[96:103], v172
g_47L10_1:
    s_waitcnt vmcnt(1)
    v_max3_u32 v19, v28, v29, v30
    v_max_u32 v19, v19, v31
    v_cmp_eq_u32 vcc, -1, v19
    s_nop 0
    s_cbranch_vccnz g_47F10_1
    v_smfmac_f32_16x16x64_bf16 v[40:43], v[28:31], a[8:15], v172
    v_smfmac_f32_16x16x64_bf16 v[44:47], v[28:31], a[72:79], v172
    v_smfmac_f32_16x16x64_bf16 v[48:51], v[28:31], a[40:47], v172
    v_smfmac_f32_16x16x64_bf16 v[52:55], v[28:31], a[104:111], v172
    s_branch g_47L8_3
g_47L11_1:
    s_waitcnt vmcnt(2)
    v_max3_u32 v19, v28, v29, v30
    v_max_u32 v19, v19, v31
    v_cmp_eq_u32 vcc, -1, v19
    s_nop 0
    s_cbranch_vccnz g_47F11_1
    v_smfmac_f32_16x16x64_bf16 v[40:43], v[28:31], a[8:15], v172
    v_smfmac_f32_16x16x64_bf16 v[44:47], v[28:31], a[72:79], v172
    v_smfmac_f32_16x16x64_bf16 v[48:51], v[28:31], a[40:47], v172
    v_smfmac_f32_16x16x64_bf16 v[52:55], v[28:31], a[104:111], v172
    s_branch g_47L9_3
g_47L13_0:
    s_waitcnt vmcnt(2)
    v_max3_u32 v19, v24, v25, v26
    v_max_u32 v19, v19, v27
    v_cmp_eq_u32 vcc, -1, v19
    s_nop 0
    s_cbranch_vccnz g_47F13_0
    v_smfmac_f32_16x16x64_bf16 v[40:43], v[24:27], a[0:7], v172
    v_smfmac_f32_16x16x64_bf16 v[44:47], v[24:27], a[64:71], v172
    v_smfmac_f32_16x16x64_bf16 v[48:51], v[24:27], a[32:39], v172
    v_smfmac_f32_16x16x64_bf16 v[52:55], v[24:27], a[96:103], v172
    s_branch g_47L12_2
g_47L13_3:
    s_waitcnt vmcnt(2)
    v_max3_u32 v19, v36, v37, v38
    v_max_u32 v19, v19, v39
    v_cmp_eq_u32 vcc, -1, v19
    s_nop 0
    s_cbranch_vccnz g_47F13_3
    v_smfmac_f32_16x16x64_bf16 v[40:43], v[36:39], a[24:31], v172
    v_smfmac_f32_16x16x64_bf16 v[44:47], v[36:39], a[88:95], v172
    v_smfmac_f32_16x16x64_bf16 v[48:51], v[36:39], a[56:63], v172
    v_smfmac_f32_16x16x64_bf16 v[52:55], v[36:39], a[120:127], v172
g_47L5_0:
    s_waitcnt vmcnt(1)
    v_max3_u32 v19, v24, v25, v26
    v_max_u32 v19, v19, v27
    v_cmp_eq_u32 vcc, -1, v19
    s_nop 0
    s_cbranch_vccnz g_47F5_0
    v_smfmac_f32_16x16x64_bf16 v[40:43], v[24:27], a[0:7], v172
    v_smfmac_f32_16x16x64_bf16 v[44:47], v[24:27], a[64:71], v172
    v_smfmac_f32_16x16x64_bf16 v[48:51], v[24:27], a[32:39], v172
    v_smfmac_f32_16x16x64_bf16 v[52:55], v[24:27], a[96:103], v172
    s_branch g_47L4_2
g_47L14_2:
    s_waitcnt vmcnt(2)
    v_max3_u32 v19, v32, v33, v34
    v_max_u32 v19, v19, v35
    v_cmp_eq_u32 vcc, -1, v19
    s_nop 0
    s_cbranch_vccnz g_47F14_2
    v_smfmac_f32_16x16x64_bf16 v[40:43], v[32:35], a[16:23], v172
    v_smfmac_f32_16x16x64_bf16 v[44:47], v[32:35], a[80:87], v172
    v_smfmac_f32_16x16x64_bf16 v[48:51], v[32:35], a[48:55], v172
    v_smfmac_f32_16x16x64_bf16 v[52:55], v[32:35], a[112:119], v172
g_47L10_3:
    s_waitcnt vmcnt(1)
    v_max3_u32 v19, v36, v37, v38
    v_max_u32 v19, v19, v39
    v_cmp_eq_u32 vcc, -1, v19
    s_nop 0
    s_cbranch_vccnz g_47F10_3
    v_smfmac_f32_16x16x64_bf16 v[40:43], v[36:39], a[24:31], v172
    v_smfmac_f32_16x16x64_bf16 v[44:47], v[36:39], a[88:95], v172
    v_smfmac_f32_16x16x64_bf16 v[48:51], v[36:39], a[56:63], v172
    v_smfmac_f32_16x16x64_bf16 v[52:55], v[36:39], a[120:127], v172
    s_branch g_47L2_1
g_47L14_3:
    s_waitcnt vmcnt(2)
    v_max3_u32 v19, v36, v37, v38
    v_max_u32 v19, v19, v39
    v_cmp_eq_u32 vcc, -1, v19
    s_nop 0
    s_cbranch_vccnz g_47F14_3
    v_smfmac_f32_16x16x64_bf16 v[40:43], v[36:39], a[24:31], v172
    v_smfmac_f32_16x16x64_bf16 v[44:47], v[36:39], a[88:95], v172
    v_smfmac_f32_16x16x64_bf16 v[48:51], v[36:39], a[56:63], v172
    v_smfmac_f32_16x16x64_bf16 v[52:55], v[36:39], a[120:127], v172
    s_branch g_47L6_1
g_47L3_1:
    s_waitcnt vmcnt(1)
    v_max3_u32 v19, v28, v29, v30
    v_max_u32 v19, v19, v31
    v_cmp_eq_u32 vcc, -1, v19
    s_nop 0
    s_cbranch_vccnz g_47F3_1
    v_smfmac_f32_16x16x64_bf16 v[40:43], v[28:31], a[8:15], v172
    v_smfmac_f32_16x16x64_bf16 v[44:47], v[28:31], a[72:79], v172
    v_smfmac_f32_16x16x64_bf16 v[48:51], v[28:31], a[40:47], v172
    v_smfmac_f32_16x16x64_bf16 v[52:55], v[28:31], a[104:111], v172
    s_branch g_47L1_0
g_47L6_2:
    s_waitcnt vmcnt(1)
    v_max3_u32 v19, v32, v33, v34
    v_max_u32 v19, v19, v35
    v_cmp_eq_u32 vcc, -1, v19
    s_nop 0
    s_cbranch_vccnz g_47F6_2
    v_smfmac_f32_16x16x64_bf16 v[40:43], v[32:35], a[16:23], v172
    v_smfmac_f32_16x16x64_bf16 v[44:47], v[32:35], a[80:87], v172
    v_smfmac_f32_16x16x64_bf16 v[48:51], v[32:35], a[48:55], v172
    v_smfmac_f32_16x16x64_bf16 v[52:55], v[32:35], a[112:119], v172
    s_branch g_47L2_1
g_47L9_0:
    s_waitcnt vmcnt(1)
    v_max3_u32 v19, v24, v25, v26
    v_max_u32 v19, v19, v27
    v_cmp_eq_u32 vcc, -1, v19
    s_nop 0
    s_cbranch_vccnz g_47F9_0
    v_smfmac_f32_16x16x64_bf16 v[40:43], v[24:27], a[0:7], v172
    v_smfmac_f32_16x16x64_bf16 v[44:47], v[24:27], a[64:71], v172
    v_smfmac_f32_16x16x64_bf16 v[48:51], v[24:27], a[32:39], v172
    v_smfmac_f32_16x16x64_bf16 v[52:55], v[24:27], a[96:103], v172
    s_branch g_47L8_3
g_47L12_3:
    s_waitcnt vmcnt(1)
    v_max3_u32 v19, v36, v37, v38
    v_max_u32 v19, v19, v39
    v_cmp_eq_u32 vcc, -1, v19
    s_nop 0
    s_cbranch_vccnz g_47F12_3
    v_smfmac_f32_16x16x64_bf16 v[40:43], v[36:39], a[24:31], v172
    v_smfmac_f32_16x16x64_bf16 v[44:47], v[36:39], a[88:95], v172
    v_smfmac_f32_16x16x64_bf16 v[48:51], v[36:39], a[56:63], v172
    v_smfmac_f32_16x16x64_bf16 v[52:55], v[36:39], a[120:127], v172
    s_branch g_47L4_2
g_47F15_0:
    s_mov_b64 exec, vcc
    buffer_load_dwordx4 v[24:27], v2, s[4:7], s16 offen offset:0 sc1
    s_mov_b64 exec, -1
    s_add_u32 s23, s23, 1
    s_cmp_lt_u32 s23, 200000
    s_cbranch_scc1 g_47L15_1
    s_mov_b32 s25, 200000
    s_branch gc_48
g_47F15_1:
    s_mov_b64 exec, vcc
    buffer_load_dwordx4 v[28:31], v2, s[4:7], s16 offen offset:1024 sc1
    s_mov_b64 exec, -1
    s_add_u32 s23, s23, 1
    s_cmp_lt_u32 s23, 200000
    s_cbranch_scc1 g_47L15_2
    s_mov_b32 s25, 200000
    s_branch gc_48
g_47F15_2:
    s_mov_b64 exec, vcc
    buffer_load_dwordx4 v[32:35], v2, s[4:7], s16 offen offset:2048 sc1
    s_mov_b64 exec, -1
    s_add_u32 s23, s23, 1
    s_cmp_lt_u32 s23, 200000
    s_cbranch_scc1 g_47L15_3
    s_mov_b32 s25, 200000
    s_branch gc_48
g_47F15_3:
    s_mov_b64 exec, vcc
    buffer_load_dwordx4 v[36:39], v2, s[4:7], s16 offen offset:3072 sc1
    s_mov_b64 exec, -1
    s_add_u32 s23, s23, 1
    s_cmp_lt_u32 s23, 200000
    s_cbranch_scc1 g_47L15_0
    s_mov_b32 s25, 200000
    s_branch gc_48
g_47F7_0:
    s_mov_b64 exec, vcc
    buffer_load_dwordx4 v[24:27], v2, s[4:7], s16 offen offset:0 sc1
    s_mov_b64 exec, -1
    s_add_u32 s23, s23, 1
    s_cmp_lt_u32 s23, 200000
    s_cbranch_scc1 g_47L7_1
    s_mov_b32 s25, 200000
    s_branch gc_48
g_47F7_1:
    s_mov_b64 exec, vcc
    buffer_load_dwordx4 v[28:31], v2, s[4:7], s16 offen offset:1024 sc1
    s_mov_b64 exec, -1
    s_add_u32 s23, s23, 1
    s_cmp_lt_u32 s23, 200000
    s_cbranch_scc1 g_47L7_2
    s_mov_b32 s25, 200000
    s_branch gc_48
g_47F7_2:
    s_mov_b64 exec, vcc
    buffer_load_dwordx4 v[32:35], v2, s[4:7], s16 offen offset:2048 sc1
    s_mov_b64 exec, -1
    s_add_u32 s23, s23, 1
    s_cmp_lt_u32 s23, 200000
    s_cbranch_scc1 g_47L7_0
    s_mov_b32 s25, 200000
    s_branch gc_48
g_47F11_0:
    s_mov_b64 exec, vcc
    buffer_load_dwordx4 v[24:27], v2, s[4:7], s16 offen offset:0 sc1
    s_mov_b64 exec, -1
    s_add_u32 s23, s23, 1
    s_cmp_lt_u32 s23, 200000
    s_cbranch_scc1 g_47L11_1
    s_mov_b32 s25, 200000
    s_branch gc_48
g_47F11_1:
    s_mov_b64 exec, vcc
    buffer_load_dwordx4 v[28:31], v2, s[4:7], s16 offen offset:1024 sc1
    s_mov_b64 exec, -1
    s_add_u32 s23, s23, 1
    s_cmp_lt_u32 s23, 200000
    s_cbranch_scc1 g_47L11_3
    s_mov_b32 s25, 200000
    s_branch gc_48
g_47F11_3:
    s_mov_b64 exec, vcc
    buffer_load_dwordx4 v[36:39], v2, s[4:7], s16 offen offset:3072 sc1
    s_mov_b64 exec, -1
    s_add_u32 s23, s23, 1
    s_cmp_lt_u32 s23, 200000
    s_cbranch_scc1 g_47L11_0
    s_mov_b32 s25, 200000
    s_branch gc_48
g_47F13_0:
    s_mov_b64 exec, vcc
    buffer_load_dwordx4 v[24:27], v2, s[4:7], s16 offen offset:0 sc1
    s_mov_b64 exec, -1
    s_add_u32 s23, s23, 1
    s_cmp_lt_u32 s23, 200000
    s_cbranch_scc1 g_47L13_2
    s_mov_b32 s25, 200000
    s_branch gc_48
g_47F13_2:
    s_mov_b64 exec, vcc
    buffer_load_dwordx4 v[32:35], v2, s[4:7], s16 offen offset:2048 sc1
    s_mov_b64 exec, -1
    s_add_u32 s23, s23, 1
    s_cmp_lt_u32 s23, 200000
    s_cbranch_scc1 g_47L13_3
    s_mov_b32 s25, 200000
    s_branch gc_48
g_47F13_3:
    s_mov_b64 exec, vcc
    buffer_load_dwordx4 v[36:39], v2, s[4:7], s16 offen offset:3072 sc1
    s_mov_b64 exec, -1
    s_add_u32 s23, s23, 1
    s_cmp_lt_u32 s23, 200000
    s_cbranch_scc1 g_47L13_0
    s_mov_b32 s25, 200000
    s_branch gc_48
g_47F14_1:
    s_mov_b64 exec, vcc
    buffer_load_dwordx4 v[28:31], v2, s[4:7], s16 offen offset:1024 sc1
    s_mov_b64 exec, -1
    s_add_u32 s23, s23, 1
    s_cmp_lt_u32 s23, 200000
    s_cbranch_scc1 g_47L14_2
    s_mov_b32 s25, 200000
    s_branch gc_48
g_47F14_2:
    s_mov_b64 exec, vcc
    buffer_load_dwordx4 v[32:35], v2, s[4:7], s16 offen offset:2048 sc1
    s_mov_b64 exec, -1
    s_add_u32 s23, s23, 1
    s_cmp_lt_u32 s23, 200000
    s_cbranch_scc1 g_47L14_3
    s_mov_b32 s25, 200000
    s_branch gc_48
g_47F14_3:
    s_mov_b64 exec, vcc
    buffer_load_dwordx4 v[36:39], v2, s[4:7], s16 offen offset:3072 sc1
    s_mov_b64 exec, -1
    s_add_u32 s23, s23, 1
    s_cmp_lt_u32 s23, 200000
    s_cbranch_scc1 g_47L14_1
    s_mov_b32 s25, 200000
    s_branch gc_48
g_47F3_0:
    s_mov_b64 exec, vcc
    buffer_load_dwordx4 v[24:27], v2, s[4:7], s16 offen offset:0 sc1
    s_mov_b64 exec, -1
    s_add_u32 s23, s23, 1
    s_cmp_lt_u32 s23, 200000
    s_cbranch_scc1 g_47L3_1
    s_mov_b32 s25, 200000
    s_branch gc_48
g_47F3_1:
    s_mov_b64 exec, vcc
    buffer_load_dwordx4 v[28:31], v2, s[4:7], s16 offen offset:1024 sc1
    s_mov_b64 exec, -1
    s_add_u32 s23, s23, 1
    s_cmp_lt_u32 s23, 200000
    s_cbranch_scc1 g_47L3_0
    s_mov_b32 s25, 200000
    s_branch gc_48
g_47F5_0:
    s_mov_b64 exec, vcc
    buffer_load_dwordx4 v[24:27], v2, s[4:7], s16 offen offset:0 sc1
    s_mov_b64 exec, -1
    s_add_u32 s23, s23, 1
    s_cmp_lt_u32 s23, 200000
    s_cbranch_scc1 g_47L5_2
    s_mov_b32 s25, 200000
    s_branch gc_48
g_47F5_2:
    s_mov_b64 exec, vcc
    buffer_load_dwordx4 v[32:35], v2, s[4:7], s16 offen offset:2048 sc1
    s_mov_b64 exec, -1
    s_add_u32 s23, s23, 1
    s_cmp_lt_u32 s23, 200000
    s_cbranch_scc1 g_47L5_0
    s_mov_b32 s25, 200000
    s_branch gc_48
g_47F6_1:
    s_mov_b64 exec, vcc
    buffer_load_dwordx4 v[28:31], v2, s[4:7], s16 offen offset:1024 sc1
    s_mov_b64 exec, -1
    s_add_u32 s23, s23, 1
    s_cmp_lt_u32 s23, 200000
    s_cbranch_scc1 g_47L6_2
    s_mov_b32 s25, 200000
    s_branch gc_48
g_47F6_2:
    s_mov_b64 exec, vcc
    buffer_load_dwordx4 v[32:35], v2, s[4:7], s16 offen offset:2048 sc1
    s_mov_b64 exec, -1
    s_add_u32 s23, s23, 1
    s_cmp_lt_u32 s23, 200000
    s_cbranch_scc1 g_47L6_1
    s_mov_b32 s25, 200000
    s_branch gc_48
g_47F9_0:
    s_mov_b64 exec, vcc
    buffer_load_dwordx4 v[24:27], v2, s[4:7], s16 offen offset:0 sc1
    s_mov_b64 exec, -1
    s_add_u32 s23, s23, 1
    s_cmp_lt_u32 s23, 200000
    s_cbranch_scc1 g_47L9_3
    s_mov_b32 s25, 200000
    s_branch gc_48
g_47F9_3:
    s_mov_b64 exec, vcc
    buffer_load_dwordx4 v[36:39], v2, s[4:7], s16 offen offset:3072 sc1
    s_mov_b64 exec, -1
    s_add_u32 s23, s23, 1
    s_cmp_lt_u32 s23, 200000
    s_cbranch_scc1 g_47L9_0
    s_mov_b32 s25, 200000
    s_branch gc_48
g_47F10_1:
    s_mov_b64 exec, vcc
    buffer_load_dwordx4 v[28:31], v2, s[4:7], s16 offen offset:1024 sc1
    s_mov_b64 exec, -1
    s_add_u32 s23, s23, 1
    s_cmp_lt_u32 s23, 200000
    s_cbranch_scc1 g_47L10_3
    s_mov_b32 s25, 200000
    s_branch gc_48
g_47F10_3:
    s_mov_b64 exec, vcc
    buffer_load_dwordx4 v[36:39], v2, s[4:7], s16 offen offset:3072 sc1
    s_mov_b64 exec, -1
    s_add_u32 s23, s23, 1
    s_cmp_lt_u32 s23, 200000
    s_cbranch_scc1 g_47L10_1
    s_mov_b32 s25, 200000
    s_branch gc_48
g_47F12_2:
    s_mov_b64 exec, vcc
    buffer_load_dwordx4 v[32:35], v2, s[4:7], s16 offen offset:2048 sc1
    s_mov_b64 exec, -1
    s_add_u32 s23, s23, 1
    s_cmp_lt_u32 s23, 200000
    s_cbranch_scc1 g_47L12_3
    s_mov_b32 s25, 200000
    s_branch gc_48
g_47F12_3:
    s_mov_b64 exec, vcc
    buffer_load_dwordx4 v[36:39], v2, s[4:7], s16 offen offset:3072 sc1
    s_mov_b64 exec, -1
    s_add_u32 s23, s23, 1
    s_cmp_lt_u32 s23, 200000
    s_cbranch_scc1 g_47L12_2
    s_mov_b32 s25, 200000
    s_branch gc_48
g_47F1_0:
    s_mov_b64 exec, vcc
    buffer_load_dwordx4 v[24:27], v2, s[4:7], s16 offen offset:0 sc1
    s_mov_b64 exec, -1
    s_add_u32 s23, s23, 1
    s_cmp_lt_u32 s23, 200000
    s_cbranch_scc1 g_47L1_0
    s_mov_b32 s25, 200000
    s_branch gc_48
g_47F2_1:
    s_mov_b64 exec, vcc
    buffer_load_dwordx4 v[28:31], v2, s[4:7], s16 offen offset:1024 sc1
    s_mov_b64 exec, -1
    s_add_u32 s23, s23, 1
    s_cmp_lt_u32 s23, 200000
    s_cbranch_scc1 g_47L2_1
    s_mov_b32 s25, 200000
    s_branch gc_48
g_47F4_2:
    s_mov_b64 exec, vcc
    buffer_load_dwordx4 v[32:35], v2, s[4:7], s16 offen offset:2048 sc1
    s_mov_b64 exec, -1
    s_add_u32 s23, s23, 1
    s_cmp_lt_u32 s23, 200000
    s_cbranch_scc1 g_47L4_2
    s_mov_b32 s25, 200000
    s_branch gc_48
g_47F8_3:
    s_mov_b64 exec, vcc
    buffer_load_dwordx4 v[36:39], v2, s[4:7], s16 offen offset:3072 sc1
    s_mov_b64 exec, -1
    s_add_u32 s23, s23, 1
    s_cmp_lt_u32 s23, 200000
    s_cbranch_scc1 g_47L8_3
    s_mov_b32 s25, 200000
    s_branch gc_48
g_49L15_0:
    s_waitcnt vmcnt(3)
    v_max3_u32 v19, v24, v25, v26
    v_max_u32 v19, v19, v27
    v_cmp_eq_u32 vcc, -1, v19
    s_nop 0
    s_cbranch_vccnz g_49F15_0
    v_smfmac_f32_16x16x64_bf16 v[64:67], v[24:27], a[192:199], v172
    v_smfmac_f32_16x16x64_bf16 v[68:71], v[24:27], a[224:231], v172
g_49L14_1:
    s_waitcnt vmcnt(2)
    v_max3_u32 v19, v28, v29, v30
    v_max_u32 v19, v19, v31
    v_cmp_eq_u32 vcc, -1, v19
    s_nop 0
    s_cbranch_vccnz g_49F14_1
    v_smfmac_f32_16x16x64_bf16 v[64:67], v[28:31], a[200:207], v172
    v_smfmac_f32_16x16x64_bf16 v[68:71], v[28:31], a[232:239], v172
g_49L12_2:
    s_waitcnt vmcnt(1)
    v_max3_u32 v19, v32, v33, v34
    v_max_u32 v19, v19, v35
    v_cmp_eq_u32 vcc, -1, v19
    s_nop 0
    s_cbranch_vccnz g_49F12_2
    v_smfmac_f32_16x16x64_bf16 v[64:67], v[32:35], a[208:215], v172
    v_smfmac_f32_16x16x64_bf16 v[68:71], v[32:35], a[240:247], v172
g_49L8_3:
    s_waitcnt vmcnt(0)
    v_max3_u32 v19, v36, v37, v38
    v_max_u32 v19, v19, v39
    v_cmp_eq_u32 vcc, -1, v19
    s_nop 0
    s_cbranch_vccnz g_49F8_3
    v_smfmac_f32_16x16x64_bf16 v[64:67], v[36:39], a[216:223], v172
    v_smfmac_f32_16x16x64_bf16 v[68:71], v[36:39], a[248:255], v172
    s_nop 4
    v_cvt_pk_bf16_f32 v80, v64, v65
    v_cvt_pk_bf16_f32 v81, v66, v67
    s_nop 0
    v_cvt_pk_bf16_f32 v82, v68, v69
    v_cvt_pk_bf16_f32 v83, v70, v71
    s_nop 1
    v_mfma_f32_16x16x32_bf16 v[88:91], v[80:83], v[84:87], 0
    s_branch gc_50
g_49L15_1:
    s_waitcnt vmcnt(3)
    v_max3_u32 v19, v28, v29, v30
    v_max_u32 v19, v19, v31
    v_cmp_eq_u32 vcc, -1, v19
    s_nop 0
    s_cbranch_vccnz g_49F15_1
    v_smfmac_f32_16x16x64_bf16 v[64:67], v[28:31], a[200:207], v172
    v_smfmac_f32_16x16x64_bf16 v[68:71], v[28:31], a[232:239], v172
g_49L13_2:
    s_waitcnt vmcnt(2)
    v_max3_u32 v19, v32, v33, v34
    v_max_u32 v19, v19, v35
    v_cmp_eq_u32 vcc, -1, v19
    s_nop 0
    s_cbranch_vccnz g_49F13_2
    v_smfmac_f32_16x16x64_bf16 v[64:67], v[32:35], a[208:215], v172
    v_smfmac_f32_16x16x64_bf16 v[68:71], v[32:35], a[240:247], v172
g_49L9_3:
    s_waitcnt vmcnt(1)
    v_max3_u32 v19, v36, v37, v38
    v_max_u32 v19, v19, v39
    v_cmp_eq_u32 vcc, -1, v19
    s_nop 0
    s_cbranch_vccnz g_49F9_3
    v_smfmac_f32_16x16x64_bf16 v[64:67], v[36:39], a[216:223], v172
    v_smfmac_f32_16x16x64_bf16 v[68:71], v[36:39], a[248:255], v172
g_49L1_0:
    s_waitcnt vmcnt(0)
    v_max3_u32 v19, v24, v25, v26
    v_max_u32 v19, v19, v27
    v_cmp_eq_u32 vcc, -1, v19
    s_nop 0
    s_cbranch_vccnz g_49F1_0
    v_smfmac_f32_16x16x64_bf16 v[64:67], v[24:27], a[192:199], v172
    v_smfmac_f32_16x16x64_bf16 v[68:71], v[24:27], a[224:231], v172
    s_nop 4
    v_cvt_pk_bf16_f32 v80, v64, v65
    v_cvt_pk_bf16_f32 v81, v66, v67
    s_nop 0
    v_cvt_pk_bf16_f32 v82, v68, v69
    v_cvt_pk_bf16_f32 v83, v70, v71
    s_nop 1
    v_mfma_f32_16x16x32_bf16 v[88:91], v[80:83], v[84:87], 0
    s_branch gc_50
g_49L15_2:
    s_waitcnt vmcnt(3)
    v_max3_u32 v19, v32, v33, v34
    v_max_u32 v19, v19, v35
    v_cmp_eq_u32 vcc, -1, v19
    s_nop 0
    s_cbranch_vccnz g_49F15_2
    v_smfmac_f32_16x16x64_bf16 v[64:67], v[32:35], a[208:215], v172
    v_smfmac_f32_16x16x64_bf16 v[68:71], v[32:35], a[240:247], v172
g_49L11_3:
    s_waitcnt vmcnt(2)
    v_max3_u32 v19, v36, v37, v38
    v_max_u32 v19, v19, v39
    v_cmp_eq_u32 vcc, -1, v19
    s_nop 0
    s_cbranch_vccnz g_49F11_3
    v_smfmac_f32_16x16x64_bf16 v[64:67], v[36:39], a[216:223], v172
    v_smfmac_f32_16x16x64_bf16 v[68:71], v[36:39], a[248:255], v172
g_49L3_0:
    s_waitcnt vmcnt(1)
    v_max3_u32 v19, v24, v25, v26
    v_max_u32 v19, v19, v27
    v_cmp_eq_u32 vcc, -1, v19
    s_nop 0
    s_cbranch_vccnz g_49F3_0
    v_smfmac_f32_16x16x64_bf16 v[64:67], v[24:27], a[192:199], v172
    v_smfmac_f32_16x16x64_bf16 v[68:71], v[24:27], a[224:231], v172
g_49L2_1:
    s_waitcnt vmcnt(0)
    v_max3_u32 v19, v28, v29, v30
    v_max_u32 v19, v19, v31
    v_cmp_eq_u32 vcc, -1, v19
    s_nop 0
    s_cbranch_vccnz g_49F2_1
    v_smfmac_f32_16x16x64_bf16 v[64:67], v[28:31], a[200:207], v172
    v_smfmac_f32_16x16x64_bf16 v[68:71], v[28:31], a[232:239], v172
    s_nop 4
    v_cvt_pk_bf16_f32 v80, v64, v65
    v_cvt_pk_bf16_f32 v81, v66, v67
    s_nop 0
    v_cvt_pk_bf16_f32 v82, v68, v69
    v_cvt_pk_bf16_f32 v83, v70, v71
    s_nop 1
    v_mfma_f32_16x16x32_bf16 v[88:91], v[80:83], v[84:87], 0
    s_branch gc_50
g_49L15_3:
    s_waitcnt vmcnt(3)
    v_max3_u32 v19, v36, v37, v38
    v_max_u32 v19, v19, v39
    v_cmp_eq_u32 vcc, -1, v19
    s_nop 0
    s_cbranch_vccnz g_49F15_3
    v_smfmac_f32_16x16x64_bf16 v[64:67], v[36:39], a[216:223], v172
    v_smfmac_f32_16x16x64_bf16 v[68:71], v[36:39], a[248:255], v172
g_49L7_0:
    s_waitcnt vmcnt(2)
    v_max3_u32 v19, v24, v25, v26
    v_max_u32 v19, v19, v27
    v_cmp_eq_u32 vcc, -1, v19
    s_nop 0
    s_cbranch_vccnz g_49F7_0
    v_smfmac_f32_16x16x64_bf16 v[64:67], v[24:27], a[192:199], v172
    v_smfmac_f32_16x16x64_bf16 v[68:71], v[24:27], a[224:231], v172
g_49L6_1:
    s_waitcnt vmcnt(1)
    v_max3_u32 v19, v28, v29, v30
    v_max_u32 v19, v19, v31
    v_cmp_eq_u32 vcc, -1, v19
    s_nop 0
    s_cbranch_vccnz g_49F6_1
    v_smfmac_f32_16x16x64_bf16 v[64:67], v[28:31], a[200:207], v172
    v_smfmac_f32_16x16x64_bf16 v[68:71], v[28:31], a[232:239], v172
g_49L4_2:
    s_waitcnt vmcnt(0)
    v_max3_u32 v19, v32, v33, v34
    v_max_u32 v19, v19, v35
    v_cmp_eq_u32 vcc, -1, v19
    s_nop 0
    s_cbranch_vccnz g_49F4_2
    v_smfmac_f32_16x16x64_bf16 v[64:67], v[32:35], a[208:215], v172
    v_smfmac_f32_16x16x64_bf16 v[68:71], v[32:35], a[240:247], v172
    s_nop 4
    v_cvt_pk_bf16_f32 v80, v64, v65
    v_cvt_pk_bf16_f32 v81, v66, v67
    s_nop 0
    v_cvt_pk_bf16_f32 v82, v68, v69
    v_cvt_pk_bf16_f32 v83, v70, v71
    s_nop 1
    v_mfma_f32_16x16x32_bf16 v[88:91], v[80:83], v[84:87], 0
    s_branch gc_50
g_49L7_1:
    s_waitcnt vmcnt(2)
    v_max3_u32 v19, v28, v29, v30
    v_max_u32 v19, v19, v31
    v_cmp_eq_u32 vcc, -1, v19
    s_nop 0
    s_cbranch_vccnz g_49F7_1
    v_smfmac_f32_16x16x64_bf16 v[64:67], v[28:31], a[200:207], v172
    v_smfmac_f32_16x16x64_bf16 v[68:71], v[28:31], a[232:239], v172
g_49L5_2:
    s_waitcnt vmcnt(1)
    v_max3_u32 v19, v32, v33, v34
    v_max_u32 v19, v19, v35
    v_cmp_eq_u32 vcc, -1, v19
    s_nop 0
    s_cbranch_vccnz g_49F5_2
    v_smfmac_f32_16x16x64_bf16 v[64:67], v[32:35], a[208:215], v172
    v_smfmac_f32_16x16x64_bf16 v[68:71], v[32:35], a[240:247], v172
    s_branch g_49L1_0
g_49L7_2:
    s_waitcnt vmcnt(2)
    v_max3_u32 v19, v32, v33, v34
    v_max_u32 v19, v19, v35
    v_cmp_eq_u32 vcc, -1, v19
    s_nop 0
    s_cbranch_vccnz g_49F7_2
    v_smfmac_f32_16x16x64_bf16 v[64:67], v[32:35], a[208:215], v172
    v_smfmac_f32_16x16x64_bf16 v[68:71], v[32:35], a[240:247], v172
    s_branch g_49L3_0
g_49L11_0:
    s_waitcnt vmcnt(2)
    v_max3_u32 v19, v24, v25, v26
    v_max_u32 v19, v19, v27
    v_cmp_eq_u32 vcc, -1, v19
    s_nop 0
    s_cbranch_vccnz g_49F11_0
    v_smfmac_f32_16x16x64_bf16 v[64:67], v[24:27], a[192:199], v172
    v_smfmac_f32_16x16x64_bf16 v[68:71], v[24:27], a[224:231], v172
g_49L10_1:
    s_waitcnt vmcnt(1)
    v_max3_u32 v19, v28, v29, v30
    v_max_u32 v19, v19, v31
    v_cmp_eq_u32 vcc, -1, v19
    s_nop 0
    s_cbranch_vccnz g_49F10_1
    v_smfmac_f32_16x16x64_bf16 v[64:67], v[28:31], a[200:207], v172
    v_smfmac_f32_16x16x64_bf16 v[68:71], v[28:31], a[232:239], v172
    s_branch g_49L8_3
g_49L11_1:
    s_waitcnt vmcnt(2)
    v_max3_u32 v19, v28, v29, v30
    v_max_u32 v19, v19, v31
    v_cmp_eq_u32 vcc, -1, v19
    s_nop 0
    s_cbranch_vccnz g_49F11_1
    v_smfmac_f32_16x16x64_bf16 v[64:67], v[28:31], a[200:207], v172
    v_smfmac_f32_16x16x64_bf16 v[68:71], v[28:31], a[232:239], v172
    s_branch g_49L9_3
g_49L13_0:
    s_waitcnt vmcnt(2)
    v_max3_u32 v19, v24, v25, v26
    v_max_u32 v19, v19, v27
    v_cmp_eq_u32 vcc, -1, v19
    s_nop 0
    s_cbranch_vccnz g_49F13_0
    v_smfmac_f32_16x16x64_bf16 v[64:67], v[24:27], a[192:199], v172
    v_smfmac_f32_16x16x64_bf16 v[68:71], v[24:27], a[224:231], v172
    s_branch g_49L12_2
g_49L13_3:
    s_waitcnt vmcnt(2)
    v_max3_u32 v19, v36, v37, v38
    v_max_u32 v19, v19, v39
    v_cmp_eq_u32 vcc, -1, v19
    s_nop 0
    s_cbranch_vccnz g_49F13_3
    v_smfmac_f32_16x16x64_bf16 v[64:67], v[36:39], a[216:223], v172
    v_smfmac_f32_16x16x64_bf16 v[68:71], v[36:39], a[248:255], v172
g_49L5_0:
    s_waitcnt vmcnt(1)
    v_max3_u32 v19, v24, v25, v26
    v_max_u32 v19, v19, v27
    v_cmp_eq_u32 vcc, -1, v19
    s_nop 0
    s_cbranch_vccnz g_49F5_0
    v_smfmac_f32_16x16x64_bf16 v[64:67], v[24:27], a[192:199], v172
    v_smfmac_f32_16x16x64_bf16 v[68:71], v[24:27], a[224:231], v172
    s_branch g_49L4_2
g_49L14_2:
    s_waitcnt vmcnt(2)
    v_max3_u32 v19, v32, v33, v34
    v_max_u32 v19, v19, v35
    v_cmp_eq_u32 vcc, -1, v19
    s_nop 0
    s_cbranch_vccnz g_49F14_2
    v_smfmac_f32_16x16x64_bf16 v[64:67], v[32:35], a[208:215], v172
    v_smfmac_f32_16x16x64_bf16 v[68:71], v[32:35], a[240:247], v172
g_49L10_3:
    s_waitcnt vmcnt(1)
    v_max3_u32 v19, v36, v37, v38
    v_max_u32 v19, v19, v39
    v_cmp_eq_u32 vcc, -1, v19
    s_nop 0
    s_cbranch_vccnz g_49F10_3
    v_smfmac_f32_16x16x64_bf16 v[64:67], v[36:39], a[216:223], v172
    v_smfmac_f32_16x16x64_bf16 v[68:71], v[36:39], a[248:255], v172
    s_branch g_49L2_1
g_49L14_3:
    s_waitcnt vmcnt(2)
    v_max3_u32 v19, v36, v37, v38
    v_max_u32 v19, v19, v39
    v_cmp_eq_u32 vcc, -1, v19
    s_nop 0
    s_cbranch_vccnz g_49F14_3
    v_smfmac_f32_16x16x64_bf16 v[64:67], v[36:39], a[216:223], v172
    v_smfmac_f32_16x16x64_bf16 v[68:71], v[36:39], a[248:255], v172
    s_branch g_49L6_1
g_49L3_1:
    s_waitcnt vmcnt(1)
    v_max3_u32 v19, v28, v29, v30
    v_max_u32 v19, v19, v31
    v_cmp_eq_u32 vcc, -1, v19
    s_nop 0
    s_cbranch_vccnz g_49F3_1
    v_smfmac_f32_16x16x64_bf16 v[64:67], v[28:31], a[200:207], v172
    v_smfmac_f32_16x16x64_bf16 v[68:71], v[28:31], a[232:239], v172
    s_branch g_49L1_0
g_49L6_2:
    s_waitcnt vmcnt(1)
    v_max3_u32 v19, v32, v33, v34
    v_max_u32 v19, v19, v35
    v_cmp_eq_u32 vcc, -1, v19
    s_nop 0
    s_cbranch_vccnz g_49F6_2
    v_smfmac_f32_16x16x64_bf16 v[64:67], v[32:35], a[208:215], v172
    v_smfmac_f32_16x16x64_bf16 v[68:71], v[32:35], a[240:247], v172
    s_branch g_49L2_1
g_49L9_0:
    s_waitcnt vmcnt(1)
    v_max3_u32 v19, v24, v25, v26
    v_max_u32 v19, v19, v27
    v_cmp_eq_u32 vcc, -1, v19
    s_nop 0
    s_cbranch_vccnz g_49F9_0
    v_smfmac_f32_16x16x64_bf16 v[64:67], v[24:27], a[192:199], v172
    v_smfmac_f32_16x16x64_bf16 v[68:71], v[24:27], a[224:231], v172
    s_branch g_49L8_3
g_49L12_3:
    s_waitcnt vmcnt(1)
    v_max3_u32 v19, v36, v37, v38
    v_max_u32 v19, v19, v39
    v_cmp_eq_u32 vcc, -1, v19
    s_nop 0
    s_cbranch_vccnz g_49F12_3
    v_smfmac_f32_16x16x64_bf16 v[64:67], v[36:39], a[216:223], v172
    v_smfmac_f32_16x16x64_bf16 v[68:71], v[36:39], a[248:255], v172
    s_branch g_49L4_2
g_49F15_0:
    s_mov_b64 exec, vcc
    buffer_load_dwordx4 v[24:27], v8, s[4:7], s16 offen offset:0 sc1
    s_mov_b64 exec, -1
    s_add_u32 s23, s23, 1
    s_cmp_lt_u32 s23, 200000
    s_cbranch_scc1 g_49L15_1
    s_mov_b32 s25, 200000
    s_branch gc_50
g_49F15_1:
    s_mov_b64 exec, vcc
    buffer_load_dwordx4 v[28:31], v8, s[4:7], s16 offen offset:1024 sc1
    s_mov_b64 exec, -1
    s_add_u32 s23, s23, 1
    s_cmp_lt_u32 s23, 200000
    s_cbranch_scc1 g_49L15_2
    s_mov_b32 s25, 200000
    s_branch gc_50
g_49F15_2:
    s_mov_b64 exec, vcc
    buffer_load_dwordx4 v[32:35], v8, s[4:7], s16 offen offset:2048 sc1
    s_mov_b64 exec, -1
    s_add_u32 s23, s23, 1
    s_cmp_lt_u32 s23, 200000
    s_cbranch_scc1 g_49L15_3
    s_mov_b32 s25, 200000
    s_branch gc_50
g_49F15_3:
    s_mov_b64 exec, vcc
    buffer_load_dwordx4 v[36:39], v8, s[4:7], s16 offen offset:3072 sc1
    s_mov_b64 exec, -1
    s_add_u32 s23, s23, 1
    s_cmp_lt_u32 s23, 200000
    s_cbranch_scc1 g_49L15_0
    s_mov_b32 s25, 200000
    s_branch gc_50
g_49F7_0:
    s_mov_b64 exec, vcc
    buffer_load_dwordx4 v[24:27], v8, s[4:7], s16 offen offset:0 sc1
    s_mov_b64 exec, -1
    s_add_u32 s23, s23, 1
    s_cmp_lt_u32 s23, 200000
    s_cbranch_scc1 g_49L7_1
    s_mov_b32 s25, 200000
    s_branch gc_50
g_49F7_1:
    s_mov_b64 exec, vcc
    buffer_load_dwordx4 v[28:31], v8, s[4:7], s16 offen offset:1024 sc1
    s_mov_b64 exec, -1
    s_add_u32 s23, s23, 1
    s_cmp_lt_u32 s23, 200000
    s_cbranch_scc1 g_49L7_2
    s_mov_b32 s25, 200000
    s_branch gc_50
g_49F7_2:
    s_mov_b64 exec, vcc
    buffer_load_dwordx4 v[32:35], v8, s[4:7], s16 offen offset:2048 sc1
    s_mov_b64 exec, -1
    s_add_u32 s23, s23, 1
    s_cmp_lt_u32 s23, 200000
    s_cbranch_scc1 g_49L7_0
    s_mov_b32 s25, 200000
    s_branch gc_50
g_49F11_0:
    s_mov_b64 exec, vcc
    buffer_load_dwordx4 v[24:27], v8, s[4:7], s16 offen offset:0 sc1
    s_mov_b64 exec, -1
    s_add_u32 s23, s23, 1
    s_cmp_lt_u32 s23, 200000
    s_cbranch_scc1 g_49L11_1
    s_mov_b32 s25, 200000
    s_branch gc_50
g_49F11_1:
    s_mov_b64 exec, vcc
    buffer_load_dwordx4 v[28:31], v8, s[4:7], s16 offen offset:1024 sc1
    s_mov_b64 exec, -1
    s_add_u32 s23, s23, 1
    s_cmp_lt_u32 s23, 200000
    s_cbranch_scc1 g_49L11_3
    s_mov_b32 s25, 200000
    s_branch gc_50
g_49F11_3:
    s_mov_b64 exec, vcc
    buffer_load_dwordx4 v[36:39], v8, s[4:7], s16 offen offset:3072 sc1
    s_mov_b64 exec, -1
    s_add_u32 s23, s23, 1
    s_cmp_lt_u32 s23, 200000
    s_cbranch_scc1 g_49L11_0
    s_mov_b32 s25, 200000
    s_branch gc_50
g_49F13_0:
    s_mov_b64 exec, vcc
    buffer_load_dwordx4 v[24:27], v8, s[4:7], s16 offen offset:0 sc1
    s_mov_b64 exec, -1
    s_add_u32 s23, s23, 1
    s_cmp_lt_u32 s23, 200000
    s_cbranch_scc1 g_49L13_2
    s_mov_b32 s25, 200000
    s_branch gc_50
g_49F13_2:
    s_mov_b64 exec, vcc
    buffer_load_dwordx4 v[32:35], v8, s[4:7], s16 offen offset:2048 sc1
    s_mov_b64 exec, -1
    s_add_u32 s23, s23, 1
    s_cmp_lt_u32 s23, 200000
    s_cbranch_scc1 g_49L13_3
    s_mov_b32 s25, 200000
    s_branch gc_50
g_49F13_3:
    s_mov_b64 exec, vcc
    buffer_load_dwordx4 v[36:39], v8, s[4:7], s16 offen offset:3072 sc1
    s_mov_b64 exec, -1
    s_add_u32 s23, s23, 1
    s_cmp_lt_u32 s23, 200000
    s_cbranch_scc1 g_49L13_0
    s_mov_b32 s25, 200000
    s_branch gc_50
g_49F14_1:
    s_mov_b64 exec, vcc
    buffer_load_dwordx4 v[28:31], v8, s[4:7], s16 offen offset:1024 sc1
    s_mov_b64 exec, -1
    s_add_u32 s23, s23, 1
    s_cmp_lt_u32 s23, 200000
    s_cbranch_scc1 g_49L14_2
    s_mov_b32 s25, 200000
    s_branch gc_50
g_49F14_2:
    s_mov_b64 exec, vcc
    buffer_load_dwordx4 v[32:35], v8, s[4:7], s16 offen offset:2048 sc1
    s_mov_b64 exec, -1
    s_add_u32 s23, s23, 1
    s_cmp_lt_u32 s23, 200000
    s_cbranch_scc1 g_49L14_3
    s_mov_b32 s25, 200000
    s_branch gc_50
g_49F14_3:
    s_mov_b64 exec, vcc
    buffer_load_dwordx4 v[36:39], v8, s[4:7], s16 offen offset:3072 sc1
    s_mov_b64 exec, -1
    s_add_u32 s23, s23, 1
    s_cmp_lt_u32 s23, 200000
    s_cbranch_scc1 g_49L14_1
    s_mov_b32 s25, 200000
    s_branch gc_50
g_49F3_0:
    s_mov_b64 exec, vcc
    buffer_load_dwordx4 v[24:27], v8, s[4:7], s16 offen offset:0 sc1
    s_mov_b64 exec, -1
    s_add_u32 s23, s23, 1
    s_cmp_lt_u32 s23, 200000
    s_cbranch_scc1 g_49L3_1
    s_mov_b32 s25, 200000
    s_branch gc_50
g_49F3_1:
    s_mov_b64 exec, vcc
    buffer_load_dwordx4 v[28:31], v8, s[4:7], s16 offen offset:1024 sc1
    s_mov_b64 exec, -1
    s_add_u32 s23, s23, 1
    s_cmp_lt_u32 s23, 200000
    s_cbranch_scc1 g_49L3_0
    s_mov_b32 s25, 200000
    s_branch gc_50
g_49F5_0:
    s_mov_b64 exec, vcc
    buffer_load_dwordx4 v[24:27], v8, s[4:7], s16 offen offset:0 sc1
    s_mov_b64 exec, -1
    s_add_u32 s23, s23, 1
    s_cmp_lt_u32 s23, 200000
    s_cbranch_scc1 g_49L5_2
    s_mov_b32 s25, 200000
    s_branch gc_50
g_49F5_2:
    s_mov_b64 exec, vcc
    buffer_load_dwordx4 v[32:35], v8, s[4:7], s16 offen offset:2048 sc1
    s_mov_b64 exec, -1
    s_add_u32 s23, s23, 1
    s_cmp_lt_u32 s23, 200000
    s_cbranch_scc1 g_49L5_0
    s_mov_b32 s25, 200000
    s_branch gc_50
g_49F6_1:
    s_mov_b64 exec, vcc
    buffer_load_dwordx4 v[28:31], v8, s[4:7], s16 offen offset:1024 sc1
    s_mov_b64 exec, -1
    s_add_u32 s23, s23, 1
    s_cmp_lt_u32 s23, 200000
    s_cbranch_scc1 g_49L6_2
    s_mov_b32 s25, 200000
    s_branch gc_50
g_49F6_2:
    s_mov_b64 exec, vcc
    buffer_load_dwordx4 v[32:35], v8, s[4:7], s16 offen offset:2048 sc1
    s_mov_b64 exec, -1
    s_add_u32 s23, s23, 1
    s_cmp_lt_u32 s23, 200000
    s_cbranch_scc1 g_49L6_1
    s_mov_b32 s25, 200000
    s_branch gc_50
g_49F9_0:
    s_mov_b64 exec, vcc
    buffer_load_dwordx4 v[24:27], v8, s[4:7], s16 offen offset:0 sc1
    s_mov_b64 exec, -1
    s_add_u32 s23, s23, 1
    s_cmp_lt_u32 s23, 200000
    s_cbranch_scc1 g_49L9_3
    s_mov_b32 s25, 200000
    s_branch gc_50
g_49F9_3:
    s_mov_b64 exec, vcc
    buffer_load_dwordx4 v[36:39], v8, s[4:7], s16 offen offset:3072 sc1
    s_mov_b64 exec, -1
    s_add_u32 s23, s23, 1
    s_cmp_lt_u32 s23, 200000
    s_cbranch_scc1 g_49L9_0
    s_mov_b32 s25, 200000
    s_branch gc_50
g_49F10_1:
    s_mov_b64 exec, vcc
    buffer_load_dwordx4 v[28:31], v8, s[4:7], s16 offen offset:1024 sc1
    s_mov_b64 exec, -1
    s_add_u32 s23, s23, 1
    s_cmp_lt_u32 s23, 200000
    s_cbranch_scc1 g_49L10_3
    s_mov_b32 s25, 200000
    s_branch gc_50
g_49F10_3:
    s_mov_b64 exec, vcc
    buffer_load_dwordx4 v[36:39], v8, s[4:7], s16 offen offset:3072 sc1
    s_mov_b64 exec, -1
    s_add_u32 s23, s23, 1
    s_cmp_lt_u32 s23, 200000
    s_cbranch_scc1 g_49L10_1
    s_mov_b32 s25, 200000
    s_branch gc_50
g_49F12_2:
    s_mov_b64 exec, vcc
    buffer_load_dwordx4 v[32:35], v8, s[4:7], s16 offen offset:2048 sc1
    s_mov_b64 exec, -1
    s_add_u32 s23, s23, 1
    s_cmp_lt_u32 s23, 200000
    s_cbranch_scc1 g_49L12_3
    s_mov_b32 s25, 200000
    s_branch gc_50
g_49F12_3:
    s_mov_b64 exec, vcc
    buffer_load_dwordx4 v[36:39], v8, s[4:7], s16 offen offset:3072 sc1
    s_mov_b64 exec, -1
    s_add_u32 s23, s23, 1
    s_cmp_lt_u32 s23, 200000
    s_cbranch_scc1 g_49L12_2
    s_mov_b32 s25, 200000
    s_branch gc_50
g_49F1_0:
    s_mov_b64 exec, vcc
    buffer_load_dwordx4 v[24:27], v8, s[4:7], s16 offen offset:0 sc1
    s_mov_b64 exec, -1
    s_add_u32 s23, s23, 1
    s_cmp_lt_u32 s23, 200000
    s_cbranch_scc1 g_49L1_0
    s_mov_b32 s25, 200000
    s_branch gc_50
g_49F2_1:
    s_mov_b64 exec, vcc
    buffer_load_dwordx4 v[28:31], v8, s[4:7], s16 offen offset:1024 sc1
    s_mov_b64 exec, -1
    s_add_u32 s23, s23, 1
    s_cmp_lt_u32 s23, 200000
    s_cbranch_scc1 g_49L2_1
    s_mov_b32 s25, 200000
    s_branch gc_50
g_49F4_2:
    s_mov_b64 exec, vcc
    buffer_load_dwordx4 v[32:35], v8, s[4:7], s16 offen offset:2048 sc1
    s_mov_b64 exec, -1
    s_add_u32 s23, s23, 1
    s_cmp_lt_u32 s23, 200000
    s_cbranch_scc1 g_49L4_2
    s_mov_b32 s25, 200000
    s_branch gc_50
g_49F8_3:
    s_mov_b64 exec, vcc
    buffer_load_dwordx4 v[36:39], v8, s[4:7], s16 offen offset:3072 sc1
    s_mov_b64 exec, -1
    s_add_u32 s23, s23, 1
    s_cmp_lt_u32 s23, 200000
    s_cbranch_scc1 g_49L8_3
    s_mov_b32 s25, 200000
    s_branch gc_50
pr_51:
    v_max3_u32 v19, v96, v97, v98
    v_max3_u32 v19, v19, v99, v100
    v_max3_u32 v19, v19, v101, v102
    v_max3_u32 v19, v19, v103, v104
    v_max3_u32 v19, v19, v105, v106
    v_max_u32 v19, v19, v107
    v_cmp_eq_u32 vcc, -1, v19
    s_nop 0
    s_cbranch_vccz pf_55
    buffer_load_dwordx4 v[96:99], v10, s[4:7], s84 offen sc1
    buffer_load_dwordx4 v[100:103], v23, s[4:7], s84 offen sc1
    buffer_load_dwordx4 v[104:107], v244, s[4:7], s84 offen sc1
    s_add_u32 s23, s23, 1
    s_cmp_lt_u32 s23, 200000
    s_cbranch_scc1 pb_53
    s_mov_b32 s25, 200000
pf_55:
    buffer_store_dwordx2 v[180:181], v11, s[4:7], s42 offen
    s_branch pg_52
.p2align 6
recur_slow_w0:
    s_nop 15
    s_mov_b32 s23, s25
g_56:
    buffer_load_dwordx4 v[24:27], v2, s[4:7], s16 offen offset:0 sc1
    buffer_load_dwordx4 v[28:31], v2, s[4:7], s16 offen offset:1024 sc1
    buffer_load_dwordx4 v[32:35], v2, s[4:7], s16 offen offset:2048 sc1
    buffer_load_dwordx4 v[36:39], v2, s[4:7], s16 offen offset:3072 sc1
    s_waitcnt vmcnt(0)
    v_max3_u32 v19, v24, v25, v26
    v_max3_u32 v19, v19, v27, v28
    v_max3_u32 v19, v19, v29, v30
    v_max3_u32 v19, v19, v31, v32
    v_max3_u32 v19, v19, v33, v34
    v_max3_u32 v19, v19, v35, v36
    v_max3_u32 v19, v19, v37, v38
    v_max_u32 v19, v19, v39
    v_cmp_eq_u32 vcc, -1, v19
    s_nop 0
    s_cbranch_vccz g_56k
    s_add_u32 s23, s23, 1
    s_cmp_lt_u32 s23, 200000
    s_cbranch_scc1 g_56
    s_mov_b32 s25, 200000
g_56k:
    v_smfmac_f32_16x16x64_bf16 v[40:43], v[24:27], a[0:7], v172
    v_smfmac_f32_16x16x64_bf16 v[44:47], v[24:27], a[64:71], v172
    v_smfmac_f32_16x16x64_bf16 v[48:51], v[24:27], a[32:39], v172
    v_smfmac_f32_16x16x64_bf16 v[52:55], v[24:27], a[96:103], v172
    v_smfmac_f32_16x16x64_bf16 v[40:43], v[28:31], a[8:15], v172
    v_smfmac_f32_16x16x64_bf16 v[44:47], v[28:31], a[72:79], v172
    v_smfmac_f32_16x16x64_bf16 v[48:51], v[28:31], a[40:47], v172
    v_smfmac_f32_16x16x64_bf16 v[52:55], v[28:31], a[104:111], v172
    v_smfmac_f32_16x16x64_bf16 v[40:43], v[32:35], a[16:23], v172
    v_smfmac_f32_16x16x64_bf16 v[44:47], v[32:35], a[80:87], v172
    v_smfmac_f32_16x16x64_bf16 v[48:51], v[32:35], a[48:55], v172
    v_smfmac_f32_16x16x64_bf16 v[52:55], v[32:35], a[112:119], v172
    v_smfmac_f32_16x16x64_bf16 v[40:43], v[36:39], a[24:31], v172
    v_smfmac_f32_16x16x64_bf16 v[44:47], v[36:39], a[88:95], v172
    v_smfmac_f32_16x16x64_bf16 v[48:51], v[36:39], a[56:63], v172
    v_smfmac_f32_16x16x64_bf16 v[52:55], v[36:39], a[120:127], v172
    v_cvt_pk_bf16_f32 v72, v40, v41
    v_cvt_pk_bf16_f32 v73, v42, v43
    v_cvt_pk_bf16_f32 v74, v44, v45
    v_cvt_pk_bf16_f32 v75, v46, v47
    v_smfmac_f32_16x16x64_bf16 v[56:59], v[24:27], a[128:135], v172
    v_cvt_pk_bf16_f32 v76, v48, v49
    v_cvt_pk_bf16_f32 v77, v50, v51
    s_nop 0
    v_cvt_pk_bf16_f32 v78, v52, v53
    v_cvt_pk_bf16_f32 v79, v54, v55
    v_smfmac_f32_16x16x64_bf16 v[60:63], v[24:27], a[160:167], v172
    v_mfma_f32_16x16x32_bf16 v[88:91], v[72:75], v[84:87], 0
    v_mfma_f32_16x16x32_bf16 v[92:95], v[76:79], v[84:87], 0
    v_smfmac_f32_16x16x64_bf16 v[56:59], v[28:31], a[136:143], v172
    v_smfmac_f32_16x16x64_bf16 v[60:63], v[28:31], a[168:175], v172
    s_barrier
    ds_read_b128 v[104:107], v16 offset:2048
    ds_read_b128 v[108:111], v16 offset:3072
    ds_read_b128 v[112:115], v16 offset:4096
    ds_read_b128 v[116:119], v16 offset:5120
    ds_read_b128 v[120:123], v16 offset:6144
    ds_read_b128 v[124:127], v16 offset:7168
    v_smfmac_f32_16x16x64_bf16 v[56:59], v[32:35], a[144:151], v172
    v_smfmac_f32_16x16x64_bf16 v[60:63], v[32:35], a[176:183], v172
    v_smfmac_f32_16x16x64_bf16 v[56:59], v[36:39], a[152:159], v172
    v_smfmac_f32_16x16x64_bf16 v[60:63], v[36:39], a[184:191], v172
    s_waitcnt lgkmcnt(5)
    v_mfma_f32_16x16x32_bf16 v[88:91], v[104:107], v[84:87], v[88:91]
    s_waitcnt lgkmcnt(4)
    v_mfma_f32_16x16x32_bf16 v[92:95], v[108:111], v[84:87], v[92:95]
    s_waitcnt lgkmcnt(3)
    v_mfma_f32_16x16x32_bf16 v[88:91], v[112:115], v[84:87], v[88:91]
    s_waitcnt lgkmcnt(2)
    v_mfma_f32_16x16x32_bf16 v[92:95], v[116:119], v[84:87], v[92:95]
    s_waitcnt lgkmcnt(1)
    v_mfma_f32_16x16x32_bf16 v[88:91], v[120:123], v[84:87], v[88:91]
    s_waitcnt lgkmcnt(0)
    v_mfma_f32_16x16x32_bf16 v[92:95], v[124:127], v[84:87], v[92:95]
    v_cvt_pk_bf16_f32 v80, v56, v57
    v_cvt_pk_bf16_f32 v81, v58, v59
    v_cvt_pk_bf16_f32 v82, v60, v61
    v_cvt_pk_bf16_f32 v83, v62, v63
    ds_write_b128 v17, v[80:83] offset:8192
    s_nop 0
    v_cvt_pk_bf16_f32 v128, v88, v89
    v_cvt_pk_bf16_f32 v129, v90, v91
    v_cvt_pk_bf16_f32 v130, v92, v93
    v_cvt_pk_bf16_f32 v131, v94, v95
    s_nop 1
    v_mfma_f32_16x16x32_bf16 v[144:147], v[132:135], v[128:131], 0
    v_mfma_f32_16x16x32_bf16 v[148:151], v[136:139], v[128:131], 0
    v_mfma_f32_16x16x32_bf16 v[140:143], v[128:131], v[128:131], 0
    s_nop 1
    buffer_store_dwordx4 v[144:147], v3, s[4:7], s16 offen sc1
    s_nop 1
    buffer_store_dwordx4 v[148:151], v3, s[4:7], s16 offen offset:128 sc1
    s_nop 1
    buffer_store_dwordx4 v[140:143], v4, s[4:7], s16 offen sc1
    s_cmp_eq_u32 s15, 63
    s_waitcnt lgkmcnt(0)
    s_barrier
    s_cbranch_scc1 recur_slow_last0
    v_readfirstlane_b32 s85, v247
    s_add_u32 s94, s15, 2
    s_barrier
    s_nop 15
    s_mov_b32 s23, s25
g_57:
    buffer_load_dwordx4 v[24:27], v8, s[4:7], s16 offen offset:0 sc1
    buffer_load_dwordx4 v[28:31], v8, s[4:7], s16 offen offset:1024 sc1
    buffer_load_dwordx4 v[32:35], v8, s[4:7], s16 offen offset:2048 sc1
    buffer_load_dwordx4 v[36:39], v8, s[4:7], s16 offen offset:3072 sc1
    s_waitcnt vmcnt(0)
    v_max3_u32 v19, v24, v25, v26
    v_max3_u32 v19, v19, v27, v28
    v_max3_u32 v19, v19, v29, v30
    v_max3_u32 v19, v19, v31, v32
    v_max3_u32 v19, v19, v33, v34
    v_max3_u32 v19, v19, v35, v36
    v_max3_u32 v19, v19, v37, v38
    v_max_u32 v19, v19, v39
    v_cmp_eq_u32 vcc, -1, v19
    s_nop 0
    s_cbranch_vccz g_57k
    s_add_u32 s23, s23, 1
    s_cmp_lt_u32 s23, 200000
    s_cbranch_scc1 g_57
    s_mov_b32 s25, 200000
g_57k:
    v_smfmac_f32_16x16x64_bf16 v[64:67], v[24:27], a[192:199], v172
    v_smfmac_f32_16x16x64_bf16 v[68:71], v[24:27], a[224:231], v172
    v_smfmac_f32_16x16x64_bf16 v[64:67], v[28:31], a[200:207], v172
    v_smfmac_f32_16x16x64_bf16 v[68:71], v[28:31], a[232:239], v172
    v_smfmac_f32_16x16x64_bf16 v[64:67], v[32:35], a[208:215], v172
    v_smfmac_f32_16x16x64_bf16 v[68:71], v[32:35], a[240:247], v172
    v_smfmac_f32_16x16x64_bf16 v[64:67], v[36:39], a[216:223], v172
    v_smfmac_f32_16x16x64_bf16 v[68:71], v[36:39], a[248:255], v172
    s_nop 4
    v_cvt_pk_bf16_f32 v80, v64, v65
    v_cvt_pk_bf16_f32 v81, v66, v67
    s_nop 0
    v_cvt_pk_bf16_f32 v82, v68, v69
    v_cvt_pk_bf16_f32 v83, v70, v71
    ds_write_b128 v17, v[80:83] offset:9216
    s_waitcnt lgkmcnt(0)
    s_barrier
    s_nop 15
    s_nop 15
    s_nop 15
    s_nop 15
    buffer_store_dwordx4 v[128:131], v14, s[4:7], s19 offen sc1
    s_add_u32 s19, s19, 512
    s_mov_b32 s23, s25
fw_58:
    s_cmp_ge_u32 s85, s94
    s_cbranch_scc1 fo_59
    buffer_load_dword v247, v245, s[4:7], 0 offen sc1
    s_add_u32 s23, s23, 1
    s_waitcnt vmcnt(0)
    v_readfirstlane_b32 s85, v247
    s_cmp_lt_u32 s23, 200000
    s_cbranch_scc1 fw_58
    s_mov_b32 s25, 200000
fo_59:
    buffer_load_dwordx4 v[132:135], v12, s[4:7], s17 offen sc1
    buffer_load_dwordx4 v[136:139], v12, s[4:7], s17 offen offset:256 sc1
    s_add_u32 s17, s17, 2048
    s_min_u32 s17, s17, 17954816
    buffer_load_dword v247, v245, s[4:7], 0 offen sc1
    v_mov_b32 v40, 0
    v_mov_b32 v41, 0
    v_mov_b32 v42, 0
    v_mov_b32 v43, 0
    v_mov_b32 v44, 0
    v_mov_b32 v45, 0
    v_mov_b32 v46, 0
    v_mov_b32 v47, 0
    v_mov_b32 v48, 0
    v_mov_b32 v49, 0
    v_mov_b32 v50, 0
    v_mov_b32 v51, 0
    v_mov_b32 v52, 0
    v_mov_b32 v53, 0
    v_mov_b32 v54, 0
    v_mov_b32 v55, 0
    v_mov_b32 v56, 0
    v_mov_b32 v57, 0
    v_mov_b32 v58, 0
    v_mov_b32 v59, 0
    v_mov_b32 v60, 0
    v_mov_b32 v61, 0
    v_mov_b32 v62, 0
    v_mov_b32 v63, 0
    v_mov_b32 v64, 0
    v_mov_b32 v65, 0
    v_mov_b32 v66, 0
    v_mov_b32 v67, 0
    v_mov_b32 v68, 0
    v_mov_b32 v69, 0
    v_mov_b32 v70, 0
    v_mov_b32 v71, 0
    s_mov_b32 s21, s16
    s_mov_b32 s16, s42
    s_mov_b32 s42, s43
    s_mov_b32 s43, s44
    s_mov_b32 s44, s21
    s_add_u32 s95, s95, 524288
    s_lshr_b32 s84, s95, 8
    s_and_b32 s84, s84, 8192
    s_xor_b32 s84, s84, s46
    s_add_u32 s84, s84, s95
    s_add_u32 s15, s15, 1
    s_barrier
    s_branch recur_slow_w0
recur_slow_last0:
    buffer_store_dwordx4 v[128:131], v14, s[4:7], s19 offen sc1
    s_waitcnt vmcnt(0)
    s_branch recur_end
.p2align 6
recur_slow_w1:
    s_nop 15
    s_mov_b32 s23, s25
g_60:
    buffer_load_dwordx4 v[24:27], v2, s[4:7], s16 offen offset:0 sc1
    buffer_load_dwordx4 v[28:31], v2, s[4:7], s16 offen offset:1024 sc1
    buffer_load_dwordx4 v[32:35], v2, s[4:7], s16 offen offset:2048 sc1
    buffer_load_dwordx4 v[36:39], v2, s[4:7], s16 offen offset:3072 sc1
    s_waitcnt vmcnt(0)
    v_max3_u32 v19, v24, v25, v26
    v_max3_u32 v19, v19, v27, v28
    v_max3_u32 v19, v19, v29, v30
    v_max3_u32 v19, v19, v31, v32
    v_max3_u32 v19, v19, v33, v34
    v_max3_u32 v19, v19, v35, v36
    v_max3_u32 v19, v19, v37, v38
    v_max_u32 v19, v19, v39
    v_cmp_eq_u32 vcc, -1, v19
    s_nop 0
    s_cbranch_vccz g_60k
    s_add_u32 s23, s23, 1
    s_cmp_lt_u32 s23, 200000
    s_cbranch_scc1 g_60
    s_mov_b32 s25, 200000
g_60k:
    v_smfmac_f32_16x16x64_bf16 v[40:43], v[24:27], a[0:7], v172
    v_smfmac_f32_16x16x64_bf16 v[44:47], v[24:27], a[64:71], v172
    v_smfmac_f32_16x16x64_bf16 v[48:51], v[24:27], a[32:39], v172
    v_smfmac_f32_16x16x64_bf16 v[52:55], v[24:27], a[96:103], v172
    v_smfmac_f32_16x16x64_bf16 v[40:43], v[28:31], a[8:15], v172
    v_smfmac_f32_16x16x64_bf16 v[44:47], v[28:31], a[72:79], v172
    v_smfmac_f32_16x16x64_bf16 v[48:51], v[28:31], a[40:47], v172
    v_smfmac_f32_16x16x64_bf16 v[52:55], v[28:31], a[104:111], v172
    v_smfmac_f32_16x16x64_bf16 v[40:43], v[32:35], a[16:23], v172
    v_smfmac_f32_16x16x64_bf16 v[44:47], v[32:35], a[80:87], v172
    v_smfmac_f32_16x16x64_bf16 v[48:51], v[32:35], a[48:55], v172
    v_smfmac_f32_16x16x64_bf16 v[52:55], v[32:35], a[112:119], v172
    v_smfmac_f32_16x16x64_bf16 v[40:43], v[36:39], a[24:31], v172
    v_smfmac_f32_16x16x64_bf16 v[44:47], v[36:39], a[88:95], v172
    v_smfmac_f32_16x16x64_bf16 v[48:51], v[36:39], a[56:63], v172
    v_smfmac_f32_16x16x64_bf16 v[52:55], v[36:39], a[120:127], v172
    v_cvt_pk_bf16_f32 v72, v40, v41
    v_cvt_pk_bf16_f32 v73, v42, v43
    v_cvt_pk_bf16_f32 v74, v44, v45
    v_cvt_pk_bf16_f32 v75, v46, v47
    ds_write_b128 v17, v[72:75] offset:0
    v_cvt_pk_bf16_f32 v76, v48, v49
    v_cvt_pk_bf16_f32 v77, v50, v51
    s_nop 0
    v_cvt_pk_bf16_f32 v78, v52, v53
    v_cvt_pk_bf16_f32 v79, v54, v55
    ds_write_b128 v17, v[76:79] offset:1024
    v_smfmac_f32_16x16x64_bf16 v[56:59], v[24:27], a[128:135], v172
    v_smfmac_f32_16x16x64_bf16 v[60:63], v[24:27], a[160:167], v172
    v_smfmac_f32_16x16x64_bf16 v[56:59], v[28:31], a[136:143], v172
    s_waitcnt lgkmcnt(0)
    s_barrier
    v_smfmac_f32_16x16x64_bf16 v[60:63], v[28:31], a[168:175], v172
    v_smfmac_f32_16x16x64_bf16 v[56:59], v[32:35], a[144:151], v172
    v_smfmac_f32_16x16x64_bf16 v[60:63], v[32:35], a[176:183], v172
    v_smfmac_f32_16x16x64_bf16 v[56:59], v[36:39], a[152:159], v172
    v_smfmac_f32_16x16x64_bf16 v[60:63], v[36:39], a[184:191], v172
    s_nop 4
    v_cvt_pk_bf16_f32 v80, v56, v57
    v_cvt_pk_bf16_f32 v81, v58, v59
    s_nop 0
    v_cvt_pk_bf16_f32 v82, v60, v61
    v_cvt_pk_bf16_f32 v83, v62, v63
    ds_write_b128 v17, v[80:83] offset:8192
    v_mov_b32 v152, v228
    v_mov_b32 v153, v229
    v_mov_b32 v156, v230
    v_mov_b32 v157, v231
    v_mov_b32 v160, v232
    v_mov_b32 v161, v233
    v_mov_b32 v164, v234
    v_mov_b32 v165, v235
    s_cmp_eq_u32 s15, 63
    s_waitcnt lgkmcnt(0)
    s_barrier
    s_cbranch_scc1 recur_end
    s_nop 15
    s_nop 15
    s_nop 7
    buffer_load_dwordx4 v[208:211], v5, s[4:7], s16 offen offset:0 sc1
    buffer_load_dwordx4 v[212:215], v5, s[4:7], s16 offen offset:1024 sc1
    buffer_load_dwordx4 v[216:219], v5, s[4:7], s16 offen offset:2048 sc1
    buffer_load_dwordx4 v[220:223], v5, s[4:7], s16 offen offset:3072 sc1
    buffer_load_dword v224, v6, s[4:7], s16 offen offset:0 sc1
    buffer_load_dword v225, v6, s[4:7], s16 offen offset:256 sc1
    buffer_load_dword v226, v6, s[4:7], s16 offen offset:512 sc1
    buffer_load_dword v227, v6, s[4:7], s16 offen offset:768 sc1
    s_mov_b32 s23, s25
    ds_read_b128 v[96:99], v16 offset:8192
    ds_read_b128 v[104:107], v16 offset:12288
    ds_read_b128 v[108:111], v16 offset:14336
    v_mfma_f32_16x16x32_bf16 v[140:143], v[84:87], v[80:83], 0
    s_waitcnt lgkmcnt(2)
    v_mfma_f32_16x16x32_bf16 v[140:143], v[84:87], v[96:99], v[140:143]
    s_waitcnt lgkmcnt(1)
    v_mfma_f32_16x16x32_bf16 v[140:143], v[84:87], v[104:107], v[140:143]
    s_waitcnt lgkmcnt(0)
    v_mfma_f32_16x16x32_bf16 v[140:143], v[84:87], v[108:111], v[140:143]
    buffer_load_dwordx4 v[24:27], v5, s[4:7], s16 offen offset:0 sc1
    buffer_load_dwordx4 v[28:31], v5, s[4:7], s16 offen offset:1024 sc1
    buffer_load_dwordx4 v[32:35], v5, s[4:7], s16 offen offset:2048 sc1
    buffer_load_dwordx4 v[36:39], v5, s[4:7], s16 offen offset:3072 sc1
    buffer_load_dword v40, v6, s[4:7], s16 offen offset:0 sc1
    buffer_load_dword v41, v6, s[4:7], s16 offen offset:256 sc1
    buffer_load_dword v42, v6, s[4:7], s16 offen offset:512 sc1
    buffer_load_dword v43, v6, s[4:7], s16 offen offset:768 sc1
    v_cvt_pk_bf16_f32 v154, v140, v179
    v_cvt_pk_bf16_f32 v158, v141, v179
    v_cvt_pk_bf16_f32 v162, v142, v179
    v_cvt_pk_bf16_f32 v166, v143, v179
    s_waitcnt vmcnt(14)
    v_pk_add_f32 v[180:181], v[208:209], v[212:213]
    v_pk_add_f32 v[182:183], v[210:211], v[214:215]
    s_waitcnt vmcnt(12)
    v_pk_add_f32 v[188:189], v[216:217], v[220:221]
    v_pk_add_f32 v[190:191], v[218:219], v[222:223]
    v_pk_add_f32 v[180:181], v[180:181], v[188:189]
    v_pk_add_f32 v[182:183], v[182:183], v[190:191]
    v_pk_add_f32 v[188:189], v[180:181], v[182:183]
    v_max3_f32 v185, v180, v181, v182
    s_waitcnt vmcnt(8)
    v_pk_add_f32 v[192:193], v[224:225], v[226:227]
    v_add_f32 v188, v188, v189
    v_add_f32 v184, v192, v193
    v_max3_f32 v185, v185, v183, v184
    v_cmp_u_f32 vcc, v188, v184
    s_nop 0
    v_max_f32_dpp v185, v185, v185 row_ror:8 row_mask:0xf bank_mask:0xf
    v_mov_b32 v186, v185
    s_nop 1
    v_permlane16_swap_b32 v185, v186
    v_max_f32 v185, v185, v186
    v_mov_b32 v186, v185
    s_cbranch_vccnz ss_61
sg_63:
    s_nop 0
    v_permlane32_swap_b32 v185, v186
    v_max_f32 v185, v185, v186
    v_mul_f32 v185, s24, v185
    v_fma_f32 v180, v180, s24, -v185
    v_fma_f32 v181, v181, s24, -v185
    v_fma_f32 v182, v182, s24, -v185
    v_fma_f32 v183, v183, s24, -v185
    v_fma_f32 v184, v184, s24, -v185
    v_exp_f32 v180, v180
    v_exp_f32 v181, v181
    v_exp_f32 v182, v182
    v_exp_f32 v183, v183
    v_exp_f32 v184, v184
    v_cvt_pk_bf16_f32 v176, v180, v181
    v_cvt_pk_bf16_f32 v177, v182, v183
    v_cvt_pk_bf16_f32 v178, v184, v179
    s_nop 1
    v_mfma_f32_16x16x32_bf16 v[240:243], v[236:239], v[176:179], 0
    v_mfma_f32_16x16x32_bf16 v[188:191], v[152:155], v[176:179], 0
    v_mfma_f32_16x16x32_bf16 v[192:195], v[156:159], v[176:179], 0
    v_mfma_f32_16x16x32_bf16 v[196:199], v[160:163], v[176:179], 0
    v_mfma_f32_16x16x32_bf16 v[200:203], v[164:167], v[176:179], 0
    v_add_f32_dpp v185, v240, v240 row_ror:8 row_mask:0xf bank_mask:0xf
    v_rcp_f32 v185, v185
    v_add_f32_dpp v88, v192, v188 row_ror:8 row_mask:0xf bank_mask:0x3
    v_add_f32_dpp v89, v193, v189 row_ror:8 row_mask:0xf bank_mask:0x3
    v_add_f32_dpp v90, v194, v190 row_ror:8 row_mask:0xf bank_mask:0x3
    v_add_f32_dpp v91, v195, v191 row_ror:8 row_mask:0xf bank_mask:0x3
    s_nop 1
    v_add_f32_dpp v88, v196, v200 row_ror:8 row_mask:0xf bank_mask:0xc
    v_add_f32_dpp v89, v197, v201 row_ror:8 row_mask:0xf bank_mask:0xc
    v_add_f32_dpp v90, v198, v202 row_ror:8 row_mask:0xf bank_mask:0xc
    v_add_f32_dpp v91, v199, v203 row_ror:8 row_mask:0xf bank_mask:0xc
    v_mul_f32 v88, v88, v185
    v_mul_f32 v89, v89, v185
    v_mul_f32 v90, v90, v185
    v_mul_f32 v91, v91, v185
    v_cvt_pk_bf16_f32 v88, v88, v89
    v_cvt_pk_bf16_f32 v89, v90, v91
    buffer_store_dwordx2 v[88:89], v7, s[4:7], s16 offen sc1
    v_readfirstlane_b32 s85, v247
    s_add_u32 s94, s15, 2
    s_barrier
    s_nop 15
    s_mov_b32 s23, s25
g_64:
    buffer_load_dwordx4 v[24:27], v8, s[4:7], s16 offen offset:0 sc1
    buffer_load_dwordx4 v[28:31], v8, s[4:7], s16 offen offset:1024 sc1
    buffer_load_dwordx4 v[32:35], v8, s[4:7], s16 offen offset:2048 sc1
    buffer_load_dwordx4 v[36:39], v8, s[4:7], s16 offen offset:3072 sc1
    s_waitcnt vmcnt(0)
    v_max3_u32 v19, v24, v25, v26
    v_max3_u32 v19, v19, v27, v28
    v_max3_u32 v19, v19, v29, v30
    v_max3_u32 v19, v19, v31, v32
    v_max3_u32 v19, v19, v33, v34
    v_max3_u32 v19, v19, v35, v36
    v_max3_u32 v19, v19, v37, v38
    v_max_u32 v19, v19, v39
    v_cmp_eq_u32 vcc, -1, v19
    s_nop 0
    s_cbranch_vccz g_64k
    s_add_u32 s23, s23, 1
    s_cmp_lt_u32 s23, 200000
    s_cbranch_scc1 g_64
    s_mov_b32 s25, 200000
g_64k:
    v_smfmac_f32_16x16x64_bf16 v[64:67], v[24:27], a[192:199], v172
    v_smfmac_f32_16x16x64_bf16 v[68:71], v[24:27], a[224:231], v172
    v_smfmac_f32_16x16x64_bf16 v[64:67], v[28:31], a[200:207], v172
    v_smfmac_f32_16x16x64_bf16 v[68:71], v[28:31], a[232:239], v172
    v_smfmac_f32_16x16x64_bf16 v[64:67], v[32:35], a[208:215], v172
    v_smfmac_f32_16x16x64_bf16 v[68:71], v[32:35], a[240:247], v172
    v_smfmac_f32_16x16x64_bf16 v[64:67], v[36:39], a[216:223], v172
    v_smfmac_f32_16x16x64_bf16 v[68:71], v[36:39], a[248:255], v172
    s_nop 4
    v_cvt_pk_bf16_f32 v80, v64, v65
    v_cvt_pk_bf16_f32 v81, v66, v67
    s_nop 0
    v_cvt_pk_bf16_f32 v82, v68, v69
    v_cvt_pk_bf16_f32 v83, v70, v71
    ds_write_b128 v17, v[80:83] offset:9216
    s_waitcnt lgkmcnt(0)
    s_barrier
    s_nop 15
    s_nop 15
    s_nop 15
    s_nop 15
    s_mov_b32 s23, s25
fw_65:
    s_cmp_ge_u32 s85, s94
    s_cbranch_scc1 fo_66
    buffer_load_dword v247, v245, s[4:7], 0 offen sc1
    s_add_u32 s23, s23, 1
    s_waitcnt vmcnt(0)
    v_readfirstlane_b32 s85, v247
    s_cmp_lt_u32 s23, 200000
    s_cbranch_scc1 fw_65
    s_mov_b32 s25, 200000
fo_66:
    buffer_load_dwordx4 v[228:231], v13, s[4:7], s18 offen offset:0 sc1
    buffer_load_dwordx4 v[232:235], v13, s[4:7], s18 offen offset:256 sc1
    s_add_u32 s18, s18, 2048
    s_min_u32 s18, s18, 35780608
    buffer_load_dword v247, v245, s[4:7], 0 offen sc1
    v_mov_b32 v40, 0
    v_mov_b32 v41, 0
    v_mov_b32 v42, 0
    v_mov_b32 v43, 0
    v_mov_b32 v44, 0
    v_mov_b32 v45, 0
    v_mov_b32 v46, 0
    v_mov_b32 v47, 0
    v_mov_b32 v48, 0
    v_mov_b32 v49, 0
    v_mov_b32 v50, 0
    v_mov_b32 v51, 0
    v_mov_b32 v52, 0
    v_mov_b32 v53, 0
    v_mov_b32 v54, 0
    v_mov_b32 v55, 0
    v_mov_b32 v56, 0
    v_mov_b32 v57, 0
    v_mov_b32 v58, 0
    v_mov_b32 v59, 0
    v_mov_b32 v60, 0
    v_mov_b32 v61, 0
    v_mov_b32 v62, 0
    v_mov_b32 v63, 0
    v_mov_b32 v64, 0
    v_mov_b32 v65, 0
    v_mov_b32 v66, 0
    v_mov_b32 v67, 0
    v_mov_b32 v68, 0
    v_mov_b32 v69, 0
    v_mov_b32 v70, 0
    v_mov_b32 v71, 0
    s_mov_b32 s21, s16
    s_mov_b32 s16, s42
    s_mov_b32 s42, s43
    s_mov_b32 s43, s44
    s_mov_b32 s44, s21
    s_add_u32 s95, s95, 524288
    s_lshr_b32 s84, s95, 8
    s_and_b32 s84, s84, 8192
    s_xor_b32 s84, s84, s46
    s_add_u32 s84, s84, s95
    s_add_u32 s15, s15, 1
    s_barrier
    s_branch recur_slow_w1
sb_62:
    v_max3_u32 v19, v24, v25, v26
    v_max3_u32 v19, v19, v27, v28
    v_max3_u32 v19, v19, v29, v30
    v_max3_u32 v19, v19, v31, v32
    v_max3_u32 v19, v19, v33, v34
    v_max3_u32 v19, v19, v35, v36
    v_max3_u32 v19, v19, v37, v38
    v_max3_u32 v19, v19, v39, v40
    v_max3_u32 v19, v19, v41, v42
    v_max_u32 v19, v19, v43
    v_cmp_eq_u32 vcc, -1, v19
    s_nop 0
    s_cbranch_vccz sg_63
    buffer_load_dwordx4 v[24:27], v5, s[4:7], s16 offen offset:0 sc1
    buffer_load_dwordx4 v[28:31], v5, s[4:7], s16 offen offset:1024 sc1
    buffer_load_dwordx4 v[32:35], v5, s[4:7], s16 offen offset:2048 sc1
    buffer_load_dwordx4 v[36:39], v5, s[4:7], s16 offen offset:3072 sc1
    buffer_load_dword v40, v6, s[4:7], s16 offen offset:0 sc1
    buffer_load_dword v41, v6, s[4:7], s16 offen offset:256 sc1
    buffer_load_dword v42, v6, s[4:7], s16 offen offset:512 sc1
    buffer_load_dword v43, v6, s[4:7], s16 offen offset:768 sc1
    s_add_u32 s23, s23, 1
    s_cmp_lt_u32 s23, 200000
    s_cbranch_scc1 ss_61
    s_mov_b32 s25, 200000
    s_branch sg_63
ss_61:
    s_waitcnt vmcnt(6)
    v_pk_add_f32 v[180:181], v[24:25], v[28:29]
    v_pk_add_f32 v[182:183], v[26:27], v[30:31]
    s_waitcnt vmcnt(4)
    v_pk_add_f32 v[188:189], v[32:33], v[36:37]
    v_pk_add_f32 v[190:191], v[34:35], v[38:39]
    v_pk_add_f32 v[180:181], v[180:181], v[188:189]
    v_pk_add_f32 v[182:183], v[182:183], v[190:191]
    v_pk_add_f32 v[188:189], v[180:181], v[182:183]
    v_max3_f32 v185, v180, v181, v182
    s_waitcnt vmcnt(0)
    v_pk_add_f32 v[192:193], v[40:41], v[42:43]
    v_add_f32 v188, v188, v189
    v_add_f32 v184, v192, v193
    v_max3_f32 v185, v185, v183, v184
    v_cmp_u_f32 vcc, v188, v184
    s_nop 0
    v_max_f32_dpp v185, v185, v185 row_ror:8 row_mask:0xf bank_mask:0xf
    v_mov_b32 v186, v185
    s_nop 1
    v_permlane16_swap_b32 v185, v186
    v_max_f32 v185, v185, v186
    v_mov_b32 v186, v185
    s_cbranch_vccnz sb_62
    s_branch sg_63
.p2align 6
recur_slow_w2:
    s_nop 15
    s_mov_b32 s23, s25
g_67:
    buffer_load_dwordx4 v[24:27], v2, s[4:7], s16 offen offset:0 sc1
    buffer_load_dwordx4 v[28:31], v2, s[4:7], s16 offen offset:1024 sc1
    buffer_load_dwordx4 v[32:35], v2, s[4:7], s16 offen offset:2048 sc1
    buffer_load_dwordx4 v[36:39], v2, s[4:7], s16 offen offset:3072 sc1
    s_waitcnt vmcnt(0)
    v_max3_u32 v19, v24, v25, v26
    v_max3_u32 v19, v19, v27, v28
    v_max3_u32 v19, v19, v29, v30
    v_max3_u32 v19, v19, v31, v32
    v_max3_u32 v19, v19, v33, v34
    v_max3_u32 v19, v19, v35, v36
    v_max3_u32 v19, v19, v37, v38
    v_max_u32 v19, v19, v39
    v_cmp_eq_u32 vcc, -1, v19
    s_nop 0
    s_cbranch_vccz g_67k
    s_add_u32 s23, s23, 1
    s_cmp_lt_u32 s23, 200000
    s_cbranch_scc1 g_67
    s_mov_b32 s25, 200000
g_67k:
    v_smfmac_f32_16x16x64_bf16 v[40:43], v[24:27], a[0:7], v172
    v_smfmac_f32_16x16x64_bf16 v[44:47], v[24:27], a[64:71], v172
    v_smfmac_f32_16x16x64_bf16 v[48:51], v[24:27], a[32:39], v172
    v_smfmac_f32_16x16x64_bf16 v[52:55], v[24:27], a[96:103], v172
    v_smfmac_f32_16x16x64_bf16 v[40:43], v[28:31], a[8:15], v172
    v_smfmac_f32_16x16x64_bf16 v[44:47], v[28:31], a[72:79], v172
    v_smfmac_f32_16x16x64_bf16 v[48:51], v[28:31], a[40:47], v172
    v_smfmac_f32_16x16x64_bf16 v[52:55], v[28:31], a[104:111], v172
    v_smfmac_f32_16x16x64_bf16 v[40:43], v[32:35], a[16:23], v172
    v_smfmac_f32_16x16x64_bf16 v[44:47], v[32:35], a[80:87], v172
    v_smfmac_f32_16x16x64_bf16 v[48:51], v[32:35], a[48:55], v172
    v_smfmac_f32_16x16x64_bf16 v[52:55], v[32:35], a[112:119], v172
    v_smfmac_f32_16x16x64_bf16 v[40:43], v[36:39], a[24:31], v172
    v_smfmac_f32_16x16x64_bf16 v[44:47], v[36:39], a[88:95], v172
    v_smfmac_f32_16x16x64_bf16 v[48:51], v[36:39], a[56:63], v172
    v_smfmac_f32_16x16x64_bf16 v[52:55], v[36:39], a[120:127], v172
    v_cvt_pk_bf16_f32 v72, v40, v41
    v_cvt_pk_bf16_f32 v73, v42, v43
    v_cvt_pk_bf16_f32 v74, v44, v45
    v_cvt_pk_bf16_f32 v75, v46, v47
    ds_write_b128 v17, v[72:75] offset:0
    v_cvt_pk_bf16_f32 v76, v48, v49
    v_cvt_pk_bf16_f32 v77, v50, v51
    s_nop 0
    v_cvt_pk_bf16_f32 v78, v52, v53
    v_cvt_pk_bf16_f32 v79, v54, v55
    ds_write_b128 v17, v[76:79] offset:1024
    v_smfmac_f32_16x16x64_bf16 v[56:59], v[24:27], a[128:135], v172
    v_smfmac_f32_16x16x64_bf16 v[60:63], v[24:27], a[160:167], v172
    v_smfmac_f32_16x16x64_bf16 v[56:59], v[28:31], a[136:143], v172
    s_waitcnt lgkmcnt(0)
    s_barrier
    v_smfmac_f32_16x16x64_bf16 v[60:63], v[28:31], a[168:175], v172
    v_smfmac_f32_16x16x64_bf16 v[56:59], v[32:35], a[144:151], v172
    v_smfmac_f32_16x16x64_bf16 v[60:63], v[32:35], a[176:183], v172
    v_smfmac_f32_16x16x64_bf16 v[56:59], v[36:39], a[152:159], v172
    v_smfmac_f32_16x16x64_bf16 v[60:63], v[36:39], a[184:191], v172
    s_nop 4
    v_cvt_pk_bf16_f32 v80, v56, v57
    v_cvt_pk_bf16_f32 v81, v58, v59
    s_nop 0
    v_cvt_pk_bf16_f32 v82, v60, v61
    v_cvt_pk_bf16_f32 v83, v62, v63
    ds_write_b128 v17, v[80:83] offset:8192
    s_cmp_eq_u32 s15, 63
    s_waitcnt lgkmcnt(0)
    s_barrier
    ds_read_b128 v[96:99], v16 offset:8192
    ds_read_b128 v[100:103], v16 offset:10240
    ds_read_b128 v[108:111], v16 offset:14336
    v_mfma_f32_16x16x32_bf16 v[140:143], v[84:87], v[80:83], 0
    s_waitcnt lgkmcnt(2)
    v_mfma_f32_16x16x32_bf16 v[140:143], v[84:87], v[96:99], v[140:143]
    s_waitcnt lgkmcnt(1)
    v_mfma_f32_16x16x32_bf16 v[140:143], v[84:87], v[100:103], v[140:143]
    s_waitcnt lgkmcnt(0)
    v_mfma_f32_16x16x32_bf16 v[140:143], v[84:87], v[108:111], v[140:143]
    s_nop 7
    v_cvt_pk_bf16_f32 v168, v140, v141
    v_cvt_pk_bf16_f32 v169, v142, v143
    v_mov_b32 v170, v168
    v_mov_b32 v171, v169
    s_nop 0
    v_permlane16_swap_b32 v168, v170
    v_permlane16_swap_b32 v169, v171
    v_mov_b32 v247, s15
    s_cbranch_scc1 recur_slow_last2
    s_barrier
    s_nop 15
    s_mov_b32 s23, s25
g_68:
    buffer_load_dwordx4 v[24:27], v8, s[4:7], s16 offen offset:0 sc1
    buffer_load_dwordx4 v[28:31], v8, s[4:7], s16 offen offset:1024 sc1
    buffer_load_dwordx4 v[32:35], v8, s[4:7], s16 offen offset:2048 sc1
    buffer_load_dwordx4 v[36:39], v8, s[4:7], s16 offen offset:3072 sc1
    s_waitcnt vmcnt(0)
    v_max3_u32 v19, v24, v25, v26
    v_max3_u32 v19, v19, v27, v28
    v_max3_u32 v19, v19, v29, v30
    v_max3_u32 v19, v19, v31, v32
    v_max3_u32 v19, v19, v33, v34
    v_max3_u32 v19, v19, v35, v36
    v_max3_u32 v19, v19, v37, v38
    v_max_u32 v19, v19, v39
    v_cmp_eq_u32 vcc, -1, v19
    s_nop 0
    s_cbranch_vccz g_68k
    s_add_u32 s23, s23, 1
    s_cmp_lt_u32 s23, 200000
    s_cbranch_scc1 g_68
    s_mov_b32 s25, 200000
g_68k:
    v_smfmac_f32_16x16x64_bf16 v[64:67], v[24:27], a[192:199], v172
    v_smfmac_f32_16x16x64_bf16 v[68:71], v[24:27], a[224:231], v172
    v_smfmac_f32_16x16x64_bf16 v[64:67], v[28:31], a[200:207], v172
    v_smfmac_f32_16x16x64_bf16 v[68:71], v[28:31], a[232:239], v172
    v_smfmac_f32_16x16x64_bf16 v[64:67], v[32:35], a[208:215], v172
    v_smfmac_f32_16x16x64_bf16 v[68:71], v[32:35], a[240:247], v172
    v_smfmac_f32_16x16x64_bf16 v[64:67], v[36:39], a[216:223], v172
    v_smfmac_f32_16x16x64_bf16 v[68:71], v[36:39], a[248:255], v172
    s_nop 4
    v_cvt_pk_bf16_f32 v80, v64, v65
    v_cvt_pk_bf16_f32 v81, v66, v67
    s_nop 0
    v_cvt_pk_bf16_f32 v82, v68, v69
    v_cvt_pk_bf16_f32 v83, v70, v71
    ds_write_b128 v17, v[80:83] offset:9216
    s_waitcnt lgkmcnt(0)
    s_barrier
    s_nop 15
    s_nop 15
    s_nop 15
    s_nop 15
    buffer_store_dwordx4 v[168:171], v15, s[4:7], s20 offen sc1
    s_add_u32 s20, s20, 512
    s_add_u32 s21, s95, 1048576
    s_lshr_b32 s22, s21, 8
    s_and_b32 s22, s22, 8192
    s_xor_b32 s22, s22, s46
    s_add_u32 s21, s21, s22
    buffer_store_dwordx4 v[204:207], v9, s[4:7], s21 offen sc1
    s_add_u32 s21, s21, 262144
    buffer_store_dword v247, v246, s[4:7], 0 offen sc1
    v_mov_b32 v40, 0
    v_mov_b32 v41, 0
    v_mov_b32 v42, 0
    v_mov_b32 v43, 0
    v_mov_b32 v44, 0
    v_mov_b32 v45, 0
    v_mov_b32 v46, 0
    v_mov_b32 v47, 0
    v_mov_b32 v48, 0
    v_mov_b32 v49, 0
    v_mov_b32 v50, 0
    v_mov_b32 v51, 0
    v_mov_b32 v52, 0
    v_mov_b32 v53, 0
    v_mov_b32 v54, 0
    v_mov_b32 v55, 0
    v_mov_b32 v56, 0
    v_mov_b32 v57, 0
    v_mov_b32 v58, 0
    v_mov_b32 v59, 0
    v_mov_b32 v60, 0
    v_mov_b32 v61, 0
    v_mov_b32 v62, 0
    v_mov_b32 v63, 0
    v_mov_b32 v64, 0
    v_mov_b32 v65, 0
    v_mov_b32 v66, 0
    v_mov_b32 v67, 0
    v_mov_b32 v68, 0
    v_mov_b32 v69, 0
    v_mov_b32 v70, 0
    v_mov_b32 v71, 0
    s_mov_b32 s21, s16
    s_mov_b32 s16, s42
    s_mov_b32 s42, s43
    s_mov_b32 s43, s44
    s_mov_b32 s44, s21
    s_add_u32 s95, s95, 524288
    s_lshr_b32 s84, s95, 8
    s_and_b32 s84, s84, 8192
    s_xor_b32 s84, s84, s46
    s_add_u32 s84, s84, s95
    s_add_u32 s15, s15, 1
    s_barrier
    s_branch recur_slow_w2
recur_slow_last2:
    buffer_store_dwordx4 v[168:171], v15, s[4:7], s20 offen sc1
    s_waitcnt vmcnt(0)
    s_branch recur_end
.p2align 6
recur_slow_w3:
    s_nop 15
    s_mov_b32 s23, s25
g_69:
    buffer_load_dwordx4 v[24:27], v2, s[4:7], s16 offen offset:0 sc1
    buffer_load_dwordx4 v[28:31], v2, s[4:7], s16 offen offset:1024 sc1
    buffer_load_dwordx4 v[32:35], v2, s[4:7], s16 offen offset:2048 sc1
    buffer_load_dwordx4 v[36:39], v2, s[4:7], s16 offen offset:3072 sc1
    s_waitcnt vmcnt(0)
    v_max3_u32 v19, v24, v25, v26
    v_max3_u32 v19, v19, v27, v28
    v_max3_u32 v19, v19, v29, v30
    v_max3_u32 v19, v19, v31, v32
    v_max3_u32 v19, v19, v33, v34
    v_max3_u32 v19, v19, v35, v36
    v_max3_u32 v19, v19, v37, v38
    v_max_u32 v19, v19, v39
    v_cmp_eq_u32 vcc, -1, v19
    s_nop 0
    s_cbranch_vccz g_69k
    s_add_u32 s23, s23, 1
    s_cmp_lt_u32 s23, 200000
    s_cbranch_scc1 g_69
    s_mov_b32 s25, 200000
g_69k:
    v_smfmac_f32_16x16x64_bf16 v[40:43], v[24:27], a[0:7], v172
    v_smfmac_f32_16x16x64_bf16 v[44:47], v[24:27], a[64:71], v172
    v_smfmac_f32_16x16x64_bf16 v[48:51], v[24:27], a[32:39], v172
    v_smfmac_f32_16x16x64_bf16 v[52:55], v[24:27], a[96:103], v172
    v_smfmac_f32_16x16x64_bf16 v[40:43], v[28:31], a[8:15], v172
    v_smfmac_f32_16x16x64_bf16 v[44:47], v[28:31], a[72:79], v172
    v_smfmac_f32_16x16x64_bf16 v[48:51], v[28:31], a[40:47], v172
    v_smfmac_f32_16x16x64_bf16 v[52:55], v[28:31], a[104:111], v172
    v_smfmac_f32_16x16x64_bf16 v[40:43], v[32:35], a[16:23], v172
    v_smfmac_f32_16x16x64_bf16 v[44:47], v[32:35], a[80:87], v172
    v_smfmac_f32_16x16x64_bf16 v[48:51], v[32:35], a[48:55], v172
    v_smfmac_f32_16x16x64_bf16 v[52:55], v[32:35], a[112:119], v172
    v_smfmac_f32_16x16x64_bf16 v[40:43], v[36:39], a[24:31], v172
    v_smfmac_f32_16x16x64_bf16 v[44:47], v[36:39], a[88:95], v172
    v_smfmac_f32_16x16x64_bf16 v[48:51], v[36:39], a[56:63], v172
    v_smfmac_f32_16x16x64_bf16 v[52:55], v[36:39], a[120:127], v172
    v_cvt_pk_bf16_f32 v72, v40, v41
    v_cvt_pk_bf16_f32 v73, v42, v43
    v_cvt_pk_bf16_f32 v74, v44, v45
    v_cvt_pk_bf16_f32 v75, v46, v47
    ds_write_b128 v17, v[72:75] offset:0
    v_cvt_pk_bf16_f32 v76, v48, v49
    v_cvt_pk_bf16_f32 v77, v50, v51
    s_nop 0
    v_cvt_pk_bf16_f32 v78, v52, v53
    v_cvt_pk_bf16_f32 v79, v54, v55
    ds_write_b128 v17, v[76:79] offset:1024
    v_smfmac_f32_16x16x64_bf16 v[56:59], v[24:27], a[128:135], v172
    v_smfmac_f32_16x16x64_bf16 v[60:63], v[24:27], a[160:167], v172
    v_smfmac_f32_16x16x64_bf16 v[56:59], v[28:31], a[136:143], v172
    s_waitcnt lgkmcnt(0)
    s_barrier
    v_smfmac_f32_16x16x64_bf16 v[60:63], v[28:31], a[168:175], v172
    v_smfmac_f32_16x16x64_bf16 v[56:59], v[32:35], a[144:151], v172
    v_smfmac_f32_16x16x64_bf16 v[60:63], v[32:35], a[176:183], v172
    v_smfmac_f32_16x16x64_bf16 v[56:59], v[36:39], a[152:159], v172
    v_smfmac_f32_16x16x64_bf16 v[60:63], v[36:39], a[184:191], v172
    s_nop 4
    v_cvt_pk_bf16_f32 v80, v56, v57
    v_cvt_pk_bf16_f32 v81, v58, v59
    s_nop 0
    v_cvt_pk_bf16_f32 v82, v60, v61
    v_cvt_pk_bf16_f32 v83, v62, v63
    ds_write_b128 v17, v[80:83] offset:8192
    buffer_store_dwordx4 v[204:207], v3, s[4:7], s43 offen sc1
    buffer_store_dwordx4 v[204:207], v3, s[4:7], s43 offen offset:128 sc1
    buffer_store_dwordx4 v[204:207], v4, s[4:7], s43 offen sc1
    buffer_store_dwordx2 v[204:205], v7, s[4:7], s43 offen sc1
    buffer_store_dwordx2 v[204:205], v11, s[4:7], s43 offen sc1
    s_cmp_eq_u32 s15, 63
    s_waitcnt lgkmcnt(0)
    s_barrier
    s_cbranch_scc1 recur_end
    s_barrier
    s_nop 15
    s_mov_b32 s23, s25
g_70:
    buffer_load_dwordx4 v[24:27], v8, s[4:7], s16 offen offset:0 sc1
    buffer_load_dwordx4 v[28:31], v8, s[4:7], s16 offen offset:1024 sc1
    buffer_load_dwordx4 v[32:35], v8, s[4:7], s16 offen offset:2048 sc1
    buffer_load_dwordx4 v[36:39], v8, s[4:7], s16 offen offset:3072 sc1
    s_waitcnt vmcnt(0)
    v_max3_u32 v19, v24, v25, v26
    v_max3_u32 v19, v19, v27, v28
    v_max3_u32 v19, v19, v29, v30
    v_max3_u32 v19, v19, v31, v32
    v_max3_u32 v19, v19, v33, v34
    v_max3_u32 v19, v19, v35, v36
    v_max3_u32 v19, v19, v37, v38
    v_max_u32 v19, v19, v39
    v_cmp_eq_u32 vcc, -1, v19
    s_nop 0
    s_cbranch_vccz g_70k
    s_add_u32 s23, s23, 1
    s_cmp_lt_u32 s23, 200000
    s_cbranch_scc1 g_70
    s_mov_b32 s25, 200000
g_70k:
    v_smfmac_f32_16x16x64_bf16 v[64:67], v[24:27], a[192:199], v172
    v_smfmac_f32_16x16x64_bf16 v[68:71], v[24:27], a[224:231], v172
    v_smfmac_f32_16x16x64_bf16 v[64:67], v[28:31], a[200:207], v172
    v_smfmac_f32_16x16x64_bf16 v[68:71], v[28:31], a[232:239], v172
    v_smfmac_f32_16x16x64_bf16 v[64:67], v[32:35], a[208:215], v172
    v_smfmac_f32_16x16x64_bf16 v[68:71], v[32:35], a[240:247], v172
    v_smfmac_f32_16x16x64_bf16 v[64:67], v[36:39], a[216:223], v172
    v_smfmac_f32_16x16x64_bf16 v[68:71], v[36:39], a[248:255], v172
    s_nop 4
    v_cvt_pk_bf16_f32 v80, v64, v65
    v_cvt_pk_bf16_f32 v81, v66, v67
    s_nop 0
    v_cvt_pk_bf16_f32 v82, v68, v69
    v_cvt_pk_bf16_f32 v83, v70, v71
    s_nop 1
    v_mfma_f32_16x16x32_bf16 v[88:91], v[80:83], v[84:87], 0
    s_barrier
    ds_read_b128 v[96:99], v16 offset:9216
    ds_read_b128 v[100:103], v16 offset:11264
    ds_read_b128 v[104:107], v16 offset:13312
    s_waitcnt lgkmcnt(2)
    v_mfma_f32_16x16x32_bf16 v[88:91], v[96:99], v[84:87], v[88:91]
    s_waitcnt lgkmcnt(1)
    v_mfma_f32_16x16x32_bf16 v[88:91], v[100:103], v[84:87], v[88:91]
    s_waitcnt lgkmcnt(0)
    v_mfma_f32_16x16x32_bf16 v[88:91], v[104:107], v[84:87], v[88:91]
    s_nop 7
    buffer_store_dwordx4 v[88:91], v9, s[4:7], s84 offen sc1
    s_add_u32 s22, s84, 262144
    s_nop 15
    s_nop 15
    s_nop 15
    s_nop 15
    s_nop 15
    s_nop 15
    s_nop 15
    s_nop 15
    s_mov_b32 s23, s25
    buffer_load_dwordx4 v[96:99], v10, s[4:7], s84 offen sc1
    buffer_load_dwordx4 v[100:103], v23, s[4:7], s84 offen sc1
    buffer_load_dwordx4 v[104:107], v244, s[4:7], s84 offen sc1
    v_mov_b32 v40, 0
    v_mov_b32 v41, 0
    v_mov_b32 v42, 0
    v_mov_b32 v43, 0
    v_mov_b32 v44, 0
    v_mov_b32 v45, 0
    v_mov_b32 v46, 0
    v_mov_b32 v47, 0
    v_mov_b32 v48, 0
    v_mov_b32 v49, 0
    v_mov_b32 v50, 0
    v_mov_b32 v51, 0
    v_mov_b32 v52, 0
    v_mov_b32 v53, 0
    v_mov_b32 v54, 0
    v_mov_b32 v55, 0
    v_mov_b32 v56, 0
    v_mov_b32 v57, 0
    v_mov_b32 v58, 0
    v_mov_b32 v59, 0
    v_mov_b32 v60, 0
    v_mov_b32 v61, 0
    v_mov_b32 v62, 0
    v_mov_b32 v63, 0
    v_mov_b32 v64, 0
    v_mov_b32 v65, 0
    v_mov_b32 v66, 0
    v_mov_b32 v67, 0
    v_mov_b32 v68, 0
    v_mov_b32 v69, 0
    v_mov_b32 v70, 0
    v_mov_b32 v71, 0
pb_73:
    s_waitcnt vmcnt(2)
    v_pk_add_f32 v[120:121], v[88:89], v[96:97]
    v_pk_add_f32 v[122:123], v[90:91], v[98:99]
    s_waitcnt vmcnt(1)
    v_pk_add_f32 v[120:121], v[120:121], v[100:101]
    v_pk_add_f32 v[122:123], v[122:123], v[102:103]
    s_waitcnt vmcnt(0)
    v_pk_add_f32 v[120:121], v[120:121], v[104:105]
    v_pk_add_f32 v[122:123], v[122:123], v[106:107]
    v_cvt_pk_bf16_f32 v180, v120, v121
    v_pk_add_f32 v[124:125], v[120:121], v[122:123]
    v_cvt_pk_bf16_f32 v181, v122, v123
    v_cmpx_o_f32 vcc, v124, v125
    buffer_store_dwordx2 v[180:181], v11, s[4:7], s42 offen sc1
    s_cmp_eq_u64 vcc, -1
    s_mov_b64 exec, -1
    s_cbranch_scc0 pr_71
pg_72:
    s_barrier
    s_mov_b32 s21, s16
    s_mov_b32 s16, s42
    s_mov_b32 s42, s43
    s_mov_b32 s43, s44
    s_mov_b32 s44, s21
    s_add_u32 s95, s95, 524288
    s_lshr_b32 s84, s95, 8
    s_and_b32 s84, s84, 8192
    s_xor_b32 s84, s84, s46
    s_add_u32 s84, s84, s95
    s_add_u32 s15, s15, 1
    s_branch recur_slow_w3
pr_71:
    v_max3_u32 v19, v96, v97, v98
    v_max3_u32 v19, v19, v99, v100
    v_max3_u32 v19, v19, v101, v102
    v_max3_u32 v19, v19, v103, v104
    v_max3_u32 v19, v19, v105, v106
    v_max_u32 v19, v19, v107
    v_cmp_eq_u32 vcc, -1, v19
    s_nop 0
    s_cbranch_vccz pf_75
    buffer_load_dwordx4 v[96:99], v10, s[4:7], s84 offen sc1
    buffer_load_dwordx4 v[100:103], v23, s[4:7], s84 offen sc1
    buffer_load_dwordx4 v[104:107], v244, s[4:7], s84 offen sc1
    s_add_u32 s23, s23, 1
    s_cmp_lt_u32 s23, 200000
    s_cbranch_scc1 pb_73
    s_mov_b32 s25, 200000
pf_75:
    buffer_store_dwordx2 v[180:181], v11, s[4:7], s42 offen sc1
    s_branch pg_72
recur_end:
    s_barrier
    v_mov_b32 v247, 64
    buffer_store_dword v247, v246, s[4:7], 0 offen sc1
    s_endpgm
.section .rodata,"a"
.p2align 6
.amdhsa_kernel concat_heads__spectral_gfnet__memory_aug_recurrent_mem_tr__prompt_kernel
  .amdhsa_next_free_vgpr 512
  .amdhsa_next_free_sgpr 102
  .amdhsa_accum_offset 256
  .amdhsa_group_segment_fixed_size 0
  .amdhsa_kernarg_size 104
  .amdhsa_user_sgpr_count 2
  .amdhsa_user_sgpr_kernarg_segment_ptr 1
  .amdhsa_system_sgpr_workgroup_id_x 1
  .amdhsa_float_denorm_mode_32 3
.end_amdhsa_kernel
```

```asm
; @launch kernel=concat_heads__spectral_gfnet__memory_aug_recurrent_mem_tr__prompt_kernel grid=(256,1,1) block=(256,1,1) lds=163840
.amdgcn_target "amdgcn-amd-amdhsa--gfx950"
.text
.globl concat_heads__spectral_gfnet__memory_aug_recurrent_mem_tr__prompt_kernel
.p2align 8
.type concat_heads__spectral_gfnet__memory_aug_recurrent_mem_tr__prompt_kernel,@function
concat_heads__spectral_gfnet__memory_aug_recurrent_mem_tr__prompt_kernel:
    s_cmp_ge_u32 s2, 256
    s_cbranch_scc1 W_end
    s_load_dwordx2 s[100:101], s[0:1], 88
    s_mov_b32 s97, s2
    s_mov_b32 s98, 0
    s_getreg_b32 s3, hwreg(HW_REG_XCC_ID, 0, 3)
role_start:
    s_andn2_b32 s2, s97, 7
    s_or_b32 s2, s2, s3
    s_bitcmp1_b32 s3, 2
    s_cbranch_scc0 R_entry
    s_cmp_ge_u32 s2, 256
    s_cbranch_scc1 W_end
    s_load_dwordx2 s[4:5], s[0:1], 96
    v_lshrrev_b32 v5, 6, v0
    v_and_b32 v1, 63, v0
    v_readfirstlane_b32 s16, v5
    s_mov_b32 s6, 268435456
    s_mov_b32 s7, 0x20000
    s_waitcnt lgkmcnt(0)
    s_lshr_b32 s90, s2, 6
    s_bfe_u32 s91, s2, 0x30003
    s_lshl_b32 s91, s91, 2
    s_and_b32 s17, s3, 3
    s_add_u32 s91, s91, s17
    s_lshl_b32 s93, s17, 3
    s_lshr_b32 s17, s91, 2
    s_add_u32 s93, s93, s17
    s_mov_b32 s92, 0
    s_lshl_b32 s17, s93, 2
    s_add_u32 s17, s17, s16
    s_lshl_b32 s18, s90, 7
    s_add_u32 s18, s18, s17
    s_lshl_b32 s18, s18, 7
    s_add_u32 s18, s18, 100663296
    s_lshl_b32 s20, s17, 7
    s_add_u32 s20, s20, 100728832
    s_cmp_eq_u32 s90, 3
    s_cselect_b32 s18, s20, s18
    s_cselect_b64 exec, 7, 1
    v_mov_b32 v5, s18
    s_and_b32 s18, s17, 31
    s_lshl_b32 s18, s18, 2
    s_lshr_b32 s20, s93, 3
    s_add_u32 s18, s18, s20
    s_lshl_b32 s18, s18, 7
    s_add_u32 s18, s18, 100745216
    v_writelane_b32 v5, s18, 1
    s_lshl_b32 s18, s17, 7
    s_add_u32 s18, s18, 100761600
    v_writelane_b32 v5, s18, 2
    v_mov_b32 v6, 0
    buffer_store_dword v6, v5, s[4:7], 0 offen sc1
    s_mov_b64 exec, -1
    s_cmp_eq_u32 s90, 3
    s_cbranch_scc1 W_F
    s_load_dwordx2 s[8:9], s[0:1], 24
    s_mov_b32 s10, 4194304
    s_mov_b32 s11, 0x20000
    s_lshr_b32 s17, s2, 3
    s_lshl_b32 s17, s17, 15
    v_lshlrev_b32 v5, 7, v0
    s_waitcnt lgkmcnt(0)
    buffer_load_dword v254, v5, s[8:11], s17 offen
    s_cmp_lg_u32 s90, 0
    s_cbranch_scc1 W_P
    s_waitcnt vmcnt(0)
    s_barrier
    s_or_b32 s17, s16, s98
    s_cmp_lg_u32 s17, 0
    s_cbranch_scc1 vote_1
    s_lshl_b32 s17, s91, 14
    s_add_u32 s17, s17, 239075328
    v_lshlrev_b32 v5, 2, v1
    v_add_u32 v5, s17, v5
    v_add_u32 v6, 8192, v5
    s_mov_b32 s20, -1
    s_mov_b32 s21, -1
    s_mov_b64 exec, 1
    buffer_store_dword v1, v5, s[4:7], 0 offen sc1
    s_mov_b32 s22, 0
vp_2:
    s_add_u32 s22, s22, 1
    s_getreg_b32 s18, hwreg(HW_REG_IB_STS, 0, 4)
    s_cmp_lt_u32 s22, 2048
    s_cselect_b32 s18, s18, 0
    s_cmp_lg_u32 s18, 0
    s_cbranch_scc1 vp_2
    s_min_u32 s20, s20, s22
    buffer_store_dword v1, v6, s[4:7], 0 offen sc1
    s_mov_b32 s22, 0
vp_3:
    s_add_u32 s22, s22, 1
    s_getreg_b32 s18, hwreg(HW_REG_IB_STS, 0, 4)
    s_cmp_lt_u32 s22, 2048
    s_cselect_b32 s18, s18, 0
    s_cmp_lg_u32 s18, 0
    s_cbranch_scc1 vp_3
    s_min_u32 s21, s21, s22
    buffer_store_dword v1, v5, s[4:7], 0 offen sc1
    s_mov_b32 s22, 0
vp_4:
    s_add_u32 s22, s22, 1
    s_getreg_b32 s18, hwreg(HW_REG_IB_STS, 0, 4)
    s_cmp_lt_u32 s22, 2048
    s_cselect_b32 s18, s18, 0
    s_cmp_lg_u32 s18, 0
    s_cbranch_scc1 vp_4
    s_min_u32 s20, s20, s22
    buffer_store_dword v1, v6, s[4:7], 0 offen sc1
    s_mov_b32 s22, 0
vp_5:
    s_add_u32 s22, s22, 1
    s_getreg_b32 s18, hwreg(HW_REG_IB_STS, 0, 4)
    s_cmp_lt_u32 s22, 2048
    s_cselect_b32 s18, s18, 0
    s_cmp_lg_u32 s18, 0
    s_cbranch_scc1 vp_5
    s_min_u32 s21, s21, s22
    buffer_store_dword v1, v5, s[4:7], 0 offen sc1
    s_mov_b32 s22, 0
vp_6:
    s_add_u32 s22, s22, 1
    s_getreg_b32 s18, hwreg(HW_REG_IB_STS, 0, 4)
    s_cmp_lt_u32 s22, 2048
    s_cselect_b32 s18, s18, 0
    s_cmp_lg_u32 s18, 0
    s_cbranch_scc1 vp_6
    s_min_u32 s20, s20, s22
    buffer_store_dword v1, v6, s[4:7], 0 offen sc1
    s_mov_b32 s22, 0
vp_7:
    s_add_u32 s22, s22, 1
    s_getreg_b32 s18, hwreg(HW_REG_IB_STS, 0, 4)
    s_cmp_lt_u32 s22, 2048
    s_cselect_b32 s18, s18, 0
    s_cmp_lg_u32 s18, 0
    s_cbranch_scc1 vp_7
    s_min_u32 s21, s21, s22
    buffer_store_dword v1, v5, s[4:7], 0 offen sc1
    s_mov_b32 s22, 0
vp_8:
    s_add_u32 s22, s22, 1
    s_getreg_b32 s18, hwreg(HW_REG_IB_STS, 0, 4)
    s_cmp_lt_u32 s22, 2048
    s_cselect_b32 s18, s18, 0
    s_cmp_lg_u32 s18, 0
    s_cbranch_scc1 vp_8
    s_min_u32 s20, s20, s22
    buffer_store_dword v1, v6, s[4:7], 0 offen sc1
    s_mov_b32 s22, 0
vp_9:
    s_add_u32 s22, s22, 1
    s_getreg_b32 s18, hwreg(HW_REG_IB_STS, 0, 4)
    s_cmp_lt_u32 s22, 2048
    s_cselect_b32 s18, s18, 0
    s_cmp_lg_u32 s18, 0
    s_cbranch_scc1 vp_9
    s_min_u32 s21, s21, s22
    s_and_b32 s17, s97, 3
    s_lshl_b32 s17, s17, 3
    s_lshl_b32 s17, 0x40, s17
    s_cmp_lt_u32 s20, s21
    s_cselect_b32 s17, s17, 0
    s_andn2_b32 s18, s97, 3
    v_mov_b32 v5, s18
    v_mov_b32 v6, s17
    global_atomic_add v5, v6, s[100:101] sc1
    s_mov_b64 exec, -1
    s_waitcnt vmcnt(0)
vote_1:
    s_waitcnt vmcnt(0)
    s_barrier
    s_cmp_lg_u32 s16, 0
    s_cbranch_scc1 reg_10
    s_and_b32 s17, s2, 3
    s_lshl_b32 s17, s17, 3
    s_lshl_b32 s18, s98, 2
    s_add_u32 s17, s17, s18
    s_lshl_b32 s17, 1, s17
    s_andn2_b32 s18, s2, 3
    v_mov_b32 v5, s18
    v_mov_b32 v6, s17
    s_mov_b64 exec, 1
    global_atomic_add v5, v6, s[100:101] sc1
    s_mov_b64 exec, -1
reg_10:
W_P:
    s_load_dwordx2 s[12:13], s[0:1], 40
    s_load_dwordx2 s[28:29], s[0:1], 48
    s_load_dwordx2 s[30:31], s[0:1], 56
    s_load_dwordx2 s[8:9], s[0:1], 24
    s_mov_b32 s10, 4194304
    s_mov_b32 s11, 0x20000
    s_mov_b32 s14, 8388608
    s_mov_b32 s15, 0x20000
    s_waitcnt lgkmcnt(0)
    s_cmp_eq_u32 s90, 1
    s_cselect_b64 s[12:13], s[28:29], s[12:13]
    s_cmp_eq_u32 s90, 2
    s_cselect_b64 s[12:13], s[30:31], s[12:13]
    s_lshl_b32 s28, s93, 2
    s_add_u32 s28, s28, s16
    s_lshl_b32 s20, s28, 6
    v_lshrrev_b32 v5, 2, v1
    v_and_b32 v6, 3, v1
    v_lshlrev_b32 v8, 4, v6
    v_lshl_add_u32 v7, v5, 13, v8
    s_mul_i32 s19, s16, 40960
    s_and_b32 s17, s93, 3
    s_lshl_b32 s17, s17, 8
    v_add_lshl_u32 v2, v0, s17, 13
    s_andn2_b32 s17, s93, 3
    s_lshl_b32 s17, s17, 8
    buffer_load_dword v253, v2, s[12:15], s17 offen offset:384
    s_add_u32 m0, s19, 0
    s_nop 0
    buffer_load_dwordx4 v7, s[12:15], s20 offen lds
    s_add_u32 s20, s20, 131072
    s_add_u32 m0, s19, 1024
    s_nop 0
    buffer_load_dwordx4 v7, s[12:15], s20 offen lds
    s_add_u32 s20, s20, 131072
    s_add_u32 m0, s19, 2048
    s_nop 0
    buffer_load_dwordx4 v7, s[12:15], s20 offen lds
    s_add_u32 s20, s20, 131072
    s_add_u32 m0, s19, 3072
    s_nop 0
    buffer_load_dwordx4 v7, s[12:15], s20 offen lds
    s_add_u32 s20, s20, 131072
    v_bfe_u32 v5, v1, 2, 2
    v_lshrrev_b32 v6, 4, v1
    v_lshl_add_u32 v5, v6, 3, v5
    v_lshl_add_u32 v8, v5, 6, v8
    v_add_u32 v8, s19, v8
    s_cmp_eq_u32 s90, 0
    s_cbranch_scc1 nq_11
    s_waitcnt vmcnt(6)
    s_barrier
    s_cmp_lg_u32 s16, 0
    s_cbranch_scc1 reg_12
    s_and_b32 s17, s2, 3
    s_lshl_b32 s17, s17, 3
    s_lshl_b32 s18, s98, 2
    s_add_u32 s17, s17, s18
    s_lshl_b32 s17, 1, s17
    s_andn2_b32 s18, s2, 3
    v_mov_b32 v5, s18
    v_mov_b32 v6, s17
    s_mov_b64 exec, 1
    global_atomic_add v5, v6, s[100:101] sc1
    s_mov_b64 exec, -1
reg_12:
    s_barrier
nq_11:
    s_add_u32 m0, s19, 4096
    s_nop 0
    buffer_load_dwordx4 v7, s[12:15], s20 offen lds
    s_add_u32 s20, s20, 131072
    s_add_u32 m0, s19, 5120
    s_nop 0
    buffer_load_dwordx4 v7, s[12:15], s20 offen lds
    s_add_u32 s20, s20, 131072
    s_add_u32 m0, s19, 6144
    s_nop 0
    buffer_load_dwordx4 v7, s[12:15], s20 offen lds
    s_add_u32 s20, s20, 131072
    s_add_u32 m0, s19, 7168
    s_nop 0
    buffer_load_dwordx4 v7, s[12:15], s20 offen lds
    s_add_u32 s20, s20, 131072
    s_add_u32 m0, s19, 8192
    s_nop 0
    buffer_load_dwordx4 v7, s[12:15], s20 offen lds
    s_add_u32 s20, s20, 131072
    s_add_u32 m0, s19, 9216
    s_nop 0
    buffer_load_dwordx4 v7, s[12:15], s20 offen lds
    s_add_u32 s20, s20, 131072
    s_add_u32 m0, s19, 10240
    s_nop 0
    buffer_load_dwordx4 v7, s[12:15], s20 offen lds
    s_add_u32 s20, s20, 131072
    s_add_u32 m0, s19, 11264
    s_nop 0
    buffer_load_dwordx4 v7, s[12:15], s20 offen lds
    s_add_u32 s20, s20, 131072
    s_add_u32 m0, s19, 12288
    s_nop 0
    buffer_load_dwordx4 v7, s[12:15], s20 offen lds
    s_add_u32 s20, s20, 131072
    s_add_u32 m0, s19, 13312
    s_nop 0
    buffer_load_dwordx4 v7, s[12:15], s20 offen lds
    s_add_u32 s20, s20, 131072
    s_add_u32 m0, s19, 14336
    s_nop 0
    buffer_load_dwordx4 v7, s[12:15], s20 offen lds
    s_add_u32 s20, s20, 131072
    s_add_u32 m0, s19, 15360
    s_nop 0
    buffer_load_dwordx4 v7, s[12:15], s20 offen lds
    s_add_u32 s20, s20, 131072
    s_add_u32 m0, s19, 16384
    s_nop 0
    buffer_load_dwordx4 v7, s[12:15], s20 offen lds
    s_add_u32 s20, s20, 131072
    s_add_u32 m0, s19, 17408
    s_nop 0
    buffer_load_dwordx4 v7, s[12:15], s20 offen lds
    s_add_u32 s20, s20, 131072
    s_add_u32 m0, s19, 18432
    s_nop 0
    buffer_load_dwordx4 v7, s[12:15], s20 offen lds
    s_add_u32 s20, s20, 131072
    s_add_u32 m0, s19, 19456
    s_nop 0
    buffer_load_dwordx4 v7, s[12:15], s20 offen lds
    s_add_u32 s20, s20, 131072
    s_add_u32 m0, s19, 20480
    s_nop 0
    buffer_load_dwordx4 v7, s[12:15], s20 offen lds
    s_add_u32 s20, s20, 131072
    s_add_u32 m0, s19, 21504
    s_nop 0
    buffer_load_dwordx4 v7, s[12:15], s20 offen lds
    s_add_u32 s20, s20, 131072
    s_add_u32 m0, s19, 22528
    s_nop 0
    buffer_load_dwordx4 v7, s[12:15], s20 offen lds
    s_add_u32 s20, s20, 131072
    s_add_u32 m0, s19, 23552
    s_nop 0
    buffer_load_dwordx4 v7, s[12:15], s20 offen lds
    s_add_u32 s20, s20, 131072
    s_add_u32 m0, s19, 24576
    s_nop 0
    buffer_load_dwordx4 v7, s[12:15], s20 offen lds
    s_add_u32 s20, s20, 131072
    s_add_u32 m0, s19, 25600
    s_nop 0
    buffer_load_dwordx4 v7, s[12:15], s20 offen lds
    s_add_u32 s20, s20, 131072
    s_add_u32 m0, s19, 26624
    s_nop 0
    buffer_load_dwordx4 v7, s[12:15], s20 offen lds
    s_add_u32 s20, s20, 131072
    s_add_u32 m0, s19, 27648
    s_nop 0
    buffer_load_dwordx4 v7, s[12:15], s20 offen lds
    s_add_u32 s20, s20, 131072
    s_add_u32 m0, s19, 28672
    s_nop 0
    buffer_load_dwordx4 v7, s[12:15], s20 offen lds
    s_add_u32 s20, s20, 131072
    s_add_u32 m0, s19, 29696
    s_nop 0
    buffer_load_dwordx4 v7, s[12:15], s20 offen lds
    s_add_u32 s20, s20, 131072
    s_add_u32 m0, s19, 30720
    s_nop 0
    buffer_load_dwordx4 v7, s[12:15], s20 offen lds
    s_add_u32 s20, s20, 131072
    s_add_u32 m0, s19, 31744
    s_nop 0
    buffer_load_dwordx4 v7, s[12:15], s20 offen lds
    s_add_u32 s20, s20, 131072
    s_add_u32 m0, s19, 32768
    s_nop 0
    buffer_load_dwordx4 v7, s[12:15], s20 offen lds
    s_add_u32 s20, s20, 131072
    s_add_u32 m0, s19, 33792
    s_nop 0
    buffer_load_dwordx4 v7, s[12:15], s20 offen lds
    s_add_u32 s20, s20, 131072
    s_add_u32 m0, s19, 34816
    s_nop 0
    buffer_load_dwordx4 v7, s[12:15], s20 offen lds
    s_add_u32 s20, s20, 131072
    s_add_u32 m0, s19, 35840
    s_nop 0
    buffer_load_dwordx4 v7, s[12:15], s20 offen lds
    s_add_u32 s20, s20, 131072
    s_add_u32 m0, s19, 36864
    s_nop 0
    buffer_load_dwordx4 v7, s[12:15], s20 offen lds
    s_add_u32 s20, s20, 131072
    s_add_u32 m0, s19, 37888
    s_nop 0
    buffer_load_dwordx4 v7, s[12:15], s20 offen lds
    s_add_u32 s20, s20, 131072
    s_add_u32 m0, s19, 38912
    s_nop 0
    buffer_load_dwordx4 v7, s[12:15], s20 offen lds
    s_add_u32 s20, s20, 131072
    s_add_u32 m0, s19, 39936
    s_nop 0
    buffer_load_dwordx4 v7, s[12:15], s20 offen lds
    s_add_u32 s20, s20, 131072
    s_waitcnt vmcnt(38)
    ds_read_b64_tr_b16 a[0:1], v8 offset:0
    ds_read_b64_tr_b16 a[2:3], v8 offset:256
    ds_read_b64_tr_b16 a[4:5], v8 offset:8
    ds_read_b64_tr_b16 a[6:7], v8 offset:264
    s_waitcnt vmcnt(36)
    ds_read_b64_tr_b16 a[8:9], v8 offset:2048
    ds_read_b64_tr_b16 a[10:11], v8 offset:2304
    ds_read_b64_tr_b16 a[12:13], v8 offset:2056
    ds_read_b64_tr_b16 a[14:15], v8 offset:2312
    s_waitcnt lgkmcnt(4)
    s_add_u32 m0, s19, 0
    s_nop 0
    buffer_load_dwordx4 v7, s[12:15], s20 offen lds
    s_add_u32 s20, s20, 131072
    s_add_u32 m0, s19, 1024
    s_nop 0
    buffer_load_dwordx4 v7, s[12:15], s20 offen lds
    s_add_u32 s20, s20, 131072
    s_waitcnt vmcnt(36)
    ds_read_b64_tr_b16 a[16:17], v8 offset:4096
    ds_read_b64_tr_b16 a[18:19], v8 offset:4352
    ds_read_b64_tr_b16 a[20:21], v8 offset:4104
    ds_read_b64_tr_b16 a[22:23], v8 offset:4360
    s_waitcnt lgkmcnt(4)
    s_add_u32 m0, s19, 2048
    s_nop 0
    buffer_load_dwordx4 v7, s[12:15], s20 offen lds
    s_add_u32 s20, s20, 131072
    s_add_u32 m0, s19, 3072
    s_nop 0
    buffer_load_dwordx4 v7, s[12:15], s20 offen lds
    s_add_u32 s20, s20, 131072
    s_waitcnt vmcnt(36)
    ds_read_b64_tr_b16 a[24:25], v8 offset:6144
    ds_read_b64_tr_b16 a[26:27], v8 offset:6400
    ds_read_b64_tr_b16 a[28:29], v8 offset:6152
    ds_read_b64_tr_b16 a[30:31], v8 offset:6408
    s_waitcnt lgkmcnt(4)
    s_add_u32 m0, s19, 4096
    s_nop 0
    buffer_load_dwordx4 v7, s[12:15], s20 offen lds
    s_add_u32 s20, s20, 131072
    s_add_u32 m0, s19, 5120
    s_nop 0
    buffer_load_dwordx4 v7, s[12:15], s20 offen lds
    s_add_u32 s20, s20, 131072
    s_waitcnt vmcnt(36)
    ds_read_b64_tr_b16 a[32:33], v8 offset:8192
    ds_read_b64_tr_b16 a[34:35], v8 offset:8448
    ds_read_b64_tr_b16 a[36:37], v8 offset:8200
    ds_read_b64_tr_b16 a[38:39], v8 offset:8456
    s_waitcnt lgkmcnt(4)
    s_add_u32 m0, s19, 6144
    s_nop 0
    buffer_load_dwordx4 v7, s[12:15], s20 offen lds
    s_add_u32 s20, s20, 131072
    s_add_u32 m0, s19, 7168
    s_nop 0
    buffer_load_dwordx4 v7, s[12:15], s20 offen lds
    s_add_u32 s20, s20, 131072
    s_waitcnt vmcnt(36)
    ds_read_b64_tr_b16 a[40:41], v8 offset:10240
    ds_read_b64_tr_b16 a[42:43], v8 offset:10496
    ds_read_b64_tr_b16 a[44:45], v8 offset:10248
    ds_read_b64_tr_b16 a[46:47], v8 offset:10504
    s_waitcnt lgkmcnt(4)
    s_add_u32 m0, s19, 8192
    s_nop 0
    buffer_load_dwordx4 v7, s[12:15], s20 offen lds
    s_add_u32 s20, s20, 131072
    s_add_u32 m0, s19, 9216
    s_nop 0
    buffer_load_dwordx4 v7, s[12:15], s20 offen lds
    s_add_u32 s20, s20, 131072
    s_waitcnt vmcnt(36)
    ds_read_b64_tr_b16 a[48:49], v8 offset:12288
    ds_read_b64_tr_b16 a[50:51], v8 offset:12544
    ds_read_b64_tr_b16 a[52:53], v8 offset:12296
    ds_read_b64_tr_b16 a[54:55], v8 offset:12552
    s_waitcnt lgkmcnt(4)
    s_add_u32 m0, s19, 10240
    s_nop 0
    buffer_load_dwordx4 v7, s[12:15], s20 offen lds
    s_add_u32 s20, s20, 131072
    s_add_u32 m0, s19, 11264
    s_nop 0
    buffer_load_dwordx4 v7, s[12:15], s20 offen lds
    s_add_u32 s20, s20, 131072
    s_waitcnt vmcnt(36)
    ds_read_b64_tr_b16 a[56:57], v8 offset:14336
    ds_read_b64_tr_b16 a[58:59], v8 offset:14592
    ds_read_b64_tr_b16 a[60:61], v8 offset:14344
    ds_read_b64_tr_b16 a[62:63], v8 offset:14600
    s_waitcnt lgkmcnt(4)
    s_add_u32 m0, s19, 12288
    s_nop 0
    buffer_load_dwordx4 v7, s[12:15], s20 offen lds
    s_add_u32 s20, s20, 131072
    s_add_u32 m0, s19, 13312
    s_nop 0
    buffer_load_dwordx4 v7, s[12:15], s20 offen lds
    s_add_u32 s20, s20, 131072
    s_waitcnt vmcnt(36)
    ds_read_b64_tr_b16 a[64:65], v8 offset:16384
    ds_read_b64_tr_b16 a[66:67], v8 offset:16640
    ds_read_b64_tr_b16 a[68:69], v8 offset:16392
    ds_read_b64_tr_b16 a[70:71], v8 offset:16648
    s_waitcnt lgkmcnt(4)
    s_add_u32 m0, s19, 14336
    s_nop 0
    buffer_load_dwordx4 v7, s[12:15], s20 offen lds
    s_add_u32 s20, s20, 131072
    s_add_u32 m0, s19, 15360
    s_nop 0
    buffer_load_dwordx4 v7, s[12:15], s20 offen lds
    s_add_u32 s20, s20, 131072
    s_waitcnt vmcnt(36)
    ds_read_b64_tr_b16 a[72:73], v8 offset:18432
    ds_read_b64_tr_b16 a[74:75], v8 offset:18688
    ds_read_b64_tr_b16 a[76:77], v8 offset:18440
    ds_read_b64_tr_b16 a[78:79], v8 offset:18696
    s_waitcnt lgkmcnt(4)
    s_add_u32 m0, s19, 16384
    s_nop 0
    buffer_load_dwordx4 v7, s[12:15], s20 offen lds
    s_add_u32 s20, s20, 131072
    s_add_u32 m0, s19, 17408
    s_nop 0
    buffer_load_dwordx4 v7, s[12:15], s20 offen lds
    s_add_u32 s20, s20, 131072
    s_waitcnt vmcnt(36)
    ds_read_b64_tr_b16 a[80:81], v8 offset:20480
    ds_read_b64_tr_b16 a[82:83], v8 offset:20736
    ds_read_b64_tr_b16 a[84:85], v8 offset:20488
    ds_read_b64_tr_b16 a[86:87], v8 offset:20744
    s_waitcnt lgkmcnt(4)
    s_add_u32 m0, s19, 18432
    s_nop 0
    buffer_load_dwordx4 v7, s[12:15], s20 offen lds
    s_add_u32 s20, s20, 131072
    s_add_u32 m0, s19, 19456
    s_nop 0
    buffer_load_dwordx4 v7, s[12:15], s20 offen lds
    s_add_u32 s20, s20, 131072
    s_waitcnt vmcnt(36)
    ds_read_b64_tr_b16 a[88:89], v8 offset:22528
    ds_read_b64_tr_b16 a[90:91], v8 offset:22784
    ds_read_b64_tr_b16 a[92:93], v8 offset:22536
    ds_read_b64_tr_b16 a[94:95], v8 offset:22792
    s_waitcnt lgkmcnt(4)
    s_add_u32 m0, s19, 20480
    s_nop 0
    buffer_load_dwordx4 v7, s[12:15], s20 offen lds
    s_add_u32 s20, s20, 131072
    s_add_u32 m0, s19, 21504
    s_nop 0
    buffer_load_dwordx4 v7, s[12:15], s20 offen lds
    s_add_u32 s20, s20, 131072
    s_waitcnt vmcnt(36)
    ds_read_b64_tr_b16 a[96:97], v8 offset:24576
    ds_read_b64_tr_b16 a[98:99], v8 offset:24832
    ds_read_b64_tr_b16 a[100:101], v8 offset:24584
    ds_read_b64_tr_b16 a[102:103], v8 offset:24840
    s_waitcnt lgkmcnt(4)
    s_add_u32 m0, s19, 22528
    s_nop 0
    buffer_load_dwordx4 v7, s[12:15], s20 offen lds
    s_add_u32 s20, s20, 131072
    s_add_u32 m0, s19, 23552
    s_nop 0
    buffer_load_dwordx4 v7, s[12:15], s20 offen lds
    s_add_u32 s20, s20, 131072
    s_waitcnt vmcnt(36)
    ds_read_b64_tr_b16 a[104:105], v8 offset:26624
    ds_read_b64_tr_b16 a[106:107], v8 offset:26880
    ds_read_b64_tr_b16 a[108:109], v8 offset:26632
    ds_read_b64_tr_b16 a[110:111], v8 offset:26888
    s_waitcnt lgkmcnt(7)
    s_waitcnt vmcnt(34)
    ds_read_b64_tr_b16 a[112:113], v8 offset:28672
    ds_read_b64_tr_b16 a[114:115], v8 offset:28928
    ds_read_b64_tr_b16 a[116:117], v8 offset:28680
    ds_read_b64_tr_b16 a[118:119], v8 offset:28936
    s_waitcnt vmcnt(32)
    ds_read_b64_tr_b16 a[120:121], v8 offset:30720
    ds_read_b64_tr_b16 a[122:123], v8 offset:30976
    ds_read_b64_tr_b16 a[124:125], v8 offset:30728
    ds_read_b64_tr_b16 a[126:127], v8 offset:30984
    s_waitcnt lgkmcnt(7)
    s_waitcnt vmcnt(30)
    ds_read_b64_tr_b16 a[128:129], v8 offset:32768
    ds_read_b64_tr_b16 a[130:131], v8 offset:33024
    ds_read_b64_tr_b16 a[132:133], v8 offset:32776
    ds_read_b64_tr_b16 a[134:135], v8 offset:33032
    s_waitcnt vmcnt(28)
    ds_read_b64_tr_b16 a[136:137], v8 offset:34816
    ds_read_b64_tr_b16 a[138:139], v8 offset:35072
    ds_read_b64_tr_b16 a[140:141], v8 offset:34824
    ds_read_b64_tr_b16 a[142:143], v8 offset:35080
    s_waitcnt lgkmcnt(7)
    s_waitcnt vmcnt(26)
    ds_read_b64_tr_b16 a[144:145], v8 offset:36864
    ds_read_b64_tr_b16 a[146:147], v8 offset:37120
    ds_read_b64_tr_b16 a[148:149], v8 offset:36872
    ds_read_b64_tr_b16 a[150:151], v8 offset:37128
    s_waitcnt vmcnt(24)
    ds_read_b64_tr_b16 a[152:153], v8 offset:38912
    ds_read_b64_tr_b16 a[154:155], v8 offset:39168
    ds_read_b64_tr_b16 a[156:157], v8 offset:38920
    ds_read_b64_tr_b16 a[158:159], v8 offset:39176
    s_waitcnt lgkmcnt(7)
    s_waitcnt vmcnt(22)
    ds_read_b64_tr_b16 a[160:161], v8 offset:0
    ds_read_b64_tr_b16 a[162:163], v8 offset:256
    ds_read_b64_tr_b16 a[164:165], v8 offset:8
    ds_read_b64_tr_b16 a[166:167], v8 offset:264
    s_waitcnt vmcnt(20)
    ds_read_b64_tr_b16 a[168:169], v8 offset:2048
    ds_read_b64_tr_b16 a[170:171], v8 offset:2304
    ds_read_b64_tr_b16 a[172:173], v8 offset:2056
    ds_read_b64_tr_b16 a[174:175], v8 offset:2312
    s_waitcnt lgkmcnt(7)
    s_waitcnt vmcnt(18)
    ds_read_b64_tr_b16 a[176:177], v8 offset:4096
    ds_read_b64_tr_b16 a[178:179], v8 offset:4352
    ds_read_b64_tr_b16 a[180:181], v8 offset:4104
    ds_read_b64_tr_b16 a[182:183], v8 offset:4360
    s_waitcnt vmcnt(16)
    ds_read_b64_tr_b16 a[184:185], v8 offset:6144
    ds_read_b64_tr_b16 a[186:187], v8 offset:6400
    ds_read_b64_tr_b16 a[188:189], v8 offset:6152
    ds_read_b64_tr_b16 a[190:191], v8 offset:6408
    s_waitcnt lgkmcnt(7)
    s_waitcnt vmcnt(14)
    ds_read_b64_tr_b16 a[192:193], v8 offset:8192
    ds_read_b64_tr_b16 a[194:195], v8 offset:8448
    ds_read_b64_tr_b16 a[196:197], v8 offset:8200
    ds_read_b64_tr_b16 a[198:199], v8 offset:8456
    s_waitcnt vmcnt(12)
    ds_read_b64_tr_b16 a[200:201], v8 offset:10240
    ds_read_b64_tr_b16 a[202:203], v8 offset:10496
    ds_read_b64_tr_b16 a[204:205], v8 offset:10248
    ds_read_b64_tr_b16 a[206:207], v8 offset:10504
    s_waitcnt lgkmcnt(7)
    s_waitcnt vmcnt(10)
    ds_read_b64_tr_b16 a[208:209], v8 offset:12288
    ds_read_b64_tr_b16 a[210:211], v8 offset:12544
    ds_read_b64_tr_b16 a[212:213], v8 offset:12296
    ds_read_b64_tr_b16 a[214:215], v8 offset:12552
    s_waitcnt vmcnt(8)
    ds_read_b64_tr_b16 a[216:217], v8 offset:14336
    ds_read_b64_tr_b16 a[218:219], v8 offset:14592
    ds_read_b64_tr_b16 a[220:221], v8 offset:14344
    ds_read_b64_tr_b16 a[222:223], v8 offset:14600
    s_waitcnt lgkmcnt(7)
    s_waitcnt vmcnt(6)
    ds_read_b64_tr_b16 a[224:225], v8 offset:16384
    ds_read_b64_tr_b16 a[226:227], v8 offset:16640
    ds_read_b64_tr_b16 a[228:229], v8 offset:16392
    ds_read_b64_tr_b16 a[230:231], v8 offset:16648
    s_waitcnt vmcnt(4)
    ds_read_b64_tr_b16 a[232:233], v8 offset:18432
    ds_read_b64_tr_b16 a[234:235], v8 offset:18688
    ds_read_b64_tr_b16 a[236:237], v8 offset:18440
    ds_read_b64_tr_b16 a[238:239], v8 offset:18696
    s_waitcnt lgkmcnt(7)
    s_waitcnt vmcnt(2)
    ds_read_b64_tr_b16 a[240:241], v8 offset:20480
    ds_read_b64_tr_b16 a[242:243], v8 offset:20736
    ds_read_b64_tr_b16 a[244:245], v8 offset:20488
    ds_read_b64_tr_b16 a[246:247], v8 offset:20744
    s_waitcnt vmcnt(0)
    ds_read_b64_tr_b16 a[248:249], v8 offset:22528
    ds_read_b64_tr_b16 a[250:251], v8 offset:22784
    ds_read_b64_tr_b16 a[252:253], v8 offset:22536
    ds_read_b64_tr_b16 a[254:255], v8 offset:22792
    s_waitcnt lgkmcnt(7)
    s_waitcnt lgkmcnt(0)
    v_and_b32 v5, 15, v1
    v_bfe_u32 v6, v1, 1, 3
    v_lshrrev_b32 v7, 4, v1
    v_xor_b32 v6, v6, v7
    v_lshlrev_b32 v6, 4, v6
    v_lshl_add_u32 v10, v5, 7, v6
    s_lshl_b32 s19, s16, 10
    v_xor_b32 v11, 64, v10
    v_add_u32 v12, 0x10000, v10
    v_add_u32 v13, 0x10000, v11
    v_lshrrev_b32 v7, 3, v1
    s_lshl_b32 s17, s16, 3
    v_add_u32 v7, s17, v7
    v_bfe_u32 v8, v7, 1, 3
    v_xor_b32 v8, v8, v1
    v_and_b32 v8, 7, v8
    v_bfe_u32 v5, v7, 2, 2
    v_and_b32 v2, 3, v7
    v_lshl_add_u32 v2, v5, 3, v2
    v_bfe_u32 v5, v7, 4, 1
    v_lshl_add_u32 v2, v5, 2, v2
    v_bfe_u32 v5, v1, 2, 2
    v_and_b32 v3, 3, v1
    v_lshl_add_u32 v3, v5, 3, v3
    v_lshlrev_b32 v2, 11, v2
    v_lshl_add_u32 v2, v8, 4, v2
    v_and_b32 v5, 48, v1
    v_lshl_add_u32 v3, v3, 6, v5
    s_mul_i32 s21, s28, 133120
    s_mul_i32 s18, s90, 17825792
    s_add_u32 s21, s21, s18
    s_lshl_b32 s18, s90, 7
    s_add_u32 s17, s28, s18
    s_lshl_b32 s17, s17, 7
    s_add_u32 s17, s17, 100663296
    v_mov_b32 v4, s17
    v_mov_b32 v5, 1073741824
    v_cmp_eq_u32 vcc, 0, v1
    s_nop 1
    v_cndmask_b32 v4, v5, v4, vcc
    s_mov_b32 s20, 0
    s_mov_b32 s24, 65536
    s_mov_b32 s25, 2048
    s_barrier
    s_cmp_eq_u32 s90, 2
    s_cbranch_scc1 P_v
    s_mov_b32 s26, s25
    s_sub_u32 s25, s21, 1073741824
    s_mov_b32 s21, 1073741824
    s_mov_b32 s23, 0
    s_mov_b32 s22, 0
    s_add_u32 m0, s19, 0
    s_nop 0
    buffer_load_dwordx4 v2, s[8:11], s20 offen offset:0 lds
    s_add_u32 m0, s19, 3968
    s_nop 0
    buffer_load_dwordx4 v2, s[8:11], s20 offen offset:128 lds
    s_add_u32 m0, s19, 7936
    s_nop 0
    buffer_load_dwordx4 v2, s[8:11], s20 offen offset:256 lds
    s_add_u32 m0, s19, 11904
    s_nop 0
    buffer_load_dwordx4 v2, s[8:11], s20 offen offset:384 lds
    s_add_u32 m0, s19, 15872
    s_nop 0
    buffer_load_dwordx4 v2, s[8:11], s20 offen offset:512 lds
    s_add_u32 m0, s19, 19840
    s_nop 0
    buffer_load_dwordx4 v2, s[8:11], s20 offen offset:640 lds
    s_add_u32 m0, s19, 23808
    s_nop 0
    buffer_load_dwordx4 v2, s[8:11], s20 offen offset:768 lds
    s_add_u32 m0, s19, 27776
    s_nop 0
    buffer_load_dwordx4 v2, s[8:11], s20 offen offset:896 lds
    s_add_u32 m0, s19, 31744
    s_nop 0
    buffer_load_dwordx4 v2, s[8:11], s20 offen offset:1024 lds
    s_add_u32 m0, s19, 35712
    s_nop 0
    buffer_load_dwordx4 v2, s[8:11], s20 offen offset:1152 lds
    s_add_u32 m0, s19, 39680
    s_nop 0
    buffer_load_dwordx4 v2, s[8:11], s20 offen offset:1280 lds
    s_add_u32 m0, s19, 43648
    s_nop 0
    buffer_load_dwordx4 v2, s[8:11], s20 offen offset:1408 lds
    s_add_u32 m0, s19, 47616
    s_nop 0
    buffer_load_dwordx4 v2, s[8:11], s20 offen offset:1536 lds
    s_add_u32 m0, s19, 51584
    s_nop 0
    buffer_load_dwordx4 v2, s[8:11], s20 offen offset:1664 lds
    s_add_u32 m0, s19, 55552
    s_nop 0
    buffer_load_dwordx4 v2, s[8:11], s20 offen offset:1792 lds
    s_add_u32 m0, s19, 59520
    s_nop 0
    buffer_load_dwordx4 v2, s[8:11], s20 offen offset:1920 lds
    s_add_u32 s20, s20, s24
    s_add_u32 m0, s19, 65536
    s_nop 0
    buffer_load_dwordx4 v2, s[8:11], s20 offen offset:0 lds
    s_add_u32 m0, s19, 69504
    s_nop 0
    buffer_load_dwordx4 v2, s[8:11], s20 offen offset:128 lds
    s_add_u32 m0, s19, 73472
    s_nop 0
    buffer_load_dwordx4 v2, s[8:11], s20 offen offset:256 lds
    v_mov_b32 v9, s23
    s_add_u32 s23, s23, 1
    buffer_store_dword v9, v4, s[4:7], 0 offen sc1
    s_mov_b32 s23, 0
    s_waitcnt vmcnt(12)
    s_barrier
    ds_read_b128 v[20:23], v10 offset:0
    ds_read_b128 v[24:27], v10 offset:2048
    ds_read_b128 v[28:31], v11 offset:0
    ds_read_b128 v[32:35], v11 offset:2048
    ds_read_b128 v[36:39], v10 offset:4096
    ds_read_b128 v[40:43], v10 offset:6144
    ds_read_b128 v[44:47], v11 offset:4096
.p2align 6
P_qk_top:
    s_waitcnt lgkmcnt(6)
    v_mfma_f32_16x16x32_bf16 v[52:55], a[0:3], v[20:23], 0
    ds_read_b128 v[48:51], v11 offset:6144
    v_mfma_f32_16x16x32_bf16 v[56:59], a[4:7], v[20:23], 0
    s_waitcnt lgkmcnt(6)
    v_mfma_f32_16x16x32_bf16 v[60:63], a[0:3], v[24:27], 0
    ds_read_b128 v[20:23], v10 offset:8192
    s_add_u32 m0, s19, 77440
    v_mfma_f32_16x16x32_bf16 v[64:67], a[4:7], v[24:27], 0
    buffer_load_dwordx4 v2, s[8:11], s20 offen offset:384 lds
    s_waitcnt lgkmcnt(6)
    v_mfma_f32_16x16x32_bf16 v[52:55], a[8:11], v[28:31], v[52:55]
    ds_read_b128 v[24:27], v10 offset:10240
    v_mfma_f32_16x16x32_bf16 v[56:59], a[12:15], v[28:31], v[56:59]
    s_waitcnt lgkmcnt(6)
    v_mfma_f32_16x16x32_bf16 v[60:63], a[8:11], v[32:35], v[60:63]
    ds_read_b128 v[28:31], v11 offset:8192
    s_add_u32 m0, s19, 81408
    v_mfma_f32_16x16x32_bf16 v[64:67], a[12:15], v[32:35], v[64:67]
    buffer_load_dwordx4 v2, s[8:11], s20 offen offset:512 lds
    s_waitcnt lgkmcnt(6)
    v_mfma_f32_16x16x32_bf16 v[52:55], a[16:19], v[36:39], v[52:55]
    ds_read_b128 v[32:35], v11 offset:10240
    v_mfma_f32_16x16x32_bf16 v[56:59], a[20:23], v[36:39], v[56:59]
    s_waitcnt lgkmcnt(6)
    v_mfma_f32_16x16x32_bf16 v[60:63], a[16:19], v[40:43], v[60:63]
    ds_read_b128 v[36:39], v10 offset:12288
    s_add_u32 m0, s19, 85376
    v_mfma_f32_16x16x32_bf16 v[64:67], a[20:23], v[40:43], v[64:67]
    buffer_load_dwordx4 v2, s[8:11], s20 offen offset:640 lds
    s_waitcnt lgkmcnt(6)
    v_mfma_f32_16x16x32_bf16 v[52:55], a[24:27], v[44:47], v[52:55]
    ds_read_b128 v[40:43], v10 offset:14336
    v_mfma_f32_16x16x32_bf16 v[56:59], a[28:31], v[44:47], v[56:59]
    s_waitcnt lgkmcnt(6)
    v_mfma_f32_16x16x32_bf16 v[60:63], a[24:27], v[48:51], v[60:63]
    ds_read_b128 v[44:47], v11 offset:12288
    s_add_u32 m0, s19, 89344
    v_mfma_f32_16x16x32_bf16 v[64:67], a[28:31], v[48:51], v[64:67]
    buffer_load_dwordx4 v2, s[8:11], s20 offen offset:768 lds
    s_waitcnt lgkmcnt(6)
    v_mfma_f32_16x16x32_bf16 v[52:55], a[32:35], v[20:23], v[52:55]
    ds_read_b128 v[48:51], v11 offset:14336
    v_mfma_f32_16x16x32_bf16 v[56:59], a[36:39], v[20:23], v[56:59]
    s_waitcnt lgkmcnt(6)
    v_mfma_f32_16x16x32_bf16 v[60:63], a[32:35], v[24:27], v[60:63]
    ds_read_b128 v[20:23], v10 offset:16384
    s_add_u32 m0, s19, 93312
    v_mfma_f32_16x16x32_bf16 v[64:67], a[36:39], v[24:27], v[64:67]
    buffer_load_dwordx4 v2, s[8:11], s20 offen offset:896 lds
    s_waitcnt lgkmcnt(6)
    v_mfma_f32_16x16x32_bf16 v[52:55], a[40:43], v[28:31], v[52:55]
    ds_read_b128 v[24:27], v10 offset:18432
    v_mfma_f32_16x16x32_bf16 v[56:59], a[44:47], v[28:31], v[56:59]
    v_cvt_pk_bf16_f32 v84, v68, v69
    s_waitcnt lgkmcnt(6)
    v_mfma_f32_16x16x32_bf16 v[60:63], a[40:43], v[32:35], v[60:63]
    ds_read_b128 v[28:31], v11 offset:16384
    v_mfma_f32_16x16x32_bf16 v[64:67], a[44:47], v[32:35], v[64:67]
    v_cvt_pk_bf16_f32 v85, v70, v71
    s_waitcnt lgkmcnt(6)
    v_mfma_f32_16x16x32_bf16 v[52:55], a[48:51], v[36:39], v[52:55]
    ds_read_b128 v[32:35], v11 offset:18432
    v_mfma_f32_16x16x32_bf16 v[56:59], a[52:55], v[36:39], v[56:59]
    v_cvt_pk_bf16_f32 v86, v72, v73
    s_waitcnt lgkmcnt(6)
    v_mfma_f32_16x16x32_bf16 v[60:63], a[48:51], v[40:43], v[60:63]
    ds_read_b128 v[36:39], v10 offset:20480
    v_mfma_f32_16x16x32_bf16 v[64:67], a[52:55], v[40:43], v[64:67]
    v_cvt_pk_bf16_f32 v87, v74, v75
    s_waitcnt lgkmcnt(6)
    v_mfma_f32_16x16x32_bf16 v[52:55], a[56:59], v[44:47], v[52:55]
    ds_read_b128 v[40:43], v10 offset:22528
    v_mfma_f32_16x16x32_bf16 v[56:59], a[60:63], v[44:47], v[56:59]
    v_cvt_pk_bf16_f32 v88, v76, v77
    s_waitcnt lgkmcnt(6)
    v_mfma_f32_16x16x32_bf16 v[60:63], a[56:59], v[48:51], v[60:63]
    ds_read_b128 v[44:47], v11 offset:20480
    v_mfma_f32_16x16x32_bf16 v[64:67], a[60:63], v[48:51], v[64:67]
    v_cvt_pk_bf16_f32 v89, v78, v79
    buffer_store_dwordx4 v[84:87], v3, s[4:7], s21 offen offset:0 sc1
    s_waitcnt lgkmcnt(6)
    v_mfma_f32_16x16x32_bf16 v[52:55], a[64:67], v[20:23], v[52:55]
    ds_read_b128 v[48:51], v11 offset:22528
    v_mfma_f32_16x16x32_bf16 v[56:59], a[68:71], v[20:23], v[56:59]
    v_cvt_pk_bf16_f32 v90, v80, v81
    s_waitcnt lgkmcnt(6)
    v_mfma_f32_16x16x32_bf16 v[60:63], a[64:67], v[24:27], v[60:63]
    ds_read_b128 v[20:23], v10 offset:24576
    v_mfma_f32_16x16x32_bf16 v[64:67], a[68:71], v[24:27], v[64:67]
    v_cvt_pk_bf16_f32 v91, v82, v83
    s_waitcnt lgkmcnt(6)
    v_mfma_f32_16x16x32_bf16 v[52:55], a[72:75], v[28:31], v[52:55]
    ds_read_b128 v[24:27], v10 offset:26624
    v_mfma_f32_16x16x32_bf16 v[56:59], a[76:79], v[28:31], v[56:59]
    s_waitcnt lgkmcnt(6)
    v_mfma_f32_16x16x32_bf16 v[60:63], a[72:75], v[32:35], v[60:63]
    ds_read_b128 v[28:31], v11 offset:24576
    v_mfma_f32_16x16x32_bf16 v[64:67], a[76:79], v[32:35], v[64:67]
    buffer_store_dwordx4 v[88:91], v3, s[4:7], s21 offen offset:256 sc1
    s_waitcnt lgkmcnt(6)
    v_mfma_f32_16x16x32_bf16 v[52:55], a[80:83], v[36:39], v[52:55]
    ds_read_b128 v[32:35], v11 offset:26624
    v_mfma_f32_16x16x32_bf16 v[56:59], a[84:87], v[36:39], v[56:59]
    s_add_u32 s21, s21, s25
    s_mov_b32 s25, s26
    s_waitcnt lgkmcnt(6)
    v_mfma_f32_16x16x32_bf16 v[60:63], a[80:83], v[40:43], v[60:63]
    ds_read_b128 v[36:39], v10 offset:28672
    v_mfma_f32_16x16x32_bf16 v[64:67], a[84:87], v[40:43], v[64:67]
    s_waitcnt lgkmcnt(6)
    v_mfma_f32_16x16x32_bf16 v[52:55], a[88:91], v[44:47], v[52:55]
    ds_read_b128 v[40:43], v10 offset:30720
    v_mfma_f32_16x16x32_bf16 v[56:59], a[92:95], v[44:47], v[56:59]
    s_waitcnt lgkmcnt(6)
    v_mfma_f32_16x16x32_bf16 v[60:63], a[88:91], v[48:51], v[60:63]
    ds_read_b128 v[44:47], v11 offset:28672
    v_mfma_f32_16x16x32_bf16 v[64:67], a[92:95], v[48:51], v[64:67]
    s_waitcnt lgkmcnt(6)
    v_mfma_f32_16x16x32_bf16 v[52:55], a[96:99], v[20:23], v[52:55]
    ds_read_b128 v[48:51], v11 offset:30720
    v_mfma_f32_16x16x32_bf16 v[56:59], a[100:103], v[20:23], v[56:59]
    s_waitcnt lgkmcnt(6)
    v_mfma_f32_16x16x32_bf16 v[60:63], a[96:99], v[24:27], v[60:63]
    s_waitcnt vmcnt(11)
    s_barrier
    ds_read_b128 v[20:23], v10 offset:32768
    v_mfma_f32_16x16x32_bf16 v[64:67], a[100:103], v[24:27], v[64:67]
    s_waitcnt lgkmcnt(6)
    v_mfma_f32_16x16x32_bf16 v[52:55], a[104:107], v[28:31], v[52:55]
    ds_read_b128 v[24:27], v10 offset:34816
    s_add_u32 m0, s19, 97280
    v_mfma_f32_16x16x32_bf16 v[56:59], a[108:111], v[28:31], v[56:59]
    buffer_load_dwordx4 v2, s[8:11], s20 offen offset:1024 lds
    s_waitcnt lgkmcnt(6)
    v_mfma_f32_16x16x32_bf16 v[60:63], a[104:107], v[32:35], v[60:63]
    ds_read_b128 v[28:31], v11 offset:32768
    v_mfma_f32_16x16x32_bf16 v[64:67], a[108:111], v[32:35], v[64:67]
    s_waitcnt lgkmcnt(6)
    v_mfma_f32_16x16x32_bf16 v[52:55], a[112:115], v[36:39], v[52:55]
    ds_read_b128 v[32:35], v11 offset:34816
    s_add_u32 m0, s19, 101248
    v_mfma_f32_16x16x32_bf16 v[56:59], a[116:119], v[36:39], v[56:59]
    buffer_load_dwordx4 v2, s[8:11], s20 offen offset:1152 lds
    s_waitcnt lgkmcnt(6)
    v_mfma_f32_16x16x32_bf16 v[60:63], a[112:115], v[40:43], v[60:63]
    ds_read_b128 v[36:39], v10 offset:36864
    v_mfma_f32_16x16x32_bf16 v[64:67], a[116:119], v[40:43], v[64:67]
    s_waitcnt lgkmcnt(6)
    v_mfma_f32_16x16x32_bf16 v[52:55], a[120:123], v[44:47], v[52:55]
    ds_read_b128 v[40:43], v10 offset:38912
    s_add_u32 m0, s19, 105216
    v_mfma_f32_16x16x32_bf16 v[56:59], a[124:127], v[44:47], v[56:59]
    buffer_load_dwordx4 v2, s[8:11], s20 offen offset:1280 lds
    s_waitcnt lgkmcnt(6)
    v_mfma_f32_16x16x32_bf16 v[60:63], a[120:123], v[48:51], v[60:63]
    ds_read_b128 v[44:47], v11 offset:36864
    v_mfma_f32_16x16x32_bf16 v[64:67], a[124:127], v[48:51], v[64:67]
    s_waitcnt lgkmcnt(6)
    v_mfma_f32_16x16x32_bf16 v[52:55], a[128:131], v[20:23], v[52:55]
    ds_read_b128 v[48:51], v11 offset:38912
    v_mfma_f32_16x16x32_bf16 v[56:59], a[132:135], v[20:23], v[56:59]
    s_waitcnt lgkmcnt(6)
    v_mfma_f32_16x16x32_bf16 v[60:63], a[128:131], v[24:27], v[60:63]
    ds_read_b128 v[20:23], v10 offset:40960
    s_add_u32 m0, s19, 109184
    v_mfma_f32_16x16x32_bf16 v[64:67], a[132:135], v[24:27], v[64:67]
    buffer_load_dwordx4 v2, s[8:11], s20 offen offset:1408 lds
    s_waitcnt lgkmcnt(6)
    v_mfma_f32_16x16x32_bf16 v[52:55], a[136:139], v[28:31], v[52:55]
    ds_read_b128 v[24:27], v10 offset:43008
    v_mfma_f32_16x16x32_bf16 v[56:59], a[140:143], v[28:31], v[56:59]
    s_waitcnt lgkmcnt(6)
    v_mfma_f32_16x16x32_bf16 v[60:63], a[136:139], v[32:35], v[60:63]
    ds_read_b128 v[28:31], v11 offset:40960
    s_add_u32 m0, s19, 113152
    v_mfma_f32_16x16x32_bf16 v[64:67], a[140:143], v[32:35], v[64:67]
    buffer_load_dwordx4 v2, s[8:11], s20 offen offset:1536 lds
    s_waitcnt lgkmcnt(6)
    v_mfma_f32_16x16x32_bf16 v[52:55], a[144:147], v[36:39], v[52:55]
    ds_read_b128 v[32:35], v11 offset:43008
    v_mfma_f32_16x16x32_bf16 v[56:59], a[148:151], v[36:39], v[56:59]
    s_waitcnt lgkmcnt(6)
    v_mfma_f32_16x16x32_bf16 v[60:63], a[144:147], v[40:43], v[60:63]
    ds_read_b128 v[36:39], v10 offset:45056
    s_add_u32 m0, s19, 117120
    v_mfma_f32_16x16x32_bf16 v[64:67], a[148:151], v[40:43], v[64:67]
    buffer_load_dwordx4 v2, s[8:11], s20 offen offset:1664 lds
    s_waitcnt lgkmcnt(6)
    v_mfma_f32_16x16x32_bf16 v[52:55], a[152:155], v[44:47], v[52:55]
    ds_read_b128 v[40:43], v10 offset:47104
    v_mfma_f32_16x16x32_bf16 v[56:59], a[156:159], v[44:47], v[56:59]
    s_waitcnt lgkmcnt(6)
    v_mfma_f32_16x16x32_bf16 v[60:63], a[152:155], v[48:51], v[60:63]
    ds_read_b128 v[44:47], v11 offset:45056
    s_add_u32 m0, s19, 121088
    v_mfma_f32_16x16x32_bf16 v[64:67], a[156:159], v[48:51], v[64:67]
    buffer_load_dwordx4 v2, s[8:11], s20 offen offset:1792 lds
    s_waitcnt lgkmcnt(6)
    v_mfma_f32_16x16x32_bf16 v[52:55], a[160:163], v[20:23], v[52:55]
    ds_read_b128 v[48:51], v11 offset:47104
    v_mfma_f32_16x16x32_bf16 v[56:59], a[164:167], v[20:23], v[56:59]
    s_waitcnt lgkmcnt(6)
    v_mfma_f32_16x16x32_bf16 v[60:63], a[160:163], v[24:27], v[60:63]
    ds_read_b128 v[20:23], v10 offset:49152
    s_add_u32 m0, s19, 125056
    v_mfma_f32_16x16x32_bf16 v[64:67], a[164:167], v[24:27], v[64:67]
    buffer_load_dwordx4 v2, s[8:11], s20 offen offset:1920 lds
    s_waitcnt lgkmcnt(6)
    v_mfma_f32_16x16x32_bf16 v[52:55], a[168:171], v[28:31], v[52:55]
    ds_read_b128 v[24:27], v10 offset:51200
    v_mfma_f32_16x16x32_bf16 v[56:59], a[172:175], v[28:31], v[56:59]
    s_add_u32 s20, s20, s24
    s_waitcnt lgkmcnt(6)
    v_mfma_f32_16x16x32_bf16 v[60:63], a[168:171], v[32:35], v[60:63]
    ds_read_b128 v[28:31], v11 offset:49152
    v_mfma_f32_16x16x32_bf16 v[64:67], a[172:175], v[32:35], v[64:67]
    s_waitcnt lgkmcnt(6)
    v_mfma_f32_16x16x32_bf16 v[52:55], a[176:179], v[36:39], v[52:55]
    ds_read_b128 v[32:35], v11 offset:51200
    v_mfma_f32_16x16x32_bf16 v[56:59], a[180:183], v[36:39], v[56:59]
    s_waitcnt lgkmcnt(6)
    v_mfma_f32_16x16x32_bf16 v[60:63], a[176:179], v[40:43], v[60:63]
    ds_read_b128 v[36:39], v10 offset:53248
    v_mfma_f32_16x16x32_bf16 v[64:67], a[180:183], v[40:43], v[64:67]
    s_waitcnt lgkmcnt(6)
    v_mfma_f32_16x16x32_bf16 v[52:55], a[184:187], v[44:47], v[52:55]
    ds_read_b128 v[40:43], v10 offset:55296
    v_mfma_f32_16x16x32_bf16 v[56:59], a[188:191], v[44:47], v[56:59]
    s_waitcnt lgkmcnt(6)
    v_mfma_f32_16x16x32_bf16 v[60:63], a[184:187], v[48:51], v[60:63]
    ds_read_b128 v[44:47], v11 offset:53248
    v_mfma_f32_16x16x32_bf16 v[64:67], a[188:191], v[48:51], v[64:67]
    s_waitcnt lgkmcnt(6)
    v_mfma_f32_16x16x32_bf16 v[52:55], a[192:195], v[20:23], v[52:55]
    ds_read_b128 v[48:51], v11 offset:55296
    v_mfma_f32_16x16x32_bf16 v[56:59], a[196:199], v[20:23], v[56:59]
    s_waitcnt lgkmcnt(6)
    v_mfma_f32_16x16x32_bf16 v[60:63], a[192:195], v[24:27], v[60:63]
    ds_read_b128 v[20:23], v10 offset:57344
    v_mfma_f32_16x16x32_bf16 v[64:67], a[196:199], v[24:27], v[64:67]
    s_waitcnt lgkmcnt(6)
    v_mfma_f32_16x16x32_bf16 v[52:55], a[200:203], v[28:31], v[52:55]
    ds_read_b128 v[24:27], v10 offset:59392
    v_mfma_f32_16x16x32_bf16 v[56:59], a[204:207], v[28:31], v[56:59]
    s_waitcnt lgkmcnt(6)
    v_mfma_f32_16x16x32_bf16 v[60:63], a[200:203], v[32:35], v[60:63]
    ds_read_b128 v[28:31], v11 offset:57344
    v_mfma_f32_16x16x32_bf16 v[64:67], a[204:207], v[32:35], v[64:67]
    s_waitcnt lgkmcnt(6)
    v_mfma_f32_16x16x32_bf16 v[52:55], a[208:211], v[36:39], v[52:55]
    ds_read_b128 v[32:35], v11 offset:59392
    v_mfma_f32_16x16x32_bf16 v[56:59], a[212:215], v[36:39], v[56:59]
    s_waitcnt lgkmcnt(6)
    v_mfma_f32_16x16x32_bf16 v[60:63], a[208:211], v[40:43], v[60:63]
    ds_read_b128 v[36:39], v10 offset:61440
    v_mfma_f32_16x16x32_bf16 v[64:67], a[212:215], v[40:43], v[64:67]
    s_waitcnt lgkmcnt(6)
    v_mfma_f32_16x16x32_bf16 v[52:55], a[216:219], v[44:47], v[52:55]
    ds_read_b128 v[40:43], v10 offset:63488
    v_mfma_f32_16x16x32_bf16 v[56:59], a[220:223], v[44:47], v[56:59]
    s_waitcnt lgkmcnt(6)
    v_mfma_f32_16x16x32_bf16 v[60:63], a[216:219], v[48:51], v[60:63]
    ds_read_b128 v[44:47], v11 offset:61440
    v_mfma_f32_16x16x32_bf16 v[64:67], a[220:223], v[48:51], v[64:67]
    s_waitcnt lgkmcnt(6)
    v_mfma_f32_16x16x32_bf16 v[52:55], a[224:227], v[20:23], v[52:55]
    ds_read_b128 v[48:51], v11 offset:63488
    v_mfma_f32_16x16x32_bf16 v[56:59], a[228:231], v[20:23], v[56:59]
    s_waitcnt lgkmcnt(6)
    v_mfma_f32_16x16x32_bf16 v[60:63], a[224:227], v[24:27], v[60:63]
    s_waitcnt vmcnt(8)
    s_barrier
    ds_read_b128 v[20:23], v12 offset:0
    v_mfma_f32_16x16x32_bf16 v[64:67], a[228:231], v[24:27], v[64:67]
    s_waitcnt lgkmcnt(6)
    v_mfma_f32_16x16x32_bf16 v[52:55], a[232:235], v[28:31], v[52:55]
    ds_read_b128 v[24:27], v12 offset:2048
    s_add_u32 m0, s19, 0
    v_mfma_f32_16x16x32_bf16 v[56:59], a[236:239], v[28:31], v[56:59]
    buffer_load_dwordx4 v2, s[8:11], s20 offen offset:0 lds
    s_waitcnt lgkmcnt(6)
    v_mfma_f32_16x16x32_bf16 v[60:63], a[232:235], v[32:35], v[60:63]
    ds_read_b128 v[28:31], v13 offset:0
    v_mfma_f32_16x16x32_bf16 v[64:67], a[236:239], v[32:35], v[64:67]
    v_mov_b32 v9, s23
    s_add_u32 s23, s23, 1
    buffer_store_dword v9, v4, s[4:7], 0 offen sc1
    s_waitcnt lgkmcnt(6)
    v_mfma_f32_16x16x32_bf16 v[52:55], a[240:243], v[36:39], v[52:55]
    ds_read_b128 v[32:35], v13 offset:2048
    s_add_u32 m0, s19, 3968
    v_mfma_f32_16x16x32_bf16 v[56:59], a[244:247], v[36:39], v[56:59]
    buffer_load_dwordx4 v2, s[8:11], s20 offen offset:128 lds
    s_waitcnt lgkmcnt(6)
    v_mfma_f32_16x16x32_bf16 v[60:63], a[240:243], v[40:43], v[60:63]
    ds_read_b128 v[36:39], v12 offset:4096
    v_mfma_f32_16x16x32_bf16 v[64:67], a[244:247], v[40:43], v[64:67]
    s_waitcnt lgkmcnt(6)
    v_mfma_f32_16x16x32_bf16 v[52:55], a[248:251], v[44:47], v[52:55]
    ds_read_b128 v[40:43], v12 offset:6144
    s_add_u32 m0, s19, 7936
    v_mfma_f32_16x16x32_bf16 v[56:59], a[252:255], v[44:47], v[56:59]
    buffer_load_dwordx4 v2, s[8:11], s20 offen offset:256 lds
    s_waitcnt lgkmcnt(6)
    v_mfma_f32_16x16x32_bf16 v[60:63], a[248:251], v[48:51], v[60:63]
    ds_read_b128 v[44:47], v13 offset:4096
    v_mfma_f32_16x16x32_bf16 v[64:67], a[252:255], v[48:51], v[64:67]
    s_waitcnt lgkmcnt(6)
    v_mfma_f32_16x16x32_bf16 v[68:71], a[0:3], v[20:23], 0
    ds_read_b128 v[48:51], v13 offset:6144
    v_mfma_f32_16x16x32_bf16 v[72:75], a[4:7], v[20:23], 0
    s_waitcnt lgkmcnt(6)
    v_mfma_f32_16x16x32_bf16 v[76:79], a[0:3], v[24:27], 0
    ds_read_b128 v[20:23], v12 offset:8192
    s_add_u32 m0, s19, 11904
    v_mfma_f32_16x16x32_bf16 v[80:83], a[4:7], v[24:27], 0
    buffer_load_dwordx4 v2, s[8:11], s20 offen offset:384 lds
    s_waitcnt lgkmcnt(6)
    v_mfma_f32_16x16x32_bf16 v[68:71], a[8:11], v[28:31], v[68:71]
    ds_read_b128 v[24:27], v12 offset:10240
    v_mfma_f32_16x16x32_bf16 v[72:75], a[12:15], v[28:31], v[72:75]
    s_waitcnt lgkmcnt(6)
    v_mfma_f32_16x16x32_bf16 v[76:79], a[8:11], v[32:35], v[76:79]
    ds_read_b128 v[28:31], v13 offset:8192
    s_add_u32 m0, s19, 15872
    v_mfma_f32_16x16x32_bf16 v[80:83], a[12:15], v[32:35], v[80:83]
    buffer_load_dwordx4 v2, s[8:11], s20 offen offset:512 lds
    s_waitcnt lgkmcnt(6)
    v_mfma_f32_16x16x32_bf16 v[68:71], a[16:19], v[36:39], v[68:71]
    ds_read_b128 v[32:35], v13 offset:10240
    v_mfma_f32_16x16x32_bf16 v[72:75], a[20:23], v[36:39], v[72:75]
    s_waitcnt lgkmcnt(6)
    v_mfma_f32_16x16x32_bf16 v[76:79], a[16:19], v[40:43], v[76:79]
    ds_read_b128 v[36:39], v12 offset:12288
    s_add_u32 m0, s19, 19840
    v_mfma_f32_16x16x32_bf16 v[80:83], a[20:23], v[40:43], v[80:83]
    buffer_load_dwordx4 v2, s[8:11], s20 offen offset:640 lds
    s_waitcnt lgkmcnt(6)
    v_mfma_f32_16x16x32_bf16 v[68:71], a[24:27], v[44:47], v[68:71]
    ds_read_b128 v[40:43], v12 offset:14336
    v_mfma_f32_16x16x32_bf16 v[72:75], a[28:31], v[44:47], v[72:75]
    s_waitcnt lgkmcnt(6)
    v_mfma_f32_16x16x32_bf16 v[76:79], a[24:27], v[48:51], v[76:79]
    ds_read_b128 v[44:47], v13 offset:12288
    s_add_u32 m0, s19, 23808
    v_mfma_f32_16x16x32_bf16 v[80:83], a[28:31], v[48:51], v[80:83]
    buffer_load_dwordx4 v2, s[8:11], s20 offen offset:768 lds
    s_waitcnt lgkmcnt(6)
    v_mfma_f32_16x16x32_bf16 v[68:71], a[32:35], v[20:23], v[68:71]
    ds_read_b128 v[48:51], v13 offset:14336
    v_mfma_f32_16x16x32_bf16 v[72:75], a[36:39], v[20:23], v[72:75]
    s_waitcnt lgkmcnt(6)
    v_mfma_f32_16x16x32_bf16 v[76:79], a[32:35], v[24:27], v[76:79]
    ds_read_b128 v[20:23], v12 offset:16384
    s_add_u32 m0, s19, 27776
    v_mfma_f32_16x16x32_bf16 v[80:83], a[36:39], v[24:27], v[80:83]
    buffer_load_dwordx4 v2, s[8:11], s20 offen offset:896 lds
    s_waitcnt lgkmcnt(6)
    v_mfma_f32_16x16x32_bf16 v[68:71], a[40:43], v[28:31], v[68:71]
    ds_read_b128 v[24:27], v12 offset:18432
    v_mfma_f32_16x16x32_bf16 v[72:75], a[44:47], v[28:31], v[72:75]
    v_cvt_pk_bf16_f32 v84, v52, v53
    s_waitcnt lgkmcnt(6)
    v_mfma_f32_16x16x32_bf16 v[76:79], a[40:43], v[32:35], v[76:79]
    ds_read_b128 v[28:31], v13 offset:16384
    v_mfma_f32_16x16x32_bf16 v[80:83], a[44:47], v[32:35], v[80:83]
    v_cvt_pk_bf16_f32 v85, v54, v55
    s_waitcnt lgkmcnt(6)
    v_mfma_f32_16x16x32_bf16 v[68:71], a[48:51], v[36:39], v[68:71]
    ds_read_b128 v[32:35], v13 offset:18432
    v_mfma_f32_16x16x32_bf16 v[72:75], a[52:55], v[36:39], v[72:75]
    v_cvt_pk_bf16_f32 v86, v56, v57
    s_waitcnt lgkmcnt(6)
    v_mfma_f32_16x16x32_bf16 v[76:79], a[48:51], v[40:43], v[76:79]
    ds_read_b128 v[36:39], v12 offset:20480
    v_mfma_f32_16x16x32_bf16 v[80:83], a[52:55], v[40:43], v[80:83]
    v_cvt_pk_bf16_f32 v87, v58, v59
    s_waitcnt lgkmcnt(6)
    v_mfma_f32_16x16x32_bf16 v[68:71], a[56:59], v[44:47], v[68:71]
    ds_read_b128 v[40:43], v12 offset:22528
    v_mfma_f32_16x16x32_bf16 v[72:75], a[60:63], v[44:47], v[72:75]
    v_cvt_pk_bf16_f32 v88, v60, v61
    s_waitcnt lgkmcnt(6)
    v_mfma_f32_16x16x32_bf16 v[76:79], a[56:59], v[48:51], v[76:79]
    ds_read_b128 v[44:47], v13 offset:20480
    v_mfma_f32_16x16x32_bf16 v[80:83], a[60:63], v[48:51], v[80:83]
    v_cvt_pk_bf16_f32 v89, v62, v63
    buffer_store_dwordx4 v[84:87], v3, s[4:7], s21 offen offset:0 sc1
    s_waitcnt lgkmcnt(6)
    v_mfma_f32_16x16x32_bf16 v[68:71], a[64:67], v[20:23], v[68:71]
    ds_read_b128 v[48:51], v13 offset:22528
    v_mfma_f32_16x16x32_bf16 v[72:75], a[68:71], v[20:23], v[72:75]
    v_cvt_pk_bf16_f32 v90, v64, v65
    s_waitcnt lgkmcnt(6)
    v_mfma_f32_16x16x32_bf16 v[76:79], a[64:67], v[24:27], v[76:79]
    ds_read_b128 v[20:23], v12 offset:24576
    v_mfma_f32_16x16x32_bf16 v[80:83], a[68:71], v[24:27], v[80:83]
    v_cvt_pk_bf16_f32 v91, v66, v67
    s_waitcnt lgkmcnt(6)
    v_mfma_f32_16x16x32_bf16 v[68:71], a[72:75], v[28:31], v[68:71]
    ds_read_b128 v[24:27], v12 offset:26624
    v_mfma_f32_16x16x32_bf16 v[72:75], a[76:79], v[28:31], v[72:75]
    s_waitcnt lgkmcnt(6)
    v_mfma_f32_16x16x32_bf16 v[76:79], a[72:75], v[32:35], v[76:79]
    ds_read_b128 v[28:31], v13 offset:24576
    v_mfma_f32_16x16x32_bf16 v[80:83], a[76:79], v[32:35], v[80:83]
    buffer_store_dwordx4 v[88:91], v3, s[4:7], s21 offen offset:256 sc1
    s_waitcnt lgkmcnt(6)
    v_mfma_f32_16x16x32_bf16 v[68:71], a[80:83], v[36:39], v[68:71]
    ds_read_b128 v[32:35], v13 offset:26624
    v_mfma_f32_16x16x32_bf16 v[72:75], a[84:87], v[36:39], v[72:75]
    s_add_u32 s21, s21, s25
    s_mov_b32 s25, s26
    s_waitcnt lgkmcnt(6)
    v_mfma_f32_16x16x32_bf16 v[76:79], a[80:83], v[40:43], v[76:79]
    ds_read_b128 v[36:39], v12 offset:28672
    v_mfma_f32_16x16x32_bf16 v[80:83], a[84:87], v[40:43], v[80:83]
    s_waitcnt lgkmcnt(6)
    v_mfma_f32_16x16x32_bf16 v[68:71], a[88:91], v[44:47], v[68:71]
    ds_read_b128 v[40:43], v12 offset:30720
    v_mfma_f32_16x16x32_bf16 v[72:75], a[92:95], v[44:47], v[72:75]
    s_waitcnt lgkmcnt(6)
    v_mfma_f32_16x16x32_bf16 v[76:79], a[88:91], v[48:51], v[76:79]
    ds_read_b128 v[44:47], v13 offset:28672
    v_mfma_f32_16x16x32_bf16 v[80:83], a[92:95], v[48:51], v[80:83]
    s_waitcnt lgkmcnt(6)
    v_mfma_f32_16x16x32_bf16 v[68:71], a[96:99], v[20:23], v[68:71]
    ds_read_b128 v[48:51], v13 offset:30720
    v_mfma_f32_16x16x32_bf16 v[72:75], a[100:103], v[20:23], v[72:75]
    s_waitcnt lgkmcnt(6)
    v_mfma_f32_16x16x32_bf16 v[76:79], a[96:99], v[24:27], v[76:79]
    s_waitcnt vmcnt(11)
    s_barrier
    ds_read_b128 v[20:23], v12 offset:32768
    v_mfma_f32_16x16x32_bf16 v[80:83], a[100:103], v[24:27], v[80:83]
    s_waitcnt lgkmcnt(6)
    v_mfma_f32_16x16x32_bf16 v[68:71], a[104:107], v[28:31], v[68:71]
    ds_read_b128 v[24:27], v12 offset:34816
    s_add_u32 m0, s19, 31744
    v_mfma_f32_16x16x32_bf16 v[72:75], a[108:111], v[28:31], v[72:75]
    buffer_load_dwordx4 v2, s[8:11], s20 offen offset:1024 lds
    s_waitcnt lgkmcnt(6)
    v_mfma_f32_16x16x32_bf16 v[76:79], a[104:107], v[32:35], v[76:79]
    ds_read_b128 v[28:31], v13 offset:32768
    v_mfma_f32_16x16x32_bf16 v[80:83], a[108:111], v[32:35], v[80:83]
    s_waitcnt lgkmcnt(6)
    v_mfma_f32_16x16x32_bf16 v[68:71], a[112:115], v[36:39], v[68:71]
    ds_read_b128 v[32:35], v13 offset:34816
    s_add_u32 m0, s19, 35712
    v_mfma_f32_16x16x32_bf16 v[72:75], a[116:119], v[36:39], v[72:75]
    buffer_load_dwordx4 v2, s[8:11], s20 offen offset:1152 lds
    s_waitcnt lgkmcnt(6)
    v_mfma_f32_16x16x32_bf16 v[76:79], a[112:115], v[40:43], v[76:79]
    ds_read_b128 v[36:39], v12 offset:36864
    v_mfma_f32_16x16x32_bf16 v[80:83], a[116:119], v[40:43], v[80:83]
    s_waitcnt lgkmcnt(6)
    v_mfma_f32_16x16x32_bf16 v[68:71], a[120:123], v[44:47], v[68:71]
    ds_read_b128 v[40:43], v12 offset:38912
    s_add_u32 m0, s19, 39680
    v_mfma_f32_16x16x32_bf16 v[72:75], a[124:127], v[44:47], v[72:75]
    buffer_load_dwordx4 v2, s[8:11], s20 offen offset:1280 lds
    s_waitcnt lgkmcnt(6)
    v_mfma_f32_16x16x32_bf16 v[76:79], a[120:123], v[48:51], v[76:79]
    ds_read_b128 v[44:47], v13 offset:36864
    v_mfma_f32_16x16x32_bf16 v[80:83], a[124:127], v[48:51], v[80:83]
    s_waitcnt lgkmcnt(6)
    v_mfma_f32_16x16x32_bf16 v[68:71], a[128:131], v[20:23], v[68:71]
    ds_read_b128 v[48:51], v13 offset:38912
    v_mfma_f32_16x16x32_bf16 v[72:75], a[132:135], v[20:23], v[72:75]
    s_waitcnt lgkmcnt(6)
    v_mfma_f32_16x16x32_bf16 v[76:79], a[128:131], v[24:27], v[76:79]
    ds_read_b128 v[20:23], v12 offset:40960
    s_add_u32 m0, s19, 43648
    v_mfma_f32_16x16x32_bf16 v[80:83], a[132:135], v[24:27], v[80:83]
    buffer_load_dwordx4 v2, s[8:11], s20 offen offset:1408 lds
    s_waitcnt lgkmcnt(6)
    v_mfma_f32_16x16x32_bf16 v[68:71], a[136:139], v[28:31], v[68:71]
    ds_read_b128 v[24:27], v12 offset:43008
    v_mfma_f32_16x16x32_bf16 v[72:75], a[140:143], v[28:31], v[72:75]
    s_waitcnt lgkmcnt(6)
    v_mfma_f32_16x16x32_bf16 v[76:79], a[136:139], v[32:35], v[76:79]
    ds_read_b128 v[28:31], v13 offset:40960
    s_add_u32 m0, s19, 47616
    v_mfma_f32_16x16x32_bf16 v[80:83], a[140:143], v[32:35], v[80:83]
    buffer_load_dwordx4 v2, s[8:11], s20 offen offset:1536 lds
    s_waitcnt lgkmcnt(6)
    v_mfma_f32_16x16x32_bf16 v[68:71], a[144:147], v[36:39], v[68:71]
    ds_read_b128 v[32:35], v13 offset:43008
    v_mfma_f32_16x16x32_bf16 v[72:75], a[148:151], v[36:39], v[72:75]
    s_waitcnt lgkmcnt(6)
    v_mfma_f32_16x16x32_bf16 v[76:79], a[144:147], v[40:43], v[76:79]
    ds_read_b128 v[36:39], v12 offset:45056
    s_add_u32 m0, s19, 51584
    v_mfma_f32_16x16x32_bf16 v[80:83], a[148:151], v[40:43], v[80:83]
    buffer_load_dwordx4 v2, s[8:11], s20 offen offset:1664 lds
    s_waitcnt lgkmcnt(6)
    v_mfma_f32_16x16x32_bf16 v[68:71], a[152:155], v[44:47], v[68:71]
    ds_read_b128 v[40:43], v12 offset:47104
    v_mfma_f32_16x16x32_bf16 v[72:75], a[156:159], v[44:47], v[72:75]
    s_waitcnt lgkmcnt(6)
    v_mfma_f32_16x16x32_bf16 v[76:79], a[152:155], v[48:51], v[76:79]
    ds_read_b128 v[44:47], v13 offset:45056
    s_add_u32 m0, s19, 55552
    v_mfma_f32_16x16x32_bf16 v[80:83], a[156:159], v[48:51], v[80:83]
    buffer_load_dwordx4 v2, s[8:11], s20 offen offset:1792 lds
    s_waitcnt lgkmcnt(6)
    v_mfma_f32_16x16x32_bf16 v[68:71], a[160:163], v[20:23], v[68:71]
    ds_read_b128 v[48:51], v13 offset:47104
    v_mfma_f32_16x16x32_bf16 v[72:75], a[164:167], v[20:23], v[72:75]
    s_waitcnt lgkmcnt(6)
    v_mfma_f32_16x16x32_bf16 v[76:79], a[160:163], v[24:27], v[76:79]
    ds_read_b128 v[20:23], v12 offset:49152
    s_add_u32 m0, s19, 59520
    v_mfma_f32_16x16x32_bf16 v[80:83], a[164:167], v[24:27], v[80:83]
    buffer_load_dwordx4 v2, s[8:11], s20 offen offset:1920 lds
    s_waitcnt lgkmcnt(6)
    v_mfma_f32_16x16x32_bf16 v[68:71], a[168:171], v[28:31], v[68:71]
    ds_read_b128 v[24:27], v12 offset:51200
    v_mfma_f32_16x16x32_bf16 v[72:75], a[172:175], v[28:31], v[72:75]
    s_add_u32 s20, s20, s24
    s_waitcnt lgkmcnt(6)
    v_mfma_f32_16x16x32_bf16 v[76:79], a[168:171], v[32:35], v[76:79]
    ds_read_b128 v[28:31], v13 offset:49152
    v_mfma_f32_16x16x32_bf16 v[80:83], a[172:175], v[32:35], v[80:83]
    s_waitcnt lgkmcnt(6)
    v_mfma_f32_16x16x32_bf16 v[68:71], a[176:179], v[36:39], v[68:71]
    ds_read_b128 v[32:35], v13 offset:51200
    v_mfma_f32_16x16x32_bf16 v[72:75], a[180:183], v[36:39], v[72:75]
    s_waitcnt lgkmcnt(6)
    v_mfma_f32_16x16x32_bf16 v[76:79], a[176:179], v[40:43], v[76:79]
    ds_read_b128 v[36:39], v12 offset:53248
    v_mfma_f32_16x16x32_bf16 v[80:83], a[180:183], v[40:43], v[80:83]
    s_waitcnt lgkmcnt(6)
    v_mfma_f32_16x16x32_bf16 v[68:71], a[184:187], v[44:47], v[68:71]
    ds_read_b128 v[40:43], v12 offset:55296
    v_mfma_f32_16x16x32_bf16 v[72:75], a[188:191], v[44:47], v[72:75]
    s_waitcnt lgkmcnt(6)
    v_mfma_f32_16x16x32_bf16 v[76:79], a[184:187], v[48:51], v[76:79]
    ds_read_b128 v[44:47], v13 offset:53248
    v_mfma_f32_16x16x32_bf16 v[80:83], a[188:191], v[48:51], v[80:83]
    s_waitcnt lgkmcnt(6)
    v_mfma_f32_16x16x32_bf16 v[68:71], a[192:195], v[20:23], v[68:71]
    ds_read_b128 v[48:51], v13 offset:55296
    v_mfma_f32_16x16x32_bf16 v[72:75], a[196:199], v[20:23], v[72:75]
    s_waitcnt lgkmcnt(6)
    v_mfma_f32_16x16x32_bf16 v[76:79], a[192:195], v[24:27], v[76:79]
    ds_read_b128 v[20:23], v12 offset:57344
    v_mfma_f32_16x16x32_bf16 v[80:83], a[196:199], v[24:27], v[80:83]
    s_waitcnt lgkmcnt(6)
    v_mfma_f32_16x16x32_bf16 v[68:71], a[200:203], v[28:31], v[68:71]
    ds_read_b128 v[24:27], v12 offset:59392
    v_mfma_f32_16x16x32_bf16 v[72:75], a[204:207], v[28:31], v[72:75]
    s_waitcnt lgkmcnt(6)
    v_mfma_f32_16x16x32_bf16 v[76:79], a[200:203], v[32:35], v[76:79]
    ds_read_b128 v[28:31], v13 offset:57344
    v_mfma_f32_16x16x32_bf16 v[80:83], a[204:207], v[32:35], v[80:83]
    s_waitcnt lgkmcnt(6)
    v_mfma_f32_16x16x32_bf16 v[68:71], a[208:211], v[36:39], v[68:71]
    ds_read_b128 v[32:35], v13 offset:59392
    v_mfma_f32_16x16x32_bf16 v[72:75], a[212:215], v[36:39], v[72:75]
    s_waitcnt lgkmcnt(6)
    v_mfma_f32_16x16x32_bf16 v[76:79], a[208:211], v[40:43], v[76:79]
    ds_read_b128 v[36:39], v12 offset:61440
    v_mfma_f32_16x16x32_bf16 v[80:83], a[212:215], v[40:43], v[80:83]
    s_waitcnt lgkmcnt(6)
    v_mfma_f32_16x16x32_bf16 v[68:71], a[216:219], v[44:47], v[68:71]
    ds_read_b128 v[40:43], v12 offset:63488
    v_mfma_f32_16x16x32_bf16 v[72:75], a[220:223], v[44:47], v[72:75]
    s_waitcnt lgkmcnt(6)
    v_mfma_f32_16x16x32_bf16 v[76:79], a[216:219], v[48:51], v[76:79]
    ds_read_b128 v[44:47], v13 offset:61440
    v_mfma_f32_16x16x32_bf16 v[80:83], a[220:223], v[48:51], v[80:83]
    s_waitcnt lgkmcnt(6)
    v_mfma_f32_16x16x32_bf16 v[68:71], a[224:227], v[20:23], v[68:71]
    ds_read_b128 v[48:51], v13 offset:63488
    v_mfma_f32_16x16x32_bf16 v[72:75], a[228:231], v[20:23], v[72:75]
    s_waitcnt lgkmcnt(6)
    v_mfma_f32_16x16x32_bf16 v[76:79], a[224:227], v[24:27], v[76:79]
    s_waitcnt vmcnt(8)
    s_barrier
    ds_read_b128 v[20:23], v10 offset:0
    v_mfma_f32_16x16x32_bf16 v[80:83], a[228:231], v[24:27], v[80:83]
    s_waitcnt lgkmcnt(6)
    v_mfma_f32_16x16x32_bf16 v[68:71], a[232:235], v[28:31], v[68:71]
    ds_read_b128 v[24:27], v10 offset:2048
    s_add_u32 m0, s19, 65536
    v_mfma_f32_16x16x32_bf16 v[72:75], a[236:239], v[28:31], v[72:75]
    buffer_load_dwordx4 v2, s[8:11], s20 offen offset:0 lds
    s_waitcnt lgkmcnt(6)
    v_mfma_f32_16x16x32_bf16 v[76:79], a[232:235], v[32:35], v[76:79]
    ds_read_b128 v[28:31], v11 offset:0
    v_mfma_f32_16x16x32_bf16 v[80:83], a[236:239], v[32:35], v[80:83]
    v_mov_b32 v9, s23
    s_add_u32 s23, s23, 1
    buffer_store_dword v9, v4, s[4:7], 0 offen sc1
    s_waitcnt lgkmcnt(6)
    v_mfma_f32_16x16x32_bf16 v[68:71], a[240:243], v[36:39], v[68:71]
    ds_read_b128 v[32:35], v11 offset:2048
    s_add_u32 m0, s19, 69504
    v_mfma_f32_16x16x32_bf16 v[72:75], a[244:247], v[36:39], v[72:75]
    buffer_load_dwordx4 v2, s[8:11], s20 offen offset:128 lds
    s_waitcnt lgkmcnt(6)
    v_mfma_f32_16x16x32_bf16 v[76:79], a[240:243], v[40:43], v[76:79]
    ds_read_b128 v[36:39], v10 offset:4096
    v_mfma_f32_16x16x32_bf16 v[80:83], a[244:247], v[40:43], v[80:83]
    s_waitcnt lgkmcnt(6)
    v_mfma_f32_16x16x32_bf16 v[68:71], a[248:251], v[44:47], v[68:71]
    ds_read_b128 v[40:43], v10 offset:6144
    s_add_u32 m0, s19, 73472
    v_mfma_f32_16x16x32_bf16 v[72:75], a[252:255], v[44:47], v[72:75]
    buffer_load_dwordx4 v2, s[8:11], s20 offen offset:256 lds
    s_waitcnt lgkmcnt(6)
    v_mfma_f32_16x16x32_bf16 v[76:79], a[248:251], v[48:51], v[76:79]
    ds_read_b128 v[44:47], v11 offset:4096
    v_mfma_f32_16x16x32_bf16 v[80:83], a[252:255], v[48:51], v[80:83]
    s_add_u32 s22, s22, 2
    s_cmp_lt_u32 s22, 64
    s_cbranch_scc1 P_qk_top
    v_cvt_pk_bf16_f32 v84, v68, v69
    v_cvt_pk_bf16_f32 v85, v70, v71
    v_cvt_pk_bf16_f32 v86, v72, v73
    v_cvt_pk_bf16_f32 v87, v74, v75
    v_cvt_pk_bf16_f32 v88, v76, v77
    v_cvt_pk_bf16_f32 v89, v78, v79
    v_cvt_pk_bf16_f32 v90, v80, v81
    v_cvt_pk_bf16_f32 v91, v82, v83
    buffer_store_dwordx4 v[84:87], v3, s[4:7], s21 offen offset:0 sc1
    buffer_store_dwordx4 v[88:91], v3, s[4:7], s21 offen offset:256 sc1
    s_waitcnt vmcnt(0) lgkmcnt(0)
    v_mov_b32 v9, s23
    s_add_u32 s23, s23, 1
    buffer_store_dword v9, v4, s[4:7], 0 offen sc1
    s_branch W_U
P_v:
    s_mov_b32 s26, s25
    s_sub_u32 s25, s21, 1073741824
    s_mov_b32 s21, 1073741824
    s_mov_b32 s23, 0
    s_mov_b32 s22, 0
    s_add_u32 m0, s19, 0
    s_nop 0
    buffer_load_dwordx4 v2, s[8:11], s20 offen offset:0 lds
    s_add_u32 m0, s19, 3968
    s_nop 0
    buffer_load_dwordx4 v2, s[8:11], s20 offen offset:128 lds
    s_add_u32 m0, s19, 7936
    s_nop 0
    buffer_load_dwordx4 v2, s[8:11], s20 offen offset:256 lds
    s_add_u32 m0, s19, 11904
    s_nop 0
    buffer_load_dwordx4 v2, s[8:11], s20 offen offset:384 lds
    s_add_u32 m0, s19, 15872
    s_nop 0
    buffer_load_dwordx4 v2, s[8:11], s20 offen offset:512 lds
    s_add_u32 m0, s19, 19840
    s_nop 0
    buffer_load_dwordx4 v2, s[8:11], s20 offen offset:640 lds
    s_add_u32 m0, s19, 23808
    s_nop 0
    buffer_load_dwordx4 v2, s[8:11], s20 offen offset:768 lds
    s_add_u32 m0, s19, 27776
    s_nop 0
    buffer_load_dwordx4 v2, s[8:11], s20 offen offset:896 lds
    s_add_u32 m0, s19, 31744
    s_nop 0
    buffer_load_dwordx4 v2, s[8:11], s20 offen offset:1024 lds
    s_add_u32 m0, s19, 35712
    s_nop 0
    buffer_load_dwordx4 v2, s[8:11], s20 offen offset:1152 lds
    s_add_u32 m0, s19, 39680
    s_nop 0
    buffer_load_dwordx4 v2, s[8:11], s20 offen offset:1280 lds
    s_add_u32 m0, s19, 43648
    s_nop 0
    buffer_load_dwordx4 v2, s[8:11], s20 offen offset:1408 lds
    s_add_u32 m0, s19, 47616
    s_nop 0
    buffer_load_dwordx4 v2, s[8:11], s20 offen offset:1536 lds
    s_add_u32 m0, s19, 51584
    s_nop 0
    buffer_load_dwordx4 v2, s[8:11], s20 offen offset:1664 lds
    s_add_u32 m0, s19, 55552
    s_nop 0
    buffer_load_dwordx4 v2, s[8:11], s20 offen offset:1792 lds
    s_add_u32 m0, s19, 59520
    s_nop 0
    buffer_load_dwordx4 v2, s[8:11], s20 offen offset:1920 lds
    s_add_u32 s20, s20, s24
    s_add_u32 m0, s19, 65536
    s_nop 0
    buffer_load_dwordx4 v2, s[8:11], s20 offen offset:0 lds
    s_add_u32 m0, s19, 69504
    s_nop 0
    buffer_load_dwordx4 v2, s[8:11], s20 offen offset:128 lds
    s_add_u32 m0, s19, 73472
    s_nop 0
    buffer_load_dwordx4 v2, s[8:11], s20 offen offset:256 lds
    v_mov_b32 v9, s23
    s_add_u32 s23, s23, 1
    buffer_store_dword v9, v4, s[4:7], 0 offen sc1
    s_mov_b32 s23, 0
    s_waitcnt vmcnt(12)
    s_barrier
    ds_read_b128 v[20:23], v10 offset:0
    ds_read_b128 v[24:27], v10 offset:2048
    ds_read_b128 v[28:31], v11 offset:0
    ds_read_b128 v[32:35], v11 offset:2048
    ds_read_b128 v[36:39], v10 offset:4096
    ds_read_b128 v[40:43], v10 offset:6144
    ds_read_b128 v[44:47], v11 offset:4096
.p2align 6
P_v_top:
    s_waitcnt lgkmcnt(6)
    v_mfma_f32_16x16x32_bf16 v[52:55], v[20:23], a[0:3], 0
    ds_read_b128 v[48:51], v11 offset:6144
    v_mfma_f32_16x16x32_bf16 v[60:63], v[20:23], a[4:7], 0
    s_waitcnt lgkmcnt(6)
    v_mfma_f32_16x16x32_bf16 v[56:59], v[24:27], a[0:3], 0
    ds_read_b128 v[20:23], v10 offset:8192
    s_add_u32 m0, s19, 77440
    v_mfma_f32_16x16x32_bf16 v[64:67], v[24:27], a[4:7], 0
    buffer_load_dwordx4 v2, s[8:11], s20 offen offset:384 lds
    s_waitcnt lgkmcnt(6)
    v_mfma_f32_16x16x32_bf16 v[52:55], v[28:31], a[8:11], v[52:55]
    ds_read_b128 v[24:27], v10 offset:10240
    v_mfma_f32_16x16x32_bf16 v[60:63], v[28:31], a[12:15], v[60:63]
    s_waitcnt lgkmcnt(6)
    v_mfma_f32_16x16x32_bf16 v[56:59], v[32:35], a[8:11], v[56:59]
    ds_read_b128 v[28:31], v11 offset:8192
    s_add_u32 m0, s19, 81408
    v_mfma_f32_16x16x32_bf16 v[64:67], v[32:35], a[12:15], v[64:67]
    buffer_load_dwordx4 v2, s[8:11], s20 offen offset:512 lds
    s_waitcnt lgkmcnt(6)
    v_mfma_f32_16x16x32_bf16 v[52:55], v[36:39], a[16:19], v[52:55]
    ds_read_b128 v[32:35], v11 offset:10240
    v_mfma_f32_16x16x32_bf16 v[60:63], v[36:39], a[20:23], v[60:63]
    s_waitcnt lgkmcnt(6)
    v_mfma_f32_16x16x32_bf16 v[56:59], v[40:43], a[16:19], v[56:59]
    ds_read_b128 v[36:39], v10 offset:12288
    s_add_u32 m0, s19, 85376
    v_mfma_f32_16x16x32_bf16 v[64:67], v[40:43], a[20:23], v[64:67]
    buffer_load_dwordx4 v2, s[8:11], s20 offen offset:640 lds
    s_waitcnt lgkmcnt(6)
    v_mfma_f32_16x16x32_bf16 v[52:55], v[44:47], a[24:27], v[52:55]
    ds_read_b128 v[40:43], v10 offset:14336
    v_mfma_f32_16x16x32_bf16 v[60:63], v[44:47], a[28:31], v[60:63]
    s_waitcnt lgkmcnt(6)
    v_mfma_f32_16x16x32_bf16 v[56:59], v[48:51], a[24:27], v[56:59]
    ds_read_b128 v[44:47], v11 offset:12288
    s_add_u32 m0, s19, 89344
    v_mfma_f32_16x16x32_bf16 v[64:67], v[48:51], a[28:31], v[64:67]
    buffer_load_dwordx4 v2, s[8:11], s20 offen offset:768 lds
    s_waitcnt lgkmcnt(6)
    v_mfma_f32_16x16x32_bf16 v[52:55], v[20:23], a[32:35], v[52:55]
    ds_read_b128 v[48:51], v11 offset:14336
    v_mfma_f32_16x16x32_bf16 v[60:63], v[20:23], a[36:39], v[60:63]
    s_waitcnt lgkmcnt(6)
    v_mfma_f32_16x16x32_bf16 v[56:59], v[24:27], a[32:35], v[56:59]
    ds_read_b128 v[20:23], v10 offset:16384
    s_add_u32 m0, s19, 93312
    v_mfma_f32_16x16x32_bf16 v[64:67], v[24:27], a[36:39], v[64:67]
    buffer_load_dwordx4 v2, s[8:11], s20 offen offset:896 lds
    s_waitcnt lgkmcnt(6)
    v_mfma_f32_16x16x32_bf16 v[52:55], v[28:31], a[40:43], v[52:55]
    ds_read_b128 v[24:27], v10 offset:18432
    v_mfma_f32_16x16x32_bf16 v[60:63], v[28:31], a[44:47], v[60:63]
    v_cvt_pk_bf16_f32 v84, v68, v69
    s_waitcnt lgkmcnt(6)
    v_mfma_f32_16x16x32_bf16 v[56:59], v[32:35], a[40:43], v[56:59]
    ds_read_b128 v[28:31], v11 offset:16384
    v_mfma_f32_16x16x32_bf16 v[64:67], v[32:35], a[44:47], v[64:67]
    v_cvt_pk_bf16_f32 v85, v70, v71
    s_waitcnt lgkmcnt(6)
    v_mfma_f32_16x16x32_bf16 v[52:55], v[36:39], a[48:51], v[52:55]
    ds_read_b128 v[32:35], v11 offset:18432
    v_mfma_f32_16x16x32_bf16 v[60:63], v[36:39], a[52:55], v[60:63]
    v_cvt_pk_bf16_f32 v86, v72, v73
    s_waitcnt lgkmcnt(6)
    v_mfma_f32_16x16x32_bf16 v[56:59], v[40:43], a[48:51], v[56:59]
    ds_read_b128 v[36:39], v10 offset:20480
    v_mfma_f32_16x16x32_bf16 v[64:67], v[40:43], a[52:55], v[64:67]
    v_cvt_pk_bf16_f32 v87, v74, v75
    s_waitcnt lgkmcnt(6)
    v_mfma_f32_16x16x32_bf16 v[52:55], v[44:47], a[56:59], v[52:55]
    ds_read_b128 v[40:43], v10 offset:22528
    v_mfma_f32_16x16x32_bf16 v[60:63], v[44:47], a[60:63], v[60:63]
    v_cvt_pk_bf16_f32 v88, v76, v77
    s_waitcnt lgkmcnt(6)
    v_mfma_f32_16x16x32_bf16 v[56:59], v[48:51], a[56:59], v[56:59]
    ds_read_b128 v[44:47], v11 offset:20480
    v_mfma_f32_16x16x32_bf16 v[64:67], v[48:51], a[60:63], v[64:67]
    v_cvt_pk_bf16_f32 v89, v78, v79
    buffer_store_dwordx4 v[84:87], v3, s[4:7], s21 offen offset:0 sc1
    s_waitcnt lgkmcnt(6)
    v_mfma_f32_16x16x32_bf16 v[52:55], v[20:23], a[64:67], v[52:55]
    ds_read_b128 v[48:51], v11 offset:22528
    v_mfma_f32_16x16x32_bf16 v[60:63], v[20:23], a[68:71], v[60:63]
    v_cvt_pk_bf16_f32 v90, v80, v81
    s_waitcnt lgkmcnt(6)
    v_mfma_f32_16x16x32_bf16 v[56:59], v[24:27], a[64:67], v[56:59]
    ds_read_b128 v[20:23], v10 offset:24576
    v_mfma_f32_16x16x32_bf16 v[64:67], v[24:27], a[68:71], v[64:67]
    v_cvt_pk_bf16_f32 v91, v82, v83
    s_waitcnt lgkmcnt(6)
    v_mfma_f32_16x16x32_bf16 v[52:55], v[28:31], a[72:75], v[52:55]
    ds_read_b128 v[24:27], v10 offset:26624
    v_mfma_f32_16x16x32_bf16 v[60:63], v[28:31], a[76:79], v[60:63]
    s_waitcnt lgkmcnt(6)
    v_mfma_f32_16x16x32_bf16 v[56:59], v[32:35], a[72:75], v[56:59]
    ds_read_b128 v[28:31], v11 offset:24576
    v_mfma_f32_16x16x32_bf16 v[64:67], v[32:35], a[76:79], v[64:67]
    buffer_store_dwordx4 v[88:91], v3, s[4:7], s21 offen offset:256 sc1
    s_waitcnt lgkmcnt(6)
    v_mfma_f32_16x16x32_bf16 v[52:55], v[36:39], a[80:83], v[52:55]
    ds_read_b128 v[32:35], v11 offset:26624
    v_mfma_f32_16x16x32_bf16 v[60:63], v[36:39], a[84:87], v[60:63]
    s_add_u32 s21, s21, s25
    s_mov_b32 s25, s26
    s_waitcnt lgkmcnt(6)
    v_mfma_f32_16x16x32_bf16 v[56:59], v[40:43], a[80:83], v[56:59]
    ds_read_b128 v[36:39], v10 offset:28672
    v_mfma_f32_16x16x32_bf16 v[64:67], v[40:43], a[84:87], v[64:67]
    s_waitcnt lgkmcnt(6)
    v_mfma_f32_16x16x32_bf16 v[52:55], v[44:47], a[88:91], v[52:55]
    ds_read_b128 v[40:43], v10 offset:30720
    v_mfma_f32_16x16x32_bf16 v[60:63], v[44:47], a[92:95], v[60:63]
    s_waitcnt lgkmcnt(6)
    v_mfma_f32_16x16x32_bf16 v[56:59], v[48:51], a[88:91], v[56:59]
    ds_read_b128 v[44:47], v11 offset:28672
    v_mfma_f32_16x16x32_bf16 v[64:67], v[48:51], a[92:95], v[64:67]
    s_waitcnt lgkmcnt(6)
    v_mfma_f32_16x16x32_bf16 v[52:55], v[20:23], a[96:99], v[52:55]
    ds_read_b128 v[48:51], v11 offset:30720
    v_mfma_f32_16x16x32_bf16 v[60:63], v[20:23], a[100:103], v[60:63]
    s_waitcnt lgkmcnt(6)
    v_mfma_f32_16x16x32_bf16 v[56:59], v[24:27], a[96:99], v[56:59]
    s_waitcnt vmcnt(11)
    s_barrier
    ds_read_b128 v[20:23], v10 offset:32768
    v_mfma_f32_16x16x32_bf16 v[64:67], v[24:27], a[100:103], v[64:67]
    s_waitcnt lgkmcnt(6)
    v_mfma_f32_16x16x32_bf16 v[52:55], v[28:31], a[104:107], v[52:55]
    ds_read_b128 v[24:27], v10 offset:34816
    s_add_u32 m0, s19, 97280
    v_mfma_f32_16x16x32_bf16 v[60:63], v[28:31], a[108:111], v[60:63]
    buffer_load_dwordx4 v2, s[8:11], s20 offen offset:1024 lds
    s_waitcnt lgkmcnt(6)
    v_mfma_f32_16x16x32_bf16 v[56:59], v[32:35], a[104:107], v[56:59]
    ds_read_b128 v[28:31], v11 offset:32768
    v_mfma_f32_16x16x32_bf16 v[64:67], v[32:35], a[108:111], v[64:67]
    s_waitcnt lgkmcnt(6)
    v_mfma_f32_16x16x32_bf16 v[52:55], v[36:39], a[112:115], v[52:55]
    ds_read_b128 v[32:35], v11 offset:34816
    s_add_u32 m0, s19, 101248
    v_mfma_f32_16x16x32_bf16 v[60:63], v[36:39], a[116:119], v[60:63]
    buffer_load_dwordx4 v2, s[8:11], s20 offen offset:1152 lds
    s_waitcnt lgkmcnt(6)
    v_mfma_f32_16x16x32_bf16 v[56:59], v[40:43], a[112:115], v[56:59]
    ds_read_b128 v[36:39], v10 offset:36864
    v_mfma_f32_16x16x32_bf16 v[64:67], v[40:43], a[116:119], v[64:67]
    s_waitcnt lgkmcnt(6)
    v_mfma_f32_16x16x32_bf16 v[52:55], v[44:47], a[120:123], v[52:55]
    ds_read_b128 v[40:43], v10 offset:38912
    s_add_u32 m0, s19, 105216
    v_mfma_f32_16x16x32_bf16 v[60:63], v[44:47], a[124:127], v[60:63]
    buffer_load_dwordx4 v2, s[8:11], s20 offen offset:1280 lds
    s_waitcnt lgkmcnt(6)
    v_mfma_f32_16x16x32_bf16 v[56:59], v[48:51], a[120:123], v[56:59]
    ds_read_b128 v[44:47], v11 offset:36864
    v_mfma_f32_16x16x32_bf16 v[64:67], v[48:51], a[124:127], v[64:67]
    s_waitcnt lgkmcnt(6)
    v_mfma_f32_16x16x32_bf16 v[52:55], v[20:23], a[128:131], v[52:55]
    ds_read_b128 v[48:51], v11 offset:38912
    v_mfma_f32_16x16x32_bf16 v[60:63], v[20:23], a[132:135], v[60:63]
    s_waitcnt lgkmcnt(6)
    v_mfma_f32_16x16x32_bf16 v[56:59], v[24:27], a[128:131], v[56:59]
    ds_read_b128 v[20:23], v10 offset:40960
    s_add_u32 m0, s19, 109184
    v_mfma_f32_16x16x32_bf16 v[64:67], v[24:27], a[132:135], v[64:67]
    buffer_load_dwordx4 v2, s[8:11], s20 offen offset:1408 lds
    s_waitcnt lgkmcnt(6)
    v_mfma_f32_16x16x32_bf16 v[52:55], v[28:31], a[136:139], v[52:55]
    ds_read_b128 v[24:27], v10 offset:43008
    v_mfma_f32_16x16x32_bf16 v[60:63], v[28:31], a[140:143], v[60:63]
    s_waitcnt lgkmcnt(6)
    v_mfma_f32_16x16x32_bf16 v[56:59], v[32:35], a[136:139], v[56:59]
    ds_read_b128 v[28:31], v11 offset:40960
    s_add_u32 m0, s19, 113152
    v_mfma_f32_16x16x32_bf16 v[64:67], v[32:35], a[140:143], v[64:67]
    buffer_load_dwordx4 v2, s[8:11], s20 offen offset:1536 lds
    s_waitcnt lgkmcnt(6)
    v_mfma_f32_16x16x32_bf16 v[52:55], v[36:39], a[144:147], v[52:55]
    ds_read_b128 v[32:35], v11 offset:43008
    v_mfma_f32_16x16x32_bf16 v[60:63], v[36:39], a[148:151], v[60:63]
    s_waitcnt lgkmcnt(6)
    v_mfma_f32_16x16x32_bf16 v[56:59], v[40:43], a[144:147], v[56:59]
    ds_read_b128 v[36:39], v10 offset:45056
    s_add_u32 m0, s19, 117120
    v_mfma_f32_16x16x32_bf16 v[64:67], v[40:43], a[148:151], v[64:67]
    buffer_load_dwordx4 v2, s[8:11], s20 offen offset:1664 lds
    s_waitcnt lgkmcnt(6)
    v_mfma_f32_16x16x32_bf16 v[52:55], v[44:47], a[152:155], v[52:55]
    ds_read_b128 v[40:43], v10 offset:47104
    v_mfma_f32_16x16x32_bf16 v[60:63], v[44:47], a[156:159], v[60:63]
    s_waitcnt lgkmcnt(6)
    v_mfma_f32_16x16x32_bf16 v[56:59], v[48:51], a[152:155], v[56:59]
    ds_read_b128 v[44:47], v11 offset:45056
    s_add_u32 m0, s19, 121088
    v_mfma_f32_16x16x32_bf16 v[64:67], v[48:51], a[156:159], v[64:67]
    buffer_load_dwordx4 v2, s[8:11], s20 offen offset:1792 lds
    s_waitcnt lgkmcnt(6)
    v_mfma_f32_16x16x32_bf16 v[52:55], v[20:23], a[160:163], v[52:55]
    ds_read_b128 v[48:51], v11 offset:47104
    v_mfma_f32_16x16x32_bf16 v[60:63], v[20:23], a[164:167], v[60:63]
    s_waitcnt lgkmcnt(6)
    v_mfma_f32_16x16x32_bf16 v[56:59], v[24:27], a[160:163], v[56:59]
    ds_read_b128 v[20:23], v10 offset:49152
    s_add_u32 m0, s19, 125056
    v_mfma_f32_16x16x32_bf16 v[64:67], v[24:27], a[164:167], v[64:67]
    buffer_load_dwordx4 v2, s[8:11], s20 offen offset:1920 lds
    s_waitcnt lgkmcnt(6)
    v_mfma_f32_16x16x32_bf16 v[52:55], v[28:31], a[168:171], v[52:55]
    ds_read_b128 v[24:27], v10 offset:51200
    v_mfma_f32_16x16x32_bf16 v[60:63], v[28:31], a[172:175], v[60:63]
    s_add_u32 s20, s20, s24
    s_waitcnt lgkmcnt(6)
    v_mfma_f32_16x16x32_bf16 v[56:59], v[32:35], a[168:171], v[56:59]
    ds_read_b128 v[28:31], v11 offset:49152
    v_mfma_f32_16x16x32_bf16 v[64:67], v[32:35], a[172:175], v[64:67]
    s_waitcnt lgkmcnt(6)
    v_mfma_f32_16x16x32_bf16 v[52:55], v[36:39], a[176:179], v[52:55]
    ds_read_b128 v[32:35], v11 offset:51200
    v_mfma_f32_16x16x32_bf16 v[60:63], v[36:39], a[180:183], v[60:63]
    s_waitcnt lgkmcnt(6)
    v_mfma_f32_16x16x32_bf16 v[56:59], v[40:43], a[176:179], v[56:59]
    ds_read_b128 v[36:39], v10 offset:53248
    v_mfma_f32_16x16x32_bf16 v[64:67], v[40:43], a[180:183], v[64:67]
    s_waitcnt lgkmcnt(6)
    v_mfma_f32_16x16x32_bf16 v[52:55], v[44:47], a[184:187], v[52:55]
    ds_read_b128 v[40:43], v10 offset:55296
    v_mfma_f32_16x16x32_bf16 v[60:63], v[44:47], a[188:191], v[60:63]
    s_waitcnt lgkmcnt(6)
    v_mfma_f32_16x16x32_bf16 v[56:59], v[48:51], a[184:187], v[56:59]
    ds_read_b128 v[44:47], v11 offset:53248
    v_mfma_f32_16x16x32_bf16 v[64:67], v[48:51], a[188:191], v[64:67]
    s_waitcnt lgkmcnt(6)
    v_mfma_f32_16x16x32_bf16 v[52:55], v[20:23], a[192:195], v[52:55]
    ds_read_b128 v[48:51], v11 offset:55296
    v_mfma_f32_16x16x32_bf16 v[60:63], v[20:23], a[196:199], v[60:63]
    s_waitcnt lgkmcnt(6)
    v_mfma_f32_16x16x32_bf16 v[56:59], v[24:27], a[192:195], v[56:59]
    ds_read_b128 v[20:23], v10 offset:57344
    v_mfma_f32_16x16x32_bf16 v[64:67], v[24:27], a[196:199], v[64:67]
    s_waitcnt lgkmcnt(6)
    v_mfma_f32_16x16x32_bf16 v[52:55], v[28:31], a[200:203], v[52:55]
    ds_read_b128 v[24:27], v10 offset:59392
    v_mfma_f32_16x16x32_bf16 v[60:63], v[28:31], a[204:207], v[60:63]
    s_waitcnt lgkmcnt(6)
    v_mfma_f32_16x16x32_bf16 v[56:59], v[32:35], a[200:203], v[56:59]
    ds_read_b128 v[28:31], v11 offset:57344
    v_mfma_f32_16x16x32_bf16 v[64:67], v[32:35], a[204:207], v[64:67]
    s_waitcnt lgkmcnt(6)
    v_mfma_f32_16x16x32_bf16 v[52:55], v[36:39], a[208:211], v[52:55]
    ds_read_b128 v[32:35], v11 offset:59392
    v_mfma_f32_16x16x32_bf16 v[60:63], v[36:39], a[212:215], v[60:63]
    s_waitcnt lgkmcnt(6)
    v_mfma_f32_16x16x32_bf16 v[56:59], v[40:43], a[208:211], v[56:59]
    ds_read_b128 v[36:39], v10 offset:61440
    v_mfma_f32_16x16x32_bf16 v[64:67], v[40:43], a[212:215], v[64:67]
    s_waitcnt lgkmcnt(6)
    v_mfma_f32_16x16x32_bf16 v[52:55], v[44:47], a[216:219], v[52:55]
    ds_read_b128 v[40:43], v10 offset:63488
    v_mfma_f32_16x16x32_bf16 v[60:63], v[44:47], a[220:223], v[60:63]
    s_waitcnt lgkmcnt(6)
    v_mfma_f32_16x16x32_bf16 v[56:59], v[48:51], a[216:219], v[56:59]
    ds_read_b128 v[44:47], v11 offset:61440
    v_mfma_f32_16x16x32_bf16 v[64:67], v[48:51], a[220:223], v[64:67]
    s_waitcnt lgkmcnt(6)
    v_mfma_f32_16x16x32_bf16 v[52:55], v[20:23], a[224:227], v[52:55]
    ds_read_b128 v[48:51], v11 offset:63488
    v_mfma_f32_16x16x32_bf16 v[60:63], v[20:23], a[228:231], v[60:63]
    s_waitcnt lgkmcnt(6)
    v_mfma_f32_16x16x32_bf16 v[56:59], v[24:27], a[224:227], v[56:59]
    s_waitcnt vmcnt(8)
    s_barrier
    ds_read_b128 v[20:23], v12 offset:0
    v_mfma_f32_16x16x32_bf16 v[64:67], v[24:27], a[228:231], v[64:67]
    s_waitcnt lgkmcnt(6)
    v_mfma_f32_16x16x32_bf16 v[52:55], v[28:31], a[232:235], v[52:55]
    ds_read_b128 v[24:27], v12 offset:2048
    s_add_u32 m0, s19, 0
    v_mfma_f32_16x16x32_bf16 v[60:63], v[28:31], a[236:239], v[60:63]
    buffer_load_dwordx4 v2, s[8:11], s20 offen offset:0 lds
    s_waitcnt lgkmcnt(6)
    v_mfma_f32_16x16x32_bf16 v[56:59], v[32:35], a[232:235], v[56:59]
    ds_read_b128 v[28:31], v13 offset:0
    v_mfma_f32_16x16x32_bf16 v[64:67], v[32:35], a[236:239], v[64:67]
    v_mov_b32 v9, s23
    s_add_u32 s23, s23, 1
    buffer_store_dword v9, v4, s[4:7], 0 offen sc1
    s_waitcnt lgkmcnt(6)
    v_mfma_f32_16x16x32_bf16 v[52:55], v[36:39], a[240:243], v[52:55]
    ds_read_b128 v[32:35], v13 offset:2048
    s_add_u32 m0, s19, 3968
    v_mfma_f32_16x16x32_bf16 v[60:63], v[36:39], a[244:247], v[60:63]
    buffer_load_dwordx4 v2, s[8:11], s20 offen offset:128 lds
    s_waitcnt lgkmcnt(6)
    v_mfma_f32_16x16x32_bf16 v[56:59], v[40:43], a[240:243], v[56:59]
    ds_read_b128 v[36:39], v12 offset:4096
    v_mfma_f32_16x16x32_bf16 v[64:67], v[40:43], a[244:247], v[64:67]
    s_waitcnt lgkmcnt(6)
    v_mfma_f32_16x16x32_bf16 v[52:55], v[44:47], a[248:251], v[52:55]
    ds_read_b128 v[40:43], v12 offset:6144
    s_add_u32 m0, s19, 7936
    v_mfma_f32_16x16x32_bf16 v[60:63], v[44:47], a[252:255], v[60:63]
    buffer_load_dwordx4 v2, s[8:11], s20 offen offset:256 lds
    s_waitcnt lgkmcnt(6)
    v_mfma_f32_16x16x32_bf16 v[56:59], v[48:51], a[248:251], v[56:59]
    ds_read_b128 v[44:47], v13 offset:4096
    v_mfma_f32_16x16x32_bf16 v[64:67], v[48:51], a[252:255], v[64:67]
    s_waitcnt lgkmcnt(6)
    v_mfma_f32_16x16x32_bf16 v[68:71], v[20:23], a[0:3], 0
    ds_read_b128 v[48:51], v13 offset:6144
    v_mfma_f32_16x16x32_bf16 v[76:79], v[20:23], a[4:7], 0
    s_waitcnt lgkmcnt(6)
    v_mfma_f32_16x16x32_bf16 v[72:75], v[24:27], a[0:3], 0
    ds_read_b128 v[20:23], v12 offset:8192
    s_add_u32 m0, s19, 11904
    v_mfma_f32_16x16x32_bf16 v[80:83], v[24:27], a[4:7], 0
    buffer_load_dwordx4 v2, s[8:11], s20 offen offset:384 lds
    s_waitcnt lgkmcnt(6)
    v_mfma_f32_16x16x32_bf16 v[68:71], v[28:31], a[8:11], v[68:71]
    ds_read_b128 v[24:27], v12 offset:10240
    v_mfma_f32_16x16x32_bf16 v[76:79], v[28:31], a[12:15], v[76:79]
    s_waitcnt lgkmcnt(6)
    v_mfma_f32_16x16x32_bf16 v[72:75], v[32:35], a[8:11], v[72:75]
    ds_read_b128 v[28:31], v13 offset:8192
    s_add_u32 m0, s19, 15872
    v_mfma_f32_16x16x32_bf16 v[80:83], v[32:35], a[12:15], v[80:83]
    buffer_load_dwordx4 v2, s[8:11], s20 offen offset:512 lds
    s_waitcnt lgkmcnt(6)
    v_mfma_f32_16x16x32_bf16 v[68:71], v[36:39], a[16:19], v[68:71]
    ds_read_b128 v[32:35], v13 offset:10240
    v_mfma_f32_16x16x32_bf16 v[76:79], v[36:39], a[20:23], v[76:79]
    s_waitcnt lgkmcnt(6)
    v_mfma_f32_16x16x32_bf16 v[72:75], v[40:43], a[16:19], v[72:75]
    ds_read_b128 v[36:39], v12 offset:12288
    s_add_u32 m0, s19, 19840
    v_mfma_f32_16x16x32_bf16 v[80:83], v[40:43], a[20:23], v[80:83]
    buffer_load_dwordx4 v2, s[8:11], s20 offen offset:640 lds
    s_waitcnt lgkmcnt(6)
    v_mfma_f32_16x16x32_bf16 v[68:71], v[44:47], a[24:27], v[68:71]
    ds_read_b128 v[40:43], v12 offset:14336
    v_mfma_f32_16x16x32_bf16 v[76:79], v[44:47], a[28:31], v[76:79]
    s_waitcnt lgkmcnt(6)
    v_mfma_f32_16x16x32_bf16 v[72:75], v[48:51], a[24:27], v[72:75]
    ds_read_b128 v[44:47], v13 offset:12288
    s_add_u32 m0, s19, 23808
    v_mfma_f32_16x16x32_bf16 v[80:83], v[48:51], a[28:31], v[80:83]
    buffer_load_dwordx4 v2, s[8:11], s20 offen offset:768 lds
    s_waitcnt lgkmcnt(6)
    v_mfma_f32_16x16x32_bf16 v[68:71], v[20:23], a[32:35], v[68:71]
    ds_read_b128 v[48:51], v13 offset:14336
    v_mfma_f32_16x16x32_bf16 v[76:79], v[20:23], a[36:39], v[76:79]
    s_waitcnt lgkmcnt(6)
    v_mfma_f32_16x16x32_bf16 v[72:75], v[24:27], a[32:35], v[72:75]
    ds_read_b128 v[20:23], v12 offset:16384
    s_add_u32 m0, s19, 27776
    v_mfma_f32_16x16x32_bf16 v[80:83], v[24:27], a[36:39], v[80:83]
    buffer_load_dwordx4 v2, s[8:11], s20 offen offset:896 lds
    s_waitcnt lgkmcnt(6)
    v_mfma_f32_16x16x32_bf16 v[68:71], v[28:31], a[40:43], v[68:71]
    ds_read_b128 v[24:27], v12 offset:18432
    v_mfma_f32_16x16x32_bf16 v[76:79], v[28:31], a[44:47], v[76:79]
    v_cvt_pk_bf16_f32 v84, v52, v53
    s_waitcnt lgkmcnt(6)
    v_mfma_f32_16x16x32_bf16 v[72:75], v[32:35], a[40:43], v[72:75]
    ds_read_b128 v[28:31], v13 offset:16384
    v_mfma_f32_16x16x32_bf16 v[80:83], v[32:35], a[44:47], v[80:83]
    v_cvt_pk_bf16_f32 v85, v54, v55
    s_waitcnt lgkmcnt(6)
    v_mfma_f32_16x16x32_bf16 v[68:71], v[36:39], a[48:51], v[68:71]
    ds_read_b128 v[32:35], v13 offset:18432
    v_mfma_f32_16x16x32_bf16 v[76:79], v[36:39], a[52:55], v[76:79]
    v_cvt_pk_bf16_f32 v86, v56, v57
    s_waitcnt lgkmcnt(6)
    v_mfma_f32_16x16x32_bf16 v[72:75], v[40:43], a[48:51], v[72:75]
    ds_read_b128 v[36:39], v12 offset:20480
    v_mfma_f32_16x16x32_bf16 v[80:83], v[40:43], a[52:55], v[80:83]
    v_cvt_pk_bf16_f32 v87, v58, v59
    s_waitcnt lgkmcnt(6)
    v_mfma_f32_16x16x32_bf16 v[68:71], v[44:47], a[56:59], v[68:71]
    ds_read_b128 v[40:43], v12 offset:22528
    v_mfma_f32_16x16x32_bf16 v[76:79], v[44:47], a[60:63], v[76:79]
    v_cvt_pk_bf16_f32 v88, v60, v61
    s_waitcnt lgkmcnt(6)
    v_mfma_f32_16x16x32_bf16 v[72:75], v[48:51], a[56:59], v[72:75]
    ds_read_b128 v[44:47], v13 offset:20480
    v_mfma_f32_16x16x32_bf16 v[80:83], v[48:51], a[60:63], v[80:83]
    v_cvt_pk_bf16_f32 v89, v62, v63
    buffer_store_dwordx4 v[84:87], v3, s[4:7], s21 offen offset:0 sc1
    s_waitcnt lgkmcnt(6)
    v_mfma_f32_16x16x32_bf16 v[68:71], v[20:23], a[64:67], v[68:71]
    ds_read_b128 v[48:51], v13 offset:22528
    v_mfma_f32_16x16x32_bf16 v[76:79], v[20:23], a[68:71], v[76:79]
    v_cvt_pk_bf16_f32 v90, v64, v65
    s_waitcnt lgkmcnt(6)
    v_mfma_f32_16x16x32_bf16 v[72:75], v[24:27], a[64:67], v[72:75]
    ds_read_b128 v[20:23], v12 offset:24576
    v_mfma_f32_16x16x32_bf16 v[80:83], v[24:27], a[68:71], v[80:83]
    v_cvt_pk_bf16_f32 v91, v66, v67
    s_waitcnt lgkmcnt(6)
    v_mfma_f32_16x16x32_bf16 v[68:71], v[28:31], a[72:75], v[68:71]
    ds_read_b128 v[24:27], v12 offset:26624
    v_mfma_f32_16x16x32_bf16 v[76:79], v[28:31], a[76:79], v[76:79]
    s_waitcnt lgkmcnt(6)
    v_mfma_f32_16x16x32_bf16 v[72:75], v[32:35], a[72:75], v[72:75]
    ds_read_b128 v[28:31], v13 offset:24576
    v_mfma_f32_16x16x32_bf16 v[80:83], v[32:35], a[76:79], v[80:83]
    buffer_store_dwordx4 v[88:91], v3, s[4:7], s21 offen offset:256 sc1
    s_waitcnt lgkmcnt(6)
    v_mfma_f32_16x16x32_bf16 v[68:71], v[36:39], a[80:83], v[68:71]
    ds_read_b128 v[32:35], v13 offset:26624
    v_mfma_f32_16x16x32_bf16 v[76:79], v[36:39], a[84:87], v[76:79]
    s_add_u32 s21, s21, s25
    s_mov_b32 s25, s26
    s_waitcnt lgkmcnt(6)
    v_mfma_f32_16x16x32_bf16 v[72:75], v[40:43], a[80:83], v[72:75]
    ds_read_b128 v[36:39], v12 offset:28672
    v_mfma_f32_16x16x32_bf16 v[80:83], v[40:43], a[84:87], v[80:83]
    s_waitcnt lgkmcnt(6)
    v_mfma_f32_16x16x32_bf16 v[68:71], v[44:47], a[88:91], v[68:71]
    ds_read_b128 v[40:43], v12 offset:30720
    v_mfma_f32_16x16x32_bf16 v[76:79], v[44:47], a[92:95], v[76:79]
    s_waitcnt lgkmcnt(6)
    v_mfma_f32_16x16x32_bf16 v[72:75], v[48:51], a[88:91], v[72:75]
    ds_read_b128 v[44:47], v13 offset:28672
    v_mfma_f32_16x16x32_bf16 v[80:83], v[48:51], a[92:95], v[80:83]
    s_waitcnt lgkmcnt(6)
    v_mfma_f32_16x16x32_bf16 v[68:71], v[20:23], a[96:99], v[68:71]
    ds_read_b128 v[48:51], v13 offset:30720
    v_mfma_f32_16x16x32_bf16 v[76:79], v[20:23], a[100:103], v[76:79]
    s_waitcnt lgkmcnt(6)
    v_mfma_f32_16x16x32_bf16 v[72:75], v[24:27], a[96:99], v[72:75]
    s_waitcnt vmcnt(11)
    s_barrier
    ds_read_b128 v[20:23], v12 offset:32768
    v_mfma_f32_16x16x32_bf16 v[80:83], v[24:27], a[100:103], v[80:83]
    s_waitcnt lgkmcnt(6)
    v_mfma_f32_16x16x32_bf16 v[68:71], v[28:31], a[104:107], v[68:71]
    ds_read_b128 v[24:27], v12 offset:34816
    s_add_u32 m0, s19, 31744
    v_mfma_f32_16x16x32_bf16 v[76:79], v[28:31], a[108:111], v[76:79]
    buffer_load_dwordx4 v2, s[8:11], s20 offen offset:1024 lds
    s_waitcnt lgkmcnt(6)
    v_mfma_f32_16x16x32_bf16 v[72:75], v[32:35], a[104:107], v[72:75]
    ds_read_b128 v[28:31], v13 offset:32768
    v_mfma_f32_16x16x32_bf16 v[80:83], v[32:35], a[108:111], v[80:83]
    s_waitcnt lgkmcnt(6)
    v_mfma_f32_16x16x32_bf16 v[68:71], v[36:39], a[112:115], v[68:71]
    ds_read_b128 v[32:35], v13 offset:34816
    s_add_u32 m0, s19, 35712
    v_mfma_f32_16x16x32_bf16 v[76:79], v[36:39], a[116:119], v[76:79]
    buffer_load_dwordx4 v2, s[8:11], s20 offen offset:1152 lds
    s_waitcnt lgkmcnt(6)
    v_mfma_f32_16x16x32_bf16 v[72:75], v[40:43], a[112:115], v[72:75]
    ds_read_b128 v[36:39], v12 offset:36864
    v_mfma_f32_16x16x32_bf16 v[80:83], v[40:43], a[116:119], v[80:83]
    s_waitcnt lgkmcnt(6)
    v_mfma_f32_16x16x32_bf16 v[68:71], v[44:47], a[120:123], v[68:71]
    ds_read_b128 v[40:43], v12 offset:38912
    s_add_u32 m0, s19, 39680
    v_mfma_f32_16x16x32_bf16 v[76:79], v[44:47], a[124:127], v[76:79]
    buffer_load_dwordx4 v2, s[8:11], s20 offen offset:1280 lds
    s_waitcnt lgkmcnt(6)
    v_mfma_f32_16x16x32_bf16 v[72:75], v[48:51], a[120:123], v[72:75]
    ds_read_b128 v[44:47], v13 offset:36864
    v_mfma_f32_16x16x32_bf16 v[80:83], v[48:51], a[124:127], v[80:83]
    s_waitcnt lgkmcnt(6)
    v_mfma_f32_16x16x32_bf16 v[68:71], v[20:23], a[128:131], v[68:71]
    ds_read_b128 v[48:51], v13 offset:38912
    v_mfma_f32_16x16x32_bf16 v[76:79], v[20:23], a[132:135], v[76:79]
    s_waitcnt lgkmcnt(6)
    v_mfma_f32_16x16x32_bf16 v[72:75], v[24:27], a[128:131], v[72:75]
    ds_read_b128 v[20:23], v12 offset:40960
    s_add_u32 m0, s19, 43648
    v_mfma_f32_16x16x32_bf16 v[80:83], v[24:27], a[132:135], v[80:83]
    buffer_load_dwordx4 v2, s[8:11], s20 offen offset:1408 lds
    s_waitcnt lgkmcnt(6)
    v_mfma_f32_16x16x32_bf16 v[68:71], v[28:31], a[136:139], v[68:71]
    ds_read_b128 v[24:27], v12 offset:43008
    v_mfma_f32_16x16x32_bf16 v[76:79], v[28:31], a[140:143], v[76:79]
    s_waitcnt lgkmcnt(6)
    v_mfma_f32_16x16x32_bf16 v[72:75], v[32:35], a[136:139], v[72:75]
    ds_read_b128 v[28:31], v13 offset:40960
    s_add_u32 m0, s19, 47616
    v_mfma_f32_16x16x32_bf16 v[80:83], v[32:35], a[140:143], v[80:83]
    buffer_load_dwordx4 v2, s[8:11], s20 offen offset:1536 lds
    s_waitcnt lgkmcnt(6)
    v_mfma_f32_16x16x32_bf16 v[68:71], v[36:39], a[144:147], v[68:71]
    ds_read_b128 v[32:35], v13 offset:43008
    v_mfma_f32_16x16x32_bf16 v[76:79], v[36:39], a[148:151], v[76:79]
    s_waitcnt lgkmcnt(6)
    v_mfma_f32_16x16x32_bf16 v[72:75], v[40:43], a[144:147], v[72:75]
    ds_read_b128 v[36:39], v12 offset:45056
    s_add_u32 m0, s19, 51584
    v_mfma_f32_16x16x32_bf16 v[80:83], v[40:43], a[148:151], v[80:83]
    buffer_load_dwordx4 v2, s[8:11], s20 offen offset:1664 lds
    s_waitcnt lgkmcnt(6)
    v_mfma_f32_16x16x32_bf16 v[68:71], v[44:47], a[152:155], v[68:71]
    ds_read_b128 v[40:43], v12 offset:47104
    v_mfma_f32_16x16x32_bf16 v[76:79], v[44:47], a[156:159], v[76:79]
    s_waitcnt lgkmcnt(6)
    v_mfma_f32_16x16x32_bf16 v[72:75], v[48:51], a[152:155], v[72:75]
    ds_read_b128 v[44:47], v13 offset:45056
    s_add_u32 m0, s19, 55552
    v_mfma_f32_16x16x32_bf16 v[80:83], v[48:51], a[156:159], v[80:83]
    buffer_load_dwordx4 v2, s[8:11], s20 offen offset:1792 lds
    s_waitcnt lgkmcnt(6)
    v_mfma_f32_16x16x32_bf16 v[68:71], v[20:23], a[160:163], v[68:71]
    ds_read_b128 v[48:51], v13 offset:47104
    v_mfma_f32_16x16x32_bf16 v[76:79], v[20:23], a[164:167], v[76:79]
    s_waitcnt lgkmcnt(6)
    v_mfma_f32_16x16x32_bf16 v[72:75], v[24:27], a[160:163], v[72:75]
    ds_read_b128 v[20:23], v12 offset:49152
    s_add_u32 m0, s19, 59520
    v_mfma_f32_16x16x32_bf16 v[80:83], v[24:27], a[164:167], v[80:83]
    buffer_load_dwordx4 v2, s[8:11], s20 offen offset:1920 lds
    s_waitcnt lgkmcnt(6)
    v_mfma_f32_16x16x32_bf16 v[68:71], v[28:31], a[168:171], v[68:71]
    ds_read_b128 v[24:27], v12 offset:51200
    v_mfma_f32_16x16x32_bf16 v[76:79], v[28:31], a[172:175], v[76:79]
    s_add_u32 s20, s20, s24
    s_waitcnt lgkmcnt(6)
    v_mfma_f32_16x16x32_bf16 v[72:75], v[32:35], a[168:171], v[72:75]
    ds_read_b128 v[28:31], v13 offset:49152
    v_mfma_f32_16x16x32_bf16 v[80:83], v[32:35], a[172:175], v[80:83]
    s_waitcnt lgkmcnt(6)
    v_mfma_f32_16x16x32_bf16 v[68:71], v[36:39], a[176:179], v[68:71]
    ds_read_b128 v[32:35], v13 offset:51200
    v_mfma_f32_16x16x32_bf16 v[76:79], v[36:39], a[180:183], v[76:79]
    s_waitcnt lgkmcnt(6)
    v_mfma_f32_16x16x32_bf16 v[72:75], v[40:43], a[176:179], v[72:75]
    ds_read_b128 v[36:39], v12 offset:53248
    v_mfma_f32_16x16x32_bf16 v[80:83], v[40:43], a[180:183], v[80:83]
    s_waitcnt lgkmcnt(6)
    v_mfma_f32_16x16x32_bf16 v[68:71], v[44:47], a[184:187], v[68:71]
    ds_read_b128 v[40:43], v12 offset:55296
    v_mfma_f32_16x16x32_bf16 v[76:79], v[44:47], a[188:191], v[76:79]
    s_waitcnt lgkmcnt(6)
    v_mfma_f32_16x16x32_bf16 v[72:75], v[48:51], a[184:187], v[72:75]
    ds_read_b128 v[44:47], v13 offset:53248
    v_mfma_f32_16x16x32_bf16 v[80:83], v[48:51], a[188:191], v[80:83]
    s_waitcnt lgkmcnt(6)
    v_mfma_f32_16x16x32_bf16 v[68:71], v[20:23], a[192:195], v[68:71]
    ds_read_b128 v[48:51], v13 offset:55296
    v_mfma_f32_16x16x32_bf16 v[76:79], v[20:23], a[196:199], v[76:79]
    s_waitcnt lgkmcnt(6)
    v_mfma_f32_16x16x32_bf16 v[72:75], v[24:27], a[192:195], v[72:75]
    ds_read_b128 v[20:23], v12 offset:57344
    v_mfma_f32_16x16x32_bf16 v[80:83], v[24:27], a[196:199], v[80:83]
    s_waitcnt lgkmcnt(6)
    v_mfma_f32_16x16x32_bf16 v[68:71], v[28:31], a[200:203], v[68:71]
    ds_read_b128 v[24:27], v12 offset:59392
    v_mfma_f32_16x16x32_bf16 v[76:79], v[28:31], a[204:207], v[76:79]
    s_waitcnt lgkmcnt(6)
    v_mfma_f32_16x16x32_bf16 v[72:75], v[32:35], a[200:203], v[72:75]
    ds_read_b128 v[28:31], v13 offset:57344
    v_mfma_f32_16x16x32_bf16 v[80:83], v[32:35], a[204:207], v[80:83]
    s_waitcnt lgkmcnt(6)
    v_mfma_f32_16x16x32_bf16 v[68:71], v[36:39], a[208:211], v[68:71]
    ds_read_b128 v[32:35], v13 offset:59392
    v_mfma_f32_16x16x32_bf16 v[76:79], v[36:39], a[212:215], v[76:79]
    s_waitcnt lgkmcnt(6)
    v_mfma_f32_16x16x32_bf16 v[72:75], v[40:43], a[208:211], v[72:75]
    ds_read_b128 v[36:39], v12 offset:61440
    v_mfma_f32_16x16x32_bf16 v[80:83], v[40:43], a[212:215], v[80:83]
    s_waitcnt lgkmcnt(6)
    v_mfma_f32_16x16x32_bf16 v[68:71], v[44:47], a[216:219], v[68:71]
    ds_read_b128 v[40:43], v12 offset:63488
    v_mfma_f32_16x16x32_bf16 v[76:79], v[44:47], a[220:223], v[76:79]
    s_waitcnt lgkmcnt(6)
    v_mfma_f32_16x16x32_bf16 v[72:75], v[48:51], a[216:219], v[72:75]
    ds_read_b128 v[44:47], v13 offset:61440
    v_mfma_f32_16x16x32_bf16 v[80:83], v[48:51], a[220:223], v[80:83]
    s_waitcnt lgkmcnt(6)
    v_mfma_f32_16x16x32_bf16 v[68:71], v[20:23], a[224:227], v[68:71]
    ds_read_b128 v[48:51], v13 offset:63488
    v_mfma_f32_16x16x32_bf16 v[76:79], v[20:23], a[228:231], v[76:79]
    s_waitcnt lgkmcnt(6)
    v_mfma_f32_16x16x32_bf16 v[72:75], v[24:27], a[224:227], v[72:75]
    s_waitcnt vmcnt(8)
    s_barrier
    ds_read_b128 v[20:23], v10 offset:0
    v_mfma_f32_16x16x32_bf16 v[80:83], v[24:27], a[228:231], v[80:83]
    s_waitcnt lgkmcnt(6)
    v_mfma_f32_16x16x32_bf16 v[68:71], v[28:31], a[232:235], v[68:71]
    ds_read_b128 v[24:27], v10 offset:2048
    s_add_u32 m0, s19, 65536
    v_mfma_f32_16x16x32_bf16 v[76:79], v[28:31], a[236:239], v[76:79]
    buffer_load_dwordx4 v2, s[8:11], s20 offen offset:0 lds
    s_waitcnt lgkmcnt(6)
    v_mfma_f32_16x16x32_bf16 v[72:75], v[32:35], a[232:235], v[72:75]
    ds_read_b128 v[28:31], v11 offset:0
    v_mfma_f32_16x16x32_bf16 v[80:83], v[32:35], a[236:239], v[80:83]
    v_mov_b32 v9, s23
    s_add_u32 s23, s23, 1
    buffer_store_dword v9, v4, s[4:7], 0 offen sc1
    s_waitcnt lgkmcnt(6)
    v_mfma_f32_16x16x32_bf16 v[68:71], v[36:39], a[240:243], v[68:71]
    ds_read_b128 v[32:35], v11 offset:2048
    s_add_u32 m0, s19, 69504
    v_mfma_f32_16x16x32_bf16 v[76:79], v[36:39], a[244:247], v[76:79]
    buffer_load_dwordx4 v2, s[8:11], s20 offen offset:128 lds
    s_waitcnt lgkmcnt(6)
    v_mfma_f32_16x16x32_bf16 v[72:75], v[40:43], a[240:243], v[72:75]
    ds_read_b128 v[36:39], v10 offset:4096
    v_mfma_f32_16x16x32_bf16 v[80:83], v[40:43], a[244:247], v[80:83]
    s_waitcnt lgkmcnt(6)
    v_mfma_f32_16x16x32_bf16 v[68:71], v[44:47], a[248:251], v[68:71]
    ds_read_b128 v[40:43], v10 offset:6144
    s_add_u32 m0, s19, 73472
    v_mfma_f32_16x16x32_bf16 v[76:79], v[44:47], a[252:255], v[76:79]
    buffer_load_dwordx4 v2, s[8:11], s20 offen offset:256 lds
    s_waitcnt lgkmcnt(6)
    v_mfma_f32_16x16x32_bf16 v[72:75], v[48:51], a[248:251], v[72:75]
    ds_read_b128 v[44:47], v11 offset:4096
    v_mfma_f32_16x16x32_bf16 v[80:83], v[48:51], a[252:255], v[80:83]
    s_add_u32 s22, s22, 2
    s_cmp_lt_u32 s22, 64
    s_cbranch_scc1 P_v_top
    v_cvt_pk_bf16_f32 v84, v68, v69
    v_cvt_pk_bf16_f32 v85, v70, v71
    s_nop 0
    v_cvt_pk_bf16_f32 v86, v72, v73
    v_cvt_pk_bf16_f32 v87, v74, v75
    v_cvt_pk_bf16_f32 v88, v76, v77
    v_cvt_pk_bf16_f32 v89, v78, v79
    v_cvt_pk_bf16_f32 v90, v80, v81
    v_cvt_pk_bf16_f32 v91, v82, v83
    buffer_store_dwordx4 v[84:87], v3, s[4:7], s21 offen offset:0 sc1
    buffer_store_dwordx4 v[88:91], v3, s[4:7], s21 offen offset:256 sc1
    s_waitcnt vmcnt(0) lgkmcnt(0)
    v_mov_b32 v9, s23
    s_add_u32 s23, s23, 1
    buffer_store_dword v9, v4, s[4:7], 0 offen sc1
    s_branch W_U
W_U:
    v_lshlrev_b32 v5, 2, v1
    s_mov_b32 s18, 0
rdv_13:
    global_load_dword v6, v5, s[100:101] sc1
    s_lshl_b32 s17, s98, 2
    s_waitcnt vmcnt(0)
    v_lshrrev_b32 v9, s17, v6
    s_cmp_eq_u32 s98, 0
    s_cselect_b32 s17, 0x0f0f0f0f, s17
    s_cselect_b32 s17, s17, 0x01010101
    v_and_b32 v9, s17, v9
    v_cmp_ne_u32 vcc, 0x01010101, v9
    s_nop 0
    s_cbranch_vccz rdvok_14
    v_sad_u8 v9, v9, 0, 0
    s_nop 1
    v_add_u32_dpp v9, v9, v9 quad_perm:[1,0,3,2] row_mask:0xf bank_mask:0xf
    v_cmp_ne_u32 vcc, 8, v9
    s_nop 0
    s_cbranch_vccnz rdvw_15
    s_mov_b32 s98, 1
    s_and_b32 s3, s97, 7
    s_barrier
    s_branch role_start
rdvw_15:
    s_sleep 4
    s_add_u32 s18, s18, 1
    s_cmp_lt_u32 s18, 262144
    s_cbranch_scc1 rdv_13
    s_mov_b32 s92, 1048576
rdvok_14:
    s_load_dwordx2 s[8:9], s[0:1], 64
    s_load_dwordx2 s[12:13], s[0:1], 80
    s_mov_b32 s10, 8388608
    s_mov_b32 s11, 0x20000
    s_mov_b32 s14, 8388608
    s_mov_b32 s15, 0x20000
    s_and_b32 s35, s93, 15
    s_lshr_b32 s28, s93, 4
    s_lshl_b32 s17, s90, 1
    s_add_u32 s28, s28, s17
    s_lshl_b32 s20, s16, 21
    s_lshl_b32 s17, s35, 7
    s_add_u32 s20, s20, s17
    v_lshrrev_b32 v5, 2, v1
    v_and_b32 v6, 3, v1
    v_lshlrev_b32 v7, 4, v6
    v_lshl_add_u32 v7, v5, 11, v7
    v_lshlrev_b32 v8, 3, v6
    v_bfe_u32 v5, v1, 2, 2
    v_lshrrev_b32 v6, 4, v1
    v_lshl_add_u32 v5, v6, 3, v5
    v_lshl_add_u32 v8, v5, 6, v8
    s_lshl_b32 s19, s16, 15
    v_add_u32 v8, s19, v8
    s_and_b32 s37, s93, 0
    s_lshl_b32 s37, s37, 18
    s_waitcnt lgkmcnt(0)
    s_barrier
    s_sub_u32 s17, s90, 1
    s_and_b32 s17, s17, 3
    s_lshl_b32 s17, s17, 3
    s_and_b32 s18, s93, 7
    s_add_u32 s17, s17, s18
    s_lshl_b32 s17, s17, 8
    v_add_lshl_u32 v5, v0, s17, 11
    s_and_b32 s17, s93, 8
    s_lshl_b32 s17, s17, 7
    buffer_load_dword v48, v5, s[8:11], s17 offen offset:384
    s_add_u32 m0, s19, 0
    s_add_u32 s17, s37, 0
    s_bitset0_b32 s17, 21
    s_add_u32 s17, s17, s20
    buffer_load_dwordx4 v7, s[8:11], s17 offen lds
    s_add_u32 m0, s19, 1024
    s_add_u32 s17, s37, 32768
    s_bitset0_b32 s17, 21
    s_add_u32 s17, s17, s20
    buffer_load_dwordx4 v7, s[8:11], s17 offen lds
    s_add_u32 m0, s19, 2048
    s_add_u32 s17, s37, 65536
    s_bitset0_b32 s17, 21
    s_add_u32 s17, s17, s20
    buffer_load_dwordx4 v7, s[8:11], s17 offen lds
    s_add_u32 m0, s19, 3072
    s_add_u32 s17, s37, 98304
    s_bitset0_b32 s17, 21
    s_add_u32 s17, s17, s20
    buffer_load_dwordx4 v7, s[8:11], s17 offen lds
    s_add_u32 m0, s19, 4096
    s_add_u32 s17, s37, 131072
    s_bitset0_b32 s17, 21
    s_add_u32 s17, s17, s20
    buffer_load_dwordx4 v7, s[8:11], s17 offen lds
    s_add_u32 m0, s19, 5120
    s_add_u32 s17, s37, 163840
    s_bitset0_b32 s17, 21
    s_add_u32 s17, s17, s20
    buffer_load_dwordx4 v7, s[8:11], s17 offen lds
    s_add_u32 m0, s19, 6144
    s_add_u32 s17, s37, 196608
    s_bitset0_b32 s17, 21
    s_add_u32 s17, s17, s20
    buffer_load_dwordx4 v7, s[8:11], s17 offen lds
    s_add_u32 m0, s19, 7168
    s_add_u32 s17, s37, 229376
    s_bitset0_b32 s17, 21
    s_add_u32 s17, s17, s20
    buffer_load_dwordx4 v7, s[8:11], s17 offen lds
    s_add_u32 m0, s19, 8192
    s_add_u32 s17, s37, 262144
    s_bitset0_b32 s17, 21
    s_add_u32 s17, s17, s20
    buffer_load_dwordx4 v7, s[8:11], s17 offen lds
    s_add_u32 m0, s19, 9216
    s_add_u32 s17, s37, 294912
    s_bitset0_b32 s17, 21
    s_add_u32 s17, s17, s20
    buffer_load_dwordx4 v7, s[8:11], s17 offen lds
    s_add_u32 m0, s19, 10240
    s_add_u32 s17, s37, 327680
    s_bitset0_b32 s17, 21
    s_add_u32 s17, s17, s20
    buffer_load_dwordx4 v7, s[8:11], s17 offen lds
    s_add_u32 m0, s19, 11264
    s_add_u32 s17, s37, 360448
    s_bitset0_b32 s17, 21
    s_add_u32 s17, s17, s20
    buffer_load_dwordx4 v7, s[8:11], s17 offen lds
    s_add_u32 m0, s19, 12288
    s_add_u32 s17, s37, 393216
    s_bitset0_b32 s17, 21
    s_add_u32 s17, s17, s20
    buffer_load_dwordx4 v7, s[8:11], s17 offen lds
    s_add_u32 m0, s19, 13312
    s_add_u32 s17, s37, 425984
    s_bitset0_b32 s17, 21
    s_add_u32 s17, s17, s20
    buffer_load_dwordx4 v7, s[8:11], s17 offen lds
    s_add_u32 m0, s19, 14336
    s_add_u32 s17, s37, 458752
    s_bitset0_b32 s17, 21
    s_add_u32 s17, s17, s20
    buffer_load_dwordx4 v7, s[8:11], s17 offen lds
    s_add_u32 m0, s19, 15360
    s_add_u32 s17, s37, 491520
    s_bitset0_b32 s17, 21
    s_add_u32 s17, s17, s20
    buffer_load_dwordx4 v7, s[8:11], s17 offen lds
    s_add_u32 m0, s19, 16384
    s_add_u32 s17, s37, 524288
    s_bitset0_b32 s17, 21
    s_add_u32 s17, s17, s20
    buffer_load_dwordx4 v7, s[8:11], s17 offen lds
    s_add_u32 m0, s19, 17408
    s_add_u32 s17, s37, 557056
    s_bitset0_b32 s17, 21
    s_add_u32 s17, s17, s20
    buffer_load_dwordx4 v7, s[8:11], s17 offen lds
    s_add_u32 m0, s19, 18432
    s_add_u32 s17, s37, 589824
    s_bitset0_b32 s17, 21
    s_add_u32 s17, s17, s20
    buffer_load_dwordx4 v7, s[8:11], s17 offen lds
    s_add_u32 m0, s19, 19456
    s_add_u32 s17, s37, 622592
    s_bitset0_b32 s17, 21
    s_add_u32 s17, s17, s20
    buffer_load_dwordx4 v7, s[8:11], s17 offen lds
    s_add_u32 m0, s19, 20480
    s_add_u32 s17, s37, 655360
    s_bitset0_b32 s17, 21
    s_add_u32 s17, s17, s20
    buffer_load_dwordx4 v7, s[8:11], s17 offen lds
    s_add_u32 m0, s19, 21504
    s_add_u32 s17, s37, 688128
    s_bitset0_b32 s17, 21
    s_add_u32 s17, s17, s20
    buffer_load_dwordx4 v7, s[8:11], s17 offen lds
    s_add_u32 m0, s19, 22528
    s_add_u32 s17, s37, 720896
    s_bitset0_b32 s17, 21
    s_add_u32 s17, s17, s20
    buffer_load_dwordx4 v7, s[8:11], s17 offen lds
    s_add_u32 m0, s19, 23552
    s_add_u32 s17, s37, 753664
    s_bitset0_b32 s17, 21
    s_add_u32 s17, s17, s20
    buffer_load_dwordx4 v7, s[8:11], s17 offen lds
    s_add_u32 m0, s19, 24576
    s_add_u32 s17, s37, 786432
    s_bitset0_b32 s17, 21
    s_add_u32 s17, s17, s20
    buffer_load_dwordx4 v7, s[8:11], s17 offen lds
    s_add_u32 m0, s19, 25600
    s_add_u32 s17, s37, 819200
    s_bitset0_b32 s17, 21
    s_add_u32 s17, s17, s20
    buffer_load_dwordx4 v7, s[8:11], s17 offen lds
    s_add_u32 m0, s19, 26624
    s_add_u32 s17, s37, 851968
    s_bitset0_b32 s17, 21
    s_add_u32 s17, s17, s20
    buffer_load_dwordx4 v7, s[8:11], s17 offen lds
    s_add_u32 m0, s19, 27648
    s_add_u32 s17, s37, 884736
    s_bitset0_b32 s17, 21
    s_add_u32 s17, s17, s20
    buffer_load_dwordx4 v7, s[8:11], s17 offen lds
    s_add_u32 m0, s19, 28672
    s_add_u32 s17, s37, 917504
    s_bitset0_b32 s17, 21
    s_add_u32 s17, s17, s20
    buffer_load_dwordx4 v7, s[8:11], s17 offen lds
    s_add_u32 m0, s19, 29696
    s_add_u32 s17, s37, 950272
    s_bitset0_b32 s17, 21
    s_add_u32 s17, s17, s20
    buffer_load_dwordx4 v7, s[8:11], s17 offen lds
    s_add_u32 m0, s19, 30720
    s_add_u32 s17, s37, 983040
    s_bitset0_b32 s17, 21
    s_add_u32 s17, s17, s20
    buffer_load_dwordx4 v7, s[8:11], s17 offen lds
    s_add_u32 m0, s19, 31744
    s_add_u32 s17, s37, 1015808
    s_bitset0_b32 s17, 21
    s_add_u32 s17, s17, s20
    buffer_load_dwordx4 v7, s[8:11], s17 offen lds
    s_waitcnt vmcnt(30)
    ds_read_b64_tr_b16 a[0:1], v8 offset:0
    ds_read_b64_tr_b16 a[2:3], v8 offset:256
    ds_read_b64_tr_b16 a[4:5], v8 offset:32
    ds_read_b64_tr_b16 a[6:7], v8 offset:288
    s_waitcnt vmcnt(28)
    ds_read_b64_tr_b16 a[8:9], v8 offset:2048
    ds_read_b64_tr_b16 a[10:11], v8 offset:2304
    ds_read_b64_tr_b16 a[12:13], v8 offset:2080
    ds_read_b64_tr_b16 a[14:15], v8 offset:2336
    s_waitcnt lgkmcnt(4)
    s_add_u32 m0, s19, 0
    s_add_u32 s17, s37, 1048576
    s_bitset0_b32 s17, 21
    s_add_u32 s17, s17, s20
    buffer_load_dwordx4 v7, s[8:11], s17 offen lds
    s_add_u32 m0, s19, 1024
    s_add_u32 s17, s37, 1081344
    s_bitset0_b32 s17, 21
    s_add_u32 s17, s17, s20
    buffer_load_dwordx4 v7, s[8:11], s17 offen lds
    s_waitcnt vmcnt(28)
    ds_read_b64_tr_b16 a[16:17], v8 offset:4096
    ds_read_b64_tr_b16 a[18:19], v8 offset:4352
    ds_read_b64_tr_b16 a[20:21], v8 offset:4128
    ds_read_b64_tr_b16 a[22:23], v8 offset:4384
    s_waitcnt lgkmcnt(4)
    s_add_u32 m0, s19, 2048
    s_add_u32 s17, s37, 1114112
    s_bitset0_b32 s17, 21
    s_add_u32 s17, s17, s20
    buffer_load_dwordx4 v7, s[8:11], s17 offen lds
    s_add_u32 m0, s19, 3072
    s_add_u32 s17, s37, 1146880
    s_bitset0_b32 s17, 21
    s_add_u32 s17, s17, s20
    buffer_load_dwordx4 v7, s[8:11], s17 offen lds
    s_waitcnt vmcnt(28)
    ds_read_b64_tr_b16 a[24:25], v8 offset:6144
    ds_read_b64_tr_b16 a[26:27], v8 offset:6400
    ds_read_b64_tr_b16 a[28:29], v8 offset:6176
    ds_read_b64_tr_b16 a[30:31], v8 offset:6432
    s_waitcnt lgkmcnt(4)
    s_add_u32 m0, s19, 4096
    s_add_u32 s17, s37, 1179648
    s_bitset0_b32 s17, 21
    s_add_u32 s17, s17, s20
    buffer_load_dwordx4 v7, s[8:11], s17 offen lds
    s_add_u32 m0, s19, 5120
    s_add_u32 s17, s37, 1212416
    s_bitset0_b32 s17, 21
    s_add_u32 s17, s17, s20
    buffer_load_dwordx4 v7, s[8:11], s17 offen lds
    s_waitcnt vmcnt(28)
    ds_read_b64_tr_b16 a[32:33], v8 offset:8192
    ds_read_b64_tr_b16 a[34:35], v8 offset:8448
    ds_read_b64_tr_b16 a[36:37], v8 offset:8224
    ds_read_b64_tr_b16 a[38:39], v8 offset:8480
    s_waitcnt lgkmcnt(4)
    s_add_u32 m0, s19, 6144
    s_add_u32 s17, s37, 1245184
    s_bitset0_b32 s17, 21
    s_add_u32 s17, s17, s20
    buffer_load_dwordx4 v7, s[8:11], s17 offen lds
    s_add_u32 m0, s19, 7168
    s_add_u32 s17, s37, 1277952
    s_bitset0_b32 s17, 21
    s_add_u32 s17, s17, s20
    buffer_load_dwordx4 v7, s[8:11], s17 offen lds
    s_waitcnt vmcnt(28)
    ds_read_b64_tr_b16 a[40:41], v8 offset:10240
    ds_read_b64_tr_b16 a[42:43], v8 offset:10496
    ds_read_b64_tr_b16 a[44:45], v8 offset:10272
    ds_read_b64_tr_b16 a[46:47], v8 offset:10528
    s_waitcnt lgkmcnt(4)
    s_add_u32 m0, s19, 8192
    s_add_u32 s17, s37, 1310720
    s_bitset0_b32 s17, 21
    s_add_u32 s17, s17, s20
    buffer_load_dwordx4 v7, s[8:11], s17 offen lds
    s_add_u32 m0, s19, 9216
    s_add_u32 s17, s37, 1343488
    s_bitset0_b32 s17, 21
    s_add_u32 s17, s17, s20
    buffer_load_dwordx4 v7, s[8:11], s17 offen lds
    s_waitcnt vmcnt(28)
    ds_read_b64_tr_b16 a[48:49], v8 offset:12288
    ds_read_b64_tr_b16 a[50:51], v8 offset:12544
    ds_read_b64_tr_b16 a[52:53], v8 offset:12320
    ds_read_b64_tr_b16 a[54:55], v8 offset:12576
    s_waitcnt lgkmcnt(4)
    s_add_u32 m0, s19, 10240
    s_add_u32 s17, s37, 1376256
    s_bitset0_b32 s17, 21
    s_add_u32 s17, s17, s20
    buffer_load_dwordx4 v7, s[8:11], s17 offen lds
    s_add_u32 m0, s19, 11264
    s_add_u32 s17, s37, 1409024
    s_bitset0_b32 s17, 21
    s_add_u32 s17, s17, s20
    buffer_load_dwordx4 v7, s[8:11], s17 offen lds
    s_waitcnt vmcnt(28)
    ds_read_b64_tr_b16 a[56:57], v8 offset:14336
    ds_read_b64_tr_b16 a[58:59], v8 offset:14592
    ds_read_b64_tr_b16 a[60:61], v8 offset:14368
    ds_read_b64_tr_b16 a[62:63], v8 offset:14624
    s_waitcnt lgkmcnt(4)
    s_add_u32 m0, s19, 12288
    s_add_u32 s17, s37, 1441792
    s_bitset0_b32 s17, 21
    s_add_u32 s17, s17, s20
    buffer_load_dwordx4 v7, s[8:11], s17 offen lds
    s_add_u32 m0, s19, 13312
    s_add_u32 s17, s37, 1474560
    s_bitset0_b32 s17, 21
    s_add_u32 s17, s17, s20
    buffer_load_dwordx4 v7, s[8:11], s17 offen lds
    s_waitcnt vmcnt(28)
    ds_read_b64_tr_b16 a[64:65], v8 offset:16384
    ds_read_b64_tr_b16 a[66:67], v8 offset:16640
    ds_read_b64_tr_b16 a[68:69], v8 offset:16416
    ds_read_b64_tr_b16 a[70:71], v8 offset:16672
    s_waitcnt lgkmcnt(4)
    s_add_u32 m0, s19, 14336
    s_add_u32 s17, s37, 1507328
    s_bitset0_b32 s17, 21
    s_add_u32 s17, s17, s20
    buffer_load_dwordx4 v7, s[8:11], s17 offen lds
    s_add_u32 m0, s19, 15360
    s_add_u32 s17, s37, 1540096
    s_bitset0_b32 s17, 21
    s_add_u32 s17, s17, s20
    buffer_load_dwordx4 v7, s[8:11], s17 offen lds
    s_waitcnt vmcnt(28)
    ds_read_b64_tr_b16 a[72:73], v8 offset:18432
    ds_read_b64_tr_b16 a[74:75], v8 offset:18688
    ds_read_b64_tr_b16 a[76:77], v8 offset:18464
    ds_read_b64_tr_b16 a[78:79], v8 offset:18720
    s_waitcnt lgkmcnt(4)
    s_add_u32 m0, s19, 16384
    s_add_u32 s17, s37, 1572864
    s_bitset0_b32 s17, 21
    s_add_u32 s17, s17, s20
    buffer_load_dwordx4 v7, s[8:11], s17 offen lds
    s_add_u32 m0, s19, 17408
    s_add_u32 s17, s37, 1605632
    s_bitset0_b32 s17, 21
    s_add_u32 s17, s17, s20
    buffer_load_dwordx4 v7, s[8:11], s17 offen lds
    s_waitcnt vmcnt(28)
    ds_read_b64_tr_b16 a[80:81], v8 offset:20480
    ds_read_b64_tr_b16 a[82:83], v8 offset:20736
    ds_read_b64_tr_b16 a[84:85], v8 offset:20512
    ds_read_b64_tr_b16 a[86:87], v8 offset:20768
    s_waitcnt lgkmcnt(4)
    s_add_u32 m0, s19, 18432
    s_add_u32 s17, s37, 1638400
    s_bitset0_b32 s17, 21
    s_add_u32 s17, s17, s20
    buffer_load_dwordx4 v7, s[8:11], s17 offen lds
    s_add_u32 m0, s19, 19456
    s_add_u32 s17, s37, 1671168
    s_bitset0_b32 s17, 21
    s_add_u32 s17, s17, s20
    buffer_load_dwordx4 v7, s[8:11], s17 offen lds
    s_waitcnt vmcnt(28)
    ds_read_b64_tr_b16 a[88:89], v8 offset:22528
    ds_read_b64_tr_b16 a[90:91], v8 offset:22784
    ds_read_b64_tr_b16 a[92:93], v8 offset:22560
    ds_read_b64_tr_b16 a[94:95], v8 offset:22816
    s_waitcnt lgkmcnt(4)
    s_add_u32 m0, s19, 20480
    s_add_u32 s17, s37, 1703936
    s_bitset0_b32 s17, 21
    s_add_u32 s17, s17, s20
    buffer_load_dwordx4 v7, s[8:11], s17 offen lds
    s_add_u32 m0, s19, 21504
    s_add_u32 s17, s37, 1736704
    s_bitset0_b32 s17, 21
    s_add_u32 s17, s17, s20
    buffer_load_dwordx4 v7, s[8:11], s17 offen lds
    s_waitcnt vmcnt(28)
    ds_read_b64_tr_b16 a[96:97], v8 offset:24576
    ds_read_b64_tr_b16 a[98:99], v8 offset:24832
    ds_read_b64_tr_b16 a[100:101], v8 offset:24608
    ds_read_b64_tr_b16 a[102:103], v8 offset:24864
    s_waitcnt lgkmcnt(4)
    s_add_u32 m0, s19, 22528
    s_add_u32 s17, s37, 1769472
    s_bitset0_b32 s17, 21
    s_add_u32 s17, s17, s20
    buffer_load_dwordx4 v7, s[8:11], s17 offen lds
    s_add_u32 m0, s19, 23552
    s_add_u32 s17, s37, 1802240
    s_bitset0_b32 s17, 21
    s_add_u32 s17, s17, s20
    buffer_load_dwordx4 v7, s[8:11], s17 offen lds
    s_waitcnt vmcnt(28)
    ds_read_b64_tr_b16 a[104:105], v8 offset:26624
    ds_read_b64_tr_b16 a[106:107], v8 offset:26880
    ds_read_b64_tr_b16 a[108:109], v8 offset:26656
    ds_read_b64_tr_b16 a[110:111], v8 offset:26912
    s_waitcnt lgkmcnt(4)
    s_add_u32 m0, s19, 24576
    s_add_u32 s17, s37, 1835008
    s_bitset0_b32 s17, 21
    s_add_u32 s17, s17, s20
    buffer_load_dwordx4 v7, s[8:11], s17 offen lds
    s_add_u32 m0, s19, 25600
    s_add_u32 s17, s37, 1867776
    s_bitset0_b32 s17, 21
    s_add_u32 s17, s17, s20
    buffer_load_dwordx4 v7, s[8:11], s17 offen lds
    s_waitcnt vmcnt(28)
    ds_read_b64_tr_b16 a[112:113], v8 offset:28672
    ds_read_b64_tr_b16 a[114:115], v8 offset:28928
    ds_read_b64_tr_b16 a[116:117], v8 offset:28704
    ds_read_b64_tr_b16 a[118:119], v8 offset:28960
    s_waitcnt lgkmcnt(4)
    s_add_u32 m0, s19, 26624
    s_add_u32 s17, s37, 1900544
    s_bitset0_b32 s17, 21
    s_add_u32 s17, s17, s20
    buffer_load_dwordx4 v7, s[8:11], s17 offen lds
    s_add_u32 m0, s19, 27648
    s_add_u32 s17, s37, 1933312
    s_bitset0_b32 s17, 21
    s_add_u32 s17, s17, s20
    buffer_load_dwordx4 v7, s[8:11], s17 offen lds
    s_waitcnt vmcnt(28)
    ds_read_b64_tr_b16 a[120:121], v8 offset:30720
    ds_read_b64_tr_b16 a[122:123], v8 offset:30976
    ds_read_b64_tr_b16 a[124:125], v8 offset:30752
    ds_read_b64_tr_b16 a[126:127], v8 offset:31008
    s_waitcnt lgkmcnt(4)
    s_add_u32 m0, s19, 28672
    s_add_u32 s17, s37, 1966080
    s_bitset0_b32 s17, 21
    s_add_u32 s17, s17, s20
    buffer_load_dwordx4 v7, s[8:11], s17 offen lds
    s_add_u32 m0, s19, 29696
    s_add_u32 s17, s37, 1998848
    s_bitset0_b32 s17, 21
    s_add_u32 s17, s17, s20
    buffer_load_dwordx4 v7, s[8:11], s17 offen lds
    s_waitcnt vmcnt(28)
    ds_read_b64_tr_b16 a[128:129], v8 offset:0
    ds_read_b64_tr_b16 a[130:131], v8 offset:256
    ds_read_b64_tr_b16 a[132:133], v8 offset:32
    ds_read_b64_tr_b16 a[134:135], v8 offset:288
    s_waitcnt lgkmcnt(4)
    s_add_u32 m0, s19, 30720
    s_add_u32 s17, s37, 2031616
    s_bitset0_b32 s17, 21
    s_add_u32 s17, s17, s20
    buffer_load_dwordx4 v7, s[8:11], s17 offen lds
    s_add_u32 m0, s19, 31744
    s_add_u32 s17, s37, 2064384
    s_bitset0_b32 s17, 21
    s_add_u32 s17, s17, s20
    buffer_load_dwordx4 v7, s[8:11], s17 offen lds
    s_waitcnt vmcnt(28)
    ds_read_b64_tr_b16 a[136:137], v8 offset:2048
    ds_read_b64_tr_b16 a[138:139], v8 offset:2304
    ds_read_b64_tr_b16 a[140:141], v8 offset:2080
    ds_read_b64_tr_b16 a[142:143], v8 offset:2336
    s_waitcnt lgkmcnt(4)
    s_add_u32 m0, s19, 0
    s_add_u32 s17, s37, 64
    s_bitset0_b32 s17, 21
    s_add_u32 s17, s17, s20
    buffer_load_dwordx4 v7, s[8:11], s17 offen lds
    s_add_u32 m0, s19, 1024
    s_add_u32 s17, s37, 32832
    s_bitset0_b32 s17, 21
    s_add_u32 s17, s17, s20
    buffer_load_dwordx4 v7, s[8:11], s17 offen lds
    s_waitcnt vmcnt(28)
    ds_read_b64_tr_b16 a[144:145], v8 offset:4096
    ds_read_b64_tr_b16 a[146:147], v8 offset:4352
    ds_read_b64_tr_b16 a[148:149], v8 offset:4128
    ds_read_b64_tr_b16 a[150:151], v8 offset:4384
    s_waitcnt lgkmcnt(4)
    s_add_u32 m0, s19, 2048
    s_add_u32 s17, s37, 131136
    s_bitset0_b32 s17, 21
    s_add_u32 s17, s17, s20
    buffer_load_dwordx4 v7, s[8:11], s17 offen lds
    s_add_u32 m0, s19, 3072
    s_add_u32 s17, s37, 163904
    s_bitset0_b32 s17, 21
    s_add_u32 s17, s17, s20
    buffer_load_dwordx4 v7, s[8:11], s17 offen lds
    s_waitcnt vmcnt(28)
    ds_read_b64_tr_b16 a[152:153], v8 offset:6144
    ds_read_b64_tr_b16 a[154:155], v8 offset:6400
    ds_read_b64_tr_b16 a[156:157], v8 offset:6176
    ds_read_b64_tr_b16 a[158:159], v8 offset:6432
    s_waitcnt lgkmcnt(4)
    s_add_u32 m0, s19, 4096
    s_add_u32 s17, s37, 262208
    s_bitset0_b32 s17, 21
    s_add_u32 s17, s17, s20
    buffer_load_dwordx4 v7, s[8:11], s17 offen lds
    s_add_u32 m0, s19, 5120
    s_add_u32 s17, s37, 294976
    s_bitset0_b32 s17, 21
    s_add_u32 s17, s17, s20
    buffer_load_dwordx4 v7, s[8:11], s17 offen lds
    s_waitcnt vmcnt(28)
    ds_read_b64_tr_b16 a[160:161], v8 offset:8192
    ds_read_b64_tr_b16 a[162:163], v8 offset:8448
    ds_read_b64_tr_b16 a[164:165], v8 offset:8224
    ds_read_b64_tr_b16 a[166:167], v8 offset:8480
    s_waitcnt lgkmcnt(4)
    s_add_u32 m0, s19, 6144
    s_add_u32 s17, s37, 393280
    s_bitset0_b32 s17, 21
    s_add_u32 s17, s17, s20
    buffer_load_dwordx4 v7, s[8:11], s17 offen lds
    s_add_u32 m0, s19, 7168
    s_add_u32 s17, s37, 426048
    s_bitset0_b32 s17, 21
    s_add_u32 s17, s17, s20
    buffer_load_dwordx4 v7, s[8:11], s17 offen lds
    s_waitcnt vmcnt(28)
    ds_read_b64_tr_b16 a[168:169], v8 offset:10240
    ds_read_b64_tr_b16 a[170:171], v8 offset:10496
    ds_read_b64_tr_b16 a[172:173], v8 offset:10272
    ds_read_b64_tr_b16 a[174:175], v8 offset:10528
    s_waitcnt lgkmcnt(4)
    s_add_u32 m0, s19, 8192
    s_add_u32 s17, s37, 524352
    s_bitset0_b32 s17, 21
    s_add_u32 s17, s17, s20
    buffer_load_dwordx4 v7, s[8:11], s17 offen lds
    s_add_u32 m0, s19, 9216
    s_add_u32 s17, s37, 557120
    s_bitset0_b32 s17, 21
    s_add_u32 s17, s17, s20
    buffer_load_dwordx4 v7, s[8:11], s17 offen lds
    s_waitcnt vmcnt(28)
    ds_read_b64_tr_b16 a[176:177], v8 offset:12288
    ds_read_b64_tr_b16 a[178:179], v8 offset:12544
    ds_read_b64_tr_b16 a[180:181], v8 offset:12320
    ds_read_b64_tr_b16 a[182:183], v8 offset:12576
    s_waitcnt lgkmcnt(4)
    s_add_u32 m0, s19, 10240
    s_add_u32 s17, s37, 655424
    s_bitset0_b32 s17, 21
    s_add_u32 s17, s17, s20
    buffer_load_dwordx4 v7, s[8:11], s17 offen lds
    s_add_u32 m0, s19, 11264
    s_add_u32 s17, s37, 688192
    s_bitset0_b32 s17, 21
    s_add_u32 s17, s17, s20
    buffer_load_dwordx4 v7, s[8:11], s17 offen lds
    s_waitcnt vmcnt(28)
    ds_read_b64_tr_b16 a[184:185], v8 offset:14336
    ds_read_b64_tr_b16 a[186:187], v8 offset:14592
    ds_read_b64_tr_b16 a[188:189], v8 offset:14368
    ds_read_b64_tr_b16 a[190:191], v8 offset:14624
    s_waitcnt lgkmcnt(4)
    s_add_u32 m0, s19, 12288
    s_add_u32 s17, s37, 786496
    s_bitset0_b32 s17, 21
    s_add_u32 s17, s17, s20
    buffer_load_dwordx4 v7, s[8:11], s17 offen lds
    s_add_u32 m0, s19, 13312
    s_add_u32 s17, s37, 819264
    s_bitset0_b32 s17, 21
    s_add_u32 s17, s17, s20
    buffer_load_dwordx4 v7, s[8:11], s17 offen lds
    s_waitcnt vmcnt(28)
    ds_read_b64_tr_b16 a[192:193], v8 offset:16384
    ds_read_b64_tr_b16 a[194:195], v8 offset:16640
    ds_read_b64_tr_b16 a[196:197], v8 offset:16416
    ds_read_b64_tr_b16 a[198:199], v8 offset:16672
    s_waitcnt lgkmcnt(4)
    s_add_u32 m0, s19, 14336
    s_add_u32 s17, s37, 917568
    s_bitset0_b32 s17, 21
    s_add_u32 s17, s17, s20
    buffer_load_dwordx4 v7, s[8:11], s17 offen lds
    s_add_u32 m0, s19, 15360
    s_add_u32 s17, s37, 950336
    s_bitset0_b32 s17, 21
    s_add_u32 s17, s17, s20
    buffer_load_dwordx4 v7, s[8:11], s17 offen lds
    s_waitcnt vmcnt(28)
    ds_read_b64_tr_b16 a[200:201], v8 offset:18432
    ds_read_b64_tr_b16 a[202:203], v8 offset:18688
    ds_read_b64_tr_b16 a[204:205], v8 offset:18464
    ds_read_b64_tr_b16 a[206:207], v8 offset:18720
    s_waitcnt lgkmcnt(4)
    s_add_u32 m0, s19, 16384
    s_add_u32 s17, s37, 1048640
    s_bitset0_b32 s17, 21
    s_add_u32 s17, s17, s20
    buffer_load_dwordx4 v7, s[8:11], s17 offen lds
    s_add_u32 m0, s19, 17408
    s_add_u32 s17, s37, 1081408
    s_bitset0_b32 s17, 21
    s_add_u32 s17, s17, s20
    buffer_load_dwordx4 v7, s[8:11], s17 offen lds
    s_waitcnt vmcnt(28)
    ds_read_b64_tr_b16 a[208:209], v8 offset:20480
    ds_read_b64_tr_b16 a[210:211], v8 offset:20736
    ds_read_b64_tr_b16 a[212:213], v8 offset:20512
    ds_read_b64_tr_b16 a[214:215], v8 offset:20768
    s_waitcnt lgkmcnt(4)
    s_add_u32 m0, s19, 18432
    s_add_u32 s17, s37, 1179712
    s_bitset0_b32 s17, 21
    s_add_u32 s17, s17, s20
    buffer_load_dwordx4 v7, s[8:11], s17 offen lds
    s_add_u32 m0, s19, 19456
    s_add_u32 s17, s37, 1212480
    s_bitset0_b32 s17, 21
    s_add_u32 s17, s17, s20
    buffer_load_dwordx4 v7, s[8:11], s17 offen lds
    s_waitcnt vmcnt(28)
    ds_read_b64_tr_b16 a[216:217], v8 offset:22528
    ds_read_b64_tr_b16 a[218:219], v8 offset:22784
    ds_read_b64_tr_b16 a[220:221], v8 offset:22560
    ds_read_b64_tr_b16 a[222:223], v8 offset:22816
    s_waitcnt lgkmcnt(4)
    s_add_u32 m0, s19, 20480
    s_add_u32 s17, s37, 1310784
    s_bitset0_b32 s17, 21
    s_add_u32 s17, s17, s20
    buffer_load_dwordx4 v7, s[8:11], s17 offen lds
    s_add_u32 m0, s19, 21504
    s_add_u32 s17, s37, 1343552
    s_bitset0_b32 s17, 21
    s_add_u32 s17, s17, s20
    buffer_load_dwordx4 v7, s[8:11], s17 offen lds
    s_waitcnt vmcnt(28)
    ds_read_b64_tr_b16 a[224:225], v8 offset:24576
    ds_read_b64_tr_b16 a[226:227], v8 offset:24832
    ds_read_b64_tr_b16 a[228:229], v8 offset:24608
    ds_read_b64_tr_b16 a[230:231], v8 offset:24864
    s_waitcnt lgkmcnt(4)
    s_add_u32 m0, s19, 22528
    s_add_u32 s17, s37, 1441856
    s_bitset0_b32 s17, 21
    s_add_u32 s17, s17, s20
    buffer_load_dwordx4 v7, s[8:11], s17 offen lds
    s_add_u32 m0, s19, 23552
    s_add_u32 s17, s37, 1474624
    s_bitset0_b32 s17, 21
    s_add_u32 s17, s17, s20
    buffer_load_dwordx4 v7, s[8:11], s17 offen lds
    s_waitcnt vmcnt(28)
    ds_read_b64_tr_b16 a[232:233], v8 offset:26624
    ds_read_b64_tr_b16 a[234:235], v8 offset:26880
    ds_read_b64_tr_b16 a[236:237], v8 offset:26656
    ds_read_b64_tr_b16 a[238:239], v8 offset:26912
    s_waitcnt lgkmcnt(4)
    s_add_u32 m0, s19, 24576
    s_add_u32 s17, s37, 1572928
    s_bitset0_b32 s17, 21
    s_add_u32 s17, s17, s20
    buffer_load_dwordx4 v7, s[8:11], s17 offen lds
    s_add_u32 m0, s19, 25600
    s_add_u32 s17, s37, 1605696
    s_bitset0_b32 s17, 21
    s_add_u32 s17, s17, s20
    buffer_load_dwordx4 v7, s[8:11], s17 offen lds
    s_waitcnt vmcnt(28)
    ds_read_b64_tr_b16 a[240:241], v8 offset:28672
    ds_read_b64_tr_b16 a[242:243], v8 offset:28928
    ds_read_b64_tr_b16 a[244:245], v8 offset:28704
    ds_read_b64_tr_b16 a[246:247], v8 offset:28960
    s_waitcnt lgkmcnt(4)
    s_add_u32 m0, s19, 26624
    s_add_u32 s17, s37, 1704000
    s_bitset0_b32 s17, 21
    s_add_u32 s17, s17, s20
    buffer_load_dwordx4 v7, s[8:11], s17 offen lds
    s_add_u32 m0, s19, 27648
    s_add_u32 s17, s37, 1736768
    s_bitset0_b32 s17, 21
    s_add_u32 s17, s17, s20
    buffer_load_dwordx4 v7, s[8:11], s17 offen lds
    s_waitcnt vmcnt(28)
    ds_read_b64_tr_b16 a[248:249], v8 offset:30720
    ds_read_b64_tr_b16 a[250:251], v8 offset:30976
    ds_read_b64_tr_b16 a[252:253], v8 offset:30752
    ds_read_b64_tr_b16 a[254:255], v8 offset:31008
    s_waitcnt lgkmcnt(4)
    s_add_u32 m0, s19, 28672
    s_add_u32 s17, s37, 1835072
    s_bitset0_b32 s17, 21
    s_add_u32 s17, s17, s20
    buffer_load_dwordx4 v7, s[8:11], s17 offen lds
    s_add_u32 m0, s19, 29696
    s_add_u32 s17, s37, 1867840
    s_bitset0_b32 s17, 21
    s_add_u32 s17, s17, s20
    buffer_load_dwordx4 v7, s[8:11], s17 offen lds
    s_waitcnt vmcnt(28)
    ds_read_b64_tr_b16 v[128:129], v8 offset:0
    ds_read_b64_tr_b16 v[130:131], v8 offset:256
    ds_read_b64_tr_b16 v[132:133], v8 offset:32
    ds_read_b64_tr_b16 v[134:135], v8 offset:288
    s_waitcnt lgkmcnt(4)
    s_add_u32 m0, s19, 30720
    s_add_u32 s17, s37, 1966144
    s_bitset0_b32 s17, 21
    s_add_u32 s17, s17, s20
    buffer_load_dwordx4 v7, s[8:11], s17 offen lds
    s_add_u32 m0, s19, 31744
    s_add_u32 s17, s37, 1998912
    s_bitset0_b32 s17, 21
    s_add_u32 s17, s17, s20
    buffer_load_dwordx4 v7, s[8:11], s17 offen lds
    s_waitcnt vmcnt(28)
    ds_read_b64_tr_b16 v[136:137], v8 offset:2048
    ds_read_b64_tr_b16 v[138:139], v8 offset:2304
    ds_read_b64_tr_b16 v[140:141], v8 offset:2080
    ds_read_b64_tr_b16 v[142:143], v8 offset:2336
    s_waitcnt lgkmcnt(4)
    s_add_u32 m0, s19, 0
    s_add_u32 s17, s37, 65600
    s_bitset0_b32 s17, 21
    s_add_u32 s17, s17, s20
    buffer_load_dwordx4 v7, s[8:11], s17 offen lds
    s_add_u32 m0, s19, 1024
    s_add_u32 s17, s37, 98368
    s_bitset0_b32 s17, 21
    s_add_u32 s17, s17, s20
    buffer_load_dwordx4 v7, s[8:11], s17 offen lds
    s_waitcnt vmcnt(28)
    ds_read_b64_tr_b16 v[144:145], v8 offset:4096
    ds_read_b64_tr_b16 v[146:147], v8 offset:4352
    ds_read_b64_tr_b16 v[148:149], v8 offset:4128
    ds_read_b64_tr_b16 v[150:151], v8 offset:4384
    s_waitcnt lgkmcnt(4)
    s_add_u32 m0, s19, 2048
    s_add_u32 s17, s37, 196672
    s_bitset0_b32 s17, 21
    s_add_u32 s17, s17, s20
    buffer_load_dwordx4 v7, s[8:11], s17 offen lds
    s_add_u32 m0, s19, 3072
    s_add_u32 s17, s37, 229440
    s_bitset0_b32 s17, 21
    s_add_u32 s17, s17, s20
    buffer_load_dwordx4 v7, s[8:11], s17 offen lds
    s_waitcnt vmcnt(28)
    ds_read_b64_tr_b16 v[152:153], v8 offset:6144
    ds_read_b64_tr_b16 v[154:155], v8 offset:6400
    ds_read_b64_tr_b16 v[156:157], v8 offset:6176
    ds_read_b64_tr_b16 v[158:159], v8 offset:6432
    s_waitcnt lgkmcnt(4)
    s_add_u32 m0, s19, 4096
    s_add_u32 s17, s37, 327744
    s_bitset0_b32 s17, 21
    s_add_u32 s17, s17, s20
    buffer_load_dwordx4 v7, s[8:11], s17 offen lds
    s_add_u32 m0, s19, 5120
    s_add_u32 s17, s37, 360512
    s_bitset0_b32 s17, 21
    s_add_u32 s17, s17, s20
    buffer_load_dwordx4 v7, s[8:11], s17 offen lds
    s_waitcnt vmcnt(28)
    ds_read_b64_tr_b16 v[160:161], v8 offset:8192
    ds_read_b64_tr_b16 v[162:163], v8 offset:8448
    ds_read_b64_tr_b16 v[164:165], v8 offset:8224
    ds_read_b64_tr_b16 v[166:167], v8 offset:8480
    s_waitcnt lgkmcnt(4)
    s_add_u32 m0, s19, 6144
    s_add_u32 s17, s37, 458816
    s_bitset0_b32 s17, 21
    s_add_u32 s17, s17, s20
    buffer_load_dwordx4 v7, s[8:11], s17 offen lds
    s_add_u32 m0, s19, 7168
    s_add_u32 s17, s37, 491584
    s_bitset0_b32 s17, 21
    s_add_u32 s17, s17, s20
    buffer_load_dwordx4 v7, s[8:11], s17 offen lds
    s_waitcnt vmcnt(28)
    ds_read_b64_tr_b16 v[168:169], v8 offset:10240
    ds_read_b64_tr_b16 v[170:171], v8 offset:10496
    ds_read_b64_tr_b16 v[172:173], v8 offset:10272
    ds_read_b64_tr_b16 v[174:175], v8 offset:10528
    s_waitcnt lgkmcnt(4)
    s_add_u32 m0, s19, 8192
    s_add_u32 s17, s37, 589888
    s_bitset0_b32 s17, 21
    s_add_u32 s17, s17, s20
    buffer_load_dwordx4 v7, s[8:11], s17 offen lds
    s_add_u32 m0, s19, 9216
    s_add_u32 s17, s37, 622656
    s_bitset0_b32 s17, 21
    s_add_u32 s17, s17, s20
    buffer_load_dwordx4 v7, s[8:11], s17 offen lds
    s_waitcnt vmcnt(28)
    ds_read_b64_tr_b16 v[176:177], v8 offset:12288
    ds_read_b64_tr_b16 v[178:179], v8 offset:12544
    ds_read_b64_tr_b16 v[180:181], v8 offset:12320
    ds_read_b64_tr_b16 v[182:183], v8 offset:12576
    s_waitcnt lgkmcnt(4)
    s_add_u32 m0, s19, 10240
    s_add_u32 s17, s37, 720960
    s_bitset0_b32 s17, 21
    s_add_u32 s17, s17, s20
    buffer_load_dwordx4 v7, s[8:11], s17 offen lds
    s_add_u32 m0, s19, 11264
    s_add_u32 s17, s37, 753728
    s_bitset0_b32 s17, 21
    s_add_u32 s17, s17, s20
    buffer_load_dwordx4 v7, s[8:11], s17 offen lds
    s_waitcnt vmcnt(28)
    ds_read_b64_tr_b16 v[184:185], v8 offset:14336
    ds_read_b64_tr_b16 v[186:187], v8 offset:14592
    ds_read_b64_tr_b16 v[188:189], v8 offset:14368
    ds_read_b64_tr_b16 v[190:191], v8 offset:14624
    s_waitcnt lgkmcnt(4)
    s_add_u32 m0, s19, 12288
    s_add_u32 s17, s37, 852032
    s_bitset0_b32 s17, 21
    s_add_u32 s17, s17, s20
    buffer_load_dwordx4 v7, s[8:11], s17 offen lds
    s_add_u32 m0, s19, 13312
    s_add_u32 s17, s37, 884800
    s_bitset0_b32 s17, 21
    s_add_u32 s17, s17, s20
    buffer_load_dwordx4 v7, s[8:11], s17 offen lds
    s_waitcnt vmcnt(28)
    ds_read_b64_tr_b16 v[192:193], v8 offset:16384
    ds_read_b64_tr_b16 v[194:195], v8 offset:16640
    ds_read_b64_tr_b16 v[196:197], v8 offset:16416
    ds_read_b64_tr_b16 v[198:199], v8 offset:16672
    s_waitcnt lgkmcnt(4)
    s_add_u32 m0, s19, 14336
    s_add_u32 s17, s37, 983104
    s_bitset0_b32 s17, 21
    s_add_u32 s17, s17, s20
    buffer_load_dwordx4 v7, s[8:11], s17 offen lds
    s_add_u32 m0, s19, 15360
    s_add_u32 s17, s37, 1015872
    s_bitset0_b32 s17, 21
    s_add_u32 s17, s17, s20
    buffer_load_dwordx4 v7, s[8:11], s17 offen lds
    s_waitcnt vmcnt(28)
    ds_read_b64_tr_b16 v[200:201], v8 offset:18432
    ds_read_b64_tr_b16 v[202:203], v8 offset:18688
    ds_read_b64_tr_b16 v[204:205], v8 offset:18464
    ds_read_b64_tr_b16 v[206:207], v8 offset:18720
    s_waitcnt lgkmcnt(4)
    s_add_u32 m0, s19, 16384
    s_add_u32 s17, s37, 1114176
    s_bitset0_b32 s17, 21
    s_add_u32 s17, s17, s20
    buffer_load_dwordx4 v7, s[8:11], s17 offen lds
    s_add_u32 m0, s19, 17408
    s_add_u32 s17, s37, 1146944
    s_bitset0_b32 s17, 21
    s_add_u32 s17, s17, s20
    buffer_load_dwordx4 v7, s[8:11], s17 offen lds
    s_waitcnt vmcnt(28)
    ds_read_b64_tr_b16 v[208:209], v8 offset:20480
    ds_read_b64_tr_b16 v[210:211], v8 offset:20736
    ds_read_b64_tr_b16 v[212:213], v8 offset:20512
    ds_read_b64_tr_b16 v[214:215], v8 offset:20768
    s_waitcnt lgkmcnt(4)
    s_add_u32 m0, s19, 18432
    s_add_u32 s17, s37, 1245248
    s_bitset0_b32 s17, 21
    s_add_u32 s17, s17, s20
    buffer_load_dwordx4 v7, s[8:11], s17 offen lds
    s_add_u32 m0, s19, 19456
    s_add_u32 s17, s37, 1278016
    s_bitset0_b32 s17, 21
    s_add_u32 s17, s17, s20
    buffer_load_dwordx4 v7, s[8:11], s17 offen lds
    s_waitcnt vmcnt(28)
    ds_read_b64_tr_b16 v[216:217], v8 offset:22528
    ds_read_b64_tr_b16 v[218:219], v8 offset:22784
    ds_read_b64_tr_b16 v[220:221], v8 offset:22560
    ds_read_b64_tr_b16 v[222:223], v8 offset:22816
    s_waitcnt lgkmcnt(4)
    s_add_u32 m0, s19, 20480
    s_add_u32 s17, s37, 1376320
    s_bitset0_b32 s17, 21
    s_add_u32 s17, s17, s20
    buffer_load_dwordx4 v7, s[8:11], s17 offen lds
    s_add_u32 m0, s19, 21504
    s_add_u32 s17, s37, 1409088
    s_bitset0_b32 s17, 21
    s_add_u32 s17, s17, s20
    buffer_load_dwordx4 v7, s[8:11], s17 offen lds
    s_waitcnt vmcnt(28)
    ds_read_b64_tr_b16 v[224:225], v8 offset:24576
    ds_read_b64_tr_b16 v[226:227], v8 offset:24832
    ds_read_b64_tr_b16 v[228:229], v8 offset:24608
    ds_read_b64_tr_b16 v[230:231], v8 offset:24864
    s_waitcnt lgkmcnt(4)
    s_add_u32 m0, s19, 22528
    s_add_u32 s17, s37, 1507392
    s_bitset0_b32 s17, 21
    s_add_u32 s17, s17, s20
    buffer_load_dwordx4 v7, s[8:11], s17 offen lds
    s_add_u32 m0, s19, 23552
    s_add_u32 s17, s37, 1540160
    s_bitset0_b32 s17, 21
    s_add_u32 s17, s17, s20
    buffer_load_dwordx4 v7, s[8:11], s17 offen lds
    s_waitcnt vmcnt(28)
    ds_read_b64_tr_b16 v[232:233], v8 offset:26624
    ds_read_b64_tr_b16 v[234:235], v8 offset:26880
    ds_read_b64_tr_b16 v[236:237], v8 offset:26656
    ds_read_b64_tr_b16 v[238:239], v8 offset:26912
    s_waitcnt lgkmcnt(4)
    s_add_u32 m0, s19, 24576
    s_add_u32 s17, s37, 1638464
    s_bitset0_b32 s17, 21
    s_add_u32 s17, s17, s20
    buffer_load_dwordx4 v7, s[8:11], s17 offen lds
    s_add_u32 m0, s19, 25600
    s_add_u32 s17, s37, 1671232
    s_bitset0_b32 s17, 21
    s_add_u32 s17, s17, s20
    buffer_load_dwordx4 v7, s[8:11], s17 offen lds
    s_waitcnt vmcnt(28)
    ds_read_b64_tr_b16 v[240:241], v8 offset:28672
    ds_read_b64_tr_b16 v[242:243], v8 offset:28928
    ds_read_b64_tr_b16 v[244:245], v8 offset:28704
    ds_read_b64_tr_b16 v[246:247], v8 offset:28960
    s_waitcnt lgkmcnt(4)
    s_add_u32 m0, s19, 26624
    s_add_u32 s17, s37, 1769536
    s_bitset0_b32 s17, 21
    s_add_u32 s17, s17, s20
    buffer_load_dwordx4 v7, s[8:11], s17 offen lds
    s_add_u32 m0, s19, 27648
    s_add_u32 s17, s37, 1802304
    s_bitset0_b32 s17, 21
    s_add_u32 s17, s17, s20
    buffer_load_dwordx4 v7, s[8:11], s17 offen lds
    s_waitcnt vmcnt(28)
    ds_read_b64_tr_b16 v[248:249], v8 offset:30720
    ds_read_b64_tr_b16 v[250:251], v8 offset:30976
    ds_read_b64_tr_b16 v[252:253], v8 offset:30752
    ds_read_b64_tr_b16 v[254:255], v8 offset:31008
    s_waitcnt lgkmcnt(4)
    s_add_u32 m0, s19, 28672
    s_add_u32 s17, s37, 1900608
    s_bitset0_b32 s17, 21
    s_add_u32 s17, s17, s20
    buffer_load_dwordx4 v7, s[8:11], s17 offen lds
    s_add_u32 m0, s19, 29696
    s_add_u32 s17, s37, 1933376
    s_bitset0_b32 s17, 21
    s_add_u32 s17, s17, s20
    buffer_load_dwordx4 v7, s[8:11], s17 offen lds
    s_waitcnt lgkmcnt(0)
    s_add_u32 m0, s19, 30720
    s_add_u32 s17, s37, 2031680
    s_bitset0_b32 s17, 21
    s_add_u32 s17, s17, s20
    buffer_load_dwordx4 v7, s[8:11], s17 offen lds
    s_add_u32 m0, s19, 31744
    s_add_u32 s17, s37, 2064448
    s_bitset0_b32 s17, 21
    s_add_u32 s17, s17, s20
    buffer_load_dwordx4 v7, s[8:11], s17 offen lds
    s_lshr_b32 s37, s37, 6
    s_add_u32 s37, s37, 54525952
    v_lshlrev_b32 v15, 4, v1
    v_add_u32 v10, s19, v15
    s_lshl_b32 s17, s16, 10
    s_add_u32 s17, s17, 131072
    v_add_u32 v14, s17, v15
    s_lshl_b32 s17, s16, 12
    s_add_u32 s18, s17, 147456
    v_add_u32 v15, s18, v15
    v_bfe_u32 v11, v1, 3, 2
    v_and_b32 v5, 7, v1
    v_lshlrev_b32 v5, 9, v5
    v_lshl_add_u32 v11, v11, 7, v5
    s_add_u32 s17, s17, 100728832
    v_add_u32 v11, s17, v11
    v_mov_b32 v12, 0
    v_and_b32 v13, 15, v1
    v_lshrrev_b32 v5, 4, v1
    v_lshlrev_b32 v5, 3, v5
    v_lshl_add_u32 v13, v13, 12, v5
    s_lshl_b32 s17, s35, 7
    s_lshl_b32 s18, s16, 5
    s_add_u32 s17, s17, s18
    s_add_u32 s17, s17, 2048
    v_add_u32 v13, s17, v13
    s_waitcnt vmcnt(0)
    s_mov_b32 s36, 0
U_wait:
    s_mov_b32 s29, s92
U_fl:
    s_lshr_b32 s17, s28, 3
    v_cmp_ge_u32 vcc, s17, v12
    s_lshl_b32 s18, s28, 2
    s_and_b32 s18, s18, 24
    s_lshr_b32 s17, vcc_lo, s18
    s_and_b32 s17, s17, 0xff
    s_cbranch_scc0 U_go
    s_cmp_ge_u32 s29, 1048576
    s_cselect_b32 s92, 1048576, s92
    s_cbranch_scc1 U_go
    s_lshl_b32 s17, s17, s18
    s_cmp_eq_u32 s29, 0
    s_cselect_b32 exec_lo, -1, s17
    s_mov_b32 exec_hi, 0
    s_add_u32 s29, s29, 1
    buffer_load_dword v12, v11, s[4:7], 0 offen sc1
    s_mov_b64 exec, -1
    s_sleep 2
    s_waitcnt vmcnt(0)
    s_branch U_fl
U_go:
    s_lshl_b32 s30, s28, 17
    s_add_u32 s30, s30, s37
    buffer_load_dwordx4 v[64:67], v10, s[4:7], s30 offen offset:0
    buffer_load_dwordx4 v[68:71], v10, s[4:7], s30 offen offset:1024
    buffer_load_dwordx4 v[72:75], v10, s[4:7], s30 offen offset:2048
    buffer_load_dwordx4 v[76:79], v10, s[4:7], s30 offen offset:3072
    s_add_u32 s30, s30, 4096
    s_bitset0_b32 s30, 15
    buffer_load_dwordx4 v[80:83], v10, s[4:7], s30 offen offset:0
    buffer_load_dwordx4 v[84:87], v10, s[4:7], s30 offen offset:1024
    buffer_load_dwordx4 v[88:91], v10, s[4:7], s30 offen offset:2048
    buffer_load_dwordx4 v[92:95], v10, s[4:7], s30 offen offset:3072
    s_add_u32 s30, s30, 4096
    s_bitset0_b32 s30, 15
    buffer_load_dwordx4 v[96:99], v10, s[4:7], s30 offen offset:0
    buffer_load_dwordx4 v[100:103], v10, s[4:7], s30 offen offset:1024
    buffer_load_dwordx4 v[104:107], v10, s[4:7], s30 offen offset:2048
    buffer_load_dwordx4 v[108:111], v10, s[4:7], s30 offen offset:3072
    s_add_u32 s30, s30, 4096
    s_bitset0_b32 s30, 15
    buffer_load_dwordx4 v[112:115], v10, s[4:7], s30 offen offset:0
    buffer_load_dwordx4 v[116:119], v10, s[4:7], s30 offen offset:1024
    buffer_load_dwordx4 v[120:123], v10, s[4:7], s30 offen offset:2048
    s_mov_b32 s34, 0
    s_mov_b32 s31, 1073741824
    ds_read_b64_tr_b16 v[32:33], v8 offset:0
    ds_read_b64_tr_b16 v[34:35], v8 offset:256
    ds_read_b64_tr_b16 v[36:37], v8 offset:32
    ds_read_b64_tr_b16 v[38:39], v8 offset:288
    ds_read_b128 v[48:51], v15 offset:0
    ds_read_b128 v[52:55], v15 offset:1024
    ds_read_b128 v[56:59], v15 offset:2048
    ds_read_b128 v[60:63], v15 offset:3072
.p2align 6
U_item:
    s_waitcnt vmcnt(14)
    v_mfma_f32_16x16x32_bf16 v[16:19], a[0:3], v[64:67], 0
    buffer_load_dwordx4 v[124:127], v10, s[4:7], s30 offen offset:3072
    v_mfma_f32_16x16x32_bf16 v[20:23], a[4:7], v[64:67], 0
    s_add_u32 s33, s28, 6
    s_lshr_b32 s17, s33, 3
    v_cmp_ge_u32 vcc, s17, v12
    s_lshl_b32 s18, s33, 2
    s_and_b32 s18, s18, 24
    v_mfma_f32_16x16x32_bf16 v[24:27], v[128:131], v[64:67], 0
    s_lshr_b32 s17, vcc_lo, s18
    s_and_b32 s17, s17, 0xff
    s_lshl_b32 exec_lo, s17, s18
    s_mov_b32 exec_hi, 0
    buffer_load_dword v12, v11, s[4:7], 0 offen sc1
    s_mov_b64 exec, -1
    v_mfma_f32_16x16x32_bf16 v[28:31], v[132:135], v[64:67], 0
    s_waitcnt vmcnt(15)
    s_waitcnt lgkmcnt(4)
    v_mfma_f32_16x16x32_bf16 v[16:19], a[8:11], v[68:71], v[16:19]
    s_add_u32 s30, s30, 4096
    s_bitset0_b32 s30, 15
    buffer_load_dwordx4 v[64:67], v10, s[4:7], s30 offen offset:0
    ds_read_b64_tr_b16 v[40:41], v8 offset:2048
    ds_read_b64_tr_b16 v[42:43], v8 offset:2304
    v_mfma_f32_16x16x32_bf16 v[20:23], a[12:15], v[68:71], v[20:23]
    ds_read_b64_tr_b16 v[44:45], v8 offset:2080
    ds_read_b64_tr_b16 v[46:47], v8 offset:2336
    v_mfma_f32_16x16x32_bf16 v[24:27], v[32:35], v[68:71], v[24:27]
    v_mfma_f32_16x16x32_bf16 v[28:31], v[36:39], v[68:71], v[28:31]
    s_waitcnt vmcnt(15)
    v_mfma_f32_16x16x32_bf16 v[16:19], a[16:19], v[72:75], v[16:19]
    buffer_load_dwordx4 v[68:71], v10, s[4:7], s30 offen offset:1024
    v_mfma_f32_16x16x32_bf16 v[20:23], a[20:23], v[72:75], v[20:23]
    s_waitcnt lgkmcnt(4)
    s_cmp_eq_u32 s34, 0
    s_cbranch_scc1 U_nb
    s_barrier
U_nb:
    v_mfma_f32_16x16x32_bf16 v[24:27], v[136:139], v[72:75], v[24:27]
    ds_read_b128 v[48:51], v15 offset:0
    ds_read_b128 v[52:55], v15 offset:1024
    v_mfma_f32_16x16x32_bf16 v[28:31], v[140:143], v[72:75], v[28:31]
    ds_read_b128 v[56:59], v15 offset:2048
    ds_read_b128 v[60:63], v15 offset:3072
    s_waitcnt vmcnt(15)
    s_waitcnt lgkmcnt(4)
    v_mfma_f32_16x16x32_bf16 v[16:19], a[24:27], v[76:79], v[16:19]
    buffer_load_dwordx4 v[72:75], v10, s[4:7], s30 offen offset:2048
    ds_read_b64_tr_b16 v[32:33], v8 offset:4096
    ds_read_b64_tr_b16 v[34:35], v8 offset:4352
    v_mfma_f32_16x16x32_bf16 v[20:23], a[28:31], v[76:79], v[20:23]
    ds_read_b64_tr_b16 v[36:37], v8 offset:4128
    ds_read_b64_tr_b16 v[38:39], v8 offset:4384
    v_mfma_f32_16x16x32_bf16 v[24:27], v[40:43], v[76:79], v[24:27]
    v_mfma_f32_16x16x32_bf16 v[28:31], v[44:47], v[76:79], v[28:31]
    s_waitcnt vmcnt(15)
    v_mfma_f32_16x16x32_bf16 v[16:19], a[32:35], v[80:83], v[16:19]
    buffer_load_dwordx4 v[76:79], v10, s[4:7], s30 offen offset:3072
    s_waitcnt lgkmcnt(4)
    v_mfma_f32_16x16x32_bf16 v[20:23], a[36:39], v[80:83], v[20:23]
    v_add_f32 v48, v48, v52
    v_add_f32 v49, v49, v53
    v_mfma_f32_16x16x32_bf16 v[24:27], v[144:147], v[80:83], v[24:27]
    v_add_f32 v50, v50, v54
    v_add_f32 v51, v51, v55
    v_mfma_f32_16x16x32_bf16 v[28:31], v[148:151], v[80:83], v[28:31]
    s_waitcnt vmcnt(15)
    s_waitcnt lgkmcnt(0)
    v_mfma_f32_16x16x32_bf16 v[16:19], a[40:43], v[84:87], v[16:19]
    s_add_u32 s30, s30, 4096
    s_bitset0_b32 s30, 15
    buffer_load_dwordx4 v[80:83], v10, s[4:7], s30 offen offset:0
    ds_read_b64_tr_b16 v[40:41], v8 offset:6144
    ds_read_b64_tr_b16 v[42:43], v8 offset:6400
    v_mfma_f32_16x16x32_bf16 v[20:23], a[44:47], v[84:87], v[20:23]
    v_add_f32 v56, v56, v60
    v_add_f32 v57, v57, v61
    ds_read_b64_tr_b16 v[44:45], v8 offset:6176
    ds_read_b64_tr_b16 v[46:47], v8 offset:6432
    v_mfma_f32_16x16x32_bf16 v[24:27], v[32:35], v[84:87], v[24:27]
    v_add_f32 v58, v58, v62
    v_add_f32 v59, v59, v63
    v_mfma_f32_16x16x32_bf16 v[28:31], v[36:39], v[84:87], v[28:31]
    s_waitcnt vmcnt(15)
    v_mfma_f32_16x16x32_bf16 v[16:19], a[48:51], v[88:91], v[16:19]
    buffer_load_dwordx4 v[84:87], v10, s[4:7], s30 offen offset:1024
    v_mfma_f32_16x16x32_bf16 v[20:23], a[52:55], v[88:91], v[20:23]
    v_add_f32 v48, v48, v56
    v_add_f32 v49, v49, v57
    v_mfma_f32_16x16x32_bf16 v[24:27], v[152:155], v[88:91], v[24:27]
    v_add_f32 v50, v50, v58
    v_add_f32 v51, v51, v59
    v_mfma_f32_16x16x32_bf16 v[28:31], v[156:159], v[88:91], v[28:31]
    s_waitcnt vmcnt(15)
    s_waitcnt lgkmcnt(0)
    v_mfma_f32_16x16x32_bf16 v[16:19], a[56:59], v[92:95], v[16:19]
    buffer_load_dwordx4 v[88:91], v10, s[4:7], s30 offen offset:2048
    ds_read_b64_tr_b16 v[32:33], v8 offset:8192
    ds_read_b64_tr_b16 v[34:35], v8 offset:8448
    v_mfma_f32_16x16x32_bf16 v[20:23], a[60:63], v[92:95], v[20:23]
    v_cvt_pk_bf16_f32 v52, v48, v49
    v_cvt_pk_bf16_f32 v53, v50, v51
    ds_read_b64_tr_b16 v[36:37], v8 offset:8224
    ds_read_b64_tr_b16 v[38:39], v8 offset:8480
    v_mfma_f32_16x16x32_bf16 v[24:27], v[40:43], v[92:95], v[24:27]
    v_mfma_f32_16x16x32_bf16 v[28:31], v[44:47], v[92:95], v[28:31]
    s_waitcnt vmcnt(15)
    v_mfma_f32_16x16x32_bf16 v[16:19], a[64:67], v[96:99], v[16:19]
    buffer_load_dwordx4 v[92:95], v10, s[4:7], s30 offen offset:3072
    v_mfma_f32_16x16x32_bf16 v[20:23], a[68:71], v[96:99], v[20:23]
    buffer_store_dwordx2 v[52:53], v13, s[12:15], s31 offen
    v_xor_b32 v15, 0x4000, v15
    v_mfma_f32_16x16x32_bf16 v[24:27], v[160:163], v[96:99], v[24:27]
    v_mfma_f32_16x16x32_bf16 v[28:31], v[164:167], v[96:99], v[28:31]
    s_waitcnt vmcnt(16)
    s_waitcnt lgkmcnt(0)
    v_mfma_f32_16x16x32_bf16 v[16:19], a[72:75], v[100:103], v[16:19]
    s_add_u32 s30, s30, 4096
    s_bitset0_b32 s30, 15
    buffer_load_dwordx4 v[96:99], v10, s[4:7], s30 offen offset:0
    ds_read_b64_tr_b16 v[40:41], v8 offset:10240
    ds_read_b64_tr_b16 v[42:43], v8 offset:10496
    v_mfma_f32_16x16x32_bf16 v[20:23], a[76:79], v[100:103], v[20:23]
    ds_read_b64_tr_b16 v[44:45], v8 offset:10272
    ds_read_b64_tr_b16 v[46:47], v8 offset:10528
    v_mfma_f32_16x16x32_bf16 v[24:27], v[32:35], v[100:103], v[24:27]
    v_mfma_f32_16x16x32_bf16 v[28:31], v[36:39], v[100:103], v[28:31]
    s_waitcnt vmcnt(16)
    v_mfma_f32_16x16x32_bf16 v[16:19], a[80:83], v[104:107], v[16:19]
    buffer_load_dwordx4 v[100:103], v10, s[4:7], s30 offen offset:1024
    v_mfma_f32_16x16x32_bf16 v[20:23], a[84:87], v[104:107], v[20:23]
    v_mfma_f32_16x16x32_bf16 v[24:27], v[168:171], v[104:107], v[24:27]
    v_mfma_f32_16x16x32_bf16 v[28:31], v[172:175], v[104:107], v[28:31]
    s_waitcnt vmcnt(16)
    s_waitcnt lgkmcnt(0)
    v_mfma_f32_16x16x32_bf16 v[16:19], a[88:91], v[108:111], v[16:19]
    buffer_load_dwordx4 v[104:107], v10, s[4:7], s30 offen offset:2048
    ds_read_b64_tr_b16 v[32:33], v8 offset:12288
    ds_read_b64_tr_b16 v[34:35], v8 offset:12544
    v_mfma_f32_16x16x32_bf16 v[20:23], a[92:95], v[108:111], v[20:23]
    ds_read_b64_tr_b16 v[36:37], v8 offset:12320
    ds_read_b64_tr_b16 v[38:39], v8 offset:12576
    v_mfma_f32_16x16x32_bf16 v[24:27], v[40:43], v[108:111], v[24:27]
    v_mfma_f32_16x16x32_bf16 v[28:31], v[44:47], v[108:111], v[28:31]
    s_waitcnt vmcnt(16)
    v_mfma_f32_16x16x32_bf16 v[16:19], a[96:99], v[112:115], v[16:19]
    buffer_load_dwordx4 v[108:111], v10, s[4:7], s30 offen offset:3072
    v_mfma_f32_16x16x32_bf16 v[20:23], a[100:103], v[112:115], v[20:23]
    v_mfma_f32_16x16x32_bf16 v[24:27], v[176:179], v[112:115], v[24:27]
    v_mfma_f32_16x16x32_bf16 v[28:31], v[180:183], v[112:115], v[28:31]
    s_waitcnt vmcnt(16)
    s_waitcnt lgkmcnt(0)
    v_mfma_f32_16x16x32_bf16 v[16:19], a[104:107], v[116:119], v[16:19]
    s_add_u32 s30, s30, 4096
    s_bitset0_b32 s30, 15
    buffer_load_dwordx4 v[112:115], v10, s[4:7], s30 offen offset:0
    ds_read_b64_tr_b16 v[40:41], v8 offset:14336
    ds_read_b64_tr_b16 v[42:43], v8 offset:14592
    v_mfma_f32_16x16x32_bf16 v[20:23], a[108:111], v[116:119], v[20:23]
    ds_read_b64_tr_b16 v[44:45], v8 offset:14368
    ds_read_b64_tr_b16 v[46:47], v8 offset:14624
    v_mfma_f32_16x16x32_bf16 v[24:27], v[32:35], v[116:119], v[24:27]
    v_mfma_f32_16x16x32_bf16 v[28:31], v[36:39], v[116:119], v[28:31]
    s_waitcnt vmcnt(16)
    v_mfma_f32_16x16x32_bf16 v[16:19], a[112:115], v[120:123], v[16:19]
    buffer_load_dwordx4 v[116:119], v10, s[4:7], s30 offen offset:1024
    v_mfma_f32_16x16x32_bf16 v[20:23], a[116:119], v[120:123], v[20:23]
    v_mfma_f32_16x16x32_bf16 v[24:27], v[184:187], v[120:123], v[24:27]
    v_mfma_f32_16x16x32_bf16 v[28:31], v[188:191], v[120:123], v[28:31]
    s_waitcnt vmcnt(16)
    s_waitcnt lgkmcnt(0)
    v_mfma_f32_16x16x32_bf16 v[16:19], a[120:123], v[124:127], v[16:19]
    buffer_load_dwordx4 v[120:123], v10, s[4:7], s30 offen offset:2048
    ds_read_b64_tr_b16 v[32:33], v8 offset:16384
    ds_read_b64_tr_b16 v[34:35], v8 offset:16640
    v_mfma_f32_16x16x32_bf16 v[20:23], a[124:127], v[124:127], v[20:23]
    ds_read_b64_tr_b16 v[36:37], v8 offset:16416
    ds_read_b64_tr_b16 v[38:39], v8 offset:16672
    v_mfma_f32_16x16x32_bf16 v[24:27], v[40:43], v[124:127], v[24:27]
    v_mfma_f32_16x16x32_bf16 v[28:31], v[44:47], v[124:127], v[28:31]
    s_waitcnt vmcnt(15)
    v_mfma_f32_16x16x32_bf16 v[16:19], a[128:131], v[64:67], v[16:19]
    buffer_load_dwordx4 v[124:127], v10, s[4:7], s30 offen offset:3072
    v_mfma_f32_16x16x32_bf16 v[20:23], a[132:135], v[64:67], v[20:23]
    s_lshr_b32 s17, s33, 3
    v_cmp_ge_u32 vcc, s17, v12
    s_lshl_b32 s18, s33, 2
    s_and_b32 s18, s18, 24
    v_mfma_f32_16x16x32_bf16 v[24:27], v[192:195], v[64:67], v[24:27]
    s_lshl_b32 s30, s33, 17
    s_add_u32 s30, s30, s37
    s_lshr_b32 s17, vcc_lo, s18
    s_and_b32 s17, s17, 0xff
    s_cselect_b32 s34, 0, 1
    s_cselect_b32 s30, 1073741824, s30
    v_mfma_f32_16x16x32_bf16 v[28:31], v[196:199], v[64:67], v[28:31]
    s_waitcnt vmcnt(15)
    s_waitcnt lgkmcnt(0)
    v_mfma_f32_16x16x32_bf16 v[16:19], a[136:139], v[68:71], v[16:19]
    buffer_load_dwordx4 v[64:67], v10, s[4:7], s30 offen offset:0
    ds_read_b64_tr_b16 v[40:41], v8 offset:18432
    ds_read_b64_tr_b16 v[42:43], v8 offset:18688
    v_mfma_f32_16x16x32_bf16 v[20:23], a[140:143], v[68:71], v[20:23]
    ds_read_b64_tr_b16 v[44:45], v8 offset:18464
    ds_read_b64_tr_b16 v[46:47], v8 offset:18720
    v_mfma_f32_16x16x32_bf16 v[24:27], v[32:35], v[68:71], v[24:27]
    v_mfma_f32_16x16x32_bf16 v[28:31], v[36:39], v[68:71], v[28:31]
    s_waitcnt vmcnt(15)
    v_mfma_f32_16x16x32_bf16 v[16:19], a[144:147], v[72:75], v[16:19]
    buffer_load_dwordx4 v[68:71], v10, s[4:7], s30 offen offset:1024
    v_mfma_f32_16x16x32_bf16 v[20:23], a[148:151], v[72:75], v[20:23]
    v_mfma_f32_16x16x32_bf16 v[24:27], v[200:203], v[72:75], v[24:27]
    v_mfma_f32_16x16x32_bf16 v[28:31], v[204:207], v[72:75], v[28:31]
    s_waitcnt vmcnt(15)
    s_waitcnt lgkmcnt(0)
    v_mfma_f32_16x16x32_bf16 v[16:19], a[152:155], v[76:79], v[16:19]
    buffer_load_dwordx4 v[72:75], v10, s[4:7], s30 offen offset:2048
    ds_read_b64_tr_b16 v[32:33], v8 offset:20480
    ds_read_b64_tr_b16 v[34:35], v8 offset:20736
    v_mfma_f32_16x16x32_bf16 v[20:23], a[156:159], v[76:79], v[20:23]
    ds_read_b64_tr_b16 v[36:37], v8 offset:20512
    ds_read_b64_tr_b16 v[38:39], v8 offset:20768
    v_mfma_f32_16x16x32_bf16 v[24:27], v[40:43], v[76:79], v[24:27]
    v_mfma_f32_16x16x32_bf16 v[28:31], v[44:47], v[76:79], v[28:31]
    s_waitcnt vmcnt(15)
    v_mfma_f32_16x16x32_bf16 v[16:19], a[160:163], v[80:83], v[16:19]
    buffer_load_dwordx4 v[76:79], v10, s[4:7], s30 offen offset:3072
    v_mfma_f32_16x16x32_bf16 v[20:23], a[164:167], v[80:83], v[20:23]
    v_mfma_f32_16x16x32_bf16 v[24:27], v[208:211], v[80:83], v[24:27]
    v_mfma_f32_16x16x32_bf16 v[28:31], v[212:215], v[80:83], v[28:31]
    s_waitcnt vmcnt(15)
    s_waitcnt lgkmcnt(0)
    v_mfma_f32_16x16x32_bf16 v[16:19], a[168:171], v[84:87], v[16:19]
    s_add_u32 s30, s30, 4096
    s_bitset0_b32 s30, 15
    buffer_load_dwordx4 v[80:83], v10, s[4:7], s30 offen offset:0
    ds_read_b64_tr_b16 v[40:41], v8 offset:22528
    ds_read_b64_tr_b16 v[42:43], v8 offset:22784
    v_mfma_f32_16x16x32_bf16 v[20:23], a[172:175], v[84:87], v[20:23]
    ds_read_b64_tr_b16 v[44:45], v8 offset:22560
    ds_read_b64_tr_b16 v[46:47], v8 offset:22816
    v_mfma_f32_16x16x32_bf16 v[24:27], v[32:35], v[84:87], v[24:27]
    v_mfma_f32_16x16x32_bf16 v[28:31], v[36:39], v[84:87], v[28:31]
    s_waitcnt vmcnt(15)
    v_mfma_f32_16x16x32_bf16 v[16:19], a[176:179], v[88:91], v[16:19]
    buffer_load_dwordx4 v[84:87], v10, s[4:7], s30 offen offset:1024
    v_mfma_f32_16x16x32_bf16 v[20:23], a[180:183], v[88:91], v[20:23]
    v_mfma_f32_16x16x32_bf16 v[24:27], v[216:219], v[88:91], v[24:27]
    v_mfma_f32_16x16x32_bf16 v[28:31], v[220:223], v[88:91], v[28:31]
    s_waitcnt vmcnt(15)
    s_waitcnt lgkmcnt(0)
    v_mfma_f32_16x16x32_bf16 v[16:19], a[184:187], v[92:95], v[16:19]
    buffer_load_dwordx4 v[88:91], v10, s[4:7], s30 offen offset:2048
    ds_read_b64_tr_b16 v[32:33], v8 offset:24576
    ds_read_b64_tr_b16 v[34:35], v8 offset:24832
    v_mfma_f32_16x16x32_bf16 v[20:23], a[188:191], v[92:95], v[20:23]
    ds_read_b64_tr_b16 v[36:37], v8 offset:24608
    ds_read_b64_tr_b16 v[38:39], v8 offset:24864
    v_mfma_f32_16x16x32_bf16 v[24:27], v[40:43], v[92:95], v[24:27]
    v_mfma_f32_16x16x32_bf16 v[28:31], v[44:47], v[92:95], v[28:31]
    s_waitcnt vmcnt(14)
    v_mfma_f32_16x16x32_bf16 v[16:19], a[192:195], v[96:99], v[16:19]
    buffer_load_dwordx4 v[92:95], v10, s[4:7], s30 offen offset:3072
    v_mfma_f32_16x16x32_bf16 v[20:23], a[196:199], v[96:99], v[20:23]
    v_mfma_f32_16x16x32_bf16 v[24:27], v[224:227], v[96:99], v[24:27]
    v_mfma_f32_16x16x32_bf16 v[28:31], v[228:231], v[96:99], v[28:31]
    s_waitcnt vmcnt(14)
    s_waitcnt lgkmcnt(0)
    v_mfma_f32_16x16x32_bf16 v[16:19], a[200:203], v[100:103], v[16:19]
    s_add_u32 s30, s30, 4096
    s_bitset0_b32 s30, 15
    buffer_load_dwordx4 v[96:99], v10, s[4:7], s30 offen offset:0
    ds_read_b64_tr_b16 v[40:41], v8 offset:26624
    ds_read_b64_tr_b16 v[42:43], v8 offset:26880
    v_mfma_f32_16x16x32_bf16 v[20:23], a[204:207], v[100:103], v[20:23]
    ds_read_b64_tr_b16 v[44:45], v8 offset:26656
    ds_read_b64_tr_b16 v[46:47], v8 offset:26912
    v_mfma_f32_16x16x32_bf16 v[24:27], v[32:35], v[100:103], v[24:27]
    v_mfma_f32_16x16x32_bf16 v[28:31], v[36:39], v[100:103], v[28:31]
    s_waitcnt vmcnt(14)
    v_mfma_f32_16x16x32_bf16 v[16:19], a[208:211], v[104:107], v[16:19]
    buffer_load_dwordx4 v[100:103], v10, s[4:7], s30 offen offset:1024
    v_mfma_f32_16x16x32_bf16 v[20:23], a[212:215], v[104:107], v[20:23]
    v_mfma_f32_16x16x32_bf16 v[24:27], v[232:235], v[104:107], v[24:27]
    v_mfma_f32_16x16x32_bf16 v[28:31], v[236:239], v[104:107], v[28:31]
    s_waitcnt vmcnt(14)
    s_waitcnt lgkmcnt(0)
    v_mfma_f32_16x16x32_bf16 v[16:19], a[216:219], v[108:111], v[16:19]
    buffer_load_dwordx4 v[104:107], v10, s[4:7], s30 offen offset:2048
    ds_read_b64_tr_b16 v[32:33], v8 offset:28672
    ds_read_b64_tr_b16 v[34:35], v8 offset:28928
    v_mfma_f32_16x16x32_bf16 v[20:23], a[220:223], v[108:111], v[20:23]
    ds_read_b64_tr_b16 v[36:37], v8 offset:28704
    ds_read_b64_tr_b16 v[38:39], v8 offset:28960
    v_mfma_f32_16x16x32_bf16 v[24:27], v[40:43], v[108:111], v[24:27]
    v_mfma_f32_16x16x32_bf16 v[28:31], v[44:47], v[108:111], v[28:31]
    s_waitcnt vmcnt(14)
    v_mfma_f32_16x16x32_bf16 v[16:19], a[224:227], v[112:115], v[16:19]
    buffer_load_dwordx4 v[108:111], v10, s[4:7], s30 offen offset:3072
    v_mfma_f32_16x16x32_bf16 v[20:23], a[228:231], v[112:115], v[20:23]
    v_mfma_f32_16x16x32_bf16 v[24:27], v[240:243], v[112:115], v[24:27]
    v_mfma_f32_16x16x32_bf16 v[28:31], v[244:247], v[112:115], v[28:31]
    s_waitcnt vmcnt(14)
    s_waitcnt lgkmcnt(0)
    v_mfma_f32_16x16x32_bf16 v[16:19], a[232:235], v[116:119], v[16:19]
    s_add_u32 s30, s30, 4096
    s_bitset0_b32 s30, 15
    buffer_load_dwordx4 v[112:115], v10, s[4:7], s30 offen offset:0
    ds_read_b64_tr_b16 v[40:41], v8 offset:30720
    ds_read_b64_tr_b16 v[42:43], v8 offset:30976
    v_mfma_f32_16x16x32_bf16 v[20:23], a[236:239], v[116:119], v[20:23]
    ds_read_b64_tr_b16 v[44:45], v8 offset:30752
    ds_read_b64_tr_b16 v[46:47], v8 offset:31008
    v_mfma_f32_16x16x32_bf16 v[24:27], v[32:35], v[116:119], v[24:27]
    v_mfma_f32_16x16x32_bf16 v[28:31], v[36:39], v[116:119], v[28:31]
    s_waitcnt vmcnt(14)
    v_mfma_f32_16x16x32_bf16 v[16:19], a[240:243], v[120:123], v[16:19]
    buffer_load_dwordx4 v[116:119], v10, s[4:7], s30 offen offset:1024
    v_mfma_f32_16x16x32_bf16 v[20:23], a[244:247], v[120:123], v[20:23]
    v_mfma_f32_16x16x32_bf16 v[24:27], v[248:251], v[120:123], v[24:27]
    v_mfma_f32_16x16x32_bf16 v[28:31], v[252:255], v[120:123], v[28:31]
    s_waitcnt vmcnt(14)
    s_waitcnt lgkmcnt(0)
    v_mfma_f32_16x16x32_bf16 v[16:19], a[248:251], v[124:127], v[16:19]
    buffer_load_dwordx4 v[120:123], v10, s[4:7], s30 offen offset:2048
    ds_read_b64_tr_b16 v[32:33], v8 offset:0
    ds_read_b64_tr_b16 v[34:35], v8 offset:256
    v_mfma_f32_16x16x32_bf16 v[20:23], a[252:255], v[124:127], v[20:23]
    ds_read_b64_tr_b16 v[36:37], v8 offset:32
    ds_read_b64_tr_b16 v[38:39], v8 offset:288
    v_mfma_f32_16x16x32_bf16 v[24:27], v[40:43], v[124:127], v[24:27]
    v_mfma_f32_16x16x32_bf16 v[28:31], v[44:47], v[124:127], v[28:31]
    s_lshl_b32 s31, s28, 16
    s_mov_b32 s28, s33
    s_cmp_eq_u32 s34, 1
    ds_write_b128 v14, v[16:19] offset:0
    ds_write_b128 v14, v[20:23] offset:4096
    ds_write_b128 v14, v[24:27] offset:8192
    s_nop 1
    ds_write_b128 v14, v[28:31] offset:12288
    v_xor_b32 v14, 0x4000, v14
    s_cbranch_scc1 U_item
    s_waitcnt lgkmcnt(0)
    s_barrier
    ds_read_b128 v[48:51], v15 offset:0
    ds_read_b128 v[52:55], v15 offset:1024
    ds_read_b128 v[56:59], v15 offset:2048
    ds_read_b128 v[60:63], v15 offset:3072
    s_waitcnt lgkmcnt(0)
    v_add_f32 v48, v48, v52
    v_add_f32 v49, v49, v53
    v_add_f32 v50, v50, v54
    v_add_f32 v51, v51, v55
    v_add_f32 v56, v56, v60
    v_add_f32 v57, v57, v61
    v_add_f32 v58, v58, v62
    v_add_f32 v59, v59, v63
    v_add_f32 v48, v48, v56
    v_add_f32 v49, v49, v57
    v_add_f32 v50, v50, v58
    v_add_f32 v51, v51, v59
    v_cvt_pk_bf16_f32 v52, v48, v49
    v_cvt_pk_bf16_f32 v53, v50, v51
    buffer_store_dwordx2 v[52:53], v13, s[12:15], s31 offen
    s_cmp_lt_u32 s28, 128
    s_cbranch_scc1 U_wait
    s_branch W_fin
W_F:
    s_waitcnt vmcnt(0)
    s_barrier
    s_cmp_lg_u32 s16, 0
    s_cbranch_scc1 reg_16
    s_and_b32 s17, s2, 3
    s_lshl_b32 s17, s17, 3
    s_lshl_b32 s18, s98, 2
    s_add_u32 s17, s17, s18
    s_lshl_b32 s17, 1, s17
    s_andn2_b32 s18, s2, 3
    v_mov_b32 v5, s18
    v_mov_b32 v6, s17
    s_mov_b64 exec, 1
    global_atomic_add v5, v6, s[100:101] sc1
    s_mov_b64 exec, -1
reg_16:
    s_load_dwordx2 s[48:49], s[0:1], 8
    s_load_dwordx2 s[52:53], s[0:1], 16
    s_mov_b32 s50, 2101248
    s_mov_b32 s51, 0x20000
    s_mov_b32 s54, 2101248
    s_mov_b32 s55, 0x20000
    s_load_dwordx2 s[40:41], s[0:1], 0
    s_load_dwordx2 s[44:45], s[0:1], 24
    s_mov_b32 s42, 4194304
    s_mov_b32 s43, 0x20000
    s_mov_b32 s46, 4194304
    s_mov_b32 s47, 0x20000
    s_lshr_b32 s28, s93, 3
    s_and_b32 s29, s93, 7
    s_lshl_b32 s29, s29, 2
    s_add_u32 s29, s29, s16
    v_bfe_u32 v5, v1, 2, 2
    v_and_b32 v7, 3, v1
    v_lshl_add_u32 v7, v5, 3, v7
    s_lshl_b32 s17, s29, 5
    v_add_u32 v7, s17, v7
    v_lshrrev_b32 v8, 4, v1
    v_cvt_f32_u32 v8, v8
    s_mov_b32 s31, 981467136
    v_add_u32 v5, 0, v7
    v_lshrrev_b32 v6, 1, v5
    v_and_b32 v30, 1, v5
    v_cmp_eq_u32 vcc, 1, v5
    v_mov_b32 v5, 512
    s_nop 0
    v_cndmask_b32 v6, v6, v5, vcc
    v_cndmask_b32 v30, v30, 0, vcc
    v_add_u32 v5, v6, v30
    v_bfe_i32 v40, v5, 1, 1
    v_add_u32 v5, v6, v5
    v_bfe_i32 v42, v5, 1, 1
    v_add_u32 v5, v6, v5
    v_bfe_i32 v44, v5, 1, 1
    v_and_b32 v40, 0x80008000, v40
    v_and_b32 v42, 0x80008000, v42
    v_and_b32 v44, 0x80008000, v44
    v_cvt_f32_u32 v6, v6
    v_cvt_f32_u32 v30, v30
    v_mul_f32 v32, s31, v6
    v_mul_f32 v30, 0x3e800000, v30
    v_mov_b32 v34, v32
    v_mul_f32 v36, 0x42000000, v32
    v_mul_f32 v5, 0x41000000, v32
    v_fma_f32 v30, v5, v8, v30
    v_add_u32 v5, 4, v7
    v_lshrrev_b32 v6, 1, v5
    v_and_b32 v31, 1, v5
    v_cmp_eq_u32 vcc, 1, v5
    v_mov_b32 v5, 512
    s_nop 0
    v_cndmask_b32 v6, v6, v5, vcc
    v_cndmask_b32 v31, v31, 0, vcc
    v_add_u32 v5, v6, v31
    v_bfe_i32 v41, v5, 1, 1
    v_add_u32 v5, v6, v5
    v_bfe_i32 v43, v5, 1, 1
    v_add_u32 v5, v6, v5
    v_bfe_i32 v45, v5, 1, 1
    v_and_b32 v41, 0x80008000, v41
    v_and_b32 v43, 0x80008000, v43
    v_and_b32 v45, 0x80008000, v45
    v_cvt_f32_u32 v6, v6
    v_cvt_f32_u32 v31, v31
    v_mul_f32 v33, s31, v6
    v_mul_f32 v31, 0x3e800000, v31
    v_mov_b32 v35, v33
    v_mul_f32 v37, 0x42000000, v33
    v_mul_f32 v5, 0x41000000, v33
    v_fma_f32 v31, v5, v8, v31
    v_fract_f32 v48, v30
    v_add_f32 v49, v48, v32
    v_cos_f32 v56, v48
    v_add_f32 v50, v49, v34
    v_cos_f32 v57, v49
    v_add_f32 v51, v50, v32
    v_cos_f32 v58, v50
    v_add_f32 v52, v51, v34
    v_cos_f32 v59, v51
    v_add_f32 v53, v52, v32
    v_cos_f32 v60, v52
    v_add_f32 v54, v53, v34
    v_cos_f32 v61, v53
    v_add_f32 v55, v54, v32
    v_cos_f32 v62, v54
    v_cos_f32 v63, v55
    v_add_f32 v30, v48, v36
    v_cvt_pk_bf16_f32 v64, v56, v57
    v_cvt_pk_bf16_f32 v65, v58, v59
    v_cvt_pk_bf16_f32 v66, v60, v61
    v_cvt_pk_bf16_f32 v67, v62, v63
    v_accvgpr_write_b32 a0, v64
    v_accvgpr_write_b32 a1, v65
    v_accvgpr_write_b32 a2, v66
    v_accvgpr_write_b32 a3, v67
    v_xor_b32_dpp v68, v64, v40 quad_perm:[0,1,3,2] row_mask:0xf bank_mask:0xf
    v_xor_b32_dpp v69, v65, v40 quad_perm:[0,1,3,2] row_mask:0xf bank_mask:0xf
    v_xor_b32_dpp v70, v66, v40 quad_perm:[0,1,3,2] row_mask:0xf bank_mask:0xf
    v_xor_b32_dpp v71, v67, v40 quad_perm:[0,1,3,2] row_mask:0xf bank_mask:0xf
    v_accvgpr_write_b32 a64, v68
    v_accvgpr_write_b32 a65, v69
    v_accvgpr_write_b32 a66, v70
    v_accvgpr_write_b32 a67, v71
    v_xor_b32 v68, v64, v42
    v_xor_b32 v69, v65, v42
    v_xor_b32 v70, v66, v42
    v_xor_b32 v71, v67, v42
    v_accvgpr_write_b32 a128, v68
    v_accvgpr_write_b32 a129, v69
    v_accvgpr_write_b32 a130, v70
    v_accvgpr_write_b32 a131, v71
    v_xor_b32_dpp v68, v64, v44 quad_perm:[0,1,3,2] row_mask:0xf bank_mask:0xf
    v_xor_b32_dpp v69, v65, v44 quad_perm:[0,1,3,2] row_mask:0xf bank_mask:0xf
    v_xor_b32_dpp v70, v66, v44 quad_perm:[0,1,3,2] row_mask:0xf bank_mask:0xf
    v_xor_b32_dpp v71, v67, v44 quad_perm:[0,1,3,2] row_mask:0xf bank_mask:0xf
    v_accvgpr_write_b32 a192, v68
    v_accvgpr_write_b32 a193, v69
    v_accvgpr_write_b32 a194, v70
    v_accvgpr_write_b32 a195, v71
    v_fract_f32 v48, v31
    v_add_f32 v49, v48, v33
    v_cos_f32 v56, v48
    v_add_f32 v50, v49, v35
    v_cos_f32 v57, v49
    v_add_f32 v51, v50, v33
    v_cos_f32 v58, v50
    v_add_f32 v52, v51, v35
    v_cos_f32 v59, v51
    v_add_f32 v53, v52, v33
    v_cos_f32 v60, v52
    v_add_f32 v54, v53, v35
    v_cos_f32 v61, v53
    v_add_f32 v55, v54, v33
    v_cos_f32 v62, v54
    v_cos_f32 v63, v55
    v_add_f32 v31, v48, v37
    v_cvt_pk_bf16_f32 v64, v56, v57
    v_cvt_pk_bf16_f32 v65, v58, v59
    v_cvt_pk_bf16_f32 v66, v60, v61
    v_cvt_pk_bf16_f32 v67, v62, v63
    v_accvgpr_write_b32 a4, v64
    v_accvgpr_write_b32 a5, v65
    v_accvgpr_write_b32 a6, v66
    v_accvgpr_write_b32 a7, v67
    v_xor_b32_dpp v68, v64, v41 quad_perm:[0,1,3,2] row_mask:0xf bank_mask:0xf
    v_xor_b32_dpp v69, v65, v41 quad_perm:[0,1,3,2] row_mask:0xf bank_mask:0xf
    v_xor_b32_dpp v70, v66, v41 quad_perm:[0,1,3,2] row_mask:0xf bank_mask:0xf
    v_xor_b32_dpp v71, v67, v41 quad_perm:[0,1,3,2] row_mask:0xf bank_mask:0xf
    v_accvgpr_write_b32 a68, v68
    v_accvgpr_write_b32 a69, v69
    v_accvgpr_write_b32 a70, v70
    v_accvgpr_write_b32 a71, v71
    v_xor_b32 v68, v64, v43
    v_xor_b32 v69, v65, v43
    v_xor_b32 v70, v66, v43
    v_xor_b32 v71, v67, v43
    v_accvgpr_write_b32 a132, v68
    v_accvgpr_write_b32 a133, v69
    v_accvgpr_write_b32 a134, v70
    v_accvgpr_write_b32 a135, v71
    v_xor_b32_dpp v68, v64, v45 quad_perm:[0,1,3,2] row_mask:0xf bank_mask:0xf
    v_xor_b32_dpp v69, v65, v45 quad_perm:[0,1,3,2] row_mask:0xf bank_mask:0xf
    v_xor_b32_dpp v70, v66, v45 quad_perm:[0,1,3,2] row_mask:0xf bank_mask:0xf
    v_xor_b32_dpp v71, v67, v45 quad_perm:[0,1,3,2] row_mask:0xf bank_mask:0xf
    v_accvgpr_write_b32 a196, v68
    v_accvgpr_write_b32 a197, v69
    v_accvgpr_write_b32 a198, v70
    v_accvgpr_write_b32 a199, v71
    v_fract_f32 v48, v30
    v_add_f32 v49, v48, v32
    v_cos_f32 v56, v48
    v_add_f32 v50, v49, v34
    v_cos_f32 v57, v49
    v_add_f32 v51, v50, v32
    v_cos_f32 v58, v50
    v_add_f32 v52, v51, v34
    v_cos_f32 v59, v51
    v_add_f32 v53, v52, v32
    v_cos_f32 v60, v52
    v_add_f32 v54, v53, v34
    v_cos_f32 v61, v53
    v_add_f32 v55, v54, v32
    v_cos_f32 v62, v54
    v_cos_f32 v63, v55
    v_add_f32 v30, v48, v36
    v_cvt_pk_bf16_f32 v64, v56, v57
    v_cvt_pk_bf16_f32 v65, v58, v59
    v_cvt_pk_bf16_f32 v66, v60, v61
    v_cvt_pk_bf16_f32 v67, v62, v63
    v_accvgpr_write_b32 a8, v64
    v_accvgpr_write_b32 a9, v65
    v_accvgpr_write_b32 a10, v66
    v_accvgpr_write_b32 a11, v67
    v_xor_b32_dpp v68, v64, v40 quad_perm:[0,1,3,2] row_mask:0xf bank_mask:0xf
    v_xor_b32_dpp v69, v65, v40 quad_perm:[0,1,3,2] row_mask:0xf bank_mask:0xf
    v_xor_b32_dpp v70, v66, v40 quad_perm:[0,1,3,2] row_mask:0xf bank_mask:0xf
    v_xor_b32_dpp v71, v67, v40 quad_perm:[0,1,3,2] row_mask:0xf bank_mask:0xf
    v_accvgpr_write_b32 a72, v68
    v_accvgpr_write_b32 a73, v69
    v_accvgpr_write_b32 a74, v70
    v_accvgpr_write_b32 a75, v71
    v_xor_b32 v68, v64, v42
    v_xor_b32 v69, v65, v42
    v_xor_b32 v70, v66, v42
    v_xor_b32 v71, v67, v42
    v_accvgpr_write_b32 a136, v68
    v_accvgpr_write_b32 a137, v69
    v_accvgpr_write_b32 a138, v70
    v_accvgpr_write_b32 a139, v71
    v_xor_b32_dpp v68, v64, v44 quad_perm:[0,1,3,2] row_mask:0xf bank_mask:0xf
    v_xor_b32_dpp v69, v65, v44 quad_perm:[0,1,3,2] row_mask:0xf bank_mask:0xf
    v_xor_b32_dpp v70, v66, v44 quad_perm:[0,1,3,2] row_mask:0xf bank_mask:0xf
    v_xor_b32_dpp v71, v67, v44 quad_perm:[0,1,3,2] row_mask:0xf bank_mask:0xf
    v_accvgpr_write_b32 a200, v68
    v_accvgpr_write_b32 a201, v69
    v_accvgpr_write_b32 a202, v70
    v_accvgpr_write_b32 a203, v71
    v_fract_f32 v48, v31
    v_add_f32 v49, v48, v33
    v_cos_f32 v56, v48
    v_add_f32 v50, v49, v35
    v_cos_f32 v57, v49
    v_add_f32 v51, v50, v33
    v_cos_f32 v58, v50
    v_add_f32 v52, v51, v35
    v_cos_f32 v59, v51
    v_add_f32 v53, v52, v33
    v_cos_f32 v60, v52
    v_add_f32 v54, v53, v35
    v_cos_f32 v61, v53
    v_add_f32 v55, v54, v33
    v_cos_f32 v62, v54
    v_cos_f32 v63, v55
    v_add_f32 v31, v48, v37
    v_cvt_pk_bf16_f32 v64, v56, v57
    v_cvt_pk_bf16_f32 v65, v58, v59
    v_cvt_pk_bf16_f32 v66, v60, v61
    v_cvt_pk_bf16_f32 v67, v62, v63
    v_accvgpr_write_b32 a12, v64
    v_accvgpr_write_b32 a13, v65
    v_accvgpr_write_b32 a14, v66
    v_accvgpr_write_b32 a15, v67
    v_xor_b32_dpp v68, v64, v41 quad_perm:[0,1,3,2] row_mask:0xf bank_mask:0xf
    v_xor_b32_dpp v69, v65, v41 quad_perm:[0,1,3,2] row_mask:0xf bank_mask:0xf
    v_xor_b32_dpp v70, v66, v41 quad_perm:[0,1,3,2] row_mask:0xf bank_mask:0xf
    v_xor_b32_dpp v71, v67, v41 quad_perm:[0,1,3,2] row_mask:0xf bank_mask:0xf
    v_accvgpr_write_b32 a76, v68
    v_accvgpr_write_b32 a77, v69
    v_accvgpr_write_b32 a78, v70
    v_accvgpr_write_b32 a79, v71
    v_xor_b32 v68, v64, v43
    v_xor_b32 v69, v65, v43
    v_xor_b32 v70, v66, v43
    v_xor_b32 v71, v67, v43
    v_accvgpr_write_b32 a140, v68
    v_accvgpr_write_b32 a141, v69
    v_accvgpr_write_b32 a142, v70
    v_accvgpr_write_b32 a143, v71
    v_xor_b32_dpp v68, v64, v45 quad_perm:[0,1,3,2] row_mask:0xf bank_mask:0xf
    v_xor_b32_dpp v69, v65, v45 quad_perm:[0,1,3,2] row_mask:0xf bank_mask:0xf
    v_xor_b32_dpp v70, v66, v45 quad_perm:[0,1,3,2] row_mask:0xf bank_mask:0xf
    v_xor_b32_dpp v71, v67, v45 quad_perm:[0,1,3,2] row_mask:0xf bank_mask:0xf
    v_accvgpr_write_b32 a204, v68
    v_accvgpr_write_b32 a205, v69
    v_accvgpr_write_b32 a206, v70
    v_accvgpr_write_b32 a207, v71
    v_fract_f32 v48, v30
    v_add_f32 v49, v48, v32
    v_cos_f32 v56, v48
    v_add_f32 v50, v49, v34
    v_cos_f32 v57, v49
    v_add_f32 v51, v50, v32
    v_cos_f32 v58, v50
    v_add_f32 v52, v51, v34
    v_cos_f32 v59, v51
    v_add_f32 v53, v52, v32
    v_cos_f32 v60, v52
    v_add_f32 v54, v53, v34
    v_cos_f32 v61, v53
    v_add_f32 v55, v54, v32
    v_cos_f32 v62, v54
    v_cos_f32 v63, v55
    v_add_f32 v30, v48, v36
    v_cvt_pk_bf16_f32 v64, v56, v57
    v_cvt_pk_bf16_f32 v65, v58, v59
    v_cvt_pk_bf16_f32 v66, v60, v61
    v_cvt_pk_bf16_f32 v67, v62, v63
    v_accvgpr_write_b32 a16, v64
    v_accvgpr_write_b32 a17, v65
    v_accvgpr_write_b32 a18, v66
    v_accvgpr_write_b32 a19, v67
    v_xor_b32_dpp v68, v64, v40 quad_perm:[0,1,3,2] row_mask:0xf bank_mask:0xf
    v_xor_b32_dpp v69, v65, v40 quad_perm:[0,1,3,2] row_mask:0xf bank_mask:0xf
    v_xor_b32_dpp v70, v66, v40 quad_perm:[0,1,3,2] row_mask:0xf bank_mask:0xf
    v_xor_b32_dpp v71, v67, v40 quad_perm:[0,1,3,2] row_mask:0xf bank_mask:0xf
    v_accvgpr_write_b32 a80, v68
    v_accvgpr_write_b32 a81, v69
    v_accvgpr_write_b32 a82, v70
    v_accvgpr_write_b32 a83, v71
    v_xor_b32 v68, v64, v42
    v_xor_b32 v69, v65, v42
    v_xor_b32 v70, v66, v42
    v_xor_b32 v71, v67, v42
    v_accvgpr_write_b32 a144, v68
    v_accvgpr_write_b32 a145, v69
    v_accvgpr_write_b32 a146, v70
    v_accvgpr_write_b32 a147, v71
    v_xor_b32_dpp v68, v64, v44 quad_perm:[0,1,3,2] row_mask:0xf bank_mask:0xf
    v_xor_b32_dpp v69, v65, v44 quad_perm:[0,1,3,2] row_mask:0xf bank_mask:0xf
    v_xor_b32_dpp v70, v66, v44 quad_perm:[0,1,3,2] row_mask:0xf bank_mask:0xf
    v_xor_b32_dpp v71, v67, v44 quad_perm:[0,1,3,2] row_mask:0xf bank_mask:0xf
    v_accvgpr_write_b32 a208, v68
    v_accvgpr_write_b32 a209, v69
    v_accvgpr_write_b32 a210, v70
    v_accvgpr_write_b32 a211, v71
    v_fract_f32 v48, v31
    v_add_f32 v49, v48, v33
    v_cos_f32 v56, v48
    v_add_f32 v50, v49, v35
    v_cos_f32 v57, v49
    v_add_f32 v51, v50, v33
    v_cos_f32 v58, v50
    v_add_f32 v52, v51, v35
    v_cos_f32 v59, v51
    v_add_f32 v53, v52, v33
    v_cos_f32 v60, v52
    v_add_f32 v54, v53, v35
    v_cos_f32 v61, v53
    v_add_f32 v55, v54, v33
    v_cos_f32 v62, v54
    v_cos_f32 v63, v55
    v_add_f32 v31, v48, v37
    v_cvt_pk_bf16_f32 v64, v56, v57
    v_cvt_pk_bf16_f32 v65, v58, v59
    v_cvt_pk_bf16_f32 v66, v60, v61
    v_cvt_pk_bf16_f32 v67, v62, v63
    v_accvgpr_write_b32 a20, v64
    v_accvgpr_write_b32 a21, v65
    v_accvgpr_write_b32 a22, v66
    v_accvgpr_write_b32 a23, v67
    v_xor_b32_dpp v68, v64, v41 quad_perm:[0,1,3,2] row_mask:0xf bank_mask:0xf
    v_xor_b32_dpp v69, v65, v41 quad_perm:[0,1,3,2] row_mask:0xf bank_mask:0xf
    v_xor_b32_dpp v70, v66, v41 quad_perm:[0,1,3,2] row_mask:0xf bank_mask:0xf
    v_xor_b32_dpp v71, v67, v41 quad_perm:[0,1,3,2] row_mask:0xf bank_mask:0xf
    v_accvgpr_write_b32 a84, v68
    v_accvgpr_write_b32 a85, v69
    v_accvgpr_write_b32 a86, v70
    v_accvgpr_write_b32 a87, v71
    v_xor_b32 v68, v64, v43
    v_xor_b32 v69, v65, v43
    v_xor_b32 v70, v66, v43
    v_xor_b32 v71, v67, v43
    v_accvgpr_write_b32 a148, v68
    v_accvgpr_write_b32 a149, v69
    v_accvgpr_write_b32 a150, v70
    v_accvgpr_write_b32 a151, v71
    v_xor_b32_dpp v68, v64, v45 quad_perm:[0,1,3,2] row_mask:0xf bank_mask:0xf
    v_xor_b32_dpp v69, v65, v45 quad_perm:[0,1,3,2] row_mask:0xf bank_mask:0xf
    v_xor_b32_dpp v70, v66, v45 quad_perm:[0,1,3,2] row_mask:0xf bank_mask:0xf
    v_xor_b32_dpp v71, v67, v45 quad_perm:[0,1,3,2] row_mask:0xf bank_mask:0xf
    v_accvgpr_write_b32 a212, v68
    v_accvgpr_write_b32 a213, v69
    v_accvgpr_write_b32 a214, v70
    v_accvgpr_write_b32 a215, v71
    v_fract_f32 v48, v30
    v_add_f32 v49, v48, v32
    v_cos_f32 v56, v48
    v_add_f32 v50, v49, v34
    v_cos_f32 v57, v49
    v_add_f32 v51, v50, v32
    v_cos_f32 v58, v50
    v_add_f32 v52, v51, v34
    v_cos_f32 v59, v51
    v_add_f32 v53, v52, v32
    v_cos_f32 v60, v52
    v_add_f32 v54, v53, v34
    v_cos_f32 v61, v53
    v_add_f32 v55, v54, v32
    v_cos_f32 v62, v54
    v_cos_f32 v63, v55
    v_add_f32 v30, v48, v36
    v_cvt_pk_bf16_f32 v64, v56, v57
    v_cvt_pk_bf16_f32 v65, v58, v59
    v_cvt_pk_bf16_f32 v66, v60, v61
    v_cvt_pk_bf16_f32 v67, v62, v63
    v_accvgpr_write_b32 a24, v64
    v_accvgpr_write_b32 a25, v65
    v_accvgpr_write_b32 a26, v66
    v_accvgpr_write_b32 a27, v67
    v_xor_b32_dpp v68, v64, v40 quad_perm:[0,1,3,2] row_mask:0xf bank_mask:0xf
    v_xor_b32_dpp v69, v65, v40 quad_perm:[0,1,3,2] row_mask:0xf bank_mask:0xf
    v_xor_b32_dpp v70, v66, v40 quad_perm:[0,1,3,2] row_mask:0xf bank_mask:0xf
    v_xor_b32_dpp v71, v67, v40 quad_perm:[0,1,3,2] row_mask:0xf bank_mask:0xf
    v_accvgpr_write_b32 a88, v68
    v_accvgpr_write_b32 a89, v69
    v_accvgpr_write_b32 a90, v70
    v_accvgpr_write_b32 a91, v71
    v_xor_b32 v68, v64, v42
    v_xor_b32 v69, v65, v42
    v_xor_b32 v70, v66, v42
    v_xor_b32 v71, v67, v42
    v_accvgpr_write_b32 a152, v68
    v_accvgpr_write_b32 a153, v69
    v_accvgpr_write_b32 a154, v70
    v_accvgpr_write_b32 a155, v71
    v_xor_b32_dpp v68, v64, v44 quad_perm:[0,1,3,2] row_mask:0xf bank_mask:0xf
    v_xor_b32_dpp v69, v65, v44 quad_perm:[0,1,3,2] row_mask:0xf bank_mask:0xf
    v_xor_b32_dpp v70, v66, v44 quad_perm:[0,1,3,2] row_mask:0xf bank_mask:0xf
    v_xor_b32_dpp v71, v67, v44 quad_perm:[0,1,3,2] row_mask:0xf bank_mask:0xf
    v_accvgpr_write_b32 a216, v68
    v_accvgpr_write_b32 a217, v69
    v_accvgpr_write_b32 a218, v70
    v_accvgpr_write_b32 a219, v71
    v_fract_f32 v48, v31
    v_add_f32 v49, v48, v33
    v_cos_f32 v56, v48
    v_add_f32 v50, v49, v35
    v_cos_f32 v57, v49
    v_add_f32 v51, v50, v33
    v_cos_f32 v58, v50
    v_add_f32 v52, v51, v35
    v_cos_f32 v59, v51
    v_add_f32 v53, v52, v33
    v_cos_f32 v60, v52
    v_add_f32 v54, v53, v35
    v_cos_f32 v61, v53
    v_add_f32 v55, v54, v33
    v_cos_f32 v62, v54
    v_cos_f32 v63, v55
    v_add_f32 v31, v48, v37
    v_cvt_pk_bf16_f32 v64, v56, v57
    v_cvt_pk_bf16_f32 v65, v58, v59
    v_cvt_pk_bf16_f32 v66, v60, v61
    v_cvt_pk_bf16_f32 v67, v62, v63
    v_accvgpr_write_b32 a28, v64
    v_accvgpr_write_b32 a29, v65
    v_accvgpr_write_b32 a30, v66
    v_accvgpr_write_b32 a31, v67
    v_xor_b32_dpp v68, v64, v41 quad_perm:[0,1,3,2] row_mask:0xf bank_mask:0xf
    v_xor_b32_dpp v69, v65, v41 quad_perm:[0,1,3,2] row_mask:0xf bank_mask:0xf
    v_xor_b32_dpp v70, v66, v41 quad_perm:[0,1,3,2] row_mask:0xf bank_mask:0xf
    v_xor_b32_dpp v71, v67, v41 quad_perm:[0,1,3,2] row_mask:0xf bank_mask:0xf
    v_accvgpr_write_b32 a92, v68
    v_accvgpr_write_b32 a93, v69
    v_accvgpr_write_b32 a94, v70
    v_accvgpr_write_b32 a95, v71
    v_xor_b32 v68, v64, v43
    v_xor_b32 v69, v65, v43
    v_xor_b32 v70, v66, v43
    v_xor_b32 v71, v67, v43
    v_accvgpr_write_b32 a156, v68
    v_accvgpr_write_b32 a157, v69
    v_accvgpr_write_b32 a158, v70
    v_accvgpr_write_b32 a159, v71
    v_xor_b32_dpp v68, v64, v45 quad_perm:[0,1,3,2] row_mask:0xf bank_mask:0xf
    v_xor_b32_dpp v69, v65, v45 quad_perm:[0,1,3,2] row_mask:0xf bank_mask:0xf
    v_xor_b32_dpp v70, v66, v45 quad_perm:[0,1,3,2] row_mask:0xf bank_mask:0xf
    v_xor_b32_dpp v71, v67, v45 quad_perm:[0,1,3,2] row_mask:0xf bank_mask:0xf
    v_accvgpr_write_b32 a220, v68
    v_accvgpr_write_b32 a221, v69
    v_accvgpr_write_b32 a222, v70
    v_accvgpr_write_b32 a223, v71
    v_fract_f32 v48, v30
    v_add_f32 v49, v48, v32
    v_cos_f32 v56, v48
    v_add_f32 v50, v49, v34
    v_cos_f32 v57, v49
    v_add_f32 v51, v50, v32
    v_cos_f32 v58, v50
    v_add_f32 v52, v51, v34
    v_cos_f32 v59, v51
    v_add_f32 v53, v52, v32
    v_cos_f32 v60, v52
    v_add_f32 v54, v53, v34
    v_cos_f32 v61, v53
    v_add_f32 v55, v54, v32
    v_cos_f32 v62, v54
    v_cos_f32 v63, v55
    v_add_f32 v30, v48, v36
    v_cvt_pk_bf16_f32 v64, v56, v57
    v_cvt_pk_bf16_f32 v65, v58, v59
    v_cvt_pk_bf16_f32 v66, v60, v61
    v_cvt_pk_bf16_f32 v67, v62, v63
    v_accvgpr_write_b32 a32, v64
    v_accvgpr_write_b32 a33, v65
    v_accvgpr_write_b32 a34, v66
    v_accvgpr_write_b32 a35, v67
    v_xor_b32_dpp v68, v64, v40 quad_perm:[0,1,3,2] row_mask:0xf bank_mask:0xf
    v_xor_b32_dpp v69, v65, v40 quad_perm:[0,1,3,2] row_mask:0xf bank_mask:0xf
    v_xor_b32_dpp v70, v66, v40 quad_perm:[0,1,3,2] row_mask:0xf bank_mask:0xf
    v_xor_b32_dpp v71, v67, v40 quad_perm:[0,1,3,2] row_mask:0xf bank_mask:0xf
    v_accvgpr_write_b32 a96, v68
    v_accvgpr_write_b32 a97, v69
    v_accvgpr_write_b32 a98, v70
    v_accvgpr_write_b32 a99, v71
    v_xor_b32 v68, v64, v42
    v_xor_b32 v69, v65, v42
    v_xor_b32 v70, v66, v42
    v_xor_b32 v71, v67, v42
    v_accvgpr_write_b32 a160, v68
    v_accvgpr_write_b32 a161, v69
    v_accvgpr_write_b32 a162, v70
    v_accvgpr_write_b32 a163, v71
    v_xor_b32_dpp v68, v64, v44 quad_perm:[0,1,3,2] row_mask:0xf bank_mask:0xf
    v_xor_b32_dpp v69, v65, v44 quad_perm:[0,1,3,2] row_mask:0xf bank_mask:0xf
    v_xor_b32_dpp v70, v66, v44 quad_perm:[0,1,3,2] row_mask:0xf bank_mask:0xf
    v_xor_b32_dpp v71, v67, v44 quad_perm:[0,1,3,2] row_mask:0xf bank_mask:0xf
    v_accvgpr_write_b32 a224, v68
    v_accvgpr_write_b32 a225, v69
    v_accvgpr_write_b32 a226, v70
    v_accvgpr_write_b32 a227, v71
    v_fract_f32 v48, v31
    v_add_f32 v49, v48, v33
    v_cos_f32 v56, v48
    v_add_f32 v50, v49, v35
    v_cos_f32 v57, v49
    v_add_f32 v51, v50, v33
    v_cos_f32 v58, v50
    v_add_f32 v52, v51, v35
    v_cos_f32 v59, v51
    v_add_f32 v53, v52, v33
    v_cos_f32 v60, v52
    v_add_f32 v54, v53, v35
    v_cos_f32 v61, v53
    v_add_f32 v55, v54, v33
    v_cos_f32 v62, v54
    v_cos_f32 v63, v55
    v_add_f32 v31, v48, v37
    v_cvt_pk_bf16_f32 v64, v56, v57
    v_cvt_pk_bf16_f32 v65, v58, v59
    v_cvt_pk_bf16_f32 v66, v60, v61
    v_cvt_pk_bf16_f32 v67, v62, v63
    v_accvgpr_write_b32 a36, v64
    v_accvgpr_write_b32 a37, v65
    v_accvgpr_write_b32 a38, v66
    v_accvgpr_write_b32 a39, v67
    v_xor_b32_dpp v68, v64, v41 quad_perm:[0,1,3,2] row_mask:0xf bank_mask:0xf
    v_xor_b32_dpp v69, v65, v41 quad_perm:[0,1,3,2] row_mask:0xf bank_mask:0xf
    v_xor_b32_dpp v70, v66, v41 quad_perm:[0,1,3,2] row_mask:0xf bank_mask:0xf
    v_xor_b32_dpp v71, v67, v41 quad_perm:[0,1,3,2] row_mask:0xf bank_mask:0xf
    v_accvgpr_write_b32 a100, v68
    v_accvgpr_write_b32 a101, v69
    v_accvgpr_write_b32 a102, v70
    v_accvgpr_write_b32 a103, v71
    v_xor_b32 v68, v64, v43
    v_xor_b32 v69, v65, v43
    v_xor_b32 v70, v66, v43
    v_xor_b32 v71, v67, v43
    v_accvgpr_write_b32 a164, v68
    v_accvgpr_write_b32 a165, v69
    v_accvgpr_write_b32 a166, v70
    v_accvgpr_write_b32 a167, v71
    v_xor_b32_dpp v68, v64, v45 quad_perm:[0,1,3,2] row_mask:0xf bank_mask:0xf
    v_xor_b32_dpp v69, v65, v45 quad_perm:[0,1,3,2] row_mask:0xf bank_mask:0xf
    v_xor_b32_dpp v70, v66, v45 quad_perm:[0,1,3,2] row_mask:0xf bank_mask:0xf
    v_xor_b32_dpp v71, v67, v45 quad_perm:[0,1,3,2] row_mask:0xf bank_mask:0xf
    v_accvgpr_write_b32 a228, v68
    v_accvgpr_write_b32 a229, v69
    v_accvgpr_write_b32 a230, v70
    v_accvgpr_write_b32 a231, v71
    v_fract_f32 v48, v30
    v_add_f32 v49, v48, v32
    v_cos_f32 v56, v48
    v_add_f32 v50, v49, v34
    v_cos_f32 v57, v49
    v_add_f32 v51, v50, v32
    v_cos_f32 v58, v50
    v_add_f32 v52, v51, v34
    v_cos_f32 v59, v51
    v_add_f32 v53, v52, v32
    v_cos_f32 v60, v52
    v_add_f32 v54, v53, v34
    v_cos_f32 v61, v53
    v_add_f32 v55, v54, v32
    v_cos_f32 v62, v54
    v_cos_f32 v63, v55
    v_add_f32 v30, v48, v36
    v_cvt_pk_bf16_f32 v64, v56, v57
    v_cvt_pk_bf16_f32 v65, v58, v59
    v_cvt_pk_bf16_f32 v66, v60, v61
    v_cvt_pk_bf16_f32 v67, v62, v63
    v_accvgpr_write_b32 a40, v64
    v_accvgpr_write_b32 a41, v65
    v_accvgpr_write_b32 a42, v66
    v_accvgpr_write_b32 a43, v67
    v_xor_b32_dpp v68, v64, v40 quad_perm:[0,1,3,2] row_mask:0xf bank_mask:0xf
    v_xor_b32_dpp v69, v65, v40 quad_perm:[0,1,3,2] row_mask:0xf bank_mask:0xf
    v_xor_b32_dpp v70, v66, v40 quad_perm:[0,1,3,2] row_mask:0xf bank_mask:0xf
    v_xor_b32_dpp v71, v67, v40 quad_perm:[0,1,3,2] row_mask:0xf bank_mask:0xf
    v_accvgpr_write_b32 a104, v68
    v_accvgpr_write_b32 a105, v69
    v_accvgpr_write_b32 a106, v70
    v_accvgpr_write_b32 a107, v71
    v_xor_b32 v68, v64, v42
    v_xor_b32 v69, v65, v42
    v_xor_b32 v70, v66, v42
    v_xor_b32 v71, v67, v42
    v_accvgpr_write_b32 a168, v68
    v_accvgpr_write_b32 a169, v69
    v_accvgpr_write_b32 a170, v70
    v_accvgpr_write_b32 a171, v71
    v_xor_b32_dpp v68, v64, v44 quad_perm:[0,1,3,2] row_mask:0xf bank_mask:0xf
    v_xor_b32_dpp v69, v65, v44 quad_perm:[0,1,3,2] row_mask:0xf bank_mask:0xf
    v_xor_b32_dpp v70, v66, v44 quad_perm:[0,1,3,2] row_mask:0xf bank_mask:0xf
    v_xor_b32_dpp v71, v67, v44 quad_perm:[0,1,3,2] row_mask:0xf bank_mask:0xf
    v_accvgpr_write_b32 a232, v68
    v_accvgpr_write_b32 a233, v69
    v_accvgpr_write_b32 a234, v70
    v_accvgpr_write_b32 a235, v71
    v_fract_f32 v48, v31
    v_add_f32 v49, v48, v33
    v_cos_f32 v56, v48
    v_add_f32 v50, v49, v35
    v_cos_f32 v57, v49
    v_add_f32 v51, v50, v33
    v_cos_f32 v58, v50
    v_add_f32 v52, v51, v35
    v_cos_f32 v59, v51
    v_add_f32 v53, v52, v33
    v_cos_f32 v60, v52
    v_add_f32 v54, v53, v35
    v_cos_f32 v61, v53
    v_add_f32 v55, v54, v33
    v_cos_f32 v62, v54
    v_cos_f32 v63, v55
    v_add_f32 v31, v48, v37
    v_cvt_pk_bf16_f32 v64, v56, v57
    v_cvt_pk_bf16_f32 v65, v58, v59
    v_cvt_pk_bf16_f32 v66, v60, v61
    v_cvt_pk_bf16_f32 v67, v62, v63
    v_accvgpr_write_b32 a44, v64
    v_accvgpr_write_b32 a45, v65
    v_accvgpr_write_b32 a46, v66
    v_accvgpr_write_b32 a47, v67
    v_xor_b32_dpp v68, v64, v41 quad_perm:[0,1,3,2] row_mask:0xf bank_mask:0xf
    v_xor_b32_dpp v69, v65, v41 quad_perm:[0,1,3,2] row_mask:0xf bank_mask:0xf
    v_xor_b32_dpp v70, v66, v41 quad_perm:[0,1,3,2] row_mask:0xf bank_mask:0xf
    v_xor_b32_dpp v71, v67, v41 quad_perm:[0,1,3,2] row_mask:0xf bank_mask:0xf
    v_accvgpr_write_b32 a108, v68
    v_accvgpr_write_b32 a109, v69
    v_accvgpr_write_b32 a110, v70
    v_accvgpr_write_b32 a111, v71
    v_xor_b32 v68, v64, v43
    v_xor_b32 v69, v65, v43
    v_xor_b32 v70, v66, v43
    v_xor_b32 v71, v67, v43
    v_accvgpr_write_b32 a172, v68
    v_accvgpr_write_b32 a173, v69
    v_accvgpr_write_b32 a174, v70
    v_accvgpr_write_b32 a175, v71
    v_xor_b32_dpp v68, v64, v45 quad_perm:[0,1,3,2] row_mask:0xf bank_mask:0xf
    v_xor_b32_dpp v69, v65, v45 quad_perm:[0,1,3,2] row_mask:0xf bank_mask:0xf
    v_xor_b32_dpp v70, v66, v45 quad_perm:[0,1,3,2] row_mask:0xf bank_mask:0xf
    v_xor_b32_dpp v71, v67, v45 quad_perm:[0,1,3,2] row_mask:0xf bank_mask:0xf
    v_accvgpr_write_b32 a236, v68
    v_accvgpr_write_b32 a237, v69
    v_accvgpr_write_b32 a238, v70
    v_accvgpr_write_b32 a239, v71
    v_fract_f32 v48, v30
    v_add_f32 v49, v48, v32
    v_cos_f32 v56, v48
    v_add_f32 v50, v49, v34
    v_cos_f32 v57, v49
    v_add_f32 v51, v50, v32
    v_cos_f32 v58, v50
    v_add_f32 v52, v51, v34
    v_cos_f32 v59, v51
    v_add_f32 v53, v52, v32
    v_cos_f32 v60, v52
    v_add_f32 v54, v53, v34
    v_cos_f32 v61, v53
    v_add_f32 v55, v54, v32
    v_cos_f32 v62, v54
    v_cos_f32 v63, v55
    v_add_f32 v30, v48, v36
    v_cvt_pk_bf16_f32 v64, v56, v57
    v_cvt_pk_bf16_f32 v65, v58, v59
    v_cvt_pk_bf16_f32 v66, v60, v61
    v_cvt_pk_bf16_f32 v67, v62, v63
    v_accvgpr_write_b32 a48, v64
    v_accvgpr_write_b32 a49, v65
    v_accvgpr_write_b32 a50, v66
    v_accvgpr_write_b32 a51, v67
    v_xor_b32_dpp v68, v64, v40 quad_perm:[0,1,3,2] row_mask:0xf bank_mask:0xf
    v_xor_b32_dpp v69, v65, v40 quad_perm:[0,1,3,2] row_mask:0xf bank_mask:0xf
    v_xor_b32_dpp v70, v66, v40 quad_perm:[0,1,3,2] row_mask:0xf bank_mask:0xf
    v_xor_b32_dpp v71, v67, v40 quad_perm:[0,1,3,2] row_mask:0xf bank_mask:0xf
    v_accvgpr_write_b32 a112, v68
    v_accvgpr_write_b32 a113, v69
    v_accvgpr_write_b32 a114, v70
    v_accvgpr_write_b32 a115, v71
    v_xor_b32 v68, v64, v42
    v_xor_b32 v69, v65, v42
    v_xor_b32 v70, v66, v42
    v_xor_b32 v71, v67, v42
    v_accvgpr_write_b32 a176, v68
    v_accvgpr_write_b32 a177, v69
    v_accvgpr_write_b32 a178, v70
    v_accvgpr_write_b32 a179, v71
    v_xor_b32_dpp v68, v64, v44 quad_perm:[0,1,3,2] row_mask:0xf bank_mask:0xf
    v_xor_b32_dpp v69, v65, v44 quad_perm:[0,1,3,2] row_mask:0xf bank_mask:0xf
    v_xor_b32_dpp v70, v66, v44 quad_perm:[0,1,3,2] row_mask:0xf bank_mask:0xf
    v_xor_b32_dpp v71, v67, v44 quad_perm:[0,1,3,2] row_mask:0xf bank_mask:0xf
    v_accvgpr_write_b32 a240, v68
    v_accvgpr_write_b32 a241, v69
    v_accvgpr_write_b32 a242, v70
    v_accvgpr_write_b32 a243, v71
    v_fract_f32 v48, v31
    v_add_f32 v49, v48, v33
    v_cos_f32 v56, v48
    v_add_f32 v50, v49, v35
    v_cos_f32 v57, v49
    v_add_f32 v51, v50, v33
    v_cos_f32 v58, v50
    v_add_f32 v52, v51, v35
    v_cos_f32 v59, v51
    v_add_f32 v53, v52, v33
    v_cos_f32 v60, v52
    v_add_f32 v54, v53, v35
    v_cos_f32 v61, v53
    v_add_f32 v55, v54, v33
    v_cos_f32 v62, v54
    v_cos_f32 v63, v55
    v_add_f32 v31, v48, v37
    v_cvt_pk_bf16_f32 v64, v56, v57
    v_cvt_pk_bf16_f32 v65, v58, v59
    v_cvt_pk_bf16_f32 v66, v60, v61
    v_cvt_pk_bf16_f32 v67, v62, v63
    v_accvgpr_write_b32 a52, v64
    v_accvgpr_write_b32 a53, v65
    v_accvgpr_write_b32 a54, v66
    v_accvgpr_write_b32 a55, v67
    v_xor_b32_dpp v68, v64, v41 quad_perm:[0,1,3,2] row_mask:0xf bank_mask:0xf
    v_xor_b32_dpp v69, v65, v41 quad_perm:[0,1,3,2] row_mask:0xf bank_mask:0xf
    v_xor_b32_dpp v70, v66, v41 quad_perm:[0,1,3,2] row_mask:0xf bank_mask:0xf
    v_xor_b32_dpp v71, v67, v41 quad_perm:[0,1,3,2] row_mask:0xf bank_mask:0xf
    v_accvgpr_write_b32 a116, v68
    v_accvgpr_write_b32 a117, v69
    v_accvgpr_write_b32 a118, v70
    v_accvgpr_write_b32 a119, v71
    v_xor_b32 v68, v64, v43
    v_xor_b32 v69, v65, v43
    v_xor_b32 v70, v66, v43
    v_xor_b32 v71, v67, v43
    v_accvgpr_write_b32 a180, v68
    v_accvgpr_write_b32 a181, v69
    v_accvgpr_write_b32 a182, v70
    v_accvgpr_write_b32 a183, v71
    v_xor_b32_dpp v68, v64, v45 quad_perm:[0,1,3,2] row_mask:0xf bank_mask:0xf
    v_xor_b32_dpp v69, v65, v45 quad_perm:[0,1,3,2] row_mask:0xf bank_mask:0xf
    v_xor_b32_dpp v70, v66, v45 quad_perm:[0,1,3,2] row_mask:0xf bank_mask:0xf
    v_xor_b32_dpp v71, v67, v45 quad_perm:[0,1,3,2] row_mask:0xf bank_mask:0xf
    v_accvgpr_write_b32 a244, v68
    v_accvgpr_write_b32 a245, v69
    v_accvgpr_write_b32 a246, v70
    v_accvgpr_write_b32 a247, v71
    v_fract_f32 v48, v30
    v_add_f32 v49, v48, v32
    v_cos_f32 v56, v48
    v_add_f32 v50, v49, v34
    v_cos_f32 v57, v49
    v_add_f32 v51, v50, v32
    v_cos_f32 v58, v50
    v_add_f32 v52, v51, v34
    v_cos_f32 v59, v51
    v_add_f32 v53, v52, v32
    v_cos_f32 v60, v52
    v_add_f32 v54, v53, v34
    v_cos_f32 v61, v53
    v_add_f32 v55, v54, v32
    v_cos_f32 v62, v54
    v_cos_f32 v63, v55
    v_add_f32 v30, v48, v36
    v_cvt_pk_bf16_f32 v64, v56, v57
    v_cvt_pk_bf16_f32 v65, v58, v59
    v_cvt_pk_bf16_f32 v66, v60, v61
    v_cvt_pk_bf16_f32 v67, v62, v63
    v_accvgpr_write_b32 a56, v64
    v_accvgpr_write_b32 a57, v65
    v_accvgpr_write_b32 a58, v66
    v_accvgpr_write_b32 a59, v67
    v_xor_b32_dpp v68, v64, v40 quad_perm:[0,1,3,2] row_mask:0xf bank_mask:0xf
    v_xor_b32_dpp v69, v65, v40 quad_perm:[0,1,3,2] row_mask:0xf bank_mask:0xf
    v_xor_b32_dpp v70, v66, v40 quad_perm:[0,1,3,2] row_mask:0xf bank_mask:0xf
    v_xor_b32_dpp v71, v67, v40 quad_perm:[0,1,3,2] row_mask:0xf bank_mask:0xf
    v_accvgpr_write_b32 a120, v68
    v_accvgpr_write_b32 a121, v69
    v_accvgpr_write_b32 a122, v70
    v_accvgpr_write_b32 a123, v71
    v_xor_b32 v68, v64, v42
    v_xor_b32 v69, v65, v42
    v_xor_b32 v70, v66, v42
    v_xor_b32 v71, v67, v42
    v_accvgpr_write_b32 a184, v68
    v_accvgpr_write_b32 a185, v69
    v_accvgpr_write_b32 a186, v70
    v_accvgpr_write_b32 a187, v71
    v_xor_b32_dpp v68, v64, v44 quad_perm:[0,1,3,2] row_mask:0xf bank_mask:0xf
    v_xor_b32_dpp v69, v65, v44 quad_perm:[0,1,3,2] row_mask:0xf bank_mask:0xf
    v_xor_b32_dpp v70, v66, v44 quad_perm:[0,1,3,2] row_mask:0xf bank_mask:0xf
    v_xor_b32_dpp v71, v67, v44 quad_perm:[0,1,3,2] row_mask:0xf bank_mask:0xf
    v_accvgpr_write_b32 a248, v68
    v_accvgpr_write_b32 a249, v69
    v_accvgpr_write_b32 a250, v70
    v_accvgpr_write_b32 a251, v71
    v_fract_f32 v48, v31
    v_add_f32 v49, v48, v33
    v_cos_f32 v56, v48
    v_add_f32 v50, v49, v35
    v_cos_f32 v57, v49
    v_add_f32 v51, v50, v33
    v_cos_f32 v58, v50
    v_add_f32 v52, v51, v35
    v_cos_f32 v59, v51
    v_add_f32 v53, v52, v33
    v_cos_f32 v60, v52
    v_add_f32 v54, v53, v35
    v_cos_f32 v61, v53
    v_add_f32 v55, v54, v33
    v_cos_f32 v62, v54
    v_cos_f32 v63, v55
    v_add_f32 v31, v48, v37
    v_cvt_pk_bf16_f32 v64, v56, v57
    v_cvt_pk_bf16_f32 v65, v58, v59
    v_cvt_pk_bf16_f32 v66, v60, v61
    v_cvt_pk_bf16_f32 v67, v62, v63
    v_accvgpr_write_b32 a60, v64
    v_accvgpr_write_b32 a61, v65
    v_accvgpr_write_b32 a62, v66
    v_accvgpr_write_b32 a63, v67
    v_xor_b32_dpp v68, v64, v41 quad_perm:[0,1,3,2] row_mask:0xf bank_mask:0xf
    v_xor_b32_dpp v69, v65, v41 quad_perm:[0,1,3,2] row_mask:0xf bank_mask:0xf
    v_xor_b32_dpp v70, v66, v41 quad_perm:[0,1,3,2] row_mask:0xf bank_mask:0xf
    v_xor_b32_dpp v71, v67, v41 quad_perm:[0,1,3,2] row_mask:0xf bank_mask:0xf
    v_accvgpr_write_b32 a124, v68
    v_accvgpr_write_b32 a125, v69
    v_accvgpr_write_b32 a126, v70
    v_accvgpr_write_b32 a127, v71
    v_xor_b32 v68, v64, v43
    v_xor_b32 v69, v65, v43
    v_xor_b32 v70, v66, v43
    v_xor_b32 v71, v67, v43
    v_accvgpr_write_b32 a188, v68
    v_accvgpr_write_b32 a189, v69
    v_accvgpr_write_b32 a190, v70
    v_accvgpr_write_b32 a191, v71
    v_xor_b32_dpp v68, v64, v45 quad_perm:[0,1,3,2] row_mask:0xf bank_mask:0xf
    v_xor_b32_dpp v69, v65, v45 quad_perm:[0,1,3,2] row_mask:0xf bank_mask:0xf
    v_xor_b32_dpp v70, v66, v45 quad_perm:[0,1,3,2] row_mask:0xf bank_mask:0xf
    v_xor_b32_dpp v71, v67, v45 quad_perm:[0,1,3,2] row_mask:0xf bank_mask:0xf
    v_accvgpr_write_b32 a252, v68
    v_accvgpr_write_b32 a253, v69
    v_accvgpr_write_b32 a254, v70
    v_accvgpr_write_b32 a255, v71
    s_and_b32 s17, s28, 1
    s_lshl_b32 s17, s17, 15
    s_lshr_b32 s18, s28, 1
    s_lshl_b32 s18, s18, 21
    s_add_u32 s17, s17, s18
    s_lshl_b32 s18, s29, 16
    s_add_u32 s17, s17, s18
    v_lshlrev_b32 v15, 7, v1
    s_waitcnt lgkmcnt(0)
    buffer_load_dword v248, v15, s[40:43], s17 offen
    s_add_u32 s17, s17, 8192
    buffer_load_dword v249, v15, s[40:43], s17 offen
    s_add_u32 s17, s17, 8192
    buffer_load_dword v250, v15, s[40:43], s17 offen
    s_add_u32 s17, s17, 8192
    buffer_load_dword v251, v15, s[40:43], s17 offen
    s_add_u32 s17, s17, 8192
    s_lshl_b32 s34, s93, 2
    s_add_u32 s34, s34, s16
    s_lshl_b32 s34, s34, 13
    s_sub_u32 s34, s34, 262144
    v_mov_b32 v247, v15
    s_lshl_b32 s17, s29, 6
    v_add_u32 v246, s17, v1
    v_mul_u32_u24 v246, 1026, v246
    s_lshl_b32 s17, s28, 8
    v_add_u32 v246, s17, v246
    v_and_b32 v246, -4, v246
    s_load_dwordx2 s[8:9], s[0:1], 0
    s_mov_b32 s10, 4194304
    s_mov_b32 s11, 0x20000
    s_waitcnt lgkmcnt(0)
    v_and_b32 v5, 15, v1
    v_bfe_u32 v6, v1, 1, 3
    v_lshrrev_b32 v7, 4, v1
    v_xor_b32 v6, v6, v7
    v_lshlrev_b32 v6, 4, v6
    v_lshl_add_u32 v10, v5, 7, v6
    s_lshl_b32 s19, s16, 10
    v_xor_b32 v11, 64, v10
    v_add_u32 v12, 0x10000, v10
    v_add_u32 v13, 0x10000, v11
    v_lshrrev_b32 v7, 3, v1
    s_lshl_b32 s17, s16, 3
    v_add_u32 v7, s17, v7
    v_bfe_u32 v8, v7, 1, 3
    v_xor_b32 v8, v8, v1
    v_and_b32 v8, 7, v8
    v_bfe_u32 v5, v7, 2, 2
    v_and_b32 v2, 3, v7
    v_lshl_add_u32 v2, v5, 3, v2
    v_bfe_u32 v5, v7, 4, 1
    v_lshl_add_u32 v2, v5, 2, v2
    v_bfe_u32 v5, v1, 2, 2
    v_and_b32 v3, 3, v1
    v_lshl_add_u32 v3, v5, 3, v3
    v_lshlrev_b32 v2, 16, v2
    v_lshl_add_u32 v2, v8, 4, v2
    v_and_b32 v5, 48, v1
    v_lshl_add_u32 v3, v3, 6, v5
    s_mul_i32 s21, s29, 139776
    s_mul_i32 s17, s28, 34816
    s_add_u32 s21, s21, s17
    s_add_u32 s21, s21, 104857600
    s_and_b32 s20, s28, 1
    s_lshl_b32 s20, s20, 15
    s_lshr_b32 s17, s28, 1
    s_lshl_b32 s17, s17, 21
    s_add_u32 s20, s20, s17
    s_mov_b32 s24, 2048
    s_mov_b32 s25, 2176
    s_barrier
    s_mov_b32 s26, s25
    s_sub_u32 s25, s21, 1073741824
    s_mov_b32 s21, 1073741824
    s_mov_b32 s23, 0
    s_mov_b32 s22, 0
    s_add_u32 m0, s19, 0
    s_nop 0
    buffer_load_dwordx4 v2, s[8:11], s20 offen offset:0 lds
    s_add_u32 m0, s19, 3968
    s_nop 0
    buffer_load_dwordx4 v2, s[8:11], s20 offen offset:128 lds
    s_add_u32 m0, s19, 7936
    s_nop 0
    buffer_load_dwordx4 v2, s[8:11], s20 offen offset:256 lds
    s_add_u32 m0, s19, 11904
    s_nop 0
    buffer_load_dwordx4 v2, s[8:11], s20 offen offset:384 lds
    s_add_u32 m0, s19, 15872
    s_nop 0
    buffer_load_dwordx4 v2, s[8:11], s20 offen offset:512 lds
    s_add_u32 m0, s19, 19840
    s_nop 0
    buffer_load_dwordx4 v2, s[8:11], s20 offen offset:640 lds
    s_add_u32 m0, s19, 23808
    s_nop 0
    buffer_load_dwordx4 v2, s[8:11], s20 offen offset:768 lds
    s_add_u32 m0, s19, 27776
    s_nop 0
    buffer_load_dwordx4 v2, s[8:11], s20 offen offset:896 lds
    s_add_u32 m0, s19, 31744
    s_nop 0
    buffer_load_dwordx4 v2, s[8:11], s20 offen offset:1024 lds
    s_add_u32 m0, s19, 35712
    s_nop 0
    buffer_load_dwordx4 v2, s[8:11], s20 offen offset:1152 lds
    s_add_u32 m0, s19, 39680
    s_nop 0
    buffer_load_dwordx4 v2, s[8:11], s20 offen offset:1280 lds
    s_add_u32 m0, s19, 43648
    s_nop 0
    buffer_load_dwordx4 v2, s[8:11], s20 offen offset:1408 lds
    s_add_u32 m0, s19, 47616
    s_nop 0
    buffer_load_dwordx4 v2, s[8:11], s20 offen offset:1536 lds
    s_add_u32 m0, s19, 51584
    s_nop 0
    buffer_load_dwordx4 v2, s[8:11], s20 offen offset:1664 lds
    s_add_u32 m0, s19, 55552
    s_nop 0
    buffer_load_dwordx4 v2, s[8:11], s20 offen offset:1792 lds
    s_add_u32 m0, s19, 59520
    s_nop 0
    buffer_load_dwordx4 v2, s[8:11], s20 offen offset:1920 lds
    s_add_u32 s20, s20, s24
    s_add_u32 m0, s19, 65536
    s_nop 0
    buffer_load_dwordx4 v2, s[8:11], s20 offen offset:0 lds
    s_add_u32 m0, s19, 69504
    s_nop 0
    buffer_load_dwordx4 v2, s[8:11], s20 offen offset:128 lds
    s_add_u32 m0, s19, 73472
    s_nop 0
    buffer_load_dwordx4 v2, s[8:11], s20 offen offset:256 lds
    s_waitcnt vmcnt(11)
    s_barrier
    ds_read_b128 v[20:23], v10 offset:0
    ds_read_b128 v[24:27], v10 offset:2048
    ds_read_b128 v[28:31], v11 offset:0
    ds_read_b128 v[32:35], v11 offset:2048
    ds_read_b128 v[36:39], v10 offset:4096
    ds_read_b128 v[40:43], v10 offset:6144
    ds_read_b128 v[44:47], v11 offset:4096
.p2align 6
F1_top:
    s_waitcnt lgkmcnt(6)
    v_mfma_f32_16x16x32_bf16 v[52:55], v[20:23], a[0:3], 0
    ds_read_b128 v[48:51], v11 offset:6144
    v_mfma_f32_16x16x32_bf16 v[60:63], v[20:23], a[4:7], 0
    s_waitcnt lgkmcnt(6)
    v_mfma_f32_16x16x32_bf16 v[56:59], v[24:27], a[0:3], 0
    ds_read_b128 v[20:23], v10 offset:8192
    s_add_u32 m0, s19, 77440
    v_mfma_f32_16x16x32_bf16 v[64:67], v[24:27], a[4:7], 0
    buffer_load_dwordx4 v2, s[8:11], s20 offen offset:384 lds
    s_waitcnt lgkmcnt(6)
    v_mfma_f32_16x16x32_bf16 v[52:55], v[28:31], a[8:11], v[52:55]
    ds_read_b128 v[24:27], v10 offset:10240
    v_mfma_f32_16x16x32_bf16 v[60:63], v[28:31], a[12:15], v[60:63]
    s_waitcnt lgkmcnt(6)
    v_mfma_f32_16x16x32_bf16 v[56:59], v[32:35], a[8:11], v[56:59]
    ds_read_b128 v[28:31], v11 offset:8192
    s_add_u32 m0, s19, 81408
    v_mfma_f32_16x16x32_bf16 v[64:67], v[32:35], a[12:15], v[64:67]
    buffer_load_dwordx4 v2, s[8:11], s20 offen offset:512 lds
    s_waitcnt lgkmcnt(6)
    v_mfma_f32_16x16x32_bf16 v[52:55], v[36:39], a[16:19], v[52:55]
    ds_read_b128 v[32:35], v11 offset:10240
    v_mfma_f32_16x16x32_bf16 v[60:63], v[36:39], a[20:23], v[60:63]
    s_waitcnt lgkmcnt(6)
    v_mfma_f32_16x16x32_bf16 v[56:59], v[40:43], a[16:19], v[56:59]
    ds_read_b128 v[36:39], v10 offset:12288
    s_add_u32 m0, s19, 85376
    v_mfma_f32_16x16x32_bf16 v[64:67], v[40:43], a[20:23], v[64:67]
    buffer_load_dwordx4 v2, s[8:11], s20 offen offset:640 lds
    s_waitcnt lgkmcnt(6)
    v_mfma_f32_16x16x32_bf16 v[52:55], v[44:47], a[24:27], v[52:55]
    ds_read_b128 v[40:43], v10 offset:14336
    v_mfma_f32_16x16x32_bf16 v[60:63], v[44:47], a[28:31], v[60:63]
    s_waitcnt lgkmcnt(6)
    v_mfma_f32_16x16x32_bf16 v[56:59], v[48:51], a[24:27], v[56:59]
    ds_read_b128 v[44:47], v11 offset:12288
    s_add_u32 m0, s19, 89344
    v_mfma_f32_16x16x32_bf16 v[64:67], v[48:51], a[28:31], v[64:67]
    buffer_load_dwordx4 v2, s[8:11], s20 offen offset:768 lds
    s_waitcnt lgkmcnt(6)
    v_mfma_f32_16x16x32_bf16 v[52:55], v[20:23], a[32:35], v[52:55]
    ds_read_b128 v[48:51], v11 offset:14336
    v_mfma_f32_16x16x32_bf16 v[60:63], v[20:23], a[36:39], v[60:63]
    s_waitcnt lgkmcnt(6)
    v_mfma_f32_16x16x32_bf16 v[56:59], v[24:27], a[32:35], v[56:59]
    ds_read_b128 v[20:23], v10 offset:16384
    s_add_u32 m0, s19, 93312
    v_mfma_f32_16x16x32_bf16 v[64:67], v[24:27], a[36:39], v[64:67]
    buffer_load_dwordx4 v2, s[8:11], s20 offen offset:896 lds
    s_waitcnt lgkmcnt(6)
    v_mfma_f32_16x16x32_bf16 v[52:55], v[28:31], a[40:43], v[52:55]
    ds_read_b128 v[24:27], v10 offset:18432
    v_mfma_f32_16x16x32_bf16 v[60:63], v[28:31], a[44:47], v[60:63]
    v_cvt_pk_bf16_f32 v84, v68, v69
    s_waitcnt lgkmcnt(6)
    v_mfma_f32_16x16x32_bf16 v[56:59], v[32:35], a[40:43], v[56:59]
    ds_read_b128 v[28:31], v11 offset:16384
    v_mfma_f32_16x16x32_bf16 v[64:67], v[32:35], a[44:47], v[64:67]
    v_cvt_pk_bf16_f32 v85, v70, v71
    s_waitcnt lgkmcnt(6)
    v_mfma_f32_16x16x32_bf16 v[52:55], v[36:39], a[48:51], v[52:55]
    ds_read_b128 v[32:35], v11 offset:18432
    v_mfma_f32_16x16x32_bf16 v[60:63], v[36:39], a[52:55], v[60:63]
    v_cvt_pk_bf16_f32 v86, v72, v73
    s_waitcnt lgkmcnt(6)
    v_mfma_f32_16x16x32_bf16 v[56:59], v[40:43], a[48:51], v[56:59]
    ds_read_b128 v[36:39], v10 offset:20480
    v_mfma_f32_16x16x32_bf16 v[64:67], v[40:43], a[52:55], v[64:67]
    v_cvt_pk_bf16_f32 v87, v74, v75
    s_waitcnt lgkmcnt(6)
    v_mfma_f32_16x16x32_bf16 v[52:55], v[44:47], a[56:59], v[52:55]
    ds_read_b128 v[40:43], v10 offset:22528
    v_mfma_f32_16x16x32_bf16 v[60:63], v[44:47], a[60:63], v[60:63]
    v_cvt_pk_bf16_f32 v88, v76, v77
    s_waitcnt lgkmcnt(6)
    v_mfma_f32_16x16x32_bf16 v[56:59], v[48:51], a[56:59], v[56:59]
    ds_read_b128 v[44:47], v11 offset:20480
    v_mfma_f32_16x16x32_bf16 v[64:67], v[48:51], a[60:63], v[64:67]
    v_cvt_pk_bf16_f32 v89, v78, v79
    buffer_store_dwordx4 v[84:87], v3, s[4:7], s21 offen offset:0 sc1
    s_waitcnt lgkmcnt(6)
    v_mfma_f32_16x16x32_bf16 v[52:55], v[20:23], a[64:67], v[52:55]
    ds_read_b128 v[48:51], v11 offset:22528
    v_mfma_f32_16x16x32_bf16 v[60:63], v[20:23], a[68:71], v[60:63]
    v_cvt_pk_bf16_f32 v90, v80, v81
    s_waitcnt lgkmcnt(6)
    v_mfma_f32_16x16x32_bf16 v[56:59], v[24:27], a[64:67], v[56:59]
    ds_read_b128 v[20:23], v10 offset:24576
    v_mfma_f32_16x16x32_bf16 v[64:67], v[24:27], a[68:71], v[64:67]
    v_cvt_pk_bf16_f32 v91, v82, v83
    s_waitcnt lgkmcnt(6)
    v_mfma_f32_16x16x32_bf16 v[52:55], v[28:31], a[72:75], v[52:55]
    ds_read_b128 v[24:27], v10 offset:26624
    v_mfma_f32_16x16x32_bf16 v[60:63], v[28:31], a[76:79], v[60:63]
    s_waitcnt lgkmcnt(6)
    v_mfma_f32_16x16x32_bf16 v[56:59], v[32:35], a[72:75], v[56:59]
    ds_read_b128 v[28:31], v11 offset:24576
    v_mfma_f32_16x16x32_bf16 v[64:67], v[32:35], a[76:79], v[64:67]
    buffer_store_dwordx4 v[88:91], v3, s[4:7], s21 offen offset:256 sc1
    s_waitcnt lgkmcnt(6)
    v_mfma_f32_16x16x32_bf16 v[52:55], v[36:39], a[80:83], v[52:55]
    ds_read_b128 v[32:35], v11 offset:26624
    v_mfma_f32_16x16x32_bf16 v[60:63], v[36:39], a[84:87], v[60:63]
    s_add_u32 s21, s21, s25
    s_mov_b32 s25, s26
    s_waitcnt lgkmcnt(6)
    v_mfma_f32_16x16x32_bf16 v[56:59], v[40:43], a[80:83], v[56:59]
    ds_read_b128 v[36:39], v10 offset:28672
    v_mfma_f32_16x16x32_bf16 v[64:67], v[40:43], a[84:87], v[64:67]
    s_waitcnt lgkmcnt(6)
    v_mfma_f32_16x16x32_bf16 v[52:55], v[44:47], a[88:91], v[52:55]
    ds_read_b128 v[40:43], v10 offset:30720
    v_mfma_f32_16x16x32_bf16 v[60:63], v[44:47], a[92:95], v[60:63]
    buffer_load_dword v248, v247, s[44:47], s34 offen
    s_add_u32 s34, s34, 1048576
    s_sub_u32 s31, s22, 10
    s_lshl_b32 s31, s31, 6
    s_cmp_lt_u32 s31, 384
    s_cselect_b32 s31, s31, 1073741824
    buffer_load_dword v249, v246, s[48:51], s31 offen
    buffer_load_dword v250, v246, s[52:55], s31 offen
    s_waitcnt lgkmcnt(6)
    v_mfma_f32_16x16x32_bf16 v[56:59], v[48:51], a[88:91], v[56:59]
    ds_read_b128 v[44:47], v11 offset:28672
    v_mfma_f32_16x16x32_bf16 v[64:67], v[48:51], a[92:95], v[64:67]
    s_waitcnt lgkmcnt(6)
    v_mfma_f32_16x16x32_bf16 v[52:55], v[20:23], a[96:99], v[52:55]
    ds_read_b128 v[48:51], v11 offset:30720
    v_mfma_f32_16x16x32_bf16 v[60:63], v[20:23], a[100:103], v[60:63]
    s_waitcnt lgkmcnt(6)
    v_mfma_f32_16x16x32_bf16 v[56:59], v[24:27], a[96:99], v[56:59]
    s_waitcnt vmcnt(13)
    s_barrier
    ds_read_b128 v[20:23], v10 offset:32768
    v_mfma_f32_16x16x32_bf16 v[64:67], v[24:27], a[100:103], v[64:67]
    s_waitcnt lgkmcnt(6)
    v_mfma_f32_16x16x32_bf16 v[52:55], v[28:31], a[104:107], v[52:55]
    ds_read_b128 v[24:27], v10 offset:34816
    s_add_u32 m0, s19, 97280
    v_mfma_f32_16x16x32_bf16 v[60:63], v[28:31], a[108:111], v[60:63]
    buffer_load_dwordx4 v2, s[8:11], s20 offen offset:1024 lds
    s_waitcnt lgkmcnt(6)
    v_mfma_f32_16x16x32_bf16 v[56:59], v[32:35], a[104:107], v[56:59]
    ds_read_b128 v[28:31], v11 offset:32768
    v_mfma_f32_16x16x32_bf16 v[64:67], v[32:35], a[108:111], v[64:67]
    s_waitcnt lgkmcnt(6)
    v_mfma_f32_16x16x32_bf16 v[52:55], v[36:39], a[112:115], v[52:55]
    ds_read_b128 v[32:35], v11 offset:34816
    s_add_u32 m0, s19, 101248
    v_mfma_f32_16x16x32_bf16 v[60:63], v[36:39], a[116:119], v[60:63]
    buffer_load_dwordx4 v2, s[8:11], s20 offen offset:1152 lds
    s_waitcnt lgkmcnt(6)
    v_mfma_f32_16x16x32_bf16 v[56:59], v[40:43], a[112:115], v[56:59]
    ds_read_b128 v[36:39], v10 offset:36864
    v_mfma_f32_16x16x32_bf16 v[64:67], v[40:43], a[116:119], v[64:67]
    s_waitcnt lgkmcnt(6)
    v_mfma_f32_16x16x32_bf16 v[52:55], v[44:47], a[120:123], v[52:55]
    ds_read_b128 v[40:43], v10 offset:38912
    s_add_u32 m0, s19, 105216
    v_mfma_f32_16x16x32_bf16 v[60:63], v[44:47], a[124:127], v[60:63]
    buffer_load_dwordx4 v2, s[8:11], s20 offen offset:1280 lds
    s_waitcnt lgkmcnt(6)
    v_mfma_f32_16x16x32_bf16 v[56:59], v[48:51], a[120:123], v[56:59]
    ds_read_b128 v[44:47], v11 offset:36864
    v_mfma_f32_16x16x32_bf16 v[64:67], v[48:51], a[124:127], v[64:67]
    s_waitcnt lgkmcnt(6)
    v_mfma_f32_16x16x32_bf16 v[52:55], v[20:23], a[128:131], v[52:55]
    ds_read_b128 v[48:51], v11 offset:38912
    v_mfma_f32_16x16x32_bf16 v[60:63], v[20:23], a[132:135], v[60:63]
    s_waitcnt lgkmcnt(6)
    v_mfma_f32_16x16x32_bf16 v[56:59], v[24:27], a[128:131], v[56:59]
    ds_read_b128 v[20:23], v10 offset:40960
    s_add_u32 m0, s19, 109184
    v_mfma_f32_16x16x32_bf16 v[64:67], v[24:27], a[132:135], v[64:67]
    buffer_load_dwordx4 v2, s[8:11], s20 offen offset:1408 lds
    s_waitcnt lgkmcnt(6)
    v_mfma_f32_16x16x32_bf16 v[52:55], v[28:31], a[136:139], v[52:55]
    ds_read_b128 v[24:27], v10 offset:43008
    v_mfma_f32_16x16x32_bf16 v[60:63], v[28:31], a[140:143], v[60:63]
    s_waitcnt lgkmcnt(6)
    v_mfma_f32_16x16x32_bf16 v[56:59], v[32:35], a[136:139], v[56:59]
    ds_read_b128 v[28:31], v11 offset:40960
    s_add_u32 m0, s19, 113152
    v_mfma_f32_16x16x32_bf16 v[64:67], v[32:35], a[140:143], v[64:67]
    buffer_load_dwordx4 v2, s[8:11], s20 offen offset:1536 lds
    s_waitcnt lgkmcnt(6)
    v_mfma_f32_16x16x32_bf16 v[52:55], v[36:39], a[144:147], v[52:55]
    ds_read_b128 v[32:35], v11 offset:43008
    v_mfma_f32_16x16x32_bf16 v[60:63], v[36:39], a[148:151], v[60:63]
    s_waitcnt lgkmcnt(6)
    v_mfma_f32_16x16x32_bf16 v[56:59], v[40:43], a[144:147], v[56:59]
    ds_read_b128 v[36:39], v10 offset:45056
    s_add_u32 m0, s19, 117120
    v_mfma_f32_16x16x32_bf16 v[64:67], v[40:43], a[148:151], v[64:67]
    buffer_load_dwordx4 v2, s[8:11], s20 offen offset:1664 lds
    s_waitcnt lgkmcnt(6)
    v_mfma_f32_16x16x32_bf16 v[52:55], v[44:47], a[152:155], v[52:55]
    ds_read_b128 v[40:43], v10 offset:47104
    v_mfma_f32_16x16x32_bf16 v[60:63], v[44:47], a[156:159], v[60:63]
    s_waitcnt lgkmcnt(6)
    v_mfma_f32_16x16x32_bf16 v[56:59], v[48:51], a[152:155], v[56:59]
    ds_read_b128 v[44:47], v11 offset:45056
    s_add_u32 m0, s19, 121088
    v_mfma_f32_16x16x32_bf16 v[64:67], v[48:51], a[156:159], v[64:67]
    buffer_load_dwordx4 v2, s[8:11], s20 offen offset:1792 lds
    s_waitcnt lgkmcnt(6)
    v_mfma_f32_16x16x32_bf16 v[52:55], v[20:23], a[160:163], v[52:55]
    ds_read_b128 v[48:51], v11 offset:47104
    v_mfma_f32_16x16x32_bf16 v[60:63], v[20:23], a[164:167], v[60:63]
    s_waitcnt lgkmcnt(6)
    v_mfma_f32_16x16x32_bf16 v[56:59], v[24:27], a[160:163], v[56:59]
    ds_read_b128 v[20:23], v10 offset:49152
    s_add_u32 m0, s19, 125056
    v_mfma_f32_16x16x32_bf16 v[64:67], v[24:27], a[164:167], v[64:67]
    buffer_load_dwordx4 v2, s[8:11], s20 offen offset:1920 lds
    s_waitcnt lgkmcnt(6)
    v_mfma_f32_16x16x32_bf16 v[52:55], v[28:31], a[168:171], v[52:55]
    ds_read_b128 v[24:27], v10 offset:51200
    v_mfma_f32_16x16x32_bf16 v[60:63], v[28:31], a[172:175], v[60:63]
    s_add_u32 s20, s20, s24
    s_waitcnt lgkmcnt(6)
    v_mfma_f32_16x16x32_bf16 v[56:59], v[32:35], a[168:171], v[56:59]
    ds_read_b128 v[28:31], v11 offset:49152
    v_mfma_f32_16x16x32_bf16 v[64:67], v[32:35], a[172:175], v[64:67]
    s_waitcnt lgkmcnt(6)
    v_mfma_f32_16x16x32_bf16 v[52:55], v[36:39], a[176:179], v[52:55]
    ds_read_b128 v[32:35], v11 offset:51200
    v_mfma_f32_16x16x32_bf16 v[60:63], v[36:39], a[180:183], v[60:63]
    s_waitcnt lgkmcnt(6)
    v_mfma_f32_16x16x32_bf16 v[56:59], v[40:43], a[176:179], v[56:59]
    ds_read_b128 v[36:39], v10 offset:53248
    v_mfma_f32_16x16x32_bf16 v[64:67], v[40:43], a[180:183], v[64:67]
    s_waitcnt lgkmcnt(6)
    v_mfma_f32_16x16x32_bf16 v[52:55], v[44:47], a[184:187], v[52:55]
    ds_read_b128 v[40:43], v10 offset:55296
    v_mfma_f32_16x16x32_bf16 v[60:63], v[44:47], a[188:191], v[60:63]
    s_waitcnt lgkmcnt(6)
    v_mfma_f32_16x16x32_bf16 v[56:59], v[48:51], a[184:187], v[56:59]
    ds_read_b128 v[44:47], v11 offset:53248
    v_mfma_f32_16x16x32_bf16 v[64:67], v[48:51], a[188:191], v[64:67]
    s_waitcnt lgkmcnt(6)
    v_mfma_f32_16x16x32_bf16 v[52:55], v[20:23], a[192:195], v[52:55]
    ds_read_b128 v[48:51], v11 offset:55296
    v_mfma_f32_16x16x32_bf16 v[60:63], v[20:23], a[196:199], v[60:63]
    s_waitcnt lgkmcnt(6)
    v_mfma_f32_16x16x32_bf16 v[56:59], v[24:27], a[192:195], v[56:59]
    ds_read_b128 v[20:23], v10 offset:57344
    v_mfma_f32_16x16x32_bf16 v[64:67], v[24:27], a[196:199], v[64:67]
    s_waitcnt lgkmcnt(6)
    v_mfma_f32_16x16x32_bf16 v[52:55], v[28:31], a[200:203], v[52:55]
    ds_read_b128 v[24:27], v10 offset:59392
    v_mfma_f32_16x16x32_bf16 v[60:63], v[28:31], a[204:207], v[60:63]
    s_waitcnt lgkmcnt(6)
    v_mfma_f32_16x16x32_bf16 v[56:59], v[32:35], a[200:203], v[56:59]
    ds_read_b128 v[28:31], v11 offset:57344
    v_mfma_f32_16x16x32_bf16 v[64:67], v[32:35], a[204:207], v[64:67]
    s_waitcnt lgkmcnt(6)
    v_mfma_f32_16x16x32_bf16 v[52:55], v[36:39], a[208:211], v[52:55]
    ds_read_b128 v[32:35], v11 offset:59392
    v_mfma_f32_16x16x32_bf16 v[60:63], v[36:39], a[212:215], v[60:63]
    s_waitcnt lgkmcnt(6)
    v_mfma_f32_16x16x32_bf16 v[56:59], v[40:43], a[208:211], v[56:59]
    ds_read_b128 v[36:39], v10 offset:61440
    v_mfma_f32_16x16x32_bf16 v[64:67], v[40:43], a[212:215], v[64:67]
    s_waitcnt lgkmcnt(6)
    v_mfma_f32_16x16x32_bf16 v[52:55], v[44:47], a[216:219], v[52:55]
    ds_read_b128 v[40:43], v10 offset:63488
    v_mfma_f32_16x16x32_bf16 v[60:63], v[44:47], a[220:223], v[60:63]
    s_waitcnt lgkmcnt(6)
    v_mfma_f32_16x16x32_bf16 v[56:59], v[48:51], a[216:219], v[56:59]
    ds_read_b128 v[44:47], v11 offset:61440
    v_mfma_f32_16x16x32_bf16 v[64:67], v[48:51], a[220:223], v[64:67]
    s_waitcnt lgkmcnt(6)
    v_mfma_f32_16x16x32_bf16 v[52:55], v[20:23], a[224:227], v[52:55]
    ds_read_b128 v[48:51], v11 offset:63488
    v_mfma_f32_16x16x32_bf16 v[60:63], v[20:23], a[228:231], v[60:63]
    s_waitcnt lgkmcnt(6)
    v_mfma_f32_16x16x32_bf16 v[56:59], v[24:27], a[224:227], v[56:59]
    s_waitcnt vmcnt(8)
    s_barrier
    ds_read_b128 v[20:23], v12 offset:0
    v_mfma_f32_16x16x32_bf16 v[64:67], v[24:27], a[228:231], v[64:67]
    s_waitcnt lgkmcnt(6)
    v_mfma_f32_16x16x32_bf16 v[52:55], v[28:31], a[232:235], v[52:55]
    ds_read_b128 v[24:27], v12 offset:2048
    s_add_u32 m0, s19, 0
    v_mfma_f32_16x16x32_bf16 v[60:63], v[28:31], a[236:239], v[60:63]
    buffer_load_dwordx4 v2, s[8:11], s20 offen offset:0 lds
    s_waitcnt lgkmcnt(6)
    v_mfma_f32_16x16x32_bf16 v[56:59], v[32:35], a[232:235], v[56:59]
    ds_read_b128 v[28:31], v13 offset:0
    v_mfma_f32_16x16x32_bf16 v[64:67], v[32:35], a[236:239], v[64:67]
    s_waitcnt lgkmcnt(6)
    v_mfma_f32_16x16x32_bf16 v[52:55], v[36:39], a[240:243], v[52:55]
    ds_read_b128 v[32:35], v13 offset:2048
    s_add_u32 m0, s19, 3968
    v_mfma_f32_16x16x32_bf16 v[60:63], v[36:39], a[244:247], v[60:63]
    buffer_load_dwordx4 v2, s[8:11], s20 offen offset:128 lds
    s_waitcnt lgkmcnt(6)
    v_mfma_f32_16x16x32_bf16 v[56:59], v[40:43], a[240:243], v[56:59]
    ds_read_b128 v[36:39], v12 offset:4096
    v_mfma_f32_16x16x32_bf16 v[64:67], v[40:43], a[244:247], v[64:67]
    s_waitcnt lgkmcnt(6)
    v_mfma_f32_16x16x32_bf16 v[52:55], v[44:47], a[248:251], v[52:55]
    ds_read_b128 v[40:43], v12 offset:6144
    s_add_u32 m0, s19, 7936
    v_mfma_f32_16x16x32_bf16 v[60:63], v[44:47], a[252:255], v[60:63]
    buffer_load_dwordx4 v2, s[8:11], s20 offen offset:256 lds
    s_waitcnt lgkmcnt(6)
    v_mfma_f32_16x16x32_bf16 v[56:59], v[48:51], a[248:251], v[56:59]
    ds_read_b128 v[44:47], v13 offset:4096
    v_mfma_f32_16x16x32_bf16 v[64:67], v[48:51], a[252:255], v[64:67]
    s_waitcnt lgkmcnt(6)
    v_mfma_f32_16x16x32_bf16 v[68:71], v[20:23], a[0:3], 0
    ds_read_b128 v[48:51], v13 offset:6144
    v_mfma_f32_16x16x32_bf16 v[76:79], v[20:23], a[4:7], 0
    s_waitcnt lgkmcnt(6)
    v_mfma_f32_16x16x32_bf16 v[72:75], v[24:27], a[0:3], 0
    ds_read_b128 v[20:23], v12 offset:8192
    s_add_u32 m0, s19, 11904
    v_mfma_f32_16x16x32_bf16 v[80:83], v[24:27], a[4:7], 0
    buffer_load_dwordx4 v2, s[8:11], s20 offen offset:384 lds
    s_waitcnt lgkmcnt(6)
    v_mfma_f32_16x16x32_bf16 v[68:71], v[28:31], a[8:11], v[68:71]
    ds_read_b128 v[24:27], v12 offset:10240
    v_mfma_f32_16x16x32_bf16 v[76:79], v[28:31], a[12:15], v[76:79]
    s_waitcnt lgkmcnt(6)
    v_mfma_f32_16x16x32_bf16 v[72:75], v[32:35], a[8:11], v[72:75]
    ds_read_b128 v[28:31], v13 offset:8192
    s_add_u32 m0, s19, 15872
    v_mfma_f32_16x16x32_bf16 v[80:83], v[32:35], a[12:15], v[80:83]
    buffer_load_dwordx4 v2, s[8:11], s20 offen offset:512 lds
    s_waitcnt lgkmcnt(6)
    v_mfma_f32_16x16x32_bf16 v[68:71], v[36:39], a[16:19], v[68:71]
    ds_read_b128 v[32:35], v13 offset:10240
    v_mfma_f32_16x16x32_bf16 v[76:79], v[36:39], a[20:23], v[76:79]
    s_waitcnt lgkmcnt(6)
    v_mfma_f32_16x16x32_bf16 v[72:75], v[40:43], a[16:19], v[72:75]
    ds_read_b128 v[36:39], v12 offset:12288
    s_add_u32 m0, s19, 19840
    v_mfma_f32_16x16x32_bf16 v[80:83], v[40:43], a[20:23], v[80:83]
    buffer_load_dwordx4 v2, s[8:11], s20 offen offset:640 lds
    s_waitcnt lgkmcnt(6)
    v_mfma_f32_16x16x32_bf16 v[68:71], v[44:47], a[24:27], v[68:71]
    ds_read_b128 v[40:43], v12 offset:14336
    v_mfma_f32_16x16x32_bf16 v[76:79], v[44:47], a[28:31], v[76:79]
    s_waitcnt lgkmcnt(6)
    v_mfma_f32_16x16x32_bf16 v[72:75], v[48:51], a[24:27], v[72:75]
    ds_read_b128 v[44:47], v13 offset:12288
    s_add_u32 m0, s19, 23808
    v_mfma_f32_16x16x32_bf16 v[80:83], v[48:51], a[28:31], v[80:83]
    buffer_load_dwordx4 v2, s[8:11], s20 offen offset:768 lds
    s_waitcnt lgkmcnt(6)
    v_mfma_f32_16x16x32_bf16 v[68:71], v[20:23], a[32:35], v[68:71]
    ds_read_b128 v[48:51], v13 offset:14336
    v_mfma_f32_16x16x32_bf16 v[76:79], v[20:23], a[36:39], v[76:79]
    s_waitcnt lgkmcnt(6)
    v_mfma_f32_16x16x32_bf16 v[72:75], v[24:27], a[32:35], v[72:75]
    ds_read_b128 v[20:23], v12 offset:16384
    s_add_u32 m0, s19, 27776
    v_mfma_f32_16x16x32_bf16 v[80:83], v[24:27], a[36:39], v[80:83]
    buffer_load_dwordx4 v2, s[8:11], s20 offen offset:896 lds
    s_waitcnt lgkmcnt(6)
    v_mfma_f32_16x16x32_bf16 v[68:71], v[28:31], a[40:43], v[68:71]
    ds_read_b128 v[24:27], v12 offset:18432
    v_mfma_f32_16x16x32_bf16 v[76:79], v[28:31], a[44:47], v[76:79]
    v_cvt_pk_bf16_f32 v84, v52, v53
    s_waitcnt lgkmcnt(6)
    v_mfma_f32_16x16x32_bf16 v[72:75], v[32:35], a[40:43], v[72:75]
    ds_read_b128 v[28:31], v13 offset:16384
    v_mfma_f32_16x16x32_bf16 v[80:83], v[32:35], a[44:47], v[80:83]
    v_cvt_pk_bf16_f32 v85, v54, v55
    s_waitcnt lgkmcnt(6)
    v_mfma_f32_16x16x32_bf16 v[68:71], v[36:39], a[48:51], v[68:71]
    ds_read_b128 v[32:35], v13 offset:18432
    v_mfma_f32_16x16x32_bf16 v[76:79], v[36:39], a[52:55], v[76:79]
    v_cvt_pk_bf16_f32 v86, v56, v57
    s_waitcnt lgkmcnt(6)
    v_mfma_f32_16x16x32_bf16 v[72:75], v[40:43], a[48:51], v[72:75]
    ds_read_b128 v[36:39], v12 offset:20480
    v_mfma_f32_16x16x32_bf16 v[80:83], v[40:43], a[52:55], v[80:83]
    v_cvt_pk_bf16_f32 v87, v58, v59
    s_waitcnt lgkmcnt(6)
    v_mfma_f32_16x16x32_bf16 v[68:71], v[44:47], a[56:59], v[68:71]
    ds_read_b128 v[40:43], v12 offset:22528
    v_mfma_f32_16x16x32_bf16 v[76:79], v[44:47], a[60:63], v[76:79]
    v_cvt_pk_bf16_f32 v88, v60, v61
    s_waitcnt lgkmcnt(6)
    v_mfma_f32_16x16x32_bf16 v[72:75], v[48:51], a[56:59], v[72:75]
    ds_read_b128 v[44:47], v13 offset:20480
    v_mfma_f32_16x16x32_bf16 v[80:83], v[48:51], a[60:63], v[80:83]
    v_cvt_pk_bf16_f32 v89, v62, v63
    buffer_store_dwordx4 v[84:87], v3, s[4:7], s21 offen offset:0 sc1
    s_waitcnt lgkmcnt(6)
    v_mfma_f32_16x16x32_bf16 v[68:71], v[20:23], a[64:67], v[68:71]
    ds_read_b128 v[48:51], v13 offset:22528
    v_mfma_f32_16x16x32_bf16 v[76:79], v[20:23], a[68:71], v[76:79]
    v_cvt_pk_bf16_f32 v90, v64, v65
    s_waitcnt lgkmcnt(6)
    v_mfma_f32_16x16x32_bf16 v[72:75], v[24:27], a[64:67], v[72:75]
    ds_read_b128 v[20:23], v12 offset:24576
    v_mfma_f32_16x16x32_bf16 v[80:83], v[24:27], a[68:71], v[80:83]
    v_cvt_pk_bf16_f32 v91, v66, v67
    s_waitcnt lgkmcnt(6)
    v_mfma_f32_16x16x32_bf16 v[68:71], v[28:31], a[72:75], v[68:71]
    ds_read_b128 v[24:27], v12 offset:26624
    v_mfma_f32_16x16x32_bf16 v[76:79], v[28:31], a[76:79], v[76:79]
    s_waitcnt lgkmcnt(6)
    v_mfma_f32_16x16x32_bf16 v[72:75], v[32:35], a[72:75], v[72:75]
    ds_read_b128 v[28:31], v13 offset:24576
    v_mfma_f32_16x16x32_bf16 v[80:83], v[32:35], a[76:79], v[80:83]
    buffer_store_dwordx4 v[88:91], v3, s[4:7], s21 offen offset:256 sc1
    s_waitcnt lgkmcnt(6)
    v_mfma_f32_16x16x32_bf16 v[68:71], v[36:39], a[80:83], v[68:71]
    ds_read_b128 v[32:35], v13 offset:26624
    v_mfma_f32_16x16x32_bf16 v[76:79], v[36:39], a[84:87], v[76:79]
    s_add_u32 s21, s21, s25
    s_mov_b32 s25, s26
    s_waitcnt lgkmcnt(6)
    v_mfma_f32_16x16x32_bf16 v[72:75], v[40:43], a[80:83], v[72:75]
    ds_read_b128 v[36:39], v12 offset:28672
    v_mfma_f32_16x16x32_bf16 v[80:83], v[40:43], a[84:87], v[80:83]
    s_waitcnt lgkmcnt(6)
    v_mfma_f32_16x16x32_bf16 v[68:71], v[44:47], a[88:91], v[68:71]
    ds_read_b128 v[40:43], v12 offset:30720
    v_mfma_f32_16x16x32_bf16 v[76:79], v[44:47], a[92:95], v[76:79]
    s_waitcnt lgkmcnt(6)
    v_mfma_f32_16x16x32_bf16 v[72:75], v[48:51], a[88:91], v[72:75]
    ds_read_b128 v[44:47], v13 offset:28672
    v_mfma_f32_16x16x32_bf16 v[80:83], v[48:51], a[92:95], v[80:83]
    s_waitcnt lgkmcnt(6)
    v_mfma_f32_16x16x32_bf16 v[68:71], v[20:23], a[96:99], v[68:71]
    ds_read_b128 v[48:51], v13 offset:30720
    v_mfma_f32_16x16x32_bf16 v[76:79], v[20:23], a[100:103], v[76:79]
    s_waitcnt lgkmcnt(6)
    v_mfma_f32_16x16x32_bf16 v[72:75], v[24:27], a[96:99], v[72:75]
    s_waitcnt vmcnt(10)
    s_barrier
    ds_read_b128 v[20:23], v12 offset:32768
    v_mfma_f32_16x16x32_bf16 v[80:83], v[24:27], a[100:103], v[80:83]
    s_waitcnt lgkmcnt(6)
    v_mfma_f32_16x16x32_bf16 v[68:71], v[28:31], a[104:107], v[68:71]
    ds_read_b128 v[24:27], v12 offset:34816
    s_add_u32 m0, s19, 31744
    v_mfma_f32_16x16x32_bf16 v[76:79], v[28:31], a[108:111], v[76:79]
    buffer_load_dwordx4 v2, s[8:11], s20 offen offset:1024 lds
    s_waitcnt lgkmcnt(6)
    v_mfma_f32_16x16x32_bf16 v[72:75], v[32:35], a[104:107], v[72:75]
    ds_read_b128 v[28:31], v13 offset:32768
    v_mfma_f32_16x16x32_bf16 v[80:83], v[32:35], a[108:111], v[80:83]
    s_waitcnt lgkmcnt(6)
    v_mfma_f32_16x16x32_bf16 v[68:71], v[36:39], a[112:115], v[68:71]
    ds_read_b128 v[32:35], v13 offset:34816
    s_add_u32 m0, s19, 35712
    v_mfma_f32_16x16x32_bf16 v[76:79], v[36:39], a[116:119], v[76:79]
    buffer_load_dwordx4 v2, s[8:11], s20 offen offset:1152 lds
    s_waitcnt lgkmcnt(6)
    v_mfma_f32_16x16x32_bf16 v[72:75], v[40:43], a[112:115], v[72:75]
    ds_read_b128 v[36:39], v12 offset:36864
    v_mfma_f32_16x16x32_bf16 v[80:83], v[40:43], a[116:119], v[80:83]
    s_waitcnt lgkmcnt(6)
    v_mfma_f32_16x16x32_bf16 v[68:71], v[44:47], a[120:123], v[68:71]
    ds_read_b128 v[40:43], v12 offset:38912
    s_add_u32 m0, s19, 39680
    v_mfma_f32_16x16x32_bf16 v[76:79], v[44:47], a[124:127], v[76:79]
    buffer_load_dwordx4 v2, s[8:11], s20 offen offset:1280 lds
    s_waitcnt lgkmcnt(6)
    v_mfma_f32_16x16x32_bf16 v[72:75], v[48:51], a[120:123], v[72:75]
    ds_read_b128 v[44:47], v13 offset:36864
    v_mfma_f32_16x16x32_bf16 v[80:83], v[48:51], a[124:127], v[80:83]
    s_waitcnt lgkmcnt(6)
    v_mfma_f32_16x16x32_bf16 v[68:71], v[20:23], a[128:131], v[68:71]
    ds_read_b128 v[48:51], v13 offset:38912
    v_mfma_f32_16x16x32_bf16 v[76:79], v[20:23], a[132:135], v[76:79]
    s_waitcnt lgkmcnt(6)
    v_mfma_f32_16x16x32_bf16 v[72:75], v[24:27], a[128:131], v[72:75]
    ds_read_b128 v[20:23], v12 offset:40960
    s_add_u32 m0, s19, 43648
    v_mfma_f32_16x16x32_bf16 v[80:83], v[24:27], a[132:135], v[80:83]
    buffer_load_dwordx4 v2, s[8:11], s20 offen offset:1408 lds
    s_waitcnt lgkmcnt(6)
    v_mfma_f32_16x16x32_bf16 v[68:71], v[28:31], a[136:139], v[68:71]
    ds_read_b128 v[24:27], v12 offset:43008
    v_mfma_f32_16x16x32_bf16 v[76:79], v[28:31], a[140:143], v[76:79]
    s_waitcnt lgkmcnt(6)
    v_mfma_f32_16x16x32_bf16 v[72:75], v[32:35], a[136:139], v[72:75]
    ds_read_b128 v[28:31], v13 offset:40960
    s_add_u32 m0, s19, 47616
    v_mfma_f32_16x16x32_bf16 v[80:83], v[32:35], a[140:143], v[80:83]
    buffer_load_dwordx4 v2, s[8:11], s20 offen offset:1536 lds
    s_waitcnt lgkmcnt(6)
    v_mfma_f32_16x16x32_bf16 v[68:71], v[36:39], a[144:147], v[68:71]
    ds_read_b128 v[32:35], v13 offset:43008
    v_mfma_f32_16x16x32_bf16 v[76:79], v[36:39], a[148:151], v[76:79]
    s_waitcnt lgkmcnt(6)
    v_mfma_f32_16x16x32_bf16 v[72:75], v[40:43], a[144:147], v[72:75]
    ds_read_b128 v[36:39], v12 offset:45056
    s_add_u32 m0, s19, 51584
    v_mfma_f32_16x16x32_bf16 v[80:83], v[40:43], a[148:151], v[80:83]
    buffer_load_dwordx4 v2, s[8:11], s20 offen offset:1664 lds
    s_waitcnt lgkmcnt(6)
    v_mfma_f32_16x16x32_bf16 v[68:71], v[44:47], a[152:155], v[68:71]
    ds_read_b128 v[40:43], v12 offset:47104
    v_mfma_f32_16x16x32_bf16 v[76:79], v[44:47], a[156:159], v[76:79]
    s_waitcnt lgkmcnt(6)
    v_mfma_f32_16x16x32_bf16 v[72:75], v[48:51], a[152:155], v[72:75]
    ds_read_b128 v[44:47], v13 offset:45056
    s_add_u32 m0, s19, 55552
    v_mfma_f32_16x16x32_bf16 v[80:83], v[48:51], a[156:159], v[80:83]
    buffer_load_dwordx4 v2, s[8:11], s20 offen offset:1792 lds
    s_waitcnt lgkmcnt(6)
    v_mfma_f32_16x16x32_bf16 v[68:71], v[20:23], a[160:163], v[68:71]
    ds_read_b128 v[48:51], v13 offset:47104
    v_mfma_f32_16x16x32_bf16 v[76:79], v[20:23], a[164:167], v[76:79]
    s_waitcnt lgkmcnt(6)
    v_mfma_f32_16x16x32_bf16 v[72:75], v[24:27], a[160:163], v[72:75]
    ds_read_b128 v[20:23], v12 offset:49152
    s_add_u32 m0, s19, 59520
    v_mfma_f32_16x16x32_bf16 v[80:83], v[24:27], a[164:167], v[80:83]
    buffer_load_dwordx4 v2, s[8:11], s20 offen offset:1920 lds
    s_waitcnt lgkmcnt(6)
    v_mfma_f32_16x16x32_bf16 v[68:71], v[28:31], a[168:171], v[68:71]
    ds_read_b128 v[24:27], v12 offset:51200
    v_mfma_f32_16x16x32_bf16 v[76:79], v[28:31], a[172:175], v[76:79]
    s_add_u32 s20, s20, s24
    s_waitcnt lgkmcnt(6)
    v_mfma_f32_16x16x32_bf16 v[72:75], v[32:35], a[168:171], v[72:75]
    ds_read_b128 v[28:31], v13 offset:49152
    v_mfma_f32_16x16x32_bf16 v[80:83], v[32:35], a[172:175], v[80:83]
    s_waitcnt lgkmcnt(6)
    v_mfma_f32_16x16x32_bf16 v[68:71], v[36:39], a[176:179], v[68:71]
    ds_read_b128 v[32:35], v13 offset:51200
    v_mfma_f32_16x16x32_bf16 v[76:79], v[36:39], a[180:183], v[76:79]
    s_waitcnt lgkmcnt(6)
    v_mfma_f32_16x16x32_bf16 v[72:75], v[40:43], a[176:179], v[72:75]
    ds_read_b128 v[36:39], v12 offset:53248
    v_mfma_f32_16x16x32_bf16 v[80:83], v[40:43], a[180:183], v[80:83]
    s_waitcnt lgkmcnt(6)
    v_mfma_f32_16x16x32_bf16 v[68:71], v[44:47], a[184:187], v[68:71]
    ds_read_b128 v[40:43], v12 offset:55296
    v_mfma_f32_16x16x32_bf16 v[76:79], v[44:47], a[188:191], v[76:79]
    s_waitcnt lgkmcnt(6)
    v_mfma_f32_16x16x32_bf16 v[72:75], v[48:51], a[184:187], v[72:75]
    ds_read_b128 v[44:47], v13 offset:53248
    v_mfma_f32_16x16x32_bf16 v[80:83], v[48:51], a[188:191], v[80:83]
    s_waitcnt lgkmcnt(6)
    v_mfma_f32_16x16x32_bf16 v[68:71], v[20:23], a[192:195], v[68:71]
    ds_read_b128 v[48:51], v13 offset:55296
    v_mfma_f32_16x16x32_bf16 v[76:79], v[20:23], a[196:199], v[76:79]
    s_waitcnt lgkmcnt(6)
    v_mfma_f32_16x16x32_bf16 v[72:75], v[24:27], a[192:195], v[72:75]
    ds_read_b128 v[20:23], v12 offset:57344
    v_mfma_f32_16x16x32_bf16 v[80:83], v[24:27], a[196:199], v[80:83]
    s_waitcnt lgkmcnt(6)
    v_mfma_f32_16x16x32_bf16 v[68:71], v[28:31], a[200:203], v[68:71]
    ds_read_b128 v[24:27], v12 offset:59392
    v_mfma_f32_16x16x32_bf16 v[76:79], v[28:31], a[204:207], v[76:79]
    s_waitcnt lgkmcnt(6)
    v_mfma_f32_16x16x32_bf16 v[72:75], v[32:35], a[200:203], v[72:75]
    ds_read_b128 v[28:31], v13 offset:57344
    v_mfma_f32_16x16x32_bf16 v[80:83], v[32:35], a[204:207], v[80:83]
    s_waitcnt lgkmcnt(6)
    v_mfma_f32_16x16x32_bf16 v[68:71], v[36:39], a[208:211], v[68:71]
    ds_read_b128 v[32:35], v13 offset:59392
    v_mfma_f32_16x16x32_bf16 v[76:79], v[36:39], a[212:215], v[76:79]
    s_waitcnt lgkmcnt(6)
    v_mfma_f32_16x16x32_bf16 v[72:75], v[40:43], a[208:211], v[72:75]
    ds_read_b128 v[36:39], v12 offset:61440
    v_mfma_f32_16x16x32_bf16 v[80:83], v[40:43], a[212:215], v[80:83]
    s_waitcnt lgkmcnt(6)
    v_mfma_f32_16x16x32_bf16 v[68:71], v[44:47], a[216:219], v[68:71]
    ds_read_b128 v[40:43], v12 offset:63488
    v_mfma_f32_16x16x32_bf16 v[76:79], v[44:47], a[220:223], v[76:79]
    s_waitcnt lgkmcnt(6)
    v_mfma_f32_16x16x32_bf16 v[72:75], v[48:51], a[216:219], v[72:75]
    ds_read_b128 v[44:47], v13 offset:61440
    v_mfma_f32_16x16x32_bf16 v[80:83], v[48:51], a[220:223], v[80:83]
    s_waitcnt lgkmcnt(6)
    v_mfma_f32_16x16x32_bf16 v[68:71], v[20:23], a[224:227], v[68:71]
    ds_read_b128 v[48:51], v13 offset:63488
    v_mfma_f32_16x16x32_bf16 v[76:79], v[20:23], a[228:231], v[76:79]
    s_waitcnt lgkmcnt(6)
    v_mfma_f32_16x16x32_bf16 v[72:75], v[24:27], a[224:227], v[72:75]
    s_waitcnt vmcnt(8)
    s_barrier
    ds_read_b128 v[20:23], v10 offset:0
    v_mfma_f32_16x16x32_bf16 v[80:83], v[24:27], a[228:231], v[80:83]
    s_waitcnt lgkmcnt(6)
    v_mfma_f32_16x16x32_bf16 v[68:71], v[28:31], a[232:235], v[68:71]
    ds_read_b128 v[24:27], v10 offset:2048
    s_add_u32 m0, s19, 65536
    v_mfma_f32_16x16x32_bf16 v[76:79], v[28:31], a[236:239], v[76:79]
    buffer_load_dwordx4 v2, s[8:11], s20 offen offset:0 lds
    s_waitcnt lgkmcnt(6)
    v_mfma_f32_16x16x32_bf16 v[72:75], v[32:35], a[232:235], v[72:75]
    ds_read_b128 v[28:31], v11 offset:0
    v_mfma_f32_16x16x32_bf16 v[80:83], v[32:35], a[236:239], v[80:83]
    s_waitcnt lgkmcnt(6)
    v_mfma_f32_16x16x32_bf16 v[68:71], v[36:39], a[240:243], v[68:71]
    ds_read_b128 v[32:35], v11 offset:2048
    s_add_u32 m0, s19, 69504
    v_mfma_f32_16x16x32_bf16 v[76:79], v[36:39], a[244:247], v[76:79]
    buffer_load_dwordx4 v2, s[8:11], s20 offen offset:128 lds
    s_waitcnt lgkmcnt(6)
    v_mfma_f32_16x16x32_bf16 v[72:75], v[40:43], a[240:243], v[72:75]
    ds_read_b128 v[36:39], v10 offset:4096
    v_mfma_f32_16x16x32_bf16 v[80:83], v[40:43], a[244:247], v[80:83]
    s_waitcnt lgkmcnt(6)
    v_mfma_f32_16x16x32_bf16 v[68:71], v[44:47], a[248:251], v[68:71]
    ds_read_b128 v[40:43], v10 offset:6144
    s_add_u32 m0, s19, 73472
    v_mfma_f32_16x16x32_bf16 v[76:79], v[44:47], a[252:255], v[76:79]
    buffer_load_dwordx4 v2, s[8:11], s20 offen offset:256 lds
    s_waitcnt lgkmcnt(6)
    v_mfma_f32_16x16x32_bf16 v[72:75], v[48:51], a[248:251], v[72:75]
    ds_read_b128 v[44:47], v11 offset:4096
    v_mfma_f32_16x16x32_bf16 v[80:83], v[48:51], a[252:255], v[80:83]
    s_add_u32 s22, s22, 2
    s_cmp_lt_u32 s22, 16
    s_cbranch_scc1 F1_top
    v_cvt_pk_bf16_f32 v84, v68, v69
    v_cvt_pk_bf16_f32 v85, v70, v71
    s_nop 0
    v_cvt_pk_bf16_f32 v86, v72, v73
    v_cvt_pk_bf16_f32 v87, v74, v75
    v_cvt_pk_bf16_f32 v88, v76, v77
    v_cvt_pk_bf16_f32 v89, v78, v79
    v_cvt_pk_bf16_f32 v90, v80, v81
    v_cvt_pk_bf16_f32 v91, v82, v83
    buffer_store_dwordx4 v[84:87], v3, s[4:7], s21 offen offset:0 sc1
    buffer_store_dwordx4 v[88:91], v3, s[4:7], s21 offen offset:256 sc1
    s_waitcnt vmcnt(0) lgkmcnt(0)
    v_lshlrev_b32 v5, 2, v1
    s_mov_b32 s18, 0
rdv_17:
    global_load_dword v6, v5, s[100:101] sc1
    s_lshl_b32 s17, s98, 2
    s_waitcnt vmcnt(0)
    v_lshrrev_b32 v9, s17, v6
    s_cmp_eq_u32 s98, 0
    s_cselect_b32 s17, 0x0f0f0f0f, s17
    s_cselect_b32 s17, s17, 0x01010101
    v_and_b32 v9, s17, v9
    v_cmp_ne_u32 vcc, 0x01010101, v9
    s_nop 0
    s_cbranch_vccz rdvok_18
    v_sad_u8 v9, v9, 0, 0
    s_nop 1
    v_add_u32_dpp v9, v9, v9 quad_perm:[1,0,3,2] row_mask:0xf bank_mask:0xf
    v_cmp_ne_u32 vcc, 8, v9
    s_nop 0
    s_cbranch_vccnz rdvw_19
    s_mov_b32 s98, 1
    s_and_b32 s3, s97, 7
    s_barrier
    s_branch role_start
rdvw_19:
    s_sleep 4
    s_add_u32 s18, s18, 1
    s_cmp_lt_u32 s18, 262144
    s_cbranch_scc1 rdv_17
    s_mov_b32 s92, 1048576
rdvok_18:
    s_barrier
    s_lshl_b32 s31, s29, 2
    s_add_u32 s31, s31, s28
    s_lshl_b32 s17, s31, 7
    s_add_u32 s17, s17, 100745216
    v_lshl_add_u32 v5, v1, 2, s17
    v_mov_b32 v6, 1
    s_mov_b64 exec, 0xffffffff
    buffer_store_dword v6, v5, s[4:7], 0 offen sc1
    s_mov_b64 exec, -1
    v_and_b32 v10, 19, v1
    v_bfe_u32 v5, v1, 2, 1
    v_bfe_u32 v6, v1, 3, 1
    v_lshl_add_u32 v10, v5, 3, v10
    v_lshl_add_u32 v10, v6, 2, v10
    v_lshrrev_b32 v8, 1, v1
    v_and_b32 v19, 19, v8
    v_bfe_u32 v5, v8, 2, 1
    v_bfe_u32 v6, v8, 3, 1
    v_lshl_add_u32 v19, v5, 3, v19
    v_lshl_add_u32 v19, v6, 2, v19
    s_load_dwordx2 s[12:13], s[0:1], 80
    s_mov_b32 s14, 8388608
    s_mov_b32 s15, 0x20000
    v_lshrrev_b32 v11, 5, v1
    v_lshl_add_u32 v12, v11, 9, v10
    v_mul_u32_u24 v12, 1026, v12
    v_and_b32 v13, 1, v1
    v_lshlrev_b32 v13, 4, v13
    v_lshlrev_b32 v14, 4, v1
    s_lshr_b32 s17, s16, 1
    s_and_b32 s18, s16, 1
    s_lshl_b32 s17, s17, 5
    s_lshl_b32 s18, s18, 10
    s_add_u32 s17, s17, s18
    s_mul_i32 s20, s17, 1026
    s_lshl_b32 s17, s93, 5
    s_add_u32 s20, s20, s17
    v_mul_u32_u24 v19, 1026, v19
    v_add_u32 v19, v19, v13
    s_mov_b32 s32, 0x05040100
    s_mov_b32 s33, 0x07060302
    v_cvt_f32_u32 v16, v10
    v_lshlrev_b32 v17, 3, v11
    v_cvt_f32_u32 v17, v17
    s_add_u32 s17, s20, 0
    buffer_load_dwordx4 v[60:63], v19, s[48:51], s17 offen
    v_add_f32 v5, 0, v16
    v_mul_f32 v5, 1015021568, v5
    v_mul_f32 v6, v5, v17
    v_mul_f32 v7, 0x41800000, v5
    v_fract_f32 v32, v6
    v_add_f32 v33, v32, v5
    v_add_f32 v34, v33, v5
    v_add_f32 v35, v34, v5
    v_add_f32 v36, v35, v5
    v_add_f32 v37, v36, v5
    v_add_f32 v38, v37, v5
    v_add_f32 v39, v38, v5
    v_add_f32 v6, v32, v7
    v_cos_f32 v40, v32
    v_sin_f32 v48, v32
    v_cos_f32 v41, v33
    buffer_load_dwordx4 v[64:67], v19, s[52:55], s17 offen
    v_sin_f32 v49, v33
    v_cos_f32 v42, v34
    v_sin_f32 v50, v34
    v_cos_f32 v43, v35
    v_sin_f32 v51, v35
    v_cos_f32 v44, v36
    v_sin_f32 v52, v36
    v_cos_f32 v45, v37
    v_sin_f32 v53, v37
    v_cos_f32 v46, v38
    v_sin_f32 v54, v38
    v_cos_f32 v47, v39
    v_sin_f32 v55, v39
    v_cvt_pk_bf16_f32 v56, v40, v41
    v_cvt_pk_bf16_f32 v57, v48, v49
    v_accvgpr_write_b32 a0, v56
    v_xor_b32 v58, 0x80008000, v57
    s_add_u32 s17, s20, 131328
    buffer_load_dwordx4 v[68:71], v19, s[48:51], s17 offen
    v_accvgpr_write_b32 a32, v57
    v_accvgpr_write_b32 a64, v58
    v_cvt_pk_bf16_f32 v56, v42, v43
    v_cvt_pk_bf16_f32 v57, v50, v51
    v_accvgpr_write_b32 a1, v56
    v_xor_b32 v58, 0x80008000, v57
    v_accvgpr_write_b32 a33, v57
    v_accvgpr_write_b32 a65, v58
    v_cvt_pk_bf16_f32 v56, v44, v45
    v_cvt_pk_bf16_f32 v57, v52, v53
    v_accvgpr_write_b32 a2, v56
    v_xor_b32 v58, 0x80008000, v57
    v_accvgpr_write_b32 a34, v57
    v_accvgpr_write_b32 a66, v58
    v_cvt_pk_bf16_f32 v56, v46, v47
    v_cvt_pk_bf16_f32 v57, v54, v55
    v_accvgpr_write_b32 a3, v56
    buffer_load_dwordx4 v[72:75], v19, s[52:55], s17 offen
    v_xor_b32 v58, 0x80008000, v57
    v_accvgpr_write_b32 a35, v57
    v_accvgpr_write_b32 a67, v58
    v_fract_f32 v32, v6
    v_add_f32 v33, v32, v5
    v_add_f32 v34, v33, v5
    v_add_f32 v35, v34, v5
    v_add_f32 v36, v35, v5
    v_add_f32 v37, v36, v5
    v_add_f32 v38, v37, v5
    v_add_f32 v39, v38, v5
    v_add_f32 v6, v32, v7
    v_cos_f32 v40, v32
    v_sin_f32 v48, v32
    v_cos_f32 v41, v33
    v_sin_f32 v49, v33
    s_add_u32 s17, s20, 262656
    buffer_load_dwordx4 v[76:79], v19, s[48:51], s17 offen
    v_cos_f32 v42, v34
    v_sin_f32 v50, v34
    v_cos_f32 v43, v35
    v_sin_f32 v51, v35
    v_cos_f32 v44, v36
    v_sin_f32 v52, v36
    v_cos_f32 v45, v37
    v_sin_f32 v53, v37
    v_cos_f32 v46, v38
    v_sin_f32 v54, v38
    v_cos_f32 v47, v39
    v_sin_f32 v55, v39
    v_cvt_pk_bf16_f32 v56, v40, v41
    v_cvt_pk_bf16_f32 v57, v48, v49
    v_accvgpr_write_b32 a4, v56
    v_xor_b32 v58, 0x80008000, v57
    v_accvgpr_write_b32 a36, v57
    buffer_load_dwordx4 v[80:83], v19, s[52:55], s17 offen
    v_accvgpr_write_b32 a68, v58
    v_cvt_pk_bf16_f32 v56, v42, v43
    v_cvt_pk_bf16_f32 v57, v50, v51
    v_accvgpr_write_b32 a5, v56
    v_xor_b32 v58, 0x80008000, v57
    v_accvgpr_write_b32 a37, v57
    v_accvgpr_write_b32 a69, v58
    v_cvt_pk_bf16_f32 v56, v44, v45
    v_cvt_pk_bf16_f32 v57, v52, v53
    v_accvgpr_write_b32 a6, v56
    v_xor_b32 v58, 0x80008000, v57
    v_accvgpr_write_b32 a38, v57
    v_accvgpr_write_b32 a70, v58
    v_cvt_pk_bf16_f32 v56, v46, v47
    v_cvt_pk_bf16_f32 v57, v54, v55
    v_accvgpr_write_b32 a7, v56
    v_xor_b32 v58, 0x80008000, v57
    s_add_u32 s17, s20, 393984
    buffer_load_dwordx4 v[84:87], v19, s[48:51], s17 offen
    v_accvgpr_write_b32 a39, v57
    v_accvgpr_write_b32 a71, v58
    v_fract_f32 v32, v6
    v_add_f32 v33, v32, v5
    v_add_f32 v34, v33, v5
    v_add_f32 v35, v34, v5
    v_add_f32 v36, v35, v5
    v_add_f32 v37, v36, v5
    v_add_f32 v38, v37, v5
    v_add_f32 v39, v38, v5
    v_add_f32 v6, v32, v7
    v_cos_f32 v40, v32
    v_sin_f32 v48, v32
    v_cos_f32 v41, v33
    v_sin_f32 v49, v33
    v_cos_f32 v42, v34
    buffer_load_dwordx4 v[88:91], v19, s[52:55], s17 offen
    v_sin_f32 v50, v34
    v_cos_f32 v43, v35
    v_sin_f32 v51, v35
    v_cos_f32 v44, v36
    v_sin_f32 v52, v36
    v_cos_f32 v45, v37
    v_sin_f32 v53, v37
    v_cos_f32 v46, v38
    v_sin_f32 v54, v38
    v_cos_f32 v47, v39
    v_sin_f32 v55, v39
    v_cvt_pk_bf16_f32 v56, v40, v41
    v_cvt_pk_bf16_f32 v57, v48, v49
    v_accvgpr_write_b32 a8, v56
    v_xor_b32 v58, 0x80008000, v57
    v_accvgpr_write_b32 a40, v57
    v_accvgpr_write_b32 a72, v58
    s_add_u32 s17, s20, 525312
    buffer_load_dwordx4 v[92:95], v19, s[48:51], s17 offen
    v_cvt_pk_bf16_f32 v56, v42, v43
    v_cvt_pk_bf16_f32 v57, v50, v51
    v_accvgpr_write_b32 a9, v56
    v_xor_b32 v58, 0x80008000, v57
    v_accvgpr_write_b32 a41, v57
    v_accvgpr_write_b32 a73, v58
    v_cvt_pk_bf16_f32 v56, v44, v45
    v_cvt_pk_bf16_f32 v57, v52, v53
    v_accvgpr_write_b32 a10, v56
    v_xor_b32 v58, 0x80008000, v57
    v_accvgpr_write_b32 a42, v57
    v_accvgpr_write_b32 a74, v58
    v_cvt_pk_bf16_f32 v56, v46, v47
    v_cvt_pk_bf16_f32 v57, v54, v55
    v_accvgpr_write_b32 a11, v56
    v_xor_b32 v58, 0x80008000, v57
    v_accvgpr_write_b32 a43, v57
    buffer_load_dwordx4 v[96:99], v19, s[52:55], s17 offen
    v_accvgpr_write_b32 a75, v58
    v_fract_f32 v32, v6
    v_add_f32 v33, v32, v5
    v_add_f32 v34, v33, v5
    v_add_f32 v35, v34, v5
    v_add_f32 v36, v35, v5
    v_add_f32 v37, v36, v5
    v_add_f32 v38, v37, v5
    v_add_f32 v39, v38, v5
    v_add_f32 v6, v32, v7
    v_cos_f32 v40, v32
    v_sin_f32 v48, v32
    v_cos_f32 v41, v33
    v_sin_f32 v49, v33
    v_cos_f32 v42, v34
    v_sin_f32 v50, v34
    s_add_u32 s17, s20, 656640
    buffer_load_dwordx4 v[100:103], v19, s[48:51], s17 offen
    v_cos_f32 v43, v35
    v_sin_f32 v51, v35
    v_cos_f32 v44, v36
    v_sin_f32 v52, v36
    v_cos_f32 v45, v37
    v_sin_f32 v53, v37
    v_cos_f32 v46, v38
    v_sin_f32 v54, v38
    v_cos_f32 v47, v39
    v_sin_f32 v55, v39
    v_cvt_pk_bf16_f32 v56, v40, v41
    v_cvt_pk_bf16_f32 v57, v48, v49
    v_accvgpr_write_b32 a12, v56
    v_xor_b32 v58, 0x80008000, v57
    v_accvgpr_write_b32 a44, v57
    v_accvgpr_write_b32 a76, v58
    v_cvt_pk_bf16_f32 v56, v42, v43
    buffer_load_dwordx4 v[104:107], v19, s[52:55], s17 offen
    v_cvt_pk_bf16_f32 v57, v50, v51
    v_accvgpr_write_b32 a13, v56
    v_xor_b32 v58, 0x80008000, v57
    v_accvgpr_write_b32 a45, v57
    v_accvgpr_write_b32 a77, v58
    v_cvt_pk_bf16_f32 v56, v44, v45
    v_cvt_pk_bf16_f32 v57, v52, v53
    v_accvgpr_write_b32 a14, v56
    v_xor_b32 v58, 0x80008000, v57
    v_accvgpr_write_b32 a46, v57
    v_accvgpr_write_b32 a78, v58
    v_cvt_pk_bf16_f32 v56, v46, v47
    v_cvt_pk_bf16_f32 v57, v54, v55
    v_accvgpr_write_b32 a15, v56
    v_xor_b32 v58, 0x80008000, v57
    v_accvgpr_write_b32 a47, v57
    v_accvgpr_write_b32 a79, v58
    s_add_u32 s17, s20, 787968
    buffer_load_dwordx4 v[108:111], v19, s[48:51], s17 offen
    v_add_f32 v5, 1107296256, v16
    v_mul_f32 v5, 1015021568, v5
    v_mul_f32 v6, v5, v17
    v_mul_f32 v7, 0x41800000, v5
    v_fract_f32 v32, v6
    v_add_f32 v33, v32, v5
    v_add_f32 v34, v33, v5
    v_add_f32 v35, v34, v5
    v_add_f32 v36, v35, v5
    v_add_f32 v37, v36, v5
    v_add_f32 v38, v37, v5
    v_add_f32 v39, v38, v5
    v_add_f32 v6, v32, v7
    v_cos_f32 v40, v32
    v_sin_f32 v48, v32
    v_cos_f32 v41, v33
    buffer_load_dwordx4 v[112:115], v19, s[52:55], s17 offen
    v_sin_f32 v49, v33
    v_cos_f32 v42, v34
    v_sin_f32 v50, v34
    v_cos_f32 v43, v35
    v_sin_f32 v51, v35
    v_cos_f32 v44, v36
    v_sin_f32 v52, v36
    v_cos_f32 v45, v37
    v_sin_f32 v53, v37
    v_cos_f32 v46, v38
    v_sin_f32 v54, v38
    v_cos_f32 v47, v39
    v_sin_f32 v55, v39
    v_cvt_pk_bf16_f32 v56, v40, v41
    v_cvt_pk_bf16_f32 v57, v48, v49
    v_accvgpr_write_b32 a16, v56
    v_xor_b32 v58, 0x80008000, v57
    s_add_u32 s17, s20, 919296
    buffer_load_dwordx4 v[116:119], v19, s[48:51], s17 offen
    v_accvgpr_write_b32 a48, v57
    v_accvgpr_write_b32 a80, v58
    v_cvt_pk_bf16_f32 v56, v42, v43
    v_cvt_pk_bf16_f32 v57, v50, v51
    v_accvgpr_write_b32 a17, v56
    v_xor_b32 v58, 0x80008000, v57
    v_accvgpr_write_b32 a49, v57
    v_accvgpr_write_b32 a81, v58
    v_cvt_pk_bf16_f32 v56, v44, v45
    v_cvt_pk_bf16_f32 v57, v52, v53
    v_accvgpr_write_b32 a18, v56
    v_xor_b32 v58, 0x80008000, v57
    v_accvgpr_write_b32 a50, v57
    v_accvgpr_write_b32 a82, v58
    v_cvt_pk_bf16_f32 v56, v46, v47
    v_cvt_pk_bf16_f32 v57, v54, v55
    v_accvgpr_write_b32 a19, v56
    buffer_load_dwordx4 v[120:123], v19, s[52:55], s17 offen
    v_xor_b32 v58, 0x80008000, v57
    v_accvgpr_write_b32 a51, v57
    v_accvgpr_write_b32 a83, v58
    v_fract_f32 v32, v6
    v_add_f32 v33, v32, v5
    v_add_f32 v34, v33, v5
    v_add_f32 v35, v34, v5
    v_add_f32 v36, v35, v5
    v_add_f32 v37, v36, v5
    v_add_f32 v38, v37, v5
    v_add_f32 v39, v38, v5
    v_add_f32 v6, v32, v7
    v_cos_f32 v40, v32
    v_sin_f32 v48, v32
    v_cos_f32 v41, v33
    v_sin_f32 v49, v33
    v_cos_f32 v42, v34
    s_add_u32 s17, s20, 65664
    buffer_load_dwordx4 v[124:127], v19, s[48:51], s17 offen
    v_sin_f32 v50, v34
    v_cos_f32 v43, v35
    v_sin_f32 v51, v35
    v_cos_f32 v44, v36
    v_sin_f32 v52, v36
    v_cos_f32 v45, v37
    v_sin_f32 v53, v37
    v_cos_f32 v46, v38
    v_sin_f32 v54, v38
    v_cos_f32 v47, v39
    v_sin_f32 v55, v39
    v_cvt_pk_bf16_f32 v56, v40, v41
    v_cvt_pk_bf16_f32 v57, v48, v49
    v_accvgpr_write_b32 a20, v56
    v_xor_b32 v58, 0x80008000, v57
    v_accvgpr_write_b32 a52, v57
    buffer_load_dwordx4 v[128:131], v19, s[52:55], s17 offen
    v_accvgpr_write_b32 a84, v58
    v_cvt_pk_bf16_f32 v56, v42, v43
    v_cvt_pk_bf16_f32 v57, v50, v51
    v_accvgpr_write_b32 a21, v56
    v_xor_b32 v58, 0x80008000, v57
    v_accvgpr_write_b32 a53, v57
    v_accvgpr_write_b32 a85, v58
    v_cvt_pk_bf16_f32 v56, v44, v45
    v_cvt_pk_bf16_f32 v57, v52, v53
    v_accvgpr_write_b32 a22, v56
    v_xor_b32 v58, 0x80008000, v57
    v_accvgpr_write_b32 a54, v57
    v_accvgpr_write_b32 a86, v58
    v_cvt_pk_bf16_f32 v56, v46, v47
    v_cvt_pk_bf16_f32 v57, v54, v55
    v_accvgpr_write_b32 a23, v56
    v_xor_b32 v58, 0x80008000, v57
    s_add_u32 s17, s20, 196992
    buffer_load_dwordx4 v[132:135], v19, s[48:51], s17 offen
    v_accvgpr_write_b32 a55, v57
    v_accvgpr_write_b32 a87, v58
    v_fract_f32 v32, v6
    v_add_f32 v33, v32, v5
    v_add_f32 v34, v33, v5
    v_add_f32 v35, v34, v5
    v_add_f32 v36, v35, v5
    v_add_f32 v37, v36, v5
    v_add_f32 v38, v37, v5
    v_add_f32 v39, v38, v5
    v_add_f32 v6, v32, v7
    v_cos_f32 v40, v32
    v_sin_f32 v48, v32
    v_cos_f32 v41, v33
    v_sin_f32 v49, v33
    v_cos_f32 v42, v34
    v_sin_f32 v50, v34
    buffer_load_dwordx4 v[136:139], v19, s[52:55], s17 offen
    v_cos_f32 v43, v35
    v_sin_f32 v51, v35
    v_cos_f32 v44, v36
    v_sin_f32 v52, v36
    v_cos_f32 v45, v37
    v_sin_f32 v53, v37
    v_cos_f32 v46, v38
    v_sin_f32 v54, v38
    v_cos_f32 v47, v39
    v_sin_f32 v55, v39
    v_cvt_pk_bf16_f32 v56, v40, v41
    v_cvt_pk_bf16_f32 v57, v48, v49
    v_accvgpr_write_b32 a24, v56
    v_xor_b32 v58, 0x80008000, v57
    v_accvgpr_write_b32 a56, v57
    v_accvgpr_write_b32 a88, v58
    s_add_u32 s17, s20, 328320
    buffer_load_dwordx4 v[140:143], v19, s[48:51], s17 offen
    v_cvt_pk_bf16_f32 v56, v42, v43
    v_cvt_pk_bf16_f32 v57, v50, v51
    v_accvgpr_write_b32 a25, v56
    v_xor_b32 v58, 0x80008000, v57
    v_accvgpr_write_b32 a57, v57
    v_accvgpr_write_b32 a89, v58
    v_cvt_pk_bf16_f32 v56, v44, v45
    v_cvt_pk_bf16_f32 v57, v52, v53
    v_accvgpr_write_b32 a26, v56
    v_xor_b32 v58, 0x80008000, v57
    v_accvgpr_write_b32 a58, v57
    v_accvgpr_write_b32 a90, v58
    v_cvt_pk_bf16_f32 v56, v46, v47
    v_cvt_pk_bf16_f32 v57, v54, v55
    v_accvgpr_write_b32 a27, v56
    v_xor_b32 v58, 0x80008000, v57
    v_accvgpr_write_b32 a59, v57
    buffer_load_dwordx4 v[144:147], v19, s[52:55], s17 offen
    v_accvgpr_write_b32 a91, v58
    v_fract_f32 v32, v6
    v_add_f32 v33, v32, v5
    v_add_f32 v34, v33, v5
    v_add_f32 v35, v34, v5
    v_add_f32 v36, v35, v5
    v_add_f32 v37, v36, v5
    v_add_f32 v38, v37, v5
    v_add_f32 v39, v38, v5
    v_add_f32 v6, v32, v7
    v_cos_f32 v40, v32
    v_sin_f32 v48, v32
    v_cos_f32 v41, v33
    v_sin_f32 v49, v33
    v_cos_f32 v42, v34
    v_sin_f32 v50, v34
    v_cos_f32 v43, v35
    s_add_u32 s17, s20, 459648
    buffer_load_dwordx4 v[148:151], v19, s[48:51], s17 offen
    v_sin_f32 v51, v35
    v_cos_f32 v44, v36
    v_sin_f32 v52, v36
    v_cos_f32 v45, v37
    v_sin_f32 v53, v37
    v_cos_f32 v46, v38
    v_sin_f32 v54, v38
    v_cos_f32 v47, v39
    v_sin_f32 v55, v39
    v_cvt_pk_bf16_f32 v56, v40, v41
    v_cvt_pk_bf16_f32 v57, v48, v49
    v_accvgpr_write_b32 a28, v56
    v_xor_b32 v58, 0x80008000, v57
    v_accvgpr_write_b32 a60, v57
    v_accvgpr_write_b32 a92, v58
    v_cvt_pk_bf16_f32 v56, v42, v43
    buffer_load_dwordx4 v[152:155], v19, s[52:55], s17 offen
    v_cvt_pk_bf16_f32 v57, v50, v51
    v_accvgpr_write_b32 a29, v56
    v_xor_b32 v58, 0x80008000, v57
    v_accvgpr_write_b32 a61, v57
    v_accvgpr_write_b32 a93, v58
    v_cvt_pk_bf16_f32 v56, v44, v45
    v_cvt_pk_bf16_f32 v57, v52, v53
    v_accvgpr_write_b32 a30, v56
    v_xor_b32 v58, 0x80008000, v57
    v_accvgpr_write_b32 a62, v57
    v_accvgpr_write_b32 a94, v58
    v_cvt_pk_bf16_f32 v56, v46, v47
    v_cvt_pk_bf16_f32 v57, v54, v55
    v_accvgpr_write_b32 a31, v56
    v_xor_b32 v58, 0x80008000, v57
    v_accvgpr_write_b32 a63, v57
    v_accvgpr_write_b32 a95, v58
    s_add_u32 s17, s20, 590976
    buffer_load_dwordx4 v[156:159], v19, s[48:51], s17 offen
    v_add_f32 v5, 0, v16
    v_mul_f32 v5, 1023410176, v5
    v_mul_f32 v6, v5, v17
    v_mul_f32 v7, 0x41800000, v5
    v_fract_f32 v32, v6
    v_add_f32 v33, v32, v5
    v_add_f32 v34, v33, v5
    v_add_f32 v35, v34, v5
    v_add_f32 v36, v35, v5
    v_add_f32 v37, v36, v5
    v_add_f32 v38, v37, v5
    v_add_f32 v39, v38, v5
    v_add_f32 v6, v32, v7
    v_cos_f32 v40, v32
    v_sin_f32 v48, v32
    v_cos_f32 v41, v33
    v_sin_f32 v49, v33
    buffer_load_dwordx4 v[160:163], v19, s[52:55], s17 offen
    v_cos_f32 v42, v34
    v_sin_f32 v50, v34
    v_cos_f32 v43, v35
    v_sin_f32 v51, v35
    v_cos_f32 v44, v36
    v_sin_f32 v52, v36
    v_cos_f32 v45, v37
    v_sin_f32 v53, v37
    v_cos_f32 v46, v38
    v_sin_f32 v54, v38
    v_cos_f32 v47, v39
    v_sin_f32 v55, v39
    v_mul_f32 v40, 981467136, v40
    v_mul_f32 v41, 981467136, v41
    v_mul_f32 v42, 981467136, v42
    v_mul_f32 v43, 981467136, v43
    s_add_u32 s17, s20, 722304
    buffer_load_dwordx4 v[164:167], v19, s[48:51], s17 offen
    v_mul_f32 v44, 981467136, v44
    v_mul_f32 v45, 981467136, v45
    v_mul_f32 v46, 981467136, v46
    v_mul_f32 v47, 981467136, v47
    v_mul_f32 v48, 981467136, v48
    v_mul_f32 v49, 981467136, v49
    v_mul_f32 v50, 981467136, v50
    v_mul_f32 v51, 981467136, v51
    v_mul_f32 v52, 981467136, v52
    v_mul_f32 v53, 981467136, v53
    v_mul_f32 v54, 981467136, v54
    v_mul_f32 v55, 981467136, v55
    v_cvt_pk_bf16_f32 v56, v40, v41
    v_cvt_pk_bf16_f32 v57, v48, v49
    v_accvgpr_write_b32 a96, v56
    v_xor_b32 v58, 0x80008000, v57
    v_accvgpr_write_b32 a104, v57
    buffer_load_dwordx4 v[168:171], v19, s[52:55], s17 offen
    v_accvgpr_write_b32 a112, v58
    v_cvt_pk_bf16_f32 v56, v42, v43
    v_cvt_pk_bf16_f32 v57, v50, v51
    v_accvgpr_write_b32 a97, v56
    v_xor_b32 v58, 0x80008000, v57
    v_accvgpr_write_b32 a105, v57
    v_accvgpr_write_b32 a113, v58
    v_cvt_pk_bf16_f32 v56, v44, v45
    v_cvt_pk_bf16_f32 v57, v52, v53
    v_accvgpr_write_b32 a98, v56
    v_xor_b32 v58, 0x80008000, v57
    v_accvgpr_write_b32 a106, v57
    v_accvgpr_write_b32 a114, v58
    v_cvt_pk_bf16_f32 v56, v46, v47
    v_cvt_pk_bf16_f32 v57, v54, v55
    v_accvgpr_write_b32 a99, v56
    v_xor_b32 v58, 0x80008000, v57
    s_add_u32 s17, s20, 853632
    buffer_load_dwordx4 v[172:175], v19, s[48:51], s17 offen
    v_accvgpr_write_b32 a107, v57
    v_accvgpr_write_b32 a115, v58
    v_fract_f32 v32, v6
    v_add_f32 v33, v32, v5
    v_add_f32 v34, v33, v5
    v_add_f32 v35, v34, v5
    v_add_f32 v36, v35, v5
    v_add_f32 v37, v36, v5
    v_add_f32 v38, v37, v5
    v_add_f32 v39, v38, v5
    v_add_f32 v6, v32, v7
    v_cos_f32 v40, v32
    v_sin_f32 v48, v32
    v_cos_f32 v41, v33
    v_sin_f32 v49, v33
    v_cos_f32 v42, v34
    buffer_load_dwordx4 v[176:179], v19, s[52:55], s17 offen
    v_sin_f32 v50, v34
    v_cos_f32 v43, v35
    v_sin_f32 v51, v35
    v_cos_f32 v44, v36
    v_sin_f32 v52, v36
    v_cos_f32 v45, v37
    v_sin_f32 v53, v37
    v_cos_f32 v46, v38
    v_sin_f32 v54, v38
    v_cos_f32 v47, v39
    v_sin_f32 v55, v39
    v_mul_f32 v40, 981467136, v40
    v_mul_f32 v41, 981467136, v41
    v_mul_f32 v42, 981467136, v42
    v_mul_f32 v43, 981467136, v43
    v_mul_f32 v44, 981467136, v44
    v_mul_f32 v45, 981467136, v45
    s_add_u32 s17, s20, 984960
    buffer_load_dwordx4 v[180:183], v19, s[48:51], s17 offen
    v_mul_f32 v46, 981467136, v46
    v_mul_f32 v47, 981467136, v47
    v_mul_f32 v48, 981467136, v48
    v_mul_f32 v49, 981467136, v49
    v_mul_f32 v50, 981467136, v50
    v_mul_f32 v51, 981467136, v51
    v_mul_f32 v52, 981467136, v52
    v_mul_f32 v53, 981467136, v53
    v_mul_f32 v54, 981467136, v54
    v_mul_f32 v55, 981467136, v55
    v_cvt_pk_bf16_f32 v56, v40, v41
    v_cvt_pk_bf16_f32 v57, v48, v49
    v_accvgpr_write_b32 a100, v56
    v_xor_b32 v58, 0x80008000, v57
    v_accvgpr_write_b32 a108, v57
    v_accvgpr_write_b32 a116, v58
    v_cvt_pk_bf16_f32 v56, v42, v43
    buffer_load_dwordx4 v[184:187], v19, s[52:55], s17 offen
    v_cvt_pk_bf16_f32 v57, v50, v51
    v_accvgpr_write_b32 a101, v56
    v_xor_b32 v58, 0x80008000, v57
    v_accvgpr_write_b32 a109, v57
    v_accvgpr_write_b32 a117, v58
    v_cvt_pk_bf16_f32 v56, v44, v45
    v_cvt_pk_bf16_f32 v57, v52, v53
    v_accvgpr_write_b32 a102, v56
    v_xor_b32 v58, 0x80008000, v57
    v_accvgpr_write_b32 a110, v57
    v_accvgpr_write_b32 a118, v58
    v_cvt_pk_bf16_f32 v56, v46, v47
    v_cvt_pk_bf16_f32 v57, v54, v55
    v_accvgpr_write_b32 a103, v56
    v_xor_b32 v58, 0x80008000, v57
    v_accvgpr_write_b32 a111, v57
    v_accvgpr_write_b32 a119, v58
    s_lshl_b32 s17, s16, 11
    v_lshlrev_b32 v5, 12, v13
    v_lshl_add_u32 v5, v8, 4, v5
    v_add_u32 v5, s17, v5
    s_cmp_eq_u32 s16, 0
    s_cselect_b32 s17, 0, 10240
    s_add_u32 s17, s17, 0x20000
    v_add_u32 v13, s17, v14
    s_waitcnt vmcnt(24)
    v_perm_b32 v236, v64, v60, s32
    v_perm_b32 v237, v72, v68, s32
    v_perm_b32 v238, v80, v76, s32
    v_perm_b32 v239, v88, v84, s32
    ds_write_b128 v5, v[236:239] offset:0
    v_perm_b32 v240, v64, v60, s33
    v_perm_b32 v241, v72, v68, s33
    v_perm_b32 v242, v80, v76, s33
    v_perm_b32 v243, v88, v84, s33
    ds_write_b128 v5, v[240:243] offset:8192
    v_perm_b32 v244, v65, v61, s32
    v_perm_b32 v245, v73, v69, s32
    v_perm_b32 v246, v81, v77, s32
    v_perm_b32 v247, v89, v85, s32
    ds_write_b128 v5, v[244:247] offset:16384
    v_perm_b32 v248, v65, v61, s33
    v_perm_b32 v249, v73, v69, s33
    v_perm_b32 v250, v81, v77, s33
    v_perm_b32 v251, v89, v85, s33
    ds_write_b128 v5, v[248:251] offset:24576
    v_perm_b32 v236, v66, v62, s32
    v_perm_b32 v237, v74, v70, s32
    v_perm_b32 v238, v82, v78, s32
    v_perm_b32 v239, v90, v86, s32
    ds_write_b128 v5, v[236:239] offset:32768
    v_perm_b32 v240, v66, v62, s33
    v_perm_b32 v241, v74, v70, s33
    v_perm_b32 v242, v82, v78, s33
    v_perm_b32 v243, v90, v86, s33
    ds_write_b128 v5, v[240:243] offset:40960
    v_perm_b32 v244, v67, v63, s32
    v_perm_b32 v245, v75, v71, s32
    v_perm_b32 v246, v83, v79, s32
    v_perm_b32 v247, v91, v87, s32
    ds_write_b128 v5, v[244:247] offset:49152
    v_perm_b32 v248, v67, v63, s33
    v_perm_b32 v249, v75, v71, s33
    v_perm_b32 v250, v83, v79, s33
    v_perm_b32 v251, v91, v87, s33
    ds_write_b128 v5, v[248:251] offset:57344
    s_waitcnt vmcnt(16)
    v_perm_b32 v236, v96, v92, s32
    v_perm_b32 v237, v104, v100, s32
    v_perm_b32 v238, v112, v108, s32
    v_perm_b32 v239, v120, v116, s32
    ds_write_b128 v5, v[236:239] offset:512
    v_perm_b32 v240, v96, v92, s33
    v_perm_b32 v241, v104, v100, s33
    v_perm_b32 v242, v112, v108, s33
    v_perm_b32 v243, v120, v116, s33
    ds_write_b128 v5, v[240:243] offset:8704
    v_perm_b32 v244, v97, v93, s32
    v_perm_b32 v245, v105, v101, s32
    v_perm_b32 v246, v113, v109, s32
    v_perm_b32 v247, v121, v117, s32
    ds_write_b128 v5, v[244:247] offset:16896
    v_perm_b32 v248, v97, v93, s33
    v_perm_b32 v249, v105, v101, s33
    v_perm_b32 v250, v113, v109, s33
    v_perm_b32 v251, v121, v117, s33
    ds_write_b128 v5, v[248:251] offset:25088
    v_perm_b32 v236, v98, v94, s32
    v_perm_b32 v237, v106, v102, s32
    v_perm_b32 v238, v114, v110, s32
    v_perm_b32 v239, v122, v118, s32
    ds_write_b128 v5, v[236:239] offset:33280
    v_perm_b32 v240, v98, v94, s33
    v_perm_b32 v241, v106, v102, s33
    v_perm_b32 v242, v114, v110, s33
    v_perm_b32 v243, v122, v118, s33
    ds_write_b128 v5, v[240:243] offset:41472
    v_perm_b32 v244, v99, v95, s32
    v_perm_b32 v245, v107, v103, s32
    v_perm_b32 v246, v115, v111, s32
    v_perm_b32 v247, v123, v119, s32
    ds_write_b128 v5, v[244:247] offset:49664
    v_perm_b32 v248, v99, v95, s33
    v_perm_b32 v249, v107, v103, s33
    v_perm_b32 v250, v115, v111, s33
    v_perm_b32 v251, v123, v119, s33
    ds_write_b128 v5, v[248:251] offset:57856
    s_waitcnt vmcnt(8)
    v_perm_b32 v236, v128, v124, s32
    v_perm_b32 v237, v136, v132, s32
    v_perm_b32 v238, v144, v140, s32
    v_perm_b32 v239, v152, v148, s32
    ds_write_b128 v5, v[236:239] offset:1024
    v_perm_b32 v240, v128, v124, s33
    v_perm_b32 v241, v136, v132, s33
    v_perm_b32 v242, v144, v140, s33
    v_perm_b32 v243, v152, v148, s33
    ds_write_b128 v5, v[240:243] offset:9216
    v_perm_b32 v244, v129, v125, s32
    v_perm_b32 v245, v137, v133, s32
    v_perm_b32 v246, v145, v141, s32
    v_perm_b32 v247, v153, v149, s32
    ds_write_b128 v5, v[244:247] offset:17408
    v_perm_b32 v248, v129, v125, s33
    v_perm_b32 v249, v137, v133, s33
    v_perm_b32 v250, v145, v141, s33
    v_perm_b32 v251, v153, v149, s33
    ds_write_b128 v5, v[248:251] offset:25600
    v_perm_b32 v236, v130, v126, s32
    v_perm_b32 v237, v138, v134, s32
    v_perm_b32 v238, v146, v142, s32
    v_perm_b32 v239, v154, v150, s32
    ds_write_b128 v5, v[236:239] offset:33792
    v_perm_b32 v240, v130, v126, s33
    v_perm_b32 v241, v138, v134, s33
    v_perm_b32 v242, v146, v142, s33
    v_perm_b32 v243, v154, v150, s33
    ds_write_b128 v5, v[240:243] offset:41984
    v_perm_b32 v244, v131, v127, s32
    v_perm_b32 v245, v139, v135, s32
    v_perm_b32 v246, v147, v143, s32
    v_perm_b32 v247, v155, v151, s32
    ds_write_b128 v5, v[244:247] offset:50176
    v_perm_b32 v248, v131, v127, s33
    v_perm_b32 v249, v139, v135, s33
    v_perm_b32 v250, v147, v143, s33
    v_perm_b32 v251, v155, v151, s33
    ds_write_b128 v5, v[248:251] offset:58368
    s_waitcnt vmcnt(0)
    v_perm_b32 v236, v160, v156, s32
    v_perm_b32 v237, v168, v164, s32
    v_perm_b32 v238, v176, v172, s32
    v_perm_b32 v239, v184, v180, s32
    ds_write_b128 v5, v[236:239] offset:1536
    v_perm_b32 v240, v160, v156, s33
    v_perm_b32 v241, v168, v164, s33
    v_perm_b32 v242, v176, v172, s33
    v_perm_b32 v243, v184, v180, s33
    ds_write_b128 v5, v[240:243] offset:9728
    v_perm_b32 v244, v161, v157, s32
    v_perm_b32 v245, v169, v165, s32
    v_perm_b32 v246, v177, v173, s32
    v_perm_b32 v247, v185, v181, s32
    ds_write_b128 v5, v[244:247] offset:17920
    v_perm_b32 v248, v161, v157, s33
    v_perm_b32 v249, v169, v165, s33
    v_perm_b32 v250, v177, v173, s33
    v_perm_b32 v251, v185, v181, s33
    ds_write_b128 v5, v[248:251] offset:26112
    v_perm_b32 v236, v162, v158, s32
    v_perm_b32 v237, v170, v166, s32
    v_perm_b32 v238, v178, v174, s32
    v_perm_b32 v239, v186, v182, s32
    ds_write_b128 v5, v[236:239] offset:34304
    v_perm_b32 v240, v162, v158, s33
    v_perm_b32 v241, v170, v166, s33
    v_perm_b32 v242, v178, v174, s33
    v_perm_b32 v243, v186, v182, s33
    ds_write_b128 v5, v[240:243] offset:42496
    v_perm_b32 v244, v163, v159, s32
    v_perm_b32 v245, v171, v167, s32
    v_perm_b32 v246, v179, v175, s32
    v_perm_b32 v247, v187, v183, s32
    ds_write_b128 v5, v[244:247] offset:50688
    v_perm_b32 v248, v163, v159, s33
    v_perm_b32 v249, v171, v167, s33
    v_perm_b32 v250, v179, v175, s33
    v_perm_b32 v251, v187, v183, s33
    ds_write_b128 v5, v[248:251] offset:58880
    v_mul_u32_u24 v15, 2176, v10
    v_lshl_add_u32 v15, v11, 4, v15
    v_lshlrev_b32 v18, 12, v11
    v_lshl_add_u32 v18, v10, 4, v18
    s_mul_i32 s32, s93, 139776
    s_lshl_b32 s17, s16, 9
    s_add_u32 s32, s32, s17
    s_add_u32 s32, s32, 104857600
    s_add_u32 s33, s32, 64
    s_lshl_b32 s31, s93, 2
    s_add_u32 s31, s31, s16
    s_lshl_b32 s35, s16, 15
    s_mov_b32 s38, 0xffff0000
    s_mov_b32 s36, 0
    s_cmp_eq_u32 s31, 0
    s_cselect_b32 s37, 5, 4
    s_cselect_b32 s33, 1073741824, s33
    s_cselect_b32 s34, 1024, 1073741824
    v_and_b32 v8, 3, v1
    v_lshlrev_b32 v8, 7, v8
    s_lshl_b32 s17, s93, 9
    s_add_u32 s17, s17, 100745216
    v_add_u32 v8, s17, v8
    s_waitcnt lgkmcnt(0)
    s_mov_b32 s30, s92
F2_w:
    buffer_load_dword v5, v8, s[4:7], 0 offen sc1
    s_waitcnt vmcnt(0)
    v_cmp_gt_u32 vcc, 1, v5
    s_nop 0
    s_and_b32 s17, vcc_lo, 15
    s_cbranch_scc0 F2_w_ok
    s_cmp_ge_u32 s30, 1048576
    s_cselect_b32 s92, 1048576, s92
    s_cbranch_scc1 F2_w_ok
    s_add_u32 s30, s30, 1
    s_sleep 8
    s_branch F2_w
F2_w_ok:
    buffer_load_dwordx4 v[128:131], v15, s[4:7], s32 offen offset:0
    buffer_load_dwordx4 v[132:135], v15, s[4:7], s32 offen offset:32
    s_add_u32 s17, s32, 69632
    buffer_load_dwordx4 v[136:139], v15, s[4:7], s17 offen offset:0
    buffer_load_dwordx4 v[140:143], v15, s[4:7], s17 offen offset:32
    buffer_load_dwordx4 v[144:147], v15, s[4:7], s33 offen offset:0
    buffer_load_dwordx4 v[148:151], v15, s[4:7], s33 offen offset:32
    s_add_u32 s17, s33, 69632
    buffer_load_dwordx4 v[152:155], v15, s[4:7], s17 offen offset:0
    buffer_load_dwordx4 v[156:159], v15, s[4:7], s17 offen offset:32
    v_add_f32 v5, 0, v16
    v_mul_f32 v5, 973078528, v5
    v_add_f32 v6, 0, v17
    v_mul_f32 v6, v6, v5
    v_cos_f32 v160, v6
    v_sin_f32 v176, v6
    v_add_f32 v6, 1065353216, v17
    v_mul_f32 v6, v6, v5
    v_cos_f32 v161, v6
    v_sin_f32 v177, v6
    v_add_f32 v6, 1073741824, v17
    v_mul_f32 v6, v6, v5
    v_cos_f32 v162, v6
    v_sin_f32 v178, v6
    v_add_f32 v6, 1077936128, v17
    v_mul_f32 v6, v6, v5
    v_cos_f32 v163, v6
    v_sin_f32 v179, v6
    v_add_f32 v6, 1082130432, v17
    v_mul_f32 v6, v6, v5
    v_cos_f32 v164, v6
    v_sin_f32 v180, v6
    v_add_f32 v6, 1084227584, v17
    v_mul_f32 v6, v6, v5
    v_cos_f32 v165, v6
    v_sin_f32 v181, v6
    v_add_f32 v6, 1086324736, v17
    v_mul_f32 v6, v6, v5
    v_cos_f32 v166, v6
    v_sin_f32 v182, v6
    v_add_f32 v6, 1088421888, v17
    v_mul_f32 v6, v6, v5
    v_cos_f32 v167, v6
    v_sin_f32 v183, v6
    v_add_f32 v6, 1098907648, v17
    v_mul_f32 v6, v6, v5
    v_cos_f32 v168, v6
    v_sin_f32 v184, v6
    v_add_f32 v6, 1099431936, v17
    v_mul_f32 v6, v6, v5
    v_cos_f32 v169, v6
    v_sin_f32 v185, v6
    v_add_f32 v6, 1099956224, v17
    v_mul_f32 v6, v6, v5
    v_cos_f32 v170, v6
    v_sin_f32 v186, v6
    v_add_f32 v6, 1100480512, v17
    v_mul_f32 v6, v6, v5
    v_cos_f32 v171, v6
    v_sin_f32 v187, v6
    v_add_f32 v6, 1101004800, v17
    v_mul_f32 v6, v6, v5
    v_cos_f32 v172, v6
    v_sin_f32 v188, v6
    v_add_f32 v6, 1101529088, v17
    v_mul_f32 v6, v6, v5
    v_cos_f32 v173, v6
    v_sin_f32 v189, v6
    v_add_f32 v6, 1102053376, v17
    v_mul_f32 v6, v6, v5
    v_cos_f32 v174, v6
    v_sin_f32 v190, v6
    v_add_f32 v6, 1102577664, v17
    v_mul_f32 v6, v6, v5
    v_cos_f32 v175, v6
    v_sin_f32 v191, v6
    v_add_f32 v5, 1107296256, v16
    v_mul_f32 v5, 973078528, v5
    v_add_f32 v6, 0, v17
    v_mul_f32 v6, v6, v5
    v_cos_f32 v192, v6
    v_sin_f32 v208, v6
    v_add_f32 v6, 1065353216, v17
    v_mul_f32 v6, v6, v5
    v_cos_f32 v193, v6
    v_sin_f32 v209, v6
    v_add_f32 v6, 1073741824, v17
    v_mul_f32 v6, v6, v5
    v_cos_f32 v194, v6
    v_sin_f32 v210, v6
    v_add_f32 v6, 1077936128, v17
    v_mul_f32 v6, v6, v5
    v_cos_f32 v195, v6
    v_sin_f32 v211, v6
    v_add_f32 v6, 1082130432, v17
    v_mul_f32 v6, v6, v5
    v_cos_f32 v196, v6
    v_sin_f32 v212, v6
    v_add_f32 v6, 1084227584, v17
    v_mul_f32 v6, v6, v5
    v_cos_f32 v197, v6
    v_sin_f32 v213, v6
    v_add_f32 v6, 1086324736, v17
    v_mul_f32 v6, v6, v5
    v_cos_f32 v198, v6
    v_sin_f32 v214, v6
    v_add_f32 v6, 1088421888, v17
    v_mul_f32 v6, v6, v5
    v_cos_f32 v199, v6
    v_sin_f32 v215, v6
    v_add_f32 v6, 1098907648, v17
    v_mul_f32 v6, v6, v5
    v_cos_f32 v200, v6
    v_sin_f32 v216, v6
    v_add_f32 v6, 1099431936, v17
    v_mul_f32 v6, v6, v5
    v_cos_f32 v201, v6
    v_sin_f32 v217, v6
    v_add_f32 v6, 1099956224, v17
    v_mul_f32 v6, v6, v5
    v_cos_f32 v202, v6
    v_sin_f32 v218, v6
    v_add_f32 v6, 1100480512, v17
    v_mul_f32 v6, v6, v5
    v_cos_f32 v203, v6
    v_sin_f32 v219, v6
    v_add_f32 v6, 1101004800, v17
    v_mul_f32 v6, v6, v5
    v_cos_f32 v204, v6
    v_sin_f32 v220, v6
    v_add_f32 v6, 1101529088, v17
    v_mul_f32 v6, v6, v5
    v_cos_f32 v205, v6
    v_sin_f32 v221, v6
    v_add_f32 v6, 1102053376, v17
    v_mul_f32 v6, v6, v5
    v_cos_f32 v206, v6
    v_sin_f32 v222, v6
    v_add_f32 v6, 1102577664, v17
    v_mul_f32 v6, v6, v5
    v_cos_f32 v207, v6
    v_sin_f32 v223, v6
    v_add_f32 v5, 0, v16
    v_mul_f32 v5, 973078528, v5
    v_add_f32 v6, 1107296256, v17
    v_mul_f32 v6, v6, v5
    v_cos_f32 v224, v6
    v_sin_f32 v240, v6
    v_add_f32 v6, 1107558400, v17
    v_mul_f32 v6, v6, v5
    v_cos_f32 v225, v6
    v_sin_f32 v241, v6
    v_add_f32 v6, 1107820544, v17
    v_mul_f32 v6, v6, v5
    v_cos_f32 v226, v6
    v_sin_f32 v242, v6
    v_add_f32 v6, 1108082688, v17
    v_mul_f32 v6, v6, v5
    v_cos_f32 v227, v6
    v_sin_f32 v243, v6
    v_add_f32 v6, 1108344832, v17
    v_mul_f32 v6, v6, v5
    v_cos_f32 v228, v6
    v_sin_f32 v244, v6
    v_add_f32 v6, 1108606976, v17
    v_mul_f32 v6, v6, v5
    v_cos_f32 v229, v6
    v_sin_f32 v245, v6
    v_add_f32 v6, 1108869120, v17
    v_mul_f32 v6, v6, v5
    v_cos_f32 v230, v6
    v_sin_f32 v246, v6
    v_add_f32 v6, 1109131264, v17
    v_mul_f32 v6, v6, v5
    v_cos_f32 v231, v6
    v_sin_f32 v247, v6
    v_add_f32 v6, 1111490560, v17
    v_mul_f32 v6, v6, v5
    v_cos_f32 v232, v6
    v_sin_f32 v248, v6
    v_add_f32 v6, 1111752704, v17
    v_mul_f32 v6, v6, v5
    v_cos_f32 v233, v6
    v_sin_f32 v249, v6
    v_add_f32 v6, 1112014848, v17
    v_mul_f32 v6, v6, v5
    v_cos_f32 v234, v6
    v_sin_f32 v250, v6
    v_add_f32 v6, 1112276992, v17
    v_mul_f32 v6, v6, v5
    v_cos_f32 v235, v6
    v_sin_f32 v251, v6
    v_add_f32 v6, 1112539136, v17
    v_mul_f32 v6, v6, v5
    v_cos_f32 v236, v6
    v_sin_f32 v252, v6
    v_add_f32 v6, 1112801280, v17
    v_mul_f32 v6, v6, v5
    v_cos_f32 v237, v6
    v_sin_f32 v253, v6
    v_add_f32 v6, 1113063424, v17
    v_mul_f32 v6, v6, v5
    v_cos_f32 v238, v6
    v_sin_f32 v254, v6
    v_add_f32 v6, 1113325568, v17
    v_mul_f32 v6, v6, v5
    v_cos_f32 v239, v6
    v_sin_f32 v255, v6
    s_barrier
.p2align 6
F2_top:
    s_waitcnt vmcnt(0)
    v_mfma_f32_32x32x16_bf16 v[32:47], v[128:131], a[0:3], 0
    v_mfma_f32_32x32x16_bf16 v[48:63], v[144:147], a[0:3], 0
    v_mfma_f32_32x32x16_bf16 v[32:47], v[144:147], a[32:35], v[32:47]
    ds_write_b128 v13, a[248:251]
    v_mfma_f32_32x32x16_bf16 v[48:63], v[128:131], a[64:67], v[48:63]
    ds_write_b128 v13, a[252:255] offset:1024
    ds_write_b16 v13, v2 offset:2
    v_mfma_f32_32x32x16_bf16 v[32:47], v[132:135], a[4:7], v[32:47]
    ds_write_b16 v13, v3 offset:1026
    v_mfma_f32_32x32x16_bf16 v[48:63], v[148:151], a[4:7], v[48:63]
    ds_write_b16 v13, v4 offset:6
    ds_write_b16 v13, v7 offset:1030
    v_mfma_f32_32x32x16_bf16 v[32:47], v[148:151], a[36:39], v[32:47]
    ds_write_b16 v13, v8 offset:10
    v_mfma_f32_32x32x16_bf16 v[48:63], v[132:135], a[68:71], v[48:63]
    ds_write_b16 v13, v10 offset:1034
    ds_write_b16 v13, v11 offset:14
    v_mfma_f32_32x32x16_bf16 v[32:47], v[136:139], a[8:11], v[32:47]
    ds_write_b16 v13, v16 offset:1038
    v_mfma_f32_32x32x16_bf16 v[48:63], v[152:155], a[8:11], v[48:63]
    v_add_u32 v13, 2048, v13
    s_add_u32 s36, s36, 1
    v_mfma_f32_32x32x16_bf16 v[32:47], v[152:155], a[40:43], v[32:47]
    s_add_u32 s32, s32, 128
    v_mfma_f32_32x32x16_bf16 v[48:63], v[136:139], a[72:75], v[48:63]
    s_add_u32 s33, s32, 64
    s_cmp_eq_u32 s36, 4
    v_mfma_f32_32x32x16_bf16 v[32:47], v[140:143], a[12:15], v[32:47]
    s_cselect_b32 s32, 104857664, s32
    v_mfma_f32_32x32x16_bf16 v[48:63], v[156:159], a[12:15], v[48:63]
    s_cselect_b32 s33, 1073741824, s33
    s_cmp_lt_u32 s36, s37
    v_mfma_f32_32x32x16_bf16 v[32:47], v[156:159], a[44:47], v[32:47]
    s_cselect_b32 s32, s32, 1073741824
    v_mfma_f32_32x32x16_bf16 v[48:63], v[140:143], a[76:79], v[48:63]
    s_cselect_b32 s33, s33, 1073741824
    v_add_u32 v19, s35, v14
    v_mfma_f32_32x32x16_bf16 v[64:79], v[128:131], a[16:19], 0
    v_mfma_f32_32x32x16_bf16 v[80:95], v[144:147], a[16:19], 0
    s_add_u32 s18, s34, 0
    buffer_load_ushort a248, v12, s[48:51], s18 offen
    buffer_load_ushort v2, v12, s[52:55], s18 offen
    v_mfma_f32_32x32x16_bf16 v[64:79], v[144:147], a[48:51], v[64:79]
    v_mul_f32 v20, v32, v160
    s_nop 0
    v_mul_f32 v22, v48, v160
    v_mul_f32 v21, v33, v161
    v_mul_f32 v23, v49, v161
    v_fma_f32 v20, v48, v176, v20
    v_mfma_f32_32x32x16_bf16 v[80:95], v[128:131], a[80:83], v[80:95]
    v_fma_f32 v22, -v32, v176, v22
    v_fma_f32 v21, v49, v177, v21
    v_fma_f32 v23, -v33, v177, v23
    v_cvt_pk_bf16_f32 v96, v20, v21
    v_cvt_pk_bf16_f32 v112, v22, v23
    v_mul_f32 v24, v34, v162
    v_mfma_f32_32x32x16_bf16 v[64:79], v[132:135], a[20:23], v[64:79]
    v_mul_f32 v26, v50, v162
    v_mul_f32 v25, v35, v163
    v_mul_f32 v27, v51, v163
    v_fma_f32 v24, v50, v178, v24
    v_fma_f32 v26, -v34, v178, v26
    v_fma_f32 v25, v51, v179, v25
    v_mfma_f32_32x32x16_bf16 v[80:95], v[148:151], a[20:23], v[80:95]
    v_fma_f32 v27, -v35, v179, v27
    v_cvt_pk_bf16_f32 v97, v24, v25
    v_cvt_pk_bf16_f32 v113, v26, v27
    v_mul_f32 v20, v36, v164
    v_mul_f32 v22, v52, v164
    v_mfma_f32_32x32x16_bf16 v[64:79], v[148:151], a[52:55], v[64:79]
    v_mul_f32 v21, v37, v165
    v_mul_f32 v23, v53, v165
    v_fma_f32 v20, v52, v180, v20
    v_fma_f32 v22, -v36, v180, v22
    v_fma_f32 v21, v53, v181, v21
    v_fma_f32 v23, -v37, v181, v23
    v_mfma_f32_32x32x16_bf16 v[80:95], v[132:135], a[84:87], v[80:95]
    v_cvt_pk_bf16_f32 v98, v20, v21
    v_cvt_pk_bf16_f32 v114, v22, v23
    v_mul_f32 v24, v38, v166
    v_mul_f32 v26, v54, v166
    v_mul_f32 v25, v39, v167
    v_mul_f32 v27, v55, v167
    v_mfma_f32_32x32x16_bf16 v[64:79], v[136:139], a[24:27], v[64:79]
    v_fma_f32 v24, v54, v182, v24
    v_fma_f32 v26, -v38, v182, v26
    v_fma_f32 v25, v55, v183, v25
    v_fma_f32 v27, -v39, v183, v27
    v_cvt_pk_bf16_f32 v99, v24, v25
    v_cvt_pk_bf16_f32 v115, v26, v27
    v_mfma_f32_32x32x16_bf16 v[80:95], v[152:155], a[24:27], v[80:95]
    v_mul_f32 v20, v40, v168
    v_mul_f32 v22, v56, v168
    v_mul_f32 v21, v41, v169
    v_mul_f32 v23, v57, v169
    v_fma_f32 v20, v56, v184, v20
    v_mfma_f32_32x32x16_bf16 v[64:79], v[152:155], a[56:59], v[64:79]
    v_fma_f32 v22, -v40, v184, v22
    v_fma_f32 v21, v57, v185, v21
    v_fma_f32 v23, -v41, v185, v23
    v_cvt_pk_bf16_f32 v100, v20, v21
    v_cvt_pk_bf16_f32 v116, v22, v23
    v_mul_f32 v24, v42, v170
    v_mfma_f32_32x32x16_bf16 v[80:95], v[136:139], a[88:91], v[80:95]
    v_mul_f32 v26, v58, v170
    v_mul_f32 v25, v43, v171
    v_mul_f32 v27, v59, v171
    v_fma_f32 v24, v58, v186, v24
    v_fma_f32 v26, -v42, v186, v26
    v_fma_f32 v25, v59, v187, v25
    v_mfma_f32_32x32x16_bf16 v[64:79], v[140:143], a[28:31], v[64:79]
    v_fma_f32 v27, -v43, v187, v27
    v_cvt_pk_bf16_f32 v101, v24, v25
    v_cvt_pk_bf16_f32 v117, v26, v27
    v_mul_f32 v20, v44, v172
    v_mul_f32 v22, v60, v172
    v_mfma_f32_32x32x16_bf16 v[80:95], v[156:159], a[28:31], v[80:95]
    v_mul_f32 v21, v45, v173
    v_mul_f32 v23, v61, v173
    v_fma_f32 v20, v60, v188, v20
    v_fma_f32 v22, -v44, v188, v22
    v_fma_f32 v21, v61, v189, v21
    v_fma_f32 v23, -v45, v189, v23
    v_mfma_f32_32x32x16_bf16 v[64:79], v[156:159], a[60:63], v[64:79]
    v_cvt_pk_bf16_f32 v102, v20, v21
    v_cvt_pk_bf16_f32 v118, v22, v23
    v_mul_f32 v24, v46, v174
    v_mul_f32 v26, v62, v174
    v_mul_f32 v25, v47, v175
    v_mul_f32 v27, v63, v175
    v_mfma_f32_32x32x16_bf16 v[80:95], v[140:143], a[92:95], v[80:95]
    v_fma_f32 v24, v62, v190, v24
    v_fma_f32 v26, -v46, v190, v26
    v_fma_f32 v25, v63, v191, v25
    v_fma_f32 v27, -v47, v191, v27
    v_cvt_pk_bf16_f32 v103, v24, v25
    v_cvt_pk_bf16_f32 v119, v26, v27
    v_mfma_f32_32x32x16_bf16 v[32:47], a[96:99], v[96:99], 0
    buffer_load_dwordx4 v[128:131], v15, s[4:7], s32 offen offset:0
    v_mfma_f32_32x32x16_bf16 v[48:63], a[96:99], v[112:115], 0
    buffer_load_dwordx4 v[132:135], v15, s[4:7], s32 offen offset:32
    v_mfma_f32_32x32x16_bf16 v[32:47], a[104:107], v[112:115], v[32:47]
    s_add_u32 s17, s32, 69632
    buffer_load_dwordx4 v[136:139], v15, s[4:7], s17 offen offset:0
    v_mul_f32 v20, v64, v192
    v_mul_f32 v22, v80, v192
    v_mul_f32 v21, v65, v193
    v_mul_f32 v23, v81, v193
    v_fma_f32 v20, v80, v208, v20
    v_fma_f32 v22, -v64, v208, v22
    v_fma_f32 v21, v81, v209, v21
    v_fma_f32 v23, -v65, v209, v23
    v_cvt_pk_bf16_f32 v104, v20, v21
    v_cvt_pk_bf16_f32 v120, v22, v23
    v_mul_f32 v24, v66, v194
    v_mul_f32 v26, v82, v194
    v_mul_f32 v25, v67, v195
    v_mfma_f32_32x32x16_bf16 v[48:63], a[112:115], v[96:99], v[48:63]
    buffer_load_dwordx4 v[140:143], v15, s[4:7], s17 offen offset:32
    v_mul_f32 v27, v83, v195
    v_fma_f32 v24, v82, v210, v24
    v_fma_f32 v26, -v66, v210, v26
    v_fma_f32 v25, v83, v211, v25
    v_fma_f32 v27, -v67, v211, v27
    v_cvt_pk_bf16_f32 v105, v24, v25
    v_cvt_pk_bf16_f32 v121, v26, v27
    v_mul_f32 v20, v68, v196
    v_mul_f32 v22, v84, v196
    v_mul_f32 v21, v69, v197
    v_mul_f32 v23, v85, v197
    v_fma_f32 v20, v84, v212, v20
    v_fma_f32 v22, -v68, v212, v22
    v_mfma_f32_32x32x16_bf16 v[32:47], a[100:103], v[100:103], v[32:47]
    buffer_load_dwordx4 v[144:147], v15, s[4:7], s33 offen offset:0
    v_fma_f32 v21, v85, v213, v21
    v_fma_f32 v23, -v69, v213, v23
    v_cvt_pk_bf16_f32 v106, v20, v21
    v_cvt_pk_bf16_f32 v122, v22, v23
    v_mul_f32 v24, v70, v198
    v_mul_f32 v26, v86, v198
    v_mul_f32 v25, v71, v199
    v_mul_f32 v27, v87, v199
    v_fma_f32 v24, v86, v214, v24
    v_fma_f32 v26, -v70, v214, v26
    v_fma_f32 v25, v87, v215, v25
    v_fma_f32 v27, -v71, v215, v27
    v_cvt_pk_bf16_f32 v107, v24, v25
    v_cvt_pk_bf16_f32 v123, v26, v27
    v_mfma_f32_32x32x16_bf16 v[48:63], a[100:103], v[116:119], v[48:63]
    buffer_load_dwordx4 v[148:151], v15, s[4:7], s33 offen offset:32
    v_mul_f32 v20, v72, v200
    v_mul_f32 v22, v88, v200
    v_mul_f32 v21, v73, v201
    v_mul_f32 v23, v89, v201
    v_fma_f32 v20, v88, v216, v20
    v_fma_f32 v22, -v72, v216, v22
    v_fma_f32 v21, v89, v217, v21
    v_fma_f32 v23, -v73, v217, v23
    v_cvt_pk_bf16_f32 v108, v20, v21
    v_cvt_pk_bf16_f32 v124, v22, v23
    v_mul_f32 v24, v74, v202
    v_mul_f32 v26, v90, v202
    v_mul_f32 v25, v75, v203
    v_mfma_f32_32x32x16_bf16 v[32:47], a[108:111], v[116:119], v[32:47]
    s_add_u32 s17, s33, 69632
    buffer_load_dwordx4 v[152:155], v15, s[4:7], s17 offen offset:0
    v_mul_f32 v27, v91, v203
    v_fma_f32 v24, v90, v218, v24
    v_fma_f32 v26, -v74, v218, v26
    v_fma_f32 v25, v91, v219, v25
    v_fma_f32 v27, -v75, v219, v27
    v_cvt_pk_bf16_f32 v109, v24, v25
    v_cvt_pk_bf16_f32 v125, v26, v27
    v_mul_f32 v20, v76, v204
    v_mul_f32 v22, v92, v204
    v_mul_f32 v21, v77, v205
    v_mul_f32 v23, v93, v205
    v_fma_f32 v20, v92, v220, v20
    v_fma_f32 v22, -v76, v220, v22
    v_mfma_f32_32x32x16_bf16 v[48:63], a[116:119], v[100:103], v[48:63]
    buffer_load_dwordx4 v[156:159], v15, s[4:7], s17 offen offset:32
    s_nop 1
    ds_read_b128 v[96:99], v19 offset:0
    ds_read_b128 v[112:115], v19 offset:1024
    ds_read_b128 v[100:103], v19 offset:2048
    ds_read_b128 v[116:119], v19 offset:3072
    v_fma_f32 v21, v93, v221, v21
    v_fma_f32 v23, -v77, v221, v23
    v_cvt_pk_bf16_f32 v110, v20, v21
    v_cvt_pk_bf16_f32 v126, v22, v23
    v_mul_f32 v24, v78, v206
    v_mul_f32 v26, v94, v206
    v_mul_f32 v25, v79, v207
    v_mul_f32 v27, v95, v207
    v_fma_f32 v24, v94, v222, v24
    v_fma_f32 v26, -v78, v222, v26
    v_fma_f32 v25, v95, v223, v25
    v_fma_f32 v27, -v79, v223, v27
    v_cvt_pk_bf16_f32 v111, v24, v25
    v_cvt_pk_bf16_f32 v127, v26, v27
    v_mfma_f32_32x32x16_bf16 v[64:79], a[96:99], v[104:107], 0
    v_mfma_f32_32x32x16_bf16 v[80:95], a[96:99], v[120:123], 0
    s_add_u32 s18, s34, 65664
    buffer_load_ushort a252, v12, s[48:51], s18 offen
    buffer_load_ushort v3, v12, s[52:55], s18 offen
    v_mfma_f32_32x32x16_bf16 v[64:79], a[104:107], v[120:123], v[64:79]
    s_waitcnt lgkmcnt(0)
    v_lshlrev_b32 v28, 16, v96
    v_and_b32 v30, s38, v96
    v_lshlrev_b32 v29, 16, v112
    v_and_b32 v31, s38, v112
    v_mul_f32 v20, v32, v28
    v_mul_f32 v22, v48, v28
    v_mul_f32 v21, v33, v29
    v_mul_f32 v23, v49, v29
    v_fma_f32 v20, -v48, v30, v20
    v_fma_f32 v22, v32, v30, v22
    v_fma_f32 v21, -v49, v31, v21
    v_fma_f32 v23, v33, v31, v23
    v_cvt_pk_bf16_f32 v96, v20, v21
    v_cvt_pk_bf16_f32 v112, v22, v23
    v_lshlrev_b32 v28, 16, v97
    v_and_b32 v30, s38, v97
    v_lshlrev_b32 v29, 16, v113
    v_mfma_f32_32x32x16_bf16 v[80:95], a[112:115], v[104:107], v[80:95]
    v_and_b32 v31, s38, v113
    v_mul_f32 v24, v34, v28
    v_mul_f32 v26, v50, v28
    v_mul_f32 v25, v35, v29
    v_mul_f32 v27, v51, v29
    v_fma_f32 v24, -v50, v30, v24
    v_fma_f32 v26, v34, v30, v26
    v_fma_f32 v25, -v51, v31, v25
    v_fma_f32 v27, v35, v31, v27
    v_cvt_pk_bf16_f32 v97, v24, v25
    v_cvt_pk_bf16_f32 v113, v26, v27
    v_lshlrev_b32 v28, 16, v98
    v_and_b32 v30, s38, v98
    v_lshlrev_b32 v29, 16, v114
    v_and_b32 v31, s38, v114
    v_mul_f32 v20, v36, v28
    v_mul_f32 v22, v52, v28
    v_mul_f32 v21, v37, v29
    v_mul_f32 v23, v53, v29
    v_mfma_f32_32x32x16_bf16 v[64:79], a[100:103], v[108:111], v[64:79]
    v_fma_f32 v20, -v52, v30, v20
    v_fma_f32 v22, v36, v30, v22
    v_fma_f32 v21, -v53, v31, v21
    v_fma_f32 v23, v37, v31, v23
    v_cvt_pk_bf16_f32 v98, v20, v21
    v_cvt_pk_bf16_f32 v114, v22, v23
    v_lshlrev_b32 v28, 16, v99
    v_and_b32 v30, s38, v99
    v_lshlrev_b32 v29, 16, v115
    v_and_b32 v31, s38, v115
    v_mul_f32 v24, v38, v28
    v_mul_f32 v26, v54, v28
    v_mul_f32 v25, v39, v29
    v_mul_f32 v27, v55, v29
    v_fma_f32 v24, -v54, v30, v24
    v_fma_f32 v26, v38, v30, v26
    v_fma_f32 v25, -v55, v31, v25
    v_fma_f32 v27, v39, v31, v27
    v_cvt_pk_bf16_f32 v99, v24, v25
    v_mfma_f32_32x32x16_bf16 v[80:95], a[100:103], v[124:127], v[80:95]
    v_cvt_pk_bf16_f32 v115, v26, v27
    v_lshlrev_b32 v28, 16, v100
    v_and_b32 v30, s38, v100
    v_lshlrev_b32 v29, 16, v116
    v_and_b32 v31, s38, v116
    v_mul_f32 v20, v40, v28
    v_mul_f32 v22, v56, v28
    v_mul_f32 v21, v41, v29
    v_mul_f32 v23, v57, v29
    v_fma_f32 v20, -v56, v30, v20
    v_fma_f32 v22, v40, v30, v22
    v_fma_f32 v21, -v57, v31, v21
    v_fma_f32 v23, v41, v31, v23
    v_cvt_pk_bf16_f32 v100, v20, v21
    v_cvt_pk_bf16_f32 v116, v22, v23
    v_lshlrev_b32 v28, 16, v101
    v_and_b32 v30, s38, v101
    v_lshlrev_b32 v29, 16, v117
    v_and_b32 v31, s38, v117
    v_mfma_f32_32x32x16_bf16 v[64:79], a[108:111], v[124:127], v[64:79]
    v_mul_f32 v24, v42, v28
    v_mul_f32 v26, v58, v28
    v_mul_f32 v25, v43, v29
    v_mul_f32 v27, v59, v29
    v_fma_f32 v24, -v58, v30, v24
    v_fma_f32 v26, v42, v30, v26
    v_fma_f32 v25, -v59, v31, v25
    v_fma_f32 v27, v43, v31, v27
    v_cvt_pk_bf16_f32 v101, v24, v25
    v_cvt_pk_bf16_f32 v117, v26, v27
    v_lshlrev_b32 v28, 16, v102
    v_and_b32 v30, s38, v102
    v_lshlrev_b32 v29, 16, v118
    v_and_b32 v31, s38, v118
    v_mul_f32 v20, v44, v28
    v_mul_f32 v22, v60, v28
    v_mul_f32 v21, v45, v29
    v_mul_f32 v23, v61, v29
    v_fma_f32 v20, -v60, v30, v20
    v_mfma_f32_32x32x16_bf16 v[80:95], a[116:119], v[108:111], v[80:95]
    s_nop 1
    ds_read_b128 v[104:107], v19 offset:4096
    ds_read_b128 v[120:123], v19 offset:5120
    ds_read_b128 v[108:111], v19 offset:6144
    ds_read_b128 v[124:127], v19 offset:7168
    v_fma_f32 v22, v44, v30, v22
    v_fma_f32 v21, -v61, v31, v21
    v_fma_f32 v23, v45, v31, v23
    v_cvt_pk_bf16_f32 v102, v20, v21
    v_cvt_pk_bf16_f32 v118, v22, v23
    v_lshlrev_b32 v28, 16, v103
    v_and_b32 v30, s38, v103
    v_lshlrev_b32 v29, 16, v119
    v_and_b32 v31, s38, v119
    v_mul_f32 v24, v46, v28
    v_mul_f32 v26, v62, v28
    v_mul_f32 v25, v47, v29
    v_mul_f32 v27, v63, v29
    v_fma_f32 v24, -v62, v30, v24
    v_fma_f32 v26, v46, v30, v26
    v_fma_f32 v25, -v63, v31, v25
    v_fma_f32 v27, v47, v31, v27
    v_cvt_pk_bf16_f32 v103, v24, v25
    v_cvt_pk_bf16_f32 v119, v26, v27
    v_mfma_f32_32x32x16_bf16 v[32:47], v[96:99], a[96:99], 0
    v_mfma_f32_32x32x16_bf16 v[48:63], v[112:115], a[96:99], 0
    s_add_u32 s18, s34, 131328
    buffer_load_ushort a249, v12, s[48:51], s18 offen
    buffer_load_ushort v4, v12, s[52:55], s18 offen
    v_mfma_f32_32x32x16_bf16 v[32:47], v[112:115], a[112:115], v[32:47]
    s_waitcnt lgkmcnt(0)
    v_lshlrev_b32 v28, 16, v104
    v_and_b32 v30, s38, v104
    v_lshlrev_b32 v29, 16, v120
    v_and_b32 v31, s38, v120
    v_mul_f32 v20, v64, v28
    v_mul_f32 v22, v80, v28
    v_mul_f32 v21, v65, v29
    v_mul_f32 v23, v81, v29
    v_fma_f32 v20, -v80, v30, v20
    v_fma_f32 v22, v64, v30, v22
    v_fma_f32 v21, -v81, v31, v21
    v_fma_f32 v23, v65, v31, v23
    v_cvt_pk_bf16_f32 v104, v20, v21
    v_cvt_pk_bf16_f32 v120, v22, v23
    v_lshlrev_b32 v28, 16, v105
    v_and_b32 v30, s38, v105
    v_lshlrev_b32 v29, 16, v121
    v_mfma_f32_32x32x16_bf16 v[48:63], v[96:99], a[104:107], v[48:63]
    v_and_b32 v31, s38, v121
    v_mul_f32 v24, v66, v28
    v_mul_f32 v26, v82, v28
    v_mul_f32 v25, v67, v29
    v_mul_f32 v27, v83, v29
    v_fma_f32 v24, -v82, v30, v24
    v_fma_f32 v26, v66, v30, v26
    v_fma_f32 v25, -v83, v31, v25
    v_fma_f32 v27, v67, v31, v27
    v_cvt_pk_bf16_f32 v105, v24, v25
    v_cvt_pk_bf16_f32 v121, v26, v27
    v_lshlrev_b32 v28, 16, v106
    v_and_b32 v30, s38, v106
    v_lshlrev_b32 v29, 16, v122
    v_and_b32 v31, s38, v122
    v_mul_f32 v20, v68, v28
    v_mul_f32 v22, v84, v28
    v_mul_f32 v21, v69, v29
    v_mul_f32 v23, v85, v29
    v_mfma_f32_32x32x16_bf16 v[32:47], v[100:103], a[100:103], v[32:47]
    v_fma_f32 v20, -v84, v30, v20
    v_fma_f32 v22, v68, v30, v22
    v_fma_f32 v21, -v85, v31, v21
    v_fma_f32 v23, v69, v31, v23
    v_cvt_pk_bf16_f32 v106, v20, v21
    v_cvt_pk_bf16_f32 v122, v22, v23
    v_lshlrev_b32 v28, 16, v107
    v_and_b32 v30, s38, v107
    v_lshlrev_b32 v29, 16, v123
    v_and_b32 v31, s38, v123
    v_mul_f32 v24, v70, v28
    v_mul_f32 v26, v86, v28
    v_mul_f32 v25, v71, v29
    v_mul_f32 v27, v87, v29
    v_fma_f32 v24, -v86, v30, v24
    v_fma_f32 v26, v70, v30, v26
    v_fma_f32 v25, -v87, v31, v25
    v_fma_f32 v27, v71, v31, v27
    v_cvt_pk_bf16_f32 v107, v24, v25
    v_mfma_f32_32x32x16_bf16 v[48:63], v[116:119], a[100:103], v[48:63]
    v_cvt_pk_bf16_f32 v123, v26, v27
    v_lshlrev_b32 v28, 16, v108
    v_and_b32 v30, s38, v108
    v_lshlrev_b32 v29, 16, v124
    v_and_b32 v31, s38, v124
    v_mul_f32 v20, v72, v28
    v_mul_f32 v22, v88, v28
    v_mul_f32 v21, v73, v29
    v_mul_f32 v23, v89, v29
    v_fma_f32 v20, -v88, v30, v20
    v_fma_f32 v22, v72, v30, v22
    v_fma_f32 v21, -v89, v31, v21
    v_fma_f32 v23, v73, v31, v23
    v_cvt_pk_bf16_f32 v108, v20, v21
    v_cvt_pk_bf16_f32 v124, v22, v23
    v_lshlrev_b32 v28, 16, v109
    v_and_b32 v30, s38, v109
    v_lshlrev_b32 v29, 16, v125
    v_and_b32 v31, s38, v125
    v_mfma_f32_32x32x16_bf16 v[32:47], v[116:119], a[116:119], v[32:47]
    v_mul_f32 v24, v74, v28
    v_mul_f32 v26, v90, v28
    v_mul_f32 v25, v75, v29
    v_mul_f32 v27, v91, v29
    v_fma_f32 v24, -v90, v30, v24
    v_fma_f32 v26, v74, v30, v26
    v_fma_f32 v25, -v91, v31, v25
    v_fma_f32 v27, v75, v31, v27
    v_cvt_pk_bf16_f32 v109, v24, v25
    v_cvt_pk_bf16_f32 v125, v26, v27
    v_lshlrev_b32 v28, 16, v110
    v_and_b32 v30, s38, v110
    v_lshlrev_b32 v29, 16, v126
    v_and_b32 v31, s38, v126
    v_mul_f32 v20, v76, v28
    v_mul_f32 v22, v92, v28
    v_mul_f32 v21, v77, v29
    v_mul_f32 v23, v93, v29
    v_fma_f32 v20, -v92, v30, v20
    v_mfma_f32_32x32x16_bf16 v[48:63], v[100:103], a[108:111], v[48:63]
    v_fma_f32 v22, v76, v30, v22
    v_fma_f32 v21, -v93, v31, v21
    v_fma_f32 v23, v77, v31, v23
    v_cvt_pk_bf16_f32 v110, v20, v21
    v_cvt_pk_bf16_f32 v126, v22, v23
    v_lshlrev_b32 v28, 16, v111
    v_and_b32 v30, s38, v111
    v_lshlrev_b32 v29, 16, v127
    v_and_b32 v31, s38, v127
    v_mul_f32 v24, v78, v28
    v_mul_f32 v26, v94, v28
    v_mul_f32 v25, v79, v29
    v_mul_f32 v27, v95, v29
    v_fma_f32 v24, -v94, v30, v24
    v_fma_f32 v26, v78, v30, v26
    v_fma_f32 v25, -v95, v31, v25
    v_fma_f32 v27, v79, v31, v27
    v_cvt_pk_bf16_f32 v111, v24, v25
    v_cvt_pk_bf16_f32 v127, v26, v27
    v_mfma_f32_32x32x16_bf16 v[64:79], v[104:107], a[96:99], 0
    v_mfma_f32_32x32x16_bf16 v[80:95], v[120:123], a[96:99], 0
    s_add_u32 s18, s34, 196992
    buffer_load_ushort a253, v12, s[48:51], s18 offen
    buffer_load_ushort v7, v12, s[52:55], s18 offen
    v_mfma_f32_32x32x16_bf16 v[64:79], v[120:123], a[112:115], v[64:79]
    v_mul_f32 v20, v32, v160
    v_mul_f32 v22, v48, v160
    v_mul_f32 v21, v33, v161
    v_mul_f32 v23, v49, v161
    v_fma_f32 v20, -v48, v176, v20
    v_fma_f32 v22, v32, v176, v22
    v_fma_f32 v21, -v49, v177, v21
    v_fma_f32 v23, v33, v177, v23
    v_cvt_pk_bf16_f32 v96, v20, v21
    v_cvt_pk_bf16_f32 v112, v22, v23
    v_mul_f32 v24, v34, v162
    v_mul_f32 v26, v50, v162
    v_mul_f32 v25, v35, v163
    v_mfma_f32_32x32x16_bf16 v[80:95], v[104:107], a[104:107], v[80:95]
    v_mul_f32 v27, v51, v163
    v_fma_f32 v24, -v50, v178, v24
    v_fma_f32 v26, v34, v178, v26
    v_fma_f32 v25, -v51, v179, v25
    v_fma_f32 v27, v35, v179, v27
    v_cvt_pk_bf16_f32 v97, v24, v25
    v_cvt_pk_bf16_f32 v113, v26, v27
    v_mul_f32 v20, v36, v164
    v_mul_f32 v22, v52, v164
    v_mul_f32 v21, v37, v165
    v_mul_f32 v23, v53, v165
    v_fma_f32 v20, -v52, v180, v20
    v_fma_f32 v22, v36, v180, v22
    v_mfma_f32_32x32x16_bf16 v[64:79], v[108:111], a[100:103], v[64:79]
    v_fma_f32 v21, -v53, v181, v21
    v_fma_f32 v23, v37, v181, v23
    v_cvt_pk_bf16_f32 v98, v20, v21
    v_cvt_pk_bf16_f32 v114, v22, v23
    v_mul_f32 v24, v38, v166
    v_mul_f32 v26, v54, v166
    v_mul_f32 v25, v39, v167
    v_mul_f32 v27, v55, v167
    v_fma_f32 v24, -v54, v182, v24
    v_fma_f32 v26, v38, v182, v26
    v_fma_f32 v25, -v55, v183, v25
    v_fma_f32 v27, v39, v183, v27
    v_cvt_pk_bf16_f32 v99, v24, v25
    v_cvt_pk_bf16_f32 v115, v26, v27
    v_mfma_f32_32x32x16_bf16 v[80:95], v[124:127], a[100:103], v[80:95]
    v_mul_f32 v20, v40, v168
    v_mul_f32 v22, v56, v168
    v_mul_f32 v21, v41, v169
    v_mul_f32 v23, v57, v169
    v_fma_f32 v20, -v56, v184, v20
    v_fma_f32 v22, v40, v184, v22
    v_fma_f32 v21, -v57, v185, v21
    v_fma_f32 v23, v41, v185, v23
    v_cvt_pk_bf16_f32 v100, v20, v21
    v_cvt_pk_bf16_f32 v116, v22, v23
    v_mul_f32 v24, v42, v170
    v_mul_f32 v26, v58, v170
    v_mul_f32 v25, v43, v171
    v_mfma_f32_32x32x16_bf16 v[64:79], v[124:127], a[116:119], v[64:79]
    v_mul_f32 v27, v59, v171
    v_fma_f32 v24, -v58, v186, v24
    v_fma_f32 v26, v42, v186, v26
    v_fma_f32 v25, -v59, v187, v25
    v_fma_f32 v27, v43, v187, v27
    v_cvt_pk_bf16_f32 v101, v24, v25
    v_cvt_pk_bf16_f32 v117, v26, v27
    v_mul_f32 v20, v44, v172
    v_mul_f32 v22, v60, v172
    v_mul_f32 v21, v45, v173
    v_mul_f32 v23, v61, v173
    v_fma_f32 v20, -v60, v188, v20
    v_fma_f32 v22, v44, v188, v22
    v_mfma_f32_32x32x16_bf16 v[80:95], v[108:111], a[108:111], v[80:95]
    v_fma_f32 v21, -v61, v189, v21
    v_fma_f32 v23, v45, v189, v23
    v_cvt_pk_bf16_f32 v102, v20, v21
    v_cvt_pk_bf16_f32 v118, v22, v23
    v_mul_f32 v24, v46, v174
    v_mul_f32 v26, v62, v174
    v_mul_f32 v25, v47, v175
    v_mul_f32 v27, v63, v175
    v_fma_f32 v24, -v62, v190, v24
    v_fma_f32 v26, v46, v190, v26
    v_fma_f32 v25, -v63, v191, v25
    v_fma_f32 v27, v47, v191, v27
    v_cvt_pk_bf16_f32 v103, v24, v25
    v_cvt_pk_bf16_f32 v119, v26, v27
    v_mfma_f32_32x32x16_bf16 v[32:47], a[0:3], v[96:99], 0
    v_mfma_f32_32x32x16_bf16 v[48:63], a[0:3], v[112:115], 0
    s_add_u32 s18, s34, 262656
    buffer_load_ushort a250, v12, s[48:51], s18 offen
    buffer_load_ushort v8, v12, s[52:55], s18 offen
    v_mfma_f32_32x32x16_bf16 v[32:47], a[64:67], v[112:115], v[32:47]
    v_mul_f32 v20, v64, v224
    v_mul_f32 v22, v80, v224
    v_mul_f32 v21, v65, v225
    v_mul_f32 v23, v81, v225
    v_fma_f32 v20, -v80, v240, v20
    v_fma_f32 v22, v64, v240, v22
    v_fma_f32 v21, -v81, v241, v21
    v_fma_f32 v23, v65, v241, v23
    v_cvt_pk_bf16_f32 v104, v20, v21
    v_cvt_pk_bf16_f32 v120, v22, v23
    v_mul_f32 v24, v66, v226
    v_mul_f32 v26, v82, v226
    v_mul_f32 v25, v67, v227
    v_mfma_f32_32x32x16_bf16 v[48:63], a[32:35], v[96:99], v[48:63]
    v_mul_f32 v27, v83, v227
    v_fma_f32 v24, -v82, v242, v24
    v_fma_f32 v26, v66, v242, v26
    v_fma_f32 v25, -v83, v243, v25
    v_fma_f32 v27, v67, v243, v27
    v_cvt_pk_bf16_f32 v105, v24, v25
    v_cvt_pk_bf16_f32 v121, v26, v27
    v_mul_f32 v20, v68, v228
    v_mul_f32 v22, v84, v228
    v_mul_f32 v21, v69, v229
    v_mul_f32 v23, v85, v229
    v_fma_f32 v20, -v84, v244, v20
    v_fma_f32 v22, v68, v244, v22
    v_mfma_f32_32x32x16_bf16 v[32:47], a[4:7], v[100:103], v[32:47]
    v_fma_f32 v21, -v85, v245, v21
    v_fma_f32 v23, v69, v245, v23
    v_cvt_pk_bf16_f32 v106, v20, v21
    v_cvt_pk_bf16_f32 v122, v22, v23
    v_mul_f32 v24, v70, v230
    v_mul_f32 v26, v86, v230
    v_mul_f32 v25, v71, v231
    v_mul_f32 v27, v87, v231
    v_fma_f32 v24, -v86, v246, v24
    v_fma_f32 v26, v70, v246, v26
    v_fma_f32 v25, -v87, v247, v25
    v_fma_f32 v27, v71, v247, v27
    v_cvt_pk_bf16_f32 v107, v24, v25
    v_cvt_pk_bf16_f32 v123, v26, v27
    v_mfma_f32_32x32x16_bf16 v[48:63], a[4:7], v[116:119], v[48:63]
    v_mul_f32 v20, v72, v232
    v_mul_f32 v22, v88, v232
    v_mul_f32 v21, v73, v233
    v_mul_f32 v23, v89, v233
    v_fma_f32 v20, -v88, v248, v20
    v_fma_f32 v22, v72, v248, v22
    v_fma_f32 v21, -v89, v249, v21
    v_fma_f32 v23, v73, v249, v23
    v_cvt_pk_bf16_f32 v108, v20, v21
    v_cvt_pk_bf16_f32 v124, v22, v23
    v_mul_f32 v24, v74, v234
    v_mul_f32 v26, v90, v234
    v_mul_f32 v25, v75, v235
    v_mfma_f32_32x32x16_bf16 v[32:47], a[68:71], v[116:119], v[32:47]
    v_mul_f32 v27, v91, v235
    v_fma_f32 v24, -v90, v250, v24
    v_fma_f32 v26, v74, v250, v26
    v_fma_f32 v25, -v91, v251, v25
    v_fma_f32 v27, v75, v251, v27
    v_cvt_pk_bf16_f32 v109, v24, v25
    v_cvt_pk_bf16_f32 v125, v26, v27
    v_mul_f32 v20, v76, v236
    v_mul_f32 v22, v92, v236
    v_mul_f32 v21, v77, v237
    v_mul_f32 v23, v93, v237
    v_fma_f32 v20, -v92, v252, v20
    v_fma_f32 v22, v76, v252, v22
    v_mfma_f32_32x32x16_bf16 v[48:63], a[36:39], v[100:103], v[48:63]
    v_fma_f32 v21, -v93, v253, v21
    v_fma_f32 v23, v77, v253, v23
    v_cvt_pk_bf16_f32 v110, v20, v21
    v_cvt_pk_bf16_f32 v126, v22, v23
    v_mul_f32 v24, v78, v238
    v_mul_f32 v26, v94, v238
    v_mul_f32 v25, v79, v239
    v_mul_f32 v27, v95, v239
    v_fma_f32 v24, -v94, v254, v24
    v_fma_f32 v26, v78, v254, v26
    v_fma_f32 v25, -v95, v255, v25
    v_fma_f32 v27, v79, v255, v27
    v_cvt_pk_bf16_f32 v111, v24, v25
    v_cvt_pk_bf16_f32 v127, v26, v27
    v_mfma_f32_32x32x16_bf16 v[32:47], a[8:11], v[104:107], v[32:47]
    s_add_u32 s18, s34, 328320
    buffer_load_ushort a254, v12, s[48:51], s18 offen
    buffer_load_ushort v10, v12, s[52:55], s18 offen
    v_mfma_f32_32x32x16_bf16 v[48:63], a[8:11], v[120:123], v[48:63]
    v_mfma_f32_32x32x16_bf16 v[32:47], a[72:75], v[120:123], v[32:47]
    v_mfma_f32_32x32x16_bf16 v[48:63], a[40:43], v[104:107], v[48:63]
    v_mfma_f32_32x32x16_bf16 v[32:47], a[12:15], v[108:111], v[32:47]
    s_add_u32 s18, s34, 393984
    buffer_load_ushort a251, v12, s[48:51], s18 offen
    buffer_load_ushort v11, v12, s[52:55], s18 offen
    v_mfma_f32_32x32x16_bf16 v[48:63], a[12:15], v[124:127], v[48:63]
    v_mfma_f32_32x32x16_bf16 v[32:47], a[76:79], v[124:127], v[32:47]
    v_mfma_f32_32x32x16_bf16 v[48:63], a[44:47], v[108:111], v[48:63]
    v_mfma_f32_32x32x16_bf16 v[64:79], a[16:19], v[96:99], 0
    s_add_u32 s18, s34, 459648
    buffer_load_ushort a255, v12, s[48:51], s18 offen
    buffer_load_ushort v16, v12, s[52:55], s18 offen
    v_mfma_f32_32x32x16_bf16 v[80:95], a[16:19], v[112:115], 0
    v_mfma_f32_32x32x16_bf16 v[64:79], a[80:83], v[112:115], v[64:79]
    s_nop 1
    v_cvt_pk_bf16_f32 v32, v32, v48
    v_mfma_f32_32x32x16_bf16 v[80:95], a[48:51], v[96:99], v[80:95]
    v_cvt_pk_bf16_f32 v33, v33, v49
    v_mfma_f32_32x32x16_bf16 v[64:79], a[20:23], v[100:103], v[64:79]
    v_cvt_pk_bf16_f32 v34, v34, v50
    v_mfma_f32_32x32x16_bf16 v[80:95], a[20:23], v[116:119], v[80:95]
    v_cvt_pk_bf16_f32 v35, v35, v51
    v_mfma_f32_32x32x16_bf16 v[64:79], a[84:87], v[116:119], v[64:79]
    v_cvt_pk_bf16_f32 v36, v36, v52
    v_mfma_f32_32x32x16_bf16 v[80:95], a[52:55], v[100:103], v[80:95]
    v_cvt_pk_bf16_f32 v37, v37, v53
    v_mfma_f32_32x32x16_bf16 v[64:79], a[24:27], v[104:107], v[64:79]
    v_cvt_pk_bf16_f32 v38, v38, v54
    v_cvt_pk_bf16_f32 v39, v39, v55
    v_mfma_f32_32x32x16_bf16 v[80:95], a[24:27], v[120:123], v[80:95]
    v_cvt_pk_bf16_f32 v40, v40, v56
    v_mfma_f32_32x32x16_bf16 v[64:79], a[88:91], v[120:123], v[64:79]
    v_cvt_pk_bf16_f32 v41, v41, v57
    v_mfma_f32_32x32x16_bf16 v[80:95], a[56:59], v[104:107], v[80:95]
    v_cvt_pk_bf16_f32 v42, v42, v58
    v_mfma_f32_32x32x16_bf16 v[64:79], a[28:31], v[108:111], v[64:79]
    v_cvt_pk_bf16_f32 v43, v43, v59
    v_mfma_f32_32x32x16_bf16 v[80:95], a[28:31], v[124:127], v[80:95]
    v_cvt_pk_bf16_f32 v44, v44, v60
    v_mfma_f32_32x32x16_bf16 v[64:79], a[92:95], v[124:127], v[64:79]
    v_cvt_pk_bf16_f32 v45, v45, v61
    v_mfma_f32_32x32x16_bf16 v[80:95], a[60:63], v[108:111], v[80:95]
    v_cvt_pk_bf16_f32 v46, v46, v62
    v_cvt_pk_bf16_f32 v47, v47, v63
    s_nop 9
    v_cvt_pk_bf16_f32 v64, v64, v80
    v_cvt_pk_bf16_f32 v65, v65, v81
    v_cvt_pk_bf16_f32 v66, v66, v82
    v_cvt_pk_bf16_f32 v67, v67, v83
    v_cvt_pk_bf16_f32 v68, v68, v84
    v_cvt_pk_bf16_f32 v69, v69, v85
    v_cvt_pk_bf16_f32 v70, v70, v86
    v_cvt_pk_bf16_f32 v71, v71, v87
    v_cvt_pk_bf16_f32 v72, v72, v88
    v_cvt_pk_bf16_f32 v73, v73, v89
    v_cvt_pk_bf16_f32 v74, v74, v90
    v_cvt_pk_bf16_f32 v75, v75, v91
    v_cvt_pk_bf16_f32 v76, v76, v92
    v_cvt_pk_bf16_f32 v77, v77, v93
    v_cvt_pk_bf16_f32 v78, v78, v94
    v_cvt_pk_bf16_f32 v79, v79, v95
    s_cmp_eq_u32 s36, 2
    s_cbranch_scc1 F2_o1
    s_cmp_eq_u32 s36, 3
    s_cbranch_scc1 F2_o2
    s_cmp_eq_u32 s36, 4
    s_cbranch_scc1 F2_o3
    s_cmp_eq_u32 s36, 5
    s_cbranch_scc1 F2_o4
    v_accvgpr_write_b32 a120, v32
    v_accvgpr_write_b32 a124, v33
    v_accvgpr_write_b32 a128, v34
    v_accvgpr_write_b32 a132, v35
    v_accvgpr_write_b32 a136, v36
    v_accvgpr_write_b32 a140, v37
    v_accvgpr_write_b32 a144, v38
    v_accvgpr_write_b32 a148, v39
    v_accvgpr_write_b32 a152, v40
    v_accvgpr_write_b32 a156, v41
    v_accvgpr_write_b32 a160, v42
    v_accvgpr_write_b32 a164, v43
    v_accvgpr_write_b32 a168, v44
    v_accvgpr_write_b32 a172, v45
    v_accvgpr_write_b32 a176, v46
    v_accvgpr_write_b32 a180, v47
    v_accvgpr_write_b32 a184, v64
    v_accvgpr_write_b32 a188, v65
    v_accvgpr_write_b32 a192, v66
    v_accvgpr_write_b32 a196, v67
    v_accvgpr_write_b32 a200, v68
    v_accvgpr_write_b32 a204, v69
    v_accvgpr_write_b32 a208, v70
    v_accvgpr_write_b32 a212, v71
    v_accvgpr_write_b32 a216, v72
    v_accvgpr_write_b32 a220, v73
    v_accvgpr_write_b32 a224, v74
    v_accvgpr_write_b32 a228, v75
    v_accvgpr_write_b32 a232, v76
    v_accvgpr_write_b32 a236, v77
    v_accvgpr_write_b32 a240, v78
    v_accvgpr_write_b32 a244, v79
    s_branch F2_nx
F2_o1:
    v_accvgpr_write_b32 a121, v32
    v_accvgpr_write_b32 a125, v33
    v_accvgpr_write_b32 a129, v34
    v_accvgpr_write_b32 a133, v35
    v_accvgpr_write_b32 a137, v36
    v_accvgpr_write_b32 a141, v37
    v_accvgpr_write_b32 a145, v38
    v_accvgpr_write_b32 a149, v39
    v_accvgpr_write_b32 a153, v40
    v_accvgpr_write_b32 a157, v41
    v_accvgpr_write_b32 a161, v42
    v_accvgpr_write_b32 a165, v43
    v_accvgpr_write_b32 a169, v44
    v_accvgpr_write_b32 a173, v45
    v_accvgpr_write_b32 a177, v46
    v_accvgpr_write_b32 a181, v47
    v_accvgpr_write_b32 a185, v64
    v_accvgpr_write_b32 a189, v65
    v_accvgpr_write_b32 a193, v66
    v_accvgpr_write_b32 a197, v67
    v_accvgpr_write_b32 a201, v68
    v_accvgpr_write_b32 a205, v69
    v_accvgpr_write_b32 a209, v70
    v_accvgpr_write_b32 a213, v71
    v_accvgpr_write_b32 a217, v72
    v_accvgpr_write_b32 a221, v73
    v_accvgpr_write_b32 a225, v74
    v_accvgpr_write_b32 a229, v75
    v_accvgpr_write_b32 a233, v76
    v_accvgpr_write_b32 a237, v77
    v_accvgpr_write_b32 a241, v78
    v_accvgpr_write_b32 a245, v79
    s_branch F2_nx
F2_o2:
    v_accvgpr_write_b32 a122, v32
    v_accvgpr_write_b32 a126, v33
    v_accvgpr_write_b32 a130, v34
    v_accvgpr_write_b32 a134, v35
    v_accvgpr_write_b32 a138, v36
    v_accvgpr_write_b32 a142, v37
    v_accvgpr_write_b32 a146, v38
    v_accvgpr_write_b32 a150, v39
    v_accvgpr_write_b32 a154, v40
    v_accvgpr_write_b32 a158, v41
    v_accvgpr_write_b32 a162, v42
    v_accvgpr_write_b32 a166, v43
    v_accvgpr_write_b32 a170, v44
    v_accvgpr_write_b32 a174, v45
    v_accvgpr_write_b32 a178, v46
    v_accvgpr_write_b32 a182, v47
    v_accvgpr_write_b32 a186, v64
    v_accvgpr_write_b32 a190, v65
    v_accvgpr_write_b32 a194, v66
    v_accvgpr_write_b32 a198, v67
    v_accvgpr_write_b32 a202, v68
    v_accvgpr_write_b32 a206, v69
    v_accvgpr_write_b32 a210, v70
    v_accvgpr_write_b32 a214, v71
    v_accvgpr_write_b32 a218, v72
    v_accvgpr_write_b32 a222, v73
    v_accvgpr_write_b32 a226, v74
    v_accvgpr_write_b32 a230, v75
    v_accvgpr_write_b32 a234, v76
    v_accvgpr_write_b32 a238, v77
    v_accvgpr_write_b32 a242, v78
    v_accvgpr_write_b32 a246, v79
    s_branch F2_nx
F2_o3:
    v_accvgpr_write_b32 a123, v32
    v_accvgpr_write_b32 a127, v33
    v_accvgpr_write_b32 a131, v34
    v_accvgpr_write_b32 a135, v35
    v_accvgpr_write_b32 a139, v36
    v_accvgpr_write_b32 a143, v37
    v_accvgpr_write_b32 a147, v38
    v_accvgpr_write_b32 a151, v39
    v_accvgpr_write_b32 a155, v40
    v_accvgpr_write_b32 a159, v41
    v_accvgpr_write_b32 a163, v42
    v_accvgpr_write_b32 a167, v43
    v_accvgpr_write_b32 a171, v44
    v_accvgpr_write_b32 a175, v45
    v_accvgpr_write_b32 a179, v46
    v_accvgpr_write_b32 a183, v47
    v_accvgpr_write_b32 a187, v64
    v_accvgpr_write_b32 a191, v65
    v_accvgpr_write_b32 a195, v66
    v_accvgpr_write_b32 a199, v67
    v_accvgpr_write_b32 a203, v68
    v_accvgpr_write_b32 a207, v69
    v_accvgpr_write_b32 a211, v70
    v_accvgpr_write_b32 a215, v71
    v_accvgpr_write_b32 a219, v72
    v_accvgpr_write_b32 a223, v73
    v_accvgpr_write_b32 a227, v74
    v_accvgpr_write_b32 a231, v75
    v_accvgpr_write_b32 a235, v76
    v_accvgpr_write_b32 a239, v77
    v_accvgpr_write_b32 a243, v78
    v_accvgpr_write_b32 a247, v79
    s_branch F2_nx
F2_o4:
    v_accvgpr_read_b32 v5, a120
    v_lshlrev_b32 v6, 16, v32
    v_bfi_b32 v5, s38, v6, v5
    v_accvgpr_write_b32 a120, v5
    v_accvgpr_read_b32 v5, a124
    v_lshlrev_b32 v6, 16, v33
    v_bfi_b32 v5, s38, v6, v5
    v_accvgpr_write_b32 a124, v5
    v_accvgpr_read_b32 v5, a128
    v_lshlrev_b32 v6, 16, v34
    v_bfi_b32 v5, s38, v6, v5
    v_accvgpr_write_b32 a128, v5
    v_accvgpr_read_b32 v5, a132
    v_lshlrev_b32 v6, 16, v35
    v_bfi_b32 v5, s38, v6, v5
    v_accvgpr_write_b32 a132, v5
    v_accvgpr_read_b32 v5, a136
    v_lshlrev_b32 v6, 16, v36
    v_bfi_b32 v5, s38, v6, v5
    v_accvgpr_write_b32 a136, v5
    v_accvgpr_read_b32 v5, a140
    v_lshlrev_b32 v6, 16, v37
    v_bfi_b32 v5, s38, v6, v5
    v_accvgpr_write_b32 a140, v5
    v_accvgpr_read_b32 v5, a144
    v_lshlrev_b32 v6, 16, v38
    v_bfi_b32 v5, s38, v6, v5
    v_accvgpr_write_b32 a144, v5
    v_accvgpr_read_b32 v5, a148
    v_lshlrev_b32 v6, 16, v39
    v_bfi_b32 v5, s38, v6, v5
    v_accvgpr_write_b32 a148, v5
    v_accvgpr_read_b32 v5, a152
    v_lshlrev_b32 v6, 16, v40
    v_bfi_b32 v5, s38, v6, v5
    v_accvgpr_write_b32 a152, v5
    v_accvgpr_read_b32 v5, a156
    v_lshlrev_b32 v6, 16, v41
    v_bfi_b32 v5, s38, v6, v5
    v_accvgpr_write_b32 a156, v5
    v_accvgpr_read_b32 v5, a160
    v_lshlrev_b32 v6, 16, v42
    v_bfi_b32 v5, s38, v6, v5
    v_accvgpr_write_b32 a160, v5
    v_accvgpr_read_b32 v5, a164
    v_lshlrev_b32 v6, 16, v43
    v_bfi_b32 v5, s38, v6, v5
    v_accvgpr_write_b32 a164, v5
    v_accvgpr_read_b32 v5, a168
    v_lshlrev_b32 v6, 16, v44
    v_bfi_b32 v5, s38, v6, v5
    v_accvgpr_write_b32 a168, v5
    v_accvgpr_read_b32 v5, a172
    v_lshlrev_b32 v6, 16, v45
    v_bfi_b32 v5, s38, v6, v5
    v_accvgpr_write_b32 a172, v5
    v_accvgpr_read_b32 v5, a176
    v_lshlrev_b32 v6, 16, v46
    v_bfi_b32 v5, s38, v6, v5
    v_accvgpr_write_b32 a176, v5
    v_accvgpr_read_b32 v5, a180
    v_lshlrev_b32 v6, 16, v47
    v_bfi_b32 v5, s38, v6, v5
    v_accvgpr_write_b32 a180, v5
    v_accvgpr_read_b32 v5, a184
    v_lshlrev_b32 v6, 16, v64
    v_bfi_b32 v5, s38, v6, v5
    v_accvgpr_write_b32 a184, v5
    v_accvgpr_read_b32 v5, a188
    v_lshlrev_b32 v6, 16, v65
    v_bfi_b32 v5, s38, v6, v5
    v_accvgpr_write_b32 a188, v5
    v_accvgpr_read_b32 v5, a192
    v_lshlrev_b32 v6, 16, v66
    v_bfi_b32 v5, s38, v6, v5
    v_accvgpr_write_b32 a192, v5
    v_accvgpr_read_b32 v5, a196
    v_lshlrev_b32 v6, 16, v67
    v_bfi_b32 v5, s38, v6, v5
    v_accvgpr_write_b32 a196, v5
    v_accvgpr_read_b32 v5, a200
    v_lshlrev_b32 v6, 16, v68
    v_bfi_b32 v5, s38, v6, v5
    v_accvgpr_write_b32 a200, v5
    v_accvgpr_read_b32 v5, a204
    v_lshlrev_b32 v6, 16, v69
    v_bfi_b32 v5, s38, v6, v5
    v_accvgpr_write_b32 a204, v5
    v_accvgpr_read_b32 v5, a208
    v_lshlrev_b32 v6, 16, v70
    v_bfi_b32 v5, s38, v6, v5
    v_accvgpr_write_b32 a208, v5
    v_accvgpr_read_b32 v5, a212
    v_lshlrev_b32 v6, 16, v71
    v_bfi_b32 v5, s38, v6, v5
    v_accvgpr_write_b32 a212, v5
    v_accvgpr_read_b32 v5, a216
    v_lshlrev_b32 v6, 16, v72
    v_bfi_b32 v5, s38, v6, v5
    v_accvgpr_write_b32 a216, v5
    v_accvgpr_read_b32 v5, a220
    v_lshlrev_b32 v6, 16, v73
    v_bfi_b32 v5, s38, v6, v5
    v_accvgpr_write_b32 a220, v5
    v_accvgpr_read_b32 v5, a224
    v_lshlrev_b32 v6, 16, v74
    v_bfi_b32 v5, s38, v6, v5
    v_accvgpr_write_b32 a224, v5
    v_accvgpr_read_b32 v5, a228
    v_lshlrev_b32 v6, 16, v75
    v_bfi_b32 v5, s38, v6, v5
    v_accvgpr_write_b32 a228, v5
    v_accvgpr_read_b32 v5, a232
    v_lshlrev_b32 v6, 16, v76
    v_bfi_b32 v5, s38, v6, v5
    v_accvgpr_write_b32 a232, v5
    v_accvgpr_read_b32 v5, a236
    v_lshlrev_b32 v6, 16, v77
    v_bfi_b32 v5, s38, v6, v5
    v_accvgpr_write_b32 a236, v5
    v_accvgpr_read_b32 v5, a240
    v_lshlrev_b32 v6, 16, v78
    v_bfi_b32 v5, s38, v6, v5
    v_accvgpr_write_b32 a240, v5
    v_accvgpr_read_b32 v5, a244
    v_lshlrev_b32 v6, 16, v79
    v_bfi_b32 v5, s38, v6, v5
    v_accvgpr_write_b32 a244, v5
F2_nx:
    s_add_u32 s35, s35, 8192
    s_bitcmp1_b32 s36, 0
    s_cselect_b32 s17, 0, 2068416
    s_add_u32 s34, s34, 1050624
    s_sub_u32 s34, s34, s17
    s_cmp_eq_u32 s36, 4
    s_cselect_b32 s35, 133120, s35
    s_cselect_b32 s34, 1073741824, s34
    s_cmp_lt_u32 s36, s37
    s_cbranch_scc1 F2_top
    s_mul_i32 s21, s31, 33024
    s_add_u32 s21, s21, 111149056
    s_add_u32 s17, s21, 0
    buffer_store_dwordx4 a[120:123], v18, s[4:7], s17 offen offset:0 sc1
    buffer_store_dwordx4 a[124:127], v18, s[4:7], s17 offen offset:512 sc1
    buffer_store_dwordx4 a[128:131], v18, s[4:7], s17 offen offset:1024 sc1
    buffer_store_dwordx4 a[132:135], v18, s[4:7], s17 offen offset:1536 sc1
    buffer_store_dwordx4 a[136:139], v18, s[4:7], s17 offen offset:2048 sc1
    buffer_store_dwordx4 a[140:143], v18, s[4:7], s17 offen offset:2560 sc1
    buffer_store_dwordx4 a[144:147], v18, s[4:7], s17 offen offset:3072 sc1
    buffer_store_dwordx4 a[148:151], v18, s[4:7], s17 offen offset:3584 sc1
    s_add_u32 s17, s21, 8192
    buffer_store_dwordx4 a[152:155], v18, s[4:7], s17 offen offset:0 sc1
    buffer_store_dwordx4 a[156:159], v18, s[4:7], s17 offen offset:512 sc1
    buffer_store_dwordx4 a[160:163], v18, s[4:7], s17 offen offset:1024 sc1
    buffer_store_dwordx4 a[164:167], v18, s[4:7], s17 offen offset:1536 sc1
    buffer_store_dwordx4 a[168:171], v18, s[4:7], s17 offen offset:2048 sc1
    buffer_store_dwordx4 a[172:175], v18, s[4:7], s17 offen offset:2560 sc1
    buffer_store_dwordx4 a[176:179], v18, s[4:7], s17 offen offset:3072 sc1
    buffer_store_dwordx4 a[180:183], v18, s[4:7], s17 offen offset:3584 sc1
    s_add_u32 s17, s21, 16384
    buffer_store_dwordx4 a[184:187], v18, s[4:7], s17 offen offset:0 sc1
    buffer_store_dwordx4 a[188:191], v18, s[4:7], s17 offen offset:512 sc1
    buffer_store_dwordx4 a[192:195], v18, s[4:7], s17 offen offset:1024 sc1
    buffer_store_dwordx4 a[196:199], v18, s[4:7], s17 offen offset:1536 sc1
    buffer_store_dwordx4 a[200:203], v18, s[4:7], s17 offen offset:2048 sc1
    buffer_store_dwordx4 a[204:207], v18, s[4:7], s17 offen offset:2560 sc1
    buffer_store_dwordx4 a[208:211], v18, s[4:7], s17 offen offset:3072 sc1
    buffer_store_dwordx4 a[212:215], v18, s[4:7], s17 offen offset:3584 sc1
    s_add_u32 s17, s21, 24576
    buffer_store_dwordx4 a[216:219], v18, s[4:7], s17 offen offset:0 sc1
    buffer_store_dwordx4 a[220:223], v18, s[4:7], s17 offen offset:512 sc1
    buffer_store_dwordx4 a[224:227], v18, s[4:7], s17 offen offset:1024 sc1
    buffer_store_dwordx4 a[228:231], v18, s[4:7], s17 offen offset:1536 sc1
    buffer_store_dwordx4 a[232:235], v18, s[4:7], s17 offen offset:2048 sc1
    buffer_store_dwordx4 a[236:239], v18, s[4:7], s17 offen offset:2560 sc1
    buffer_store_dwordx4 a[240:243], v18, s[4:7], s17 offen offset:3072 sc1
    buffer_store_dwordx4 a[244:247], v18, s[4:7], s17 offen offset:3584 sc1
    s_waitcnt vmcnt(0)
    s_lshl_b32 s17, s31, 7
    s_add_u32 s17, s17, 100761600
    v_lshl_add_u32 v5, v1, 2, s17
    v_mov_b32 v6, 1
    s_mov_b64 exec, 0xffffffff
    buffer_store_dword v6, v5, s[4:7], 0 offen sc1
    s_mov_b64 exec, -1
    v_bfe_u32 v5, v1, 2, 2
    v_and_b32 v7, 3, v1
    v_lshl_add_u32 v7, v5, 3, v7
    s_lshl_b32 s17, s29, 5
    v_add_u32 v7, s17, v7
    v_lshrrev_b32 v8, 4, v1
    v_cvt_f32_u32 v8, v8
    s_mov_b32 s31, 981467136
    v_and_b32 v38, 1, v7
    v_add_u32 v5, 0, v7
    v_cvt_f32_u32 v6, v5
    v_mul_f32 v6, s31, v6
    v_mov_b32 v32, 0x3e800000
    v_sub_f32 v34, v6, v32
    v_mul_f32 v36, 0x41800000, v6
    v_mul_f32 v5, 4.0, v6
    v_mul_f32 v30, v5, v8
    v_add_u32 v5, 4, v7
    v_cvt_f32_u32 v6, v5
    v_mul_f32 v6, s31, v6
    v_mov_b32 v33, 0x3e800000
    v_sub_f32 v35, v6, v33
    v_mul_f32 v37, 0x41800000, v6
    v_mul_f32 v5, 4.0, v6
    v_mul_f32 v31, v5, v8
    v_lshlrev_b32 v40, 4, v38
    v_bfe_u32 v5, v7, 1, 1
    v_add_u32 v6, 1, v7
    v_bfe_u32 v6, v6, 1, 1
    v_lshlrev_b32 v5, 15, v5
    v_lshl_or_b32 v41, v6, 31, v5
    v_fract_f32 v48, v30
    v_add_f32 v49, v48, v32
    v_cos_f32 v56, v48
    v_add_f32 v50, v49, v34
    v_cos_f32 v57, v49
    v_add_f32 v51, v50, v32
    v_cos_f32 v58, v50
    v_add_f32 v52, v51, v34
    v_cos_f32 v59, v51
    v_add_f32 v53, v52, v32
    v_cos_f32 v60, v52
    v_add_f32 v54, v53, v34
    v_cos_f32 v61, v53
    v_add_f32 v55, v54, v32
    v_cos_f32 v62, v54
    v_cos_f32 v63, v55
    v_add_f32 v30, v48, v36
    v_cvt_pk_bf16_f32 v64, v56, v57
    v_cvt_pk_bf16_f32 v65, v58, v59
    v_cvt_pk_bf16_f32 v66, v60, v61
    v_cvt_pk_bf16_f32 v67, v62, v63
    v_accvgpr_write_b32 a0, v64
    v_accvgpr_write_b32 a1, v65
    v_accvgpr_write_b32 a2, v66
    v_accvgpr_write_b32 a3, v67
    v_alignbit_b32 v68, v64, v64, v40
    v_xor_b32 v68, v68, v41
    v_alignbit_b32 v69, v65, v65, v40
    v_xor_b32 v69, v69, v41
    v_alignbit_b32 v70, v66, v66, v40
    v_xor_b32 v70, v70, v41
    v_alignbit_b32 v71, v67, v67, v40
    v_xor_b32 v71, v71, v41
    v_accvgpr_write_b32 a128, v68
    v_accvgpr_write_b32 a129, v69
    v_accvgpr_write_b32 a130, v70
    v_accvgpr_write_b32 a131, v71
    v_fract_f32 v48, v31
    v_add_f32 v49, v48, v33
    v_cos_f32 v56, v48
    v_add_f32 v50, v49, v35
    v_cos_f32 v57, v49
    v_add_f32 v51, v50, v33
    v_cos_f32 v58, v50
    v_add_f32 v52, v51, v35
    v_cos_f32 v59, v51
    v_add_f32 v53, v52, v33
    v_cos_f32 v60, v52
    v_add_f32 v54, v53, v35
    v_cos_f32 v61, v53
    v_add_f32 v55, v54, v33
    v_cos_f32 v62, v54
    v_cos_f32 v63, v55
    v_add_f32 v31, v48, v37
    v_cvt_pk_bf16_f32 v64, v56, v57
    v_cvt_pk_bf16_f32 v65, v58, v59
    v_cvt_pk_bf16_f32 v66, v60, v61
    v_cvt_pk_bf16_f32 v67, v62, v63
    v_accvgpr_write_b32 a4, v64
    v_accvgpr_write_b32 a5, v65
    v_accvgpr_write_b32 a6, v66
    v_accvgpr_write_b32 a7, v67
    v_alignbit_b32 v68, v64, v64, v40
    v_xor_b32 v68, v68, v41
    v_alignbit_b32 v69, v65, v65, v40
    v_xor_b32 v69, v69, v41
    v_alignbit_b32 v70, v66, v66, v40
    v_xor_b32 v70, v70, v41
    v_alignbit_b32 v71, v67, v67, v40
    v_xor_b32 v71, v71, v41
    v_accvgpr_write_b32 a132, v68
    v_accvgpr_write_b32 a133, v69
    v_accvgpr_write_b32 a134, v70
    v_accvgpr_write_b32 a135, v71
    v_fract_f32 v48, v30
    v_add_f32 v49, v48, v32
    v_cos_f32 v56, v48
    v_add_f32 v50, v49, v34
    v_cos_f32 v57, v49
    v_add_f32 v51, v50, v32
    v_cos_f32 v58, v50
    v_add_f32 v52, v51, v34
    v_cos_f32 v59, v51
    v_add_f32 v53, v52, v32
    v_cos_f32 v60, v52
    v_add_f32 v54, v53, v34
    v_cos_f32 v61, v53
    v_add_f32 v55, v54, v32
    v_cos_f32 v62, v54
    v_cos_f32 v63, v55
    v_add_f32 v30, v48, v36
    v_cvt_pk_bf16_f32 v64, v56, v57
    v_cvt_pk_bf16_f32 v65, v58, v59
    v_cvt_pk_bf16_f32 v66, v60, v61
    v_cvt_pk_bf16_f32 v67, v62, v63
    v_accvgpr_write_b32 a8, v64
    v_accvgpr_write_b32 a9, v65
    v_accvgpr_write_b32 a10, v66
    v_accvgpr_write_b32 a11, v67
    v_alignbit_b32 v68, v64, v64, v40
    v_xor_b32 v68, v68, v41
    v_alignbit_b32 v69, v65, v65, v40
    v_xor_b32 v69, v69, v41
    v_alignbit_b32 v70, v66, v66, v40
    v_xor_b32 v70, v70, v41
    v_alignbit_b32 v71, v67, v67, v40
    v_xor_b32 v71, v71, v41
    v_accvgpr_write_b32 a136, v68
    v_accvgpr_write_b32 a137, v69
    v_accvgpr_write_b32 a138, v70
    v_accvgpr_write_b32 a139, v71
    v_fract_f32 v48, v31
    v_add_f32 v49, v48, v33
    v_cos_f32 v56, v48
    v_add_f32 v50, v49, v35
    v_cos_f32 v57, v49
    v_add_f32 v51, v50, v33
    v_cos_f32 v58, v50
    v_add_f32 v52, v51, v35
    v_cos_f32 v59, v51
    v_add_f32 v53, v52, v33
    v_cos_f32 v60, v52
    v_add_f32 v54, v53, v35
    v_cos_f32 v61, v53
    v_add_f32 v55, v54, v33
    v_cos_f32 v62, v54
    v_cos_f32 v63, v55
    v_add_f32 v31, v48, v37
    v_cvt_pk_bf16_f32 v64, v56, v57
    v_cvt_pk_bf16_f32 v65, v58, v59
    v_cvt_pk_bf16_f32 v66, v60, v61
    v_cvt_pk_bf16_f32 v67, v62, v63
    v_accvgpr_write_b32 a12, v64
    v_accvgpr_write_b32 a13, v65
    v_accvgpr_write_b32 a14, v66
    v_accvgpr_write_b32 a15, v67
    v_alignbit_b32 v68, v64, v64, v40
    v_xor_b32 v68, v68, v41
    v_alignbit_b32 v69, v65, v65, v40
    v_xor_b32 v69, v69, v41
    v_alignbit_b32 v70, v66, v66, v40
    v_xor_b32 v70, v70, v41
    v_alignbit_b32 v71, v67, v67, v40
    v_xor_b32 v71, v71, v41
    v_accvgpr_write_b32 a140, v68
    v_accvgpr_write_b32 a141, v69
    v_accvgpr_write_b32 a142, v70
    v_accvgpr_write_b32 a143, v71
    v_fract_f32 v48, v30
    v_add_f32 v49, v48, v32
    v_cos_f32 v56, v48
    v_add_f32 v50, v49, v34
    v_cos_f32 v57, v49
    v_add_f32 v51, v50, v32
    v_cos_f32 v58, v50
    v_add_f32 v52, v51, v34
    v_cos_f32 v59, v51
    v_add_f32 v53, v52, v32
    v_cos_f32 v60, v52
    v_add_f32 v54, v53, v34
    v_cos_f32 v61, v53
    v_add_f32 v55, v54, v32
    v_cos_f32 v62, v54
    v_cos_f32 v63, v55
    v_add_f32 v30, v48, v36
    v_cvt_pk_bf16_f32 v64, v56, v57
    v_cvt_pk_bf16_f32 v65, v58, v59
    v_cvt_pk_bf16_f32 v66, v60, v61
    v_cvt_pk_bf16_f32 v67, v62, v63
    v_accvgpr_write_b32 a16, v64
    v_accvgpr_write_b32 a17, v65
    v_accvgpr_write_b32 a18, v66
    v_accvgpr_write_b32 a19, v67
    v_alignbit_b32 v68, v64, v64, v40
    v_xor_b32 v68, v68, v41
    v_alignbit_b32 v69, v65, v65, v40
    v_xor_b32 v69, v69, v41
    v_alignbit_b32 v70, v66, v66, v40
    v_xor_b32 v70, v70, v41
    v_alignbit_b32 v71, v67, v67, v40
    v_xor_b32 v71, v71, v41
    v_accvgpr_write_b32 a144, v68
    v_accvgpr_write_b32 a145, v69
    v_accvgpr_write_b32 a146, v70
    v_accvgpr_write_b32 a147, v71
    v_fract_f32 v48, v31
    v_add_f32 v49, v48, v33
    v_cos_f32 v56, v48
    v_add_f32 v50, v49, v35
    v_cos_f32 v57, v49
    v_add_f32 v51, v50, v33
    v_cos_f32 v58, v50
    v_add_f32 v52, v51, v35
    v_cos_f32 v59, v51
    v_add_f32 v53, v52, v33
    v_cos_f32 v60, v52
    v_add_f32 v54, v53, v35
    v_cos_f32 v61, v53
    v_add_f32 v55, v54, v33
    v_cos_f32 v62, v54
    v_cos_f32 v63, v55
    v_add_f32 v31, v48, v37
    v_cvt_pk_bf16_f32 v64, v56, v57
    v_cvt_pk_bf16_f32 v65, v58, v59
    v_cvt_pk_bf16_f32 v66, v60, v61
    v_cvt_pk_bf16_f32 v67, v62, v63
    v_accvgpr_write_b32 a20, v64
    v_accvgpr_write_b32 a21, v65
    v_accvgpr_write_b32 a22, v66
    v_accvgpr_write_b32 a23, v67
    v_alignbit_b32 v68, v64, v64, v40
    v_xor_b32 v68, v68, v41
    v_alignbit_b32 v69, v65, v65, v40
    v_xor_b32 v69, v69, v41
    v_alignbit_b32 v70, v66, v66, v40
    v_xor_b32 v70, v70, v41
    v_alignbit_b32 v71, v67, v67, v40
    v_xor_b32 v71, v71, v41
    v_accvgpr_write_b32 a148, v68
    v_accvgpr_write_b32 a149, v69
    v_accvgpr_write_b32 a150, v70
    v_accvgpr_write_b32 a151, v71
    v_fract_f32 v48, v30
    v_add_f32 v49, v48, v32
    v_cos_f32 v56, v48
    v_add_f32 v50, v49, v34
    v_cos_f32 v57, v49
    v_add_f32 v51, v50, v32
    v_cos_f32 v58, v50
    v_add_f32 v52, v51, v34
    v_cos_f32 v59, v51
    v_add_f32 v53, v52, v32
    v_cos_f32 v60, v52
    v_add_f32 v54, v53, v34
    v_cos_f32 v61, v53
    v_add_f32 v55, v54, v32
    v_cos_f32 v62, v54
    v_cos_f32 v63, v55
    v_add_f32 v30, v48, v36
    v_cvt_pk_bf16_f32 v64, v56, v57
    v_cvt_pk_bf16_f32 v65, v58, v59
    v_cvt_pk_bf16_f32 v66, v60, v61
    v_cvt_pk_bf16_f32 v67, v62, v63
    v_accvgpr_write_b32 a24, v64
    v_accvgpr_write_b32 a25, v65
    v_accvgpr_write_b32 a26, v66
    v_accvgpr_write_b32 a27, v67
    v_alignbit_b32 v68, v64, v64, v40
    v_xor_b32 v68, v68, v41
    v_alignbit_b32 v69, v65, v65, v40
    v_xor_b32 v69, v69, v41
    v_alignbit_b32 v70, v66, v66, v40
    v_xor_b32 v70, v70, v41
    v_alignbit_b32 v71, v67, v67, v40
    v_xor_b32 v71, v71, v41
    v_accvgpr_write_b32 a152, v68
    v_accvgpr_write_b32 a153, v69
    v_accvgpr_write_b32 a154, v70
    v_accvgpr_write_b32 a155, v71
    v_fract_f32 v48, v31
    v_add_f32 v49, v48, v33
    v_cos_f32 v56, v48
    v_add_f32 v50, v49, v35
    v_cos_f32 v57, v49
    v_add_f32 v51, v50, v33
    v_cos_f32 v58, v50
    v_add_f32 v52, v51, v35
    v_cos_f32 v59, v51
    v_add_f32 v53, v52, v33
    v_cos_f32 v60, v52
    v_add_f32 v54, v53, v35
    v_cos_f32 v61, v53
    v_add_f32 v55, v54, v33
    v_cos_f32 v62, v54
    v_cos_f32 v63, v55
    v_add_f32 v31, v48, v37
    v_cvt_pk_bf16_f32 v64, v56, v57
    v_cvt_pk_bf16_f32 v65, v58, v59
    v_cvt_pk_bf16_f32 v66, v60, v61
    v_cvt_pk_bf16_f32 v67, v62, v63
    v_accvgpr_write_b32 a28, v64
    v_accvgpr_write_b32 a29, v65
    v_accvgpr_write_b32 a30, v66
    v_accvgpr_write_b32 a31, v67
    v_alignbit_b32 v68, v64, v64, v40
    v_xor_b32 v68, v68, v41
    v_alignbit_b32 v69, v65, v65, v40
    v_xor_b32 v69, v69, v41
    v_alignbit_b32 v70, v66, v66, v40
    v_xor_b32 v70, v70, v41
    v_alignbit_b32 v71, v67, v67, v40
    v_xor_b32 v71, v71, v41
    v_accvgpr_write_b32 a156, v68
    v_accvgpr_write_b32 a157, v69
    v_accvgpr_write_b32 a158, v70
    v_accvgpr_write_b32 a159, v71
    v_fract_f32 v48, v30
    v_add_f32 v49, v48, v32
    v_cos_f32 v56, v48
    v_add_f32 v50, v49, v34
    v_cos_f32 v57, v49
    v_add_f32 v51, v50, v32
    v_cos_f32 v58, v50
    v_add_f32 v52, v51, v34
    v_cos_f32 v59, v51
    v_add_f32 v53, v52, v32
    v_cos_f32 v60, v52
    v_add_f32 v54, v53, v34
    v_cos_f32 v61, v53
    v_add_f32 v55, v54, v32
    v_cos_f32 v62, v54
    v_cos_f32 v63, v55
    v_add_f32 v30, v48, v36
    v_cvt_pk_bf16_f32 v64, v56, v57
    v_cvt_pk_bf16_f32 v65, v58, v59
    v_cvt_pk_bf16_f32 v66, v60, v61
    v_cvt_pk_bf16_f32 v67, v62, v63
    v_accvgpr_write_b32 a32, v64
    v_accvgpr_write_b32 a33, v65
    v_accvgpr_write_b32 a34, v66
    v_accvgpr_write_b32 a35, v67
    v_alignbit_b32 v68, v64, v64, v40
    v_xor_b32 v68, v68, v41
    v_alignbit_b32 v69, v65, v65, v40
    v_xor_b32 v69, v69, v41
    v_alignbit_b32 v70, v66, v66, v40
    v_xor_b32 v70, v70, v41
    v_alignbit_b32 v71, v67, v67, v40
    v_xor_b32 v71, v71, v41
    v_accvgpr_write_b32 a160, v68
    v_accvgpr_write_b32 a161, v69
    v_accvgpr_write_b32 a162, v70
    v_accvgpr_write_b32 a163, v71
    v_fract_f32 v48, v31
    v_add_f32 v49, v48, v33
    v_cos_f32 v56, v48
    v_add_f32 v50, v49, v35
    v_cos_f32 v57, v49
    v_add_f32 v51, v50, v33
    v_cos_f32 v58, v50
    v_add_f32 v52, v51, v35
    v_cos_f32 v59, v51
    v_add_f32 v53, v52, v33
    v_cos_f32 v60, v52
    v_add_f32 v54, v53, v35
    v_cos_f32 v61, v53
    v_add_f32 v55, v54, v33
    v_cos_f32 v62, v54
    v_cos_f32 v63, v55
    v_add_f32 v31, v48, v37
    v_cvt_pk_bf16_f32 v64, v56, v57
    v_cvt_pk_bf16_f32 v65, v58, v59
    v_cvt_pk_bf16_f32 v66, v60, v61
    v_cvt_pk_bf16_f32 v67, v62, v63
    v_accvgpr_write_b32 a36, v64
    v_accvgpr_write_b32 a37, v65
    v_accvgpr_write_b32 a38, v66
    v_accvgpr_write_b32 a39, v67
    v_alignbit_b32 v68, v64, v64, v40
    v_xor_b32 v68, v68, v41
    v_alignbit_b32 v69, v65, v65, v40
    v_xor_b32 v69, v69, v41
    v_alignbit_b32 v70, v66, v66, v40
    v_xor_b32 v70, v70, v41
    v_alignbit_b32 v71, v67, v67, v40
    v_xor_b32 v71, v71, v41
    v_accvgpr_write_b32 a164, v68
    v_accvgpr_write_b32 a165, v69
    v_accvgpr_write_b32 a166, v70
    v_accvgpr_write_b32 a167, v71
    v_fract_f32 v48, v30
    v_add_f32 v49, v48, v32
    v_cos_f32 v56, v48
    v_add_f32 v50, v49, v34
    v_cos_f32 v57, v49
    v_add_f32 v51, v50, v32
    v_cos_f32 v58, v50
    v_add_f32 v52, v51, v34
    v_cos_f32 v59, v51
    v_add_f32 v53, v52, v32
    v_cos_f32 v60, v52
    v_add_f32 v54, v53, v34
    v_cos_f32 v61, v53
    v_add_f32 v55, v54, v32
    v_cos_f32 v62, v54
    v_cos_f32 v63, v55
    v_add_f32 v30, v48, v36
    v_cvt_pk_bf16_f32 v64, v56, v57
    v_cvt_pk_bf16_f32 v65, v58, v59
    v_cvt_pk_bf16_f32 v66, v60, v61
    v_cvt_pk_bf16_f32 v67, v62, v63
    v_accvgpr_write_b32 a40, v64
    v_accvgpr_write_b32 a41, v65
    v_accvgpr_write_b32 a42, v66
    v_accvgpr_write_b32 a43, v67
    v_alignbit_b32 v68, v64, v64, v40
    v_xor_b32 v68, v68, v41
    v_alignbit_b32 v69, v65, v65, v40
    v_xor_b32 v69, v69, v41
    v_alignbit_b32 v70, v66, v66, v40
    v_xor_b32 v70, v70, v41
    v_alignbit_b32 v71, v67, v67, v40
    v_xor_b32 v71, v71, v41
    v_accvgpr_write_b32 a168, v68
    v_accvgpr_write_b32 a169, v69
    v_accvgpr_write_b32 a170, v70
    v_accvgpr_write_b32 a171, v71
    v_fract_f32 v48, v31
    v_add_f32 v49, v48, v33
    v_cos_f32 v56, v48
    v_add_f32 v50, v49, v35
    v_cos_f32 v57, v49
    v_add_f32 v51, v50, v33
    v_cos_f32 v58, v50
    v_add_f32 v52, v51, v35
    v_cos_f32 v59, v51
    v_add_f32 v53, v52, v33
    v_cos_f32 v60, v52
    v_add_f32 v54, v53, v35
    v_cos_f32 v61, v53
    v_add_f32 v55, v54, v33
    v_cos_f32 v62, v54
    v_cos_f32 v63, v55
    v_add_f32 v31, v48, v37
    v_cvt_pk_bf16_f32 v64, v56, v57
    v_cvt_pk_bf16_f32 v65, v58, v59
    v_cvt_pk_bf16_f32 v66, v60, v61
    v_cvt_pk_bf16_f32 v67, v62, v63
    v_accvgpr_write_b32 a44, v64
    v_accvgpr_write_b32 a45, v65
    v_accvgpr_write_b32 a46, v66
    v_accvgpr_write_b32 a47, v67
    v_alignbit_b32 v68, v64, v64, v40
    v_xor_b32 v68, v68, v41
    v_alignbit_b32 v69, v65, v65, v40
    v_xor_b32 v69, v69, v41
    v_alignbit_b32 v70, v66, v66, v40
    v_xor_b32 v70, v70, v41
    v_alignbit_b32 v71, v67, v67, v40
    v_xor_b32 v71, v71, v41
    v_accvgpr_write_b32 a172, v68
    v_accvgpr_write_b32 a173, v69
    v_accvgpr_write_b32 a174, v70
    v_accvgpr_write_b32 a175, v71
    v_fract_f32 v48, v30
    v_add_f32 v49, v48, v32
    v_cos_f32 v56, v48
    v_add_f32 v50, v49, v34
    v_cos_f32 v57, v49
    v_add_f32 v51, v50, v32
    v_cos_f32 v58, v50
    v_add_f32 v52, v51, v34
    v_cos_f32 v59, v51
    v_add_f32 v53, v52, v32
    v_cos_f32 v60, v52
    v_add_f32 v54, v53, v34
    v_cos_f32 v61, v53
    v_add_f32 v55, v54, v32
    v_cos_f32 v62, v54
    v_cos_f32 v63, v55
    v_add_f32 v30, v48, v36
    v_cvt_pk_bf16_f32 v64, v56, v57
    v_cvt_pk_bf16_f32 v65, v58, v59
    v_cvt_pk_bf16_f32 v66, v60, v61
    v_cvt_pk_bf16_f32 v67, v62, v63
    v_accvgpr_write_b32 a48, v64
    v_accvgpr_write_b32 a49, v65
    v_accvgpr_write_b32 a50, v66
    v_accvgpr_write_b32 a51, v67
    v_alignbit_b32 v68, v64, v64, v40
    v_xor_b32 v68, v68, v41
    v_alignbit_b32 v69, v65, v65, v40
    v_xor_b32 v69, v69, v41
    v_alignbit_b32 v70, v66, v66, v40
    v_xor_b32 v70, v70, v41
    v_alignbit_b32 v71, v67, v67, v40
    v_xor_b32 v71, v71, v41
    v_accvgpr_write_b32 a176, v68
    v_accvgpr_write_b32 a177, v69
    v_accvgpr_write_b32 a178, v70
    v_accvgpr_write_b32 a179, v71
    v_fract_f32 v48, v31
    v_add_f32 v49, v48, v33
    v_cos_f32 v56, v48
    v_add_f32 v50, v49, v35
    v_cos_f32 v57, v49
    v_add_f32 v51, v50, v33
    v_cos_f32 v58, v50
    v_add_f32 v52, v51, v35
    v_cos_f32 v59, v51
    v_add_f32 v53, v52, v33
    v_cos_f32 v60, v52
    v_add_f32 v54, v53, v35
    v_cos_f32 v61, v53
    v_add_f32 v55, v54, v33
    v_cos_f32 v62, v54
    v_cos_f32 v63, v55
    v_add_f32 v31, v48, v37
    v_cvt_pk_bf16_f32 v64, v56, v57
    v_cvt_pk_bf16_f32 v65, v58, v59
    v_cvt_pk_bf16_f32 v66, v60, v61
    v_cvt_pk_bf16_f32 v67, v62, v63
    v_accvgpr_write_b32 a52, v64
    v_accvgpr_write_b32 a53, v65
    v_accvgpr_write_b32 a54, v66
    v_accvgpr_write_b32 a55, v67
    v_alignbit_b32 v68, v64, v64, v40
    v_xor_b32 v68, v68, v41
    v_alignbit_b32 v69, v65, v65, v40
    v_xor_b32 v69, v69, v41
    v_alignbit_b32 v70, v66, v66, v40
    v_xor_b32 v70, v70, v41
    v_alignbit_b32 v71, v67, v67, v40
    v_xor_b32 v71, v71, v41
    v_accvgpr_write_b32 a180, v68
    v_accvgpr_write_b32 a181, v69
    v_accvgpr_write_b32 a182, v70
    v_accvgpr_write_b32 a183, v71
    v_fract_f32 v48, v30
    v_add_f32 v49, v48, v32
    v_cos_f32 v56, v48
    v_add_f32 v50, v49, v34
    v_cos_f32 v57, v49
    v_add_f32 v51, v50, v32
    v_cos_f32 v58, v50
    v_add_f32 v52, v51, v34
    v_cos_f32 v59, v51
    v_add_f32 v53, v52, v32
    v_cos_f32 v60, v52
    v_add_f32 v54, v53, v34
    v_cos_f32 v61, v53
    v_add_f32 v55, v54, v32
    v_cos_f32 v62, v54
    v_cos_f32 v63, v55
    v_add_f32 v30, v48, v36
    v_cvt_pk_bf16_f32 v64, v56, v57
    v_cvt_pk_bf16_f32 v65, v58, v59
    v_cvt_pk_bf16_f32 v66, v60, v61
    v_cvt_pk_bf16_f32 v67, v62, v63
    v_accvgpr_write_b32 a56, v64
    v_accvgpr_write_b32 a57, v65
    v_accvgpr_write_b32 a58, v66
    v_accvgpr_write_b32 a59, v67
    v_alignbit_b32 v68, v64, v64, v40
    v_xor_b32 v68, v68, v41
    v_alignbit_b32 v69, v65, v65, v40
    v_xor_b32 v69, v69, v41
    v_alignbit_b32 v70, v66, v66, v40
    v_xor_b32 v70, v70, v41
    v_alignbit_b32 v71, v67, v67, v40
    v_xor_b32 v71, v71, v41
    v_accvgpr_write_b32 a184, v68
    v_accvgpr_write_b32 a185, v69
    v_accvgpr_write_b32 a186, v70
    v_accvgpr_write_b32 a187, v71
    v_fract_f32 v48, v31
    v_add_f32 v49, v48, v33
    v_cos_f32 v56, v48
    v_add_f32 v50, v49, v35
    v_cos_f32 v57, v49
    v_add_f32 v51, v50, v33
    v_cos_f32 v58, v50
    v_add_f32 v52, v51, v35
    v_cos_f32 v59, v51
    v_add_f32 v53, v52, v33
    v_cos_f32 v60, v52
    v_add_f32 v54, v53, v35
    v_cos_f32 v61, v53
    v_add_f32 v55, v54, v33
    v_cos_f32 v62, v54
    v_cos_f32 v63, v55
    v_add_f32 v31, v48, v37
    v_cvt_pk_bf16_f32 v64, v56, v57
    v_cvt_pk_bf16_f32 v65, v58, v59
    v_cvt_pk_bf16_f32 v66, v60, v61
    v_cvt_pk_bf16_f32 v67, v62, v63
    v_accvgpr_write_b32 a60, v64
    v_accvgpr_write_b32 a61, v65
    v_accvgpr_write_b32 a62, v66
    v_accvgpr_write_b32 a63, v67
    v_alignbit_b32 v68, v64, v64, v40
    v_xor_b32 v68, v68, v41
    v_alignbit_b32 v69, v65, v65, v40
    v_xor_b32 v69, v69, v41
    v_alignbit_b32 v70, v66, v66, v40
    v_xor_b32 v70, v70, v41
    v_alignbit_b32 v71, v67, v67, v40
    v_xor_b32 v71, v71, v41
    v_accvgpr_write_b32 a188, v68
    v_accvgpr_write_b32 a189, v69
    v_accvgpr_write_b32 a190, v70
    v_accvgpr_write_b32 a191, v71
    v_fract_f32 v48, v30
    v_add_f32 v49, v48, v32
    v_cos_f32 v56, v48
    v_add_f32 v50, v49, v34
    v_cos_f32 v57, v49
    v_add_f32 v51, v50, v32
    v_cos_f32 v58, v50
    v_add_f32 v52, v51, v34
    v_cos_f32 v59, v51
    v_add_f32 v53, v52, v32
    v_cos_f32 v60, v52
    v_add_f32 v54, v53, v34
    v_cos_f32 v61, v53
    v_add_f32 v55, v54, v32
    v_cos_f32 v62, v54
    v_cos_f32 v63, v55
    v_add_f32 v30, v48, v36
    v_cvt_pk_bf16_f32 v64, v56, v57
    v_cvt_pk_bf16_f32 v65, v58, v59
    v_cvt_pk_bf16_f32 v66, v60, v61
    v_cvt_pk_bf16_f32 v67, v62, v63
    v_accvgpr_write_b32 a64, v64
    v_accvgpr_write_b32 a65, v65
    v_accvgpr_write_b32 a66, v66
    v_accvgpr_write_b32 a67, v67
    v_alignbit_b32 v68, v64, v64, v40
    v_xor_b32 v68, v68, v41
    v_alignbit_b32 v69, v65, v65, v40
    v_xor_b32 v69, v69, v41
    v_alignbit_b32 v70, v66, v66, v40
    v_xor_b32 v70, v70, v41
    v_alignbit_b32 v71, v67, v67, v40
    v_xor_b32 v71, v71, v41
    v_accvgpr_write_b32 a192, v68
    v_accvgpr_write_b32 a193, v69
    v_accvgpr_write_b32 a194, v70
    v_accvgpr_write_b32 a195, v71
    v_fract_f32 v48, v31
    v_add_f32 v49, v48, v33
    v_cos_f32 v56, v48
    v_add_f32 v50, v49, v35
    v_cos_f32 v57, v49
    v_add_f32 v51, v50, v33
    v_cos_f32 v58, v50
    v_add_f32 v52, v51, v35
    v_cos_f32 v59, v51
    v_add_f32 v53, v52, v33
    v_cos_f32 v60, v52
    v_add_f32 v54, v53, v35
    v_cos_f32 v61, v53
    v_add_f32 v55, v54, v33
    v_cos_f32 v62, v54
    v_cos_f32 v63, v55
    v_add_f32 v31, v48, v37
    v_cvt_pk_bf16_f32 v64, v56, v57
    v_cvt_pk_bf16_f32 v65, v58, v59
    v_cvt_pk_bf16_f32 v66, v60, v61
    v_cvt_pk_bf16_f32 v67, v62, v63
    v_accvgpr_write_b32 a68, v64
    v_accvgpr_write_b32 a69, v65
    v_accvgpr_write_b32 a70, v66
    v_accvgpr_write_b32 a71, v67
    v_alignbit_b32 v68, v64, v64, v40
    v_xor_b32 v68, v68, v41
    v_alignbit_b32 v69, v65, v65, v40
    v_xor_b32 v69, v69, v41
    v_alignbit_b32 v70, v66, v66, v40
    v_xor_b32 v70, v70, v41
    v_alignbit_b32 v71, v67, v67, v40
    v_xor_b32 v71, v71, v41
    v_accvgpr_write_b32 a196, v68
    v_accvgpr_write_b32 a197, v69
    v_accvgpr_write_b32 a198, v70
    v_accvgpr_write_b32 a199, v71
    v_fract_f32 v48, v30
    v_add_f32 v49, v48, v32
    v_cos_f32 v56, v48
    v_add_f32 v50, v49, v34
    v_cos_f32 v57, v49
    v_add_f32 v51, v50, v32
    v_cos_f32 v58, v50
    v_add_f32 v52, v51, v34
    v_cos_f32 v59, v51
    v_add_f32 v53, v52, v32
    v_cos_f32 v60, v52
    v_add_f32 v54, v53, v34
    v_cos_f32 v61, v53
    v_add_f32 v55, v54, v32
    v_cos_f32 v62, v54
    v_cos_f32 v63, v55
    v_add_f32 v30, v48, v36
    v_cvt_pk_bf16_f32 v64, v56, v57
    v_cvt_pk_bf16_f32 v65, v58, v59
    v_cvt_pk_bf16_f32 v66, v60, v61
    v_cvt_pk_bf16_f32 v67, v62, v63
    v_accvgpr_write_b32 a72, v64
    v_accvgpr_write_b32 a73, v65
    v_accvgpr_write_b32 a74, v66
    v_accvgpr_write_b32 a75, v67
    v_alignbit_b32 v68, v64, v64, v40
    v_xor_b32 v68, v68, v41
    v_alignbit_b32 v69, v65, v65, v40
    v_xor_b32 v69, v69, v41
    v_alignbit_b32 v70, v66, v66, v40
    v_xor_b32 v70, v70, v41
    v_alignbit_b32 v71, v67, v67, v40
    v_xor_b32 v71, v71, v41
    v_accvgpr_write_b32 a200, v68
    v_accvgpr_write_b32 a201, v69
    v_accvgpr_write_b32 a202, v70
    v_accvgpr_write_b32 a203, v71
    v_fract_f32 v48, v31
    v_add_f32 v49, v48, v33
    v_cos_f32 v56, v48
    v_add_f32 v50, v49, v35
    v_cos_f32 v57, v49
    v_add_f32 v51, v50, v33
    v_cos_f32 v58, v50
    v_add_f32 v52, v51, v35
    v_cos_f32 v59, v51
    v_add_f32 v53, v52, v33
    v_cos_f32 v60, v52
    v_add_f32 v54, v53, v35
    v_cos_f32 v61, v53
    v_add_f32 v55, v54, v33
    v_cos_f32 v62, v54
    v_cos_f32 v63, v55
    v_add_f32 v31, v48, v37
    v_cvt_pk_bf16_f32 v64, v56, v57
    v_cvt_pk_bf16_f32 v65, v58, v59
    v_cvt_pk_bf16_f32 v66, v60, v61
    v_cvt_pk_bf16_f32 v67, v62, v63
    v_accvgpr_write_b32 a76, v64
    v_accvgpr_write_b32 a77, v65
    v_accvgpr_write_b32 a78, v66
    v_accvgpr_write_b32 a79, v67
    v_alignbit_b32 v68, v64, v64, v40
    v_xor_b32 v68, v68, v41
    v_alignbit_b32 v69, v65, v65, v40
    v_xor_b32 v69, v69, v41
    v_alignbit_b32 v70, v66, v66, v40
    v_xor_b32 v70, v70, v41
    v_alignbit_b32 v71, v67, v67, v40
    v_xor_b32 v71, v71, v41
    v_accvgpr_write_b32 a204, v68
    v_accvgpr_write_b32 a205, v69
    v_accvgpr_write_b32 a206, v70
    v_accvgpr_write_b32 a207, v71
    v_fract_f32 v48, v30
    v_add_f32 v49, v48, v32
    v_cos_f32 v56, v48
    v_add_f32 v50, v49, v34
    v_cos_f32 v57, v49
    v_add_f32 v51, v50, v32
    v_cos_f32 v58, v50
    v_add_f32 v52, v51, v34
    v_cos_f32 v59, v51
    v_add_f32 v53, v52, v32
    v_cos_f32 v60, v52
    v_add_f32 v54, v53, v34
    v_cos_f32 v61, v53
    v_add_f32 v55, v54, v32
    v_cos_f32 v62, v54
    v_cos_f32 v63, v55
    v_add_f32 v30, v48, v36
    v_cvt_pk_bf16_f32 v64, v56, v57
    v_cvt_pk_bf16_f32 v65, v58, v59
    v_cvt_pk_bf16_f32 v66, v60, v61
    v_cvt_pk_bf16_f32 v67, v62, v63
    v_accvgpr_write_b32 a80, v64
    v_accvgpr_write_b32 a81, v65
    v_accvgpr_write_b32 a82, v66
    v_accvgpr_write_b32 a83, v67
    v_alignbit_b32 v68, v64, v64, v40
    v_xor_b32 v68, v68, v41
    v_alignbit_b32 v69, v65, v65, v40
    v_xor_b32 v69, v69, v41
    v_alignbit_b32 v70, v66, v66, v40
    v_xor_b32 v70, v70, v41
    v_alignbit_b32 v71, v67, v67, v40
    v_xor_b32 v71, v71, v41
    v_accvgpr_write_b32 a208, v68
    v_accvgpr_write_b32 a209, v69
    v_accvgpr_write_b32 a210, v70
    v_accvgpr_write_b32 a211, v71
    v_fract_f32 v48, v31
    v_add_f32 v49, v48, v33
    v_cos_f32 v56, v48
    v_add_f32 v50, v49, v35
    v_cos_f32 v57, v49
    v_add_f32 v51, v50, v33
    v_cos_f32 v58, v50
    v_add_f32 v52, v51, v35
    v_cos_f32 v59, v51
    v_add_f32 v53, v52, v33
    v_cos_f32 v60, v52
    v_add_f32 v54, v53, v35
    v_cos_f32 v61, v53
    v_add_f32 v55, v54, v33
    v_cos_f32 v62, v54
    v_cos_f32 v63, v55
    v_add_f32 v31, v48, v37
    v_cvt_pk_bf16_f32 v64, v56, v57
    v_cvt_pk_bf16_f32 v65, v58, v59
    v_cvt_pk_bf16_f32 v66, v60, v61
    v_cvt_pk_bf16_f32 v67, v62, v63
    v_accvgpr_write_b32 a84, v64
    v_accvgpr_write_b32 a85, v65
    v_accvgpr_write_b32 a86, v66
    v_accvgpr_write_b32 a87, v67
    v_alignbit_b32 v68, v64, v64, v40
    v_xor_b32 v68, v68, v41
    v_alignbit_b32 v69, v65, v65, v40
    v_xor_b32 v69, v69, v41
    v_alignbit_b32 v70, v66, v66, v40
    v_xor_b32 v70, v70, v41
    v_alignbit_b32 v71, v67, v67, v40
    v_xor_b32 v71, v71, v41
    v_accvgpr_write_b32 a212, v68
    v_accvgpr_write_b32 a213, v69
    v_accvgpr_write_b32 a214, v70
    v_accvgpr_write_b32 a215, v71
    v_fract_f32 v48, v30
    v_add_f32 v49, v48, v32
    v_cos_f32 v56, v48
    v_add_f32 v50, v49, v34
    v_cos_f32 v57, v49
    v_add_f32 v51, v50, v32
    v_cos_f32 v58, v50
    v_add_f32 v52, v51, v34
    v_cos_f32 v59, v51
    v_add_f32 v53, v52, v32
    v_cos_f32 v60, v52
    v_add_f32 v54, v53, v34
    v_cos_f32 v61, v53
    v_add_f32 v55, v54, v32
    v_cos_f32 v62, v54
    v_cos_f32 v63, v55
    v_add_f32 v30, v48, v36
    v_cvt_pk_bf16_f32 v64, v56, v57
    v_cvt_pk_bf16_f32 v65, v58, v59
    v_cvt_pk_bf16_f32 v66, v60, v61
    v_cvt_pk_bf16_f32 v67, v62, v63
    v_accvgpr_write_b32 a88, v64
    v_accvgpr_write_b32 a89, v65
    v_accvgpr_write_b32 a90, v66
    v_accvgpr_write_b32 a91, v67
    v_alignbit_b32 v68, v64, v64, v40
    v_xor_b32 v68, v68, v41
    v_alignbit_b32 v69, v65, v65, v40
    v_xor_b32 v69, v69, v41
    v_alignbit_b32 v70, v66, v66, v40
    v_xor_b32 v70, v70, v41
    v_alignbit_b32 v71, v67, v67, v40
    v_xor_b32 v71, v71, v41
    v_accvgpr_write_b32 a216, v68
    v_accvgpr_write_b32 a217, v69
    v_accvgpr_write_b32 a218, v70
    v_accvgpr_write_b32 a219, v71
    v_fract_f32 v48, v31
    v_add_f32 v49, v48, v33
    v_cos_f32 v56, v48
    v_add_f32 v50, v49, v35
    v_cos_f32 v57, v49
    v_add_f32 v51, v50, v33
    v_cos_f32 v58, v50
    v_add_f32 v52, v51, v35
    v_cos_f32 v59, v51
    v_add_f32 v53, v52, v33
    v_cos_f32 v60, v52
    v_add_f32 v54, v53, v35
    v_cos_f32 v61, v53
    v_add_f32 v55, v54, v33
    v_cos_f32 v62, v54
    v_cos_f32 v63, v55
    v_add_f32 v31, v48, v37
    v_cvt_pk_bf16_f32 v64, v56, v57
    v_cvt_pk_bf16_f32 v65, v58, v59
    v_cvt_pk_bf16_f32 v66, v60, v61
    v_cvt_pk_bf16_f32 v67, v62, v63
    v_accvgpr_write_b32 a92, v64
    v_accvgpr_write_b32 a93, v65
    v_accvgpr_write_b32 a94, v66
    v_accvgpr_write_b32 a95, v67
    v_alignbit_b32 v68, v64, v64, v40
    v_xor_b32 v68, v68, v41
    v_alignbit_b32 v69, v65, v65, v40
    v_xor_b32 v69, v69, v41
    v_alignbit_b32 v70, v66, v66, v40
    v_xor_b32 v70, v70, v41
    v_alignbit_b32 v71, v67, v67, v40
    v_xor_b32 v71, v71, v41
    v_accvgpr_write_b32 a220, v68
    v_accvgpr_write_b32 a221, v69
    v_accvgpr_write_b32 a222, v70
    v_accvgpr_write_b32 a223, v71
    v_fract_f32 v48, v30
    v_add_f32 v49, v48, v32
    v_cos_f32 v56, v48
    v_add_f32 v50, v49, v34
    v_cos_f32 v57, v49
    v_add_f32 v51, v50, v32
    v_cos_f32 v58, v50
    v_add_f32 v52, v51, v34
    v_cos_f32 v59, v51
    v_add_f32 v53, v52, v32
    v_cos_f32 v60, v52
    v_add_f32 v54, v53, v34
    v_cos_f32 v61, v53
    v_add_f32 v55, v54, v32
    v_cos_f32 v62, v54
    v_cos_f32 v63, v55
    v_add_f32 v30, v48, v36
    v_cvt_pk_bf16_f32 v64, v56, v57
    v_cvt_pk_bf16_f32 v65, v58, v59
    v_cvt_pk_bf16_f32 v66, v60, v61
    v_cvt_pk_bf16_f32 v67, v62, v63
    v_accvgpr_write_b32 a96, v64
    v_accvgpr_write_b32 a97, v65
    v_accvgpr_write_b32 a98, v66
    v_accvgpr_write_b32 a99, v67
    v_alignbit_b32 v68, v64, v64, v40
    v_xor_b32 v68, v68, v41
    v_alignbit_b32 v69, v65, v65, v40
    v_xor_b32 v69, v69, v41
    v_alignbit_b32 v70, v66, v66, v40
    v_xor_b32 v70, v70, v41
    v_alignbit_b32 v71, v67, v67, v40
    v_xor_b32 v71, v71, v41
    v_accvgpr_write_b32 a224, v68
    v_accvgpr_write_b32 a225, v69
    v_accvgpr_write_b32 a226, v70
    v_accvgpr_write_b32 a227, v71
    v_fract_f32 v48, v31
    v_add_f32 v49, v48, v33
    v_cos_f32 v56, v48
    v_add_f32 v50, v49, v35
    v_cos_f32 v57, v49
    v_add_f32 v51, v50, v33
    v_cos_f32 v58, v50
    v_add_f32 v52, v51, v35
    v_cos_f32 v59, v51
    v_add_f32 v53, v52, v33
    v_cos_f32 v60, v52
    v_add_f32 v54, v53, v35
    v_cos_f32 v61, v53
    v_add_f32 v55, v54, v33
    v_cos_f32 v62, v54
    v_cos_f32 v63, v55
    v_add_f32 v31, v48, v37
    v_cvt_pk_bf16_f32 v64, v56, v57
    v_cvt_pk_bf16_f32 v65, v58, v59
    v_cvt_pk_bf16_f32 v66, v60, v61
    v_cvt_pk_bf16_f32 v67, v62, v63
    v_accvgpr_write_b32 a100, v64
    v_accvgpr_write_b32 a101, v65
    v_accvgpr_write_b32 a102, v66
    v_accvgpr_write_b32 a103, v67
    v_alignbit_b32 v68, v64, v64, v40
    v_xor_b32 v68, v68, v41
    v_alignbit_b32 v69, v65, v65, v40
    v_xor_b32 v69, v69, v41
    v_alignbit_b32 v70, v66, v66, v40
    v_xor_b32 v70, v70, v41
    v_alignbit_b32 v71, v67, v67, v40
    v_xor_b32 v71, v71, v41
    v_accvgpr_write_b32 a228, v68
    v_accvgpr_write_b32 a229, v69
    v_accvgpr_write_b32 a230, v70
    v_accvgpr_write_b32 a231, v71
    v_fract_f32 v48, v30
    v_add_f32 v49, v48, v32
    v_cos_f32 v56, v48
    v_add_f32 v50, v49, v34
    v_cos_f32 v57, v49
    v_add_f32 v51, v50, v32
    v_cos_f32 v58, v50
    v_add_f32 v52, v51, v34
    v_cos_f32 v59, v51
    v_add_f32 v53, v52, v32
    v_cos_f32 v60, v52
    v_add_f32 v54, v53, v34
    v_cos_f32 v61, v53
    v_add_f32 v55, v54, v32
    v_cos_f32 v62, v54
    v_cos_f32 v63, v55
    v_add_f32 v30, v48, v36
    v_cvt_pk_bf16_f32 v64, v56, v57
    v_cvt_pk_bf16_f32 v65, v58, v59
    v_cvt_pk_bf16_f32 v66, v60, v61
    v_cvt_pk_bf16_f32 v67, v62, v63
    v_accvgpr_write_b32 a104, v64
    v_accvgpr_write_b32 a105, v65
    v_accvgpr_write_b32 a106, v66
    v_accvgpr_write_b32 a107, v67
    v_alignbit_b32 v68, v64, v64, v40
    v_xor_b32 v68, v68, v41
    v_alignbit_b32 v69, v65, v65, v40
    v_xor_b32 v69, v69, v41
    v_alignbit_b32 v70, v66, v66, v40
    v_xor_b32 v70, v70, v41
    v_alignbit_b32 v71, v67, v67, v40
    v_xor_b32 v71, v71, v41
    v_accvgpr_write_b32 a232, v68
    v_accvgpr_write_b32 a233, v69
    v_accvgpr_write_b32 a234, v70
    v_accvgpr_write_b32 a235, v71
    v_fract_f32 v48, v31
    v_add_f32 v49, v48, v33
    v_cos_f32 v56, v48
    v_add_f32 v50, v49, v35
    v_cos_f32 v57, v49
    v_add_f32 v51, v50, v33
    v_cos_f32 v58, v50
    v_add_f32 v52, v51, v35
    v_cos_f32 v59, v51
    v_add_f32 v53, v52, v33
    v_cos_f32 v60, v52
    v_add_f32 v54, v53, v35
    v_cos_f32 v61, v53
    v_add_f32 v55, v54, v33
    v_cos_f32 v62, v54
    v_cos_f32 v63, v55
    v_add_f32 v31, v48, v37
    v_cvt_pk_bf16_f32 v64, v56, v57
    v_cvt_pk_bf16_f32 v65, v58, v59
    v_cvt_pk_bf16_f32 v66, v60, v61
    v_cvt_pk_bf16_f32 v67, v62, v63
    v_accvgpr_write_b32 a108, v64
    v_accvgpr_write_b32 a109, v65
    v_accvgpr_write_b32 a110, v66
    v_accvgpr_write_b32 a111, v67
    v_alignbit_b32 v68, v64, v64, v40
    v_xor_b32 v68, v68, v41
    v_alignbit_b32 v69, v65, v65, v40
    v_xor_b32 v69, v69, v41
    v_alignbit_b32 v70, v66, v66, v40
    v_xor_b32 v70, v70, v41
    v_alignbit_b32 v71, v67, v67, v40
    v_xor_b32 v71, v71, v41
    v_accvgpr_write_b32 a236, v68
    v_accvgpr_write_b32 a237, v69
    v_accvgpr_write_b32 a238, v70
    v_accvgpr_write_b32 a239, v71
    v_fract_f32 v48, v30
    v_add_f32 v49, v48, v32
    v_cos_f32 v56, v48
    v_add_f32 v50, v49, v34
    v_cos_f32 v57, v49
    v_add_f32 v51, v50, v32
    v_cos_f32 v58, v50
    v_add_f32 v52, v51, v34
    v_cos_f32 v59, v51
    v_add_f32 v53, v52, v32
    v_cos_f32 v60, v52
    v_add_f32 v54, v53, v34
    v_cos_f32 v61, v53
    v_add_f32 v55, v54, v32
    v_cos_f32 v62, v54
    v_cos_f32 v63, v55
    v_add_f32 v30, v48, v36
    v_cvt_pk_bf16_f32 v64, v56, v57
    v_cvt_pk_bf16_f32 v65, v58, v59
    v_cvt_pk_bf16_f32 v66, v60, v61
    v_cvt_pk_bf16_f32 v67, v62, v63
    v_accvgpr_write_b32 a112, v64
    v_accvgpr_write_b32 a113, v65
    v_accvgpr_write_b32 a114, v66
    v_accvgpr_write_b32 a115, v67
    v_alignbit_b32 v68, v64, v64, v40
    v_xor_b32 v68, v68, v41
    v_alignbit_b32 v69, v65, v65, v40
    v_xor_b32 v69, v69, v41
    v_alignbit_b32 v70, v66, v66, v40
    v_xor_b32 v70, v70, v41
    v_alignbit_b32 v71, v67, v67, v40
    v_xor_b32 v71, v71, v41
    v_accvgpr_write_b32 a240, v68
    v_accvgpr_write_b32 a241, v69
    v_accvgpr_write_b32 a242, v70
    v_accvgpr_write_b32 a243, v71
    v_fract_f32 v48, v31
    v_add_f32 v49, v48, v33
    v_cos_f32 v56, v48
    v_add_f32 v50, v49, v35
    v_cos_f32 v57, v49
    v_add_f32 v51, v50, v33
    v_cos_f32 v58, v50
    v_add_f32 v52, v51, v35
    v_cos_f32 v59, v51
    v_add_f32 v53, v52, v33
    v_cos_f32 v60, v52
    v_add_f32 v54, v53, v35
    v_cos_f32 v61, v53
    v_add_f32 v55, v54, v33
    v_cos_f32 v62, v54
    v_cos_f32 v63, v55
    v_add_f32 v31, v48, v37
    v_cvt_pk_bf16_f32 v64, v56, v57
    v_cvt_pk_bf16_f32 v65, v58, v59
    v_cvt_pk_bf16_f32 v66, v60, v61
    v_cvt_pk_bf16_f32 v67, v62, v63
    v_accvgpr_write_b32 a116, v64
    v_accvgpr_write_b32 a117, v65
    v_accvgpr_write_b32 a118, v66
    v_accvgpr_write_b32 a119, v67
    v_alignbit_b32 v68, v64, v64, v40
    v_xor_b32 v68, v68, v41
    v_alignbit_b32 v69, v65, v65, v40
    v_xor_b32 v69, v69, v41
    v_alignbit_b32 v70, v66, v66, v40
    v_xor_b32 v70, v70, v41
    v_alignbit_b32 v71, v67, v67, v40
    v_xor_b32 v71, v71, v41
    v_accvgpr_write_b32 a244, v68
    v_accvgpr_write_b32 a245, v69
    v_accvgpr_write_b32 a246, v70
    v_accvgpr_write_b32 a247, v71
    v_fract_f32 v48, v30
    v_add_f32 v49, v48, v32
    v_cos_f32 v56, v48
    v_add_f32 v50, v49, v34
    v_cos_f32 v57, v49
    v_add_f32 v51, v50, v32
    v_cos_f32 v58, v50
    v_add_f32 v52, v51, v34
    v_cos_f32 v59, v51
    v_add_f32 v53, v52, v32
    v_cos_f32 v60, v52
    v_add_f32 v54, v53, v34
    v_cos_f32 v61, v53
    v_add_f32 v55, v54, v32
    v_cos_f32 v62, v54
    v_cos_f32 v63, v55
    v_add_f32 v30, v48, v36
    v_cvt_pk_bf16_f32 v64, v56, v57
    v_cvt_pk_bf16_f32 v65, v58, v59
    v_cvt_pk_bf16_f32 v66, v60, v61
    v_cvt_pk_bf16_f32 v67, v62, v63
    v_accvgpr_write_b32 a120, v64
    v_accvgpr_write_b32 a121, v65
    v_accvgpr_write_b32 a122, v66
    v_accvgpr_write_b32 a123, v67
    v_alignbit_b32 v68, v64, v64, v40
    v_xor_b32 v68, v68, v41
    v_alignbit_b32 v69, v65, v65, v40
    v_xor_b32 v69, v69, v41
    v_alignbit_b32 v70, v66, v66, v40
    v_xor_b32 v70, v70, v41
    v_alignbit_b32 v71, v67, v67, v40
    v_xor_b32 v71, v71, v41
    v_accvgpr_write_b32 a248, v68
    v_accvgpr_write_b32 a249, v69
    v_accvgpr_write_b32 a250, v70
    v_accvgpr_write_b32 a251, v71
    v_fract_f32 v48, v31
    v_add_f32 v49, v48, v33
    v_cos_f32 v56, v48
    v_add_f32 v50, v49, v35
    v_cos_f32 v57, v49
    v_add_f32 v51, v50, v33
    v_cos_f32 v58, v50
    v_add_f32 v52, v51, v35
    v_cos_f32 v59, v51
    v_add_f32 v53, v52, v33
    v_cos_f32 v60, v52
    v_add_f32 v54, v53, v35
    v_cos_f32 v61, v53
    v_add_f32 v55, v54, v33
    v_cos_f32 v62, v54
    v_cos_f32 v63, v55
    v_add_f32 v31, v48, v37
    v_cvt_pk_bf16_f32 v64, v56, v57
    v_cvt_pk_bf16_f32 v65, v58, v59
    v_cvt_pk_bf16_f32 v66, v60, v61
    v_cvt_pk_bf16_f32 v67, v62, v63
    v_accvgpr_write_b32 a124, v64
    v_accvgpr_write_b32 a125, v65
    v_accvgpr_write_b32 a126, v66
    v_accvgpr_write_b32 a127, v67
    v_alignbit_b32 v68, v64, v64, v40
    v_xor_b32 v68, v68, v41
    v_alignbit_b32 v69, v65, v65, v40
    v_xor_b32 v69, v69, v41
    v_alignbit_b32 v70, v66, v66, v40
    v_xor_b32 v70, v70, v41
    v_alignbit_b32 v71, v67, v67, v40
    v_xor_b32 v71, v71, v41
    v_accvgpr_write_b32 a252, v68
    v_accvgpr_write_b32 a253, v69
    v_accvgpr_write_b32 a254, v70
    v_accvgpr_write_b32 a255, v71
    v_lshlrev_b32 v6, 31, v38
    v_or_b32 v6, 0x3f003f00, v6
    v_cmp_gt_u32 vcc, 16, v1
    v_accvgpr_read_b32 v5, a0
    s_nop 0
    v_cndmask_b32 v5, v5, v6, vcc
    v_accvgpr_write_b32 a0, v5
    v_accvgpr_read_b32 v5, a4
    v_cndmask_b32 v5, v5, v6, vcc
    v_accvgpr_write_b32 a4, v5
    v_and_b32 v5, 15, v1
    v_lshrrev_b32 v6, 4, v1
    v_lshlrev_b32 v5, 4, v5
    v_lshl_add_u32 v10, v6, 9, v5
    v_add_u32 v11, 2048, v10
    v_add_u32 v12, 0x10000, v10
    v_add_u32 v13, 0x10000, v11
    s_lshl_b32 s19, s16, 10
    s_lshl_b32 s17, s16, 1
    v_lshrrev_b32 v8, 5, v1
    v_add_u32 v8, s17, v8
    v_and_b32 v7, 31, v1
    v_mul_u32_u24 v2, 33024, v8
    v_lshl_add_u32 v2, v7, 4, v2
    v_and_b32 v3, 15, v1
    v_and_b32 v5, 48, v1
    v_lshl_add_u32 v3, v3, 12, v5
    v_add_u32 v4, 0x10000, v3
    s_lshl_b32 s21, s28, 21
    s_lshl_b32 s17, s29, 6
    s_add_u32 s21, s21, s17
    s_lshl_b32 s20, s28, 13
    s_add_u32 s20, s20, 111149056
    s_mov_b32 s24, 512
    s_mov_b32 s25, 131072
    v_and_b32 v7, 31, v1
    v_lshlrev_b32 v7, 7, v7
    s_lshl_b32 s17, s16, 12
    s_add_u32 s17, s17, 100761600
    v_add_u32 v7, s17, v7
    s_mov_b32 s30, s92
F3_w0:
    buffer_load_dword v5, v7, s[4:7], 0 offen sc1
    s_waitcnt vmcnt(0)
    v_cmp_gt_u32 vcc, 1, v5
    s_nop 0
    s_cmp_lg_u64 vcc, 0
    s_cbranch_scc0 F3_w0_ok
    s_cmp_ge_u32 s30, 1048576
    s_cselect_b32 s92, 1048576, s92
    s_cbranch_scc1 F3_w0_ok
    s_add_u32 s30, s30, 1
    s_sleep 8
    s_branch F3_w0
F3_w0_ok:
    s_barrier
    s_mov_b32 s26, s25
    s_sub_u32 s25, s21, 1073741824
    s_mov_b32 s21, 1073741824
    s_mov_b32 s23, 0
    s_mov_b32 s22, 0
    s_add_u32 m0, s19, 0
    s_add_u32 s17, s20, 0
    buffer_load_dwordx4 v2, s[4:7], s17 offen lds
    s_add_u32 m0, s19, 4096
    s_add_u32 s17, s20, 264192
    buffer_load_dwordx4 v2, s[4:7], s17 offen lds
    s_add_u32 m0, s19, 8192
    s_add_u32 s17, s20, 528384
    buffer_load_dwordx4 v2, s[4:7], s17 offen lds
    s_add_u32 m0, s19, 12288
    s_add_u32 s17, s20, 792576
    buffer_load_dwordx4 v2, s[4:7], s17 offen lds
    s_add_u32 m0, s19, 16384
    s_add_u32 s17, s20, 1056768
    buffer_load_dwordx4 v2, s[4:7], s17 offen lds
    s_add_u32 m0, s19, 20480
    s_add_u32 s17, s20, 1320960
    buffer_load_dwordx4 v2, s[4:7], s17 offen lds
    s_add_u32 m0, s19, 24576
    s_add_u32 s17, s20, 1585152
    buffer_load_dwordx4 v2, s[4:7], s17 offen lds
    s_add_u32 m0, s19, 28672
    s_add_u32 s17, s20, 1849344
    buffer_load_dwordx4 v2, s[4:7], s17 offen lds
    s_add_u32 m0, s19, 32768
    s_add_u32 s17, s20, 2113536
    buffer_load_dwordx4 v2, s[4:7], s17 offen lds
    s_add_u32 m0, s19, 36864
    s_add_u32 s17, s20, 2377728
    buffer_load_dwordx4 v2, s[4:7], s17 offen lds
    s_add_u32 m0, s19, 40960
    s_add_u32 s17, s20, 2641920
    buffer_load_dwordx4 v2, s[4:7], s17 offen lds
    s_add_u32 m0, s19, 45056
    s_add_u32 s17, s20, 2906112
    buffer_load_dwordx4 v2, s[4:7], s17 offen lds
    s_add_u32 m0, s19, 49152
    s_add_u32 s17, s20, 3170304
    buffer_load_dwordx4 v2, s[4:7], s17 offen lds
    s_add_u32 m0, s19, 53248
    s_add_u32 s17, s20, 3434496
    buffer_load_dwordx4 v2, s[4:7], s17 offen lds
    s_add_u32 m0, s19, 57344
    s_add_u32 s17, s20, 3698688
    buffer_load_dwordx4 v2, s[4:7], s17 offen lds
    s_add_u32 m0, s19, 61440
    s_add_u32 s17, s20, 3962880
    buffer_load_dwordx4 v2, s[4:7], s17 offen lds
    s_add_u32 s20, s20, s24
    s_add_u32 m0, s19, 65536
    s_add_u32 s17, s20, 0
    buffer_load_dwordx4 v2, s[4:7], s17 offen lds
    s_add_u32 m0, s19, 69632
    s_add_u32 s17, s20, 264192
    buffer_load_dwordx4 v2, s[4:7], s17 offen lds
    s_add_u32 m0, s19, 73728
    s_add_u32 s17, s20, 528384
    buffer_load_dwordx4 v2, s[4:7], s17 offen lds
    s_waitcnt vmcnt(11)
    s_barrier
    ds_read_b128 v[20:23], v10 offset:0
    ds_read_b128 v[24:27], v10 offset:256
    ds_read_b128 v[28:31], v11 offset:0
    ds_read_b128 v[32:35], v11 offset:256
    ds_read_b128 v[36:39], v10 offset:4096
    ds_read_b128 v[40:43], v10 offset:4352
    ds_read_b128 v[44:47], v11 offset:4096
.p2align 6
F3_top:
    s_waitcnt lgkmcnt(6)
    v_mfma_f32_16x16x32_bf16 v[52:55], a[0:3], v[20:23], 0
    ds_read_b128 v[48:51], v11 offset:4352
    v_mfma_f32_16x16x32_bf16 v[56:59], a[4:7], v[20:23], 0
    s_waitcnt lgkmcnt(6)
    v_mfma_f32_16x16x32_bf16 v[60:63], a[0:3], v[24:27], 0
    ds_read_b128 v[20:23], v10 offset:8192
    s_add_u32 m0, s19, 77824
    v_mfma_f32_16x16x32_bf16 v[64:67], a[4:7], v[24:27], 0
    s_add_u32 s17, s20, 792576
    buffer_load_dwordx4 v2, s[4:7], s17 offen lds
    s_waitcnt lgkmcnt(6)
    v_mfma_f32_16x16x32_bf16 v[52:55], a[8:11], v[28:31], v[52:55]
    ds_read_b128 v[24:27], v10 offset:8448
    v_mfma_f32_16x16x32_bf16 v[56:59], a[12:15], v[28:31], v[56:59]
    s_waitcnt lgkmcnt(6)
    v_mfma_f32_16x16x32_bf16 v[60:63], a[8:11], v[32:35], v[60:63]
    ds_read_b128 v[28:31], v11 offset:8192
    s_add_u32 m0, s19, 81920
    v_mfma_f32_16x16x32_bf16 v[64:67], a[12:15], v[32:35], v[64:67]
    s_add_u32 s17, s20, 1056768
    buffer_load_dwordx4 v2, s[4:7], s17 offen lds
    s_waitcnt lgkmcnt(6)
    v_mfma_f32_16x16x32_bf16 v[52:55], a[16:19], v[36:39], v[52:55]
    ds_read_b128 v[32:35], v11 offset:8448
    v_mfma_f32_16x16x32_bf16 v[56:59], a[20:23], v[36:39], v[56:59]
    s_waitcnt lgkmcnt(6)
    v_mfma_f32_16x16x32_bf16 v[60:63], a[16:19], v[40:43], v[60:63]
    ds_read_b128 v[36:39], v10 offset:12288
    s_add_u32 m0, s19, 86016
    v_mfma_f32_16x16x32_bf16 v[64:67], a[20:23], v[40:43], v[64:67]
    s_add_u32 s17, s20, 1320960
    buffer_load_dwordx4 v2, s[4:7], s17 offen lds
    s_waitcnt lgkmcnt(6)
    v_mfma_f32_16x16x32_bf16 v[52:55], a[24:27], v[44:47], v[52:55]
    ds_read_b128 v[40:43], v10 offset:12544
    v_mfma_f32_16x16x32_bf16 v[56:59], a[28:31], v[44:47], v[56:59]
    s_waitcnt lgkmcnt(6)
    v_mfma_f32_16x16x32_bf16 v[60:63], a[24:27], v[48:51], v[60:63]
    ds_read_b128 v[44:47], v11 offset:12288
    s_add_u32 m0, s19, 90112
    v_mfma_f32_16x16x32_bf16 v[64:67], a[28:31], v[48:51], v[64:67]
    s_add_u32 s17, s20, 1585152
    buffer_load_dwordx4 v2, s[4:7], s17 offen lds
    s_waitcnt lgkmcnt(6)
    v_mfma_f32_16x16x32_bf16 v[52:55], a[32:35], v[20:23], v[52:55]
    ds_read_b128 v[48:51], v11 offset:12544
    v_mfma_f32_16x16x32_bf16 v[56:59], a[36:39], v[20:23], v[56:59]
    s_waitcnt lgkmcnt(6)
    v_mfma_f32_16x16x32_bf16 v[60:63], a[32:35], v[24:27], v[60:63]
    ds_read_b128 v[20:23], v10 offset:16384
    s_add_u32 m0, s19, 94208
    v_mfma_f32_16x16x32_bf16 v[64:67], a[36:39], v[24:27], v[64:67]
    s_add_u32 s17, s20, 1849344
    buffer_load_dwordx4 v2, s[4:7], s17 offen lds
    s_waitcnt lgkmcnt(6)
    v_mfma_f32_16x16x32_bf16 v[52:55], a[40:43], v[28:31], v[52:55]
    ds_read_b128 v[24:27], v10 offset:16640
    v_mfma_f32_16x16x32_bf16 v[56:59], a[44:47], v[28:31], v[56:59]
    v_cvt_pk_bf16_f32 v84, v68, v69
    s_waitcnt lgkmcnt(6)
    v_mfma_f32_16x16x32_bf16 v[60:63], a[40:43], v[32:35], v[60:63]
    ds_read_b128 v[28:31], v11 offset:16384
    v_mfma_f32_16x16x32_bf16 v[64:67], a[44:47], v[32:35], v[64:67]
    v_cvt_pk_bf16_f32 v85, v70, v71
    s_waitcnt lgkmcnt(6)
    v_mfma_f32_16x16x32_bf16 v[52:55], a[48:51], v[36:39], v[52:55]
    ds_read_b128 v[32:35], v11 offset:16640
    v_mfma_f32_16x16x32_bf16 v[56:59], a[52:55], v[36:39], v[56:59]
    v_cvt_pk_bf16_f32 v86, v72, v73
    s_waitcnt lgkmcnt(6)
    v_mfma_f32_16x16x32_bf16 v[60:63], a[48:51], v[40:43], v[60:63]
    ds_read_b128 v[36:39], v10 offset:20480
    v_mfma_f32_16x16x32_bf16 v[64:67], a[52:55], v[40:43], v[64:67]
    v_cvt_pk_bf16_f32 v87, v74, v75
    s_waitcnt lgkmcnt(6)
    v_mfma_f32_16x16x32_bf16 v[52:55], a[56:59], v[44:47], v[52:55]
    ds_read_b128 v[40:43], v10 offset:20736
    v_mfma_f32_16x16x32_bf16 v[56:59], a[60:63], v[44:47], v[56:59]
    v_cvt_pk_bf16_f32 v88, v76, v77
    s_waitcnt lgkmcnt(6)
    v_mfma_f32_16x16x32_bf16 v[60:63], a[56:59], v[48:51], v[60:63]
    ds_read_b128 v[44:47], v11 offset:20480
    v_mfma_f32_16x16x32_bf16 v[64:67], a[60:63], v[48:51], v[64:67]
    v_cvt_pk_bf16_f32 v89, v78, v79
    buffer_store_dwordx4 v[84:87], v3, s[12:15], s21 offen
    s_waitcnt lgkmcnt(6)
    v_mfma_f32_16x16x32_bf16 v[52:55], a[64:67], v[20:23], v[52:55]
    ds_read_b128 v[48:51], v11 offset:20736
    v_mfma_f32_16x16x32_bf16 v[56:59], a[68:71], v[20:23], v[56:59]
    v_cvt_pk_bf16_f32 v90, v80, v81
    s_waitcnt lgkmcnt(6)
    v_mfma_f32_16x16x32_bf16 v[60:63], a[64:67], v[24:27], v[60:63]
    ds_read_b128 v[20:23], v10 offset:24576
    v_mfma_f32_16x16x32_bf16 v[64:67], a[68:71], v[24:27], v[64:67]
    v_cvt_pk_bf16_f32 v91, v82, v83
    s_waitcnt lgkmcnt(6)
    v_mfma_f32_16x16x32_bf16 v[52:55], a[72:75], v[28:31], v[52:55]
    ds_read_b128 v[24:27], v10 offset:24832
    v_mfma_f32_16x16x32_bf16 v[56:59], a[76:79], v[28:31], v[56:59]
    s_waitcnt lgkmcnt(6)
    v_mfma_f32_16x16x32_bf16 v[60:63], a[72:75], v[32:35], v[60:63]
    ds_read_b128 v[28:31], v11 offset:24576
    v_mfma_f32_16x16x32_bf16 v[64:67], a[76:79], v[32:35], v[64:67]
    buffer_store_dwordx4 v[88:91], v4, s[12:15], s21 offen
    s_waitcnt lgkmcnt(6)
    v_mfma_f32_16x16x32_bf16 v[52:55], a[80:83], v[36:39], v[52:55]
    ds_read_b128 v[32:35], v11 offset:24832
    v_mfma_f32_16x16x32_bf16 v[56:59], a[84:87], v[36:39], v[56:59]
    s_add_u32 s21, s21, s25
    s_mov_b32 s25, s26
    s_waitcnt lgkmcnt(6)
    v_mfma_f32_16x16x32_bf16 v[60:63], a[80:83], v[40:43], v[60:63]
    ds_read_b128 v[36:39], v10 offset:28672
    v_mfma_f32_16x16x32_bf16 v[64:67], a[84:87], v[40:43], v[64:67]
    s_waitcnt lgkmcnt(6)
    v_mfma_f32_16x16x32_bf16 v[52:55], a[88:91], v[44:47], v[52:55]
    ds_read_b128 v[40:43], v10 offset:28928
    v_mfma_f32_16x16x32_bf16 v[56:59], a[92:95], v[44:47], v[56:59]
    s_waitcnt lgkmcnt(6)
    v_mfma_f32_16x16x32_bf16 v[60:63], a[88:91], v[48:51], v[60:63]
    ds_read_b128 v[44:47], v11 offset:28672
    v_mfma_f32_16x16x32_bf16 v[64:67], a[92:95], v[48:51], v[64:67]
    s_waitcnt lgkmcnt(6)
    v_mfma_f32_16x16x32_bf16 v[52:55], a[96:99], v[20:23], v[52:55]
    ds_read_b128 v[48:51], v11 offset:28928
    v_mfma_f32_16x16x32_bf16 v[56:59], a[100:103], v[20:23], v[56:59]
    s_waitcnt lgkmcnt(6)
    v_mfma_f32_16x16x32_bf16 v[60:63], a[96:99], v[24:27], v[60:63]
    s_waitcnt vmcnt(10)
    s_barrier
    ds_read_b128 v[20:23], v10 offset:32768
    v_mfma_f32_16x16x32_bf16 v[64:67], a[100:103], v[24:27], v[64:67]
    s_waitcnt lgkmcnt(6)
    v_mfma_f32_16x16x32_bf16 v[52:55], a[104:107], v[28:31], v[52:55]
    ds_read_b128 v[24:27], v10 offset:33024
    s_add_u32 m0, s19, 98304
    v_mfma_f32_16x16x32_bf16 v[56:59], a[108:111], v[28:31], v[56:59]
    s_add_u32 s17, s20, 2113536
    buffer_load_dwordx4 v2, s[4:7], s17 offen lds
    s_waitcnt lgkmcnt(6)
    v_mfma_f32_16x16x32_bf16 v[60:63], a[104:107], v[32:35], v[60:63]
    ds_read_b128 v[28:31], v11 offset:32768
    v_mfma_f32_16x16x32_bf16 v[64:67], a[108:111], v[32:35], v[64:67]
    s_waitcnt lgkmcnt(6)
    v_mfma_f32_16x16x32_bf16 v[52:55], a[112:115], v[36:39], v[52:55]
    ds_read_b128 v[32:35], v11 offset:33024
    s_add_u32 m0, s19, 102400
    v_mfma_f32_16x16x32_bf16 v[56:59], a[116:119], v[36:39], v[56:59]
    s_add_u32 s17, s20, 2377728
    buffer_load_dwordx4 v2, s[4:7], s17 offen lds
    s_waitcnt lgkmcnt(6)
    v_mfma_f32_16x16x32_bf16 v[60:63], a[112:115], v[40:43], v[60:63]
    ds_read_b128 v[36:39], v10 offset:36864
    v_mfma_f32_16x16x32_bf16 v[64:67], a[116:119], v[40:43], v[64:67]
    s_waitcnt lgkmcnt(6)
    v_mfma_f32_16x16x32_bf16 v[52:55], a[120:123], v[44:47], v[52:55]
    ds_read_b128 v[40:43], v10 offset:37120
    s_add_u32 m0, s19, 106496
    v_mfma_f32_16x16x32_bf16 v[56:59], a[124:127], v[44:47], v[56:59]
    s_add_u32 s17, s20, 2641920
    buffer_load_dwordx4 v2, s[4:7], s17 offen lds
    s_waitcnt lgkmcnt(6)
    v_mfma_f32_16x16x32_bf16 v[60:63], a[120:123], v[48:51], v[60:63]
    ds_read_b128 v[44:47], v11 offset:36864
    v_mfma_f32_16x16x32_bf16 v[64:67], a[124:127], v[48:51], v[64:67]
    s_waitcnt lgkmcnt(6)
    v_mfma_f32_16x16x32_bf16 v[52:55], a[128:131], v[20:23], v[52:55]
    ds_read_b128 v[48:51], v11 offset:37120
    v_mfma_f32_16x16x32_bf16 v[56:59], a[132:135], v[20:23], v[56:59]
    s_waitcnt lgkmcnt(6)
    v_mfma_f32_16x16x32_bf16 v[60:63], a[128:131], v[24:27], v[60:63]
    ds_read_b128 v[20:23], v10 offset:40960
    s_add_u32 m0, s19, 110592
    v_mfma_f32_16x16x32_bf16 v[64:67], a[132:135], v[24:27], v[64:67]
    s_add_u32 s17, s20, 2906112
    buffer_load_dwordx4 v2, s[4:7], s17 offen lds
    s_waitcnt lgkmcnt(6)
    v_mfma_f32_16x16x32_bf16 v[52:55], a[136:139], v[28:31], v[52:55]
    ds_read_b128 v[24:27], v10 offset:41216
    v_mfma_f32_16x16x32_bf16 v[56:59], a[140:143], v[28:31], v[56:59]
    s_waitcnt lgkmcnt(6)
    v_mfma_f32_16x16x32_bf16 v[60:63], a[136:139], v[32:35], v[60:63]
    ds_read_b128 v[28:31], v11 offset:40960
    s_add_u32 m0, s19, 114688
    v_mfma_f32_16x16x32_bf16 v[64:67], a[140:143], v[32:35], v[64:67]
    s_add_u32 s17, s20, 3170304
    buffer_load_dwordx4 v2, s[4:7], s17 offen lds
    s_waitcnt lgkmcnt(6)
    v_mfma_f32_16x16x32_bf16 v[52:55], a[144:147], v[36:39], v[52:55]
    ds_read_b128 v[32:35], v11 offset:41216
    v_mfma_f32_16x16x32_bf16 v[56:59], a[148:151], v[36:39], v[56:59]
    s_waitcnt lgkmcnt(6)
    v_mfma_f32_16x16x32_bf16 v[60:63], a[144:147], v[40:43], v[60:63]
    ds_read_b128 v[36:39], v10 offset:45056
    s_add_u32 m0, s19, 118784
    v_mfma_f32_16x16x32_bf16 v[64:67], a[148:151], v[40:43], v[64:67]
    s_add_u32 s17, s20, 3434496
    buffer_load_dwordx4 v2, s[4:7], s17 offen lds
    s_waitcnt lgkmcnt(6)
    v_mfma_f32_16x16x32_bf16 v[52:55], a[152:155], v[44:47], v[52:55]
    ds_read_b128 v[40:43], v10 offset:45312
    v_mfma_f32_16x16x32_bf16 v[56:59], a[156:159], v[44:47], v[56:59]
    s_waitcnt lgkmcnt(6)
    v_mfma_f32_16x16x32_bf16 v[60:63], a[152:155], v[48:51], v[60:63]
    ds_read_b128 v[44:47], v11 offset:45056
    s_add_u32 m0, s19, 122880
    v_mfma_f32_16x16x32_bf16 v[64:67], a[156:159], v[48:51], v[64:67]
    s_add_u32 s17, s20, 3698688
    buffer_load_dwordx4 v2, s[4:7], s17 offen lds
    s_waitcnt lgkmcnt(6)
    v_mfma_f32_16x16x32_bf16 v[52:55], a[160:163], v[20:23], v[52:55]
    ds_read_b128 v[48:51], v11 offset:45312
    v_mfma_f32_16x16x32_bf16 v[56:59], a[164:167], v[20:23], v[56:59]
    s_waitcnt lgkmcnt(6)
    v_mfma_f32_16x16x32_bf16 v[60:63], a[160:163], v[24:27], v[60:63]
    ds_read_b128 v[20:23], v10 offset:49152
    s_add_u32 m0, s19, 126976
    v_mfma_f32_16x16x32_bf16 v[64:67], a[164:167], v[24:27], v[64:67]
    s_add_u32 s17, s20, 3962880
    buffer_load_dwordx4 v2, s[4:7], s17 offen lds
    s_waitcnt lgkmcnt(6)
    v_mfma_f32_16x16x32_bf16 v[52:55], a[168:171], v[28:31], v[52:55]
    ds_read_b128 v[24:27], v10 offset:49408
    v_mfma_f32_16x16x32_bf16 v[56:59], a[172:175], v[28:31], v[56:59]
    s_add_u32 s20, s20, s24
    s_waitcnt lgkmcnt(6)
    v_mfma_f32_16x16x32_bf16 v[60:63], a[168:171], v[32:35], v[60:63]
    ds_read_b128 v[28:31], v11 offset:49152
    v_mfma_f32_16x16x32_bf16 v[64:67], a[172:175], v[32:35], v[64:67]
    s_waitcnt lgkmcnt(6)
    v_mfma_f32_16x16x32_bf16 v[52:55], a[176:179], v[36:39], v[52:55]
    ds_read_b128 v[32:35], v11 offset:49408
    v_mfma_f32_16x16x32_bf16 v[56:59], a[180:183], v[36:39], v[56:59]
    s_waitcnt lgkmcnt(6)
    v_mfma_f32_16x16x32_bf16 v[60:63], a[176:179], v[40:43], v[60:63]
    ds_read_b128 v[36:39], v10 offset:53248
    v_mfma_f32_16x16x32_bf16 v[64:67], a[180:183], v[40:43], v[64:67]
    s_waitcnt lgkmcnt(6)
    v_mfma_f32_16x16x32_bf16 v[52:55], a[184:187], v[44:47], v[52:55]
    ds_read_b128 v[40:43], v10 offset:53504
    v_mfma_f32_16x16x32_bf16 v[56:59], a[188:191], v[44:47], v[56:59]
    s_waitcnt lgkmcnt(6)
    v_mfma_f32_16x16x32_bf16 v[60:63], a[184:187], v[48:51], v[60:63]
    ds_read_b128 v[44:47], v11 offset:53248
    v_mfma_f32_16x16x32_bf16 v[64:67], a[188:191], v[48:51], v[64:67]
    s_waitcnt lgkmcnt(6)
    v_mfma_f32_16x16x32_bf16 v[52:55], a[192:195], v[20:23], v[52:55]
    ds_read_b128 v[48:51], v11 offset:53504
    v_mfma_f32_16x16x32_bf16 v[56:59], a[196:199], v[20:23], v[56:59]
    s_waitcnt lgkmcnt(6)
    v_mfma_f32_16x16x32_bf16 v[60:63], a[192:195], v[24:27], v[60:63]
    ds_read_b128 v[20:23], v10 offset:57344
    v_mfma_f32_16x16x32_bf16 v[64:67], a[196:199], v[24:27], v[64:67]
    s_waitcnt lgkmcnt(6)
    v_mfma_f32_16x16x32_bf16 v[52:55], a[200:203], v[28:31], v[52:55]
    ds_read_b128 v[24:27], v10 offset:57600
    v_mfma_f32_16x16x32_bf16 v[56:59], a[204:207], v[28:31], v[56:59]
    s_waitcnt lgkmcnt(6)
    v_mfma_f32_16x16x32_bf16 v[60:63], a[200:203], v[32:35], v[60:63]
    ds_read_b128 v[28:31], v11 offset:57344
    v_mfma_f32_16x16x32_bf16 v[64:67], a[204:207], v[32:35], v[64:67]
    s_waitcnt lgkmcnt(6)
    v_mfma_f32_16x16x32_bf16 v[52:55], a[208:211], v[36:39], v[52:55]
    ds_read_b128 v[32:35], v11 offset:57600
    v_mfma_f32_16x16x32_bf16 v[56:59], a[212:215], v[36:39], v[56:59]
    s_waitcnt lgkmcnt(6)
    v_mfma_f32_16x16x32_bf16 v[60:63], a[208:211], v[40:43], v[60:63]
    ds_read_b128 v[36:39], v10 offset:61440
    v_mfma_f32_16x16x32_bf16 v[64:67], a[212:215], v[40:43], v[64:67]
    s_waitcnt lgkmcnt(6)
    v_mfma_f32_16x16x32_bf16 v[52:55], a[216:219], v[44:47], v[52:55]
    ds_read_b128 v[40:43], v10 offset:61696
    v_mfma_f32_16x16x32_bf16 v[56:59], a[220:223], v[44:47], v[56:59]
    s_waitcnt lgkmcnt(6)
    v_mfma_f32_16x16x32_bf16 v[60:63], a[216:219], v[48:51], v[60:63]
    ds_read_b128 v[44:47], v11 offset:61440
    v_mfma_f32_16x16x32_bf16 v[64:67], a[220:223], v[48:51], v[64:67]
    s_waitcnt lgkmcnt(6)
    v_mfma_f32_16x16x32_bf16 v[52:55], a[224:227], v[20:23], v[52:55]
    ds_read_b128 v[48:51], v11 offset:61696
    v_mfma_f32_16x16x32_bf16 v[56:59], a[228:231], v[20:23], v[56:59]
    s_waitcnt lgkmcnt(6)
    v_mfma_f32_16x16x32_bf16 v[60:63], a[224:227], v[24:27], v[60:63]
    s_waitcnt vmcnt(8)
    s_barrier
    ds_read_b128 v[20:23], v12 offset:0
    v_mfma_f32_16x16x32_bf16 v[64:67], a[228:231], v[24:27], v[64:67]
    s_waitcnt lgkmcnt(6)
    v_mfma_f32_16x16x32_bf16 v[52:55], a[232:235], v[28:31], v[52:55]
    ds_read_b128 v[24:27], v12 offset:256
    s_add_u32 m0, s19, 0
    v_mfma_f32_16x16x32_bf16 v[56:59], a[236:239], v[28:31], v[56:59]
    s_add_u32 s17, s20, 0
    buffer_load_dwordx4 v2, s[4:7], s17 offen lds
    s_waitcnt lgkmcnt(6)
    v_mfma_f32_16x16x32_bf16 v[60:63], a[232:235], v[32:35], v[60:63]
    ds_read_b128 v[28:31], v13 offset:0
    v_mfma_f32_16x16x32_bf16 v[64:67], a[236:239], v[32:35], v[64:67]
    s_waitcnt lgkmcnt(6)
    v_mfma_f32_16x16x32_bf16 v[52:55], a[240:243], v[36:39], v[52:55]
    ds_read_b128 v[32:35], v13 offset:256
    s_add_u32 m0, s19, 4096
    v_mfma_f32_16x16x32_bf16 v[56:59], a[244:247], v[36:39], v[56:59]
    s_add_u32 s17, s20, 264192
    buffer_load_dwordx4 v2, s[4:7], s17 offen lds
    s_waitcnt lgkmcnt(6)
    v_mfma_f32_16x16x32_bf16 v[60:63], a[240:243], v[40:43], v[60:63]
    ds_read_b128 v[36:39], v12 offset:4096
    v_mfma_f32_16x16x32_bf16 v[64:67], a[244:247], v[40:43], v[64:67]
    s_waitcnt lgkmcnt(6)
    v_mfma_f32_16x16x32_bf16 v[52:55], a[248:251], v[44:47], v[52:55]
    ds_read_b128 v[40:43], v12 offset:4352
    s_add_u32 m0, s19, 8192
    v_mfma_f32_16x16x32_bf16 v[56:59], a[252:255], v[44:47], v[56:59]
    s_add_u32 s17, s20, 528384
    buffer_load_dwordx4 v2, s[4:7], s17 offen lds
    s_waitcnt lgkmcnt(6)
    v_mfma_f32_16x16x32_bf16 v[60:63], a[248:251], v[48:51], v[60:63]
    ds_read_b128 v[44:47], v13 offset:4096
    v_mfma_f32_16x16x32_bf16 v[64:67], a[252:255], v[48:51], v[64:67]
    s_waitcnt lgkmcnt(6)
    v_mfma_f32_16x16x32_bf16 v[68:71], a[0:3], v[20:23], 0
    ds_read_b128 v[48:51], v13 offset:4352
    v_mfma_f32_16x16x32_bf16 v[72:75], a[4:7], v[20:23], 0
    s_waitcnt lgkmcnt(6)
    v_mfma_f32_16x16x32_bf16 v[76:79], a[0:3], v[24:27], 0
    ds_read_b128 v[20:23], v12 offset:8192
    s_add_u32 m0, s19, 12288
    v_mfma_f32_16x16x32_bf16 v[80:83], a[4:7], v[24:27], 0
    s_add_u32 s17, s20, 792576
    buffer_load_dwordx4 v2, s[4:7], s17 offen lds
    s_waitcnt lgkmcnt(6)
    v_mfma_f32_16x16x32_bf16 v[68:71], a[8:11], v[28:31], v[68:71]
    ds_read_b128 v[24:27], v12 offset:8448
    v_mfma_f32_16x16x32_bf16 v[72:75], a[12:15], v[28:31], v[72:75]
    s_waitcnt lgkmcnt(6)
    v_mfma_f32_16x16x32_bf16 v[76:79], a[8:11], v[32:35], v[76:79]
    ds_read_b128 v[28:31], v13 offset:8192
    s_add_u32 m0, s19, 16384
    v_mfma_f32_16x16x32_bf16 v[80:83], a[12:15], v[32:35], v[80:83]
    s_add_u32 s17, s20, 1056768
    buffer_load_dwordx4 v2, s[4:7], s17 offen lds
    s_waitcnt lgkmcnt(6)
    v_mfma_f32_16x16x32_bf16 v[68:71], a[16:19], v[36:39], v[68:71]
    ds_read_b128 v[32:35], v13 offset:8448
    v_mfma_f32_16x16x32_bf16 v[72:75], a[20:23], v[36:39], v[72:75]
    s_waitcnt lgkmcnt(6)
    v_mfma_f32_16x16x32_bf16 v[76:79], a[16:19], v[40:43], v[76:79]
    ds_read_b128 v[36:39], v12 offset:12288
    s_add_u32 m0, s19, 20480
    v_mfma_f32_16x16x32_bf16 v[80:83], a[20:23], v[40:43], v[80:83]
    s_add_u32 s17, s20, 1320960
    buffer_load_dwordx4 v2, s[4:7], s17 offen lds
    s_waitcnt lgkmcnt(6)
    v_mfma_f32_16x16x32_bf16 v[68:71], a[24:27], v[44:47], v[68:71]
    ds_read_b128 v[40:43], v12 offset:12544
    v_mfma_f32_16x16x32_bf16 v[72:75], a[28:31], v[44:47], v[72:75]
    s_waitcnt lgkmcnt(6)
    v_mfma_f32_16x16x32_bf16 v[76:79], a[24:27], v[48:51], v[76:79]
    ds_read_b128 v[44:47], v13 offset:12288
    s_add_u32 m0, s19, 24576
    v_mfma_f32_16x16x32_bf16 v[80:83], a[28:31], v[48:51], v[80:83]
    s_add_u32 s17, s20, 1585152
    buffer_load_dwordx4 v2, s[4:7], s17 offen lds
    s_waitcnt lgkmcnt(6)
    v_mfma_f32_16x16x32_bf16 v[68:71], a[32:35], v[20:23], v[68:71]
    ds_read_b128 v[48:51], v13 offset:12544
    v_mfma_f32_16x16x32_bf16 v[72:75], a[36:39], v[20:23], v[72:75]
    s_waitcnt lgkmcnt(6)
    v_mfma_f32_16x16x32_bf16 v[76:79], a[32:35], v[24:27], v[76:79]
    ds_read_b128 v[20:23], v12 offset:16384
    s_add_u32 m0, s19, 28672
    v_mfma_f32_16x16x32_bf16 v[80:83], a[36:39], v[24:27], v[80:83]
    s_add_u32 s17, s20, 1849344
    buffer_load_dwordx4 v2, s[4:7], s17 offen lds
    s_waitcnt lgkmcnt(6)
    v_mfma_f32_16x16x32_bf16 v[68:71], a[40:43], v[28:31], v[68:71]
    ds_read_b128 v[24:27], v12 offset:16640
    v_mfma_f32_16x16x32_bf16 v[72:75], a[44:47], v[28:31], v[72:75]
    v_cvt_pk_bf16_f32 v84, v52, v53
    s_waitcnt lgkmcnt(6)
    v_mfma_f32_16x16x32_bf16 v[76:79], a[40:43], v[32:35], v[76:79]
    ds_read_b128 v[28:31], v13 offset:16384
    v_mfma_f32_16x16x32_bf16 v[80:83], a[44:47], v[32:35], v[80:83]
    v_cvt_pk_bf16_f32 v85, v54, v55
    s_waitcnt lgkmcnt(6)
    v_mfma_f32_16x16x32_bf16 v[68:71], a[48:51], v[36:39], v[68:71]
    ds_read_b128 v[32:35], v13 offset:16640
    v_mfma_f32_16x16x32_bf16 v[72:75], a[52:55], v[36:39], v[72:75]
    v_cvt_pk_bf16_f32 v86, v56, v57
    s_waitcnt lgkmcnt(6)
    v_mfma_f32_16x16x32_bf16 v[76:79], a[48:51], v[40:43], v[76:79]
    ds_read_b128 v[36:39], v12 offset:20480
    v_mfma_f32_16x16x32_bf16 v[80:83], a[52:55], v[40:43], v[80:83]
    v_cvt_pk_bf16_f32 v87, v58, v59
    s_waitcnt lgkmcnt(6)
    v_mfma_f32_16x16x32_bf16 v[68:71], a[56:59], v[44:47], v[68:71]
    ds_read_b128 v[40:43], v12 offset:20736
    v_mfma_f32_16x16x32_bf16 v[72:75], a[60:63], v[44:47], v[72:75]
    v_cvt_pk_bf16_f32 v88, v60, v61
    s_waitcnt lgkmcnt(6)
    v_mfma_f32_16x16x32_bf16 v[76:79], a[56:59], v[48:51], v[76:79]
    ds_read_b128 v[44:47], v13 offset:20480
    v_mfma_f32_16x16x32_bf16 v[80:83], a[60:63], v[48:51], v[80:83]
    v_cvt_pk_bf16_f32 v89, v62, v63
    buffer_store_dwordx4 v[84:87], v3, s[12:15], s21 offen
    s_waitcnt lgkmcnt(6)
    v_mfma_f32_16x16x32_bf16 v[68:71], a[64:67], v[20:23], v[68:71]
    ds_read_b128 v[48:51], v13 offset:20736
    v_mfma_f32_16x16x32_bf16 v[72:75], a[68:71], v[20:23], v[72:75]
    v_cvt_pk_bf16_f32 v90, v64, v65
    s_waitcnt lgkmcnt(6)
    v_mfma_f32_16x16x32_bf16 v[76:79], a[64:67], v[24:27], v[76:79]
    ds_read_b128 v[20:23], v12 offset:24576
    v_mfma_f32_16x16x32_bf16 v[80:83], a[68:71], v[24:27], v[80:83]
    v_cvt_pk_bf16_f32 v91, v66, v67
    s_waitcnt lgkmcnt(6)
    v_mfma_f32_16x16x32_bf16 v[68:71], a[72:75], v[28:31], v[68:71]
    ds_read_b128 v[24:27], v12 offset:24832
    v_mfma_f32_16x16x32_bf16 v[72:75], a[76:79], v[28:31], v[72:75]
    s_waitcnt lgkmcnt(6)
    v_mfma_f32_16x16x32_bf16 v[76:79], a[72:75], v[32:35], v[76:79]
    ds_read_b128 v[28:31], v13 offset:24576
    v_mfma_f32_16x16x32_bf16 v[80:83], a[76:79], v[32:35], v[80:83]
    buffer_store_dwordx4 v[88:91], v4, s[12:15], s21 offen
    s_waitcnt lgkmcnt(6)
    v_mfma_f32_16x16x32_bf16 v[68:71], a[80:83], v[36:39], v[68:71]
    ds_read_b128 v[32:35], v13 offset:24832
    v_mfma_f32_16x16x32_bf16 v[72:75], a[84:87], v[36:39], v[72:75]
    s_add_u32 s21, s21, s25
    s_mov_b32 s25, s26
    s_waitcnt lgkmcnt(6)
    v_mfma_f32_16x16x32_bf16 v[76:79], a[80:83], v[40:43], v[76:79]
    ds_read_b128 v[36:39], v12 offset:28672
    v_mfma_f32_16x16x32_bf16 v[80:83], a[84:87], v[40:43], v[80:83]
    s_waitcnt lgkmcnt(6)
    v_mfma_f32_16x16x32_bf16 v[68:71], a[88:91], v[44:47], v[68:71]
    ds_read_b128 v[40:43], v12 offset:28928
    v_mfma_f32_16x16x32_bf16 v[72:75], a[92:95], v[44:47], v[72:75]
    s_waitcnt lgkmcnt(6)
    v_mfma_f32_16x16x32_bf16 v[76:79], a[88:91], v[48:51], v[76:79]
    ds_read_b128 v[44:47], v13 offset:28672
    v_mfma_f32_16x16x32_bf16 v[80:83], a[92:95], v[48:51], v[80:83]
    s_waitcnt lgkmcnt(6)
    v_mfma_f32_16x16x32_bf16 v[68:71], a[96:99], v[20:23], v[68:71]
    ds_read_b128 v[48:51], v13 offset:28928
    v_mfma_f32_16x16x32_bf16 v[72:75], a[100:103], v[20:23], v[72:75]
    s_waitcnt lgkmcnt(6)
    v_mfma_f32_16x16x32_bf16 v[76:79], a[96:99], v[24:27], v[76:79]
    s_waitcnt vmcnt(10)
    s_barrier
    ds_read_b128 v[20:23], v12 offset:32768
    v_mfma_f32_16x16x32_bf16 v[80:83], a[100:103], v[24:27], v[80:83]
    s_waitcnt lgkmcnt(6)
    v_mfma_f32_16x16x32_bf16 v[68:71], a[104:107], v[28:31], v[68:71]
    ds_read_b128 v[24:27], v12 offset:33024
    s_add_u32 m0, s19, 32768
    v_mfma_f32_16x16x32_bf16 v[72:75], a[108:111], v[28:31], v[72:75]
    s_add_u32 s17, s20, 2113536
    buffer_load_dwordx4 v2, s[4:7], s17 offen lds
    s_waitcnt lgkmcnt(6)
    v_mfma_f32_16x16x32_bf16 v[76:79], a[104:107], v[32:35], v[76:79]
    ds_read_b128 v[28:31], v13 offset:32768
    v_mfma_f32_16x16x32_bf16 v[80:83], a[108:111], v[32:35], v[80:83]
    s_waitcnt lgkmcnt(6)
    v_mfma_f32_16x16x32_bf16 v[68:71], a[112:115], v[36:39], v[68:71]
    ds_read_b128 v[32:35], v13 offset:33024
    s_add_u32 m0, s19, 36864
    v_mfma_f32_16x16x32_bf16 v[72:75], a[116:119], v[36:39], v[72:75]
    s_add_u32 s17, s20, 2377728
    buffer_load_dwordx4 v2, s[4:7], s17 offen lds
    s_waitcnt lgkmcnt(6)
    v_mfma_f32_16x16x32_bf16 v[76:79], a[112:115], v[40:43], v[76:79]
    ds_read_b128 v[36:39], v12 offset:36864
    v_mfma_f32_16x16x32_bf16 v[80:83], a[116:119], v[40:43], v[80:83]
    s_waitcnt lgkmcnt(6)
    v_mfma_f32_16x16x32_bf16 v[68:71], a[120:123], v[44:47], v[68:71]
    ds_read_b128 v[40:43], v12 offset:37120
    s_add_u32 m0, s19, 40960
    v_mfma_f32_16x16x32_bf16 v[72:75], a[124:127], v[44:47], v[72:75]
    s_add_u32 s17, s20, 2641920
    buffer_load_dwordx4 v2, s[4:7], s17 offen lds
    s_waitcnt lgkmcnt(6)
    v_mfma_f32_16x16x32_bf16 v[76:79], a[120:123], v[48:51], v[76:79]
    ds_read_b128 v[44:47], v13 offset:36864
    v_mfma_f32_16x16x32_bf16 v[80:83], a[124:127], v[48:51], v[80:83]
    s_waitcnt lgkmcnt(6)
    v_mfma_f32_16x16x32_bf16 v[68:71], a[128:131], v[20:23], v[68:71]
    ds_read_b128 v[48:51], v13 offset:37120
    v_mfma_f32_16x16x32_bf16 v[72:75], a[132:135], v[20:23], v[72:75]
    s_waitcnt lgkmcnt(6)
    v_mfma_f32_16x16x32_bf16 v[76:79], a[128:131], v[24:27], v[76:79]
    ds_read_b128 v[20:23], v12 offset:40960
    s_add_u32 m0, s19, 45056
    v_mfma_f32_16x16x32_bf16 v[80:83], a[132:135], v[24:27], v[80:83]
    s_add_u32 s17, s20, 2906112
    buffer_load_dwordx4 v2, s[4:7], s17 offen lds
    s_waitcnt lgkmcnt(6)
    v_mfma_f32_16x16x32_bf16 v[68:71], a[136:139], v[28:31], v[68:71]
    ds_read_b128 v[24:27], v12 offset:41216
    v_mfma_f32_16x16x32_bf16 v[72:75], a[140:143], v[28:31], v[72:75]
    s_waitcnt lgkmcnt(6)
    v_mfma_f32_16x16x32_bf16 v[76:79], a[136:139], v[32:35], v[76:79]
    ds_read_b128 v[28:31], v13 offset:40960
    s_add_u32 m0, s19, 49152
    v_mfma_f32_16x16x32_bf16 v[80:83], a[140:143], v[32:35], v[80:83]
    s_add_u32 s17, s20, 3170304
    buffer_load_dwordx4 v2, s[4:7], s17 offen lds
    s_waitcnt lgkmcnt(6)
    v_mfma_f32_16x16x32_bf16 v[68:71], a[144:147], v[36:39], v[68:71]
    ds_read_b128 v[32:35], v13 offset:41216
    v_mfma_f32_16x16x32_bf16 v[72:75], a[148:151], v[36:39], v[72:75]
    s_waitcnt lgkmcnt(6)
    v_mfma_f32_16x16x32_bf16 v[76:79], a[144:147], v[40:43], v[76:79]
    ds_read_b128 v[36:39], v12 offset:45056
    s_add_u32 m0, s19, 53248
    v_mfma_f32_16x16x32_bf16 v[80:83], a[148:151], v[40:43], v[80:83]
    s_add_u32 s17, s20, 3434496
    buffer_load_dwordx4 v2, s[4:7], s17 offen lds
    s_waitcnt lgkmcnt(6)
    v_mfma_f32_16x16x32_bf16 v[68:71], a[152:155], v[44:47], v[68:71]
    ds_read_b128 v[40:43], v12 offset:45312
    v_mfma_f32_16x16x32_bf16 v[72:75], a[156:159], v[44:47], v[72:75]
    s_waitcnt lgkmcnt(6)
    v_mfma_f32_16x16x32_bf16 v[76:79], a[152:155], v[48:51], v[76:79]
    ds_read_b128 v[44:47], v13 offset:45056
    s_add_u32 m0, s19, 57344
    v_mfma_f32_16x16x32_bf16 v[80:83], a[156:159], v[48:51], v[80:83]
    s_add_u32 s17, s20, 3698688
    buffer_load_dwordx4 v2, s[4:7], s17 offen lds
    s_waitcnt lgkmcnt(6)
    v_mfma_f32_16x16x32_bf16 v[68:71], a[160:163], v[20:23], v[68:71]
    ds_read_b128 v[48:51], v13 offset:45312
    v_mfma_f32_16x16x32_bf16 v[72:75], a[164:167], v[20:23], v[72:75]
    s_waitcnt lgkmcnt(6)
    v_mfma_f32_16x16x32_bf16 v[76:79], a[160:163], v[24:27], v[76:79]
    ds_read_b128 v[20:23], v12 offset:49152
    s_add_u32 m0, s19, 61440
    v_mfma_f32_16x16x32_bf16 v[80:83], a[164:167], v[24:27], v[80:83]
    s_add_u32 s17, s20, 3962880
    buffer_load_dwordx4 v2, s[4:7], s17 offen lds
    s_waitcnt lgkmcnt(6)
    v_mfma_f32_16x16x32_bf16 v[68:71], a[168:171], v[28:31], v[68:71]
    ds_read_b128 v[24:27], v12 offset:49408
    v_mfma_f32_16x16x32_bf16 v[72:75], a[172:175], v[28:31], v[72:75]
    s_add_u32 s20, s20, s24
    s_waitcnt lgkmcnt(6)
    v_mfma_f32_16x16x32_bf16 v[76:79], a[168:171], v[32:35], v[76:79]
    ds_read_b128 v[28:31], v13 offset:49152
    v_mfma_f32_16x16x32_bf16 v[80:83], a[172:175], v[32:35], v[80:83]
    s_waitcnt lgkmcnt(6)
    v_mfma_f32_16x16x32_bf16 v[68:71], a[176:179], v[36:39], v[68:71]
    ds_read_b128 v[32:35], v13 offset:49408
    v_mfma_f32_16x16x32_bf16 v[72:75], a[180:183], v[36:39], v[72:75]
    s_waitcnt lgkmcnt(6)
    v_mfma_f32_16x16x32_bf16 v[76:79], a[176:179], v[40:43], v[76:79]
    ds_read_b128 v[36:39], v12 offset:53248
    v_mfma_f32_16x16x32_bf16 v[80:83], a[180:183], v[40:43], v[80:83]
    s_waitcnt lgkmcnt(6)
    v_mfma_f32_16x16x32_bf16 v[68:71], a[184:187], v[44:47], v[68:71]
    ds_read_b128 v[40:43], v12 offset:53504
    v_mfma_f32_16x16x32_bf16 v[72:75], a[188:191], v[44:47], v[72:75]
    s_waitcnt lgkmcnt(6)
    v_mfma_f32_16x16x32_bf16 v[76:79], a[184:187], v[48:51], v[76:79]
    ds_read_b128 v[44:47], v13 offset:53248
    v_mfma_f32_16x16x32_bf16 v[80:83], a[188:191], v[48:51], v[80:83]
    s_waitcnt lgkmcnt(6)
    v_mfma_f32_16x16x32_bf16 v[68:71], a[192:195], v[20:23], v[68:71]
    ds_read_b128 v[48:51], v13 offset:53504
    v_mfma_f32_16x16x32_bf16 v[72:75], a[196:199], v[20:23], v[72:75]
    s_waitcnt lgkmcnt(6)
    v_mfma_f32_16x16x32_bf16 v[76:79], a[192:195], v[24:27], v[76:79]
    ds_read_b128 v[20:23], v12 offset:57344
    v_mfma_f32_16x16x32_bf16 v[80:83], a[196:199], v[24:27], v[80:83]
    s_waitcnt lgkmcnt(6)
    v_mfma_f32_16x16x32_bf16 v[68:71], a[200:203], v[28:31], v[68:71]
    ds_read_b128 v[24:27], v12 offset:57600
    v_mfma_f32_16x16x32_bf16 v[72:75], a[204:207], v[28:31], v[72:75]
    s_waitcnt lgkmcnt(6)
    v_mfma_f32_16x16x32_bf16 v[76:79], a[200:203], v[32:35], v[76:79]
    ds_read_b128 v[28:31], v13 offset:57344
    v_mfma_f32_16x16x32_bf16 v[80:83], a[204:207], v[32:35], v[80:83]
    s_waitcnt lgkmcnt(6)
    v_mfma_f32_16x16x32_bf16 v[68:71], a[208:211], v[36:39], v[68:71]
    ds_read_b128 v[32:35], v13 offset:57600
    v_mfma_f32_16x16x32_bf16 v[72:75], a[212:215], v[36:39], v[72:75]
    s_waitcnt lgkmcnt(6)
    v_mfma_f32_16x16x32_bf16 v[76:79], a[208:211], v[40:43], v[76:79]
    ds_read_b128 v[36:39], v12 offset:61440
    v_mfma_f32_16x16x32_bf16 v[80:83], a[212:215], v[40:43], v[80:83]
    s_waitcnt lgkmcnt(6)
    v_mfma_f32_16x16x32_bf16 v[68:71], a[216:219], v[44:47], v[68:71]
    ds_read_b128 v[40:43], v12 offset:61696
    v_mfma_f32_16x16x32_bf16 v[72:75], a[220:223], v[44:47], v[72:75]
    s_waitcnt lgkmcnt(6)
    v_mfma_f32_16x16x32_bf16 v[76:79], a[216:219], v[48:51], v[76:79]
    ds_read_b128 v[44:47], v13 offset:61440
    v_mfma_f32_16x16x32_bf16 v[80:83], a[220:223], v[48:51], v[80:83]
    s_waitcnt lgkmcnt(6)
    v_mfma_f32_16x16x32_bf16 v[68:71], a[224:227], v[20:23], v[68:71]
    ds_read_b128 v[48:51], v13 offset:61696
    v_mfma_f32_16x16x32_bf16 v[72:75], a[228:231], v[20:23], v[72:75]
    s_waitcnt lgkmcnt(6)
    v_mfma_f32_16x16x32_bf16 v[76:79], a[224:227], v[24:27], v[76:79]
    s_waitcnt vmcnt(8)
    s_barrier
    ds_read_b128 v[20:23], v10 offset:0
    v_mfma_f32_16x16x32_bf16 v[80:83], a[228:231], v[24:27], v[80:83]
    s_waitcnt lgkmcnt(6)
    v_mfma_f32_16x16x32_bf16 v[68:71], a[232:235], v[28:31], v[68:71]
    ds_read_b128 v[24:27], v10 offset:256
    s_add_u32 m0, s19, 65536
    v_mfma_f32_16x16x32_bf16 v[72:75], a[236:239], v[28:31], v[72:75]
    s_add_u32 s17, s20, 0
    buffer_load_dwordx4 v2, s[4:7], s17 offen lds
    s_waitcnt lgkmcnt(6)
    v_mfma_f32_16x16x32_bf16 v[76:79], a[232:235], v[32:35], v[76:79]
    ds_read_b128 v[28:31], v11 offset:0
    v_mfma_f32_16x16x32_bf16 v[80:83], a[236:239], v[32:35], v[80:83]
    s_waitcnt lgkmcnt(6)
    v_mfma_f32_16x16x32_bf16 v[68:71], a[240:243], v[36:39], v[68:71]
    ds_read_b128 v[32:35], v11 offset:256
    s_add_u32 m0, s19, 69632
    v_mfma_f32_16x16x32_bf16 v[72:75], a[244:247], v[36:39], v[72:75]
    s_add_u32 s17, s20, 264192
    buffer_load_dwordx4 v2, s[4:7], s17 offen lds
    s_waitcnt lgkmcnt(6)
    v_mfma_f32_16x16x32_bf16 v[76:79], a[240:243], v[40:43], v[76:79]
    ds_read_b128 v[36:39], v10 offset:4096
    v_mfma_f32_16x16x32_bf16 v[80:83], a[244:247], v[40:43], v[80:83]
    s_waitcnt lgkmcnt(6)
    v_mfma_f32_16x16x32_bf16 v[68:71], a[248:251], v[44:47], v[68:71]
    ds_read_b128 v[40:43], v10 offset:4352
    s_add_u32 m0, s19, 73728
    v_mfma_f32_16x16x32_bf16 v[72:75], a[252:255], v[44:47], v[72:75]
    s_add_u32 s17, s20, 528384
    buffer_load_dwordx4 v2, s[4:7], s17 offen lds
    s_waitcnt lgkmcnt(6)
    v_mfma_f32_16x16x32_bf16 v[76:79], a[248:251], v[48:51], v[76:79]
    ds_read_b128 v[44:47], v11 offset:4096
    v_mfma_f32_16x16x32_bf16 v[80:83], a[252:255], v[48:51], v[80:83]
    s_add_u32 s22, s22, 2
    s_cmp_lt_u32 s22, 16
    s_cbranch_scc1 F3_top
    v_cvt_pk_bf16_f32 v84, v68, v69
    v_cvt_pk_bf16_f32 v85, v70, v71
    v_cvt_pk_bf16_f32 v86, v72, v73
    v_cvt_pk_bf16_f32 v87, v74, v75
    v_cvt_pk_bf16_f32 v88, v76, v77
    v_cvt_pk_bf16_f32 v89, v78, v79
    v_cvt_pk_bf16_f32 v90, v80, v81
    v_cvt_pk_bf16_f32 v91, v82, v83
    buffer_store_dwordx4 v[84:87], v3, s[12:15], s21 offen
    buffer_store_dwordx4 v[88:91], v4, s[12:15], s21 offen
    s_waitcnt vmcnt(0) lgkmcnt(0)
    s_branch W_T
W_T:
    v_and_b32 v7, 19, v1
    v_bfe_u32 v5, v1, 2, 1
    v_bfe_u32 v6, v1, 3, 1
    v_lshl_add_u32 v7, v5, 3, v7
    v_lshl_add_u32 v7, v6, 2, v7
    v_lshrrev_b32 v5, 5, v1
    v_and_b32 v6, 31, v1
    v_lshlrev_b32 v8, 4, v5
    v_lshl_add_u32 v10, v6, 6, v8
    v_lshl_add_u32 v11, v7, 6, v8
    v_mov_b32 v17, 1073741824
    v_cmp_gt_u32 vcc, 8, v6
    s_nop 1
    v_cndmask_b32 v12, v17, v10, vcc
    v_lshlrev_b32 v13, 3, v5
    v_lshl_add_u32 v13, v7, 4, v13
    v_and_b32 v14, 15, v1
    v_lshlrev_b32 v14, 4, v14
    v_lshl_add_u32 v14, v5, 8, v14
    v_bfe_u32 v8, v1, 4, 1
    v_lshl_add_u32 v14, v8, 17, v14
    v_lshrrev_b32 v15, 2, v1
    v_and_b32 v8, 3, v1
    v_lshl_add_u32 v15, v15, 7, v8
    s_lshl_b32 s17, s93, 2
    v_add_u32 v15, s17, v15
    v_lshlrev_b32 v15, 7, v15
    v_add_u32 v15, 100663296, v15
    v_cmp_gt_u32 vcc, 16, v1
    s_nop 1
    v_cndmask_b32 v15, v17, v15, vcc
    v_mov_b32 v16, 0
    s_add_u32 s18, s16, s17
    s_lshl_b32 s18, s18, 7
    s_add_u32 s18, s18, 100728832
    v_lshl_add_u32 v4, v1, 2, s18
    v_cmp_gt_u32 vcc, 32, v1
    s_nop 1
    v_cndmask_b32 v4, v17, v4, vcc
    v_lshlrev_b32 v5, 3, v5
    v_sub_u32 v6, v6, v5
    s_mov_b32 s29, 1040356334
    s_mov_b32 s28, s16
    s_mul_i32 s31, s17, 133120
    s_lshl_b32 s18, s28, 11
    s_add_u32 s31, s31, s18
    s_mul_i32 s32, s17, 33280
    s_lshl_b32 s18, s28, 9
    s_add_u32 s32, s32, s18
    s_add_u32 s32, s32, 71303168
    s_lshl_b32 s33, s28, 18
    s_lshl_b32 s18, s93, 12
    s_add_u32 s33, s33, s18
    s_add_u32 s33, s33, 54525952
    v_mov_b32 v17, 0xff800000
    s_mov_b32 s35, 0
    v_mov_b32 v9, 0
    v_cmp_le_i32 s[36:37], 0, v6
    v_cmp_le_i32 s[38:39], 1, v6
    v_cmp_le_i32 s[40:41], 2, v6
    v_cmp_le_i32 s[42:43], 3, v6
    v_cmp_le_i32 s[44:45], 4, v6
    v_cmp_le_i32 s[46:47], 5, v6
    v_cmp_le_i32 s[48:49], 6, v6
    v_cmp_le_i32 s[50:51], 7, v6
    v_cmp_le_i32 s[52:53], 16, v6
    v_cmp_le_i32 s[54:55], 17, v6
    v_cmp_le_i32 s[56:57], 18, v6
    v_cmp_le_i32 s[58:59], 19, v6
    v_cmp_le_i32 s[60:61], 20, v6
    v_cmp_le_i32 s[62:63], 21, v6
    v_cmp_le_i32 s[64:65], 22, v6
    v_cmp_le_i32 s[66:67], 23, v6
    v_mov_b32 v54, 0
    v_mov_b32 v55, 0
    v_mov_b32 v58, 0
    v_mov_b32 v59, 0
    v_mov_b32 v62, 0
    v_mov_b32 v63, 0
    v_mov_b32 v66, 0
    v_mov_b32 v67, 0
    v_mov_b32 v102, 0
    v_mov_b32 v103, 0
    v_mov_b32 v106, 0
    v_mov_b32 v107, 0
    v_mov_b32 v110, 0
    v_mov_b32 v111, 0
    v_mov_b32 v114, 0
    v_mov_b32 v115, 0
    v_mov_b32 v158, 0
    v_mov_b32 v159, 0
    s_mov_b32 s30, s92
T_p:
    v_cmp_ge_u32 vcc, s28, v16
    s_nop 0
    s_and_b32 s17, vcc_lo, 4095
    s_cbranch_scc0 T_pk
    s_cmp_ge_u32 s30, 1048576
    s_cselect_b32 s92, 1048576, s92
    s_cbranch_scc1 T_pk
    s_add_u32 s30, s30, 1
    buffer_load_dword v16, v15, s[4:7], 0 offen sc1
    s_sleep 8
    s_waitcnt vmcnt(0)
    s_branch T_p
T_pk:
    s_add_u32 s17, s31, 0
    buffer_load_dwordx4 a[0:3], v10, s[4:7], s17 offen offset:0
    buffer_load_dwordx4 a[4:7], v10, s[4:7], s17 offen offset:32
    s_add_u32 s17, s31, 133120
    buffer_load_dwordx4 a[8:11], v10, s[4:7], s17 offen offset:0
    buffer_load_dwordx4 a[12:15], v10, s[4:7], s17 offen offset:32
    s_add_u32 s17, s31, 266240
    buffer_load_dwordx4 a[16:19], v10, s[4:7], s17 offen offset:0
    buffer_load_dwordx4 a[20:23], v10, s[4:7], s17 offen offset:32
    s_add_u32 s17, s31, 399360
    buffer_load_dwordx4 a[24:27], v10, s[4:7], s17 offen offset:0
    buffer_load_dwordx4 a[28:31], v10, s[4:7], s17 offen offset:32
    s_add_u32 s17, s31, 17825792
    buffer_load_dwordx4 a[32:35], v11, s[4:7], s17 offen offset:0
    buffer_load_dwordx4 a[36:39], v11, s[4:7], s17 offen offset:32
    s_add_u32 s17, s31, 17958912
    buffer_load_dwordx4 a[40:43], v11, s[4:7], s17 offen offset:0
    buffer_load_dwordx4 a[44:47], v11, s[4:7], s17 offen offset:32
    s_add_u32 s17, s31, 18092032
    buffer_load_dwordx4 a[48:51], v11, s[4:7], s17 offen offset:0
    buffer_load_dwordx4 a[52:55], v11, s[4:7], s17 offen offset:32
    s_add_u32 s17, s31, 18225152
    buffer_load_dwordx4 a[56:59], v11, s[4:7], s17 offen offset:0
    buffer_load_dwordx4 a[60:63], v11, s[4:7], s17 offen offset:32
    s_add_u32 s17, s31, 35651584
    buffer_load_dwordx4 a[64:67], v11, s[4:7], s17 offen offset:0
    buffer_load_dwordx4 a[68:71], v11, s[4:7], s17 offen offset:32
    s_add_u32 s17, s31, 35784704
    buffer_load_dwordx4 a[72:75], v11, s[4:7], s17 offen offset:0
    buffer_load_dwordx4 a[76:79], v11, s[4:7], s17 offen offset:32
    s_add_u32 s17, s31, 35917824
    buffer_load_dwordx4 a[80:83], v11, s[4:7], s17 offen offset:0
    buffer_load_dwordx4 a[84:87], v11, s[4:7], s17 offen offset:32
    s_add_u32 s17, s31, 36050944
    buffer_load_dwordx4 a[88:91], v11, s[4:7], s17 offen offset:0
    buffer_load_dwordx4 a[92:95], v11, s[4:7], s17 offen offset:32
T_top0:
    s_cmp_eq_u32 s35, 0
    s_cbranch_scc1 T_slow0
T_go0:
    s_add_u32 s34, s28, 4
    s_min_u32 s68, s34, 63
    s_waitcnt vmcnt(8)
    v_cmp_ge_u32 vcc, s68, v16
    s_nop 0
    s_and_b32 s17, vcc_lo, 0xfff
    s_cbranch_scc1 T_pw0
T_pok0:
    s_add_u32 s31, s31, 8192
    s_add_u32 s32, s32, 2048
    s_and_b32 s17, vcc_lo, 61440
    s_cselect_b32 s35, 0, 1
    s_cselect_b32 s69, 1073741824, s32
    s_cmp_lt_u32 s34, 64
    s_cselect_b32 s68, s31, 1073741824
    s_cselect_b32 s69, s69, 1073741824
    buffer_load_dword v16, v15, s[4:7], 0 offen sc1
    v_mfma_f32_32x32x16_bf16 v[116:131], a[32:35], a[0:3], 0
    s_add_u32 s17, s68, 0
    buffer_load_dwordx4 a[96:99], v10, s[4:7], s17 offen offset:0
    buffer_load_dwordx4 a[100:103], v10, s[4:7], s17 offen offset:32
    v_mfma_f32_32x32x16_bf16 v[116:131], a[36:39], a[4:7], v[116:131]
    s_add_u32 s17, s68, 133120
    buffer_load_dwordx4 a[104:107], v10, s[4:7], s17 offen offset:0
    buffer_load_dwordx4 a[108:111], v10, s[4:7], s17 offen offset:32
    v_mfma_f32_32x32x16_bf16 v[116:131], a[40:43], a[8:11], v[116:131]
    s_add_u32 s17, s68, 266240
    buffer_load_dwordx4 a[112:115], v10, s[4:7], s17 offen offset:0
    buffer_load_dwordx4 a[116:119], v10, s[4:7], s17 offen offset:32
    v_mfma_f32_32x32x16_bf16 v[116:131], a[44:47], a[12:15], v[116:131]
    s_add_u32 s17, s68, 399360
    buffer_load_dwordx4 a[120:123], v10, s[4:7], s17 offen offset:0
    buffer_load_dwordx4 a[124:127], v10, s[4:7], s17 offen offset:32
    v_mfma_f32_32x32x16_bf16 v[116:131], a[48:51], a[16:19], v[116:131]
    s_add_u32 s17, s68, 17825792
    buffer_load_dwordx4 a[128:131], v11, s[4:7], s17 offen offset:0
    buffer_load_dwordx4 a[132:135], v11, s[4:7], s17 offen offset:32
    v_mfma_f32_32x32x16_bf16 v[116:131], a[52:55], a[20:23], v[116:131]
    s_add_u32 s17, s68, 17958912
    buffer_load_dwordx4 a[136:139], v11, s[4:7], s17 offen offset:0
    buffer_load_dwordx4 a[140:143], v11, s[4:7], s17 offen offset:32
    v_mfma_f32_32x32x16_bf16 v[116:131], a[56:59], a[24:27], v[116:131]
    s_add_u32 s17, s68, 18092032
    buffer_load_dwordx4 a[144:147], v11, s[4:7], s17 offen offset:0
    buffer_load_dwordx4 a[148:151], v11, s[4:7], s17 offen offset:32
    v_mfma_f32_32x32x16_bf16 v[116:131], a[60:63], a[28:31], v[116:131]
    s_add_u32 s17, s68, 18225152
    buffer_load_dwordx4 a[152:155], v11, s[4:7], s17 offen offset:0
    buffer_load_dwordx4 a[156:159], v11, s[4:7], s17 offen offset:32
    v_mfma_f32_32x32x16_bf16 v[132:147], v[20:23], a[0:3], 0
    s_add_u32 s17, s68, 35651584
    buffer_load_dwordx4 a[160:163], v11, s[4:7], s17 offen offset:0
    buffer_load_dwordx4 a[164:167], v11, s[4:7], s17 offen offset:32
    v_mfma_f32_32x32x16_bf16 v[132:147], v[24:27], a[4:7], v[132:147]
    s_add_u32 s17, s68, 35784704
    buffer_load_dwordx4 a[168:171], v11, s[4:7], s17 offen offset:0
    buffer_load_dwordx4 a[172:175], v11, s[4:7], s17 offen offset:32
    v_mfma_f32_32x32x16_bf16 v[132:147], v[28:31], a[8:11], v[132:147]
    s_add_u32 s17, s68, 35917824
    buffer_load_dwordx4 a[176:179], v11, s[4:7], s17 offen offset:0
    buffer_load_dwordx4 a[180:183], v11, s[4:7], s17 offen offset:32
    v_mfma_f32_32x32x16_bf16 v[132:147], v[32:35], a[12:15], v[132:147]
    s_add_u32 s17, s68, 36050944
    buffer_load_dwordx4 a[184:187], v11, s[4:7], s17 offen offset:0
    buffer_load_dwordx4 a[188:191], v11, s[4:7], s17 offen offset:32
    v_mfma_f32_32x32x16_bf16 v[132:147], v[36:39], a[16:19], v[132:147]
    s_add_u32 s17, s69, 0
    s_add_u32 s18, s69, 5242880
    buffer_load_dwordx4 v[68:71], v12, s[4:7], s17 offen offset:0
    buffer_load_dwordx4 v[72:75], v12, s[4:7], s17 offen offset:32
    buffer_load_dwordx2 v[100:101], v13, s[4:7], s18 offen
    v_mfma_f32_32x32x16_bf16 v[132:147], v[40:43], a[20:23], v[132:147]
    s_add_u32 s17, s69, 33280
    s_add_u32 s18, s69, 5276160
    buffer_load_dwordx4 v[76:79], v12, s[4:7], s17 offen offset:0
    buffer_load_dwordx4 v[80:83], v12, s[4:7], s17 offen offset:32
    buffer_load_dwordx2 v[104:105], v13, s[4:7], s18 offen
    v_mfma_f32_32x32x16_bf16 v[132:147], v[44:47], a[24:27], v[132:147]
    s_add_u32 s17, s69, 66560
    s_add_u32 s18, s69, 5309440
    buffer_load_dwordx4 v[84:87], v12, s[4:7], s17 offen offset:0
    buffer_load_dwordx4 v[88:91], v12, s[4:7], s17 offen offset:32
    buffer_load_dwordx2 v[108:109], v13, s[4:7], s18 offen
    v_mfma_f32_32x32x16_bf16 v[132:147], v[48:51], a[28:31], v[132:147]
    s_add_u32 s17, s69, 99840
    s_add_u32 s18, s69, 5342720
    buffer_load_dwordx4 v[92:95], v12, s[4:7], s17 offen offset:0
    buffer_load_dwordx4 v[96:99], v12, s[4:7], s17 offen offset:32
    buffer_load_dwordx2 v[112:113], v13, s[4:7], s18 offen
    v_cndmask_b32 v116, v17, v116, s[36:37]
    v_cndmask_b32 v117, v17, v117, s[38:39]
    v_cndmask_b32 v118, v17, v118, s[40:41]
    v_cndmask_b32 v119, v17, v119, s[42:43]
    v_cndmask_b32 v120, v17, v120, s[44:45]
    v_cndmask_b32 v121, v17, v121, s[46:47]
    v_cndmask_b32 v122, v17, v122, s[48:49]
    v_cndmask_b32 v123, v17, v123, s[50:51]
    v_cndmask_b32 v124, v17, v124, s[52:53]
    v_cndmask_b32 v125, v17, v125, s[54:55]
    v_cndmask_b32 v126, v17, v126, s[56:57]
    v_cndmask_b32 v127, v17, v127, s[58:59]
    v_cndmask_b32 v128, v17, v128, s[60:61]
    v_cndmask_b32 v129, v17, v129, s[62:63]
    v_cndmask_b32 v130, v17, v130, s[64:65]
    v_cndmask_b32 v131, v17, v131, s[66:67]
    v_max3_f32 v18, v116, v117, v118
    v_max3_f32 v18, v18, v119, v120
    v_max3_f32 v18, v18, v121, v122
    v_max3_f32 v18, v18, v123, v124
    v_max3_f32 v18, v18, v125, v126
    v_max3_f32 v18, v18, v127, v128
    v_max3_f32 v18, v18, v129, v130
    v_max3_f32 v18, v18, v131, v132
    v_max3_f32 v18, v18, v133, v134
    v_max_f32 v18, v18, v135
    v_mov_b32 v5, v18
    s_nop 1
    v_permlane32_swap_b32 v18, v5
    v_max_f32 v18, v18, v5
    v_mul_f32 v18, s29, v18
    v_fma_f32 v116, v116, s29, -v18
    v_fma_f32 v117, v117, s29, -v18
    v_fma_f32 v118, v118, s29, -v18
    v_fma_f32 v119, v119, s29, -v18
    v_fma_f32 v120, v120, s29, -v18
    v_fma_f32 v121, v121, s29, -v18
    v_fma_f32 v122, v122, s29, -v18
    v_fma_f32 v123, v123, s29, -v18
    v_fma_f32 v124, v124, s29, -v18
    v_fma_f32 v125, v125, s29, -v18
    v_fma_f32 v126, v126, s29, -v18
    v_fma_f32 v127, v127, s29, -v18
    v_fma_f32 v128, v128, s29, -v18
    v_fma_f32 v129, v129, s29, -v18
    v_fma_f32 v130, v130, s29, -v18
    v_fma_f32 v131, v131, s29, -v18
    v_fma_f32 v132, v132, s29, -v18
    v_fma_f32 v133, v133, s29, -v18
    v_fma_f32 v134, v134, s29, -v18
    v_fma_f32 v135, v135, s29, -v18
    v_exp_f32 v116, v116
    v_exp_f32 v117, v117
    v_exp_f32 v118, v118
    v_exp_f32 v119, v119
    v_exp_f32 v120, v120
    v_exp_f32 v121, v121
    v_exp_f32 v122, v122
    v_exp_f32 v123, v123
    v_exp_f32 v124, v124
    v_exp_f32 v125, v125
    v_exp_f32 v126, v126
    v_exp_f32 v127, v127
    v_exp_f32 v128, v128
    v_exp_f32 v129, v129
    v_exp_f32 v130, v130
    v_exp_f32 v131, v131
    v_exp_f32 v132, v132
    v_exp_f32 v133, v133
    v_exp_f32 v134, v134
    v_exp_f32 v135, v135
    s_waitcnt vmcnt(37)
    buffer_store_dword v9, v4, s[4:7], 0 offen sc1
    v_add_f32 v19, v116, v117
    v_add_f32 v6, v118, v119
    v_add_f32 v19, v19, v120
    v_add_f32 v6, v6, v121
    v_add_f32 v19, v19, v122
    v_add_f32 v6, v6, v123
    v_add_f32 v19, v19, v124
    v_add_f32 v6, v6, v125
    v_add_f32 v19, v19, v126
    v_add_f32 v6, v6, v127
    v_add_f32 v19, v19, v128
    v_add_f32 v6, v6, v129
    v_add_f32 v19, v19, v130
    v_add_f32 v6, v6, v131
    v_add_f32 v19, v19, v132
    v_add_f32 v6, v6, v133
    v_add_f32 v19, v19, v134
    v_add_f32 v6, v6, v135
    v_add_f32 v19, v19, v6
    v_mov_b32 v5, v19
    s_nop 1
    v_permlane32_swap_b32 v19, v5
    v_add_f32 v19, v19, v5
    v_rcp_f32 v19, v19
    s_nop 0
    v_mul_f32 v116, v116, v19
    v_mul_f32 v117, v117, v19
    v_mul_f32 v118, v118, v19
    v_mul_f32 v119, v119, v19
    v_mul_f32 v120, v120, v19
    v_mul_f32 v121, v121, v19
    v_mul_f32 v122, v122, v19
    v_mul_f32 v123, v123, v19
    v_mul_f32 v124, v124, v19
    v_mul_f32 v125, v125, v19
    v_mul_f32 v126, v126, v19
    v_mul_f32 v127, v127, v19
    v_mul_f32 v128, v128, v19
    v_mul_f32 v129, v129, v19
    v_mul_f32 v130, v130, v19
    v_mul_f32 v131, v131, v19
    v_mul_f32 v132, v132, v19
    v_mul_f32 v133, v133, v19
    v_mul_f32 v134, v134, v19
    v_mul_f32 v135, v135, v19
    v_cvt_pk_bf16_f32 v148, v116, v117
    v_cvt_pk_bf16_f32 v149, v118, v119
    v_cvt_pk_bf16_f32 v150, v120, v121
    v_cvt_pk_bf16_f32 v151, v122, v123
    v_cvt_pk_bf16_f32 v152, v124, v125
    v_cvt_pk_bf16_f32 v153, v126, v127
    v_cvt_pk_bf16_f32 v154, v128, v129
    v_cvt_pk_bf16_f32 v155, v130, v131
    v_cvt_pk_bf16_f32 v156, v132, v133
    v_cvt_pk_bf16_f32 v157, v134, v135
    v_mfma_f32_32x32x16_bf16 v[160:175], a[64:67], v[148:151], 0
    v_mfma_f32_32x32x16_bf16 v[160:175], a[68:71], v[152:155], v[160:175]
    v_mfma_f32_32x32x16_bf16 v[160:175], v[52:55], v[156:159], v[160:175]
    v_mfma_f32_32x32x16_bf16 v[176:191], a[72:75], v[148:151], 0
    v_mfma_f32_32x32x16_bf16 v[176:191], a[76:79], v[152:155], v[176:191]
    v_mfma_f32_32x32x16_bf16 v[176:191], v[56:59], v[156:159], v[176:191]
    s_nop 2
    v_cvt_pk_bf16_f32 v224, v160, v161
    v_cvt_pk_bf16_f32 v225, v162, v163
    v_cvt_pk_bf16_f32 v226, v164, v165
    v_cvt_pk_bf16_f32 v227, v166, v167
    v_cvt_pk_bf16_f32 v228, v168, v169
    v_cvt_pk_bf16_f32 v229, v170, v171
    v_cvt_pk_bf16_f32 v230, v172, v173
    v_cvt_pk_bf16_f32 v231, v174, v175
    buffer_store_dwordx4 v[224:227], v14, s[4:7], s33 offen offset:0 sc1
    buffer_store_dwordx4 v[228:231], v14, s[4:7], s33 offen offset:512 sc1
    v_mfma_f32_32x32x16_bf16 v[192:207], a[80:83], v[148:151], 0
    v_mfma_f32_32x32x16_bf16 v[192:207], a[84:87], v[152:155], v[192:207]
    v_mfma_f32_32x32x16_bf16 v[192:207], v[60:63], v[156:159], v[192:207]
    v_cvt_pk_bf16_f32 v232, v176, v177
    v_cvt_pk_bf16_f32 v233, v178, v179
    v_cvt_pk_bf16_f32 v234, v180, v181
    v_cvt_pk_bf16_f32 v235, v182, v183
    v_cvt_pk_bf16_f32 v236, v184, v185
    v_cvt_pk_bf16_f32 v237, v186, v187
    v_cvt_pk_bf16_f32 v238, v188, v189
    v_cvt_pk_bf16_f32 v239, v190, v191
    buffer_store_dwordx4 v[232:235], v14, s[4:7], s33 offen offset:1024 sc1
    buffer_store_dwordx4 v[236:239], v14, s[4:7], s33 offen offset:1536 sc1
    v_mfma_f32_32x32x16_bf16 v[208:223], a[88:91], v[148:151], 0
    v_mfma_f32_32x32x16_bf16 v[208:223], a[92:95], v[152:155], v[208:223]
    v_mfma_f32_32x32x16_bf16 v[208:223], v[64:67], v[156:159], v[208:223]
    v_cvt_pk_bf16_f32 v240, v192, v193
    v_cvt_pk_bf16_f32 v241, v194, v195
    v_cvt_pk_bf16_f32 v242, v196, v197
    v_cvt_pk_bf16_f32 v243, v198, v199
    v_cvt_pk_bf16_f32 v244, v200, v201
    v_cvt_pk_bf16_f32 v245, v202, v203
    v_cvt_pk_bf16_f32 v246, v204, v205
    v_cvt_pk_bf16_f32 v247, v206, v207
    buffer_store_dwordx4 v[240:243], v14, s[4:7], s33 offen offset:2048 sc1
    buffer_store_dwordx4 v[244:247], v14, s[4:7], s33 offen offset:2560 sc1
    v_add_u32 v9, 1, v9
    s_nop 0
    v_cvt_pk_bf16_f32 v248, v208, v209
    v_cvt_pk_bf16_f32 v249, v210, v211
    v_cvt_pk_bf16_f32 v250, v212, v213
    v_cvt_pk_bf16_f32 v251, v214, v215
    v_cvt_pk_bf16_f32 v252, v216, v217
    v_cvt_pk_bf16_f32 v253, v218, v219
    v_cvt_pk_bf16_f32 v254, v220, v221
    v_cvt_pk_bf16_f32 v255, v222, v223
    buffer_store_dwordx4 v[248:251], v14, s[4:7], s33 offen offset:3072 sc1
    buffer_store_dwordx4 v[252:255], v14, s[4:7], s33 offen offset:3584 sc1
    s_mov_b32 s28, s34
    s_add_u32 s33, s33, 1048576
T_top1:
    s_cmp_eq_u32 s35, 0
    s_cbranch_scc1 T_slow1
T_go1:
    s_add_u32 s34, s28, 4
    s_min_u32 s68, s34, 63
    s_waitcnt vmcnt(8)
    v_cmp_ge_u32 vcc, s68, v16
    s_nop 0
    s_and_b32 s17, vcc_lo, 0xfff
    s_cbranch_scc1 T_pw1
T_pok1:
    s_add_u32 s31, s31, 8192
    s_add_u32 s32, s32, 2048
    s_and_b32 s17, vcc_lo, 61440
    s_cselect_b32 s35, 0, 1
    s_cselect_b32 s69, 1073741824, s32
    s_cmp_lt_u32 s34, 64
    s_cselect_b32 s68, s31, 1073741824
    s_cselect_b32 s69, s69, 1073741824
    buffer_load_dword v16, v15, s[4:7], 0 offen sc1
    v_mfma_f32_32x32x16_bf16 v[116:131], a[128:131], a[96:99], 0
    s_add_u32 s17, s68, 0
    buffer_load_dwordx4 a[0:3], v10, s[4:7], s17 offen offset:0
    buffer_load_dwordx4 a[4:7], v10, s[4:7], s17 offen offset:32
    v_mfma_f32_32x32x16_bf16 v[116:131], a[132:135], a[100:103], v[116:131]
    s_add_u32 s17, s68, 133120
    buffer_load_dwordx4 a[8:11], v10, s[4:7], s17 offen offset:0
    buffer_load_dwordx4 a[12:15], v10, s[4:7], s17 offen offset:32
    v_mfma_f32_32x32x16_bf16 v[116:131], a[136:139], a[104:107], v[116:131]
    s_add_u32 s17, s68, 266240
    buffer_load_dwordx4 a[16:19], v10, s[4:7], s17 offen offset:0
    buffer_load_dwordx4 a[20:23], v10, s[4:7], s17 offen offset:32
    v_mfma_f32_32x32x16_bf16 v[116:131], a[140:143], a[108:111], v[116:131]
    s_add_u32 s17, s68, 399360
    buffer_load_dwordx4 a[24:27], v10, s[4:7], s17 offen offset:0
    buffer_load_dwordx4 a[28:31], v10, s[4:7], s17 offen offset:32
    v_mfma_f32_32x32x16_bf16 v[116:131], a[144:147], a[112:115], v[116:131]
    s_add_u32 s17, s68, 17825792
    buffer_load_dwordx4 a[32:35], v11, s[4:7], s17 offen offset:0
    buffer_load_dwordx4 a[36:39], v11, s[4:7], s17 offen offset:32
    v_mfma_f32_32x32x16_bf16 v[116:131], a[148:151], a[116:119], v[116:131]
    s_add_u32 s17, s68, 17958912
    buffer_load_dwordx4 a[40:43], v11, s[4:7], s17 offen offset:0
    buffer_load_dwordx4 a[44:47], v11, s[4:7], s17 offen offset:32
    v_mfma_f32_32x32x16_bf16 v[116:131], a[152:155], a[120:123], v[116:131]
    s_add_u32 s17, s68, 18092032
    buffer_load_dwordx4 a[48:51], v11, s[4:7], s17 offen offset:0
    buffer_load_dwordx4 a[52:55], v11, s[4:7], s17 offen offset:32
    v_mfma_f32_32x32x16_bf16 v[116:131], a[156:159], a[124:127], v[116:131]
    s_add_u32 s17, s68, 18225152
    buffer_load_dwordx4 a[56:59], v11, s[4:7], s17 offen offset:0
    buffer_load_dwordx4 a[60:63], v11, s[4:7], s17 offen offset:32
    v_mfma_f32_32x32x16_bf16 v[132:147], v[68:71], a[96:99], 0
    s_add_u32 s17, s68, 35651584
    buffer_load_dwordx4 a[64:67], v11, s[4:7], s17 offen offset:0
    buffer_load_dwordx4 a[68:71], v11, s[4:7], s17 offen offset:32
    v_mfma_f32_32x32x16_bf16 v[132:147], v[72:75], a[100:103], v[132:147]
    s_add_u32 s17, s68, 35784704
    buffer_load_dwordx4 a[72:75], v11, s[4:7], s17 offen offset:0
    buffer_load_dwordx4 a[76:79], v11, s[4:7], s17 offen offset:32
    v_mfma_f32_32x32x16_bf16 v[132:147], v[76:79], a[104:107], v[132:147]
    s_add_u32 s17, s68, 35917824
    buffer_load_dwordx4 a[80:83], v11, s[4:7], s17 offen offset:0
    buffer_load_dwordx4 a[84:87], v11, s[4:7], s17 offen offset:32
    v_mfma_f32_32x32x16_bf16 v[132:147], v[80:83], a[108:111], v[132:147]
    s_add_u32 s17, s68, 36050944
    buffer_load_dwordx4 a[88:91], v11, s[4:7], s17 offen offset:0
    buffer_load_dwordx4 a[92:95], v11, s[4:7], s17 offen offset:32
    v_mfma_f32_32x32x16_bf16 v[132:147], v[84:87], a[112:115], v[132:147]
    s_add_u32 s17, s69, 0
    s_add_u32 s18, s69, 5242880
    buffer_load_dwordx4 v[20:23], v12, s[4:7], s17 offen offset:0
    buffer_load_dwordx4 v[24:27], v12, s[4:7], s17 offen offset:32
    buffer_load_dwordx2 v[52:53], v13, s[4:7], s18 offen
    v_mfma_f32_32x32x16_bf16 v[132:147], v[88:91], a[116:119], v[132:147]
    s_add_u32 s17, s69, 33280
    s_add_u32 s18, s69, 5276160
    buffer_load_dwordx4 v[28:31], v12, s[4:7], s17 offen offset:0
    buffer_load_dwordx4 v[32:35], v12, s[4:7], s17 offen offset:32
    buffer_load_dwordx2 v[56:57], v13, s[4:7], s18 offen
    v_mfma_f32_32x32x16_bf16 v[132:147], v[92:95], a[120:123], v[132:147]
    s_add_u32 s17, s69, 66560
    s_add_u32 s18, s69, 5309440
    buffer_load_dwordx4 v[36:39], v12, s[4:7], s17 offen offset:0
    buffer_load_dwordx4 v[40:43], v12, s[4:7], s17 offen offset:32
    buffer_load_dwordx2 v[60:61], v13, s[4:7], s18 offen
    v_mfma_f32_32x32x16_bf16 v[132:147], v[96:99], a[124:127], v[132:147]
    s_add_u32 s17, s69, 99840
    s_add_u32 s18, s69, 5342720
    buffer_load_dwordx4 v[44:47], v12, s[4:7], s17 offen offset:0
    buffer_load_dwordx4 v[48:51], v12, s[4:7], s17 offen offset:32
    buffer_load_dwordx2 v[64:65], v13, s[4:7], s18 offen
    v_cndmask_b32 v116, v17, v116, s[36:37]
    v_cndmask_b32 v117, v17, v117, s[38:39]
    v_cndmask_b32 v118, v17, v118, s[40:41]
    v_cndmask_b32 v119, v17, v119, s[42:43]
    v_cndmask_b32 v120, v17, v120, s[44:45]
    v_cndmask_b32 v121, v17, v121, s[46:47]
    v_cndmask_b32 v122, v17, v122, s[48:49]
    v_cndmask_b32 v123, v17, v123, s[50:51]
    v_cndmask_b32 v124, v17, v124, s[52:53]
    v_cndmask_b32 v125, v17, v125, s[54:55]
    v_cndmask_b32 v126, v17, v126, s[56:57]
    v_cndmask_b32 v127, v17, v127, s[58:59]
    v_cndmask_b32 v128, v17, v128, s[60:61]
    v_cndmask_b32 v129, v17, v129, s[62:63]
    v_cndmask_b32 v130, v17, v130, s[64:65]
    v_cndmask_b32 v131, v17, v131, s[66:67]
    v_max3_f32 v18, v116, v117, v118
    v_max3_f32 v18, v18, v119, v120
    v_max3_f32 v18, v18, v121, v122
    v_max3_f32 v18, v18, v123, v124
    v_max3_f32 v18, v18, v125, v126
    v_max3_f32 v18, v18, v127, v128
    v_max3_f32 v18, v18, v129, v130
    v_max3_f32 v18, v18, v131, v132
    v_max3_f32 v18, v18, v133, v134
    v_max_f32 v18, v18, v135
    v_mov_b32 v5, v18
    s_nop 1
    v_permlane32_swap_b32 v18, v5
    v_max_f32 v18, v18, v5
    v_mul_f32 v18, s29, v18
    v_fma_f32 v116, v116, s29, -v18
    v_fma_f32 v117, v117, s29, -v18
    v_fma_f32 v118, v118, s29, -v18
    v_fma_f32 v119, v119, s29, -v18
    v_fma_f32 v120, v120, s29, -v18
    v_fma_f32 v121, v121, s29, -v18
    v_fma_f32 v122, v122, s29, -v18
    v_fma_f32 v123, v123, s29, -v18
    v_fma_f32 v124, v124, s29, -v18
    v_fma_f32 v125, v125, s29, -v18
    v_fma_f32 v126, v126, s29, -v18
    v_fma_f32 v127, v127, s29, -v18
    v_fma_f32 v128, v128, s29, -v18
    v_fma_f32 v129, v129, s29, -v18
    v_fma_f32 v130, v130, s29, -v18
    v_fma_f32 v131, v131, s29, -v18
    v_fma_f32 v132, v132, s29, -v18
    v_fma_f32 v133, v133, s29, -v18
    v_fma_f32 v134, v134, s29, -v18
    v_fma_f32 v135, v135, s29, -v18
    v_exp_f32 v116, v116
    v_exp_f32 v117, v117
    v_exp_f32 v118, v118
    v_exp_f32 v119, v119
    v_exp_f32 v120, v120
    v_exp_f32 v121, v121
    v_exp_f32 v122, v122
    v_exp_f32 v123, v123
    v_exp_f32 v124, v124
    v_exp_f32 v125, v125
    v_exp_f32 v126, v126
    v_exp_f32 v127, v127
    v_exp_f32 v128, v128
    v_exp_f32 v129, v129
    v_exp_f32 v130, v130
    v_exp_f32 v131, v131
    v_exp_f32 v132, v132
    v_exp_f32 v133, v133
    v_exp_f32 v134, v134
    v_exp_f32 v135, v135
    s_waitcnt vmcnt(37)
    buffer_store_dword v9, v4, s[4:7], 0 offen sc1
    v_add_f32 v19, v116, v117
    v_add_f32 v6, v118, v119
    v_add_f32 v19, v19, v120
    v_add_f32 v6, v6, v121
    v_add_f32 v19, v19, v122
    v_add_f32 v6, v6, v123
    v_add_f32 v19, v19, v124
    v_add_f32 v6, v6, v125
    v_add_f32 v19, v19, v126
    v_add_f32 v6, v6, v127
    v_add_f32 v19, v19, v128
    v_add_f32 v6, v6, v129
    v_add_f32 v19, v19, v130
    v_add_f32 v6, v6, v131
    v_add_f32 v19, v19, v132
    v_add_f32 v6, v6, v133
    v_add_f32 v19, v19, v134
    v_add_f32 v6, v6, v135
    v_add_f32 v19, v19, v6
    v_mov_b32 v5, v19
    s_nop 1
    v_permlane32_swap_b32 v19, v5
    v_add_f32 v19, v19, v5
    v_rcp_f32 v19, v19
    s_nop 0
    v_mul_f32 v116, v116, v19
    v_mul_f32 v117, v117, v19
    v_mul_f32 v118, v118, v19
    v_mul_f32 v119, v119, v19
    v_mul_f32 v120, v120, v19
    v_mul_f32 v121, v121, v19
    v_mul_f32 v122, v122, v19
    v_mul_f32 v123, v123, v19
    v_mul_f32 v124, v124, v19
    v_mul_f32 v125, v125, v19
    v_mul_f32 v126, v126, v19
    v_mul_f32 v127, v127, v19
    v_mul_f32 v128, v128, v19
    v_mul_f32 v129, v129, v19
    v_mul_f32 v130, v130, v19
    v_mul_f32 v131, v131, v19
    v_mul_f32 v132, v132, v19
    v_mul_f32 v133, v133, v19
    v_mul_f32 v134, v134, v19
    v_mul_f32 v135, v135, v19
    v_cvt_pk_bf16_f32 v148, v116, v117
    v_cvt_pk_bf16_f32 v149, v118, v119
    v_cvt_pk_bf16_f32 v150, v120, v121
    v_cvt_pk_bf16_f32 v151, v122, v123
    v_cvt_pk_bf16_f32 v152, v124, v125
    v_cvt_pk_bf16_f32 v153, v126, v127
    v_cvt_pk_bf16_f32 v154, v128, v129
    v_cvt_pk_bf16_f32 v155, v130, v131
    v_cvt_pk_bf16_f32 v156, v132, v133
    v_cvt_pk_bf16_f32 v157, v134, v135
    v_mfma_f32_32x32x16_bf16 v[160:175], a[160:163], v[148:151], 0
    v_mfma_f32_32x32x16_bf16 v[160:175], a[164:167], v[152:155], v[160:175]
    v_mfma_f32_32x32x16_bf16 v[160:175], v[100:103], v[156:159], v[160:175]
    v_mfma_f32_32x32x16_bf16 v[176:191], a[168:171], v[148:151], 0
    v_mfma_f32_32x32x16_bf16 v[176:191], a[172:175], v[152:155], v[176:191]
    v_mfma_f32_32x32x16_bf16 v[176:191], v[104:107], v[156:159], v[176:191]
    s_nop 2
    v_cvt_pk_bf16_f32 v224, v160, v161
    v_cvt_pk_bf16_f32 v225, v162, v163
    v_cvt_pk_bf16_f32 v226, v164, v165
    v_cvt_pk_bf16_f32 v227, v166, v167
    v_cvt_pk_bf16_f32 v228, v168, v169
    v_cvt_pk_bf16_f32 v229, v170, v171
    v_cvt_pk_bf16_f32 v230, v172, v173
    v_cvt_pk_bf16_f32 v231, v174, v175
    buffer_store_dwordx4 v[224:227], v14, s[4:7], s33 offen offset:0 sc1
    buffer_store_dwordx4 v[228:231], v14, s[4:7], s33 offen offset:512 sc1
    v_mfma_f32_32x32x16_bf16 v[192:207], a[176:179], v[148:151], 0
    v_mfma_f32_32x32x16_bf16 v[192:207], a[180:183], v[152:155], v[192:207]
    v_mfma_f32_32x32x16_bf16 v[192:207], v[108:111], v[156:159], v[192:207]
    v_cvt_pk_bf16_f32 v232, v176, v177
    v_cvt_pk_bf16_f32 v233, v178, v179
    v_cvt_pk_bf16_f32 v234, v180, v181
    v_cvt_pk_bf16_f32 v235, v182, v183
    v_cvt_pk_bf16_f32 v236, v184, v185
    v_cvt_pk_bf16_f32 v237, v186, v187
    v_cvt_pk_bf16_f32 v238, v188, v189
    v_cvt_pk_bf16_f32 v239, v190, v191
    buffer_store_dwordx4 v[232:235], v14, s[4:7], s33 offen offset:1024 sc1
    buffer_store_dwordx4 v[236:239], v14, s[4:7], s33 offen offset:1536 sc1
    v_mfma_f32_32x32x16_bf16 v[208:223], a[184:187], v[148:151], 0
    v_mfma_f32_32x32x16_bf16 v[208:223], a[188:191], v[152:155], v[208:223]
    v_mfma_f32_32x32x16_bf16 v[208:223], v[112:115], v[156:159], v[208:223]
    v_cvt_pk_bf16_f32 v240, v192, v193
    v_cvt_pk_bf16_f32 v241, v194, v195
    v_cvt_pk_bf16_f32 v242, v196, v197
    v_cvt_pk_bf16_f32 v243, v198, v199
    v_cvt_pk_bf16_f32 v244, v200, v201
    v_cvt_pk_bf16_f32 v245, v202, v203
    v_cvt_pk_bf16_f32 v246, v204, v205
    v_cvt_pk_bf16_f32 v247, v206, v207
    buffer_store_dwordx4 v[240:243], v14, s[4:7], s33 offen offset:2048 sc1
    buffer_store_dwordx4 v[244:247], v14, s[4:7], s33 offen offset:2560 sc1
    v_add_u32 v9, 1, v9
    s_nop 0
    v_cvt_pk_bf16_f32 v248, v208, v209
    v_cvt_pk_bf16_f32 v249, v210, v211
    v_cvt_pk_bf16_f32 v250, v212, v213
    v_cvt_pk_bf16_f32 v251, v214, v215
    v_cvt_pk_bf16_f32 v252, v216, v217
    v_cvt_pk_bf16_f32 v253, v218, v219
    v_cvt_pk_bf16_f32 v254, v220, v221
    v_cvt_pk_bf16_f32 v255, v222, v223
    buffer_store_dwordx4 v[248:251], v14, s[4:7], s33 offen offset:3072 sc1
    buffer_store_dwordx4 v[252:255], v14, s[4:7], s33 offen offset:3584 sc1
    s_mov_b32 s28, s34
    s_add_u32 s33, s33, 1048576
    s_cmp_lt_u32 s28, 64
    s_cbranch_scc1 T_top0
T_fin:
    s_waitcnt vmcnt(0)
    buffer_store_dword v9, v4, s[4:7], 0 offen sc1
    s_branch W_fin
T_slow0:
    s_waitcnt vmcnt(0)
    buffer_store_dword v9, v4, s[4:7], 0 offen sc1
    s_mov_b32 s30, s92
T_s0:
    v_cmp_ge_u32 vcc, s28, v16
    s_nop 0
    s_and_b32 s17, vcc_lo, 61440
    s_cbranch_scc0 T_sk0
    s_cmp_ge_u32 s30, 1048576
    s_cselect_b32 s92, 1048576, s92
    s_cbranch_scc1 T_sk0
    s_add_u32 s30, s30, 1
    buffer_load_dword v16, v15, s[4:7], 0 offen sc1
    s_sleep 2
    s_waitcnt vmcnt(0)
    s_branch T_s0
T_sk0:
    s_add_u32 s17, s32, 0
    s_add_u32 s18, s32, 5242880
    buffer_load_dwordx4 v[20:23], v12, s[4:7], s17 offen offset:0
    buffer_load_dwordx4 v[24:27], v12, s[4:7], s17 offen offset:32
    buffer_load_dwordx2 v[52:53], v13, s[4:7], s18 offen
    s_add_u32 s17, s32, 33280
    s_add_u32 s18, s32, 5276160
    buffer_load_dwordx4 v[28:31], v12, s[4:7], s17 offen offset:0
    buffer_load_dwordx4 v[32:35], v12, s[4:7], s17 offen offset:32
    buffer_load_dwordx2 v[56:57], v13, s[4:7], s18 offen
    s_add_u32 s17, s32, 66560
    s_add_u32 s18, s32, 5309440
    buffer_load_dwordx4 v[36:39], v12, s[4:7], s17 offen offset:0
    buffer_load_dwordx4 v[40:43], v12, s[4:7], s17 offen offset:32
    buffer_load_dwordx2 v[60:61], v13, s[4:7], s18 offen
    s_add_u32 s17, s32, 99840
    s_add_u32 s18, s32, 5342720
    buffer_load_dwordx4 v[44:47], v12, s[4:7], s17 offen offset:0
    buffer_load_dwordx4 v[48:51], v12, s[4:7], s17 offen offset:32
    buffer_load_dwordx2 v[64:65], v13, s[4:7], s18 offen
    s_waitcnt vmcnt(0)
    s_branch T_go0
T_pw0:
    s_mov_b32 s30, s92
T_q0:
    v_cmp_ge_u32 vcc, s68, v16
    s_nop 0
    s_and_b32 s17, vcc_lo, 4095
    s_cbranch_scc0 T_pok0
    s_cmp_ge_u32 s30, 1048576
    s_cselect_b32 s92, 1048576, s92
    s_cbranch_scc1 T_pok0
    s_add_u32 s30, s30, 1
    buffer_load_dword v16, v15, s[4:7], 0 offen sc1
    s_sleep 8
    s_waitcnt vmcnt(0)
    s_branch T_q0
T_slow1:
    s_waitcnt vmcnt(0)
    buffer_store_dword v9, v4, s[4:7], 0 offen sc1
    s_cmp_ge_u32 s28, 60
    s_cbranch_scc1 T_last
    s_mov_b32 s30, s92
T_s1:
    v_cmp_ge_u32 vcc, s28, v16
    s_nop 0
    s_and_b32 s17, vcc_lo, 61440
    s_cbranch_scc0 T_sk1
    s_cmp_ge_u32 s30, 1048576
    s_cselect_b32 s92, 1048576, s92
    s_cbranch_scc1 T_sk1
    s_add_u32 s30, s30, 1
    buffer_load_dword v16, v15, s[4:7], 0 offen sc1
    s_sleep 2
    s_waitcnt vmcnt(0)
    s_branch T_s1
T_sk1:
    s_add_u32 s17, s32, 0
    s_add_u32 s18, s32, 5242880
    buffer_load_dwordx4 v[68:71], v12, s[4:7], s17 offen offset:0
    buffer_load_dwordx4 v[72:75], v12, s[4:7], s17 offen offset:32
    buffer_load_dwordx2 v[100:101], v13, s[4:7], s18 offen
    s_add_u32 s17, s32, 33280
    s_add_u32 s18, s32, 5276160
    buffer_load_dwordx4 v[76:79], v12, s[4:7], s17 offen offset:0
    buffer_load_dwordx4 v[80:83], v12, s[4:7], s17 offen offset:32
    buffer_load_dwordx2 v[104:105], v13, s[4:7], s18 offen
    s_add_u32 s17, s32, 66560
    s_add_u32 s18, s32, 5309440
    buffer_load_dwordx4 v[84:87], v12, s[4:7], s17 offen offset:0
    buffer_load_dwordx4 v[88:91], v12, s[4:7], s17 offen offset:32
    buffer_load_dwordx2 v[108:109], v13, s[4:7], s18 offen
    s_add_u32 s17, s32, 99840
    s_add_u32 s18, s32, 5342720
    buffer_load_dwordx4 v[92:95], v12, s[4:7], s17 offen offset:0
    buffer_load_dwordx4 v[96:99], v12, s[4:7], s17 offen offset:32
    buffer_load_dwordx2 v[112:113], v13, s[4:7], s18 offen
    s_waitcnt vmcnt(0)
    s_branch T_go1
T_pw1:
    s_mov_b32 s30, s92
T_q1:
    v_cmp_ge_u32 vcc, s68, v16
    s_nop 0
    s_and_b32 s17, vcc_lo, 4095
    s_cbranch_scc0 T_pok1
    s_cmp_ge_u32 s30, 1048576
    s_cselect_b32 s92, 1048576, s92
    s_cbranch_scc1 T_pok1
    s_add_u32 s30, s30, 1
    buffer_load_dword v16, v15, s[4:7], 0 offen sc1
    s_sleep 8
    s_waitcnt vmcnt(0)
    s_branch T_q1
T_last:
    v_mfma_f32_32x32x16_bf16 v[116:131], a[128:131], a[96:99], 0
    v_mfma_f32_32x32x16_bf16 v[116:131], a[132:135], a[100:103], v[116:131]
    v_mfma_f32_32x32x16_bf16 v[116:131], a[136:139], a[104:107], v[116:131]
    v_mfma_f32_32x32x16_bf16 v[116:131], a[140:143], a[108:111], v[116:131]
    v_mfma_f32_32x32x16_bf16 v[116:131], a[144:147], a[112:115], v[116:131]
    v_mfma_f32_32x32x16_bf16 v[116:131], a[148:151], a[116:119], v[116:131]
    v_mfma_f32_32x32x16_bf16 v[116:131], a[152:155], a[120:123], v[116:131]
    v_mfma_f32_32x32x16_bf16 v[116:131], a[156:159], a[124:127], v[116:131]
    s_nop 11
    v_cndmask_b32 v116, v17, v116, s[36:37]
    v_cndmask_b32 v117, v17, v117, s[38:39]
    v_cndmask_b32 v118, v17, v118, s[40:41]
    v_cndmask_b32 v119, v17, v119, s[42:43]
    v_cndmask_b32 v120, v17, v120, s[44:45]
    v_cndmask_b32 v121, v17, v121, s[46:47]
    v_cndmask_b32 v122, v17, v122, s[48:49]
    v_cndmask_b32 v123, v17, v123, s[50:51]
    v_cndmask_b32 v124, v17, v124, s[52:53]
    v_cndmask_b32 v125, v17, v125, s[54:55]
    v_cndmask_b32 v126, v17, v126, s[56:57]
    v_cndmask_b32 v127, v17, v127, s[58:59]
    v_cndmask_b32 v128, v17, v128, s[60:61]
    v_cndmask_b32 v129, v17, v129, s[62:63]
    v_cndmask_b32 v130, v17, v130, s[64:65]
    v_cndmask_b32 v131, v17, v131, s[66:67]
    v_max3_f32 v20, v116, v117, v118
    v_max3_f32 v20, v20, v119, v120
    v_max3_f32 v20, v20, v121, v122
    v_max3_f32 v20, v20, v123, v124
    v_max3_f32 v20, v20, v125, v126
    v_max3_f32 v20, v20, v127, v128
    v_max3_f32 v20, v20, v129, v130
    v_max_f32 v20, v20, v131
    v_mov_b32 v5, v20
    s_nop 1
    v_permlane32_swap_b32 v20, v5
    v_max_f32 v20, v20, v5
    v_mul_f32 v18, s29, v20
    v_fma_f32 v116, v116, s29, -v18
    v_fma_f32 v117, v117, s29, -v18
    v_fma_f32 v118, v118, s29, -v18
    v_fma_f32 v119, v119, s29, -v18
    v_fma_f32 v120, v120, s29, -v18
    v_fma_f32 v121, v121, s29, -v18
    v_fma_f32 v122, v122, s29, -v18
    v_fma_f32 v123, v123, s29, -v18
    v_fma_f32 v124, v124, s29, -v18
    v_fma_f32 v125, v125, s29, -v18
    v_fma_f32 v126, v126, s29, -v18
    v_fma_f32 v127, v127, s29, -v18
    v_fma_f32 v128, v128, s29, -v18
    v_fma_f32 v129, v129, s29, -v18
    v_fma_f32 v130, v130, s29, -v18
    v_fma_f32 v131, v131, s29, -v18
    v_exp_f32 v116, v116
    v_exp_f32 v117, v117
    v_exp_f32 v118, v118
    v_exp_f32 v119, v119
    v_exp_f32 v120, v120
    v_exp_f32 v121, v121
    v_exp_f32 v122, v122
    v_exp_f32 v123, v123
    v_exp_f32 v124, v124
    v_exp_f32 v125, v125
    v_exp_f32 v126, v126
    v_exp_f32 v127, v127
    v_exp_f32 v128, v128
    v_exp_f32 v129, v129
    v_exp_f32 v130, v130
    v_exp_f32 v131, v131
    v_add_f32 v19, v116, v117
    v_add_f32 v19, v19, v118
    v_add_f32 v19, v19, v119
    v_add_f32 v19, v19, v120
    v_add_f32 v19, v19, v121
    v_add_f32 v19, v19, v122
    v_add_f32 v19, v19, v123
    v_add_f32 v19, v19, v124
    v_add_f32 v19, v19, v125
    v_add_f32 v19, v19, v126
    v_add_f32 v19, v19, v127
    v_add_f32 v19, v19, v128
    v_add_f32 v19, v19, v129
    v_add_f32 v19, v19, v130
    v_add_f32 v19, v19, v131
    v_cvt_pk_bf16_f32 v148, v116, v117
    v_cvt_pk_bf16_f32 v149, v118, v119
    v_cvt_pk_bf16_f32 v150, v120, v121
    v_cvt_pk_bf16_f32 v151, v122, v123
    v_cvt_pk_bf16_f32 v152, v124, v125
    v_cvt_pk_bf16_f32 v153, v126, v127
    v_cvt_pk_bf16_f32 v154, v128, v129
    v_cvt_pk_bf16_f32 v155, v130, v131
    v_mfma_f32_32x32x16_bf16 v[160:175], a[160:163], v[148:151], 0
    s_nop 0
    v_mfma_f32_32x32x16_bf16 v[160:175], a[164:167], v[152:155], v[160:175]
    v_mfma_f32_32x32x16_bf16 v[176:191], a[168:171], v[148:151], 0
    v_mfma_f32_32x32x16_bf16 v[176:191], a[172:175], v[152:155], v[176:191]
    v_mfma_f32_32x32x16_bf16 v[192:207], a[176:179], v[148:151], 0
    v_mfma_f32_32x32x16_bf16 v[192:207], a[180:183], v[152:155], v[192:207]
    v_mfma_f32_32x32x16_bf16 v[208:223], a[184:187], v[148:151], 0
    v_mfma_f32_32x32x16_bf16 v[208:223], a[188:191], v[152:155], v[208:223]
    s_cmp_ge_u32 s28, 61
    s_cselect_b64 s[48:49], 0xffff, 0
    s_sub_u32 s34, s28, 2
    s_add_u32 s36, s32, 0
    s_add_u32 s40, s32, 5242880
    s_add_u32 s37, s32, 33280
    s_add_u32 s41, s32, 5276160
    s_add_u32 s38, s32, 66560
    s_add_u32 s42, s32, 5309440
    s_add_u32 s39, s32, 99840
    s_add_u32 s43, s32, 5342720
    v_add_u32 v9, 1, v9
    s_mov_b32 s30, s92
T_l0:
    v_cmp_ge_u32 vcc, s34, v16
    s_nop 0
    s_and_b32 s17, vcc_lo, 61440
    s_cbranch_scc0 T_l1
    s_cmp_ge_u32 s30, 1048576
    s_cselect_b32 s92, 1048576, s92
    s_cbranch_scc1 T_l1
    s_add_u32 s30, s30, 1
    buffer_load_dword v16, v15, s[4:7], 0 offen sc1
    s_sleep 2
    s_waitcnt vmcnt(0)
    s_branch T_l0
T_l2:
    v_max3_u32 v5, v68, v69, v70
    v_max3_u32 v5, v5, v71, v72
    v_max3_u32 v5, v5, v73, v74
    v_max3_u32 v5, v5, v75, v76
    v_max3_u32 v5, v5, v77, v78
    v_max3_u32 v5, v5, v79, v80
    v_max3_u32 v5, v5, v81, v82
    v_max3_u32 v5, v5, v83, v84
    v_max3_u32 v5, v5, v85, v86
    v_max3_u32 v5, v5, v87, v88
    v_max3_u32 v5, v5, v89, v90
    v_max3_u32 v5, v5, v91, v92
    v_max3_u32 v5, v5, v93, v94
    v_max3_u32 v5, v5, v95, v96
    v_max3_u32 v5, v5, v97, v98
    v_max3_u32 v5, v5, v99, v6
    v_cmp_eq_u32 vcc, -1, v5
    s_nop 0
    s_cbranch_vccz T_l3
    s_add_u32 s30, s30, 1
    s_cmp_ge_u32 s30, 1048576
    s_cbranch_scc1 T_l3
T_l1:
    buffer_load_dwordx4 v[68:71], v12, s[4:7], s36 offen offset:0 sc1
    buffer_load_dwordx4 v[72:75], v12, s[4:7], s36 offen offset:32 sc1
    buffer_load_dwordx4 v[76:79], v12, s[4:7], s37 offen offset:0 sc1
    buffer_load_dwordx4 v[80:83], v12, s[4:7], s37 offen offset:32 sc1
    buffer_load_dwordx4 v[84:87], v12, s[4:7], s38 offen offset:0 sc1
    buffer_load_dwordx4 v[88:91], v12, s[4:7], s38 offen offset:32 sc1
    buffer_load_dwordx4 v[92:95], v12, s[4:7], s39 offen offset:0 sc1
    buffer_load_dwordx4 v[96:99], v12, s[4:7], s39 offen offset:32 sc1
    buffer_load_dwordx2 v[100:101], v13, s[4:7], s40 offen sc1
    buffer_load_dwordx2 v[104:105], v13, s[4:7], s41 offen sc1
    buffer_load_dwordx2 v[108:109], v13, s[4:7], s42 offen sc1
    buffer_load_dwordx2 v[112:113], v13, s[4:7], s43 offen sc1
    s_waitcnt vmcnt(11)
    v_mfma_f32_32x32x16_bf16 v[132:147], v[68:71], a[96:99], 0
    s_waitcnt vmcnt(10)
    v_mfma_f32_32x32x16_bf16 v[132:147], v[72:75], a[100:103], v[132:147]
    s_waitcnt vmcnt(9)
    v_mfma_f32_32x32x16_bf16 v[132:147], v[76:79], a[104:107], v[132:147]
    s_waitcnt vmcnt(8)
    v_mfma_f32_32x32x16_bf16 v[132:147], v[80:83], a[108:111], v[132:147]
    s_waitcnt vmcnt(7)
    v_mfma_f32_32x32x16_bf16 v[132:147], v[84:87], a[112:115], v[132:147]
    s_waitcnt vmcnt(6)
    v_mfma_f32_32x32x16_bf16 v[132:147], v[88:91], a[116:119], v[132:147]
    s_waitcnt vmcnt(5)
    v_mfma_f32_32x32x16_bf16 v[132:147], v[92:95], a[120:123], v[132:147]
    s_waitcnt vmcnt(4)
    v_mfma_f32_32x32x16_bf16 v[132:147], v[96:99], a[124:127], v[132:147]
    s_waitcnt vmcnt(0)
    v_max3_u32 v6, v100, v101, v104
    v_max3_u32 v6, v6, v105, v108
    v_max3_u32 v6, v6, v109, v112
    v_max_u32 v6, v6, v113
    v_cmp_eq_u32 s[44:45], -1, v6
    s_nop 5
    v_cmp_u_f32 s[46:47], v132, v133
    v_cmp_u_f32 vcc, v134, v135
    v_max3_f32 v18, v132, v133, v20
    s_or_b64 s[44:45], s[44:45], s[46:47]
    v_max3_f32 v18, v134, v135, v18
    s_or_b64 vcc, vcc, s[44:45]
    s_cbranch_vccnz T_l2
T_l3:
    v_mov_b32 v5, v18
    s_nop 1
    v_permlane32_swap_b32 v18, v5
    v_max_f32 v18, v18, v5
    v_mul_f32 v18, s29, v18
    v_fma_f32 v21, v20, s29, -v18
    v_fma_f32 v132, v132, s29, -v18
    v_fma_f32 v133, v133, s29, -v18
    v_fma_f32 v134, v134, s29, -v18
    v_fma_f32 v135, v135, s29, -v18
    v_exp_f32 v21, v21
    v_exp_f32 v132, v132
    v_exp_f32 v133, v133
    v_exp_f32 v134, v134
    v_exp_f32 v135, v135
    v_fma_f32 v19, v19, v21, v132
    v_add_f32 v6, v133, v134
    v_add_f32 v19, v19, v135
    v_add_f32 v19, v19, v6
    v_mov_b32 v5, v19
    s_nop 1
    v_permlane32_swap_b32 v19, v5
    v_add_f32 v19, v19, v5
    v_rcp_f32 v19, v19
    s_nop 0
    v_mul_f32 v21, v21, v19
    v_mul_f32 v132, v132, v19
    v_mul_f32 v133, v133, v19
    v_mul_f32 v134, v134, v19
    v_mul_f32 v135, v135, v19
    v_cvt_pk_bf16_f32 v156, v132, v133
    v_cvt_pk_bf16_f32 v157, v134, v135
    v_mul_f32 v160, v160, v21
    v_mul_f32 v161, v161, v21
    v_mul_f32 v162, v162, v21
    v_mul_f32 v163, v163, v21
    v_mul_f32 v164, v164, v21
    v_mul_f32 v165, v165, v21
    v_mul_f32 v166, v166, v21
    v_mul_f32 v167, v167, v21
    v_mul_f32 v168, v168, v21
    v_mul_f32 v169, v169, v21
    v_mul_f32 v170, v170, v21
    v_mul_f32 v171, v171, v21
    v_mul_f32 v172, v172, v21
    v_mul_f32 v173, v173, v21
    v_mul_f32 v174, v174, v21
    v_mul_f32 v175, v175, v21
    s_nop 1
    v_mfma_f32_32x32x16_bf16 v[160:175], v[100:103], v[156:159], v[160:175]
    v_mul_f32 v176, v176, v21
    v_mul_f32 v177, v177, v21
    v_mul_f32 v178, v178, v21
    v_mul_f32 v179, v179, v21
    v_mul_f32 v180, v180, v21
    v_mul_f32 v181, v181, v21
    v_mul_f32 v182, v182, v21
    v_mul_f32 v183, v183, v21
    v_mul_f32 v184, v184, v21
    v_mul_f32 v185, v185, v21
    v_mul_f32 v186, v186, v21
    v_mul_f32 v187, v187, v21
    v_mul_f32 v188, v188, v21
    v_mul_f32 v189, v189, v21
    v_mul_f32 v190, v190, v21
    v_mul_f32 v191, v191, v21
    s_nop 1
    v_mfma_f32_32x32x16_bf16 v[176:191], v[104:107], v[156:159], v[176:191]
    v_cvt_pk_bf16_f32 v224, v160, v161
    v_cvt_pk_bf16_f32 v225, v162, v163
    v_cvt_pk_bf16_f32 v226, v164, v165
    v_cvt_pk_bf16_f32 v227, v166, v167
    v_cvt_pk_bf16_f32 v228, v168, v169
    v_cvt_pk_bf16_f32 v229, v170, v171
    v_cvt_pk_bf16_f32 v230, v172, v173
    v_cvt_pk_bf16_f32 v231, v174, v175
    buffer_store_dwordx4 v[224:227], v14, s[4:7], s33 offen offset:0 sc1
    buffer_store_dwordx4 v[228:231], v14, s[4:7], s33 offen offset:512 sc1
    v_mul_f32 v192, v192, v21
    v_mul_f32 v193, v193, v21
    v_mul_f32 v194, v194, v21
    v_mul_f32 v195, v195, v21
    v_mul_f32 v196, v196, v21
    v_mul_f32 v197, v197, v21
    v_mul_f32 v198, v198, v21
    v_mul_f32 v199, v199, v21
    v_mul_f32 v200, v200, v21
    v_mul_f32 v201, v201, v21
    v_mul_f32 v202, v202, v21
    v_mul_f32 v203, v203, v21
    v_mul_f32 v204, v204, v21
    v_mul_f32 v205, v205, v21
    v_mul_f32 v206, v206, v21
    v_mul_f32 v207, v207, v21
    s_nop 1
    v_mfma_f32_32x32x16_bf16 v[192:207], v[108:111], v[156:159], v[192:207]
    v_cvt_pk_bf16_f32 v232, v176, v177
    v_cvt_pk_bf16_f32 v233, v178, v179
    v_cvt_pk_bf16_f32 v234, v180, v181
    v_cvt_pk_bf16_f32 v235, v182, v183
    v_cvt_pk_bf16_f32 v236, v184, v185
    v_cvt_pk_bf16_f32 v237, v186, v187
    v_cvt_pk_bf16_f32 v238, v188, v189
    v_cvt_pk_bf16_f32 v239, v190, v191
    buffer_store_dwordx4 v[232:235], v14, s[4:7], s33 offen offset:1024 sc1
    buffer_store_dwordx4 v[236:239], v14, s[4:7], s33 offen offset:1536 sc1
    v_mul_f32 v208, v208, v21
    v_mul_f32 v209, v209, v21
    v_mul_f32 v210, v210, v21
    v_mul_f32 v211, v211, v21
    v_mul_f32 v212, v212, v21
    v_mul_f32 v213, v213, v21
    v_mul_f32 v214, v214, v21
    v_mul_f32 v215, v215, v21
    v_mul_f32 v216, v216, v21
    v_mul_f32 v217, v217, v21
    v_mul_f32 v218, v218, v21
    v_mul_f32 v219, v219, v21
    v_mul_f32 v220, v220, v21
    v_mul_f32 v221, v221, v21
    v_mul_f32 v222, v222, v21
    v_mul_f32 v223, v223, v21
    s_nop 1
    v_mfma_f32_32x32x16_bf16 v[208:223], v[112:115], v[156:159], v[208:223]
    v_cvt_pk_bf16_f32 v240, v192, v193
    v_cvt_pk_bf16_f32 v241, v194, v195
    v_cvt_pk_bf16_f32 v242, v196, v197
    v_cvt_pk_bf16_f32 v243, v198, v199
    v_cvt_pk_bf16_f32 v244, v200, v201
    v_cvt_pk_bf16_f32 v245, v202, v203
    v_cvt_pk_bf16_f32 v246, v204, v205
    v_cvt_pk_bf16_f32 v247, v206, v207
    buffer_store_dwordx4 v[240:243], v14, s[4:7], s33 offen offset:2048 sc1
    buffer_store_dwordx4 v[244:247], v14, s[4:7], s33 offen offset:2560 sc1
    s_nop 1
    v_cvt_pk_bf16_f32 v248, v208, v209
    v_cvt_pk_bf16_f32 v249, v210, v211
    v_cvt_pk_bf16_f32 v250, v212, v213
    v_cvt_pk_bf16_f32 v251, v214, v215
    v_cvt_pk_bf16_f32 v252, v216, v217
    v_cvt_pk_bf16_f32 v253, v218, v219
    v_cvt_pk_bf16_f32 v254, v220, v221
    v_cvt_pk_bf16_f32 v255, v222, v223
    buffer_store_dwordx4 v[248:251], v14, s[4:7], s33 offen offset:3072 sc1
    buffer_store_dwordx4 v[252:255], v14, s[4:7], s33 offen offset:3584 sc1
    s_branch T_fin
W_fin:
W_end:
    s_endpgm
R_entry:
    s_mov_b32 s12, s3
    s_lshr_b32 s13, s2, 3
    s_load_dwordx2 s[4:5], s[0:1], 96
    s_load_dwordx2 s[28:29], s[0:1], 32
    s_load_dwordx2 s[30:31], s[0:1], 40
    s_load_dwordx2 s[32:33], s[0:1], 48
    s_load_dwordx2 s[34:35], s[0:1], 56
    s_load_dwordx2 s[36:37], s[0:1], 64
    v_lshrrev_b32 v19, 6, v0
    v_and_b32 v1, 63, v0
    v_readfirstlane_b32 s14, v19
    s_mov_b32 s6, 268435456
    s_mov_b32 s7, 0x20000
    s_mov_b32 s10, 8388608
    s_mov_b32 s11, 0x20000
    s_mov_b32 s25, 0
    s_mov_b32 s24, 1040356334
    s_waitcnt lgkmcnt(0)
    v_and_b32 v96, 7, v1
    v_bfe_u32 v97, v1, 3, 1
    v_lshrrev_b32 v98, 4, v1
    v_lshlrev_b32 v19, 4, v1
    s_lshl_b32 s21, s12, 14
    s_lshl_b32 s22, s14, 12
    s_add_u32 s21, s21, s22
    s_add_u32 s22, s21, 0
    v_add_u32 v2, s22, v19
    s_add_u32 s22, s21, 229376
    v_add_u32 v8, s22, v19
    s_lshr_b32 s21, s13, 1
    s_lshl_b32 s21, s21, 10
    s_and_b32 s22, s13, 1
    s_lshl_b32 s22, s22, 7
    s_add_u32 s21, s21, s22
    s_lshl_b32 s22, s12, 14
    s_add_u32 s21, s21, s22
    v_lshlrev_b32 v20, 8, v98
    v_lshl_add_u32 v20, v96, 4, v20
    v_lshl_add_u32 v20, v97, 3, v20
    s_add_u32 s22, s21, 229376
    v_add_u32 v7, s22, v20
    s_add_u32 s22, s21, 0
    v_add_u32 v11, s22, v20
    s_lshr_b32 s21, s13, 1
    s_lshl_b32 s21, s21, 14
    s_and_b32 s22, s13, 1
    s_lshl_b32 s22, s22, 12
    s_add_u32 s21, s21, s22
    s_lshl_b32 s22, s12, 10
    s_add_u32 s22, s21, s22
    v_add_u32 v9, s22, v19
    v_xor_b32 v10, 1024, v9
    v_xor_b32 v23, 2048, v9
    v_xor_b32 v244, 3072, v9
    s_mov_b32 s95, 167772160
    s_lshr_b32 s40, s13, 2
    s_lshl_b32 s21, s12, 3
    s_add_u32 s40, s40, s21
    s_and_b32 s41, s13, 3
    s_mul_i32 s21, s40, 5120
    s_add_u32 s21, s21, 65536
    v_add_u32 v5, s21, v19
    v_lshlrev_b32 v20, 2, v1
    s_add_u32 s22, s21, 4096
    v_add_u32 v6, s22, v20
    s_lshl_b32 s22, s41, 10
    s_add_u32 s22, s22, s21
    v_add_u32 v3, s22, v19
    v_mov_b32 v21, 1073741824
    v_cmp_eq_u32 vcc, 0, v97
    s_nop 1
    v_cndmask_b32 v3, v21, v3, vcc
    s_lshl_b32 s22, s41, 8
    s_add_u32 s22, s22, s21
    s_add_u32 s22, s22, 4096
    v_lshlrev_b32 v20, 4, v98
    v_lshl_add_u32 v20, v96, 5, v20
    v_add_u32 v4, s22, v20
    v_cndmask_b32 v4, v4, v21, vcc
    v_cmp_gt_u32 vcc, 2, v98
    s_nop 1
    v_cndmask_b32 v4, v21, v4, vcc
    s_lshl_b32 s27, s40, 7
    s_lshl_b32 s21, s41, 5
    s_add_u32 s27, s27, s21
    v_bfe_u32 v20, v1, 2, 2
    v_and_b32 v22, 3, v1
    v_lshl_add_u32 v20, v20, 3, v22
    v_lshlrev_b32 v12, 6, v20
    v_lshl_add_u32 v12, v98, 4, v12
    s_and_b32 s21, s14, 1
    s_lshl_b32 s21, s21, 14
    s_lshl_b32 s22, s27, 2
    s_add_u32 s21, s21, s22
    s_add_u32 s21, s21, 100679680
    v_mov_b32 v245, s21
    s_mov_b32 s85, 0
    s_mul_i32 s21, s27, 4160
    v_add_u32 v12, s21, v12
    v_mov_b32 v13, v12
    v_lshlrev_b32 v15, 4, v20
    v_lshl_add_u32 v15, v98, 5, v15
    s_mul_i32 s21, s27, 1040
    v_add_u32 v15, s21, v15
    v_and_b32 v22, 1, v98
    v_cmp_eq_u32 vcc, 0, v22
    s_nop 1
    v_cndmask_b32 v15, v21, v15, vcc
    v_lshlrev_b32 v14, 6, v96
    v_lshl_add_u32 v14, v98, 4, v14
    v_add_u32 v14, s21, v14
    v_cmp_eq_u32 vcc, 1, v97
    s_nop 1
    v_cndmask_b32 v14, v21, v14, vcc
    v_mov_b32 v16, v19
    s_lshl_b32 s21, s14, 11
    v_add_u32 v17, s21, v19
    v_and_b32 v20, 15, v1
    v_bfe_u32 v22, v1, 2, 2
    v_and_b32 v18, 1, v1
    v_lshl_add_u32 v18, v22, 1, v18
    v_bfe_u32 v22, v1, 1, 1
    v_lshl_add_u32 v18, v22, 3, v18
    s_cmp_eq_u32 s14, 1
    s_cselect_b64 vcc, -1, 0
    v_cndmask_b32 v20, v20, v18, vcc
    v_and_b32 v22, 1, v98
    v_lshlrev_b32 v22, 2, v22
    v_sub_u32 v20, v20, v22
    v_mov_b32 v22, 0x3f80
    v_mov_b32 v18, 0x3f800000
    v_mov_b32 v172, 0x4444
    v_mov_b32 v84, 0xeeee
    v_cmp_eq_u32 vcc, 1, v97
    s_nop 1
    v_cndmask_b32 v172, v172, v84, vcc
    v_cmp_eq_u32 vcc, 0, v20
    s_nop 1
    v_cndmask_b32 v84, 0, v22, vcc
    v_cmp_eq_u32 vcc, 1, v20
    s_nop 1
    v_cndmask_b32 v84, v84, v18, vcc
    v_cmp_eq_u32 vcc, 2, v20
    s_nop 1
    v_cndmask_b32 v85, 0, v22, vcc
    v_cmp_eq_u32 vcc, 3, v20
    s_nop 1
    v_cndmask_b32 v85, v85, v18, vcc
    v_cmp_eq_u32 vcc, 8, v20
    s_nop 1
    v_cndmask_b32 v86, 0, v22, vcc
    v_cmp_eq_u32 vcc, 9, v20
    s_nop 1
    v_cndmask_b32 v86, v86, v18, vcc
    v_cmp_eq_u32 vcc, 10, v20
    s_nop 1
    v_cndmask_b32 v87, 0, v22, vcc
    v_cmp_eq_u32 vcc, 11, v20
    s_nop 1
    v_cndmask_b32 v87, v87, v18, vcc
    s_mov_b32 s16, 81788928
    s_mov_b32 s42, 82083840
    s_mov_b32 s43, 82378752
    s_mov_b32 s44, 82673664
    s_mov_b32 s17, 17825792
    s_mov_b32 s18, 35651584
    s_mov_b32 s19, 71303168
    s_mov_b32 s20, 76546048
    s_mov_b32 s15, 0
    v_mov_b32 v204, -1
    v_mov_b32 v205, -1
    v_mov_b32 v206, -1
    v_mov_b32 v207, -1
    v_mov_b32 v236, 0x3f803f80
    v_mov_b32 v237, 0x3f803f80
    v_mov_b32 v238, 0x3f803f80
    v_mov_b32 v239, 0x3f803f80
    s_mul_i32 s22, s14, 294912
    s_add_u32 s22, s22, 81788928
    buffer_store_dwordx4 v[204:207], v3, s[4:7], s22 offen sc1
    buffer_store_dwordx4 v[204:207], v3, s[4:7], s22 offen offset:128 sc1
    buffer_store_dwordx4 v[204:207], v4, s[4:7], s22 offen sc1
    buffer_store_dwordx2 v[204:205], v7, s[4:7], s22 offen sc1
    buffer_store_dwordx2 v[204:205], v11, s[4:7], s22 offen sc1
    s_lshl_b32 s22, s14, 18
    s_add_u32 s22, s22, 167772160
    buffer_store_dwordx4 v[204:207], v9, s[4:7], s22 offen sc1
    s_add_u32 s22, s22, 8192
    buffer_store_dwordx4 v[204:207], v9, s[4:7], s22 offen sc1
    s_lshl_b32 s22, s14, 9
    s_add_u32 s22, s22, 71333888
    buffer_store_dwordx4 v[204:207], v14, s[4:7], s22 offen sc1
    s_add_u32 s22, s22, 5242880
    buffer_store_dwordx4 v[204:207], v15, s[4:7], s22 offen sc1
    s_lshl_b32 s22, s27, 2
    s_add_u32 s22, s22, 100712448
    v_lshlrev_b32 v246, 2, v1
    v_add_u32 v246, s22, v246
    v_cmp_gt_u32 vcc, 32, v1
    s_nop 1
    v_cndmask_b32 v246, v21, v246, vcc
    v_mov_b32 v247, 0
    buffer_store_dword v247, v246, s[4:7], 0 offen sc1
    v_lshrrev_b32 v19, 2, v1
    v_and_b32 v22, 3, v1
    v_lshlrev_b32 v22, 4, v22
    v_lshl_add_u32 v140, v19, 13, v22
    v_lshl_add_u32 v141, v19, 11, v22
    s_mul_i32 s86, s14, 40960
    s_lshr_b32 s21, s13, 3
    s_cmp_eq_u32 s21, 1
    s_cselect_b64 s[8:9], s[32:33], s[30:31]
    s_cmp_eq_u32 s21, 2
    s_cselect_b64 s[8:9], s[34:35], s[8:9]
    s_cmp_eq_u32 s21, 3
    s_cselect_b64 s[8:9], s[36:37], s[8:9]
    s_cselect_b32 s21, 11, 13
    s_cselect_b32 s87, 21, 11
    s_lshl_b32 s87, s12, s87
    s_and_b32 s22, s13, 3
    s_lshl_b32 s22, s22, 8
    v_add_u32 v142, s22, v0
    v_lshlrev_b32 v142, s21, v142
    s_and_b32 s22, s13, 4
    s_lshl_b32 s22, s22, 8
    s_add_u32 s87, s87, s22
    buffer_load_dword v143, v142, s[8:11], s87 offen offset:384
    s_cmp_eq_u32 s87, 7168
    s_cselect_b32 s87, s87, 1073741824
    buffer_load_dword v144, v142, s[8:11], s87 offen offset:896
    s_mov_b32 s8, s32
    s_mov_b32 s9, s33
    s_lshl_b32 s87, s14, 21
    s_lshl_b32 s22, s27, 1
    s_add_u32 s87, s87, s22
    s_add_u32 m0, s86, 0
    s_nop 0
    buffer_load_dwordx4 v140, s[8:11], s87 offen lds
    s_add_u32 s87, s87, 131072
    s_add_u32 m0, s86, 1024
    s_nop 0
    buffer_load_dwordx4 v140, s[8:11], s87 offen lds
    s_add_u32 s87, s87, 131072
    s_add_u32 m0, s86, 2048
    s_nop 0
    buffer_load_dwordx4 v140, s[8:11], s87 offen lds
    s_add_u32 s87, s87, 131072
    s_add_u32 m0, s86, 3072
    s_nop 0
    buffer_load_dwordx4 v140, s[8:11], s87 offen lds
    s_add_u32 s87, s87, 131072
    v_bfe_u32 v19, v1, 2, 1
    v_lshl_add_u32 v19, v98, 2, v19
    v_lshl_add_u32 v19, v97, 5, v19
    v_lshl_add_u32 v22, v19, 6, v22
    v_add_u32 v22, s86, v22
    s_waitcnt vmcnt(6)
    s_barrier
    s_cmp_lg_u32 s14, 0
    s_cbranch_scc1 reg_20
    s_and_b32 s21, s2, 3
    s_lshl_b32 s21, s21, 3
    s_lshl_b32 s22, s98, 2
    s_add_u32 s21, s21, s22
    s_lshl_b32 s21, 1, s21
    s_andn2_b32 s22, s2, 3
    v_mov_b32 v20, s22
    v_mov_b32 v21, s21
    s_mov_b64 exec, 1
    global_atomic_add v20, v21, s[100:101] sc1
    s_mov_b64 exec, -1
reg_20:
    s_barrier
    s_add_u32 m0, s86, 4096
    s_nop 0
    buffer_load_dwordx4 v140, s[8:11], s87 offen lds
    s_add_u32 s87, s87, 131072
    s_add_u32 m0, s86, 5120
    s_nop 0
    buffer_load_dwordx4 v140, s[8:11], s87 offen lds
    s_add_u32 s87, s87, 131072
    s_add_u32 m0, s86, 6144
    s_nop 0
    buffer_load_dwordx4 v140, s[8:11], s87 offen lds
    s_add_u32 s87, s87, 131072
    s_add_u32 m0, s86, 7168
    s_nop 0
    buffer_load_dwordx4 v140, s[8:11], s87 offen lds
    s_add_u32 s87, s87, 131072
    s_add_u32 m0, s86, 8192
    s_nop 0
    buffer_load_dwordx4 v140, s[8:11], s87 offen lds
    s_add_u32 s87, s87, 131072
    s_add_u32 m0, s86, 9216
    s_nop 0
    buffer_load_dwordx4 v140, s[8:11], s87 offen lds
    s_add_u32 s87, s87, 131072
    s_add_u32 m0, s86, 10240
    s_nop 0
    buffer_load_dwordx4 v140, s[8:11], s87 offen lds
    s_add_u32 s87, s87, 131072
    s_add_u32 m0, s86, 11264
    s_nop 0
    buffer_load_dwordx4 v140, s[8:11], s87 offen lds
    s_add_u32 s87, s87, 131072
    s_add_u32 m0, s86, 12288
    s_nop 0
    buffer_load_dwordx4 v140, s[8:11], s87 offen lds
    s_add_u32 s87, s87, 131072
    s_add_u32 m0, s86, 13312
    s_nop 0
    buffer_load_dwordx4 v140, s[8:11], s87 offen lds
    s_add_u32 s87, s87, 131072
    s_add_u32 m0, s86, 14336
    s_nop 0
    buffer_load_dwordx4 v140, s[8:11], s87 offen lds
    s_add_u32 s87, s87, 131072
    s_add_u32 m0, s86, 15360
    s_nop 0
    buffer_load_dwordx4 v140, s[8:11], s87 offen lds
    s_add_u32 s87, s87, 131072
    s_mov_b32 s8, s34
    s_mov_b32 s9, s35
    s_lshl_b32 s87, s14, 21
    s_lshl_b32 s22, s27, 1
    s_add_u32 s87, s87, s22
    s_add_u32 m0, s86, 16384
    s_nop 0
    buffer_load_dwordx4 v140, s[8:11], s87 offen lds
    s_add_u32 s87, s87, 131072
    s_add_u32 m0, s86, 17408
    s_nop 0
    buffer_load_dwordx4 v140, s[8:11], s87 offen lds
    s_add_u32 s87, s87, 131072
    s_add_u32 m0, s86, 18432
    s_nop 0
    buffer_load_dwordx4 v140, s[8:11], s87 offen lds
    s_add_u32 s87, s87, 131072
    s_add_u32 m0, s86, 19456
    s_nop 0
    buffer_load_dwordx4 v140, s[8:11], s87 offen lds
    s_add_u32 s87, s87, 131072
    s_add_u32 m0, s86, 20480
    s_nop 0
    buffer_load_dwordx4 v140, s[8:11], s87 offen lds
    s_add_u32 s87, s87, 131072
    s_add_u32 m0, s86, 21504
    s_nop 0
    buffer_load_dwordx4 v140, s[8:11], s87 offen lds
    s_add_u32 s87, s87, 131072
    s_add_u32 m0, s86, 22528
    s_nop 0
    buffer_load_dwordx4 v140, s[8:11], s87 offen lds
    s_add_u32 s87, s87, 131072
    s_add_u32 m0, s86, 23552
    s_nop 0
    buffer_load_dwordx4 v140, s[8:11], s87 offen lds
    s_add_u32 s87, s87, 131072
    s_add_u32 m0, s86, 24576
    s_nop 0
    buffer_load_dwordx4 v140, s[8:11], s87 offen lds
    s_add_u32 s87, s87, 131072
    s_add_u32 m0, s86, 25600
    s_nop 0
    buffer_load_dwordx4 v140, s[8:11], s87 offen lds
    s_add_u32 s87, s87, 131072
    s_add_u32 m0, s86, 26624
    s_nop 0
    buffer_load_dwordx4 v140, s[8:11], s87 offen lds
    s_add_u32 s87, s87, 131072
    s_add_u32 m0, s86, 27648
    s_nop 0
    buffer_load_dwordx4 v140, s[8:11], s87 offen lds
    s_add_u32 s87, s87, 131072
    s_add_u32 m0, s86, 28672
    s_nop 0
    buffer_load_dwordx4 v140, s[8:11], s87 offen lds
    s_add_u32 s87, s87, 131072
    s_add_u32 m0, s86, 29696
    s_nop 0
    buffer_load_dwordx4 v140, s[8:11], s87 offen lds
    s_add_u32 s87, s87, 131072
    s_add_u32 m0, s86, 30720
    s_nop 0
    buffer_load_dwordx4 v140, s[8:11], s87 offen lds
    s_add_u32 s87, s87, 131072
    s_add_u32 m0, s86, 31744
    s_nop 0
    buffer_load_dwordx4 v140, s[8:11], s87 offen lds
    s_add_u32 s87, s87, 131072
    s_mov_b32 s8, s30
    s_mov_b32 s9, s31
    s_lshl_b32 s87, s14, 21
    s_lshl_b32 s22, s27, 1
    s_add_u32 s87, s87, s22
    s_add_u32 m0, s86, 32768
    s_nop 0
    buffer_load_dwordx4 v140, s[8:11], s87 offen lds
    s_add_u32 s87, s87, 131072
    s_add_u32 m0, s86, 33792
    s_nop 0
    buffer_load_dwordx4 v140, s[8:11], s87 offen lds
    s_add_u32 s87, s87, 131072
    s_add_u32 m0, s86, 34816
    s_nop 0
    buffer_load_dwordx4 v140, s[8:11], s87 offen lds
    s_add_u32 s87, s87, 131072
    s_add_u32 m0, s86, 35840
    s_nop 0
    buffer_load_dwordx4 v140, s[8:11], s87 offen lds
    s_add_u32 s87, s87, 131072
    s_add_u32 m0, s86, 36864
    s_nop 0
    buffer_load_dwordx4 v140, s[8:11], s87 offen lds
    s_add_u32 s87, s87, 131072
    s_add_u32 m0, s86, 37888
    s_nop 0
    buffer_load_dwordx4 v140, s[8:11], s87 offen lds
    s_add_u32 s87, s87, 131072
    s_add_u32 m0, s86, 38912
    s_nop 0
    buffer_load_dwordx4 v140, s[8:11], s87 offen lds
    s_add_u32 s87, s87, 131072
    s_add_u32 m0, s86, 39936
    s_nop 0
    buffer_load_dwordx4 v140, s[8:11], s87 offen lds
    s_add_u32 s87, s87, 131072
    s_waitcnt vmcnt(36)
    ds_read_b64_tr_b16 a[64:65], v22 offset:0
    ds_read_b64_tr_b16 a[66:67], v22 offset:128
    ds_read_b64_tr_b16 a[68:69], v22 offset:1024
    ds_read_b64_tr_b16 a[70:71], v22 offset:1152
    s_waitcnt lgkmcnt(4)
    ds_read_b64_tr_b16 a[96:97], v22 offset:8
    ds_read_b64_tr_b16 a[98:99], v22 offset:136
    ds_read_b64_tr_b16 a[100:101], v22 offset:1032
    ds_read_b64_tr_b16 a[102:103], v22 offset:1160
    s_waitcnt vmcnt(32)
    ds_read_b64_tr_b16 a[72:73], v22 offset:4096
    ds_read_b64_tr_b16 a[74:75], v22 offset:4224
    ds_read_b64_tr_b16 a[76:77], v22 offset:5120
    ds_read_b64_tr_b16 a[78:79], v22 offset:5248
    s_waitcnt lgkmcnt(4)
    ds_read_b64_tr_b16 a[104:105], v22 offset:4104
    ds_read_b64_tr_b16 a[106:107], v22 offset:4232
    ds_read_b64_tr_b16 a[108:109], v22 offset:5128
    ds_read_b64_tr_b16 a[110:111], v22 offset:5256
    s_add_u32 m0, s86, 0
    s_nop 0
    buffer_load_dwordx4 v140, s[8:11], s87 offen lds
    s_add_u32 s87, s87, 131072
    s_add_u32 m0, s86, 1024
    s_nop 0
    buffer_load_dwordx4 v140, s[8:11], s87 offen lds
    s_add_u32 s87, s87, 131072
    s_add_u32 m0, s86, 2048
    s_nop 0
    buffer_load_dwordx4 v140, s[8:11], s87 offen lds
    s_add_u32 s87, s87, 131072
    s_add_u32 m0, s86, 3072
    s_nop 0
    buffer_load_dwordx4 v140, s[8:11], s87 offen lds
    s_add_u32 s87, s87, 131072
    s_waitcnt vmcnt(32)
    ds_read_b64_tr_b16 a[80:81], v22 offset:8192
    ds_read_b64_tr_b16 a[82:83], v22 offset:8320
    ds_read_b64_tr_b16 a[84:85], v22 offset:9216
    ds_read_b64_tr_b16 a[86:87], v22 offset:9344
    s_waitcnt lgkmcnt(4)
    ds_read_b64_tr_b16 a[112:113], v22 offset:8200
    ds_read_b64_tr_b16 a[114:115], v22 offset:8328
    ds_read_b64_tr_b16 a[116:117], v22 offset:9224
    ds_read_b64_tr_b16 a[118:119], v22 offset:9352
    s_add_u32 m0, s86, 4096
    s_nop 0
    buffer_load_dwordx4 v140, s[8:11], s87 offen lds
    s_add_u32 s87, s87, 131072
    s_add_u32 m0, s86, 5120
    s_nop 0
    buffer_load_dwordx4 v140, s[8:11], s87 offen lds
    s_add_u32 s87, s87, 131072
    s_add_u32 m0, s86, 6144
    s_nop 0
    buffer_load_dwordx4 v140, s[8:11], s87 offen lds
    s_add_u32 s87, s87, 131072
    s_add_u32 m0, s86, 7168
    s_nop 0
    buffer_load_dwordx4 v140, s[8:11], s87 offen lds
    s_add_u32 s87, s87, 131072
    s_waitcnt vmcnt(32)
    ds_read_b64_tr_b16 a[88:89], v22 offset:12288
    ds_read_b64_tr_b16 a[90:91], v22 offset:12416
    ds_read_b64_tr_b16 a[92:93], v22 offset:13312
    ds_read_b64_tr_b16 a[94:95], v22 offset:13440
    s_waitcnt lgkmcnt(4)
    ds_read_b64_tr_b16 a[120:121], v22 offset:12296
    ds_read_b64_tr_b16 a[122:123], v22 offset:12424
    ds_read_b64_tr_b16 a[124:125], v22 offset:13320
    ds_read_b64_tr_b16 a[126:127], v22 offset:13448
    s_mov_b32 s8, s36
    s_mov_b32 s9, s37
    s_lshl_b32 s87, s12, 21
    s_lshl_b32 s22, s14, 19
    s_add_u32 s87, s87, s22
    s_lshl_b32 s22, s13, 6
    s_add_u32 s87, s87, s22
    s_add_u32 m0, s86, 8192
    s_nop 0
    buffer_load_dwordx4 v141, s[8:11], s87 offen lds
    s_add_u32 s87, s87, 32768
    s_add_u32 m0, s86, 9216
    s_nop 0
    buffer_load_dwordx4 v141, s[8:11], s87 offen lds
    s_add_u32 s87, s87, 32768
    s_add_u32 m0, s86, 10240
    s_nop 0
    buffer_load_dwordx4 v141, s[8:11], s87 offen lds
    s_add_u32 s87, s87, 32768
    s_add_u32 m0, s86, 11264
    s_nop 0
    buffer_load_dwordx4 v141, s[8:11], s87 offen lds
    s_add_u32 s87, s87, 32768
    s_waitcnt vmcnt(32)
    ds_read_b64_tr_b16 a[128:129], v22 offset:16384
    ds_read_b64_tr_b16 a[130:131], v22 offset:16512
    ds_read_b64_tr_b16 a[132:133], v22 offset:17408
    ds_read_b64_tr_b16 a[134:135], v22 offset:17536
    s_waitcnt lgkmcnt(4)
    ds_read_b64_tr_b16 a[160:161], v22 offset:16392
    ds_read_b64_tr_b16 a[162:163], v22 offset:16520
    ds_read_b64_tr_b16 a[164:165], v22 offset:17416
    ds_read_b64_tr_b16 a[166:167], v22 offset:17544
    s_add_u32 m0, s86, 12288
    s_nop 0
    buffer_load_dwordx4 v141, s[8:11], s87 offen lds
    s_add_u32 s87, s87, 32768
    s_add_u32 m0, s86, 13312
    s_nop 0
    buffer_load_dwordx4 v141, s[8:11], s87 offen lds
    s_add_u32 s87, s87, 32768
    s_add_u32 m0, s86, 14336
    s_nop 0
    buffer_load_dwordx4 v141, s[8:11], s87 offen lds
    s_add_u32 s87, s87, 32768
    s_add_u32 m0, s86, 15360
    s_nop 0
    buffer_load_dwordx4 v141, s[8:11], s87 offen lds
    s_add_u32 s87, s87, 32768
    s_waitcnt vmcnt(32)
    ds_read_b64_tr_b16 a[136:137], v22 offset:20480
    ds_read_b64_tr_b16 a[138:139], v22 offset:20608
    ds_read_b64_tr_b16 a[140:141], v22 offset:21504
    ds_read_b64_tr_b16 a[142:143], v22 offset:21632
    s_waitcnt lgkmcnt(4)
    ds_read_b64_tr_b16 a[168:169], v22 offset:20488
    ds_read_b64_tr_b16 a[170:171], v22 offset:20616
    ds_read_b64_tr_b16 a[172:173], v22 offset:21512
    ds_read_b64_tr_b16 a[174:175], v22 offset:21640
    s_add_u32 m0, s86, 16384
    s_nop 0
    buffer_load_dwordx4 v141, s[8:11], s87 offen lds
    s_add_u32 s87, s87, 32768
    s_add_u32 m0, s86, 17408
    s_nop 0
    buffer_load_dwordx4 v141, s[8:11], s87 offen lds
    s_add_u32 s87, s87, 32768
    s_add_u32 m0, s86, 18432
    s_nop 0
    buffer_load_dwordx4 v141, s[8:11], s87 offen lds
    s_add_u32 s87, s87, 32768
    s_add_u32 m0, s86, 19456
    s_nop 0
    buffer_load_dwordx4 v141, s[8:11], s87 offen lds
    s_add_u32 s87, s87, 32768
    s_waitcnt vmcnt(32)
    ds_read_b64_tr_b16 a[144:145], v22 offset:24576
    ds_read_b64_tr_b16 a[146:147], v22 offset:24704
    ds_read_b64_tr_b16 a[148:149], v22 offset:25600
    ds_read_b64_tr_b16 a[150:151], v22 offset:25728
    s_waitcnt lgkmcnt(4)
    ds_read_b64_tr_b16 a[176:177], v22 offset:24584
    ds_read_b64_tr_b16 a[178:179], v22 offset:24712
    ds_read_b64_tr_b16 a[180:181], v22 offset:25608
    ds_read_b64_tr_b16 a[182:183], v22 offset:25736
    s_add_u32 m0, s86, 20480
    s_nop 0
    buffer_load_dwordx4 v141, s[8:11], s87 offen lds
    s_add_u32 s87, s87, 32768
    s_add_u32 m0, s86, 21504
    s_nop 0
    buffer_load_dwordx4 v141, s[8:11], s87 offen lds
    s_add_u32 s87, s87, 32768
    s_add_u32 m0, s86, 22528
    s_nop 0
    buffer_load_dwordx4 v141, s[8:11], s87 offen lds
    s_add_u32 s87, s87, 32768
    s_add_u32 m0, s86, 23552
    s_nop 0
    buffer_load_dwordx4 v141, s[8:11], s87 offen lds
    s_add_u32 s87, s87, 32768
    s_waitcnt vmcnt(32)
    ds_read_b64_tr_b16 a[152:153], v22 offset:28672
    ds_read_b64_tr_b16 a[154:155], v22 offset:28800
    ds_read_b64_tr_b16 a[156:157], v22 offset:29696
    ds_read_b64_tr_b16 a[158:159], v22 offset:29824
    s_waitcnt lgkmcnt(4)
    ds_read_b64_tr_b16 a[184:185], v22 offset:28680
    ds_read_b64_tr_b16 a[186:187], v22 offset:28808
    ds_read_b64_tr_b16 a[188:189], v22 offset:29704
    ds_read_b64_tr_b16 a[190:191], v22 offset:29832
    s_waitcnt vmcnt(28)
    ds_read_b64_tr_b16 a[0:1], v22 offset:32768
    ds_read_b64_tr_b16 a[2:3], v22 offset:32896
    ds_read_b64_tr_b16 a[4:5], v22 offset:33792
    ds_read_b64_tr_b16 a[6:7], v22 offset:33920
    s_waitcnt lgkmcnt(4)
    ds_read_b64_tr_b16 a[32:33], v22 offset:32776
    ds_read_b64_tr_b16 a[34:35], v22 offset:32904
    ds_read_b64_tr_b16 a[36:37], v22 offset:33800
    ds_read_b64_tr_b16 a[38:39], v22 offset:33928
    s_waitcnt vmcnt(24)
    ds_read_b64_tr_b16 a[8:9], v22 offset:36864
    ds_read_b64_tr_b16 a[10:11], v22 offset:36992
    ds_read_b64_tr_b16 a[12:13], v22 offset:37888
    ds_read_b64_tr_b16 a[14:15], v22 offset:38016
    s_waitcnt lgkmcnt(4)
    ds_read_b64_tr_b16 a[40:41], v22 offset:36872
    ds_read_b64_tr_b16 a[42:43], v22 offset:37000
    ds_read_b64_tr_b16 a[44:45], v22 offset:37896
    ds_read_b64_tr_b16 a[46:47], v22 offset:38024
    s_waitcnt vmcnt(20)
    ds_read_b64_tr_b16 a[16:17], v22 offset:0
    ds_read_b64_tr_b16 a[18:19], v22 offset:128
    ds_read_b64_tr_b16 a[20:21], v22 offset:1024
    ds_read_b64_tr_b16 a[22:23], v22 offset:1152
    s_waitcnt lgkmcnt(4)
    ds_read_b64_tr_b16 a[48:49], v22 offset:8
    ds_read_b64_tr_b16 a[50:51], v22 offset:136
    ds_read_b64_tr_b16 a[52:53], v22 offset:1032
    ds_read_b64_tr_b16 a[54:55], v22 offset:1160
    s_waitcnt vmcnt(16)
    ds_read_b64_tr_b16 a[24:25], v22 offset:4096
    ds_read_b64_tr_b16 a[26:27], v22 offset:4224
    ds_read_b64_tr_b16 a[28:29], v22 offset:5120
    ds_read_b64_tr_b16 a[30:31], v22 offset:5248
    s_waitcnt lgkmcnt(4)
    ds_read_b64_tr_b16 a[56:57], v22 offset:4104
    ds_read_b64_tr_b16 a[58:59], v22 offset:4232
    ds_read_b64_tr_b16 a[60:61], v22 offset:5128
    ds_read_b64_tr_b16 a[62:63], v22 offset:5256
    s_waitcnt vmcnt(12)
    ds_read_b64_tr_b16 a[192:193], v22 offset:8192
    ds_read_b64_tr_b16 a[194:195], v22 offset:8320
    ds_read_b64_tr_b16 a[196:197], v22 offset:9216
    ds_read_b64_tr_b16 a[198:199], v22 offset:9344
    s_waitcnt lgkmcnt(4)
    ds_read_b64_tr_b16 a[224:225], v22 offset:8200
    ds_read_b64_tr_b16 a[226:227], v22 offset:8328
    ds_read_b64_tr_b16 a[228:229], v22 offset:9224
    ds_read_b64_tr_b16 a[230:231], v22 offset:9352
    s_waitcnt vmcnt(8)
    ds_read_b64_tr_b16 a[200:201], v22 offset:12288
    ds_read_b64_tr_b16 a[202:203], v22 offset:12416
    ds_read_b64_tr_b16 a[204:205], v22 offset:13312
    ds_read_b64_tr_b16 a[206:207], v22 offset:13440
    s_waitcnt lgkmcnt(4)
    ds_read_b64_tr_b16 a[232:233], v22 offset:12296
    ds_read_b64_tr_b16 a[234:235], v22 offset:12424
    ds_read_b64_tr_b16 a[236:237], v22 offset:13320
    ds_read_b64_tr_b16 a[238:239], v22 offset:13448
    s_waitcnt vmcnt(4)
    ds_read_b64_tr_b16 a[208:209], v22 offset:16384
    ds_read_b64_tr_b16 a[210:211], v22 offset:16512
    ds_read_b64_tr_b16 a[212:213], v22 offset:17408
    ds_read_b64_tr_b16 a[214:215], v22 offset:17536
    s_waitcnt lgkmcnt(4)
    ds_read_b64_tr_b16 a[240:241], v22 offset:16392
    ds_read_b64_tr_b16 a[242:243], v22 offset:16520
    ds_read_b64_tr_b16 a[244:245], v22 offset:17416
    ds_read_b64_tr_b16 a[246:247], v22 offset:17544
    s_waitcnt vmcnt(0)
    ds_read_b64_tr_b16 a[216:217], v22 offset:20480
    ds_read_b64_tr_b16 a[218:219], v22 offset:20608
    ds_read_b64_tr_b16 a[220:221], v22 offset:21504
    ds_read_b64_tr_b16 a[222:223], v22 offset:21632
    s_waitcnt lgkmcnt(4)
    ds_read_b64_tr_b16 a[248:249], v22 offset:20488
    ds_read_b64_tr_b16 a[250:251], v22 offset:20616
    ds_read_b64_tr_b16 a[252:253], v22 offset:21512
    ds_read_b64_tr_b16 a[254:255], v22 offset:21640
    s_waitcnt lgkmcnt(0)
    v_mov_b32 v155, 0
    v_mov_b32 v159, 0
    v_mov_b32 v163, 0
    v_mov_b32 v167, 0
    v_mov_b32 v179, 0
    s_mov_b32 s8, s28
    s_mov_b32 s9, s29
    s_mov_b32 s10, 16384
    v_lshlrev_b32 v20, 11, v96
    v_lshl_add_u32 v20, v98, 4, v20
    v_lshl_add_u32 v20, v97, 3, v20
    s_lshl_b32 s21, s13, 6
    buffer_load_dwordx2 v[88:89], v20, s[8:11], s21 offen
    v_lshlrev_b32 v20, 2, v1
    s_mov_b32 s22, 0
rdv_21:
    global_load_dword v21, v20, s[100:101] sc1
    s_lshl_b32 s21, s98, 2
    s_waitcnt vmcnt(0)
    v_lshrrev_b32 v22, s21, v21
    s_cmp_eq_u32 s98, 0
    s_cselect_b32 s21, 0x0f0f0f0f, s21
    s_cselect_b32 s21, s21, 0x01010101
    v_and_b32 v22, s21, v22
    v_cmp_ne_u32 vcc, 0x01010101, v22
    s_nop 0
    s_cbranch_vccz rdvok_22
    v_sad_u8 v22, v22, 0, 0
    s_nop 1
    v_add_u32_dpp v22, v22, v22 quad_perm:[1,0,3,2] row_mask:0xf bank_mask:0xf
    v_cmp_ne_u32 vcc, 8, v22
    s_nop 0
    s_cbranch_vccnz rdvw_23
    s_mov_b32 s98, 1
    s_and_b32 s3, s97, 7
    s_barrier
    s_branch role_start
rdvw_23:
    s_sleep 4
    s_add_u32 s22, s22, 1
    s_cmp_lt_u32 s22, 262144
    s_cbranch_scc1 rdv_21
    s_mov_b32 s25, 200000
rdvok_22:
    v_and_b32 v22, 0x40404040, v21
    v_bcnt_u32_b32 v22, v22, 0
    s_mov_b32 s46, 0
    v_cmp_le_u32 vcc, 1, v22
    s_nop 0
    s_bcnt1_i32_b64 s21, vcc
    s_add_u32 s46, s46, s21
    v_cmp_le_u32 vcc, 2, v22
    s_nop 0
    s_bcnt1_i32_b64 s21, vcc
    s_add_u32 s46, s46, s21
    v_cmp_le_u32 vcc, 3, v22
    s_nop 0
    s_bcnt1_i32_b64 s21, vcc
    s_add_u32 s46, s46, s21
    v_cmp_le_u32 vcc, 4, v22
    s_nop 0
    s_bcnt1_i32_b64 s21, vcc
    s_add_u32 s46, s46, s21
    s_cmp_gt_u32 s46, 16
    s_cselect_b32 s46, 8192, 0
    s_add_u32 s84, s95, s46
    s_xor_b32 s45, s98, 1
    v_min_u32 v88, -2, v88
    v_min_u32 v89, -2, v89
    buffer_store_dwordx2 v[88:89], v11, s[4:7], s16 offen sc1
    v_mov_b32 v40, 0
    v_mov_b32 v41, 0
    v_mov_b32 v42, 0
    v_mov_b32 v43, 0
    v_mov_b32 v44, 0
    v_mov_b32 v45, 0
    v_mov_b32 v46, 0
    v_mov_b32 v47, 0
    v_mov_b32 v48, 0
    v_mov_b32 v49, 0
    v_mov_b32 v50, 0
    v_mov_b32 v51, 0
    v_mov_b32 v52, 0
    v_mov_b32 v53, 0
    v_mov_b32 v54, 0
    v_mov_b32 v55, 0
    v_mov_b32 v56, 0
    v_mov_b32 v57, 0
    v_mov_b32 v58, 0
    v_mov_b32 v59, 0
    v_mov_b32 v60, 0
    v_mov_b32 v61, 0
    v_mov_b32 v62, 0
    v_mov_b32 v63, 0
    v_mov_b32 v64, 0
    v_mov_b32 v65, 0
    v_mov_b32 v66, 0
    v_mov_b32 v67, 0
    v_mov_b32 v68, 0
    v_mov_b32 v69, 0
    v_mov_b32 v70, 0
    v_mov_b32 v71, 0
    s_cmp_ge_u32 s14, 2
    s_cbranch_scc1 kv_24
    s_mov_b32 s94, 1
    s_mov_b32 s23, s25
fw_26:
    s_cmp_ge_u32 s85, s94
    s_cbranch_scc1 fo_27
    buffer_load_dword v247, v245, s[4:7], 0 offen sc1
    s_add_u32 s23, s23, 1
    s_waitcnt vmcnt(0)
    v_readfirstlane_b32 s85, v247
    s_cmp_lt_u32 s23, 200000
    s_cbranch_scc1 fw_26
    s_mov_b32 s25, 200000
fo_27:
    s_cmp_eq_u32 s14, 1
    s_cbranch_scc1 kv_25
    buffer_load_dwordx4 v[132:135], v12, s[4:7], s17 offen sc1
    buffer_load_dwordx4 v[136:139], v12, s[4:7], s17 offen offset:256 sc1
    s_add_u32 s17, s17, 2048
    s_min_u32 s17, s17, 17954816
    s_branch kv_24
kv_25:
    buffer_load_dwordx4 v[228:231], v13, s[4:7], s18 offen offset:0 sc1
    buffer_load_dwordx4 v[232:235], v13, s[4:7], s18 offen offset:256 sc1
    s_add_u32 s18, s18, 2048
    s_min_u32 s18, s18, 35780608
kv_24:
    s_mov_b32 s23, s25
    s_barrier
    s_cmp_eq_u32 s45, 0
    s_cbranch_scc1 recur_slow_disp
    s_cmp_eq_u32 s14, 1
    s_cbranch_scc1 recur_fast_w1
    s_cmp_eq_u32 s14, 2
    s_cbranch_scc1 recur_fast_w2
    s_cmp_eq_u32 s14, 3
    s_cbranch_scc1 recur_fast_w3
    s_branch recur_fast_w0
recur_slow_disp:
    s_cmp_eq_u32 s14, 1
    s_cbranch_scc1 recur_slow_w1
    s_cmp_eq_u32 s14, 2
    s_cbranch_scc1 recur_slow_w2
    s_cmp_eq_u32 s14, 3
    s_cbranch_scc1 recur_slow_w3
    s_branch recur_slow_w0
.p2align 6
recur_fast_w0:
    s_nop 15
    s_mov_b32 s23, s25
    buffer_load_dwordx4 v[24:27], v2, s[4:7], s16 offen offset:0 sc1
    s_nop 11
    buffer_load_dwordx4 v[28:31], v2, s[4:7], s16 offen offset:1024 sc1
    s_nop 11
    buffer_load_dwordx4 v[32:35], v2, s[4:7], s16 offen offset:2048 sc1
    s_nop 11
    buffer_load_dwordx4 v[36:39], v2, s[4:7], s16 offen offset:3072 sc1
    s_waitcnt vmcnt(3)
    v_max3_u32 v19, v24, v25, v26
    v_max_u32 v19, v19, v27
    v_cmp_eq_u32 vcc, -1, v19
    s_nop 0
    s_cbranch_vccnz g_28F15_0
    v_smfmac_f32_16x16x64_bf16 v[40:43], v[24:27], a[0:7], v172
    s_waitcnt vmcnt(2)
    v_max3_u32 v19, v28, v29, v30
    v_max_u32 v19, v19, v31
    v_smfmac_f32_16x16x64_bf16 v[44:47], v[24:27], a[64:71], v172
    v_cmp_eq_u32 vcc, -1, v19
    v_smfmac_f32_16x16x64_bf16 v[48:51], v[24:27], a[32:39], v172
    v_smfmac_f32_16x16x64_bf16 v[52:55], v[24:27], a[96:103], v172
    s_cbranch_vccnz g_28F14_1
    v_smfmac_f32_16x16x64_bf16 v[40:43], v[28:31], a[8:15], v172
    s_waitcnt vmcnt(1)
    v_max3_u32 v19, v32, v33, v34
    v_max_u32 v19, v19, v35
    v_smfmac_f32_16x16x64_bf16 v[44:47], v[28:31], a[72:79], v172
    v_cmp_eq_u32 vcc, -1, v19
    v_smfmac_f32_16x16x64_bf16 v[48:51], v[28:31], a[40:47], v172
    v_smfmac_f32_16x16x64_bf16 v[52:55], v[28:31], a[104:111], v172
    s_cbranch_vccnz g_28F12_2
    v_smfmac_f32_16x16x64_bf16 v[40:43], v[32:35], a[16:23], v172
    s_waitcnt vmcnt(0)
    v_max3_u32 v19, v36, v37, v38
    v_max_u32 v19, v19, v39
    v_smfmac_f32_16x16x64_bf16 v[44:47], v[32:35], a[80:87], v172
    v_cmp_eq_u32 vcc, -1, v19
    v_smfmac_f32_16x16x64_bf16 v[48:51], v[32:35], a[48:55], v172
    v_smfmac_f32_16x16x64_bf16 v[52:55], v[32:35], a[112:119], v172
    s_cbranch_vccnz g_28F8_3
    v_smfmac_f32_16x16x64_bf16 v[40:43], v[36:39], a[24:31], v172
    v_smfmac_f32_16x16x64_bf16 v[44:47], v[36:39], a[88:95], v172
    v_smfmac_f32_16x16x64_bf16 v[48:51], v[36:39], a[56:63], v172
    v_smfmac_f32_16x16x64_bf16 v[52:55], v[36:39], a[120:127], v172
gc_29:
    v_cvt_pk_bf16_f32 v72, v40, v41
    v_cvt_pk_bf16_f32 v73, v42, v43
    v_cvt_pk_bf16_f32 v74, v44, v45
    v_cvt_pk_bf16_f32 v75, v46, v47
    v_smfmac_f32_16x16x64_bf16 v[56:59], v[24:27], a[128:135], v172
    v_cvt_pk_bf16_f32 v76, v48, v49
    v_cvt_pk_bf16_f32 v77, v50, v51
    s_nop 0
    v_cvt_pk_bf16_f32 v78, v52, v53
    v_cvt_pk_bf16_f32 v79, v54, v55
    v_smfmac_f32_16x16x64_bf16 v[60:63], v[24:27], a[160:167], v172
    v_mfma_f32_16x16x32_bf16 v[88:91], v[72:75], v[84:87], 0
    v_mfma_f32_16x16x32_bf16 v[92:95], v[76:79], v[84:87], 0
    v_smfmac_f32_16x16x64_bf16 v[56:59], v[28:31], a[136:143], v172
    v_smfmac_f32_16x16x64_bf16 v[60:63], v[28:31], a[168:175], v172
    s_barrier
    ds_read_b128 v[104:107], v16 offset:2048
    ds_read_b128 v[108:111], v16 offset:3072
    ds_read_b128 v[112:115], v16 offset:4096
    ds_read_b128 v[116:119], v16 offset:5120
    ds_read_b128 v[120:123], v16 offset:6144
    ds_read_b128 v[124:127], v16 offset:7168
    v_smfmac_f32_16x16x64_bf16 v[56:59], v[32:35], a[144:151], v172
    v_smfmac_f32_16x16x64_bf16 v[60:63], v[32:35], a[176:183], v172
    v_smfmac_f32_16x16x64_bf16 v[56:59], v[36:39], a[152:159], v172
    v_smfmac_f32_16x16x64_bf16 v[60:63], v[36:39], a[184:191], v172
    s_waitcnt lgkmcnt(5)
    v_mfma_f32_16x16x32_bf16 v[88:91], v[104:107], v[84:87], v[88:91]
    s_waitcnt lgkmcnt(4)
    v_mfma_f32_16x16x32_bf16 v[92:95], v[108:111], v[84:87], v[92:95]
    s_waitcnt lgkmcnt(3)
    v_mfma_f32_16x16x32_bf16 v[88:91], v[112:115], v[84:87], v[88:91]
    s_waitcnt lgkmcnt(2)
    v_mfma_f32_16x16x32_bf16 v[92:95], v[116:119], v[84:87], v[92:95]
    s_waitcnt lgkmcnt(1)
    v_mfma_f32_16x16x32_bf16 v[88:91], v[120:123], v[84:87], v[88:91]
    s_waitcnt lgkmcnt(0)
    v_mfma_f32_16x16x32_bf16 v[92:95], v[124:127], v[84:87], v[92:95]
    v_cvt_pk_bf16_f32 v80, v56, v57
    v_cvt_pk_bf16_f32 v81, v58, v59
    v_cvt_pk_bf16_f32 v82, v60, v61
    v_cvt_pk_bf16_f32 v83, v62, v63
    ds_write_b128 v17, v[80:83] offset:8192
    s_nop 0
    v_cvt_pk_bf16_f32 v128, v88, v89
    v_cvt_pk_bf16_f32 v129, v90, v91
    v_cvt_pk_bf16_f32 v130, v92, v93
    v_cvt_pk_bf16_f32 v131, v94, v95
    s_nop 1
    v_mfma_f32_16x16x32_bf16 v[144:147], v[132:135], v[128:131], 0
    v_mfma_f32_16x16x32_bf16 v[148:151], v[136:139], v[128:131], 0
    v_mfma_f32_16x16x32_bf16 v[140:143], v[128:131], v[128:131], 0
    s_nop 1
    buffer_store_dwordx4 v[144:147], v3, s[4:7], s16 offen
    s_nop 1
    buffer_store_dwordx4 v[148:151], v3, s[4:7], s16 offen offset:128
    s_nop 1
    buffer_store_dwordx4 v[140:143], v4, s[4:7], s16 offen
    s_cmp_eq_u32 s15, 63
    s_waitcnt lgkmcnt(0)
    s_barrier
    s_cbranch_scc1 recur_fast_last0
    v_readfirstlane_b32 s85, v247
    s_add_u32 s94, s15, 2
    s_barrier
    s_nop 15
    s_mov_b32 s23, s25
    buffer_load_dwordx4 v[24:27], v8, s[4:7], s16 offen offset:0 sc1
    s_nop 11
    buffer_load_dwordx4 v[28:31], v8, s[4:7], s16 offen offset:1024 sc1
    s_nop 11
    buffer_load_dwordx4 v[32:35], v8, s[4:7], s16 offen offset:2048 sc1
    s_nop 11
    buffer_load_dwordx4 v[36:39], v8, s[4:7], s16 offen offset:3072 sc1
    s_waitcnt vmcnt(3)
    v_max3_u32 v19, v24, v25, v26
    v_max_u32 v19, v19, v27
    v_cmp_eq_u32 vcc, -1, v19
    s_nop 0
    s_cbranch_vccnz g_30F15_0
    v_smfmac_f32_16x16x64_bf16 v[64:67], v[24:27], a[192:199], v172
    v_smfmac_f32_16x16x64_bf16 v[68:71], v[24:27], a[224:231], v172
    s_waitcnt vmcnt(2)
    v_max3_u32 v19, v28, v29, v30
    v_max_u32 v19, v19, v31
    v_cmp_eq_u32 vcc, -1, v19
    s_nop 0
    s_cbranch_vccnz g_30F14_1
    v_smfmac_f32_16x16x64_bf16 v[64:67], v[28:31], a[200:207], v172
    v_smfmac_f32_16x16x64_bf16 v[68:71], v[28:31], a[232:239], v172
    s_waitcnt vmcnt(1)
    v_max3_u32 v19, v32, v33, v34
    v_max_u32 v19, v19, v35
    v_cmp_eq_u32 vcc, -1, v19
    s_nop 0
    s_cbranch_vccnz g_30F12_2
    v_smfmac_f32_16x16x64_bf16 v[64:67], v[32:35], a[208:215], v172
    v_smfmac_f32_16x16x64_bf16 v[68:71], v[32:35], a[240:247], v172
    s_waitcnt vmcnt(0)
    v_max3_u32 v19, v36, v37, v38
    v_max_u32 v19, v19, v39
    v_cmp_eq_u32 vcc, -1, v19
    s_nop 0
    s_cbranch_vccnz g_30F8_3
    v_smfmac_f32_16x16x64_bf16 v[64:67], v[36:39], a[216:223], v172
    v_smfmac_f32_16x16x64_bf16 v[68:71], v[36:39], a[248:255], v172
    s_nop 4
    v_cvt_pk_bf16_f32 v80, v64, v65
    v_cvt_pk_bf16_f32 v81, v66, v67
    s_nop 0
    v_cvt_pk_bf16_f32 v82, v68, v69
    v_cvt_pk_bf16_f32 v83, v70, v71
    ds_write_b128 v17, v[80:83] offset:9216
gc_31:
    s_waitcnt lgkmcnt(0)
    s_barrier
    s_nop 15
    s_nop 15
    s_nop 15
    s_nop 15
    buffer_store_dwordx4 v[128:131], v14, s[4:7], s19 offen sc1
    s_add_u32 s19, s19, 512
    s_mov_b32 s23, s25
fw_32:
    s_cmp_ge_u32 s85, s94
    s_cbranch_scc1 fo_33
    buffer_load_dword v247, v245, s[4:7], 0 offen sc1
    s_add_u32 s23, s23, 1
    s_waitcnt vmcnt(0)
    v_readfirstlane_b32 s85, v247
    s_cmp_lt_u32 s23, 200000
    s_cbranch_scc1 fw_32
    s_mov_b32 s25, 200000
fo_33:
    buffer_load_dwordx4 v[132:135], v12, s[4:7], s17 offen sc1
    buffer_load_dwordx4 v[136:139], v12, s[4:7], s17 offen offset:256 sc1
    s_add_u32 s17, s17, 2048
    s_min_u32 s17, s17, 17954816
    buffer_load_dword v247, v245, s[4:7], 0 offen sc1
    v_mov_b32 v40, 0
    v_mov_b32 v41, 0
    v_mov_b32 v42, 0
    v_mov_b32 v43, 0
    v_mov_b32 v44, 0
    v_mov_b32 v45, 0
    v_mov_b32 v46, 0
    v_mov_b32 v47, 0
    v_mov_b32 v48, 0
    v_mov_b32 v49, 0
    v_mov_b32 v50, 0
    v_mov_b32 v51, 0
    v_mov_b32 v52, 0
    v_mov_b32 v53, 0
    v_mov_b32 v54, 0
    v_mov_b32 v55, 0
    v_mov_b32 v56, 0
    v_mov_b32 v57, 0
    v_mov_b32 v58, 0
    v_mov_b32 v59, 0
    v_mov_b32 v60, 0
    v_mov_b32 v61, 0
    v_mov_b32 v62, 0
    v_mov_b32 v63, 0
    v_mov_b32 v64, 0
    v_mov_b32 v65, 0
    v_mov_b32 v66, 0
    v_mov_b32 v67, 0
    v_mov_b32 v68, 0
    v_mov_b32 v69, 0
    v_mov_b32 v70, 0
    v_mov_b32 v71, 0
    s_mov_b32 s21, s16
    s_mov_b32 s16, s42
    s_mov_b32 s42, s43
    s_mov_b32 s43, s44
    s_mov_b32 s44, s21
    s_add_u32 s95, s95, 524288
    s_lshr_b32 s84, s95, 8
    s_and_b32 s84, s84, 8192
    s_xor_b32 s84, s84, s46
    s_add_u32 s84, s84, s95
    s_add_u32 s15, s15, 1
    s_barrier
    s_branch recur_fast_w0
g_28L15_0:
    s_waitcnt vmcnt(3)
    v_max3_u32 v19, v24, v25, v26
    v_max_u32 v19, v19, v27
    v_cmp_eq_u32 vcc, -1, v19
    s_nop 0
    s_cbranch_vccnz g_28F15_0
    v_smfmac_f32_16x16x64_bf16 v[40:43], v[24:27], a[0:7], v172
    v_smfmac_f32_16x16x64_bf16 v[44:47], v[24:27], a[64:71], v172
    v_smfmac_f32_16x16x64_bf16 v[48:51], v[24:27], a[32:39], v172
    v_smfmac_f32_16x16x64_bf16 v[52:55], v[24:27], a[96:103], v172
g_28L14_1:
    s_waitcnt vmcnt(2)
    v_max3_u32 v19, v28, v29, v30
    v_max_u32 v19, v19, v31
    v_cmp_eq_u32 vcc, -1, v19
    s_nop 0
    s_cbranch_vccnz g_28F14_1
    v_smfmac_f32_16x16x64_bf16 v[40:43], v[28:31], a[8:15], v172
    v_smfmac_f32_16x16x64_bf16 v[44:47], v[28:31], a[72:79], v172
    v_smfmac_f32_16x16x64_bf16 v[48:51], v[28:31], a[40:47], v172
    v_smfmac_f32_16x16x64_bf16 v[52:55], v[28:31], a[104:111], v172
g_28L12_2:
    s_waitcnt vmcnt(1)
    v_max3_u32 v19, v32, v33, v34
    v_max_u32 v19, v19, v35
    v_cmp_eq_u32 vcc, -1, v19
    s_nop 0
    s_cbranch_vccnz g_28F12_2
    v_smfmac_f32_16x16x64_bf16 v[40:43], v[32:35], a[16:23], v172
    v_smfmac_f32_16x16x64_bf16 v[44:47], v[32:35], a[80:87], v172
    v_smfmac_f32_16x16x64_bf16 v[48:51], v[32:35], a[48:55], v172
    v_smfmac_f32_16x16x64_bf16 v[52:55], v[32:35], a[112:119], v172
g_28L8_3:
    s_waitcnt vmcnt(0)
    v_max3_u32 v19, v36, v37, v38
    v_max_u32 v19, v19, v39
    v_cmp_eq_u32 vcc, -1, v19
    s_nop 0
    s_cbranch_vccnz g_28F8_3
    v_smfmac_f32_16x16x64_bf16 v[40:43], v[36:39], a[24:31], v172
    v_smfmac_f32_16x16x64_bf16 v[44:47], v[36:39], a[88:95], v172
    v_smfmac_f32_16x16x64_bf16 v[48:51], v[36:39], a[56:63], v172
    v_smfmac_f32_16x16x64_bf16 v[52:55], v[36:39], a[120:127], v172
    s_branch gc_29
g_28L15_1:
    s_waitcnt vmcnt(3)
    v_max3_u32 v19, v28, v29, v30
    v_max_u32 v19, v19, v31
    v_cmp_eq_u32 vcc, -1, v19
    s_nop 0
    s_cbranch_vccnz g_28F15_1
    v_smfmac_f32_16x16x64_bf16 v[40:43], v[28:31], a[8:15], v172
    v_smfmac_f32_16x16x64_bf16 v[44:47], v[28:31], a[72:79], v172
    v_smfmac_f32_16x16x64_bf16 v[48:51], v[28:31], a[40:47], v172
    v_smfmac_f32_16x16x64_bf16 v[52:55], v[28:31], a[104:111], v172
g_28L13_2:
    s_waitcnt vmcnt(2)
    v_max3_u32 v19, v32, v33, v34
    v_max_u32 v19, v19, v35
    v_cmp_eq_u32 vcc, -1, v19
    s_nop 0
    s_cbranch_vccnz g_28F13_2
    v_smfmac_f32_16x16x64_bf16 v[40:43], v[32:35], a[16:23], v172
    v_smfmac_f32_16x16x64_bf16 v[44:47], v[32:35], a[80:87], v172
    v_smfmac_f32_16x16x64_bf16 v[48:51], v[32:35], a[48:55], v172
    v_smfmac_f32_16x16x64_bf16 v[52:55], v[32:35], a[112:119], v172
g_28L9_3:
    s_waitcnt vmcnt(1)
    v_max3_u32 v19, v36, v37, v38
    v_max_u32 v19, v19, v39
    v_cmp_eq_u32 vcc, -1, v19
    s_nop 0
    s_cbranch_vccnz g_28F9_3
    v_smfmac_f32_16x16x64_bf16 v[40:43], v[36:39], a[24:31], v172
    v_smfmac_f32_16x16x64_bf16 v[44:47], v[36:39], a[88:95], v172
    v_smfmac_f32_16x16x64_bf16 v[48:51], v[36:39], a[56:63], v172
    v_smfmac_f32_16x16x64_bf16 v[52:55], v[36:39], a[120:127], v172
g_28L1_0:
    s_waitcnt vmcnt(0)
    v_max3_u32 v19, v24, v25, v26
    v_max_u32 v19, v19, v27
    v_cmp_eq_u32 vcc, -1, v19
    s_nop 0
    s_cbranch_vccnz g_28F1_0
    v_smfmac_f32_16x16x64_bf16 v[40:43], v[24:27], a[0:7], v172
    v_smfmac_f32_16x16x64_bf16 v[44:47], v[24:27], a[64:71], v172
    v_smfmac_f32_16x16x64_bf16 v[48:51], v[24:27], a[32:39], v172
    v_smfmac_f32_16x16x64_bf16 v[52:55], v[24:27], a[96:103], v172
    s_branch gc_29
g_28L15_2:
    s_waitcnt vmcnt(3)
    v_max3_u32 v19, v32, v33, v34
    v_max_u32 v19, v19, v35
    v_cmp_eq_u32 vcc, -1, v19
    s_nop 0
    s_cbranch_vccnz g_28F15_2
    v_smfmac_f32_16x16x64_bf16 v[40:43], v[32:35], a[16:23], v172
    v_smfmac_f32_16x16x64_bf16 v[44:47], v[32:35], a[80:87], v172
    v_smfmac_f32_16x16x64_bf16 v[48:51], v[32:35], a[48:55], v172
    v_smfmac_f32_16x16x64_bf16 v[52:55], v[32:35], a[112:119], v172
g_28L11_3:
    s_waitcnt vmcnt(2)
    v_max3_u32 v19, v36, v37, v38
    v_max_u32 v19, v19, v39
    v_cmp_eq_u32 vcc, -1, v19
    s_nop 0
    s_cbranch_vccnz g_28F11_3
    v_smfmac_f32_16x16x64_bf16 v[40:43], v[36:39], a[24:31], v172
    v_smfmac_f32_16x16x64_bf16 v[44:47], v[36:39], a[88:95], v172
    v_smfmac_f32_16x16x64_bf16 v[48:51], v[36:39], a[56:63], v172
    v_smfmac_f32_16x16x64_bf16 v[52:55], v[36:39], a[120:127], v172
g_28L3_0:
    s_waitcnt vmcnt(1)
    v_max3_u32 v19, v24, v25, v26
    v_max_u32 v19, v19, v27
    v_cmp_eq_u32 vcc, -1, v19
    s_nop 0
    s_cbranch_vccnz g_28F3_0
    v_smfmac_f32_16x16x64_bf16 v[40:43], v[24:27], a[0:7], v172
    v_smfmac_f32_16x16x64_bf16 v[44:47], v[24:27], a[64:71], v172
    v_smfmac_f32_16x16x64_bf16 v[48:51], v[24:27], a[32:39], v172
    v_smfmac_f32_16x16x64_bf16 v[52:55], v[24:27], a[96:103], v172
g_28L2_1:
    s_waitcnt vmcnt(0)
    v_max3_u32 v19, v28, v29, v30
    v_max_u32 v19, v19, v31
    v_cmp_eq_u32 vcc, -1, v19
    s_nop 0
    s_cbranch_vccnz g_28F2_1
    v_smfmac_f32_16x16x64_bf16 v[40:43], v[28:31], a[8:15], v172
    v_smfmac_f32_16x16x64_bf16 v[44:47], v[28:31], a[72:79], v172
    v_smfmac_f32_16x16x64_bf16 v[48:51], v[28:31], a[40:47], v172
    v_smfmac_f32_16x16x64_bf16 v[52:55], v[28:31], a[104:111], v172
    s_branch gc_29
g_28L15_3:
    s_waitcnt vmcnt(3)
    v_max3_u32 v19, v36, v37, v38
    v_max_u32 v19, v19, v39
    v_cmp_eq_u32 vcc, -1, v19
    s_nop 0
    s_cbranch_vccnz g_28F15_3
    v_smfmac_f32_16x16x64_bf16 v[40:43], v[36:39], a[24:31], v172
    v_smfmac_f32_16x16x64_bf16 v[44:47], v[36:39], a[88:95], v172
    v_smfmac_f32_16x16x64_bf16 v[48:51], v[36:39], a[56:63], v172
    v_smfmac_f32_16x16x64_bf16 v[52:55], v[36:39], a[120:127], v172
g_28L7_0:
    s_waitcnt vmcnt(2)
    v_max3_u32 v19, v24, v25, v26
    v_max_u32 v19, v19, v27
    v_cmp_eq_u32 vcc, -1, v19
    s_nop 0
    s_cbranch_vccnz g_28F7_0
    v_smfmac_f32_16x16x64_bf16 v[40:43], v[24:27], a[0:7], v172
    v_smfmac_f32_16x16x64_bf16 v[44:47], v[24:27], a[64:71], v172
    v_smfmac_f32_16x16x64_bf16 v[48:51], v[24:27], a[32:39], v172
    v_smfmac_f32_16x16x64_bf16 v[52:55], v[24:27], a[96:103], v172
g_28L6_1:
    s_waitcnt vmcnt(1)
    v_max3_u32 v19, v28, v29, v30
    v_max_u32 v19, v19, v31
    v_cmp_eq_u32 vcc, -1, v19
    s_nop 0
    s_cbranch_vccnz g_28F6_1
    v_smfmac_f32_16x16x64_bf16 v[40:43], v[28:31], a[8:15], v172
    v_smfmac_f32_16x16x64_bf16 v[44:47], v[28:31], a[72:79], v172
    v_smfmac_f32_16x16x64_bf16 v[48:51], v[28:31], a[40:47], v172
    v_smfmac_f32_16x16x64_bf16 v[52:55], v[28:31], a[104:111], v172
g_28L4_2:
    s_waitcnt vmcnt(0)
    v_max3_u32 v19, v32, v33, v34
    v_max_u32 v19, v19, v35
    v_cmp_eq_u32 vcc, -1, v19
    s_nop 0
    s_cbranch_vccnz g_28F4_2
    v_smfmac_f32_16x16x64_bf16 v[40:43], v[32:35], a[16:23], v172
    v_smfmac_f32_16x16x64_bf16 v[44:47], v[32:35], a[80:87], v172
    v_smfmac_f32_16x16x64_bf16 v[48:51], v[32:35], a[48:55], v172
    v_smfmac_f32_16x16x64_bf16 v[52:55], v[32:35], a[112:119], v172
    s_branch gc_29
g_28L7_1:
    s_waitcnt vmcnt(2)
    v_max3_u32 v19, v28, v29, v30
    v_max_u32 v19, v19, v31
    v_cmp_eq_u32 vcc, -1, v19
    s_nop 0
    s_cbranch_vccnz g_28F7_1
    v_smfmac_f32_16x16x64_bf16 v[40:43], v[28:31], a[8:15], v172
    v_smfmac_f32_16x16x64_bf16 v[44:47], v[28:31], a[72:79], v172
    v_smfmac_f32_16x16x64_bf16 v[48:51], v[28:31], a[40:47], v172
    v_smfmac_f32_16x16x64_bf16 v[52:55], v[28:31], a[104:111], v172
g_28L5_2:
    s_waitcnt vmcnt(1)
    v_max3_u32 v19, v32, v33, v34
    v_max_u32 v19, v19, v35
    v_cmp_eq_u32 vcc, -1, v19
    s_nop 0
    s_cbranch_vccnz g_28F5_2
    v_smfmac_f32_16x16x64_bf16 v[40:43], v[32:35], a[16:23], v172
    v_smfmac_f32_16x16x64_bf16 v[44:47], v[32:35], a[80:87], v172
    v_smfmac_f32_16x16x64_bf16 v[48:51], v[32:35], a[48:55], v172
    v_smfmac_f32_16x16x64_bf16 v[52:55], v[32:35], a[112:119], v172
    s_branch g_28L1_0
g_28L7_2:
    s_waitcnt vmcnt(2)
    v_max3_u32 v19, v32, v33, v34
    v_max_u32 v19, v19, v35
    v_cmp_eq_u32 vcc, -1, v19
    s_nop 0
    s_cbranch_vccnz g_28F7_2
    v_smfmac_f32_16x16x64_bf16 v[40:43], v[32:35], a[16:23], v172
    v_smfmac_f32_16x16x64_bf16 v[44:47], v[32:35], a[80:87], v172
    v_smfmac_f32_16x16x64_bf16 v[48:51], v[32:35], a[48:55], v172
    v_smfmac_f32_16x16x64_bf16 v[52:55], v[32:35], a[112:119], v172
    s_branch g_28L3_0
g_28L11_0:
    s_waitcnt vmcnt(2)
    v_max3_u32 v19, v24, v25, v26
    v_max_u32 v19, v19, v27
    v_cmp_eq_u32 vcc, -1, v19
    s_nop 0
    s_cbranch_vccnz g_28F11_0
    v_smfmac_f32_16x16x64_bf16 v[40:43], v[24:27], a[0:7], v172
    v_smfmac_f32_16x16x64_bf16 v[44:47], v[24:27], a[64:71], v172
    v_smfmac_f32_16x16x64_bf16 v[48:51], v[24:27], a[32:39], v172
    v_smfmac_f32_16x16x64_bf16 v[52:55], v[24:27], a[96:103], v172
g_28L10_1:
    s_waitcnt vmcnt(1)
    v_max3_u32 v19, v28, v29, v30
    v_max_u32 v19, v19, v31
    v_cmp_eq_u32 vcc, -1, v19
    s_nop 0
    s_cbranch_vccnz g_28F10_1
    v_smfmac_f32_16x16x64_bf16 v[40:43], v[28:31], a[8:15], v172
    v_smfmac_f32_16x16x64_bf16 v[44:47], v[28:31], a[72:79], v172
    v_smfmac_f32_16x16x64_bf16 v[48:51], v[28:31], a[40:47], v172
    v_smfmac_f32_16x16x64_bf16 v[52:55], v[28:31], a[104:111], v172
    s_branch g_28L8_3
g_28L11_1:
    s_waitcnt vmcnt(2)
    v_max3_u32 v19, v28, v29, v30
    v_max_u32 v19, v19, v31
    v_cmp_eq_u32 vcc, -1, v19
    s_nop 0
    s_cbranch_vccnz g_28F11_1
    v_smfmac_f32_16x16x64_bf16 v[40:43], v[28:31], a[8:15], v172
    v_smfmac_f32_16x16x64_bf16 v[44:47], v[28:31], a[72:79], v172
    v_smfmac_f32_16x16x64_bf16 v[48:51], v[28:31], a[40:47], v172
    v_smfmac_f32_16x16x64_bf16 v[52:55], v[28:31], a[104:111], v172
    s_branch g_28L9_3
g_28L13_0:
    s_waitcnt vmcnt(2)
    v_max3_u32 v19, v24, v25, v26
    v_max_u32 v19, v19, v27
    v_cmp_eq_u32 vcc, -1, v19
    s_nop 0
    s_cbranch_vccnz g_28F13_0
    v_smfmac_f32_16x16x64_bf16 v[40:43], v[24:27], a[0:7], v172
    v_smfmac_f32_16x16x64_bf16 v[44:47], v[24:27], a[64:71], v172
    v_smfmac_f32_16x16x64_bf16 v[48:51], v[24:27], a[32:39], v172
    v_smfmac_f32_16x16x64_bf16 v[52:55], v[24:27], a[96:103], v172
    s_branch g_28L12_2
g_28L13_3:
    s_waitcnt vmcnt(2)
    v_max3_u32 v19, v36, v37, v38
    v_max_u32 v19, v19, v39
    v_cmp_eq_u32 vcc, -1, v19
    s_nop 0
    s_cbranch_vccnz g_28F13_3
    v_smfmac_f32_16x16x64_bf16 v[40:43], v[36:39], a[24:31], v172
    v_smfmac_f32_16x16x64_bf16 v[44:47], v[36:39], a[88:95], v172
    v_smfmac_f32_16x16x64_bf16 v[48:51], v[36:39], a[56:63], v172
    v_smfmac_f32_16x16x64_bf16 v[52:55], v[36:39], a[120:127], v172
g_28L5_0:
    s_waitcnt vmcnt(1)
    v_max3_u32 v19, v24, v25, v26
    v_max_u32 v19, v19, v27
    v_cmp_eq_u32 vcc, -1, v19
    s_nop 0
    s_cbranch_vccnz g_28F5_0
    v_smfmac_f32_16x16x64_bf16 v[40:43], v[24:27], a[0:7], v172
    v_smfmac_f32_16x16x64_bf16 v[44:47], v[24:27], a[64:71], v172
    v_smfmac_f32_16x16x64_bf16 v[48:51], v[24:27], a[32:39], v172
    v_smfmac_f32_16x16x64_bf16 v[52:55], v[24:27], a[96:103], v172
    s_branch g_28L4_2
g_28L14_2:
    s_waitcnt vmcnt(2)
    v_max3_u32 v19, v32, v33, v34
    v_max_u32 v19, v19, v35
    v_cmp_eq_u32 vcc, -1, v19
    s_nop 0
    s_cbranch_vccnz g_28F14_2
    v_smfmac_f32_16x16x64_bf16 v[40:43], v[32:35], a[16:23], v172
    v_smfmac_f32_16x16x64_bf16 v[44:47], v[32:35], a[80:87], v172
    v_smfmac_f32_16x16x64_bf16 v[48:51], v[32:35], a[48:55], v172
    v_smfmac_f32_16x16x64_bf16 v[52:55], v[32:35], a[112:119], v172
g_28L10_3:
    s_waitcnt vmcnt(1)
    v_max3_u32 v19, v36, v37, v38
    v_max_u32 v19, v19, v39
    v_cmp_eq_u32 vcc, -1, v19
    s_nop 0
    s_cbranch_vccnz g_28F10_3
    v_smfmac_f32_16x16x64_bf16 v[40:43], v[36:39], a[24:31], v172
    v_smfmac_f32_16x16x64_bf16 v[44:47], v[36:39], a[88:95], v172
    v_smfmac_f32_16x16x64_bf16 v[48:51], v[36:39], a[56:63], v172
    v_smfmac_f32_16x16x64_bf16 v[52:55], v[36:39], a[120:127], v172
    s_branch g_28L2_1
g_28L14_3:
    s_waitcnt vmcnt(2)
    v_max3_u32 v19, v36, v37, v38
    v_max_u32 v19, v19, v39
    v_cmp_eq_u32 vcc, -1, v19
    s_nop 0
    s_cbranch_vccnz g_28F14_3
    v_smfmac_f32_16x16x64_bf16 v[40:43], v[36:39], a[24:31], v172
    v_smfmac_f32_16x16x64_bf16 v[44:47], v[36:39], a[88:95], v172
    v_smfmac_f32_16x16x64_bf16 v[48:51], v[36:39], a[56:63], v172
    v_smfmac_f32_16x16x64_bf16 v[52:55], v[36:39], a[120:127], v172
    s_branch g_28L6_1
g_28L3_1:
    s_waitcnt vmcnt(1)
    v_max3_u32 v19, v28, v29, v30
    v_max_u32 v19, v19, v31
    v_cmp_eq_u32 vcc, -1, v19
    s_nop 0
    s_cbranch_vccnz g_28F3_1
    v_smfmac_f32_16x16x64_bf16 v[40:43], v[28:31], a[8:15], v172
    v_smfmac_f32_16x16x64_bf16 v[44:47], v[28:31], a[72:79], v172
    v_smfmac_f32_16x16x64_bf16 v[48:51], v[28:31], a[40:47], v172
    v_smfmac_f32_16x16x64_bf16 v[52:55], v[28:31], a[104:111], v172
    s_branch g_28L1_0
g_28L6_2:
    s_waitcnt vmcnt(1)
    v_max3_u32 v19, v32, v33, v34
    v_max_u32 v19, v19, v35
    v_cmp_eq_u32 vcc, -1, v19
    s_nop 0
    s_cbranch_vccnz g_28F6_2
    v_smfmac_f32_16x16x64_bf16 v[40:43], v[32:35], a[16:23], v172
    v_smfmac_f32_16x16x64_bf16 v[44:47], v[32:35], a[80:87], v172
    v_smfmac_f32_16x16x64_bf16 v[48:51], v[32:35], a[48:55], v172
    v_smfmac_f32_16x16x64_bf16 v[52:55], v[32:35], a[112:119], v172
    s_branch g_28L2_1
g_28L9_0:
    s_waitcnt vmcnt(1)
    v_max3_u32 v19, v24, v25, v26
    v_max_u32 v19, v19, v27
    v_cmp_eq_u32 vcc, -1, v19
    s_nop 0
    s_cbranch_vccnz g_28F9_0
    v_smfmac_f32_16x16x64_bf16 v[40:43], v[24:27], a[0:7], v172
    v_smfmac_f32_16x16x64_bf16 v[44:47], v[24:27], a[64:71], v172
    v_smfmac_f32_16x16x64_bf16 v[48:51], v[24:27], a[32:39], v172
    v_smfmac_f32_16x16x64_bf16 v[52:55], v[24:27], a[96:103], v172
    s_branch g_28L8_3
g_28L12_3:
    s_waitcnt vmcnt(1)
    v_max3_u32 v19, v36, v37, v38
    v_max_u32 v19, v19, v39
    v_cmp_eq_u32 vcc, -1, v19
    s_nop 0
    s_cbranch_vccnz g_28F12_3
    v_smfmac_f32_16x16x64_bf16 v[40:43], v[36:39], a[24:31], v172
    v_smfmac_f32_16x16x64_bf16 v[44:47], v[36:39], a[88:95], v172
    v_smfmac_f32_16x16x64_bf16 v[48:51], v[36:39], a[56:63], v172
    v_smfmac_f32_16x16x64_bf16 v[52:55], v[36:39], a[120:127], v172
    s_branch g_28L4_2
g_28F15_0:
    s_mov_b64 exec, vcc
    buffer_load_dwordx4 v[24:27], v2, s[4:7], s16 offen offset:0 sc1
    s_mov_b64 exec, -1
    s_add_u32 s23, s23, 1
    s_cmp_lt_u32 s23, 200000
    s_cbranch_scc1 g_28L15_1
    s_mov_b32 s25, 200000
    s_branch gc_29
g_28F15_1:
    s_mov_b64 exec, vcc
    buffer_load_dwordx4 v[28:31], v2, s[4:7], s16 offen offset:1024 sc1
    s_mov_b64 exec, -1
    s_add_u32 s23, s23, 1
    s_cmp_lt_u32 s23, 200000
    s_cbranch_scc1 g_28L15_2
    s_mov_b32 s25, 200000
    s_branch gc_29
g_28F15_2:
    s_mov_b64 exec, vcc
    buffer_load_dwordx4 v[32:35], v2, s[4:7], s16 offen offset:2048 sc1
    s_mov_b64 exec, -1
    s_add_u32 s23, s23, 1
    s_cmp_lt_u32 s23, 200000
    s_cbranch_scc1 g_28L15_3
    s_mov_b32 s25, 200000
    s_branch gc_29
g_28F15_3:
    s_mov_b64 exec, vcc
    buffer_load_dwordx4 v[36:39], v2, s[4:7], s16 offen offset:3072 sc1
    s_mov_b64 exec, -1
    s_add_u32 s23, s23, 1
    s_cmp_lt_u32 s23, 200000
    s_cbranch_scc1 g_28L15_0
    s_mov_b32 s25, 200000
    s_branch gc_29
g_28F7_0:
    s_mov_b64 exec, vcc
    buffer_load_dwordx4 v[24:27], v2, s[4:7], s16 offen offset:0 sc1
    s_mov_b64 exec, -1
    s_add_u32 s23, s23, 1
    s_cmp_lt_u32 s23, 200000
    s_cbranch_scc1 g_28L7_1
    s_mov_b32 s25, 200000
    s_branch gc_29
g_28F7_1:
    s_mov_b64 exec, vcc
    buffer_load_dwordx4 v[28:31], v2, s[4:7], s16 offen offset:1024 sc1
    s_mov_b64 exec, -1
    s_add_u32 s23, s23, 1
    s_cmp_lt_u32 s23, 200000
    s_cbranch_scc1 g_28L7_2
    s_mov_b32 s25, 200000
    s_branch gc_29
g_28F7_2:
    s_mov_b64 exec, vcc
    buffer_load_dwordx4 v[32:35], v2, s[4:7], s16 offen offset:2048 sc1
    s_mov_b64 exec, -1
    s_add_u32 s23, s23, 1
    s_cmp_lt_u32 s23, 200000
    s_cbranch_scc1 g_28L7_0
    s_mov_b32 s25, 200000
    s_branch gc_29
g_28F11_0:
    s_mov_b64 exec, vcc
    buffer_load_dwordx4 v[24:27], v2, s[4:7], s16 offen offset:0 sc1
    s_mov_b64 exec, -1
    s_add_u32 s23, s23, 1
    s_cmp_lt_u32 s23, 200000
    s_cbranch_scc1 g_28L11_1
    s_mov_b32 s25, 200000
    s_branch gc_29
g_28F11_1:
    s_mov_b64 exec, vcc
    buffer_load_dwordx4 v[28:31], v2, s[4:7], s16 offen offset:1024 sc1
    s_mov_b64 exec, -1
    s_add_u32 s23, s23, 1
    s_cmp_lt_u32 s23, 200000
    s_cbranch_scc1 g_28L11_3
    s_mov_b32 s25, 200000
    s_branch gc_29
g_28F11_3:
    s_mov_b64 exec, vcc
    buffer_load_dwordx4 v[36:39], v2, s[4:7], s16 offen offset:3072 sc1
    s_mov_b64 exec, -1
    s_add_u32 s23, s23, 1
    s_cmp_lt_u32 s23, 200000
    s_cbranch_scc1 g_28L11_0
    s_mov_b32 s25, 200000
    s_branch gc_29
g_28F13_0:
    s_mov_b64 exec, vcc
    buffer_load_dwordx4 v[24:27], v2, s[4:7], s16 offen offset:0 sc1
    s_mov_b64 exec, -1
    s_add_u32 s23, s23, 1
    s_cmp_lt_u32 s23, 200000
    s_cbranch_scc1 g_28L13_2
    s_mov_b32 s25, 200000
    s_branch gc_29
g_28F13_2:
    s_mov_b64 exec, vcc
    buffer_load_dwordx4 v[32:35], v2, s[4:7], s16 offen offset:2048 sc1
    s_mov_b64 exec, -1
    s_add_u32 s23, s23, 1
    s_cmp_lt_u32 s23, 200000
    s_cbranch_scc1 g_28L13_3
    s_mov_b32 s25, 200000
    s_branch gc_29
g_28F13_3:
    s_mov_b64 exec, vcc
    buffer_load_dwordx4 v[36:39], v2, s[4:7], s16 offen offset:3072 sc1
    s_mov_b64 exec, -1
    s_add_u32 s23, s23, 1
    s_cmp_lt_u32 s23, 200000
    s_cbranch_scc1 g_28L13_0
    s_mov_b32 s25, 200000
    s_branch gc_29
g_28F14_1:
    s_mov_b64 exec, vcc
    buffer_load_dwordx4 v[28:31], v2, s[4:7], s16 offen offset:1024 sc1
    s_mov_b64 exec, -1
    s_add_u32 s23, s23, 1
    s_cmp_lt_u32 s23, 200000
    s_cbranch_scc1 g_28L14_2
    s_mov_b32 s25, 200000
    s_branch gc_29
g_28F14_2:
    s_mov_b64 exec, vcc
    buffer_load_dwordx4 v[32:35], v2, s[4:7], s16 offen offset:2048 sc1
    s_mov_b64 exec, -1
    s_add_u32 s23, s23, 1
    s_cmp_lt_u32 s23, 200000
    s_cbranch_scc1 g_28L14_3
    s_mov_b32 s25, 200000
    s_branch gc_29
g_28F14_3:
    s_mov_b64 exec, vcc
    buffer_load_dwordx4 v[36:39], v2, s[4:7], s16 offen offset:3072 sc1
    s_mov_b64 exec, -1
    s_add_u32 s23, s23, 1
    s_cmp_lt_u32 s23, 200000
    s_cbranch_scc1 g_28L14_1
    s_mov_b32 s25, 200000
    s_branch gc_29
g_28F3_0:
    s_mov_b64 exec, vcc
    buffer_load_dwordx4 v[24:27], v2, s[4:7], s16 offen offset:0 sc1
    s_mov_b64 exec, -1
    s_add_u32 s23, s23, 1
    s_cmp_lt_u32 s23, 200000
    s_cbranch_scc1 g_28L3_1
    s_mov_b32 s25, 200000
    s_branch gc_29
g_28F3_1:
    s_mov_b64 exec, vcc
    buffer_load_dwordx4 v[28:31], v2, s[4:7], s16 offen offset:1024 sc1
    s_mov_b64 exec, -1
    s_add_u32 s23, s23, 1
    s_cmp_lt_u32 s23, 200000
    s_cbranch_scc1 g_28L3_0
    s_mov_b32 s25, 200000
    s_branch gc_29
g_28F5_0:
    s_mov_b64 exec, vcc
    buffer_load_dwordx4 v[24:27], v2, s[4:7], s16 offen offset:0 sc1
    s_mov_b64 exec, -1
    s_add_u32 s23, s23, 1
    s_cmp_lt_u32 s23, 200000
    s_cbranch_scc1 g_28L5_2
    s_mov_b32 s25, 200000
    s_branch gc_29
g_28F5_2:
    s_mov_b64 exec, vcc
    buffer_load_dwordx4 v[32:35], v2, s[4:7], s16 offen offset:2048 sc1
    s_mov_b64 exec, -1
    s_add_u32 s23, s23, 1
    s_cmp_lt_u32 s23, 200000
    s_cbranch_scc1 g_28L5_0
    s_mov_b32 s25, 200000
    s_branch gc_29
g_28F6_1:
    s_mov_b64 exec, vcc
    buffer_load_dwordx4 v[28:31], v2, s[4:7], s16 offen offset:1024 sc1
    s_mov_b64 exec, -1
    s_add_u32 s23, s23, 1
    s_cmp_lt_u32 s23, 200000
    s_cbranch_scc1 g_28L6_2
    s_mov_b32 s25, 200000
    s_branch gc_29
g_28F6_2:
    s_mov_b64 exec, vcc
    buffer_load_dwordx4 v[32:35], v2, s[4:7], s16 offen offset:2048 sc1
    s_mov_b64 exec, -1
    s_add_u32 s23, s23, 1
    s_cmp_lt_u32 s23, 200000
    s_cbranch_scc1 g_28L6_1
    s_mov_b32 s25, 200000
    s_branch gc_29
g_28F9_0:
    s_mov_b64 exec, vcc
    buffer_load_dwordx4 v[24:27], v2, s[4:7], s16 offen offset:0 sc1
    s_mov_b64 exec, -1
    s_add_u32 s23, s23, 1
    s_cmp_lt_u32 s23, 200000
    s_cbranch_scc1 g_28L9_3
    s_mov_b32 s25, 200000
    s_branch gc_29
g_28F9_3:
    s_mov_b64 exec, vcc
    buffer_load_dwordx4 v[36:39], v2, s[4:7], s16 offen offset:3072 sc1
    s_mov_b64 exec, -1
    s_add_u32 s23, s23, 1
    s_cmp_lt_u32 s23, 200000
    s_cbranch_scc1 g_28L9_0
    s_mov_b32 s25, 200000
    s_branch gc_29
g_28F10_1:
    s_mov_b64 exec, vcc
    buffer_load_dwordx4 v[28:31], v2, s[4:7], s16 offen offset:1024 sc1
    s_mov_b64 exec, -1
    s_add_u32 s23, s23, 1
    s_cmp_lt_u32 s23, 200000
    s_cbranch_scc1 g_28L10_3
    s_mov_b32 s25, 200000
    s_branch gc_29
g_28F10_3:
    s_mov_b64 exec, vcc
    buffer_load_dwordx4 v[36:39], v2, s[4:7], s16 offen offset:3072 sc1
    s_mov_b64 exec, -1
    s_add_u32 s23, s23, 1
    s_cmp_lt_u32 s23, 200000
    s_cbranch_scc1 g_28L10_1
    s_mov_b32 s25, 200000
    s_branch gc_29
g_28F12_2:
    s_mov_b64 exec, vcc
    buffer_load_dwordx4 v[32:35], v2, s[4:7], s16 offen offset:2048 sc1
    s_mov_b64 exec, -1
    s_add_u32 s23, s23, 1
    s_cmp_lt_u32 s23, 200000
    s_cbranch_scc1 g_28L12_3
    s_mov_b32 s25, 200000
    s_branch gc_29
g_28F12_3:
    s_mov_b64 exec, vcc
    buffer_load_dwordx4 v[36:39], v2, s[4:7], s16 offen offset:3072 sc1
    s_mov_b64 exec, -1
    s_add_u32 s23, s23, 1
    s_cmp_lt_u32 s23, 200000
    s_cbranch_scc1 g_28L12_2
    s_mov_b32 s25, 200000
    s_branch gc_29
g_28F1_0:
    s_mov_b64 exec, vcc
    buffer_load_dwordx4 v[24:27], v2, s[4:7], s16 offen offset:0 sc1
    s_mov_b64 exec, -1
    s_add_u32 s23, s23, 1
    s_cmp_lt_u32 s23, 200000
    s_cbranch_scc1 g_28L1_0
    s_mov_b32 s25, 200000
    s_branch gc_29
g_28F2_1:
    s_mov_b64 exec, vcc
    buffer_load_dwordx4 v[28:31], v2, s[4:7], s16 offen offset:1024 sc1
    s_mov_b64 exec, -1
    s_add_u32 s23, s23, 1
    s_cmp_lt_u32 s23, 200000
    s_cbranch_scc1 g_28L2_1
    s_mov_b32 s25, 200000
    s_branch gc_29
g_28F4_2:
    s_mov_b64 exec, vcc
    buffer_load_dwordx4 v[32:35], v2, s[4:7], s16 offen offset:2048 sc1
    s_mov_b64 exec, -1
    s_add_u32 s23, s23, 1
    s_cmp_lt_u32 s23, 200000
    s_cbranch_scc1 g_28L4_2
    s_mov_b32 s25, 200000
    s_branch gc_29
g_28F8_3:
    s_mov_b64 exec, vcc
    buffer_load_dwordx4 v[36:39], v2, s[4:7], s16 offen offset:3072 sc1
    s_mov_b64 exec, -1
    s_add_u32 s23, s23, 1
    s_cmp_lt_u32 s23, 200000
    s_cbranch_scc1 g_28L8_3
    s_mov_b32 s25, 200000
    s_branch gc_29
recur_fast_last0:
    buffer_store_dwordx4 v[128:131], v14, s[4:7], s19 offen sc1
    s_waitcnt vmcnt(0)
    s_branch recur_end
g_30L15_0:
    s_waitcnt vmcnt(3)
    v_max3_u32 v19, v24, v25, v26
    v_max_u32 v19, v19, v27
    v_cmp_eq_u32 vcc, -1, v19
    s_nop 0
    s_cbranch_vccnz g_30F15_0
    v_smfmac_f32_16x16x64_bf16 v[64:67], v[24:27], a[192:199], v172
    v_smfmac_f32_16x16x64_bf16 v[68:71], v[24:27], a[224:231], v172
g_30L14_1:
    s_waitcnt vmcnt(2)
    v_max3_u32 v19, v28, v29, v30
    v_max_u32 v19, v19, v31
    v_cmp_eq_u32 vcc, -1, v19
    s_nop 0
    s_cbranch_vccnz g_30F14_1
    v_smfmac_f32_16x16x64_bf16 v[64:67], v[28:31], a[200:207], v172
    v_smfmac_f32_16x16x64_bf16 v[68:71], v[28:31], a[232:239], v172
g_30L12_2:
    s_waitcnt vmcnt(1)
    v_max3_u32 v19, v32, v33, v34
    v_max_u32 v19, v19, v35
    v_cmp_eq_u32 vcc, -1, v19
    s_nop 0
    s_cbranch_vccnz g_30F12_2
    v_smfmac_f32_16x16x64_bf16 v[64:67], v[32:35], a[208:215], v172
    v_smfmac_f32_16x16x64_bf16 v[68:71], v[32:35], a[240:247], v172
g_30L8_3:
    s_waitcnt vmcnt(0)
    v_max3_u32 v19, v36, v37, v38
    v_max_u32 v19, v19, v39
    v_cmp_eq_u32 vcc, -1, v19
    s_nop 0
    s_cbranch_vccnz g_30F8_3
    v_smfmac_f32_16x16x64_bf16 v[64:67], v[36:39], a[216:223], v172
    v_smfmac_f32_16x16x64_bf16 v[68:71], v[36:39], a[248:255], v172
    s_nop 4
    v_cvt_pk_bf16_f32 v80, v64, v65
    v_cvt_pk_bf16_f32 v81, v66, v67
    s_nop 0
    v_cvt_pk_bf16_f32 v82, v68, v69
    v_cvt_pk_bf16_f32 v83, v70, v71
    ds_write_b128 v17, v[80:83] offset:9216
    s_branch gc_31
g_30L15_1:
    s_waitcnt vmcnt(3)
    v_max3_u32 v19, v28, v29, v30
    v_max_u32 v19, v19, v31
    v_cmp_eq_u32 vcc, -1, v19
    s_nop 0
    s_cbranch_vccnz g_30F15_1
    v_smfmac_f32_16x16x64_bf16 v[64:67], v[28:31], a[200:207], v172
    v_smfmac_f32_16x16x64_bf16 v[68:71], v[28:31], a[232:239], v172
g_30L13_2:
    s_waitcnt vmcnt(2)
    v_max3_u32 v19, v32, v33, v34
    v_max_u32 v19, v19, v35
    v_cmp_eq_u32 vcc, -1, v19
    s_nop 0
    s_cbranch_vccnz g_30F13_2
    v_smfmac_f32_16x16x64_bf16 v[64:67], v[32:35], a[208:215], v172
    v_smfmac_f32_16x16x64_bf16 v[68:71], v[32:35], a[240:247], v172
g_30L9_3:
    s_waitcnt vmcnt(1)
    v_max3_u32 v19, v36, v37, v38
    v_max_u32 v19, v19, v39
    v_cmp_eq_u32 vcc, -1, v19
    s_nop 0
    s_cbranch_vccnz g_30F9_3
    v_smfmac_f32_16x16x64_bf16 v[64:67], v[36:39], a[216:223], v172
    v_smfmac_f32_16x16x64_bf16 v[68:71], v[36:39], a[248:255], v172
g_30L1_0:
    s_waitcnt vmcnt(0)
    v_max3_u32 v19, v24, v25, v26
    v_max_u32 v19, v19, v27
    v_cmp_eq_u32 vcc, -1, v19
    s_nop 0
    s_cbranch_vccnz g_30F1_0
    v_smfmac_f32_16x16x64_bf16 v[64:67], v[24:27], a[192:199], v172
    v_smfmac_f32_16x16x64_bf16 v[68:71], v[24:27], a[224:231], v172
    s_nop 4
    v_cvt_pk_bf16_f32 v80, v64, v65
    v_cvt_pk_bf16_f32 v81, v66, v67
    s_nop 0
    v_cvt_pk_bf16_f32 v82, v68, v69
    v_cvt_pk_bf16_f32 v83, v70, v71
    ds_write_b128 v17, v[80:83] offset:9216
    s_branch gc_31
g_30L15_2:
    s_waitcnt vmcnt(3)
    v_max3_u32 v19, v32, v33, v34
    v_max_u32 v19, v19, v35
    v_cmp_eq_u32 vcc, -1, v19
    s_nop 0
    s_cbranch_vccnz g_30F15_2
    v_smfmac_f32_16x16x64_bf16 v[64:67], v[32:35], a[208:215], v172
    v_smfmac_f32_16x16x64_bf16 v[68:71], v[32:35], a[240:247], v172
g_30L11_3:
    s_waitcnt vmcnt(2)
    v_max3_u32 v19, v36, v37, v38
    v_max_u32 v19, v19, v39
    v_cmp_eq_u32 vcc, -1, v19
    s_nop 0
    s_cbranch_vccnz g_30F11_3
    v_smfmac_f32_16x16x64_bf16 v[64:67], v[36:39], a[216:223], v172
    v_smfmac_f32_16x16x64_bf16 v[68:71], v[36:39], a[248:255], v172
g_30L3_0:
    s_waitcnt vmcnt(1)
    v_max3_u32 v19, v24, v25, v26
    v_max_u32 v19, v19, v27
    v_cmp_eq_u32 vcc, -1, v19
    s_nop 0
    s_cbranch_vccnz g_30F3_0
    v_smfmac_f32_16x16x64_bf16 v[64:67], v[24:27], a[192:199], v172
    v_smfmac_f32_16x16x64_bf16 v[68:71], v[24:27], a[224:231], v172
g_30L2_1:
    s_waitcnt vmcnt(0)
    v_max3_u32 v19, v28, v29, v30
    v_max_u32 v19, v19, v31
    v_cmp_eq_u32 vcc, -1, v19
    s_nop 0
    s_cbranch_vccnz g_30F2_1
    v_smfmac_f32_16x16x64_bf16 v[64:67], v[28:31], a[200:207], v172
    v_smfmac_f32_16x16x64_bf16 v[68:71], v[28:31], a[232:239], v172
    s_nop 4
    v_cvt_pk_bf16_f32 v80, v64, v65
    v_cvt_pk_bf16_f32 v81, v66, v67
    s_nop 0
    v_cvt_pk_bf16_f32 v82, v68, v69
    v_cvt_pk_bf16_f32 v83, v70, v71
    ds_write_b128 v17, v[80:83] offset:9216
    s_branch gc_31
g_30L15_3:
    s_waitcnt vmcnt(3)
    v_max3_u32 v19, v36, v37, v38
    v_max_u32 v19, v19, v39
    v_cmp_eq_u32 vcc, -1, v19
    s_nop 0
    s_cbranch_vccnz g_30F15_3
    v_smfmac_f32_16x16x64_bf16 v[64:67], v[36:39], a[216:223], v172
    v_smfmac_f32_16x16x64_bf16 v[68:71], v[36:39], a[248:255], v172
g_30L7_0:
    s_waitcnt vmcnt(2)
    v_max3_u32 v19, v24, v25, v26
    v_max_u32 v19, v19, v27
    v_cmp_eq_u32 vcc, -1, v19
    s_nop 0
    s_cbranch_vccnz g_30F7_0
    v_smfmac_f32_16x16x64_bf16 v[64:67], v[24:27], a[192:199], v172
    v_smfmac_f32_16x16x64_bf16 v[68:71], v[24:27], a[224:231], v172
g_30L6_1:
    s_waitcnt vmcnt(1)
    v_max3_u32 v19, v28, v29, v30
    v_max_u32 v19, v19, v31
    v_cmp_eq_u32 vcc, -1, v19
    s_nop 0
    s_cbranch_vccnz g_30F6_1
    v_smfmac_f32_16x16x64_bf16 v[64:67], v[28:31], a[200:207], v172
    v_smfmac_f32_16x16x64_bf16 v[68:71], v[28:31], a[232:239], v172
g_30L4_2:
    s_waitcnt vmcnt(0)
    v_max3_u32 v19, v32, v33, v34
    v_max_u32 v19, v19, v35
    v_cmp_eq_u32 vcc, -1, v19
    s_nop 0
    s_cbranch_vccnz g_30F4_2
    v_smfmac_f32_16x16x64_bf16 v[64:67], v[32:35], a[208:215], v172
    v_smfmac_f32_16x16x64_bf16 v[68:71], v[32:35], a[240:247], v172
    s_nop 4
    v_cvt_pk_bf16_f32 v80, v64, v65
    v_cvt_pk_bf16_f32 v81, v66, v67
    s_nop 0
    v_cvt_pk_bf16_f32 v82, v68, v69
    v_cvt_pk_bf16_f32 v83, v70, v71
    ds_write_b128 v17, v[80:83] offset:9216
    s_branch gc_31
g_30L7_1:
    s_waitcnt vmcnt(2)
    v_max3_u32 v19, v28, v29, v30
    v_max_u32 v19, v19, v31
    v_cmp_eq_u32 vcc, -1, v19
    s_nop 0
    s_cbranch_vccnz g_30F7_1
    v_smfmac_f32_16x16x64_bf16 v[64:67], v[28:31], a[200:207], v172
    v_smfmac_f32_16x16x64_bf16 v[68:71], v[28:31], a[232:239], v172
g_30L5_2:
    s_waitcnt vmcnt(1)
    v_max3_u32 v19, v32, v33, v34
    v_max_u32 v19, v19, v35
    v_cmp_eq_u32 vcc, -1, v19
    s_nop 0
    s_cbranch_vccnz g_30F5_2
    v_smfmac_f32_16x16x64_bf16 v[64:67], v[32:35], a[208:215], v172
    v_smfmac_f32_16x16x64_bf16 v[68:71], v[32:35], a[240:247], v172
    s_branch g_30L1_0
g_30L7_2:
    s_waitcnt vmcnt(2)
    v_max3_u32 v19, v32, v33, v34
    v_max_u32 v19, v19, v35
    v_cmp_eq_u32 vcc, -1, v19
    s_nop 0
    s_cbranch_vccnz g_30F7_2
    v_smfmac_f32_16x16x64_bf16 v[64:67], v[32:35], a[208:215], v172
    v_smfmac_f32_16x16x64_bf16 v[68:71], v[32:35], a[240:247], v172
    s_branch g_30L3_0
g_30L11_0:
    s_waitcnt vmcnt(2)
    v_max3_u32 v19, v24, v25, v26
    v_max_u32 v19, v19, v27
    v_cmp_eq_u32 vcc, -1, v19
    s_nop 0
    s_cbranch_vccnz g_30F11_0
    v_smfmac_f32_16x16x64_bf16 v[64:67], v[24:27], a[192:199], v172
    v_smfmac_f32_16x16x64_bf16 v[68:71], v[24:27], a[224:231], v172
g_30L10_1:
    s_waitcnt vmcnt(1)
    v_max3_u32 v19, v28, v29, v30
    v_max_u32 v19, v19, v31
    v_cmp_eq_u32 vcc, -1, v19
    s_nop 0
    s_cbranch_vccnz g_30F10_1
    v_smfmac_f32_16x16x64_bf16 v[64:67], v[28:31], a[200:207], v172
    v_smfmac_f32_16x16x64_bf16 v[68:71], v[28:31], a[232:239], v172
    s_branch g_30L8_3
g_30L11_1:
    s_waitcnt vmcnt(2)
    v_max3_u32 v19, v28, v29, v30
    v_max_u32 v19, v19, v31
    v_cmp_eq_u32 vcc, -1, v19
    s_nop 0
    s_cbranch_vccnz g_30F11_1
    v_smfmac_f32_16x16x64_bf16 v[64:67], v[28:31], a[200:207], v172
    v_smfmac_f32_16x16x64_bf16 v[68:71], v[28:31], a[232:239], v172
    s_branch g_30L9_3
g_30L13_0:
    s_waitcnt vmcnt(2)
    v_max3_u32 v19, v24, v25, v26
    v_max_u32 v19, v19, v27
    v_cmp_eq_u32 vcc, -1, v19
    s_nop 0
    s_cbranch_vccnz g_30F13_0
    v_smfmac_f32_16x16x64_bf16 v[64:67], v[24:27], a[192:199], v172
    v_smfmac_f32_16x16x64_bf16 v[68:71], v[24:27], a[224:231], v172
    s_branch g_30L12_2
g_30L13_3:
    s_waitcnt vmcnt(2)
    v_max3_u32 v19, v36, v37, v38
    v_max_u32 v19, v19, v39
    v_cmp_eq_u32 vcc, -1, v19
    s_nop 0
    s_cbranch_vccnz g_30F13_3
    v_smfmac_f32_16x16x64_bf16 v[64:67], v[36:39], a[216:223], v172
    v_smfmac_f32_16x16x64_bf16 v[68:71], v[36:39], a[248:255], v172
g_30L5_0:
    s_waitcnt vmcnt(1)
    v_max3_u32 v19, v24, v25, v26
    v_max_u32 v19, v19, v27
    v_cmp_eq_u32 vcc, -1, v19
    s_nop 0
    s_cbranch_vccnz g_30F5_0
    v_smfmac_f32_16x16x64_bf16 v[64:67], v[24:27], a[192:199], v172
    v_smfmac_f32_16x16x64_bf16 v[68:71], v[24:27], a[224:231], v172
    s_branch g_30L4_2
g_30L14_2:
    s_waitcnt vmcnt(2)
    v_max3_u32 v19, v32, v33, v34
    v_max_u32 v19, v19, v35
    v_cmp_eq_u32 vcc, -1, v19
    s_nop 0
    s_cbranch_vccnz g_30F14_2
    v_smfmac_f32_16x16x64_bf16 v[64:67], v[32:35], a[208:215], v172
    v_smfmac_f32_16x16x64_bf16 v[68:71], v[32:35], a[240:247], v172
g_30L10_3:
    s_waitcnt vmcnt(1)
    v_max3_u32 v19, v36, v37, v38
    v_max_u32 v19, v19, v39
    v_cmp_eq_u32 vcc, -1, v19
    s_nop 0
    s_cbranch_vccnz g_30F10_3
    v_smfmac_f32_16x16x64_bf16 v[64:67], v[36:39], a[216:223], v172
    v_smfmac_f32_16x16x64_bf16 v[68:71], v[36:39], a[248:255], v172
    s_branch g_30L2_1
g_30L14_3:
    s_waitcnt vmcnt(2)
    v_max3_u32 v19, v36, v37, v38
    v_max_u32 v19, v19, v39
    v_cmp_eq_u32 vcc, -1, v19
    s_nop 0
    s_cbranch_vccnz g_30F14_3
    v_smfmac_f32_16x16x64_bf16 v[64:67], v[36:39], a[216:223], v172
    v_smfmac_f32_16x16x64_bf16 v[68:71], v[36:39], a[248:255], v172
    s_branch g_30L6_1
g_30L3_1:
    s_waitcnt vmcnt(1)
    v_max3_u32 v19, v28, v29, v30
    v_max_u32 v19, v19, v31
    v_cmp_eq_u32 vcc, -1, v19
    s_nop 0
    s_cbranch_vccnz g_30F3_1
    v_smfmac_f32_16x16x64_bf16 v[64:67], v[28:31], a[200:207], v172
    v_smfmac_f32_16x16x64_bf16 v[68:71], v[28:31], a[232:239], v172
    s_branch g_30L1_0
g_30L6_2:
    s_waitcnt vmcnt(1)
    v_max3_u32 v19, v32, v33, v34
    v_max_u32 v19, v19, v35
    v_cmp_eq_u32 vcc, -1, v19
    s_nop 0
    s_cbranch_vccnz g_30F6_2
    v_smfmac_f32_16x16x64_bf16 v[64:67], v[32:35], a[208:215], v172
    v_smfmac_f32_16x16x64_bf16 v[68:71], v[32:35], a[240:247], v172
    s_branch g_30L2_1
g_30L9_0:
    s_waitcnt vmcnt(1)
    v_max3_u32 v19, v24, v25, v26
    v_max_u32 v19, v19, v27
    v_cmp_eq_u32 vcc, -1, v19
    s_nop 0
    s_cbranch_vccnz g_30F9_0
    v_smfmac_f32_16x16x64_bf16 v[64:67], v[24:27], a[192:199], v172
    v_smfmac_f32_16x16x64_bf16 v[68:71], v[24:27], a[224:231], v172
    s_branch g_30L8_3
g_30L12_3:
    s_waitcnt vmcnt(1)
    v_max3_u32 v19, v36, v37, v38
    v_max_u32 v19, v19, v39
    v_cmp_eq_u32 vcc, -1, v19
    s_nop 0
    s_cbranch_vccnz g_30F12_3
    v_smfmac_f32_16x16x64_bf16 v[64:67], v[36:39], a[216:223], v172
    v_smfmac_f32_16x16x64_bf16 v[68:71], v[36:39], a[248:255], v172
    s_branch g_30L4_2
g_30F15_0:
    s_mov_b64 exec, vcc
    buffer_load_dwordx4 v[24:27], v8, s[4:7], s16 offen offset:0 sc1
    s_mov_b64 exec, -1
    s_add_u32 s23, s23, 1
    s_cmp_lt_u32 s23, 200000
    s_cbranch_scc1 g_30L15_1
    s_mov_b32 s25, 200000
    s_branch gc_31
g_30F15_1:
    s_mov_b64 exec, vcc
    buffer_load_dwordx4 v[28:31], v8, s[4:7], s16 offen offset:1024 sc1
    s_mov_b64 exec, -1
    s_add_u32 s23, s23, 1
    s_cmp_lt_u32 s23, 200000
    s_cbranch_scc1 g_30L15_2
    s_mov_b32 s25, 200000
    s_branch gc_31
g_30F15_2:
    s_mov_b64 exec, vcc
    buffer_load_dwordx4 v[32:35], v8, s[4:7], s16 offen offset:2048 sc1
    s_mov_b64 exec, -1
    s_add_u32 s23, s23, 1
    s_cmp_lt_u32 s23, 200000
    s_cbranch_scc1 g_30L15_3
    s_mov_b32 s25, 200000
    s_branch gc_31
g_30F15_3:
    s_mov_b64 exec, vcc
    buffer_load_dwordx4 v[36:39], v8, s[4:7], s16 offen offset:3072 sc1
    s_mov_b64 exec, -1
    s_add_u32 s23, s23, 1
    s_cmp_lt_u32 s23, 200000
    s_cbranch_scc1 g_30L15_0
    s_mov_b32 s25, 200000
    s_branch gc_31
g_30F7_0:
    s_mov_b64 exec, vcc
    buffer_load_dwordx4 v[24:27], v8, s[4:7], s16 offen offset:0 sc1
    s_mov_b64 exec, -1
    s_add_u32 s23, s23, 1
    s_cmp_lt_u32 s23, 200000
    s_cbranch_scc1 g_30L7_1
    s_mov_b32 s25, 200000
    s_branch gc_31
g_30F7_1:
    s_mov_b64 exec, vcc
    buffer_load_dwordx4 v[28:31], v8, s[4:7], s16 offen offset:1024 sc1
    s_mov_b64 exec, -1
    s_add_u32 s23, s23, 1
    s_cmp_lt_u32 s23, 200000
    s_cbranch_scc1 g_30L7_2
    s_mov_b32 s25, 200000
    s_branch gc_31
g_30F7_2:
    s_mov_b64 exec, vcc
    buffer_load_dwordx4 v[32:35], v8, s[4:7], s16 offen offset:2048 sc1
    s_mov_b64 exec, -1
    s_add_u32 s23, s23, 1
    s_cmp_lt_u32 s23, 200000
    s_cbranch_scc1 g_30L7_0
    s_mov_b32 s25, 200000
    s_branch gc_31
g_30F11_0:
    s_mov_b64 exec, vcc
    buffer_load_dwordx4 v[24:27], v8, s[4:7], s16 offen offset:0 sc1
    s_mov_b64 exec, -1
    s_add_u32 s23, s23, 1
    s_cmp_lt_u32 s23, 200000
    s_cbranch_scc1 g_30L11_1
    s_mov_b32 s25, 200000
    s_branch gc_31
g_30F11_1:
    s_mov_b64 exec, vcc
    buffer_load_dwordx4 v[28:31], v8, s[4:7], s16 offen offset:1024 sc1
    s_mov_b64 exec, -1
    s_add_u32 s23, s23, 1
    s_cmp_lt_u32 s23, 200000
    s_cbranch_scc1 g_30L11_3
    s_mov_b32 s25, 200000
    s_branch gc_31
g_30F11_3:
    s_mov_b64 exec, vcc
    buffer_load_dwordx4 v[36:39], v8, s[4:7], s16 offen offset:3072 sc1
    s_mov_b64 exec, -1
    s_add_u32 s23, s23, 1
    s_cmp_lt_u32 s23, 200000
    s_cbranch_scc1 g_30L11_0
    s_mov_b32 s25, 200000
    s_branch gc_31
g_30F13_0:
    s_mov_b64 exec, vcc
    buffer_load_dwordx4 v[24:27], v8, s[4:7], s16 offen offset:0 sc1
    s_mov_b64 exec, -1
    s_add_u32 s23, s23, 1
    s_cmp_lt_u32 s23, 200000
    s_cbranch_scc1 g_30L13_2
    s_mov_b32 s25, 200000
    s_branch gc_31
g_30F13_2:
    s_mov_b64 exec, vcc
    buffer_load_dwordx4 v[32:35], v8, s[4:7], s16 offen offset:2048 sc1
    s_mov_b64 exec, -1
    s_add_u32 s23, s23, 1
    s_cmp_lt_u32 s23, 200000
    s_cbranch_scc1 g_30L13_3
    s_mov_b32 s25, 200000
    s_branch gc_31
g_30F13_3:
    s_mov_b64 exec, vcc
    buffer_load_dwordx4 v[36:39], v8, s[4:7], s16 offen offset:3072 sc1
    s_mov_b64 exec, -1
    s_add_u32 s23, s23, 1
    s_cmp_lt_u32 s23, 200000
    s_cbranch_scc1 g_30L13_0
    s_mov_b32 s25, 200000
    s_branch gc_31
g_30F14_1:
    s_mov_b64 exec, vcc
    buffer_load_dwordx4 v[28:31], v8, s[4:7], s16 offen offset:1024 sc1
    s_mov_b64 exec, -1
    s_add_u32 s23, s23, 1
    s_cmp_lt_u32 s23, 200000
    s_cbranch_scc1 g_30L14_2
    s_mov_b32 s25, 200000
    s_branch gc_31
g_30F14_2:
    s_mov_b64 exec, vcc
    buffer_load_dwordx4 v[32:35], v8, s[4:7], s16 offen offset:2048 sc1
    s_mov_b64 exec, -1
    s_add_u32 s23, s23, 1
    s_cmp_lt_u32 s23, 200000
    s_cbranch_scc1 g_30L14_3
    s_mov_b32 s25, 200000
    s_branch gc_31
g_30F14_3:
    s_mov_b64 exec, vcc
    buffer_load_dwordx4 v[36:39], v8, s[4:7], s16 offen offset:3072 sc1
    s_mov_b64 exec, -1
    s_add_u32 s23, s23, 1
    s_cmp_lt_u32 s23, 200000
    s_cbranch_scc1 g_30L14_1
    s_mov_b32 s25, 200000
    s_branch gc_31
g_30F3_0:
    s_mov_b64 exec, vcc
    buffer_load_dwordx4 v[24:27], v8, s[4:7], s16 offen offset:0 sc1
    s_mov_b64 exec, -1
    s_add_u32 s23, s23, 1
    s_cmp_lt_u32 s23, 200000
    s_cbranch_scc1 g_30L3_1
    s_mov_b32 s25, 200000
    s_branch gc_31
g_30F3_1:
    s_mov_b64 exec, vcc
    buffer_load_dwordx4 v[28:31], v8, s[4:7], s16 offen offset:1024 sc1
    s_mov_b64 exec, -1
    s_add_u32 s23, s23, 1
    s_cmp_lt_u32 s23, 200000
    s_cbranch_scc1 g_30L3_0
    s_mov_b32 s25, 200000
    s_branch gc_31
g_30F5_0:
    s_mov_b64 exec, vcc
    buffer_load_dwordx4 v[24:27], v8, s[4:7], s16 offen offset:0 sc1
    s_mov_b64 exec, -1
    s_add_u32 s23, s23, 1
    s_cmp_lt_u32 s23, 200000
    s_cbranch_scc1 g_30L5_2
    s_mov_b32 s25, 200000
    s_branch gc_31
g_30F5_2:
    s_mov_b64 exec, vcc
    buffer_load_dwordx4 v[32:35], v8, s[4:7], s16 offen offset:2048 sc1
    s_mov_b64 exec, -1
    s_add_u32 s23, s23, 1
    s_cmp_lt_u32 s23, 200000
    s_cbranch_scc1 g_30L5_0
    s_mov_b32 s25, 200000
    s_branch gc_31
g_30F6_1:
    s_mov_b64 exec, vcc
    buffer_load_dwordx4 v[28:31], v8, s[4:7], s16 offen offset:1024 sc1
    s_mov_b64 exec, -1
    s_add_u32 s23, s23, 1
    s_cmp_lt_u32 s23, 200000
    s_cbranch_scc1 g_30L6_2
    s_mov_b32 s25, 200000
    s_branch gc_31
g_30F6_2:
    s_mov_b64 exec, vcc
    buffer_load_dwordx4 v[32:35], v8, s[4:7], s16 offen offset:2048 sc1
    s_mov_b64 exec, -1
    s_add_u32 s23, s23, 1
    s_cmp_lt_u32 s23, 200000
    s_cbranch_scc1 g_30L6_1
    s_mov_b32 s25, 200000
    s_branch gc_31
g_30F9_0:
    s_mov_b64 exec, vcc
    buffer_load_dwordx4 v[24:27], v8, s[4:7], s16 offen offset:0 sc1
    s_mov_b64 exec, -1
    s_add_u32 s23, s23, 1
    s_cmp_lt_u32 s23, 200000
    s_cbranch_scc1 g_30L9_3
    s_mov_b32 s25, 200000
    s_branch gc_31
g_30F9_3:
    s_mov_b64 exec, vcc
    buffer_load_dwordx4 v[36:39], v8, s[4:7], s16 offen offset:3072 sc1
    s_mov_b64 exec, -1
    s_add_u32 s23, s23, 1
    s_cmp_lt_u32 s23, 200000
    s_cbranch_scc1 g_30L9_0
    s_mov_b32 s25, 200000
    s_branch gc_31
g_30F10_1:
    s_mov_b64 exec, vcc
    buffer_load_dwordx4 v[28:31], v8, s[4:7], s16 offen offset:1024 sc1
    s_mov_b64 exec, -1
    s_add_u32 s23, s23, 1
    s_cmp_lt_u32 s23, 200000
    s_cbranch_scc1 g_30L10_3
    s_mov_b32 s25, 200000
    s_branch gc_31
g_30F10_3:
    s_mov_b64 exec, vcc
    buffer_load_dwordx4 v[36:39], v8, s[4:7], s16 offen offset:3072 sc1
    s_mov_b64 exec, -1
    s_add_u32 s23, s23, 1
    s_cmp_lt_u32 s23, 200000
    s_cbranch_scc1 g_30L10_1
    s_mov_b32 s25, 200000
    s_branch gc_31
g_30F12_2:
    s_mov_b64 exec, vcc
    buffer_load_dwordx4 v[32:35], v8, s[4:7], s16 offen offset:2048 sc1
    s_mov_b64 exec, -1
    s_add_u32 s23, s23, 1
    s_cmp_lt_u32 s23, 200000
    s_cbranch_scc1 g_30L12_3
    s_mov_b32 s25, 200000
    s_branch gc_31
g_30F12_3:
    s_mov_b64 exec, vcc
    buffer_load_dwordx4 v[36:39], v8, s[4:7], s16 offen offset:3072 sc1
    s_mov_b64 exec, -1
    s_add_u32 s23, s23, 1
    s_cmp_lt_u32 s23, 200000
    s_cbranch_scc1 g_30L12_2
    s_mov_b32 s25, 200000
    s_branch gc_31
g_30F1_0:
    s_mov_b64 exec, vcc
    buffer_load_dwordx4 v[24:27], v8, s[4:7], s16 offen offset:0 sc1
    s_mov_b64 exec, -1
    s_add_u32 s23, s23, 1
    s_cmp_lt_u32 s23, 200000
    s_cbranch_scc1 g_30L1_0
    s_mov_b32 s25, 200000
    s_branch gc_31
g_30F2_1:
    s_mov_b64 exec, vcc
    buffer_load_dwordx4 v[28:31], v8, s[4:7], s16 offen offset:1024 sc1
    s_mov_b64 exec, -1
    s_add_u32 s23, s23, 1
    s_cmp_lt_u32 s23, 200000
    s_cbranch_scc1 g_30L2_1
    s_mov_b32 s25, 200000
    s_branch gc_31
g_30F4_2:
    s_mov_b64 exec, vcc
    buffer_load_dwordx4 v[32:35], v8, s[4:7], s16 offen offset:2048 sc1
    s_mov_b64 exec, -1
    s_add_u32 s23, s23, 1
    s_cmp_lt_u32 s23, 200000
    s_cbranch_scc1 g_30L4_2
    s_mov_b32 s25, 200000
    s_branch gc_31
g_30F8_3:
    s_mov_b64 exec, vcc
    buffer_load_dwordx4 v[36:39], v8, s[4:7], s16 offen offset:3072 sc1
    s_mov_b64 exec, -1
    s_add_u32 s23, s23, 1
    s_cmp_lt_u32 s23, 200000
    s_cbranch_scc1 g_30L8_3
    s_mov_b32 s25, 200000
    s_branch gc_31
.p2align 6
recur_fast_w1:
    s_nop 15
    s_mov_b32 s23, s25
    buffer_load_dwordx4 v[24:27], v2, s[4:7], s16 offen offset:0 sc1
    s_nop 11
    buffer_load_dwordx4 v[28:31], v2, s[4:7], s16 offen offset:1024 sc1
    s_nop 11
    buffer_load_dwordx4 v[32:35], v2, s[4:7], s16 offen offset:2048 sc1
    s_nop 11
    buffer_load_dwordx4 v[36:39], v2, s[4:7], s16 offen offset:3072 sc1
    s_waitcnt vmcnt(3)
    v_max3_u32 v19, v24, v25, v26
    v_max_u32 v19, v19, v27
    v_cmp_eq_u32 vcc, -1, v19
    s_nop 0
    s_cbranch_vccnz g_34F15_0
    v_smfmac_f32_16x16x64_bf16 v[40:43], v[24:27], a[0:7], v172
    s_waitcnt vmcnt(2)
    v_max3_u32 v19, v28, v29, v30
    v_max_u32 v19, v19, v31
    v_smfmac_f32_16x16x64_bf16 v[44:47], v[24:27], a[64:71], v172
    v_cmp_eq_u32 vcc, -1, v19
    v_smfmac_f32_16x16x64_bf16 v[48:51], v[24:27], a[32:39], v172
    v_smfmac_f32_16x16x64_bf16 v[52:55], v[24:27], a[96:103], v172
    s_cbranch_vccnz g_34F14_1
    v_smfmac_f32_16x16x64_bf16 v[40:43], v[28:31], a[8:15], v172
    s_waitcnt vmcnt(1)
    v_max3_u32 v19, v32, v33, v34
    v_max_u32 v19, v19, v35
    v_smfmac_f32_16x16x64_bf16 v[44:47], v[28:31], a[72:79], v172
    v_cmp_eq_u32 vcc, -1, v19
    v_smfmac_f32_16x16x64_bf16 v[48:51], v[28:31], a[40:47], v172
    v_smfmac_f32_16x16x64_bf16 v[52:55], v[28:31], a[104:111], v172
    s_cbranch_vccnz g_34F12_2
    v_smfmac_f32_16x16x64_bf16 v[40:43], v[32:35], a[16:23], v172
    s_waitcnt vmcnt(0)
    v_max3_u32 v19, v36, v37, v38
    v_max_u32 v19, v19, v39
    v_smfmac_f32_16x16x64_bf16 v[44:47], v[32:35], a[80:87], v172
    v_cmp_eq_u32 vcc, -1, v19
    v_smfmac_f32_16x16x64_bf16 v[48:51], v[32:35], a[48:55], v172
    v_smfmac_f32_16x16x64_bf16 v[52:55], v[32:35], a[112:119], v172
    s_cbranch_vccnz g_34F8_3
    v_smfmac_f32_16x16x64_bf16 v[40:43], v[36:39], a[24:31], v172
    v_smfmac_f32_16x16x64_bf16 v[44:47], v[36:39], a[88:95], v172
    v_smfmac_f32_16x16x64_bf16 v[48:51], v[36:39], a[56:63], v172
    v_smfmac_f32_16x16x64_bf16 v[52:55], v[36:39], a[120:127], v172
gc_35:
    v_cvt_pk_bf16_f32 v72, v40, v41
    v_cvt_pk_bf16_f32 v73, v42, v43
    v_cvt_pk_bf16_f32 v74, v44, v45
    v_cvt_pk_bf16_f32 v75, v46, v47
    ds_write_b128 v17, v[72:75] offset:0
    v_cvt_pk_bf16_f32 v76, v48, v49
    v_cvt_pk_bf16_f32 v77, v50, v51
    s_nop 0
    v_cvt_pk_bf16_f32 v78, v52, v53
    v_cvt_pk_bf16_f32 v79, v54, v55
    ds_write_b128 v17, v[76:79] offset:1024
    v_smfmac_f32_16x16x64_bf16 v[56:59], v[24:27], a[128:135], v172
    v_smfmac_f32_16x16x64_bf16 v[60:63], v[24:27], a[160:167], v172
    v_smfmac_f32_16x16x64_bf16 v[56:59], v[28:31], a[136:143], v172
    s_waitcnt lgkmcnt(0)
    s_barrier
    v_smfmac_f32_16x16x64_bf16 v[60:63], v[28:31], a[168:175], v172
    v_smfmac_f32_16x16x64_bf16 v[56:59], v[32:35], a[144:151], v172
    v_smfmac_f32_16x16x64_bf16 v[60:63], v[32:35], a[176:183], v172
    v_smfmac_f32_16x16x64_bf16 v[56:59], v[36:39], a[152:159], v172
    v_smfmac_f32_16x16x64_bf16 v[60:63], v[36:39], a[184:191], v172
    s_nop 4
    v_cvt_pk_bf16_f32 v80, v56, v57
    v_cvt_pk_bf16_f32 v81, v58, v59
    s_nop 0
    v_cvt_pk_bf16_f32 v82, v60, v61
    v_cvt_pk_bf16_f32 v83, v62, v63
    ds_write_b128 v17, v[80:83] offset:8192
    v_mov_b32 v152, v228
    v_mov_b32 v153, v229
    v_mov_b32 v156, v230
    v_mov_b32 v157, v231
    v_mov_b32 v160, v232
    v_mov_b32 v161, v233
    v_mov_b32 v164, v234
    v_mov_b32 v165, v235
    s_cmp_eq_u32 s15, 63
    s_waitcnt lgkmcnt(0)
    s_barrier
    s_cbranch_scc1 recur_end
    s_nop 15
    s_nop 15
    s_nop 7
    buffer_load_dwordx4 v[208:211], v5, s[4:7], s16 offen offset:0 sc1
    buffer_load_dwordx4 v[212:215], v5, s[4:7], s16 offen offset:1024 sc1
    buffer_load_dwordx4 v[216:219], v5, s[4:7], s16 offen offset:2048 sc1
    buffer_load_dwordx4 v[220:223], v5, s[4:7], s16 offen offset:3072 sc1
    buffer_load_dword v224, v6, s[4:7], s16 offen offset:0 sc1
    buffer_load_dword v225, v6, s[4:7], s16 offen offset:256 sc1
    buffer_load_dword v226, v6, s[4:7], s16 offen offset:512 sc1
    buffer_load_dword v227, v6, s[4:7], s16 offen offset:768 sc1
    s_mov_b32 s23, s25
    ds_read_b128 v[96:99], v16 offset:8192
    ds_read_b128 v[104:107], v16 offset:12288
    ds_read_b128 v[108:111], v16 offset:14336
    v_mfma_f32_16x16x32_bf16 v[140:143], v[84:87], v[80:83], 0
    s_waitcnt lgkmcnt(2)
    v_mfma_f32_16x16x32_bf16 v[140:143], v[84:87], v[96:99], v[140:143]
    s_waitcnt lgkmcnt(1)
    v_mfma_f32_16x16x32_bf16 v[140:143], v[84:87], v[104:107], v[140:143]
    s_waitcnt lgkmcnt(0)
    v_mfma_f32_16x16x32_bf16 v[140:143], v[84:87], v[108:111], v[140:143]
    buffer_load_dwordx4 v[24:27], v5, s[4:7], s16 offen offset:0 sc1
    buffer_load_dwordx4 v[28:31], v5, s[4:7], s16 offen offset:1024 sc1
    buffer_load_dwordx4 v[32:35], v5, s[4:7], s16 offen offset:2048 sc1
    buffer_load_dwordx4 v[36:39], v5, s[4:7], s16 offen offset:3072 sc1
    buffer_load_dword v40, v6, s[4:7], s16 offen offset:0 sc1
    buffer_load_dword v41, v6, s[4:7], s16 offen offset:256 sc1
    buffer_load_dword v42, v6, s[4:7], s16 offen offset:512 sc1
    buffer_load_dword v43, v6, s[4:7], s16 offen offset:768 sc1
    v_cvt_pk_bf16_f32 v154, v140, v179
    v_cvt_pk_bf16_f32 v158, v141, v179
    v_cvt_pk_bf16_f32 v162, v142, v179
    v_cvt_pk_bf16_f32 v166, v143, v179
    s_waitcnt vmcnt(14)
    v_pk_add_f32 v[180:181], v[208:209], v[212:213]
    v_pk_add_f32 v[182:183], v[210:211], v[214:215]
    s_waitcnt vmcnt(12)
    v_pk_add_f32 v[188:189], v[216:217], v[220:221]
    v_pk_add_f32 v[190:191], v[218:219], v[222:223]
    v_pk_add_f32 v[180:181], v[180:181], v[188:189]
    v_pk_add_f32 v[182:183], v[182:183], v[190:191]
    v_pk_add_f32 v[188:189], v[180:181], v[182:183]
    v_max3_f32 v185, v180, v181, v182
    s_waitcnt vmcnt(8)
    v_pk_add_f32 v[192:193], v[224:225], v[226:227]
    v_add_f32 v188, v188, v189
    v_add_f32 v184, v192, v193
    v_max3_f32 v185, v185, v183, v184
    v_cmp_u_f32 vcc, v188, v184
    s_nop 0
    v_max_f32_dpp v185, v185, v185 row_ror:8 row_mask:0xf bank_mask:0xf
    v_mov_b32 v186, v185
    s_nop 1
    v_permlane16_swap_b32 v185, v186
    v_max_f32 v185, v185, v186
    v_mov_b32 v186, v185
    s_cbranch_vccnz ss_36
sg_38:
    s_nop 0
    v_permlane32_swap_b32 v185, v186
    v_max_f32 v185, v185, v186
    v_mul_f32 v185, s24, v185
    v_fma_f32 v180, v180, s24, -v185
    v_fma_f32 v181, v181, s24, -v185
    v_fma_f32 v182, v182, s24, -v185
    v_fma_f32 v183, v183, s24, -v185
    v_fma_f32 v184, v184, s24, -v185
    v_exp_f32 v180, v180
    v_exp_f32 v181, v181
    v_exp_f32 v182, v182
    v_exp_f32 v183, v183
    v_exp_f32 v184, v184
    v_cvt_pk_bf16_f32 v176, v180, v181
    v_cvt_pk_bf16_f32 v177, v182, v183
    v_cvt_pk_bf16_f32 v178, v184, v179
    s_nop 1
    v_mfma_f32_16x16x32_bf16 v[240:243], v[236:239], v[176:179], 0
    v_mfma_f32_16x16x32_bf16 v[188:191], v[152:155], v[176:179], 0
    v_mfma_f32_16x16x32_bf16 v[192:195], v[156:159], v[176:179], 0
    v_mfma_f32_16x16x32_bf16 v[196:199], v[160:163], v[176:179], 0
    v_mfma_f32_16x16x32_bf16 v[200:203], v[164:167], v[176:179], 0
    v_add_f32_dpp v185, v240, v240 row_ror:8 row_mask:0xf bank_mask:0xf
    v_rcp_f32 v185, v185
    v_add_f32_dpp v88, v192, v188 row_ror:8 row_mask:0xf bank_mask:0x3
    v_add_f32_dpp v89, v193, v189 row_ror:8 row_mask:0xf bank_mask:0x3
    v_add_f32_dpp v90, v194, v190 row_ror:8 row_mask:0xf bank_mask:0x3
    v_add_f32_dpp v91, v195, v191 row_ror:8 row_mask:0xf bank_mask:0x3
    s_nop 1
    v_add_f32_dpp v88, v196, v200 row_ror:8 row_mask:0xf bank_mask:0xc
    v_add_f32_dpp v89, v197, v201 row_ror:8 row_mask:0xf bank_mask:0xc
    v_add_f32_dpp v90, v198, v202 row_ror:8 row_mask:0xf bank_mask:0xc
    v_add_f32_dpp v91, v199, v203 row_ror:8 row_mask:0xf bank_mask:0xc
    v_mul_f32 v88, v88, v185
    v_mul_f32 v89, v89, v185
    v_mul_f32 v90, v90, v185
    v_mul_f32 v91, v91, v185
    v_cvt_pk_bf16_f32 v88, v88, v89
    v_cvt_pk_bf16_f32 v89, v90, v91
    buffer_store_dwordx2 v[88:89], v7, s[4:7], s16 offen
    v_readfirstlane_b32 s85, v247
    s_add_u32 s94, s15, 2
    s_barrier
    s_nop 15
    s_mov_b32 s23, s25
    buffer_load_dwordx4 v[24:27], v8, s[4:7], s16 offen offset:0 sc1
    s_nop 11
    buffer_load_dwordx4 v[28:31], v8, s[4:7], s16 offen offset:1024 sc1
    s_nop 11
    buffer_load_dwordx4 v[32:35], v8, s[4:7], s16 offen offset:2048 sc1
    s_nop 11
    buffer_load_dwordx4 v[36:39], v8, s[4:7], s16 offen offset:3072 sc1
    s_waitcnt vmcnt(3)
    v_max3_u32 v19, v24, v25, v26
    v_max_u32 v19, v19, v27
    v_cmp_eq_u32 vcc, -1, v19
    s_nop 0
    s_cbranch_vccnz g_39F15_0
    v_smfmac_f32_16x16x64_bf16 v[64:67], v[24:27], a[192:199], v172
    v_smfmac_f32_16x16x64_bf16 v[68:71], v[24:27], a[224:231], v172
    s_waitcnt vmcnt(2)
    v_max3_u32 v19, v28, v29, v30
    v_max_u32 v19, v19, v31
    v_cmp_eq_u32 vcc, -1, v19
    s_nop 0
    s_cbranch_vccnz g_39F14_1
    v_smfmac_f32_16x16x64_bf16 v[64:67], v[28:31], a[200:207], v172
    v_smfmac_f32_16x16x64_bf16 v[68:71], v[28:31], a[232:239], v172
    s_waitcnt vmcnt(1)
    v_max3_u32 v19, v32, v33, v34
    v_max_u32 v19, v19, v35
    v_cmp_eq_u32 vcc, -1, v19
    s_nop 0
    s_cbranch_vccnz g_39F12_2
    v_smfmac_f32_16x16x64_bf16 v[64:67], v[32:35], a[208:215], v172
    v_smfmac_f32_16x16x64_bf16 v[68:71], v[32:35], a[240:247], v172
    s_waitcnt vmcnt(0)
    v_max3_u32 v19, v36, v37, v38
    v_max_u32 v19, v19, v39
    v_cmp_eq_u32 vcc, -1, v19
    s_nop 0
    s_cbranch_vccnz g_39F8_3
    v_smfmac_f32_16x16x64_bf16 v[64:67], v[36:39], a[216:223], v172
    v_smfmac_f32_16x16x64_bf16 v[68:71], v[36:39], a[248:255], v172
    s_nop 4
    v_cvt_pk_bf16_f32 v80, v64, v65
    v_cvt_pk_bf16_f32 v81, v66, v67
    s_nop 0
    v_cvt_pk_bf16_f32 v82, v68, v69
    v_cvt_pk_bf16_f32 v83, v70, v71
    ds_write_b128 v17, v[80:83] offset:9216
gc_40:
    s_waitcnt lgkmcnt(0)
    s_barrier
    s_nop 15
    s_nop 15
    s_nop 15
    s_nop 15
    s_mov_b32 s23, s25
fw_41:
    s_cmp_ge_u32 s85, s94
    s_cbranch_scc1 fo_42
    buffer_load_dword v247, v245, s[4:7], 0 offen sc1
    s_add_u32 s23, s23, 1
    s_waitcnt vmcnt(0)
    v_readfirstlane_b32 s85, v247
    s_cmp_lt_u32 s23, 200000
    s_cbranch_scc1 fw_41
    s_mov_b32 s25, 200000
fo_42:
    buffer_load_dwordx4 v[228:231], v13, s[4:7], s18 offen offset:0 sc1
    buffer_load_dwordx4 v[232:235], v13, s[4:7], s18 offen offset:256 sc1
    s_add_u32 s18, s18, 2048
    s_min_u32 s18, s18, 35780608
    buffer_load_dword v247, v245, s[4:7], 0 offen sc1
    v_mov_b32 v40, 0
    v_mov_b32 v41, 0
    v_mov_b32 v42, 0
    v_mov_b32 v43, 0
    v_mov_b32 v44, 0
    v_mov_b32 v45, 0
    v_mov_b32 v46, 0
    v_mov_b32 v47, 0
    v_mov_b32 v48, 0
    v_mov_b32 v49, 0
    v_mov_b32 v50, 0
    v_mov_b32 v51, 0
    v_mov_b32 v52, 0
    v_mov_b32 v53, 0
    v_mov_b32 v54, 0
    v_mov_b32 v55, 0
    v_mov_b32 v56, 0
    v_mov_b32 v57, 0
    v_mov_b32 v58, 0
    v_mov_b32 v59, 0
    v_mov_b32 v60, 0
    v_mov_b32 v61, 0
    v_mov_b32 v62, 0
    v_mov_b32 v63, 0
    v_mov_b32 v64, 0
    v_mov_b32 v65, 0
    v_mov_b32 v66, 0
    v_mov_b32 v67, 0
    v_mov_b32 v68, 0
    v_mov_b32 v69, 0
    v_mov_b32 v70, 0
    v_mov_b32 v71, 0
    s_mov_b32 s21, s16
    s_mov_b32 s16, s42
    s_mov_b32 s42, s43
    s_mov_b32 s43, s44
    s_mov_b32 s44, s21
    s_add_u32 s95, s95, 524288
    s_lshr_b32 s84, s95, 8
    s_and_b32 s84, s84, 8192
    s_xor_b32 s84, s84, s46
    s_add_u32 s84, s84, s95
    s_add_u32 s15, s15, 1
    s_barrier
    s_branch recur_fast_w1
g_34L15_0:
    s_waitcnt vmcnt(3)
    v_max3_u32 v19, v24, v25, v26
    v_max_u32 v19, v19, v27
    v_cmp_eq_u32 vcc, -1, v19
    s_nop 0
    s_cbranch_vccnz g_34F15_0
    v_smfmac_f32_16x16x64_bf16 v[40:43], v[24:27], a[0:7], v172
    v_smfmac_f32_16x16x64_bf16 v[44:47], v[24:27], a[64:71], v172
    v_smfmac_f32_16x16x64_bf16 v[48:51], v[24:27], a[32:39], v172
    v_smfmac_f32_16x16x64_bf16 v[52:55], v[24:27], a[96:103], v172
g_34L14_1:
    s_waitcnt vmcnt(2)
    v_max3_u32 v19, v28, v29, v30
    v_max_u32 v19, v19, v31
    v_cmp_eq_u32 vcc, -1, v19
    s_nop 0
    s_cbranch_vccnz g_34F14_1
    v_smfmac_f32_16x16x64_bf16 v[40:43], v[28:31], a[8:15], v172
    v_smfmac_f32_16x16x64_bf16 v[44:47], v[28:31], a[72:79], v172
    v_smfmac_f32_16x16x64_bf16 v[48:51], v[28:31], a[40:47], v172
    v_smfmac_f32_16x16x64_bf16 v[52:55], v[28:31], a[104:111], v172
g_34L12_2:
    s_waitcnt vmcnt(1)
    v_max3_u32 v19, v32, v33, v34
    v_max_u32 v19, v19, v35
    v_cmp_eq_u32 vcc, -1, v19
    s_nop 0
    s_cbranch_vccnz g_34F12_2
    v_smfmac_f32_16x16x64_bf16 v[40:43], v[32:35], a[16:23], v172
    v_smfmac_f32_16x16x64_bf16 v[44:47], v[32:35], a[80:87], v172
    v_smfmac_f32_16x16x64_bf16 v[48:51], v[32:35], a[48:55], v172
    v_smfmac_f32_16x16x64_bf16 v[52:55], v[32:35], a[112:119], v172
g_34L8_3:
    s_waitcnt vmcnt(0)
    v_max3_u32 v19, v36, v37, v38
    v_max_u32 v19, v19, v39
    v_cmp_eq_u32 vcc, -1, v19
    s_nop 0
    s_cbranch_vccnz g_34F8_3
    v_smfmac_f32_16x16x64_bf16 v[40:43], v[36:39], a[24:31], v172
    v_smfmac_f32_16x16x64_bf16 v[44:47], v[36:39], a[88:95], v172
    v_smfmac_f32_16x16x64_bf16 v[48:51], v[36:39], a[56:63], v172
    v_smfmac_f32_16x16x64_bf16 v[52:55], v[36:39], a[120:127], v172
    s_branch gc_35
g_34L15_1:
    s_waitcnt vmcnt(3)
    v_max3_u32 v19, v28, v29, v30
    v_max_u32 v19, v19, v31
    v_cmp_eq_u32 vcc, -1, v19
    s_nop 0
    s_cbranch_vccnz g_34F15_1
    v_smfmac_f32_16x16x64_bf16 v[40:43], v[28:31], a[8:15], v172
    v_smfmac_f32_16x16x64_bf16 v[44:47], v[28:31], a[72:79], v172
    v_smfmac_f32_16x16x64_bf16 v[48:51], v[28:31], a[40:47], v172
    v_smfmac_f32_16x16x64_bf16 v[52:55], v[28:31], a[104:111], v172
g_34L13_2:
    s_waitcnt vmcnt(2)
    v_max3_u32 v19, v32, v33, v34
    v_max_u32 v19, v19, v35
    v_cmp_eq_u32 vcc, -1, v19
    s_nop 0
    s_cbranch_vccnz g_34F13_2
    v_smfmac_f32_16x16x64_bf16 v[40:43], v[32:35], a[16:23], v172
    v_smfmac_f32_16x16x64_bf16 v[44:47], v[32:35], a[80:87], v172
    v_smfmac_f32_16x16x64_bf16 v[48:51], v[32:35], a[48:55], v172
    v_smfmac_f32_16x16x64_bf16 v[52:55], v[32:35], a[112:119], v172
g_34L9_3:
    s_waitcnt vmcnt(1)
    v_max3_u32 v19, v36, v37, v38
    v_max_u32 v19, v19, v39
    v_cmp_eq_u32 vcc, -1, v19
    s_nop 0
    s_cbranch_vccnz g_34F9_3
    v_smfmac_f32_16x16x64_bf16 v[40:43], v[36:39], a[24:31], v172
    v_smfmac_f32_16x16x64_bf16 v[44:47], v[36:39], a[88:95], v172
    v_smfmac_f32_16x16x64_bf16 v[48:51], v[36:39], a[56:63], v172
    v_smfmac_f32_16x16x64_bf16 v[52:55], v[36:39], a[120:127], v172
g_34L1_0:
    s_waitcnt vmcnt(0)
    v_max3_u32 v19, v24, v25, v26
    v_max_u32 v19, v19, v27
    v_cmp_eq_u32 vcc, -1, v19
    s_nop 0
    s_cbranch_vccnz g_34F1_0
    v_smfmac_f32_16x16x64_bf16 v[40:43], v[24:27], a[0:7], v172
    v_smfmac_f32_16x16x64_bf16 v[44:47], v[24:27], a[64:71], v172
    v_smfmac_f32_16x16x64_bf16 v[48:51], v[24:27], a[32:39], v172
    v_smfmac_f32_16x16x64_bf16 v[52:55], v[24:27], a[96:103], v172
    s_branch gc_35
g_34L15_2:
    s_waitcnt vmcnt(3)
    v_max3_u32 v19, v32, v33, v34
    v_max_u32 v19, v19, v35
    v_cmp_eq_u32 vcc, -1, v19
    s_nop 0
    s_cbranch_vccnz g_34F15_2
    v_smfmac_f32_16x16x64_bf16 v[40:43], v[32:35], a[16:23], v172
    v_smfmac_f32_16x16x64_bf16 v[44:47], v[32:35], a[80:87], v172
    v_smfmac_f32_16x16x64_bf16 v[48:51], v[32:35], a[48:55], v172
    v_smfmac_f32_16x16x64_bf16 v[52:55], v[32:35], a[112:119], v172
g_34L11_3:
    s_waitcnt vmcnt(2)
    v_max3_u32 v19, v36, v37, v38
    v_max_u32 v19, v19, v39
    v_cmp_eq_u32 vcc, -1, v19
    s_nop 0
    s_cbranch_vccnz g_34F11_3
    v_smfmac_f32_16x16x64_bf16 v[40:43], v[36:39], a[24:31], v172
    v_smfmac_f32_16x16x64_bf16 v[44:47], v[36:39], a[88:95], v172
    v_smfmac_f32_16x16x64_bf16 v[48:51], v[36:39], a[56:63], v172
    v_smfmac_f32_16x16x64_bf16 v[52:55], v[36:39], a[120:127], v172
g_34L3_0:
    s_waitcnt vmcnt(1)
    v_max3_u32 v19, v24, v25, v26
    v_max_u32 v19, v19, v27
    v_cmp_eq_u32 vcc, -1, v19
    s_nop 0
    s_cbranch_vccnz g_34F3_0
    v_smfmac_f32_16x16x64_bf16 v[40:43], v[24:27], a[0:7], v172
    v_smfmac_f32_16x16x64_bf16 v[44:47], v[24:27], a[64:71], v172
    v_smfmac_f32_16x16x64_bf16 v[48:51], v[24:27], a[32:39], v172
    v_smfmac_f32_16x16x64_bf16 v[52:55], v[24:27], a[96:103], v172
g_34L2_1:
    s_waitcnt vmcnt(0)
    v_max3_u32 v19, v28, v29, v30
    v_max_u32 v19, v19, v31
    v_cmp_eq_u32 vcc, -1, v19
    s_nop 0
    s_cbranch_vccnz g_34F2_1
    v_smfmac_f32_16x16x64_bf16 v[40:43], v[28:31], a[8:15], v172
    v_smfmac_f32_16x16x64_bf16 v[44:47], v[28:31], a[72:79], v172
    v_smfmac_f32_16x16x64_bf16 v[48:51], v[28:31], a[40:47], v172
    v_smfmac_f32_16x16x64_bf16 v[52:55], v[28:31], a[104:111], v172
    s_branch gc_35
g_34L15_3:
    s_waitcnt vmcnt(3)
    v_max3_u32 v19, v36, v37, v38
    v_max_u32 v19, v19, v39
    v_cmp_eq_u32 vcc, -1, v19
    s_nop 0
    s_cbranch_vccnz g_34F15_3
    v_smfmac_f32_16x16x64_bf16 v[40:43], v[36:39], a[24:31], v172
    v_smfmac_f32_16x16x64_bf16 v[44:47], v[36:39], a[88:95], v172
    v_smfmac_f32_16x16x64_bf16 v[48:51], v[36:39], a[56:63], v172
    v_smfmac_f32_16x16x64_bf16 v[52:55], v[36:39], a[120:127], v172
g_34L7_0:
    s_waitcnt vmcnt(2)
    v_max3_u32 v19, v24, v25, v26
    v_max_u32 v19, v19, v27
    v_cmp_eq_u32 vcc, -1, v19
    s_nop 0
    s_cbranch_vccnz g_34F7_0
    v_smfmac_f32_16x16x64_bf16 v[40:43], v[24:27], a[0:7], v172
    v_smfmac_f32_16x16x64_bf16 v[44:47], v[24:27], a[64:71], v172
    v_smfmac_f32_16x16x64_bf16 v[48:51], v[24:27], a[32:39], v172
    v_smfmac_f32_16x16x64_bf16 v[52:55], v[24:27], a[96:103], v172
g_34L6_1:
    s_waitcnt vmcnt(1)
    v_max3_u32 v19, v28, v29, v30
    v_max_u32 v19, v19, v31
    v_cmp_eq_u32 vcc, -1, v19
    s_nop 0
    s_cbranch_vccnz g_34F6_1
    v_smfmac_f32_16x16x64_bf16 v[40:43], v[28:31], a[8:15], v172
    v_smfmac_f32_16x16x64_bf16 v[44:47], v[28:31], a[72:79], v172
    v_smfmac_f32_16x16x64_bf16 v[48:51], v[28:31], a[40:47], v172
    v_smfmac_f32_16x16x64_bf16 v[52:55], v[28:31], a[104:111], v172
g_34L4_2:
    s_waitcnt vmcnt(0)
    v_max3_u32 v19, v32, v33, v34
    v_max_u32 v19, v19, v35
    v_cmp_eq_u32 vcc, -1, v19
    s_nop 0
    s_cbranch_vccnz g_34F4_2
    v_smfmac_f32_16x16x64_bf16 v[40:43], v[32:35], a[16:23], v172
    v_smfmac_f32_16x16x64_bf16 v[44:47], v[32:35], a[80:87], v172
    v_smfmac_f32_16x16x64_bf16 v[48:51], v[32:35], a[48:55], v172
    v_smfmac_f32_16x16x64_bf16 v[52:55], v[32:35], a[112:119], v172
    s_branch gc_35
g_34L7_1:
    s_waitcnt vmcnt(2)
    v_max3_u32 v19, v28, v29, v30
    v_max_u32 v19, v19, v31
    v_cmp_eq_u32 vcc, -1, v19
    s_nop 0
    s_cbranch_vccnz g_34F7_1
    v_smfmac_f32_16x16x64_bf16 v[40:43], v[28:31], a[8:15], v172
    v_smfmac_f32_16x16x64_bf16 v[44:47], v[28:31], a[72:79], v172
    v_smfmac_f32_16x16x64_bf16 v[48:51], v[28:31], a[40:47], v172
    v_smfmac_f32_16x16x64_bf16 v[52:55], v[28:31], a[104:111], v172
g_34L5_2:
    s_waitcnt vmcnt(1)
    v_max3_u32 v19, v32, v33, v34
    v_max_u32 v19, v19, v35
    v_cmp_eq_u32 vcc, -1, v19
    s_nop 0
    s_cbranch_vccnz g_34F5_2
    v_smfmac_f32_16x16x64_bf16 v[40:43], v[32:35], a[16:23], v172
    v_smfmac_f32_16x16x64_bf16 v[44:47], v[32:35], a[80:87], v172
    v_smfmac_f32_16x16x64_bf16 v[48:51], v[32:35], a[48:55], v172
    v_smfmac_f32_16x16x64_bf16 v[52:55], v[32:35], a[112:119], v172
    s_branch g_34L1_0
g_34L7_2:
    s_waitcnt vmcnt(2)
    v_max3_u32 v19, v32, v33, v34
    v_max_u32 v19, v19, v35
    v_cmp_eq_u32 vcc, -1, v19
    s_nop 0
    s_cbranch_vccnz g_34F7_2
    v_smfmac_f32_16x16x64_bf16 v[40:43], v[32:35], a[16:23], v172
    v_smfmac_f32_16x16x64_bf16 v[44:47], v[32:35], a[80:87], v172
    v_smfmac_f32_16x16x64_bf16 v[48:51], v[32:35], a[48:55], v172
    v_smfmac_f32_16x16x64_bf16 v[52:55], v[32:35], a[112:119], v172
    s_branch g_34L3_0
g_34L11_0:
    s_waitcnt vmcnt(2)
    v_max3_u32 v19, v24, v25, v26
    v_max_u32 v19, v19, v27
    v_cmp_eq_u32 vcc, -1, v19
    s_nop 0
    s_cbranch_vccnz g_34F11_0
    v_smfmac_f32_16x16x64_bf16 v[40:43], v[24:27], a[0:7], v172
    v_smfmac_f32_16x16x64_bf16 v[44:47], v[24:27], a[64:71], v172
    v_smfmac_f32_16x16x64_bf16 v[48:51], v[24:27], a[32:39], v172
    v_smfmac_f32_16x16x64_bf16 v[52:55], v[24:27], a[96:103], v172
g_34L10_1:
    s_waitcnt vmcnt(1)
    v_max3_u32 v19, v28, v29, v30
    v_max_u32 v19, v19, v31
    v_cmp_eq_u32 vcc, -1, v19
    s_nop 0
    s_cbranch_vccnz g_34F10_1
    v_smfmac_f32_16x16x64_bf16 v[40:43], v[28:31], a[8:15], v172
    v_smfmac_f32_16x16x64_bf16 v[44:47], v[28:31], a[72:79], v172
    v_smfmac_f32_16x16x64_bf16 v[48:51], v[28:31], a[40:47], v172
    v_smfmac_f32_16x16x64_bf16 v[52:55], v[28:31], a[104:111], v172
    s_branch g_34L8_3
g_34L11_1:
    s_waitcnt vmcnt(2)
    v_max3_u32 v19, v28, v29, v30
    v_max_u32 v19, v19, v31
    v_cmp_eq_u32 vcc, -1, v19
    s_nop 0
    s_cbranch_vccnz g_34F11_1
    v_smfmac_f32_16x16x64_bf16 v[40:43], v[28:31], a[8:15], v172
    v_smfmac_f32_16x16x64_bf16 v[44:47], v[28:31], a[72:79], v172
    v_smfmac_f32_16x16x64_bf16 v[48:51], v[28:31], a[40:47], v172
    v_smfmac_f32_16x16x64_bf16 v[52:55], v[28:31], a[104:111], v172
    s_branch g_34L9_3
g_34L13_0:
    s_waitcnt vmcnt(2)
    v_max3_u32 v19, v24, v25, v26
    v_max_u32 v19, v19, v27
    v_cmp_eq_u32 vcc, -1, v19
    s_nop 0
    s_cbranch_vccnz g_34F13_0
    v_smfmac_f32_16x16x64_bf16 v[40:43], v[24:27], a[0:7], v172
    v_smfmac_f32_16x16x64_bf16 v[44:47], v[24:27], a[64:71], v172
    v_smfmac_f32_16x16x64_bf16 v[48:51], v[24:27], a[32:39], v172
    v_smfmac_f32_16x16x64_bf16 v[52:55], v[24:27], a[96:103], v172
    s_branch g_34L12_2
g_34L13_3:
    s_waitcnt vmcnt(2)
    v_max3_u32 v19, v36, v37, v38
    v_max_u32 v19, v19, v39
    v_cmp_eq_u32 vcc, -1, v19
    s_nop 0
    s_cbranch_vccnz g_34F13_3
    v_smfmac_f32_16x16x64_bf16 v[40:43], v[36:39], a[24:31], v172
    v_smfmac_f32_16x16x64_bf16 v[44:47], v[36:39], a[88:95], v172
    v_smfmac_f32_16x16x64_bf16 v[48:51], v[36:39], a[56:63], v172
    v_smfmac_f32_16x16x64_bf16 v[52:55], v[36:39], a[120:127], v172
g_34L5_0:
    s_waitcnt vmcnt(1)
    v_max3_u32 v19, v24, v25, v26
    v_max_u32 v19, v19, v27
    v_cmp_eq_u32 vcc, -1, v19
    s_nop 0
    s_cbranch_vccnz g_34F5_0
    v_smfmac_f32_16x16x64_bf16 v[40:43], v[24:27], a[0:7], v172
    v_smfmac_f32_16x16x64_bf16 v[44:47], v[24:27], a[64:71], v172
    v_smfmac_f32_16x16x64_bf16 v[48:51], v[24:27], a[32:39], v172
    v_smfmac_f32_16x16x64_bf16 v[52:55], v[24:27], a[96:103], v172
    s_branch g_34L4_2
g_34L14_2:
    s_waitcnt vmcnt(2)
    v_max3_u32 v19, v32, v33, v34
    v_max_u32 v19, v19, v35
    v_cmp_eq_u32 vcc, -1, v19
    s_nop 0
    s_cbranch_vccnz g_34F14_2
    v_smfmac_f32_16x16x64_bf16 v[40:43], v[32:35], a[16:23], v172
    v_smfmac_f32_16x16x64_bf16 v[44:47], v[32:35], a[80:87], v172
    v_smfmac_f32_16x16x64_bf16 v[48:51], v[32:35], a[48:55], v172
    v_smfmac_f32_16x16x64_bf16 v[52:55], v[32:35], a[112:119], v172
g_34L10_3:
    s_waitcnt vmcnt(1)
    v_max3_u32 v19, v36, v37, v38
    v_max_u32 v19, v19, v39
    v_cmp_eq_u32 vcc, -1, v19
    s_nop 0
    s_cbranch_vccnz g_34F10_3
    v_smfmac_f32_16x16x64_bf16 v[40:43], v[36:39], a[24:31], v172
    v_smfmac_f32_16x16x64_bf16 v[44:47], v[36:39], a[88:95], v172
    v_smfmac_f32_16x16x64_bf16 v[48:51], v[36:39], a[56:63], v172
    v_smfmac_f32_16x16x64_bf16 v[52:55], v[36:39], a[120:127], v172
    s_branch g_34L2_1
g_34L14_3:
    s_waitcnt vmcnt(2)
    v_max3_u32 v19, v36, v37, v38
    v_max_u32 v19, v19, v39
    v_cmp_eq_u32 vcc, -1, v19
    s_nop 0
    s_cbranch_vccnz g_34F14_3
    v_smfmac_f32_16x16x64_bf16 v[40:43], v[36:39], a[24:31], v172
    v_smfmac_f32_16x16x64_bf16 v[44:47], v[36:39], a[88:95], v172
    v_smfmac_f32_16x16x64_bf16 v[48:51], v[36:39], a[56:63], v172
    v_smfmac_f32_16x16x64_bf16 v[52:55], v[36:39], a[120:127], v172
    s_branch g_34L6_1
g_34L3_1:
    s_waitcnt vmcnt(1)
    v_max3_u32 v19, v28, v29, v30
    v_max_u32 v19, v19, v31
    v_cmp_eq_u32 vcc, -1, v19
    s_nop 0
    s_cbranch_vccnz g_34F3_1
    v_smfmac_f32_16x16x64_bf16 v[40:43], v[28:31], a[8:15], v172
    v_smfmac_f32_16x16x64_bf16 v[44:47], v[28:31], a[72:79], v172
    v_smfmac_f32_16x16x64_bf16 v[48:51], v[28:31], a[40:47], v172
    v_smfmac_f32_16x16x64_bf16 v[52:55], v[28:31], a[104:111], v172
    s_branch g_34L1_0
g_34L6_2:
    s_waitcnt vmcnt(1)
    v_max3_u32 v19, v32, v33, v34
    v_max_u32 v19, v19, v35
    v_cmp_eq_u32 vcc, -1, v19
    s_nop 0
    s_cbranch_vccnz g_34F6_2
    v_smfmac_f32_16x16x64_bf16 v[40:43], v[32:35], a[16:23], v172
    v_smfmac_f32_16x16x64_bf16 v[44:47], v[32:35], a[80:87], v172
    v_smfmac_f32_16x16x64_bf16 v[48:51], v[32:35], a[48:55], v172
    v_smfmac_f32_16x16x64_bf16 v[52:55], v[32:35], a[112:119], v172
    s_branch g_34L2_1
g_34L9_0:
    s_waitcnt vmcnt(1)
    v_max3_u32 v19, v24, v25, v26
    v_max_u32 v19, v19, v27
    v_cmp_eq_u32 vcc, -1, v19
    s_nop 0
    s_cbranch_vccnz g_34F9_0
    v_smfmac_f32_16x16x64_bf16 v[40:43], v[24:27], a[0:7], v172
    v_smfmac_f32_16x16x64_bf16 v[44:47], v[24:27], a[64:71], v172
    v_smfmac_f32_16x16x64_bf16 v[48:51], v[24:27], a[32:39], v172
    v_smfmac_f32_16x16x64_bf16 v[52:55], v[24:27], a[96:103], v172
    s_branch g_34L8_3
g_34L12_3:
    s_waitcnt vmcnt(1)
    v_max3_u32 v19, v36, v37, v38
    v_max_u32 v19, v19, v39
    v_cmp_eq_u32 vcc, -1, v19
    s_nop 0
    s_cbranch_vccnz g_34F12_3
    v_smfmac_f32_16x16x64_bf16 v[40:43], v[36:39], a[24:31], v172
    v_smfmac_f32_16x16x64_bf16 v[44:47], v[36:39], a[88:95], v172
    v_smfmac_f32_16x16x64_bf16 v[48:51], v[36:39], a[56:63], v172
    v_smfmac_f32_16x16x64_bf16 v[52:55], v[36:39], a[120:127], v172
    s_branch g_34L4_2
g_34F15_0:
    s_mov_b64 exec, vcc
    buffer_load_dwordx4 v[24:27], v2, s[4:7], s16 offen offset:0 sc1
    s_mov_b64 exec, -1
    s_add_u32 s23, s23, 1
    s_cmp_lt_u32 s23, 200000
    s_cbranch_scc1 g_34L15_1
    s_mov_b32 s25, 200000
    s_branch gc_35
g_34F15_1:
    s_mov_b64 exec, vcc
    buffer_load_dwordx4 v[28:31], v2, s[4:7], s16 offen offset:1024 sc1
    s_mov_b64 exec, -1
    s_add_u32 s23, s23, 1
    s_cmp_lt_u32 s23, 200000
    s_cbranch_scc1 g_34L15_2
    s_mov_b32 s25, 200000
    s_branch gc_35
g_34F15_2:
    s_mov_b64 exec, vcc
    buffer_load_dwordx4 v[32:35], v2, s[4:7], s16 offen offset:2048 sc1
    s_mov_b64 exec, -1
    s_add_u32 s23, s23, 1
    s_cmp_lt_u32 s23, 200000
    s_cbranch_scc1 g_34L15_3
    s_mov_b32 s25, 200000
    s_branch gc_35
g_34F15_3:
    s_mov_b64 exec, vcc
    buffer_load_dwordx4 v[36:39], v2, s[4:7], s16 offen offset:3072 sc1
    s_mov_b64 exec, -1
    s_add_u32 s23, s23, 1
    s_cmp_lt_u32 s23, 200000
    s_cbranch_scc1 g_34L15_0
    s_mov_b32 s25, 200000
    s_branch gc_35
g_34F7_0:
    s_mov_b64 exec, vcc
    buffer_load_dwordx4 v[24:27], v2, s[4:7], s16 offen offset:0 sc1
    s_mov_b64 exec, -1
    s_add_u32 s23, s23, 1
    s_cmp_lt_u32 s23, 200000
    s_cbranch_scc1 g_34L7_1
    s_mov_b32 s25, 200000
    s_branch gc_35
g_34F7_1:
    s_mov_b64 exec, vcc
    buffer_load_dwordx4 v[28:31], v2, s[4:7], s16 offen offset:1024 sc1
    s_mov_b64 exec, -1
    s_add_u32 s23, s23, 1
    s_cmp_lt_u32 s23, 200000
    s_cbranch_scc1 g_34L7_2
    s_mov_b32 s25, 200000
    s_branch gc_35
g_34F7_2:
    s_mov_b64 exec, vcc
    buffer_load_dwordx4 v[32:35], v2, s[4:7], s16 offen offset:2048 sc1
    s_mov_b64 exec, -1
    s_add_u32 s23, s23, 1
    s_cmp_lt_u32 s23, 200000
    s_cbranch_scc1 g_34L7_0
    s_mov_b32 s25, 200000
    s_branch gc_35
g_34F11_0:
    s_mov_b64 exec, vcc
    buffer_load_dwordx4 v[24:27], v2, s[4:7], s16 offen offset:0 sc1
    s_mov_b64 exec, -1
    s_add_u32 s23, s23, 1
    s_cmp_lt_u32 s23, 200000
    s_cbranch_scc1 g_34L11_1
    s_mov_b32 s25, 200000
    s_branch gc_35
g_34F11_1:
    s_mov_b64 exec, vcc
    buffer_load_dwordx4 v[28:31], v2, s[4:7], s16 offen offset:1024 sc1
    s_mov_b64 exec, -1
    s_add_u32 s23, s23, 1
    s_cmp_lt_u32 s23, 200000
    s_cbranch_scc1 g_34L11_3
    s_mov_b32 s25, 200000
    s_branch gc_35
g_34F11_3:
    s_mov_b64 exec, vcc
    buffer_load_dwordx4 v[36:39], v2, s[4:7], s16 offen offset:3072 sc1
    s_mov_b64 exec, -1
    s_add_u32 s23, s23, 1
    s_cmp_lt_u32 s23, 200000
    s_cbranch_scc1 g_34L11_0
    s_mov_b32 s25, 200000
    s_branch gc_35
g_34F13_0:
    s_mov_b64 exec, vcc
    buffer_load_dwordx4 v[24:27], v2, s[4:7], s16 offen offset:0 sc1
    s_mov_b64 exec, -1
    s_add_u32 s23, s23, 1
    s_cmp_lt_u32 s23, 200000
    s_cbranch_scc1 g_34L13_2
    s_mov_b32 s25, 200000
    s_branch gc_35
g_34F13_2:
    s_mov_b64 exec, vcc
    buffer_load_dwordx4 v[32:35], v2, s[4:7], s16 offen offset:2048 sc1
    s_mov_b64 exec, -1
    s_add_u32 s23, s23, 1
    s_cmp_lt_u32 s23, 200000
    s_cbranch_scc1 g_34L13_3
    s_mov_b32 s25, 200000
    s_branch gc_35
g_34F13_3:
    s_mov_b64 exec, vcc
    buffer_load_dwordx4 v[36:39], v2, s[4:7], s16 offen offset:3072 sc1
    s_mov_b64 exec, -1
    s_add_u32 s23, s23, 1
    s_cmp_lt_u32 s23, 200000
    s_cbranch_scc1 g_34L13_0
    s_mov_b32 s25, 200000
    s_branch gc_35
g_34F14_1:
    s_mov_b64 exec, vcc
    buffer_load_dwordx4 v[28:31], v2, s[4:7], s16 offen offset:1024 sc1
    s_mov_b64 exec, -1
    s_add_u32 s23, s23, 1
    s_cmp_lt_u32 s23, 200000
    s_cbranch_scc1 g_34L14_2
    s_mov_b32 s25, 200000
    s_branch gc_35
g_34F14_2:
    s_mov_b64 exec, vcc
    buffer_load_dwordx4 v[32:35], v2, s[4:7], s16 offen offset:2048 sc1
    s_mov_b64 exec, -1
    s_add_u32 s23, s23, 1
    s_cmp_lt_u32 s23, 200000
    s_cbranch_scc1 g_34L14_3
    s_mov_b32 s25, 200000
    s_branch gc_35
g_34F14_3:
    s_mov_b64 exec, vcc
    buffer_load_dwordx4 v[36:39], v2, s[4:7], s16 offen offset:3072 sc1
    s_mov_b64 exec, -1
    s_add_u32 s23, s23, 1
    s_cmp_lt_u32 s23, 200000
    s_cbranch_scc1 g_34L14_1
    s_mov_b32 s25, 200000
    s_branch gc_35
g_34F3_0:
    s_mov_b64 exec, vcc
    buffer_load_dwordx4 v[24:27], v2, s[4:7], s16 offen offset:0 sc1
    s_mov_b64 exec, -1
    s_add_u32 s23, s23, 1
    s_cmp_lt_u32 s23, 200000
    s_cbranch_scc1 g_34L3_1
    s_mov_b32 s25, 200000
    s_branch gc_35
g_34F3_1:
    s_mov_b64 exec, vcc
    buffer_load_dwordx4 v[28:31], v2, s[4:7], s16 offen offset:1024 sc1
    s_mov_b64 exec, -1
    s_add_u32 s23, s23, 1
    s_cmp_lt_u32 s23, 200000
    s_cbranch_scc1 g_34L3_0
    s_mov_b32 s25, 200000
    s_branch gc_35
g_34F5_0:
    s_mov_b64 exec, vcc
    buffer_load_dwordx4 v[24:27], v2, s[4:7], s16 offen offset:0 sc1
    s_mov_b64 exec, -1
    s_add_u32 s23, s23, 1
    s_cmp_lt_u32 s23, 200000
    s_cbranch_scc1 g_34L5_2
    s_mov_b32 s25, 200000
    s_branch gc_35
g_34F5_2:
    s_mov_b64 exec, vcc
    buffer_load_dwordx4 v[32:35], v2, s[4:7], s16 offen offset:2048 sc1
    s_mov_b64 exec, -1
    s_add_u32 s23, s23, 1
    s_cmp_lt_u32 s23, 200000
    s_cbranch_scc1 g_34L5_0
    s_mov_b32 s25, 200000
    s_branch gc_35
g_34F6_1:
    s_mov_b64 exec, vcc
    buffer_load_dwordx4 v[28:31], v2, s[4:7], s16 offen offset:1024 sc1
    s_mov_b64 exec, -1
    s_add_u32 s23, s23, 1
    s_cmp_lt_u32 s23, 200000
    s_cbranch_scc1 g_34L6_2
    s_mov_b32 s25, 200000
    s_branch gc_35
g_34F6_2:
    s_mov_b64 exec, vcc
    buffer_load_dwordx4 v[32:35], v2, s[4:7], s16 offen offset:2048 sc1
    s_mov_b64 exec, -1
    s_add_u32 s23, s23, 1
    s_cmp_lt_u32 s23, 200000
    s_cbranch_scc1 g_34L6_1
    s_mov_b32 s25, 200000
    s_branch gc_35
g_34F9_0:
    s_mov_b64 exec, vcc
    buffer_load_dwordx4 v[24:27], v2, s[4:7], s16 offen offset:0 sc1
    s_mov_b64 exec, -1
    s_add_u32 s23, s23, 1
    s_cmp_lt_u32 s23, 200000
    s_cbranch_scc1 g_34L9_3
    s_mov_b32 s25, 200000
    s_branch gc_35
g_34F9_3:
    s_mov_b64 exec, vcc
    buffer_load_dwordx4 v[36:39], v2, s[4:7], s16 offen offset:3072 sc1
    s_mov_b64 exec, -1
    s_add_u32 s23, s23, 1
    s_cmp_lt_u32 s23, 200000
    s_cbranch_scc1 g_34L9_0
    s_mov_b32 s25, 200000
    s_branch gc_35
g_34F10_1:
    s_mov_b64 exec, vcc
    buffer_load_dwordx4 v[28:31], v2, s[4:7], s16 offen offset:1024 sc1
    s_mov_b64 exec, -1
    s_add_u32 s23, s23, 1
    s_cmp_lt_u32 s23, 200000
    s_cbranch_scc1 g_34L10_3
    s_mov_b32 s25, 200000
    s_branch gc_35
g_34F10_3:
    s_mov_b64 exec, vcc
    buffer_load_dwordx4 v[36:39], v2, s[4:7], s16 offen offset:3072 sc1
    s_mov_b64 exec, -1
    s_add_u32 s23, s23, 1
    s_cmp_lt_u32 s23, 200000
    s_cbranch_scc1 g_34L10_1
    s_mov_b32 s25, 200000
    s_branch gc_35
g_34F12_2:
    s_mov_b64 exec, vcc
    buffer_load_dwordx4 v[32:35], v2, s[4:7], s16 offen offset:2048 sc1
    s_mov_b64 exec, -1
    s_add_u32 s23, s23, 1
    s_cmp_lt_u32 s23, 200000
    s_cbranch_scc1 g_34L12_3
    s_mov_b32 s25, 200000
    s_branch gc_35
g_34F12_3:
    s_mov_b64 exec, vcc
    buffer_load_dwordx4 v[36:39], v2, s[4:7], s16 offen offset:3072 sc1
    s_mov_b64 exec, -1
    s_add_u32 s23, s23, 1
    s_cmp_lt_u32 s23, 200000
    s_cbranch_scc1 g_34L12_2
    s_mov_b32 s25, 200000
    s_branch gc_35
g_34F1_0:
    s_mov_b64 exec, vcc
    buffer_load_dwordx4 v[24:27], v2, s[4:7], s16 offen offset:0 sc1
    s_mov_b64 exec, -1
    s_add_u32 s23, s23, 1
    s_cmp_lt_u32 s23, 200000
    s_cbranch_scc1 g_34L1_0
    s_mov_b32 s25, 200000
    s_branch gc_35
g_34F2_1:
    s_mov_b64 exec, vcc
    buffer_load_dwordx4 v[28:31], v2, s[4:7], s16 offen offset:1024 sc1
    s_mov_b64 exec, -1
    s_add_u32 s23, s23, 1
    s_cmp_lt_u32 s23, 200000
    s_cbranch_scc1 g_34L2_1
    s_mov_b32 s25, 200000
    s_branch gc_35
g_34F4_2:
    s_mov_b64 exec, vcc
    buffer_load_dwordx4 v[32:35], v2, s[4:7], s16 offen offset:2048 sc1
    s_mov_b64 exec, -1
    s_add_u32 s23, s23, 1
    s_cmp_lt_u32 s23, 200000
    s_cbranch_scc1 g_34L4_2
    s_mov_b32 s25, 200000
    s_branch gc_35
g_34F8_3:
    s_mov_b64 exec, vcc
    buffer_load_dwordx4 v[36:39], v2, s[4:7], s16 offen offset:3072 sc1
    s_mov_b64 exec, -1
    s_add_u32 s23, s23, 1
    s_cmp_lt_u32 s23, 200000
    s_cbranch_scc1 g_34L8_3
    s_mov_b32 s25, 200000
    s_branch gc_35
sb_37:
    v_max3_u32 v19, v24, v25, v26
    v_max3_u32 v19, v19, v27, v28
    v_max3_u32 v19, v19, v29, v30
    v_max3_u32 v19, v19, v31, v32
    v_max3_u32 v19, v19, v33, v34
    v_max3_u32 v19, v19, v35, v36
    v_max3_u32 v19, v19, v37, v38
    v_max3_u32 v19, v19, v39, v40
    v_max3_u32 v19, v19, v41, v42
    v_max_u32 v19, v19, v43
    v_cmp_eq_u32 vcc, -1, v19
    s_nop 0
    s_cbranch_vccz sg_38
    buffer_load_dwordx4 v[24:27], v5, s[4:7], s16 offen offset:0 sc1
    buffer_load_dwordx4 v[28:31], v5, s[4:7], s16 offen offset:1024 sc1
    buffer_load_dwordx4 v[32:35], v5, s[4:7], s16 offen offset:2048 sc1
    buffer_load_dwordx4 v[36:39], v5, s[4:7], s16 offen offset:3072 sc1
    buffer_load_dword v40, v6, s[4:7], s16 offen offset:0 sc1
    buffer_load_dword v41, v6, s[4:7], s16 offen offset:256 sc1
    buffer_load_dword v42, v6, s[4:7], s16 offen offset:512 sc1
    buffer_load_dword v43, v6, s[4:7], s16 offen offset:768 sc1
    s_add_u32 s23, s23, 1
    s_cmp_lt_u32 s23, 200000
    s_cbranch_scc1 ss_36
    s_mov_b32 s25, 200000
    s_branch sg_38
ss_36:
    s_waitcnt vmcnt(6)
    v_pk_add_f32 v[180:181], v[24:25], v[28:29]
    v_pk_add_f32 v[182:183], v[26:27], v[30:31]
    s_waitcnt vmcnt(4)
    v_pk_add_f32 v[188:189], v[32:33], v[36:37]
    v_pk_add_f32 v[190:191], v[34:35], v[38:39]
    v_pk_add_f32 v[180:181], v[180:181], v[188:189]
    v_pk_add_f32 v[182:183], v[182:183], v[190:191]
    v_pk_add_f32 v[188:189], v[180:181], v[182:183]
    v_max3_f32 v185, v180, v181, v182
    s_waitcnt vmcnt(0)
    v_pk_add_f32 v[192:193], v[40:41], v[42:43]
    v_add_f32 v188, v188, v189
    v_add_f32 v184, v192, v193
    v_max3_f32 v185, v185, v183, v184
    v_cmp_u_f32 vcc, v188, v184
    s_nop 0
    v_max_f32_dpp v185, v185, v185 row_ror:8 row_mask:0xf bank_mask:0xf
    v_mov_b32 v186, v185
    s_nop 1
    v_permlane16_swap_b32 v185, v186
    v_max_f32 v185, v185, v186
    v_mov_b32 v186, v185
    s_cbranch_vccnz sb_37
    s_branch sg_38
g_39L15_0:
    s_waitcnt vmcnt(3)
    v_max3_u32 v19, v24, v25, v26
    v_max_u32 v19, v19, v27
    v_cmp_eq_u32 vcc, -1, v19
    s_nop 0
    s_cbranch_vccnz g_39F15_0
    v_smfmac_f32_16x16x64_bf16 v[64:67], v[24:27], a[192:199], v172
    v_smfmac_f32_16x16x64_bf16 v[68:71], v[24:27], a[224:231], v172
g_39L14_1:
    s_waitcnt vmcnt(2)
    v_max3_u32 v19, v28, v29, v30
    v_max_u32 v19, v19, v31
    v_cmp_eq_u32 vcc, -1, v19
    s_nop 0
    s_cbranch_vccnz g_39F14_1
    v_smfmac_f32_16x16x64_bf16 v[64:67], v[28:31], a[200:207], v172
    v_smfmac_f32_16x16x64_bf16 v[68:71], v[28:31], a[232:239], v172
g_39L12_2:
    s_waitcnt vmcnt(1)
    v_max3_u32 v19, v32, v33, v34
    v_max_u32 v19, v19, v35
    v_cmp_eq_u32 vcc, -1, v19
    s_nop 0
    s_cbranch_vccnz g_39F12_2
    v_smfmac_f32_16x16x64_bf16 v[64:67], v[32:35], a[208:215], v172
    v_smfmac_f32_16x16x64_bf16 v[68:71], v[32:35], a[240:247], v172
g_39L8_3:
    s_waitcnt vmcnt(0)
    v_max3_u32 v19, v36, v37, v38
    v_max_u32 v19, v19, v39
    v_cmp_eq_u32 vcc, -1, v19
    s_nop 0
    s_cbranch_vccnz g_39F8_3
    v_smfmac_f32_16x16x64_bf16 v[64:67], v[36:39], a[216:223], v172
    v_smfmac_f32_16x16x64_bf16 v[68:71], v[36:39], a[248:255], v172
    s_nop 4
    v_cvt_pk_bf16_f32 v80, v64, v65
    v_cvt_pk_bf16_f32 v81, v66, v67
    s_nop 0
    v_cvt_pk_bf16_f32 v82, v68, v69
    v_cvt_pk_bf16_f32 v83, v70, v71
    ds_write_b128 v17, v[80:83] offset:9216
    s_branch gc_40
g_39L15_1:
    s_waitcnt vmcnt(3)
    v_max3_u32 v19, v28, v29, v30
    v_max_u32 v19, v19, v31
    v_cmp_eq_u32 vcc, -1, v19
    s_nop 0
    s_cbranch_vccnz g_39F15_1
    v_smfmac_f32_16x16x64_bf16 v[64:67], v[28:31], a[200:207], v172
    v_smfmac_f32_16x16x64_bf16 v[68:71], v[28:31], a[232:239], v172
g_39L13_2:
    s_waitcnt vmcnt(2)
    v_max3_u32 v19, v32, v33, v34
    v_max_u32 v19, v19, v35
    v_cmp_eq_u32 vcc, -1, v19
    s_nop 0
    s_cbranch_vccnz g_39F13_2
    v_smfmac_f32_16x16x64_bf16 v[64:67], v[32:35], a[208:215], v172
    v_smfmac_f32_16x16x64_bf16 v[68:71], v[32:35], a[240:247], v172
g_39L9_3:
    s_waitcnt vmcnt(1)
    v_max3_u32 v19, v36, v37, v38
    v_max_u32 v19, v19, v39
    v_cmp_eq_u32 vcc, -1, v19
    s_nop 0
    s_cbranch_vccnz g_39F9_3
    v_smfmac_f32_16x16x64_bf16 v[64:67], v[36:39], a[216:223], v172
    v_smfmac_f32_16x16x64_bf16 v[68:71], v[36:39], a[248:255], v172
g_39L1_0:
    s_waitcnt vmcnt(0)
    v_max3_u32 v19, v24, v25, v26
    v_max_u32 v19, v19, v27
    v_cmp_eq_u32 vcc, -1, v19
    s_nop 0
    s_cbranch_vccnz g_39F1_0
    v_smfmac_f32_16x16x64_bf16 v[64:67], v[24:27], a[192:199], v172
    v_smfmac_f32_16x16x64_bf16 v[68:71], v[24:27], a[224:231], v172
    s_nop 4
    v_cvt_pk_bf16_f32 v80, v64, v65
    v_cvt_pk_bf16_f32 v81, v66, v67
    s_nop 0
    v_cvt_pk_bf16_f32 v82, v68, v69
    v_cvt_pk_bf16_f32 v83, v70, v71
    ds_write_b128 v17, v[80:83] offset:9216
    s_branch gc_40
g_39L15_2:
    s_waitcnt vmcnt(3)
    v_max3_u32 v19, v32, v33, v34
    v_max_u32 v19, v19, v35
    v_cmp_eq_u32 vcc, -1, v19
    s_nop 0
    s_cbranch_vccnz g_39F15_2
    v_smfmac_f32_16x16x64_bf16 v[64:67], v[32:35], a[208:215], v172
    v_smfmac_f32_16x16x64_bf16 v[68:71], v[32:35], a[240:247], v172
g_39L11_3:
    s_waitcnt vmcnt(2)
    v_max3_u32 v19, v36, v37, v38
    v_max_u32 v19, v19, v39
    v_cmp_eq_u32 vcc, -1, v19
    s_nop 0
    s_cbranch_vccnz g_39F11_3
    v_smfmac_f32_16x16x64_bf16 v[64:67], v[36:39], a[216:223], v172
    v_smfmac_f32_16x16x64_bf16 v[68:71], v[36:39], a[248:255], v172
g_39L3_0:
    s_waitcnt vmcnt(1)
    v_max3_u32 v19, v24, v25, v26
    v_max_u32 v19, v19, v27
    v_cmp_eq_u32 vcc, -1, v19
    s_nop 0
    s_cbranch_vccnz g_39F3_0
    v_smfmac_f32_16x16x64_bf16 v[64:67], v[24:27], a[192:199], v172
    v_smfmac_f32_16x16x64_bf16 v[68:71], v[24:27], a[224:231], v172
g_39L2_1:
    s_waitcnt vmcnt(0)
    v_max3_u32 v19, v28, v29, v30
    v_max_u32 v19, v19, v31
    v_cmp_eq_u32 vcc, -1, v19
    s_nop 0
    s_cbranch_vccnz g_39F2_1
    v_smfmac_f32_16x16x64_bf16 v[64:67], v[28:31], a[200:207], v172
    v_smfmac_f32_16x16x64_bf16 v[68:71], v[28:31], a[232:239], v172
    s_nop 4
    v_cvt_pk_bf16_f32 v80, v64, v65
    v_cvt_pk_bf16_f32 v81, v66, v67
    s_nop 0
    v_cvt_pk_bf16_f32 v82, v68, v69
    v_cvt_pk_bf16_f32 v83, v70, v71
    ds_write_b128 v17, v[80:83] offset:9216
    s_branch gc_40
g_39L15_3:
    s_waitcnt vmcnt(3)
    v_max3_u32 v19, v36, v37, v38
    v_max_u32 v19, v19, v39
    v_cmp_eq_u32 vcc, -1, v19
    s_nop 0
    s_cbranch_vccnz g_39F15_3
    v_smfmac_f32_16x16x64_bf16 v[64:67], v[36:39], a[216:223], v172
    v_smfmac_f32_16x16x64_bf16 v[68:71], v[36:39], a[248:255], v172
g_39L7_0:
    s_waitcnt vmcnt(2)
    v_max3_u32 v19, v24, v25, v26
    v_max_u32 v19, v19, v27
    v_cmp_eq_u32 vcc, -1, v19
    s_nop 0
    s_cbranch_vccnz g_39F7_0
    v_smfmac_f32_16x16x64_bf16 v[64:67], v[24:27], a[192:199], v172
    v_smfmac_f32_16x16x64_bf16 v[68:71], v[24:27], a[224:231], v172
g_39L6_1:
    s_waitcnt vmcnt(1)
    v_max3_u32 v19, v28, v29, v30
    v_max_u32 v19, v19, v31
    v_cmp_eq_u32 vcc, -1, v19
    s_nop 0
    s_cbranch_vccnz g_39F6_1
    v_smfmac_f32_16x16x64_bf16 v[64:67], v[28:31], a[200:207], v172
    v_smfmac_f32_16x16x64_bf16 v[68:71], v[28:31], a[232:239], v172
g_39L4_2:
    s_waitcnt vmcnt(0)
    v_max3_u32 v19, v32, v33, v34
    v_max_u32 v19, v19, v35
    v_cmp_eq_u32 vcc, -1, v19
    s_nop 0
    s_cbranch_vccnz g_39F4_2
    v_smfmac_f32_16x16x64_bf16 v[64:67], v[32:35], a[208:215], v172
    v_smfmac_f32_16x16x64_bf16 v[68:71], v[32:35], a[240:247], v172
    s_nop 4
    v_cvt_pk_bf16_f32 v80, v64, v65
    v_cvt_pk_bf16_f32 v81, v66, v67
    s_nop 0
    v_cvt_pk_bf16_f32 v82, v68, v69
    v_cvt_pk_bf16_f32 v83, v70, v71
    ds_write_b128 v17, v[80:83] offset:9216
    s_branch gc_40
g_39L7_1:
    s_waitcnt vmcnt(2)
    v_max3_u32 v19, v28, v29, v30
    v_max_u32 v19, v19, v31
    v_cmp_eq_u32 vcc, -1, v19
    s_nop 0
    s_cbranch_vccnz g_39F7_1
    v_smfmac_f32_16x16x64_bf16 v[64:67], v[28:31], a[200:207], v172
    v_smfmac_f32_16x16x64_bf16 v[68:71], v[28:31], a[232:239], v172
g_39L5_2:
    s_waitcnt vmcnt(1)
    v_max3_u32 v19, v32, v33, v34
    v_max_u32 v19, v19, v35
    v_cmp_eq_u32 vcc, -1, v19
    s_nop 0
    s_cbranch_vccnz g_39F5_2
    v_smfmac_f32_16x16x64_bf16 v[64:67], v[32:35], a[208:215], v172
    v_smfmac_f32_16x16x64_bf16 v[68:71], v[32:35], a[240:247], v172
    s_branch g_39L1_0
g_39L7_2:
    s_waitcnt vmcnt(2)
    v_max3_u32 v19, v32, v33, v34
    v_max_u32 v19, v19, v35
    v_cmp_eq_u32 vcc, -1, v19
    s_nop 0
    s_cbranch_vccnz g_39F7_2
    v_smfmac_f32_16x16x64_bf16 v[64:67], v[32:35], a[208:215], v172
    v_smfmac_f32_16x16x64_bf16 v[68:71], v[32:35], a[240:247], v172
    s_branch g_39L3_0
g_39L11_0:
    s_waitcnt vmcnt(2)
    v_max3_u32 v19, v24, v25, v26
    v_max_u32 v19, v19, v27
    v_cmp_eq_u32 vcc, -1, v19
    s_nop 0
    s_cbranch_vccnz g_39F11_0
    v_smfmac_f32_16x16x64_bf16 v[64:67], v[24:27], a[192:199], v172
    v_smfmac_f32_16x16x64_bf16 v[68:71], v[24:27], a[224:231], v172
g_39L10_1:
    s_waitcnt vmcnt(1)
    v_max3_u32 v19, v28, v29, v30
    v_max_u32 v19, v19, v31
    v_cmp_eq_u32 vcc, -1, v19
    s_nop 0
    s_cbranch_vccnz g_39F10_1
    v_smfmac_f32_16x16x64_bf16 v[64:67], v[28:31], a[200:207], v172
    v_smfmac_f32_16x16x64_bf16 v[68:71], v[28:31], a[232:239], v172
    s_branch g_39L8_3
g_39L11_1:
    s_waitcnt vmcnt(2)
    v_max3_u32 v19, v28, v29, v30
    v_max_u32 v19, v19, v31
    v_cmp_eq_u32 vcc, -1, v19
    s_nop 0
    s_cbranch_vccnz g_39F11_1
    v_smfmac_f32_16x16x64_bf16 v[64:67], v[28:31], a[200:207], v172
    v_smfmac_f32_16x16x64_bf16 v[68:71], v[28:31], a[232:239], v172
    s_branch g_39L9_3
g_39L13_0:
    s_waitcnt vmcnt(2)
    v_max3_u32 v19, v24, v25, v26
    v_max_u32 v19, v19, v27
    v_cmp_eq_u32 vcc, -1, v19
    s_nop 0
    s_cbranch_vccnz g_39F13_0
    v_smfmac_f32_16x16x64_bf16 v[64:67], v[24:27], a[192:199], v172
    v_smfmac_f32_16x16x64_bf16 v[68:71], v[24:27], a[224:231], v172
    s_branch g_39L12_2
g_39L13_3:
    s_waitcnt vmcnt(2)
    v_max3_u32 v19, v36, v37, v38
    v_max_u32 v19, v19, v39
    v_cmp_eq_u32 vcc, -1, v19
    s_nop 0
    s_cbranch_vccnz g_39F13_3
    v_smfmac_f32_16x16x64_bf16 v[64:67], v[36:39], a[216:223], v172
    v_smfmac_f32_16x16x64_bf16 v[68:71], v[36:39], a[248:255], v172
g_39L5_0:
    s_waitcnt vmcnt(1)
    v_max3_u32 v19, v24, v25, v26
    v_max_u32 v19, v19, v27
    v_cmp_eq_u32 vcc, -1, v19
    s_nop 0
    s_cbranch_vccnz g_39F5_0
    v_smfmac_f32_16x16x64_bf16 v[64:67], v[24:27], a[192:199], v172
    v_smfmac_f32_16x16x64_bf16 v[68:71], v[24:27], a[224:231], v172
    s_branch g_39L4_2
g_39L14_2:
    s_waitcnt vmcnt(2)
    v_max3_u32 v19, v32, v33, v34
    v_max_u32 v19, v19, v35
    v_cmp_eq_u32 vcc, -1, v19
    s_nop 0
    s_cbranch_vccnz g_39F14_2
    v_smfmac_f32_16x16x64_bf16 v[64:67], v[32:35], a[208:215], v172
    v_smfmac_f32_16x16x64_bf16 v[68:71], v[32:35], a[240:247], v172
g_39L10_3:
    s_waitcnt vmcnt(1)
    v_max3_u32 v19, v36, v37, v38
    v_max_u32 v19, v19, v39
    v_cmp_eq_u32 vcc, -1, v19
    s_nop 0
    s_cbranch_vccnz g_39F10_3
    v_smfmac_f32_16x16x64_bf16 v[64:67], v[36:39], a[216:223], v172
    v_smfmac_f32_16x16x64_bf16 v[68:71], v[36:39], a[248:255], v172
    s_branch g_39L2_1
g_39L14_3:
    s_waitcnt vmcnt(2)
    v_max3_u32 v19, v36, v37, v38
    v_max_u32 v19, v19, v39
    v_cmp_eq_u32 vcc, -1, v19
    s_nop 0
    s_cbranch_vccnz g_39F14_3
    v_smfmac_f32_16x16x64_bf16 v[64:67], v[36:39], a[216:223], v172
    v_smfmac_f32_16x16x64_bf16 v[68:71], v[36:39], a[248:255], v172
    s_branch g_39L6_1
g_39L3_1:
    s_waitcnt vmcnt(1)
    v_max3_u32 v19, v28, v29, v30
    v_max_u32 v19, v19, v31
    v_cmp_eq_u32 vcc, -1, v19
    s_nop 0
    s_cbranch_vccnz g_39F3_1
    v_smfmac_f32_16x16x64_bf16 v[64:67], v[28:31], a[200:207], v172
    v_smfmac_f32_16x16x64_bf16 v[68:71], v[28:31], a[232:239], v172
    s_branch g_39L1_0
g_39L6_2:
    s_waitcnt vmcnt(1)
    v_max3_u32 v19, v32, v33, v34
    v_max_u32 v19, v19, v35
    v_cmp_eq_u32 vcc, -1, v19
    s_nop 0
    s_cbranch_vccnz g_39F6_2
    v_smfmac_f32_16x16x64_bf16 v[64:67], v[32:35], a[208:215], v172
    v_smfmac_f32_16x16x64_bf16 v[68:71], v[32:35], a[240:247], v172
    s_branch g_39L2_1
g_39L9_0:
    s_waitcnt vmcnt(1)
    v_max3_u32 v19, v24, v25, v26
    v_max_u32 v19, v19, v27
    v_cmp_eq_u32 vcc, -1, v19
    s_nop 0
    s_cbranch_vccnz g_39F9_0
    v_smfmac_f32_16x16x64_bf16 v[64:67], v[24:27], a[192:199], v172
    v_smfmac_f32_16x16x64_bf16 v[68:71], v[24:27], a[224:231], v172
    s_branch g_39L8_3
g_39L12_3:
    s_waitcnt vmcnt(1)
    v_max3_u32 v19, v36, v37, v38
    v_max_u32 v19, v19, v39
    v_cmp_eq_u32 vcc, -1, v19
    s_nop 0
    s_cbranch_vccnz g_39F12_3
    v_smfmac_f32_16x16x64_bf16 v[64:67], v[36:39], a[216:223], v172
    v_smfmac_f32_16x16x64_bf16 v[68:71], v[36:39], a[248:255], v172
    s_branch g_39L4_2
g_39F15_0:
    s_mov_b64 exec, vcc
    buffer_load_dwordx4 v[24:27], v8, s[4:7], s16 offen offset:0 sc1
    s_mov_b64 exec, -1
    s_add_u32 s23, s23, 1
    s_cmp_lt_u32 s23, 200000
    s_cbranch_scc1 g_39L15_1
    s_mov_b32 s25, 200000
    s_branch gc_40
g_39F15_1:
    s_mov_b64 exec, vcc
    buffer_load_dwordx4 v[28:31], v8, s[4:7], s16 offen offset:1024 sc1
    s_mov_b64 exec, -1
    s_add_u32 s23, s23, 1
    s_cmp_lt_u32 s23, 200000
    s_cbranch_scc1 g_39L15_2
    s_mov_b32 s25, 200000
    s_branch gc_40
g_39F15_2:
    s_mov_b64 exec, vcc
    buffer_load_dwordx4 v[32:35], v8, s[4:7], s16 offen offset:2048 sc1
    s_mov_b64 exec, -1
    s_add_u32 s23, s23, 1
    s_cmp_lt_u32 s23, 200000
    s_cbranch_scc1 g_39L15_3
    s_mov_b32 s25, 200000
    s_branch gc_40
g_39F15_3:
    s_mov_b64 exec, vcc
    buffer_load_dwordx4 v[36:39], v8, s[4:7], s16 offen offset:3072 sc1
    s_mov_b64 exec, -1
    s_add_u32 s23, s23, 1
    s_cmp_lt_u32 s23, 200000
    s_cbranch_scc1 g_39L15_0
    s_mov_b32 s25, 200000
    s_branch gc_40
g_39F7_0:
    s_mov_b64 exec, vcc
    buffer_load_dwordx4 v[24:27], v8, s[4:7], s16 offen offset:0 sc1
    s_mov_b64 exec, -1
    s_add_u32 s23, s23, 1
    s_cmp_lt_u32 s23, 200000
    s_cbranch_scc1 g_39L7_1
    s_mov_b32 s25, 200000
    s_branch gc_40
g_39F7_1:
    s_mov_b64 exec, vcc
    buffer_load_dwordx4 v[28:31], v8, s[4:7], s16 offen offset:1024 sc1
    s_mov_b64 exec, -1
    s_add_u32 s23, s23, 1
    s_cmp_lt_u32 s23, 200000
    s_cbranch_scc1 g_39L7_2
    s_mov_b32 s25, 200000
    s_branch gc_40
g_39F7_2:
    s_mov_b64 exec, vcc
    buffer_load_dwordx4 v[32:35], v8, s[4:7], s16 offen offset:2048 sc1
    s_mov_b64 exec, -1
    s_add_u32 s23, s23, 1
    s_cmp_lt_u32 s23, 200000
    s_cbranch_scc1 g_39L7_0
    s_mov_b32 s25, 200000
    s_branch gc_40
g_39F11_0:
    s_mov_b64 exec, vcc
    buffer_load_dwordx4 v[24:27], v8, s[4:7], s16 offen offset:0 sc1
    s_mov_b64 exec, -1
    s_add_u32 s23, s23, 1
    s_cmp_lt_u32 s23, 200000
    s_cbranch_scc1 g_39L11_1
    s_mov_b32 s25, 200000
    s_branch gc_40
g_39F11_1:
    s_mov_b64 exec, vcc
    buffer_load_dwordx4 v[28:31], v8, s[4:7], s16 offen offset:1024 sc1
    s_mov_b64 exec, -1
    s_add_u32 s23, s23, 1
    s_cmp_lt_u32 s23, 200000
    s_cbranch_scc1 g_39L11_3
    s_mov_b32 s25, 200000
    s_branch gc_40
g_39F11_3:
    s_mov_b64 exec, vcc
    buffer_load_dwordx4 v[36:39], v8, s[4:7], s16 offen offset:3072 sc1
    s_mov_b64 exec, -1
    s_add_u32 s23, s23, 1
    s_cmp_lt_u32 s23, 200000
    s_cbranch_scc1 g_39L11_0
    s_mov_b32 s25, 200000
    s_branch gc_40
g_39F13_0:
    s_mov_b64 exec, vcc
    buffer_load_dwordx4 v[24:27], v8, s[4:7], s16 offen offset:0 sc1
    s_mov_b64 exec, -1
    s_add_u32 s23, s23, 1
    s_cmp_lt_u32 s23, 200000
    s_cbranch_scc1 g_39L13_2
    s_mov_b32 s25, 200000
    s_branch gc_40
g_39F13_2:
    s_mov_b64 exec, vcc
    buffer_load_dwordx4 v[32:35], v8, s[4:7], s16 offen offset:2048 sc1
    s_mov_b64 exec, -1
    s_add_u32 s23, s23, 1
    s_cmp_lt_u32 s23, 200000
    s_cbranch_scc1 g_39L13_3
    s_mov_b32 s25, 200000
    s_branch gc_40
g_39F13_3:
    s_mov_b64 exec, vcc
    buffer_load_dwordx4 v[36:39], v8, s[4:7], s16 offen offset:3072 sc1
    s_mov_b64 exec, -1
    s_add_u32 s23, s23, 1
    s_cmp_lt_u32 s23, 200000
    s_cbranch_scc1 g_39L13_0
    s_mov_b32 s25, 200000
    s_branch gc_40
g_39F14_1:
    s_mov_b64 exec, vcc
    buffer_load_dwordx4 v[28:31], v8, s[4:7], s16 offen offset:1024 sc1
    s_mov_b64 exec, -1
    s_add_u32 s23, s23, 1
    s_cmp_lt_u32 s23, 200000
    s_cbranch_scc1 g_39L14_2
    s_mov_b32 s25, 200000
    s_branch gc_40
g_39F14_2:
    s_mov_b64 exec, vcc
    buffer_load_dwordx4 v[32:35], v8, s[4:7], s16 offen offset:2048 sc1
    s_mov_b64 exec, -1
    s_add_u32 s23, s23, 1
    s_cmp_lt_u32 s23, 200000
    s_cbranch_scc1 g_39L14_3
    s_mov_b32 s25, 200000
    s_branch gc_40
g_39F14_3:
    s_mov_b64 exec, vcc
    buffer_load_dwordx4 v[36:39], v8, s[4:7], s16 offen offset:3072 sc1
    s_mov_b64 exec, -1
    s_add_u32 s23, s23, 1
    s_cmp_lt_u32 s23, 200000
    s_cbranch_scc1 g_39L14_1
    s_mov_b32 s25, 200000
    s_branch gc_40
g_39F3_0:
    s_mov_b64 exec, vcc
    buffer_load_dwordx4 v[24:27], v8, s[4:7], s16 offen offset:0 sc1
    s_mov_b64 exec, -1
    s_add_u32 s23, s23, 1
    s_cmp_lt_u32 s23, 200000
    s_cbranch_scc1 g_39L3_1
    s_mov_b32 s25, 200000
    s_branch gc_40
g_39F3_1:
    s_mov_b64 exec, vcc
    buffer_load_dwordx4 v[28:31], v8, s[4:7], s16 offen offset:1024 sc1
    s_mov_b64 exec, -1
    s_add_u32 s23, s23, 1
    s_cmp_lt_u32 s23, 200000
    s_cbranch_scc1 g_39L3_0
    s_mov_b32 s25, 200000
    s_branch gc_40
g_39F5_0:
    s_mov_b64 exec, vcc
    buffer_load_dwordx4 v[24:27], v8, s[4:7], s16 offen offset:0 sc1
    s_mov_b64 exec, -1
    s_add_u32 s23, s23, 1
    s_cmp_lt_u32 s23, 200000
    s_cbranch_scc1 g_39L5_2
    s_mov_b32 s25, 200000
    s_branch gc_40
g_39F5_2:
    s_mov_b64 exec, vcc
    buffer_load_dwordx4 v[32:35], v8, s[4:7], s16 offen offset:2048 sc1
    s_mov_b64 exec, -1
    s_add_u32 s23, s23, 1
    s_cmp_lt_u32 s23, 200000
    s_cbranch_scc1 g_39L5_0
    s_mov_b32 s25, 200000
    s_branch gc_40
g_39F6_1:
    s_mov_b64 exec, vcc
    buffer_load_dwordx4 v[28:31], v8, s[4:7], s16 offen offset:1024 sc1
    s_mov_b64 exec, -1
    s_add_u32 s23, s23, 1
    s_cmp_lt_u32 s23, 200000
    s_cbranch_scc1 g_39L6_2
    s_mov_b32 s25, 200000
    s_branch gc_40
g_39F6_2:
    s_mov_b64 exec, vcc
    buffer_load_dwordx4 v[32:35], v8, s[4:7], s16 offen offset:2048 sc1
    s_mov_b64 exec, -1
    s_add_u32 s23, s23, 1
    s_cmp_lt_u32 s23, 200000
    s_cbranch_scc1 g_39L6_1
    s_mov_b32 s25, 200000
    s_branch gc_40
g_39F9_0:
    s_mov_b64 exec, vcc
    buffer_load_dwordx4 v[24:27], v8, s[4:7], s16 offen offset:0 sc1
    s_mov_b64 exec, -1
    s_add_u32 s23, s23, 1
    s_cmp_lt_u32 s23, 200000
    s_cbranch_scc1 g_39L9_3
    s_mov_b32 s25, 200000
    s_branch gc_40
g_39F9_3:
    s_mov_b64 exec, vcc
    buffer_load_dwordx4 v[36:39], v8, s[4:7], s16 offen offset:3072 sc1
    s_mov_b64 exec, -1
    s_add_u32 s23, s23, 1
    s_cmp_lt_u32 s23, 200000
    s_cbranch_scc1 g_39L9_0
    s_mov_b32 s25, 200000
    s_branch gc_40
g_39F10_1:
    s_mov_b64 exec, vcc
    buffer_load_dwordx4 v[28:31], v8, s[4:7], s16 offen offset:1024 sc1
    s_mov_b64 exec, -1
    s_add_u32 s23, s23, 1
    s_cmp_lt_u32 s23, 200000
    s_cbranch_scc1 g_39L10_3
    s_mov_b32 s25, 200000
    s_branch gc_40
g_39F10_3:
    s_mov_b64 exec, vcc
    buffer_load_dwordx4 v[36:39], v8, s[4:7], s16 offen offset:3072 sc1
    s_mov_b64 exec, -1
    s_add_u32 s23, s23, 1
    s_cmp_lt_u32 s23, 200000
    s_cbranch_scc1 g_39L10_1
    s_mov_b32 s25, 200000
    s_branch gc_40
g_39F12_2:
    s_mov_b64 exec, vcc
    buffer_load_dwordx4 v[32:35], v8, s[4:7], s16 offen offset:2048 sc1
    s_mov_b64 exec, -1
    s_add_u32 s23, s23, 1
    s_cmp_lt_u32 s23, 200000
    s_cbranch_scc1 g_39L12_3
    s_mov_b32 s25, 200000
    s_branch gc_40
g_39F12_3:
    s_mov_b64 exec, vcc
    buffer_load_dwordx4 v[36:39], v8, s[4:7], s16 offen offset:3072 sc1
    s_mov_b64 exec, -1
    s_add_u32 s23, s23, 1
    s_cmp_lt_u32 s23, 200000
    s_cbranch_scc1 g_39L12_2
    s_mov_b32 s25, 200000
    s_branch gc_40
g_39F1_0:
    s_mov_b64 exec, vcc
    buffer_load_dwordx4 v[24:27], v8, s[4:7], s16 offen offset:0 sc1
    s_mov_b64 exec, -1
    s_add_u32 s23, s23, 1
    s_cmp_lt_u32 s23, 200000
    s_cbranch_scc1 g_39L1_0
    s_mov_b32 s25, 200000
    s_branch gc_40
g_39F2_1:
    s_mov_b64 exec, vcc
    buffer_load_dwordx4 v[28:31], v8, s[4:7], s16 offen offset:1024 sc1
    s_mov_b64 exec, -1
    s_add_u32 s23, s23, 1
    s_cmp_lt_u32 s23, 200000
    s_cbranch_scc1 g_39L2_1
    s_mov_b32 s25, 200000
    s_branch gc_40
g_39F4_2:
    s_mov_b64 exec, vcc
    buffer_load_dwordx4 v[32:35], v8, s[4:7], s16 offen offset:2048 sc1
    s_mov_b64 exec, -1
    s_add_u32 s23, s23, 1
    s_cmp_lt_u32 s23, 200000
    s_cbranch_scc1 g_39L4_2
    s_mov_b32 s25, 200000
    s_branch gc_40
g_39F8_3:
    s_mov_b64 exec, vcc
    buffer_load_dwordx4 v[36:39], v8, s[4:7], s16 offen offset:3072 sc1
    s_mov_b64 exec, -1
    s_add_u32 s23, s23, 1
    s_cmp_lt_u32 s23, 200000
    s_cbranch_scc1 g_39L8_3
    s_mov_b32 s25, 200000
    s_branch gc_40
.p2align 6
recur_fast_w2:
    s_nop 15
    s_mov_b32 s23, s25
    buffer_load_dwordx4 v[24:27], v2, s[4:7], s16 offen offset:0 sc1
    s_nop 11
    buffer_load_dwordx4 v[28:31], v2, s[4:7], s16 offen offset:1024 sc1
    s_nop 11
    buffer_load_dwordx4 v[32:35], v2, s[4:7], s16 offen offset:2048 sc1
    s_nop 11
    buffer_load_dwordx4 v[36:39], v2, s[4:7], s16 offen offset:3072 sc1
    s_waitcnt vmcnt(3)
    v_max3_u32 v19, v24, v25, v26
    v_max_u32 v19, v19, v27
    v_cmp_eq_u32 vcc, -1, v19
    s_nop 0
    s_cbranch_vccnz g_43F15_0
    v_smfmac_f32_16x16x64_bf16 v[40:43], v[24:27], a[0:7], v172
    s_waitcnt vmcnt(2)
    v_max3_u32 v19, v28, v29, v30
    v_max_u32 v19, v19, v31
    v_smfmac_f32_16x16x64_bf16 v[44:47], v[24:27], a[64:71], v172
    v_cmp_eq_u32 vcc, -1, v19
    v_smfmac_f32_16x16x64_bf16 v[48:51], v[24:27], a[32:39], v172
    v_smfmac_f32_16x16x64_bf16 v[52:55], v[24:27], a[96:103], v172
    s_cbranch_vccnz g_43F14_1
    v_smfmac_f32_16x16x64_bf16 v[40:43], v[28:31], a[8:15], v172
    s_waitcnt vmcnt(1)
    v_max3_u32 v19, v32, v33, v34
    v_max_u32 v19, v19, v35
    v_smfmac_f32_16x16x64_bf16 v[44:47], v[28:31], a[72:79], v172
    v_cmp_eq_u32 vcc, -1, v19
    v_smfmac_f32_16x16x64_bf16 v[48:51], v[28:31], a[40:47], v172
    v_smfmac_f32_16x16x64_bf16 v[52:55], v[28:31], a[104:111], v172
    s_cbranch_vccnz g_43F12_2
    v_smfmac_f32_16x16x64_bf16 v[40:43], v[32:35], a[16:23], v172
    s_waitcnt vmcnt(0)
    v_max3_u32 v19, v36, v37, v38
    v_max_u32 v19, v19, v39
    v_smfmac_f32_16x16x64_bf16 v[44:47], v[32:35], a[80:87], v172
    v_cmp_eq_u32 vcc, -1, v19
    v_smfmac_f32_16x16x64_bf16 v[48:51], v[32:35], a[48:55], v172
    v_smfmac_f32_16x16x64_bf16 v[52:55], v[32:35], a[112:119], v172
    s_cbranch_vccnz g_43F8_3
    v_smfmac_f32_16x16x64_bf16 v[40:43], v[36:39], a[24:31], v172
    v_smfmac_f32_16x16x64_bf16 v[44:47], v[36:39], a[88:95], v172
    v_smfmac_f32_16x16x64_bf16 v[48:51], v[36:39], a[56:63], v172
    v_smfmac_f32_16x16x64_bf16 v[52:55], v[36:39], a[120:127], v172
gc_44:
    v_cvt_pk_bf16_f32 v72, v40, v41
    v_cvt_pk_bf16_f32 v73, v42, v43
    v_cvt_pk_bf16_f32 v74, v44, v45
    v_cvt_pk_bf16_f32 v75, v46, v47
    ds_write_b128 v17, v[72:75] offset:0
    v_cvt_pk_bf16_f32 v76, v48, v49
    v_cvt_pk_bf16_f32 v77, v50, v51
    s_nop 0
    v_cvt_pk_bf16_f32 v78, v52, v53
    v_cvt_pk_bf16_f32 v79, v54, v55
    ds_write_b128 v17, v[76:79] offset:1024
    v_smfmac_f32_16x16x64_bf16 v[56:59], v[24:27], a[128:135], v172
    v_smfmac_f32_16x16x64_bf16 v[60:63], v[24:27], a[160:167], v172
    v_smfmac_f32_16x16x64_bf16 v[56:59], v[28:31], a[136:143], v172
    s_waitcnt lgkmcnt(0)
    s_barrier
    v_smfmac_f32_16x16x64_bf16 v[60:63], v[28:31], a[168:175], v172
    v_smfmac_f32_16x16x64_bf16 v[56:59], v[32:35], a[144:151], v172
    v_smfmac_f32_16x16x64_bf16 v[60:63], v[32:35], a[176:183], v172
    v_smfmac_f32_16x16x64_bf16 v[56:59], v[36:39], a[152:159], v172
    v_smfmac_f32_16x16x64_bf16 v[60:63], v[36:39], a[184:191], v172
    s_nop 4
    v_cvt_pk_bf16_f32 v80, v56, v57
    v_cvt_pk_bf16_f32 v81, v58, v59
    s_nop 0
    v_cvt_pk_bf16_f32 v82, v60, v61
    v_cvt_pk_bf16_f32 v83, v62, v63
    ds_write_b128 v17, v[80:83] offset:8192
    s_cmp_eq_u32 s15, 63
    s_waitcnt lgkmcnt(0)
    s_barrier
    ds_read_b128 v[96:99], v16 offset:8192
    ds_read_b128 v[100:103], v16 offset:10240
    ds_read_b128 v[108:111], v16 offset:14336
    v_mfma_f32_16x16x32_bf16 v[140:143], v[84:87], v[80:83], 0
    s_waitcnt lgkmcnt(2)
    v_mfma_f32_16x16x32_bf16 v[140:143], v[84:87], v[96:99], v[140:143]
    s_waitcnt lgkmcnt(1)
    v_mfma_f32_16x16x32_bf16 v[140:143], v[84:87], v[100:103], v[140:143]
    s_waitcnt lgkmcnt(0)
    v_mfma_f32_16x16x32_bf16 v[140:143], v[84:87], v[108:111], v[140:143]
    s_nop 7
    v_cvt_pk_bf16_f32 v168, v140, v141
    v_cvt_pk_bf16_f32 v169, v142, v143
    v_mov_b32 v170, v168
    v_mov_b32 v171, v169
    s_nop 0
    v_permlane16_swap_b32 v168, v170
    v_permlane16_swap_b32 v169, v171
    v_mov_b32 v247, s15
    s_cbranch_scc1 recur_fast_last2
    s_barrier
    s_nop 15
    s_mov_b32 s23, s25
    buffer_load_dwordx4 v[24:27], v8, s[4:7], s16 offen offset:0 sc1
    s_nop 11
    buffer_load_dwordx4 v[28:31], v8, s[4:7], s16 offen offset:1024 sc1
    s_nop 11
    buffer_load_dwordx4 v[32:35], v8, s[4:7], s16 offen offset:2048 sc1
    s_nop 11
    buffer_load_dwordx4 v[36:39], v8, s[4:7], s16 offen offset:3072 sc1
    s_waitcnt vmcnt(3)
    v_max3_u32 v19, v24, v25, v26
    v_max_u32 v19, v19, v27
    v_cmp_eq_u32 vcc, -1, v19
    s_nop 0
    s_cbranch_vccnz g_45F15_0
    v_smfmac_f32_16x16x64_bf16 v[64:67], v[24:27], a[192:199], v172
    v_smfmac_f32_16x16x64_bf16 v[68:71], v[24:27], a[224:231], v172
    s_waitcnt vmcnt(2)
    v_max3_u32 v19, v28, v29, v30
    v_max_u32 v19, v19, v31
    v_cmp_eq_u32 vcc, -1, v19
    s_nop 0
    s_cbranch_vccnz g_45F14_1
    v_smfmac_f32_16x16x64_bf16 v[64:67], v[28:31], a[200:207], v172
    v_smfmac_f32_16x16x64_bf16 v[68:71], v[28:31], a[232:239], v172
    s_waitcnt vmcnt(1)
    v_max3_u32 v19, v32, v33, v34
    v_max_u32 v19, v19, v35
    v_cmp_eq_u32 vcc, -1, v19
    s_nop 0
    s_cbranch_vccnz g_45F12_2
    v_smfmac_f32_16x16x64_bf16 v[64:67], v[32:35], a[208:215], v172
    v_smfmac_f32_16x16x64_bf16 v[68:71], v[32:35], a[240:247], v172
    s_waitcnt vmcnt(0)
    v_max3_u32 v19, v36, v37, v38
    v_max_u32 v19, v19, v39
    v_cmp_eq_u32 vcc, -1, v19
    s_nop 0
    s_cbranch_vccnz g_45F8_3
    v_smfmac_f32_16x16x64_bf16 v[64:67], v[36:39], a[216:223], v172
    v_smfmac_f32_16x16x64_bf16 v[68:71], v[36:39], a[248:255], v172
    s_nop 4
    v_cvt_pk_bf16_f32 v80, v64, v65
    v_cvt_pk_bf16_f32 v81, v66, v67
    s_nop 0
    v_cvt_pk_bf16_f32 v82, v68, v69
    v_cvt_pk_bf16_f32 v83, v70, v71
    ds_write_b128 v17, v[80:83] offset:9216
gc_46:
    s_waitcnt lgkmcnt(0)
    s_barrier
    s_nop 15
    s_nop 15
    s_nop 15
    s_nop 15
    buffer_store_dwordx4 v[168:171], v15, s[4:7], s20 offen sc1
    s_add_u32 s20, s20, 512
    s_add_u32 s21, s95, 1048576
    s_lshr_b32 s22, s21, 8
    s_and_b32 s22, s22, 8192
    s_xor_b32 s22, s22, s46
    s_add_u32 s21, s21, s22
    buffer_store_dwordx4 v[204:207], v9, s[4:7], s21 offen sc1
    s_add_u32 s21, s21, 262144
    buffer_store_dword v247, v246, s[4:7], 0 offen sc1
    v_mov_b32 v40, 0
    v_mov_b32 v41, 0
    v_mov_b32 v42, 0
    v_mov_b32 v43, 0
    v_mov_b32 v44, 0
    v_mov_b32 v45, 0
    v_mov_b32 v46, 0
    v_mov_b32 v47, 0
    v_mov_b32 v48, 0
    v_mov_b32 v49, 0
    v_mov_b32 v50, 0
    v_mov_b32 v51, 0
    v_mov_b32 v52, 0
    v_mov_b32 v53, 0
    v_mov_b32 v54, 0
    v_mov_b32 v55, 0
    v_mov_b32 v56, 0
    v_mov_b32 v57, 0
    v_mov_b32 v58, 0
    v_mov_b32 v59, 0
    v_mov_b32 v60, 0
    v_mov_b32 v61, 0
    v_mov_b32 v62, 0
    v_mov_b32 v63, 0
    v_mov_b32 v64, 0
    v_mov_b32 v65, 0
    v_mov_b32 v66, 0
    v_mov_b32 v67, 0
    v_mov_b32 v68, 0
    v_mov_b32 v69, 0
    v_mov_b32 v70, 0
    v_mov_b32 v71, 0
    s_mov_b32 s21, s16
    s_mov_b32 s16, s42
    s_mov_b32 s42, s43
    s_mov_b32 s43, s44
    s_mov_b32 s44, s21
    s_add_u32 s95, s95, 524288
    s_lshr_b32 s84, s95, 8
    s_and_b32 s84, s84, 8192
    s_xor_b32 s84, s84, s46
    s_add_u32 s84, s84, s95
    s_add_u32 s15, s15, 1
    s_barrier
    s_branch recur_fast_w2
g_43L15_0:
    s_waitcnt vmcnt(3)
    v_max3_u32 v19, v24, v25, v26
    v_max_u32 v19, v19, v27
    v_cmp_eq_u32 vcc, -1, v19
    s_nop 0
    s_cbranch_vccnz g_43F15_0
    v_smfmac_f32_16x16x64_bf16 v[40:43], v[24:27], a[0:7], v172
    v_smfmac_f32_16x16x64_bf16 v[44:47], v[24:27], a[64:71], v172
    v_smfmac_f32_16x16x64_bf16 v[48:51], v[24:27], a[32:39], v172
    v_smfmac_f32_16x16x64_bf16 v[52:55], v[24:27], a[96:103], v172
g_43L14_1:
    s_waitcnt vmcnt(2)
    v_max3_u32 v19, v28, v29, v30
    v_max_u32 v19, v19, v31
    v_cmp_eq_u32 vcc, -1, v19
    s_nop 0
    s_cbranch_vccnz g_43F14_1
    v_smfmac_f32_16x16x64_bf16 v[40:43], v[28:31], a[8:15], v172
    v_smfmac_f32_16x16x64_bf16 v[44:47], v[28:31], a[72:79], v172
    v_smfmac_f32_16x16x64_bf16 v[48:51], v[28:31], a[40:47], v172
    v_smfmac_f32_16x16x64_bf16 v[52:55], v[28:31], a[104:111], v172
g_43L12_2:
    s_waitcnt vmcnt(1)
    v_max3_u32 v19, v32, v33, v34
    v_max_u32 v19, v19, v35
    v_cmp_eq_u32 vcc, -1, v19
    s_nop 0
    s_cbranch_vccnz g_43F12_2
    v_smfmac_f32_16x16x64_bf16 v[40:43], v[32:35], a[16:23], v172
    v_smfmac_f32_16x16x64_bf16 v[44:47], v[32:35], a[80:87], v172
    v_smfmac_f32_16x16x64_bf16 v[48:51], v[32:35], a[48:55], v172
    v_smfmac_f32_16x16x64_bf16 v[52:55], v[32:35], a[112:119], v172
g_43L8_3:
    s_waitcnt vmcnt(0)
    v_max3_u32 v19, v36, v37, v38
    v_max_u32 v19, v19, v39
    v_cmp_eq_u32 vcc, -1, v19
    s_nop 0
    s_cbranch_vccnz g_43F8_3
    v_smfmac_f32_16x16x64_bf16 v[40:43], v[36:39], a[24:31], v172
    v_smfmac_f32_16x16x64_bf16 v[44:47], v[36:39], a[88:95], v172
    v_smfmac_f32_16x16x64_bf16 v[48:51], v[36:39], a[56:63], v172
    v_smfmac_f32_16x16x64_bf16 v[52:55], v[36:39], a[120:127], v172
    s_branch gc_44
g_43L15_1:
    s_waitcnt vmcnt(3)
    v_max3_u32 v19, v28, v29, v30
    v_max_u32 v19, v19, v31
    v_cmp_eq_u32 vcc, -1, v19
    s_nop 0
    s_cbranch_vccnz g_43F15_1
    v_smfmac_f32_16x16x64_bf16 v[40:43], v[28:31], a[8:15], v172
    v_smfmac_f32_16x16x64_bf16 v[44:47], v[28:31], a[72:79], v172
    v_smfmac_f32_16x16x64_bf16 v[48:51], v[28:31], a[40:47], v172
    v_smfmac_f32_16x16x64_bf16 v[52:55], v[28:31], a[104:111], v172
g_43L13_2:
    s_waitcnt vmcnt(2)
    v_max3_u32 v19, v32, v33, v34
    v_max_u32 v19, v19, v35
    v_cmp_eq_u32 vcc, -1, v19
    s_nop 0
    s_cbranch_vccnz g_43F13_2
    v_smfmac_f32_16x16x64_bf16 v[40:43], v[32:35], a[16:23], v172
    v_smfmac_f32_16x16x64_bf16 v[44:47], v[32:35], a[80:87], v172
    v_smfmac_f32_16x16x64_bf16 v[48:51], v[32:35], a[48:55], v172
    v_smfmac_f32_16x16x64_bf16 v[52:55], v[32:35], a[112:119], v172
g_43L9_3:
    s_waitcnt vmcnt(1)
    v_max3_u32 v19, v36, v37, v38
    v_max_u32 v19, v19, v39
    v_cmp_eq_u32 vcc, -1, v19
    s_nop 0
    s_cbranch_vccnz g_43F9_3
    v_smfmac_f32_16x16x64_bf16 v[40:43], v[36:39], a[24:31], v172
    v_smfmac_f32_16x16x64_bf16 v[44:47], v[36:39], a[88:95], v172
    v_smfmac_f32_16x16x64_bf16 v[48:51], v[36:39], a[56:63], v172
    v_smfmac_f32_16x16x64_bf16 v[52:55], v[36:39], a[120:127], v172
g_43L1_0:
    s_waitcnt vmcnt(0)
    v_max3_u32 v19, v24, v25, v26
    v_max_u32 v19, v19, v27
    v_cmp_eq_u32 vcc, -1, v19
    s_nop 0
    s_cbranch_vccnz g_43F1_0
    v_smfmac_f32_16x16x64_bf16 v[40:43], v[24:27], a[0:7], v172
    v_smfmac_f32_16x16x64_bf16 v[44:47], v[24:27], a[64:71], v172
    v_smfmac_f32_16x16x64_bf16 v[48:51], v[24:27], a[32:39], v172
    v_smfmac_f32_16x16x64_bf16 v[52:55], v[24:27], a[96:103], v172
    s_branch gc_44
g_43L15_2:
    s_waitcnt vmcnt(3)
    v_max3_u32 v19, v32, v33, v34
    v_max_u32 v19, v19, v35
    v_cmp_eq_u32 vcc, -1, v19
    s_nop 0
    s_cbranch_vccnz g_43F15_2
    v_smfmac_f32_16x16x64_bf16 v[40:43], v[32:35], a[16:23], v172
    v_smfmac_f32_16x16x64_bf16 v[44:47], v[32:35], a[80:87], v172
    v_smfmac_f32_16x16x64_bf16 v[48:51], v[32:35], a[48:55], v172
    v_smfmac_f32_16x16x64_bf16 v[52:55], v[32:35], a[112:119], v172
g_43L11_3:
    s_waitcnt vmcnt(2)
    v_max3_u32 v19, v36, v37, v38
    v_max_u32 v19, v19, v39
    v_cmp_eq_u32 vcc, -1, v19
    s_nop 0
    s_cbranch_vccnz g_43F11_3
    v_smfmac_f32_16x16x64_bf16 v[40:43], v[36:39], a[24:31], v172
    v_smfmac_f32_16x16x64_bf16 v[44:47], v[36:39], a[88:95], v172
    v_smfmac_f32_16x16x64_bf16 v[48:51], v[36:39], a[56:63], v172
    v_smfmac_f32_16x16x64_bf16 v[52:55], v[36:39], a[120:127], v172
g_43L3_0:
    s_waitcnt vmcnt(1)
    v_max3_u32 v19, v24, v25, v26
    v_max_u32 v19, v19, v27
    v_cmp_eq_u32 vcc, -1, v19
    s_nop 0
    s_cbranch_vccnz g_43F3_0
    v_smfmac_f32_16x16x64_bf16 v[40:43], v[24:27], a[0:7], v172
    v_smfmac_f32_16x16x64_bf16 v[44:47], v[24:27], a[64:71], v172
    v_smfmac_f32_16x16x64_bf16 v[48:51], v[24:27], a[32:39], v172
    v_smfmac_f32_16x16x64_bf16 v[52:55], v[24:27], a[96:103], v172
g_43L2_1:
    s_waitcnt vmcnt(0)
    v_max3_u32 v19, v28, v29, v30
    v_max_u32 v19, v19, v31
    v_cmp_eq_u32 vcc, -1, v19
    s_nop 0
    s_cbranch_vccnz g_43F2_1
    v_smfmac_f32_16x16x64_bf16 v[40:43], v[28:31], a[8:15], v172
    v_smfmac_f32_16x16x64_bf16 v[44:47], v[28:31], a[72:79], v172
    v_smfmac_f32_16x16x64_bf16 v[48:51], v[28:31], a[40:47], v172
    v_smfmac_f32_16x16x64_bf16 v[52:55], v[28:31], a[104:111], v172
    s_branch gc_44
g_43L15_3:
    s_waitcnt vmcnt(3)
    v_max3_u32 v19, v36, v37, v38
    v_max_u32 v19, v19, v39
    v_cmp_eq_u32 vcc, -1, v19
    s_nop 0
    s_cbranch_vccnz g_43F15_3
    v_smfmac_f32_16x16x64_bf16 v[40:43], v[36:39], a[24:31], v172
    v_smfmac_f32_16x16x64_bf16 v[44:47], v[36:39], a[88:95], v172
    v_smfmac_f32_16x16x64_bf16 v[48:51], v[36:39], a[56:63], v172
    v_smfmac_f32_16x16x64_bf16 v[52:55], v[36:39], a[120:127], v172
g_43L7_0:
    s_waitcnt vmcnt(2)
    v_max3_u32 v19, v24, v25, v26
    v_max_u32 v19, v19, v27
    v_cmp_eq_u32 vcc, -1, v19
    s_nop 0
    s_cbranch_vccnz g_43F7_0
    v_smfmac_f32_16x16x64_bf16 v[40:43], v[24:27], a[0:7], v172
    v_smfmac_f32_16x16x64_bf16 v[44:47], v[24:27], a[64:71], v172
    v_smfmac_f32_16x16x64_bf16 v[48:51], v[24:27], a[32:39], v172
    v_smfmac_f32_16x16x64_bf16 v[52:55], v[24:27], a[96:103], v172
g_43L6_1:
    s_waitcnt vmcnt(1)
    v_max3_u32 v19, v28, v29, v30
    v_max_u32 v19, v19, v31
    v_cmp_eq_u32 vcc, -1, v19
    s_nop 0
    s_cbranch_vccnz g_43F6_1
    v_smfmac_f32_16x16x64_bf16 v[40:43], v[28:31], a[8:15], v172
    v_smfmac_f32_16x16x64_bf16 v[44:47], v[28:31], a[72:79], v172
    v_smfmac_f32_16x16x64_bf16 v[48:51], v[28:31], a[40:47], v172
    v_smfmac_f32_16x16x64_bf16 v[52:55], v[28:31], a[104:111], v172
g_43L4_2:
    s_waitcnt vmcnt(0)
    v_max3_u32 v19, v32, v33, v34
    v_max_u32 v19, v19, v35
    v_cmp_eq_u32 vcc, -1, v19
    s_nop 0
    s_cbranch_vccnz g_43F4_2
    v_smfmac_f32_16x16x64_bf16 v[40:43], v[32:35], a[16:23], v172
    v_smfmac_f32_16x16x64_bf16 v[44:47], v[32:35], a[80:87], v172
    v_smfmac_f32_16x16x64_bf16 v[48:51], v[32:35], a[48:55], v172
    v_smfmac_f32_16x16x64_bf16 v[52:55], v[32:35], a[112:119], v172
    s_branch gc_44
g_43L7_1:
    s_waitcnt vmcnt(2)
    v_max3_u32 v19, v28, v29, v30
    v_max_u32 v19, v19, v31
    v_cmp_eq_u32 vcc, -1, v19
    s_nop 0
    s_cbranch_vccnz g_43F7_1
    v_smfmac_f32_16x16x64_bf16 v[40:43], v[28:31], a[8:15], v172
    v_smfmac_f32_16x16x64_bf16 v[44:47], v[28:31], a[72:79], v172
    v_smfmac_f32_16x16x64_bf16 v[48:51], v[28:31], a[40:47], v172
    v_smfmac_f32_16x16x64_bf16 v[52:55], v[28:31], a[104:111], v172
g_43L5_2:
    s_waitcnt vmcnt(1)
    v_max3_u32 v19, v32, v33, v34
    v_max_u32 v19, v19, v35
    v_cmp_eq_u32 vcc, -1, v19
    s_nop 0
    s_cbranch_vccnz g_43F5_2
    v_smfmac_f32_16x16x64_bf16 v[40:43], v[32:35], a[16:23], v172
    v_smfmac_f32_16x16x64_bf16 v[44:47], v[32:35], a[80:87], v172
    v_smfmac_f32_16x16x64_bf16 v[48:51], v[32:35], a[48:55], v172
    v_smfmac_f32_16x16x64_bf16 v[52:55], v[32:35], a[112:119], v172
    s_branch g_43L1_0
g_43L7_2:
    s_waitcnt vmcnt(2)
    v_max3_u32 v19, v32, v33, v34
    v_max_u32 v19, v19, v35
    v_cmp_eq_u32 vcc, -1, v19
    s_nop 0
    s_cbranch_vccnz g_43F7_2
    v_smfmac_f32_16x16x64_bf16 v[40:43], v[32:35], a[16:23], v172
    v_smfmac_f32_16x16x64_bf16 v[44:47], v[32:35], a[80:87], v172
    v_smfmac_f32_16x16x64_bf16 v[48:51], v[32:35], a[48:55], v172
    v_smfmac_f32_16x16x64_bf16 v[52:55], v[32:35], a[112:119], v172
    s_branch g_43L3_0
g_43L11_0:
    s_waitcnt vmcnt(2)
    v_max3_u32 v19, v24, v25, v26
    v_max_u32 v19, v19, v27
    v_cmp_eq_u32 vcc, -1, v19
    s_nop 0
    s_cbranch_vccnz g_43F11_0
    v_smfmac_f32_16x16x64_bf16 v[40:43], v[24:27], a[0:7], v172
    v_smfmac_f32_16x16x64_bf16 v[44:47], v[24:27], a[64:71], v172
    v_smfmac_f32_16x16x64_bf16 v[48:51], v[24:27], a[32:39], v172
    v_smfmac_f32_16x16x64_bf16 v[52:55], v[24:27], a[96:103], v172
g_43L10_1:
    s_waitcnt vmcnt(1)
    v_max3_u32 v19, v28, v29, v30
    v_max_u32 v19, v19, v31
    v_cmp_eq_u32 vcc, -1, v19
    s_nop 0
    s_cbranch_vccnz g_43F10_1
    v_smfmac_f32_16x16x64_bf16 v[40:43], v[28:31], a[8:15], v172
    v_smfmac_f32_16x16x64_bf16 v[44:47], v[28:31], a[72:79], v172
    v_smfmac_f32_16x16x64_bf16 v[48:51], v[28:31], a[40:47], v172
    v_smfmac_f32_16x16x64_bf16 v[52:55], v[28:31], a[104:111], v172
    s_branch g_43L8_3
g_43L11_1:
    s_waitcnt vmcnt(2)
    v_max3_u32 v19, v28, v29, v30
    v_max_u32 v19, v19, v31
    v_cmp_eq_u32 vcc, -1, v19
    s_nop 0
    s_cbranch_vccnz g_43F11_1
    v_smfmac_f32_16x16x64_bf16 v[40:43], v[28:31], a[8:15], v172
    v_smfmac_f32_16x16x64_bf16 v[44:47], v[28:31], a[72:79], v172
    v_smfmac_f32_16x16x64_bf16 v[48:51], v[28:31], a[40:47], v172
    v_smfmac_f32_16x16x64_bf16 v[52:55], v[28:31], a[104:111], v172
    s_branch g_43L9_3
g_43L13_0:
    s_waitcnt vmcnt(2)
    v_max3_u32 v19, v24, v25, v26
    v_max_u32 v19, v19, v27
    v_cmp_eq_u32 vcc, -1, v19
    s_nop 0
    s_cbranch_vccnz g_43F13_0
    v_smfmac_f32_16x16x64_bf16 v[40:43], v[24:27], a[0:7], v172
    v_smfmac_f32_16x16x64_bf16 v[44:47], v[24:27], a[64:71], v172
    v_smfmac_f32_16x16x64_bf16 v[48:51], v[24:27], a[32:39], v172
    v_smfmac_f32_16x16x64_bf16 v[52:55], v[24:27], a[96:103], v172
    s_branch g_43L12_2
g_43L13_3:
    s_waitcnt vmcnt(2)
    v_max3_u32 v19, v36, v37, v38
    v_max_u32 v19, v19, v39
    v_cmp_eq_u32 vcc, -1, v19
    s_nop 0
    s_cbranch_vccnz g_43F13_3
    v_smfmac_f32_16x16x64_bf16 v[40:43], v[36:39], a[24:31], v172
    v_smfmac_f32_16x16x64_bf16 v[44:47], v[36:39], a[88:95], v172
    v_smfmac_f32_16x16x64_bf16 v[48:51], v[36:39], a[56:63], v172
    v_smfmac_f32_16x16x64_bf16 v[52:55], v[36:39], a[120:127], v172
g_43L5_0:
    s_waitcnt vmcnt(1)
    v_max3_u32 v19, v24, v25, v26
    v_max_u32 v19, v19, v27
    v_cmp_eq_u32 vcc, -1, v19
    s_nop 0
    s_cbranch_vccnz g_43F5_0
    v_smfmac_f32_16x16x64_bf16 v[40:43], v[24:27], a[0:7], v172
    v_smfmac_f32_16x16x64_bf16 v[44:47], v[24:27], a[64:71], v172
    v_smfmac_f32_16x16x64_bf16 v[48:51], v[24:27], a[32:39], v172
    v_smfmac_f32_16x16x64_bf16 v[52:55], v[24:27], a[96:103], v172
    s_branch g_43L4_2
g_43L14_2:
    s_waitcnt vmcnt(2)
    v_max3_u32 v19, v32, v33, v34
    v_max_u32 v19, v19, v35
    v_cmp_eq_u32 vcc, -1, v19
    s_nop 0
    s_cbranch_vccnz g_43F14_2
    v_smfmac_f32_16x16x64_bf16 v[40:43], v[32:35], a[16:23], v172
    v_smfmac_f32_16x16x64_bf16 v[44:47], v[32:35], a[80:87], v172
    v_smfmac_f32_16x16x64_bf16 v[48:51], v[32:35], a[48:55], v172
    v_smfmac_f32_16x16x64_bf16 v[52:55], v[32:35], a[112:119], v172
g_43L10_3:
    s_waitcnt vmcnt(1)
    v_max3_u32 v19, v36, v37, v38
    v_max_u32 v19, v19, v39
    v_cmp_eq_u32 vcc, -1, v19
    s_nop 0
    s_cbranch_vccnz g_43F10_3
    v_smfmac_f32_16x16x64_bf16 v[40:43], v[36:39], a[24:31], v172
    v_smfmac_f32_16x16x64_bf16 v[44:47], v[36:39], a[88:95], v172
    v_smfmac_f32_16x16x64_bf16 v[48:51], v[36:39], a[56:63], v172
    v_smfmac_f32_16x16x64_bf16 v[52:55], v[36:39], a[120:127], v172
    s_branch g_43L2_1
g_43L14_3:
    s_waitcnt vmcnt(2)
    v_max3_u32 v19, v36, v37, v38
    v_max_u32 v19, v19, v39
    v_cmp_eq_u32 vcc, -1, v19
    s_nop 0
    s_cbranch_vccnz g_43F14_3
    v_smfmac_f32_16x16x64_bf16 v[40:43], v[36:39], a[24:31], v172
    v_smfmac_f32_16x16x64_bf16 v[44:47], v[36:39], a[88:95], v172
    v_smfmac_f32_16x16x64_bf16 v[48:51], v[36:39], a[56:63], v172
    v_smfmac_f32_16x16x64_bf16 v[52:55], v[36:39], a[120:127], v172
    s_branch g_43L6_1
g_43L3_1:
    s_waitcnt vmcnt(1)
    v_max3_u32 v19, v28, v29, v30
    v_max_u32 v19, v19, v31
    v_cmp_eq_u32 vcc, -1, v19
    s_nop 0
    s_cbranch_vccnz g_43F3_1
    v_smfmac_f32_16x16x64_bf16 v[40:43], v[28:31], a[8:15], v172
    v_smfmac_f32_16x16x64_bf16 v[44:47], v[28:31], a[72:79], v172
    v_smfmac_f32_16x16x64_bf16 v[48:51], v[28:31], a[40:47], v172
    v_smfmac_f32_16x16x64_bf16 v[52:55], v[28:31], a[104:111], v172
    s_branch g_43L1_0
g_43L6_2:
    s_waitcnt vmcnt(1)
    v_max3_u32 v19, v32, v33, v34
    v_max_u32 v19, v19, v35
    v_cmp_eq_u32 vcc, -1, v19
    s_nop 0
    s_cbranch_vccnz g_43F6_2
    v_smfmac_f32_16x16x64_bf16 v[40:43], v[32:35], a[16:23], v172
    v_smfmac_f32_16x16x64_bf16 v[44:47], v[32:35], a[80:87], v172
    v_smfmac_f32_16x16x64_bf16 v[48:51], v[32:35], a[48:55], v172
    v_smfmac_f32_16x16x64_bf16 v[52:55], v[32:35], a[112:119], v172
    s_branch g_43L2_1
g_43L9_0:
    s_waitcnt vmcnt(1)
    v_max3_u32 v19, v24, v25, v26
    v_max_u32 v19, v19, v27
    v_cmp_eq_u32 vcc, -1, v19
    s_nop 0
    s_cbranch_vccnz g_43F9_0
    v_smfmac_f32_16x16x64_bf16 v[40:43], v[24:27], a[0:7], v172
    v_smfmac_f32_16x16x64_bf16 v[44:47], v[24:27], a[64:71], v172
    v_smfmac_f32_16x16x64_bf16 v[48:51], v[24:27], a[32:39], v172
    v_smfmac_f32_16x16x64_bf16 v[52:55], v[24:27], a[96:103], v172
    s_branch g_43L8_3
g_43L12_3:
    s_waitcnt vmcnt(1)
    v_max3_u32 v19, v36, v37, v38
    v_max_u32 v19, v19, v39
    v_cmp_eq_u32 vcc, -1, v19
    s_nop 0
    s_cbranch_vccnz g_43F12_3
    v_smfmac_f32_16x16x64_bf16 v[40:43], v[36:39], a[24:31], v172
    v_smfmac_f32_16x16x64_bf16 v[44:47], v[36:39], a[88:95], v172
    v_smfmac_f32_16x16x64_bf16 v[48:51], v[36:39], a[56:63], v172
    v_smfmac_f32_16x16x64_bf16 v[52:55], v[36:39], a[120:127], v172
    s_branch g_43L4_2
g_43F15_0:
    s_mov_b64 exec, vcc
    buffer_load_dwordx4 v[24:27], v2, s[4:7], s16 offen offset:0 sc1
    s_mov_b64 exec, -1
    s_add_u32 s23, s23, 1
    s_cmp_lt_u32 s23, 200000
    s_cbranch_scc1 g_43L15_1
    s_mov_b32 s25, 200000
    s_branch gc_44
g_43F15_1:
    s_mov_b64 exec, vcc
    buffer_load_dwordx4 v[28:31], v2, s[4:7], s16 offen offset:1024 sc1
    s_mov_b64 exec, -1
    s_add_u32 s23, s23, 1
    s_cmp_lt_u32 s23, 200000
    s_cbranch_scc1 g_43L15_2
    s_mov_b32 s25, 200000
    s_branch gc_44
g_43F15_2:
    s_mov_b64 exec, vcc
    buffer_load_dwordx4 v[32:35], v2, s[4:7], s16 offen offset:2048 sc1
    s_mov_b64 exec, -1
    s_add_u32 s23, s23, 1
    s_cmp_lt_u32 s23, 200000
    s_cbranch_scc1 g_43L15_3
    s_mov_b32 s25, 200000
    s_branch gc_44
g_43F15_3:
    s_mov_b64 exec, vcc
    buffer_load_dwordx4 v[36:39], v2, s[4:7], s16 offen offset:3072 sc1
    s_mov_b64 exec, -1
    s_add_u32 s23, s23, 1
    s_cmp_lt_u32 s23, 200000
    s_cbranch_scc1 g_43L15_0
    s_mov_b32 s25, 200000
    s_branch gc_44
g_43F7_0:
    s_mov_b64 exec, vcc
    buffer_load_dwordx4 v[24:27], v2, s[4:7], s16 offen offset:0 sc1
    s_mov_b64 exec, -1
    s_add_u32 s23, s23, 1
    s_cmp_lt_u32 s23, 200000
    s_cbranch_scc1 g_43L7_1
    s_mov_b32 s25, 200000
    s_branch gc_44
g_43F7_1:
    s_mov_b64 exec, vcc
    buffer_load_dwordx4 v[28:31], v2, s[4:7], s16 offen offset:1024 sc1
    s_mov_b64 exec, -1
    s_add_u32 s23, s23, 1
    s_cmp_lt_u32 s23, 200000
    s_cbranch_scc1 g_43L7_2
    s_mov_b32 s25, 200000
    s_branch gc_44
g_43F7_2:
    s_mov_b64 exec, vcc
    buffer_load_dwordx4 v[32:35], v2, s[4:7], s16 offen offset:2048 sc1
    s_mov_b64 exec, -1
    s_add_u32 s23, s23, 1
    s_cmp_lt_u32 s23, 200000
    s_cbranch_scc1 g_43L7_0
    s_mov_b32 s25, 200000
    s_branch gc_44
g_43F11_0:
    s_mov_b64 exec, vcc
    buffer_load_dwordx4 v[24:27], v2, s[4:7], s16 offen offset:0 sc1
    s_mov_b64 exec, -1
    s_add_u32 s23, s23, 1
    s_cmp_lt_u32 s23, 200000
    s_cbranch_scc1 g_43L11_1
    s_mov_b32 s25, 200000
    s_branch gc_44
g_43F11_1:
    s_mov_b64 exec, vcc
    buffer_load_dwordx4 v[28:31], v2, s[4:7], s16 offen offset:1024 sc1
    s_mov_b64 exec, -1
    s_add_u32 s23, s23, 1
    s_cmp_lt_u32 s23, 200000
    s_cbranch_scc1 g_43L11_3
    s_mov_b32 s25, 200000
    s_branch gc_44
g_43F11_3:
    s_mov_b64 exec, vcc
    buffer_load_dwordx4 v[36:39], v2, s[4:7], s16 offen offset:3072 sc1
    s_mov_b64 exec, -1
    s_add_u32 s23, s23, 1
    s_cmp_lt_u32 s23, 200000
    s_cbranch_scc1 g_43L11_0
    s_mov_b32 s25, 200000
    s_branch gc_44
g_43F13_0:
    s_mov_b64 exec, vcc
    buffer_load_dwordx4 v[24:27], v2, s[4:7], s16 offen offset:0 sc1
    s_mov_b64 exec, -1
    s_add_u32 s23, s23, 1
    s_cmp_lt_u32 s23, 200000
    s_cbranch_scc1 g_43L13_2
    s_mov_b32 s25, 200000
    s_branch gc_44
g_43F13_2:
    s_mov_b64 exec, vcc
    buffer_load_dwordx4 v[32:35], v2, s[4:7], s16 offen offset:2048 sc1
    s_mov_b64 exec, -1
    s_add_u32 s23, s23, 1
    s_cmp_lt_u32 s23, 200000
    s_cbranch_scc1 g_43L13_3
    s_mov_b32 s25, 200000
    s_branch gc_44
g_43F13_3:
    s_mov_b64 exec, vcc
    buffer_load_dwordx4 v[36:39], v2, s[4:7], s16 offen offset:3072 sc1
    s_mov_b64 exec, -1
    s_add_u32 s23, s23, 1
    s_cmp_lt_u32 s23, 200000
    s_cbranch_scc1 g_43L13_0
    s_mov_b32 s25, 200000
    s_branch gc_44
g_43F14_1:
    s_mov_b64 exec, vcc
    buffer_load_dwordx4 v[28:31], v2, s[4:7], s16 offen offset:1024 sc1
    s_mov_b64 exec, -1
    s_add_u32 s23, s23, 1
    s_cmp_lt_u32 s23, 200000
    s_cbranch_scc1 g_43L14_2
    s_mov_b32 s25, 200000
    s_branch gc_44
g_43F14_2:
    s_mov_b64 exec, vcc
    buffer_load_dwordx4 v[32:35], v2, s[4:7], s16 offen offset:2048 sc1
    s_mov_b64 exec, -1
    s_add_u32 s23, s23, 1
    s_cmp_lt_u32 s23, 200000
    s_cbranch_scc1 g_43L14_3
    s_mov_b32 s25, 200000
    s_branch gc_44
g_43F14_3:
    s_mov_b64 exec, vcc
    buffer_load_dwordx4 v[36:39], v2, s[4:7], s16 offen offset:3072 sc1
    s_mov_b64 exec, -1
    s_add_u32 s23, s23, 1
    s_cmp_lt_u32 s23, 200000
    s_cbranch_scc1 g_43L14_1
    s_mov_b32 s25, 200000
    s_branch gc_44
g_43F3_0:
    s_mov_b64 exec, vcc
    buffer_load_dwordx4 v[24:27], v2, s[4:7], s16 offen offset:0 sc1
    s_mov_b64 exec, -1
    s_add_u32 s23, s23, 1
    s_cmp_lt_u32 s23, 200000
    s_cbranch_scc1 g_43L3_1
    s_mov_b32 s25, 200000
    s_branch gc_44
g_43F3_1:
    s_mov_b64 exec, vcc
    buffer_load_dwordx4 v[28:31], v2, s[4:7], s16 offen offset:1024 sc1
    s_mov_b64 exec, -1
    s_add_u32 s23, s23, 1
    s_cmp_lt_u32 s23, 200000
    s_cbranch_scc1 g_43L3_0
    s_mov_b32 s25, 200000
    s_branch gc_44
g_43F5_0:
    s_mov_b64 exec, vcc
    buffer_load_dwordx4 v[24:27], v2, s[4:7], s16 offen offset:0 sc1
    s_mov_b64 exec, -1
    s_add_u32 s23, s23, 1
    s_cmp_lt_u32 s23, 200000
    s_cbranch_scc1 g_43L5_2
    s_mov_b32 s25, 200000
    s_branch gc_44
g_43F5_2:
    s_mov_b64 exec, vcc
    buffer_load_dwordx4 v[32:35], v2, s[4:7], s16 offen offset:2048 sc1
    s_mov_b64 exec, -1
    s_add_u32 s23, s23, 1
    s_cmp_lt_u32 s23, 200000
    s_cbranch_scc1 g_43L5_0
    s_mov_b32 s25, 200000
    s_branch gc_44
g_43F6_1:
    s_mov_b64 exec, vcc
    buffer_load_dwordx4 v[28:31], v2, s[4:7], s16 offen offset:1024 sc1
    s_mov_b64 exec, -1
    s_add_u32 s23, s23, 1
    s_cmp_lt_u32 s23, 200000
    s_cbranch_scc1 g_43L6_2
    s_mov_b32 s25, 200000
    s_branch gc_44
g_43F6_2:
    s_mov_b64 exec, vcc
    buffer_load_dwordx4 v[32:35], v2, s[4:7], s16 offen offset:2048 sc1
    s_mov_b64 exec, -1
    s_add_u32 s23, s23, 1
    s_cmp_lt_u32 s23, 200000
    s_cbranch_scc1 g_43L6_1
    s_mov_b32 s25, 200000
    s_branch gc_44
g_43F9_0:
    s_mov_b64 exec, vcc
    buffer_load_dwordx4 v[24:27], v2, s[4:7], s16 offen offset:0 sc1
    s_mov_b64 exec, -1
    s_add_u32 s23, s23, 1
    s_cmp_lt_u32 s23, 200000
    s_cbranch_scc1 g_43L9_3
    s_mov_b32 s25, 200000
    s_branch gc_44
g_43F9_3:
    s_mov_b64 exec, vcc
    buffer_load_dwordx4 v[36:39], v2, s[4:7], s16 offen offset:3072 sc1
    s_mov_b64 exec, -1
    s_add_u32 s23, s23, 1
    s_cmp_lt_u32 s23, 200000
    s_cbranch_scc1 g_43L9_0
    s_mov_b32 s25, 200000
    s_branch gc_44
g_43F10_1:
    s_mov_b64 exec, vcc
    buffer_load_dwordx4 v[28:31], v2, s[4:7], s16 offen offset:1024 sc1
    s_mov_b64 exec, -1
    s_add_u32 s23, s23, 1
    s_cmp_lt_u32 s23, 200000
    s_cbranch_scc1 g_43L10_3
    s_mov_b32 s25, 200000
    s_branch gc_44
g_43F10_3:
    s_mov_b64 exec, vcc
    buffer_load_dwordx4 v[36:39], v2, s[4:7], s16 offen offset:3072 sc1
    s_mov_b64 exec, -1
    s_add_u32 s23, s23, 1
    s_cmp_lt_u32 s23, 200000
    s_cbranch_scc1 g_43L10_1
    s_mov_b32 s25, 200000
    s_branch gc_44
g_43F12_2:
    s_mov_b64 exec, vcc
    buffer_load_dwordx4 v[32:35], v2, s[4:7], s16 offen offset:2048 sc1
    s_mov_b64 exec, -1
    s_add_u32 s23, s23, 1
    s_cmp_lt_u32 s23, 200000
    s_cbranch_scc1 g_43L12_3
    s_mov_b32 s25, 200000
    s_branch gc_44
g_43F12_3:
    s_mov_b64 exec, vcc
    buffer_load_dwordx4 v[36:39], v2, s[4:7], s16 offen offset:3072 sc1
    s_mov_b64 exec, -1
    s_add_u32 s23, s23, 1
    s_cmp_lt_u32 s23, 200000
    s_cbranch_scc1 g_43L12_2
    s_mov_b32 s25, 200000
    s_branch gc_44
g_43F1_0:
    s_mov_b64 exec, vcc
    buffer_load_dwordx4 v[24:27], v2, s[4:7], s16 offen offset:0 sc1
    s_mov_b64 exec, -1
    s_add_u32 s23, s23, 1
    s_cmp_lt_u32 s23, 200000
    s_cbranch_scc1 g_43L1_0
    s_mov_b32 s25, 200000
    s_branch gc_44
g_43F2_1:
    s_mov_b64 exec, vcc
    buffer_load_dwordx4 v[28:31], v2, s[4:7], s16 offen offset:1024 sc1
    s_mov_b64 exec, -1
    s_add_u32 s23, s23, 1
    s_cmp_lt_u32 s23, 200000
    s_cbranch_scc1 g_43L2_1
    s_mov_b32 s25, 200000
    s_branch gc_44
g_43F4_2:
    s_mov_b64 exec, vcc
    buffer_load_dwordx4 v[32:35], v2, s[4:7], s16 offen offset:2048 sc1
    s_mov_b64 exec, -1
    s_add_u32 s23, s23, 1
    s_cmp_lt_u32 s23, 200000
    s_cbranch_scc1 g_43L4_2
    s_mov_b32 s25, 200000
    s_branch gc_44
g_43F8_3:
    s_mov_b64 exec, vcc
    buffer_load_dwordx4 v[36:39], v2, s[4:7], s16 offen offset:3072 sc1
    s_mov_b64 exec, -1
    s_add_u32 s23, s23, 1
    s_cmp_lt_u32 s23, 200000
    s_cbranch_scc1 g_43L8_3
    s_mov_b32 s25, 200000
    s_branch gc_44
recur_fast_last2:
    buffer_store_dwordx4 v[168:171], v15, s[4:7], s20 offen sc1
    s_waitcnt vmcnt(0)
    s_branch recur_end
g_45L15_0:
    s_waitcnt vmcnt(3)
    v_max3_u32 v19, v24, v25, v26
    v_max_u32 v19, v19, v27
    v_cmp_eq_u32 vcc, -1, v19
    s_nop 0
    s_cbranch_vccnz g_45F15_0
    v_smfmac_f32_16x16x64_bf16 v[64:67], v[24:27], a[192:199], v172
    v_smfmac_f32_16x16x64_bf16 v[68:71], v[24:27], a[224:231], v172
g_45L14_1:
    s_waitcnt vmcnt(2)
    v_max3_u32 v19, v28, v29, v30
    v_max_u32 v19, v19, v31
    v_cmp_eq_u32 vcc, -1, v19
    s_nop 0
    s_cbranch_vccnz g_45F14_1
    v_smfmac_f32_16x16x64_bf16 v[64:67], v[28:31], a[200:207], v172
    v_smfmac_f32_16x16x64_bf16 v[68:71], v[28:31], a[232:239], v172
g_45L12_2:
    s_waitcnt vmcnt(1)
    v_max3_u32 v19, v32, v33, v34
    v_max_u32 v19, v19, v35
    v_cmp_eq_u32 vcc, -1, v19
    s_nop 0
    s_cbranch_vccnz g_45F12_2
    v_smfmac_f32_16x16x64_bf16 v[64:67], v[32:35], a[208:215], v172
    v_smfmac_f32_16x16x64_bf16 v[68:71], v[32:35], a[240:247], v172
g_45L8_3:
    s_waitcnt vmcnt(0)
    v_max3_u32 v19, v36, v37, v38
    v_max_u32 v19, v19, v39
    v_cmp_eq_u32 vcc, -1, v19
    s_nop 0
    s_cbranch_vccnz g_45F8_3
    v_smfmac_f32_16x16x64_bf16 v[64:67], v[36:39], a[216:223], v172
    v_smfmac_f32_16x16x64_bf16 v[68:71], v[36:39], a[248:255], v172
    s_nop 4
    v_cvt_pk_bf16_f32 v80, v64, v65
    v_cvt_pk_bf16_f32 v81, v66, v67
    s_nop 0
    v_cvt_pk_bf16_f32 v82, v68, v69
    v_cvt_pk_bf16_f32 v83, v70, v71
    ds_write_b128 v17, v[80:83] offset:9216
    s_branch gc_46
g_45L15_1:
    s_waitcnt vmcnt(3)
    v_max3_u32 v19, v28, v29, v30
    v_max_u32 v19, v19, v31
    v_cmp_eq_u32 vcc, -1, v19
    s_nop 0
    s_cbranch_vccnz g_45F15_1
    v_smfmac_f32_16x16x64_bf16 v[64:67], v[28:31], a[200:207], v172
    v_smfmac_f32_16x16x64_bf16 v[68:71], v[28:31], a[232:239], v172
g_45L13_2:
    s_waitcnt vmcnt(2)
    v_max3_u32 v19, v32, v33, v34
    v_max_u32 v19, v19, v35
    v_cmp_eq_u32 vcc, -1, v19
    s_nop 0
    s_cbranch_vccnz g_45F13_2
    v_smfmac_f32_16x16x64_bf16 v[64:67], v[32:35], a[208:215], v172
    v_smfmac_f32_16x16x64_bf16 v[68:71], v[32:35], a[240:247], v172
g_45L9_3:
    s_waitcnt vmcnt(1)
    v_max3_u32 v19, v36, v37, v38
    v_max_u32 v19, v19, v39
    v_cmp_eq_u32 vcc, -1, v19
    s_nop 0
    s_cbranch_vccnz g_45F9_3
    v_smfmac_f32_16x16x64_bf16 v[64:67], v[36:39], a[216:223], v172
    v_smfmac_f32_16x16x64_bf16 v[68:71], v[36:39], a[248:255], v172
g_45L1_0:
    s_waitcnt vmcnt(0)
    v_max3_u32 v19, v24, v25, v26
    v_max_u32 v19, v19, v27
    v_cmp_eq_u32 vcc, -1, v19
    s_nop 0
    s_cbranch_vccnz g_45F1_0
    v_smfmac_f32_16x16x64_bf16 v[64:67], v[24:27], a[192:199], v172
    v_smfmac_f32_16x16x64_bf16 v[68:71], v[24:27], a[224:231], v172
    s_nop 4
    v_cvt_pk_bf16_f32 v80, v64, v65
    v_cvt_pk_bf16_f32 v81, v66, v67
    s_nop 0
    v_cvt_pk_bf16_f32 v82, v68, v69
    v_cvt_pk_bf16_f32 v83, v70, v71
    ds_write_b128 v17, v[80:83] offset:9216
    s_branch gc_46
g_45L15_2:
    s_waitcnt vmcnt(3)
    v_max3_u32 v19, v32, v33, v34
    v_max_u32 v19, v19, v35
    v_cmp_eq_u32 vcc, -1, v19
    s_nop 0
    s_cbranch_vccnz g_45F15_2
    v_smfmac_f32_16x16x64_bf16 v[64:67], v[32:35], a[208:215], v172
    v_smfmac_f32_16x16x64_bf16 v[68:71], v[32:35], a[240:247], v172
g_45L11_3:
    s_waitcnt vmcnt(2)
    v_max3_u32 v19, v36, v37, v38
    v_max_u32 v19, v19, v39
    v_cmp_eq_u32 vcc, -1, v19
    s_nop 0
    s_cbranch_vccnz g_45F11_3
    v_smfmac_f32_16x16x64_bf16 v[64:67], v[36:39], a[216:223], v172
    v_smfmac_f32_16x16x64_bf16 v[68:71], v[36:39], a[248:255], v172
g_45L3_0:
    s_waitcnt vmcnt(1)
    v_max3_u32 v19, v24, v25, v26
    v_max_u32 v19, v19, v27
    v_cmp_eq_u32 vcc, -1, v19
    s_nop 0
    s_cbranch_vccnz g_45F3_0
    v_smfmac_f32_16x16x64_bf16 v[64:67], v[24:27], a[192:199], v172
    v_smfmac_f32_16x16x64_bf16 v[68:71], v[24:27], a[224:231], v172
g_45L2_1:
    s_waitcnt vmcnt(0)
    v_max3_u32 v19, v28, v29, v30
    v_max_u32 v19, v19, v31
    v_cmp_eq_u32 vcc, -1, v19
    s_nop 0
    s_cbranch_vccnz g_45F2_1
    v_smfmac_f32_16x16x64_bf16 v[64:67], v[28:31], a[200:207], v172
    v_smfmac_f32_16x16x64_bf16 v[68:71], v[28:31], a[232:239], v172
    s_nop 4
    v_cvt_pk_bf16_f32 v80, v64, v65
    v_cvt_pk_bf16_f32 v81, v66, v67
    s_nop 0
    v_cvt_pk_bf16_f32 v82, v68, v69
    v_cvt_pk_bf16_f32 v83, v70, v71
    ds_write_b128 v17, v[80:83] offset:9216
    s_branch gc_46
g_45L15_3:
    s_waitcnt vmcnt(3)
    v_max3_u32 v19, v36, v37, v38
    v_max_u32 v19, v19, v39
    v_cmp_eq_u32 vcc, -1, v19
    s_nop 0
    s_cbranch_vccnz g_45F15_3
    v_smfmac_f32_16x16x64_bf16 v[64:67], v[36:39], a[216:223], v172
    v_smfmac_f32_16x16x64_bf16 v[68:71], v[36:39], a[248:255], v172
g_45L7_0:
    s_waitcnt vmcnt(2)
    v_max3_u32 v19, v24, v25, v26
    v_max_u32 v19, v19, v27
    v_cmp_eq_u32 vcc, -1, v19
    s_nop 0
    s_cbranch_vccnz g_45F7_0
    v_smfmac_f32_16x16x64_bf16 v[64:67], v[24:27], a[192:199], v172
    v_smfmac_f32_16x16x64_bf16 v[68:71], v[24:27], a[224:231], v172
g_45L6_1:
    s_waitcnt vmcnt(1)
    v_max3_u32 v19, v28, v29, v30
    v_max_u32 v19, v19, v31
    v_cmp_eq_u32 vcc, -1, v19
    s_nop 0
    s_cbranch_vccnz g_45F6_1
    v_smfmac_f32_16x16x64_bf16 v[64:67], v[28:31], a[200:207], v172
    v_smfmac_f32_16x16x64_bf16 v[68:71], v[28:31], a[232:239], v172
g_45L4_2:
    s_waitcnt vmcnt(0)
    v_max3_u32 v19, v32, v33, v34
    v_max_u32 v19, v19, v35
    v_cmp_eq_u32 vcc, -1, v19
    s_nop 0
    s_cbranch_vccnz g_45F4_2
    v_smfmac_f32_16x16x64_bf16 v[64:67], v[32:35], a[208:215], v172
    v_smfmac_f32_16x16x64_bf16 v[68:71], v[32:35], a[240:247], v172
    s_nop 4
    v_cvt_pk_bf16_f32 v80, v64, v65
    v_cvt_pk_bf16_f32 v81, v66, v67
    s_nop 0
    v_cvt_pk_bf16_f32 v82, v68, v69
    v_cvt_pk_bf16_f32 v83, v70, v71
    ds_write_b128 v17, v[80:83] offset:9216
    s_branch gc_46
g_45L7_1:
    s_waitcnt vmcnt(2)
    v_max3_u32 v19, v28, v29, v30
    v_max_u32 v19, v19, v31
    v_cmp_eq_u32 vcc, -1, v19
    s_nop 0
    s_cbranch_vccnz g_45F7_1
    v_smfmac_f32_16x16x64_bf16 v[64:67], v[28:31], a[200:207], v172
    v_smfmac_f32_16x16x64_bf16 v[68:71], v[28:31], a[232:239], v172
g_45L5_2:
    s_waitcnt vmcnt(1)
    v_max3_u32 v19, v32, v33, v34
    v_max_u32 v19, v19, v35
    v_cmp_eq_u32 vcc, -1, v19
    s_nop 0
    s_cbranch_vccnz g_45F5_2
    v_smfmac_f32_16x16x64_bf16 v[64:67], v[32:35], a[208:215], v172
    v_smfmac_f32_16x16x64_bf16 v[68:71], v[32:35], a[240:247], v172
    s_branch g_45L1_0
g_45L7_2:
    s_waitcnt vmcnt(2)
    v_max3_u32 v19, v32, v33, v34
    v_max_u32 v19, v19, v35
    v_cmp_eq_u32 vcc, -1, v19
    s_nop 0
    s_cbranch_vccnz g_45F7_2
    v_smfmac_f32_16x16x64_bf16 v[64:67], v[32:35], a[208:215], v172
    v_smfmac_f32_16x16x64_bf16 v[68:71], v[32:35], a[240:247], v172
    s_branch g_45L3_0
g_45L11_0:
    s_waitcnt vmcnt(2)
    v_max3_u32 v19, v24, v25, v26
    v_max_u32 v19, v19, v27
    v_cmp_eq_u32 vcc, -1, v19
    s_nop 0
    s_cbranch_vccnz g_45F11_0
    v_smfmac_f32_16x16x64_bf16 v[64:67], v[24:27], a[192:199], v172
    v_smfmac_f32_16x16x64_bf16 v[68:71], v[24:27], a[224:231], v172
g_45L10_1:
    s_waitcnt vmcnt(1)
    v_max3_u32 v19, v28, v29, v30
    v_max_u32 v19, v19, v31
    v_cmp_eq_u32 vcc, -1, v19
    s_nop 0
    s_cbranch_vccnz g_45F10_1
    v_smfmac_f32_16x16x64_bf16 v[64:67], v[28:31], a[200:207], v172
    v_smfmac_f32_16x16x64_bf16 v[68:71], v[28:31], a[232:239], v172
    s_branch g_45L8_3
g_45L11_1:
    s_waitcnt vmcnt(2)
    v_max3_u32 v19, v28, v29, v30
    v_max_u32 v19, v19, v31
    v_cmp_eq_u32 vcc, -1, v19
    s_nop 0
    s_cbranch_vccnz g_45F11_1
    v_smfmac_f32_16x16x64_bf16 v[64:67], v[28:31], a[200:207], v172
    v_smfmac_f32_16x16x64_bf16 v[68:71], v[28:31], a[232:239], v172
    s_branch g_45L9_3
g_45L13_0:
    s_waitcnt vmcnt(2)
    v_max3_u32 v19, v24, v25, v26
    v_max_u32 v19, v19, v27
    v_cmp_eq_u32 vcc, -1, v19
    s_nop 0
    s_cbranch_vccnz g_45F13_0
    v_smfmac_f32_16x16x64_bf16 v[64:67], v[24:27], a[192:199], v172
    v_smfmac_f32_16x16x64_bf16 v[68:71], v[24:27], a[224:231], v172
    s_branch g_45L12_2
g_45L13_3:
    s_waitcnt vmcnt(2)
    v_max3_u32 v19, v36, v37, v38
    v_max_u32 v19, v19, v39
    v_cmp_eq_u32 vcc, -1, v19
    s_nop 0
    s_cbranch_vccnz g_45F13_3
    v_smfmac_f32_16x16x64_bf16 v[64:67], v[36:39], a[216:223], v172
    v_smfmac_f32_16x16x64_bf16 v[68:71], v[36:39], a[248:255], v172
g_45L5_0:
    s_waitcnt vmcnt(1)
    v_max3_u32 v19, v24, v25, v26
    v_max_u32 v19, v19, v27
    v_cmp_eq_u32 vcc, -1, v19
    s_nop 0
    s_cbranch_vccnz g_45F5_0
    v_smfmac_f32_16x16x64_bf16 v[64:67], v[24:27], a[192:199], v172
    v_smfmac_f32_16x16x64_bf16 v[68:71], v[24:27], a[224:231], v172
    s_branch g_45L4_2
g_45L14_2:
    s_waitcnt vmcnt(2)
    v_max3_u32 v19, v32, v33, v34
    v_max_u32 v19, v19, v35
    v_cmp_eq_u32 vcc, -1, v19
    s_nop 0
    s_cbranch_vccnz g_45F14_2
    v_smfmac_f32_16x16x64_bf16 v[64:67], v[32:35], a[208:215], v172
    v_smfmac_f32_16x16x64_bf16 v[68:71], v[32:35], a[240:247], v172
g_45L10_3:
    s_waitcnt vmcnt(1)
    v_max3_u32 v19, v36, v37, v38
    v_max_u32 v19, v19, v39
    v_cmp_eq_u32 vcc, -1, v19
    s_nop 0
    s_cbranch_vccnz g_45F10_3
    v_smfmac_f32_16x16x64_bf16 v[64:67], v[36:39], a[216:223], v172
    v_smfmac_f32_16x16x64_bf16 v[68:71], v[36:39], a[248:255], v172
    s_branch g_45L2_1
g_45L14_3:
    s_waitcnt vmcnt(2)
    v_max3_u32 v19, v36, v37, v38
    v_max_u32 v19, v19, v39
    v_cmp_eq_u32 vcc, -1, v19
    s_nop 0
    s_cbranch_vccnz g_45F14_3
    v_smfmac_f32_16x16x64_bf16 v[64:67], v[36:39], a[216:223], v172
    v_smfmac_f32_16x16x64_bf16 v[68:71], v[36:39], a[248:255], v172
    s_branch g_45L6_1
g_45L3_1:
    s_waitcnt vmcnt(1)
    v_max3_u32 v19, v28, v29, v30
    v_max_u32 v19, v19, v31
    v_cmp_eq_u32 vcc, -1, v19
    s_nop 0
    s_cbranch_vccnz g_45F3_1
    v_smfmac_f32_16x16x64_bf16 v[64:67], v[28:31], a[200:207], v172
    v_smfmac_f32_16x16x64_bf16 v[68:71], v[28:31], a[232:239], v172
    s_branch g_45L1_0
g_45L6_2:
    s_waitcnt vmcnt(1)
    v_max3_u32 v19, v32, v33, v34
    v_max_u32 v19, v19, v35
    v_cmp_eq_u32 vcc, -1, v19
    s_nop 0
    s_cbranch_vccnz g_45F6_2
    v_smfmac_f32_16x16x64_bf16 v[64:67], v[32:35], a[208:215], v172
    v_smfmac_f32_16x16x64_bf16 v[68:71], v[32:35], a[240:247], v172
    s_branch g_45L2_1
g_45L9_0:
    s_waitcnt vmcnt(1)
    v_max3_u32 v19, v24, v25, v26
    v_max_u32 v19, v19, v27
    v_cmp_eq_u32 vcc, -1, v19
    s_nop 0
    s_cbranch_vccnz g_45F9_0
    v_smfmac_f32_16x16x64_bf16 v[64:67], v[24:27], a[192:199], v172
    v_smfmac_f32_16x16x64_bf16 v[68:71], v[24:27], a[224:231], v172
    s_branch g_45L8_3
g_45L12_3:
    s_waitcnt vmcnt(1)
    v_max3_u32 v19, v36, v37, v38
    v_max_u32 v19, v19, v39
    v_cmp_eq_u32 vcc, -1, v19
    s_nop 0
    s_cbranch_vccnz g_45F12_3
    v_smfmac_f32_16x16x64_bf16 v[64:67], v[36:39], a[216:223], v172
    v_smfmac_f32_16x16x64_bf16 v[68:71], v[36:39], a[248:255], v172
    s_branch g_45L4_2
g_45F15_0:
    s_mov_b64 exec, vcc
    buffer_load_dwordx4 v[24:27], v8, s[4:7], s16 offen offset:0 sc1
    s_mov_b64 exec, -1
    s_add_u32 s23, s23, 1
    s_cmp_lt_u32 s23, 200000
    s_cbranch_scc1 g_45L15_1
    s_mov_b32 s25, 200000
    s_branch gc_46
g_45F15_1:
    s_mov_b64 exec, vcc
    buffer_load_dwordx4 v[28:31], v8, s[4:7], s16 offen offset:1024 sc1
    s_mov_b64 exec, -1
    s_add_u32 s23, s23, 1
    s_cmp_lt_u32 s23, 200000
    s_cbranch_scc1 g_45L15_2
    s_mov_b32 s25, 200000
    s_branch gc_46
g_45F15_2:
    s_mov_b64 exec, vcc
    buffer_load_dwordx4 v[32:35], v8, s[4:7], s16 offen offset:2048 sc1
    s_mov_b64 exec, -1
    s_add_u32 s23, s23, 1
    s_cmp_lt_u32 s23, 200000
    s_cbranch_scc1 g_45L15_3
    s_mov_b32 s25, 200000
    s_branch gc_46
g_45F15_3:
    s_mov_b64 exec, vcc
    buffer_load_dwordx4 v[36:39], v8, s[4:7], s16 offen offset:3072 sc1
    s_mov_b64 exec, -1
    s_add_u32 s23, s23, 1
    s_cmp_lt_u32 s23, 200000
    s_cbranch_scc1 g_45L15_0
    s_mov_b32 s25, 200000
    s_branch gc_46
g_45F7_0:
    s_mov_b64 exec, vcc
    buffer_load_dwordx4 v[24:27], v8, s[4:7], s16 offen offset:0 sc1
    s_mov_b64 exec, -1
    s_add_u32 s23, s23, 1
    s_cmp_lt_u32 s23, 200000
    s_cbranch_scc1 g_45L7_1
    s_mov_b32 s25, 200000
    s_branch gc_46
g_45F7_1:
    s_mov_b64 exec, vcc
    buffer_load_dwordx4 v[28:31], v8, s[4:7], s16 offen offset:1024 sc1
    s_mov_b64 exec, -1
    s_add_u32 s23, s23, 1
    s_cmp_lt_u32 s23, 200000
    s_cbranch_scc1 g_45L7_2
    s_mov_b32 s25, 200000
    s_branch gc_46
g_45F7_2:
    s_mov_b64 exec, vcc
    buffer_load_dwordx4 v[32:35], v8, s[4:7], s16 offen offset:2048 sc1
    s_mov_b64 exec, -1
    s_add_u32 s23, s23, 1
    s_cmp_lt_u32 s23, 200000
    s_cbranch_scc1 g_45L7_0
    s_mov_b32 s25, 200000
    s_branch gc_46
g_45F11_0:
    s_mov_b64 exec, vcc
    buffer_load_dwordx4 v[24:27], v8, s[4:7], s16 offen offset:0 sc1
    s_mov_b64 exec, -1
    s_add_u32 s23, s23, 1
    s_cmp_lt_u32 s23, 200000
    s_cbranch_scc1 g_45L11_1
    s_mov_b32 s25, 200000
    s_branch gc_46
g_45F11_1:
    s_mov_b64 exec, vcc
    buffer_load_dwordx4 v[28:31], v8, s[4:7], s16 offen offset:1024 sc1
    s_mov_b64 exec, -1
    s_add_u32 s23, s23, 1
    s_cmp_lt_u32 s23, 200000
    s_cbranch_scc1 g_45L11_3
    s_mov_b32 s25, 200000
    s_branch gc_46
g_45F11_3:
    s_mov_b64 exec, vcc
    buffer_load_dwordx4 v[36:39], v8, s[4:7], s16 offen offset:3072 sc1
    s_mov_b64 exec, -1
    s_add_u32 s23, s23, 1
    s_cmp_lt_u32 s23, 200000
    s_cbranch_scc1 g_45L11_0
    s_mov_b32 s25, 200000
    s_branch gc_46
g_45F13_0:
    s_mov_b64 exec, vcc
    buffer_load_dwordx4 v[24:27], v8, s[4:7], s16 offen offset:0 sc1
    s_mov_b64 exec, -1
    s_add_u32 s23, s23, 1
    s_cmp_lt_u32 s23, 200000
    s_cbranch_scc1 g_45L13_2
    s_mov_b32 s25, 200000
    s_branch gc_46
g_45F13_2:
    s_mov_b64 exec, vcc
    buffer_load_dwordx4 v[32:35], v8, s[4:7], s16 offen offset:2048 sc1
    s_mov_b64 exec, -1
    s_add_u32 s23, s23, 1
    s_cmp_lt_u32 s23, 200000
    s_cbranch_scc1 g_45L13_3
    s_mov_b32 s25, 200000
    s_branch gc_46
g_45F13_3:
    s_mov_b64 exec, vcc
    buffer_load_dwordx4 v[36:39], v8, s[4:7], s16 offen offset:3072 sc1
    s_mov_b64 exec, -1
    s_add_u32 s23, s23, 1
    s_cmp_lt_u32 s23, 200000
    s_cbranch_scc1 g_45L13_0
    s_mov_b32 s25, 200000
    s_branch gc_46
g_45F14_1:
    s_mov_b64 exec, vcc
    buffer_load_dwordx4 v[28:31], v8, s[4:7], s16 offen offset:1024 sc1
    s_mov_b64 exec, -1
    s_add_u32 s23, s23, 1
    s_cmp_lt_u32 s23, 200000
    s_cbranch_scc1 g_45L14_2
    s_mov_b32 s25, 200000
    s_branch gc_46
g_45F14_2:
    s_mov_b64 exec, vcc
    buffer_load_dwordx4 v[32:35], v8, s[4:7], s16 offen offset:2048 sc1
    s_mov_b64 exec, -1
    s_add_u32 s23, s23, 1
    s_cmp_lt_u32 s23, 200000
    s_cbranch_scc1 g_45L14_3
    s_mov_b32 s25, 200000
    s_branch gc_46
g_45F14_3:
    s_mov_b64 exec, vcc
    buffer_load_dwordx4 v[36:39], v8, s[4:7], s16 offen offset:3072 sc1
    s_mov_b64 exec, -1
    s_add_u32 s23, s23, 1
    s_cmp_lt_u32 s23, 200000
    s_cbranch_scc1 g_45L14_1
    s_mov_b32 s25, 200000
    s_branch gc_46
g_45F3_0:
    s_mov_b64 exec, vcc
    buffer_load_dwordx4 v[24:27], v8, s[4:7], s16 offen offset:0 sc1
    s_mov_b64 exec, -1
    s_add_u32 s23, s23, 1
    s_cmp_lt_u32 s23, 200000
    s_cbranch_scc1 g_45L3_1
    s_mov_b32 s25, 200000
    s_branch gc_46
g_45F3_1:
    s_mov_b64 exec, vcc
    buffer_load_dwordx4 v[28:31], v8, s[4:7], s16 offen offset:1024 sc1
    s_mov_b64 exec, -1
    s_add_u32 s23, s23, 1
    s_cmp_lt_u32 s23, 200000
    s_cbranch_scc1 g_45L3_0
    s_mov_b32 s25, 200000
    s_branch gc_46
g_45F5_0:
    s_mov_b64 exec, vcc
    buffer_load_dwordx4 v[24:27], v8, s[4:7], s16 offen offset:0 sc1
    s_mov_b64 exec, -1
    s_add_u32 s23, s23, 1
    s_cmp_lt_u32 s23, 200000
    s_cbranch_scc1 g_45L5_2
    s_mov_b32 s25, 200000
    s_branch gc_46
g_45F5_2:
    s_mov_b64 exec, vcc
    buffer_load_dwordx4 v[32:35], v8, s[4:7], s16 offen offset:2048 sc1
    s_mov_b64 exec, -1
    s_add_u32 s23, s23, 1
    s_cmp_lt_u32 s23, 200000
    s_cbranch_scc1 g_45L5_0
    s_mov_b32 s25, 200000
    s_branch gc_46
g_45F6_1:
    s_mov_b64 exec, vcc
    buffer_load_dwordx4 v[28:31], v8, s[4:7], s16 offen offset:1024 sc1
    s_mov_b64 exec, -1
    s_add_u32 s23, s23, 1
    s_cmp_lt_u32 s23, 200000
    s_cbranch_scc1 g_45L6_2
    s_mov_b32 s25, 200000
    s_branch gc_46
g_45F6_2:
    s_mov_b64 exec, vcc
    buffer_load_dwordx4 v[32:35], v8, s[4:7], s16 offen offset:2048 sc1
    s_mov_b64 exec, -1
    s_add_u32 s23, s23, 1
    s_cmp_lt_u32 s23, 200000
    s_cbranch_scc1 g_45L6_1
    s_mov_b32 s25, 200000
    s_branch gc_46
g_45F9_0:
    s_mov_b64 exec, vcc
    buffer_load_dwordx4 v[24:27], v8, s[4:7], s16 offen offset:0 sc1
    s_mov_b64 exec, -1
    s_add_u32 s23, s23, 1
    s_cmp_lt_u32 s23, 200000
    s_cbranch_scc1 g_45L9_3
    s_mov_b32 s25, 200000
    s_branch gc_46
g_45F9_3:
    s_mov_b64 exec, vcc
    buffer_load_dwordx4 v[36:39], v8, s[4:7], s16 offen offset:3072 sc1
    s_mov_b64 exec, -1
    s_add_u32 s23, s23, 1
    s_cmp_lt_u32 s23, 200000
    s_cbranch_scc1 g_45L9_0
    s_mov_b32 s25, 200000
    s_branch gc_46
g_45F10_1:
    s_mov_b64 exec, vcc
    buffer_load_dwordx4 v[28:31], v8, s[4:7], s16 offen offset:1024 sc1
    s_mov_b64 exec, -1
    s_add_u32 s23, s23, 1
    s_cmp_lt_u32 s23, 200000
    s_cbranch_scc1 g_45L10_3
    s_mov_b32 s25, 200000
    s_branch gc_46
g_45F10_3:
    s_mov_b64 exec, vcc
    buffer_load_dwordx4 v[36:39], v8, s[4:7], s16 offen offset:3072 sc1
    s_mov_b64 exec, -1
    s_add_u32 s23, s23, 1
    s_cmp_lt_u32 s23, 200000
    s_cbranch_scc1 g_45L10_1
    s_mov_b32 s25, 200000
    s_branch gc_46
g_45F12_2:
    s_mov_b64 exec, vcc
    buffer_load_dwordx4 v[32:35], v8, s[4:7], s16 offen offset:2048 sc1
    s_mov_b64 exec, -1
    s_add_u32 s23, s23, 1
    s_cmp_lt_u32 s23, 200000
    s_cbranch_scc1 g_45L12_3
    s_mov_b32 s25, 200000
    s_branch gc_46
g_45F12_3:
    s_mov_b64 exec, vcc
    buffer_load_dwordx4 v[36:39], v8, s[4:7], s16 offen offset:3072 sc1
    s_mov_b64 exec, -1
    s_add_u32 s23, s23, 1
    s_cmp_lt_u32 s23, 200000
    s_cbranch_scc1 g_45L12_2
    s_mov_b32 s25, 200000
    s_branch gc_46
g_45F1_0:
    s_mov_b64 exec, vcc
    buffer_load_dwordx4 v[24:27], v8, s[4:7], s16 offen offset:0 sc1
    s_mov_b64 exec, -1
    s_add_u32 s23, s23, 1
    s_cmp_lt_u32 s23, 200000
    s_cbranch_scc1 g_45L1_0
    s_mov_b32 s25, 200000
    s_branch gc_46
g_45F2_1:
    s_mov_b64 exec, vcc
    buffer_load_dwordx4 v[28:31], v8, s[4:7], s16 offen offset:1024 sc1
    s_mov_b64 exec, -1
    s_add_u32 s23, s23, 1
    s_cmp_lt_u32 s23, 200000
    s_cbranch_scc1 g_45L2_1
    s_mov_b32 s25, 200000
    s_branch gc_46
g_45F4_2:
    s_mov_b64 exec, vcc
    buffer_load_dwordx4 v[32:35], v8, s[4:7], s16 offen offset:2048 sc1
    s_mov_b64 exec, -1
    s_add_u32 s23, s23, 1
    s_cmp_lt_u32 s23, 200000
    s_cbranch_scc1 g_45L4_2
    s_mov_b32 s25, 200000
    s_branch gc_46
g_45F8_3:
    s_mov_b64 exec, vcc
    buffer_load_dwordx4 v[36:39], v8, s[4:7], s16 offen offset:3072 sc1
    s_mov_b64 exec, -1
    s_add_u32 s23, s23, 1
    s_cmp_lt_u32 s23, 200000
    s_cbranch_scc1 g_45L8_3
    s_mov_b32 s25, 200000
    s_branch gc_46
.p2align 6
recur_fast_w3:
    s_nop 15
    s_mov_b32 s23, s25
    buffer_load_dwordx4 v[24:27], v2, s[4:7], s16 offen offset:0 sc1
    s_nop 11
    buffer_load_dwordx4 v[28:31], v2, s[4:7], s16 offen offset:1024 sc1
    s_nop 11
    buffer_load_dwordx4 v[32:35], v2, s[4:7], s16 offen offset:2048 sc1
    s_nop 11
    buffer_load_dwordx4 v[36:39], v2, s[4:7], s16 offen offset:3072 sc1
    s_waitcnt vmcnt(3)
    v_max3_u32 v19, v24, v25, v26
    v_max_u32 v19, v19, v27
    v_cmp_eq_u32 vcc, -1, v19
    s_nop 0
    s_cbranch_vccnz g_47F15_0
    v_smfmac_f32_16x16x64_bf16 v[40:43], v[24:27], a[0:7], v172
    s_waitcnt vmcnt(2)
    v_max3_u32 v19, v28, v29, v30
    v_max_u32 v19, v19, v31
    v_smfmac_f32_16x16x64_bf16 v[44:47], v[24:27], a[64:71], v172
    v_cmp_eq_u32 vcc, -1, v19
    v_smfmac_f32_16x16x64_bf16 v[48:51], v[24:27], a[32:39], v172
    v_smfmac_f32_16x16x64_bf16 v[52:55], v[24:27], a[96:103], v172
    s_cbranch_vccnz g_47F14_1
    v_smfmac_f32_16x16x64_bf16 v[40:43], v[28:31], a[8:15], v172
    s_waitcnt vmcnt(1)
    v_max3_u32 v19, v32, v33, v34
    v_max_u32 v19, v19, v35
    v_smfmac_f32_16x16x64_bf16 v[44:47], v[28:31], a[72:79], v172
    v_cmp_eq_u32 vcc, -1, v19
    v_smfmac_f32_16x16x64_bf16 v[48:51], v[28:31], a[40:47], v172
    v_smfmac_f32_16x16x64_bf16 v[52:55], v[28:31], a[104:111], v172
    s_cbranch_vccnz g_47F12_2
    v_smfmac_f32_16x16x64_bf16 v[40:43], v[32:35], a[16:23], v172
    s_waitcnt vmcnt(0)
    v_max3_u32 v19, v36, v37, v38
    v_max_u32 v19, v19, v39
    v_smfmac_f32_16x16x64_bf16 v[44:47], v[32:35], a[80:87], v172
    v_cmp_eq_u32 vcc, -1, v19
    v_smfmac_f32_16x16x64_bf16 v[48:51], v[32:35], a[48:55], v172
    v_smfmac_f32_16x16x64_bf16 v[52:55], v[32:35], a[112:119], v172
    s_cbranch_vccnz g_47F8_3
    v_smfmac_f32_16x16x64_bf16 v[40:43], v[36:39], a[24:31], v172
    v_smfmac_f32_16x16x64_bf16 v[44:47], v[36:39], a[88:95], v172
    v_smfmac_f32_16x16x64_bf16 v[48:51], v[36:39], a[56:63], v172
    v_smfmac_f32_16x16x64_bf16 v[52:55], v[36:39], a[120:127], v172
gc_48:
    v_cvt_pk_bf16_f32 v72, v40, v41
    v_cvt_pk_bf16_f32 v73, v42, v43
    v_cvt_pk_bf16_f32 v74, v44, v45
    v_cvt_pk_bf16_f32 v75, v46, v47
    ds_write_b128 v17, v[72:75] offset:0
    v_cvt_pk_bf16_f32 v76, v48, v49
    v_cvt_pk_bf16_f32 v77, v50, v51
    s_nop 0
    v_cvt_pk_bf16_f32 v78, v52, v53
    v_cvt_pk_bf16_f32 v79, v54, v55
    ds_write_b128 v17, v[76:79] offset:1024
    v_smfmac_f32_16x16x64_bf16 v[56:59], v[24:27], a[128:135], v172
    v_smfmac_f32_16x16x64_bf16 v[60:63], v[24:27], a[160:167], v172
    v_smfmac_f32_16x16x64_bf16 v[56:59], v[28:31], a[136:143], v172
    s_waitcnt lgkmcnt(0)
    s_barrier
    v_smfmac_f32_16x16x64_bf16 v[60:63], v[28:31], a[168:175], v172
    v_smfmac_f32_16x16x64_bf16 v[56:59], v[32:35], a[144:151], v172
    v_smfmac_f32_16x16x64_bf16 v[60:63], v[32:35], a[176:183], v172
    v_smfmac_f32_16x16x64_bf16 v[56:59], v[36:39], a[152:159], v172
    v_smfmac_f32_16x16x64_bf16 v[60:63], v[36:39], a[184:191], v172
    s_nop 4
    v_cvt_pk_bf16_f32 v80, v56, v57
    v_cvt_pk_bf16_f32 v81, v58, v59
    s_nop 0
    v_cvt_pk_bf16_f32 v82, v60, v61
    v_cvt_pk_bf16_f32 v83, v62, v63
    ds_write_b128 v17, v[80:83] offset:8192
    buffer_store_dwordx4 v[204:207], v3, s[4:7], s43 offen
    buffer_store_dwordx4 v[204:207], v3, s[4:7], s43 offen offset:128
    buffer_store_dwordx4 v[204:207], v4, s[4:7], s43 offen
    buffer_store_dwordx2 v[204:205], v7, s[4:7], s43 offen
    buffer_store_dwordx2 v[204:205], v11, s[4:7], s43 offen
    s_cmp_eq_u32 s15, 63
    s_waitcnt lgkmcnt(0)
    s_barrier
    s_cbranch_scc1 recur_end
    s_barrier
    s_nop 15
    s_mov_b32 s23, s25
    buffer_load_dwordx4 v[24:27], v8, s[4:7], s16 offen offset:0 sc1
    s_nop 11
    buffer_load_dwordx4 v[28:31], v8, s[4:7], s16 offen offset:1024 sc1
    s_nop 11
    buffer_load_dwordx4 v[32:35], v8, s[4:7], s16 offen offset:2048 sc1
    s_nop 11
    buffer_load_dwordx4 v[36:39], v8, s[4:7], s16 offen offset:3072 sc1
    s_waitcnt vmcnt(3)
    v_max3_u32 v19, v24, v25, v26
    v_max_u32 v19, v19, v27
    v_cmp_eq_u32 vcc, -1, v19
    s_nop 0
    s_cbranch_vccnz g_49F15_0
    v_smfmac_f32_16x16x64_bf16 v[64:67], v[24:27], a[192:199], v172
    v_smfmac_f32_16x16x64_bf16 v[68:71], v[24:27], a[224:231], v172
    s_waitcnt vmcnt(2)
    v_max3_u32 v19, v28, v29, v30
    v_max_u32 v19, v19, v31
    v_cmp_eq_u32 vcc, -1, v19
    s_nop 0
    s_cbranch_vccnz g_49F14_1
    v_smfmac_f32_16x16x64_bf16 v[64:67], v[28:31], a[200:207], v172
    v_smfmac_f32_16x16x64_bf16 v[68:71], v[28:31], a[232:239], v172
    s_waitcnt vmcnt(1)
    v_max3_u32 v19, v32, v33, v34
    v_max_u32 v19, v19, v35
    v_cmp_eq_u32 vcc, -1, v19
    s_nop 0
    s_cbranch_vccnz g_49F12_2
    v_smfmac_f32_16x16x64_bf16 v[64:67], v[32:35], a[208:215], v172
    v_smfmac_f32_16x16x64_bf16 v[68:71], v[32:35], a[240:247], v172
    s_waitcnt vmcnt(0)
    v_max3_u32 v19, v36, v37, v38
    v_max_u32 v19, v19, v39
    v_cmp_eq_u32 vcc, -1, v19
    s_nop 0
    s_cbranch_vccnz g_49F8_3
    v_smfmac_f32_16x16x64_bf16 v[64:67], v[36:39], a[216:223], v172
    v_smfmac_f32_16x16x64_bf16 v[68:71], v[36:39], a[248:255], v172
    s_nop 4
    v_cvt_pk_bf16_f32 v80, v64, v65
    v_cvt_pk_bf16_f32 v81, v66, v67
    s_nop 0
    v_cvt_pk_bf16_f32 v82, v68, v69
    v_cvt_pk_bf16_f32 v83, v70, v71
    s_nop 1
    v_mfma_f32_16x16x32_bf16 v[88:91], v[80:83], v[84:87], 0
gc_50:
    s_barrier
    ds_read_b128 v[96:99], v16 offset:9216
    ds_read_b128 v[100:103], v16 offset:11264
    ds_read_b128 v[104:107], v16 offset:13312
    s_waitcnt lgkmcnt(2)
    v_mfma_f32_16x16x32_bf16 v[88:91], v[96:99], v[84:87], v[88:91]
    s_waitcnt lgkmcnt(1)
    v_mfma_f32_16x16x32_bf16 v[88:91], v[100:103], v[84:87], v[88:91]
    s_waitcnt lgkmcnt(0)
    v_mfma_f32_16x16x32_bf16 v[88:91], v[104:107], v[84:87], v[88:91]
    s_nop 7
    buffer_store_dwordx4 v[88:91], v9, s[4:7], s84 offen sc1
    s_add_u32 s22, s84, 262144
    s_nop 15
    s_nop 15
    s_nop 15
    s_nop 15
    s_nop 15
    s_nop 15
    s_nop 15
    s_nop 15
    s_mov_b32 s23, s25
    buffer_load_dwordx4 v[96:99], v10, s[4:7], s84 offen sc1
    buffer_load_dwordx4 v[100:103], v23, s[4:7], s84 offen sc1
    buffer_load_dwordx4 v[104:107], v244, s[4:7], s84 offen sc1
    v_mov_b32 v40, 0
    v_mov_b32 v41, 0
    v_mov_b32 v42, 0
    v_mov_b32 v43, 0
    v_mov_b32 v44, 0
    v_mov_b32 v45, 0
    v_mov_b32 v46, 0
    v_mov_b32 v47, 0
    v_mov_b32 v48, 0
    v_mov_b32 v49, 0
    v_mov_b32 v50, 0
    v_mov_b32 v51, 0
    v_mov_b32 v52, 0
    v_mov_b32 v53, 0
    v_mov_b32 v54, 0
    v_mov_b32 v55, 0
    v_mov_b32 v56, 0
    v_mov_b32 v57, 0
    v_mov_b32 v58, 0
    v_mov_b32 v59, 0
    v_mov_b32 v60, 0
    v_mov_b32 v61, 0
    v_mov_b32 v62, 0
    v_mov_b32 v63, 0
    v_mov_b32 v64, 0
    v_mov_b32 v65, 0
    v_mov_b32 v66, 0
    v_mov_b32 v67, 0
    v_mov_b32 v68, 0
    v_mov_b32 v69, 0
    v_mov_b32 v70, 0
    v_mov_b32 v71, 0
pb_53:
    s_waitcnt vmcnt(2)
    v_pk_add_f32 v[120:121], v[88:89], v[96:97]
    v_pk_add_f32 v[122:123], v[90:91], v[98:99]
    s_waitcnt vmcnt(1)
    v_pk_add_f32 v[120:121], v[120:121], v[100:101]
    v_pk_add_f32 v[122:123], v[122:123], v[102:103]
    s_waitcnt vmcnt(0)
    v_pk_add_f32 v[120:121], v[120:121], v[104:105]
    v_pk_add_f32 v[122:123], v[122:123], v[106:107]
    v_cvt_pk_bf16_f32 v180, v120, v121
    v_pk_add_f32 v[124:125], v[120:121], v[122:123]
    v_cvt_pk_bf16_f32 v181, v122, v123
    v_cmpx_o_f32 vcc, v124, v125
    buffer_store_dwordx2 v[180:181], v11, s[4:7], s42 offen
    s_cmp_eq_u64 vcc, -1
    s_mov_b64 exec, -1
    s_cbranch_scc0 pr_51
pg_52:
    s_barrier
    s_mov_b32 s21, s16
    s_mov_b32 s16, s42
    s_mov_b32 s42, s43
    s_mov_b32 s43, s44
    s_mov_b32 s44, s21
    s_add_u32 s95, s95, 524288
    s_lshr_b32 s84, s95, 8
    s_and_b32 s84, s84, 8192
    s_xor_b32 s84, s84, s46
    s_add_u32 s84, s84, s95
    s_add_u32 s15, s15, 1
    s_branch recur_fast_w3
g_47L15_0:
    s_waitcnt vmcnt(3)
    v_max3_u32 v19, v24, v25, v26
    v_max_u32 v19, v19, v27
    v_cmp_eq_u32 vcc, -1, v19
    s_nop 0
    s_cbranch_vccnz g_47F15_0
    v_smfmac_f32_16x16x64_bf16 v[40:43], v[24:27], a[0:7], v172
    v_smfmac_f32_16x16x64_bf16 v[44:47], v[24:27], a[64:71], v172
    v_smfmac_f32_16x16x64_bf16 v[48:51], v[24:27], a[32:39], v172
    v_smfmac_f32_16x16x64_bf16 v[52:55], v[24:27], a[96:103], v172
g_47L14_1:
    s_waitcnt vmcnt(2)
    v_max3_u32 v19, v28, v29, v30
    v_max_u32 v19, v19, v31
    v_cmp_eq_u32 vcc, -1, v19
    s_nop 0
    s_cbranch_vccnz g_47F14_1
    v_smfmac_f32_16x16x64_bf16 v[40:43], v[28:31], a[8:15], v172
    v_smfmac_f32_16x16x64_bf16 v[44:47], v[28:31], a[72:79], v172
    v_smfmac_f32_16x16x64_bf16 v[48:51], v[28:31], a[40:47], v172
    v_smfmac_f32_16x16x64_bf16 v[52:55], v[28:31], a[104:111], v172
g_47L12_2:
    s_waitcnt vmcnt(1)
    v_max3_u32 v19, v32, v33, v34
    v_max_u32 v19, v19, v35
    v_cmp_eq_u32 vcc, -1, v19
    s_nop 0
    s_cbranch_vccnz g_47F12_2
    v_smfmac_f32_16x16x64_bf16 v[40:43], v[32:35], a[16:23], v172
    v_smfmac_f32_16x16x64_bf16 v[44:47], v[32:35], a[80:87], v172
    v_smfmac_f32_16x16x64_bf16 v[48:51], v[32:35], a[48:55], v172
    v_smfmac_f32_16x16x64_bf16 v[52:55], v[32:35], a[112:119], v172
g_47L8_3:
    s_waitcnt vmcnt(0)
    v_max3_u32 v19, v36, v37, v38
    v_max_u32 v19, v19, v39
    v_cmp_eq_u32 vcc, -1, v19
    s_nop 0
    s_cbranch_vccnz g_47F8_3
    v_smfmac_f32_16x16x64_bf16 v[40:43], v[36:39], a[24:31], v172
    v_smfmac_f32_16x16x64_bf16 v[44:47], v[36:39], a[88:95], v172
    v_smfmac_f32_16x16x64_bf16 v[48:51], v[36:39], a[56:63], v172
    v_smfmac_f32_16x16x64_bf16 v[52:55], v[36:39], a[120:127], v172
    s_branch gc_48
g_47L15_1:
    s_waitcnt vmcnt(3)
    v_max3_u32 v19, v28, v29, v30
    v_max_u32 v19, v19, v31
    v_cmp_eq_u32 vcc, -1, v19
    s_nop 0
    s_cbranch_vccnz g_47F15_1
    v_smfmac_f32_16x16x64_bf16 v[40:43], v[28:31], a[8:15], v172
    v_smfmac_f32_16x16x64_bf16 v[44:47], v[28:31], a[72:79], v172
    v_smfmac_f32_16x16x64_bf16 v[48:51], v[28:31], a[40:47], v172
    v_smfmac_f32_16x16x64_bf16 v[52:55], v[28:31], a[104:111], v172
g_47L13_2:
    s_waitcnt vmcnt(2)
    v_max3_u32 v19, v32, v33, v34
    v_max_u32 v19, v19, v35
    v_cmp_eq_u32 vcc, -1, v19
    s_nop 0
    s_cbranch_vccnz g_47F13_2
    v_smfmac_f32_16x16x64_bf16 v[40:43], v[32:35], a[16:23], v172
    v_smfmac_f32_16x16x64_bf16 v[44:47], v[32:35], a[80:87], v172
    v_smfmac_f32_16x16x64_bf16 v[48:51], v[32:35], a[48:55], v172
    v_smfmac_f32_16x16x64_bf16 v[52:55], v[32:35], a[112:119], v172
g_47L9_3:
    s_waitcnt vmcnt(1)
    v_max3_u32 v19, v36, v37, v38
    v_max_u32 v19, v19, v39
    v_cmp_eq_u32 vcc, -1, v19
    s_nop 0
    s_cbranch_vccnz g_47F9_3
    v_smfmac_f32_16x16x64_bf16 v[40:43], v[36:39], a[24:31], v172
    v_smfmac_f32_16x16x64_bf16 v[44:47], v[36:39], a[88:95], v172
    v_smfmac_f32_16x16x64_bf16 v[48:51], v[36:39], a[56:63], v172
    v_smfmac_f32_16x16x64_bf16 v[52:55], v[36:39], a[120:127], v172
g_47L1_0:
    s_waitcnt vmcnt(0)
    v_max3_u32 v19, v24, v25, v26
    v_max_u32 v19, v19, v27
    v_cmp_eq_u32 vcc, -1, v19
    s_nop 0
    s_cbranch_vccnz g_47F1_0
    v_smfmac_f32_16x16x64_bf16 v[40:43], v[24:27], a[0:7], v172
    v_smfmac_f32_16x16x64_bf16 v[44:47], v[24:27], a[64:71], v172
    v_smfmac_f32_16x16x64_bf16 v[48:51], v[24:27], a[32:39], v172
    v_smfmac_f32_16x16x64_bf16 v[52:55], v[24:27], a[96:103], v172
    s_branch gc_48
g_47L15_2:
    s_waitcnt vmcnt(3)
    v_max3_u32 v19, v32, v33, v34
    v_max_u32 v19, v19, v35
    v_cmp_eq_u32 vcc, -1, v19
    s_nop 0
    s_cbranch_vccnz g_47F15_2
    v_smfmac_f32_16x16x64_bf16 v[40:43], v[32:35], a[16:23], v172
    v_smfmac_f32_16x16x64_bf16 v[44:47], v[32:35], a[80:87], v172
    v_smfmac_f32_16x16x64_bf16 v[48:51], v[32:35], a[48:55], v172
    v_smfmac_f32_16x16x64_bf16 v[52:55], v[32:35], a[112:119], v172
g_47L11_3:
    s_waitcnt vmcnt(2)
    v_max3_u32 v19, v36, v37, v38
    v_max_u32 v19, v19, v39
    v_cmp_eq_u32 vcc, -1, v19
    s_nop 0
    s_cbranch_vccnz g_47F11_3
    v_smfmac_f32_16x16x64_bf16 v[40:43], v[36:39], a[24:31], v172
    v_smfmac_f32_16x16x64_bf16 v[44:47], v[36:39], a[88:95], v172
    v_smfmac_f32_16x16x64_bf16 v[48:51], v[36:39], a[56:63], v172
    v_smfmac_f32_16x16x64_bf16 v[52:55], v[36:39], a[120:127], v172
g_47L3_0:
    s_waitcnt vmcnt(1)
    v_max3_u32 v19, v24, v25, v26
    v_max_u32 v19, v19, v27
    v_cmp_eq_u32 vcc, -1, v19
    s_nop 0
    s_cbranch_vccnz g_47F3_0
    v_smfmac_f32_16x16x64_bf16 v[40:43], v[24:27], a[0:7], v172
    v_smfmac_f32_16x16x64_bf16 v[44:47], v[24:27], a[64:71], v172
    v_smfmac_f32_16x16x64_bf16 v[48:51], v[24:27], a[32:39], v172
    v_smfmac_f32_16x16x64_bf16 v[52:55], v[24:27], a[96:103], v172
g_47L2_1:
    s_waitcnt vmcnt(0)
    v_max3_u32 v19, v28, v29, v30
    v_max_u32 v19, v19, v31
    v_cmp_eq_u32 vcc, -1, v19
    s_nop 0
    s_cbranch_vccnz g_47F2_1
    v_smfmac_f32_16x16x64_bf16 v[40:43], v[28:31], a[8:15], v172
    v_smfmac_f32_16x16x64_bf16 v[44:47], v[28:31], a[72:79], v172
    v_smfmac_f32_16x16x64_bf16 v[48:51], v[28:31], a[40:47], v172
    v_smfmac_f32_16x16x64_bf16 v[52:55], v[28:31], a[104:111], v172
    s_branch gc_48
g_47L15_3:
    s_waitcnt vmcnt(3)
    v_max3_u32 v19, v36, v37, v38
    v_max_u32 v19, v19, v39
    v_cmp_eq_u32 vcc, -1, v19
    s_nop 0
    s_cbranch_vccnz g_47F15_3
    v_smfmac_f32_16x16x64_bf16 v[40:43], v[36:39], a[24:31], v172
    v_smfmac_f32_16x16x64_bf16 v[44:47], v[36:39], a[88:95], v172
    v_smfmac_f32_16x16x64_bf16 v[48:51], v[36:39], a[56:63], v172
    v_smfmac_f32_16x16x64_bf16 v[52:55], v[36:39], a[120:127], v172
g_47L7_0:
    s_waitcnt vmcnt(2)
    v_max3_u32 v19, v24, v25, v26
    v_max_u32 v19, v19, v27
    v_cmp_eq_u32 vcc, -1, v19
    s_nop 0
    s_cbranch_vccnz g_47F7_0
    v_smfmac_f32_16x16x64_bf16 v[40:43], v[24:27], a[0:7], v172
    v_smfmac_f32_16x16x64_bf16 v[44:47], v[24:27], a[64:71], v172
    v_smfmac_f32_16x16x64_bf16 v[48:51], v[24:27], a[32:39], v172
    v_smfmac_f32_16x16x64_bf16 v[52:55], v[24:27], a[96:103], v172
g_47L6_1:
    s_waitcnt vmcnt(1)
    v_max3_u32 v19, v28, v29, v30
    v_max_u32 v19, v19, v31
    v_cmp_eq_u32 vcc, -1, v19
    s_nop 0
    s_cbranch_vccnz g_47F6_1
    v_smfmac_f32_16x16x64_bf16 v[40:43], v[28:31], a[8:15], v172
    v_smfmac_f32_16x16x64_bf16 v[44:47], v[28:31], a[72:79], v172
    v_smfmac_f32_16x16x64_bf16 v[48:51], v[28:31], a[40:47], v172
    v_smfmac_f32_16x16x64_bf16 v[52:55], v[28:31], a[104:111], v172
g_47L4_2:
    s_waitcnt vmcnt(0)
    v_max3_u32 v19, v32, v33, v34
    v_max_u32 v19, v19, v35
    v_cmp_eq_u32 vcc, -1, v19
    s_nop 0
    s_cbranch_vccnz g_47F4_2
    v_smfmac_f32_16x16x64_bf16 v[40:43], v[32:35], a[16:23], v172
    v_smfmac_f32_16x16x64_bf16 v[44:47], v[32:35], a[80:87], v172
    v_smfmac_f32_16x16x64_bf16 v[48:51], v[32:35], a[48:55], v172
    v_smfmac_f32_16x16x64_bf16 v[52:55], v[32:35], a[112:119], v172
    s_branch gc_48
g_47L7_1:
    s_waitcnt vmcnt(2)
    v_max3_u32 v19, v28, v29, v30
    v_max_u32 v19, v19, v31
    v_cmp_eq_u32 vcc, -1, v19
    s_nop 0
    s_cbranch_vccnz g_47F7_1
    v_smfmac_f32_16x16x64_bf16 v[40:43], v[28:31], a[8:15], v172
    v_smfmac_f32_16x16x64_bf16 v[44:47], v[28:31], a[72:79], v172
    v_smfmac_f32_16x16x64_bf16 v[48:51], v[28:31], a[40:47], v172
    v_smfmac_f32_16x16x64_bf16 v[52:55], v[28:31], a[104:111], v172
g_47L5_2:
    s_waitcnt vmcnt(1)
    v_max3_u32 v19, v32, v33, v34
    v_max_u32 v19, v19, v35
    v_cmp_eq_u32 vcc, -1, v19
    s_nop 0
    s_cbranch_vccnz g_47F5_2
    v_smfmac_f32_16x16x64_bf16 v[40:43], v[32:35], a[16:23], v172
    v_smfmac_f32_16x16x64_bf16 v[44:47], v[32:35], a[80:87], v172
    v_smfmac_f32_16x16x64_bf16 v[48:51], v[32:35], a[48:55], v172
    v_smfmac_f32_16x16x64_bf16 v[52:55], v[32:35], a[112:119], v172
    s_branch g_47L1_0
g_47L7_2:
    s_waitcnt vmcnt(2)
    v_max3_u32 v19, v32, v33, v34
    v_max_u32 v19, v19, v35
    v_cmp_eq_u32 vcc, -1, v19
    s_nop 0
    s_cbranch_vccnz g_47F7_2
    v_smfmac_f32_16x16x64_bf16 v[40:43], v[32:35], a[16:23], v172
    v_smfmac_f32_16x16x64_bf16 v[44:47], v[32:35], a[80:87], v172
    v_smfmac_f32_16x16x64_bf16 v[48:51], v[32:35], a[48:55], v172
    v_smfmac_f32_16x16x64_bf16 v[52:55], v[32:35], a[112:119], v172
    s_branch g_47L3_0
g_47L11_0:
    s_waitcnt vmcnt(2)
    v_max3_u32 v19, v24, v25, v26
    v_max_u32 v19, v19, v27
    v_cmp_eq_u32 vcc, -1, v19
    s_nop 0
    s_cbranch_vccnz g_47F11_0
    v_smfmac_f32_16x16x64_bf16 v[40:43], v[24:27], a[0:7], v172
    v_smfmac_f32_16x16x64_bf16 v[44:47], v[24:27], a[64:71], v172
    v_smfmac_f32_16x16x64_bf16 v[48:51], v[24:27], a[32:39], v172
    v_smfmac_f32_16x16x64_bf16 v[52:55], v[24:27], a[96:103], v172
g_47L10_1:
    s_waitcnt vmcnt(1)
    v_max3_u32 v19, v28, v29, v30
    v_max_u32 v19, v19, v31
    v_cmp_eq_u32 vcc, -1, v19
    s_nop 0
    s_cbranch_vccnz g_47F10_1
    v_smfmac_f32_16x16x64_bf16 v[40:43], v[28:31], a[8:15], v172
    v_smfmac_f32_16x16x64_bf16 v[44:47], v[28:31], a[72:79], v172
    v_smfmac_f32_16x16x64_bf16 v[48:51], v[28:31], a[40:47], v172
    v_smfmac_f32_16x16x64_bf16 v[52:55], v[28:31], a[104:111], v172
    s_branch g_47L8_3
g_47L11_1:
    s_waitcnt vmcnt(2)
    v_max3_u32 v19, v28, v29, v30
    v_max_u32 v19, v19, v31
    v_cmp_eq_u32 vcc, -1, v19
    s_nop 0
    s_cbranch_vccnz g_47F11_1
    v_smfmac_f32_16x16x64_bf16 v[40:43], v[28:31], a[8:15], v172
    v_smfmac_f32_16x16x64_bf16 v[44:47], v[28:31], a[72:79], v172
    v_smfmac_f32_16x16x64_bf16 v[48:51], v[28:31], a[40:47], v172
    v_smfmac_f32_16x16x64_bf16 v[52:55], v[28:31], a[104:111], v172
    s_branch g_47L9_3
g_47L13_0:
    s_waitcnt vmcnt(2)
    v_max3_u32 v19, v24, v25, v26
    v_max_u32 v19, v19, v27
    v_cmp_eq_u32 vcc, -1, v19
    s_nop 0
    s_cbranch_vccnz g_47F13_0
    v_smfmac_f32_16x16x64_bf16 v[40:43], v[24:27], a[0:7], v172
    v_smfmac_f32_16x16x64_bf16 v[44:47], v[24:27], a[64:71], v172
    v_smfmac_f32_16x16x64_bf16 v[48:51], v[24:27], a[32:39], v172
    v_smfmac_f32_16x16x64_bf16 v[52:55], v[24:27], a[96:103], v172
    s_branch g_47L12_2
g_47L13_3:
    s_waitcnt vmcnt(2)
    v_max3_u32 v19, v36, v37, v38
    v_max_u32 v19, v19, v39
    v_cmp_eq_u32 vcc, -1, v19
    s_nop 0
    s_cbranch_vccnz g_47F13_3
    v_smfmac_f32_16x16x64_bf16 v[40:43], v[36:39], a[24:31], v172
    v_smfmac_f32_16x16x64_bf16 v[44:47], v[36:39], a[88:95], v172
    v_smfmac_f32_16x16x64_bf16 v[48:51], v[36:39], a[56:63], v172
    v_smfmac_f32_16x16x64_bf16 v[52:55], v[36:39], a[120:127], v172
g_47L5_0:
    s_waitcnt vmcnt(1)
    v_max3_u32 v19, v24, v25, v26
    v_max_u32 v19, v19, v27
    v_cmp_eq_u32 vcc, -1, v19
    s_nop 0
    s_cbranch_vccnz g_47F5_0
    v_smfmac_f32_16x16x64_bf16 v[40:43], v[24:27], a[0:7], v172
    v_smfmac_f32_16x16x64_bf16 v[44:47], v[24:27], a[64:71], v172
    v_smfmac_f32_16x16x64_bf16 v[48:51], v[24:27], a[32:39], v172
    v_smfmac_f32_16x16x64_bf16 v[52:55], v[24:27], a[96:103], v172
    s_branch g_47L4_2
g_47L14_2:
    s_waitcnt vmcnt(2)
    v_max3_u32 v19, v32, v33, v34
    v_max_u32 v19, v19, v35
    v_cmp_eq_u32 vcc, -1, v19
    s_nop 0
    s_cbranch_vccnz g_47F14_2
    v_smfmac_f32_16x16x64_bf16 v[40:43], v[32:35], a[16:23], v172
    v_smfmac_f32_16x16x64_bf16 v[44:47], v[32:35], a[80:87], v172
    v_smfmac_f32_16x16x64_bf16 v[48:51], v[32:35], a[48:55], v172
    v_smfmac_f32_16x16x64_bf16 v[52:55], v[32:35], a[112:119], v172
g_47L10_3:
    s_waitcnt vmcnt(1)
    v_max3_u32 v19, v36, v37, v38
    v_max_u32 v19, v19, v39
    v_cmp_eq_u32 vcc, -1, v19
    s_nop 0
    s_cbranch_vccnz g_47F10_3
    v_smfmac_f32_16x16x64_bf16 v[40:43], v[36:39], a[24:31], v172
    v_smfmac_f32_16x16x64_bf16 v[44:47], v[36:39], a[88:95], v172
    v_smfmac_f32_16x16x64_bf16 v[48:51], v[36:39], a[56:63], v172
    v_smfmac_f32_16x16x64_bf16 v[52:55], v[36:39], a[120:127], v172
    s_branch g_47L2_1
g_47L14_3:
    s_waitcnt vmcnt(2)
    v_max3_u32 v19, v36, v37, v38
    v_max_u32 v19, v19, v39
    v_cmp_eq_u32 vcc, -1, v19
    s_nop 0
    s_cbranch_vccnz g_47F14_3
    v_smfmac_f32_16x16x64_bf16 v[40:43], v[36:39], a[24:31], v172
    v_smfmac_f32_16x16x64_bf16 v[44:47], v[36:39], a[88:95], v172
    v_smfmac_f32_16x16x64_bf16 v[48:51], v[36:39], a[56:63], v172
    v_smfmac_f32_16x16x64_bf16 v[52:55], v[36:39], a[120:127], v172
    s_branch g_47L6_1
g_47L3_1:
    s_waitcnt vmcnt(1)
    v_max3_u32 v19, v28, v29, v30
    v_max_u32 v19, v19, v31
    v_cmp_eq_u32 vcc, -1, v19
    s_nop 0
    s_cbranch_vccnz g_47F3_1
    v_smfmac_f32_16x16x64_bf16 v[40:43], v[28:31], a[8:15], v172
    v_smfmac_f32_16x16x64_bf16 v[44:47], v[28:31], a[72:79], v172
    v_smfmac_f32_16x16x64_bf16 v[48:51], v[28:31], a[40:47], v172
    v_smfmac_f32_16x16x64_bf16 v[52:55], v[28:31], a[104:111], v172
    s_branch g_47L1_0
g_47L6_2:
    s_waitcnt vmcnt(1)
    v_max3_u32 v19, v32, v33, v34
    v_max_u32 v19, v19, v35
    v_cmp_eq_u32 vcc, -1, v19
    s_nop 0
    s_cbranch_vccnz g_47F6_2
    v_smfmac_f32_16x16x64_bf16 v[40:43], v[32:35], a[16:23], v172
    v_smfmac_f32_16x16x64_bf16 v[44:47], v[32:35], a[80:87], v172
    v_smfmac_f32_16x16x64_bf16 v[48:51], v[32:35], a[48:55], v172
    v_smfmac_f32_16x16x64_bf16 v[52:55], v[32:35], a[112:119], v172
    s_branch g_47L2_1
g_47L9_0:
    s_waitcnt vmcnt(1)
    v_max3_u32 v19, v24, v25, v26
    v_max_u32 v19, v19, v27
    v_cmp_eq_u32 vcc, -1, v19
    s_nop 0
    s_cbranch_vccnz g_47F9_0
    v_smfmac_f32_16x16x64_bf16 v[40:43], v[24:27], a[0:7], v172
    v_smfmac_f32_16x16x64_bf16 v[44:47], v[24:27], a[64:71], v172
    v_smfmac_f32_16x16x64_bf16 v[48:51], v[24:27], a[32:39], v172
    v_smfmac_f32_16x16x64_bf16 v[52:55], v[24:27], a[96:103], v172
    s_branch g_47L8_3
g_47L12_3:
    s_waitcnt vmcnt(1)
    v_max3_u32 v19, v36, v37, v38
    v_max_u32 v19, v19, v39
    v_cmp_eq_u32 vcc, -1, v19
    s_nop 0
    s_cbranch_vccnz g_47F12_3
    v_smfmac_f32_16x16x64_bf16 v[40:43], v[36:39], a[24:31], v172
    v_smfmac_f32_16x16x64_bf16 v[44:47], v[36:39], a[88:95], v172
    v_smfmac_f32_16x16x64_bf16 v[48:51], v[36:39], a[56:63], v172
    v_smfmac_f32_16x16x64_bf16 v[52:55], v[36:39], a[120:127], v172
    s_branch g_47L4_2
g_47F15_0:
    s_mov_b64 exec, vcc
    buffer_load_dwordx4 v[24:27], v2, s[4:7], s16 offen offset:0 sc1
    s_mov_b64 exec, -1
    s_add_u32 s23, s23, 1
    s_cmp_lt_u32 s23, 200000
    s_cbranch_scc1 g_47L15_1
    s_mov_b32 s25, 200000
    s_branch gc_48
g_47F15_1:
    s_mov_b64 exec, vcc
    buffer_load_dwordx4 v[28:31], v2, s[4:7], s16 offen offset:1024 sc1
    s_mov_b64 exec, -1
    s_add_u32 s23, s23, 1
    s_cmp_lt_u32 s23, 200000
    s_cbranch_scc1 g_47L15_2
    s_mov_b32 s25, 200000
    s_branch gc_48
g_47F15_2:
    s_mov_b64 exec, vcc
    buffer_load_dwordx4 v[32:35], v2, s[4:7], s16 offen offset:2048 sc1
    s_mov_b64 exec, -1
    s_add_u32 s23, s23, 1
    s_cmp_lt_u32 s23, 200000
    s_cbranch_scc1 g_47L15_3
    s_mov_b32 s25, 200000
    s_branch gc_48
g_47F15_3:
    s_mov_b64 exec, vcc
    buffer_load_dwordx4 v[36:39], v2, s[4:7], s16 offen offset:3072 sc1
    s_mov_b64 exec, -1
    s_add_u32 s23, s23, 1
    s_cmp_lt_u32 s23, 200000
    s_cbranch_scc1 g_47L15_0
    s_mov_b32 s25, 200000
    s_branch gc_48
g_47F7_0:
    s_mov_b64 exec, vcc
    buffer_load_dwordx4 v[24:27], v2, s[4:7], s16 offen offset:0 sc1
    s_mov_b64 exec, -1
    s_add_u32 s23, s23, 1
    s_cmp_lt_u32 s23, 200000
    s_cbranch_scc1 g_47L7_1
    s_mov_b32 s25, 200000
    s_branch gc_48
g_47F7_1:
    s_mov_b64 exec, vcc
    buffer_load_dwordx4 v[28:31], v2, s[4:7], s16 offen offset:1024 sc1
    s_mov_b64 exec, -1
    s_add_u32 s23, s23, 1
    s_cmp_lt_u32 s23, 200000
    s_cbranch_scc1 g_47L7_2
    s_mov_b32 s25, 200000
    s_branch gc_48
g_47F7_2:
    s_mov_b64 exec, vcc
    buffer_load_dwordx4 v[32:35], v2, s[4:7], s16 offen offset:2048 sc1
    s_mov_b64 exec, -1
    s_add_u32 s23, s23, 1
    s_cmp_lt_u32 s23, 200000
    s_cbranch_scc1 g_47L7_0
    s_mov_b32 s25, 200000
    s_branch gc_48
g_47F11_0:
    s_mov_b64 exec, vcc
    buffer_load_dwordx4 v[24:27], v2, s[4:7], s16 offen offset:0 sc1
    s_mov_b64 exec, -1
    s_add_u32 s23, s23, 1
    s_cmp_lt_u32 s23, 200000
    s_cbranch_scc1 g_47L11_1
    s_mov_b32 s25, 200000
    s_branch gc_48
g_47F11_1:
    s_mov_b64 exec, vcc
    buffer_load_dwordx4 v[28:31], v2, s[4:7], s16 offen offset:1024 sc1
    s_mov_b64 exec, -1
    s_add_u32 s23, s23, 1
    s_cmp_lt_u32 s23, 200000
    s_cbranch_scc1 g_47L11_3
    s_mov_b32 s25, 200000
    s_branch gc_48
g_47F11_3:
    s_mov_b64 exec, vcc
    buffer_load_dwordx4 v[36:39], v2, s[4:7], s16 offen offset:3072 sc1
    s_mov_b64 exec, -1
    s_add_u32 s23, s23, 1
    s_cmp_lt_u32 s23, 200000
    s_cbranch_scc1 g_47L11_0
    s_mov_b32 s25, 200000
    s_branch gc_48
g_47F13_0:
    s_mov_b64 exec, vcc
    buffer_load_dwordx4 v[24:27], v2, s[4:7], s16 offen offset:0 sc1
    s_mov_b64 exec, -1
    s_add_u32 s23, s23, 1
    s_cmp_lt_u32 s23, 200000
    s_cbranch_scc1 g_47L13_2
    s_mov_b32 s25, 200000
    s_branch gc_48
g_47F13_2:
    s_mov_b64 exec, vcc
    buffer_load_dwordx4 v[32:35], v2, s[4:7], s16 offen offset:2048 sc1
    s_mov_b64 exec, -1
    s_add_u32 s23, s23, 1
    s_cmp_lt_u32 s23, 200000
    s_cbranch_scc1 g_47L13_3
    s_mov_b32 s25, 200000
    s_branch gc_48
g_47F13_3:
    s_mov_b64 exec, vcc
    buffer_load_dwordx4 v[36:39], v2, s[4:7], s16 offen offset:3072 sc1
    s_mov_b64 exec, -1
    s_add_u32 s23, s23, 1
    s_cmp_lt_u32 s23, 200000
    s_cbranch_scc1 g_47L13_0
    s_mov_b32 s25, 200000
    s_branch gc_48
g_47F14_1:
    s_mov_b64 exec, vcc
    buffer_load_dwordx4 v[28:31], v2, s[4:7], s16 offen offset:1024 sc1
    s_mov_b64 exec, -1
    s_add_u32 s23, s23, 1
    s_cmp_lt_u32 s23, 200000
    s_cbranch_scc1 g_47L14_2
    s_mov_b32 s25, 200000
    s_branch gc_48
g_47F14_2:
    s_mov_b64 exec, vcc
    buffer_load_dwordx4 v[32:35], v2, s[4:7], s16 offen offset:2048 sc1
    s_mov_b64 exec, -1
    s_add_u32 s23, s23, 1
    s_cmp_lt_u32 s23, 200000
    s_cbranch_scc1 g_47L14_3
    s_mov_b32 s25, 200000
    s_branch gc_48
g_47F14_3:
    s_mov_b64 exec, vcc
    buffer_load_dwordx4 v[36:39], v2, s[4:7], s16 offen offset:3072 sc1
    s_mov_b64 exec, -1
    s_add_u32 s23, s23, 1
    s_cmp_lt_u32 s23, 200000
    s_cbranch_scc1 g_47L14_1
    s_mov_b32 s25, 200000
    s_branch gc_48
g_47F3_0:
    s_mov_b64 exec, vcc
    buffer_load_dwordx4 v[24:27], v2, s[4:7], s16 offen offset:0 sc1
    s_mov_b64 exec, -1
    s_add_u32 s23, s23, 1
    s_cmp_lt_u32 s23, 200000
    s_cbranch_scc1 g_47L3_1
    s_mov_b32 s25, 200000
    s_branch gc_48
g_47F3_1:
    s_mov_b64 exec, vcc
    buffer_load_dwordx4 v[28:31], v2, s[4:7], s16 offen offset:1024 sc1
    s_mov_b64 exec, -1
    s_add_u32 s23, s23, 1
    s_cmp_lt_u32 s23, 200000
    s_cbranch_scc1 g_47L3_0
    s_mov_b32 s25, 200000
    s_branch gc_48
g_47F5_0:
    s_mov_b64 exec, vcc
    buffer_load_dwordx4 v[24:27], v2, s[4:7], s16 offen offset:0 sc1
    s_mov_b64 exec, -1
    s_add_u32 s23, s23, 1
    s_cmp_lt_u32 s23, 200000
    s_cbranch_scc1 g_47L5_2
    s_mov_b32 s25, 200000
    s_branch gc_48
g_47F5_2:
    s_mov_b64 exec, vcc
    buffer_load_dwordx4 v[32:35], v2, s[4:7], s16 offen offset:2048 sc1
    s_mov_b64 exec, -1
    s_add_u32 s23, s23, 1
    s_cmp_lt_u32 s23, 200000
    s_cbranch_scc1 g_47L5_0
    s_mov_b32 s25, 200000
    s_branch gc_48
g_47F6_1:
    s_mov_b64 exec, vcc
    buffer_load_dwordx4 v[28:31], v2, s[4:7], s16 offen offset:1024 sc1
    s_mov_b64 exec, -1
    s_add_u32 s23, s23, 1
    s_cmp_lt_u32 s23, 200000
    s_cbranch_scc1 g_47L6_2
    s_mov_b32 s25, 200000
    s_branch gc_48
g_47F6_2:
    s_mov_b64 exec, vcc
    buffer_load_dwordx4 v[32:35], v2, s[4:7], s16 offen offset:2048 sc1
    s_mov_b64 exec, -1
    s_add_u32 s23, s23, 1
    s_cmp_lt_u32 s23, 200000
    s_cbranch_scc1 g_47L6_1
    s_mov_b32 s25, 200000
    s_branch gc_48
g_47F9_0:
    s_mov_b64 exec, vcc
    buffer_load_dwordx4 v[24:27], v2, s[4:7], s16 offen offset:0 sc1
    s_mov_b64 exec, -1
    s_add_u32 s23, s23, 1
    s_cmp_lt_u32 s23, 200000
    s_cbranch_scc1 g_47L9_3
    s_mov_b32 s25, 200000
    s_branch gc_48
g_47F9_3:
    s_mov_b64 exec, vcc
    buffer_load_dwordx4 v[36:39], v2, s[4:7], s16 offen offset:3072 sc1
    s_mov_b64 exec, -1
    s_add_u32 s23, s23, 1
    s_cmp_lt_u32 s23, 200000
    s_cbranch_scc1 g_47L9_0
    s_mov_b32 s25, 200000
    s_branch gc_48
g_47F10_1:
    s_mov_b64 exec, vcc
    buffer_load_dwordx4 v[28:31], v2, s[4:7], s16 offen offset:1024 sc1
    s_mov_b64 exec, -1
    s_add_u32 s23, s23, 1
    s_cmp_lt_u32 s23, 200000
    s_cbranch_scc1 g_47L10_3
    s_mov_b32 s25, 200000
    s_branch gc_48
g_47F10_3:
    s_mov_b64 exec, vcc
    buffer_load_dwordx4 v[36:39], v2, s[4:7], s16 offen offset:3072 sc1
    s_mov_b64 exec, -1
    s_add_u32 s23, s23, 1
    s_cmp_lt_u32 s23, 200000
    s_cbranch_scc1 g_47L10_1
    s_mov_b32 s25, 200000
    s_branch gc_48
g_47F12_2:
    s_mov_b64 exec, vcc
    buffer_load_dwordx4 v[32:35], v2, s[4:7], s16 offen offset:2048 sc1
    s_mov_b64 exec, -1
    s_add_u32 s23, s23, 1
    s_cmp_lt_u32 s23, 200000
    s_cbranch_scc1 g_47L12_3
    s_mov_b32 s25, 200000
    s_branch gc_48
g_47F12_3:
    s_mov_b64 exec, vcc
    buffer_load_dwordx4 v[36:39], v2, s[4:7], s16 offen offset:3072 sc1
    s_mov_b64 exec, -1
    s_add_u32 s23, s23, 1
    s_cmp_lt_u32 s23, 200000
    s_cbranch_scc1 g_47L12_2
    s_mov_b32 s25, 200000
    s_branch gc_48
g_47F1_0:
    s_mov_b64 exec, vcc
    buffer_load_dwordx4 v[24:27], v2, s[4:7], s16 offen offset:0 sc1
    s_mov_b64 exec, -1
    s_add_u32 s23, s23, 1
    s_cmp_lt_u32 s23, 200000
    s_cbranch_scc1 g_47L1_0
    s_mov_b32 s25, 200000
    s_branch gc_48
g_47F2_1:
    s_mov_b64 exec, vcc
    buffer_load_dwordx4 v[28:31], v2, s[4:7], s16 offen offset:1024 sc1
    s_mov_b64 exec, -1
    s_add_u32 s23, s23, 1
    s_cmp_lt_u32 s23, 200000
    s_cbranch_scc1 g_47L2_1
    s_mov_b32 s25, 200000
    s_branch gc_48
g_47F4_2:
    s_mov_b64 exec, vcc
    buffer_load_dwordx4 v[32:35], v2, s[4:7], s16 offen offset:2048 sc1
    s_mov_b64 exec, -1
    s_add_u32 s23, s23, 1
    s_cmp_lt_u32 s23, 200000
    s_cbranch_scc1 g_47L4_2
    s_mov_b32 s25, 200000
    s_branch gc_48
g_47F8_3:
    s_mov_b64 exec, vcc
    buffer_load_dwordx4 v[36:39], v2, s[4:7], s16 offen offset:3072 sc1
    s_mov_b64 exec, -1
    s_add_u32 s23, s23, 1
    s_cmp_lt_u32 s23, 200000
    s_cbranch_scc1 g_47L8_3
    s_mov_b32 s25, 200000
    s_branch gc_48
g_49L15_0:
    s_waitcnt vmcnt(3)
    v_max3_u32 v19, v24, v25, v26
    v_max_u32 v19, v19, v27
    v_cmp_eq_u32 vcc, -1, v19
    s_nop 0
    s_cbranch_vccnz g_49F15_0
    v_smfmac_f32_16x16x64_bf16 v[64:67], v[24:27], a[192:199], v172
    v_smfmac_f32_16x16x64_bf16 v[68:71], v[24:27], a[224:231], v172
g_49L14_1:
    s_waitcnt vmcnt(2)
    v_max3_u32 v19, v28, v29, v30
    v_max_u32 v19, v19, v31
    v_cmp_eq_u32 vcc, -1, v19
    s_nop 0
    s_cbranch_vccnz g_49F14_1
    v_smfmac_f32_16x16x64_bf16 v[64:67], v[28:31], a[200:207], v172
    v_smfmac_f32_16x16x64_bf16 v[68:71], v[28:31], a[232:239], v172
g_49L12_2:
    s_waitcnt vmcnt(1)
    v_max3_u32 v19, v32, v33, v34
    v_max_u32 v19, v19, v35
    v_cmp_eq_u32 vcc, -1, v19
    s_nop 0
    s_cbranch_vccnz g_49F12_2
    v_smfmac_f32_16x16x64_bf16 v[64:67], v[32:35], a[208:215], v172
    v_smfmac_f32_16x16x64_bf16 v[68:71], v[32:35], a[240:247], v172
g_49L8_3:
    s_waitcnt vmcnt(0)
    v_max3_u32 v19, v36, v37, v38
    v_max_u32 v19, v19, v39
    v_cmp_eq_u32 vcc, -1, v19
    s_nop 0
    s_cbranch_vccnz g_49F8_3
    v_smfmac_f32_16x16x64_bf16 v[64:67], v[36:39], a[216:223], v172
    v_smfmac_f32_16x16x64_bf16 v[68:71], v[36:39], a[248:255], v172
    s_nop 4
    v_cvt_pk_bf16_f32 v80, v64, v65
    v_cvt_pk_bf16_f32 v81, v66, v67
    s_nop 0
    v_cvt_pk_bf16_f32 v82, v68, v69
    v_cvt_pk_bf16_f32 v83, v70, v71
    s_nop 1
    v_mfma_f32_16x16x32_bf16 v[88:91], v[80:83], v[84:87], 0
    s_branch gc_50
g_49L15_1:
    s_waitcnt vmcnt(3)
    v_max3_u32 v19, v28, v29, v30
    v_max_u32 v19, v19, v31
    v_cmp_eq_u32 vcc, -1, v19
    s_nop 0
    s_cbranch_vccnz g_49F15_1
    v_smfmac_f32_16x16x64_bf16 v[64:67], v[28:31], a[200:207], v172
    v_smfmac_f32_16x16x64_bf16 v[68:71], v[28:31], a[232:239], v172
g_49L13_2:
    s_waitcnt vmcnt(2)
    v_max3_u32 v19, v32, v33, v34
    v_max_u32 v19, v19, v35
    v_cmp_eq_u32 vcc, -1, v19
    s_nop 0
    s_cbranch_vccnz g_49F13_2
    v_smfmac_f32_16x16x64_bf16 v[64:67], v[32:35], a[208:215], v172
    v_smfmac_f32_16x16x64_bf16 v[68:71], v[32:35], a[240:247], v172
g_49L9_3:
    s_waitcnt vmcnt(1)
    v_max3_u32 v19, v36, v37, v38
    v_max_u32 v19, v19, v39
    v_cmp_eq_u32 vcc, -1, v19
    s_nop 0
    s_cbranch_vccnz g_49F9_3
    v_smfmac_f32_16x16x64_bf16 v[64:67], v[36:39], a[216:223], v172
    v_smfmac_f32_16x16x64_bf16 v[68:71], v[36:39], a[248:255], v172
g_49L1_0:
    s_waitcnt vmcnt(0)
    v_max3_u32 v19, v24, v25, v26
    v_max_u32 v19, v19, v27
    v_cmp_eq_u32 vcc, -1, v19
    s_nop 0
    s_cbranch_vccnz g_49F1_0
    v_smfmac_f32_16x16x64_bf16 v[64:67], v[24:27], a[192:199], v172
    v_smfmac_f32_16x16x64_bf16 v[68:71], v[24:27], a[224:231], v172
    s_nop 4
    v_cvt_pk_bf16_f32 v80, v64, v65
    v_cvt_pk_bf16_f32 v81, v66, v67
    s_nop 0
    v_cvt_pk_bf16_f32 v82, v68, v69
    v_cvt_pk_bf16_f32 v83, v70, v71
    s_nop 1
    v_mfma_f32_16x16x32_bf16 v[88:91], v[80:83], v[84:87], 0
    s_branch gc_50
g_49L15_2:
    s_waitcnt vmcnt(3)
    v_max3_u32 v19, v32, v33, v34
    v_max_u32 v19, v19, v35
    v_cmp_eq_u32 vcc, -1, v19
    s_nop 0
    s_cbranch_vccnz g_49F15_2
    v_smfmac_f32_16x16x64_bf16 v[64:67], v[32:35], a[208:215], v172
    v_smfmac_f32_16x16x64_bf16 v[68:71], v[32:35], a[240:247], v172
g_49L11_3:
    s_waitcnt vmcnt(2)
    v_max3_u32 v19, v36, v37, v38
    v_max_u32 v19, v19, v39
    v_cmp_eq_u32 vcc, -1, v19
    s_nop 0
    s_cbranch_vccnz g_49F11_3
    v_smfmac_f32_16x16x64_bf16 v[64:67], v[36:39], a[216:223], v172
    v_smfmac_f32_16x16x64_bf16 v[68:71], v[36:39], a[248:255], v172
g_49L3_0:
    s_waitcnt vmcnt(1)
    v_max3_u32 v19, v24, v25, v26
    v_max_u32 v19, v19, v27
    v_cmp_eq_u32 vcc, -1, v19
    s_nop 0
    s_cbranch_vccnz g_49F3_0
    v_smfmac_f32_16x16x64_bf16 v[64:67], v[24:27], a[192:199], v172
    v_smfmac_f32_16x16x64_bf16 v[68:71], v[24:27], a[224:231], v172
g_49L2_1:
    s_waitcnt vmcnt(0)
    v_max3_u32 v19, v28, v29, v30
    v_max_u32 v19, v19, v31
    v_cmp_eq_u32 vcc, -1, v19
    s_nop 0
    s_cbranch_vccnz g_49F2_1
    v_smfmac_f32_16x16x64_bf16 v[64:67], v[28:31], a[200:207], v172
    v_smfmac_f32_16x16x64_bf16 v[68:71], v[28:31], a[232:239], v172
    s_nop 4
    v_cvt_pk_bf16_f32 v80, v64, v65
    v_cvt_pk_bf16_f32 v81, v66, v67
    s_nop 0
    v_cvt_pk_bf16_f32 v82, v68, v69
    v_cvt_pk_bf16_f32 v83, v70, v71
    s_nop 1
    v_mfma_f32_16x16x32_bf16 v[88:91], v[80:83], v[84:87], 0
    s_branch gc_50
g_49L15_3:
    s_waitcnt vmcnt(3)
    v_max3_u32 v19, v36, v37, v38
    v_max_u32 v19, v19, v39
    v_cmp_eq_u32 vcc, -1, v19
    s_nop 0
    s_cbranch_vccnz g_49F15_3
    v_smfmac_f32_16x16x64_bf16 v[64:67], v[36:39], a[216:223], v172
    v_smfmac_f32_16x16x64_bf16 v[68:71], v[36:39], a[248:255], v172
g_49L7_0:
    s_waitcnt vmcnt(2)
    v_max3_u32 v19, v24, v25, v26
    v_max_u32 v19, v19, v27
    v_cmp_eq_u32 vcc, -1, v19
    s_nop 0
    s_cbranch_vccnz g_49F7_0
    v_smfmac_f32_16x16x64_bf16 v[64:67], v[24:27], a[192:199], v172
    v_smfmac_f32_16x16x64_bf16 v[68:71], v[24:27], a[224:231], v172
g_49L6_1:
    s_waitcnt vmcnt(1)
    v_max3_u32 v19, v28, v29, v30
    v_max_u32 v19, v19, v31
    v_cmp_eq_u32 vcc, -1, v19
    s_nop 0
    s_cbranch_vccnz g_49F6_1
    v_smfmac_f32_16x16x64_bf16 v[64:67], v[28:31], a[200:207], v172
    v_smfmac_f32_16x16x64_bf16 v[68:71], v[28:31], a[232:239], v172
g_49L4_2:
    s_waitcnt vmcnt(0)
    v_max3_u32 v19, v32, v33, v34
    v_max_u32 v19, v19, v35
    v_cmp_eq_u32 vcc, -1, v19
    s_nop 0
    s_cbranch_vccnz g_49F4_2
    v_smfmac_f32_16x16x64_bf16 v[64:67], v[32:35], a[208:215], v172
    v_smfmac_f32_16x16x64_bf16 v[68:71], v[32:35], a[240:247], v172
    s_nop 4
    v_cvt_pk_bf16_f32 v80, v64, v65
    v_cvt_pk_bf16_f32 v81, v66, v67
    s_nop 0
    v_cvt_pk_bf16_f32 v82, v68, v69
    v_cvt_pk_bf16_f32 v83, v70, v71
    s_nop 1
    v_mfma_f32_16x16x32_bf16 v[88:91], v[80:83], v[84:87], 0
    s_branch gc_50
g_49L7_1:
    s_waitcnt vmcnt(2)
    v_max3_u32 v19, v28, v29, v30
    v_max_u32 v19, v19, v31
    v_cmp_eq_u32 vcc, -1, v19
    s_nop 0
    s_cbranch_vccnz g_49F7_1
    v_smfmac_f32_16x16x64_bf16 v[64:67], v[28:31], a[200:207], v172
    v_smfmac_f32_16x16x64_bf16 v[68:71], v[28:31], a[232:239], v172
g_49L5_2:
    s_waitcnt vmcnt(1)
    v_max3_u32 v19, v32, v33, v34
    v_max_u32 v19, v19, v35
    v_cmp_eq_u32 vcc, -1, v19
    s_nop 0
    s_cbranch_vccnz g_49F5_2
    v_smfmac_f32_16x16x64_bf16 v[64:67], v[32:35], a[208:215], v172
    v_smfmac_f32_16x16x64_bf16 v[68:71], v[32:35], a[240:247], v172
    s_branch g_49L1_0
g_49L7_2:
    s_waitcnt vmcnt(2)
    v_max3_u32 v19, v32, v33, v34
    v_max_u32 v19, v19, v35
    v_cmp_eq_u32 vcc, -1, v19
    s_nop 0
    s_cbranch_vccnz g_49F7_2
    v_smfmac_f32_16x16x64_bf16 v[64:67], v[32:35], a[208:215], v172
    v_smfmac_f32_16x16x64_bf16 v[68:71], v[32:35], a[240:247], v172
    s_branch g_49L3_0
g_49L11_0:
    s_waitcnt vmcnt(2)
    v_max3_u32 v19, v24, v25, v26
    v_max_u32 v19, v19, v27
    v_cmp_eq_u32 vcc, -1, v19
    s_nop 0
    s_cbranch_vccnz g_49F11_0
    v_smfmac_f32_16x16x64_bf16 v[64:67], v[24:27], a[192:199], v172
    v_smfmac_f32_16x16x64_bf16 v[68:71], v[24:27], a[224:231], v172
g_49L10_1:
    s_waitcnt vmcnt(1)
    v_max3_u32 v19, v28, v29, v30
    v_max_u32 v19, v19, v31
    v_cmp_eq_u32 vcc, -1, v19
    s_nop 0
    s_cbranch_vccnz g_49F10_1
    v_smfmac_f32_16x16x64_bf16 v[64:67], v[28:31], a[200:207], v172
    v_smfmac_f32_16x16x64_bf16 v[68:71], v[28:31], a[232:239], v172
    s_branch g_49L8_3
g_49L11_1:
    s_waitcnt vmcnt(2)
    v_max3_u32 v19, v28, v29, v30
    v_max_u32 v19, v19, v31
    v_cmp_eq_u32 vcc, -1, v19
    s_nop 0
    s_cbranch_vccnz g_49F11_1
    v_smfmac_f32_16x16x64_bf16 v[64:67], v[28:31], a[200:207], v172
    v_smfmac_f32_16x16x64_bf16 v[68:71], v[28:31], a[232:239], v172
    s_branch g_49L9_3
g_49L13_0:
    s_waitcnt vmcnt(2)
    v_max3_u32 v19, v24, v25, v26
    v_max_u32 v19, v19, v27
    v_cmp_eq_u32 vcc, -1, v19
    s_nop 0
    s_cbranch_vccnz g_49F13_0
    v_smfmac_f32_16x16x64_bf16 v[64:67], v[24:27], a[192:199], v172
    v_smfmac_f32_16x16x64_bf16 v[68:71], v[24:27], a[224:231], v172
    s_branch g_49L12_2
g_49L13_3:
    s_waitcnt vmcnt(2)
    v_max3_u32 v19, v36, v37, v38
    v_max_u32 v19, v19, v39
    v_cmp_eq_u32 vcc, -1, v19
    s_nop 0
    s_cbranch_vccnz g_49F13_3
    v_smfmac_f32_16x16x64_bf16 v[64:67], v[36:39], a[216:223], v172
    v_smfmac_f32_16x16x64_bf16 v[68:71], v[36:39], a[248:255], v172
g_49L5_0:
    s_waitcnt vmcnt(1)
    v_max3_u32 v19, v24, v25, v26
    v_max_u32 v19, v19, v27
    v_cmp_eq_u32 vcc, -1, v19
    s_nop 0
    s_cbranch_vccnz g_49F5_0
    v_smfmac_f32_16x16x64_bf16 v[64:67], v[24:27], a[192:199], v172
    v_smfmac_f32_16x16x64_bf16 v[68:71], v[24:27], a[224:231], v172
    s_branch g_49L4_2
g_49L14_2:
    s_waitcnt vmcnt(2)
    v_max3_u32 v19, v32, v33, v34
    v_max_u32 v19, v19, v35
    v_cmp_eq_u32 vcc, -1, v19
    s_nop 0
    s_cbranch_vccnz g_49F14_2
    v_smfmac_f32_16x16x64_bf16 v[64:67], v[32:35], a[208:215], v172
    v_smfmac_f32_16x16x64_bf16 v[68:71], v[32:35], a[240:247], v172
g_49L10_3:
    s_waitcnt vmcnt(1)
    v_max3_u32 v19, v36, v37, v38
    v_max_u32 v19, v19, v39
    v_cmp_eq_u32 vcc, -1, v19
    s_nop 0
    s_cbranch_vccnz g_49F10_3
    v_smfmac_f32_16x16x64_bf16 v[64:67], v[36:39], a[216:223], v172
    v_smfmac_f32_16x16x64_bf16 v[68:71], v[36:39], a[248:255], v172
    s_branch g_49L2_1
g_49L14_3:
    s_waitcnt vmcnt(2)
    v_max3_u32 v19, v36, v37, v38
    v_max_u32 v19, v19, v39
    v_cmp_eq_u32 vcc, -1, v19
    s_nop 0
    s_cbranch_vccnz g_49F14_3
    v_smfmac_f32_16x16x64_bf16 v[64:67], v[36:39], a[216:223], v172
    v_smfmac_f32_16x16x64_bf16 v[68:71], v[36:39], a[248:255], v172
    s_branch g_49L6_1
g_49L3_1:
    s_waitcnt vmcnt(1)
    v_max3_u32 v19, v28, v29, v30
    v_max_u32 v19, v19, v31
    v_cmp_eq_u32 vcc, -1, v19
    s_nop 0
    s_cbranch_vccnz g_49F3_1
    v_smfmac_f32_16x16x64_bf16 v[64:67], v[28:31], a[200:207], v172
    v_smfmac_f32_16x16x64_bf16 v[68:71], v[28:31], a[232:239], v172
    s_branch g_49L1_0
g_49L6_2:
    s_waitcnt vmcnt(1)
    v_max3_u32 v19, v32, v33, v34
    v_max_u32 v19, v19, v35
    v_cmp_eq_u32 vcc, -1, v19
    s_nop 0
    s_cbranch_vccnz g_49F6_2
    v_smfmac_f32_16x16x64_bf16 v[64:67], v[32:35], a[208:215], v172
    v_smfmac_f32_16x16x64_bf16 v[68:71], v[32:35], a[240:247], v172
    s_branch g_49L2_1
g_49L9_0:
    s_waitcnt vmcnt(1)
    v_max3_u32 v19, v24, v25, v26
    v_max_u32 v19, v19, v27
    v_cmp_eq_u32 vcc, -1, v19
    s_nop 0
    s_cbranch_vccnz g_49F9_0
    v_smfmac_f32_16x16x64_bf16 v[64:67], v[24:27], a[192:199], v172
    v_smfmac_f32_16x16x64_bf16 v[68:71], v[24:27], a[224:231], v172
    s_branch g_49L8_3
g_49L12_3:
    s_waitcnt vmcnt(1)
    v_max3_u32 v19, v36, v37, v38
    v_max_u32 v19, v19, v39
    v_cmp_eq_u32 vcc, -1, v19
    s_nop 0
    s_cbranch_vccnz g_49F12_3
    v_smfmac_f32_16x16x64_bf16 v[64:67], v[36:39], a[216:223], v172
    v_smfmac_f32_16x16x64_bf16 v[68:71], v[36:39], a[248:255], v172
    s_branch g_49L4_2
g_49F15_0:
    s_mov_b64 exec, vcc
    buffer_load_dwordx4 v[24:27], v8, s[4:7], s16 offen offset:0 sc1
    s_mov_b64 exec, -1
    s_add_u32 s23, s23, 1
    s_cmp_lt_u32 s23, 200000
    s_cbranch_scc1 g_49L15_1
    s_mov_b32 s25, 200000
    s_branch gc_50
g_49F15_1:
    s_mov_b64 exec, vcc
    buffer_load_dwordx4 v[28:31], v8, s[4:7], s16 offen offset:1024 sc1
    s_mov_b64 exec, -1
    s_add_u32 s23, s23, 1
    s_cmp_lt_u32 s23, 200000
    s_cbranch_scc1 g_49L15_2
    s_mov_b32 s25, 200000
    s_branch gc_50
g_49F15_2:
    s_mov_b64 exec, vcc
    buffer_load_dwordx4 v[32:35], v8, s[4:7], s16 offen offset:2048 sc1
    s_mov_b64 exec, -1
    s_add_u32 s23, s23, 1
    s_cmp_lt_u32 s23, 200000
    s_cbranch_scc1 g_49L15_3
    s_mov_b32 s25, 200000
    s_branch gc_50
g_49F15_3:
    s_mov_b64 exec, vcc
    buffer_load_dwordx4 v[36:39], v8, s[4:7], s16 offen offset:3072 sc1
    s_mov_b64 exec, -1
    s_add_u32 s23, s23, 1
    s_cmp_lt_u32 s23, 200000
    s_cbranch_scc1 g_49L15_0
    s_mov_b32 s25, 200000
    s_branch gc_50
g_49F7_0:
    s_mov_b64 exec, vcc
    buffer_load_dwordx4 v[24:27], v8, s[4:7], s16 offen offset:0 sc1
    s_mov_b64 exec, -1
    s_add_u32 s23, s23, 1
    s_cmp_lt_u32 s23, 200000
    s_cbranch_scc1 g_49L7_1
    s_mov_b32 s25, 200000
    s_branch gc_50
g_49F7_1:
    s_mov_b64 exec, vcc
    buffer_load_dwordx4 v[28:31], v8, s[4:7], s16 offen offset:1024 sc1
    s_mov_b64 exec, -1
    s_add_u32 s23, s23, 1
    s_cmp_lt_u32 s23, 200000
    s_cbranch_scc1 g_49L7_2
    s_mov_b32 s25, 200000
    s_branch gc_50
g_49F7_2:
    s_mov_b64 exec, vcc
    buffer_load_dwordx4 v[32:35], v8, s[4:7], s16 offen offset:2048 sc1
    s_mov_b64 exec, -1
    s_add_u32 s23, s23, 1
    s_cmp_lt_u32 s23, 200000
    s_cbranch_scc1 g_49L7_0
    s_mov_b32 s25, 200000
    s_branch gc_50
g_49F11_0:
    s_mov_b64 exec, vcc
    buffer_load_dwordx4 v[24:27], v8, s[4:7], s16 offen offset:0 sc1
    s_mov_b64 exec, -1
    s_add_u32 s23, s23, 1
    s_cmp_lt_u32 s23, 200000
    s_cbranch_scc1 g_49L11_1
    s_mov_b32 s25, 200000
    s_branch gc_50
g_49F11_1:
    s_mov_b64 exec, vcc
    buffer_load_dwordx4 v[28:31], v8, s[4:7], s16 offen offset:1024 sc1
    s_mov_b64 exec, -1
    s_add_u32 s23, s23, 1
    s_cmp_lt_u32 s23, 200000
    s_cbranch_scc1 g_49L11_3
    s_mov_b32 s25, 200000
    s_branch gc_50
g_49F11_3:
    s_mov_b64 exec, vcc
    buffer_load_dwordx4 v[36:39], v8, s[4:7], s16 offen offset:3072 sc1
    s_mov_b64 exec, -1
    s_add_u32 s23, s23, 1
    s_cmp_lt_u32 s23, 200000
    s_cbranch_scc1 g_49L11_0
    s_mov_b32 s25, 200000
    s_branch gc_50
g_49F13_0:
    s_mov_b64 exec, vcc
    buffer_load_dwordx4 v[24:27], v8, s[4:7], s16 offen offset:0 sc1
    s_mov_b64 exec, -1
    s_add_u32 s23, s23, 1
    s_cmp_lt_u32 s23, 200000
    s_cbranch_scc1 g_49L13_2
    s_mov_b32 s25, 200000
    s_branch gc_50
g_49F13_2:
    s_mov_b64 exec, vcc
    buffer_load_dwordx4 v[32:35], v8, s[4:7], s16 offen offset:2048 sc1
    s_mov_b64 exec, -1
    s_add_u32 s23, s23, 1
    s_cmp_lt_u32 s23, 200000
    s_cbranch_scc1 g_49L13_3
    s_mov_b32 s25, 200000
    s_branch gc_50
g_49F13_3:
    s_mov_b64 exec, vcc
    buffer_load_dwordx4 v[36:39], v8, s[4:7], s16 offen offset:3072 sc1
    s_mov_b64 exec, -1
    s_add_u32 s23, s23, 1
    s_cmp_lt_u32 s23, 200000
    s_cbranch_scc1 g_49L13_0
    s_mov_b32 s25, 200000
    s_branch gc_50
g_49F14_1:
    s_mov_b64 exec, vcc
    buffer_load_dwordx4 v[28:31], v8, s[4:7], s16 offen offset:1024 sc1
    s_mov_b64 exec, -1
    s_add_u32 s23, s23, 1
    s_cmp_lt_u32 s23, 200000
    s_cbranch_scc1 g_49L14_2
    s_mov_b32 s25, 200000
    s_branch gc_50
g_49F14_2:
    s_mov_b64 exec, vcc
    buffer_load_dwordx4 v[32:35], v8, s[4:7], s16 offen offset:2048 sc1
    s_mov_b64 exec, -1
    s_add_u32 s23, s23, 1
    s_cmp_lt_u32 s23, 200000
    s_cbranch_scc1 g_49L14_3
    s_mov_b32 s25, 200000
    s_branch gc_50
g_49F14_3:
    s_mov_b64 exec, vcc
    buffer_load_dwordx4 v[36:39], v8, s[4:7], s16 offen offset:3072 sc1
    s_mov_b64 exec, -1
    s_add_u32 s23, s23, 1
    s_cmp_lt_u32 s23, 200000
    s_cbranch_scc1 g_49L14_1
    s_mov_b32 s25, 200000
    s_branch gc_50
g_49F3_0:
    s_mov_b64 exec, vcc
    buffer_load_dwordx4 v[24:27], v8, s[4:7], s16 offen offset:0 sc1
    s_mov_b64 exec, -1
    s_add_u32 s23, s23, 1
    s_cmp_lt_u32 s23, 200000
    s_cbranch_scc1 g_49L3_1
    s_mov_b32 s25, 200000
    s_branch gc_50
g_49F3_1:
    s_mov_b64 exec, vcc
    buffer_load_dwordx4 v[28:31], v8, s[4:7], s16 offen offset:1024 sc1
    s_mov_b64 exec, -1
    s_add_u32 s23, s23, 1
    s_cmp_lt_u32 s23, 200000
    s_cbranch_scc1 g_49L3_0
    s_mov_b32 s25, 200000
    s_branch gc_50
g_49F5_0:
    s_mov_b64 exec, vcc
    buffer_load_dwordx4 v[24:27], v8, s[4:7], s16 offen offset:0 sc1
    s_mov_b64 exec, -1
    s_add_u32 s23, s23, 1
    s_cmp_lt_u32 s23, 200000
    s_cbranch_scc1 g_49L5_2
    s_mov_b32 s25, 200000
    s_branch gc_50
g_49F5_2:
    s_mov_b64 exec, vcc
    buffer_load_dwordx4 v[32:35], v8, s[4:7], s16 offen offset:2048 sc1
    s_mov_b64 exec, -1
    s_add_u32 s23, s23, 1
    s_cmp_lt_u32 s23, 200000
    s_cbranch_scc1 g_49L5_0
    s_mov_b32 s25, 200000
    s_branch gc_50
g_49F6_1:
    s_mov_b64 exec, vcc
    buffer_load_dwordx4 v[28:31], v8, s[4:7], s16 offen offset:1024 sc1
    s_mov_b64 exec, -1
    s_add_u32 s23, s23, 1
    s_cmp_lt_u32 s23, 200000
    s_cbranch_scc1 g_49L6_2
    s_mov_b32 s25, 200000
    s_branch gc_50
g_49F6_2:
    s_mov_b64 exec, vcc
    buffer_load_dwordx4 v[32:35], v8, s[4:7], s16 offen offset:2048 sc1
    s_mov_b64 exec, -1
    s_add_u32 s23, s23, 1
    s_cmp_lt_u32 s23, 200000
    s_cbranch_scc1 g_49L6_1
    s_mov_b32 s25, 200000
    s_branch gc_50
g_49F9_0:
    s_mov_b64 exec, vcc
    buffer_load_dwordx4 v[24:27], v8, s[4:7], s16 offen offset:0 sc1
    s_mov_b64 exec, -1
    s_add_u32 s23, s23, 1
    s_cmp_lt_u32 s23, 200000
    s_cbranch_scc1 g_49L9_3
    s_mov_b32 s25, 200000
    s_branch gc_50
g_49F9_3:
    s_mov_b64 exec, vcc
    buffer_load_dwordx4 v[36:39], v8, s[4:7], s16 offen offset:3072 sc1
    s_mov_b64 exec, -1
    s_add_u32 s23, s23, 1
    s_cmp_lt_u32 s23, 200000
    s_cbranch_scc1 g_49L9_0
    s_mov_b32 s25, 200000
    s_branch gc_50
g_49F10_1:
    s_mov_b64 exec, vcc
    buffer_load_dwordx4 v[28:31], v8, s[4:7], s16 offen offset:1024 sc1
    s_mov_b64 exec, -1
    s_add_u32 s23, s23, 1
    s_cmp_lt_u32 s23, 200000
    s_cbranch_scc1 g_49L10_3
    s_mov_b32 s25, 200000
    s_branch gc_50
g_49F10_3:
    s_mov_b64 exec, vcc
    buffer_load_dwordx4 v[36:39], v8, s[4:7], s16 offen offset:3072 sc1
    s_mov_b64 exec, -1
    s_add_u32 s23, s23, 1
    s_cmp_lt_u32 s23, 200000
    s_cbranch_scc1 g_49L10_1
    s_mov_b32 s25, 200000
    s_branch gc_50
g_49F12_2:
    s_mov_b64 exec, vcc
    buffer_load_dwordx4 v[32:35], v8, s[4:7], s16 offen offset:2048 sc1
    s_mov_b64 exec, -1
    s_add_u32 s23, s23, 1
    s_cmp_lt_u32 s23, 200000
    s_cbranch_scc1 g_49L12_3
    s_mov_b32 s25, 200000
    s_branch gc_50
g_49F12_3:
    s_mov_b64 exec, vcc
    buffer_load_dwordx4 v[36:39], v8, s[4:7], s16 offen offset:3072 sc1
    s_mov_b64 exec, -1
    s_add_u32 s23, s23, 1
    s_cmp_lt_u32 s23, 200000
    s_cbranch_scc1 g_49L12_2
    s_mov_b32 s25, 200000
    s_branch gc_50
g_49F1_0:
    s_mov_b64 exec, vcc
    buffer_load_dwordx4 v[24:27], v8, s[4:7], s16 offen offset:0 sc1
    s_mov_b64 exec, -1
    s_add_u32 s23, s23, 1
    s_cmp_lt_u32 s23, 200000
    s_cbranch_scc1 g_49L1_0
    s_mov_b32 s25, 200000
    s_branch gc_50
g_49F2_1:
    s_mov_b64 exec, vcc
    buffer_load_dwordx4 v[28:31], v8, s[4:7], s16 offen offset:1024 sc1
    s_mov_b64 exec, -1
    s_add_u32 s23, s23, 1
    s_cmp_lt_u32 s23, 200000
    s_cbranch_scc1 g_49L2_1
    s_mov_b32 s25, 200000
    s_branch gc_50
g_49F4_2:
    s_mov_b64 exec, vcc
    buffer_load_dwordx4 v[32:35], v8, s[4:7], s16 offen offset:2048 sc1
    s_mov_b64 exec, -1
    s_add_u32 s23, s23, 1
    s_cmp_lt_u32 s23, 200000
    s_cbranch_scc1 g_49L4_2
    s_mov_b32 s25, 200000
    s_branch gc_50
g_49F8_3:
    s_mov_b64 exec, vcc
    buffer_load_dwordx4 v[36:39], v8, s[4:7], s16 offen offset:3072 sc1
    s_mov_b64 exec, -1
    s_add_u32 s23, s23, 1
    s_cmp_lt_u32 s23, 200000
    s_cbranch_scc1 g_49L8_3
    s_mov_b32 s25, 200000
    s_branch gc_50
pr_51:
    v_max3_u32 v19, v96, v97, v98
    v_max3_u32 v19, v19, v99, v100
    v_max3_u32 v19, v19, v101, v102
    v_max3_u32 v19, v19, v103, v104
    v_max3_u32 v19, v19, v105, v106
    v_max_u32 v19, v19, v107
    v_cmp_eq_u32 vcc, -1, v19
    s_nop 0
    s_cbranch_vccz pf_55
    buffer_load_dwordx4 v[96:99], v10, s[4:7], s84 offen sc1
    buffer_load_dwordx4 v[100:103], v23, s[4:7], s84 offen sc1
    buffer_load_dwordx4 v[104:107], v244, s[4:7], s84 offen sc1
    s_add_u32 s23, s23, 1
    s_cmp_lt_u32 s23, 200000
    s_cbranch_scc1 pb_53
    s_mov_b32 s25, 200000
pf_55:
    buffer_store_dwordx2 v[180:181], v11, s[4:7], s42 offen
    s_branch pg_52
.p2align 6
recur_slow_w0:
    s_nop 15
    s_mov_b32 s23, s25
g_56:
    buffer_load_dwordx4 v[24:27], v2, s[4:7], s16 offen offset:0 sc1
    buffer_load_dwordx4 v[28:31], v2, s[4:7], s16 offen offset:1024 sc1
    buffer_load_dwordx4 v[32:35], v2, s[4:7], s16 offen offset:2048 sc1
    buffer_load_dwordx4 v[36:39], v2, s[4:7], s16 offen offset:3072 sc1
    s_waitcnt vmcnt(0)
    v_max3_u32 v19, v24, v25, v26
    v_max3_u32 v19, v19, v27, v28
    v_max3_u32 v19, v19, v29, v30
    v_max3_u32 v19, v19, v31, v32
    v_max3_u32 v19, v19, v33, v34
    v_max3_u32 v19, v19, v35, v36
    v_max3_u32 v19, v19, v37, v38
    v_max_u32 v19, v19, v39
    v_cmp_eq_u32 vcc, -1, v19
    s_nop 0
    s_cbranch_vccz g_56k
    s_add_u32 s23, s23, 1
    s_cmp_lt_u32 s23, 200000
    s_cbranch_scc1 g_56
    s_mov_b32 s25, 200000
g_56k:
    v_smfmac_f32_16x16x64_bf16 v[40:43], v[24:27], a[0:7], v172
    v_smfmac_f32_16x16x64_bf16 v[44:47], v[24:27], a[64:71], v172
    v_smfmac_f32_16x16x64_bf16 v[48:51], v[24:27], a[32:39], v172
    v_smfmac_f32_16x16x64_bf16 v[52:55], v[24:27], a[96:103], v172
    v_smfmac_f32_16x16x64_bf16 v[40:43], v[28:31], a[8:15], v172
    v_smfmac_f32_16x16x64_bf16 v[44:47], v[28:31], a[72:79], v172
    v_smfmac_f32_16x16x64_bf16 v[48:51], v[28:31], a[40:47], v172
    v_smfmac_f32_16x16x64_bf16 v[52:55], v[28:31], a[104:111], v172
    v_smfmac_f32_16x16x64_bf16 v[40:43], v[32:35], a[16:23], v172
    v_smfmac_f32_16x16x64_bf16 v[44:47], v[32:35], a[80:87], v172
    v_smfmac_f32_16x16x64_bf16 v[48:51], v[32:35], a[48:55], v172
    v_smfmac_f32_16x16x64_bf16 v[52:55], v[32:35], a[112:119], v172
    v_smfmac_f32_16x16x64_bf16 v[40:43], v[36:39], a[24:31], v172
    v_smfmac_f32_16x16x64_bf16 v[44:47], v[36:39], a[88:95], v172
    v_smfmac_f32_16x16x64_bf16 v[48:51], v[36:39], a[56:63], v172
    v_smfmac_f32_16x16x64_bf16 v[52:55], v[36:39], a[120:127], v172
    v_cvt_pk_bf16_f32 v72, v40, v41
    v_cvt_pk_bf16_f32 v73, v42, v43
    v_cvt_pk_bf16_f32 v74, v44, v45
    v_cvt_pk_bf16_f32 v75, v46, v47
    v_smfmac_f32_16x16x64_bf16 v[56:59], v[24:27], a[128:135], v172
    v_cvt_pk_bf16_f32 v76, v48, v49
    v_cvt_pk_bf16_f32 v77, v50, v51
    s_nop 0
    v_cvt_pk_bf16_f32 v78, v52, v53
    v_cvt_pk_bf16_f32 v79, v54, v55
    v_smfmac_f32_16x16x64_bf16 v[60:63], v[24:27], a[160:167], v172
    v_mfma_f32_16x16x32_bf16 v[88:91], v[72:75], v[84:87], 0
    v_mfma_f32_16x16x32_bf16 v[92:95], v[76:79], v[84:87], 0
    v_smfmac_f32_16x16x64_bf16 v[56:59], v[28:31], a[136:143], v172
    v_smfmac_f32_16x16x64_bf16 v[60:63], v[28:31], a[168:175], v172
    s_barrier
    ds_read_b128 v[104:107], v16 offset:2048
    ds_read_b128 v[108:111], v16 offset:3072
    ds_read_b128 v[112:115], v16 offset:4096
    ds_read_b128 v[116:119], v16 offset:5120
    ds_read_b128 v[120:123], v16 offset:6144
    ds_read_b128 v[124:127], v16 offset:7168
    v_smfmac_f32_16x16x64_bf16 v[56:59], v[32:35], a[144:151], v172
    v_smfmac_f32_16x16x64_bf16 v[60:63], v[32:35], a[176:183], v172
    v_smfmac_f32_16x16x64_bf16 v[56:59], v[36:39], a[152:159], v172
    v_smfmac_f32_16x16x64_bf16 v[60:63], v[36:39], a[184:191], v172
    s_waitcnt lgkmcnt(5)
    v_mfma_f32_16x16x32_bf16 v[88:91], v[104:107], v[84:87], v[88:91]
    s_waitcnt lgkmcnt(4)
    v_mfma_f32_16x16x32_bf16 v[92:95], v[108:111], v[84:87], v[92:95]
    s_waitcnt lgkmcnt(3)
    v_mfma_f32_16x16x32_bf16 v[88:91], v[112:115], v[84:87], v[88:91]
    s_waitcnt lgkmcnt(2)
    v_mfma_f32_16x16x32_bf16 v[92:95], v[116:119], v[84:87], v[92:95]
    s_waitcnt lgkmcnt(1)
    v_mfma_f32_16x16x32_bf16 v[88:91], v[120:123], v[84:87], v[88:91]
    s_waitcnt lgkmcnt(0)
    v_mfma_f32_16x16x32_bf16 v[92:95], v[124:127], v[84:87], v[92:95]
    v_cvt_pk_bf16_f32 v80, v56, v57
    v_cvt_pk_bf16_f32 v81, v58, v59
    v_cvt_pk_bf16_f32 v82, v60, v61
    v_cvt_pk_bf16_f32 v83, v62, v63
    ds_write_b128 v17, v[80:83] offset:8192
    s_nop 0
    v_cvt_pk_bf16_f32 v128, v88, v89
    v_cvt_pk_bf16_f32 v129, v90, v91
    v_cvt_pk_bf16_f32 v130, v92, v93
    v_cvt_pk_bf16_f32 v131, v94, v95
    s_nop 1
    v_mfma_f32_16x16x32_bf16 v[144:147], v[132:135], v[128:131], 0
    v_mfma_f32_16x16x32_bf16 v[148:151], v[136:139], v[128:131], 0
    v_mfma_f32_16x16x32_bf16 v[140:143], v[128:131], v[128:131], 0
    s_nop 1
    buffer_store_dwordx4 v[144:147], v3, s[4:7], s16 offen sc1
    s_nop 1
    buffer_store_dwordx4 v[148:151], v3, s[4:7], s16 offen offset:128 sc1
    s_nop 1
    buffer_store_dwordx4 v[140:143], v4, s[4:7], s16 offen sc1
    s_cmp_eq_u32 s15, 63
    s_waitcnt lgkmcnt(0)
    s_barrier
    s_cbranch_scc1 recur_slow_last0
    v_readfirstlane_b32 s85, v247
    s_add_u32 s94, s15, 2
    s_barrier
    s_nop 15
    s_mov_b32 s23, s25
g_57:
    buffer_load_dwordx4 v[24:27], v8, s[4:7], s16 offen offset:0 sc1
    buffer_load_dwordx4 v[28:31], v8, s[4:7], s16 offen offset:1024 sc1
    buffer_load_dwordx4 v[32:35], v8, s[4:7], s16 offen offset:2048 sc1
    buffer_load_dwordx4 v[36:39], v8, s[4:7], s16 offen offset:3072 sc1
    s_waitcnt vmcnt(0)
    v_max3_u32 v19, v24, v25, v26
    v_max3_u32 v19, v19, v27, v28
    v_max3_u32 v19, v19, v29, v30
    v_max3_u32 v19, v19, v31, v32
    v_max3_u32 v19, v19, v33, v34
    v_max3_u32 v19, v19, v35, v36
    v_max3_u32 v19, v19, v37, v38
    v_max_u32 v19, v19, v39
    v_cmp_eq_u32 vcc, -1, v19
    s_nop 0
    s_cbranch_vccz g_57k
    s_add_u32 s23, s23, 1
    s_cmp_lt_u32 s23, 200000
    s_cbranch_scc1 g_57
    s_mov_b32 s25, 200000
g_57k:
    v_smfmac_f32_16x16x64_bf16 v[64:67], v[24:27], a[192:199], v172
    v_smfmac_f32_16x16x64_bf16 v[68:71], v[24:27], a[224:231], v172
    v_smfmac_f32_16x16x64_bf16 v[64:67], v[28:31], a[200:207], v172
    v_smfmac_f32_16x16x64_bf16 v[68:71], v[28:31], a[232:239], v172
    v_smfmac_f32_16x16x64_bf16 v[64:67], v[32:35], a[208:215], v172
    v_smfmac_f32_16x16x64_bf16 v[68:71], v[32:35], a[240:247], v172
    v_smfmac_f32_16x16x64_bf16 v[64:67], v[36:39], a[216:223], v172
    v_smfmac_f32_16x16x64_bf16 v[68:71], v[36:39], a[248:255], v172
    s_nop 4
    v_cvt_pk_bf16_f32 v80, v64, v65
    v_cvt_pk_bf16_f32 v81, v66, v67
    s_nop 0
    v_cvt_pk_bf16_f32 v82, v68, v69
    v_cvt_pk_bf16_f32 v83, v70, v71
    ds_write_b128 v17, v[80:83] offset:9216
    s_waitcnt lgkmcnt(0)
    s_barrier
    s_nop 15
    s_nop 15
    s_nop 15
    s_nop 15
    buffer_store_dwordx4 v[128:131], v14, s[4:7], s19 offen sc1
    s_add_u32 s19, s19, 512
    s_mov_b32 s23, s25
fw_58:
    s_cmp_ge_u32 s85, s94
    s_cbranch_scc1 fo_59
    buffer_load_dword v247, v245, s[4:7], 0 offen sc1
    s_add_u32 s23, s23, 1
    s_waitcnt vmcnt(0)
    v_readfirstlane_b32 s85, v247
    s_cmp_lt_u32 s23, 200000
    s_cbranch_scc1 fw_58
    s_mov_b32 s25, 200000
fo_59:
    buffer_load_dwordx4 v[132:135], v12, s[4:7], s17 offen sc1
    buffer_load_dwordx4 v[136:139], v12, s[4:7], s17 offen offset:256 sc1
    s_add_u32 s17, s17, 2048
    s_min_u32 s17, s17, 17954816
    buffer_load_dword v247, v245, s[4:7], 0 offen sc1
    v_mov_b32 v40, 0
    v_mov_b32 v41, 0
    v_mov_b32 v42, 0
    v_mov_b32 v43, 0
    v_mov_b32 v44, 0
    v_mov_b32 v45, 0
    v_mov_b32 v46, 0
    v_mov_b32 v47, 0
    v_mov_b32 v48, 0
    v_mov_b32 v49, 0
    v_mov_b32 v50, 0
    v_mov_b32 v51, 0
    v_mov_b32 v52, 0
    v_mov_b32 v53, 0
    v_mov_b32 v54, 0
    v_mov_b32 v55, 0
    v_mov_b32 v56, 0
    v_mov_b32 v57, 0
    v_mov_b32 v58, 0
    v_mov_b32 v59, 0
    v_mov_b32 v60, 0
    v_mov_b32 v61, 0
    v_mov_b32 v62, 0
    v_mov_b32 v63, 0
    v_mov_b32 v64, 0
    v_mov_b32 v65, 0
    v_mov_b32 v66, 0
    v_mov_b32 v67, 0
    v_mov_b32 v68, 0
    v_mov_b32 v69, 0
    v_mov_b32 v70, 0
    v_mov_b32 v71, 0
    s_mov_b32 s21, s16
    s_mov_b32 s16, s42
    s_mov_b32 s42, s43
    s_mov_b32 s43, s44
    s_mov_b32 s44, s21
    s_add_u32 s95, s95, 524288
    s_lshr_b32 s84, s95, 8
    s_and_b32 s84, s84, 8192
    s_xor_b32 s84, s84, s46
    s_add_u32 s84, s84, s95
    s_add_u32 s15, s15, 1
    s_barrier
    s_branch recur_slow_w0
recur_slow_last0:
    buffer_store_dwordx4 v[128:131], v14, s[4:7], s19 offen sc1
    s_waitcnt vmcnt(0)
    s_branch recur_end
.p2align 6
recur_slow_w1:
    s_nop 15
    s_mov_b32 s23, s25
g_60:
    buffer_load_dwordx4 v[24:27], v2, s[4:7], s16 offen offset:0 sc1
    buffer_load_dwordx4 v[28:31], v2, s[4:7], s16 offen offset:1024 sc1
    buffer_load_dwordx4 v[32:35], v2, s[4:7], s16 offen offset:2048 sc1
    buffer_load_dwordx4 v[36:39], v2, s[4:7], s16 offen offset:3072 sc1
    s_waitcnt vmcnt(0)
    v_max3_u32 v19, v24, v25, v26
    v_max3_u32 v19, v19, v27, v28
    v_max3_u32 v19, v19, v29, v30
    v_max3_u32 v19, v19, v31, v32
    v_max3_u32 v19, v19, v33, v34
    v_max3_u32 v19, v19, v35, v36
    v_max3_u32 v19, v19, v37, v38
    v_max_u32 v19, v19, v39
    v_cmp_eq_u32 vcc, -1, v19
    s_nop 0
    s_cbranch_vccz g_60k
    s_add_u32 s23, s23, 1
    s_cmp_lt_u32 s23, 200000
    s_cbranch_scc1 g_60
    s_mov_b32 s25, 200000
g_60k:
    v_smfmac_f32_16x16x64_bf16 v[40:43], v[24:27], a[0:7], v172
    v_smfmac_f32_16x16x64_bf16 v[44:47], v[24:27], a[64:71], v172
    v_smfmac_f32_16x16x64_bf16 v[48:51], v[24:27], a[32:39], v172
    v_smfmac_f32_16x16x64_bf16 v[52:55], v[24:27], a[96:103], v172
    v_smfmac_f32_16x16x64_bf16 v[40:43], v[28:31], a[8:15], v172
    v_smfmac_f32_16x16x64_bf16 v[44:47], v[28:31], a[72:79], v172
    v_smfmac_f32_16x16x64_bf16 v[48:51], v[28:31], a[40:47], v172
    v_smfmac_f32_16x16x64_bf16 v[52:55], v[28:31], a[104:111], v172
    v_smfmac_f32_16x16x64_bf16 v[40:43], v[32:35], a[16:23], v172
    v_smfmac_f32_16x16x64_bf16 v[44:47], v[32:35], a[80:87], v172
    v_smfmac_f32_16x16x64_bf16 v[48:51], v[32:35], a[48:55], v172
    v_smfmac_f32_16x16x64_bf16 v[52:55], v[32:35], a[112:119], v172
    v_smfmac_f32_16x16x64_bf16 v[40:43], v[36:39], a[24:31], v172
    v_smfmac_f32_16x16x64_bf16 v[44:47], v[36:39], a[88:95], v172
    v_smfmac_f32_16x16x64_bf16 v[48:51], v[36:39], a[56:63], v172
    v_smfmac_f32_16x16x64_bf16 v[52:55], v[36:39], a[120:127], v172
    v_cvt_pk_bf16_f32 v72, v40, v41
    v_cvt_pk_bf16_f32 v73, v42, v43
    v_cvt_pk_bf16_f32 v74, v44, v45
    v_cvt_pk_bf16_f32 v75, v46, v47
    ds_write_b128 v17, v[72:75] offset:0
    v_cvt_pk_bf16_f32 v76, v48, v49
    v_cvt_pk_bf16_f32 v77, v50, v51
    s_nop 0
    v_cvt_pk_bf16_f32 v78, v52, v53
    v_cvt_pk_bf16_f32 v79, v54, v55
    ds_write_b128 v17, v[76:79] offset:1024
    v_smfmac_f32_16x16x64_bf16 v[56:59], v[24:27], a[128:135], v172
    v_smfmac_f32_16x16x64_bf16 v[60:63], v[24:27], a[160:167], v172
    v_smfmac_f32_16x16x64_bf16 v[56:59], v[28:31], a[136:143], v172
    s_waitcnt lgkmcnt(0)
    s_barrier
    v_smfmac_f32_16x16x64_bf16 v[60:63], v[28:31], a[168:175], v172
    v_smfmac_f32_16x16x64_bf16 v[56:59], v[32:35], a[144:151], v172
    v_smfmac_f32_16x16x64_bf16 v[60:63], v[32:35], a[176:183], v172
    v_smfmac_f32_16x16x64_bf16 v[56:59], v[36:39], a[152:159], v172
    v_smfmac_f32_16x16x64_bf16 v[60:63], v[36:39], a[184:191], v172
    s_nop 4
    v_cvt_pk_bf16_f32 v80, v56, v57
    v_cvt_pk_bf16_f32 v81, v58, v59
    s_nop 0
    v_cvt_pk_bf16_f32 v82, v60, v61
    v_cvt_pk_bf16_f32 v83, v62, v63
    ds_write_b128 v17, v[80:83] offset:8192
    v_mov_b32 v152, v228
    v_mov_b32 v153, v229
    v_mov_b32 v156, v230
    v_mov_b32 v157, v231
    v_mov_b32 v160, v232
    v_mov_b32 v161, v233
    v_mov_b32 v164, v234
    v_mov_b32 v165, v235
    s_cmp_eq_u32 s15, 63
    s_waitcnt lgkmcnt(0)
    s_barrier
    s_cbranch_scc1 recur_end
    s_nop 15
    s_nop 15
    s_nop 7
    buffer_load_dwordx4 v[208:211], v5, s[4:7], s16 offen offset:0 sc1
    buffer_load_dwordx4 v[212:215], v5, s[4:7], s16 offen offset:1024 sc1
    buffer_load_dwordx4 v[216:219], v5, s[4:7], s16 offen offset:2048 sc1
    buffer_load_dwordx4 v[220:223], v5, s[4:7], s16 offen offset:3072 sc1
    buffer_load_dword v224, v6, s[4:7], s16 offen offset:0 sc1
    buffer_load_dword v225, v6, s[4:7], s16 offen offset:256 sc1
    buffer_load_dword v226, v6, s[4:7], s16 offen offset:512 sc1
    buffer_load_dword v227, v6, s[4:7], s16 offen offset:768 sc1
    s_mov_b32 s23, s25
    ds_read_b128 v[96:99], v16 offset:8192
    ds_read_b128 v[104:107], v16 offset:12288
    ds_read_b128 v[108:111], v16 offset:14336
    v_mfma_f32_16x16x32_bf16 v[140:143], v[84:87], v[80:83], 0
    s_waitcnt lgkmcnt(2)
    v_mfma_f32_16x16x32_bf16 v[140:143], v[84:87], v[96:99], v[140:143]
    s_waitcnt lgkmcnt(1)
    v_mfma_f32_16x16x32_bf16 v[140:143], v[84:87], v[104:107], v[140:143]
    s_waitcnt lgkmcnt(0)
    v_mfma_f32_16x16x32_bf16 v[140:143], v[84:87], v[108:111], v[140:143]
    buffer_load_dwordx4 v[24:27], v5, s[4:7], s16 offen offset:0 sc1
    buffer_load_dwordx4 v[28:31], v5, s[4:7], s16 offen offset:1024 sc1
    buffer_load_dwordx4 v[32:35], v5, s[4:7], s16 offen offset:2048 sc1
    buffer_load_dwordx4 v[36:39], v5, s[4:7], s16 offen offset:3072 sc1
    buffer_load_dword v40, v6, s[4:7], s16 offen offset:0 sc1
    buffer_load_dword v41, v6, s[4:7], s16 offen offset:256 sc1
    buffer_load_dword v42, v6, s[4:7], s16 offen offset:512 sc1
    buffer_load_dword v43, v6, s[4:7], s16 offen offset:768 sc1
    v_cvt_pk_bf16_f32 v154, v140, v179
    v_cvt_pk_bf16_f32 v158, v141, v179
    v_cvt_pk_bf16_f32 v162, v142, v179
    v_cvt_pk_bf16_f32 v166, v143, v179
    s_waitcnt vmcnt(14)
    v_pk_add_f32 v[180:181], v[208:209], v[212:213]
    v_pk_add_f32 v[182:183], v[210:211], v[214:215]
    s_waitcnt vmcnt(12)
    v_pk_add_f32 v[188:189], v[216:217], v[220:221]
    v_pk_add_f32 v[190:191], v[218:219], v[222:223]
    v_pk_add_f32 v[180:181], v[180:181], v[188:189]
    v_pk_add_f32 v[182:183], v[182:183], v[190:191]
    v_pk_add_f32 v[188:189], v[180:181], v[182:183]
    v_max3_f32 v185, v180, v181, v182
    s_waitcnt vmcnt(8)
    v_pk_add_f32 v[192:193], v[224:225], v[226:227]
    v_add_f32 v188, v188, v189
    v_add_f32 v184, v192, v193
    v_max3_f32 v185, v185, v183, v184
    v_cmp_u_f32 vcc, v188, v184
    s_nop 0
    v_max_f32_dpp v185, v185, v185 row_ror:8 row_mask:0xf bank_mask:0xf
    v_mov_b32 v186, v185
    s_nop 1
    v_permlane16_swap_b32 v185, v186
    v_max_f32 v185, v185, v186
    v_mov_b32 v186, v185
    s_cbranch_vccnz ss_61
sg_63:
    s_nop 0
    v_permlane32_swap_b32 v185, v186
    v_max_f32 v185, v185, v186
    v_mul_f32 v185, s24, v185
    v_fma_f32 v180, v180, s24, -v185
    v_fma_f32 v181, v181, s24, -v185
    v_fma_f32 v182, v182, s24, -v185
    v_fma_f32 v183, v183, s24, -v185
    v_fma_f32 v184, v184, s24, -v185
    v_exp_f32 v180, v180
    v_exp_f32 v181, v181
    v_exp_f32 v182, v182
    v_exp_f32 v183, v183
    v_exp_f32 v184, v184
    v_cvt_pk_bf16_f32 v176, v180, v181
    v_cvt_pk_bf16_f32 v177, v182, v183
    v_cvt_pk_bf16_f32 v178, v184, v179
    s_nop 1
    v_mfma_f32_16x16x32_bf16 v[240:243], v[236:239], v[176:179], 0
    v_mfma_f32_16x16x32_bf16 v[188:191], v[152:155], v[176:179], 0
    v_mfma_f32_16x16x32_bf16 v[192:195], v[156:159], v[176:179], 0
    v_mfma_f32_16x16x32_bf16 v[196:199], v[160:163], v[176:179], 0
    v_mfma_f32_16x16x32_bf16 v[200:203], v[164:167], v[176:179], 0
    v_add_f32_dpp v185, v240, v240 row_ror:8 row_mask:0xf bank_mask:0xf
    v_rcp_f32 v185, v185
    v_add_f32_dpp v88, v192, v188 row_ror:8 row_mask:0xf bank_mask:0x3
    v_add_f32_dpp v89, v193, v189 row_ror:8 row_mask:0xf bank_mask:0x3
    v_add_f32_dpp v90, v194, v190 row_ror:8 row_mask:0xf bank_mask:0x3
    v_add_f32_dpp v91, v195, v191 row_ror:8 row_mask:0xf bank_mask:0x3
    s_nop 1
    v_add_f32_dpp v88, v196, v200 row_ror:8 row_mask:0xf bank_mask:0xc
    v_add_f32_dpp v89, v197, v201 row_ror:8 row_mask:0xf bank_mask:0xc
    v_add_f32_dpp v90, v198, v202 row_ror:8 row_mask:0xf bank_mask:0xc
    v_add_f32_dpp v91, v199, v203 row_ror:8 row_mask:0xf bank_mask:0xc
    v_mul_f32 v88, v88, v185
    v_mul_f32 v89, v89, v185
    v_mul_f32 v90, v90, v185
    v_mul_f32 v91, v91, v185
    v_cvt_pk_bf16_f32 v88, v88, v89
    v_cvt_pk_bf16_f32 v89, v90, v91
    buffer_store_dwordx2 v[88:89], v7, s[4:7], s16 offen sc1
    v_readfirstlane_b32 s85, v247
    s_add_u32 s94, s15, 2
    s_barrier
    s_nop 15
    s_mov_b32 s23, s25
g_64:
    buffer_load_dwordx4 v[24:27], v8, s[4:7], s16 offen offset:0 sc1
    buffer_load_dwordx4 v[28:31], v8, s[4:7], s16 offen offset:1024 sc1
    buffer_load_dwordx4 v[32:35], v8, s[4:7], s16 offen offset:2048 sc1
    buffer_load_dwordx4 v[36:39], v8, s[4:7], s16 offen offset:3072 sc1
    s_waitcnt vmcnt(0)
    v_max3_u32 v19, v24, v25, v26
    v_max3_u32 v19, v19, v27, v28
    v_max3_u32 v19, v19, v29, v30
    v_max3_u32 v19, v19, v31, v32
    v_max3_u32 v19, v19, v33, v34
    v_max3_u32 v19, v19, v35, v36
    v_max3_u32 v19, v19, v37, v38
    v_max_u32 v19, v19, v39
    v_cmp_eq_u32 vcc, -1, v19
    s_nop 0
    s_cbranch_vccz g_64k
    s_add_u32 s23, s23, 1
    s_cmp_lt_u32 s23, 200000
    s_cbranch_scc1 g_64
    s_mov_b32 s25, 200000
g_64k:
    v_smfmac_f32_16x16x64_bf16 v[64:67], v[24:27], a[192:199], v172
    v_smfmac_f32_16x16x64_bf16 v[68:71], v[24:27], a[224:231], v172
    v_smfmac_f32_16x16x64_bf16 v[64:67], v[28:31], a[200:207], v172
    v_smfmac_f32_16x16x64_bf16 v[68:71], v[28:31], a[232:239], v172
    v_smfmac_f32_16x16x64_bf16 v[64:67], v[32:35], a[208:215], v172
    v_smfmac_f32_16x16x64_bf16 v[68:71], v[32:35], a[240:247], v172
    v_smfmac_f32_16x16x64_bf16 v[64:67], v[36:39], a[216:223], v172
    v_smfmac_f32_16x16x64_bf16 v[68:71], v[36:39], a[248:255], v172
    s_nop 4
    v_cvt_pk_bf16_f32 v80, v64, v65
    v_cvt_pk_bf16_f32 v81, v66, v67
    s_nop 0
    v_cvt_pk_bf16_f32 v82, v68, v69
    v_cvt_pk_bf16_f32 v83, v70, v71
    ds_write_b128 v17, v[80:83] offset:9216
    s_waitcnt lgkmcnt(0)
    s_barrier
    s_nop 15
    s_nop 15
    s_nop 15
    s_nop 15
    s_mov_b32 s23, s25
fw_65:
    s_cmp_ge_u32 s85, s94
    s_cbranch_scc1 fo_66
    buffer_load_dword v247, v245, s[4:7], 0 offen sc1
    s_add_u32 s23, s23, 1
    s_waitcnt vmcnt(0)
    v_readfirstlane_b32 s85, v247
    s_cmp_lt_u32 s23, 200000
    s_cbranch_scc1 fw_65
    s_mov_b32 s25, 200000
fo_66:
    buffer_load_dwordx4 v[228:231], v13, s[4:7], s18 offen offset:0 sc1
    buffer_load_dwordx4 v[232:235], v13, s[4:7], s18 offen offset:256 sc1
    s_add_u32 s18, s18, 2048
    s_min_u32 s18, s18, 35780608
    buffer_load_dword v247, v245, s[4:7], 0 offen sc1
    v_mov_b32 v40, 0
    v_mov_b32 v41, 0
    v_mov_b32 v42, 0
    v_mov_b32 v43, 0
    v_mov_b32 v44, 0
    v_mov_b32 v45, 0
    v_mov_b32 v46, 0
    v_mov_b32 v47, 0
    v_mov_b32 v48, 0
    v_mov_b32 v49, 0
    v_mov_b32 v50, 0
    v_mov_b32 v51, 0
    v_mov_b32 v52, 0
    v_mov_b32 v53, 0
    v_mov_b32 v54, 0
    v_mov_b32 v55, 0
    v_mov_b32 v56, 0
    v_mov_b32 v57, 0
    v_mov_b32 v58, 0
    v_mov_b32 v59, 0
    v_mov_b32 v60, 0
    v_mov_b32 v61, 0
    v_mov_b32 v62, 0
    v_mov_b32 v63, 0
    v_mov_b32 v64, 0
    v_mov_b32 v65, 0
    v_mov_b32 v66, 0
    v_mov_b32 v67, 0
    v_mov_b32 v68, 0
    v_mov_b32 v69, 0
    v_mov_b32 v70, 0
    v_mov_b32 v71, 0
    s_mov_b32 s21, s16
    s_mov_b32 s16, s42
    s_mov_b32 s42, s43
    s_mov_b32 s43, s44
    s_mov_b32 s44, s21
    s_add_u32 s95, s95, 524288
    s_lshr_b32 s84, s95, 8
    s_and_b32 s84, s84, 8192
    s_xor_b32 s84, s84, s46
    s_add_u32 s84, s84, s95
    s_add_u32 s15, s15, 1
    s_barrier
    s_branch recur_slow_w1
sb_62:
    v_max3_u32 v19, v24, v25, v26
    v_max3_u32 v19, v19, v27, v28
    v_max3_u32 v19, v19, v29, v30
    v_max3_u32 v19, v19, v31, v32
    v_max3_u32 v19, v19, v33, v34
    v_max3_u32 v19, v19, v35, v36
    v_max3_u32 v19, v19, v37, v38
    v_max3_u32 v19, v19, v39, v40
    v_max3_u32 v19, v19, v41, v42
    v_max_u32 v19, v19, v43
    v_cmp_eq_u32 vcc, -1, v19
    s_nop 0
    s_cbranch_vccz sg_63
    buffer_load_dwordx4 v[24:27], v5, s[4:7], s16 offen offset:0 sc1
    buffer_load_dwordx4 v[28:31], v5, s[4:7], s16 offen offset:1024 sc1
    buffer_load_dwordx4 v[32:35], v5, s[4:7], s16 offen offset:2048 sc1
    buffer_load_dwordx4 v[36:39], v5, s[4:7], s16 offen offset:3072 sc1
    buffer_load_dword v40, v6, s[4:7], s16 offen offset:0 sc1
    buffer_load_dword v41, v6, s[4:7], s16 offen offset:256 sc1
    buffer_load_dword v42, v6, s[4:7], s16 offen offset:512 sc1
    buffer_load_dword v43, v6, s[4:7], s16 offen offset:768 sc1
    s_add_u32 s23, s23, 1
    s_cmp_lt_u32 s23, 200000
    s_cbranch_scc1 ss_61
    s_mov_b32 s25, 200000
    s_branch sg_63
ss_61:
    s_waitcnt vmcnt(6)
    v_pk_add_f32 v[180:181], v[24:25], v[28:29]
    v_pk_add_f32 v[182:183], v[26:27], v[30:31]
    s_waitcnt vmcnt(4)
    v_pk_add_f32 v[188:189], v[32:33], v[36:37]
    v_pk_add_f32 v[190:191], v[34:35], v[38:39]
    v_pk_add_f32 v[180:181], v[180:181], v[188:189]
    v_pk_add_f32 v[182:183], v[182:183], v[190:191]
    v_pk_add_f32 v[188:189], v[180:181], v[182:183]
    v_max3_f32 v185, v180, v181, v182
    s_waitcnt vmcnt(0)
    v_pk_add_f32 v[192:193], v[40:41], v[42:43]
    v_add_f32 v188, v188, v189
    v_add_f32 v184, v192, v193
    v_max3_f32 v185, v185, v183, v184
    v_cmp_u_f32 vcc, v188, v184
    s_nop 0
    v_max_f32_dpp v185, v185, v185 row_ror:8 row_mask:0xf bank_mask:0xf
    v_mov_b32 v186, v185
    s_nop 1
    v_permlane16_swap_b32 v185, v186
    v_max_f32 v185, v185, v186
    v_mov_b32 v186, v185
    s_cbranch_vccnz sb_62
    s_branch sg_63
.p2align 6
recur_slow_w2:
    s_nop 15
    s_mov_b32 s23, s25
g_67:
    buffer_load_dwordx4 v[24:27], v2, s[4:7], s16 offen offset:0 sc1
    buffer_load_dwordx4 v[28:31], v2, s[4:7], s16 offen offset:1024 sc1
    buffer_load_dwordx4 v[32:35], v2, s[4:7], s16 offen offset:2048 sc1
    buffer_load_dwordx4 v[36:39], v2, s[4:7], s16 offen offset:3072 sc1
    s_waitcnt vmcnt(0)
    v_max3_u32 v19, v24, v25, v26
    v_max3_u32 v19, v19, v27, v28
    v_max3_u32 v19, v19, v29, v30
    v_max3_u32 v19, v19, v31, v32
    v_max3_u32 v19, v19, v33, v34
    v_max3_u32 v19, v19, v35, v36
    v_max3_u32 v19, v19, v37, v38
    v_max_u32 v19, v19, v39
    v_cmp_eq_u32 vcc, -1, v19
    s_nop 0
    s_cbranch_vccz g_67k
    s_add_u32 s23, s23, 1
    s_cmp_lt_u32 s23, 200000
    s_cbranch_scc1 g_67
    s_mov_b32 s25, 200000
g_67k:
    v_smfmac_f32_16x16x64_bf16 v[40:43], v[24:27], a[0:7], v172
    v_smfmac_f32_16x16x64_bf16 v[44:47], v[24:27], a[64:71], v172
    v_smfmac_f32_16x16x64_bf16 v[48:51], v[24:27], a[32:39], v172
    v_smfmac_f32_16x16x64_bf16 v[52:55], v[24:27], a[96:103], v172
    v_smfmac_f32_16x16x64_bf16 v[40:43], v[28:31], a[8:15], v172
    v_smfmac_f32_16x16x64_bf16 v[44:47], v[28:31], a[72:79], v172
    v_smfmac_f32_16x16x64_bf16 v[48:51], v[28:31], a[40:47], v172
    v_smfmac_f32_16x16x64_bf16 v[52:55], v[28:31], a[104:111], v172
    v_smfmac_f32_16x16x64_bf16 v[40:43], v[32:35], a[16:23], v172
    v_smfmac_f32_16x16x64_bf16 v[44:47], v[32:35], a[80:87], v172
    v_smfmac_f32_16x16x64_bf16 v[48:51], v[32:35], a[48:55], v172
    v_smfmac_f32_16x16x64_bf16 v[52:55], v[32:35], a[112:119], v172
    v_smfmac_f32_16x16x64_bf16 v[40:43], v[36:39], a[24:31], v172
    v_smfmac_f32_16x16x64_bf16 v[44:47], v[36:39], a[88:95], v172
    v_smfmac_f32_16x16x64_bf16 v[48:51], v[36:39], a[56:63], v172
    v_smfmac_f32_16x16x64_bf16 v[52:55], v[36:39], a[120:127], v172
    v_cvt_pk_bf16_f32 v72, v40, v41
    v_cvt_pk_bf16_f32 v73, v42, v43
    v_cvt_pk_bf16_f32 v74, v44, v45
    v_cvt_pk_bf16_f32 v75, v46, v47
    ds_write_b128 v17, v[72:75] offset:0
    v_cvt_pk_bf16_f32 v76, v48, v49
    v_cvt_pk_bf16_f32 v77, v50, v51
    s_nop 0
    v_cvt_pk_bf16_f32 v78, v52, v53
    v_cvt_pk_bf16_f32 v79, v54, v55
    ds_write_b128 v17, v[76:79] offset:1024
    v_smfmac_f32_16x16x64_bf16 v[56:59], v[24:27], a[128:135], v172
    v_smfmac_f32_16x16x64_bf16 v[60:63], v[24:27], a[160:167], v172
    v_smfmac_f32_16x16x64_bf16 v[56:59], v[28:31], a[136:143], v172
    s_waitcnt lgkmcnt(0)
    s_barrier
    v_smfmac_f32_16x16x64_bf16 v[60:63], v[28:31], a[168:175], v172
    v_smfmac_f32_16x16x64_bf16 v[56:59], v[32:35], a[144:151], v172
    v_smfmac_f32_16x16x64_bf16 v[60:63], v[32:35], a[176:183], v172
    v_smfmac_f32_16x16x64_bf16 v[56:59], v[36:39], a[152:159], v172
    v_smfmac_f32_16x16x64_bf16 v[60:63], v[36:39], a[184:191], v172
    s_nop 4
    v_cvt_pk_bf16_f32 v80, v56, v57
    v_cvt_pk_bf16_f32 v81, v58, v59
    s_nop 0
    v_cvt_pk_bf16_f32 v82, v60, v61
    v_cvt_pk_bf16_f32 v83, v62, v63
    ds_write_b128 v17, v[80:83] offset:8192
    s_cmp_eq_u32 s15, 63
    s_waitcnt lgkmcnt(0)
    s_barrier
    ds_read_b128 v[96:99], v16 offset:8192
    ds_read_b128 v[100:103], v16 offset:10240
    ds_read_b128 v[108:111], v16 offset:14336
    v_mfma_f32_16x16x32_bf16 v[140:143], v[84:87], v[80:83], 0
    s_waitcnt lgkmcnt(2)
    v_mfma_f32_16x16x32_bf16 v[140:143], v[84:87], v[96:99], v[140:143]
    s_waitcnt lgkmcnt(1)
    v_mfma_f32_16x16x32_bf16 v[140:143], v[84:87], v[100:103], v[140:143]
    s_waitcnt lgkmcnt(0)
    v_mfma_f32_16x16x32_bf16 v[140:143], v[84:87], v[108:111], v[140:143]
    s_nop 7
    v_cvt_pk_bf16_f32 v168, v140, v141
    v_cvt_pk_bf16_f32 v169, v142, v143
    v_mov_b32 v170, v168
    v_mov_b32 v171, v169
    s_nop 0
    v_permlane16_swap_b32 v168, v170
    v_permlane16_swap_b32 v169, v171
    v_mov_b32 v247, s15
    s_cbranch_scc1 recur_slow_last2
    s_barrier
    s_nop 15
    s_mov_b32 s23, s25
g_68:
    buffer_load_dwordx4 v[24:27], v8, s[4:7], s16 offen offset:0 sc1
    buffer_load_dwordx4 v[28:31], v8, s[4:7], s16 offen offset:1024 sc1
    buffer_load_dwordx4 v[32:35], v8, s[4:7], s16 offen offset:2048 sc1
    buffer_load_dwordx4 v[36:39], v8, s[4:7], s16 offen offset:3072 sc1
    s_waitcnt vmcnt(0)
    v_max3_u32 v19, v24, v25, v26
    v_max3_u32 v19, v19, v27, v28
    v_max3_u32 v19, v19, v29, v30
    v_max3_u32 v19, v19, v31, v32
    v_max3_u32 v19, v19, v33, v34
    v_max3_u32 v19, v19, v35, v36
    v_max3_u32 v19, v19, v37, v38
    v_max_u32 v19, v19, v39
    v_cmp_eq_u32 vcc, -1, v19
    s_nop 0
    s_cbranch_vccz g_68k
    s_add_u32 s23, s23, 1
    s_cmp_lt_u32 s23, 200000
    s_cbranch_scc1 g_68
    s_mov_b32 s25, 200000
g_68k:
    v_smfmac_f32_16x16x64_bf16 v[64:67], v[24:27], a[192:199], v172
    v_smfmac_f32_16x16x64_bf16 v[68:71], v[24:27], a[224:231], v172
    v_smfmac_f32_16x16x64_bf16 v[64:67], v[28:31], a[200:207], v172
    v_smfmac_f32_16x16x64_bf16 v[68:71], v[28:31], a[232:239], v172
    v_smfmac_f32_16x16x64_bf16 v[64:67], v[32:35], a[208:215], v172
    v_smfmac_f32_16x16x64_bf16 v[68:71], v[32:35], a[240:247], v172
    v_smfmac_f32_16x16x64_bf16 v[64:67], v[36:39], a[216:223], v172
    v_smfmac_f32_16x16x64_bf16 v[68:71], v[36:39], a[248:255], v172
    s_nop 4
    v_cvt_pk_bf16_f32 v80, v64, v65
    v_cvt_pk_bf16_f32 v81, v66, v67
    s_nop 0
    v_cvt_pk_bf16_f32 v82, v68, v69
    v_cvt_pk_bf16_f32 v83, v70, v71
    ds_write_b128 v17, v[80:83] offset:9216
    s_waitcnt lgkmcnt(0)
    s_barrier
    s_nop 15
    s_nop 15
    s_nop 15
    s_nop 15
    buffer_store_dwordx4 v[168:171], v15, s[4:7], s20 offen sc1
    s_add_u32 s20, s20, 512
    s_add_u32 s21, s95, 1048576
    s_lshr_b32 s22, s21, 8
    s_and_b32 s22, s22, 8192
    s_xor_b32 s22, s22, s46
    s_add_u32 s21, s21, s22
    buffer_store_dwordx4 v[204:207], v9, s[4:7], s21 offen sc1
    s_add_u32 s21, s21, 262144
    buffer_store_dword v247, v246, s[4:7], 0 offen sc1
    v_mov_b32 v40, 0
    v_mov_b32 v41, 0
    v_mov_b32 v42, 0
    v_mov_b32 v43, 0
    v_mov_b32 v44, 0
    v_mov_b32 v45, 0
    v_mov_b32 v46, 0
    v_mov_b32 v47, 0
    v_mov_b32 v48, 0
    v_mov_b32 v49, 0
    v_mov_b32 v50, 0
    v_mov_b32 v51, 0
    v_mov_b32 v52, 0
    v_mov_b32 v53, 0
    v_mov_b32 v54, 0
    v_mov_b32 v55, 0
    v_mov_b32 v56, 0
    v_mov_b32 v57, 0
    v_mov_b32 v58, 0
    v_mov_b32 v59, 0
    v_mov_b32 v60, 0
    v_mov_b32 v61, 0
    v_mov_b32 v62, 0
    v_mov_b32 v63, 0
    v_mov_b32 v64, 0
    v_mov_b32 v65, 0
    v_mov_b32 v66, 0
    v_mov_b32 v67, 0
    v_mov_b32 v68, 0
    v_mov_b32 v69, 0
    v_mov_b32 v70, 0
    v_mov_b32 v71, 0
    s_mov_b32 s21, s16
    s_mov_b32 s16, s42
    s_mov_b32 s42, s43
    s_mov_b32 s43, s44
    s_mov_b32 s44, s21
    s_add_u32 s95, s95, 524288
    s_lshr_b32 s84, s95, 8
    s_and_b32 s84, s84, 8192
    s_xor_b32 s84, s84, s46
    s_add_u32 s84, s84, s95
    s_add_u32 s15, s15, 1
    s_barrier
    s_branch recur_slow_w2
recur_slow_last2:
    buffer_store_dwordx4 v[168:171], v15, s[4:7], s20 offen sc1
    s_waitcnt vmcnt(0)
    s_branch recur_end
.p2align 6
recur_slow_w3:
    s_nop 15
    s_mov_b32 s23, s25
g_69:
    buffer_load_dwordx4 v[24:27], v2, s[4:7], s16 offen offset:0 sc1
    buffer_load_dwordx4 v[28:31], v2, s[4:7], s16 offen offset:1024 sc1
    buffer_load_dwordx4 v[32:35], v2, s[4:7], s16 offen offset:2048 sc1
    buffer_load_dwordx4 v[36:39], v2, s[4:7], s16 offen offset:3072 sc1
    s_waitcnt vmcnt(0)
    v_max3_u32 v19, v24, v25, v26
    v_max3_u32 v19, v19, v27, v28
    v_max3_u32 v19, v19, v29, v30
    v_max3_u32 v19, v19, v31, v32
    v_max3_u32 v19, v19, v33, v34
    v_max3_u32 v19, v19, v35, v36
    v_max3_u32 v19, v19, v37, v38
    v_max_u32 v19, v19, v39
    v_cmp_eq_u32 vcc, -1, v19
    s_nop 0
    s_cbranch_vccz g_69k
    s_add_u32 s23, s23, 1
    s_cmp_lt_u32 s23, 200000
    s_cbranch_scc1 g_69
    s_mov_b32 s25, 200000
g_69k:
    v_smfmac_f32_16x16x64_bf16 v[40:43], v[24:27], a[0:7], v172
    v_smfmac_f32_16x16x64_bf16 v[44:47], v[24:27], a[64:71], v172
    v_smfmac_f32_16x16x64_bf16 v[48:51], v[24:27], a[32:39], v172
    v_smfmac_f32_16x16x64_bf16 v[52:55], v[24:27], a[96:103], v172
    v_smfmac_f32_16x16x64_bf16 v[40:43], v[28:31], a[8:15], v172
    v_smfmac_f32_16x16x64_bf16 v[44:47], v[28:31], a[72:79], v172
    v_smfmac_f32_16x16x64_bf16 v[48:51], v[28:31], a[40:47], v172
    v_smfmac_f32_16x16x64_bf16 v[52:55], v[28:31], a[104:111], v172
    v_smfmac_f32_16x16x64_bf16 v[40:43], v[32:35], a[16:23], v172
    v_smfmac_f32_16x16x64_bf16 v[44:47], v[32:35], a[80:87], v172
    v_smfmac_f32_16x16x64_bf16 v[48:51], v[32:35], a[48:55], v172
    v_smfmac_f32_16x16x64_bf16 v[52:55], v[32:35], a[112:119], v172
    v_smfmac_f32_16x16x64_bf16 v[40:43], v[36:39], a[24:31], v172
    v_smfmac_f32_16x16x64_bf16 v[44:47], v[36:39], a[88:95], v172
    v_smfmac_f32_16x16x64_bf16 v[48:51], v[36:39], a[56:63], v172
    v_smfmac_f32_16x16x64_bf16 v[52:55], v[36:39], a[120:127], v172
    v_cvt_pk_bf16_f32 v72, v40, v41
    v_cvt_pk_bf16_f32 v73, v42, v43
    v_cvt_pk_bf16_f32 v74, v44, v45
    v_cvt_pk_bf16_f32 v75, v46, v47
    ds_write_b128 v17, v[72:75] offset:0
    v_cvt_pk_bf16_f32 v76, v48, v49
    v_cvt_pk_bf16_f32 v77, v50, v51
    s_nop 0
    v_cvt_pk_bf16_f32 v78, v52, v53
    v_cvt_pk_bf16_f32 v79, v54, v55
    ds_write_b128 v17, v[76:79] offset:1024
    v_smfmac_f32_16x16x64_bf16 v[56:59], v[24:27], a[128:135], v172
    v_smfmac_f32_16x16x64_bf16 v[60:63], v[24:27], a[160:167], v172
    v_smfmac_f32_16x16x64_bf16 v[56:59], v[28:31], a[136:143], v172
    s_waitcnt lgkmcnt(0)
    s_barrier
    v_smfmac_f32_16x16x64_bf16 v[60:63], v[28:31], a[168:175], v172
    v_smfmac_f32_16x16x64_bf16 v[56:59], v[32:35], a[144:151], v172
    v_smfmac_f32_16x16x64_bf16 v[60:63], v[32:35], a[176:183], v172
    v_smfmac_f32_16x16x64_bf16 v[56:59], v[36:39], a[152:159], v172
    v_smfmac_f32_16x16x64_bf16 v[60:63], v[36:39], a[184:191], v172
    s_nop 4
    v_cvt_pk_bf16_f32 v80, v56, v57
    v_cvt_pk_bf16_f32 v81, v58, v59
    s_nop 0
    v_cvt_pk_bf16_f32 v82, v60, v61
    v_cvt_pk_bf16_f32 v83, v62, v63
    ds_write_b128 v17, v[80:83] offset:8192
    buffer_store_dwordx4 v[204:207], v3, s[4:7], s43 offen sc1
    buffer_store_dwordx4 v[204:207], v3, s[4:7], s43 offen offset:128 sc1
    buffer_store_dwordx4 v[204:207], v4, s[4:7], s43 offen sc1
    buffer_store_dwordx2 v[204:205], v7, s[4:7], s43 offen sc1
    buffer_store_dwordx2 v[204:205], v11, s[4:7], s43 offen sc1
    s_cmp_eq_u32 s15, 63
    s_waitcnt lgkmcnt(0)
    s_barrier
    s_cbranch_scc1 recur_end
    s_barrier
    s_nop 15
    s_mov_b32 s23, s25
g_70:
    buffer_load_dwordx4 v[24:27], v8, s[4:7], s16 offen offset:0 sc1
    buffer_load_dwordx4 v[28:31], v8, s[4:7], s16 offen offset:1024 sc1
    buffer_load_dwordx4 v[32:35], v8, s[4:7], s16 offen offset:2048 sc1
    buffer_load_dwordx4 v[36:39], v8, s[4:7], s16 offen offset:3072 sc1
    s_waitcnt vmcnt(0)
    v_max3_u32 v19, v24, v25, v26
    v_max3_u32 v19, v19, v27, v28
    v_max3_u32 v19, v19, v29, v30
    v_max3_u32 v19, v19, v31, v32
    v_max3_u32 v19, v19, v33, v34
    v_max3_u32 v19, v19, v35, v36
    v_max3_u32 v19, v19, v37, v38
    v_max_u32 v19, v19, v39
    v_cmp_eq_u32 vcc, -1, v19
    s_nop 0
    s_cbranch_vccz g_70k
    s_add_u32 s23, s23, 1
    s_cmp_lt_u32 s23, 200000
    s_cbranch_scc1 g_70
    s_mov_b32 s25, 200000
g_70k:
    v_smfmac_f32_16x16x64_bf16 v[64:67], v[24:27], a[192:199], v172
    v_smfmac_f32_16x16x64_bf16 v[68:71], v[24:27], a[224:231], v172
    v_smfmac_f32_16x16x64_bf16 v[64:67], v[28:31], a[200:207], v172
    v_smfmac_f32_16x16x64_bf16 v[68:71], v[28:31], a[232:239], v172
    v_smfmac_f32_16x16x64_bf16 v[64:67], v[32:35], a[208:215], v172
    v_smfmac_f32_16x16x64_bf16 v[68:71], v[32:35], a[240:247], v172
    v_smfmac_f32_16x16x64_bf16 v[64:67], v[36:39], a[216:223], v172
    v_smfmac_f32_16x16x64_bf16 v[68:71], v[36:39], a[248:255], v172
    s_nop 4
    v_cvt_pk_bf16_f32 v80, v64, v65
    v_cvt_pk_bf16_f32 v81, v66, v67
    s_nop 0
    v_cvt_pk_bf16_f32 v82, v68, v69
    v_cvt_pk_bf16_f32 v83, v70, v71
    s_nop 1
    v_mfma_f32_16x16x32_bf16 v[88:91], v[80:83], v[84:87], 0
    s_barrier
    ds_read_b128 v[96:99], v16 offset:9216
    ds_read_b128 v[100:103], v16 offset:11264
    ds_read_b128 v[104:107], v16 offset:13312
    s_waitcnt lgkmcnt(2)
    v_mfma_f32_16x16x32_bf16 v[88:91], v[96:99], v[84:87], v[88:91]
    s_waitcnt lgkmcnt(1)
    v_mfma_f32_16x16x32_bf16 v[88:91], v[100:103], v[84:87], v[88:91]
    s_waitcnt lgkmcnt(0)
    v_mfma_f32_16x16x32_bf16 v[88:91], v[104:107], v[84:87], v[88:91]
    s_nop 7
    buffer_store_dwordx4 v[88:91], v9, s[4:7], s84 offen sc1
    s_add_u32 s22, s84, 262144
    s_nop 15
    s_nop 15
    s_nop 15
    s_nop 15
    s_nop 15
    s_nop 15
    s_nop 15
    s_nop 15
    s_mov_b32 s23, s25
    buffer_load_dwordx4 v[96:99], v10, s[4:7], s84 offen sc1
    buffer_load_dwordx4 v[100:103], v23, s[4:7], s84 offen sc1
    buffer_load_dwordx4 v[104:107], v244, s[4:7], s84 offen sc1
    v_mov_b32 v40, 0
    v_mov_b32 v41, 0
    v_mov_b32 v42, 0
    v_mov_b32 v43, 0
    v_mov_b32 v44, 0
    v_mov_b32 v45, 0
    v_mov_b32 v46, 0
    v_mov_b32 v47, 0
    v_mov_b32 v48, 0
    v_mov_b32 v49, 0
    v_mov_b32 v50, 0
    v_mov_b32 v51, 0
    v_mov_b32 v52, 0
    v_mov_b32 v53, 0
    v_mov_b32 v54, 0
    v_mov_b32 v55, 0
    v_mov_b32 v56, 0
    v_mov_b32 v57, 0
    v_mov_b32 v58, 0
    v_mov_b32 v59, 0
    v_mov_b32 v60, 0
    v_mov_b32 v61, 0
    v_mov_b32 v62, 0
    v_mov_b32 v63, 0
    v_mov_b32 v64, 0
    v_mov_b32 v65, 0
    v_mov_b32 v66, 0
    v_mov_b32 v67, 0
    v_mov_b32 v68, 0
    v_mov_b32 v69, 0
    v_mov_b32 v70, 0
    v_mov_b32 v71, 0
pb_73:
    s_waitcnt vmcnt(2)
    v_pk_add_f32 v[120:121], v[88:89], v[96:97]
    v_pk_add_f32 v[122:123], v[90:91], v[98:99]
    s_waitcnt vmcnt(1)
    v_pk_add_f32 v[120:121], v[120:121], v[100:101]
    v_pk_add_f32 v[122:123], v[122:123], v[102:103]
    s_waitcnt vmcnt(0)
    v_pk_add_f32 v[120:121], v[120:121], v[104:105]
    v_pk_add_f32 v[122:123], v[122:123], v[106:107]
    v_cvt_pk_bf16_f32 v180, v120, v121
    v_pk_add_f32 v[124:125], v[120:121], v[122:123]
    v_cvt_pk_bf16_f32 v181, v122, v123
    v_cmpx_o_f32 vcc, v124, v125
    buffer_store_dwordx2 v[180:181], v11, s[4:7], s42 offen sc1
    s_cmp_eq_u64 vcc, -1
    s_mov_b64 exec, -1
    s_cbranch_scc0 pr_71
pg_72:
    s_barrier
    s_mov_b32 s21, s16
    s_mov_b32 s16, s42
    s_mov_b32 s42, s43
    s_mov_b32 s43, s44
    s_mov_b32 s44, s21
    s_add_u32 s95, s95, 524288
    s_lshr_b32 s84, s95, 8
    s_and_b32 s84, s84, 8192
    s_xor_b32 s84, s84, s46
    s_add_u32 s84, s84, s95
    s_add_u32 s15, s15, 1
    s_branch recur_slow_w3
pr_71:
    v_max3_u32 v19, v96, v97, v98
    v_max3_u32 v19, v19, v99, v100
    v_max3_u32 v19, v19, v101, v102
    v_max3_u32 v19, v19, v103, v104
    v_max3_u32 v19, v19, v105, v106
    v_max_u32 v19, v19, v107
    v_cmp_eq_u32 vcc, -1, v19
    s_nop 0
    s_cbranch_vccz pf_75
    buffer_load_dwordx4 v[96:99], v10, s[4:7], s84 offen sc1
    buffer_load_dwordx4 v[100:103], v23, s[4:7], s84 offen sc1
    buffer_load_dwordx4 v[104:107], v244, s[4:7], s84 offen sc1
    s_add_u32 s23, s23, 1
    s_cmp_lt_u32 s23, 200000
    s_cbranch_scc1 pb_73
    s_mov_b32 s25, 200000
pf_75:
    buffer_store_dwordx2 v[180:181], v11, s[4:7], s42 offen sc1
    s_branch pg_72
recur_end:
    s_barrier
    v_mov_b32 v247, 64
    buffer_store_dword v247, v246, s[4:7], 0 offen sc1
    s_endpgm
.section .rodata,"a"
.p2align 6
.amdhsa_kernel concat_heads__spectral_gfnet__memory_aug_recurrent_mem_tr__prompt_kernel
  .amdhsa_next_free_vgpr 512
  .amdhsa_next_free_sgpr 102
  .amdhsa_accum_offset 256
  .amdhsa_group_segment_fixed_size 0
  .amdhsa_kernarg_size 104
  .amdhsa_user_sgpr_count 2
  .amdhsa_user_sgpr_kernarg_segment_ptr 1
  .amdhsa_system_sgpr_workgroup_id_x 1
  .amdhsa_float_denorm_mode_32 3
.end_amdhsa_kernel
```

```asm
; @launch kernel=concat_heads__spectral_gfnet__memory_aug_recurrent_mem_tr__prompt_kernel grid=(256,1,1) block=(256,1,1) lds=163840
.amdgcn_target "amdgcn-amd-amdhsa--gfx950"
.text
.globl concat_heads__spectral_gfnet__memory_aug_recurrent_mem_tr__prompt_kernel
.p2align 8
.type concat_heads__spectral_gfnet__memory_aug_recurrent_mem_tr__prompt_kernel,@function
concat_heads__spectral_gfnet__memory_aug_recurrent_mem_tr__prompt_kernel:
    s_cmp_ge_u32 s2, 256
    s_cbranch_scc1 W_end
    s_load_dwordx2 s[100:101], s[0:1], 88
    s_mov_b32 s97, s2
    s_mov_b32 s98, 0
    s_getreg_b32 s3, hwreg(HW_REG_XCC_ID, 0, 3)
role_start:
    s_andn2_b32 s2, s97, 7
    s_or_b32 s2, s2, s3
    s_bitcmp1_b32 s3, 2
    s_cbranch_scc0 R_entry
    s_cmp_ge_u32 s2, 256
    s_cbranch_scc1 W_end
    s_load_dwordx2 s[4:5], s[0:1], 96
    v_lshrrev_b32 v5, 6, v0
    v_and_b32 v1, 63, v0
    v_readfirstlane_b32 s16, v5
    s_mov_b32 s6, 268435456
    s_mov_b32 s7, 0x20000
    s_waitcnt lgkmcnt(0)
    s_lshr_b32 s90, s2, 6
    s_bfe_u32 s91, s2, 0x30003
    s_lshl_b32 s91, s91, 2
    s_and_b32 s17, s3, 3
    s_add_u32 s91, s91, s17
    s_lshl_b32 s93, s17, 3
    s_lshr_b32 s17, s91, 2
    s_add_u32 s93, s93, s17
    s_mov_b32 s92, 0
    s_lshl_b32 s17, s93, 2
    s_add_u32 s17, s17, s16
    s_lshl_b32 s18, s90, 7
    s_add_u32 s18, s18, s17
    s_lshl_b32 s18, s18, 7
    s_add_u32 s18, s18, 100663296
    s_lshl_b32 s20, s17, 7
    s_add_u32 s20, s20, 100728832
    s_cmp_eq_u32 s90, 3
    s_cselect_b32 s18, s20, s18
    s_cselect_b64 exec, 7, 1
    v_mov_b32 v5, s18
    s_and_b32 s18, s17, 31
    s_lshl_b32 s18, s18, 2
    s_lshr_b32 s20, s93, 3
    s_add_u32 s18, s18, s20
    s_lshl_b32 s18, s18, 7
    s_add_u32 s18, s18, 100745216
    v_writelane_b32 v5, s18, 1
    s_lshl_b32 s18, s17, 7
    s_add_u32 s18, s18, 100761600
    v_writelane_b32 v5, s18, 2
    v_mov_b32 v6, 0
    buffer_store_dword v6, v5, s[4:7], 0 offen sc1
    s_mov_b64 exec, -1
    s_cmp_eq_u32 s90, 3
    s_cbranch_scc1 W_F
    s_load_dwordx2 s[8:9], s[0:1], 24
    s_mov_b32 s10, 4194304
    s_mov_b32 s11, 0x20000
    s_lshr_b32 s17, s2, 3
    s_lshl_b32 s17, s17, 15
    v_lshlrev_b32 v5, 7, v0
    s_waitcnt lgkmcnt(0)
    buffer_load_dword v254, v5, s[8:11], s17 offen
    s_cmp_lg_u32 s90, 0
    s_cbranch_scc1 W_P
    s_waitcnt vmcnt(0)
    s_barrier
    s_or_b32 s17, s16, s98
    s_cmp_lg_u32 s17, 0
    s_cbranch_scc1 vote_1
    s_lshl_b32 s17, s91, 14
    s_add_u32 s17, s17, 239075328
    v_lshlrev_b32 v5, 2, v1
    v_add_u32 v5, s17, v5
    v_add_u32 v6, 8192, v5
    s_mov_b32 s20, -1
    s_mov_b32 s21, -1
    s_mov_b64 exec, 1
    buffer_store_dword v1, v5, s[4:7], 0 offen sc1
    s_mov_b32 s22, 0
vp_2:
    s_add_u32 s22, s22, 1
    s_getreg_b32 s18, hwreg(HW_REG_IB_STS, 0, 4)
    s_cmp_lt_u32 s22, 2048
    s_cselect_b32 s18, s18, 0
    s_cmp_lg_u32 s18, 0
    s_cbranch_scc1 vp_2
    s_min_u32 s20, s20, s22
    buffer_store_dword v1, v6, s[4:7], 0 offen sc1
    s_mov_b32 s22, 0
vp_3:
    s_add_u32 s22, s22, 1
    s_getreg_b32 s18, hwreg(HW_REG_IB_STS, 0, 4)
    s_cmp_lt_u32 s22, 2048
    s_cselect_b32 s18, s18, 0
    s_cmp_lg_u32 s18, 0
    s_cbranch_scc1 vp_3
    s_min_u32 s21, s21, s22
    buffer_store_dword v1, v5, s[4:7], 0 offen sc1
    s_mov_b32 s22, 0
vp_4:
    s_add_u32 s22, s22, 1
    s_getreg_b32 s18, hwreg(HW_REG_IB_STS, 0, 4)
    s_cmp_lt_u32 s22, 2048
    s_cselect_b32 s18, s18, 0
    s_cmp_lg_u32 s18, 0
    s_cbranch_scc1 vp_4
    s_min_u32 s20, s20, s22
    buffer_store_dword v1, v6, s[4:7], 0 offen sc1
    s_mov_b32 s22, 0
vp_5:
    s_add_u32 s22, s22, 1
    s_getreg_b32 s18, hwreg(HW_REG_IB_STS, 0, 4)
    s_cmp_lt_u32 s22, 2048
    s_cselect_b32 s18, s18, 0
    s_cmp_lg_u32 s18, 0
    s_cbranch_scc1 vp_5
    s_min_u32 s21, s21, s22
    buffer_store_dword v1, v5, s[4:7], 0 offen sc1
    s_mov_b32 s22, 0
vp_6:
    s_add_u32 s22, s22, 1
    s_getreg_b32 s18, hwreg(HW_REG_IB_STS, 0, 4)
    s_cmp_lt_u32 s22, 2048
    s_cselect_b32 s18, s18, 0
    s_cmp_lg_u32 s18, 0
    s_cbranch_scc1 vp_6
    s_min_u32 s20, s20, s22
    buffer_store_dword v1, v6, s[4:7], 0 offen sc1
    s_mov_b32 s22, 0
vp_7:
    s_add_u32 s22, s22, 1
    s_getreg_b32 s18, hwreg(HW_REG_IB_STS, 0, 4)
    s_cmp_lt_u32 s22, 2048
    s_cselect_b32 s18, s18, 0
    s_cmp_lg_u32 s18, 0
    s_cbranch_scc1 vp_7
    s_min_u32 s21, s21, s22
    buffer_store_dword v1, v5, s[4:7], 0 offen sc1
    s_mov_b32 s22, 0
vp_8:
    s_add_u32 s22, s22, 1
    s_getreg_b32 s18, hwreg(HW_REG_IB_STS, 0, 4)
    s_cmp_lt_u32 s22, 2048
    s_cselect_b32 s18, s18, 0
    s_cmp_lg_u32 s18, 0
    s_cbranch_scc1 vp_8
    s_min_u32 s20, s20, s22
    buffer_store_dword v1, v6, s[4:7], 0 offen sc1
    s_mov_b32 s22, 0
vp_9:
    s_add_u32 s22, s22, 1
    s_getreg_b32 s18, hwreg(HW_REG_IB_STS, 0, 4)
    s_cmp_lt_u32 s22, 2048
    s_cselect_b32 s18, s18, 0
    s_cmp_lg_u32 s18, 0
    s_cbranch_scc1 vp_9
    s_min_u32 s21, s21, s22
    s_and_b32 s17, s97, 3
    s_lshl_b32 s17, s17, 3
    s_lshl_b32 s17, 0x40, s17
    s_cmp_lt_u32 s20, s21
    s_cselect_b32 s17, s17, 0
    s_andn2_b32 s18, s97, 3
    v_mov_b32 v5, s18
    v_mov_b32 v6, s17
    global_atomic_add v5, v6, s[100:101] sc1
    s_mov_b64 exec, -1
    s_waitcnt vmcnt(0)
vote_1:
    s_waitcnt vmcnt(0)
    s_barrier
    s_cmp_lg_u32 s16, 0
    s_cbranch_scc1 reg_10
    s_and_b32 s17, s2, 3
    s_lshl_b32 s17, s17, 3
    s_lshl_b32 s18, s98, 2
    s_add_u32 s17, s17, s18
    s_lshl_b32 s17, 1, s17
    s_andn2_b32 s18, s2, 3
    v_mov_b32 v5, s18
    v_mov_b32 v6, s17
    s_mov_b64 exec, 1
    global_atomic_add v5, v6, s[100:101] sc1
    s_mov_b64 exec, -1
reg_10:
W_P:
    s_load_dwordx2 s[12:13], s[0:1], 40
    s_load_dwordx2 s[28:29], s[0:1], 48
    s_load_dwordx2 s[30:31], s[0:1], 56
    s_load_dwordx2 s[8:9], s[0:1], 24
    s_mov_b32 s10, 4194304
    s_mov_b32 s11, 0x20000
    s_mov_b32 s14, 8388608
    s_mov_b32 s15, 0x20000
    s_waitcnt lgkmcnt(0)
    s_cmp_eq_u32 s90, 1
    s_cselect_b64 s[12:13], s[28:29], s[12:13]
    s_cmp_eq_u32 s90, 2
    s_cselect_b64 s[12:13], s[30:31], s[12:13]
    s_lshl_b32 s28, s93, 2
    s_add_u32 s28, s28, s16
    s_lshl_b32 s20, s28, 6
    v_lshrrev_b32 v5, 2, v1
    v_and_b32 v6, 3, v1
    v_lshlrev_b32 v8, 4, v6
    v_lshl_add_u32 v7, v5, 13, v8
    s_mul_i32 s19, s16, 40960
    s_and_b32 s17, s93, 3
    s_lshl_b32 s17, s17, 8
    v_add_lshl_u32 v2, v0, s17, 13
    s_andn2_b32 s17, s93, 3
    s_lshl_b32 s17, s17, 8
    buffer_load_dword v253, v2, s[12:15], s17 offen offset:384
    s_add_u32 m0, s19, 0
    s_nop 0
    buffer_load_dwordx4 v7, s[12:15], s20 offen lds
    s_add_u32 s20, s20, 131072
    s_add_u32 m0, s19, 1024
    s_nop 0
    buffer_load_dwordx4 v7, s[12:15], s20 offen lds
    s_add_u32 s20, s20, 131072
    s_add_u32 m0, s19, 2048
    s_nop 0
    buffer_load_dwordx4 v7, s[12:15], s20 offen lds
    s_add_u32 s20, s20, 131072
    s_add_u32 m0, s19, 3072
    s_nop 0
    buffer_load_dwordx4 v7, s[12:15], s20 offen lds
    s_add_u32 s20, s20, 131072
    v_bfe_u32 v5, v1, 2, 2
    v_lshrrev_b32 v6, 4, v1
    v_lshl_add_u32 v5, v6, 3, v5
    v_lshl_add_u32 v8, v5, 6, v8
    v_add_u32 v8, s19, v8
    s_cmp_eq_u32 s90, 0
    s_cbranch_scc1 nq_11
    s_waitcnt vmcnt(6)
    s_barrier
    s_cmp_lg_u32 s16, 0
    s_cbranch_scc1 reg_12
    s_and_b32 s17, s2, 3
    s_lshl_b32 s17, s17, 3
    s_lshl_b32 s18, s98, 2
    s_add_u32 s17, s17, s18
    s_lshl_b32 s17, 1, s17
    s_andn2_b32 s18, s2, 3
    v_mov_b32 v5, s18
    v_mov_b32 v6, s17
    s_mov_b64 exec, 1
    global_atomic_add v5, v6, s[100:101] sc1
    s_mov_b64 exec, -1
reg_12:
    s_barrier
nq_11:
    s_add_u32 m0, s19, 4096
    s_nop 0
    buffer_load_dwordx4 v7, s[12:15], s20 offen lds
    s_add_u32 s20, s20, 131072
    s_add_u32 m0, s19, 5120
    s_nop 0
    buffer_load_dwordx4 v7, s[12:15], s20 offen lds
    s_add_u32 s20, s20, 131072
    s_add_u32 m0, s19, 6144
    s_nop 0
    buffer_load_dwordx4 v7, s[12:15], s20 offen lds
    s_add_u32 s20, s20, 131072
    s_add_u32 m0, s19, 7168
    s_nop 0
    buffer_load_dwordx4 v7, s[12:15], s20 offen lds
    s_add_u32 s20, s20, 131072
    s_add_u32 m0, s19, 8192
    s_nop 0
    buffer_load_dwordx4 v7, s[12:15], s20 offen lds
    s_add_u32 s20, s20, 131072
    s_add_u32 m0, s19, 9216
    s_nop 0
    buffer_load_dwordx4 v7, s[12:15], s20 offen lds
    s_add_u32 s20, s20, 131072
    s_add_u32 m0, s19, 10240
    s_nop 0
    buffer_load_dwordx4 v7, s[12:15], s20 offen lds
    s_add_u32 s20, s20, 131072
    s_add_u32 m0, s19, 11264
    s_nop 0
    buffer_load_dwordx4 v7, s[12:15], s20 offen lds
    s_add_u32 s20, s20, 131072
    s_add_u32 m0, s19, 12288
    s_nop 0
    buffer_load_dwordx4 v7, s[12:15], s20 offen lds
    s_add_u32 s20, s20, 131072
    s_add_u32 m0, s19, 13312
    s_nop 0
    buffer_load_dwordx4 v7, s[12:15], s20 offen lds
    s_add_u32 s20, s20, 131072
    s_add_u32 m0, s19, 14336
    s_nop 0
    buffer_load_dwordx4 v7, s[12:15], s20 offen lds
    s_add_u32 s20, s20, 131072
    s_add_u32 m0, s19, 15360
    s_nop 0
    buffer_load_dwordx4 v7, s[12:15], s20 offen lds
    s_add_u32 s20, s20, 131072
    s_add_u32 m0, s19, 16384
    s_nop 0
    buffer_load_dwordx4 v7, s[12:15], s20 offen lds
    s_add_u32 s20, s20, 131072
    s_add_u32 m0, s19, 17408
    s_nop 0
    buffer_load_dwordx4 v7, s[12:15], s20 offen lds
    s_add_u32 s20, s20, 131072
    s_add_u32 m0, s19, 18432
    s_nop 0
    buffer_load_dwordx4 v7, s[12:15], s20 offen lds
    s_add_u32 s20, s20, 131072
    s_add_u32 m0, s19, 19456
    s_nop 0
    buffer_load_dwordx4 v7, s[12:15], s20 offen lds
    s_add_u32 s20, s20, 131072
    s_add_u32 m0, s19, 20480
    s_nop 0
    buffer_load_dwordx4 v7, s[12:15], s20 offen lds
    s_add_u32 s20, s20, 131072
    s_add_u32 m0, s19, 21504
    s_nop 0
    buffer_load_dwordx4 v7, s[12:15], s20 offen lds
    s_add_u32 s20, s20, 131072
    s_add_u32 m0, s19, 22528
    s_nop 0
    buffer_load_dwordx4 v7, s[12:15], s20 offen lds
    s_add_u32 s20, s20, 131072
    s_add_u32 m0, s19, 23552
    s_nop 0
    buffer_load_dwordx4 v7, s[12:15], s20 offen lds
    s_add_u32 s20, s20, 131072
    s_add_u32 m0, s19, 24576
    s_nop 0
    buffer_load_dwordx4 v7, s[12:15], s20 offen lds
    s_add_u32 s20, s20, 131072
    s_add_u32 m0, s19, 25600
    s_nop 0
    buffer_load_dwordx4 v7, s[12:15], s20 offen lds
    s_add_u32 s20, s20, 131072
    s_add_u32 m0, s19, 26624
    s_nop 0
    buffer_load_dwordx4 v7, s[12:15], s20 offen lds
    s_add_u32 s20, s20, 131072
    s_add_u32 m0, s19, 27648
    s_nop 0
    buffer_load_dwordx4 v7, s[12:15], s20 offen lds
    s_add_u32 s20, s20, 131072
    s_add_u32 m0, s19, 28672
    s_nop 0
    buffer_load_dwordx4 v7, s[12:15], s20 offen lds
    s_add_u32 s20, s20, 131072
    s_add_u32 m0, s19, 29696
    s_nop 0
    buffer_load_dwordx4 v7, s[12:15], s20 offen lds
    s_add_u32 s20, s20, 131072
    s_add_u32 m0, s19, 30720
    s_nop 0
    buffer_load_dwordx4 v7, s[12:15], s20 offen lds
    s_add_u32 s20, s20, 131072
    s_add_u32 m0, s19, 31744
    s_nop 0
    buffer_load_dwordx4 v7, s[12:15], s20 offen lds
    s_add_u32 s20, s20, 131072
    s_add_u32 m0, s19, 32768
    s_nop 0
    buffer_load_dwordx4 v7, s[12:15], s20 offen lds
    s_add_u32 s20, s20, 131072
    s_add_u32 m0, s19, 33792
    s_nop 0
    buffer_load_dwordx4 v7, s[12:15], s20 offen lds
    s_add_u32 s20, s20, 131072
    s_add_u32 m0, s19, 34816
    s_nop 0
    buffer_load_dwordx4 v7, s[12:15], s20 offen lds
    s_add_u32 s20, s20, 131072
    s_add_u32 m0, s19, 35840
    s_nop 0
    buffer_load_dwordx4 v7, s[12:15], s20 offen lds
    s_add_u32 s20, s20, 131072
    s_add_u32 m0, s19, 36864
    s_nop 0
    buffer_load_dwordx4 v7, s[12:15], s20 offen lds
    s_add_u32 s20, s20, 131072
    s_add_u32 m0, s19, 37888
    s_nop 0
    buffer_load_dwordx4 v7, s[12:15], s20 offen lds
    s_add_u32 s20, s20, 131072
    s_add_u32 m0, s19, 38912
    s_nop 0
    buffer_load_dwordx4 v7, s[12:15], s20 offen lds
    s_add_u32 s20, s20, 131072
    s_add_u32 m0, s19, 39936
    s_nop 0
    buffer_load_dwordx4 v7, s[12:15], s20 offen lds
    s_add_u32 s20, s20, 131072
    s_waitcnt vmcnt(38)
    ds_read_b64_tr_b16 a[0:1], v8 offset:0
    ds_read_b64_tr_b16 a[2:3], v8 offset:256
    ds_read_b64_tr_b16 a[4:5], v8 offset:8
    ds_read_b64_tr_b16 a[6:7], v8 offset:264
    s_waitcnt vmcnt(36)
    ds_read_b64_tr_b16 a[8:9], v8 offset:2048
    ds_read_b64_tr_b16 a[10:11], v8 offset:2304
    ds_read_b64_tr_b16 a[12:13], v8 offset:2056
    ds_read_b64_tr_b16 a[14:15], v8 offset:2312
    s_waitcnt lgkmcnt(4)
    s_add_u32 m0, s19, 0
    s_nop 0
    buffer_load_dwordx4 v7, s[12:15], s20 offen lds
    s_add_u32 s20, s20, 131072
    s_add_u32 m0, s19, 1024
    s_nop 0
    buffer_load_dwordx4 v7, s[12:15], s20 offen lds
    s_add_u32 s20, s20, 131072
    s_waitcnt vmcnt(36)
    ds_read_b64_tr_b16 a[16:17], v8 offset:4096
    ds_read_b64_tr_b16 a[18:19], v8 offset:4352
    ds_read_b64_tr_b16 a[20:21], v8 offset:4104
    ds_read_b64_tr_b16 a[22:23], v8 offset:4360
    s_waitcnt lgkmcnt(4)
    s_add_u32 m0, s19, 2048
    s_nop 0
    buffer_load_dwordx4 v7, s[12:15], s20 offen lds
    s_add_u32 s20, s20, 131072
    s_add_u32 m0, s19, 3072
    s_nop 0
    buffer_load_dwordx4 v7, s[12:15], s20 offen lds
    s_add_u32 s20, s20, 131072
    s_waitcnt vmcnt(36)
    ds_read_b64_tr_b16 a[24:25], v8 offset:6144
    ds_read_b64_tr_b16 a[26:27], v8 offset:6400
    ds_read_b64_tr_b16 a[28:29], v8 offset:6152
    ds_read_b64_tr_b16 a[30:31], v8 offset:6408
    s_waitcnt lgkmcnt(4)
    s_add_u32 m0, s19, 4096
    s_nop 0
    buffer_load_dwordx4 v7, s[12:15], s20 offen lds
    s_add_u32 s20, s20, 131072
    s_add_u32 m0, s19, 5120
    s_nop 0
    buffer_load_dwordx4 v7, s[12:15], s20 offen lds
    s_add_u32 s20, s20, 131072
    s_waitcnt vmcnt(36)
    ds_read_b64_tr_b16 a[32:33], v8 offset:8192
    ds_read_b64_tr_b16 a[34:35], v8 offset:8448
    ds_read_b64_tr_b16 a[36:37], v8 offset:8200
    ds_read_b64_tr_b16 a[38:39], v8 offset:8456
    s_waitcnt lgkmcnt(4)
    s_add_u32 m0, s19, 6144
    s_nop 0
    buffer_load_dwordx4 v7, s[12:15], s20 offen lds
    s_add_u32 s20, s20, 131072
    s_add_u32 m0, s19, 7168
    s_nop 0
    buffer_load_dwordx4 v7, s[12:15], s20 offen lds
    s_add_u32 s20, s20, 131072
    s_waitcnt vmcnt(36)
    ds_read_b64_tr_b16 a[40:41], v8 offset:10240
    ds_read_b64_tr_b16 a[42:43], v8 offset:10496
    ds_read_b64_tr_b16 a[44:45], v8 offset:10248
    ds_read_b64_tr_b16 a[46:47], v8 offset:10504
    s_waitcnt lgkmcnt(4)
    s_add_u32 m0, s19, 8192
    s_nop 0
    buffer_load_dwordx4 v7, s[12:15], s20 offen lds
    s_add_u32 s20, s20, 131072
    s_add_u32 m0, s19, 9216
    s_nop 0
    buffer_load_dwordx4 v7, s[12:15], s20 offen lds
    s_add_u32 s20, s20, 131072
    s_waitcnt vmcnt(36)
    ds_read_b64_tr_b16 a[48:49], v8 offset:12288
    ds_read_b64_tr_b16 a[50:51], v8 offset:12544
    ds_read_b64_tr_b16 a[52:53], v8 offset:12296
    ds_read_b64_tr_b16 a[54:55], v8 offset:12552
    s_waitcnt lgkmcnt(4)
    s_add_u32 m0, s19, 10240
    s_nop 0
    buffer_load_dwordx4 v7, s[12:15], s20 offen lds
    s_add_u32 s20, s20, 131072
    s_add_u32 m0, s19, 11264
    s_nop 0
    buffer_load_dwordx4 v7, s[12:15], s20 offen lds
    s_add_u32 s20, s20, 131072
    s_waitcnt vmcnt(36)
    ds_read_b64_tr_b16 a[56:57], v8 offset:14336
    ds_read_b64_tr_b16 a[58:59], v8 offset:14592
    ds_read_b64_tr_b16 a[60:61], v8 offset:14344
    ds_read_b64_tr_b16 a[62:63], v8 offset:14600
    s_waitcnt lgkmcnt(4)
    s_add_u32 m0, s19, 12288
    s_nop 0
    buffer_load_dwordx4 v7, s[12:15], s20 offen lds
    s_add_u32 s20, s20, 131072
    s_add_u32 m0, s19, 13312
    s_nop 0
    buffer_load_dwordx4 v7, s[12:15], s20 offen lds
    s_add_u32 s20, s20, 131072
    s_waitcnt vmcnt(36)
    ds_read_b64_tr_b16 a[64:65], v8 offset:16384
    ds_read_b64_tr_b16 a[66:67], v8 offset:16640
    ds_read_b64_tr_b16 a[68:69], v8 offset:16392
    ds_read_b64_tr_b16 a[70:71], v8 offset:16648
    s_waitcnt lgkmcnt(4)
    s_add_u32 m0, s19, 14336
    s_nop 0
    buffer_load_dwordx4 v7, s[12:15], s20 offen lds
    s_add_u32 s20, s20, 131072
    s_add_u32 m0, s19, 15360
    s_nop 0
    buffer_load_dwordx4 v7, s[12:15], s20 offen lds
    s_add_u32 s20, s20, 131072
    s_waitcnt vmcnt(36)
    ds_read_b64_tr_b16 a[72:73], v8 offset:18432
    ds_read_b64_tr_b16 a[74:75], v8 offset:18688
    ds_read_b64_tr_b16 a[76:77], v8 offset:18440
    ds_read_b64_tr_b16 a[78:79], v8 offset:18696
    s_waitcnt lgkmcnt(4)
    s_add_u32 m0, s19, 16384
    s_nop 0
    buffer_load_dwordx4 v7, s[12:15], s20 offen lds
    s_add_u32 s20, s20, 131072
    s_add_u32 m0, s19, 17408
    s_nop 0
    buffer_load_dwordx4 v7, s[12:15], s20 offen lds
    s_add_u32 s20, s20, 131072
    s_waitcnt vmcnt(36)
    ds_read_b64_tr_b16 a[80:81], v8 offset:20480
    ds_read_b64_tr_b16 a[82:83], v8 offset:20736
    ds_read_b64_tr_b16 a[84:85], v8 offset:20488
    ds_read_b64_tr_b16 a[86:87], v8 offset:20744
    s_waitcnt lgkmcnt(4)
    s_add_u32 m0, s19, 18432
    s_nop 0
    buffer_load_dwordx4 v7, s[12:15], s20 offen lds
    s_add_u32 s20, s20, 131072
    s_add_u32 m0, s19, 19456
    s_nop 0
    buffer_load_dwordx4 v7, s[12:15], s20 offen lds
    s_add_u32 s20, s20, 131072
    s_waitcnt vmcnt(36)
    ds_read_b64_tr_b16 a[88:89], v8 offset:22528
    ds_read_b64_tr_b16 a[90:91], v8 offset:22784
    ds_read_b64_tr_b16 a[92:93], v8 offset:22536
    ds_read_b64_tr_b16 a[94:95], v8 offset:22792
    s_waitcnt lgkmcnt(4)
    s_add_u32 m0, s19, 20480
    s_nop 0
    buffer_load_dwordx4 v7, s[12:15], s20 offen lds
    s_add_u32 s20, s20, 131072
    s_add_u32 m0, s19, 21504
    s_nop 0
    buffer_load_dwordx4 v7, s[12:15], s20 offen lds
    s_add_u32 s20, s20, 131072
    s_waitcnt vmcnt(36)
    ds_read_b64_tr_b16 a[96:97], v8 offset:24576
    ds_read_b64_tr_b16 a[98:99], v8 offset:24832
    ds_read_b64_tr_b16 a[100:101], v8 offset:24584
    ds_read_b64_tr_b16 a[102:103], v8 offset:24840
    s_waitcnt lgkmcnt(4)
    s_add_u32 m0, s19, 22528
    s_nop 0
    buffer_load_dwordx4 v7, s[12:15], s20 offen lds
    s_add_u32 s20, s20, 131072
    s_add_u32 m0, s19, 23552
    s_nop 0
    buffer_load_dwordx4 v7, s[12:15], s20 offen lds
    s_add_u32 s20, s20, 131072
    s_waitcnt vmcnt(36)
    ds_read_b64_tr_b16 a[104:105], v8 offset:26624
    ds_read_b64_tr_b16 a[106:107], v8 offset:26880
    ds_read_b64_tr_b16 a[108:109], v8 offset:26632
    ds_read_b64_tr_b16 a[110:111], v8 offset:26888
    s_waitcnt lgkmcnt(7)
    s_waitcnt vmcnt(34)
    ds_read_b64_tr_b16 a[112:113], v8 offset:28672
    ds_read_b64_tr_b16 a[114:115], v8 offset:28928
    ds_read_b64_tr_b16 a[116:117], v8 offset:28680
    ds_read_b64_tr_b16 a[118:119], v8 offset:28936
    s_waitcnt vmcnt(32)
    ds_read_b64_tr_b16 a[120:121], v8 offset:30720
    ds_read_b64_tr_b16 a[122:123], v8 offset:30976
    ds_read_b64_tr_b16 a[124:125], v8 offset:30728
    ds_read_b64_tr_b16 a[126:127], v8 offset:30984
    s_waitcnt lgkmcnt(7)
    s_waitcnt vmcnt(30)
    ds_read_b64_tr_b16 a[128:129], v8 offset:32768
    ds_read_b64_tr_b16 a[130:131], v8 offset:33024
    ds_read_b64_tr_b16 a[132:133], v8 offset:32776
    ds_read_b64_tr_b16 a[134:135], v8 offset:33032
    s_waitcnt vmcnt(28)
    ds_read_b64_tr_b16 a[136:137], v8 offset:34816
    ds_read_b64_tr_b16 a[138:139], v8 offset:35072
    ds_read_b64_tr_b16 a[140:141], v8 offset:34824
    ds_read_b64_tr_b16 a[142:143], v8 offset:35080
    s_waitcnt lgkmcnt(7)
    s_waitcnt vmcnt(26)
    ds_read_b64_tr_b16 a[144:145], v8 offset:36864
    ds_read_b64_tr_b16 a[146:147], v8 offset:37120
    ds_read_b64_tr_b16 a[148:149], v8 offset:36872
    ds_read_b64_tr_b16 a[150:151], v8 offset:37128
    s_waitcnt vmcnt(24)
    ds_read_b64_tr_b16 a[152:153], v8 offset:38912
    ds_read_b64_tr_b16 a[154:155], v8 offset:39168
    ds_read_b64_tr_b16 a[156:157], v8 offset:38920
    ds_read_b64_tr_b16 a[158:159], v8 offset:39176
    s_waitcnt lgkmcnt(7)
    s_waitcnt vmcnt(22)
    ds_read_b64_tr_b16 a[160:161], v8 offset:0
    ds_read_b64_tr_b16 a[162:163], v8 offset:256
    ds_read_b64_tr_b16 a[164:165], v8 offset:8
    ds_read_b64_tr_b16 a[166:167], v8 offset:264
    s_waitcnt vmcnt(20)
    ds_read_b64_tr_b16 a[168:169], v8 offset:2048
    ds_read_b64_tr_b16 a[170:171], v8 offset:2304
    ds_read_b64_tr_b16 a[172:173], v8 offset:2056
    ds_read_b64_tr_b16 a[174:175], v8 offset:2312
    s_waitcnt lgkmcnt(7)
    s_waitcnt vmcnt(18)
    ds_read_b64_tr_b16 a[176:177], v8 offset:4096
    ds_read_b64_tr_b16 a[178:179], v8 offset:4352
    ds_read_b64_tr_b16 a[180:181], v8 offset:4104
    ds_read_b64_tr_b16 a[182:183], v8 offset:4360
    s_waitcnt vmcnt(16)
    ds_read_b64_tr_b16 a[184:185], v8 offset:6144
    ds_read_b64_tr_b16 a[186:187], v8 offset:6400
    ds_read_b64_tr_b16 a[188:189], v8 offset:6152
    ds_read_b64_tr_b16 a[190:191], v8 offset:6408
    s_waitcnt lgkmcnt(7)
    s_waitcnt vmcnt(14)
    ds_read_b64_tr_b16 a[192:193], v8 offset:8192
    ds_read_b64_tr_b16 a[194:195], v8 offset:8448
    ds_read_b64_tr_b16 a[196:197], v8 offset:8200
    ds_read_b64_tr_b16 a[198:199], v8 offset:8456
    s_waitcnt vmcnt(12)
    ds_read_b64_tr_b16 a[200:201], v8 offset:10240
    ds_read_b64_tr_b16 a[202:203], v8 offset:10496
    ds_read_b64_tr_b16 a[204:205], v8 offset:10248
    ds_read_b64_tr_b16 a[206:207], v8 offset:10504
    s_waitcnt lgkmcnt(7)
    s_waitcnt vmcnt(10)
    ds_read_b64_tr_b16 a[208:209], v8 offset:12288
    ds_read_b64_tr_b16 a[210:211], v8 offset:12544
    ds_read_b64_tr_b16 a[212:213], v8 offset:12296
    ds_read_b64_tr_b16 a[214:215], v8 offset:12552
    s_waitcnt vmcnt(8)
    ds_read_b64_tr_b16 a[216:217], v8 offset:14336
    ds_read_b64_tr_b16 a[218:219], v8 offset:14592
    ds_read_b64_tr_b16 a[220:221], v8 offset:14344
    ds_read_b64_tr_b16 a[222:223], v8 offset:14600
    s_waitcnt lgkmcnt(7)
    s_waitcnt vmcnt(6)
    ds_read_b64_tr_b16 a[224:225], v8 offset:16384
    ds_read_b64_tr_b16 a[226:227], v8 offset:16640
    ds_read_b64_tr_b16 a[228:229], v8 offset:16392
    ds_read_b64_tr_b16 a[230:231], v8 offset:16648
    s_waitcnt vmcnt(4)
    ds_read_b64_tr_b16 a[232:233], v8 offset:18432
    ds_read_b64_tr_b16 a[234:235], v8 offset:18688
    ds_read_b64_tr_b16 a[236:237], v8 offset:18440
    ds_read_b64_tr_b16 a[238:239], v8 offset:18696
    s_waitcnt lgkmcnt(7)
    s_waitcnt vmcnt(2)
    ds_read_b64_tr_b16 a[240:241], v8 offset:20480
    ds_read_b64_tr_b16 a[242:243], v8 offset:20736
    ds_read_b64_tr_b16 a[244:245], v8 offset:20488
    ds_read_b64_tr_b16 a[246:247], v8 offset:20744
    s_waitcnt vmcnt(0)
    ds_read_b64_tr_b16 a[248:249], v8 offset:22528
    ds_read_b64_tr_b16 a[250:251], v8 offset:22784
    ds_read_b64_tr_b16 a[252:253], v8 offset:22536
    ds_read_b64_tr_b16 a[254:255], v8 offset:22792
    s_waitcnt lgkmcnt(7)
    s_waitcnt lgkmcnt(0)
    v_and_b32 v5, 15, v1
    v_bfe_u32 v6, v1, 1, 3
    v_lshrrev_b32 v7, 4, v1
    v_xor_b32 v6, v6, v7
    v_lshlrev_b32 v6, 4, v6
    v_lshl_add_u32 v10, v5, 7, v6
    s_lshl_b32 s19, s16, 10
    v_xor_b32 v11, 64, v10
    v_add_u32 v12, 0x10000, v10
    v_add_u32 v13, 0x10000, v11
    v_lshrrev_b32 v7, 3, v1
    s_lshl_b32 s17, s16, 3
    v_add_u32 v7, s17, v7
    v_bfe_u32 v8, v7, 1, 3
    v_xor_b32 v8, v8, v1
    v_and_b32 v8, 7, v8
    v_bfe_u32 v5, v7, 2, 2
    v_and_b32 v2, 3, v7
    v_lshl_add_u32 v2, v5, 3, v2
    v_bfe_u32 v5, v7, 4, 1
    v_lshl_add_u32 v2, v5, 2, v2
    v_bfe_u32 v5, v1, 2, 2
    v_and_b32 v3, 3, v1
    v_lshl_add_u32 v3, v5, 3, v3
    v_lshlrev_b32 v2, 11, v2
    v_lshl_add_u32 v2, v8, 4, v2
    v_and_b32 v5, 48, v1
    v_lshl_add_u32 v3, v3, 6, v5
    s_mul_i32 s21, s28, 133120
    s_mul_i32 s18, s90, 17825792
    s_add_u32 s21, s21, s18
    s_lshl_b32 s18, s90, 7
    s_add_u32 s17, s28, s18
    s_lshl_b32 s17, s17, 7
    s_add_u32 s17, s17, 100663296
    v_mov_b32 v4, s17
    v_mov_b32 v5, 1073741824
    v_cmp_eq_u32 vcc, 0, v1
    s_nop 1
    v_cndmask_b32 v4, v5, v4, vcc
    v_lshlrev_b32 v252, 7, v1
    s_cmp_eq_u32 s90, 0
    s_cselect_b32 s20, 0, 32
    v_cmp_gt_u32 vcc, s20, v1
    s_nop 1
    v_cndmask_b32 v252, v5, v252, vcc
    s_mov_b32 s20, 0
    s_mov_b32 s24, 65536
    s_mov_b32 s25, 2048
    s_barrier
    s_cmp_eq_u32 s90, 2
    s_cbranch_scc1 P_v
    s_mov_b32 s26, s25
    s_sub_u32 s25, s21, 1073741824
    s_mov_b32 s21, 1073741824
    s_mov_b32 s23, 0
    s_mov_b32 s22, 0
    s_add_u32 m0, s19, 0
    s_nop 0
    buffer_load_dwordx4 v2, s[8:11], s20 offen offset:0 lds
    s_add_u32 m0, s19, 3968
    s_nop 0
    buffer_load_dwordx4 v2, s[8:11], s20 offen offset:128 lds
    s_add_u32 m0, s19, 7936
    s_nop 0
    buffer_load_dwordx4 v2, s[8:11], s20 offen offset:256 lds
    s_add_u32 m0, s19, 11904
    s_nop 0
    buffer_load_dwordx4 v2, s[8:11], s20 offen offset:384 lds
    s_add_u32 m0, s19, 15872
    s_nop 0
    buffer_load_dwordx4 v2, s[8:11], s20 offen offset:512 lds
    s_add_u32 m0, s19, 19840
    s_nop 0
    buffer_load_dwordx4 v2, s[8:11], s20 offen offset:640 lds
    s_add_u32 m0, s19, 23808
    s_nop 0
    buffer_load_dwordx4 v2, s[8:11], s20 offen offset:768 lds
    s_add_u32 m0, s19, 27776
    s_nop 0
    buffer_load_dwordx4 v2, s[8:11], s20 offen offset:896 lds
    s_add_u32 m0, s19, 31744
    s_nop 0
    buffer_load_dwordx4 v2, s[8:11], s20 offen offset:1024 lds
    s_add_u32 m0, s19, 35712
    s_nop 0
    buffer_load_dwordx4 v2, s[8:11], s20 offen offset:1152 lds
    s_add_u32 m0, s19, 39680
    s_nop 0
    buffer_load_dwordx4 v2, s[8:11], s20 offen offset:1280 lds
    s_add_u32 m0, s19, 43648
    s_nop 0
    buffer_load_dwordx4 v2, s[8:11], s20 offen offset:1408 lds
    s_add_u32 m0, s19, 47616
    s_nop 0
    buffer_load_dwordx4 v2, s[8:11], s20 offen offset:1536 lds
    s_add_u32 m0, s19, 51584
    s_nop 0
    buffer_load_dwordx4 v2, s[8:11], s20 offen offset:1664 lds
    s_add_u32 m0, s19, 55552
    s_nop 0
    buffer_load_dwordx4 v2, s[8:11], s20 offen offset:1792 lds
    s_add_u32 m0, s19, 59520
    s_nop 0
    buffer_load_dwordx4 v2, s[8:11], s20 offen offset:1920 lds
    s_add_u32 s20, s20, s24
    s_add_u32 m0, s19, 65536
    s_nop 0
    buffer_load_dwordx4 v2, s[8:11], s20 offen offset:0 lds
    s_add_u32 m0, s19, 69504
    s_nop 0
    buffer_load_dwordx4 v2, s[8:11], s20 offen offset:128 lds
    s_add_u32 m0, s19, 73472
    s_nop 0
    buffer_load_dwordx4 v2, s[8:11], s20 offen offset:256 lds
    v_mov_b32 v9, s23
    s_add_u32 s23, s23, 1
    buffer_store_dword v9, v4, s[4:7], 0 offen sc1
    s_mov_b32 s23, 0
    s_waitcnt vmcnt(12)
    s_barrier
    ds_read_b128 v[20:23], v10 offset:0
    ds_read_b128 v[24:27], v10 offset:2048
    ds_read_b128 v[28:31], v11 offset:0
    ds_read_b128 v[32:35], v11 offset:2048
    ds_read_b128 v[36:39], v10 offset:4096
    ds_read_b128 v[40:43], v10 offset:6144
    ds_read_b128 v[44:47], v11 offset:4096
.p2align 6
P_qk_top:
    s_waitcnt lgkmcnt(6)
    v_mfma_f32_16x16x32_bf16 v[52:55], a[0:3], v[20:23], 0
    ds_read_b128 v[48:51], v11 offset:6144
    v_mfma_f32_16x16x32_bf16 v[56:59], a[4:7], v[20:23], 0
    s_waitcnt lgkmcnt(6)
    v_mfma_f32_16x16x32_bf16 v[60:63], a[0:3], v[24:27], 0
    ds_read_b128 v[20:23], v10 offset:8192
    s_add_u32 m0, s19, 77440
    v_mfma_f32_16x16x32_bf16 v[64:67], a[4:7], v[24:27], 0
    buffer_load_dwordx4 v2, s[8:11], s20 offen offset:384 lds
    s_waitcnt lgkmcnt(6)
    v_mfma_f32_16x16x32_bf16 v[52:55], a[8:11], v[28:31], v[52:55]
    ds_read_b128 v[24:27], v10 offset:10240
    v_mfma_f32_16x16x32_bf16 v[56:59], a[12:15], v[28:31], v[56:59]
    s_waitcnt lgkmcnt(6)
    v_mfma_f32_16x16x32_bf16 v[60:63], a[8:11], v[32:35], v[60:63]
    ds_read_b128 v[28:31], v11 offset:8192
    s_add_u32 m0, s19, 81408
    v_mfma_f32_16x16x32_bf16 v[64:67], a[12:15], v[32:35], v[64:67]
    buffer_load_dwordx4 v2, s[8:11], s20 offen offset:512 lds
    s_waitcnt lgkmcnt(6)
    v_mfma_f32_16x16x32_bf16 v[52:55], a[16:19], v[36:39], v[52:55]
    ds_read_b128 v[32:35], v11 offset:10240
    v_mfma_f32_16x16x32_bf16 v[56:59], a[20:23], v[36:39], v[56:59]
    s_waitcnt lgkmcnt(6)
    v_mfma_f32_16x16x32_bf16 v[60:63], a[16:19], v[40:43], v[60:63]
    ds_read_b128 v[36:39], v10 offset:12288
    s_add_u32 m0, s19, 85376
    v_mfma_f32_16x16x32_bf16 v[64:67], a[20:23], v[40:43], v[64:67]
    buffer_load_dwordx4 v2, s[8:11], s20 offen offset:640 lds
    s_waitcnt lgkmcnt(6)
    v_mfma_f32_16x16x32_bf16 v[52:55], a[24:27], v[44:47], v[52:55]
    ds_read_b128 v[40:43], v10 offset:14336
    v_mfma_f32_16x16x32_bf16 v[56:59], a[28:31], v[44:47], v[56:59]
    s_waitcnt lgkmcnt(6)
    v_mfma_f32_16x16x32_bf16 v[60:63], a[24:27], v[48:51], v[60:63]
    ds_read_b128 v[44:47], v11 offset:12288
    s_add_u32 m0, s19, 89344
    v_mfma_f32_16x16x32_bf16 v[64:67], a[28:31], v[48:51], v[64:67]
    buffer_load_dwordx4 v2, s[8:11], s20 offen offset:768 lds
    s_waitcnt lgkmcnt(6)
    v_mfma_f32_16x16x32_bf16 v[52:55], a[32:35], v[20:23], v[52:55]
    ds_read_b128 v[48:51], v11 offset:14336
    v_mfma_f32_16x16x32_bf16 v[56:59], a[36:39], v[20:23], v[56:59]
    s_waitcnt lgkmcnt(6)
    v_mfma_f32_16x16x32_bf16 v[60:63], a[32:35], v[24:27], v[60:63]
    ds_read_b128 v[20:23], v10 offset:16384
    s_add_u32 m0, s19, 93312
    v_mfma_f32_16x16x32_bf16 v[64:67], a[36:39], v[24:27], v[64:67]
    buffer_load_dwordx4 v2, s[8:11], s20 offen offset:896 lds
    s_waitcnt lgkmcnt(6)
    v_mfma_f32_16x16x32_bf16 v[52:55], a[40:43], v[28:31], v[52:55]
    ds_read_b128 v[24:27], v10 offset:18432
    v_mfma_f32_16x16x32_bf16 v[56:59], a[44:47], v[28:31], v[56:59]
    v_cvt_pk_bf16_f32 v84, v68, v69
    s_waitcnt lgkmcnt(6)
    v_mfma_f32_16x16x32_bf16 v[60:63], a[40:43], v[32:35], v[60:63]
    ds_read_b128 v[28:31], v11 offset:16384
    v_mfma_f32_16x16x32_bf16 v[64:67], a[44:47], v[32:35], v[64:67]
    v_cvt_pk_bf16_f32 v85, v70, v71
    s_waitcnt lgkmcnt(6)
    v_mfma_f32_16x16x32_bf16 v[52:55], a[48:51], v[36:39], v[52:55]
    ds_read_b128 v[32:35], v11 offset:18432
    v_mfma_f32_16x16x32_bf16 v[56:59], a[52:55], v[36:39], v[56:59]
    v_cvt_pk_bf16_f32 v86, v72, v73
    s_waitcnt lgkmcnt(6)
    v_mfma_f32_16x16x32_bf16 v[60:63], a[48:51], v[40:43], v[60:63]
    ds_read_b128 v[36:39], v10 offset:20480
    v_mfma_f32_16x16x32_bf16 v[64:67], a[52:55], v[40:43], v[64:67]
    v_cvt_pk_bf16_f32 v87, v74, v75
    s_waitcnt lgkmcnt(6)
    v_mfma_f32_16x16x32_bf16 v[52:55], a[56:59], v[44:47], v[52:55]
    ds_read_b128 v[40:43], v10 offset:22528
    v_mfma_f32_16x16x32_bf16 v[56:59], a[60:63], v[44:47], v[56:59]
    v_cvt_pk_bf16_f32 v88, v76, v77
    s_waitcnt lgkmcnt(6)
    v_mfma_f32_16x16x32_bf16 v[60:63], a[56:59], v[48:51], v[60:63]
    ds_read_b128 v[44:47], v11 offset:20480
    v_mfma_f32_16x16x32_bf16 v[64:67], a[60:63], v[48:51], v[64:67]
    v_cvt_pk_bf16_f32 v89, v78, v79
    buffer_store_dwordx4 v[84:87], v3, s[4:7], s21 offen offset:0 sc1
    s_waitcnt lgkmcnt(6)
    v_mfma_f32_16x16x32_bf16 v[52:55], a[64:67], v[20:23], v[52:55]
    ds_read_b128 v[48:51], v11 offset:22528
    v_mfma_f32_16x16x32_bf16 v[56:59], a[68:71], v[20:23], v[56:59]
    v_cvt_pk_bf16_f32 v90, v80, v81
    s_waitcnt lgkmcnt(6)
    v_mfma_f32_16x16x32_bf16 v[60:63], a[64:67], v[24:27], v[60:63]
    ds_read_b128 v[20:23], v10 offset:24576
    v_mfma_f32_16x16x32_bf16 v[64:67], a[68:71], v[24:27], v[64:67]
    v_cvt_pk_bf16_f32 v91, v82, v83
    s_waitcnt lgkmcnt(6)
    v_mfma_f32_16x16x32_bf16 v[52:55], a[72:75], v[28:31], v[52:55]
    ds_read_b128 v[24:27], v10 offset:26624
    v_mfma_f32_16x16x32_bf16 v[56:59], a[76:79], v[28:31], v[56:59]
    s_waitcnt lgkmcnt(6)
    v_mfma_f32_16x16x32_bf16 v[60:63], a[72:75], v[32:35], v[60:63]
    ds_read_b128 v[28:31], v11 offset:24576
    v_mfma_f32_16x16x32_bf16 v[64:67], a[76:79], v[32:35], v[64:67]
    buffer_store_dwordx4 v[88:91], v3, s[4:7], s21 offen offset:256 sc1
    s_waitcnt lgkmcnt(6)
    v_mfma_f32_16x16x32_bf16 v[52:55], a[80:83], v[36:39], v[52:55]
    ds_read_b128 v[32:35], v11 offset:26624
    v_mfma_f32_16x16x32_bf16 v[56:59], a[84:87], v[36:39], v[56:59]
    s_add_u32 s21, s21, s25
    s_mov_b32 s25, s26
    s_waitcnt lgkmcnt(6)
    v_mfma_f32_16x16x32_bf16 v[60:63], a[80:83], v[40:43], v[60:63]
    ds_read_b128 v[36:39], v10 offset:28672
    v_mfma_f32_16x16x32_bf16 v[64:67], a[84:87], v[40:43], v[64:67]
    s_waitcnt lgkmcnt(6)
    v_mfma_f32_16x16x32_bf16 v[52:55], a[88:91], v[44:47], v[52:55]
    ds_read_b128 v[40:43], v10 offset:30720
    v_mfma_f32_16x16x32_bf16 v[56:59], a[92:95], v[44:47], v[56:59]
    s_waitcnt lgkmcnt(6)
    v_mfma_f32_16x16x32_bf16 v[60:63], a[88:91], v[48:51], v[60:63]
    ds_read_b128 v[44:47], v11 offset:28672
    v_mfma_f32_16x16x32_bf16 v[64:67], a[92:95], v[48:51], v[64:67]
    s_waitcnt lgkmcnt(6)
    v_mfma_f32_16x16x32_bf16 v[52:55], a[96:99], v[20:23], v[52:55]
    ds_read_b128 v[48:51], v11 offset:30720
    v_mfma_f32_16x16x32_bf16 v[56:59], a[100:103], v[20:23], v[56:59]
    s_waitcnt lgkmcnt(6)
    v_mfma_f32_16x16x32_bf16 v[60:63], a[96:99], v[24:27], v[60:63]
    s_waitcnt vmcnt(11)
    s_barrier
    ds_read_b128 v[20:23], v10 offset:32768
    v_mfma_f32_16x16x32_bf16 v[64:67], a[100:103], v[24:27], v[64:67]
    s_waitcnt lgkmcnt(6)
    v_mfma_f32_16x16x32_bf16 v[52:55], a[104:107], v[28:31], v[52:55]
    ds_read_b128 v[24:27], v10 offset:34816
    s_add_u32 m0, s19, 97280
    v_mfma_f32_16x16x32_bf16 v[56:59], a[108:111], v[28:31], v[56:59]
    buffer_load_dwordx4 v2, s[8:11], s20 offen offset:1024 lds
    s_waitcnt lgkmcnt(6)
    v_mfma_f32_16x16x32_bf16 v[60:63], a[104:107], v[32:35], v[60:63]
    ds_read_b128 v[28:31], v11 offset:32768
    v_mfma_f32_16x16x32_bf16 v[64:67], a[108:111], v[32:35], v[64:67]
    s_waitcnt lgkmcnt(6)
    v_mfma_f32_16x16x32_bf16 v[52:55], a[112:115], v[36:39], v[52:55]
    ds_read_b128 v[32:35], v11 offset:34816
    s_add_u32 m0, s19, 101248
    v_mfma_f32_16x16x32_bf16 v[56:59], a[116:119], v[36:39], v[56:59]
    buffer_load_dwordx4 v2, s[8:11], s20 offen offset:1152 lds
    s_waitcnt lgkmcnt(6)
    v_mfma_f32_16x16x32_bf16 v[60:63], a[112:115], v[40:43], v[60:63]
    ds_read_b128 v[36:39], v10 offset:36864
    v_mfma_f32_16x16x32_bf16 v[64:67], a[116:119], v[40:43], v[64:67]
    s_waitcnt lgkmcnt(6)
    v_mfma_f32_16x16x32_bf16 v[52:55], a[120:123], v[44:47], v[52:55]
    ds_read_b128 v[40:43], v10 offset:38912
    s_add_u32 m0, s19, 105216
    v_mfma_f32_16x16x32_bf16 v[56:59], a[124:127], v[44:47], v[56:59]
    buffer_load_dwordx4 v2, s[8:11], s20 offen offset:1280 lds
    s_waitcnt lgkmcnt(6)
    v_mfma_f32_16x16x32_bf16 v[60:63], a[120:123], v[48:51], v[60:63]
    ds_read_b128 v[44:47], v11 offset:36864
    v_mfma_f32_16x16x32_bf16 v[64:67], a[124:127], v[48:51], v[64:67]
    s_waitcnt lgkmcnt(6)
    v_mfma_f32_16x16x32_bf16 v[52:55], a[128:131], v[20:23], v[52:55]
    ds_read_b128 v[48:51], v11 offset:38912
    v_mfma_f32_16x16x32_bf16 v[56:59], a[132:135], v[20:23], v[56:59]
    s_waitcnt lgkmcnt(6)
    v_mfma_f32_16x16x32_bf16 v[60:63], a[128:131], v[24:27], v[60:63]
    ds_read_b128 v[20:23], v10 offset:40960
    s_add_u32 m0, s19, 109184
    v_mfma_f32_16x16x32_bf16 v[64:67], a[132:135], v[24:27], v[64:67]
    buffer_load_dwordx4 v2, s[8:11], s20 offen offset:1408 lds
    s_waitcnt lgkmcnt(6)
    v_mfma_f32_16x16x32_bf16 v[52:55], a[136:139], v[28:31], v[52:55]
    ds_read_b128 v[24:27], v10 offset:43008
    v_mfma_f32_16x16x32_bf16 v[56:59], a[140:143], v[28:31], v[56:59]
    s_waitcnt lgkmcnt(6)
    v_mfma_f32_16x16x32_bf16 v[60:63], a[136:139], v[32:35], v[60:63]
    ds_read_b128 v[28:31], v11 offset:40960
    s_add_u32 m0, s19, 113152
    v_mfma_f32_16x16x32_bf16 v[64:67], a[140:143], v[32:35], v[64:67]
    buffer_load_dwordx4 v2, s[8:11], s20 offen offset:1536 lds
    s_waitcnt lgkmcnt(6)
    v_mfma_f32_16x16x32_bf16 v[52:55], a[144:147], v[36:39], v[52:55]
    ds_read_b128 v[32:35], v11 offset:43008
    v_mfma_f32_16x16x32_bf16 v[56:59], a[148:151], v[36:39], v[56:59]
    s_waitcnt lgkmcnt(6)
    v_mfma_f32_16x16x32_bf16 v[60:63], a[144:147], v[40:43], v[60:63]
    ds_read_b128 v[36:39], v10 offset:45056
    s_add_u32 m0, s19, 117120
    v_mfma_f32_16x16x32_bf16 v[64:67], a[148:151], v[40:43], v[64:67]
    buffer_load_dwordx4 v2, s[8:11], s20 offen offset:1664 lds
    s_waitcnt lgkmcnt(6)
    v_mfma_f32_16x16x32_bf16 v[52:55], a[152:155], v[44:47], v[52:55]
    ds_read_b128 v[40:43], v10 offset:47104
    v_mfma_f32_16x16x32_bf16 v[56:59], a[156:159], v[44:47], v[56:59]
    s_waitcnt lgkmcnt(6)
    v_mfma_f32_16x16x32_bf16 v[60:63], a[152:155], v[48:51], v[60:63]
    ds_read_b128 v[44:47], v11 offset:45056
    s_add_u32 m0, s19, 121088
    v_mfma_f32_16x16x32_bf16 v[64:67], a[156:159], v[48:51], v[64:67]
    buffer_load_dwordx4 v2, s[8:11], s20 offen offset:1792 lds
    s_waitcnt lgkmcnt(6)
    v_mfma_f32_16x16x32_bf16 v[52:55], a[160:163], v[20:23], v[52:55]
    ds_read_b128 v[48:51], v11 offset:47104
    v_mfma_f32_16x16x32_bf16 v[56:59], a[164:167], v[20:23], v[56:59]
    s_waitcnt lgkmcnt(6)
    v_mfma_f32_16x16x32_bf16 v[60:63], a[160:163], v[24:27], v[60:63]
    ds_read_b128 v[20:23], v10 offset:49152
    s_add_u32 m0, s19, 125056
    v_mfma_f32_16x16x32_bf16 v[64:67], a[164:167], v[24:27], v[64:67]
    buffer_load_dwordx4 v2, s[8:11], s20 offen offset:1920 lds
    s_waitcnt lgkmcnt(6)
    v_mfma_f32_16x16x32_bf16 v[52:55], a[168:171], v[28:31], v[52:55]
    ds_read_b128 v[24:27], v10 offset:51200
    v_mfma_f32_16x16x32_bf16 v[56:59], a[172:175], v[28:31], v[56:59]
    s_add_u32 s20, s20, s24
    s_waitcnt lgkmcnt(6)
    v_mfma_f32_16x16x32_bf16 v[60:63], a[168:171], v[32:35], v[60:63]
    ds_read_b128 v[28:31], v11 offset:49152
    v_mfma_f32_16x16x32_bf16 v[64:67], a[172:175], v[32:35], v[64:67]
    s_waitcnt lgkmcnt(6)
    v_mfma_f32_16x16x32_bf16 v[52:55], a[176:179], v[36:39], v[52:55]
    ds_read_b128 v[32:35], v11 offset:51200
    v_mfma_f32_16x16x32_bf16 v[56:59], a[180:183], v[36:39], v[56:59]
    s_waitcnt lgkmcnt(6)
    v_mfma_f32_16x16x32_bf16 v[60:63], a[176:179], v[40:43], v[60:63]
    ds_read_b128 v[36:39], v10 offset:53248
    v_mfma_f32_16x16x32_bf16 v[64:67], a[180:183], v[40:43], v[64:67]
    s_waitcnt lgkmcnt(6)
    v_mfma_f32_16x16x32_bf16 v[52:55], a[184:187], v[44:47], v[52:55]
    ds_read_b128 v[40:43], v10 offset:55296
    v_mfma_f32_16x16x32_bf16 v[56:59], a[188:191], v[44:47], v[56:59]
    s_waitcnt lgkmcnt(6)
    v_mfma_f32_16x16x32_bf16 v[60:63], a[184:187], v[48:51], v[60:63]
    ds_read_b128 v[44:47], v11 offset:53248
    v_mfma_f32_16x16x32_bf16 v[64:67], a[188:191], v[48:51], v[64:67]
    s_waitcnt lgkmcnt(6)
    v_mfma_f32_16x16x32_bf16 v[52:55], a[192:195], v[20:23], v[52:55]
    ds_read_b128 v[48:51], v11 offset:55296
    v_mfma_f32_16x16x32_bf16 v[56:59], a[196:199], v[20:23], v[56:59]
    s_waitcnt lgkmcnt(6)
    v_mfma_f32_16x16x32_bf16 v[60:63], a[192:195], v[24:27], v[60:63]
    ds_read_b128 v[20:23], v10 offset:57344
    v_mfma_f32_16x16x32_bf16 v[64:67], a[196:199], v[24:27], v[64:67]
    s_waitcnt lgkmcnt(6)
    v_mfma_f32_16x16x32_bf16 v[52:55], a[200:203], v[28:31], v[52:55]
    ds_read_b128 v[24:27], v10 offset:59392
    v_mfma_f32_16x16x32_bf16 v[56:59], a[204:207], v[28:31], v[56:59]
    s_waitcnt lgkmcnt(6)
    v_mfma_f32_16x16x32_bf16 v[60:63], a[200:203], v[32:35], v[60:63]
    ds_read_b128 v[28:31], v11 offset:57344
    v_mfma_f32_16x16x32_bf16 v[64:67], a[204:207], v[32:35], v[64:67]
    s_waitcnt lgkmcnt(6)
    v_mfma_f32_16x16x32_bf16 v[52:55], a[208:211], v[36:39], v[52:55]
    ds_read_b128 v[32:35], v11 offset:59392
    v_mfma_f32_16x16x32_bf16 v[56:59], a[212:215], v[36:39], v[56:59]
    s_waitcnt lgkmcnt(6)
    v_mfma_f32_16x16x32_bf16 v[60:63], a[208:211], v[40:43], v[60:63]
    ds_read_b128 v[36:39], v10 offset:61440
    v_mfma_f32_16x16x32_bf16 v[64:67], a[212:215], v[40:43], v[64:67]
    s_waitcnt lgkmcnt(6)
    v_mfma_f32_16x16x32_bf16 v[52:55], a[216:219], v[44:47], v[52:55]
    ds_read_b128 v[40:43], v10 offset:63488
    v_mfma_f32_16x16x32_bf16 v[56:59], a[220:223], v[44:47], v[56:59]
    s_waitcnt lgkmcnt(6)
    v_mfma_f32_16x16x32_bf16 v[60:63], a[216:219], v[48:51], v[60:63]
    ds_read_b128 v[44:47], v11 offset:61440
    v_mfma_f32_16x16x32_bf16 v[64:67], a[220:223], v[48:51], v[64:67]
    s_waitcnt lgkmcnt(6)
    v_mfma_f32_16x16x32_bf16 v[52:55], a[224:227], v[20:23], v[52:55]
    ds_read_b128 v[48:51], v11 offset:63488
    v_mfma_f32_16x16x32_bf16 v[56:59], a[228:231], v[20:23], v[56:59]
    s_waitcnt lgkmcnt(6)
    v_mfma_f32_16x16x32_bf16 v[60:63], a[224:227], v[24:27], v[60:63]
    s_waitcnt vmcnt(8)
    s_barrier
    ds_read_b128 v[20:23], v12 offset:0
    v_mfma_f32_16x16x32_bf16 v[64:67], a[228:231], v[24:27], v[64:67]
    s_waitcnt lgkmcnt(6)
    v_mfma_f32_16x16x32_bf16 v[52:55], a[232:235], v[28:31], v[52:55]
    ds_read_b128 v[24:27], v12 offset:2048
    s_add_u32 m0, s19, 0
    v_mfma_f32_16x16x32_bf16 v[56:59], a[236:239], v[28:31], v[56:59]
    buffer_load_dwordx4 v2, s[8:11], s20 offen offset:0 lds
    s_waitcnt lgkmcnt(6)
    v_mfma_f32_16x16x32_bf16 v[60:63], a[232:235], v[32:35], v[60:63]
    ds_read_b128 v[28:31], v13 offset:0
    v_mfma_f32_16x16x32_bf16 v[64:67], a[236:239], v[32:35], v[64:67]
    v_mov_b32 v9, s23
    s_add_u32 s23, s23, 1
    buffer_store_dword v9, v4, s[4:7], 0 offen sc1
    s_waitcnt lgkmcnt(6)
    v_mfma_f32_16x16x32_bf16 v[52:55], a[240:243], v[36:39], v[52:55]
    ds_read_b128 v[32:35], v13 offset:2048
    s_add_u32 m0, s19, 3968
    v_mfma_f32_16x16x32_bf16 v[56:59], a[244:247], v[36:39], v[56:59]
    buffer_load_dwordx4 v2, s[8:11], s20 offen offset:128 lds
    s_waitcnt lgkmcnt(6)
    v_mfma_f32_16x16x32_bf16 v[60:63], a[240:243], v[40:43], v[60:63]
    ds_read_b128 v[36:39], v12 offset:4096
    v_mfma_f32_16x16x32_bf16 v[64:67], a[244:247], v[40:43], v[64:67]
    s_waitcnt lgkmcnt(6)
    v_mfma_f32_16x16x32_bf16 v[52:55], a[248:251], v[44:47], v[52:55]
    ds_read_b128 v[40:43], v12 offset:6144
    s_add_u32 m0, s19, 7936
    v_mfma_f32_16x16x32_bf16 v[56:59], a[252:255], v[44:47], v[56:59]
    buffer_load_dwordx4 v2, s[8:11], s20 offen offset:256 lds
    s_waitcnt lgkmcnt(6)
    v_mfma_f32_16x16x32_bf16 v[60:63], a[248:251], v[48:51], v[60:63]
    ds_read_b128 v[44:47], v13 offset:4096
    v_mfma_f32_16x16x32_bf16 v[64:67], a[252:255], v[48:51], v[64:67]
    s_waitcnt lgkmcnt(6)
    v_mfma_f32_16x16x32_bf16 v[68:71], a[0:3], v[20:23], 0
    ds_read_b128 v[48:51], v13 offset:6144
    v_mfma_f32_16x16x32_bf16 v[72:75], a[4:7], v[20:23], 0
    s_waitcnt lgkmcnt(6)
    v_mfma_f32_16x16x32_bf16 v[76:79], a[0:3], v[24:27], 0
    ds_read_b128 v[20:23], v12 offset:8192
    s_add_u32 m0, s19, 11904
    v_mfma_f32_16x16x32_bf16 v[80:83], a[4:7], v[24:27], 0
    buffer_load_dwordx4 v2, s[8:11], s20 offen offset:384 lds
    s_waitcnt lgkmcnt(6)
    v_mfma_f32_16x16x32_bf16 v[68:71], a[8:11], v[28:31], v[68:71]
    ds_read_b128 v[24:27], v12 offset:10240
    v_mfma_f32_16x16x32_bf16 v[72:75], a[12:15], v[28:31], v[72:75]
    s_waitcnt lgkmcnt(6)
    v_mfma_f32_16x16x32_bf16 v[76:79], a[8:11], v[32:35], v[76:79]
    ds_read_b128 v[28:31], v13 offset:8192
    s_add_u32 m0, s19, 15872
    v_mfma_f32_16x16x32_bf16 v[80:83], a[12:15], v[32:35], v[80:83]
    buffer_load_dwordx4 v2, s[8:11], s20 offen offset:512 lds
    s_waitcnt lgkmcnt(6)
    v_mfma_f32_16x16x32_bf16 v[68:71], a[16:19], v[36:39], v[68:71]
    ds_read_b128 v[32:35], v13 offset:10240
    v_mfma_f32_16x16x32_bf16 v[72:75], a[20:23], v[36:39], v[72:75]
    s_waitcnt lgkmcnt(6)
    v_mfma_f32_16x16x32_bf16 v[76:79], a[16:19], v[40:43], v[76:79]
    ds_read_b128 v[36:39], v12 offset:12288
    s_add_u32 m0, s19, 19840
    v_mfma_f32_16x16x32_bf16 v[80:83], a[20:23], v[40:43], v[80:83]
    buffer_load_dwordx4 v2, s[8:11], s20 offen offset:640 lds
    s_waitcnt lgkmcnt(6)
    v_mfma_f32_16x16x32_bf16 v[68:71], a[24:27], v[44:47], v[68:71]
    ds_read_b128 v[40:43], v12 offset:14336
    v_mfma_f32_16x16x32_bf16 v[72:75], a[28:31], v[44:47], v[72:75]
    s_waitcnt lgkmcnt(6)
    v_mfma_f32_16x16x32_bf16 v[76:79], a[24:27], v[48:51], v[76:79]
    ds_read_b128 v[44:47], v13 offset:12288
    s_add_u32 m0, s19, 23808
    v_mfma_f32_16x16x32_bf16 v[80:83], a[28:31], v[48:51], v[80:83]
    buffer_load_dwordx4 v2, s[8:11], s20 offen offset:768 lds
    s_waitcnt lgkmcnt(6)
    v_mfma_f32_16x16x32_bf16 v[68:71], a[32:35], v[20:23], v[68:71]
    ds_read_b128 v[48:51], v13 offset:14336
    v_mfma_f32_16x16x32_bf16 v[72:75], a[36:39], v[20:23], v[72:75]
    s_waitcnt lgkmcnt(6)
    v_mfma_f32_16x16x32_bf16 v[76:79], a[32:35], v[24:27], v[76:79]
    ds_read_b128 v[20:23], v12 offset:16384
    s_add_u32 m0, s19, 27776
    v_mfma_f32_16x16x32_bf16 v[80:83], a[36:39], v[24:27], v[80:83]
    buffer_load_dwordx4 v2, s[8:11], s20 offen offset:896 lds
    s_waitcnt lgkmcnt(6)
    v_mfma_f32_16x16x32_bf16 v[68:71], a[40:43], v[28:31], v[68:71]
    ds_read_b128 v[24:27], v12 offset:18432
    v_mfma_f32_16x16x32_bf16 v[72:75], a[44:47], v[28:31], v[72:75]
    v_cvt_pk_bf16_f32 v84, v52, v53
    s_waitcnt lgkmcnt(6)
    v_mfma_f32_16x16x32_bf16 v[76:79], a[40:43], v[32:35], v[76:79]
    ds_read_b128 v[28:31], v13 offset:16384
    v_mfma_f32_16x16x32_bf16 v[80:83], a[44:47], v[32:35], v[80:83]
    v_cvt_pk_bf16_f32 v85, v54, v55
    s_waitcnt lgkmcnt(6)
    v_mfma_f32_16x16x32_bf16 v[68:71], a[48:51], v[36:39], v[68:71]
    ds_read_b128 v[32:35], v13 offset:18432
    v_mfma_f32_16x16x32_bf16 v[72:75], a[52:55], v[36:39], v[72:75]
    v_cvt_pk_bf16_f32 v86, v56, v57
    s_waitcnt lgkmcnt(6)
    v_mfma_f32_16x16x32_bf16 v[76:79], a[48:51], v[40:43], v[76:79]
    ds_read_b128 v[36:39], v12 offset:20480
    v_mfma_f32_16x16x32_bf16 v[80:83], a[52:55], v[40:43], v[80:83]
    v_cvt_pk_bf16_f32 v87, v58, v59
    s_waitcnt lgkmcnt(6)
    v_mfma_f32_16x16x32_bf16 v[68:71], a[56:59], v[44:47], v[68:71]
    ds_read_b128 v[40:43], v12 offset:22528
    v_mfma_f32_16x16x32_bf16 v[72:75], a[60:63], v[44:47], v[72:75]
    v_cvt_pk_bf16_f32 v88, v60, v61
    s_waitcnt lgkmcnt(6)
    v_mfma_f32_16x16x32_bf16 v[76:79], a[56:59], v[48:51], v[76:79]
    ds_read_b128 v[44:47], v13 offset:20480
    v_mfma_f32_16x16x32_bf16 v[80:83], a[60:63], v[48:51], v[80:83]
    v_cvt_pk_bf16_f32 v89, v62, v63
    buffer_store_dwordx4 v[84:87], v3, s[4:7], s21 offen offset:0 sc1
    s_waitcnt lgkmcnt(6)
    v_mfma_f32_16x16x32_bf16 v[68:71], a[64:67], v[20:23], v[68:71]
    ds_read_b128 v[48:51], v13 offset:22528
    v_mfma_f32_16x16x32_bf16 v[72:75], a[68:71], v[20:23], v[72:75]
    v_cvt_pk_bf16_f32 v90, v64, v65
    s_waitcnt lgkmcnt(6)
    v_mfma_f32_16x16x32_bf16 v[76:79], a[64:67], v[24:27], v[76:79]
    ds_read_b128 v[20:23], v12 offset:24576
    v_mfma_f32_16x16x32_bf16 v[80:83], a[68:71], v[24:27], v[80:83]
    v_cvt_pk_bf16_f32 v91, v66, v67
    s_waitcnt lgkmcnt(6)
    v_mfma_f32_16x16x32_bf16 v[68:71], a[72:75], v[28:31], v[68:71]
    ds_read_b128 v[24:27], v12 offset:26624
    v_mfma_f32_16x16x32_bf16 v[72:75], a[76:79], v[28:31], v[72:75]
    s_waitcnt lgkmcnt(6)
    v_mfma_f32_16x16x32_bf16 v[76:79], a[72:75], v[32:35], v[76:79]
    ds_read_b128 v[28:31], v13 offset:24576
    v_mfma_f32_16x16x32_bf16 v[80:83], a[76:79], v[32:35], v[80:83]
    buffer_store_dwordx4 v[88:91], v3, s[4:7], s21 offen offset:256 sc1
    s_waitcnt lgkmcnt(6)
    v_mfma_f32_16x16x32_bf16 v[68:71], a[80:83], v[36:39], v[68:71]
    ds_read_b128 v[32:35], v13 offset:26624
    v_mfma_f32_16x16x32_bf16 v[72:75], a[84:87], v[36:39], v[72:75]
    s_add_u32 s21, s21, s25
    s_mov_b32 s25, s26
    s_waitcnt lgkmcnt(6)
    v_mfma_f32_16x16x32_bf16 v[76:79], a[80:83], v[40:43], v[76:79]
    ds_read_b128 v[36:39], v12 offset:28672
    v_mfma_f32_16x16x32_bf16 v[80:83], a[84:87], v[40:43], v[80:83]
    s_waitcnt lgkmcnt(6)
    v_mfma_f32_16x16x32_bf16 v[68:71], a[88:91], v[44:47], v[68:71]
    ds_read_b128 v[40:43], v12 offset:30720
    v_mfma_f32_16x16x32_bf16 v[72:75], a[92:95], v[44:47], v[72:75]
    s_waitcnt lgkmcnt(6)
    v_mfma_f32_16x16x32_bf16 v[76:79], a[88:91], v[48:51], v[76:79]
    ds_read_b128 v[44:47], v13 offset:28672
    v_mfma_f32_16x16x32_bf16 v[80:83], a[92:95], v[48:51], v[80:83]
    s_waitcnt lgkmcnt(6)
    v_mfma_f32_16x16x32_bf16 v[68:71], a[96:99], v[20:23], v[68:71]
    ds_read_b128 v[48:51], v13 offset:30720
    v_mfma_f32_16x16x32_bf16 v[72:75], a[100:103], v[20:23], v[72:75]
    s_waitcnt lgkmcnt(6)
    v_mfma_f32_16x16x32_bf16 v[76:79], a[96:99], v[24:27], v[76:79]
    s_waitcnt vmcnt(11)
    s_barrier
    ds_read_b128 v[20:23], v12 offset:32768
    v_mfma_f32_16x16x32_bf16 v[80:83], a[100:103], v[24:27], v[80:83]
    s_waitcnt lgkmcnt(6)
    v_mfma_f32_16x16x32_bf16 v[68:71], a[104:107], v[28:31], v[68:71]
    ds_read_b128 v[24:27], v12 offset:34816
    s_add_u32 m0, s19, 31744
    v_mfma_f32_16x16x32_bf16 v[72:75], a[108:111], v[28:31], v[72:75]
    buffer_load_dwordx4 v2, s[8:11], s20 offen offset:1024 lds
    s_waitcnt lgkmcnt(6)
    v_mfma_f32_16x16x32_bf16 v[76:79], a[104:107], v[32:35], v[76:79]
    ds_read_b128 v[28:31], v13 offset:32768
    v_mfma_f32_16x16x32_bf16 v[80:83], a[108:111], v[32:35], v[80:83]
    s_waitcnt lgkmcnt(6)
    v_mfma_f32_16x16x32_bf16 v[68:71], a[112:115], v[36:39], v[68:71]
    ds_read_b128 v[32:35], v13 offset:34816
    s_add_u32 m0, s19, 35712
    v_mfma_f32_16x16x32_bf16 v[72:75], a[116:119], v[36:39], v[72:75]
    buffer_load_dwordx4 v2, s[8:11], s20 offen offset:1152 lds
    s_waitcnt lgkmcnt(6)
    v_mfma_f32_16x16x32_bf16 v[76:79], a[112:115], v[40:43], v[76:79]
    ds_read_b128 v[36:39], v12 offset:36864
    v_mfma_f32_16x16x32_bf16 v[80:83], a[116:119], v[40:43], v[80:83]
    s_waitcnt lgkmcnt(6)
    v_mfma_f32_16x16x32_bf16 v[68:71], a[120:123], v[44:47], v[68:71]
    ds_read_b128 v[40:43], v12 offset:38912
    s_add_u32 m0, s19, 39680
    v_mfma_f32_16x16x32_bf16 v[72:75], a[124:127], v[44:47], v[72:75]
    buffer_load_dwordx4 v2, s[8:11], s20 offen offset:1280 lds
    s_waitcnt lgkmcnt(6)
    v_mfma_f32_16x16x32_bf16 v[76:79], a[120:123], v[48:51], v[76:79]
    ds_read_b128 v[44:47], v13 offset:36864
    v_mfma_f32_16x16x32_bf16 v[80:83], a[124:127], v[48:51], v[80:83]
    s_waitcnt lgkmcnt(6)
    v_mfma_f32_16x16x32_bf16 v[68:71], a[128:131], v[20:23], v[68:71]
    ds_read_b128 v[48:51], v13 offset:38912
    v_mfma_f32_16x16x32_bf16 v[72:75], a[132:135], v[20:23], v[72:75]
    s_waitcnt lgkmcnt(6)
    v_mfma_f32_16x16x32_bf16 v[76:79], a[128:131], v[24:27], v[76:79]
    ds_read_b128 v[20:23], v12 offset:40960
    s_add_u32 m0, s19, 43648
    v_mfma_f32_16x16x32_bf16 v[80:83], a[132:135], v[24:27], v[80:83]
    buffer_load_dwordx4 v2, s[8:11], s20 offen offset:1408 lds
    s_waitcnt lgkmcnt(6)
    v_mfma_f32_16x16x32_bf16 v[68:71], a[136:139], v[28:31], v[68:71]
    ds_read_b128 v[24:27], v12 offset:43008
    v_mfma_f32_16x16x32_bf16 v[72:75], a[140:143], v[28:31], v[72:75]
    s_waitcnt lgkmcnt(6)
    v_mfma_f32_16x16x32_bf16 v[76:79], a[136:139], v[32:35], v[76:79]
    ds_read_b128 v[28:31], v13 offset:40960
    s_add_u32 m0, s19, 47616
    v_mfma_f32_16x16x32_bf16 v[80:83], a[140:143], v[32:35], v[80:83]
    buffer_load_dwordx4 v2, s[8:11], s20 offen offset:1536 lds
    s_waitcnt lgkmcnt(6)
    v_mfma_f32_16x16x32_bf16 v[68:71], a[144:147], v[36:39], v[68:71]
    ds_read_b128 v[32:35], v13 offset:43008
    v_mfma_f32_16x16x32_bf16 v[72:75], a[148:151], v[36:39], v[72:75]
    s_waitcnt lgkmcnt(6)
    v_mfma_f32_16x16x32_bf16 v[76:79], a[144:147], v[40:43], v[76:79]
    ds_read_b128 v[36:39], v12 offset:45056
    s_add_u32 m0, s19, 51584
    v_mfma_f32_16x16x32_bf16 v[80:83], a[148:151], v[40:43], v[80:83]
    buffer_load_dwordx4 v2, s[8:11], s20 offen offset:1664 lds
    s_waitcnt lgkmcnt(6)
    v_mfma_f32_16x16x32_bf16 v[68:71], a[152:155], v[44:47], v[68:71]
    ds_read_b128 v[40:43], v12 offset:47104
    v_mfma_f32_16x16x32_bf16 v[72:75], a[156:159], v[44:47], v[72:75]
    s_waitcnt lgkmcnt(6)
    v_mfma_f32_16x16x32_bf16 v[76:79], a[152:155], v[48:51], v[76:79]
    ds_read_b128 v[44:47], v13 offset:45056
    s_add_u32 m0, s19, 55552
    v_mfma_f32_16x16x32_bf16 v[80:83], a[156:159], v[48:51], v[80:83]
    buffer_load_dwordx4 v2, s[8:11], s20 offen offset:1792 lds
    s_waitcnt lgkmcnt(6)
    v_mfma_f32_16x16x32_bf16 v[68:71], a[160:163], v[20:23], v[68:71]
    ds_read_b128 v[48:51], v13 offset:47104
    v_mfma_f32_16x16x32_bf16 v[72:75], a[164:167], v[20:23], v[72:75]
    s_waitcnt lgkmcnt(6)
    v_mfma_f32_16x16x32_bf16 v[76:79], a[160:163], v[24:27], v[76:79]
    ds_read_b128 v[20:23], v12 offset:49152
    s_add_u32 m0, s19, 59520
    v_mfma_f32_16x16x32_bf16 v[80:83], a[164:167], v[24:27], v[80:83]
    buffer_load_dwordx4 v2, s[8:11], s20 offen offset:1920 lds
    s_waitcnt lgkmcnt(6)
    v_mfma_f32_16x16x32_bf16 v[68:71], a[168:171], v[28:31], v[68:71]
    ds_read_b128 v[24:27], v12 offset:51200
    v_mfma_f32_16x16x32_bf16 v[72:75], a[172:175], v[28:31], v[72:75]
    s_add_u32 s20, s20, s24
    s_waitcnt lgkmcnt(6)
    v_mfma_f32_16x16x32_bf16 v[76:79], a[168:171], v[32:35], v[76:79]
    ds_read_b128 v[28:31], v13 offset:49152
    v_mfma_f32_16x16x32_bf16 v[80:83], a[172:175], v[32:35], v[80:83]
    s_waitcnt lgkmcnt(6)
    v_mfma_f32_16x16x32_bf16 v[68:71], a[176:179], v[36:39], v[68:71]
    ds_read_b128 v[32:35], v13 offset:51200
    v_mfma_f32_16x16x32_bf16 v[72:75], a[180:183], v[36:39], v[72:75]
    s_waitcnt lgkmcnt(6)
    v_mfma_f32_16x16x32_bf16 v[76:79], a[176:179], v[40:43], v[76:79]
    ds_read_b128 v[36:39], v12 offset:53248
    v_mfma_f32_16x16x32_bf16 v[80:83], a[180:183], v[40:43], v[80:83]
    s_waitcnt lgkmcnt(6)
    v_mfma_f32_16x16x32_bf16 v[68:71], a[184:187], v[44:47], v[68:71]
    ds_read_b128 v[40:43], v12 offset:55296
    v_mfma_f32_16x16x32_bf16 v[72:75], a[188:191], v[44:47], v[72:75]
    s_waitcnt lgkmcnt(6)
    v_mfma_f32_16x16x32_bf16 v[76:79], a[184:187], v[48:51], v[76:79]
    ds_read_b128 v[44:47], v13 offset:53248
    v_mfma_f32_16x16x32_bf16 v[80:83], a[188:191], v[48:51], v[80:83]
    s_waitcnt lgkmcnt(6)
    v_mfma_f32_16x16x32_bf16 v[68:71], a[192:195], v[20:23], v[68:71]
    ds_read_b128 v[48:51], v13 offset:55296
    v_mfma_f32_16x16x32_bf16 v[72:75], a[196:199], v[20:23], v[72:75]
    s_waitcnt lgkmcnt(6)
    v_mfma_f32_16x16x32_bf16 v[76:79], a[192:195], v[24:27], v[76:79]
    ds_read_b128 v[20:23], v12 offset:57344
    v_mfma_f32_16x16x32_bf16 v[80:83], a[196:199], v[24:27], v[80:83]
    s_waitcnt lgkmcnt(6)
    v_mfma_f32_16x16x32_bf16 v[68:71], a[200:203], v[28:31], v[68:71]
    ds_read_b128 v[24:27], v12 offset:59392
    v_mfma_f32_16x16x32_bf16 v[72:75], a[204:207], v[28:31], v[72:75]
    s_waitcnt lgkmcnt(6)
    v_mfma_f32_16x16x32_bf16 v[76:79], a[200:203], v[32:35], v[76:79]
    ds_read_b128 v[28:31], v13 offset:57344
    v_mfma_f32_16x16x32_bf16 v[80:83], a[204:207], v[32:35], v[80:83]
    s_waitcnt lgkmcnt(6)
    v_mfma_f32_16x16x32_bf16 v[68:71], a[208:211], v[36:39], v[68:71]
    ds_read_b128 v[32:35], v13 offset:59392
    v_mfma_f32_16x16x32_bf16 v[72:75], a[212:215], v[36:39], v[72:75]
    s_waitcnt lgkmcnt(6)
    v_mfma_f32_16x16x32_bf16 v[76:79], a[208:211], v[40:43], v[76:79]
    ds_read_b128 v[36:39], v12 offset:61440
    v_mfma_f32_16x16x32_bf16 v[80:83], a[212:215], v[40:43], v[80:83]
    s_waitcnt lgkmcnt(6)
    v_mfma_f32_16x16x32_bf16 v[68:71], a[216:219], v[44:47], v[68:71]
    ds_read_b128 v[40:43], v12 offset:63488
    v_mfma_f32_16x16x32_bf16 v[72:75], a[220:223], v[44:47], v[72:75]
    s_waitcnt lgkmcnt(6)
    v_mfma_f32_16x16x32_bf16 v[76:79], a[216:219], v[48:51], v[76:79]
    ds_read_b128 v[44:47], v13 offset:61440
    v_mfma_f32_16x16x32_bf16 v[80:83], a[220:223], v[48:51], v[80:83]
    s_waitcnt lgkmcnt(6)
    v_mfma_f32_16x16x32_bf16 v[68:71], a[224:227], v[20:23], v[68:71]
    ds_read_b128 v[48:51], v13 offset:63488
    v_mfma_f32_16x16x32_bf16 v[72:75], a[228:231], v[20:23], v[72:75]
    s_waitcnt lgkmcnt(6)
    v_mfma_f32_16x16x32_bf16 v[76:79], a[224:227], v[24:27], v[76:79]
    s_waitcnt vmcnt(8)
    s_barrier
    ds_read_b128 v[20:23], v10 offset:0
    v_mfma_f32_16x16x32_bf16 v[80:83], a[228:231], v[24:27], v[80:83]
    s_waitcnt lgkmcnt(6)
    v_mfma_f32_16x16x32_bf16 v[68:71], a[232:235], v[28:31], v[68:71]
    ds_read_b128 v[24:27], v10 offset:2048
    s_add_u32 m0, s19, 65536
    v_mfma_f32_16x16x32_bf16 v[72:75], a[236:239], v[28:31], v[72:75]
    buffer_load_dwordx4 v2, s[8:11], s20 offen offset:0 lds
    s_waitcnt lgkmcnt(6)
    v_mfma_f32_16x16x32_bf16 v[76:79], a[232:235], v[32:35], v[76:79]
    ds_read_b128 v[28:31], v11 offset:0
    v_mfma_f32_16x16x32_bf16 v[80:83], a[236:239], v[32:35], v[80:83]
    v_mov_b32 v9, s23
    s_add_u32 s23, s23, 1
    buffer_store_dword v9, v4, s[4:7], 0 offen sc1
    s_waitcnt lgkmcnt(6)
    v_mfma_f32_16x16x32_bf16 v[68:71], a[240:243], v[36:39], v[68:71]
    ds_read_b128 v[32:35], v11 offset:2048
    s_add_u32 m0, s19, 69504
    v_mfma_f32_16x16x32_bf16 v[72:75], a[244:247], v[36:39], v[72:75]
    buffer_load_dwordx4 v2, s[8:11], s20 offen offset:128 lds
    s_waitcnt lgkmcnt(6)
    v_mfma_f32_16x16x32_bf16 v[76:79], a[240:243], v[40:43], v[76:79]
    ds_read_b128 v[36:39], v10 offset:4096
    v_mfma_f32_16x16x32_bf16 v[80:83], a[244:247], v[40:43], v[80:83]
    s_waitcnt lgkmcnt(6)
    v_mfma_f32_16x16x32_bf16 v[68:71], a[248:251], v[44:47], v[68:71]
    ds_read_b128 v[40:43], v10 offset:6144
    s_add_u32 m0, s19, 73472
    v_mfma_f32_16x16x32_bf16 v[72:75], a[252:255], v[44:47], v[72:75]
    buffer_load_dwordx4 v2, s[8:11], s20 offen offset:256 lds
    s_waitcnt lgkmcnt(6)
    v_mfma_f32_16x16x32_bf16 v[76:79], a[248:251], v[48:51], v[76:79]
    ds_read_b128 v[44:47], v11 offset:4096
    v_mfma_f32_16x16x32_bf16 v[80:83], a[252:255], v[48:51], v[80:83]
    s_add_u32 s22, s22, 2
    s_cmp_lt_u32 s22, 64
    s_cbranch_scc1 P_qk_top
    v_cvt_pk_bf16_f32 v84, v68, v69
    v_cvt_pk_bf16_f32 v85, v70, v71
    v_cvt_pk_bf16_f32 v86, v72, v73
    v_cvt_pk_bf16_f32 v87, v74, v75
    v_cvt_pk_bf16_f32 v88, v76, v77
    v_cvt_pk_bf16_f32 v89, v78, v79
    v_cvt_pk_bf16_f32 v90, v80, v81
    v_cvt_pk_bf16_f32 v91, v82, v83
    buffer_store_dwordx4 v[84:87], v3, s[4:7], s21 offen offset:0 sc1
    buffer_store_dwordx4 v[88:91], v3, s[4:7], s21 offen offset:256 sc1
    s_waitcnt vmcnt(0) lgkmcnt(0)
    v_mov_b32 v9, s23
    s_add_u32 s23, s23, 1
    buffer_store_dword v9, v4, s[4:7], 0 offen sc1
    s_branch W_U
P_v:
    s_mov_b32 s26, s25
    s_sub_u32 s25, s21, 1073741824
    s_mov_b32 s21, 1073741824
    s_mov_b32 s23, 0
    s_mov_b32 s22, 0
    s_add_u32 m0, s19, 0
    s_nop 0
    buffer_load_dwordx4 v2, s[8:11], s20 offen offset:0 lds
    s_add_u32 m0, s19, 3968
    s_nop 0
    buffer_load_dwordx4 v2, s[8:11], s20 offen offset:128 lds
    s_add_u32 m0, s19, 7936
    s_nop 0
    buffer_load_dwordx4 v2, s[8:11], s20 offen offset:256 lds
    s_add_u32 m0, s19, 11904
    s_nop 0
    buffer_load_dwordx4 v2, s[8:11], s20 offen offset:384 lds
    s_add_u32 m0, s19, 15872
    s_nop 0
    buffer_load_dwordx4 v2, s[8:11], s20 offen offset:512 lds
    s_add_u32 m0, s19, 19840
    s_nop 0
    buffer_load_dwordx4 v2, s[8:11], s20 offen offset:640 lds
    s_add_u32 m0, s19, 23808
    s_nop 0
    buffer_load_dwordx4 v2, s[8:11], s20 offen offset:768 lds
    s_add_u32 m0, s19, 27776
    s_nop 0
    buffer_load_dwordx4 v2, s[8:11], s20 offen offset:896 lds
    s_add_u32 m0, s19, 31744
    s_nop 0
    buffer_load_dwordx4 v2, s[8:11], s20 offen offset:1024 lds
    s_add_u32 m0, s19, 35712
    s_nop 0
    buffer_load_dwordx4 v2, s[8:11], s20 offen offset:1152 lds
    s_add_u32 m0, s19, 39680
    s_nop 0
    buffer_load_dwordx4 v2, s[8:11], s20 offen offset:1280 lds
    s_add_u32 m0, s19, 43648
    s_nop 0
    buffer_load_dwordx4 v2, s[8:11], s20 offen offset:1408 lds
    s_add_u32 m0, s19, 47616
    s_nop 0
    buffer_load_dwordx4 v2, s[8:11], s20 offen offset:1536 lds
    s_add_u32 m0, s19, 51584
    s_nop 0
    buffer_load_dwordx4 v2, s[8:11], s20 offen offset:1664 lds
    s_add_u32 m0, s19, 55552
    s_nop 0
    buffer_load_dwordx4 v2, s[8:11], s20 offen offset:1792 lds
    s_add_u32 m0, s19, 59520
    s_nop 0
    buffer_load_dwordx4 v2, s[8:11], s20 offen offset:1920 lds
    s_add_u32 s20, s20, s24
    s_add_u32 m0, s19, 65536
    s_nop 0
    buffer_load_dwordx4 v2, s[8:11], s20 offen offset:0 lds
    s_add_u32 m0, s19, 69504
    s_nop 0
    buffer_load_dwordx4 v2, s[8:11], s20 offen offset:128 lds
    s_add_u32 m0, s19, 73472
    s_nop 0
    buffer_load_dwordx4 v2, s[8:11], s20 offen offset:256 lds
    v_mov_b32 v9, s23
    s_add_u32 s23, s23, 1
    buffer_store_dword v9, v4, s[4:7], 0 offen sc1
    s_mov_b32 s23, 0
    s_waitcnt vmcnt(12)
    s_barrier
    ds_read_b128 v[20:23], v10 offset:0
    ds_read_b128 v[24:27], v10 offset:2048
    ds_read_b128 v[28:31], v11 offset:0
    ds_read_b128 v[32:35], v11 offset:2048
    ds_read_b128 v[36:39], v10 offset:4096
    ds_read_b128 v[40:43], v10 offset:6144
    ds_read_b128 v[44:47], v11 offset:4096
.p2align 6
P_v_top:
    s_waitcnt lgkmcnt(6)
    v_mfma_f32_16x16x32_bf16 v[52:55], v[20:23], a[0:3], 0
    ds_read_b128 v[48:51], v11 offset:6144
    v_mfma_f32_16x16x32_bf16 v[60:63], v[20:23], a[4:7], 0
    s_waitcnt lgkmcnt(6)
    v_mfma_f32_16x16x32_bf16 v[56:59], v[24:27], a[0:3], 0
    ds_read_b128 v[20:23], v10 offset:8192
    s_add_u32 m0, s19, 77440
    v_mfma_f32_16x16x32_bf16 v[64:67], v[24:27], a[4:7], 0
    buffer_load_dwordx4 v2, s[8:11], s20 offen offset:384 lds
    s_waitcnt lgkmcnt(6)
    v_mfma_f32_16x16x32_bf16 v[52:55], v[28:31], a[8:11], v[52:55]
    ds_read_b128 v[24:27], v10 offset:10240
    v_mfma_f32_16x16x32_bf16 v[60:63], v[28:31], a[12:15], v[60:63]
    s_waitcnt lgkmcnt(6)
    v_mfma_f32_16x16x32_bf16 v[56:59], v[32:35], a[8:11], v[56:59]
    ds_read_b128 v[28:31], v11 offset:8192
    s_add_u32 m0, s19, 81408
    v_mfma_f32_16x16x32_bf16 v[64:67], v[32:35], a[12:15], v[64:67]
    buffer_load_dwordx4 v2, s[8:11], s20 offen offset:512 lds
    s_waitcnt lgkmcnt(6)
    v_mfma_f32_16x16x32_bf16 v[52:55], v[36:39], a[16:19], v[52:55]
    ds_read_b128 v[32:35], v11 offset:10240
    v_mfma_f32_16x16x32_bf16 v[60:63], v[36:39], a[20:23], v[60:63]
    s_waitcnt lgkmcnt(6)
    v_mfma_f32_16x16x32_bf16 v[56:59], v[40:43], a[16:19], v[56:59]
    ds_read_b128 v[36:39], v10 offset:12288
    s_add_u32 m0, s19, 85376
    v_mfma_f32_16x16x32_bf16 v[64:67], v[40:43], a[20:23], v[64:67]
    buffer_load_dwordx4 v2, s[8:11], s20 offen offset:640 lds
    s_waitcnt lgkmcnt(6)
    v_mfma_f32_16x16x32_bf16 v[52:55], v[44:47], a[24:27], v[52:55]
    ds_read_b128 v[40:43], v10 offset:14336
    v_mfma_f32_16x16x32_bf16 v[60:63], v[44:47], a[28:31], v[60:63]
    s_waitcnt lgkmcnt(6)
    v_mfma_f32_16x16x32_bf16 v[56:59], v[48:51], a[24:27], v[56:59]
    ds_read_b128 v[44:47], v11 offset:12288
    s_add_u32 m0, s19, 89344
    v_mfma_f32_16x16x32_bf16 v[64:67], v[48:51], a[28:31], v[64:67]
    buffer_load_dwordx4 v2, s[8:11], s20 offen offset:768 lds
    s_waitcnt lgkmcnt(6)
    v_mfma_f32_16x16x32_bf16 v[52:55], v[20:23], a[32:35], v[52:55]
    ds_read_b128 v[48:51], v11 offset:14336
    v_mfma_f32_16x16x32_bf16 v[60:63], v[20:23], a[36:39], v[60:63]
    s_waitcnt lgkmcnt(6)
    v_mfma_f32_16x16x32_bf16 v[56:59], v[24:27], a[32:35], v[56:59]
    ds_read_b128 v[20:23], v10 offset:16384
    s_add_u32 m0, s19, 93312
    v_mfma_f32_16x16x32_bf16 v[64:67], v[24:27], a[36:39], v[64:67]
    buffer_load_dwordx4 v2, s[8:11], s20 offen offset:896 lds
    s_waitcnt lgkmcnt(6)
    v_mfma_f32_16x16x32_bf16 v[52:55], v[28:31], a[40:43], v[52:55]
    ds_read_b128 v[24:27], v10 offset:18432
    v_mfma_f32_16x16x32_bf16 v[60:63], v[28:31], a[44:47], v[60:63]
    v_cvt_pk_bf16_f32 v84, v68, v69
    s_waitcnt lgkmcnt(6)
    v_mfma_f32_16x16x32_bf16 v[56:59], v[32:35], a[40:43], v[56:59]
    ds_read_b128 v[28:31], v11 offset:16384
    v_mfma_f32_16x16x32_bf16 v[64:67], v[32:35], a[44:47], v[64:67]
    v_cvt_pk_bf16_f32 v85, v70, v71
    s_waitcnt lgkmcnt(6)
    v_mfma_f32_16x16x32_bf16 v[52:55], v[36:39], a[48:51], v[52:55]
    ds_read_b128 v[32:35], v11 offset:18432
    v_mfma_f32_16x16x32_bf16 v[60:63], v[36:39], a[52:55], v[60:63]
    v_cvt_pk_bf16_f32 v86, v72, v73
    s_waitcnt lgkmcnt(6)
    v_mfma_f32_16x16x32_bf16 v[56:59], v[40:43], a[48:51], v[56:59]
    ds_read_b128 v[36:39], v10 offset:20480
    v_mfma_f32_16x16x32_bf16 v[64:67], v[40:43], a[52:55], v[64:67]
    v_cvt_pk_bf16_f32 v87, v74, v75
    s_waitcnt lgkmcnt(6)
    v_mfma_f32_16x16x32_bf16 v[52:55], v[44:47], a[56:59], v[52:55]
    ds_read_b128 v[40:43], v10 offset:22528
    v_mfma_f32_16x16x32_bf16 v[60:63], v[44:47], a[60:63], v[60:63]
    v_cvt_pk_bf16_f32 v88, v76, v77
    s_waitcnt lgkmcnt(6)
    v_mfma_f32_16x16x32_bf16 v[56:59], v[48:51], a[56:59], v[56:59]
    ds_read_b128 v[44:47], v11 offset:20480
    v_mfma_f32_16x16x32_bf16 v[64:67], v[48:51], a[60:63], v[64:67]
    v_cvt_pk_bf16_f32 v89, v78, v79
    buffer_store_dwordx4 v[84:87], v3, s[4:7], s21 offen offset:0 sc1
    s_waitcnt lgkmcnt(6)
    v_mfma_f32_16x16x32_bf16 v[52:55], v[20:23], a[64:67], v[52:55]
    ds_read_b128 v[48:51], v11 offset:22528
    v_mfma_f32_16x16x32_bf16 v[60:63], v[20:23], a[68:71], v[60:63]
    v_cvt_pk_bf16_f32 v90, v80, v81
    s_waitcnt lgkmcnt(6)
    v_mfma_f32_16x16x32_bf16 v[56:59], v[24:27], a[64:67], v[56:59]
    ds_read_b128 v[20:23], v10 offset:24576
    v_mfma_f32_16x16x32_bf16 v[64:67], v[24:27], a[68:71], v[64:67]
    v_cvt_pk_bf16_f32 v91, v82, v83
    s_waitcnt lgkmcnt(6)
    v_mfma_f32_16x16x32_bf16 v[52:55], v[28:31], a[72:75], v[52:55]
    ds_read_b128 v[24:27], v10 offset:26624
    v_mfma_f32_16x16x32_bf16 v[60:63], v[28:31], a[76:79], v[60:63]
    s_waitcnt lgkmcnt(6)
    v_mfma_f32_16x16x32_bf16 v[56:59], v[32:35], a[72:75], v[56:59]
    ds_read_b128 v[28:31], v11 offset:24576
    v_mfma_f32_16x16x32_bf16 v[64:67], v[32:35], a[76:79], v[64:67]
    buffer_store_dwordx4 v[88:91], v3, s[4:7], s21 offen offset:256 sc1
    s_waitcnt lgkmcnt(6)
    v_mfma_f32_16x16x32_bf16 v[52:55], v[36:39], a[80:83], v[52:55]
    ds_read_b128 v[32:35], v11 offset:26624
    v_mfma_f32_16x16x32_bf16 v[60:63], v[36:39], a[84:87], v[60:63]
    s_add_u32 s21, s21, s25
    s_mov_b32 s25, s26
    s_waitcnt lgkmcnt(6)
    v_mfma_f32_16x16x32_bf16 v[56:59], v[40:43], a[80:83], v[56:59]
    ds_read_b128 v[36:39], v10 offset:28672
    v_mfma_f32_16x16x32_bf16 v[64:67], v[40:43], a[84:87], v[64:67]
    s_waitcnt lgkmcnt(6)
    v_mfma_f32_16x16x32_bf16 v[52:55], v[44:47], a[88:91], v[52:55]
    ds_read_b128 v[40:43], v10 offset:30720
    v_mfma_f32_16x16x32_bf16 v[60:63], v[44:47], a[92:95], v[60:63]
    s_waitcnt lgkmcnt(6)
    v_mfma_f32_16x16x32_bf16 v[56:59], v[48:51], a[88:91], v[56:59]
    ds_read_b128 v[44:47], v11 offset:28672
    v_mfma_f32_16x16x32_bf16 v[64:67], v[48:51], a[92:95], v[64:67]
    s_waitcnt lgkmcnt(6)
    v_mfma_f32_16x16x32_bf16 v[52:55], v[20:23], a[96:99], v[52:55]
    ds_read_b128 v[48:51], v11 offset:30720
    v_mfma_f32_16x16x32_bf16 v[60:63], v[20:23], a[100:103], v[60:63]
    s_waitcnt lgkmcnt(6)
    v_mfma_f32_16x16x32_bf16 v[56:59], v[24:27], a[96:99], v[56:59]
    s_waitcnt vmcnt(11)
    s_barrier
    ds_read_b128 v[20:23], v10 offset:32768
    v_mfma_f32_16x16x32_bf16 v[64:67], v[24:27], a[100:103], v[64:67]
    s_waitcnt lgkmcnt(6)
    v_mfma_f32_16x16x32_bf16 v[52:55], v[28:31], a[104:107], v[52:55]
    ds_read_b128 v[24:27], v10 offset:34816
    s_add_u32 m0, s19, 97280
    v_mfma_f32_16x16x32_bf16 v[60:63], v[28:31], a[108:111], v[60:63]
    buffer_load_dwordx4 v2, s[8:11], s20 offen offset:1024 lds
    s_waitcnt lgkmcnt(6)
    v_mfma_f32_16x16x32_bf16 v[56:59], v[32:35], a[104:107], v[56:59]
    ds_read_b128 v[28:31], v11 offset:32768
    v_mfma_f32_16x16x32_bf16 v[64:67], v[32:35], a[108:111], v[64:67]
    s_waitcnt lgkmcnt(6)
    v_mfma_f32_16x16x32_bf16 v[52:55], v[36:39], a[112:115], v[52:55]
    ds_read_b128 v[32:35], v11 offset:34816
    s_add_u32 m0, s19, 101248
    v_mfma_f32_16x16x32_bf16 v[60:63], v[36:39], a[116:119], v[60:63]
    buffer_load_dwordx4 v2, s[8:11], s20 offen offset:1152 lds
    s_waitcnt lgkmcnt(6)
    v_mfma_f32_16x16x32_bf16 v[56:59], v[40:43], a[112:115], v[56:59]
    ds_read_b128 v[36:39], v10 offset:36864
    v_mfma_f32_16x16x32_bf16 v[64:67], v[40:43], a[116:119], v[64:67]
    s_waitcnt lgkmcnt(6)
    v_mfma_f32_16x16x32_bf16 v[52:55], v[44:47], a[120:123], v[52:55]
    ds_read_b128 v[40:43], v10 offset:38912
    s_add_u32 m0, s19, 105216
    v_mfma_f32_16x16x32_bf16 v[60:63], v[44:47], a[124:127], v[60:63]
    buffer_load_dwordx4 v2, s[8:11], s20 offen offset:1280 lds
    s_waitcnt lgkmcnt(6)
    v_mfma_f32_16x16x32_bf16 v[56:59], v[48:51], a[120:123], v[56:59]
    ds_read_b128 v[44:47], v11 offset:36864
    v_mfma_f32_16x16x32_bf16 v[64:67], v[48:51], a[124:127], v[64:67]
    s_waitcnt lgkmcnt(6)
    v_mfma_f32_16x16x32_bf16 v[52:55], v[20:23], a[128:131], v[52:55]
    ds_read_b128 v[48:51], v11 offset:38912
    v_mfma_f32_16x16x32_bf16 v[60:63], v[20:23], a[132:135], v[60:63]
    s_waitcnt lgkmcnt(6)
    v_mfma_f32_16x16x32_bf16 v[56:59], v[24:27], a[128:131], v[56:59]
    ds_read_b128 v[20:23], v10 offset:40960
    s_add_u32 m0, s19, 109184
    v_mfma_f32_16x16x32_bf16 v[64:67], v[24:27], a[132:135], v[64:67]
    buffer_load_dwordx4 v2, s[8:11], s20 offen offset:1408 lds
    s_waitcnt lgkmcnt(6)
    v_mfma_f32_16x16x32_bf16 v[52:55], v[28:31], a[136:139], v[52:55]
    ds_read_b128 v[24:27], v10 offset:43008
    v_mfma_f32_16x16x32_bf16 v[60:63], v[28:31], a[140:143], v[60:63]
    s_waitcnt lgkmcnt(6)
    v_mfma_f32_16x16x32_bf16 v[56:59], v[32:35], a[136:139], v[56:59]
    ds_read_b128 v[28:31], v11 offset:40960
    s_add_u32 m0, s19, 113152
    v_mfma_f32_16x16x32_bf16 v[64:67], v[32:35], a[140:143], v[64:67]
    buffer_load_dwordx4 v2, s[8:11], s20 offen offset:1536 lds
    s_waitcnt lgkmcnt(6)
    v_mfma_f32_16x16x32_bf16 v[52:55], v[36:39], a[144:147], v[52:55]
    ds_read_b128 v[32:35], v11 offset:43008
    v_mfma_f32_16x16x32_bf16 v[60:63], v[36:39], a[148:151], v[60:63]
    s_waitcnt lgkmcnt(6)
    v_mfma_f32_16x16x32_bf16 v[56:59], v[40:43], a[144:147], v[56:59]
    ds_read_b128 v[36:39], v10 offset:45056
    s_add_u32 m0, s19, 117120
    v_mfma_f32_16x16x32_bf16 v[64:67], v[40:43], a[148:151], v[64:67]
    buffer_load_dwordx4 v2, s[8:11], s20 offen offset:1664 lds
    s_waitcnt lgkmcnt(6)
    v_mfma_f32_16x16x32_bf16 v[52:55], v[44:47], a[152:155], v[52:55]
    ds_read_b128 v[40:43], v10 offset:47104
    v_mfma_f32_16x16x32_bf16 v[60:63], v[44:47], a[156:159], v[60:63]
    s_waitcnt lgkmcnt(6)
    v_mfma_f32_16x16x32_bf16 v[56:59], v[48:51], a[152:155], v[56:59]
    ds_read_b128 v[44:47], v11 offset:45056
    s_add_u32 m0, s19, 121088
    v_mfma_f32_16x16x32_bf16 v[64:67], v[48:51], a[156:159], v[64:67]
    buffer_load_dwordx4 v2, s[8:11], s20 offen offset:1792 lds
    s_waitcnt lgkmcnt(6)
    v_mfma_f32_16x16x32_bf16 v[52:55], v[20:23], a[160:163], v[52:55]
    ds_read_b128 v[48:51], v11 offset:47104
    v_mfma_f32_16x16x32_bf16 v[60:63], v[20:23], a[164:167], v[60:63]
    s_waitcnt lgkmcnt(6)
    v_mfma_f32_16x16x32_bf16 v[56:59], v[24:27], a[160:163], v[56:59]
    ds_read_b128 v[20:23], v10 offset:49152
    s_add_u32 m0, s19, 125056
    v_mfma_f32_16x16x32_bf16 v[64:67], v[24:27], a[164:167], v[64:67]
    buffer_load_dwordx4 v2, s[8:11], s20 offen offset:1920 lds
    s_waitcnt lgkmcnt(6)
    v_mfma_f32_16x16x32_bf16 v[52:55], v[28:31], a[168:171], v[52:55]
    ds_read_b128 v[24:27], v10 offset:51200
    v_mfma_f32_16x16x32_bf16 v[60:63], v[28:31], a[172:175], v[60:63]
    s_add_u32 s20, s20, s24
    s_waitcnt lgkmcnt(6)
    v_mfma_f32_16x16x32_bf16 v[56:59], v[32:35], a[168:171], v[56:59]
    ds_read_b128 v[28:31], v11 offset:49152
    v_mfma_f32_16x16x32_bf16 v[64:67], v[32:35], a[172:175], v[64:67]
    s_waitcnt lgkmcnt(6)
    v_mfma_f32_16x16x32_bf16 v[52:55], v[36:39], a[176:179], v[52:55]
    ds_read_b128 v[32:35], v11 offset:51200
    v_mfma_f32_16x16x32_bf16 v[60:63], v[36:39], a[180:183], v[60:63]
    s_waitcnt lgkmcnt(6)
    v_mfma_f32_16x16x32_bf16 v[56:59], v[40:43], a[176:179], v[56:59]
    ds_read_b128 v[36:39], v10 offset:53248
    v_mfma_f32_16x16x32_bf16 v[64:67], v[40:43], a[180:183], v[64:67]
    s_waitcnt lgkmcnt(6)
    v_mfma_f32_16x16x32_bf16 v[52:55], v[44:47], a[184:187], v[52:55]
    ds_read_b128 v[40:43], v10 offset:55296
    v_mfma_f32_16x16x32_bf16 v[60:63], v[44:47], a[188:191], v[60:63]
    s_waitcnt lgkmcnt(6)
    v_mfma_f32_16x16x32_bf16 v[56:59], v[48:51], a[184:187], v[56:59]
    ds_read_b128 v[44:47], v11 offset:53248
    v_mfma_f32_16x16x32_bf16 v[64:67], v[48:51], a[188:191], v[64:67]
    s_waitcnt lgkmcnt(6)
    v_mfma_f32_16x16x32_bf16 v[52:55], v[20:23], a[192:195], v[52:55]
    ds_read_b128 v[48:51], v11 offset:55296
    v_mfma_f32_16x16x32_bf16 v[60:63], v[20:23], a[196:199], v[60:63]
    s_waitcnt lgkmcnt(6)
    v_mfma_f32_16x16x32_bf16 v[56:59], v[24:27], a[192:195], v[56:59]
    ds_read_b128 v[20:23], v10 offset:57344
    v_mfma_f32_16x16x32_bf16 v[64:67], v[24:27], a[196:199], v[64:67]
    s_waitcnt lgkmcnt(6)
    v_mfma_f32_16x16x32_bf16 v[52:55], v[28:31], a[200:203], v[52:55]
    ds_read_b128 v[24:27], v10 offset:59392
    v_mfma_f32_16x16x32_bf16 v[60:63], v[28:31], a[204:207], v[60:63]
    s_waitcnt lgkmcnt(6)
    v_mfma_f32_16x16x32_bf16 v[56:59], v[32:35], a[200:203], v[56:59]
    ds_read_b128 v[28:31], v11 offset:57344
    v_mfma_f32_16x16x32_bf16 v[64:67], v[32:35], a[204:207], v[64:67]
    s_waitcnt lgkmcnt(6)
    v_mfma_f32_16x16x32_bf16 v[52:55], v[36:39], a[208:211], v[52:55]
    ds_read_b128 v[32:35], v11 offset:59392
    v_mfma_f32_16x16x32_bf16 v[60:63], v[36:39], a[212:215], v[60:63]
    s_waitcnt lgkmcnt(6)
    v_mfma_f32_16x16x32_bf16 v[56:59], v[40:43], a[208:211], v[56:59]
    ds_read_b128 v[36:39], v10 offset:61440
    v_mfma_f32_16x16x32_bf16 v[64:67], v[40:43], a[212:215], v[64:67]
    s_waitcnt lgkmcnt(6)
    v_mfma_f32_16x16x32_bf16 v[52:55], v[44:47], a[216:219], v[52:55]
    ds_read_b128 v[40:43], v10 offset:63488
    v_mfma_f32_16x16x32_bf16 v[60:63], v[44:47], a[220:223], v[60:63]
    s_waitcnt lgkmcnt(6)
    v_mfma_f32_16x16x32_bf16 v[56:59], v[48:51], a[216:219], v[56:59]
    ds_read_b128 v[44:47], v11 offset:61440
    v_mfma_f32_16x16x32_bf16 v[64:67], v[48:51], a[220:223], v[64:67]
    s_waitcnt lgkmcnt(6)
    v_mfma_f32_16x16x32_bf16 v[52:55], v[20:23], a[224:227], v[52:55]
    ds_read_b128 v[48:51], v11 offset:63488
    v_mfma_f32_16x16x32_bf16 v[60:63], v[20:23], a[228:231], v[60:63]
    s_waitcnt lgkmcnt(6)
    v_mfma_f32_16x16x32_bf16 v[56:59], v[24:27], a[224:227], v[56:59]
    s_waitcnt vmcnt(8)
    s_barrier
    ds_read_b128 v[20:23], v12 offset:0
    v_mfma_f32_16x16x32_bf16 v[64:67], v[24:27], a[228:231], v[64:67]
    s_waitcnt lgkmcnt(6)
    v_mfma_f32_16x16x32_bf16 v[52:55], v[28:31], a[232:235], v[52:55]
    ds_read_b128 v[24:27], v12 offset:2048
    s_add_u32 m0, s19, 0
    v_mfma_f32_16x16x32_bf16 v[60:63], v[28:31], a[236:239], v[60:63]
    buffer_load_dwordx4 v2, s[8:11], s20 offen offset:0 lds
    s_waitcnt lgkmcnt(6)
    v_mfma_f32_16x16x32_bf16 v[56:59], v[32:35], a[232:235], v[56:59]
    ds_read_b128 v[28:31], v13 offset:0
    v_mfma_f32_16x16x32_bf16 v[64:67], v[32:35], a[236:239], v[64:67]
    v_mov_b32 v9, s23
    s_add_u32 s23, s23, 1
    buffer_store_dword v9, v4, s[4:7], 0 offen sc1
    s_waitcnt lgkmcnt(6)
    v_mfma_f32_16x16x32_bf16 v[52:55], v[36:39], a[240:243], v[52:55]
    ds_read_b128 v[32:35], v13 offset:2048
    s_add_u32 m0, s19, 3968
    v_mfma_f32_16x16x32_bf16 v[60:63], v[36:39], a[244:247], v[60:63]
    buffer_load_dwordx4 v2, s[8:11], s20 offen offset:128 lds
    s_waitcnt lgkmcnt(6)
    v_mfma_f32_16x16x32_bf16 v[56:59], v[40:43], a[240:243], v[56:59]
    ds_read_b128 v[36:39], v12 offset:4096
    v_mfma_f32_16x16x32_bf16 v[64:67], v[40:43], a[244:247], v[64:67]
    s_waitcnt lgkmcnt(6)
    v_mfma_f32_16x16x32_bf16 v[52:55], v[44:47], a[248:251], v[52:55]
    ds_read_b128 v[40:43], v12 offset:6144
    s_add_u32 m0, s19, 7936
    v_mfma_f32_16x16x32_bf16 v[60:63], v[44:47], a[252:255], v[60:63]
    buffer_load_dwordx4 v2, s[8:11], s20 offen offset:256 lds
    s_waitcnt lgkmcnt(6)
    v_mfma_f32_16x16x32_bf16 v[56:59], v[48:51], a[248:251], v[56:59]
    ds_read_b128 v[44:47], v13 offset:4096
    v_mfma_f32_16x16x32_bf16 v[64:67], v[48:51], a[252:255], v[64:67]
    s_waitcnt lgkmcnt(6)
    v_mfma_f32_16x16x32_bf16 v[68:71], v[20:23], a[0:3], 0
    ds_read_b128 v[48:51], v13 offset:6144
    v_mfma_f32_16x16x32_bf16 v[76:79], v[20:23], a[4:7], 0
    s_waitcnt lgkmcnt(6)
    v_mfma_f32_16x16x32_bf16 v[72:75], v[24:27], a[0:3], 0
    ds_read_b128 v[20:23], v12 offset:8192
    s_add_u32 m0, s19, 11904
    v_mfma_f32_16x16x32_bf16 v[80:83], v[24:27], a[4:7], 0
    buffer_load_dwordx4 v2, s[8:11], s20 offen offset:384 lds
    s_waitcnt lgkmcnt(6)
    v_mfma_f32_16x16x32_bf16 v[68:71], v[28:31], a[8:11], v[68:71]
    ds_read_b128 v[24:27], v12 offset:10240
    v_mfma_f32_16x16x32_bf16 v[76:79], v[28:31], a[12:15], v[76:79]
    s_waitcnt lgkmcnt(6)
    v_mfma_f32_16x16x32_bf16 v[72:75], v[32:35], a[8:11], v[72:75]
    ds_read_b128 v[28:31], v13 offset:8192
    s_add_u32 m0, s19, 15872
    v_mfma_f32_16x16x32_bf16 v[80:83], v[32:35], a[12:15], v[80:83]
    buffer_load_dwordx4 v2, s[8:11], s20 offen offset:512 lds
    s_waitcnt lgkmcnt(6)
    v_mfma_f32_16x16x32_bf16 v[68:71], v[36:39], a[16:19], v[68:71]
    ds_read_b128 v[32:35], v13 offset:10240
    v_mfma_f32_16x16x32_bf16 v[76:79], v[36:39], a[20:23], v[76:79]
    s_waitcnt lgkmcnt(6)
    v_mfma_f32_16x16x32_bf16 v[72:75], v[40:43], a[16:19], v[72:75]
    ds_read_b128 v[36:39], v12 offset:12288
    s_add_u32 m0, s19, 19840
    v_mfma_f32_16x16x32_bf16 v[80:83], v[40:43], a[20:23], v[80:83]
    buffer_load_dwordx4 v2, s[8:11], s20 offen offset:640 lds
    s_waitcnt lgkmcnt(6)
    v_mfma_f32_16x16x32_bf16 v[68:71], v[44:47], a[24:27], v[68:71]
    ds_read_b128 v[40:43], v12 offset:14336
    v_mfma_f32_16x16x32_bf16 v[76:79], v[44:47], a[28:31], v[76:79]
    s_waitcnt lgkmcnt(6)
    v_mfma_f32_16x16x32_bf16 v[72:75], v[48:51], a[24:27], v[72:75]
    ds_read_b128 v[44:47], v13 offset:12288
    s_add_u32 m0, s19, 23808
    v_mfma_f32_16x16x32_bf16 v[80:83], v[48:51], a[28:31], v[80:83]
    buffer_load_dwordx4 v2, s[8:11], s20 offen offset:768 lds
    s_waitcnt lgkmcnt(6)
    v_mfma_f32_16x16x32_bf16 v[68:71], v[20:23], a[32:35], v[68:71]
    ds_read_b128 v[48:51], v13 offset:14336
    v_mfma_f32_16x16x32_bf16 v[76:79], v[20:23], a[36:39], v[76:79]
    s_waitcnt lgkmcnt(6)
    v_mfma_f32_16x16x32_bf16 v[72:75], v[24:27], a[32:35], v[72:75]
    ds_read_b128 v[20:23], v12 offset:16384
    s_add_u32 m0, s19, 27776
    v_mfma_f32_16x16x32_bf16 v[80:83], v[24:27], a[36:39], v[80:83]
    buffer_load_dwordx4 v2, s[8:11], s20 offen offset:896 lds
    s_waitcnt lgkmcnt(6)
    v_mfma_f32_16x16x32_bf16 v[68:71], v[28:31], a[40:43], v[68:71]
    ds_read_b128 v[24:27], v12 offset:18432
    v_mfma_f32_16x16x32_bf16 v[76:79], v[28:31], a[44:47], v[76:79]
    v_cvt_pk_bf16_f32 v84, v52, v53
    s_waitcnt lgkmcnt(6)
    v_mfma_f32_16x16x32_bf16 v[72:75], v[32:35], a[40:43], v[72:75]
    ds_read_b128 v[28:31], v13 offset:16384
    v_mfma_f32_16x16x32_bf16 v[80:83], v[32:35], a[44:47], v[80:83]
    v_cvt_pk_bf16_f32 v85, v54, v55
    s_waitcnt lgkmcnt(6)
    v_mfma_f32_16x16x32_bf16 v[68:71], v[36:39], a[48:51], v[68:71]
    ds_read_b128 v[32:35], v13 offset:18432
    v_mfma_f32_16x16x32_bf16 v[76:79], v[36:39], a[52:55], v[76:79]
    v_cvt_pk_bf16_f32 v86, v56, v57
    s_waitcnt lgkmcnt(6)
    v_mfma_f32_16x16x32_bf16 v[72:75], v[40:43], a[48:51], v[72:75]
    ds_read_b128 v[36:39], v12 offset:20480
    v_mfma_f32_16x16x32_bf16 v[80:83], v[40:43], a[52:55], v[80:83]
    v_cvt_pk_bf16_f32 v87, v58, v59
    s_waitcnt lgkmcnt(6)
    v_mfma_f32_16x16x32_bf16 v[68:71], v[44:47], a[56:59], v[68:71]
    ds_read_b128 v[40:43], v12 offset:22528
    v_mfma_f32_16x16x32_bf16 v[76:79], v[44:47], a[60:63], v[76:79]
    v_cvt_pk_bf16_f32 v88, v60, v61
    s_waitcnt lgkmcnt(6)
    v_mfma_f32_16x16x32_bf16 v[72:75], v[48:51], a[56:59], v[72:75]
    ds_read_b128 v[44:47], v13 offset:20480
    v_mfma_f32_16x16x32_bf16 v[80:83], v[48:51], a[60:63], v[80:83]
    v_cvt_pk_bf16_f32 v89, v62, v63
    buffer_store_dwordx4 v[84:87], v3, s[4:7], s21 offen offset:0 sc1
    s_waitcnt lgkmcnt(6)
    v_mfma_f32_16x16x32_bf16 v[68:71], v[20:23], a[64:67], v[68:71]
    ds_read_b128 v[48:51], v13 offset:22528
    v_mfma_f32_16x16x32_bf16 v[76:79], v[20:23], a[68:71], v[76:79]
    v_cvt_pk_bf16_f32 v90, v64, v65
    s_waitcnt lgkmcnt(6)
    v_mfma_f32_16x16x32_bf16 v[72:75], v[24:27], a[64:67], v[72:75]
    ds_read_b128 v[20:23], v12 offset:24576
    v_mfma_f32_16x16x32_bf16 v[80:83], v[24:27], a[68:71], v[80:83]
    v_cvt_pk_bf16_f32 v91, v66, v67
    s_waitcnt lgkmcnt(6)
    v_mfma_f32_16x16x32_bf16 v[68:71], v[28:31], a[72:75], v[68:71]
    ds_read_b128 v[24:27], v12 offset:26624
    v_mfma_f32_16x16x32_bf16 v[76:79], v[28:31], a[76:79], v[76:79]
    s_waitcnt lgkmcnt(6)
    v_mfma_f32_16x16x32_bf16 v[72:75], v[32:35], a[72:75], v[72:75]
    ds_read_b128 v[28:31], v13 offset:24576
    v_mfma_f32_16x16x32_bf16 v[80:83], v[32:35], a[76:79], v[80:83]
    buffer_store_dwordx4 v[88:91], v3, s[4:7], s21 offen offset:256 sc1
    s_waitcnt lgkmcnt(6)
    v_mfma_f32_16x16x32_bf16 v[68:71], v[36:39], a[80:83], v[68:71]
    ds_read_b128 v[32:35], v13 offset:26624
    v_mfma_f32_16x16x32_bf16 v[76:79], v[36:39], a[84:87], v[76:79]
    s_add_u32 s21, s21, s25
    s_mov_b32 s25, s26
    s_waitcnt lgkmcnt(6)
    v_mfma_f32_16x16x32_bf16 v[72:75], v[40:43], a[80:83], v[72:75]
    ds_read_b128 v[36:39], v12 offset:28672
    v_mfma_f32_16x16x32_bf16 v[80:83], v[40:43], a[84:87], v[80:83]
    s_waitcnt lgkmcnt(6)
    v_mfma_f32_16x16x32_bf16 v[68:71], v[44:47], a[88:91], v[68:71]
    ds_read_b128 v[40:43], v12 offset:30720
    v_mfma_f32_16x16x32_bf16 v[76:79], v[44:47], a[92:95], v[76:79]
    s_waitcnt lgkmcnt(6)
    v_mfma_f32_16x16x32_bf16 v[72:75], v[48:51], a[88:91], v[72:75]
    ds_read_b128 v[44:47], v13 offset:28672
    v_mfma_f32_16x16x32_bf16 v[80:83], v[48:51], a[92:95], v[80:83]
    s_waitcnt lgkmcnt(6)
    v_mfma_f32_16x16x32_bf16 v[68:71], v[20:23], a[96:99], v[68:71]
    ds_read_b128 v[48:51], v13 offset:30720
    v_mfma_f32_16x16x32_bf16 v[76:79], v[20:23], a[100:103], v[76:79]
    s_waitcnt lgkmcnt(6)
    v_mfma_f32_16x16x32_bf16 v[72:75], v[24:27], a[96:99], v[72:75]
    s_waitcnt vmcnt(11)
    s_barrier
    ds_read_b128 v[20:23], v12 offset:32768
    v_mfma_f32_16x16x32_bf16 v[80:83], v[24:27], a[100:103], v[80:83]
    s_waitcnt lgkmcnt(6)
    v_mfma_f32_16x16x32_bf16 v[68:71], v[28:31], a[104:107], v[68:71]
    ds_read_b128 v[24:27], v12 offset:34816
    s_add_u32 m0, s19, 31744
    v_mfma_f32_16x16x32_bf16 v[76:79], v[28:31], a[108:111], v[76:79]
    buffer_load_dwordx4 v2, s[8:11], s20 offen offset:1024 lds
    s_waitcnt lgkmcnt(6)
    v_mfma_f32_16x16x32_bf16 v[72:75], v[32:35], a[104:107], v[72:75]
    ds_read_b128 v[28:31], v13 offset:32768
    v_mfma_f32_16x16x32_bf16 v[80:83], v[32:35], a[108:111], v[80:83]
    s_waitcnt lgkmcnt(6)
    v_mfma_f32_16x16x32_bf16 v[68:71], v[36:39], a[112:115], v[68:71]
    ds_read_b128 v[32:35], v13 offset:34816
    s_add_u32 m0, s19, 35712
    v_mfma_f32_16x16x32_bf16 v[76:79], v[36:39], a[116:119], v[76:79]
    buffer_load_dwordx4 v2, s[8:11], s20 offen offset:1152 lds
    s_waitcnt lgkmcnt(6)
    v_mfma_f32_16x16x32_bf16 v[72:75], v[40:43], a[112:115], v[72:75]
    ds_read_b128 v[36:39], v12 offset:36864
    v_mfma_f32_16x16x32_bf16 v[80:83], v[40:43], a[116:119], v[80:83]
    s_waitcnt lgkmcnt(6)
    v_mfma_f32_16x16x32_bf16 v[68:71], v[44:47], a[120:123], v[68:71]
    ds_read_b128 v[40:43], v12 offset:38912
    s_add_u32 m0, s19, 39680
    v_mfma_f32_16x16x32_bf16 v[76:79], v[44:47], a[124:127], v[76:79]
    buffer_load_dwordx4 v2, s[8:11], s20 offen offset:1280 lds
    s_waitcnt lgkmcnt(6)
    v_mfma_f32_16x16x32_bf16 v[72:75], v[48:51], a[120:123], v[72:75]
    ds_read_b128 v[44:47], v13 offset:36864
    v_mfma_f32_16x16x32_bf16 v[80:83], v[48:51], a[124:127], v[80:83]
    s_waitcnt lgkmcnt(6)
    v_mfma_f32_16x16x32_bf16 v[68:71], v[20:23], a[128:131], v[68:71]
    ds_read_b128 v[48:51], v13 offset:38912
    v_mfma_f32_16x16x32_bf16 v[76:79], v[20:23], a[132:135], v[76:79]
    s_waitcnt lgkmcnt(6)
    v_mfma_f32_16x16x32_bf16 v[72:75], v[24:27], a[128:131], v[72:75]
    ds_read_b128 v[20:23], v12 offset:40960
    s_add_u32 m0, s19, 43648
    v_mfma_f32_16x16x32_bf16 v[80:83], v[24:27], a[132:135], v[80:83]
    buffer_load_dwordx4 v2, s[8:11], s20 offen offset:1408 lds
    s_waitcnt lgkmcnt(6)
    v_mfma_f32_16x16x32_bf16 v[68:71], v[28:31], a[136:139], v[68:71]
    ds_read_b128 v[24:27], v12 offset:43008
    v_mfma_f32_16x16x32_bf16 v[76:79], v[28:31], a[140:143], v[76:79]
    s_waitcnt lgkmcnt(6)
    v_mfma_f32_16x16x32_bf16 v[72:75], v[32:35], a[136:139], v[72:75]
    ds_read_b128 v[28:31], v13 offset:40960
    s_add_u32 m0, s19, 47616
    v_mfma_f32_16x16x32_bf16 v[80:83], v[32:35], a[140:143], v[80:83]
    buffer_load_dwordx4 v2, s[8:11], s20 offen offset:1536 lds
    s_waitcnt lgkmcnt(6)
    v_mfma_f32_16x16x32_bf16 v[68:71], v[36:39], a[144:147], v[68:71]
    ds_read_b128 v[32:35], v13 offset:43008
    v_mfma_f32_16x16x32_bf16 v[76:79], v[36:39], a[148:151], v[76:79]
    s_waitcnt lgkmcnt(6)
    v_mfma_f32_16x16x32_bf16 v[72:75], v[40:43], a[144:147], v[72:75]
    ds_read_b128 v[36:39], v12 offset:45056
    s_add_u32 m0, s19, 51584
    v_mfma_f32_16x16x32_bf16 v[80:83], v[40:43], a[148:151], v[80:83]
    buffer_load_dwordx4 v2, s[8:11], s20 offen offset:1664 lds
    s_waitcnt lgkmcnt(6)
    v_mfma_f32_16x16x32_bf16 v[68:71], v[44:47], a[152:155], v[68:71]
    ds_read_b128 v[40:43], v12 offset:47104
    v_mfma_f32_16x16x32_bf16 v[76:79], v[44:47], a[156:159], v[76:79]
    s_waitcnt lgkmcnt(6)
    v_mfma_f32_16x16x32_bf16 v[72:75], v[48:51], a[152:155], v[72:75]
    ds_read_b128 v[44:47], v13 offset:45056
    s_add_u32 m0, s19, 55552
    v_mfma_f32_16x16x32_bf16 v[80:83], v[48:51], a[156:159], v[80:83]
    buffer_load_dwordx4 v2, s[8:11], s20 offen offset:1792 lds
    s_waitcnt lgkmcnt(6)
    v_mfma_f32_16x16x32_bf16 v[68:71], v[20:23], a[160:163], v[68:71]
    ds_read_b128 v[48:51], v13 offset:47104
    v_mfma_f32_16x16x32_bf16 v[76:79], v[20:23], a[164:167], v[76:79]
    s_waitcnt lgkmcnt(6)
    v_mfma_f32_16x16x32_bf16 v[72:75], v[24:27], a[160:163], v[72:75]
    ds_read_b128 v[20:23], v12 offset:49152
    s_add_u32 m0, s19, 59520
    v_mfma_f32_16x16x32_bf16 v[80:83], v[24:27], a[164:167], v[80:83]
    buffer_load_dwordx4 v2, s[8:11], s20 offen offset:1920 lds
    s_waitcnt lgkmcnt(6)
    v_mfma_f32_16x16x32_bf16 v[68:71], v[28:31], a[168:171], v[68:71]
    ds_read_b128 v[24:27], v12 offset:51200
    v_mfma_f32_16x16x32_bf16 v[76:79], v[28:31], a[172:175], v[76:79]
    s_add_u32 s20, s20, s24
    s_waitcnt lgkmcnt(6)
    v_mfma_f32_16x16x32_bf16 v[72:75], v[32:35], a[168:171], v[72:75]
    ds_read_b128 v[28:31], v13 offset:49152
    v_mfma_f32_16x16x32_bf16 v[80:83], v[32:35], a[172:175], v[80:83]
    s_waitcnt lgkmcnt(6)
    v_mfma_f32_16x16x32_bf16 v[68:71], v[36:39], a[176:179], v[68:71]
    ds_read_b128 v[32:35], v13 offset:51200
    v_mfma_f32_16x16x32_bf16 v[76:79], v[36:39], a[180:183], v[76:79]
    s_waitcnt lgkmcnt(6)
    v_mfma_f32_16x16x32_bf16 v[72:75], v[40:43], a[176:179], v[72:75]
    ds_read_b128 v[36:39], v12 offset:53248
    v_mfma_f32_16x16x32_bf16 v[80:83], v[40:43], a[180:183], v[80:83]
    s_waitcnt lgkmcnt(6)
    v_mfma_f32_16x16x32_bf16 v[68:71], v[44:47], a[184:187], v[68:71]
    ds_read_b128 v[40:43], v12 offset:55296
    v_mfma_f32_16x16x32_bf16 v[76:79], v[44:47], a[188:191], v[76:79]
    s_waitcnt lgkmcnt(6)
    v_mfma_f32_16x16x32_bf16 v[72:75], v[48:51], a[184:187], v[72:75]
    ds_read_b128 v[44:47], v13 offset:53248
    v_mfma_f32_16x16x32_bf16 v[80:83], v[48:51], a[188:191], v[80:83]
    s_waitcnt lgkmcnt(6)
    v_mfma_f32_16x16x32_bf16 v[68:71], v[20:23], a[192:195], v[68:71]
    ds_read_b128 v[48:51], v13 offset:55296
    v_mfma_f32_16x16x32_bf16 v[76:79], v[20:23], a[196:199], v[76:79]
    s_waitcnt lgkmcnt(6)
    v_mfma_f32_16x16x32_bf16 v[72:75], v[24:27], a[192:195], v[72:75]
    ds_read_b128 v[20:23], v12 offset:57344
    v_mfma_f32_16x16x32_bf16 v[80:83], v[24:27], a[196:199], v[80:83]
    s_waitcnt lgkmcnt(6)
    v_mfma_f32_16x16x32_bf16 v[68:71], v[28:31], a[200:203], v[68:71]
    ds_read_b128 v[24:27], v12 offset:59392
    v_mfma_f32_16x16x32_bf16 v[76:79], v[28:31], a[204:207], v[76:79]
    s_waitcnt lgkmcnt(6)
    v_mfma_f32_16x16x32_bf16 v[72:75], v[32:35], a[200:203], v[72:75]
    ds_read_b128 v[28:31], v13 offset:57344
    v_mfma_f32_16x16x32_bf16 v[80:83], v[32:35], a[204:207], v[80:83]
    s_waitcnt lgkmcnt(6)
    v_mfma_f32_16x16x32_bf16 v[68:71], v[36:39], a[208:211], v[68:71]
    ds_read_b128 v[32:35], v13 offset:59392
    v_mfma_f32_16x16x32_bf16 v[76:79], v[36:39], a[212:215], v[76:79]
    s_waitcnt lgkmcnt(6)
    v_mfma_f32_16x16x32_bf16 v[72:75], v[40:43], a[208:211], v[72:75]
    ds_read_b128 v[36:39], v12 offset:61440
    v_mfma_f32_16x16x32_bf16 v[80:83], v[40:43], a[212:215], v[80:83]
    s_waitcnt lgkmcnt(6)
    v_mfma_f32_16x16x32_bf16 v[68:71], v[44:47], a[216:219], v[68:71]
    ds_read_b128 v[40:43], v12 offset:63488
    v_mfma_f32_16x16x32_bf16 v[76:79], v[44:47], a[220:223], v[76:79]
    s_waitcnt lgkmcnt(6)
    v_mfma_f32_16x16x32_bf16 v[72:75], v[48:51], a[216:219], v[72:75]
    ds_read_b128 v[44:47], v13 offset:61440
    v_mfma_f32_16x16x32_bf16 v[80:83], v[48:51], a[220:223], v[80:83]
    s_waitcnt lgkmcnt(6)
    v_mfma_f32_16x16x32_bf16 v[68:71], v[20:23], a[224:227], v[68:71]
    ds_read_b128 v[48:51], v13 offset:63488
    v_mfma_f32_16x16x32_bf16 v[76:79], v[20:23], a[228:231], v[76:79]
    s_waitcnt lgkmcnt(6)
    v_mfma_f32_16x16x32_bf16 v[72:75], v[24:27], a[224:227], v[72:75]
    s_waitcnt vmcnt(8)
    s_barrier
    ds_read_b128 v[20:23], v10 offset:0
    v_mfma_f32_16x16x32_bf16 v[80:83], v[24:27], a[228:231], v[80:83]
    s_waitcnt lgkmcnt(6)
    v_mfma_f32_16x16x32_bf16 v[68:71], v[28:31], a[232:235], v[68:71]
    ds_read_b128 v[24:27], v10 offset:2048
    s_add_u32 m0, s19, 65536
    v_mfma_f32_16x16x32_bf16 v[76:79], v[28:31], a[236:239], v[76:79]
    buffer_load_dwordx4 v2, s[8:11], s20 offen offset:0 lds
    s_waitcnt lgkmcnt(6)
    v_mfma_f32_16x16x32_bf16 v[72:75], v[32:35], a[232:235], v[72:75]
    ds_read_b128 v[28:31], v11 offset:0
    v_mfma_f32_16x16x32_bf16 v[80:83], v[32:35], a[236:239], v[80:83]
    v_mov_b32 v9, s23
    s_add_u32 s23, s23, 1
    buffer_store_dword v9, v4, s[4:7], 0 offen sc1
    s_waitcnt lgkmcnt(6)
    v_mfma_f32_16x16x32_bf16 v[68:71], v[36:39], a[240:243], v[68:71]
    ds_read_b128 v[32:35], v11 offset:2048
    s_add_u32 m0, s19, 69504
    v_mfma_f32_16x16x32_bf16 v[76:79], v[36:39], a[244:247], v[76:79]
    buffer_load_dwordx4 v2, s[8:11], s20 offen offset:128 lds
    s_waitcnt lgkmcnt(6)
    v_mfma_f32_16x16x32_bf16 v[72:75], v[40:43], a[240:243], v[72:75]
    ds_read_b128 v[36:39], v10 offset:4096
    v_mfma_f32_16x16x32_bf16 v[80:83], v[40:43], a[244:247], v[80:83]
    s_waitcnt lgkmcnt(6)
    v_mfma_f32_16x16x32_bf16 v[68:71], v[44:47], a[248:251], v[68:71]
    ds_read_b128 v[40:43], v10 offset:6144
    s_add_u32 m0, s19, 73472
    v_mfma_f32_16x16x32_bf16 v[76:79], v[44:47], a[252:255], v[76:79]
    buffer_load_dwordx4 v2, s[8:11], s20 offen offset:256 lds
    s_waitcnt lgkmcnt(6)
    v_mfma_f32_16x16x32_bf16 v[72:75], v[48:51], a[248:251], v[72:75]
    ds_read_b128 v[44:47], v11 offset:4096
    v_mfma_f32_16x16x32_bf16 v[80:83], v[48:51], a[252:255], v[80:83]
    s_add_u32 s22, s22, 2
    s_cmp_lt_u32 s22, 64
    s_cbranch_scc1 P_v_top
    v_cvt_pk_bf16_f32 v84, v68, v69
    v_cvt_pk_bf16_f32 v85, v70, v71
    s_nop 0
    v_cvt_pk_bf16_f32 v86, v72, v73
    v_cvt_pk_bf16_f32 v87, v74, v75
    v_cvt_pk_bf16_f32 v88, v76, v77
    v_cvt_pk_bf16_f32 v89, v78, v79
    v_cvt_pk_bf16_f32 v90, v80, v81
    v_cvt_pk_bf16_f32 v91, v82, v83
    buffer_store_dwordx4 v[84:87], v3, s[4:7], s21 offen offset:0 sc1
    buffer_store_dwordx4 v[88:91], v3, s[4:7], s21 offen offset:256 sc1
    s_waitcnt vmcnt(0) lgkmcnt(0)
    v_mov_b32 v9, s23
    s_add_u32 s23, s23, 1
    buffer_store_dword v9, v4, s[4:7], 0 offen sc1
    s_branch W_U
W_U:
    v_lshlrev_b32 v5, 2, v1
    s_mov_b32 s18, 0
rdv_13:
    global_load_dword v6, v5, s[100:101] sc1
    s_lshl_b32 s17, s98, 2
    s_waitcnt vmcnt(0)
    v_lshrrev_b32 v9, s17, v6
    s_cmp_eq_u32 s98, 0
    s_cselect_b32 s17, 0x0f0f0f0f, s17
    s_cselect_b32 s17, s17, 0x01010101
    v_and_b32 v9, s17, v9
    v_cmp_ne_u32 vcc, 0x01010101, v9
    s_nop 0
    s_cbranch_vccz rdvok_14
    v_sad_u8 v9, v9, 0, 0
    s_nop 1
    v_add_u32_dpp v9, v9, v9 quad_perm:[1,0,3,2] row_mask:0xf bank_mask:0xf
    v_cmp_ne_u32 vcc, 8, v9
    s_nop 0
    s_cbranch_vccnz rdvw_15
    s_mov_b32 s98, 1
    s_and_b32 s3, s97, 7
    s_barrier
    s_branch role_start
rdvw_15:
    s_sleep 4
    s_add_u32 s18, s18, 1
    s_cmp_lt_u32 s18, 262144
    s_cbranch_scc1 rdv_13
    s_mov_b32 s92, 1048576
rdvok_14:
    s_load_dwordx2 s[8:9], s[0:1], 64
    s_load_dwordx2 s[12:13], s[0:1], 80
    s_mov_b32 s10, 8388608
    s_mov_b32 s11, 0x20000
    s_mov_b32 s14, 8388608
    s_mov_b32 s15, 0x20000
    s_lshl_b32 s17, s90, 2
    s_lshr_b32 s17, 0, s17
    s_add_u32 s35, s93, s17
    s_and_b32 s35, s35, 15
    s_lshr_b32 s28, s93, 4
    s_lshl_b32 s17, s90, 2
    s_lshr_b32 s17, 516, s17
    s_and_b32 s17, s17, 15
    s_add_u32 s28, s28, s17
    s_lshl_b32 s20, s16, 21
    s_lshl_b32 s17, s35, 7
    s_add_u32 s20, s20, s17
    v_lshrrev_b32 v5, 2, v1
    v_and_b32 v6, 3, v1
    v_lshlrev_b32 v7, 4, v6
    v_lshl_add_u32 v7, v5, 11, v7
    v_lshlrev_b32 v8, 3, v6
    v_bfe_u32 v5, v1, 2, 2
    v_lshrrev_b32 v6, 4, v1
    v_lshl_add_u32 v5, v6, 3, v5
    v_lshl_add_u32 v8, v5, 6, v8
    s_lshl_b32 s19, s16, 15
    v_add_u32 v8, s19, v8
    s_and_b32 s37, s93, 0
    s_lshl_b32 s37, s37, 18
    s_waitcnt lgkmcnt(0)
    s_barrier
    s_sub_u32 s17, s90, 1
    s_and_b32 s17, s17, 3
    s_lshl_b32 s17, s17, 3
    s_and_b32 s18, s93, 7
    s_add_u32 s17, s17, s18
    s_lshl_b32 s17, s17, 8
    v_add_lshl_u32 v5, v0, s17, 11
    s_and_b32 s17, s93, 8
    s_lshl_b32 s17, s17, 7
    buffer_load_dword v48, v5, s[8:11], s17 offen offset:384
    s_add_u32 m0, s19, 0
    s_add_u32 s17, s37, 0
    s_bitset0_b32 s17, 21
    s_add_u32 s17, s17, s20
    buffer_load_dwordx4 v7, s[8:11], s17 offen lds
    s_add_u32 m0, s19, 1024
    s_add_u32 s17, s37, 32768
    s_bitset0_b32 s17, 21
    s_add_u32 s17, s17, s20
    buffer_load_dwordx4 v7, s[8:11], s17 offen lds
    s_add_u32 m0, s19, 2048
    s_add_u32 s17, s37, 65536
    s_bitset0_b32 s17, 21
    s_add_u32 s17, s17, s20
    buffer_load_dwordx4 v7, s[8:11], s17 offen lds
    s_add_u32 m0, s19, 3072
    s_add_u32 s17, s37, 98304
    s_bitset0_b32 s17, 21
    s_add_u32 s17, s17, s20
    buffer_load_dwordx4 v7, s[8:11], s17 offen lds
    s_add_u32 m0, s19, 4096
    s_add_u32 s17, s37, 131072
    s_bitset0_b32 s17, 21
    s_add_u32 s17, s17, s20
    buffer_load_dwordx4 v7, s[8:11], s17 offen lds
    s_add_u32 m0, s19, 5120
    s_add_u32 s17, s37, 163840
    s_bitset0_b32 s17, 21
    s_add_u32 s17, s17, s20
    buffer_load_dwordx4 v7, s[8:11], s17 offen lds
    s_add_u32 m0, s19, 6144
    s_add_u32 s17, s37, 196608
    s_bitset0_b32 s17, 21
    s_add_u32 s17, s17, s20
    buffer_load_dwordx4 v7, s[8:11], s17 offen lds
    s_add_u32 m0, s19, 7168
    s_add_u32 s17, s37, 229376
    s_bitset0_b32 s17, 21
    s_add_u32 s17, s17, s20
    buffer_load_dwordx4 v7, s[8:11], s17 offen lds
    s_add_u32 m0, s19, 8192
    s_add_u32 s17, s37, 262144
    s_bitset0_b32 s17, 21
    s_add_u32 s17, s17, s20
    buffer_load_dwordx4 v7, s[8:11], s17 offen lds
    s_add_u32 m0, s19, 9216
    s_add_u32 s17, s37, 294912
    s_bitset0_b32 s17, 21
    s_add_u32 s17, s17, s20
    buffer_load_dwordx4 v7, s[8:11], s17 offen lds
    s_add_u32 m0, s19, 10240
    s_add_u32 s17, s37, 327680
    s_bitset0_b32 s17, 21
    s_add_u32 s17, s17, s20
    buffer_load_dwordx4 v7, s[8:11], s17 offen lds
    s_add_u32 m0, s19, 11264
    s_add_u32 s17, s37, 360448
    s_bitset0_b32 s17, 21
    s_add_u32 s17, s17, s20
    buffer_load_dwordx4 v7, s[8:11], s17 offen lds
    s_add_u32 m0, s19, 12288
    s_add_u32 s17, s37, 393216
    s_bitset0_b32 s17, 21
    s_add_u32 s17, s17, s20
    buffer_load_dwordx4 v7, s[8:11], s17 offen lds
    s_add_u32 m0, s19, 13312
    s_add_u32 s17, s37, 425984
    s_bitset0_b32 s17, 21
    s_add_u32 s17, s17, s20
    buffer_load_dwordx4 v7, s[8:11], s17 offen lds
    s_add_u32 m0, s19, 14336
    s_add_u32 s17, s37, 458752
    s_bitset0_b32 s17, 21
    s_add_u32 s17, s17, s20
    buffer_load_dwordx4 v7, s[8:11], s17 offen lds
    s_add_u32 m0, s19, 15360
    s_add_u32 s17, s37, 491520
    s_bitset0_b32 s17, 21
    s_add_u32 s17, s17, s20
    buffer_load_dwordx4 v7, s[8:11], s17 offen lds
    s_add_u32 m0, s19, 16384
    s_add_u32 s17, s37, 524288
    s_bitset0_b32 s17, 21
    s_add_u32 s17, s17, s20
    buffer_load_dwordx4 v7, s[8:11], s17 offen lds
    s_add_u32 m0, s19, 17408
    s_add_u32 s17, s37, 557056
    s_bitset0_b32 s17, 21
    s_add_u32 s17, s17, s20
    buffer_load_dwordx4 v7, s[8:11], s17 offen lds
    s_add_u32 m0, s19, 18432
    s_add_u32 s17, s37, 589824
    s_bitset0_b32 s17, 21
    s_add_u32 s17, s17, s20
    buffer_load_dwordx4 v7, s[8:11], s17 offen lds
    s_add_u32 m0, s19, 19456
    s_add_u32 s17, s37, 622592
    s_bitset0_b32 s17, 21
    s_add_u32 s17, s17, s20
    buffer_load_dwordx4 v7, s[8:11], s17 offen lds
    s_add_u32 m0, s19, 20480
    s_add_u32 s17, s37, 655360
    s_bitset0_b32 s17, 21
    s_add_u32 s17, s17, s20
    buffer_load_dwordx4 v7, s[8:11], s17 offen lds
    s_add_u32 m0, s19, 21504
    s_add_u32 s17, s37, 688128
    s_bitset0_b32 s17, 21
    s_add_u32 s17, s17, s20
    buffer_load_dwordx4 v7, s[8:11], s17 offen lds
    s_add_u32 m0, s19, 22528
    s_add_u32 s17, s37, 720896
    s_bitset0_b32 s17, 21
    s_add_u32 s17, s17, s20
    buffer_load_dwordx4 v7, s[8:11], s17 offen lds
    s_add_u32 m0, s19, 23552
    s_add_u32 s17, s37, 753664
    s_bitset0_b32 s17, 21
    s_add_u32 s17, s17, s20
    buffer_load_dwordx4 v7, s[8:11], s17 offen lds
    s_add_u32 m0, s19, 24576
    s_add_u32 s17, s37, 786432
    s_bitset0_b32 s17, 21
    s_add_u32 s17, s17, s20
    buffer_load_dwordx4 v7, s[8:11], s17 offen lds
    s_add_u32 m0, s19, 25600
    s_add_u32 s17, s37, 819200
    s_bitset0_b32 s17, 21
    s_add_u32 s17, s17, s20
    buffer_load_dwordx4 v7, s[8:11], s17 offen lds
    s_add_u32 m0, s19, 26624
    s_add_u32 s17, s37, 851968
    s_bitset0_b32 s17, 21
    s_add_u32 s17, s17, s20
    buffer_load_dwordx4 v7, s[8:11], s17 offen lds
    s_add_u32 m0, s19, 27648
    s_add_u32 s17, s37, 884736
    s_bitset0_b32 s17, 21
    s_add_u32 s17, s17, s20
    buffer_load_dwordx4 v7, s[8:11], s17 offen lds
    s_add_u32 m0, s19, 28672
    s_add_u32 s17, s37, 917504
    s_bitset0_b32 s17, 21
    s_add_u32 s17, s17, s20
    buffer_load_dwordx4 v7, s[8:11], s17 offen lds
    s_add_u32 m0, s19, 29696
    s_add_u32 s17, s37, 950272
    s_bitset0_b32 s17, 21
    s_add_u32 s17, s17, s20
    buffer_load_dwordx4 v7, s[8:11], s17 offen lds
    s_add_u32 m0, s19, 30720
    s_add_u32 s17, s37, 983040
    s_bitset0_b32 s17, 21
    s_add_u32 s17, s17, s20
    buffer_load_dwordx4 v7, s[8:11], s17 offen lds
    s_add_u32 m0, s19, 31744
    s_add_u32 s17, s37, 1015808
    s_bitset0_b32 s17, 21
    s_add_u32 s17, s17, s20
    buffer_load_dwordx4 v7, s[8:11], s17 offen lds
    s_waitcnt vmcnt(30)
    ds_read_b64_tr_b16 a[0:1], v8 offset:0
    ds_read_b64_tr_b16 a[2:3], v8 offset:256
    ds_read_b64_tr_b16 a[4:5], v8 offset:32
    ds_read_b64_tr_b16 a[6:7], v8 offset:288
    s_waitcnt vmcnt(28)
    ds_read_b64_tr_b16 a[8:9], v8 offset:2048
    ds_read_b64_tr_b16 a[10:11], v8 offset:2304
    ds_read_b64_tr_b16 a[12:13], v8 offset:2080
    ds_read_b64_tr_b16 a[14:15], v8 offset:2336
    s_waitcnt lgkmcnt(4)
    s_add_u32 m0, s19, 0
    s_add_u32 s17, s37, 1048576
    s_bitset0_b32 s17, 21
    s_add_u32 s17, s17, s20
    buffer_load_dwordx4 v7, s[8:11], s17 offen lds
    s_add_u32 m0, s19, 1024
    s_add_u32 s17, s37, 1081344
    s_bitset0_b32 s17, 21
    s_add_u32 s17, s17, s20
    buffer_load_dwordx4 v7, s[8:11], s17 offen lds
    s_waitcnt vmcnt(28)
    ds_read_b64_tr_b16 a[16:17], v8 offset:4096
    ds_read_b64_tr_b16 a[18:19], v8 offset:4352
    ds_read_b64_tr_b16 a[20:21], v8 offset:4128
    ds_read_b64_tr_b16 a[22:23], v8 offset:4384
    s_waitcnt lgkmcnt(4)
    s_add_u32 m0, s19, 2048
    s_add_u32 s17, s37, 1114112
    s_bitset0_b32 s17, 21
    s_add_u32 s17, s17, s20
    buffer_load_dwordx4 v7, s[8:11], s17 offen lds
    s_add_u32 m0, s19, 3072
    s_add_u32 s17, s37, 1146880
    s_bitset0_b32 s17, 21
    s_add_u32 s17, s17, s20
    buffer_load_dwordx4 v7, s[8:11], s17 offen lds
    s_waitcnt vmcnt(28)
    ds_read_b64_tr_b16 a[24:25], v8 offset:6144
    ds_read_b64_tr_b16 a[26:27], v8 offset:6400
    ds_read_b64_tr_b16 a[28:29], v8 offset:6176
    ds_read_b64_tr_b16 a[30:31], v8 offset:6432
    s_waitcnt lgkmcnt(4)
    s_add_u32 m0, s19, 4096
    s_add_u32 s17, s37, 1179648
    s_bitset0_b32 s17, 21
    s_add_u32 s17, s17, s20
    buffer_load_dwordx4 v7, s[8:11], s17 offen lds
    s_add_u32 m0, s19, 5120
    s_add_u32 s17, s37, 1212416
    s_bitset0_b32 s17, 21
    s_add_u32 s17, s17, s20
    buffer_load_dwordx4 v7, s[8:11], s17 offen lds
    s_waitcnt vmcnt(28)
    ds_read_b64_tr_b16 a[32:33], v8 offset:8192
    ds_read_b64_tr_b16 a[34:35], v8 offset:8448
    ds_read_b64_tr_b16 a[36:37], v8 offset:8224
    ds_read_b64_tr_b16 a[38:39], v8 offset:8480
    s_waitcnt lgkmcnt(4)
    s_add_u32 m0, s19, 6144
    s_add_u32 s17, s37, 1245184
    s_bitset0_b32 s17, 21
    s_add_u32 s17, s17, s20
    buffer_load_dwordx4 v7, s[8:11], s17 offen lds
    s_add_u32 m0, s19, 7168
    s_add_u32 s17, s37, 1277952
    s_bitset0_b32 s17, 21
    s_add_u32 s17, s17, s20
    buffer_load_dwordx4 v7, s[8:11], s17 offen lds
    s_waitcnt vmcnt(28)
    ds_read_b64_tr_b16 a[40:41], v8 offset:10240
    ds_read_b64_tr_b16 a[42:43], v8 offset:10496
    ds_read_b64_tr_b16 a[44:45], v8 offset:10272
    ds_read_b64_tr_b16 a[46:47], v8 offset:10528
    s_waitcnt lgkmcnt(4)
    s_add_u32 m0, s19, 8192
    s_add_u32 s17, s37, 1310720
    s_bitset0_b32 s17, 21
    s_add_u32 s17, s17, s20
    buffer_load_dwordx4 v7, s[8:11], s17 offen lds
    s_add_u32 m0, s19, 9216
    s_add_u32 s17, s37, 1343488
    s_bitset0_b32 s17, 21
    s_add_u32 s17, s17, s20
    buffer_load_dwordx4 v7, s[8:11], s17 offen lds
    s_waitcnt vmcnt(28)
    ds_read_b64_tr_b16 a[48:49], v8 offset:12288
    ds_read_b64_tr_b16 a[50:51], v8 offset:12544
    ds_read_b64_tr_b16 a[52:53], v8 offset:12320
    ds_read_b64_tr_b16 a[54:55], v8 offset:12576
    s_waitcnt lgkmcnt(4)
    s_add_u32 m0, s19, 10240
    s_add_u32 s17, s37, 1376256
    s_bitset0_b32 s17, 21
    s_add_u32 s17, s17, s20
    buffer_load_dwordx4 v7, s[8:11], s17 offen lds
    s_add_u32 m0, s19, 11264
    s_add_u32 s17, s37, 1409024
    s_bitset0_b32 s17, 21
    s_add_u32 s17, s17, s20
    buffer_load_dwordx4 v7, s[8:11], s17 offen lds
    s_waitcnt vmcnt(28)
    ds_read_b64_tr_b16 a[56:57], v8 offset:14336
    ds_read_b64_tr_b16 a[58:59], v8 offset:14592
    ds_read_b64_tr_b16 a[60:61], v8 offset:14368
    ds_read_b64_tr_b16 a[62:63], v8 offset:14624
    s_waitcnt lgkmcnt(4)
    s_add_u32 m0, s19, 12288
    s_add_u32 s17, s37, 1441792
    s_bitset0_b32 s17, 21
    s_add_u32 s17, s17, s20
    buffer_load_dwordx4 v7, s[8:11], s17 offen lds
    s_add_u32 m0, s19, 13312
    s_add_u32 s17, s37, 1474560
    s_bitset0_b32 s17, 21
    s_add_u32 s17, s17, s20
    buffer_load_dwordx4 v7, s[8:11], s17 offen lds
    s_waitcnt vmcnt(28)
    ds_read_b64_tr_b16 a[64:65], v8 offset:16384
    ds_read_b64_tr_b16 a[66:67], v8 offset:16640
    ds_read_b64_tr_b16 a[68:69], v8 offset:16416
    ds_read_b64_tr_b16 a[70:71], v8 offset:16672
    s_waitcnt lgkmcnt(4)
    s_add_u32 m0, s19, 14336
    s_add_u32 s17, s37, 1507328
    s_bitset0_b32 s17, 21
    s_add_u32 s17, s17, s20
    buffer_load_dwordx4 v7, s[8:11], s17 offen lds
    s_add_u32 m0, s19, 15360
    s_add_u32 s17, s37, 1540096
    s_bitset0_b32 s17, 21
    s_add_u32 s17, s17, s20
    buffer_load_dwordx4 v7, s[8:11], s17 offen lds
    s_waitcnt vmcnt(28)
    ds_read_b64_tr_b16 a[72:73], v8 offset:18432
    ds_read_b64_tr_b16 a[74:75], v8 offset:18688
    ds_read_b64_tr_b16 a[76:77], v8 offset:18464
    ds_read_b64_tr_b16 a[78:79], v8 offset:18720
    s_waitcnt lgkmcnt(4)
    s_add_u32 m0, s19, 16384
    s_add_u32 s17, s37, 1572864
    s_bitset0_b32 s17, 21
    s_add_u32 s17, s17, s20
    buffer_load_dwordx4 v7, s[8:11], s17 offen lds
    s_add_u32 m0, s19, 17408
    s_add_u32 s17, s37, 1605632
    s_bitset0_b32 s17, 21
    s_add_u32 s17, s17, s20
    buffer_load_dwordx4 v7, s[8:11], s17 offen lds
    s_waitcnt vmcnt(28)
    ds_read_b64_tr_b16 a[80:81], v8 offset:20480
    ds_read_b64_tr_b16 a[82:83], v8 offset:20736
    ds_read_b64_tr_b16 a[84:85], v8 offset:20512
    ds_read_b64_tr_b16 a[86:87], v8 offset:20768
    s_waitcnt lgkmcnt(4)
    s_add_u32 m0, s19, 18432
    s_add_u32 s17, s37, 1638400
    s_bitset0_b32 s17, 21
    s_add_u32 s17, s17, s20
    buffer_load_dwordx4 v7, s[8:11], s17 offen lds
    s_add_u32 m0, s19, 19456
    s_add_u32 s17, s37, 1671168
    s_bitset0_b32 s17, 21
    s_add_u32 s17, s17, s20
    buffer_load_dwordx4 v7, s[8:11], s17 offen lds
    s_waitcnt vmcnt(28)
    ds_read_b64_tr_b16 a[88:89], v8 offset:22528
    ds_read_b64_tr_b16 a[90:91], v8 offset:22784
    ds_read_b64_tr_b16 a[92:93], v8 offset:22560
    ds_read_b64_tr_b16 a[94:95], v8 offset:22816
    s_waitcnt lgkmcnt(4)
    s_add_u32 m0, s19, 20480
    s_add_u32 s17, s37, 1703936
    s_bitset0_b32 s17, 21
    s_add_u32 s17, s17, s20
    buffer_load_dwordx4 v7, s[8:11], s17 offen lds
    s_add_u32 m0, s19, 21504
    s_add_u32 s17, s37, 1736704
    s_bitset0_b32 s17, 21
    s_add_u32 s17, s17, s20
    buffer_load_dwordx4 v7, s[8:11], s17 offen lds
    s_waitcnt vmcnt(28)
    ds_read_b64_tr_b16 a[96:97], v8 offset:24576
    ds_read_b64_tr_b16 a[98:99], v8 offset:24832
    ds_read_b64_tr_b16 a[100:101], v8 offset:24608
    ds_read_b64_tr_b16 a[102:103], v8 offset:24864
    s_waitcnt lgkmcnt(4)
    s_add_u32 m0, s19, 22528
    s_add_u32 s17, s37, 1769472
    s_bitset0_b32 s17, 21
    s_add_u32 s17, s17, s20
    buffer_load_dwordx4 v7, s[8:11], s17 offen lds
    s_add_u32 m0, s19, 23552
    s_add_u32 s17, s37, 1802240
    s_bitset0_b32 s17, 21
    s_add_u32 s17, s17, s20
    buffer_load_dwordx4 v7, s[8:11], s17 offen lds
    s_waitcnt vmcnt(28)
    ds_read_b64_tr_b16 a[104:105], v8 offset:26624
    ds_read_b64_tr_b16 a[106:107], v8 offset:26880
    ds_read_b64_tr_b16 a[108:109], v8 offset:26656
    ds_read_b64_tr_b16 a[110:111], v8 offset:26912
    s_waitcnt lgkmcnt(4)
    s_add_u32 m0, s19, 24576
    s_add_u32 s17, s37, 1835008
    s_bitset0_b32 s17, 21
    s_add_u32 s17, s17, s20
    buffer_load_dwordx4 v7, s[8:11], s17 offen lds
    s_add_u32 m0, s19, 25600
    s_add_u32 s17, s37, 1867776
    s_bitset0_b32 s17, 21
    s_add_u32 s17, s17, s20
    buffer_load_dwordx4 v7, s[8:11], s17 offen lds
    s_waitcnt vmcnt(28)
    ds_read_b64_tr_b16 a[112:113], v8 offset:28672
    ds_read_b64_tr_b16 a[114:115], v8 offset:28928
    ds_read_b64_tr_b16 a[116:117], v8 offset:28704
    ds_read_b64_tr_b16 a[118:119], v8 offset:28960
    s_waitcnt lgkmcnt(4)
    s_add_u32 m0, s19, 26624
    s_add_u32 s17, s37, 1900544
    s_bitset0_b32 s17, 21
    s_add_u32 s17, s17, s20
    buffer_load_dwordx4 v7, s[8:11], s17 offen lds
    s_add_u32 m0, s19, 27648
    s_add_u32 s17, s37, 1933312
    s_bitset0_b32 s17, 21
    s_add_u32 s17, s17, s20
    buffer_load_dwordx4 v7, s[8:11], s17 offen lds
    s_waitcnt vmcnt(28)
    ds_read_b64_tr_b16 a[120:121], v8 offset:30720
    ds_read_b64_tr_b16 a[122:123], v8 offset:30976
    ds_read_b64_tr_b16 a[124:125], v8 offset:30752
    ds_read_b64_tr_b16 a[126:127], v8 offset:31008
    s_waitcnt lgkmcnt(4)
    s_add_u32 m0, s19, 28672
    s_add_u32 s17, s37, 1966080
    s_bitset0_b32 s17, 21
    s_add_u32 s17, s17, s20
    buffer_load_dwordx4 v7, s[8:11], s17 offen lds
    s_add_u32 m0, s19, 29696
    s_add_u32 s17, s37, 1998848
    s_bitset0_b32 s17, 21
    s_add_u32 s17, s17, s20
    buffer_load_dwordx4 v7, s[8:11], s17 offen lds
    s_waitcnt vmcnt(28)
    ds_read_b64_tr_b16 a[128:129], v8 offset:0
    ds_read_b64_tr_b16 a[130:131], v8 offset:256
    ds_read_b64_tr_b16 a[132:133], v8 offset:32
    ds_read_b64_tr_b16 a[134:135], v8 offset:288
    s_waitcnt lgkmcnt(4)
    s_add_u32 m0, s19, 30720
    s_add_u32 s17, s37, 2031616
    s_bitset0_b32 s17, 21
    s_add_u32 s17, s17, s20
    buffer_load_dwordx4 v7, s[8:11], s17 offen lds
    s_add_u32 m0, s19, 31744
    s_add_u32 s17, s37, 2064384
    s_bitset0_b32 s17, 21
    s_add_u32 s17, s17, s20
    buffer_load_dwordx4 v7, s[8:11], s17 offen lds
    s_waitcnt vmcnt(28)
    ds_read_b64_tr_b16 a[136:137], v8 offset:2048
    ds_read_b64_tr_b16 a[138:139], v8 offset:2304
    ds_read_b64_tr_b16 a[140:141], v8 offset:2080
    ds_read_b64_tr_b16 a[142:143], v8 offset:2336
    s_waitcnt lgkmcnt(4)
    s_add_u32 m0, s19, 0
    s_add_u32 s17, s37, 64
    s_bitset0_b32 s17, 21
    s_add_u32 s17, s17, s20
    buffer_load_dwordx4 v7, s[8:11], s17 offen lds
    s_add_u32 m0, s19, 1024
    s_add_u32 s17, s37, 32832
    s_bitset0_b32 s17, 21
    s_add_u32 s17, s17, s20
    buffer_load_dwordx4 v7, s[8:11], s17 offen lds
    s_waitcnt vmcnt(28)
    ds_read_b64_tr_b16 a[144:145], v8 offset:4096
    ds_read_b64_tr_b16 a[146:147], v8 offset:4352
    ds_read_b64_tr_b16 a[148:149], v8 offset:4128
    ds_read_b64_tr_b16 a[150:151], v8 offset:4384
    s_waitcnt lgkmcnt(4)
    s_add_u32 m0, s19, 2048
    s_add_u32 s17, s37, 131136
    s_bitset0_b32 s17, 21
    s_add_u32 s17, s17, s20
    buffer_load_dwordx4 v7, s[8:11], s17 offen lds
    s_add_u32 m0, s19, 3072
    s_add_u32 s17, s37, 163904
    s_bitset0_b32 s17, 21
    s_add_u32 s17, s17, s20
    buffer_load_dwordx4 v7, s[8:11], s17 offen lds
    s_waitcnt vmcnt(28)
    ds_read_b64_tr_b16 a[152:153], v8 offset:6144
    ds_read_b64_tr_b16 a[154:155], v8 offset:6400
    ds_read_b64_tr_b16 a[156:157], v8 offset:6176
    ds_read_b64_tr_b16 a[158:159], v8 offset:6432
    s_waitcnt lgkmcnt(4)
    s_add_u32 m0, s19, 4096
    s_add_u32 s17, s37, 262208
    s_bitset0_b32 s17, 21
    s_add_u32 s17, s17, s20
    buffer_load_dwordx4 v7, s[8:11], s17 offen lds
    s_add_u32 m0, s19, 5120
    s_add_u32 s17, s37, 294976
    s_bitset0_b32 s17, 21
    s_add_u32 s17, s17, s20
    buffer_load_dwordx4 v7, s[8:11], s17 offen lds
    s_waitcnt vmcnt(28)
    ds_read_b64_tr_b16 a[160:161], v8 offset:8192
    ds_read_b64_tr_b16 a[162:163], v8 offset:8448
    ds_read_b64_tr_b16 a[164:165], v8 offset:8224
    ds_read_b64_tr_b16 a[166:167], v8 offset:8480
    s_waitcnt lgkmcnt(4)
    s_add_u32 m0, s19, 6144
    s_add_u32 s17, s37, 393280
    s_bitset0_b32 s17, 21
    s_add_u32 s17, s17, s20
    buffer_load_dwordx4 v7, s[8:11], s17 offen lds
    s_add_u32 m0, s19, 7168
    s_add_u32 s17, s37, 426048
    s_bitset0_b32 s17, 21
    s_add_u32 s17, s17, s20
    buffer_load_dwordx4 v7, s[8:11], s17 offen lds
    s_waitcnt vmcnt(28)
    ds_read_b64_tr_b16 a[168:169], v8 offset:10240
    ds_read_b64_tr_b16 a[170:171], v8 offset:10496
    ds_read_b64_tr_b16 a[172:173], v8 offset:10272
    ds_read_b64_tr_b16 a[174:175], v8 offset:10528
    s_waitcnt lgkmcnt(4)
    s_add_u32 m0, s19, 8192
    s_add_u32 s17, s37, 524352
    s_bitset0_b32 s17, 21
    s_add_u32 s17, s17, s20
    buffer_load_dwordx4 v7, s[8:11], s17 offen lds
    s_add_u32 m0, s19, 9216
    s_add_u32 s17, s37, 557120
    s_bitset0_b32 s17, 21
    s_add_u32 s17, s17, s20
    buffer_load_dwordx4 v7, s[8:11], s17 offen lds
    s_waitcnt vmcnt(28)
    ds_read_b64_tr_b16 a[176:177], v8 offset:12288
    ds_read_b64_tr_b16 a[178:179], v8 offset:12544
    ds_read_b64_tr_b16 a[180:181], v8 offset:12320
    ds_read_b64_tr_b16 a[182:183], v8 offset:12576
    s_waitcnt lgkmcnt(4)
    s_add_u32 m0, s19, 10240
    s_add_u32 s17, s37, 655424
    s_bitset0_b32 s17, 21
    s_add_u32 s17, s17, s20
    buffer_load_dwordx4 v7, s[8:11], s17 offen lds
    s_add_u32 m0, s19, 11264
    s_add_u32 s17, s37, 688192
    s_bitset0_b32 s17, 21
    s_add_u32 s17, s17, s20
    buffer_load_dwordx4 v7, s[8:11], s17 offen lds
    s_waitcnt vmcnt(28)
    ds_read_b64_tr_b16 a[184:185], v8 offset:14336
    ds_read_b64_tr_b16 a[186:187], v8 offset:14592
    ds_read_b64_tr_b16 a[188:189], v8 offset:14368
    ds_read_b64_tr_b16 a[190:191], v8 offset:14624
    s_waitcnt lgkmcnt(4)
    s_add_u32 m0, s19, 12288
    s_add_u32 s17, s37, 786496
    s_bitset0_b32 s17, 21
    s_add_u32 s17, s17, s20
    buffer_load_dwordx4 v7, s[8:11], s17 offen lds
    s_add_u32 m0, s19, 13312
    s_add_u32 s17, s37, 819264
    s_bitset0_b32 s17, 21
    s_add_u32 s17, s17, s20
    buffer_load_dwordx4 v7, s[8:11], s17 offen lds
    s_waitcnt vmcnt(28)
    ds_read_b64_tr_b16 a[192:193], v8 offset:16384
    ds_read_b64_tr_b16 a[194:195], v8 offset:16640
    ds_read_b64_tr_b16 a[196:197], v8 offset:16416
    ds_read_b64_tr_b16 a[198:199], v8 offset:16672
    s_waitcnt lgkmcnt(4)
    s_add_u32 m0, s19, 14336
    s_add_u32 s17, s37, 917568
    s_bitset0_b32 s17, 21
    s_add_u32 s17, s17, s20
    buffer_load_dwordx4 v7, s[8:11], s17 offen lds
    s_add_u32 m0, s19, 15360
    s_add_u32 s17, s37, 950336
    s_bitset0_b32 s17, 21
    s_add_u32 s17, s17, s20
    buffer_load_dwordx4 v7, s[8:11], s17 offen lds
    s_waitcnt vmcnt(28)
    ds_read_b64_tr_b16 a[200:201], v8 offset:18432
    ds_read_b64_tr_b16 a[202:203], v8 offset:18688
    ds_read_b64_tr_b16 a[204:205], v8 offset:18464
    ds_read_b64_tr_b16 a[206:207], v8 offset:18720
    s_waitcnt lgkmcnt(4)
    s_add_u32 m0, s19, 16384
    s_add_u32 s17, s37, 1048640
    s_bitset0_b32 s17, 21
    s_add_u32 s17, s17, s20
    buffer_load_dwordx4 v7, s[8:11], s17 offen lds
    s_add_u32 m0, s19, 17408
    s_add_u32 s17, s37, 1081408
    s_bitset0_b32 s17, 21
    s_add_u32 s17, s17, s20
    buffer_load_dwordx4 v7, s[8:11], s17 offen lds
    s_waitcnt vmcnt(28)
    ds_read_b64_tr_b16 a[208:209], v8 offset:20480
    ds_read_b64_tr_b16 a[210:211], v8 offset:20736
    ds_read_b64_tr_b16 a[212:213], v8 offset:20512
    ds_read_b64_tr_b16 a[214:215], v8 offset:20768
    s_waitcnt lgkmcnt(4)
    s_add_u32 m0, s19, 18432
    s_add_u32 s17, s37, 1179712
    s_bitset0_b32 s17, 21
    s_add_u32 s17, s17, s20
    buffer_load_dwordx4 v7, s[8:11], s17 offen lds
    s_add_u32 m0, s19, 19456
    s_add_u32 s17, s37, 1212480
    s_bitset0_b32 s17, 21
    s_add_u32 s17, s17, s20
    buffer_load_dwordx4 v7, s[8:11], s17 offen lds
    s_waitcnt vmcnt(28)
    ds_read_b64_tr_b16 a[216:217], v8 offset:22528
    ds_read_b64_tr_b16 a[218:219], v8 offset:22784
    ds_read_b64_tr_b16 a[220:221], v8 offset:22560
    ds_read_b64_tr_b16 a[222:223], v8 offset:22816
    s_waitcnt lgkmcnt(4)
    s_add_u32 m0, s19, 20480
    s_add_u32 s17, s37, 1310784
    s_bitset0_b32 s17, 21
    s_add_u32 s17, s17, s20
    buffer_load_dwordx4 v7, s[8:11], s17 offen lds
    s_add_u32 m0, s19, 21504
    s_add_u32 s17, s37, 1343552
    s_bitset0_b32 s17, 21
    s_add_u32 s17, s17, s20
    buffer_load_dwordx4 v7, s[8:11], s17 offen lds
    s_waitcnt vmcnt(28)
    ds_read_b64_tr_b16 a[224:225], v8 offset:24576
    ds_read_b64_tr_b16 a[226:227], v8 offset:24832
    ds_read_b64_tr_b16 a[228:229], v8 offset:24608
    ds_read_b64_tr_b16 a[230:231], v8 offset:24864
    s_waitcnt lgkmcnt(4)
    s_add_u32 m0, s19, 22528
    s_add_u32 s17, s37, 1441856
    s_bitset0_b32 s17, 21
    s_add_u32 s17, s17, s20
    buffer_load_dwordx4 v7, s[8:11], s17 offen lds
    s_add_u32 m0, s19, 23552
    s_add_u32 s17, s37, 1474624
    s_bitset0_b32 s17, 21
    s_add_u32 s17, s17, s20
    buffer_load_dwordx4 v7, s[8:11], s17 offen lds
    s_waitcnt vmcnt(28)
    ds_read_b64_tr_b16 a[232:233], v8 offset:26624
    ds_read_b64_tr_b16 a[234:235], v8 offset:26880
    ds_read_b64_tr_b16 a[236:237], v8 offset:26656
    ds_read_b64_tr_b16 a[238:239], v8 offset:26912
    s_waitcnt lgkmcnt(4)
    s_add_u32 m0, s19, 24576
    s_add_u32 s17, s37, 1572928
    s_bitset0_b32 s17, 21
    s_add_u32 s17, s17, s20
    buffer_load_dwordx4 v7, s[8:11], s17 offen lds
    s_add_u32 m0, s19, 25600
    s_add_u32 s17, s37, 1605696
    s_bitset0_b32 s17, 21
    s_add_u32 s17, s17, s20
    buffer_load_dwordx4 v7, s[8:11], s17 offen lds
    s_waitcnt vmcnt(28)
    ds_read_b64_tr_b16 a[240:241], v8 offset:28672
    ds_read_b64_tr_b16 a[242:243], v8 offset:28928
    ds_read_b64_tr_b16 a[244:245], v8 offset:28704
    ds_read_b64_tr_b16 a[246:247], v8 offset:28960
    s_waitcnt lgkmcnt(4)
    s_add_u32 m0, s19, 26624
    s_add_u32 s17, s37, 1704000
    s_bitset0_b32 s17, 21
    s_add_u32 s17, s17, s20
    buffer_load_dwordx4 v7, s[8:11], s17 offen lds
    s_add_u32 m0, s19, 27648
    s_add_u32 s17, s37, 1736768
    s_bitset0_b32 s17, 21
    s_add_u32 s17, s17, s20
    buffer_load_dwordx4 v7, s[8:11], s17 offen lds
    s_waitcnt vmcnt(28)
    ds_read_b64_tr_b16 a[248:249], v8 offset:30720
    ds_read_b64_tr_b16 a[250:251], v8 offset:30976
    ds_read_b64_tr_b16 a[252:253], v8 offset:30752
    ds_read_b64_tr_b16 a[254:255], v8 offset:31008
    s_waitcnt lgkmcnt(4)
    s_add_u32 m0, s19, 28672
    s_add_u32 s17, s37, 1835072
    s_bitset0_b32 s17, 21
    s_add_u32 s17, s17, s20
    buffer_load_dwordx4 v7, s[8:11], s17 offen lds
    s_add_u32 m0, s19, 29696
    s_add_u32 s17, s37, 1867840
    s_bitset0_b32 s17, 21
    s_add_u32 s17, s17, s20
    buffer_load_dwordx4 v7, s[8:11], s17 offen lds
    s_waitcnt vmcnt(28)
    ds_read_b64_tr_b16 v[128:129], v8 offset:0
    ds_read_b64_tr_b16 v[130:131], v8 offset:256
    ds_read_b64_tr_b16 v[132:133], v8 offset:32
    ds_read_b64_tr_b16 v[134:135], v8 offset:288
    s_waitcnt lgkmcnt(4)
    s_add_u32 m0, s19, 30720
    s_add_u32 s17, s37, 1966144
    s_bitset0_b32 s17, 21
    s_add_u32 s17, s17, s20
    buffer_load_dwordx4 v7, s[8:11], s17 offen lds
    s_add_u32 m0, s19, 31744
    s_add_u32 s17, s37, 1998912
    s_bitset0_b32 s17, 21
    s_add_u32 s17, s17, s20
    buffer_load_dwordx4 v7, s[8:11], s17 offen lds
    s_waitcnt vmcnt(28)
    ds_read_b64_tr_b16 v[136:137], v8 offset:2048
    ds_read_b64_tr_b16 v[138:139], v8 offset:2304
    ds_read_b64_tr_b16 v[140:141], v8 offset:2080
    ds_read_b64_tr_b16 v[142:143], v8 offset:2336
    s_waitcnt lgkmcnt(4)
    s_add_u32 m0, s19, 0
    s_add_u32 s17, s37, 65600
    s_bitset0_b32 s17, 21
    s_add_u32 s17, s17, s20
    buffer_load_dwordx4 v7, s[8:11], s17 offen lds
    s_add_u32 m0, s19, 1024
    s_add_u32 s17, s37, 98368
    s_bitset0_b32 s17, 21
    s_add_u32 s17, s17, s20
    buffer_load_dwordx4 v7, s[8:11], s17 offen lds
    s_waitcnt vmcnt(28)
    ds_read_b64_tr_b16 v[144:145], v8 offset:4096
    ds_read_b64_tr_b16 v[146:147], v8 offset:4352
    ds_read_b64_tr_b16 v[148:149], v8 offset:4128
    ds_read_b64_tr_b16 v[150:151], v8 offset:4384
    s_waitcnt lgkmcnt(4)
    s_add_u32 m0, s19, 2048
    s_add_u32 s17, s37, 196672
    s_bitset0_b32 s17, 21
    s_add_u32 s17, s17, s20
    buffer_load_dwordx4 v7, s[8:11], s17 offen lds
    s_add_u32 m0, s19, 3072
    s_add_u32 s17, s37, 229440
    s_bitset0_b32 s17, 21
    s_add_u32 s17, s17, s20
    buffer_load_dwordx4 v7, s[8:11], s17 offen lds
    s_waitcnt vmcnt(28)
    ds_read_b64_tr_b16 v[152:153], v8 offset:6144
    ds_read_b64_tr_b16 v[154:155], v8 offset:6400
    ds_read_b64_tr_b16 v[156:157], v8 offset:6176
    ds_read_b64_tr_b16 v[158:159], v8 offset:6432
    s_waitcnt lgkmcnt(4)
    s_add_u32 m0, s19, 4096
    s_add_u32 s17, s37, 327744
    s_bitset0_b32 s17, 21
    s_add_u32 s17, s17, s20
    buffer_load_dwordx4 v7, s[8:11], s17 offen lds
    s_add_u32 m0, s19, 5120
    s_add_u32 s17, s37, 360512
    s_bitset0_b32 s17, 21
    s_add_u32 s17, s17, s20
    buffer_load_dwordx4 v7, s[8:11], s17 offen lds
    s_waitcnt vmcnt(28)
    ds_read_b64_tr_b16 v[160:161], v8 offset:8192
    ds_read_b64_tr_b16 v[162:163], v8 offset:8448
    ds_read_b64_tr_b16 v[164:165], v8 offset:8224
    ds_read_b64_tr_b16 v[166:167], v8 offset:8480
    s_waitcnt lgkmcnt(4)
    s_add_u32 m0, s19, 6144
    s_add_u32 s17, s37, 458816
    s_bitset0_b32 s17, 21
    s_add_u32 s17, s17, s20
    buffer_load_dwordx4 v7, s[8:11], s17 offen lds
    s_add_u32 m0, s19, 7168
    s_add_u32 s17, s37, 491584
    s_bitset0_b32 s17, 21
    s_add_u32 s17, s17, s20
    buffer_load_dwordx4 v7, s[8:11], s17 offen lds
    s_waitcnt vmcnt(28)
    ds_read_b64_tr_b16 v[168:169], v8 offset:10240
    ds_read_b64_tr_b16 v[170:171], v8 offset:10496
    ds_read_b64_tr_b16 v[172:173], v8 offset:10272
    ds_read_b64_tr_b16 v[174:175], v8 offset:10528
    s_waitcnt lgkmcnt(4)
    s_add_u32 m0, s19, 8192
    s_add_u32 s17, s37, 589888
    s_bitset0_b32 s17, 21
    s_add_u32 s17, s17, s20
    buffer_load_dwordx4 v7, s[8:11], s17 offen lds
    s_add_u32 m0, s19, 9216
    s_add_u32 s17, s37, 622656
    s_bitset0_b32 s17, 21
    s_add_u32 s17, s17, s20
    buffer_load_dwordx4 v7, s[8:11], s17 offen lds
    s_waitcnt vmcnt(28)
    ds_read_b64_tr_b16 v[176:177], v8 offset:12288
    ds_read_b64_tr_b16 v[178:179], v8 offset:12544
    ds_read_b64_tr_b16 v[180:181], v8 offset:12320
    ds_read_b64_tr_b16 v[182:183], v8 offset:12576
    s_waitcnt lgkmcnt(4)
    s_add_u32 m0, s19, 10240
    s_add_u32 s17, s37, 720960
    s_bitset0_b32 s17, 21
    s_add_u32 s17, s17, s20
    buffer_load_dwordx4 v7, s[8:11], s17 offen lds
    s_add_u32 m0, s19, 11264
    s_add_u32 s17, s37, 753728
    s_bitset0_b32 s17, 21
    s_add_u32 s17, s17, s20
    buffer_load_dwordx4 v7, s[8:11], s17 offen lds
    s_waitcnt vmcnt(28)
    ds_read_b64_tr_b16 v[184:185], v8 offset:14336
    ds_read_b64_tr_b16 v[186:187], v8 offset:14592
    ds_read_b64_tr_b16 v[188:189], v8 offset:14368
    ds_read_b64_tr_b16 v[190:191], v8 offset:14624
    s_waitcnt lgkmcnt(4)
    s_add_u32 m0, s19, 12288
    s_add_u32 s17, s37, 852032
    s_bitset0_b32 s17, 21
    s_add_u32 s17, s17, s20
    buffer_load_dwordx4 v7, s[8:11], s17 offen lds
    s_add_u32 m0, s19, 13312
    s_add_u32 s17, s37, 884800
    s_bitset0_b32 s17, 21
    s_add_u32 s17, s17, s20
    buffer_load_dwordx4 v7, s[8:11], s17 offen lds
    s_waitcnt vmcnt(28)
    ds_read_b64_tr_b16 v[192:193], v8 offset:16384
    ds_read_b64_tr_b16 v[194:195], v8 offset:16640
    ds_read_b64_tr_b16 v[196:197], v8 offset:16416
    ds_read_b64_tr_b16 v[198:199], v8 offset:16672
    s_waitcnt lgkmcnt(4)
    s_add_u32 m0, s19, 14336
    s_add_u32 s17, s37, 983104
    s_bitset0_b32 s17, 21
    s_add_u32 s17, s17, s20
    buffer_load_dwordx4 v7, s[8:11], s17 offen lds
    s_add_u32 m0, s19, 15360
    s_add_u32 s17, s37, 1015872
    s_bitset0_b32 s17, 21
    s_add_u32 s17, s17, s20
    buffer_load_dwordx4 v7, s[8:11], s17 offen lds
    s_waitcnt vmcnt(28)
    ds_read_b64_tr_b16 v[200:201], v8 offset:18432
    ds_read_b64_tr_b16 v[202:203], v8 offset:18688
    ds_read_b64_tr_b16 v[204:205], v8 offset:18464
    ds_read_b64_tr_b16 v[206:207], v8 offset:18720
    s_waitcnt lgkmcnt(4)
    s_add_u32 m0, s19, 16384
    s_add_u32 s17, s37, 1114176
    s_bitset0_b32 s17, 21
    s_add_u32 s17, s17, s20
    buffer_load_dwordx4 v7, s[8:11], s17 offen lds
    s_add_u32 m0, s19, 17408
    s_add_u32 s17, s37, 1146944
    s_bitset0_b32 s17, 21
    s_add_u32 s17, s17, s20
    buffer_load_dwordx4 v7, s[8:11], s17 offen lds
    s_waitcnt vmcnt(28)
    ds_read_b64_tr_b16 v[208:209], v8 offset:20480
    ds_read_b64_tr_b16 v[210:211], v8 offset:20736
    ds_read_b64_tr_b16 v[212:213], v8 offset:20512
    ds_read_b64_tr_b16 v[214:215], v8 offset:20768
    s_waitcnt lgkmcnt(4)
    s_add_u32 m0, s19, 18432
    s_add_u32 s17, s37, 1245248
    s_bitset0_b32 s17, 21
    s_add_u32 s17, s17, s20
    buffer_load_dwordx4 v7, s[8:11], s17 offen lds
    s_add_u32 m0, s19, 19456
    s_add_u32 s17, s37, 1278016
    s_bitset0_b32 s17, 21
    s_add_u32 s17, s17, s20
    buffer_load_dwordx4 v7, s[8:11], s17 offen lds
    s_waitcnt vmcnt(28)
    ds_read_b64_tr_b16 v[216:217], v8 offset:22528
    ds_read_b64_tr_b16 v[218:219], v8 offset:22784
    ds_read_b64_tr_b16 v[220:221], v8 offset:22560
    ds_read_b64_tr_b16 v[222:223], v8 offset:22816
    s_waitcnt lgkmcnt(4)
    s_add_u32 m0, s19, 20480
    s_add_u32 s17, s37, 1376320
    s_bitset0_b32 s17, 21
    s_add_u32 s17, s17, s20
    buffer_load_dwordx4 v7, s[8:11], s17 offen lds
    s_add_u32 m0, s19, 21504
    s_add_u32 s17, s37, 1409088
    s_bitset0_b32 s17, 21
    s_add_u32 s17, s17, s20
    buffer_load_dwordx4 v7, s[8:11], s17 offen lds
    s_waitcnt vmcnt(28)
    ds_read_b64_tr_b16 v[224:225], v8 offset:24576
    ds_read_b64_tr_b16 v[226:227], v8 offset:24832
    ds_read_b64_tr_b16 v[228:229], v8 offset:24608
    ds_read_b64_tr_b16 v[230:231], v8 offset:24864
    s_waitcnt lgkmcnt(4)
    s_add_u32 m0, s19, 22528
    s_add_u32 s17, s37, 1507392
    s_bitset0_b32 s17, 21
    s_add_u32 s17, s17, s20
    buffer_load_dwordx4 v7, s[8:11], s17 offen lds
    s_add_u32 m0, s19, 23552
    s_add_u32 s17, s37, 1540160
    s_bitset0_b32 s17, 21
    s_add_u32 s17, s17, s20
    buffer_load_dwordx4 v7, s[8:11], s17 offen lds
    s_waitcnt vmcnt(28)
    ds_read_b64_tr_b16 v[232:233], v8 offset:26624
    ds_read_b64_tr_b16 v[234:235], v8 offset:26880
    ds_read_b64_tr_b16 v[236:237], v8 offset:26656
    ds_read_b64_tr_b16 v[238:239], v8 offset:26912
    s_waitcnt lgkmcnt(4)
    s_add_u32 m0, s19, 24576
    s_add_u32 s17, s37, 1638464
    s_bitset0_b32 s17, 21
    s_add_u32 s17, s17, s20
    buffer_load_dwordx4 v7, s[8:11], s17 offen lds
    s_add_u32 m0, s19, 25600
    s_add_u32 s17, s37, 1671232
    s_bitset0_b32 s17, 21
    s_add_u32 s17, s17, s20
    buffer_load_dwordx4 v7, s[8:11], s17 offen lds
    s_waitcnt vmcnt(28)
    ds_read_b64_tr_b16 v[240:241], v8 offset:28672
    ds_read_b64_tr_b16 v[242:243], v8 offset:28928
    ds_read_b64_tr_b16 v[244:245], v8 offset:28704
    ds_read_b64_tr_b16 v[246:247], v8 offset:28960
    s_waitcnt lgkmcnt(4)
    s_add_u32 m0, s19, 26624
    s_add_u32 s17, s37, 1769536
    s_bitset0_b32 s17, 21
    s_add_u32 s17, s17, s20
    buffer_load_dwordx4 v7, s[8:11], s17 offen lds
    s_add_u32 m0, s19, 27648
    s_add_u32 s17, s37, 1802304
    s_bitset0_b32 s17, 21
    s_add_u32 s17, s17, s20
    buffer_load_dwordx4 v7, s[8:11], s17 offen lds
    s_waitcnt vmcnt(28)
    ds_read_b64_tr_b16 v[248:249], v8 offset:30720
    ds_read_b64_tr_b16 v[250:251], v8 offset:30976
    ds_read_b64_tr_b16 v[252:253], v8 offset:30752
    ds_read_b64_tr_b16 v[254:255], v8 offset:31008
    s_waitcnt lgkmcnt(4)
    s_add_u32 m0, s19, 28672
    s_add_u32 s17, s37, 1900608
    s_bitset0_b32 s17, 21
    s_add_u32 s17, s17, s20
    buffer_load_dwordx4 v7, s[8:11], s17 offen lds
    s_add_u32 m0, s19, 29696
    s_add_u32 s17, s37, 1933376
    s_bitset0_b32 s17, 21
    s_add_u32 s17, s17, s20
    buffer_load_dwordx4 v7, s[8:11], s17 offen lds
    s_waitcnt lgkmcnt(0)
    s_add_u32 m0, s19, 30720
    s_add_u32 s17, s37, 2031680
    s_bitset0_b32 s17, 21
    s_add_u32 s17, s17, s20
    buffer_load_dwordx4 v7, s[8:11], s17 offen lds
    s_add_u32 m0, s19, 31744
    s_add_u32 s17, s37, 2064448
    s_bitset0_b32 s17, 21
    s_add_u32 s17, s17, s20
    buffer_load_dwordx4 v7, s[8:11], s17 offen lds
    s_lshr_b32 s37, s37, 6
    s_add_u32 s37, s37, 54525952
    v_lshlrev_b32 v15, 4, v1
    v_add_u32 v10, s19, v15
    s_lshl_b32 s17, s16, 10
    s_add_u32 s17, s17, 131072
    v_add_u32 v14, s17, v15
    s_lshl_b32 s17, s16, 12
    s_add_u32 s18, s17, 147456
    v_add_u32 v15, s18, v15
    v_bfe_u32 v11, v1, 3, 2
    v_and_b32 v5, 7, v1
    v_lshlrev_b32 v5, 9, v5
    v_lshl_add_u32 v11, v11, 7, v5
    s_add_u32 s17, s17, 100728832
    v_add_u32 v11, s17, v11
    v_mov_b32 v12, 0
    v_and_b32 v13, 15, v1
    v_lshrrev_b32 v5, 4, v1
    v_lshlrev_b32 v5, 3, v5
    v_lshl_add_u32 v13, v13, 12, v5
    s_lshl_b32 s17, s35, 7
    s_lshl_b32 s18, s16, 5
    s_add_u32 s17, s17, s18
    s_add_u32 s17, s17, 2048
    v_add_u32 v13, s17, v13
    s_waitcnt vmcnt(0)
    s_mov_b32 s36, 0
U_wait:
    s_mov_b32 s29, s92
U_fl:
    s_lshr_b32 s17, s28, 3
    v_cmp_ge_u32 vcc, s17, v12
    s_lshl_b32 s18, s28, 2
    s_and_b32 s18, s18, 24
    s_lshr_b32 s17, vcc_lo, s18
    s_and_b32 s17, s17, 0xff
    s_cbranch_scc0 U_go
    s_cmp_ge_u32 s29, 1048576
    s_cselect_b32 s92, 1048576, s92
    s_cbranch_scc1 U_go
    s_lshl_b32 s17, s17, s18
    s_cmp_eq_u32 s29, 0
    s_cselect_b32 exec_lo, -1, s17
    s_mov_b32 exec_hi, 0
    s_add_u32 s29, s29, 1
    buffer_load_dword v12, v11, s[4:7], 0 offen sc1
    s_mov_b64 exec, -1
    s_sleep 2
    s_waitcnt vmcnt(0)
    s_branch U_fl
U_go:
    s_lshl_b32 s30, s28, 17
    s_add_u32 s30, s30, s37
    buffer_load_dwordx4 v[64:67], v10, s[4:7], s30 offen offset:0
    buffer_load_dwordx4 v[68:71], v10, s[4:7], s30 offen offset:1024
    buffer_load_dwordx4 v[72:75], v10, s[4:7], s30 offen offset:2048
    buffer_load_dwordx4 v[76:79], v10, s[4:7], s30 offen offset:3072
    s_add_u32 s30, s30, 4096
    s_bitset0_b32 s30, 15
    buffer_load_dwordx4 v[80:83], v10, s[4:7], s30 offen offset:0
    buffer_load_dwordx4 v[84:87], v10, s[4:7], s30 offen offset:1024
    buffer_load_dwordx4 v[88:91], v10, s[4:7], s30 offen offset:2048
    buffer_load_dwordx4 v[92:95], v10, s[4:7], s30 offen offset:3072
    s_add_u32 s30, s30, 4096
    s_bitset0_b32 s30, 15
    buffer_load_dwordx4 v[96:99], v10, s[4:7], s30 offen offset:0
    buffer_load_dwordx4 v[100:103], v10, s[4:7], s30 offen offset:1024
    buffer_load_dwordx4 v[104:107], v10, s[4:7], s30 offen offset:2048
    buffer_load_dwordx4 v[108:111], v10, s[4:7], s30 offen offset:3072
    s_add_u32 s30, s30, 4096
    s_bitset0_b32 s30, 15
    buffer_load_dwordx4 v[112:115], v10, s[4:7], s30 offen offset:0
    buffer_load_dwordx4 v[116:119], v10, s[4:7], s30 offen offset:1024
    buffer_load_dwordx4 v[120:123], v10, s[4:7], s30 offen offset:2048
    s_mov_b32 s34, 0
    s_mov_b32 s31, 1073741824
    ds_read_b64_tr_b16 v[32:33], v8 offset:0
    ds_read_b64_tr_b16 v[34:35], v8 offset:256
    ds_read_b64_tr_b16 v[36:37], v8 offset:32
    ds_read_b64_tr_b16 v[38:39], v8 offset:288
    ds_read_b128 v[48:51], v15 offset:0
    ds_read_b128 v[52:55], v15 offset:1024
    ds_read_b128 v[56:59], v15 offset:2048
    ds_read_b128 v[60:63], v15 offset:3072
.p2align 6
U_item:
    s_waitcnt vmcnt(14)
    v_mfma_f32_16x16x32_bf16 v[16:19], a[0:3], v[64:67], 0
    buffer_load_dwordx4 v[124:127], v10, s[4:7], s30 offen offset:3072
    v_mfma_f32_16x16x32_bf16 v[20:23], a[4:7], v[64:67], 0
    s_add_u32 s33, s28, 6
    s_lshr_b32 s17, s33, 3
    v_cmp_ge_u32 vcc, s17, v12
    s_lshl_b32 s18, s33, 2
    s_and_b32 s18, s18, 24
    v_mfma_f32_16x16x32_bf16 v[24:27], v[128:131], v[64:67], 0
    s_lshr_b32 s17, vcc_lo, s18
    s_and_b32 s17, s17, 0xff
    s_lshl_b32 exec_lo, s17, s18
    s_mov_b32 exec_hi, 0
    buffer_load_dword v12, v11, s[4:7], 0 offen sc1
    s_mov_b64 exec, -1
    v_mfma_f32_16x16x32_bf16 v[28:31], v[132:135], v[64:67], 0
    s_waitcnt vmcnt(15)
    s_waitcnt lgkmcnt(4)
    v_mfma_f32_16x16x32_bf16 v[16:19], a[8:11], v[68:71], v[16:19]
    s_add_u32 s30, s30, 4096
    s_bitset0_b32 s30, 15
    buffer_load_dwordx4 v[64:67], v10, s[4:7], s30 offen offset:0
    ds_read_b64_tr_b16 v[40:41], v8 offset:2048
    ds_read_b64_tr_b16 v[42:43], v8 offset:2304
    v_mfma_f32_16x16x32_bf16 v[20:23], a[12:15], v[68:71], v[20:23]
    ds_read_b64_tr_b16 v[44:45], v8 offset:2080
    ds_read_b64_tr_b16 v[46:47], v8 offset:2336
    v_mfma_f32_16x16x32_bf16 v[24:27], v[32:35], v[68:71], v[24:27]
    v_mfma_f32_16x16x32_bf16 v[28:31], v[36:39], v[68:71], v[28:31]
    s_waitcnt vmcnt(15)
    v_mfma_f32_16x16x32_bf16 v[16:19], a[16:19], v[72:75], v[16:19]
    buffer_load_dwordx4 v[68:71], v10, s[4:7], s30 offen offset:1024
    v_mfma_f32_16x16x32_bf16 v[20:23], a[20:23], v[72:75], v[20:23]
    s_waitcnt lgkmcnt(4)
    s_cmp_eq_u32 s34, 0
    s_cbranch_scc1 U_nb
    s_barrier
U_nb:
    v_mfma_f32_16x16x32_bf16 v[24:27], v[136:139], v[72:75], v[24:27]
    ds_read_b128 v[48:51], v15 offset:0
    ds_read_b128 v[52:55], v15 offset:1024
    v_mfma_f32_16x16x32_bf16 v[28:31], v[140:143], v[72:75], v[28:31]
    ds_read_b128 v[56:59], v15 offset:2048
    ds_read_b128 v[60:63], v15 offset:3072
    s_waitcnt vmcnt(15)
    s_waitcnt lgkmcnt(4)
    v_mfma_f32_16x16x32_bf16 v[16:19], a[24:27], v[76:79], v[16:19]
    buffer_load_dwordx4 v[72:75], v10, s[4:7], s30 offen offset:2048
    ds_read_b64_tr_b16 v[32:33], v8 offset:4096
    ds_read_b64_tr_b16 v[34:35], v8 offset:4352
    v_mfma_f32_16x16x32_bf16 v[20:23], a[28:31], v[76:79], v[20:23]
    ds_read_b64_tr_b16 v[36:37], v8 offset:4128
    ds_read_b64_tr_b16 v[38:39], v8 offset:4384
    v_mfma_f32_16x16x32_bf16 v[24:27], v[40:43], v[76:79], v[24:27]
    v_mfma_f32_16x16x32_bf16 v[28:31], v[44:47], v[76:79], v[28:31]
    s_waitcnt vmcnt(15)
    v_mfma_f32_16x16x32_bf16 v[16:19], a[32:35], v[80:83], v[16:19]
    buffer_load_dwordx4 v[76:79], v10, s[4:7], s30 offen offset:3072
    s_waitcnt lgkmcnt(4)
    v_mfma_f32_16x16x32_bf16 v[20:23], a[36:39], v[80:83], v[20:23]
    v_add_f32 v48, v48, v52
    v_add_f32 v49, v49, v53
    v_mfma_f32_16x16x32_bf16 v[24:27], v[144:147], v[80:83], v[24:27]
    v_add_f32 v50, v50, v54
    v_add_f32 v51, v51, v55
    v_mfma_f32_16x16x32_bf16 v[28:31], v[148:151], v[80:83], v[28:31]
    s_waitcnt vmcnt(15)
    s_waitcnt lgkmcnt(0)
    v_mfma_f32_16x16x32_bf16 v[16:19], a[40:43], v[84:87], v[16:19]
    s_add_u32 s30, s30, 4096
    s_bitset0_b32 s30, 15
    buffer_load_dwordx4 v[80:83], v10, s[4:7], s30 offen offset:0
    ds_read_b64_tr_b16 v[40:41], v8 offset:6144
    ds_read_b64_tr_b16 v[42:43], v8 offset:6400
    v_mfma_f32_16x16x32_bf16 v[20:23], a[44:47], v[84:87], v[20:23]
    v_add_f32 v56, v56, v60
    v_add_f32 v57, v57, v61
    ds_read_b64_tr_b16 v[44:45], v8 offset:6176
    ds_read_b64_tr_b16 v[46:47], v8 offset:6432
    v_mfma_f32_16x16x32_bf16 v[24:27], v[32:35], v[84:87], v[24:27]
    v_add_f32 v58, v58, v62
    v_add_f32 v59, v59, v63
    v_mfma_f32_16x16x32_bf16 v[28:31], v[36:39], v[84:87], v[28:31]
    s_waitcnt vmcnt(15)
    v_mfma_f32_16x16x32_bf16 v[16:19], a[48:51], v[88:91], v[16:19]
    buffer_load_dwordx4 v[84:87], v10, s[4:7], s30 offen offset:1024
    v_mfma_f32_16x16x32_bf16 v[20:23], a[52:55], v[88:91], v[20:23]
    v_add_f32 v48, v48, v56
    v_add_f32 v49, v49, v57
    v_mfma_f32_16x16x32_bf16 v[24:27], v[152:155], v[88:91], v[24:27]
    v_add_f32 v50, v50, v58
    v_add_f32 v51, v51, v59
    v_mfma_f32_16x16x32_bf16 v[28:31], v[156:159], v[88:91], v[28:31]
    s_waitcnt vmcnt(15)
    s_waitcnt lgkmcnt(0)
    v_mfma_f32_16x16x32_bf16 v[16:19], a[56:59], v[92:95], v[16:19]
    buffer_load_dwordx4 v[88:91], v10, s[4:7], s30 offen offset:2048
    ds_read_b64_tr_b16 v[32:33], v8 offset:8192
    ds_read_b64_tr_b16 v[34:35], v8 offset:8448
    v_mfma_f32_16x16x32_bf16 v[20:23], a[60:63], v[92:95], v[20:23]
    v_cvt_pk_bf16_f32 v52, v48, v49
    v_cvt_pk_bf16_f32 v53, v50, v51
    ds_read_b64_tr_b16 v[36:37], v8 offset:8224
    ds_read_b64_tr_b16 v[38:39], v8 offset:8480
    v_mfma_f32_16x16x32_bf16 v[24:27], v[40:43], v[92:95], v[24:27]
    v_mfma_f32_16x16x32_bf16 v[28:31], v[44:47], v[92:95], v[28:31]
    s_waitcnt vmcnt(15)
    v_mfma_f32_16x16x32_bf16 v[16:19], a[64:67], v[96:99], v[16:19]
    buffer_load_dwordx4 v[92:95], v10, s[4:7], s30 offen offset:3072
    v_mfma_f32_16x16x32_bf16 v[20:23], a[68:71], v[96:99], v[20:23]
    buffer_store_dwordx2 v[52:53], v13, s[12:15], s31 offen
    v_xor_b32 v15, 0x4000, v15
    v_mfma_f32_16x16x32_bf16 v[24:27], v[160:163], v[96:99], v[24:27]
    v_mfma_f32_16x16x32_bf16 v[28:31], v[164:167], v[96:99], v[28:31]
    s_waitcnt vmcnt(16)
    s_waitcnt lgkmcnt(0)
    v_mfma_f32_16x16x32_bf16 v[16:19], a[72:75], v[100:103], v[16:19]
    s_add_u32 s30, s30, 4096
    s_bitset0_b32 s30, 15
    buffer_load_dwordx4 v[96:99], v10, s[4:7], s30 offen offset:0
    ds_read_b64_tr_b16 v[40:41], v8 offset:10240
    ds_read_b64_tr_b16 v[42:43], v8 offset:10496
    v_mfma_f32_16x16x32_bf16 v[20:23], a[76:79], v[100:103], v[20:23]
    ds_read_b64_tr_b16 v[44:45], v8 offset:10272
    ds_read_b64_tr_b16 v[46:47], v8 offset:10528
    v_mfma_f32_16x16x32_bf16 v[24:27], v[32:35], v[100:103], v[24:27]
    v_mfma_f32_16x16x32_bf16 v[28:31], v[36:39], v[100:103], v[28:31]
    s_waitcnt vmcnt(16)
    v_mfma_f32_16x16x32_bf16 v[16:19], a[80:83], v[104:107], v[16:19]
    buffer_load_dwordx4 v[100:103], v10, s[4:7], s30 offen offset:1024
    v_mfma_f32_16x16x32_bf16 v[20:23], a[84:87], v[104:107], v[20:23]
    v_mfma_f32_16x16x32_bf16 v[24:27], v[168:171], v[104:107], v[24:27]
    v_mfma_f32_16x16x32_bf16 v[28:31], v[172:175], v[104:107], v[28:31]
    s_waitcnt vmcnt(16)
    s_waitcnt lgkmcnt(0)
    v_mfma_f32_16x16x32_bf16 v[16:19], a[88:91], v[108:111], v[16:19]
    buffer_load_dwordx4 v[104:107], v10, s[4:7], s30 offen offset:2048
    ds_read_b64_tr_b16 v[32:33], v8 offset:12288
    ds_read_b64_tr_b16 v[34:35], v8 offset:12544
    v_mfma_f32_16x16x32_bf16 v[20:23], a[92:95], v[108:111], v[20:23]
    ds_read_b64_tr_b16 v[36:37], v8 offset:12320
    ds_read_b64_tr_b16 v[38:39], v8 offset:12576
    v_mfma_f32_16x16x32_bf16 v[24:27], v[40:43], v[108:111], v[24:27]
    v_mfma_f32_16x16x32_bf16 v[28:31], v[44:47], v[108:111], v[28:31]
    s_waitcnt vmcnt(16)
    v_mfma_f32_16x16x32_bf16 v[16:19], a[96:99], v[112:115], v[16:19]
    buffer_load_dwordx4 v[108:111], v10, s[4:7], s30 offen offset:3072
    v_mfma_f32_16x16x32_bf16 v[20:23], a[100:103], v[112:115], v[20:23]
    v_mfma_f32_16x16x32_bf16 v[24:27], v[176:179], v[112:115], v[24:27]
    v_mfma_f32_16x16x32_bf16 v[28:31], v[180:183], v[112:115], v[28:31]
    s_waitcnt vmcnt(16)
    s_waitcnt lgkmcnt(0)
    v_mfma_f32_16x16x32_bf16 v[16:19], a[104:107], v[116:119], v[16:19]
    s_add_u32 s30, s30, 4096
    s_bitset0_b32 s30, 15
    buffer_load_dwordx4 v[112:115], v10, s[4:7], s30 offen offset:0
    ds_read_b64_tr_b16 v[40:41], v8 offset:14336
    ds_read_b64_tr_b16 v[42:43], v8 offset:14592
    v_mfma_f32_16x16x32_bf16 v[20:23], a[108:111], v[116:119], v[20:23]
    ds_read_b64_tr_b16 v[44:45], v8 offset:14368
    ds_read_b64_tr_b16 v[46:47], v8 offset:14624
    v_mfma_f32_16x16x32_bf16 v[24:27], v[32:35], v[116:119], v[24:27]
    v_mfma_f32_16x16x32_bf16 v[28:31], v[36:39], v[116:119], v[28:31]
    s_waitcnt vmcnt(16)
    v_mfma_f32_16x16x32_bf16 v[16:19], a[112:115], v[120:123], v[16:19]
    buffer_load_dwordx4 v[116:119], v10, s[4:7], s30 offen offset:1024
    v_mfma_f32_16x16x32_bf16 v[20:23], a[116:119], v[120:123], v[20:23]
    v_mfma_f32_16x16x32_bf16 v[24:27], v[184:187], v[120:123], v[24:27]
    v_mfma_f32_16x16x32_bf16 v[28:31], v[188:191], v[120:123], v[28:31]
    s_waitcnt vmcnt(16)
    s_waitcnt lgkmcnt(0)
    v_mfma_f32_16x16x32_bf16 v[16:19], a[120:123], v[124:127], v[16:19]
    buffer_load_dwordx4 v[120:123], v10, s[4:7], s30 offen offset:2048
    ds_read_b64_tr_b16 v[32:33], v8 offset:16384
    ds_read_b64_tr_b16 v[34:35], v8 offset:16640
    v_mfma_f32_16x16x32_bf16 v[20:23], a[124:127], v[124:127], v[20:23]
    ds_read_b64_tr_b16 v[36:37], v8 offset:16416
    ds_read_b64_tr_b16 v[38:39], v8 offset:16672
    v_mfma_f32_16x16x32_bf16 v[24:27], v[40:43], v[124:127], v[24:27]
    v_mfma_f32_16x16x32_bf16 v[28:31], v[44:47], v[124:127], v[28:31]
    s_waitcnt vmcnt(15)
    v_mfma_f32_16x16x32_bf16 v[16:19], a[128:131], v[64:67], v[16:19]
    buffer_load_dwordx4 v[124:127], v10, s[4:7], s30 offen offset:3072
    v_mfma_f32_16x16x32_bf16 v[20:23], a[132:135], v[64:67], v[20:23]
    s_lshr_b32 s17, s33, 3
    v_cmp_ge_u32 vcc, s17, v12
    s_lshl_b32 s18, s33, 2
    s_and_b32 s18, s18, 24
    v_mfma_f32_16x16x32_bf16 v[24:27], v[192:195], v[64:67], v[24:27]
    s_lshl_b32 s30, s33, 17
    s_add_u32 s30, s30, s37
    s_lshr_b32 s17, vcc_lo, s18
    s_and_b32 s17, s17, 0xff
    s_cselect_b32 s34, 0, 1
    s_cselect_b32 s30, 1073741824, s30
    v_mfma_f32_16x16x32_bf16 v[28:31], v[196:199], v[64:67], v[28:31]
    s_waitcnt vmcnt(15)
    s_waitcnt lgkmcnt(0)
    v_mfma_f32_16x16x32_bf16 v[16:19], a[136:139], v[68:71], v[16:19]
    buffer_load_dwordx4 v[64:67], v10, s[4:7], s30 offen offset:0
    ds_read_b64_tr_b16 v[40:41], v8 offset:18432
    ds_read_b64_tr_b16 v[42:43], v8 offset:18688
    v_mfma_f32_16x16x32_bf16 v[20:23], a[140:143], v[68:71], v[20:23]
    ds_read_b64_tr_b16 v[44:45], v8 offset:18464
    ds_read_b64_tr_b16 v[46:47], v8 offset:18720
    v_mfma_f32_16x16x32_bf16 v[24:27], v[32:35], v[68:71], v[24:27]
    v_mfma_f32_16x16x32_bf16 v[28:31], v[36:39], v[68:71], v[28:31]
    s_waitcnt vmcnt(15)
    v_mfma_f32_16x16x32_bf16 v[16:19], a[144:147], v[72:75], v[16:19]
    buffer_load_dwordx4 v[68:71], v10, s[4:7], s30 offen offset:1024
    v_mfma_f32_16x16x32_bf16 v[20:23], a[148:151], v[72:75], v[20:23]
    v_mfma_f32_16x16x32_bf16 v[24:27], v[200:203], v[72:75], v[24:27]
    v_mfma_f32_16x16x32_bf16 v[28:31], v[204:207], v[72:75], v[28:31]
    s_waitcnt vmcnt(15)
    s_waitcnt lgkmcnt(0)
    v_mfma_f32_16x16x32_bf16 v[16:19], a[152:155], v[76:79], v[16:19]
    buffer_load_dwordx4 v[72:75], v10, s[4:7], s30 offen offset:2048
    ds_read_b64_tr_b16 v[32:33], v8 offset:20480
    ds_read_b64_tr_b16 v[34:35], v8 offset:20736
    v_mfma_f32_16x16x32_bf16 v[20:23], a[156:159], v[76:79], v[20:23]
    ds_read_b64_tr_b16 v[36:37], v8 offset:20512
    ds_read_b64_tr_b16 v[38:39], v8 offset:20768
    v_mfma_f32_16x16x32_bf16 v[24:27], v[40:43], v[76:79], v[24:27]
    v_mfma_f32_16x16x32_bf16 v[28:31], v[44:47], v[76:79], v[28:31]
    s_waitcnt vmcnt(15)
    v_mfma_f32_16x16x32_bf16 v[16:19], a[160:163], v[80:83], v[16:19]
    buffer_load_dwordx4 v[76:79], v10, s[4:7], s30 offen offset:3072
    v_mfma_f32_16x16x32_bf16 v[20:23], a[164:167], v[80:83], v[20:23]
    v_mfma_f32_16x16x32_bf16 v[24:27], v[208:211], v[80:83], v[24:27]
    v_mfma_f32_16x16x32_bf16 v[28:31], v[212:215], v[80:83], v[28:31]
    s_waitcnt vmcnt(15)
    s_waitcnt lgkmcnt(0)
    v_mfma_f32_16x16x32_bf16 v[16:19], a[168:171], v[84:87], v[16:19]
    s_add_u32 s30, s30, 4096
    s_bitset0_b32 s30, 15
    buffer_load_dwordx4 v[80:83], v10, s[4:7], s30 offen offset:0
    ds_read_b64_tr_b16 v[40:41], v8 offset:22528
    ds_read_b64_tr_b16 v[42:43], v8 offset:22784
    v_mfma_f32_16x16x32_bf16 v[20:23], a[172:175], v[84:87], v[20:23]
    ds_read_b64_tr_b16 v[44:45], v8 offset:22560
    ds_read_b64_tr_b16 v[46:47], v8 offset:22816
    v_mfma_f32_16x16x32_bf16 v[24:27], v[32:35], v[84:87], v[24:27]
    v_mfma_f32_16x16x32_bf16 v[28:31], v[36:39], v[84:87], v[28:31]
    s_waitcnt vmcnt(15)
    v_mfma_f32_16x16x32_bf16 v[16:19], a[176:179], v[88:91], v[16:19]
    buffer_load_dwordx4 v[84:87], v10, s[4:7], s30 offen offset:1024
    v_mfma_f32_16x16x32_bf16 v[20:23], a[180:183], v[88:91], v[20:23]
    v_mfma_f32_16x16x32_bf16 v[24:27], v[216:219], v[88:91], v[24:27]
    v_mfma_f32_16x16x32_bf16 v[28:31], v[220:223], v[88:91], v[28:31]
    s_waitcnt vmcnt(15)
    s_waitcnt lgkmcnt(0)
    v_mfma_f32_16x16x32_bf16 v[16:19], a[184:187], v[92:95], v[16:19]
    buffer_load_dwordx4 v[88:91], v10, s[4:7], s30 offen offset:2048
    ds_read_b64_tr_b16 v[32:33], v8 offset:24576
    ds_read_b64_tr_b16 v[34:35], v8 offset:24832
    v_mfma_f32_16x16x32_bf16 v[20:23], a[188:191], v[92:95], v[20:23]
    ds_read_b64_tr_b16 v[36:37], v8 offset:24608
    ds_read_b64_tr_b16 v[38:39], v8 offset:24864
    v_mfma_f32_16x16x32_bf16 v[24:27], v[40:43], v[92:95], v[24:27]
    v_mfma_f32_16x16x32_bf16 v[28:31], v[44:47], v[92:95], v[28:31]
    s_waitcnt vmcnt(14)
    v_mfma_f32_16x16x32_bf16 v[16:19], a[192:195], v[96:99], v[16:19]
    buffer_load_dwordx4 v[92:95], v10, s[4:7], s30 offen offset:3072
    v_mfma_f32_16x16x32_bf16 v[20:23], a[196:199], v[96:99], v[20:23]
    v_mfma_f32_16x16x32_bf16 v[24:27], v[224:227], v[96:99], v[24:27]
    v_mfma_f32_16x16x32_bf16 v[28:31], v[228:231], v[96:99], v[28:31]
    s_waitcnt vmcnt(14)
    s_waitcnt lgkmcnt(0)
    v_mfma_f32_16x16x32_bf16 v[16:19], a[200:203], v[100:103], v[16:19]
    s_add_u32 s30, s30, 4096
    s_bitset0_b32 s30, 15
    buffer_load_dwordx4 v[96:99], v10, s[4:7], s30 offen offset:0
    ds_read_b64_tr_b16 v[40:41], v8 offset:26624
    ds_read_b64_tr_b16 v[42:43], v8 offset:26880
    v_mfma_f32_16x16x32_bf16 v[20:23], a[204:207], v[100:103], v[20:23]
    ds_read_b64_tr_b16 v[44:45], v8 offset:26656
    ds_read_b64_tr_b16 v[46:47], v8 offset:26912
    v_mfma_f32_16x16x32_bf16 v[24:27], v[32:35], v[100:103], v[24:27]
    v_mfma_f32_16x16x32_bf16 v[28:31], v[36:39], v[100:103], v[28:31]
    s_waitcnt vmcnt(14)
    v_mfma_f32_16x16x32_bf16 v[16:19], a[208:211], v[104:107], v[16:19]
    buffer_load_dwordx4 v[100:103], v10, s[4:7], s30 offen offset:1024
    v_mfma_f32_16x16x32_bf16 v[20:23], a[212:215], v[104:107], v[20:23]
    v_mfma_f32_16x16x32_bf16 v[24:27], v[232:235], v[104:107], v[24:27]
    v_mfma_f32_16x16x32_bf16 v[28:31], v[236:239], v[104:107], v[28:31]
    s_waitcnt vmcnt(14)
    s_waitcnt lgkmcnt(0)
    v_mfma_f32_16x16x32_bf16 v[16:19], a[216:219], v[108:111], v[16:19]
    buffer_load_dwordx4 v[104:107], v10, s[4:7], s30 offen offset:2048
    ds_read_b64_tr_b16 v[32:33], v8 offset:28672
    ds_read_b64_tr_b16 v[34:35], v8 offset:28928
    v_mfma_f32_16x16x32_bf16 v[20:23], a[220:223], v[108:111], v[20:23]
    ds_read_b64_tr_b16 v[36:37], v8 offset:28704
    ds_read_b64_tr_b16 v[38:39], v8 offset:28960
    v_mfma_f32_16x16x32_bf16 v[24:27], v[40:43], v[108:111], v[24:27]
    v_mfma_f32_16x16x32_bf16 v[28:31], v[44:47], v[108:111], v[28:31]
    s_waitcnt vmcnt(14)
    v_mfma_f32_16x16x32_bf16 v[16:19], a[224:227], v[112:115], v[16:19]
    buffer_load_dwordx4 v[108:111], v10, s[4:7], s30 offen offset:3072
    v_mfma_f32_16x16x32_bf16 v[20:23], a[228:231], v[112:115], v[20:23]
    v_mfma_f32_16x16x32_bf16 v[24:27], v[240:243], v[112:115], v[24:27]
    v_mfma_f32_16x16x32_bf16 v[28:31], v[244:247], v[112:115], v[28:31]
    s_waitcnt vmcnt(14)
    s_waitcnt lgkmcnt(0)
    v_mfma_f32_16x16x32_bf16 v[16:19], a[232:235], v[116:119], v[16:19]
    s_add_u32 s30, s30, 4096
    s_bitset0_b32 s30, 15
    buffer_load_dwordx4 v[112:115], v10, s[4:7], s30 offen offset:0
    ds_read_b64_tr_b16 v[40:41], v8 offset:30720
    ds_read_b64_tr_b16 v[42:43], v8 offset:30976
    v_mfma_f32_16x16x32_bf16 v[20:23], a[236:239], v[116:119], v[20:23]
    ds_read_b64_tr_b16 v[44:45], v8 offset:30752
    ds_read_b64_tr_b16 v[46:47], v8 offset:31008
    v_mfma_f32_16x16x32_bf16 v[24:27], v[32:35], v[116:119], v[24:27]
    v_mfma_f32_16x16x32_bf16 v[28:31], v[36:39], v[116:119], v[28:31]
    s_waitcnt vmcnt(14)
    v_mfma_f32_16x16x32_bf16 v[16:19], a[240:243], v[120:123], v[16:19]
    buffer_load_dwordx4 v[116:119], v10, s[4:7], s30 offen offset:1024
    v_mfma_f32_16x16x32_bf16 v[20:23], a[244:247], v[120:123], v[20:23]
    v_mfma_f32_16x16x32_bf16 v[24:27], v[248:251], v[120:123], v[24:27]
    v_mfma_f32_16x16x32_bf16 v[28:31], v[252:255], v[120:123], v[28:31]
    s_waitcnt vmcnt(14)
    s_waitcnt lgkmcnt(0)
    v_mfma_f32_16x16x32_bf16 v[16:19], a[248:251], v[124:127], v[16:19]
    buffer_load_dwordx4 v[120:123], v10, s[4:7], s30 offen offset:2048
    ds_read_b64_tr_b16 v[32:33], v8 offset:0
    ds_read_b64_tr_b16 v[34:35], v8 offset:256
    v_mfma_f32_16x16x32_bf16 v[20:23], a[252:255], v[124:127], v[20:23]
    ds_read_b64_tr_b16 v[36:37], v8 offset:32
    ds_read_b64_tr_b16 v[38:39], v8 offset:288
    v_mfma_f32_16x16x32_bf16 v[24:27], v[40:43], v[124:127], v[24:27]
    v_mfma_f32_16x16x32_bf16 v[28:31], v[44:47], v[124:127], v[28:31]
    s_lshl_b32 s31, s28, 16
    s_mov_b32 s28, s33
    s_cmp_eq_u32 s34, 1
    ds_write_b128 v14, v[16:19] offset:0
    ds_write_b128 v14, v[20:23] offset:4096
    ds_write_b128 v14, v[24:27] offset:8192
    s_nop 1
    ds_write_b128 v14, v[28:31] offset:12288
    v_xor_b32 v14, 0x4000, v14
    s_cbranch_scc1 U_item
    s_waitcnt lgkmcnt(0)
    s_barrier
    ds_read_b128 v[48:51], v15 offset:0
    ds_read_b128 v[52:55], v15 offset:1024
    ds_read_b128 v[56:59], v15 offset:2048
    ds_read_b128 v[60:63], v15 offset:3072
    s_waitcnt lgkmcnt(0)
    v_add_f32 v48, v48, v52
    v_add_f32 v49, v49, v53
    v_add_f32 v50, v50, v54
    v_add_f32 v51, v51, v55
    v_add_f32 v56, v56, v60
    v_add_f32 v57, v57, v61
    v_add_f32 v58, v58, v62
    v_add_f32 v59, v59, v63
    v_add_f32 v48, v48, v56
    v_add_f32 v49, v49, v57
    v_add_f32 v50, v50, v58
    v_add_f32 v51, v51, v59
    v_cvt_pk_bf16_f32 v52, v48, v49
    v_cvt_pk_bf16_f32 v53, v50, v51
    buffer_store_dwordx2 v[52:53], v13, s[12:15], s31 offen
    s_cmp_lt_u32 s28, 128
    s_cbranch_scc1 U_wait
    s_branch W_fin
W_F:
    s_waitcnt vmcnt(0)
    s_barrier
    s_cmp_lg_u32 s16, 0
    s_cbranch_scc1 reg_16
    s_and_b32 s17, s2, 3
    s_lshl_b32 s17, s17, 3
    s_lshl_b32 s18, s98, 2
    s_add_u32 s17, s17, s18
    s_lshl_b32 s17, 1, s17
    s_andn2_b32 s18, s2, 3
    v_mov_b32 v5, s18
    v_mov_b32 v6, s17
    s_mov_b64 exec, 1
    global_atomic_add v5, v6, s[100:101] sc1
    s_mov_b64 exec, -1
reg_16:
    s_load_dwordx2 s[48:49], s[0:1], 8
    s_load_dwordx2 s[52:53], s[0:1], 16
    s_mov_b32 s50, 2101248
    s_mov_b32 s51, 0x20000
    s_mov_b32 s54, 2101248
    s_mov_b32 s55, 0x20000
    s_load_dwordx2 s[40:41], s[0:1], 0
    s_load_dwordx2 s[44:45], s[0:1], 24
    s_mov_b32 s42, 4194304
    s_mov_b32 s43, 0x20000
    s_mov_b32 s46, 4194304
    s_mov_b32 s47, 0x20000
    s_lshr_b32 s28, s93, 3
    s_and_b32 s29, s93, 7
    s_lshl_b32 s29, s29, 2
    s_add_u32 s29, s29, s16
    v_bfe_u32 v5, v1, 2, 2
    v_and_b32 v7, 3, v1
    v_lshl_add_u32 v7, v5, 3, v7
    s_lshl_b32 s17, s29, 5
    v_add_u32 v7, s17, v7
    v_lshrrev_b32 v8, 4, v1
    v_cvt_f32_u32 v8, v8
    s_mov_b32 s31, 981467136
    v_add_u32 v5, 0, v7
    v_lshrrev_b32 v6, 1, v5
    v_and_b32 v30, 1, v5
    v_cmp_eq_u32 vcc, 1, v5
    v_mov_b32 v5, 512
    s_nop 0
    v_cndmask_b32 v6, v6, v5, vcc
    v_cndmask_b32 v30, v30, 0, vcc
    v_add_u32 v5, v6, v30
    v_bfe_i32 v40, v5, 1, 1
    v_add_u32 v5, v6, v5
    v_bfe_i32 v42, v5, 1, 1
    v_add_u32 v5, v6, v5
    v_bfe_i32 v44, v5, 1, 1
    v_and_b32 v40, 0x80008000, v40
    v_and_b32 v42, 0x80008000, v42
    v_and_b32 v44, 0x80008000, v44
    v_cvt_f32_u32 v6, v6
    v_cvt_f32_u32 v30, v30
    v_mul_f32 v32, s31, v6
    v_mul_f32 v30, 0x3e800000, v30
    v_mov_b32 v34, v32
    v_mul_f32 v36, 0x42000000, v32
    v_mul_f32 v5, 0x41000000, v32
    v_fma_f32 v30, v5, v8, v30
    v_add_u32 v5, 4, v7
    v_lshrrev_b32 v6, 1, v5
    v_and_b32 v31, 1, v5
    v_cmp_eq_u32 vcc, 1, v5
    v_mov_b32 v5, 512
    s_nop 0
    v_cndmask_b32 v6, v6, v5, vcc
    v_cndmask_b32 v31, v31, 0, vcc
    v_add_u32 v5, v6, v31
    v_bfe_i32 v41, v5, 1, 1
    v_add_u32 v5, v6, v5
    v_bfe_i32 v43, v5, 1, 1
    v_add_u32 v5, v6, v5
    v_bfe_i32 v45, v5, 1, 1
    v_and_b32 v41, 0x80008000, v41
    v_and_b32 v43, 0x80008000, v43
    v_and_b32 v45, 0x80008000, v45
    v_cvt_f32_u32 v6, v6
    v_cvt_f32_u32 v31, v31
    v_mul_f32 v33, s31, v6
    v_mul_f32 v31, 0x3e800000, v31
    v_mov_b32 v35, v33
    v_mul_f32 v37, 0x42000000, v33
    v_mul_f32 v5, 0x41000000, v33
    v_fma_f32 v31, v5, v8, v31
    v_fract_f32 v48, v30
    v_add_f32 v49, v48, v32
    v_cos_f32 v56, v48
    v_add_f32 v50, v49, v34
    v_cos_f32 v57, v49
    v_add_f32 v51, v50, v32
    v_cos_f32 v58, v50
    v_add_f32 v52, v51, v34
    v_cos_f32 v59, v51
    v_add_f32 v53, v52, v32
    v_cos_f32 v60, v52
    v_add_f32 v54, v53, v34
    v_cos_f32 v61, v53
    v_add_f32 v55, v54, v32
    v_cos_f32 v62, v54
    v_cos_f32 v63, v55
    v_add_f32 v30, v48, v36
    v_cvt_pk_bf16_f32 v64, v56, v57
    v_cvt_pk_bf16_f32 v65, v58, v59
    v_cvt_pk_bf16_f32 v66, v60, v61
    v_cvt_pk_bf16_f32 v67, v62, v63
    v_accvgpr_write_b32 a0, v64
    v_accvgpr_write_b32 a1, v65
    v_accvgpr_write_b32 a2, v66
    v_accvgpr_write_b32 a3, v67
    v_xor_b32_dpp v68, v64, v40 quad_perm:[0,1,3,2] row_mask:0xf bank_mask:0xf
    v_xor_b32_dpp v69, v65, v40 quad_perm:[0,1,3,2] row_mask:0xf bank_mask:0xf
    v_xor_b32_dpp v70, v66, v40 quad_perm:[0,1,3,2] row_mask:0xf bank_mask:0xf
    v_xor_b32_dpp v71, v67, v40 quad_perm:[0,1,3,2] row_mask:0xf bank_mask:0xf
    v_accvgpr_write_b32 a64, v68
    v_accvgpr_write_b32 a65, v69
    v_accvgpr_write_b32 a66, v70
    v_accvgpr_write_b32 a67, v71
    v_xor_b32 v68, v64, v42
    v_xor_b32 v69, v65, v42
    v_xor_b32 v70, v66, v42
    v_xor_b32 v71, v67, v42
    v_accvgpr_write_b32 a128, v68
    v_accvgpr_write_b32 a129, v69
    v_accvgpr_write_b32 a130, v70
    v_accvgpr_write_b32 a131, v71
    v_xor_b32_dpp v68, v64, v44 quad_perm:[0,1,3,2] row_mask:0xf bank_mask:0xf
    v_xor_b32_dpp v69, v65, v44 quad_perm:[0,1,3,2] row_mask:0xf bank_mask:0xf
    v_xor_b32_dpp v70, v66, v44 quad_perm:[0,1,3,2] row_mask:0xf bank_mask:0xf
    v_xor_b32_dpp v71, v67, v44 quad_perm:[0,1,3,2] row_mask:0xf bank_mask:0xf
    v_accvgpr_write_b32 a192, v68
    v_accvgpr_write_b32 a193, v69
    v_accvgpr_write_b32 a194, v70
    v_accvgpr_write_b32 a195, v71
    v_fract_f32 v48, v31
    v_add_f32 v49, v48, v33
    v_cos_f32 v56, v48
    v_add_f32 v50, v49, v35
    v_cos_f32 v57, v49
    v_add_f32 v51, v50, v33
    v_cos_f32 v58, v50
    v_add_f32 v52, v51, v35
    v_cos_f32 v59, v51
    v_add_f32 v53, v52, v33
    v_cos_f32 v60, v52
    v_add_f32 v54, v53, v35
    v_cos_f32 v61, v53
    v_add_f32 v55, v54, v33
    v_cos_f32 v62, v54
    v_cos_f32 v63, v55
    v_add_f32 v31, v48, v37
    v_cvt_pk_bf16_f32 v64, v56, v57
    v_cvt_pk_bf16_f32 v65, v58, v59
    v_cvt_pk_bf16_f32 v66, v60, v61
    v_cvt_pk_bf16_f32 v67, v62, v63
    v_accvgpr_write_b32 a4, v64
    v_accvgpr_write_b32 a5, v65
    v_accvgpr_write_b32 a6, v66
    v_accvgpr_write_b32 a7, v67
    v_xor_b32_dpp v68, v64, v41 quad_perm:[0,1,3,2] row_mask:0xf bank_mask:0xf
    v_xor_b32_dpp v69, v65, v41 quad_perm:[0,1,3,2] row_mask:0xf bank_mask:0xf
    v_xor_b32_dpp v70, v66, v41 quad_perm:[0,1,3,2] row_mask:0xf bank_mask:0xf
    v_xor_b32_dpp v71, v67, v41 quad_perm:[0,1,3,2] row_mask:0xf bank_mask:0xf
    v_accvgpr_write_b32 a68, v68
    v_accvgpr_write_b32 a69, v69
    v_accvgpr_write_b32 a70, v70
    v_accvgpr_write_b32 a71, v71
    v_xor_b32 v68, v64, v43
    v_xor_b32 v69, v65, v43
    v_xor_b32 v70, v66, v43
    v_xor_b32 v71, v67, v43
    v_accvgpr_write_b32 a132, v68
    v_accvgpr_write_b32 a133, v69
    v_accvgpr_write_b32 a134, v70
    v_accvgpr_write_b32 a135, v71
    v_xor_b32_dpp v68, v64, v45 quad_perm:[0,1,3,2] row_mask:0xf bank_mask:0xf
    v_xor_b32_dpp v69, v65, v45 quad_perm:[0,1,3,2] row_mask:0xf bank_mask:0xf
    v_xor_b32_dpp v70, v66, v45 quad_perm:[0,1,3,2] row_mask:0xf bank_mask:0xf
    v_xor_b32_dpp v71, v67, v45 quad_perm:[0,1,3,2] row_mask:0xf bank_mask:0xf
    v_accvgpr_write_b32 a196, v68
    v_accvgpr_write_b32 a197, v69
    v_accvgpr_write_b32 a198, v70
    v_accvgpr_write_b32 a199, v71
    v_fract_f32 v48, v30
    v_add_f32 v49, v48, v32
    v_cos_f32 v56, v48
    v_add_f32 v50, v49, v34
    v_cos_f32 v57, v49
    v_add_f32 v51, v50, v32
    v_cos_f32 v58, v50
    v_add_f32 v52, v51, v34
    v_cos_f32 v59, v51
    v_add_f32 v53, v52, v32
    v_cos_f32 v60, v52
    v_add_f32 v54, v53, v34
    v_cos_f32 v61, v53
    v_add_f32 v55, v54, v32
    v_cos_f32 v62, v54
    v_cos_f32 v63, v55
    v_add_f32 v30, v48, v36
    v_cvt_pk_bf16_f32 v64, v56, v57
    v_cvt_pk_bf16_f32 v65, v58, v59
    v_cvt_pk_bf16_f32 v66, v60, v61
    v_cvt_pk_bf16_f32 v67, v62, v63
    v_accvgpr_write_b32 a8, v64
    v_accvgpr_write_b32 a9, v65
    v_accvgpr_write_b32 a10, v66
    v_accvgpr_write_b32 a11, v67
    v_xor_b32_dpp v68, v64, v40 quad_perm:[0,1,3,2] row_mask:0xf bank_mask:0xf
    v_xor_b32_dpp v69, v65, v40 quad_perm:[0,1,3,2] row_mask:0xf bank_mask:0xf
    v_xor_b32_dpp v70, v66, v40 quad_perm:[0,1,3,2] row_mask:0xf bank_mask:0xf
    v_xor_b32_dpp v71, v67, v40 quad_perm:[0,1,3,2] row_mask:0xf bank_mask:0xf
    v_accvgpr_write_b32 a72, v68
    v_accvgpr_write_b32 a73, v69
    v_accvgpr_write_b32 a74, v70
    v_accvgpr_write_b32 a75, v71
    v_xor_b32 v68, v64, v42
    v_xor_b32 v69, v65, v42
    v_xor_b32 v70, v66, v42
    v_xor_b32 v71, v67, v42
    v_accvgpr_write_b32 a136, v68
    v_accvgpr_write_b32 a137, v69
    v_accvgpr_write_b32 a138, v70
    v_accvgpr_write_b32 a139, v71
    v_xor_b32_dpp v68, v64, v44 quad_perm:[0,1,3,2] row_mask:0xf bank_mask:0xf
    v_xor_b32_dpp v69, v65, v44 quad_perm:[0,1,3,2] row_mask:0xf bank_mask:0xf
    v_xor_b32_dpp v70, v66, v44 quad_perm:[0,1,3,2] row_mask:0xf bank_mask:0xf
    v_xor_b32_dpp v71, v67, v44 quad_perm:[0,1,3,2] row_mask:0xf bank_mask:0xf
    v_accvgpr_write_b32 a200, v68
    v_accvgpr_write_b32 a201, v69
    v_accvgpr_write_b32 a202, v70
    v_accvgpr_write_b32 a203, v71
    v_fract_f32 v48, v31
    v_add_f32 v49, v48, v33
    v_cos_f32 v56, v48
    v_add_f32 v50, v49, v35
    v_cos_f32 v57, v49
    v_add_f32 v51, v50, v33
    v_cos_f32 v58, v50
    v_add_f32 v52, v51, v35
    v_cos_f32 v59, v51
    v_add_f32 v53, v52, v33
    v_cos_f32 v60, v52
    v_add_f32 v54, v53, v35
    v_cos_f32 v61, v53
    v_add_f32 v55, v54, v33
    v_cos_f32 v62, v54
    v_cos_f32 v63, v55
    v_add_f32 v31, v48, v37
    v_cvt_pk_bf16_f32 v64, v56, v57
    v_cvt_pk_bf16_f32 v65, v58, v59
    v_cvt_pk_bf16_f32 v66, v60, v61
    v_cvt_pk_bf16_f32 v67, v62, v63
    v_accvgpr_write_b32 a12, v64
    v_accvgpr_write_b32 a13, v65
    v_accvgpr_write_b32 a14, v66
    v_accvgpr_write_b32 a15, v67
    v_xor_b32_dpp v68, v64, v41 quad_perm:[0,1,3,2] row_mask:0xf bank_mask:0xf
    v_xor_b32_dpp v69, v65, v41 quad_perm:[0,1,3,2] row_mask:0xf bank_mask:0xf
    v_xor_b32_dpp v70, v66, v41 quad_perm:[0,1,3,2] row_mask:0xf bank_mask:0xf
    v_xor_b32_dpp v71, v67, v41 quad_perm:[0,1,3,2] row_mask:0xf bank_mask:0xf
    v_accvgpr_write_b32 a76, v68
    v_accvgpr_write_b32 a77, v69
    v_accvgpr_write_b32 a78, v70
    v_accvgpr_write_b32 a79, v71
    v_xor_b32 v68, v64, v43
    v_xor_b32 v69, v65, v43
    v_xor_b32 v70, v66, v43
    v_xor_b32 v71, v67, v43
    v_accvgpr_write_b32 a140, v68
    v_accvgpr_write_b32 a141, v69
    v_accvgpr_write_b32 a142, v70
    v_accvgpr_write_b32 a143, v71
    v_xor_b32_dpp v68, v64, v45 quad_perm:[0,1,3,2] row_mask:0xf bank_mask:0xf
    v_xor_b32_dpp v69, v65, v45 quad_perm:[0,1,3,2] row_mask:0xf bank_mask:0xf
    v_xor_b32_dpp v70, v66, v45 quad_perm:[0,1,3,2] row_mask:0xf bank_mask:0xf
    v_xor_b32_dpp v71, v67, v45 quad_perm:[0,1,3,2] row_mask:0xf bank_mask:0xf
    v_accvgpr_write_b32 a204, v68
    v_accvgpr_write_b32 a205, v69
    v_accvgpr_write_b32 a206, v70
    v_accvgpr_write_b32 a207, v71
    v_fract_f32 v48, v30
    v_add_f32 v49, v48, v32
    v_cos_f32 v56, v48
    v_add_f32 v50, v49, v34
    v_cos_f32 v57, v49
    v_add_f32 v51, v50, v32
    v_cos_f32 v58, v50
    v_add_f32 v52, v51, v34
    v_cos_f32 v59, v51
    v_add_f32 v53, v52, v32
    v_cos_f32 v60, v52
    v_add_f32 v54, v53, v34
    v_cos_f32 v61, v53
    v_add_f32 v55, v54, v32
    v_cos_f32 v62, v54
    v_cos_f32 v63, v55
    v_add_f32 v30, v48, v36
    v_cvt_pk_bf16_f32 v64, v56, v57
    v_cvt_pk_bf16_f32 v65, v58, v59
    v_cvt_pk_bf16_f32 v66, v60, v61
    v_cvt_pk_bf16_f32 v67, v62, v63
    v_accvgpr_write_b32 a16, v64
    v_accvgpr_write_b32 a17, v65
    v_accvgpr_write_b32 a18, v66
    v_accvgpr_write_b32 a19, v67
    v_xor_b32_dpp v68, v64, v40 quad_perm:[0,1,3,2] row_mask:0xf bank_mask:0xf
    v_xor_b32_dpp v69, v65, v40 quad_perm:[0,1,3,2] row_mask:0xf bank_mask:0xf
    v_xor_b32_dpp v70, v66, v40 quad_perm:[0,1,3,2] row_mask:0xf bank_mask:0xf
    v_xor_b32_dpp v71, v67, v40 quad_perm:[0,1,3,2] row_mask:0xf bank_mask:0xf
    v_accvgpr_write_b32 a80, v68
    v_accvgpr_write_b32 a81, v69
    v_accvgpr_write_b32 a82, v70
    v_accvgpr_write_b32 a83, v71
    v_xor_b32 v68, v64, v42
    v_xor_b32 v69, v65, v42
    v_xor_b32 v70, v66, v42
    v_xor_b32 v71, v67, v42
    v_accvgpr_write_b32 a144, v68
    v_accvgpr_write_b32 a145, v69
    v_accvgpr_write_b32 a146, v70
    v_accvgpr_write_b32 a147, v71
    v_xor_b32_dpp v68, v64, v44 quad_perm:[0,1,3,2] row_mask:0xf bank_mask:0xf
    v_xor_b32_dpp v69, v65, v44 quad_perm:[0,1,3,2] row_mask:0xf bank_mask:0xf
    v_xor_b32_dpp v70, v66, v44 quad_perm:[0,1,3,2] row_mask:0xf bank_mask:0xf
    v_xor_b32_dpp v71, v67, v44 quad_perm:[0,1,3,2] row_mask:0xf bank_mask:0xf
    v_accvgpr_write_b32 a208, v68
    v_accvgpr_write_b32 a209, v69
    v_accvgpr_write_b32 a210, v70
    v_accvgpr_write_b32 a211, v71
    v_fract_f32 v48, v31
    v_add_f32 v49, v48, v33
    v_cos_f32 v56, v48
    v_add_f32 v50, v49, v35
    v_cos_f32 v57, v49
    v_add_f32 v51, v50, v33
    v_cos_f32 v58, v50
    v_add_f32 v52, v51, v35
    v_cos_f32 v59, v51
    v_add_f32 v53, v52, v33
    v_cos_f32 v60, v52
    v_add_f32 v54, v53, v35
    v_cos_f32 v61, v53
    v_add_f32 v55, v54, v33
    v_cos_f32 v62, v54
    v_cos_f32 v63, v55
    v_add_f32 v31, v48, v37
    v_cvt_pk_bf16_f32 v64, v56, v57
    v_cvt_pk_bf16_f32 v65, v58, v59
    v_cvt_pk_bf16_f32 v66, v60, v61
    v_cvt_pk_bf16_f32 v67, v62, v63
    v_accvgpr_write_b32 a20, v64
    v_accvgpr_write_b32 a21, v65
    v_accvgpr_write_b32 a22, v66
    v_accvgpr_write_b32 a23, v67
    v_xor_b32_dpp v68, v64, v41 quad_perm:[0,1,3,2] row_mask:0xf bank_mask:0xf
    v_xor_b32_dpp v69, v65, v41 quad_perm:[0,1,3,2] row_mask:0xf bank_mask:0xf
    v_xor_b32_dpp v70, v66, v41 quad_perm:[0,1,3,2] row_mask:0xf bank_mask:0xf
    v_xor_b32_dpp v71, v67, v41 quad_perm:[0,1,3,2] row_mask:0xf bank_mask:0xf
    v_accvgpr_write_b32 a84, v68
    v_accvgpr_write_b32 a85, v69
    v_accvgpr_write_b32 a86, v70
    v_accvgpr_write_b32 a87, v71
    v_xor_b32 v68, v64, v43
    v_xor_b32 v69, v65, v43
    v_xor_b32 v70, v66, v43
    v_xor_b32 v71, v67, v43
    v_accvgpr_write_b32 a148, v68
    v_accvgpr_write_b32 a149, v69
    v_accvgpr_write_b32 a150, v70
    v_accvgpr_write_b32 a151, v71
    v_xor_b32_dpp v68, v64, v45 quad_perm:[0,1,3,2] row_mask:0xf bank_mask:0xf
    v_xor_b32_dpp v69, v65, v45 quad_perm:[0,1,3,2] row_mask:0xf bank_mask:0xf
    v_xor_b32_dpp v70, v66, v45 quad_perm:[0,1,3,2] row_mask:0xf bank_mask:0xf
    v_xor_b32_dpp v71, v67, v45 quad_perm:[0,1,3,2] row_mask:0xf bank_mask:0xf
    v_accvgpr_write_b32 a212, v68
    v_accvgpr_write_b32 a213, v69
    v_accvgpr_write_b32 a214, v70
    v_accvgpr_write_b32 a215, v71
    v_fract_f32 v48, v30
    v_add_f32 v49, v48, v32
    v_cos_f32 v56, v48
    v_add_f32 v50, v49, v34
    v_cos_f32 v57, v49
    v_add_f32 v51, v50, v32
    v_cos_f32 v58, v50
    v_add_f32 v52, v51, v34
    v_cos_f32 v59, v51
    v_add_f32 v53, v52, v32
    v_cos_f32 v60, v52
    v_add_f32 v54, v53, v34
    v_cos_f32 v61, v53
    v_add_f32 v55, v54, v32
    v_cos_f32 v62, v54
    v_cos_f32 v63, v55
    v_add_f32 v30, v48, v36
    v_cvt_pk_bf16_f32 v64, v56, v57
    v_cvt_pk_bf16_f32 v65, v58, v59
    v_cvt_pk_bf16_f32 v66, v60, v61
    v_cvt_pk_bf16_f32 v67, v62, v63
    v_accvgpr_write_b32 a24, v64
    v_accvgpr_write_b32 a25, v65
    v_accvgpr_write_b32 a26, v66
    v_accvgpr_write_b32 a27, v67
    v_xor_b32_dpp v68, v64, v40 quad_perm:[0,1,3,2] row_mask:0xf bank_mask:0xf
    v_xor_b32_dpp v69, v65, v40 quad_perm:[0,1,3,2] row_mask:0xf bank_mask:0xf
    v_xor_b32_dpp v70, v66, v40 quad_perm:[0,1,3,2] row_mask:0xf bank_mask:0xf
    v_xor_b32_dpp v71, v67, v40 quad_perm:[0,1,3,2] row_mask:0xf bank_mask:0xf
    v_accvgpr_write_b32 a88, v68
    v_accvgpr_write_b32 a89, v69
    v_accvgpr_write_b32 a90, v70
    v_accvgpr_write_b32 a91, v71
    v_xor_b32 v68, v64, v42
    v_xor_b32 v69, v65, v42
    v_xor_b32 v70, v66, v42
    v_xor_b32 v71, v67, v42
    v_accvgpr_write_b32 a152, v68
    v_accvgpr_write_b32 a153, v69
    v_accvgpr_write_b32 a154, v70
    v_accvgpr_write_b32 a155, v71
    v_xor_b32_dpp v68, v64, v44 quad_perm:[0,1,3,2] row_mask:0xf bank_mask:0xf
    v_xor_b32_dpp v69, v65, v44 quad_perm:[0,1,3,2] row_mask:0xf bank_mask:0xf
    v_xor_b32_dpp v70, v66, v44 quad_perm:[0,1,3,2] row_mask:0xf bank_mask:0xf
    v_xor_b32_dpp v71, v67, v44 quad_perm:[0,1,3,2] row_mask:0xf bank_mask:0xf
    v_accvgpr_write_b32 a216, v68
    v_accvgpr_write_b32 a217, v69
    v_accvgpr_write_b32 a218, v70
    v_accvgpr_write_b32 a219, v71
    v_fract_f32 v48, v31
    v_add_f32 v49, v48, v33
    v_cos_f32 v56, v48
    v_add_f32 v50, v49, v35
    v_cos_f32 v57, v49
    v_add_f32 v51, v50, v33
    v_cos_f32 v58, v50
    v_add_f32 v52, v51, v35
    v_cos_f32 v59, v51
    v_add_f32 v53, v52, v33
    v_cos_f32 v60, v52
    v_add_f32 v54, v53, v35
    v_cos_f32 v61, v53
    v_add_f32 v55, v54, v33
    v_cos_f32 v62, v54
    v_cos_f32 v63, v55
    v_add_f32 v31, v48, v37
    v_cvt_pk_bf16_f32 v64, v56, v57
    v_cvt_pk_bf16_f32 v65, v58, v59
    v_cvt_pk_bf16_f32 v66, v60, v61
    v_cvt_pk_bf16_f32 v67, v62, v63
    v_accvgpr_write_b32 a28, v64
    v_accvgpr_write_b32 a29, v65
    v_accvgpr_write_b32 a30, v66
    v_accvgpr_write_b32 a31, v67
    v_xor_b32_dpp v68, v64, v41 quad_perm:[0,1,3,2] row_mask:0xf bank_mask:0xf
    v_xor_b32_dpp v69, v65, v41 quad_perm:[0,1,3,2] row_mask:0xf bank_mask:0xf
    v_xor_b32_dpp v70, v66, v41 quad_perm:[0,1,3,2] row_mask:0xf bank_mask:0xf
    v_xor_b32_dpp v71, v67, v41 quad_perm:[0,1,3,2] row_mask:0xf bank_mask:0xf
    v_accvgpr_write_b32 a92, v68
    v_accvgpr_write_b32 a93, v69
    v_accvgpr_write_b32 a94, v70
    v_accvgpr_write_b32 a95, v71
    v_xor_b32 v68, v64, v43
    v_xor_b32 v69, v65, v43
    v_xor_b32 v70, v66, v43
    v_xor_b32 v71, v67, v43
    v_accvgpr_write_b32 a156, v68
    v_accvgpr_write_b32 a157, v69
    v_accvgpr_write_b32 a158, v70
    v_accvgpr_write_b32 a159, v71
    v_xor_b32_dpp v68, v64, v45 quad_perm:[0,1,3,2] row_mask:0xf bank_mask:0xf
    v_xor_b32_dpp v69, v65, v45 quad_perm:[0,1,3,2] row_mask:0xf bank_mask:0xf
    v_xor_b32_dpp v70, v66, v45 quad_perm:[0,1,3,2] row_mask:0xf bank_mask:0xf
    v_xor_b32_dpp v71, v67, v45 quad_perm:[0,1,3,2] row_mask:0xf bank_mask:0xf
    v_accvgpr_write_b32 a220, v68
    v_accvgpr_write_b32 a221, v69
    v_accvgpr_write_b32 a222, v70
    v_accvgpr_write_b32 a223, v71
    v_fract_f32 v48, v30
    v_add_f32 v49, v48, v32
    v_cos_f32 v56, v48
    v_add_f32 v50, v49, v34
    v_cos_f32 v57, v49
    v_add_f32 v51, v50, v32
    v_cos_f32 v58, v50
    v_add_f32 v52, v51, v34
    v_cos_f32 v59, v51
    v_add_f32 v53, v52, v32
    v_cos_f32 v60, v52
    v_add_f32 v54, v53, v34
    v_cos_f32 v61, v53
    v_add_f32 v55, v54, v32
    v_cos_f32 v62, v54
    v_cos_f32 v63, v55
    v_add_f32 v30, v48, v36
    v_cvt_pk_bf16_f32 v64, v56, v57
    v_cvt_pk_bf16_f32 v65, v58, v59
    v_cvt_pk_bf16_f32 v66, v60, v61
    v_cvt_pk_bf16_f32 v67, v62, v63
    v_accvgpr_write_b32 a32, v64
    v_accvgpr_write_b32 a33, v65
    v_accvgpr_write_b32 a34, v66
    v_accvgpr_write_b32 a35, v67
    v_xor_b32_dpp v68, v64, v40 quad_perm:[0,1,3,2] row_mask:0xf bank_mask:0xf
    v_xor_b32_dpp v69, v65, v40 quad_perm:[0,1,3,2] row_mask:0xf bank_mask:0xf
    v_xor_b32_dpp v70, v66, v40 quad_perm:[0,1,3,2] row_mask:0xf bank_mask:0xf
    v_xor_b32_dpp v71, v67, v40 quad_perm:[0,1,3,2] row_mask:0xf bank_mask:0xf
    v_accvgpr_write_b32 a96, v68
    v_accvgpr_write_b32 a97, v69
    v_accvgpr_write_b32 a98, v70
    v_accvgpr_write_b32 a99, v71
    v_xor_b32 v68, v64, v42
    v_xor_b32 v69, v65, v42
    v_xor_b32 v70, v66, v42
    v_xor_b32 v71, v67, v42
    v_accvgpr_write_b32 a160, v68
    v_accvgpr_write_b32 a161, v69
    v_accvgpr_write_b32 a162, v70
    v_accvgpr_write_b32 a163, v71
    v_xor_b32_dpp v68, v64, v44 quad_perm:[0,1,3,2] row_mask:0xf bank_mask:0xf
    v_xor_b32_dpp v69, v65, v44 quad_perm:[0,1,3,2] row_mask:0xf bank_mask:0xf
    v_xor_b32_dpp v70, v66, v44 quad_perm:[0,1,3,2] row_mask:0xf bank_mask:0xf
    v_xor_b32_dpp v71, v67, v44 quad_perm:[0,1,3,2] row_mask:0xf bank_mask:0xf
    v_accvgpr_write_b32 a224, v68
    v_accvgpr_write_b32 a225, v69
    v_accvgpr_write_b32 a226, v70
    v_accvgpr_write_b32 a227, v71
    v_fract_f32 v48, v31
    v_add_f32 v49, v48, v33
    v_cos_f32 v56, v48
    v_add_f32 v50, v49, v35
    v_cos_f32 v57, v49
    v_add_f32 v51, v50, v33
    v_cos_f32 v58, v50
    v_add_f32 v52, v51, v35
    v_cos_f32 v59, v51
    v_add_f32 v53, v52, v33
    v_cos_f32 v60, v52
    v_add_f32 v54, v53, v35
    v_cos_f32 v61, v53
    v_add_f32 v55, v54, v33
    v_cos_f32 v62, v54
    v_cos_f32 v63, v55
    v_add_f32 v31, v48, v37
    v_cvt_pk_bf16_f32 v64, v56, v57
    v_cvt_pk_bf16_f32 v65, v58, v59
    v_cvt_pk_bf16_f32 v66, v60, v61
    v_cvt_pk_bf16_f32 v67, v62, v63
    v_accvgpr_write_b32 a36, v64
    v_accvgpr_write_b32 a37, v65
    v_accvgpr_write_b32 a38, v66
    v_accvgpr_write_b32 a39, v67
    v_xor_b32_dpp v68, v64, v41 quad_perm:[0,1,3,2] row_mask:0xf bank_mask:0xf
    v_xor_b32_dpp v69, v65, v41 quad_perm:[0,1,3,2] row_mask:0xf bank_mask:0xf
    v_xor_b32_dpp v70, v66, v41 quad_perm:[0,1,3,2] row_mask:0xf bank_mask:0xf
    v_xor_b32_dpp v71, v67, v41 quad_perm:[0,1,3,2] row_mask:0xf bank_mask:0xf
    v_accvgpr_write_b32 a100, v68
    v_accvgpr_write_b32 a101, v69
    v_accvgpr_write_b32 a102, v70
    v_accvgpr_write_b32 a103, v71
    v_xor_b32 v68, v64, v43
    v_xor_b32 v69, v65, v43
    v_xor_b32 v70, v66, v43
    v_xor_b32 v71, v67, v43
    v_accvgpr_write_b32 a164, v68
    v_accvgpr_write_b32 a165, v69
    v_accvgpr_write_b32 a166, v70
    v_accvgpr_write_b32 a167, v71
    v_xor_b32_dpp v68, v64, v45 quad_perm:[0,1,3,2] row_mask:0xf bank_mask:0xf
    v_xor_b32_dpp v69, v65, v45 quad_perm:[0,1,3,2] row_mask:0xf bank_mask:0xf
    v_xor_b32_dpp v70, v66, v45 quad_perm:[0,1,3,2] row_mask:0xf bank_mask:0xf
    v_xor_b32_dpp v71, v67, v45 quad_perm:[0,1,3,2] row_mask:0xf bank_mask:0xf
    v_accvgpr_write_b32 a228, v68
    v_accvgpr_write_b32 a229, v69
    v_accvgpr_write_b32 a230, v70
    v_accvgpr_write_b32 a231, v71
    v_fract_f32 v48, v30
    v_add_f32 v49, v48, v32
    v_cos_f32 v56, v48
    v_add_f32 v50, v49, v34
    v_cos_f32 v57, v49
    v_add_f32 v51, v50, v32
    v_cos_f32 v58, v50
    v_add_f32 v52, v51, v34
    v_cos_f32 v59, v51
    v_add_f32 v53, v52, v32
    v_cos_f32 v60, v52
    v_add_f32 v54, v53, v34
    v_cos_f32 v61, v53
    v_add_f32 v55, v54, v32
    v_cos_f32 v62, v54
    v_cos_f32 v63, v55
    v_add_f32 v30, v48, v36
    v_cvt_pk_bf16_f32 v64, v56, v57
    v_cvt_pk_bf16_f32 v65, v58, v59
    v_cvt_pk_bf16_f32 v66, v60, v61
    v_cvt_pk_bf16_f32 v67, v62, v63
    v_accvgpr_write_b32 a40, v64
    v_accvgpr_write_b32 a41, v65
    v_accvgpr_write_b32 a42, v66
    v_accvgpr_write_b32 a43, v67
    v_xor_b32_dpp v68, v64, v40 quad_perm:[0,1,3,2] row_mask:0xf bank_mask:0xf
    v_xor_b32_dpp v69, v65, v40 quad_perm:[0,1,3,2] row_mask:0xf bank_mask:0xf
    v_xor_b32_dpp v70, v66, v40 quad_perm:[0,1,3,2] row_mask:0xf bank_mask:0xf
    v_xor_b32_dpp v71, v67, v40 quad_perm:[0,1,3,2] row_mask:0xf bank_mask:0xf
    v_accvgpr_write_b32 a104, v68
    v_accvgpr_write_b32 a105, v69
    v_accvgpr_write_b32 a106, v70
    v_accvgpr_write_b32 a107, v71
    v_xor_b32 v68, v64, v42
    v_xor_b32 v69, v65, v42
    v_xor_b32 v70, v66, v42
    v_xor_b32 v71, v67, v42
    v_accvgpr_write_b32 a168, v68
    v_accvgpr_write_b32 a169, v69
    v_accvgpr_write_b32 a170, v70
    v_accvgpr_write_b32 a171, v71
    v_xor_b32_dpp v68, v64, v44 quad_perm:[0,1,3,2] row_mask:0xf bank_mask:0xf
    v_xor_b32_dpp v69, v65, v44 quad_perm:[0,1,3,2] row_mask:0xf bank_mask:0xf
    v_xor_b32_dpp v70, v66, v44 quad_perm:[0,1,3,2] row_mask:0xf bank_mask:0xf
    v_xor_b32_dpp v71, v67, v44 quad_perm:[0,1,3,2] row_mask:0xf bank_mask:0xf
    v_accvgpr_write_b32 a232, v68
    v_accvgpr_write_b32 a233, v69
    v_accvgpr_write_b32 a234, v70
    v_accvgpr_write_b32 a235, v71
    v_fract_f32 v48, v31
    v_add_f32 v49, v48, v33
    v_cos_f32 v56, v48
    v_add_f32 v50, v49, v35
    v_cos_f32 v57, v49
    v_add_f32 v51, v50, v33
    v_cos_f32 v58, v50
    v_add_f32 v52, v51, v35
    v_cos_f32 v59, v51
    v_add_f32 v53, v52, v33
    v_cos_f32 v60, v52
    v_add_f32 v54, v53, v35
    v_cos_f32 v61, v53
    v_add_f32 v55, v54, v33
    v_cos_f32 v62, v54
    v_cos_f32 v63, v55
    v_add_f32 v31, v48, v37
    v_cvt_pk_bf16_f32 v64, v56, v57
    v_cvt_pk_bf16_f32 v65, v58, v59
    v_cvt_pk_bf16_f32 v66, v60, v61
    v_cvt_pk_bf16_f32 v67, v62, v63
    v_accvgpr_write_b32 a44, v64
    v_accvgpr_write_b32 a45, v65
    v_accvgpr_write_b32 a46, v66
    v_accvgpr_write_b32 a47, v67
    v_xor_b32_dpp v68, v64, v41 quad_perm:[0,1,3,2] row_mask:0xf bank_mask:0xf
    v_xor_b32_dpp v69, v65, v41 quad_perm:[0,1,3,2] row_mask:0xf bank_mask:0xf
    v_xor_b32_dpp v70, v66, v41 quad_perm:[0,1,3,2] row_mask:0xf bank_mask:0xf
    v_xor_b32_dpp v71, v67, v41 quad_perm:[0,1,3,2] row_mask:0xf bank_mask:0xf
    v_accvgpr_write_b32 a108, v68
    v_accvgpr_write_b32 a109, v69
    v_accvgpr_write_b32 a110, v70
    v_accvgpr_write_b32 a111, v71
    v_xor_b32 v68, v64, v43
    v_xor_b32 v69, v65, v43
    v_xor_b32 v70, v66, v43
    v_xor_b32 v71, v67, v43
    v_accvgpr_write_b32 a172, v68
    v_accvgpr_write_b32 a173, v69
    v_accvgpr_write_b32 a174, v70
    v_accvgpr_write_b32 a175, v71
    v_xor_b32_dpp v68, v64, v45 quad_perm:[0,1,3,2] row_mask:0xf bank_mask:0xf
    v_xor_b32_dpp v69, v65, v45 quad_perm:[0,1,3,2] row_mask:0xf bank_mask:0xf
    v_xor_b32_dpp v70, v66, v45 quad_perm:[0,1,3,2] row_mask:0xf bank_mask:0xf
    v_xor_b32_dpp v71, v67, v45 quad_perm:[0,1,3,2] row_mask:0xf bank_mask:0xf
    v_accvgpr_write_b32 a236, v68
    v_accvgpr_write_b32 a237, v69
    v_accvgpr_write_b32 a238, v70
    v_accvgpr_write_b32 a239, v71
    v_fract_f32 v48, v30
    v_add_f32 v49, v48, v32
    v_cos_f32 v56, v48
    v_add_f32 v50, v49, v34
    v_cos_f32 v57, v49
    v_add_f32 v51, v50, v32
    v_cos_f32 v58, v50
    v_add_f32 v52, v51, v34
    v_cos_f32 v59, v51
    v_add_f32 v53, v52, v32
    v_cos_f32 v60, v52
    v_add_f32 v54, v53, v34
    v_cos_f32 v61, v53
    v_add_f32 v55, v54, v32
    v_cos_f32 v62, v54
    v_cos_f32 v63, v55
    v_add_f32 v30, v48, v36
    v_cvt_pk_bf16_f32 v64, v56, v57
    v_cvt_pk_bf16_f32 v65, v58, v59
    v_cvt_pk_bf16_f32 v66, v60, v61
    v_cvt_pk_bf16_f32 v67, v62, v63
    v_accvgpr_write_b32 a48, v64
    v_accvgpr_write_b32 a49, v65
    v_accvgpr_write_b32 a50, v66
    v_accvgpr_write_b32 a51, v67
    v_xor_b32_dpp v68, v64, v40 quad_perm:[0,1,3,2] row_mask:0xf bank_mask:0xf
    v_xor_b32_dpp v69, v65, v40 quad_perm:[0,1,3,2] row_mask:0xf bank_mask:0xf
    v_xor_b32_dpp v70, v66, v40 quad_perm:[0,1,3,2] row_mask:0xf bank_mask:0xf
    v_xor_b32_dpp v71, v67, v40 quad_perm:[0,1,3,2] row_mask:0xf bank_mask:0xf
    v_accvgpr_write_b32 a112, v68
    v_accvgpr_write_b32 a113, v69
    v_accvgpr_write_b32 a114, v70
    v_accvgpr_write_b32 a115, v71
    v_xor_b32 v68, v64, v42
    v_xor_b32 v69, v65, v42
    v_xor_b32 v70, v66, v42
    v_xor_b32 v71, v67, v42
    v_accvgpr_write_b32 a176, v68
    v_accvgpr_write_b32 a177, v69
    v_accvgpr_write_b32 a178, v70
    v_accvgpr_write_b32 a179, v71
    v_xor_b32_dpp v68, v64, v44 quad_perm:[0,1,3,2] row_mask:0xf bank_mask:0xf
    v_xor_b32_dpp v69, v65, v44 quad_perm:[0,1,3,2] row_mask:0xf bank_mask:0xf
    v_xor_b32_dpp v70, v66, v44 quad_perm:[0,1,3,2] row_mask:0xf bank_mask:0xf
    v_xor_b32_dpp v71, v67, v44 quad_perm:[0,1,3,2] row_mask:0xf bank_mask:0xf
    v_accvgpr_write_b32 a240, v68
    v_accvgpr_write_b32 a241, v69
    v_accvgpr_write_b32 a242, v70
    v_accvgpr_write_b32 a243, v71
    v_fract_f32 v48, v31
    v_add_f32 v49, v48, v33
    v_cos_f32 v56, v48
    v_add_f32 v50, v49, v35
    v_cos_f32 v57, v49
    v_add_f32 v51, v50, v33
    v_cos_f32 v58, v50
    v_add_f32 v52, v51, v35
    v_cos_f32 v59, v51
    v_add_f32 v53, v52, v33
    v_cos_f32 v60, v52
    v_add_f32 v54, v53, v35
    v_cos_f32 v61, v53
    v_add_f32 v55, v54, v33
    v_cos_f32 v62, v54
    v_cos_f32 v63, v55
    v_add_f32 v31, v48, v37
    v_cvt_pk_bf16_f32 v64, v56, v57
    v_cvt_pk_bf16_f32 v65, v58, v59
    v_cvt_pk_bf16_f32 v66, v60, v61
    v_cvt_pk_bf16_f32 v67, v62, v63
    v_accvgpr_write_b32 a52, v64
    v_accvgpr_write_b32 a53, v65
    v_accvgpr_write_b32 a54, v66
    v_accvgpr_write_b32 a55, v67
    v_xor_b32_dpp v68, v64, v41 quad_perm:[0,1,3,2] row_mask:0xf bank_mask:0xf
    v_xor_b32_dpp v69, v65, v41 quad_perm:[0,1,3,2] row_mask:0xf bank_mask:0xf
    v_xor_b32_dpp v70, v66, v41 quad_perm:[0,1,3,2] row_mask:0xf bank_mask:0xf
    v_xor_b32_dpp v71, v67, v41 quad_perm:[0,1,3,2] row_mask:0xf bank_mask:0xf
    v_accvgpr_write_b32 a116, v68
    v_accvgpr_write_b32 a117, v69
    v_accvgpr_write_b32 a118, v70
    v_accvgpr_write_b32 a119, v71
    v_xor_b32 v68, v64, v43
    v_xor_b32 v69, v65, v43
    v_xor_b32 v70, v66, v43
    v_xor_b32 v71, v67, v43
    v_accvgpr_write_b32 a180, v68
    v_accvgpr_write_b32 a181, v69
    v_accvgpr_write_b32 a182, v70
    v_accvgpr_write_b32 a183, v71
    v_xor_b32_dpp v68, v64, v45 quad_perm:[0,1,3,2] row_mask:0xf bank_mask:0xf
    v_xor_b32_dpp v69, v65, v45 quad_perm:[0,1,3,2] row_mask:0xf bank_mask:0xf
    v_xor_b32_dpp v70, v66, v45 quad_perm:[0,1,3,2] row_mask:0xf bank_mask:0xf
    v_xor_b32_dpp v71, v67, v45 quad_perm:[0,1,3,2] row_mask:0xf bank_mask:0xf
    v_accvgpr_write_b32 a244, v68
    v_accvgpr_write_b32 a245, v69
    v_accvgpr_write_b32 a246, v70
    v_accvgpr_write_b32 a247, v71
    v_fract_f32 v48, v30
    v_add_f32 v49, v48, v32
    v_cos_f32 v56, v48
    v_add_f32 v50, v49, v34
    v_cos_f32 v57, v49
    v_add_f32 v51, v50, v32
    v_cos_f32 v58, v50
    v_add_f32 v52, v51, v34
    v_cos_f32 v59, v51
    v_add_f32 v53, v52, v32
    v_cos_f32 v60, v52
    v_add_f32 v54, v53, v34
    v_cos_f32 v61, v53
    v_add_f32 v55, v54, v32
    v_cos_f32 v62, v54
    v_cos_f32 v63, v55
    v_add_f32 v30, v48, v36
    v_cvt_pk_bf16_f32 v64, v56, v57
    v_cvt_pk_bf16_f32 v65, v58, v59
    v_cvt_pk_bf16_f32 v66, v60, v61
    v_cvt_pk_bf16_f32 v67, v62, v63
    v_accvgpr_write_b32 a56, v64
    v_accvgpr_write_b32 a57, v65
    v_accvgpr_write_b32 a58, v66
    v_accvgpr_write_b32 a59, v67
    v_xor_b32_dpp v68, v64, v40 quad_perm:[0,1,3,2] row_mask:0xf bank_mask:0xf
    v_xor_b32_dpp v69, v65, v40 quad_perm:[0,1,3,2] row_mask:0xf bank_mask:0xf
    v_xor_b32_dpp v70, v66, v40 quad_perm:[0,1,3,2] row_mask:0xf bank_mask:0xf
    v_xor_b32_dpp v71, v67, v40 quad_perm:[0,1,3,2] row_mask:0xf bank_mask:0xf
    v_accvgpr_write_b32 a120, v68
    v_accvgpr_write_b32 a121, v69
    v_accvgpr_write_b32 a122, v70
    v_accvgpr_write_b32 a123, v71
    v_xor_b32 v68, v64, v42
    v_xor_b32 v69, v65, v42
    v_xor_b32 v70, v66, v42
    v_xor_b32 v71, v67, v42
    v_accvgpr_write_b32 a184, v68
    v_accvgpr_write_b32 a185, v69
    v_accvgpr_write_b32 a186, v70
    v_accvgpr_write_b32 a187, v71
    v_xor_b32_dpp v68, v64, v44 quad_perm:[0,1,3,2] row_mask:0xf bank_mask:0xf
    v_xor_b32_dpp v69, v65, v44 quad_perm:[0,1,3,2] row_mask:0xf bank_mask:0xf
    v_xor_b32_dpp v70, v66, v44 quad_perm:[0,1,3,2] row_mask:0xf bank_mask:0xf
    v_xor_b32_dpp v71, v67, v44 quad_perm:[0,1,3,2] row_mask:0xf bank_mask:0xf
    v_accvgpr_write_b32 a248, v68
    v_accvgpr_write_b32 a249, v69
    v_accvgpr_write_b32 a250, v70
    v_accvgpr_write_b32 a251, v71
    v_fract_f32 v48, v31
    v_add_f32 v49, v48, v33
    v_cos_f32 v56, v48
    v_add_f32 v50, v49, v35
    v_cos_f32 v57, v49
    v_add_f32 v51, v50, v33
    v_cos_f32 v58, v50
    v_add_f32 v52, v51, v35
    v_cos_f32 v59, v51
    v_add_f32 v53, v52, v33
    v_cos_f32 v60, v52
    v_add_f32 v54, v53, v35
    v_cos_f32 v61, v53
    v_add_f32 v55, v54, v33
    v_cos_f32 v62, v54
    v_cos_f32 v63, v55
    v_add_f32 v31, v48, v37
    v_cvt_pk_bf16_f32 v64, v56, v57
    v_cvt_pk_bf16_f32 v65, v58, v59
    v_cvt_pk_bf16_f32 v66, v60, v61
    v_cvt_pk_bf16_f32 v67, v62, v63
    v_accvgpr_write_b32 a60, v64
    v_accvgpr_write_b32 a61, v65
    v_accvgpr_write_b32 a62, v66
    v_accvgpr_write_b32 a63, v67
    v_xor_b32_dpp v68, v64, v41 quad_perm:[0,1,3,2] row_mask:0xf bank_mask:0xf
    v_xor_b32_dpp v69, v65, v41 quad_perm:[0,1,3,2] row_mask:0xf bank_mask:0xf
    v_xor_b32_dpp v70, v66, v41 quad_perm:[0,1,3,2] row_mask:0xf bank_mask:0xf
    v_xor_b32_dpp v71, v67, v41 quad_perm:[0,1,3,2] row_mask:0xf bank_mask:0xf
    v_accvgpr_write_b32 a124, v68
    v_accvgpr_write_b32 a125, v69
    v_accvgpr_write_b32 a126, v70
    v_accvgpr_write_b32 a127, v71
    v_xor_b32 v68, v64, v43
    v_xor_b32 v69, v65, v43
    v_xor_b32 v70, v66, v43
    v_xor_b32 v71, v67, v43
    v_accvgpr_write_b32 a188, v68
    v_accvgpr_write_b32 a189, v69
    v_accvgpr_write_b32 a190, v70
    v_accvgpr_write_b32 a191, v71
    v_xor_b32_dpp v68, v64, v45 quad_perm:[0,1,3,2] row_mask:0xf bank_mask:0xf
    v_xor_b32_dpp v69, v65, v45 quad_perm:[0,1,3,2] row_mask:0xf bank_mask:0xf
    v_xor_b32_dpp v70, v66, v45 quad_perm:[0,1,3,2] row_mask:0xf bank_mask:0xf
    v_xor_b32_dpp v71, v67, v45 quad_perm:[0,1,3,2] row_mask:0xf bank_mask:0xf
    v_accvgpr_write_b32 a252, v68
    v_accvgpr_write_b32 a253, v69
    v_accvgpr_write_b32 a254, v70
    v_accvgpr_write_b32 a255, v71
    s_and_b32 s17, s28, 1
    s_lshl_b32 s17, s17, 15
    s_lshr_b32 s18, s28, 1
    s_lshl_b32 s18, s18, 21
    s_add_u32 s17, s17, s18
    s_lshl_b32 s18, s29, 16
    s_add_u32 s17, s17, s18
    v_lshlrev_b32 v15, 7, v1
    s_waitcnt lgkmcnt(0)
    buffer_load_dword v248, v15, s[40:43], s17 offen
    s_add_u32 s17, s17, 8192
    buffer_load_dword v249, v15, s[40:43], s17 offen
    s_add_u32 s17, s17, 8192
    buffer_load_dword v250, v15, s[40:43], s17 offen
    s_add_u32 s17, s17, 8192
    buffer_load_dword v251, v15, s[40:43], s17 offen
    s_add_u32 s17, s17, 8192
    s_lshl_b32 s34, s93, 2
    s_add_u32 s34, s34, s16
    s_lshl_b32 s34, s34, 13
    s_sub_u32 s34, s34, 262144
    v_mov_b32 v247, v15
    s_lshl_b32 s17, s29, 6
    v_add_u32 v246, s17, v1
    v_mul_u32_u24 v246, 1026, v246
    s_lshl_b32 s17, s28, 8
    v_add_u32 v246, s17, v246
    v_and_b32 v246, -4, v246
    s_load_dwordx2 s[8:9], s[0:1], 0
    s_mov_b32 s10, 4194304
    s_mov_b32 s11, 0x20000
    s_waitcnt lgkmcnt(0)
    v_and_b32 v5, 15, v1
    v_bfe_u32 v6, v1, 1, 3
    v_lshrrev_b32 v7, 4, v1
    v_xor_b32 v6, v6, v7
    v_lshlrev_b32 v6, 4, v6
    v_lshl_add_u32 v10, v5, 7, v6
    s_lshl_b32 s19, s16, 10
    v_xor_b32 v11, 64, v10
    v_add_u32 v12, 0x10000, v10
    v_add_u32 v13, 0x10000, v11
    v_lshrrev_b32 v7, 3, v1
    s_lshl_b32 s17, s16, 3
    v_add_u32 v7, s17, v7
    v_bfe_u32 v8, v7, 1, 3
    v_xor_b32 v8, v8, v1
    v_and_b32 v8, 7, v8
    v_bfe_u32 v5, v7, 2, 2
    v_and_b32 v2, 3, v7
    v_lshl_add_u32 v2, v5, 3, v2
    v_bfe_u32 v5, v7, 4, 1
    v_lshl_add_u32 v2, v5, 2, v2
    v_bfe_u32 v5, v1, 2, 2
    v_and_b32 v3, 3, v1
    v_lshl_add_u32 v3, v5, 3, v3
    v_lshlrev_b32 v2, 16, v2
    v_lshl_add_u32 v2, v8, 4, v2
    v_and_b32 v5, 48, v1
    v_lshl_add_u32 v3, v3, 6, v5
    s_mul_i32 s21, s29, 139776
    s_mul_i32 s17, s28, 34816
    s_add_u32 s21, s21, s17
    s_add_u32 s21, s21, 104857600
    s_and_b32 s20, s28, 1
    s_lshl_b32 s20, s20, 15
    s_lshr_b32 s17, s28, 1
    s_lshl_b32 s17, s17, 21
    s_add_u32 s20, s20, s17
    s_mov_b32 s24, 2048
    s_mov_b32 s25, 2176
    s_barrier
    s_mov_b32 s26, s25
    s_sub_u32 s25, s21, 1073741824
    s_mov_b32 s21, 1073741824
    s_mov_b32 s23, 0
    s_mov_b32 s22, 0
    s_add_u32 m0, s19, 0
    s_nop 0
    buffer_load_dwordx4 v2, s[8:11], s20 offen offset:0 lds
    s_add_u32 m0, s19, 3968
    s_nop 0
    buffer_load_dwordx4 v2, s[8:11], s20 offen offset:128 lds
    s_add_u32 m0, s19, 7936
    s_nop 0
    buffer_load_dwordx4 v2, s[8:11], s20 offen offset:256 lds
    s_add_u32 m0, s19, 11904
    s_nop 0
    buffer_load_dwordx4 v2, s[8:11], s20 offen offset:384 lds
    s_add_u32 m0, s19, 15872
    s_nop 0
    buffer_load_dwordx4 v2, s[8:11], s20 offen offset:512 lds
    s_add_u32 m0, s19, 19840
    s_nop 0
    buffer_load_dwordx4 v2, s[8:11], s20 offen offset:640 lds
    s_add_u32 m0, s19, 23808
    s_nop 0
    buffer_load_dwordx4 v2, s[8:11], s20 offen offset:768 lds
    s_add_u32 m0, s19, 27776
    s_nop 0
    buffer_load_dwordx4 v2, s[8:11], s20 offen offset:896 lds
    s_add_u32 m0, s19, 31744
    s_nop 0
    buffer_load_dwordx4 v2, s[8:11], s20 offen offset:1024 lds
    s_add_u32 m0, s19, 35712
    s_nop 0
    buffer_load_dwordx4 v2, s[8:11], s20 offen offset:1152 lds
    s_add_u32 m0, s19, 39680
    s_nop 0
    buffer_load_dwordx4 v2, s[8:11], s20 offen offset:1280 lds
    s_add_u32 m0, s19, 43648
    s_nop 0
    buffer_load_dwordx4 v2, s[8:11], s20 offen offset:1408 lds
    s_add_u32 m0, s19, 47616
    s_nop 0
    buffer_load_dwordx4 v2, s[8:11], s20 offen offset:1536 lds
    s_add_u32 m0, s19, 51584
    s_nop 0
    buffer_load_dwordx4 v2, s[8:11], s20 offen offset:1664 lds
    s_add_u32 m0, s19, 55552
    s_nop 0
    buffer_load_dwordx4 v2, s[8:11], s20 offen offset:1792 lds
    s_add_u32 m0, s19, 59520
    s_nop 0
    buffer_load_dwordx4 v2, s[8:11], s20 offen offset:1920 lds
    s_add_u32 s20, s20, s24
    s_add_u32 m0, s19, 65536
    s_nop 0
    buffer_load_dwordx4 v2, s[8:11], s20 offen offset:0 lds
    s_add_u32 m0, s19, 69504
    s_nop 0
    buffer_load_dwordx4 v2, s[8:11], s20 offen offset:128 lds
    s_add_u32 m0, s19, 73472
    s_nop 0
    buffer_load_dwordx4 v2, s[8:11], s20 offen offset:256 lds
    s_waitcnt vmcnt(11)
    s_barrier
    ds_read_b128 v[20:23], v10 offset:0
    ds_read_b128 v[24:27], v10 offset:2048
    ds_read_b128 v[28:31], v11 offset:0
    ds_read_b128 v[32:35], v11 offset:2048
    ds_read_b128 v[36:39], v10 offset:4096
    ds_read_b128 v[40:43], v10 offset:6144
    ds_read_b128 v[44:47], v11 offset:4096
.p2align 6
F1_top:
    s_waitcnt lgkmcnt(6)
    v_mfma_f32_16x16x32_bf16 v[52:55], v[20:23], a[0:3], 0
    ds_read_b128 v[48:51], v11 offset:6144
    v_mfma_f32_16x16x32_bf16 v[60:63], v[20:23], a[4:7], 0
    s_waitcnt lgkmcnt(6)
    v_mfma_f32_16x16x32_bf16 v[56:59], v[24:27], a[0:3], 0
    ds_read_b128 v[20:23], v10 offset:8192
    s_add_u32 m0, s19, 77440
    v_mfma_f32_16x16x32_bf16 v[64:67], v[24:27], a[4:7], 0
    buffer_load_dwordx4 v2, s[8:11], s20 offen offset:384 lds
    s_waitcnt lgkmcnt(6)
    v_mfma_f32_16x16x32_bf16 v[52:55], v[28:31], a[8:11], v[52:55]
    ds_read_b128 v[24:27], v10 offset:10240
    v_mfma_f32_16x16x32_bf16 v[60:63], v[28:31], a[12:15], v[60:63]
    s_waitcnt lgkmcnt(6)
    v_mfma_f32_16x16x32_bf16 v[56:59], v[32:35], a[8:11], v[56:59]
    ds_read_b128 v[28:31], v11 offset:8192
    s_add_u32 m0, s19, 81408
    v_mfma_f32_16x16x32_bf16 v[64:67], v[32:35], a[12:15], v[64:67]
    buffer_load_dwordx4 v2, s[8:11], s20 offen offset:512 lds
    s_waitcnt lgkmcnt(6)
    v_mfma_f32_16x16x32_bf16 v[52:55], v[36:39], a[16:19], v[52:55]
    ds_read_b128 v[32:35], v11 offset:10240
    v_mfma_f32_16x16x32_bf16 v[60:63], v[36:39], a[20:23], v[60:63]
    s_waitcnt lgkmcnt(6)
    v_mfma_f32_16x16x32_bf16 v[56:59], v[40:43], a[16:19], v[56:59]
    ds_read_b128 v[36:39], v10 offset:12288
    s_add_u32 m0, s19, 85376
    v_mfma_f32_16x16x32_bf16 v[64:67], v[40:43], a[20:23], v[64:67]
    buffer_load_dwordx4 v2, s[8:11], s20 offen offset:640 lds
    s_waitcnt lgkmcnt(6)
    v_mfma_f32_16x16x32_bf16 v[52:55], v[44:47], a[24:27], v[52:55]
    ds_read_b128 v[40:43], v10 offset:14336
    v_mfma_f32_16x16x32_bf16 v[60:63], v[44:47], a[28:31], v[60:63]
    s_waitcnt lgkmcnt(6)
    v_mfma_f32_16x16x32_bf16 v[56:59], v[48:51], a[24:27], v[56:59]
    ds_read_b128 v[44:47], v11 offset:12288
    s_add_u32 m0, s19, 89344
    v_mfma_f32_16x16x32_bf16 v[64:67], v[48:51], a[28:31], v[64:67]
    buffer_load_dwordx4 v2, s[8:11], s20 offen offset:768 lds
    s_waitcnt lgkmcnt(6)
    v_mfma_f32_16x16x32_bf16 v[52:55], v[20:23], a[32:35], v[52:55]
    ds_read_b128 v[48:51], v11 offset:14336
    v_mfma_f32_16x16x32_bf16 v[60:63], v[20:23], a[36:39], v[60:63]
    s_waitcnt lgkmcnt(6)
    v_mfma_f32_16x16x32_bf16 v[56:59], v[24:27], a[32:35], v[56:59]
    ds_read_b128 v[20:23], v10 offset:16384
    s_add_u32 m0, s19, 93312
    v_mfma_f32_16x16x32_bf16 v[64:67], v[24:27], a[36:39], v[64:67]
    buffer_load_dwordx4 v2, s[8:11], s20 offen offset:896 lds
    s_waitcnt lgkmcnt(6)
    v_mfma_f32_16x16x32_bf16 v[52:55], v[28:31], a[40:43], v[52:55]
    ds_read_b128 v[24:27], v10 offset:18432
    v_mfma_f32_16x16x32_bf16 v[60:63], v[28:31], a[44:47], v[60:63]
    v_cvt_pk_bf16_f32 v84, v68, v69
    s_waitcnt lgkmcnt(6)
    v_mfma_f32_16x16x32_bf16 v[56:59], v[32:35], a[40:43], v[56:59]
    ds_read_b128 v[28:31], v11 offset:16384
    v_mfma_f32_16x16x32_bf16 v[64:67], v[32:35], a[44:47], v[64:67]
    v_cvt_pk_bf16_f32 v85, v70, v71
    s_waitcnt lgkmcnt(6)
    v_mfma_f32_16x16x32_bf16 v[52:55], v[36:39], a[48:51], v[52:55]
    ds_read_b128 v[32:35], v11 offset:18432
    v_mfma_f32_16x16x32_bf16 v[60:63], v[36:39], a[52:55], v[60:63]
    v_cvt_pk_bf16_f32 v86, v72, v73
    s_waitcnt lgkmcnt(6)
    v_mfma_f32_16x16x32_bf16 v[56:59], v[40:43], a[48:51], v[56:59]
    ds_read_b128 v[36:39], v10 offset:20480
    v_mfma_f32_16x16x32_bf16 v[64:67], v[40:43], a[52:55], v[64:67]
    v_cvt_pk_bf16_f32 v87, v74, v75
    s_waitcnt lgkmcnt(6)
    v_mfma_f32_16x16x32_bf16 v[52:55], v[44:47], a[56:59], v[52:55]
    ds_read_b128 v[40:43], v10 offset:22528
    v_mfma_f32_16x16x32_bf16 v[60:63], v[44:47], a[60:63], v[60:63]
    v_cvt_pk_bf16_f32 v88, v76, v77
    s_waitcnt lgkmcnt(6)
    v_mfma_f32_16x16x32_bf16 v[56:59], v[48:51], a[56:59], v[56:59]
    ds_read_b128 v[44:47], v11 offset:20480
    v_mfma_f32_16x16x32_bf16 v[64:67], v[48:51], a[60:63], v[64:67]
    v_cvt_pk_bf16_f32 v89, v78, v79
    buffer_store_dwordx4 v[84:87], v3, s[4:7], s21 offen offset:0 sc1
    s_waitcnt lgkmcnt(6)
    v_mfma_f32_16x16x32_bf16 v[52:55], v[20:23], a[64:67], v[52:55]
    ds_read_b128 v[48:51], v11 offset:22528
    v_mfma_f32_16x16x32_bf16 v[60:63], v[20:23], a[68:71], v[60:63]
    v_cvt_pk_bf16_f32 v90, v80, v81
    s_waitcnt lgkmcnt(6)
    v_mfma_f32_16x16x32_bf16 v[56:59], v[24:27], a[64:67], v[56:59]
    ds_read_b128 v[20:23], v10 offset:24576
    v_mfma_f32_16x16x32_bf16 v[64:67], v[24:27], a[68:71], v[64:67]
    v_cvt_pk_bf16_f32 v91, v82, v83
    s_waitcnt lgkmcnt(6)
    v_mfma_f32_16x16x32_bf16 v[52:55], v[28:31], a[72:75], v[52:55]
    ds_read_b128 v[24:27], v10 offset:26624
    v_mfma_f32_16x16x32_bf16 v[60:63], v[28:31], a[76:79], v[60:63]
    s_waitcnt lgkmcnt(6)
    v_mfma_f32_16x16x32_bf16 v[56:59], v[32:35], a[72:75], v[56:59]
    ds_read_b128 v[28:31], v11 offset:24576
    v_mfma_f32_16x16x32_bf16 v[64:67], v[32:35], a[76:79], v[64:67]
    buffer_store_dwordx4 v[88:91], v3, s[4:7], s21 offen offset:256 sc1
    s_waitcnt lgkmcnt(6)
    v_mfma_f32_16x16x32_bf16 v[52:55], v[36:39], a[80:83], v[52:55]
    ds_read_b128 v[32:35], v11 offset:26624
    v_mfma_f32_16x16x32_bf16 v[60:63], v[36:39], a[84:87], v[60:63]
    s_add_u32 s21, s21, s25
    s_mov_b32 s25, s26
    s_waitcnt lgkmcnt(6)
    v_mfma_f32_16x16x32_bf16 v[56:59], v[40:43], a[80:83], v[56:59]
    ds_read_b128 v[36:39], v10 offset:28672
    v_mfma_f32_16x16x32_bf16 v[64:67], v[40:43], a[84:87], v[64:67]
    s_waitcnt lgkmcnt(6)
    v_mfma_f32_16x16x32_bf16 v[52:55], v[44:47], a[88:91], v[52:55]
    ds_read_b128 v[40:43], v10 offset:30720
    v_mfma_f32_16x16x32_bf16 v[60:63], v[44:47], a[92:95], v[60:63]
    buffer_load_dword v248, v247, s[44:47], s34 offen
    s_add_u32 s34, s34, 1048576
    s_sub_u32 s31, s22, 10
    s_lshl_b32 s31, s31, 6
    s_cmp_lt_u32 s31, 384
    s_cselect_b32 s31, s31, 1073741824
    buffer_load_dword v249, v246, s[48:51], s31 offen
    buffer_load_dword v250, v246, s[52:55], s31 offen
    s_waitcnt lgkmcnt(6)
    v_mfma_f32_16x16x32_bf16 v[56:59], v[48:51], a[88:91], v[56:59]
    ds_read_b128 v[44:47], v11 offset:28672
    v_mfma_f32_16x16x32_bf16 v[64:67], v[48:51], a[92:95], v[64:67]
    s_waitcnt lgkmcnt(6)
    v_mfma_f32_16x16x32_bf16 v[52:55], v[20:23], a[96:99], v[52:55]
    ds_read_b128 v[48:51], v11 offset:30720
    v_mfma_f32_16x16x32_bf16 v[60:63], v[20:23], a[100:103], v[60:63]
    s_waitcnt lgkmcnt(6)
    v_mfma_f32_16x16x32_bf16 v[56:59], v[24:27], a[96:99], v[56:59]
    s_waitcnt vmcnt(13)
    s_barrier
    ds_read_b128 v[20:23], v10 offset:32768
    v_mfma_f32_16x16x32_bf16 v[64:67], v[24:27], a[100:103], v[64:67]
    s_waitcnt lgkmcnt(6)
    v_mfma_f32_16x16x32_bf16 v[52:55], v[28:31], a[104:107], v[52:55]
    ds_read_b128 v[24:27], v10 offset:34816
    s_add_u32 m0, s19, 97280
    v_mfma_f32_16x16x32_bf16 v[60:63], v[28:31], a[108:111], v[60:63]
    buffer_load_dwordx4 v2, s[8:11], s20 offen offset:1024 lds
    s_waitcnt lgkmcnt(6)
    v_mfma_f32_16x16x32_bf16 v[56:59], v[32:35], a[104:107], v[56:59]
    ds_read_b128 v[28:31], v11 offset:32768
    v_mfma_f32_16x16x32_bf16 v[64:67], v[32:35], a[108:111], v[64:67]
    s_waitcnt lgkmcnt(6)
    v_mfma_f32_16x16x32_bf16 v[52:55], v[36:39], a[112:115], v[52:55]
    ds_read_b128 v[32:35], v11 offset:34816
    s_add_u32 m0, s19, 101248
    v_mfma_f32_16x16x32_bf16 v[60:63], v[36:39], a[116:119], v[60:63]
    buffer_load_dwordx4 v2, s[8:11], s20 offen offset:1152 lds
    s_waitcnt lgkmcnt(6)
    v_mfma_f32_16x16x32_bf16 v[56:59], v[40:43], a[112:115], v[56:59]
    ds_read_b128 v[36:39], v10 offset:36864
    v_mfma_f32_16x16x32_bf16 v[64:67], v[40:43], a[116:119], v[64:67]
    s_waitcnt lgkmcnt(6)
    v_mfma_f32_16x16x32_bf16 v[52:55], v[44:47], a[120:123], v[52:55]
    ds_read_b128 v[40:43], v10 offset:38912
    s_add_u32 m0, s19, 105216
    v_mfma_f32_16x16x32_bf16 v[60:63], v[44:47], a[124:127], v[60:63]
    buffer_load_dwordx4 v2, s[8:11], s20 offen offset:1280 lds
    s_waitcnt lgkmcnt(6)
    v_mfma_f32_16x16x32_bf16 v[56:59], v[48:51], a[120:123], v[56:59]
    ds_read_b128 v[44:47], v11 offset:36864
    v_mfma_f32_16x16x32_bf16 v[64:67], v[48:51], a[124:127], v[64:67]
    s_waitcnt lgkmcnt(6)
    v_mfma_f32_16x16x32_bf16 v[52:55], v[20:23], a[128:131], v[52:55]
    ds_read_b128 v[48:51], v11 offset:38912
    v_mfma_f32_16x16x32_bf16 v[60:63], v[20:23], a[132:135], v[60:63]
    s_waitcnt lgkmcnt(6)
    v_mfma_f32_16x16x32_bf16 v[56:59], v[24:27], a[128:131], v[56:59]
    ds_read_b128 v[20:23], v10 offset:40960
    s_add_u32 m0, s19, 109184
    v_mfma_f32_16x16x32_bf16 v[64:67], v[24:27], a[132:135], v[64:67]
    buffer_load_dwordx4 v2, s[8:11], s20 offen offset:1408 lds
    s_waitcnt lgkmcnt(6)
    v_mfma_f32_16x16x32_bf16 v[52:55], v[28:31], a[136:139], v[52:55]
    ds_read_b128 v[24:27], v10 offset:43008
    v_mfma_f32_16x16x32_bf16 v[60:63], v[28:31], a[140:143], v[60:63]
    s_waitcnt lgkmcnt(6)
    v_mfma_f32_16x16x32_bf16 v[56:59], v[32:35], a[136:139], v[56:59]
    ds_read_b128 v[28:31], v11 offset:40960
    s_add_u32 m0, s19, 113152
    v_mfma_f32_16x16x32_bf16 v[64:67], v[32:35], a[140:143], v[64:67]
    buffer_load_dwordx4 v2, s[8:11], s20 offen offset:1536 lds
    s_waitcnt lgkmcnt(6)
    v_mfma_f32_16x16x32_bf16 v[52:55], v[36:39], a[144:147], v[52:55]
    ds_read_b128 v[32:35], v11 offset:43008
    v_mfma_f32_16x16x32_bf16 v[60:63], v[36:39], a[148:151], v[60:63]
    s_waitcnt lgkmcnt(6)
    v_mfma_f32_16x16x32_bf16 v[56:59], v[40:43], a[144:147], v[56:59]
    ds_read_b128 v[36:39], v10 offset:45056
    s_add_u32 m0, s19, 117120
    v_mfma_f32_16x16x32_bf16 v[64:67], v[40:43], a[148:151], v[64:67]
    buffer_load_dwordx4 v2, s[8:11], s20 offen offset:1664 lds
    s_waitcnt lgkmcnt(6)
    v_mfma_f32_16x16x32_bf16 v[52:55], v[44:47], a[152:155], v[52:55]
    ds_read_b128 v[40:43], v10 offset:47104
    v_mfma_f32_16x16x32_bf16 v[60:63], v[44:47], a[156:159], v[60:63]
    s_waitcnt lgkmcnt(6)
    v_mfma_f32_16x16x32_bf16 v[56:59], v[48:51], a[152:155], v[56:59]
    ds_read_b128 v[44:47], v11 offset:45056
    s_add_u32 m0, s19, 121088
    v_mfma_f32_16x16x32_bf16 v[64:67], v[48:51], a[156:159], v[64:67]
    buffer_load_dwordx4 v2, s[8:11], s20 offen offset:1792 lds
    s_waitcnt lgkmcnt(6)
    v_mfma_f32_16x16x32_bf16 v[52:55], v[20:23], a[160:163], v[52:55]
    ds_read_b128 v[48:51], v11 offset:47104
    v_mfma_f32_16x16x32_bf16 v[60:63], v[20:23], a[164:167], v[60:63]
    s_waitcnt lgkmcnt(6)
    v_mfma_f32_16x16x32_bf16 v[56:59], v[24:27], a[160:163], v[56:59]
    ds_read_b128 v[20:23], v10 offset:49152
    s_add_u32 m0, s19, 125056
    v_mfma_f32_16x16x32_bf16 v[64:67], v[24:27], a[164:167], v[64:67]
    buffer_load_dwordx4 v2, s[8:11], s20 offen offset:1920 lds
    s_waitcnt lgkmcnt(6)
    v_mfma_f32_16x16x32_bf16 v[52:55], v[28:31], a[168:171], v[52:55]
    ds_read_b128 v[24:27], v10 offset:51200
    v_mfma_f32_16x16x32_bf16 v[60:63], v[28:31], a[172:175], v[60:63]
    s_add_u32 s20, s20, s24
    s_waitcnt lgkmcnt(6)
    v_mfma_f32_16x16x32_bf16 v[56:59], v[32:35], a[168:171], v[56:59]
    ds_read_b128 v[28:31], v11 offset:49152
    v_mfma_f32_16x16x32_bf16 v[64:67], v[32:35], a[172:175], v[64:67]
    s_waitcnt lgkmcnt(6)
    v_mfma_f32_16x16x32_bf16 v[52:55], v[36:39], a[176:179], v[52:55]
    ds_read_b128 v[32:35], v11 offset:51200
    v_mfma_f32_16x16x32_bf16 v[60:63], v[36:39], a[180:183], v[60:63]
    s_waitcnt lgkmcnt(6)
    v_mfma_f32_16x16x32_bf16 v[56:59], v[40:43], a[176:179], v[56:59]
    ds_read_b128 v[36:39], v10 offset:53248
    v_mfma_f32_16x16x32_bf16 v[64:67], v[40:43], a[180:183], v[64:67]
    s_waitcnt lgkmcnt(6)
    v_mfma_f32_16x16x32_bf16 v[52:55], v[44:47], a[184:187], v[52:55]
    ds_read_b128 v[40:43], v10 offset:55296
    v_mfma_f32_16x16x32_bf16 v[60:63], v[44:47], a[188:191], v[60:63]
    s_waitcnt lgkmcnt(6)
    v_mfma_f32_16x16x32_bf16 v[56:59], v[48:51], a[184:187], v[56:59]
    ds_read_b128 v[44:47], v11 offset:53248
    v_mfma_f32_16x16x32_bf16 v[64:67], v[48:51], a[188:191], v[64:67]
    s_waitcnt lgkmcnt(6)
    v_mfma_f32_16x16x32_bf16 v[52:55], v[20:23], a[192:195], v[52:55]
    ds_read_b128 v[48:51], v11 offset:55296
    v_mfma_f32_16x16x32_bf16 v[60:63], v[20:23], a[196:199], v[60:63]
    s_waitcnt lgkmcnt(6)
    v_mfma_f32_16x16x32_bf16 v[56:59], v[24:27], a[192:195], v[56:59]
    ds_read_b128 v[20:23], v10 offset:57344
    v_mfma_f32_16x16x32_bf16 v[64:67], v[24:27], a[196:199], v[64:67]
    s_waitcnt lgkmcnt(6)
    v_mfma_f32_16x16x32_bf16 v[52:55], v[28:31], a[200:203], v[52:55]
    ds_read_b128 v[24:27], v10 offset:59392
    v_mfma_f32_16x16x32_bf16 v[60:63], v[28:31], a[204:207], v[60:63]
    s_waitcnt lgkmcnt(6)
    v_mfma_f32_16x16x32_bf16 v[56:59], v[32:35], a[200:203], v[56:59]
    ds_read_b128 v[28:31], v11 offset:57344
    v_mfma_f32_16x16x32_bf16 v[64:67], v[32:35], a[204:207], v[64:67]
    s_waitcnt lgkmcnt(6)
    v_mfma_f32_16x16x32_bf16 v[52:55], v[36:39], a[208:211], v[52:55]
    ds_read_b128 v[32:35], v11 offset:59392
    v_mfma_f32_16x16x32_bf16 v[60:63], v[36:39], a[212:215], v[60:63]
    s_waitcnt lgkmcnt(6)
    v_mfma_f32_16x16x32_bf16 v[56:59], v[40:43], a[208:211], v[56:59]
    ds_read_b128 v[36:39], v10 offset:61440
    v_mfma_f32_16x16x32_bf16 v[64:67], v[40:43], a[212:215], v[64:67]
    s_waitcnt lgkmcnt(6)
    v_mfma_f32_16x16x32_bf16 v[52:55], v[44:47], a[216:219], v[52:55]
    ds_read_b128 v[40:43], v10 offset:63488
    v_mfma_f32_16x16x32_bf16 v[60:63], v[44:47], a[220:223], v[60:63]
    s_waitcnt lgkmcnt(6)
    v_mfma_f32_16x16x32_bf16 v[56:59], v[48:51], a[216:219], v[56:59]
    ds_read_b128 v[44:47], v11 offset:61440
    v_mfma_f32_16x16x32_bf16 v[64:67], v[48:51], a[220:223], v[64:67]
    s_waitcnt lgkmcnt(6)
    v_mfma_f32_16x16x32_bf16 v[52:55], v[20:23], a[224:227], v[52:55]
    ds_read_b128 v[48:51], v11 offset:63488
    v_mfma_f32_16x16x32_bf16 v[60:63], v[20:23], a[228:231], v[60:63]
    s_waitcnt lgkmcnt(6)
    v_mfma_f32_16x16x32_bf16 v[56:59], v[24:27], a[224:227], v[56:59]
    s_waitcnt vmcnt(8)
    s_barrier
    ds_read_b128 v[20:23], v12 offset:0
    v_mfma_f32_16x16x32_bf16 v[64:67], v[24:27], a[228:231], v[64:67]
    s_waitcnt lgkmcnt(6)
    v_mfma_f32_16x16x32_bf16 v[52:55], v[28:31], a[232:235], v[52:55]
    ds_read_b128 v[24:27], v12 offset:2048
    s_add_u32 m0, s19, 0
    v_mfma_f32_16x16x32_bf16 v[60:63], v[28:31], a[236:239], v[60:63]
    buffer_load_dwordx4 v2, s[8:11], s20 offen offset:0 lds
    s_waitcnt lgkmcnt(6)
    v_mfma_f32_16x16x32_bf16 v[56:59], v[32:35], a[232:235], v[56:59]
    ds_read_b128 v[28:31], v13 offset:0
    v_mfma_f32_16x16x32_bf16 v[64:67], v[32:35], a[236:239], v[64:67]
    s_waitcnt lgkmcnt(6)
    v_mfma_f32_16x16x32_bf16 v[52:55], v[36:39], a[240:243], v[52:55]
    ds_read_b128 v[32:35], v13 offset:2048
    s_add_u32 m0, s19, 3968
    v_mfma_f32_16x16x32_bf16 v[60:63], v[36:39], a[244:247], v[60:63]
    buffer_load_dwordx4 v2, s[8:11], s20 offen offset:128 lds
    s_waitcnt lgkmcnt(6)
    v_mfma_f32_16x16x32_bf16 v[56:59], v[40:43], a[240:243], v[56:59]
    ds_read_b128 v[36:39], v12 offset:4096
    v_mfma_f32_16x16x32_bf16 v[64:67], v[40:43], a[244:247], v[64:67]
    s_waitcnt lgkmcnt(6)
    v_mfma_f32_16x16x32_bf16 v[52:55], v[44:47], a[248:251], v[52:55]
    ds_read_b128 v[40:43], v12 offset:6144
    s_add_u32 m0, s19, 7936
    v_mfma_f32_16x16x32_bf16 v[60:63], v[44:47], a[252:255], v[60:63]
    buffer_load_dwordx4 v2, s[8:11], s20 offen offset:256 lds
    s_waitcnt lgkmcnt(6)
    v_mfma_f32_16x16x32_bf16 v[56:59], v[48:51], a[248:251], v[56:59]
    ds_read_b128 v[44:47], v13 offset:4096
    v_mfma_f32_16x16x32_bf16 v[64:67], v[48:51], a[252:255], v[64:67]
    s_waitcnt lgkmcnt(6)
    v_mfma_f32_16x16x32_bf16 v[68:71], v[20:23], a[0:3], 0
    ds_read_b128 v[48:51], v13 offset:6144
    v_mfma_f32_16x16x32_bf16 v[76:79], v[20:23], a[4:7], 0
    s_waitcnt lgkmcnt(6)
    v_mfma_f32_16x16x32_bf16 v[72:75], v[24:27], a[0:3], 0
    ds_read_b128 v[20:23], v12 offset:8192
    s_add_u32 m0, s19, 11904
    v_mfma_f32_16x16x32_bf16 v[80:83], v[24:27], a[4:7], 0
    buffer_load_dwordx4 v2, s[8:11], s20 offen offset:384 lds
    s_waitcnt lgkmcnt(6)
    v_mfma_f32_16x16x32_bf16 v[68:71], v[28:31], a[8:11], v[68:71]
    ds_read_b128 v[24:27], v12 offset:10240
    v_mfma_f32_16x16x32_bf16 v[76:79], v[28:31], a[12:15], v[76:79]
    s_waitcnt lgkmcnt(6)
    v_mfma_f32_16x16x32_bf16 v[72:75], v[32:35], a[8:11], v[72:75]
    ds_read_b128 v[28:31], v13 offset:8192
    s_add_u32 m0, s19, 15872
    v_mfma_f32_16x16x32_bf16 v[80:83], v[32:35], a[12:15], v[80:83]
    buffer_load_dwordx4 v2, s[8:11], s20 offen offset:512 lds
    s_waitcnt lgkmcnt(6)
    v_mfma_f32_16x16x32_bf16 v[68:71], v[36:39], a[16:19], v[68:71]
    ds_read_b128 v[32:35], v13 offset:10240
    v_mfma_f32_16x16x32_bf16 v[76:79], v[36:39], a[20:23], v[76:79]
    s_waitcnt lgkmcnt(6)
    v_mfma_f32_16x16x32_bf16 v[72:75], v[40:43], a[16:19], v[72:75]
    ds_read_b128 v[36:39], v12 offset:12288
    s_add_u32 m0, s19, 19840
    v_mfma_f32_16x16x32_bf16 v[80:83], v[40:43], a[20:23], v[80:83]
    buffer_load_dwordx4 v2, s[8:11], s20 offen offset:640 lds
    s_waitcnt lgkmcnt(6)
    v_mfma_f32_16x16x32_bf16 v[68:71], v[44:47], a[24:27], v[68:71]
    ds_read_b128 v[40:43], v12 offset:14336
    v_mfma_f32_16x16x32_bf16 v[76:79], v[44:47], a[28:31], v[76:79]
    s_waitcnt lgkmcnt(6)
    v_mfma_f32_16x16x32_bf16 v[72:75], v[48:51], a[24:27], v[72:75]
    ds_read_b128 v[44:47], v13 offset:12288
    s_add_u32 m0, s19, 23808
    v_mfma_f32_16x16x32_bf16 v[80:83], v[48:51], a[28:31], v[80:83]
    buffer_load_dwordx4 v2, s[8:11], s20 offen offset:768 lds
    s_waitcnt lgkmcnt(6)
    v_mfma_f32_16x16x32_bf16 v[68:71], v[20:23], a[32:35], v[68:71]
    ds_read_b128 v[48:51], v13 offset:14336
    v_mfma_f32_16x16x32_bf16 v[76:79], v[20:23], a[36:39], v[76:79]
    s_waitcnt lgkmcnt(6)
    v_mfma_f32_16x16x32_bf16 v[72:75], v[24:27], a[32:35], v[72:75]
    ds_read_b128 v[20:23], v12 offset:16384
    s_add_u32 m0, s19, 27776
    v_mfma_f32_16x16x32_bf16 v[80:83], v[24:27], a[36:39], v[80:83]
    buffer_load_dwordx4 v2, s[8:11], s20 offen offset:896 lds
    s_waitcnt lgkmcnt(6)
    v_mfma_f32_16x16x32_bf16 v[68:71], v[28:31], a[40:43], v[68:71]
    ds_read_b128 v[24:27], v12 offset:18432
    v_mfma_f32_16x16x32_bf16 v[76:79], v[28:31], a[44:47], v[76:79]
    v_cvt_pk_bf16_f32 v84, v52, v53
    s_waitcnt lgkmcnt(6)
    v_mfma_f32_16x16x32_bf16 v[72:75], v[32:35], a[40:43], v[72:75]
    ds_read_b128 v[28:31], v13 offset:16384
    v_mfma_f32_16x16x32_bf16 v[80:83], v[32:35], a[44:47], v[80:83]
    v_cvt_pk_bf16_f32 v85, v54, v55
    s_waitcnt lgkmcnt(6)
    v_mfma_f32_16x16x32_bf16 v[68:71], v[36:39], a[48:51], v[68:71]
    ds_read_b128 v[32:35], v13 offset:18432
    v_mfma_f32_16x16x32_bf16 v[76:79], v[36:39], a[52:55], v[76:79]
    v_cvt_pk_bf16_f32 v86, v56, v57
    s_waitcnt lgkmcnt(6)
    v_mfma_f32_16x16x32_bf16 v[72:75], v[40:43], a[48:51], v[72:75]
    ds_read_b128 v[36:39], v12 offset:20480
    v_mfma_f32_16x16x32_bf16 v[80:83], v[40:43], a[52:55], v[80:83]
    v_cvt_pk_bf16_f32 v87, v58, v59
    s_waitcnt lgkmcnt(6)
    v_mfma_f32_16x16x32_bf16 v[68:71], v[44:47], a[56:59], v[68:71]
    ds_read_b128 v[40:43], v12 offset:22528
    v_mfma_f32_16x16x32_bf16 v[76:79], v[44:47], a[60:63], v[76:79]
    v_cvt_pk_bf16_f32 v88, v60, v61
    s_waitcnt lgkmcnt(6)
    v_mfma_f32_16x16x32_bf16 v[72:75], v[48:51], a[56:59], v[72:75]
    ds_read_b128 v[44:47], v13 offset:20480
    v_mfma_f32_16x16x32_bf16 v[80:83], v[48:51], a[60:63], v[80:83]
    v_cvt_pk_bf16_f32 v89, v62, v63
    buffer_store_dwordx4 v[84:87], v3, s[4:7], s21 offen offset:0 sc1
    s_waitcnt lgkmcnt(6)
    v_mfma_f32_16x16x32_bf16 v[68:71], v[20:23], a[64:67], v[68:71]
    ds_read_b128 v[48:51], v13 offset:22528
    v_mfma_f32_16x16x32_bf16 v[76:79], v[20:23], a[68:71], v[76:79]
    v_cvt_pk_bf16_f32 v90, v64, v65
    s_waitcnt lgkmcnt(6)
    v_mfma_f32_16x16x32_bf16 v[72:75], v[24:27], a[64:67], v[72:75]
    ds_read_b128 v[20:23], v12 offset:24576
    v_mfma_f32_16x16x32_bf16 v[80:83], v[24:27], a[68:71], v[80:83]
    v_cvt_pk_bf16_f32 v91, v66, v67
    s_waitcnt lgkmcnt(6)
    v_mfma_f32_16x16x32_bf16 v[68:71], v[28:31], a[72:75], v[68:71]
    ds_read_b128 v[24:27], v12 offset:26624
    v_mfma_f32_16x16x32_bf16 v[76:79], v[28:31], a[76:79], v[76:79]
    s_waitcnt lgkmcnt(6)
    v_mfma_f32_16x16x32_bf16 v[72:75], v[32:35], a[72:75], v[72:75]
    ds_read_b128 v[28:31], v13 offset:24576
    v_mfma_f32_16x16x32_bf16 v[80:83], v[32:35], a[76:79], v[80:83]
    buffer_store_dwordx4 v[88:91], v3, s[4:7], s21 offen offset:256 sc1
    s_waitcnt lgkmcnt(6)
    v_mfma_f32_16x16x32_bf16 v[68:71], v[36:39], a[80:83], v[68:71]
    ds_read_b128 v[32:35], v13 offset:26624
    v_mfma_f32_16x16x32_bf16 v[76:79], v[36:39], a[84:87], v[76:79]
    s_add_u32 s21, s21, s25
    s_mov_b32 s25, s26
    s_waitcnt lgkmcnt(6)
    v_mfma_f32_16x16x32_bf16 v[72:75], v[40:43], a[80:83], v[72:75]
    ds_read_b128 v[36:39], v12 offset:28672
    v_mfma_f32_16x16x32_bf16 v[80:83], v[40:43], a[84:87], v[80:83]
    s_waitcnt lgkmcnt(6)
    v_mfma_f32_16x16x32_bf16 v[68:71], v[44:47], a[88:91], v[68:71]
    ds_read_b128 v[40:43], v12 offset:30720
    v_mfma_f32_16x16x32_bf16 v[76:79], v[44:47], a[92:95], v[76:79]
    s_waitcnt lgkmcnt(6)
    v_mfma_f32_16x16x32_bf16 v[72:75], v[48:51], a[88:91], v[72:75]
    ds_read_b128 v[44:47], v13 offset:28672
    v_mfma_f32_16x16x32_bf16 v[80:83], v[48:51], a[92:95], v[80:83]
    s_waitcnt lgkmcnt(6)
    v_mfma_f32_16x16x32_bf16 v[68:71], v[20:23], a[96:99], v[68:71]
    ds_read_b128 v[48:51], v13 offset:30720
    v_mfma_f32_16x16x32_bf16 v[76:79], v[20:23], a[100:103], v[76:79]
    s_waitcnt lgkmcnt(6)
    v_mfma_f32_16x16x32_bf16 v[72:75], v[24:27], a[96:99], v[72:75]
    s_waitcnt vmcnt(10)
    s_barrier
    ds_read_b128 v[20:23], v12 offset:32768
    v_mfma_f32_16x16x32_bf16 v[80:83], v[24:27], a[100:103], v[80:83]
    s_waitcnt lgkmcnt(6)
    v_mfma_f32_16x16x32_bf16 v[68:71], v[28:31], a[104:107], v[68:71]
    ds_read_b128 v[24:27], v12 offset:34816
    s_add_u32 m0, s19, 31744
    v_mfma_f32_16x16x32_bf16 v[76:79], v[28:31], a[108:111], v[76:79]
    buffer_load_dwordx4 v2, s[8:11], s20 offen offset:1024 lds
    s_waitcnt lgkmcnt(6)
    v_mfma_f32_16x16x32_bf16 v[72:75], v[32:35], a[104:107], v[72:75]
    ds_read_b128 v[28:31], v13 offset:32768
    v_mfma_f32_16x16x32_bf16 v[80:83], v[32:35], a[108:111], v[80:83]
    s_waitcnt lgkmcnt(6)
    v_mfma_f32_16x16x32_bf16 v[68:71], v[36:39], a[112:115], v[68:71]
    ds_read_b128 v[32:35], v13 offset:34816
    s_add_u32 m0, s19, 35712
    v_mfma_f32_16x16x32_bf16 v[76:79], v[36:39], a[116:119], v[76:79]
    buffer_load_dwordx4 v2, s[8:11], s20 offen offset:1152 lds
    s_waitcnt lgkmcnt(6)
    v_mfma_f32_16x16x32_bf16 v[72:75], v[40:43], a[112:115], v[72:75]
    ds_read_b128 v[36:39], v12 offset:36864
    v_mfma_f32_16x16x32_bf16 v[80:83], v[40:43], a[116:119], v[80:83]
    s_waitcnt lgkmcnt(6)
    v_mfma_f32_16x16x32_bf16 v[68:71], v[44:47], a[120:123], v[68:71]
    ds_read_b128 v[40:43], v12 offset:38912
    s_add_u32 m0, s19, 39680
    v_mfma_f32_16x16x32_bf16 v[76:79], v[44:47], a[124:127], v[76:79]
    buffer_load_dwordx4 v2, s[8:11], s20 offen offset:1280 lds
    s_waitcnt lgkmcnt(6)
    v_mfma_f32_16x16x32_bf16 v[72:75], v[48:51], a[120:123], v[72:75]
    ds_read_b128 v[44:47], v13 offset:36864
    v_mfma_f32_16x16x32_bf16 v[80:83], v[48:51], a[124:127], v[80:83]
    s_waitcnt lgkmcnt(6)
    v_mfma_f32_16x16x32_bf16 v[68:71], v[20:23], a[128:131], v[68:71]
    ds_read_b128 v[48:51], v13 offset:38912
    v_mfma_f32_16x16x32_bf16 v[76:79], v[20:23], a[132:135], v[76:79]
    s_waitcnt lgkmcnt(6)
    v_mfma_f32_16x16x32_bf16 v[72:75], v[24:27], a[128:131], v[72:75]
    ds_read_b128 v[20:23], v12 offset:40960
    s_add_u32 m0, s19, 43648
    v_mfma_f32_16x16x32_bf16 v[80:83], v[24:27], a[132:135], v[80:83]
    buffer_load_dwordx4 v2, s[8:11], s20 offen offset:1408 lds
    s_waitcnt lgkmcnt(6)
    v_mfma_f32_16x16x32_bf16 v[68:71], v[28:31], a[136:139], v[68:71]
    ds_read_b128 v[24:27], v12 offset:43008
    v_mfma_f32_16x16x32_bf16 v[76:79], v[28:31], a[140:143], v[76:79]
    s_waitcnt lgkmcnt(6)
    v_mfma_f32_16x16x32_bf16 v[72:75], v[32:35], a[136:139], v[72:75]
    ds_read_b128 v[28:31], v13 offset:40960
    s_add_u32 m0, s19, 47616
    v_mfma_f32_16x16x32_bf16 v[80:83], v[32:35], a[140:143], v[80:83]
    buffer_load_dwordx4 v2, s[8:11], s20 offen offset:1536 lds
    s_waitcnt lgkmcnt(6)
    v_mfma_f32_16x16x32_bf16 v[68:71], v[36:39], a[144:147], v[68:71]
    ds_read_b128 v[32:35], v13 offset:43008
    v_mfma_f32_16x16x32_bf16 v[76:79], v[36:39], a[148:151], v[76:79]
    s_waitcnt lgkmcnt(6)
    v_mfma_f32_16x16x32_bf16 v[72:75], v[40:43], a[144:147], v[72:75]
    ds_read_b128 v[36:39], v12 offset:45056
    s_add_u32 m0, s19, 51584
    v_mfma_f32_16x16x32_bf16 v[80:83], v[40:43], a[148:151], v[80:83]
    buffer_load_dwordx4 v2, s[8:11], s20 offen offset:1664 lds
    s_waitcnt lgkmcnt(6)
    v_mfma_f32_16x16x32_bf16 v[68:71], v[44:47], a[152:155], v[68:71]
    ds_read_b128 v[40:43], v12 offset:47104
    v_mfma_f32_16x16x32_bf16 v[76:79], v[44:47], a[156:159], v[76:79]
    s_waitcnt lgkmcnt(6)
    v_mfma_f32_16x16x32_bf16 v[72:75], v[48:51], a[152:155], v[72:75]
    ds_read_b128 v[44:47], v13 offset:45056
    s_add_u32 m0, s19, 55552
    v_mfma_f32_16x16x32_bf16 v[80:83], v[48:51], a[156:159], v[80:83]
    buffer_load_dwordx4 v2, s[8:11], s20 offen offset:1792 lds
    s_waitcnt lgkmcnt(6)
    v_mfma_f32_16x16x32_bf16 v[68:71], v[20:23], a[160:163], v[68:71]
    ds_read_b128 v[48:51], v13 offset:47104
    v_mfma_f32_16x16x32_bf16 v[76:79], v[20:23], a[164:167], v[76:79]
    s_waitcnt lgkmcnt(6)
    v_mfma_f32_16x16x32_bf16 v[72:75], v[24:27], a[160:163], v[72:75]
    ds_read_b128 v[20:23], v12 offset:49152
    s_add_u32 m0, s19, 59520
    v_mfma_f32_16x16x32_bf16 v[80:83], v[24:27], a[164:167], v[80:83]
    buffer_load_dwordx4 v2, s[8:11], s20 offen offset:1920 lds
    s_waitcnt lgkmcnt(6)
    v_mfma_f32_16x16x32_bf16 v[68:71], v[28:31], a[168:171], v[68:71]
    ds_read_b128 v[24:27], v12 offset:51200
    v_mfma_f32_16x16x32_bf16 v[76:79], v[28:31], a[172:175], v[76:79]
    s_add_u32 s20, s20, s24
    s_waitcnt lgkmcnt(6)
    v_mfma_f32_16x16x32_bf16 v[72:75], v[32:35], a[168:171], v[72:75]
    ds_read_b128 v[28:31], v13 offset:49152
    v_mfma_f32_16x16x32_bf16 v[80:83], v[32:35], a[172:175], v[80:83]
    s_waitcnt lgkmcnt(6)
    v_mfma_f32_16x16x32_bf16 v[68:71], v[36:39], a[176:179], v[68:71]
    ds_read_b128 v[32:35], v13 offset:51200
    v_mfma_f32_16x16x32_bf16 v[76:79], v[36:39], a[180:183], v[76:79]
    s_waitcnt lgkmcnt(6)
    v_mfma_f32_16x16x32_bf16 v[72:75], v[40:43], a[176:179], v[72:75]
    ds_read_b128 v[36:39], v12 offset:53248
    v_mfma_f32_16x16x32_bf16 v[80:83], v[40:43], a[180:183], v[80:83]
    s_waitcnt lgkmcnt(6)
    v_mfma_f32_16x16x32_bf16 v[68:71], v[44:47], a[184:187], v[68:71]
    ds_read_b128 v[40:43], v12 offset:55296
    v_mfma_f32_16x16x32_bf16 v[76:79], v[44:47], a[188:191], v[76:79]
    s_waitcnt lgkmcnt(6)
    v_mfma_f32_16x16x32_bf16 v[72:75], v[48:51], a[184:187], v[72:75]
    ds_read_b128 v[44:47], v13 offset:53248
    v_mfma_f32_16x16x32_bf16 v[80:83], v[48:51], a[188:191], v[80:83]
    s_waitcnt lgkmcnt(6)
    v_mfma_f32_16x16x32_bf16 v[68:71], v[20:23], a[192:195], v[68:71]
    ds_read_b128 v[48:51], v13 offset:55296
    v_mfma_f32_16x16x32_bf16 v[76:79], v[20:23], a[196:199], v[76:79]
    s_waitcnt lgkmcnt(6)
    v_mfma_f32_16x16x32_bf16 v[72:75], v[24:27], a[192:195], v[72:75]
    ds_read_b128 v[20:23], v12 offset:57344
    v_mfma_f32_16x16x32_bf16 v[80:83], v[24:27], a[196:199], v[80:83]
    s_waitcnt lgkmcnt(6)
    v_mfma_f32_16x16x32_bf16 v[68:71], v[28:31], a[200:203], v[68:71]
    ds_read_b128 v[24:27], v12 offset:59392
    v_mfma_f32_16x16x32_bf16 v[76:79], v[28:31], a[204:207], v[76:79]
    s_waitcnt lgkmcnt(6)
    v_mfma_f32_16x16x32_bf16 v[72:75], v[32:35], a[200:203], v[72:75]
    ds_read_b128 v[28:31], v13 offset:57344
    v_mfma_f32_16x16x32_bf16 v[80:83], v[32:35], a[204:207], v[80:83]
    s_waitcnt lgkmcnt(6)
    v_mfma_f32_16x16x32_bf16 v[68:71], v[36:39], a[208:211], v[68:71]
    ds_read_b128 v[32:35], v13 offset:59392
    v_mfma_f32_16x16x32_bf16 v[76:79], v[36:39], a[212:215], v[76:79]
    s_waitcnt lgkmcnt(6)
    v_mfma_f32_16x16x32_bf16 v[72:75], v[40:43], a[208:211], v[72:75]
    ds_read_b128 v[36:39], v12 offset:61440
    v_mfma_f32_16x16x32_bf16 v[80:83], v[40:43], a[212:215], v[80:83]
    s_waitcnt lgkmcnt(6)
    v_mfma_f32_16x16x32_bf16 v[68:71], v[44:47], a[216:219], v[68:71]
    ds_read_b128 v[40:43], v12 offset:63488
    v_mfma_f32_16x16x32_bf16 v[76:79], v[44:47], a[220:223], v[76:79]
    s_waitcnt lgkmcnt(6)
    v_mfma_f32_16x16x32_bf16 v[72:75], v[48:51], a[216:219], v[72:75]
    ds_read_b128 v[44:47], v13 offset:61440
    v_mfma_f32_16x16x32_bf16 v[80:83], v[48:51], a[220:223], v[80:83]
    s_waitcnt lgkmcnt(6)
    v_mfma_f32_16x16x32_bf16 v[68:71], v[20:23], a[224:227], v[68:71]
    ds_read_b128 v[48:51], v13 offset:63488
    v_mfma_f32_16x16x32_bf16 v[76:79], v[20:23], a[228:231], v[76:79]
    s_waitcnt lgkmcnt(6)
    v_mfma_f32_16x16x32_bf16 v[72:75], v[24:27], a[224:227], v[72:75]
    s_waitcnt vmcnt(8)
    s_barrier
    ds_read_b128 v[20:23], v10 offset:0
    v_mfma_f32_16x16x32_bf16 v[80:83], v[24:27], a[228:231], v[80:83]
    s_waitcnt lgkmcnt(6)
    v_mfma_f32_16x16x32_bf16 v[68:71], v[28:31], a[232:235], v[68:71]
    ds_read_b128 v[24:27], v10 offset:2048
    s_add_u32 m0, s19, 65536
    v_mfma_f32_16x16x32_bf16 v[76:79], v[28:31], a[236:239], v[76:79]
    buffer_load_dwordx4 v2, s[8:11], s20 offen offset:0 lds
    s_waitcnt lgkmcnt(6)
    v_mfma_f32_16x16x32_bf16 v[72:75], v[32:35], a[232:235], v[72:75]
    ds_read_b128 v[28:31], v11 offset:0
    v_mfma_f32_16x16x32_bf16 v[80:83], v[32:35], a[236:239], v[80:83]
    s_waitcnt lgkmcnt(6)
    v_mfma_f32_16x16x32_bf16 v[68:71], v[36:39], a[240:243], v[68:71]
    ds_read_b128 v[32:35], v11 offset:2048
    s_add_u32 m0, s19, 69504
    v_mfma_f32_16x16x32_bf16 v[76:79], v[36:39], a[244:247], v[76:79]
    buffer_load_dwordx4 v2, s[8:11], s20 offen offset:128 lds
    s_waitcnt lgkmcnt(6)
    v_mfma_f32_16x16x32_bf16 v[72:75], v[40:43], a[240:243], v[72:75]
    ds_read_b128 v[36:39], v10 offset:4096
    v_mfma_f32_16x16x32_bf16 v[80:83], v[40:43], a[244:247], v[80:83]
    s_waitcnt lgkmcnt(6)
    v_mfma_f32_16x16x32_bf16 v[68:71], v[44:47], a[248:251], v[68:71]
    ds_read_b128 v[40:43], v10 offset:6144
    s_add_u32 m0, s19, 73472
    v_mfma_f32_16x16x32_bf16 v[76:79], v[44:47], a[252:255], v[76:79]
    buffer_load_dwordx4 v2, s[8:11], s20 offen offset:256 lds
    s_waitcnt lgkmcnt(6)
    v_mfma_f32_16x16x32_bf16 v[72:75], v[48:51], a[248:251], v[72:75]
    ds_read_b128 v[44:47], v11 offset:4096
    v_mfma_f32_16x16x32_bf16 v[80:83], v[48:51], a[252:255], v[80:83]
    s_add_u32 s22, s22, 2
    s_cmp_lt_u32 s22, 16
    s_cbranch_scc1 F1_top
    v_cvt_pk_bf16_f32 v84, v68, v69
    v_cvt_pk_bf16_f32 v85, v70, v71
    s_nop 0
    v_cvt_pk_bf16_f32 v86, v72, v73
    v_cvt_pk_bf16_f32 v87, v74, v75
    v_cvt_pk_bf16_f32 v88, v76, v77
    v_cvt_pk_bf16_f32 v89, v78, v79
    v_cvt_pk_bf16_f32 v90, v80, v81
    v_cvt_pk_bf16_f32 v91, v82, v83
    buffer_store_dwordx4 v[84:87], v3, s[4:7], s21 offen offset:0 sc1
    buffer_store_dwordx4 v[88:91], v3, s[4:7], s21 offen offset:256 sc1
    s_waitcnt vmcnt(0) lgkmcnt(0)
    v_lshlrev_b32 v5, 2, v1
    s_mov_b32 s18, 0
rdv_17:
    global_load_dword v6, v5, s[100:101] sc1
    s_lshl_b32 s17, s98, 2
    s_waitcnt vmcnt(0)
    v_lshrrev_b32 v9, s17, v6
    s_cmp_eq_u32 s98, 0
    s_cselect_b32 s17, 0x0f0f0f0f, s17
    s_cselect_b32 s17, s17, 0x01010101
    v_and_b32 v9, s17, v9
    v_cmp_ne_u32 vcc, 0x01010101, v9
    s_nop 0
    s_cbranch_vccz rdvok_18
    v_sad_u8 v9, v9, 0, 0
    s_nop 1
    v_add_u32_dpp v9, v9, v9 quad_perm:[1,0,3,2] row_mask:0xf bank_mask:0xf
    v_cmp_ne_u32 vcc, 8, v9
    s_nop 0
    s_cbranch_vccnz rdvw_19
    s_mov_b32 s98, 1
    s_and_b32 s3, s97, 7
    s_barrier
    s_branch role_start
rdvw_19:
    s_sleep 4
    s_add_u32 s18, s18, 1
    s_cmp_lt_u32 s18, 262144
    s_cbranch_scc1 rdv_17
    s_mov_b32 s92, 1048576
rdvok_18:
    s_barrier
    s_lshl_b32 s31, s29, 2
    s_add_u32 s31, s31, s28
    s_lshl_b32 s17, s31, 7
    s_add_u32 s17, s17, 100745216
    v_lshl_add_u32 v5, v1, 2, s17
    v_mov_b32 v6, 1
    s_mov_b64 exec, 0xffffffff
    buffer_store_dword v6, v5, s[4:7], 0 offen sc1
    s_mov_b64 exec, -1
    v_and_b32 v10, 19, v1
    v_bfe_u32 v5, v1, 2, 1
    v_bfe_u32 v6, v1, 3, 1
    v_lshl_add_u32 v10, v5, 3, v10
    v_lshl_add_u32 v10, v6, 2, v10
    v_lshrrev_b32 v8, 1, v1
    v_and_b32 v19, 19, v8
    v_bfe_u32 v5, v8, 2, 1
    v_bfe_u32 v6, v8, 3, 1
    v_lshl_add_u32 v19, v5, 3, v19
    v_lshl_add_u32 v19, v6, 2, v19
    s_load_dwordx2 s[12:13], s[0:1], 80
    s_mov_b32 s14, 8388608
    s_mov_b32 s15, 0x20000
    v_lshrrev_b32 v11, 5, v1
    v_lshl_add_u32 v12, v11, 9, v10
    v_mul_u32_u24 v12, 1026, v12
    v_and_b32 v13, 1, v1
    v_lshlrev_b32 v13, 4, v13
    v_lshlrev_b32 v14, 4, v1
    s_lshr_b32 s17, s16, 1
    s_and_b32 s18, s16, 1
    s_lshl_b32 s17, s17, 5
    s_lshl_b32 s18, s18, 10
    s_add_u32 s17, s17, s18
    s_mul_i32 s20, s17, 1026
    s_lshl_b32 s17, s93, 5
    s_add_u32 s20, s20, s17
    v_mul_u32_u24 v19, 1026, v19
    v_add_u32 v19, v19, v13
    s_mov_b32 s32, 0x05040100
    s_mov_b32 s33, 0x07060302
    v_cvt_f32_u32 v16, v10
    v_lshlrev_b32 v17, 3, v11
    v_cvt_f32_u32 v17, v17
    s_add_u32 s17, s20, 0
    buffer_load_dwordx4 v[60:63], v19, s[48:51], s17 offen
    v_add_f32 v5, 0, v16
    v_mul_f32 v5, 1015021568, v5
    v_mul_f32 v6, v5, v17
    v_mul_f32 v7, 0x41800000, v5
    v_fract_f32 v32, v6
    v_add_f32 v33, v32, v5
    v_add_f32 v34, v33, v5
    v_add_f32 v35, v34, v5
    v_add_f32 v36, v35, v5
    v_add_f32 v37, v36, v5
    v_add_f32 v38, v37, v5
    v_add_f32 v39, v38, v5
    v_add_f32 v6, v32, v7
    v_cos_f32 v40, v32
    v_sin_f32 v48, v32
    v_cos_f32 v41, v33
    buffer_load_dwordx4 v[64:67], v19, s[52:55], s17 offen
    v_sin_f32 v49, v33
    v_cos_f32 v42, v34
    v_sin_f32 v50, v34
    v_cos_f32 v43, v35
    v_sin_f32 v51, v35
    v_cos_f32 v44, v36
    v_sin_f32 v52, v36
    v_cos_f32 v45, v37
    v_sin_f32 v53, v37
    v_cos_f32 v46, v38
    v_sin_f32 v54, v38
    v_cos_f32 v47, v39
    v_sin_f32 v55, v39
    v_cvt_pk_bf16_f32 v56, v40, v41
    v_cvt_pk_bf16_f32 v57, v48, v49
    v_accvgpr_write_b32 a0, v56
    v_xor_b32 v58, 0x80008000, v57
    s_add_u32 s17, s20, 131328
    buffer_load_dwordx4 v[68:71], v19, s[48:51], s17 offen
    v_accvgpr_write_b32 a32, v57
    v_accvgpr_write_b32 a64, v58
    v_cvt_pk_bf16_f32 v56, v42, v43
    v_cvt_pk_bf16_f32 v57, v50, v51
    v_accvgpr_write_b32 a1, v56
    v_xor_b32 v58, 0x80008000, v57
    v_accvgpr_write_b32 a33, v57
    v_accvgpr_write_b32 a65, v58
    v_cvt_pk_bf16_f32 v56, v44, v45
    v_cvt_pk_bf16_f32 v57, v52, v53
    v_accvgpr_write_b32 a2, v56
    v_xor_b32 v58, 0x80008000, v57
    v_accvgpr_write_b32 a34, v57
    v_accvgpr_write_b32 a66, v58
    v_cvt_pk_bf16_f32 v56, v46, v47
    v_cvt_pk_bf16_f32 v57, v54, v55
    v_accvgpr_write_b32 a3, v56
    buffer_load_dwordx4 v[72:75], v19, s[52:55], s17 offen
    v_xor_b32 v58, 0x80008000, v57
    v_accvgpr_write_b32 a35, v57
    v_accvgpr_write_b32 a67, v58
    v_fract_f32 v32, v6
    v_add_f32 v33, v32, v5
    v_add_f32 v34, v33, v5
    v_add_f32 v35, v34, v5
    v_add_f32 v36, v35, v5
    v_add_f32 v37, v36, v5
    v_add_f32 v38, v37, v5
    v_add_f32 v39, v38, v5
    v_add_f32 v6, v32, v7
    v_cos_f32 v40, v32
    v_sin_f32 v48, v32
    v_cos_f32 v41, v33
    v_sin_f32 v49, v33
    s_add_u32 s17, s20, 262656
    buffer_load_dwordx4 v[76:79], v19, s[48:51], s17 offen
    v_cos_f32 v42, v34
    v_sin_f32 v50, v34
    v_cos_f32 v43, v35
    v_sin_f32 v51, v35
    v_cos_f32 v44, v36
    v_sin_f32 v52, v36
    v_cos_f32 v45, v37
    v_sin_f32 v53, v37
    v_cos_f32 v46, v38
    v_sin_f32 v54, v38
    v_cos_f32 v47, v39
    v_sin_f32 v55, v39
    v_cvt_pk_bf16_f32 v56, v40, v41
    v_cvt_pk_bf16_f32 v57, v48, v49
    v_accvgpr_write_b32 a4, v56
    v_xor_b32 v58, 0x80008000, v57
    v_accvgpr_write_b32 a36, v57
    buffer_load_dwordx4 v[80:83], v19, s[52:55], s17 offen
    v_accvgpr_write_b32 a68, v58
    v_cvt_pk_bf16_f32 v56, v42, v43
    v_cvt_pk_bf16_f32 v57, v50, v51
    v_accvgpr_write_b32 a5, v56
    v_xor_b32 v58, 0x80008000, v57
    v_accvgpr_write_b32 a37, v57
    v_accvgpr_write_b32 a69, v58
    v_cvt_pk_bf16_f32 v56, v44, v45
    v_cvt_pk_bf16_f32 v57, v52, v53
    v_accvgpr_write_b32 a6, v56
    v_xor_b32 v58, 0x80008000, v57
    v_accvgpr_write_b32 a38, v57
    v_accvgpr_write_b32 a70, v58
    v_cvt_pk_bf16_f32 v56, v46, v47
    v_cvt_pk_bf16_f32 v57, v54, v55
    v_accvgpr_write_b32 a7, v56
    v_xor_b32 v58, 0x80008000, v57
    s_add_u32 s17, s20, 393984
    buffer_load_dwordx4 v[84:87], v19, s[48:51], s17 offen
    v_accvgpr_write_b32 a39, v57
    v_accvgpr_write_b32 a71, v58
    v_fract_f32 v32, v6
    v_add_f32 v33, v32, v5
    v_add_f32 v34, v33, v5
    v_add_f32 v35, v34, v5
    v_add_f32 v36, v35, v5
    v_add_f32 v37, v36, v5
    v_add_f32 v38, v37, v5
    v_add_f32 v39, v38, v5
    v_add_f32 v6, v32, v7
    v_cos_f32 v40, v32
    v_sin_f32 v48, v32
    v_cos_f32 v41, v33
    v_sin_f32 v49, v33
    v_cos_f32 v42, v34
    buffer_load_dwordx4 v[88:91], v19, s[52:55], s17 offen
    v_sin_f32 v50, v34
    v_cos_f32 v43, v35
    v_sin_f32 v51, v35
    v_cos_f32 v44, v36
    v_sin_f32 v52, v36
    v_cos_f32 v45, v37
    v_sin_f32 v53, v37
    v_cos_f32 v46, v38
    v_sin_f32 v54, v38
    v_cos_f32 v47, v39
    v_sin_f32 v55, v39
    v_cvt_pk_bf16_f32 v56, v40, v41
    v_cvt_pk_bf16_f32 v57, v48, v49
    v_accvgpr_write_b32 a8, v56
    v_xor_b32 v58, 0x80008000, v57
    v_accvgpr_write_b32 a40, v57
    v_accvgpr_write_b32 a72, v58
    s_add_u32 s17, s20, 525312
    buffer_load_dwordx4 v[92:95], v19, s[48:51], s17 offen
    v_cvt_pk_bf16_f32 v56, v42, v43
    v_cvt_pk_bf16_f32 v57, v50, v51
    v_accvgpr_write_b32 a9, v56
    v_xor_b32 v58, 0x80008000, v57
    v_accvgpr_write_b32 a41, v57
    v_accvgpr_write_b32 a73, v58
    v_cvt_pk_bf16_f32 v56, v44, v45
    v_cvt_pk_bf16_f32 v57, v52, v53
    v_accvgpr_write_b32 a10, v56
    v_xor_b32 v58, 0x80008000, v57
    v_accvgpr_write_b32 a42, v57
    v_accvgpr_write_b32 a74, v58
    v_cvt_pk_bf16_f32 v56, v46, v47
    v_cvt_pk_bf16_f32 v57, v54, v55
    v_accvgpr_write_b32 a11, v56
    v_xor_b32 v58, 0x80008000, v57
    v_accvgpr_write_b32 a43, v57
    buffer_load_dwordx4 v[96:99], v19, s[52:55], s17 offen
    v_accvgpr_write_b32 a75, v58
    v_fract_f32 v32, v6
    v_add_f32 v33, v32, v5
    v_add_f32 v34, v33, v5
    v_add_f32 v35, v34, v5
    v_add_f32 v36, v35, v5
    v_add_f32 v37, v36, v5
    v_add_f32 v38, v37, v5
    v_add_f32 v39, v38, v5
    v_add_f32 v6, v32, v7
    v_cos_f32 v40, v32
    v_sin_f32 v48, v32
    v_cos_f32 v41, v33
    v_sin_f32 v49, v33
    v_cos_f32 v42, v34
    v_sin_f32 v50, v34
    s_add_u32 s17, s20, 656640
    buffer_load_dwordx4 v[100:103], v19, s[48:51], s17 offen
    v_cos_f32 v43, v35
    v_sin_f32 v51, v35
    v_cos_f32 v44, v36
    v_sin_f32 v52, v36
    v_cos_f32 v45, v37
    v_sin_f32 v53, v37
    v_cos_f32 v46, v38
    v_sin_f32 v54, v38
    v_cos_f32 v47, v39
    v_sin_f32 v55, v39
    v_cvt_pk_bf16_f32 v56, v40, v41
    v_cvt_pk_bf16_f32 v57, v48, v49
    v_accvgpr_write_b32 a12, v56
    v_xor_b32 v58, 0x80008000, v57
    v_accvgpr_write_b32 a44, v57
    v_accvgpr_write_b32 a76, v58
    v_cvt_pk_bf16_f32 v56, v42, v43
    buffer_load_dwordx4 v[104:107], v19, s[52:55], s17 offen
    v_cvt_pk_bf16_f32 v57, v50, v51
    v_accvgpr_write_b32 a13, v56
    v_xor_b32 v58, 0x80008000, v57
    v_accvgpr_write_b32 a45, v57
    v_accvgpr_write_b32 a77, v58
    v_cvt_pk_bf16_f32 v56, v44, v45
    v_cvt_pk_bf16_f32 v57, v52, v53
    v_accvgpr_write_b32 a14, v56
    v_xor_b32 v58, 0x80008000, v57
    v_accvgpr_write_b32 a46, v57
    v_accvgpr_write_b32 a78, v58
    v_cvt_pk_bf16_f32 v56, v46, v47
    v_cvt_pk_bf16_f32 v57, v54, v55
    v_accvgpr_write_b32 a15, v56
    v_xor_b32 v58, 0x80008000, v57
    v_accvgpr_write_b32 a47, v57
    v_accvgpr_write_b32 a79, v58
    s_add_u32 s17, s20, 787968
    buffer_load_dwordx4 v[108:111], v19, s[48:51], s17 offen
    v_add_f32 v5, 1107296256, v16
    v_mul_f32 v5, 1015021568, v5
    v_mul_f32 v6, v5, v17
    v_mul_f32 v7, 0x41800000, v5
    v_fract_f32 v32, v6
    v_add_f32 v33, v32, v5
    v_add_f32 v34, v33, v5
    v_add_f32 v35, v34, v5
    v_add_f32 v36, v35, v5
    v_add_f32 v37, v36, v5
    v_add_f32 v38, v37, v5
    v_add_f32 v39, v38, v5
    v_add_f32 v6, v32, v7
    v_cos_f32 v40, v32
    v_sin_f32 v48, v32
    v_cos_f32 v41, v33
    buffer_load_dwordx4 v[112:115], v19, s[52:55], s17 offen
    v_sin_f32 v49, v33
    v_cos_f32 v42, v34
    v_sin_f32 v50, v34
    v_cos_f32 v43, v35
    v_sin_f32 v51, v35
    v_cos_f32 v44, v36
    v_sin_f32 v52, v36
    v_cos_f32 v45, v37
    v_sin_f32 v53, v37
    v_cos_f32 v46, v38
    v_sin_f32 v54, v38
    v_cos_f32 v47, v39
    v_sin_f32 v55, v39
    v_cvt_pk_bf16_f32 v56, v40, v41
    v_cvt_pk_bf16_f32 v57, v48, v49
    v_accvgpr_write_b32 a16, v56
    v_xor_b32 v58, 0x80008000, v57
    s_add_u32 s17, s20, 919296
    buffer_load_dwordx4 v[116:119], v19, s[48:51], s17 offen
    v_accvgpr_write_b32 a48, v57
    v_accvgpr_write_b32 a80, v58
    v_cvt_pk_bf16_f32 v56, v42, v43
    v_cvt_pk_bf16_f32 v57, v50, v51
    v_accvgpr_write_b32 a17, v56
    v_xor_b32 v58, 0x80008000, v57
    v_accvgpr_write_b32 a49, v57
    v_accvgpr_write_b32 a81, v58
    v_cvt_pk_bf16_f32 v56, v44, v45
    v_cvt_pk_bf16_f32 v57, v52, v53
    v_accvgpr_write_b32 a18, v56
    v_xor_b32 v58, 0x80008000, v57
    v_accvgpr_write_b32 a50, v57
    v_accvgpr_write_b32 a82, v58
    v_cvt_pk_bf16_f32 v56, v46, v47
    v_cvt_pk_bf16_f32 v57, v54, v55
    v_accvgpr_write_b32 a19, v56
    buffer_load_dwordx4 v[120:123], v19, s[52:55], s17 offen
    v_xor_b32 v58, 0x80008000, v57
    v_accvgpr_write_b32 a51, v57
    v_accvgpr_write_b32 a83, v58
    v_fract_f32 v32, v6
    v_add_f32 v33, v32, v5
    v_add_f32 v34, v33, v5
    v_add_f32 v35, v34, v5
    v_add_f32 v36, v35, v5
    v_add_f32 v37, v36, v5
    v_add_f32 v38, v37, v5
    v_add_f32 v39, v38, v5
    v_add_f32 v6, v32, v7
    v_cos_f32 v40, v32
    v_sin_f32 v48, v32
    v_cos_f32 v41, v33
    v_sin_f32 v49, v33
    v_cos_f32 v42, v34
    s_add_u32 s17, s20, 65664
    buffer_load_dwordx4 v[124:127], v19, s[48:51], s17 offen
    v_sin_f32 v50, v34
    v_cos_f32 v43, v35
    v_sin_f32 v51, v35
    v_cos_f32 v44, v36
    v_sin_f32 v52, v36
    v_cos_f32 v45, v37
    v_sin_f32 v53, v37
    v_cos_f32 v46, v38
    v_sin_f32 v54, v38
    v_cos_f32 v47, v39
    v_sin_f32 v55, v39
    v_cvt_pk_bf16_f32 v56, v40, v41
    v_cvt_pk_bf16_f32 v57, v48, v49
    v_accvgpr_write_b32 a20, v56
    v_xor_b32 v58, 0x80008000, v57
    v_accvgpr_write_b32 a52, v57
    buffer_load_dwordx4 v[128:131], v19, s[52:55], s17 offen
    v_accvgpr_write_b32 a84, v58
    v_cvt_pk_bf16_f32 v56, v42, v43
    v_cvt_pk_bf16_f32 v57, v50, v51
    v_accvgpr_write_b32 a21, v56
    v_xor_b32 v58, 0x80008000, v57
    v_accvgpr_write_b32 a53, v57
    v_accvgpr_write_b32 a85, v58
    v_cvt_pk_bf16_f32 v56, v44, v45
    v_cvt_pk_bf16_f32 v57, v52, v53
    v_accvgpr_write_b32 a22, v56
    v_xor_b32 v58, 0x80008000, v57
    v_accvgpr_write_b32 a54, v57
    v_accvgpr_write_b32 a86, v58
    v_cvt_pk_bf16_f32 v56, v46, v47
    v_cvt_pk_bf16_f32 v57, v54, v55
    v_accvgpr_write_b32 a23, v56
    v_xor_b32 v58, 0x80008000, v57
    s_add_u32 s17, s20, 196992
    buffer_load_dwordx4 v[132:135], v19, s[48:51], s17 offen
    v_accvgpr_write_b32 a55, v57
    v_accvgpr_write_b32 a87, v58
    v_fract_f32 v32, v6
    v_add_f32 v33, v32, v5
    v_add_f32 v34, v33, v5
    v_add_f32 v35, v34, v5
    v_add_f32 v36, v35, v5
    v_add_f32 v37, v36, v5
    v_add_f32 v38, v37, v5
    v_add_f32 v39, v38, v5
    v_add_f32 v6, v32, v7
    v_cos_f32 v40, v32
    v_sin_f32 v48, v32
    v_cos_f32 v41, v33
    v_sin_f32 v49, v33
    v_cos_f32 v42, v34
    v_sin_f32 v50, v34
    buffer_load_dwordx4 v[136:139], v19, s[52:55], s17 offen
    v_cos_f32 v43, v35
    v_sin_f32 v51, v35
    v_cos_f32 v44, v36
    v_sin_f32 v52, v36
    v_cos_f32 v45, v37
    v_sin_f32 v53, v37
    v_cos_f32 v46, v38
    v_sin_f32 v54, v38
    v_cos_f32 v47, v39
    v_sin_f32 v55, v39
    v_cvt_pk_bf16_f32 v56, v40, v41
    v_cvt_pk_bf16_f32 v57, v48, v49
    v_accvgpr_write_b32 a24, v56
    v_xor_b32 v58, 0x80008000, v57
    v_accvgpr_write_b32 a56, v57
    v_accvgpr_write_b32 a88, v58
    s_add_u32 s17, s20, 328320
    buffer_load_dwordx4 v[140:143], v19, s[48:51], s17 offen
    v_cvt_pk_bf16_f32 v56, v42, v43
    v_cvt_pk_bf16_f32 v57, v50, v51
    v_accvgpr_write_b32 a25, v56
    v_xor_b32 v58, 0x80008000, v57
    v_accvgpr_write_b32 a57, v57
    v_accvgpr_write_b32 a89, v58
    v_cvt_pk_bf16_f32 v56, v44, v45
    v_cvt_pk_bf16_f32 v57, v52, v53
    v_accvgpr_write_b32 a26, v56
    v_xor_b32 v58, 0x80008000, v57
    v_accvgpr_write_b32 a58, v57
    v_accvgpr_write_b32 a90, v58
    v_cvt_pk_bf16_f32 v56, v46, v47
    v_cvt_pk_bf16_f32 v57, v54, v55
    v_accvgpr_write_b32 a27, v56
    v_xor_b32 v58, 0x80008000, v57
    v_accvgpr_write_b32 a59, v57
    buffer_load_dwordx4 v[144:147], v19, s[52:55], s17 offen
    v_accvgpr_write_b32 a91, v58
    v_fract_f32 v32, v6
    v_add_f32 v33, v32, v5
    v_add_f32 v34, v33, v5
    v_add_f32 v35, v34, v5
    v_add_f32 v36, v35, v5
    v_add_f32 v37, v36, v5
    v_add_f32 v38, v37, v5
    v_add_f32 v39, v38, v5
    v_add_f32 v6, v32, v7
    v_cos_f32 v40, v32
    v_sin_f32 v48, v32
    v_cos_f32 v41, v33
    v_sin_f32 v49, v33
    v_cos_f32 v42, v34
    v_sin_f32 v50, v34
    v_cos_f32 v43, v35
    s_add_u32 s17, s20, 459648
    buffer_load_dwordx4 v[148:151], v19, s[48:51], s17 offen
    v_sin_f32 v51, v35
    v_cos_f32 v44, v36
    v_sin_f32 v52, v36
    v_cos_f32 v45, v37
    v_sin_f32 v53, v37
    v_cos_f32 v46, v38
    v_sin_f32 v54, v38
    v_cos_f32 v47, v39
    v_sin_f32 v55, v39
    v_cvt_pk_bf16_f32 v56, v40, v41
    v_cvt_pk_bf16_f32 v57, v48, v49
    v_accvgpr_write_b32 a28, v56
    v_xor_b32 v58, 0x80008000, v57
    v_accvgpr_write_b32 a60, v57
    v_accvgpr_write_b32 a92, v58
    v_cvt_pk_bf16_f32 v56, v42, v43
    buffer_load_dwordx4 v[152:155], v19, s[52:55], s17 offen
    v_cvt_pk_bf16_f32 v57, v50, v51
    v_accvgpr_write_b32 a29, v56
    v_xor_b32 v58, 0x80008000, v57
    v_accvgpr_write_b32 a61, v57
    v_accvgpr_write_b32 a93, v58
    v_cvt_pk_bf16_f32 v56, v44, v45
    v_cvt_pk_bf16_f32 v57, v52, v53
    v_accvgpr_write_b32 a30, v56
    v_xor_b32 v58, 0x80008000, v57
    v_accvgpr_write_b32 a62, v57
    v_accvgpr_write_b32 a94, v58
    v_cvt_pk_bf16_f32 v56, v46, v47
    v_cvt_pk_bf16_f32 v57, v54, v55
    v_accvgpr_write_b32 a31, v56
    v_xor_b32 v58, 0x80008000, v57
    v_accvgpr_write_b32 a63, v57
    v_accvgpr_write_b32 a95, v58
    s_add_u32 s17, s20, 590976
    buffer_load_dwordx4 v[156:159], v19, s[48:51], s17 offen
    v_add_f32 v5, 0, v16
    v_mul_f32 v5, 1023410176, v5
    v_mul_f32 v6, v5, v17
    v_mul_f32 v7, 0x41800000, v5
    v_fract_f32 v32, v6
    v_add_f32 v33, v32, v5
    v_add_f32 v34, v33, v5
    v_add_f32 v35, v34, v5
    v_add_f32 v36, v35, v5
    v_add_f32 v37, v36, v5
    v_add_f32 v38, v37, v5
    v_add_f32 v39, v38, v5
    v_add_f32 v6, v32, v7
    v_cos_f32 v40, v32
    v_sin_f32 v48, v32
    v_cos_f32 v41, v33
    v_sin_f32 v49, v33
    buffer_load_dwordx4 v[160:163], v19, s[52:55], s17 offen
    v_cos_f32 v42, v34
    v_sin_f32 v50, v34
    v_cos_f32 v43, v35
    v_sin_f32 v51, v35
    v_cos_f32 v44, v36
    v_sin_f32 v52, v36
    v_cos_f32 v45, v37
    v_sin_f32 v53, v37
    v_cos_f32 v46, v38
    v_sin_f32 v54, v38
    v_cos_f32 v47, v39
    v_sin_f32 v55, v39
    v_mul_f32 v40, 981467136, v40
    v_mul_f32 v41, 981467136, v41
    v_mul_f32 v42, 981467136, v42
    v_mul_f32 v43, 981467136, v43
    s_add_u32 s17, s20, 722304
    buffer_load_dwordx4 v[164:167], v19, s[48:51], s17 offen
    v_mul_f32 v44, 981467136, v44
    v_mul_f32 v45, 981467136, v45
    v_mul_f32 v46, 981467136, v46
    v_mul_f32 v47, 981467136, v47
    v_mul_f32 v48, 981467136, v48
    v_mul_f32 v49, 981467136, v49
    v_mul_f32 v50, 981467136, v50
    v_mul_f32 v51, 981467136, v51
    v_mul_f32 v52, 981467136, v52
    v_mul_f32 v53, 981467136, v53
    v_mul_f32 v54, 981467136, v54
    v_mul_f32 v55, 981467136, v55
    v_cvt_pk_bf16_f32 v56, v40, v41
    v_cvt_pk_bf16_f32 v57, v48, v49
    v_accvgpr_write_b32 a96, v56
    v_xor_b32 v58, 0x80008000, v57
    v_accvgpr_write_b32 a104, v57
    buffer_load_dwordx4 v[168:171], v19, s[52:55], s17 offen
    v_accvgpr_write_b32 a112, v58
    v_cvt_pk_bf16_f32 v56, v42, v43
    v_cvt_pk_bf16_f32 v57, v50, v51
    v_accvgpr_write_b32 a97, v56
    v_xor_b32 v58, 0x80008000, v57
    v_accvgpr_write_b32 a105, v57
    v_accvgpr_write_b32 a113, v58
    v_cvt_pk_bf16_f32 v56, v44, v45
    v_cvt_pk_bf16_f32 v57, v52, v53
    v_accvgpr_write_b32 a98, v56
    v_xor_b32 v58, 0x80008000, v57
    v_accvgpr_write_b32 a106, v57
    v_accvgpr_write_b32 a114, v58
    v_cvt_pk_bf16_f32 v56, v46, v47
    v_cvt_pk_bf16_f32 v57, v54, v55
    v_accvgpr_write_b32 a99, v56
    v_xor_b32 v58, 0x80008000, v57
    s_add_u32 s17, s20, 853632
    buffer_load_dwordx4 v[172:175], v19, s[48:51], s17 offen
    v_accvgpr_write_b32 a107, v57
    v_accvgpr_write_b32 a115, v58
    v_fract_f32 v32, v6
    v_add_f32 v33, v32, v5
    v_add_f32 v34, v33, v5
    v_add_f32 v35, v34, v5
    v_add_f32 v36, v35, v5
    v_add_f32 v37, v36, v5
    v_add_f32 v38, v37, v5
    v_add_f32 v39, v38, v5
    v_add_f32 v6, v32, v7
    v_cos_f32 v40, v32
    v_sin_f32 v48, v32
    v_cos_f32 v41, v33
    v_sin_f32 v49, v33
    v_cos_f32 v42, v34
    buffer_load_dwordx4 v[176:179], v19, s[52:55], s17 offen
    v_sin_f32 v50, v34
    v_cos_f32 v43, v35
    v_sin_f32 v51, v35
    v_cos_f32 v44, v36
    v_sin_f32 v52, v36
    v_cos_f32 v45, v37
    v_sin_f32 v53, v37
    v_cos_f32 v46, v38
    v_sin_f32 v54, v38
    v_cos_f32 v47, v39
    v_sin_f32 v55, v39
    v_mul_f32 v40, 981467136, v40
    v_mul_f32 v41, 981467136, v41
    v_mul_f32 v42, 981467136, v42
    v_mul_f32 v43, 981467136, v43
    v_mul_f32 v44, 981467136, v44
    v_mul_f32 v45, 981467136, v45
    s_add_u32 s17, s20, 984960
    buffer_load_dwordx4 v[180:183], v19, s[48:51], s17 offen
    v_mul_f32 v46, 981467136, v46
    v_mul_f32 v47, 981467136, v47
    v_mul_f32 v48, 981467136, v48
    v_mul_f32 v49, 981467136, v49
    v_mul_f32 v50, 981467136, v50
    v_mul_f32 v51, 981467136, v51
    v_mul_f32 v52, 981467136, v52
    v_mul_f32 v53, 981467136, v53
    v_mul_f32 v54, 981467136, v54
    v_mul_f32 v55, 981467136, v55
    v_cvt_pk_bf16_f32 v56, v40, v41
    v_cvt_pk_bf16_f32 v57, v48, v49
    v_accvgpr_write_b32 a100, v56
    v_xor_b32 v58, 0x80008000, v57
    v_accvgpr_write_b32 a108, v57
    v_accvgpr_write_b32 a116, v58
    v_cvt_pk_bf16_f32 v56, v42, v43
    buffer_load_dwordx4 v[184:187], v19, s[52:55], s17 offen
    v_cvt_pk_bf16_f32 v57, v50, v51
    v_accvgpr_write_b32 a101, v56
    v_xor_b32 v58, 0x80008000, v57
    v_accvgpr_write_b32 a109, v57
    v_accvgpr_write_b32 a117, v58
    v_cvt_pk_bf16_f32 v56, v44, v45
    v_cvt_pk_bf16_f32 v57, v52, v53
    v_accvgpr_write_b32 a102, v56
    v_xor_b32 v58, 0x80008000, v57
    v_accvgpr_write_b32 a110, v57
    v_accvgpr_write_b32 a118, v58
    v_cvt_pk_bf16_f32 v56, v46, v47
    v_cvt_pk_bf16_f32 v57, v54, v55
    v_accvgpr_write_b32 a103, v56
    v_xor_b32 v58, 0x80008000, v57
    v_accvgpr_write_b32 a111, v57
    v_accvgpr_write_b32 a119, v58
    s_lshl_b32 s17, s16, 11
    v_lshlrev_b32 v5, 12, v13
    v_lshl_add_u32 v5, v8, 4, v5
    v_add_u32 v5, s17, v5
    s_cmp_eq_u32 s16, 0
    s_cselect_b32 s17, 0, 10240
    s_add_u32 s17, s17, 0x20000
    v_add_u32 v13, s17, v14
    s_waitcnt vmcnt(24)
    v_perm_b32 v236, v64, v60, s32
    v_perm_b32 v237, v72, v68, s32
    v_perm_b32 v238, v80, v76, s32
    v_perm_b32 v239, v88, v84, s32
    ds_write_b128 v5, v[236:239] offset:0
    v_perm_b32 v240, v64, v60, s33
    v_perm_b32 v241, v72, v68, s33
    v_perm_b32 v242, v80, v76, s33
    v_perm_b32 v243, v88, v84, s33
    ds_write_b128 v5, v[240:243] offset:8192
    v_perm_b32 v244, v65, v61, s32
    v_perm_b32 v245, v73, v69, s32
    v_perm_b32 v246, v81, v77, s32
    v_perm_b32 v247, v89, v85, s32
    ds_write_b128 v5, v[244:247] offset:16384
    v_perm_b32 v248, v65, v61, s33
    v_perm_b32 v249, v73, v69, s33
    v_perm_b32 v250, v81, v77, s33
    v_perm_b32 v251, v89, v85, s33
    ds_write_b128 v5, v[248:251] offset:24576
    v_perm_b32 v236, v66, v62, s32
    v_perm_b32 v237, v74, v70, s32
    v_perm_b32 v238, v82, v78, s32
    v_perm_b32 v239, v90, v86, s32
    ds_write_b128 v5, v[236:239] offset:32768
    v_perm_b32 v240, v66, v62, s33
    v_perm_b32 v241, v74, v70, s33
    v_perm_b32 v242, v82, v78, s33
    v_perm_b32 v243, v90, v86, s33
    ds_write_b128 v5, v[240:243] offset:40960
    v_perm_b32 v244, v67, v63, s32
    v_perm_b32 v245, v75, v71, s32
    v_perm_b32 v246, v83, v79, s32
    v_perm_b32 v247, v91, v87, s32
    ds_write_b128 v5, v[244:247] offset:49152
    v_perm_b32 v248, v67, v63, s33
    v_perm_b32 v249, v75, v71, s33
    v_perm_b32 v250, v83, v79, s33
    v_perm_b32 v251, v91, v87, s33
    ds_write_b128 v5, v[248:251] offset:57344
    s_waitcnt vmcnt(16)
    v_perm_b32 v236, v96, v92, s32
    v_perm_b32 v237, v104, v100, s32
    v_perm_b32 v238, v112, v108, s32
    v_perm_b32 v239, v120, v116, s32
    ds_write_b128 v5, v[236:239] offset:512
    v_perm_b32 v240, v96, v92, s33
    v_perm_b32 v241, v104, v100, s33
    v_perm_b32 v242, v112, v108, s33
    v_perm_b32 v243, v120, v116, s33
    ds_write_b128 v5, v[240:243] offset:8704
    v_perm_b32 v244, v97, v93, s32
    v_perm_b32 v245, v105, v101, s32
    v_perm_b32 v246, v113, v109, s32
    v_perm_b32 v247, v121, v117, s32
    ds_write_b128 v5, v[244:247] offset:16896
    v_perm_b32 v248, v97, v93, s33
    v_perm_b32 v249, v105, v101, s33
    v_perm_b32 v250, v113, v109, s33
    v_perm_b32 v251, v121, v117, s33
    ds_write_b128 v5, v[248:251] offset:25088
    v_perm_b32 v236, v98, v94, s32
    v_perm_b32 v237, v106, v102, s32
    v_perm_b32 v238, v114, v110, s32
    v_perm_b32 v239, v122, v118, s32
    ds_write_b128 v5, v[236:239] offset:33280
    v_perm_b32 v240, v98, v94, s33
    v_perm_b32 v241, v106, v102, s33
    v_perm_b32 v242, v114, v110, s33
    v_perm_b32 v243, v122, v118, s33
    ds_write_b128 v5, v[240:243] offset:41472
    v_perm_b32 v244, v99, v95, s32
    v_perm_b32 v245, v107, v103, s32
    v_perm_b32 v246, v115, v111, s32
    v_perm_b32 v247, v123, v119, s32
    ds_write_b128 v5, v[244:247] offset:49664
    v_perm_b32 v248, v99, v95, s33
    v_perm_b32 v249, v107, v103, s33
    v_perm_b32 v250, v115, v111, s33
    v_perm_b32 v251, v123, v119, s33
    ds_write_b128 v5, v[248:251] offset:57856
    s_waitcnt vmcnt(8)
    v_perm_b32 v236, v128, v124, s32
    v_perm_b32 v237, v136, v132, s32
    v_perm_b32 v238, v144, v140, s32
    v_perm_b32 v239, v152, v148, s32
    ds_write_b128 v5, v[236:239] offset:1024
    v_perm_b32 v240, v128, v124, s33
    v_perm_b32 v241, v136, v132, s33
    v_perm_b32 v242, v144, v140, s33
    v_perm_b32 v243, v152, v148, s33
    ds_write_b128 v5, v[240:243] offset:9216
    v_perm_b32 v244, v129, v125, s32
    v_perm_b32 v245, v137, v133, s32
    v_perm_b32 v246, v145, v141, s32
    v_perm_b32 v247, v153, v149, s32
    ds_write_b128 v5, v[244:247] offset:17408
    v_perm_b32 v248, v129, v125, s33
    v_perm_b32 v249, v137, v133, s33
    v_perm_b32 v250, v145, v141, s33
    v_perm_b32 v251, v153, v149, s33
    ds_write_b128 v5, v[248:251] offset:25600
    v_perm_b32 v236, v130, v126, s32
    v_perm_b32 v237, v138, v134, s32
    v_perm_b32 v238, v146, v142, s32
    v_perm_b32 v239, v154, v150, s32
    ds_write_b128 v5, v[236:239] offset:33792
    v_perm_b32 v240, v130, v126, s33
    v_perm_b32 v241, v138, v134, s33
    v_perm_b32 v242, v146, v142, s33
    v_perm_b32 v243, v154, v150, s33
    ds_write_b128 v5, v[240:243] offset:41984
    v_perm_b32 v244, v131, v127, s32
    v_perm_b32 v245, v139, v135, s32
    v_perm_b32 v246, v147, v143, s32
    v_perm_b32 v247, v155, v151, s32
    ds_write_b128 v5, v[244:247] offset:50176
    v_perm_b32 v248, v131, v127, s33
    v_perm_b32 v249, v139, v135, s33
    v_perm_b32 v250, v147, v143, s33
    v_perm_b32 v251, v155, v151, s33
    ds_write_b128 v5, v[248:251] offset:58368
    s_waitcnt vmcnt(0)
    v_perm_b32 v236, v160, v156, s32
    v_perm_b32 v237, v168, v164, s32
    v_perm_b32 v238, v176, v172, s32
    v_perm_b32 v239, v184, v180, s32
    ds_write_b128 v5, v[236:239] offset:1536
    v_perm_b32 v240, v160, v156, s33
    v_perm_b32 v241, v168, v164, s33
    v_perm_b32 v242, v176, v172, s33
    v_perm_b32 v243, v184, v180, s33
    ds_write_b128 v5, v[240:243] offset:9728
    v_perm_b32 v244, v161, v157, s32
    v_perm_b32 v245, v169, v165, s32
    v_perm_b32 v246, v177, v173, s32
    v_perm_b32 v247, v185, v181, s32
    ds_write_b128 v5, v[244:247] offset:17920
    v_perm_b32 v248, v161, v157, s33
    v_perm_b32 v249, v169, v165, s33
    v_perm_b32 v250, v177, v173, s33
    v_perm_b32 v251, v185, v181, s33
    ds_write_b128 v5, v[248:251] offset:26112
    v_perm_b32 v236, v162, v158, s32
    v_perm_b32 v237, v170, v166, s32
    v_perm_b32 v238, v178, v174, s32
    v_perm_b32 v239, v186, v182, s32
    ds_write_b128 v5, v[236:239] offset:34304
    v_perm_b32 v240, v162, v158, s33
    v_perm_b32 v241, v170, v166, s33
    v_perm_b32 v242, v178, v174, s33
    v_perm_b32 v243, v186, v182, s33
    ds_write_b128 v5, v[240:243] offset:42496
    v_perm_b32 v244, v163, v159, s32
    v_perm_b32 v245, v171, v167, s32
    v_perm_b32 v246, v179, v175, s32
    v_perm_b32 v247, v187, v183, s32
    ds_write_b128 v5, v[244:247] offset:50688
    v_perm_b32 v248, v163, v159, s33
    v_perm_b32 v249, v171, v167, s33
    v_perm_b32 v250, v179, v175, s33
    v_perm_b32 v251, v187, v183, s33
    ds_write_b128 v5, v[248:251] offset:58880
    v_mul_u32_u24 v15, 2176, v10
    v_lshl_add_u32 v15, v11, 4, v15
    v_lshlrev_b32 v18, 12, v11
    v_lshl_add_u32 v18, v10, 4, v18
    s_mul_i32 s32, s93, 139776
    s_lshl_b32 s17, s16, 9
    s_add_u32 s32, s32, s17
    s_add_u32 s32, s32, 104857600
    s_add_u32 s33, s32, 64
    s_lshl_b32 s31, s93, 2
    s_add_u32 s31, s31, s16
    s_lshl_b32 s35, s16, 15
    s_mov_b32 s38, 0xffff0000
    s_mov_b32 s36, 0
    s_cmp_eq_u32 s31, 0
    s_cselect_b32 s37, 5, 4
    s_cselect_b32 s33, 1073741824, s33
    s_cselect_b32 s34, 1024, 1073741824
    v_and_b32 v8, 3, v1
    v_lshlrev_b32 v8, 7, v8
    s_lshl_b32 s17, s93, 9
    s_add_u32 s17, s17, 100745216
    v_add_u32 v8, s17, v8
    s_waitcnt lgkmcnt(0)
    s_mov_b32 s30, s92
F2_w:
    buffer_load_dword v5, v8, s[4:7], 0 offen sc1
    s_waitcnt vmcnt(0)
    v_cmp_gt_u32 vcc, 1, v5
    s_nop 0
    s_and_b32 s17, vcc_lo, 15
    s_cbranch_scc0 F2_w_ok
    s_cmp_ge_u32 s30, 1048576
    s_cselect_b32 s92, 1048576, s92
    s_cbranch_scc1 F2_w_ok
    s_add_u32 s30, s30, 1
    s_sleep 8
    s_branch F2_w
F2_w_ok:
    buffer_load_dwordx4 v[128:131], v15, s[4:7], s32 offen offset:0
    buffer_load_dwordx4 v[132:135], v15, s[4:7], s32 offen offset:32
    s_add_u32 s17, s32, 69632
    buffer_load_dwordx4 v[136:139], v15, s[4:7], s17 offen offset:0
    buffer_load_dwordx4 v[140:143], v15, s[4:7], s17 offen offset:32
    buffer_load_dwordx4 v[144:147], v15, s[4:7], s33 offen offset:0
    buffer_load_dwordx4 v[148:151], v15, s[4:7], s33 offen offset:32
    s_add_u32 s17, s33, 69632
    buffer_load_dwordx4 v[152:155], v15, s[4:7], s17 offen offset:0
    buffer_load_dwordx4 v[156:159], v15, s[4:7], s17 offen offset:32
    v_add_f32 v5, 0, v16
    v_mul_f32 v5, 973078528, v5
    v_add_f32 v6, 0, v17
    v_mul_f32 v6, v6, v5
    v_cos_f32 v160, v6
    v_sin_f32 v176, v6
    v_add_f32 v6, 1065353216, v17
    v_mul_f32 v6, v6, v5
    v_cos_f32 v161, v6
    v_sin_f32 v177, v6
    v_add_f32 v6, 1073741824, v17
    v_mul_f32 v6, v6, v5
    v_cos_f32 v162, v6
    v_sin_f32 v178, v6
    v_add_f32 v6, 1077936128, v17
    v_mul_f32 v6, v6, v5
    v_cos_f32 v163, v6
    v_sin_f32 v179, v6
    v_add_f32 v6, 1082130432, v17
    v_mul_f32 v6, v6, v5
    v_cos_f32 v164, v6
    v_sin_f32 v180, v6
    v_add_f32 v6, 1084227584, v17
    v_mul_f32 v6, v6, v5
    v_cos_f32 v165, v6
    v_sin_f32 v181, v6
    v_add_f32 v6, 1086324736, v17
    v_mul_f32 v6, v6, v5
    v_cos_f32 v166, v6
    v_sin_f32 v182, v6
    v_add_f32 v6, 1088421888, v17
    v_mul_f32 v6, v6, v5
    v_cos_f32 v167, v6
    v_sin_f32 v183, v6
    v_add_f32 v6, 1098907648, v17
    v_mul_f32 v6, v6, v5
    v_cos_f32 v168, v6
    v_sin_f32 v184, v6
    v_add_f32 v6, 1099431936, v17
    v_mul_f32 v6, v6, v5
    v_cos_f32 v169, v6
    v_sin_f32 v185, v6
    v_add_f32 v6, 1099956224, v17
    v_mul_f32 v6, v6, v5
    v_cos_f32 v170, v6
    v_sin_f32 v186, v6
    v_add_f32 v6, 1100480512, v17
    v_mul_f32 v6, v6, v5
    v_cos_f32 v171, v6
    v_sin_f32 v187, v6
    v_add_f32 v6, 1101004800, v17
    v_mul_f32 v6, v6, v5
    v_cos_f32 v172, v6
    v_sin_f32 v188, v6
    v_add_f32 v6, 1101529088, v17
    v_mul_f32 v6, v6, v5
    v_cos_f32 v173, v6
    v_sin_f32 v189, v6
    v_add_f32 v6, 1102053376, v17
    v_mul_f32 v6, v6, v5
    v_cos_f32 v174, v6
    v_sin_f32 v190, v6
    v_add_f32 v6, 1102577664, v17
    v_mul_f32 v6, v6, v5
    v_cos_f32 v175, v6
    v_sin_f32 v191, v6
    v_add_f32 v5, 1107296256, v16
    v_mul_f32 v5, 973078528, v5
    v_add_f32 v6, 0, v17
    v_mul_f32 v6, v6, v5
    v_cos_f32 v192, v6
    v_sin_f32 v208, v6
    v_add_f32 v6, 1065353216, v17
    v_mul_f32 v6, v6, v5
    v_cos_f32 v193, v6
    v_sin_f32 v209, v6
    v_add_f32 v6, 1073741824, v17
    v_mul_f32 v6, v6, v5
    v_cos_f32 v194, v6
    v_sin_f32 v210, v6
    v_add_f32 v6, 1077936128, v17
    v_mul_f32 v6, v6, v5
    v_cos_f32 v195, v6
    v_sin_f32 v211, v6
    v_add_f32 v6, 1082130432, v17
    v_mul_f32 v6, v6, v5
    v_cos_f32 v196, v6
    v_sin_f32 v212, v6
    v_add_f32 v6, 1084227584, v17
    v_mul_f32 v6, v6, v5
    v_cos_f32 v197, v6
    v_sin_f32 v213, v6
    v_add_f32 v6, 1086324736, v17
    v_mul_f32 v6, v6, v5
    v_cos_f32 v198, v6
    v_sin_f32 v214, v6
    v_add_f32 v6, 1088421888, v17
    v_mul_f32 v6, v6, v5
    v_cos_f32 v199, v6
    v_sin_f32 v215, v6
    v_add_f32 v6, 1098907648, v17
    v_mul_f32 v6, v6, v5
    v_cos_f32 v200, v6
    v_sin_f32 v216, v6
    v_add_f32 v6, 1099431936, v17
    v_mul_f32 v6, v6, v5
    v_cos_f32 v201, v6
    v_sin_f32 v217, v6
    v_add_f32 v6, 1099956224, v17
    v_mul_f32 v6, v6, v5
    v_cos_f32 v202, v6
    v_sin_f32 v218, v6
    v_add_f32 v6, 1100480512, v17
    v_mul_f32 v6, v6, v5
    v_cos_f32 v203, v6
    v_sin_f32 v219, v6
    v_add_f32 v6, 1101004800, v17
    v_mul_f32 v6, v6, v5
    v_cos_f32 v204, v6
    v_sin_f32 v220, v6
    v_add_f32 v6, 1101529088, v17
    v_mul_f32 v6, v6, v5
    v_cos_f32 v205, v6
    v_sin_f32 v221, v6
    v_add_f32 v6, 1102053376, v17
    v_mul_f32 v6, v6, v5
    v_cos_f32 v206, v6
    v_sin_f32 v222, v6
    v_add_f32 v6, 1102577664, v17
    v_mul_f32 v6, v6, v5
    v_cos_f32 v207, v6
    v_sin_f32 v223, v6
    v_add_f32 v5, 0, v16
    v_mul_f32 v5, 973078528, v5
    v_add_f32 v6, 1107296256, v17
    v_mul_f32 v6, v6, v5
    v_cos_f32 v224, v6
    v_sin_f32 v240, v6
    v_add_f32 v6, 1107558400, v17
    v_mul_f32 v6, v6, v5
    v_cos_f32 v225, v6
    v_sin_f32 v241, v6
    v_add_f32 v6, 1107820544, v17
    v_mul_f32 v6, v6, v5
    v_cos_f32 v226, v6
    v_sin_f32 v242, v6
    v_add_f32 v6, 1108082688, v17
    v_mul_f32 v6, v6, v5
    v_cos_f32 v227, v6
    v_sin_f32 v243, v6
    v_add_f32 v6, 1108344832, v17
    v_mul_f32 v6, v6, v5
    v_cos_f32 v228, v6
    v_sin_f32 v244, v6
    v_add_f32 v6, 1108606976, v17
    v_mul_f32 v6, v6, v5
    v_cos_f32 v229, v6
    v_sin_f32 v245, v6
    v_add_f32 v6, 1108869120, v17
    v_mul_f32 v6, v6, v5
    v_cos_f32 v230, v6
    v_sin_f32 v246, v6
    v_add_f32 v6, 1109131264, v17
    v_mul_f32 v6, v6, v5
    v_cos_f32 v231, v6
    v_sin_f32 v247, v6
    v_add_f32 v6, 1111490560, v17
    v_mul_f32 v6, v6, v5
    v_cos_f32 v232, v6
    v_sin_f32 v248, v6
    v_add_f32 v6, 1111752704, v17
    v_mul_f32 v6, v6, v5
    v_cos_f32 v233, v6
    v_sin_f32 v249, v6
    v_add_f32 v6, 1112014848, v17
    v_mul_f32 v6, v6, v5
    v_cos_f32 v234, v6
    v_sin_f32 v250, v6
    v_add_f32 v6, 1112276992, v17
    v_mul_f32 v6, v6, v5
    v_cos_f32 v235, v6
    v_sin_f32 v251, v6
    v_add_f32 v6, 1112539136, v17
    v_mul_f32 v6, v6, v5
    v_cos_f32 v236, v6
    v_sin_f32 v252, v6
    v_add_f32 v6, 1112801280, v17
    v_mul_f32 v6, v6, v5
    v_cos_f32 v237, v6
    v_sin_f32 v253, v6
    v_add_f32 v6, 1113063424, v17
    v_mul_f32 v6, v6, v5
    v_cos_f32 v238, v6
    v_sin_f32 v254, v6
    v_add_f32 v6, 1113325568, v17
    v_mul_f32 v6, v6, v5
    v_cos_f32 v239, v6
    v_sin_f32 v255, v6
    s_barrier
.p2align 6
F2_top:
    s_waitcnt vmcnt(0)
    v_mfma_f32_32x32x16_bf16 v[32:47], v[128:131], a[0:3], 0
    v_mfma_f32_32x32x16_bf16 v[48:63], v[144:147], a[0:3], 0
    v_mfma_f32_32x32x16_bf16 v[32:47], v[144:147], a[32:35], v[32:47]
    ds_write_b128 v13, a[248:251]
    v_mfma_f32_32x32x16_bf16 v[48:63], v[128:131], a[64:67], v[48:63]
    ds_write_b128 v13, a[252:255] offset:1024
    ds_write_b16 v13, v2 offset:2
    v_mfma_f32_32x32x16_bf16 v[32:47], v[132:135], a[4:7], v[32:47]
    ds_write_b16 v13, v3 offset:1026
    v_mfma_f32_32x32x16_bf16 v[48:63], v[148:151], a[4:7], v[48:63]
    ds_write_b16 v13, v4 offset:6
    ds_write_b16 v13, v7 offset:1030
    v_mfma_f32_32x32x16_bf16 v[32:47], v[148:151], a[36:39], v[32:47]
    ds_write_b16 v13, v8 offset:10
    v_mfma_f32_32x32x16_bf16 v[48:63], v[132:135], a[68:71], v[48:63]
    ds_write_b16 v13, v10 offset:1034
    ds_write_b16 v13, v11 offset:14
    v_mfma_f32_32x32x16_bf16 v[32:47], v[136:139], a[8:11], v[32:47]
    ds_write_b16 v13, v16 offset:1038
    v_mfma_f32_32x32x16_bf16 v[48:63], v[152:155], a[8:11], v[48:63]
    v_add_u32 v13, 2048, v13
    s_add_u32 s36, s36, 1
    v_mfma_f32_32x32x16_bf16 v[32:47], v[152:155], a[40:43], v[32:47]
    s_add_u32 s32, s32, 128
    v_mfma_f32_32x32x16_bf16 v[48:63], v[136:139], a[72:75], v[48:63]
    s_add_u32 s33, s32, 64
    s_cmp_eq_u32 s36, 4
    v_mfma_f32_32x32x16_bf16 v[32:47], v[140:143], a[12:15], v[32:47]
    s_cselect_b32 s32, 104857664, s32
    v_mfma_f32_32x32x16_bf16 v[48:63], v[156:159], a[12:15], v[48:63]
    s_cselect_b32 s33, 1073741824, s33
    s_cmp_lt_u32 s36, s37
    v_mfma_f32_32x32x16_bf16 v[32:47], v[156:159], a[44:47], v[32:47]
    s_cselect_b32 s32, s32, 1073741824
    v_mfma_f32_32x32x16_bf16 v[48:63], v[140:143], a[76:79], v[48:63]
    s_cselect_b32 s33, s33, 1073741824
    v_add_u32 v19, s35, v14
    v_mfma_f32_32x32x16_bf16 v[64:79], v[128:131], a[16:19], 0
    v_mfma_f32_32x32x16_bf16 v[80:95], v[144:147], a[16:19], 0
    s_add_u32 s18, s34, 0
    buffer_load_ushort a248, v12, s[48:51], s18 offen
    buffer_load_ushort v2, v12, s[52:55], s18 offen
    v_mfma_f32_32x32x16_bf16 v[64:79], v[144:147], a[48:51], v[64:79]
    v_mul_f32 v20, v32, v160
    s_nop 0
    v_mul_f32 v22, v48, v160
    v_mul_f32 v21, v33, v161
    v_mul_f32 v23, v49, v161
    v_fma_f32 v20, v48, v176, v20
    v_mfma_f32_32x32x16_bf16 v[80:95], v[128:131], a[80:83], v[80:95]
    v_fma_f32 v22, -v32, v176, v22
    v_fma_f32 v21, v49, v177, v21
    v_fma_f32 v23, -v33, v177, v23
    v_cvt_pk_bf16_f32 v96, v20, v21
    v_cvt_pk_bf16_f32 v112, v22, v23
    v_mul_f32 v24, v34, v162
    v_mfma_f32_32x32x16_bf16 v[64:79], v[132:135], a[20:23], v[64:79]
    v_mul_f32 v26, v50, v162
    v_mul_f32 v25, v35, v163
    v_mul_f32 v27, v51, v163
    v_fma_f32 v24, v50, v178, v24
    v_fma_f32 v26, -v34, v178, v26
    v_fma_f32 v25, v51, v179, v25
    v_mfma_f32_32x32x16_bf16 v[80:95], v[148:151], a[20:23], v[80:95]
    v_fma_f32 v27, -v35, v179, v27
    v_cvt_pk_bf16_f32 v97, v24, v25
    v_cvt_pk_bf16_f32 v113, v26, v27
    v_mul_f32 v20, v36, v164
    v_mul_f32 v22, v52, v164
    v_mfma_f32_32x32x16_bf16 v[64:79], v[148:151], a[52:55], v[64:79]
    v_mul_f32 v21, v37, v165
    v_mul_f32 v23, v53, v165
    v_fma_f32 v20, v52, v180, v20
    v_fma_f32 v22, -v36, v180, v22
    v_fma_f32 v21, v53, v181, v21
    v_fma_f32 v23, -v37, v181, v23
    v_mfma_f32_32x32x16_bf16 v[80:95], v[132:135], a[84:87], v[80:95]
    v_cvt_pk_bf16_f32 v98, v20, v21
    v_cvt_pk_bf16_f32 v114, v22, v23
    v_mul_f32 v24, v38, v166
    v_mul_f32 v26, v54, v166
    v_mul_f32 v25, v39, v167
    v_mul_f32 v27, v55, v167
    v_mfma_f32_32x32x16_bf16 v[64:79], v[136:139], a[24:27], v[64:79]
    v_fma_f32 v24, v54, v182, v24
    v_fma_f32 v26, -v38, v182, v26
    v_fma_f32 v25, v55, v183, v25
    v_fma_f32 v27, -v39, v183, v27
    v_cvt_pk_bf16_f32 v99, v24, v25
    v_cvt_pk_bf16_f32 v115, v26, v27
    v_mfma_f32_32x32x16_bf16 v[80:95], v[152:155], a[24:27], v[80:95]
    v_mul_f32 v20, v40, v168
    v_mul_f32 v22, v56, v168
    v_mul_f32 v21, v41, v169
    v_mul_f32 v23, v57, v169
    v_fma_f32 v20, v56, v184, v20
    v_mfma_f32_32x32x16_bf16 v[64:79], v[152:155], a[56:59], v[64:79]
    v_fma_f32 v22, -v40, v184, v22
    v_fma_f32 v21, v57, v185, v21
    v_fma_f32 v23, -v41, v185, v23
    v_cvt_pk_bf16_f32 v100, v20, v21
    v_cvt_pk_bf16_f32 v116, v22, v23
    v_mul_f32 v24, v42, v170
    v_mfma_f32_32x32x16_bf16 v[80:95], v[136:139], a[88:91], v[80:95]
    v_mul_f32 v26, v58, v170
    v_mul_f32 v25, v43, v171
    v_mul_f32 v27, v59, v171
    v_fma_f32 v24, v58, v186, v24
    v_fma_f32 v26, -v42, v186, v26
    v_fma_f32 v25, v59, v187, v25
    v_mfma_f32_32x32x16_bf16 v[64:79], v[140:143], a[28:31], v[64:79]
    v_fma_f32 v27, -v43, v187, v27
    v_cvt_pk_bf16_f32 v101, v24, v25
    v_cvt_pk_bf16_f32 v117, v26, v27
    v_mul_f32 v20, v44, v172
    v_mul_f32 v22, v60, v172
    v_mfma_f32_32x32x16_bf16 v[80:95], v[156:159], a[28:31], v[80:95]
    v_mul_f32 v21, v45, v173
    v_mul_f32 v23, v61, v173
    v_fma_f32 v20, v60, v188, v20
    v_fma_f32 v22, -v44, v188, v22
    v_fma_f32 v21, v61, v189, v21
    v_fma_f32 v23, -v45, v189, v23
    v_mfma_f32_32x32x16_bf16 v[64:79], v[156:159], a[60:63], v[64:79]
    v_cvt_pk_bf16_f32 v102, v20, v21
    v_cvt_pk_bf16_f32 v118, v22, v23
    v_mul_f32 v24, v46, v174
    v_mul_f32 v26, v62, v174
    v_mul_f32 v25, v47, v175
    v_mul_f32 v27, v63, v175
    v_mfma_f32_32x32x16_bf16 v[80:95], v[140:143], a[92:95], v[80:95]
    v_fma_f32 v24, v62, v190, v24
    v_fma_f32 v26, -v46, v190, v26
    v_fma_f32 v25, v63, v191, v25
    v_fma_f32 v27, -v47, v191, v27
    v_cvt_pk_bf16_f32 v103, v24, v25
    v_cvt_pk_bf16_f32 v119, v26, v27
    v_mfma_f32_32x32x16_bf16 v[32:47], a[96:99], v[96:99], 0
    buffer_load_dwordx4 v[128:131], v15, s[4:7], s32 offen offset:0
    v_mfma_f32_32x32x16_bf16 v[48:63], a[96:99], v[112:115], 0
    buffer_load_dwordx4 v[132:135], v15, s[4:7], s32 offen offset:32
    v_mfma_f32_32x32x16_bf16 v[32:47], a[104:107], v[112:115], v[32:47]
    s_add_u32 s17, s32, 69632
    buffer_load_dwordx4 v[136:139], v15, s[4:7], s17 offen offset:0
    v_mul_f32 v20, v64, v192
    v_mul_f32 v22, v80, v192
    v_mul_f32 v21, v65, v193
    v_mul_f32 v23, v81, v193
    v_fma_f32 v20, v80, v208, v20
    v_fma_f32 v22, -v64, v208, v22
    v_fma_f32 v21, v81, v209, v21
    v_fma_f32 v23, -v65, v209, v23
    v_cvt_pk_bf16_f32 v104, v20, v21
    v_cvt_pk_bf16_f32 v120, v22, v23
    v_mul_f32 v24, v66, v194
    v_mul_f32 v26, v82, v194
    v_mul_f32 v25, v67, v195
    v_mfma_f32_32x32x16_bf16 v[48:63], a[112:115], v[96:99], v[48:63]
    buffer_load_dwordx4 v[140:143], v15, s[4:7], s17 offen offset:32
    v_mul_f32 v27, v83, v195
    v_fma_f32 v24, v82, v210, v24
    v_fma_f32 v26, -v66, v210, v26
    v_fma_f32 v25, v83, v211, v25
    v_fma_f32 v27, -v67, v211, v27
    v_cvt_pk_bf16_f32 v105, v24, v25
    v_cvt_pk_bf16_f32 v121, v26, v27
    v_mul_f32 v20, v68, v196
    v_mul_f32 v22, v84, v196
    v_mul_f32 v21, v69, v197
    v_mul_f32 v23, v85, v197
    v_fma_f32 v20, v84, v212, v20
    v_fma_f32 v22, -v68, v212, v22
    v_mfma_f32_32x32x16_bf16 v[32:47], a[100:103], v[100:103], v[32:47]
    buffer_load_dwordx4 v[144:147], v15, s[4:7], s33 offen offset:0
    v_fma_f32 v21, v85, v213, v21
    v_fma_f32 v23, -v69, v213, v23
    v_cvt_pk_bf16_f32 v106, v20, v21
    v_cvt_pk_bf16_f32 v122, v22, v23
    v_mul_f32 v24, v70, v198
    v_mul_f32 v26, v86, v198
    v_mul_f32 v25, v71, v199
    v_mul_f32 v27, v87, v199
    v_fma_f32 v24, v86, v214, v24
    v_fma_f32 v26, -v70, v214, v26
    v_fma_f32 v25, v87, v215, v25
    v_fma_f32 v27, -v71, v215, v27
    v_cvt_pk_bf16_f32 v107, v24, v25
    v_cvt_pk_bf16_f32 v123, v26, v27
    v_mfma_f32_32x32x16_bf16 v[48:63], a[100:103], v[116:119], v[48:63]
    buffer_load_dwordx4 v[148:151], v15, s[4:7], s33 offen offset:32
    v_mul_f32 v20, v72, v200
    v_mul_f32 v22, v88, v200
    v_mul_f32 v21, v73, v201
    v_mul_f32 v23, v89, v201
    v_fma_f32 v20, v88, v216, v20
    v_fma_f32 v22, -v72, v216, v22
    v_fma_f32 v21, v89, v217, v21
    v_fma_f32 v23, -v73, v217, v23
    v_cvt_pk_bf16_f32 v108, v20, v21
    v_cvt_pk_bf16_f32 v124, v22, v23
    v_mul_f32 v24, v74, v202
    v_mul_f32 v26, v90, v202
    v_mul_f32 v25, v75, v203
    v_mfma_f32_32x32x16_bf16 v[32:47], a[108:111], v[116:119], v[32:47]
    s_add_u32 s17, s33, 69632
    buffer_load_dwordx4 v[152:155], v15, s[4:7], s17 offen offset:0
    v_mul_f32 v27, v91, v203
    v_fma_f32 v24, v90, v218, v24
    v_fma_f32 v26, -v74, v218, v26
    v_fma_f32 v25, v91, v219, v25
    v_fma_f32 v27, -v75, v219, v27
    v_cvt_pk_bf16_f32 v109, v24, v25
    v_cvt_pk_bf16_f32 v125, v26, v27
    v_mul_f32 v20, v76, v204
    v_mul_f32 v22, v92, v204
    v_mul_f32 v21, v77, v205
    v_mul_f32 v23, v93, v205
    v_fma_f32 v20, v92, v220, v20
    v_fma_f32 v22, -v76, v220, v22
    v_mfma_f32_32x32x16_bf16 v[48:63], a[116:119], v[100:103], v[48:63]
    buffer_load_dwordx4 v[156:159], v15, s[4:7], s17 offen offset:32
    s_nop 1
    ds_read_b128 v[96:99], v19 offset:0
    ds_read_b128 v[112:115], v19 offset:1024
    ds_read_b128 v[100:103], v19 offset:2048
    ds_read_b128 v[116:119], v19 offset:3072
    v_fma_f32 v21, v93, v221, v21
    v_fma_f32 v23, -v77, v221, v23
    v_cvt_pk_bf16_f32 v110, v20, v21
    v_cvt_pk_bf16_f32 v126, v22, v23
    v_mul_f32 v24, v78, v206
    v_mul_f32 v26, v94, v206
    v_mul_f32 v25, v79, v207
    v_mul_f32 v27, v95, v207
    v_fma_f32 v24, v94, v222, v24
    v_fma_f32 v26, -v78, v222, v26
    v_fma_f32 v25, v95, v223, v25
    v_fma_f32 v27, -v79, v223, v27
    v_cvt_pk_bf16_f32 v111, v24, v25
    v_cvt_pk_bf16_f32 v127, v26, v27
    v_mfma_f32_32x32x16_bf16 v[64:79], a[96:99], v[104:107], 0
    v_mfma_f32_32x32x16_bf16 v[80:95], a[96:99], v[120:123], 0
    s_add_u32 s18, s34, 65664
    buffer_load_ushort a252, v12, s[48:51], s18 offen
    buffer_load_ushort v3, v12, s[52:55], s18 offen
    v_mfma_f32_32x32x16_bf16 v[64:79], a[104:107], v[120:123], v[64:79]
    s_waitcnt lgkmcnt(0)
    v_lshlrev_b32 v28, 16, v96
    v_and_b32 v30, s38, v96
    v_lshlrev_b32 v29, 16, v112
    v_and_b32 v31, s38, v112
    v_mul_f32 v20, v32, v28
    v_mul_f32 v22, v48, v28
    v_mul_f32 v21, v33, v29
    v_mul_f32 v23, v49, v29
    v_fma_f32 v20, -v48, v30, v20
    v_fma_f32 v22, v32, v30, v22
    v_fma_f32 v21, -v49, v31, v21
    v_fma_f32 v23, v33, v31, v23
    v_cvt_pk_bf16_f32 v96, v20, v21
    v_cvt_pk_bf16_f32 v112, v22, v23
    v_lshlrev_b32 v28, 16, v97
    v_and_b32 v30, s38, v97
    v_lshlrev_b32 v29, 16, v113
    v_mfma_f32_32x32x16_bf16 v[80:95], a[112:115], v[104:107], v[80:95]
    v_and_b32 v31, s38, v113
    v_mul_f32 v24, v34, v28
    v_mul_f32 v26, v50, v28
    v_mul_f32 v25, v35, v29
    v_mul_f32 v27, v51, v29
    v_fma_f32 v24, -v50, v30, v24
    v_fma_f32 v26, v34, v30, v26
    v_fma_f32 v25, -v51, v31, v25
    v_fma_f32 v27, v35, v31, v27
    v_cvt_pk_bf16_f32 v97, v24, v25
    v_cvt_pk_bf16_f32 v113, v26, v27
    v_lshlrev_b32 v28, 16, v98
    v_and_b32 v30, s38, v98
    v_lshlrev_b32 v29, 16, v114
    v_and_b32 v31, s38, v114
    v_mul_f32 v20, v36, v28
    v_mul_f32 v22, v52, v28
    v_mul_f32 v21, v37, v29
    v_mul_f32 v23, v53, v29
    v_mfma_f32_32x32x16_bf16 v[64:79], a[100:103], v[108:111], v[64:79]
    v_fma_f32 v20, -v52, v30, v20
    v_fma_f32 v22, v36, v30, v22
    v_fma_f32 v21, -v53, v31, v21
    v_fma_f32 v23, v37, v31, v23
    v_cvt_pk_bf16_f32 v98, v20, v21
    v_cvt_pk_bf16_f32 v114, v22, v23
    v_lshlrev_b32 v28, 16, v99
    v_and_b32 v30, s38, v99
    v_lshlrev_b32 v29, 16, v115
    v_and_b32 v31, s38, v115
    v_mul_f32 v24, v38, v28
    v_mul_f32 v26, v54, v28
    v_mul_f32 v25, v39, v29
    v_mul_f32 v27, v55, v29
    v_fma_f32 v24, -v54, v30, v24
    v_fma_f32 v26, v38, v30, v26
    v_fma_f32 v25, -v55, v31, v25
    v_fma_f32 v27, v39, v31, v27
    v_cvt_pk_bf16_f32 v99, v24, v25
    v_mfma_f32_32x32x16_bf16 v[80:95], a[100:103], v[124:127], v[80:95]
    v_cvt_pk_bf16_f32 v115, v26, v27
    v_lshlrev_b32 v28, 16, v100
    v_and_b32 v30, s38, v100
    v_lshlrev_b32 v29, 16, v116
    v_and_b32 v31, s38, v116
    v_mul_f32 v20, v40, v28
    v_mul_f32 v22, v56, v28
    v_mul_f32 v21, v41, v29
    v_mul_f32 v23, v57, v29
    v_fma_f32 v20, -v56, v30, v20
    v_fma_f32 v22, v40, v30, v22
    v_fma_f32 v21, -v57, v31, v21
    v_fma_f32 v23, v41, v31, v23
    v_cvt_pk_bf16_f32 v100, v20, v21
    v_cvt_pk_bf16_f32 v116, v22, v23
    v_lshlrev_b32 v28, 16, v101
    v_and_b32 v30, s38, v101
    v_lshlrev_b32 v29, 16, v117
    v_and_b32 v31, s38, v117
    v_mfma_f32_32x32x16_bf16 v[64:79], a[108:111], v[124:127], v[64:79]
    v_mul_f32 v24, v42, v28
    v_mul_f32 v26, v58, v28
    v_mul_f32 v25, v43, v29
    v_mul_f32 v27, v59, v29
    v_fma_f32 v24, -v58, v30, v24
    v_fma_f32 v26, v42, v30, v26
    v_fma_f32 v25, -v59, v31, v25
    v_fma_f32 v27, v43, v31, v27
    v_cvt_pk_bf16_f32 v101, v24, v25
    v_cvt_pk_bf16_f32 v117, v26, v27
    v_lshlrev_b32 v28, 16, v102
    v_and_b32 v30, s38, v102
    v_lshlrev_b32 v29, 16, v118
    v_and_b32 v31, s38, v118
    v_mul_f32 v20, v44, v28
    v_mul_f32 v22, v60, v28
    v_mul_f32 v21, v45, v29
    v_mul_f32 v23, v61, v29
    v_fma_f32 v20, -v60, v30, v20
    v_mfma_f32_32x32x16_bf16 v[80:95], a[116:119], v[108:111], v[80:95]
    s_nop 1
    ds_read_b128 v[104:107], v19 offset:4096
    ds_read_b128 v[120:123], v19 offset:5120
    ds_read_b128 v[108:111], v19 offset:6144
    ds_read_b128 v[124:127], v19 offset:7168
    v_fma_f32 v22, v44, v30, v22
    v_fma_f32 v21, -v61, v31, v21
    v_fma_f32 v23, v45, v31, v23
    v_cvt_pk_bf16_f32 v102, v20, v21
    v_cvt_pk_bf16_f32 v118, v22, v23
    v_lshlrev_b32 v28, 16, v103
    v_and_b32 v30, s38, v103
    v_lshlrev_b32 v29, 16, v119
    v_and_b32 v31, s38, v119
    v_mul_f32 v24, v46, v28
    v_mul_f32 v26, v62, v28
    v_mul_f32 v25, v47, v29
    v_mul_f32 v27, v63, v29
    v_fma_f32 v24, -v62, v30, v24
    v_fma_f32 v26, v46, v30, v26
    v_fma_f32 v25, -v63, v31, v25
    v_fma_f32 v27, v47, v31, v27
    v_cvt_pk_bf16_f32 v103, v24, v25
    v_cvt_pk_bf16_f32 v119, v26, v27
    v_mfma_f32_32x32x16_bf16 v[32:47], v[96:99], a[96:99], 0
    v_mfma_f32_32x32x16_bf16 v[48:63], v[112:115], a[96:99], 0
    s_add_u32 s18, s34, 131328
    buffer_load_ushort a249, v12, s[48:51], s18 offen
    buffer_load_ushort v4, v12, s[52:55], s18 offen
    v_mfma_f32_32x32x16_bf16 v[32:47], v[112:115], a[112:115], v[32:47]
    s_waitcnt lgkmcnt(0)
    v_lshlrev_b32 v28, 16, v104
    v_and_b32 v30, s38, v104
    v_lshlrev_b32 v29, 16, v120
    v_and_b32 v31, s38, v120
    v_mul_f32 v20, v64, v28
    v_mul_f32 v22, v80, v28
    v_mul_f32 v21, v65, v29
    v_mul_f32 v23, v81, v29
    v_fma_f32 v20, -v80, v30, v20
    v_fma_f32 v22, v64, v30, v22
    v_fma_f32 v21, -v81, v31, v21
    v_fma_f32 v23, v65, v31, v23
    v_cvt_pk_bf16_f32 v104, v20, v21
    v_cvt_pk_bf16_f32 v120, v22, v23
    v_lshlrev_b32 v28, 16, v105
    v_and_b32 v30, s38, v105
    v_lshlrev_b32 v29, 16, v121
    v_mfma_f32_32x32x16_bf16 v[48:63], v[96:99], a[104:107], v[48:63]
    v_and_b32 v31, s38, v121
    v_mul_f32 v24, v66, v28
    v_mul_f32 v26, v82, v28
    v_mul_f32 v25, v67, v29
    v_mul_f32 v27, v83, v29
    v_fma_f32 v24, -v82, v30, v24
    v_fma_f32 v26, v66, v30, v26
    v_fma_f32 v25, -v83, v31, v25
    v_fma_f32 v27, v67, v31, v27
    v_cvt_pk_bf16_f32 v105, v24, v25
    v_cvt_pk_bf16_f32 v121, v26, v27
    v_lshlrev_b32 v28, 16, v106
    v_and_b32 v30, s38, v106
    v_lshlrev_b32 v29, 16, v122
    v_and_b32 v31, s38, v122
    v_mul_f32 v20, v68, v28
    v_mul_f32 v22, v84, v28
    v_mul_f32 v21, v69, v29
    v_mul_f32 v23, v85, v29
    v_mfma_f32_32x32x16_bf16 v[32:47], v[100:103], a[100:103], v[32:47]
    v_fma_f32 v20, -v84, v30, v20
    v_fma_f32 v22, v68, v30, v22
    v_fma_f32 v21, -v85, v31, v21
    v_fma_f32 v23, v69, v31, v23
    v_cvt_pk_bf16_f32 v106, v20, v21
    v_cvt_pk_bf16_f32 v122, v22, v23
    v_lshlrev_b32 v28, 16, v107
    v_and_b32 v30, s38, v107
    v_lshlrev_b32 v29, 16, v123
    v_and_b32 v31, s38, v123
    v_mul_f32 v24, v70, v28
    v_mul_f32 v26, v86, v28
    v_mul_f32 v25, v71, v29
    v_mul_f32 v27, v87, v29
    v_fma_f32 v24, -v86, v30, v24
    v_fma_f32 v26, v70, v30, v26
    v_fma_f32 v25, -v87, v31, v25
    v_fma_f32 v27, v71, v31, v27
    v_cvt_pk_bf16_f32 v107, v24, v25
    v_mfma_f32_32x32x16_bf16 v[48:63], v[116:119], a[100:103], v[48:63]
    v_cvt_pk_bf16_f32 v123, v26, v27
    v_lshlrev_b32 v28, 16, v108
    v_and_b32 v30, s38, v108
    v_lshlrev_b32 v29, 16, v124
    v_and_b32 v31, s38, v124
    v_mul_f32 v20, v72, v28
    v_mul_f32 v22, v88, v28
    v_mul_f32 v21, v73, v29
    v_mul_f32 v23, v89, v29
    v_fma_f32 v20, -v88, v30, v20
    v_fma_f32 v22, v72, v30, v22
    v_fma_f32 v21, -v89, v31, v21
    v_fma_f32 v23, v73, v31, v23
    v_cvt_pk_bf16_f32 v108, v20, v21
    v_cvt_pk_bf16_f32 v124, v22, v23
    v_lshlrev_b32 v28, 16, v109
    v_and_b32 v30, s38, v109
    v_lshlrev_b32 v29, 16, v125
    v_and_b32 v31, s38, v125
    v_mfma_f32_32x32x16_bf16 v[32:47], v[116:119], a[116:119], v[32:47]
    v_mul_f32 v24, v74, v28
    v_mul_f32 v26, v90, v28
    v_mul_f32 v25, v75, v29
    v_mul_f32 v27, v91, v29
    v_fma_f32 v24, -v90, v30, v24
    v_fma_f32 v26, v74, v30, v26
    v_fma_f32 v25, -v91, v31, v25
    v_fma_f32 v27, v75, v31, v27
    v_cvt_pk_bf16_f32 v109, v24, v25
    v_cvt_pk_bf16_f32 v125, v26, v27
    v_lshlrev_b32 v28, 16, v110
    v_and_b32 v30, s38, v110
    v_lshlrev_b32 v29, 16, v126
    v_and_b32 v31, s38, v126
    v_mul_f32 v20, v76, v28
    v_mul_f32 v22, v92, v28
    v_mul_f32 v21, v77, v29
    v_mul_f32 v23, v93, v29
    v_fma_f32 v20, -v92, v30, v20
    v_mfma_f32_32x32x16_bf16 v[48:63], v[100:103], a[108:111], v[48:63]
    v_fma_f32 v22, v76, v30, v22
    v_fma_f32 v21, -v93, v31, v21
    v_fma_f32 v23, v77, v31, v23
    v_cvt_pk_bf16_f32 v110, v20, v21
    v_cvt_pk_bf16_f32 v126, v22, v23
    v_lshlrev_b32 v28, 16, v111
    v_and_b32 v30, s38, v111
    v_lshlrev_b32 v29, 16, v127
    v_and_b32 v31, s38, v127
    v_mul_f32 v24, v78, v28
    v_mul_f32 v26, v94, v28
    v_mul_f32 v25, v79, v29
    v_mul_f32 v27, v95, v29
    v_fma_f32 v24, -v94, v30, v24
    v_fma_f32 v26, v78, v30, v26
    v_fma_f32 v25, -v95, v31, v25
    v_fma_f32 v27, v79, v31, v27
    v_cvt_pk_bf16_f32 v111, v24, v25
    v_cvt_pk_bf16_f32 v127, v26, v27
    v_mfma_f32_32x32x16_bf16 v[64:79], v[104:107], a[96:99], 0
    v_mfma_f32_32x32x16_bf16 v[80:95], v[120:123], a[96:99], 0
    s_add_u32 s18, s34, 196992
    buffer_load_ushort a253, v12, s[48:51], s18 offen
    buffer_load_ushort v7, v12, s[52:55], s18 offen
    v_mfma_f32_32x32x16_bf16 v[64:79], v[120:123], a[112:115], v[64:79]
    v_mul_f32 v20, v32, v160
    v_mul_f32 v22, v48, v160
    v_mul_f32 v21, v33, v161
    v_mul_f32 v23, v49, v161
    v_fma_f32 v20, -v48, v176, v20
    v_fma_f32 v22, v32, v176, v22
    v_fma_f32 v21, -v49, v177, v21
    v_fma_f32 v23, v33, v177, v23
    v_cvt_pk_bf16_f32 v96, v20, v21
    v_cvt_pk_bf16_f32 v112, v22, v23
    v_mul_f32 v24, v34, v162
    v_mul_f32 v26, v50, v162
    v_mul_f32 v25, v35, v163
    v_mfma_f32_32x32x16_bf16 v[80:95], v[104:107], a[104:107], v[80:95]
    v_mul_f32 v27, v51, v163
    v_fma_f32 v24, -v50, v178, v24
    v_fma_f32 v26, v34, v178, v26
    v_fma_f32 v25, -v51, v179, v25
    v_fma_f32 v27, v35, v179, v27
    v_cvt_pk_bf16_f32 v97, v24, v25
    v_cvt_pk_bf16_f32 v113, v26, v27
    v_mul_f32 v20, v36, v164
    v_mul_f32 v22, v52, v164
    v_mul_f32 v21, v37, v165
    v_mul_f32 v23, v53, v165
    v_fma_f32 v20, -v52, v180, v20
    v_fma_f32 v22, v36, v180, v22
    v_mfma_f32_32x32x16_bf16 v[64:79], v[108:111], a[100:103], v[64:79]
    v_fma_f32 v21, -v53, v181, v21
    v_fma_f32 v23, v37, v181, v23
    v_cvt_pk_bf16_f32 v98, v20, v21
    v_cvt_pk_bf16_f32 v114, v22, v23
    v_mul_f32 v24, v38, v166
    v_mul_f32 v26, v54, v166
    v_mul_f32 v25, v39, v167
    v_mul_f32 v27, v55, v167
    v_fma_f32 v24, -v54, v182, v24
    v_fma_f32 v26, v38, v182, v26
    v_fma_f32 v25, -v55, v183, v25
    v_fma_f32 v27, v39, v183, v27
    v_cvt_pk_bf16_f32 v99, v24, v25
    v_cvt_pk_bf16_f32 v115, v26, v27
    v_mfma_f32_32x32x16_bf16 v[80:95], v[124:127], a[100:103], v[80:95]
    v_mul_f32 v20, v40, v168
    v_mul_f32 v22, v56, v168
    v_mul_f32 v21, v41, v169
    v_mul_f32 v23, v57, v169
    v_fma_f32 v20, -v56, v184, v20
    v_fma_f32 v22, v40, v184, v22
    v_fma_f32 v21, -v57, v185, v21
    v_fma_f32 v23, v41, v185, v23
    v_cvt_pk_bf16_f32 v100, v20, v21
    v_cvt_pk_bf16_f32 v116, v22, v23
    v_mul_f32 v24, v42, v170
    v_mul_f32 v26, v58, v170
    v_mul_f32 v25, v43, v171
    v_mfma_f32_32x32x16_bf16 v[64:79], v[124:127], a[116:119], v[64:79]
    v_mul_f32 v27, v59, v171
    v_fma_f32 v24, -v58, v186, v24
    v_fma_f32 v26, v42, v186, v26
    v_fma_f32 v25, -v59, v187, v25
    v_fma_f32 v27, v43, v187, v27
    v_cvt_pk_bf16_f32 v101, v24, v25
    v_cvt_pk_bf16_f32 v117, v26, v27
    v_mul_f32 v20, v44, v172
    v_mul_f32 v22, v60, v172
    v_mul_f32 v21, v45, v173
    v_mul_f32 v23, v61, v173
    v_fma_f32 v20, -v60, v188, v20
    v_fma_f32 v22, v44, v188, v22
    v_mfma_f32_32x32x16_bf16 v[80:95], v[108:111], a[108:111], v[80:95]
    v_fma_f32 v21, -v61, v189, v21
    v_fma_f32 v23, v45, v189, v23
    v_cvt_pk_bf16_f32 v102, v20, v21
    v_cvt_pk_bf16_f32 v118, v22, v23
    v_mul_f32 v24, v46, v174
    v_mul_f32 v26, v62, v174
    v_mul_f32 v25, v47, v175
    v_mul_f32 v27, v63, v175
    v_fma_f32 v24, -v62, v190, v24
    v_fma_f32 v26, v46, v190, v26
    v_fma_f32 v25, -v63, v191, v25
    v_fma_f32 v27, v47, v191, v27
    v_cvt_pk_bf16_f32 v103, v24, v25
    v_cvt_pk_bf16_f32 v119, v26, v27
    v_mfma_f32_32x32x16_bf16 v[32:47], a[0:3], v[96:99], 0
    v_mfma_f32_32x32x16_bf16 v[48:63], a[0:3], v[112:115], 0
    s_add_u32 s18, s34, 262656
    buffer_load_ushort a250, v12, s[48:51], s18 offen
    buffer_load_ushort v8, v12, s[52:55], s18 offen
    v_mfma_f32_32x32x16_bf16 v[32:47], a[64:67], v[112:115], v[32:47]
    v_mul_f32 v20, v64, v224
    v_mul_f32 v22, v80, v224
    v_mul_f32 v21, v65, v225
    v_mul_f32 v23, v81, v225
    v_fma_f32 v20, -v80, v240, v20
    v_fma_f32 v22, v64, v240, v22
    v_fma_f32 v21, -v81, v241, v21
    v_fma_f32 v23, v65, v241, v23
    v_cvt_pk_bf16_f32 v104, v20, v21
    v_cvt_pk_bf16_f32 v120, v22, v23
    v_mul_f32 v24, v66, v226
    v_mul_f32 v26, v82, v226
    v_mul_f32 v25, v67, v227
    v_mfma_f32_32x32x16_bf16 v[48:63], a[32:35], v[96:99], v[48:63]
    v_mul_f32 v27, v83, v227
    v_fma_f32 v24, -v82, v242, v24
    v_fma_f32 v26, v66, v242, v26
    v_fma_f32 v25, -v83, v243, v25
    v_fma_f32 v27, v67, v243, v27
    v_cvt_pk_bf16_f32 v105, v24, v25
    v_cvt_pk_bf16_f32 v121, v26, v27
    v_mul_f32 v20, v68, v228
    v_mul_f32 v22, v84, v228
    v_mul_f32 v21, v69, v229
    v_mul_f32 v23, v85, v229
    v_fma_f32 v20, -v84, v244, v20
    v_fma_f32 v22, v68, v244, v22
    v_mfma_f32_32x32x16_bf16 v[32:47], a[4:7], v[100:103], v[32:47]
    v_fma_f32 v21, -v85, v245, v21
    v_fma_f32 v23, v69, v245, v23
    v_cvt_pk_bf16_f32 v106, v20, v21
    v_cvt_pk_bf16_f32 v122, v22, v23
    v_mul_f32 v24, v70, v230
    v_mul_f32 v26, v86, v230
    v_mul_f32 v25, v71, v231
    v_mul_f32 v27, v87, v231
    v_fma_f32 v24, -v86, v246, v24
    v_fma_f32 v26, v70, v246, v26
    v_fma_f32 v25, -v87, v247, v25
    v_fma_f32 v27, v71, v247, v27
    v_cvt_pk_bf16_f32 v107, v24, v25
    v_cvt_pk_bf16_f32 v123, v26, v27
    v_mfma_f32_32x32x16_bf16 v[48:63], a[4:7], v[116:119], v[48:63]
    v_mul_f32 v20, v72, v232
    v_mul_f32 v22, v88, v232
    v_mul_f32 v21, v73, v233
    v_mul_f32 v23, v89, v233
    v_fma_f32 v20, -v88, v248, v20
    v_fma_f32 v22, v72, v248, v22
    v_fma_f32 v21, -v89, v249, v21
    v_fma_f32 v23, v73, v249, v23
    v_cvt_pk_bf16_f32 v108, v20, v21
    v_cvt_pk_bf16_f32 v124, v22, v23
    v_mul_f32 v24, v74, v234
    v_mul_f32 v26, v90, v234
    v_mul_f32 v25, v75, v235
    v_mfma_f32_32x32x16_bf16 v[32:47], a[68:71], v[116:119], v[32:47]
    v_mul_f32 v27, v91, v235
    v_fma_f32 v24, -v90, v250, v24
    v_fma_f32 v26, v74, v250, v26
    v_fma_f32 v25, -v91, v251, v25
    v_fma_f32 v27, v75, v251, v27
    v_cvt_pk_bf16_f32 v109, v24, v25
    v_cvt_pk_bf16_f32 v125, v26, v27
    v_mul_f32 v20, v76, v236
    v_mul_f32 v22, v92, v236
    v_mul_f32 v21, v77, v237
    v_mul_f32 v23, v93, v237
    v_fma_f32 v20, -v92, v252, v20
    v_fma_f32 v22, v76, v252, v22
    v_mfma_f32_32x32x16_bf16 v[48:63], a[36:39], v[100:103], v[48:63]
    v_fma_f32 v21, -v93, v253, v21
    v_fma_f32 v23, v77, v253, v23
    v_cvt_pk_bf16_f32 v110, v20, v21
    v_cvt_pk_bf16_f32 v126, v22, v23
    v_mul_f32 v24, v78, v238
    v_mul_f32 v26, v94, v238
    v_mul_f32 v25, v79, v239
    v_mul_f32 v27, v95, v239
    v_fma_f32 v24, -v94, v254, v24
    v_fma_f32 v26, v78, v254, v26
    v_fma_f32 v25, -v95, v255, v25
    v_fma_f32 v27, v79, v255, v27
    v_cvt_pk_bf16_f32 v111, v24, v25
    v_cvt_pk_bf16_f32 v127, v26, v27
    v_mfma_f32_32x32x16_bf16 v[32:47], a[8:11], v[104:107], v[32:47]
    s_add_u32 s18, s34, 328320
    buffer_load_ushort a254, v12, s[48:51], s18 offen
    buffer_load_ushort v10, v12, s[52:55], s18 offen
    v_mfma_f32_32x32x16_bf16 v[48:63], a[8:11], v[120:123], v[48:63]
    v_mfma_f32_32x32x16_bf16 v[32:47], a[72:75], v[120:123], v[32:47]
    v_mfma_f32_32x32x16_bf16 v[48:63], a[40:43], v[104:107], v[48:63]
    v_mfma_f32_32x32x16_bf16 v[32:47], a[12:15], v[108:111], v[32:47]
    s_add_u32 s18, s34, 393984
    buffer_load_ushort a251, v12, s[48:51], s18 offen
    buffer_load_ushort v11, v12, s[52:55], s18 offen
    v_mfma_f32_32x32x16_bf16 v[48:63], a[12:15], v[124:127], v[48:63]
    v_mfma_f32_32x32x16_bf16 v[32:47], a[76:79], v[124:127], v[32:47]
    v_mfma_f32_32x32x16_bf16 v[48:63], a[44:47], v[108:111], v[48:63]
    v_mfma_f32_32x32x16_bf16 v[64:79], a[16:19], v[96:99], 0
    s_add_u32 s18, s34, 459648
    buffer_load_ushort a255, v12, s[48:51], s18 offen
    buffer_load_ushort v16, v12, s[52:55], s18 offen
    v_mfma_f32_32x32x16_bf16 v[80:95], a[16:19], v[112:115], 0
    v_mfma_f32_32x32x16_bf16 v[64:79], a[80:83], v[112:115], v[64:79]
    s_nop 1
    v_cvt_pk_bf16_f32 v32, v32, v48
    v_mfma_f32_32x32x16_bf16 v[80:95], a[48:51], v[96:99], v[80:95]
    v_cvt_pk_bf16_f32 v33, v33, v49
    v_mfma_f32_32x32x16_bf16 v[64:79], a[20:23], v[100:103], v[64:79]
    v_cvt_pk_bf16_f32 v34, v34, v50
    v_mfma_f32_32x32x16_bf16 v[80:95], a[20:23], v[116:119], v[80:95]
    v_cvt_pk_bf16_f32 v35, v35, v51
    v_mfma_f32_32x32x16_bf16 v[64:79], a[84:87], v[116:119], v[64:79]
    v_cvt_pk_bf16_f32 v36, v36, v52
    v_mfma_f32_32x32x16_bf16 v[80:95], a[52:55], v[100:103], v[80:95]
    v_cvt_pk_bf16_f32 v37, v37, v53
    v_mfma_f32_32x32x16_bf16 v[64:79], a[24:27], v[104:107], v[64:79]
    v_cvt_pk_bf16_f32 v38, v38, v54
    v_cvt_pk_bf16_f32 v39, v39, v55
    v_mfma_f32_32x32x16_bf16 v[80:95], a[24:27], v[120:123], v[80:95]
    v_cvt_pk_bf16_f32 v40, v40, v56
    v_mfma_f32_32x32x16_bf16 v[64:79], a[88:91], v[120:123], v[64:79]
    v_cvt_pk_bf16_f32 v41, v41, v57
    v_mfma_f32_32x32x16_bf16 v[80:95], a[56:59], v[104:107], v[80:95]
    v_cvt_pk_bf16_f32 v42, v42, v58
    v_mfma_f32_32x32x16_bf16 v[64:79], a[28:31], v[108:111], v[64:79]
    v_cvt_pk_bf16_f32 v43, v43, v59
    v_mfma_f32_32x32x16_bf16 v[80:95], a[28:31], v[124:127], v[80:95]
    v_cvt_pk_bf16_f32 v44, v44, v60
    v_mfma_f32_32x32x16_bf16 v[64:79], a[92:95], v[124:127], v[64:79]
    v_cvt_pk_bf16_f32 v45, v45, v61
    v_mfma_f32_32x32x16_bf16 v[80:95], a[60:63], v[108:111], v[80:95]
    v_cvt_pk_bf16_f32 v46, v46, v62
    v_cvt_pk_bf16_f32 v47, v47, v63
    s_nop 9
    v_cvt_pk_bf16_f32 v64, v64, v80
    v_cvt_pk_bf16_f32 v65, v65, v81
    v_cvt_pk_bf16_f32 v66, v66, v82
    v_cvt_pk_bf16_f32 v67, v67, v83
    v_cvt_pk_bf16_f32 v68, v68, v84
    v_cvt_pk_bf16_f32 v69, v69, v85
    v_cvt_pk_bf16_f32 v70, v70, v86
    v_cvt_pk_bf16_f32 v71, v71, v87
    v_cvt_pk_bf16_f32 v72, v72, v88
    v_cvt_pk_bf16_f32 v73, v73, v89
    v_cvt_pk_bf16_f32 v74, v74, v90
    v_cvt_pk_bf16_f32 v75, v75, v91
    v_cvt_pk_bf16_f32 v76, v76, v92
    v_cvt_pk_bf16_f32 v77, v77, v93
    v_cvt_pk_bf16_f32 v78, v78, v94
    v_cvt_pk_bf16_f32 v79, v79, v95
    s_cmp_eq_u32 s36, 2
    s_cbranch_scc1 F2_o1
    s_cmp_eq_u32 s36, 3
    s_cbranch_scc1 F2_o2
    s_cmp_eq_u32 s36, 4
    s_cbranch_scc1 F2_o3
    s_cmp_eq_u32 s36, 5
    s_cbranch_scc1 F2_o4
    v_accvgpr_write_b32 a120, v32
    v_accvgpr_write_b32 a124, v33
    v_accvgpr_write_b32 a128, v34
    v_accvgpr_write_b32 a132, v35
    v_accvgpr_write_b32 a136, v36
    v_accvgpr_write_b32 a140, v37
    v_accvgpr_write_b32 a144, v38
    v_accvgpr_write_b32 a148, v39
    v_accvgpr_write_b32 a152, v40
    v_accvgpr_write_b32 a156, v41
    v_accvgpr_write_b32 a160, v42
    v_accvgpr_write_b32 a164, v43
    v_accvgpr_write_b32 a168, v44
    v_accvgpr_write_b32 a172, v45
    v_accvgpr_write_b32 a176, v46
    v_accvgpr_write_b32 a180, v47
    v_accvgpr_write_b32 a184, v64
    v_accvgpr_write_b32 a188, v65
    v_accvgpr_write_b32 a192, v66
    v_accvgpr_write_b32 a196, v67
    v_accvgpr_write_b32 a200, v68
    v_accvgpr_write_b32 a204, v69
    v_accvgpr_write_b32 a208, v70
    v_accvgpr_write_b32 a212, v71
    v_accvgpr_write_b32 a216, v72
    v_accvgpr_write_b32 a220, v73
    v_accvgpr_write_b32 a224, v74
    v_accvgpr_write_b32 a228, v75
    v_accvgpr_write_b32 a232, v76
    v_accvgpr_write_b32 a236, v77
    v_accvgpr_write_b32 a240, v78
    v_accvgpr_write_b32 a244, v79
    s_branch F2_nx
F2_o1:
    v_accvgpr_write_b32 a121, v32
    v_accvgpr_write_b32 a125, v33
    v_accvgpr_write_b32 a129, v34
    v_accvgpr_write_b32 a133, v35
    v_accvgpr_write_b32 a137, v36
    v_accvgpr_write_b32 a141, v37
    v_accvgpr_write_b32 a145, v38
    v_accvgpr_write_b32 a149, v39
    v_accvgpr_write_b32 a153, v40
    v_accvgpr_write_b32 a157, v41
    v_accvgpr_write_b32 a161, v42
    v_accvgpr_write_b32 a165, v43
    v_accvgpr_write_b32 a169, v44
    v_accvgpr_write_b32 a173, v45
    v_accvgpr_write_b32 a177, v46
    v_accvgpr_write_b32 a181, v47
    v_accvgpr_write_b32 a185, v64
    v_accvgpr_write_b32 a189, v65
    v_accvgpr_write_b32 a193, v66
    v_accvgpr_write_b32 a197, v67
    v_accvgpr_write_b32 a201, v68
    v_accvgpr_write_b32 a205, v69
    v_accvgpr_write_b32 a209, v70
    v_accvgpr_write_b32 a213, v71
    v_accvgpr_write_b32 a217, v72
    v_accvgpr_write_b32 a221, v73
    v_accvgpr_write_b32 a225, v74
    v_accvgpr_write_b32 a229, v75
    v_accvgpr_write_b32 a233, v76
    v_accvgpr_write_b32 a237, v77
    v_accvgpr_write_b32 a241, v78
    v_accvgpr_write_b32 a245, v79
    s_branch F2_nx
F2_o2:
    v_accvgpr_write_b32 a122, v32
    v_accvgpr_write_b32 a126, v33
    v_accvgpr_write_b32 a130, v34
    v_accvgpr_write_b32 a134, v35
    v_accvgpr_write_b32 a138, v36
    v_accvgpr_write_b32 a142, v37
    v_accvgpr_write_b32 a146, v38
    v_accvgpr_write_b32 a150, v39
    v_accvgpr_write_b32 a154, v40
    v_accvgpr_write_b32 a158, v41
    v_accvgpr_write_b32 a162, v42
    v_accvgpr_write_b32 a166, v43
    v_accvgpr_write_b32 a170, v44
    v_accvgpr_write_b32 a174, v45
    v_accvgpr_write_b32 a178, v46
    v_accvgpr_write_b32 a182, v47
    v_accvgpr_write_b32 a186, v64
    v_accvgpr_write_b32 a190, v65
    v_accvgpr_write_b32 a194, v66
    v_accvgpr_write_b32 a198, v67
    v_accvgpr_write_b32 a202, v68
    v_accvgpr_write_b32 a206, v69
    v_accvgpr_write_b32 a210, v70
    v_accvgpr_write_b32 a214, v71
    v_accvgpr_write_b32 a218, v72
    v_accvgpr_write_b32 a222, v73
    v_accvgpr_write_b32 a226, v74
    v_accvgpr_write_b32 a230, v75
    v_accvgpr_write_b32 a234, v76
    v_accvgpr_write_b32 a238, v77
    v_accvgpr_write_b32 a242, v78
    v_accvgpr_write_b32 a246, v79
    s_branch F2_nx
F2_o3:
    v_accvgpr_write_b32 a123, v32
    v_accvgpr_write_b32 a127, v33
    v_accvgpr_write_b32 a131, v34
    v_accvgpr_write_b32 a135, v35
    v_accvgpr_write_b32 a139, v36
    v_accvgpr_write_b32 a143, v37
    v_accvgpr_write_b32 a147, v38
    v_accvgpr_write_b32 a151, v39
    v_accvgpr_write_b32 a155, v40
    v_accvgpr_write_b32 a159, v41
    v_accvgpr_write_b32 a163, v42
    v_accvgpr_write_b32 a167, v43
    v_accvgpr_write_b32 a171, v44
    v_accvgpr_write_b32 a175, v45
    v_accvgpr_write_b32 a179, v46
    v_accvgpr_write_b32 a183, v47
    v_accvgpr_write_b32 a187, v64
    v_accvgpr_write_b32 a191, v65
    v_accvgpr_write_b32 a195, v66
    v_accvgpr_write_b32 a199, v67
    v_accvgpr_write_b32 a203, v68
    v_accvgpr_write_b32 a207, v69
    v_accvgpr_write_b32 a211, v70
    v_accvgpr_write_b32 a215, v71
    v_accvgpr_write_b32 a219, v72
    v_accvgpr_write_b32 a223, v73
    v_accvgpr_write_b32 a227, v74
    v_accvgpr_write_b32 a231, v75
    v_accvgpr_write_b32 a235, v76
    v_accvgpr_write_b32 a239, v77
    v_accvgpr_write_b32 a243, v78
    v_accvgpr_write_b32 a247, v79
    s_branch F2_nx
F2_o4:
    v_accvgpr_read_b32 v5, a120
    v_lshlrev_b32 v6, 16, v32
    v_bfi_b32 v5, s38, v6, v5
    v_accvgpr_write_b32 a120, v5
    v_accvgpr_read_b32 v5, a124
    v_lshlrev_b32 v6, 16, v33
    v_bfi_b32 v5, s38, v6, v5
    v_accvgpr_write_b32 a124, v5
    v_accvgpr_read_b32 v5, a128
    v_lshlrev_b32 v6, 16, v34
    v_bfi_b32 v5, s38, v6, v5
    v_accvgpr_write_b32 a128, v5
    v_accvgpr_read_b32 v5, a132
    v_lshlrev_b32 v6, 16, v35
    v_bfi_b32 v5, s38, v6, v5
    v_accvgpr_write_b32 a132, v5
    v_accvgpr_read_b32 v5, a136
    v_lshlrev_b32 v6, 16, v36
    v_bfi_b32 v5, s38, v6, v5
    v_accvgpr_write_b32 a136, v5
    v_accvgpr_read_b32 v5, a140
    v_lshlrev_b32 v6, 16, v37
    v_bfi_b32 v5, s38, v6, v5
    v_accvgpr_write_b32 a140, v5
    v_accvgpr_read_b32 v5, a144
    v_lshlrev_b32 v6, 16, v38
    v_bfi_b32 v5, s38, v6, v5
    v_accvgpr_write_b32 a144, v5
    v_accvgpr_read_b32 v5, a148
    v_lshlrev_b32 v6, 16, v39
    v_bfi_b32 v5, s38, v6, v5
    v_accvgpr_write_b32 a148, v5
    v_accvgpr_read_b32 v5, a152
    v_lshlrev_b32 v6, 16, v40
    v_bfi_b32 v5, s38, v6, v5
    v_accvgpr_write_b32 a152, v5
    v_accvgpr_read_b32 v5, a156
    v_lshlrev_b32 v6, 16, v41
    v_bfi_b32 v5, s38, v6, v5
    v_accvgpr_write_b32 a156, v5
    v_accvgpr_read_b32 v5, a160
    v_lshlrev_b32 v6, 16, v42
    v_bfi_b32 v5, s38, v6, v5
    v_accvgpr_write_b32 a160, v5
    v_accvgpr_read_b32 v5, a164
    v_lshlrev_b32 v6, 16, v43
    v_bfi_b32 v5, s38, v6, v5
    v_accvgpr_write_b32 a164, v5
    v_accvgpr_read_b32 v5, a168
    v_lshlrev_b32 v6, 16, v44
    v_bfi_b32 v5, s38, v6, v5
    v_accvgpr_write_b32 a168, v5
    v_accvgpr_read_b32 v5, a172
    v_lshlrev_b32 v6, 16, v45
    v_bfi_b32 v5, s38, v6, v5
    v_accvgpr_write_b32 a172, v5
    v_accvgpr_read_b32 v5, a176
    v_lshlrev_b32 v6, 16, v46
    v_bfi_b32 v5, s38, v6, v5
    v_accvgpr_write_b32 a176, v5
    v_accvgpr_read_b32 v5, a180
    v_lshlrev_b32 v6, 16, v47
    v_bfi_b32 v5, s38, v6, v5
    v_accvgpr_write_b32 a180, v5
    v_accvgpr_read_b32 v5, a184
    v_lshlrev_b32 v6, 16, v64
    v_bfi_b32 v5, s38, v6, v5
    v_accvgpr_write_b32 a184, v5
    v_accvgpr_read_b32 v5, a188
    v_lshlrev_b32 v6, 16, v65
    v_bfi_b32 v5, s38, v6, v5
    v_accvgpr_write_b32 a188, v5
    v_accvgpr_read_b32 v5, a192
    v_lshlrev_b32 v6, 16, v66
    v_bfi_b32 v5, s38, v6, v5
    v_accvgpr_write_b32 a192, v5
    v_accvgpr_read_b32 v5, a196
    v_lshlrev_b32 v6, 16, v67
    v_bfi_b32 v5, s38, v6, v5
    v_accvgpr_write_b32 a196, v5
    v_accvgpr_read_b32 v5, a200
    v_lshlrev_b32 v6, 16, v68
    v_bfi_b32 v5, s38, v6, v5
    v_accvgpr_write_b32 a200, v5
    v_accvgpr_read_b32 v5, a204
    v_lshlrev_b32 v6, 16, v69
    v_bfi_b32 v5, s38, v6, v5
    v_accvgpr_write_b32 a204, v5
    v_accvgpr_read_b32 v5, a208
    v_lshlrev_b32 v6, 16, v70
    v_bfi_b32 v5, s38, v6, v5
    v_accvgpr_write_b32 a208, v5
    v_accvgpr_read_b32 v5, a212
    v_lshlrev_b32 v6, 16, v71
    v_bfi_b32 v5, s38, v6, v5
    v_accvgpr_write_b32 a212, v5
    v_accvgpr_read_b32 v5, a216
    v_lshlrev_b32 v6, 16, v72
    v_bfi_b32 v5, s38, v6, v5
    v_accvgpr_write_b32 a216, v5
    v_accvgpr_read_b32 v5, a220
    v_lshlrev_b32 v6, 16, v73
    v_bfi_b32 v5, s38, v6, v5
    v_accvgpr_write_b32 a220, v5
    v_accvgpr_read_b32 v5, a224
    v_lshlrev_b32 v6, 16, v74
    v_bfi_b32 v5, s38, v6, v5
    v_accvgpr_write_b32 a224, v5
    v_accvgpr_read_b32 v5, a228
    v_lshlrev_b32 v6, 16, v75
    v_bfi_b32 v5, s38, v6, v5
    v_accvgpr_write_b32 a228, v5
    v_accvgpr_read_b32 v5, a232
    v_lshlrev_b32 v6, 16, v76
    v_bfi_b32 v5, s38, v6, v5
    v_accvgpr_write_b32 a232, v5
    v_accvgpr_read_b32 v5, a236
    v_lshlrev_b32 v6, 16, v77
    v_bfi_b32 v5, s38, v6, v5
    v_accvgpr_write_b32 a236, v5
    v_accvgpr_read_b32 v5, a240
    v_lshlrev_b32 v6, 16, v78
    v_bfi_b32 v5, s38, v6, v5
    v_accvgpr_write_b32 a240, v5
    v_accvgpr_read_b32 v5, a244
    v_lshlrev_b32 v6, 16, v79
    v_bfi_b32 v5, s38, v6, v5
    v_accvgpr_write_b32 a244, v5
F2_nx:
    s_add_u32 s35, s35, 8192
    s_bitcmp1_b32 s36, 0
    s_cselect_b32 s17, 0, 2068416
    s_add_u32 s34, s34, 1050624
    s_sub_u32 s34, s34, s17
    s_cmp_eq_u32 s36, 4
    s_cselect_b32 s35, 133120, s35
    s_cselect_b32 s34, 1073741824, s34
    s_cmp_lt_u32 s36, s37
    s_cbranch_scc1 F2_top
    s_mul_i32 s21, s31, 33024
    s_add_u32 s21, s21, 111149056
    s_add_u32 s17, s21, 0
    buffer_store_dwordx4 a[120:123], v18, s[4:7], s17 offen offset:0 sc1
    buffer_store_dwordx4 a[124:127], v18, s[4:7], s17 offen offset:512 sc1
    buffer_store_dwordx4 a[128:131], v18, s[4:7], s17 offen offset:1024 sc1
    buffer_store_dwordx4 a[132:135], v18, s[4:7], s17 offen offset:1536 sc1
    buffer_store_dwordx4 a[136:139], v18, s[4:7], s17 offen offset:2048 sc1
    buffer_store_dwordx4 a[140:143], v18, s[4:7], s17 offen offset:2560 sc1
    buffer_store_dwordx4 a[144:147], v18, s[4:7], s17 offen offset:3072 sc1
    buffer_store_dwordx4 a[148:151], v18, s[4:7], s17 offen offset:3584 sc1
    s_add_u32 s17, s21, 8192
    buffer_store_dwordx4 a[152:155], v18, s[4:7], s17 offen offset:0 sc1
    buffer_store_dwordx4 a[156:159], v18, s[4:7], s17 offen offset:512 sc1
    buffer_store_dwordx4 a[160:163], v18, s[4:7], s17 offen offset:1024 sc1
    buffer_store_dwordx4 a[164:167], v18, s[4:7], s17 offen offset:1536 sc1
    buffer_store_dwordx4 a[168:171], v18, s[4:7], s17 offen offset:2048 sc1
    buffer_store_dwordx4 a[172:175], v18, s[4:7], s17 offen offset:2560 sc1
    buffer_store_dwordx4 a[176:179], v18, s[4:7], s17 offen offset:3072 sc1
    buffer_store_dwordx4 a[180:183], v18, s[4:7], s17 offen offset:3584 sc1
    s_add_u32 s17, s21, 16384
    buffer_store_dwordx4 a[184:187], v18, s[4:7], s17 offen offset:0 sc1
    buffer_store_dwordx4 a[188:191], v18, s[4:7], s17 offen offset:512 sc1
    buffer_store_dwordx4 a[192:195], v18, s[4:7], s17 offen offset:1024 sc1
    buffer_store_dwordx4 a[196:199], v18, s[4:7], s17 offen offset:1536 sc1
    buffer_store_dwordx4 a[200:203], v18, s[4:7], s17 offen offset:2048 sc1
    buffer_store_dwordx4 a[204:207], v18, s[4:7], s17 offen offset:2560 sc1
    buffer_store_dwordx4 a[208:211], v18, s[4:7], s17 offen offset:3072 sc1
    buffer_store_dwordx4 a[212:215], v18, s[4:7], s17 offen offset:3584 sc1
    s_add_u32 s17, s21, 24576
    buffer_store_dwordx4 a[216:219], v18, s[4:7], s17 offen offset:0 sc1
    buffer_store_dwordx4 a[220:223], v18, s[4:7], s17 offen offset:512 sc1
    buffer_store_dwordx4 a[224:227], v18, s[4:7], s17 offen offset:1024 sc1
    buffer_store_dwordx4 a[228:231], v18, s[4:7], s17 offen offset:1536 sc1
    buffer_store_dwordx4 a[232:235], v18, s[4:7], s17 offen offset:2048 sc1
    buffer_store_dwordx4 a[236:239], v18, s[4:7], s17 offen offset:2560 sc1
    buffer_store_dwordx4 a[240:243], v18, s[4:7], s17 offen offset:3072 sc1
    buffer_store_dwordx4 a[244:247], v18, s[4:7], s17 offen offset:3584 sc1
    s_waitcnt vmcnt(0)
    s_lshl_b32 s17, s31, 7
    s_add_u32 s17, s17, 100761600
    v_lshl_add_u32 v5, v1, 2, s17
    v_mov_b32 v6, 1
    s_mov_b64 exec, 0xffffffff
    buffer_store_dword v6, v5, s[4:7], 0 offen sc1
    s_mov_b64 exec, -1
    v_bfe_u32 v5, v1, 2, 2
    v_and_b32 v7, 3, v1
    v_lshl_add_u32 v7, v5, 3, v7
    s_lshl_b32 s17, s29, 5
    v_add_u32 v7, s17, v7
    v_lshrrev_b32 v8, 4, v1
    v_cvt_f32_u32 v8, v8
    s_mov_b32 s31, 981467136
    v_and_b32 v38, 1, v7
    v_add_u32 v5, 0, v7
    v_cvt_f32_u32 v6, v5
    v_mul_f32 v6, s31, v6
    v_mov_b32 v32, 0x3e800000
    v_sub_f32 v34, v6, v32
    v_mul_f32 v36, 0x41800000, v6
    v_mul_f32 v5, 4.0, v6
    v_mul_f32 v30, v5, v8
    v_add_u32 v5, 4, v7
    v_cvt_f32_u32 v6, v5
    v_mul_f32 v6, s31, v6
    v_mov_b32 v33, 0x3e800000
    v_sub_f32 v35, v6, v33
    v_mul_f32 v37, 0x41800000, v6
    v_mul_f32 v5, 4.0, v6
    v_mul_f32 v31, v5, v8
    v_lshlrev_b32 v40, 4, v38
    v_bfe_u32 v5, v7, 1, 1
    v_add_u32 v6, 1, v7
    v_bfe_u32 v6, v6, 1, 1
    v_lshlrev_b32 v5, 15, v5
    v_lshl_or_b32 v41, v6, 31, v5
    v_fract_f32 v48, v30
    v_add_f32 v49, v48, v32
    v_cos_f32 v56, v48
    v_add_f32 v50, v49, v34
    v_cos_f32 v57, v49
    v_add_f32 v51, v50, v32
    v_cos_f32 v58, v50
    v_add_f32 v52, v51, v34
    v_cos_f32 v59, v51
    v_add_f32 v53, v52, v32
    v_cos_f32 v60, v52
    v_add_f32 v54, v53, v34
    v_cos_f32 v61, v53
    v_add_f32 v55, v54, v32
    v_cos_f32 v62, v54
    v_cos_f32 v63, v55
    v_add_f32 v30, v48, v36
    v_cvt_pk_bf16_f32 v64, v56, v57
    v_cvt_pk_bf16_f32 v65, v58, v59
    v_cvt_pk_bf16_f32 v66, v60, v61
    v_cvt_pk_bf16_f32 v67, v62, v63
    v_accvgpr_write_b32 a0, v64
    v_accvgpr_write_b32 a1, v65
    v_accvgpr_write_b32 a2, v66
    v_accvgpr_write_b32 a3, v67
    v_alignbit_b32 v68, v64, v64, v40
    v_xor_b32 v68, v68, v41
    v_alignbit_b32 v69, v65, v65, v40
    v_xor_b32 v69, v69, v41
    v_alignbit_b32 v70, v66, v66, v40
    v_xor_b32 v70, v70, v41
    v_alignbit_b32 v71, v67, v67, v40
    v_xor_b32 v71, v71, v41
    v_accvgpr_write_b32 a128, v68
    v_accvgpr_write_b32 a129, v69
    v_accvgpr_write_b32 a130, v70
    v_accvgpr_write_b32 a131, v71
    v_fract_f32 v48, v31
    v_add_f32 v49, v48, v33
    v_cos_f32 v56, v48
    v_add_f32 v50, v49, v35
    v_cos_f32 v57, v49
    v_add_f32 v51, v50, v33
    v_cos_f32 v58, v50
    v_add_f32 v52, v51, v35
    v_cos_f32 v59, v51
    v_add_f32 v53, v52, v33
    v_cos_f32 v60, v52
    v_add_f32 v54, v53, v35
    v_cos_f32 v61, v53
    v_add_f32 v55, v54, v33
    v_cos_f32 v62, v54
    v_cos_f32 v63, v55
    v_add_f32 v31, v48, v37
    v_cvt_pk_bf16_f32 v64, v56, v57
    v_cvt_pk_bf16_f32 v65, v58, v59
    v_cvt_pk_bf16_f32 v66, v60, v61
    v_cvt_pk_bf16_f32 v67, v62, v63
    v_accvgpr_write_b32 a4, v64
    v_accvgpr_write_b32 a5, v65
    v_accvgpr_write_b32 a6, v66
    v_accvgpr_write_b32 a7, v67
    v_alignbit_b32 v68, v64, v64, v40
    v_xor_b32 v68, v68, v41
    v_alignbit_b32 v69, v65, v65, v40
    v_xor_b32 v69, v69, v41
    v_alignbit_b32 v70, v66, v66, v40
    v_xor_b32 v70, v70, v41
    v_alignbit_b32 v71, v67, v67, v40
    v_xor_b32 v71, v71, v41
    v_accvgpr_write_b32 a132, v68
    v_accvgpr_write_b32 a133, v69
    v_accvgpr_write_b32 a134, v70
    v_accvgpr_write_b32 a135, v71
    v_fract_f32 v48, v30
    v_add_f32 v49, v48, v32
    v_cos_f32 v56, v48
    v_add_f32 v50, v49, v34
    v_cos_f32 v57, v49
    v_add_f32 v51, v50, v32
    v_cos_f32 v58, v50
    v_add_f32 v52, v51, v34
    v_cos_f32 v59, v51
    v_add_f32 v53, v52, v32
    v_cos_f32 v60, v52
    v_add_f32 v54, v53, v34
    v_cos_f32 v61, v53
    v_add_f32 v55, v54, v32
    v_cos_f32 v62, v54
    v_cos_f32 v63, v55
    v_add_f32 v30, v48, v36
    v_cvt_pk_bf16_f32 v64, v56, v57
    v_cvt_pk_bf16_f32 v65, v58, v59
    v_cvt_pk_bf16_f32 v66, v60, v61
    v_cvt_pk_bf16_f32 v67, v62, v63
    v_accvgpr_write_b32 a8, v64
    v_accvgpr_write_b32 a9, v65
    v_accvgpr_write_b32 a10, v66
    v_accvgpr_write_b32 a11, v67
    v_alignbit_b32 v68, v64, v64, v40
    v_xor_b32 v68, v68, v41
    v_alignbit_b32 v69, v65, v65, v40
    v_xor_b32 v69, v69, v41
    v_alignbit_b32 v70, v66, v66, v40
    v_xor_b32 v70, v70, v41
    v_alignbit_b32 v71, v67, v67, v40
    v_xor_b32 v71, v71, v41
    v_accvgpr_write_b32 a136, v68
    v_accvgpr_write_b32 a137, v69
    v_accvgpr_write_b32 a138, v70
    v_accvgpr_write_b32 a139, v71
    v_fract_f32 v48, v31
    v_add_f32 v49, v48, v33
    v_cos_f32 v56, v48
    v_add_f32 v50, v49, v35
    v_cos_f32 v57, v49
    v_add_f32 v51, v50, v33
    v_cos_f32 v58, v50
    v_add_f32 v52, v51, v35
    v_cos_f32 v59, v51
    v_add_f32 v53, v52, v33
    v_cos_f32 v60, v52
    v_add_f32 v54, v53, v35
    v_cos_f32 v61, v53
    v_add_f32 v55, v54, v33
    v_cos_f32 v62, v54
    v_cos_f32 v63, v55
    v_add_f32 v31, v48, v37
    v_cvt_pk_bf16_f32 v64, v56, v57
    v_cvt_pk_bf16_f32 v65, v58, v59
    v_cvt_pk_bf16_f32 v66, v60, v61
    v_cvt_pk_bf16_f32 v67, v62, v63
    v_accvgpr_write_b32 a12, v64
    v_accvgpr_write_b32 a13, v65
    v_accvgpr_write_b32 a14, v66
    v_accvgpr_write_b32 a15, v67
    v_alignbit_b32 v68, v64, v64, v40
    v_xor_b32 v68, v68, v41
    v_alignbit_b32 v69, v65, v65, v40
    v_xor_b32 v69, v69, v41
    v_alignbit_b32 v70, v66, v66, v40
    v_xor_b32 v70, v70, v41
    v_alignbit_b32 v71, v67, v67, v40
    v_xor_b32 v71, v71, v41
    v_accvgpr_write_b32 a140, v68
    v_accvgpr_write_b32 a141, v69
    v_accvgpr_write_b32 a142, v70
    v_accvgpr_write_b32 a143, v71
    v_fract_f32 v48, v30
    v_add_f32 v49, v48, v32
    v_cos_f32 v56, v48
    v_add_f32 v50, v49, v34
    v_cos_f32 v57, v49
    v_add_f32 v51, v50, v32
    v_cos_f32 v58, v50
    v_add_f32 v52, v51, v34
    v_cos_f32 v59, v51
    v_add_f32 v53, v52, v32
    v_cos_f32 v60, v52
    v_add_f32 v54, v53, v34
    v_cos_f32 v61, v53
    v_add_f32 v55, v54, v32
    v_cos_f32 v62, v54
    v_cos_f32 v63, v55
    v_add_f32 v30, v48, v36
    v_cvt_pk_bf16_f32 v64, v56, v57
    v_cvt_pk_bf16_f32 v65, v58, v59
    v_cvt_pk_bf16_f32 v66, v60, v61
    v_cvt_pk_bf16_f32 v67, v62, v63
    v_accvgpr_write_b32 a16, v64
    v_accvgpr_write_b32 a17, v65
    v_accvgpr_write_b32 a18, v66
    v_accvgpr_write_b32 a19, v67
    v_alignbit_b32 v68, v64, v64, v40
    v_xor_b32 v68, v68, v41
    v_alignbit_b32 v69, v65, v65, v40
    v_xor_b32 v69, v69, v41
    v_alignbit_b32 v70, v66, v66, v40
    v_xor_b32 v70, v70, v41
    v_alignbit_b32 v71, v67, v67, v40
    v_xor_b32 v71, v71, v41
    v_accvgpr_write_b32 a144, v68
    v_accvgpr_write_b32 a145, v69
    v_accvgpr_write_b32 a146, v70
    v_accvgpr_write_b32 a147, v71
    v_fract_f32 v48, v31
    v_add_f32 v49, v48, v33
    v_cos_f32 v56, v48
    v_add_f32 v50, v49, v35
    v_cos_f32 v57, v49
    v_add_f32 v51, v50, v33
    v_cos_f32 v58, v50
    v_add_f32 v52, v51, v35
    v_cos_f32 v59, v51
    v_add_f32 v53, v52, v33
    v_cos_f32 v60, v52
    v_add_f32 v54, v53, v35
    v_cos_f32 v61, v53
    v_add_f32 v55, v54, v33
    v_cos_f32 v62, v54
    v_cos_f32 v63, v55
    v_add_f32 v31, v48, v37
    v_cvt_pk_bf16_f32 v64, v56, v57
    v_cvt_pk_bf16_f32 v65, v58, v59
    v_cvt_pk_bf16_f32 v66, v60, v61
    v_cvt_pk_bf16_f32 v67, v62, v63
    v_accvgpr_write_b32 a20, v64
    v_accvgpr_write_b32 a21, v65
    v_accvgpr_write_b32 a22, v66
    v_accvgpr_write_b32 a23, v67
    v_alignbit_b32 v68, v64, v64, v40
    v_xor_b32 v68, v68, v41
    v_alignbit_b32 v69, v65, v65, v40
    v_xor_b32 v69, v69, v41
    v_alignbit_b32 v70, v66, v66, v40
    v_xor_b32 v70, v70, v41
    v_alignbit_b32 v71, v67, v67, v40
    v_xor_b32 v71, v71, v41
    v_accvgpr_write_b32 a148, v68
    v_accvgpr_write_b32 a149, v69
    v_accvgpr_write_b32 a150, v70
    v_accvgpr_write_b32 a151, v71
    v_fract_f32 v48, v30
    v_add_f32 v49, v48, v32
    v_cos_f32 v56, v48
    v_add_f32 v50, v49, v34
    v_cos_f32 v57, v49
    v_add_f32 v51, v50, v32
    v_cos_f32 v58, v50
    v_add_f32 v52, v51, v34
    v_cos_f32 v59, v51
    v_add_f32 v53, v52, v32
    v_cos_f32 v60, v52
    v_add_f32 v54, v53, v34
    v_cos_f32 v61, v53
    v_add_f32 v55, v54, v32
    v_cos_f32 v62, v54
    v_cos_f32 v63, v55
    v_add_f32 v30, v48, v36
    v_cvt_pk_bf16_f32 v64, v56, v57
    v_cvt_pk_bf16_f32 v65, v58, v59
    v_cvt_pk_bf16_f32 v66, v60, v61
    v_cvt_pk_bf16_f32 v67, v62, v63
    v_accvgpr_write_b32 a24, v64
    v_accvgpr_write_b32 a25, v65
    v_accvgpr_write_b32 a26, v66
    v_accvgpr_write_b32 a27, v67
    v_alignbit_b32 v68, v64, v64, v40
    v_xor_b32 v68, v68, v41
    v_alignbit_b32 v69, v65, v65, v40
    v_xor_b32 v69, v69, v41
    v_alignbit_b32 v70, v66, v66, v40
    v_xor_b32 v70, v70, v41
    v_alignbit_b32 v71, v67, v67, v40
    v_xor_b32 v71, v71, v41
    v_accvgpr_write_b32 a152, v68
    v_accvgpr_write_b32 a153, v69
    v_accvgpr_write_b32 a154, v70
    v_accvgpr_write_b32 a155, v71
    v_fract_f32 v48, v31
    v_add_f32 v49, v48, v33
    v_cos_f32 v56, v48
    v_add_f32 v50, v49, v35
    v_cos_f32 v57, v49
    v_add_f32 v51, v50, v33
    v_cos_f32 v58, v50
    v_add_f32 v52, v51, v35
    v_cos_f32 v59, v51
    v_add_f32 v53, v52, v33
    v_cos_f32 v60, v52
    v_add_f32 v54, v53, v35
    v_cos_f32 v61, v53
    v_add_f32 v55, v54, v33
    v_cos_f32 v62, v54
    v_cos_f32 v63, v55
    v_add_f32 v31, v48, v37
    v_cvt_pk_bf16_f32 v64, v56, v57
    v_cvt_pk_bf16_f32 v65, v58, v59
    v_cvt_pk_bf16_f32 v66, v60, v61
    v_cvt_pk_bf16_f32 v67, v62, v63
    v_accvgpr_write_b32 a28, v64
    v_accvgpr_write_b32 a29, v65
    v_accvgpr_write_b32 a30, v66
    v_accvgpr_write_b32 a31, v67
    v_alignbit_b32 v68, v64, v64, v40
    v_xor_b32 v68, v68, v41
    v_alignbit_b32 v69, v65, v65, v40
    v_xor_b32 v69, v69, v41
    v_alignbit_b32 v70, v66, v66, v40
    v_xor_b32 v70, v70, v41
    v_alignbit_b32 v71, v67, v67, v40
    v_xor_b32 v71, v71, v41
    v_accvgpr_write_b32 a156, v68
    v_accvgpr_write_b32 a157, v69
    v_accvgpr_write_b32 a158, v70
    v_accvgpr_write_b32 a159, v71
    v_fract_f32 v48, v30
    v_add_f32 v49, v48, v32
    v_cos_f32 v56, v48
    v_add_f32 v50, v49, v34
    v_cos_f32 v57, v49
    v_add_f32 v51, v50, v32
    v_cos_f32 v58, v50
    v_add_f32 v52, v51, v34
    v_cos_f32 v59, v51
    v_add_f32 v53, v52, v32
    v_cos_f32 v60, v52
    v_add_f32 v54, v53, v34
    v_cos_f32 v61, v53
    v_add_f32 v55, v54, v32
    v_cos_f32 v62, v54
    v_cos_f32 v63, v55
    v_add_f32 v30, v48, v36
    v_cvt_pk_bf16_f32 v64, v56, v57
    v_cvt_pk_bf16_f32 v65, v58, v59
    v_cvt_pk_bf16_f32 v66, v60, v61
    v_cvt_pk_bf16_f32 v67, v62, v63
    v_accvgpr_write_b32 a32, v64
    v_accvgpr_write_b32 a33, v65
    v_accvgpr_write_b32 a34, v66
    v_accvgpr_write_b32 a35, v67
    v_alignbit_b32 v68, v64, v64, v40
    v_xor_b32 v68, v68, v41
    v_alignbit_b32 v69, v65, v65, v40
    v_xor_b32 v69, v69, v41
    v_alignbit_b32 v70, v66, v66, v40
    v_xor_b32 v70, v70, v41
    v_alignbit_b32 v71, v67, v67, v40
    v_xor_b32 v71, v71, v41
    v_accvgpr_write_b32 a160, v68
    v_accvgpr_write_b32 a161, v69
    v_accvgpr_write_b32 a162, v70
    v_accvgpr_write_b32 a163, v71
    v_fract_f32 v48, v31
    v_add_f32 v49, v48, v33
    v_cos_f32 v56, v48
    v_add_f32 v50, v49, v35
    v_cos_f32 v57, v49
    v_add_f32 v51, v50, v33
    v_cos_f32 v58, v50
    v_add_f32 v52, v51, v35
    v_cos_f32 v59, v51
    v_add_f32 v53, v52, v33
    v_cos_f32 v60, v52
    v_add_f32 v54, v53, v35
    v_cos_f32 v61, v53
    v_add_f32 v55, v54, v33
    v_cos_f32 v62, v54
    v_cos_f32 v63, v55
    v_add_f32 v31, v48, v37
    v_cvt_pk_bf16_f32 v64, v56, v57
    v_cvt_pk_bf16_f32 v65, v58, v59
    v_cvt_pk_bf16_f32 v66, v60, v61
    v_cvt_pk_bf16_f32 v67, v62, v63
    v_accvgpr_write_b32 a36, v64
    v_accvgpr_write_b32 a37, v65
    v_accvgpr_write_b32 a38, v66
    v_accvgpr_write_b32 a39, v67
    v_alignbit_b32 v68, v64, v64, v40
    v_xor_b32 v68, v68, v41
    v_alignbit_b32 v69, v65, v65, v40
    v_xor_b32 v69, v69, v41
    v_alignbit_b32 v70, v66, v66, v40
    v_xor_b32 v70, v70, v41
    v_alignbit_b32 v71, v67, v67, v40
    v_xor_b32 v71, v71, v41
    v_accvgpr_write_b32 a164, v68
    v_accvgpr_write_b32 a165, v69
    v_accvgpr_write_b32 a166, v70
    v_accvgpr_write_b32 a167, v71
    v_fract_f32 v48, v30
    v_add_f32 v49, v48, v32
    v_cos_f32 v56, v48
    v_add_f32 v50, v49, v34
    v_cos_f32 v57, v49
    v_add_f32 v51, v50, v32
    v_cos_f32 v58, v50
    v_add_f32 v52, v51, v34
    v_cos_f32 v59, v51
    v_add_f32 v53, v52, v32
    v_cos_f32 v60, v52
    v_add_f32 v54, v53, v34
    v_cos_f32 v61, v53
    v_add_f32 v55, v54, v32
    v_cos_f32 v62, v54
    v_cos_f32 v63, v55
    v_add_f32 v30, v48, v36
    v_cvt_pk_bf16_f32 v64, v56, v57
    v_cvt_pk_bf16_f32 v65, v58, v59
    v_cvt_pk_bf16_f32 v66, v60, v61
    v_cvt_pk_bf16_f32 v67, v62, v63
    v_accvgpr_write_b32 a40, v64
    v_accvgpr_write_b32 a41, v65
    v_accvgpr_write_b32 a42, v66
    v_accvgpr_write_b32 a43, v67
    v_alignbit_b32 v68, v64, v64, v40
    v_xor_b32 v68, v68, v41
    v_alignbit_b32 v69, v65, v65, v40
    v_xor_b32 v69, v69, v41
    v_alignbit_b32 v70, v66, v66, v40
    v_xor_b32 v70, v70, v41
    v_alignbit_b32 v71, v67, v67, v40
    v_xor_b32 v71, v71, v41
    v_accvgpr_write_b32 a168, v68
    v_accvgpr_write_b32 a169, v69
    v_accvgpr_write_b32 a170, v70
    v_accvgpr_write_b32 a171, v71
    v_fract_f32 v48, v31
    v_add_f32 v49, v48, v33
    v_cos_f32 v56, v48
    v_add_f32 v50, v49, v35
    v_cos_f32 v57, v49
    v_add_f32 v51, v50, v33
    v_cos_f32 v58, v50
    v_add_f32 v52, v51, v35
    v_cos_f32 v59, v51
    v_add_f32 v53, v52, v33
    v_cos_f32 v60, v52
    v_add_f32 v54, v53, v35
    v_cos_f32 v61, v53
    v_add_f32 v55, v54, v33
    v_cos_f32 v62, v54
    v_cos_f32 v63, v55
    v_add_f32 v31, v48, v37
    v_cvt_pk_bf16_f32 v64, v56, v57
    v_cvt_pk_bf16_f32 v65, v58, v59
    v_cvt_pk_bf16_f32 v66, v60, v61
    v_cvt_pk_bf16_f32 v67, v62, v63
    v_accvgpr_write_b32 a44, v64
    v_accvgpr_write_b32 a45, v65
    v_accvgpr_write_b32 a46, v66
    v_accvgpr_write_b32 a47, v67
    v_alignbit_b32 v68, v64, v64, v40
    v_xor_b32 v68, v68, v41
    v_alignbit_b32 v69, v65, v65, v40
    v_xor_b32 v69, v69, v41
    v_alignbit_b32 v70, v66, v66, v40
    v_xor_b32 v70, v70, v41
    v_alignbit_b32 v71, v67, v67, v40
    v_xor_b32 v71, v71, v41
    v_accvgpr_write_b32 a172, v68
    v_accvgpr_write_b32 a173, v69
    v_accvgpr_write_b32 a174, v70
    v_accvgpr_write_b32 a175, v71
    v_fract_f32 v48, v30
    v_add_f32 v49, v48, v32
    v_cos_f32 v56, v48
    v_add_f32 v50, v49, v34
    v_cos_f32 v57, v49
    v_add_f32 v51, v50, v32
    v_cos_f32 v58, v50
    v_add_f32 v52, v51, v34
    v_cos_f32 v59, v51
    v_add_f32 v53, v52, v32
    v_cos_f32 v60, v52
    v_add_f32 v54, v53, v34
    v_cos_f32 v61, v53
    v_add_f32 v55, v54, v32
    v_cos_f32 v62, v54
    v_cos_f32 v63, v55
    v_add_f32 v30, v48, v36
    v_cvt_pk_bf16_f32 v64, v56, v57
    v_cvt_pk_bf16_f32 v65, v58, v59
    v_cvt_pk_bf16_f32 v66, v60, v61
    v_cvt_pk_bf16_f32 v67, v62, v63
    v_accvgpr_write_b32 a48, v64
    v_accvgpr_write_b32 a49, v65
    v_accvgpr_write_b32 a50, v66
    v_accvgpr_write_b32 a51, v67
    v_alignbit_b32 v68, v64, v64, v40
    v_xor_b32 v68, v68, v41
    v_alignbit_b32 v69, v65, v65, v40
    v_xor_b32 v69, v69, v41
    v_alignbit_b32 v70, v66, v66, v40
    v_xor_b32 v70, v70, v41
    v_alignbit_b32 v71, v67, v67, v40
    v_xor_b32 v71, v71, v41
    v_accvgpr_write_b32 a176, v68
    v_accvgpr_write_b32 a177, v69
    v_accvgpr_write_b32 a178, v70
    v_accvgpr_write_b32 a179, v71
    v_fract_f32 v48, v31
    v_add_f32 v49, v48, v33
    v_cos_f32 v56, v48
    v_add_f32 v50, v49, v35
    v_cos_f32 v57, v49
    v_add_f32 v51, v50, v33
    v_cos_f32 v58, v50
    v_add_f32 v52, v51, v35
    v_cos_f32 v59, v51
    v_add_f32 v53, v52, v33
    v_cos_f32 v60, v52
    v_add_f32 v54, v53, v35
    v_cos_f32 v61, v53
    v_add_f32 v55, v54, v33
    v_cos_f32 v62, v54
    v_cos_f32 v63, v55
    v_add_f32 v31, v48, v37
    v_cvt_pk_bf16_f32 v64, v56, v57
    v_cvt_pk_bf16_f32 v65, v58, v59
    v_cvt_pk_bf16_f32 v66, v60, v61
    v_cvt_pk_bf16_f32 v67, v62, v63
    v_accvgpr_write_b32 a52, v64
    v_accvgpr_write_b32 a53, v65
    v_accvgpr_write_b32 a54, v66
    v_accvgpr_write_b32 a55, v67
    v_alignbit_b32 v68, v64, v64, v40
    v_xor_b32 v68, v68, v41
    v_alignbit_b32 v69, v65, v65, v40
    v_xor_b32 v69, v69, v41
    v_alignbit_b32 v70, v66, v66, v40
    v_xor_b32 v70, v70, v41
    v_alignbit_b32 v71, v67, v67, v40
    v_xor_b32 v71, v71, v41
    v_accvgpr_write_b32 a180, v68
    v_accvgpr_write_b32 a181, v69
    v_accvgpr_write_b32 a182, v70
    v_accvgpr_write_b32 a183, v71
    v_fract_f32 v48, v30
    v_add_f32 v49, v48, v32
    v_cos_f32 v56, v48
    v_add_f32 v50, v49, v34
    v_cos_f32 v57, v49
    v_add_f32 v51, v50, v32
    v_cos_f32 v58, v50
    v_add_f32 v52, v51, v34
    v_cos_f32 v59, v51
    v_add_f32 v53, v52, v32
    v_cos_f32 v60, v52
    v_add_f32 v54, v53, v34
    v_cos_f32 v61, v53
    v_add_f32 v55, v54, v32
    v_cos_f32 v62, v54
    v_cos_f32 v63, v55
    v_add_f32 v30, v48, v36
    v_cvt_pk_bf16_f32 v64, v56, v57
    v_cvt_pk_bf16_f32 v65, v58, v59
    v_cvt_pk_bf16_f32 v66, v60, v61
    v_cvt_pk_bf16_f32 v67, v62, v63
    v_accvgpr_write_b32 a56, v64
    v_accvgpr_write_b32 a57, v65
    v_accvgpr_write_b32 a58, v66
    v_accvgpr_write_b32 a59, v67
    v_alignbit_b32 v68, v64, v64, v40
    v_xor_b32 v68, v68, v41
    v_alignbit_b32 v69, v65, v65, v40
    v_xor_b32 v69, v69, v41
    v_alignbit_b32 v70, v66, v66, v40
    v_xor_b32 v70, v70, v41
    v_alignbit_b32 v71, v67, v67, v40
    v_xor_b32 v71, v71, v41
    v_accvgpr_write_b32 a184, v68
    v_accvgpr_write_b32 a185, v69
    v_accvgpr_write_b32 a186, v70
    v_accvgpr_write_b32 a187, v71
    v_fract_f32 v48, v31
    v_add_f32 v49, v48, v33
    v_cos_f32 v56, v48
    v_add_f32 v50, v49, v35
    v_cos_f32 v57, v49
    v_add_f32 v51, v50, v33
    v_cos_f32 v58, v50
    v_add_f32 v52, v51, v35
    v_cos_f32 v59, v51
    v_add_f32 v53, v52, v33
    v_cos_f32 v60, v52
    v_add_f32 v54, v53, v35
    v_cos_f32 v61, v53
    v_add_f32 v55, v54, v33
    v_cos_f32 v62, v54
    v_cos_f32 v63, v55
    v_add_f32 v31, v48, v37
    v_cvt_pk_bf16_f32 v64, v56, v57
    v_cvt_pk_bf16_f32 v65, v58, v59
    v_cvt_pk_bf16_f32 v66, v60, v61
    v_cvt_pk_bf16_f32 v67, v62, v63
    v_accvgpr_write_b32 a60, v64
    v_accvgpr_write_b32 a61, v65
    v_accvgpr_write_b32 a62, v66
    v_accvgpr_write_b32 a63, v67
    v_alignbit_b32 v68, v64, v64, v40
    v_xor_b32 v68, v68, v41
    v_alignbit_b32 v69, v65, v65, v40
    v_xor_b32 v69, v69, v41
    v_alignbit_b32 v70, v66, v66, v40
    v_xor_b32 v70, v70, v41
    v_alignbit_b32 v71, v67, v67, v40
    v_xor_b32 v71, v71, v41
    v_accvgpr_write_b32 a188, v68
    v_accvgpr_write_b32 a189, v69
    v_accvgpr_write_b32 a190, v70
    v_accvgpr_write_b32 a191, v71
    v_fract_f32 v48, v30
    v_add_f32 v49, v48, v32
    v_cos_f32 v56, v48
    v_add_f32 v50, v49, v34
    v_cos_f32 v57, v49
    v_add_f32 v51, v50, v32
    v_cos_f32 v58, v50
    v_add_f32 v52, v51, v34
    v_cos_f32 v59, v51
    v_add_f32 v53, v52, v32
    v_cos_f32 v60, v52
    v_add_f32 v54, v53, v34
    v_cos_f32 v61, v53
    v_add_f32 v55, v54, v32
    v_cos_f32 v62, v54
    v_cos_f32 v63, v55
    v_add_f32 v30, v48, v36
    v_cvt_pk_bf16_f32 v64, v56, v57
    v_cvt_pk_bf16_f32 v65, v58, v59
    v_cvt_pk_bf16_f32 v66, v60, v61
    v_cvt_pk_bf16_f32 v67, v62, v63
    v_accvgpr_write_b32 a64, v64
    v_accvgpr_write_b32 a65, v65
    v_accvgpr_write_b32 a66, v66
    v_accvgpr_write_b32 a67, v67
    v_alignbit_b32 v68, v64, v64, v40
    v_xor_b32 v68, v68, v41
    v_alignbit_b32 v69, v65, v65, v40
    v_xor_b32 v69, v69, v41
    v_alignbit_b32 v70, v66, v66, v40
    v_xor_b32 v70, v70, v41
    v_alignbit_b32 v71, v67, v67, v40
    v_xor_b32 v71, v71, v41
    v_accvgpr_write_b32 a192, v68
    v_accvgpr_write_b32 a193, v69
    v_accvgpr_write_b32 a194, v70
    v_accvgpr_write_b32 a195, v71
    v_fract_f32 v48, v31
    v_add_f32 v49, v48, v33
    v_cos_f32 v56, v48
    v_add_f32 v50, v49, v35
    v_cos_f32 v57, v49
    v_add_f32 v51, v50, v33
    v_cos_f32 v58, v50
    v_add_f32 v52, v51, v35
    v_cos_f32 v59, v51
    v_add_f32 v53, v52, v33
    v_cos_f32 v60, v52
    v_add_f32 v54, v53, v35
    v_cos_f32 v61, v53
    v_add_f32 v55, v54, v33
    v_cos_f32 v62, v54
    v_cos_f32 v63, v55
    v_add_f32 v31, v48, v37
    v_cvt_pk_bf16_f32 v64, v56, v57
    v_cvt_pk_bf16_f32 v65, v58, v59
    v_cvt_pk_bf16_f32 v66, v60, v61
    v_cvt_pk_bf16_f32 v67, v62, v63
    v_accvgpr_write_b32 a68, v64
    v_accvgpr_write_b32 a69, v65
    v_accvgpr_write_b32 a70, v66
    v_accvgpr_write_b32 a71, v67
    v_alignbit_b32 v68, v64, v64, v40
    v_xor_b32 v68, v68, v41
    v_alignbit_b32 v69, v65, v65, v40
    v_xor_b32 v69, v69, v41
    v_alignbit_b32 v70, v66, v66, v40
    v_xor_b32 v70, v70, v41
    v_alignbit_b32 v71, v67, v67, v40
    v_xor_b32 v71, v71, v41
    v_accvgpr_write_b32 a196, v68
    v_accvgpr_write_b32 a197, v69
    v_accvgpr_write_b32 a198, v70
    v_accvgpr_write_b32 a199, v71
    v_fract_f32 v48, v30
    v_add_f32 v49, v48, v32
    v_cos_f32 v56, v48
    v_add_f32 v50, v49, v34
    v_cos_f32 v57, v49
    v_add_f32 v51, v50, v32
    v_cos_f32 v58, v50
    v_add_f32 v52, v51, v34
    v_cos_f32 v59, v51
    v_add_f32 v53, v52, v32
    v_cos_f32 v60, v52
    v_add_f32 v54, v53, v34
    v_cos_f32 v61, v53
    v_add_f32 v55, v54, v32
    v_cos_f32 v62, v54
    v_cos_f32 v63, v55
    v_add_f32 v30, v48, v36
    v_cvt_pk_bf16_f32 v64, v56, v57
    v_cvt_pk_bf16_f32 v65, v58, v59
    v_cvt_pk_bf16_f32 v66, v60, v61
    v_cvt_pk_bf16_f32 v67, v62, v63
    v_accvgpr_write_b32 a72, v64
    v_accvgpr_write_b32 a73, v65
    v_accvgpr_write_b32 a74, v66
    v_accvgpr_write_b32 a75, v67
    v_alignbit_b32 v68, v64, v64, v40
    v_xor_b32 v68, v68, v41
    v_alignbit_b32 v69, v65, v65, v40
    v_xor_b32 v69, v69, v41
    v_alignbit_b32 v70, v66, v66, v40
    v_xor_b32 v70, v70, v41
    v_alignbit_b32 v71, v67, v67, v40
    v_xor_b32 v71, v71, v41
    v_accvgpr_write_b32 a200, v68
    v_accvgpr_write_b32 a201, v69
    v_accvgpr_write_b32 a202, v70
    v_accvgpr_write_b32 a203, v71
    v_fract_f32 v48, v31
    v_add_f32 v49, v48, v33
    v_cos_f32 v56, v48
    v_add_f32 v50, v49, v35
    v_cos_f32 v57, v49
    v_add_f32 v51, v50, v33
    v_cos_f32 v58, v50
    v_add_f32 v52, v51, v35
    v_cos_f32 v59, v51
    v_add_f32 v53, v52, v33
    v_cos_f32 v60, v52
    v_add_f32 v54, v53, v35
    v_cos_f32 v61, v53
    v_add_f32 v55, v54, v33
    v_cos_f32 v62, v54
    v_cos_f32 v63, v55
    v_add_f32 v31, v48, v37
    v_cvt_pk_bf16_f32 v64, v56, v57
    v_cvt_pk_bf16_f32 v65, v58, v59
    v_cvt_pk_bf16_f32 v66, v60, v61
    v_cvt_pk_bf16_f32 v67, v62, v63
    v_accvgpr_write_b32 a76, v64
    v_accvgpr_write_b32 a77, v65
    v_accvgpr_write_b32 a78, v66
    v_accvgpr_write_b32 a79, v67
    v_alignbit_b32 v68, v64, v64, v40
    v_xor_b32 v68, v68, v41
    v_alignbit_b32 v69, v65, v65, v40
    v_xor_b32 v69, v69, v41
    v_alignbit_b32 v70, v66, v66, v40
    v_xor_b32 v70, v70, v41
    v_alignbit_b32 v71, v67, v67, v40
    v_xor_b32 v71, v71, v41
    v_accvgpr_write_b32 a204, v68
    v_accvgpr_write_b32 a205, v69
    v_accvgpr_write_b32 a206, v70
    v_accvgpr_write_b32 a207, v71
    v_fract_f32 v48, v30
    v_add_f32 v49, v48, v32
    v_cos_f32 v56, v48
    v_add_f32 v50, v49, v34
    v_cos_f32 v57, v49
    v_add_f32 v51, v50, v32
    v_cos_f32 v58, v50
    v_add_f32 v52, v51, v34
    v_cos_f32 v59, v51
    v_add_f32 v53, v52, v32
    v_cos_f32 v60, v52
    v_add_f32 v54, v53, v34
    v_cos_f32 v61, v53
    v_add_f32 v55, v54, v32
    v_cos_f32 v62, v54
    v_cos_f32 v63, v55
    v_add_f32 v30, v48, v36
    v_cvt_pk_bf16_f32 v64, v56, v57
    v_cvt_pk_bf16_f32 v65, v58, v59
    v_cvt_pk_bf16_f32 v66, v60, v61
    v_cvt_pk_bf16_f32 v67, v62, v63
    v_accvgpr_write_b32 a80, v64
    v_accvgpr_write_b32 a81, v65
    v_accvgpr_write_b32 a82, v66
    v_accvgpr_write_b32 a83, v67
    v_alignbit_b32 v68, v64, v64, v40
    v_xor_b32 v68, v68, v41
    v_alignbit_b32 v69, v65, v65, v40
    v_xor_b32 v69, v69, v41
    v_alignbit_b32 v70, v66, v66, v40
    v_xor_b32 v70, v70, v41
    v_alignbit_b32 v71, v67, v67, v40
    v_xor_b32 v71, v71, v41
    v_accvgpr_write_b32 a208, v68
    v_accvgpr_write_b32 a209, v69
    v_accvgpr_write_b32 a210, v70
    v_accvgpr_write_b32 a211, v71
    v_fract_f32 v48, v31
    v_add_f32 v49, v48, v33
    v_cos_f32 v56, v48
    v_add_f32 v50, v49, v35
    v_cos_f32 v57, v49
    v_add_f32 v51, v50, v33
    v_cos_f32 v58, v50
    v_add_f32 v52, v51, v35
    v_cos_f32 v59, v51
    v_add_f32 v53, v52, v33
    v_cos_f32 v60, v52
    v_add_f32 v54, v53, v35
    v_cos_f32 v61, v53
    v_add_f32 v55, v54, v33
    v_cos_f32 v62, v54
    v_cos_f32 v63, v55
    v_add_f32 v31, v48, v37
    v_cvt_pk_bf16_f32 v64, v56, v57
    v_cvt_pk_bf16_f32 v65, v58, v59
    v_cvt_pk_bf16_f32 v66, v60, v61
    v_cvt_pk_bf16_f32 v67, v62, v63
    v_accvgpr_write_b32 a84, v64
    v_accvgpr_write_b32 a85, v65
    v_accvgpr_write_b32 a86, v66
    v_accvgpr_write_b32 a87, v67
    v_alignbit_b32 v68, v64, v64, v40
    v_xor_b32 v68, v68, v41
    v_alignbit_b32 v69, v65, v65, v40
    v_xor_b32 v69, v69, v41
    v_alignbit_b32 v70, v66, v66, v40
    v_xor_b32 v70, v70, v41
    v_alignbit_b32 v71, v67, v67, v40
    v_xor_b32 v71, v71, v41
    v_accvgpr_write_b32 a212, v68
    v_accvgpr_write_b32 a213, v69
    v_accvgpr_write_b32 a214, v70
    v_accvgpr_write_b32 a215, v71
    v_fract_f32 v48, v30
    v_add_f32 v49, v48, v32
    v_cos_f32 v56, v48
    v_add_f32 v50, v49, v34
    v_cos_f32 v57, v49
    v_add_f32 v51, v50, v32
    v_cos_f32 v58, v50
    v_add_f32 v52, v51, v34
    v_cos_f32 v59, v51
    v_add_f32 v53, v52, v32
    v_cos_f32 v60, v52
    v_add_f32 v54, v53, v34
    v_cos_f32 v61, v53
    v_add_f32 v55, v54, v32
    v_cos_f32 v62, v54
    v_cos_f32 v63, v55
    v_add_f32 v30, v48, v36
    v_cvt_pk_bf16_f32 v64, v56, v57
    v_cvt_pk_bf16_f32 v65, v58, v59
    v_cvt_pk_bf16_f32 v66, v60, v61
    v_cvt_pk_bf16_f32 v67, v62, v63
    v_accvgpr_write_b32 a88, v64
    v_accvgpr_write_b32 a89, v65
    v_accvgpr_write_b32 a90, v66
    v_accvgpr_write_b32 a91, v67
    v_alignbit_b32 v68, v64, v64, v40
    v_xor_b32 v68, v68, v41
    v_alignbit_b32 v69, v65, v65, v40
    v_xor_b32 v69, v69, v41
    v_alignbit_b32 v70, v66, v66, v40
    v_xor_b32 v70, v70, v41
    v_alignbit_b32 v71, v67, v67, v40
    v_xor_b32 v71, v71, v41
    v_accvgpr_write_b32 a216, v68
    v_accvgpr_write_b32 a217, v69
    v_accvgpr_write_b32 a218, v70
    v_accvgpr_write_b32 a219, v71
    v_fract_f32 v48, v31
    v_add_f32 v49, v48, v33
    v_cos_f32 v56, v48
    v_add_f32 v50, v49, v35
    v_cos_f32 v57, v49
    v_add_f32 v51, v50, v33
    v_cos_f32 v58, v50
    v_add_f32 v52, v51, v35
    v_cos_f32 v59, v51
    v_add_f32 v53, v52, v33
    v_cos_f32 v60, v52
    v_add_f32 v54, v53, v35
    v_cos_f32 v61, v53
    v_add_f32 v55, v54, v33
    v_cos_f32 v62, v54
    v_cos_f32 v63, v55
    v_add_f32 v31, v48, v37
    v_cvt_pk_bf16_f32 v64, v56, v57
    v_cvt_pk_bf16_f32 v65, v58, v59
    v_cvt_pk_bf16_f32 v66, v60, v61
    v_cvt_pk_bf16_f32 v67, v62, v63
    v_accvgpr_write_b32 a92, v64
    v_accvgpr_write_b32 a93, v65
    v_accvgpr_write_b32 a94, v66
    v_accvgpr_write_b32 a95, v67
    v_alignbit_b32 v68, v64, v64, v40
    v_xor_b32 v68, v68, v41
    v_alignbit_b32 v69, v65, v65, v40
    v_xor_b32 v69, v69, v41
    v_alignbit_b32 v70, v66, v66, v40
    v_xor_b32 v70, v70, v41
    v_alignbit_b32 v71, v67, v67, v40
    v_xor_b32 v71, v71, v41
    v_accvgpr_write_b32 a220, v68
    v_accvgpr_write_b32 a221, v69
    v_accvgpr_write_b32 a222, v70
    v_accvgpr_write_b32 a223, v71
    v_fract_f32 v48, v30
    v_add_f32 v49, v48, v32
    v_cos_f32 v56, v48
    v_add_f32 v50, v49, v34
    v_cos_f32 v57, v49
    v_add_f32 v51, v50, v32
    v_cos_f32 v58, v50
    v_add_f32 v52, v51, v34
    v_cos_f32 v59, v51
    v_add_f32 v53, v52, v32
    v_cos_f32 v60, v52
    v_add_f32 v54, v53, v34
    v_cos_f32 v61, v53
    v_add_f32 v55, v54, v32
    v_cos_f32 v62, v54
    v_cos_f32 v63, v55
    v_add_f32 v30, v48, v36
    v_cvt_pk_bf16_f32 v64, v56, v57
    v_cvt_pk_bf16_f32 v65, v58, v59
    v_cvt_pk_bf16_f32 v66, v60, v61
    v_cvt_pk_bf16_f32 v67, v62, v63
    v_accvgpr_write_b32 a96, v64
    v_accvgpr_write_b32 a97, v65
    v_accvgpr_write_b32 a98, v66
    v_accvgpr_write_b32 a99, v67
    v_alignbit_b32 v68, v64, v64, v40
    v_xor_b32 v68, v68, v41
    v_alignbit_b32 v69, v65, v65, v40
    v_xor_b32 v69, v69, v41
    v_alignbit_b32 v70, v66, v66, v40
    v_xor_b32 v70, v70, v41
    v_alignbit_b32 v71, v67, v67, v40
    v_xor_b32 v71, v71, v41
    v_accvgpr_write_b32 a224, v68
    v_accvgpr_write_b32 a225, v69
    v_accvgpr_write_b32 a226, v70
    v_accvgpr_write_b32 a227, v71
    v_fract_f32 v48, v31
    v_add_f32 v49, v48, v33
    v_cos_f32 v56, v48
    v_add_f32 v50, v49, v35
    v_cos_f32 v57, v49
    v_add_f32 v51, v50, v33
    v_cos_f32 v58, v50
    v_add_f32 v52, v51, v35
    v_cos_f32 v59, v51
    v_add_f32 v53, v52, v33
    v_cos_f32 v60, v52
    v_add_f32 v54, v53, v35
    v_cos_f32 v61, v53
    v_add_f32 v55, v54, v33
    v_cos_f32 v62, v54
    v_cos_f32 v63, v55
    v_add_f32 v31, v48, v37
    v_cvt_pk_bf16_f32 v64, v56, v57
    v_cvt_pk_bf16_f32 v65, v58, v59
    v_cvt_pk_bf16_f32 v66, v60, v61
    v_cvt_pk_bf16_f32 v67, v62, v63
    v_accvgpr_write_b32 a100, v64
    v_accvgpr_write_b32 a101, v65
    v_accvgpr_write_b32 a102, v66
    v_accvgpr_write_b32 a103, v67
    v_alignbit_b32 v68, v64, v64, v40
    v_xor_b32 v68, v68, v41
    v_alignbit_b32 v69, v65, v65, v40
    v_xor_b32 v69, v69, v41
    v_alignbit_b32 v70, v66, v66, v40
    v_xor_b32 v70, v70, v41
    v_alignbit_b32 v71, v67, v67, v40
    v_xor_b32 v71, v71, v41
    v_accvgpr_write_b32 a228, v68
    v_accvgpr_write_b32 a229, v69
    v_accvgpr_write_b32 a230, v70
    v_accvgpr_write_b32 a231, v71
    v_fract_f32 v48, v30
    v_add_f32 v49, v48, v32
    v_cos_f32 v56, v48
    v_add_f32 v50, v49, v34
    v_cos_f32 v57, v49
    v_add_f32 v51, v50, v32
    v_cos_f32 v58, v50
    v_add_f32 v52, v51, v34
    v_cos_f32 v59, v51
    v_add_f32 v53, v52, v32
    v_cos_f32 v60, v52
    v_add_f32 v54, v53, v34
    v_cos_f32 v61, v53
    v_add_f32 v55, v54, v32
    v_cos_f32 v62, v54
    v_cos_f32 v63, v55
    v_add_f32 v30, v48, v36
    v_cvt_pk_bf16_f32 v64, v56, v57
    v_cvt_pk_bf16_f32 v65, v58, v59
    v_cvt_pk_bf16_f32 v66, v60, v61
    v_cvt_pk_bf16_f32 v67, v62, v63
    v_accvgpr_write_b32 a104, v64
    v_accvgpr_write_b32 a105, v65
    v_accvgpr_write_b32 a106, v66
    v_accvgpr_write_b32 a107, v67
    v_alignbit_b32 v68, v64, v64, v40
    v_xor_b32 v68, v68, v41
    v_alignbit_b32 v69, v65, v65, v40
    v_xor_b32 v69, v69, v41
    v_alignbit_b32 v70, v66, v66, v40
    v_xor_b32 v70, v70, v41
    v_alignbit_b32 v71, v67, v67, v40
    v_xor_b32 v71, v71, v41
    v_accvgpr_write_b32 a232, v68
    v_accvgpr_write_b32 a233, v69
    v_accvgpr_write_b32 a234, v70
    v_accvgpr_write_b32 a235, v71
    v_fract_f32 v48, v31
    v_add_f32 v49, v48, v33
    v_cos_f32 v56, v48
    v_add_f32 v50, v49, v35
    v_cos_f32 v57, v49
    v_add_f32 v51, v50, v33
    v_cos_f32 v58, v50
    v_add_f32 v52, v51, v35
    v_cos_f32 v59, v51
    v_add_f32 v53, v52, v33
    v_cos_f32 v60, v52
    v_add_f32 v54, v53, v35
    v_cos_f32 v61, v53
    v_add_f32 v55, v54, v33
    v_cos_f32 v62, v54
    v_cos_f32 v63, v55
    v_add_f32 v31, v48, v37
    v_cvt_pk_bf16_f32 v64, v56, v57
    v_cvt_pk_bf16_f32 v65, v58, v59
    v_cvt_pk_bf16_f32 v66, v60, v61
    v_cvt_pk_bf16_f32 v67, v62, v63
    v_accvgpr_write_b32 a108, v64
    v_accvgpr_write_b32 a109, v65
    v_accvgpr_write_b32 a110, v66
    v_accvgpr_write_b32 a111, v67
    v_alignbit_b32 v68, v64, v64, v40
    v_xor_b32 v68, v68, v41
    v_alignbit_b32 v69, v65, v65, v40
    v_xor_b32 v69, v69, v41
    v_alignbit_b32 v70, v66, v66, v40
    v_xor_b32 v70, v70, v41
    v_alignbit_b32 v71, v67, v67, v40
    v_xor_b32 v71, v71, v41
    v_accvgpr_write_b32 a236, v68
    v_accvgpr_write_b32 a237, v69
    v_accvgpr_write_b32 a238, v70
    v_accvgpr_write_b32 a239, v71
    v_fract_f32 v48, v30
    v_add_f32 v49, v48, v32
    v_cos_f32 v56, v48
    v_add_f32 v50, v49, v34
    v_cos_f32 v57, v49
    v_add_f32 v51, v50, v32
    v_cos_f32 v58, v50
    v_add_f32 v52, v51, v34
    v_cos_f32 v59, v51
    v_add_f32 v53, v52, v32
    v_cos_f32 v60, v52
    v_add_f32 v54, v53, v34
    v_cos_f32 v61, v53
    v_add_f32 v55, v54, v32
    v_cos_f32 v62, v54
    v_cos_f32 v63, v55
    v_add_f32 v30, v48, v36
    v_cvt_pk_bf16_f32 v64, v56, v57
    v_cvt_pk_bf16_f32 v65, v58, v59
    v_cvt_pk_bf16_f32 v66, v60, v61
    v_cvt_pk_bf16_f32 v67, v62, v63
    v_accvgpr_write_b32 a112, v64
    v_accvgpr_write_b32 a113, v65
    v_accvgpr_write_b32 a114, v66
    v_accvgpr_write_b32 a115, v67
    v_alignbit_b32 v68, v64, v64, v40
    v_xor_b32 v68, v68, v41
    v_alignbit_b32 v69, v65, v65, v40
    v_xor_b32 v69, v69, v41
    v_alignbit_b32 v70, v66, v66, v40
    v_xor_b32 v70, v70, v41
    v_alignbit_b32 v71, v67, v67, v40
    v_xor_b32 v71, v71, v41
    v_accvgpr_write_b32 a240, v68
    v_accvgpr_write_b32 a241, v69
    v_accvgpr_write_b32 a242, v70
    v_accvgpr_write_b32 a243, v71
    v_fract_f32 v48, v31
    v_add_f32 v49, v48, v33
    v_cos_f32 v56, v48
    v_add_f32 v50, v49, v35
    v_cos_f32 v57, v49
    v_add_f32 v51, v50, v33
    v_cos_f32 v58, v50
    v_add_f32 v52, v51, v35
    v_cos_f32 v59, v51
    v_add_f32 v53, v52, v33
    v_cos_f32 v60, v52
    v_add_f32 v54, v53, v35
    v_cos_f32 v61, v53
    v_add_f32 v55, v54, v33
    v_cos_f32 v62, v54
    v_cos_f32 v63, v55
    v_add_f32 v31, v48, v37
    v_cvt_pk_bf16_f32 v64, v56, v57
    v_cvt_pk_bf16_f32 v65, v58, v59
    v_cvt_pk_bf16_f32 v66, v60, v61
    v_cvt_pk_bf16_f32 v67, v62, v63
    v_accvgpr_write_b32 a116, v64
    v_accvgpr_write_b32 a117, v65
    v_accvgpr_write_b32 a118, v66
    v_accvgpr_write_b32 a119, v67
    v_alignbit_b32 v68, v64, v64, v40
    v_xor_b32 v68, v68, v41
    v_alignbit_b32 v69, v65, v65, v40
    v_xor_b32 v69, v69, v41
    v_alignbit_b32 v70, v66, v66, v40
    v_xor_b32 v70, v70, v41
    v_alignbit_b32 v71, v67, v67, v40
    v_xor_b32 v71, v71, v41
    v_accvgpr_write_b32 a244, v68
    v_accvgpr_write_b32 a245, v69
    v_accvgpr_write_b32 a246, v70
    v_accvgpr_write_b32 a247, v71
    v_fract_f32 v48, v30
    v_add_f32 v49, v48, v32
    v_cos_f32 v56, v48
    v_add_f32 v50, v49, v34
    v_cos_f32 v57, v49
    v_add_f32 v51, v50, v32
    v_cos_f32 v58, v50
    v_add_f32 v52, v51, v34
    v_cos_f32 v59, v51
    v_add_f32 v53, v52, v32
    v_cos_f32 v60, v52
    v_add_f32 v54, v53, v34
    v_cos_f32 v61, v53
    v_add_f32 v55, v54, v32
    v_cos_f32 v62, v54
    v_cos_f32 v63, v55
    v_add_f32 v30, v48, v36
    v_cvt_pk_bf16_f32 v64, v56, v57
    v_cvt_pk_bf16_f32 v65, v58, v59
    v_cvt_pk_bf16_f32 v66, v60, v61
    v_cvt_pk_bf16_f32 v67, v62, v63
    v_accvgpr_write_b32 a120, v64
    v_accvgpr_write_b32 a121, v65
    v_accvgpr_write_b32 a122, v66
    v_accvgpr_write_b32 a123, v67
    v_alignbit_b32 v68, v64, v64, v40
    v_xor_b32 v68, v68, v41
    v_alignbit_b32 v69, v65, v65, v40
    v_xor_b32 v69, v69, v41
    v_alignbit_b32 v70, v66, v66, v40
    v_xor_b32 v70, v70, v41
    v_alignbit_b32 v71, v67, v67, v40
    v_xor_b32 v71, v71, v41
    v_accvgpr_write_b32 a248, v68
    v_accvgpr_write_b32 a249, v69
    v_accvgpr_write_b32 a250, v70
    v_accvgpr_write_b32 a251, v71
    v_fract_f32 v48, v31
    v_add_f32 v49, v48, v33
    v_cos_f32 v56, v48
    v_add_f32 v50, v49, v35
    v_cos_f32 v57, v49
    v_add_f32 v51, v50, v33
    v_cos_f32 v58, v50
    v_add_f32 v52, v51, v35
    v_cos_f32 v59, v51
    v_add_f32 v53, v52, v33
    v_cos_f32 v60, v52
    v_add_f32 v54, v53, v35
    v_cos_f32 v61, v53
    v_add_f32 v55, v54, v33
    v_cos_f32 v62, v54
    v_cos_f32 v63, v55
    v_add_f32 v31, v48, v37
    v_cvt_pk_bf16_f32 v64, v56, v57
    v_cvt_pk_bf16_f32 v65, v58, v59
    v_cvt_pk_bf16_f32 v66, v60, v61
    v_cvt_pk_bf16_f32 v67, v62, v63
    v_accvgpr_write_b32 a124, v64
    v_accvgpr_write_b32 a125, v65
    v_accvgpr_write_b32 a126, v66
    v_accvgpr_write_b32 a127, v67
    v_alignbit_b32 v68, v64, v64, v40
    v_xor_b32 v68, v68, v41
    v_alignbit_b32 v69, v65, v65, v40
    v_xor_b32 v69, v69, v41
    v_alignbit_b32 v70, v66, v66, v40
    v_xor_b32 v70, v70, v41
    v_alignbit_b32 v71, v67, v67, v40
    v_xor_b32 v71, v71, v41
    v_accvgpr_write_b32 a252, v68
    v_accvgpr_write_b32 a253, v69
    v_accvgpr_write_b32 a254, v70
    v_accvgpr_write_b32 a255, v71
    v_lshlrev_b32 v6, 31, v38
    v_or_b32 v6, 0x3f003f00, v6
    v_cmp_gt_u32 vcc, 16, v1
    v_accvgpr_read_b32 v5, a0
    s_nop 0
    v_cndmask_b32 v5, v5, v6, vcc
    v_accvgpr_write_b32 a0, v5
    v_accvgpr_read_b32 v5, a4
    v_cndmask_b32 v5, v5, v6, vcc
    v_accvgpr_write_b32 a4, v5
    v_and_b32 v5, 15, v1
    v_lshrrev_b32 v6, 4, v1
    v_lshlrev_b32 v5, 4, v5
    v_lshl_add_u32 v10, v6, 9, v5
    v_add_u32 v11, 2048, v10
    v_add_u32 v12, 0x10000, v10
    v_add_u32 v13, 0x10000, v11
    s_lshl_b32 s19, s16, 10
    s_lshl_b32 s17, s16, 1
    v_lshrrev_b32 v8, 5, v1
    v_add_u32 v8, s17, v8
    v_and_b32 v7, 31, v1
    v_mul_u32_u24 v2, 33024, v8
    v_lshl_add_u32 v2, v7, 4, v2
    v_and_b32 v3, 15, v1
    v_and_b32 v5, 48, v1
    v_lshl_add_u32 v3, v3, 12, v5
    v_add_u32 v4, 0x10000, v3
    s_lshl_b32 s21, s28, 21
    s_lshl_b32 s17, s29, 6
    s_add_u32 s21, s21, s17
    s_lshl_b32 s20, s28, 13
    s_add_u32 s20, s20, 111149056
    s_mov_b32 s24, 512
    s_mov_b32 s25, 131072
    v_and_b32 v7, 31, v1
    v_lshlrev_b32 v7, 7, v7
    s_lshl_b32 s17, s16, 12
    s_add_u32 s17, s17, 100761600
    v_add_u32 v7, s17, v7
    s_mov_b32 s30, s92
F3_w0:
    buffer_load_dword v5, v7, s[4:7], 0 offen sc1
    s_waitcnt vmcnt(0)
    v_cmp_gt_u32 vcc, 1, v5
    s_nop 0
    s_cmp_lg_u64 vcc, 0
    s_cbranch_scc0 F3_w0_ok
    s_cmp_ge_u32 s30, 1048576
    s_cselect_b32 s92, 1048576, s92
    s_cbranch_scc1 F3_w0_ok
    s_add_u32 s30, s30, 1
    s_sleep 8
    s_branch F3_w0
F3_w0_ok:
    s_barrier
    s_mov_b32 s26, s25
    s_sub_u32 s25, s21, 1073741824
    s_mov_b32 s21, 1073741824
    s_mov_b32 s23, 0
    s_mov_b32 s22, 0
    s_add_u32 m0, s19, 0
    s_add_u32 s17, s20, 0
    buffer_load_dwordx4 v2, s[4:7], s17 offen lds
    s_add_u32 m0, s19, 4096
    s_add_u32 s17, s20, 264192
    buffer_load_dwordx4 v2, s[4:7], s17 offen lds
    s_add_u32 m0, s19, 8192
    s_add_u32 s17, s20, 528384
    buffer_load_dwordx4 v2, s[4:7], s17 offen lds
    s_add_u32 m0, s19, 12288
    s_add_u32 s17, s20, 792576
    buffer_load_dwordx4 v2, s[4:7], s17 offen lds
    s_add_u32 m0, s19, 16384
    s_add_u32 s17, s20, 1056768
    buffer_load_dwordx4 v2, s[4:7], s17 offen lds
    s_add_u32 m0, s19, 20480
    s_add_u32 s17, s20, 1320960
    buffer_load_dwordx4 v2, s[4:7], s17 offen lds
    s_add_u32 m0, s19, 24576
    s_add_u32 s17, s20, 1585152
    buffer_load_dwordx4 v2, s[4:7], s17 offen lds
    s_add_u32 m0, s19, 28672
    s_add_u32 s17, s20, 1849344
    buffer_load_dwordx4 v2, s[4:7], s17 offen lds
    s_add_u32 m0, s19, 32768
    s_add_u32 s17, s20, 2113536
    buffer_load_dwordx4 v2, s[4:7], s17 offen lds
    s_add_u32 m0, s19, 36864
    s_add_u32 s17, s20, 2377728
    buffer_load_dwordx4 v2, s[4:7], s17 offen lds
    s_add_u32 m0, s19, 40960
    s_add_u32 s17, s20, 2641920
    buffer_load_dwordx4 v2, s[4:7], s17 offen lds
    s_add_u32 m0, s19, 45056
    s_add_u32 s17, s20, 2906112
    buffer_load_dwordx4 v2, s[4:7], s17 offen lds
    s_add_u32 m0, s19, 49152
    s_add_u32 s17, s20, 3170304
    buffer_load_dwordx4 v2, s[4:7], s17 offen lds
    s_add_u32 m0, s19, 53248
    s_add_u32 s17, s20, 3434496
    buffer_load_dwordx4 v2, s[4:7], s17 offen lds
    s_add_u32 m0, s19, 57344
    s_add_u32 s17, s20, 3698688
    buffer_load_dwordx4 v2, s[4:7], s17 offen lds
    s_add_u32 m0, s19, 61440
    s_add_u32 s17, s20, 3962880
    buffer_load_dwordx4 v2, s[4:7], s17 offen lds
    s_add_u32 s20, s20, s24
    s_add_u32 m0, s19, 65536
    s_add_u32 s17, s20, 0
    buffer_load_dwordx4 v2, s[4:7], s17 offen lds
    s_add_u32 m0, s19, 69632
    s_add_u32 s17, s20, 264192
    buffer_load_dwordx4 v2, s[4:7], s17 offen lds
    s_add_u32 m0, s19, 73728
    s_add_u32 s17, s20, 528384
    buffer_load_dwordx4 v2, s[4:7], s17 offen lds
    s_waitcnt vmcnt(11)
    s_barrier
    ds_read_b128 v[20:23], v10 offset:0
    ds_read_b128 v[24:27], v10 offset:256
    ds_read_b128 v[28:31], v11 offset:0
    ds_read_b128 v[32:35], v11 offset:256
    ds_read_b128 v[36:39], v10 offset:4096
    ds_read_b128 v[40:43], v10 offset:4352
    ds_read_b128 v[44:47], v11 offset:4096
.p2align 6
F3_top:
    s_waitcnt lgkmcnt(6)
    v_mfma_f32_16x16x32_bf16 v[52:55], a[0:3], v[20:23], 0
    ds_read_b128 v[48:51], v11 offset:4352
    v_mfma_f32_16x16x32_bf16 v[56:59], a[4:7], v[20:23], 0
    s_waitcnt lgkmcnt(6)
    v_mfma_f32_16x16x32_bf16 v[60:63], a[0:3], v[24:27], 0
    ds_read_b128 v[20:23], v10 offset:8192
    s_add_u32 m0, s19, 77824
    v_mfma_f32_16x16x32_bf16 v[64:67], a[4:7], v[24:27], 0
    s_add_u32 s17, s20, 792576
    buffer_load_dwordx4 v2, s[4:7], s17 offen lds
    s_waitcnt lgkmcnt(6)
    v_mfma_f32_16x16x32_bf16 v[52:55], a[8:11], v[28:31], v[52:55]
    ds_read_b128 v[24:27], v10 offset:8448
    v_mfma_f32_16x16x32_bf16 v[56:59], a[12:15], v[28:31], v[56:59]
    s_waitcnt lgkmcnt(6)
    v_mfma_f32_16x16x32_bf16 v[60:63], a[8:11], v[32:35], v[60:63]
    ds_read_b128 v[28:31], v11 offset:8192
    s_add_u32 m0, s19, 81920
    v_mfma_f32_16x16x32_bf16 v[64:67], a[12:15], v[32:35], v[64:67]
    s_add_u32 s17, s20, 1056768
    buffer_load_dwordx4 v2, s[4:7], s17 offen lds
    s_waitcnt lgkmcnt(6)
    v_mfma_f32_16x16x32_bf16 v[52:55], a[16:19], v[36:39], v[52:55]
    ds_read_b128 v[32:35], v11 offset:8448
    v_mfma_f32_16x16x32_bf16 v[56:59], a[20:23], v[36:39], v[56:59]
    s_waitcnt lgkmcnt(6)
    v_mfma_f32_16x16x32_bf16 v[60:63], a[16:19], v[40:43], v[60:63]
    ds_read_b128 v[36:39], v10 offset:12288
    s_add_u32 m0, s19, 86016
    v_mfma_f32_16x16x32_bf16 v[64:67], a[20:23], v[40:43], v[64:67]
    s_add_u32 s17, s20, 1320960
    buffer_load_dwordx4 v2, s[4:7], s17 offen lds
    s_waitcnt lgkmcnt(6)
    v_mfma_f32_16x16x32_bf16 v[52:55], a[24:27], v[44:47], v[52:55]
    ds_read_b128 v[40:43], v10 offset:12544
    v_mfma_f32_16x16x32_bf16 v[56:59], a[28:31], v[44:47], v[56:59]
    s_waitcnt lgkmcnt(6)
    v_mfma_f32_16x16x32_bf16 v[60:63], a[24:27], v[48:51], v[60:63]
    ds_read_b128 v[44:47], v11 offset:12288
    s_add_u32 m0, s19, 90112
    v_mfma_f32_16x16x32_bf16 v[64:67], a[28:31], v[48:51], v[64:67]
    s_add_u32 s17, s20, 1585152
    buffer_load_dwordx4 v2, s[4:7], s17 offen lds
    s_waitcnt lgkmcnt(6)
    v_mfma_f32_16x16x32_bf16 v[52:55], a[32:35], v[20:23], v[52:55]
    ds_read_b128 v[48:51], v11 offset:12544
    v_mfma_f32_16x16x32_bf16 v[56:59], a[36:39], v[20:23], v[56:59]
    s_waitcnt lgkmcnt(6)
    v_mfma_f32_16x16x32_bf16 v[60:63], a[32:35], v[24:27], v[60:63]
    ds_read_b128 v[20:23], v10 offset:16384
    s_add_u32 m0, s19, 94208
    v_mfma_f32_16x16x32_bf16 v[64:67], a[36:39], v[24:27], v[64:67]
    s_add_u32 s17, s20, 1849344
    buffer_load_dwordx4 v2, s[4:7], s17 offen lds
    s_waitcnt lgkmcnt(6)
    v_mfma_f32_16x16x32_bf16 v[52:55], a[40:43], v[28:31], v[52:55]
    ds_read_b128 v[24:27], v10 offset:16640
    v_mfma_f32_16x16x32_bf16 v[56:59], a[44:47], v[28:31], v[56:59]
    v_cvt_pk_bf16_f32 v84, v68, v69
    s_waitcnt lgkmcnt(6)
    v_mfma_f32_16x16x32_bf16 v[60:63], a[40:43], v[32:35], v[60:63]
    ds_read_b128 v[28:31], v11 offset:16384
    v_mfma_f32_16x16x32_bf16 v[64:67], a[44:47], v[32:35], v[64:67]
    v_cvt_pk_bf16_f32 v85, v70, v71
    s_waitcnt lgkmcnt(6)
    v_mfma_f32_16x16x32_bf16 v[52:55], a[48:51], v[36:39], v[52:55]
    ds_read_b128 v[32:35], v11 offset:16640
    v_mfma_f32_16x16x32_bf16 v[56:59], a[52:55], v[36:39], v[56:59]
    v_cvt_pk_bf16_f32 v86, v72, v73
    s_waitcnt lgkmcnt(6)
    v_mfma_f32_16x16x32_bf16 v[60:63], a[48:51], v[40:43], v[60:63]
    ds_read_b128 v[36:39], v10 offset:20480
    v_mfma_f32_16x16x32_bf16 v[64:67], a[52:55], v[40:43], v[64:67]
    v_cvt_pk_bf16_f32 v87, v74, v75
    s_waitcnt lgkmcnt(6)
    v_mfma_f32_16x16x32_bf16 v[52:55], a[56:59], v[44:47], v[52:55]
    ds_read_b128 v[40:43], v10 offset:20736
    v_mfma_f32_16x16x32_bf16 v[56:59], a[60:63], v[44:47], v[56:59]
    v_cvt_pk_bf16_f32 v88, v76, v77
    s_waitcnt lgkmcnt(6)
    v_mfma_f32_16x16x32_bf16 v[60:63], a[56:59], v[48:51], v[60:63]
    ds_read_b128 v[44:47], v11 offset:20480
    v_mfma_f32_16x16x32_bf16 v[64:67], a[60:63], v[48:51], v[64:67]
    v_cvt_pk_bf16_f32 v89, v78, v79
    buffer_store_dwordx4 v[84:87], v3, s[12:15], s21 offen
    s_waitcnt lgkmcnt(6)
    v_mfma_f32_16x16x32_bf16 v[52:55], a[64:67], v[20:23], v[52:55]
    ds_read_b128 v[48:51], v11 offset:20736
    v_mfma_f32_16x16x32_bf16 v[56:59], a[68:71], v[20:23], v[56:59]
    v_cvt_pk_bf16_f32 v90, v80, v81
    s_waitcnt lgkmcnt(6)
    v_mfma_f32_16x16x32_bf16 v[60:63], a[64:67], v[24:27], v[60:63]
    ds_read_b128 v[20:23], v10 offset:24576
    v_mfma_f32_16x16x32_bf16 v[64:67], a[68:71], v[24:27], v[64:67]
    v_cvt_pk_bf16_f32 v91, v82, v83
    s_waitcnt lgkmcnt(6)
    v_mfma_f32_16x16x32_bf16 v[52:55], a[72:75], v[28:31], v[52:55]
    ds_read_b128 v[24:27], v10 offset:24832
    v_mfma_f32_16x16x32_bf16 v[56:59], a[76:79], v[28:31], v[56:59]
    s_waitcnt lgkmcnt(6)
    v_mfma_f32_16x16x32_bf16 v[60:63], a[72:75], v[32:35], v[60:63]
    ds_read_b128 v[28:31], v11 offset:24576
    v_mfma_f32_16x16x32_bf16 v[64:67], a[76:79], v[32:35], v[64:67]
    buffer_store_dwordx4 v[88:91], v4, s[12:15], s21 offen
    s_waitcnt lgkmcnt(6)
    v_mfma_f32_16x16x32_bf16 v[52:55], a[80:83], v[36:39], v[52:55]
    ds_read_b128 v[32:35], v11 offset:24832
    v_mfma_f32_16x16x32_bf16 v[56:59], a[84:87], v[36:39], v[56:59]
    s_add_u32 s21, s21, s25
    s_mov_b32 s25, s26
    s_waitcnt lgkmcnt(6)
    v_mfma_f32_16x16x32_bf16 v[60:63], a[80:83], v[40:43], v[60:63]
    ds_read_b128 v[36:39], v10 offset:28672
    v_mfma_f32_16x16x32_bf16 v[64:67], a[84:87], v[40:43], v[64:67]
    s_waitcnt lgkmcnt(6)
    v_mfma_f32_16x16x32_bf16 v[52:55], a[88:91], v[44:47], v[52:55]
    ds_read_b128 v[40:43], v10 offset:28928
    v_mfma_f32_16x16x32_bf16 v[56:59], a[92:95], v[44:47], v[56:59]
    s_waitcnt lgkmcnt(6)
    v_mfma_f32_16x16x32_bf16 v[60:63], a[88:91], v[48:51], v[60:63]
    ds_read_b128 v[44:47], v11 offset:28672
    v_mfma_f32_16x16x32_bf16 v[64:67], a[92:95], v[48:51], v[64:67]
    s_waitcnt lgkmcnt(6)
    v_mfma_f32_16x16x32_bf16 v[52:55], a[96:99], v[20:23], v[52:55]
    ds_read_b128 v[48:51], v11 offset:28928
    v_mfma_f32_16x16x32_bf16 v[56:59], a[100:103], v[20:23], v[56:59]
    s_waitcnt lgkmcnt(6)
    v_mfma_f32_16x16x32_bf16 v[60:63], a[96:99], v[24:27], v[60:63]
    s_waitcnt vmcnt(10)
    s_barrier
    ds_read_b128 v[20:23], v10 offset:32768
    v_mfma_f32_16x16x32_bf16 v[64:67], a[100:103], v[24:27], v[64:67]
    s_waitcnt lgkmcnt(6)
    v_mfma_f32_16x16x32_bf16 v[52:55], a[104:107], v[28:31], v[52:55]
    ds_read_b128 v[24:27], v10 offset:33024
    s_add_u32 m0, s19, 98304
    v_mfma_f32_16x16x32_bf16 v[56:59], a[108:111], v[28:31], v[56:59]
    s_add_u32 s17, s20, 2113536
    buffer_load_dwordx4 v2, s[4:7], s17 offen lds
    s_waitcnt lgkmcnt(6)
    v_mfma_f32_16x16x32_bf16 v[60:63], a[104:107], v[32:35], v[60:63]
    ds_read_b128 v[28:31], v11 offset:32768
    v_mfma_f32_16x16x32_bf16 v[64:67], a[108:111], v[32:35], v[64:67]
    s_waitcnt lgkmcnt(6)
    v_mfma_f32_16x16x32_bf16 v[52:55], a[112:115], v[36:39], v[52:55]
    ds_read_b128 v[32:35], v11 offset:33024
    s_add_u32 m0, s19, 102400
    v_mfma_f32_16x16x32_bf16 v[56:59], a[116:119], v[36:39], v[56:59]
    s_add_u32 s17, s20, 2377728
    buffer_load_dwordx4 v2, s[4:7], s17 offen lds
    s_waitcnt lgkmcnt(6)
    v_mfma_f32_16x16x32_bf16 v[60:63], a[112:115], v[40:43], v[60:63]
    ds_read_b128 v[36:39], v10 offset:36864
    v_mfma_f32_16x16x32_bf16 v[64:67], a[116:119], v[40:43], v[64:67]
    s_waitcnt lgkmcnt(6)
    v_mfma_f32_16x16x32_bf16 v[52:55], a[120:123], v[44:47], v[52:55]
    ds_read_b128 v[40:43], v10 offset:37120
    s_add_u32 m0, s19, 106496
    v_mfma_f32_16x16x32_bf16 v[56:59], a[124:127], v[44:47], v[56:59]
    s_add_u32 s17, s20, 2641920
    buffer_load_dwordx4 v2, s[4:7], s17 offen lds
    s_waitcnt lgkmcnt(6)
    v_mfma_f32_16x16x32_bf16 v[60:63], a[120:123], v[48:51], v[60:63]
    ds_read_b128 v[44:47], v11 offset:36864
    v_mfma_f32_16x16x32_bf16 v[64:67], a[124:127], v[48:51], v[64:67]
    s_waitcnt lgkmcnt(6)
    v_mfma_f32_16x16x32_bf16 v[52:55], a[128:131], v[20:23], v[52:55]
    ds_read_b128 v[48:51], v11 offset:37120
    v_mfma_f32_16x16x32_bf16 v[56:59], a[132:135], v[20:23], v[56:59]
    s_waitcnt lgkmcnt(6)
    v_mfma_f32_16x16x32_bf16 v[60:63], a[128:131], v[24:27], v[60:63]
    ds_read_b128 v[20:23], v10 offset:40960
    s_add_u32 m0, s19, 110592
    v_mfma_f32_16x16x32_bf16 v[64:67], a[132:135], v[24:27], v[64:67]
    s_add_u32 s17, s20, 2906112
    buffer_load_dwordx4 v2, s[4:7], s17 offen lds
    s_waitcnt lgkmcnt(6)
    v_mfma_f32_16x16x32_bf16 v[52:55], a[136:139], v[28:31], v[52:55]
    ds_read_b128 v[24:27], v10 offset:41216
    v_mfma_f32_16x16x32_bf16 v[56:59], a[140:143], v[28:31], v[56:59]
    s_waitcnt lgkmcnt(6)
    v_mfma_f32_16x16x32_bf16 v[60:63], a[136:139], v[32:35], v[60:63]
    ds_read_b128 v[28:31], v11 offset:40960
    s_add_u32 m0, s19, 114688
    v_mfma_f32_16x16x32_bf16 v[64:67], a[140:143], v[32:35], v[64:67]
    s_add_u32 s17, s20, 3170304
    buffer_load_dwordx4 v2, s[4:7], s17 offen lds
    s_waitcnt lgkmcnt(6)
    v_mfma_f32_16x16x32_bf16 v[52:55], a[144:147], v[36:39], v[52:55]
    ds_read_b128 v[32:35], v11 offset:41216
    v_mfma_f32_16x16x32_bf16 v[56:59], a[148:151], v[36:39], v[56:59]
    s_waitcnt lgkmcnt(6)
    v_mfma_f32_16x16x32_bf16 v[60:63], a[144:147], v[40:43], v[60:63]
    ds_read_b128 v[36:39], v10 offset:45056
    s_add_u32 m0, s19, 118784
    v_mfma_f32_16x16x32_bf16 v[64:67], a[148:151], v[40:43], v[64:67]
    s_add_u32 s17, s20, 3434496
    buffer_load_dwordx4 v2, s[4:7], s17 offen lds
    s_waitcnt lgkmcnt(6)
    v_mfma_f32_16x16x32_bf16 v[52:55], a[152:155], v[44:47], v[52:55]
    ds_read_b128 v[40:43], v10 offset:45312
    v_mfma_f32_16x16x32_bf16 v[56:59], a[156:159], v[44:47], v[56:59]
    s_waitcnt lgkmcnt(6)
    v_mfma_f32_16x16x32_bf16 v[60:63], a[152:155], v[48:51], v[60:63]
    ds_read_b128 v[44:47], v11 offset:45056
    s_add_u32 m0, s19, 122880
    v_mfma_f32_16x16x32_bf16 v[64:67], a[156:159], v[48:51], v[64:67]
    s_add_u32 s17, s20, 3698688
    buffer_load_dwordx4 v2, s[4:7], s17 offen lds
    s_waitcnt lgkmcnt(6)
    v_mfma_f32_16x16x32_bf16 v[52:55], a[160:163], v[20:23], v[52:55]
    ds_read_b128 v[48:51], v11 offset:45312
    v_mfma_f32_16x16x32_bf16 v[56:59], a[164:167], v[20:23], v[56:59]
    s_waitcnt lgkmcnt(6)
    v_mfma_f32_16x16x32_bf16 v[60:63], a[160:163], v[24:27], v[60:63]
    ds_read_b128 v[20:23], v10 offset:49152
    s_add_u32 m0, s19, 126976
    v_mfma_f32_16x16x32_bf16 v[64:67], a[164:167], v[24:27], v[64:67]
    s_add_u32 s17, s20, 3962880
    buffer_load_dwordx4 v2, s[4:7], s17 offen lds
    s_waitcnt lgkmcnt(6)
    v_mfma_f32_16x16x32_bf16 v[52:55], a[168:171], v[28:31], v[52:55]
    ds_read_b128 v[24:27], v10 offset:49408
    v_mfma_f32_16x16x32_bf16 v[56:59], a[172:175], v[28:31], v[56:59]
    s_add_u32 s20, s20, s24
    s_waitcnt lgkmcnt(6)
    v_mfma_f32_16x16x32_bf16 v[60:63], a[168:171], v[32:35], v[60:63]
    ds_read_b128 v[28:31], v11 offset:49152
    v_mfma_f32_16x16x32_bf16 v[64:67], a[172:175], v[32:35], v[64:67]
    s_waitcnt lgkmcnt(6)
    v_mfma_f32_16x16x32_bf16 v[52:55], a[176:179], v[36:39], v[52:55]
    ds_read_b128 v[32:35], v11 offset:49408
    v_mfma_f32_16x16x32_bf16 v[56:59], a[180:183], v[36:39], v[56:59]
    s_waitcnt lgkmcnt(6)
    v_mfma_f32_16x16x32_bf16 v[60:63], a[176:179], v[40:43], v[60:63]
    ds_read_b128 v[36:39], v10 offset:53248
    v_mfma_f32_16x16x32_bf16 v[64:67], a[180:183], v[40:43], v[64:67]
    s_waitcnt lgkmcnt(6)
    v_mfma_f32_16x16x32_bf16 v[52:55], a[184:187], v[44:47], v[52:55]
    ds_read_b128 v[40:43], v10 offset:53504
    v_mfma_f32_16x16x32_bf16 v[56:59], a[188:191], v[44:47], v[56:59]
    s_waitcnt lgkmcnt(6)
    v_mfma_f32_16x16x32_bf16 v[60:63], a[184:187], v[48:51], v[60:63]
    ds_read_b128 v[44:47], v11 offset:53248
    v_mfma_f32_16x16x32_bf16 v[64:67], a[188:191], v[48:51], v[64:67]
    s_waitcnt lgkmcnt(6)
    v_mfma_f32_16x16x32_bf16 v[52:55], a[192:195], v[20:23], v[52:55]
    ds_read_b128 v[48:51], v11 offset:53504
    v_mfma_f32_16x16x32_bf16 v[56:59], a[196:199], v[20:23], v[56:59]
    s_waitcnt lgkmcnt(6)
    v_mfma_f32_16x16x32_bf16 v[60:63], a[192:195], v[24:27], v[60:63]
    ds_read_b128 v[20:23], v10 offset:57344
    v_mfma_f32_16x16x32_bf16 v[64:67], a[196:199], v[24:27], v[64:67]
    s_waitcnt lgkmcnt(6)
    v_mfma_f32_16x16x32_bf16 v[52:55], a[200:203], v[28:31], v[52:55]
    ds_read_b128 v[24:27], v10 offset:57600
    v_mfma_f32_16x16x32_bf16 v[56:59], a[204:207], v[28:31], v[56:59]
    s_waitcnt lgkmcnt(6)
    v_mfma_f32_16x16x32_bf16 v[60:63], a[200:203], v[32:35], v[60:63]
    ds_read_b128 v[28:31], v11 offset:57344
    v_mfma_f32_16x16x32_bf16 v[64:67], a[204:207], v[32:35], v[64:67]
    s_waitcnt lgkmcnt(6)
    v_mfma_f32_16x16x32_bf16 v[52:55], a[208:211], v[36:39], v[52:55]
    ds_read_b128 v[32:35], v11 offset:57600
    v_mfma_f32_16x16x32_bf16 v[56:59], a[212:215], v[36:39], v[56:59]
    s_waitcnt lgkmcnt(6)
    v_mfma_f32_16x16x32_bf16 v[60:63], a[208:211], v[40:43], v[60:63]
    ds_read_b128 v[36:39], v10 offset:61440
    v_mfma_f32_16x16x32_bf16 v[64:67], a[212:215], v[40:43], v[64:67]
    s_waitcnt lgkmcnt(6)
    v_mfma_f32_16x16x32_bf16 v[52:55], a[216:219], v[44:47], v[52:55]
    ds_read_b128 v[40:43], v10 offset:61696
    v_mfma_f32_16x16x32_bf16 v[56:59], a[220:223], v[44:47], v[56:59]
    s_waitcnt lgkmcnt(6)
    v_mfma_f32_16x16x32_bf16 v[60:63], a[216:219], v[48:51], v[60:63]
    ds_read_b128 v[44:47], v11 offset:61440
    v_mfma_f32_16x16x32_bf16 v[64:67], a[220:223], v[48:51], v[64:67]
    s_waitcnt lgkmcnt(6)
    v_mfma_f32_16x16x32_bf16 v[52:55], a[224:227], v[20:23], v[52:55]
    ds_read_b128 v[48:51], v11 offset:61696
    v_mfma_f32_16x16x32_bf16 v[56:59], a[228:231], v[20:23], v[56:59]
    s_waitcnt lgkmcnt(6)
    v_mfma_f32_16x16x32_bf16 v[60:63], a[224:227], v[24:27], v[60:63]
    s_waitcnt vmcnt(8)
    s_barrier
    ds_read_b128 v[20:23], v12 offset:0
    v_mfma_f32_16x16x32_bf16 v[64:67], a[228:231], v[24:27], v[64:67]
    s_waitcnt lgkmcnt(6)
    v_mfma_f32_16x16x32_bf16 v[52:55], a[232:235], v[28:31], v[52:55]
    ds_read_b128 v[24:27], v12 offset:256
    s_add_u32 m0, s19, 0
    v_mfma_f32_16x16x32_bf16 v[56:59], a[236:239], v[28:31], v[56:59]
    s_add_u32 s17, s20, 0
    buffer_load_dwordx4 v2, s[4:7], s17 offen lds
    s_waitcnt lgkmcnt(6)
    v_mfma_f32_16x16x32_bf16 v[60:63], a[232:235], v[32:35], v[60:63]
    ds_read_b128 v[28:31], v13 offset:0
    v_mfma_f32_16x16x32_bf16 v[64:67], a[236:239], v[32:35], v[64:67]
    s_waitcnt lgkmcnt(6)
    v_mfma_f32_16x16x32_bf16 v[52:55], a[240:243], v[36:39], v[52:55]
    ds_read_b128 v[32:35], v13 offset:256
    s_add_u32 m0, s19, 4096
    v_mfma_f32_16x16x32_bf16 v[56:59], a[244:247], v[36:39], v[56:59]
    s_add_u32 s17, s20, 264192
    buffer_load_dwordx4 v2, s[4:7], s17 offen lds
    s_waitcnt lgkmcnt(6)
    v_mfma_f32_16x16x32_bf16 v[60:63], a[240:243], v[40:43], v[60:63]
    ds_read_b128 v[36:39], v12 offset:4096
    v_mfma_f32_16x16x32_bf16 v[64:67], a[244:247], v[40:43], v[64:67]
    s_waitcnt lgkmcnt(6)
    v_mfma_f32_16x16x32_bf16 v[52:55], a[248:251], v[44:47], v[52:55]
    ds_read_b128 v[40:43], v12 offset:4352
    s_add_u32 m0, s19, 8192
    v_mfma_f32_16x16x32_bf16 v[56:59], a[252:255], v[44:47], v[56:59]
    s_add_u32 s17, s20, 528384
    buffer_load_dwordx4 v2, s[4:7], s17 offen lds
    s_waitcnt lgkmcnt(6)
    v_mfma_f32_16x16x32_bf16 v[60:63], a[248:251], v[48:51], v[60:63]
    ds_read_b128 v[44:47], v13 offset:4096
    v_mfma_f32_16x16x32_bf16 v[64:67], a[252:255], v[48:51], v[64:67]
    s_waitcnt lgkmcnt(6)
    v_mfma_f32_16x16x32_bf16 v[68:71], a[0:3], v[20:23], 0
    ds_read_b128 v[48:51], v13 offset:4352
    v_mfma_f32_16x16x32_bf16 v[72:75], a[4:7], v[20:23], 0
    s_waitcnt lgkmcnt(6)
    v_mfma_f32_16x16x32_bf16 v[76:79], a[0:3], v[24:27], 0
    ds_read_b128 v[20:23], v12 offset:8192
    s_add_u32 m0, s19, 12288
    v_mfma_f32_16x16x32_bf16 v[80:83], a[4:7], v[24:27], 0
    s_add_u32 s17, s20, 792576
    buffer_load_dwordx4 v2, s[4:7], s17 offen lds
    s_waitcnt lgkmcnt(6)
    v_mfma_f32_16x16x32_bf16 v[68:71], a[8:11], v[28:31], v[68:71]
    ds_read_b128 v[24:27], v12 offset:8448
    v_mfma_f32_16x16x32_bf16 v[72:75], a[12:15], v[28:31], v[72:75]
    s_waitcnt lgkmcnt(6)
    v_mfma_f32_16x16x32_bf16 v[76:79], a[8:11], v[32:35], v[76:79]
    ds_read_b128 v[28:31], v13 offset:8192
    s_add_u32 m0, s19, 16384
    v_mfma_f32_16x16x32_bf16 v[80:83], a[12:15], v[32:35], v[80:83]
    s_add_u32 s17, s20, 1056768
    buffer_load_dwordx4 v2, s[4:7], s17 offen lds
    s_waitcnt lgkmcnt(6)
    v_mfma_f32_16x16x32_bf16 v[68:71], a[16:19], v[36:39], v[68:71]
    ds_read_b128 v[32:35], v13 offset:8448
    v_mfma_f32_16x16x32_bf16 v[72:75], a[20:23], v[36:39], v[72:75]
    s_waitcnt lgkmcnt(6)
    v_mfma_f32_16x16x32_bf16 v[76:79], a[16:19], v[40:43], v[76:79]
    ds_read_b128 v[36:39], v12 offset:12288
    s_add_u32 m0, s19, 20480
    v_mfma_f32_16x16x32_bf16 v[80:83], a[20:23], v[40:43], v[80:83]
    s_add_u32 s17, s20, 1320960
    buffer_load_dwordx4 v2, s[4:7], s17 offen lds
    s_waitcnt lgkmcnt(6)
    v_mfma_f32_16x16x32_bf16 v[68:71], a[24:27], v[44:47], v[68:71]
    ds_read_b128 v[40:43], v12 offset:12544
    v_mfma_f32_16x16x32_bf16 v[72:75], a[28:31], v[44:47], v[72:75]
    s_waitcnt lgkmcnt(6)
    v_mfma_f32_16x16x32_bf16 v[76:79], a[24:27], v[48:51], v[76:79]
    ds_read_b128 v[44:47], v13 offset:12288
    s_add_u32 m0, s19, 24576
    v_mfma_f32_16x16x32_bf16 v[80:83], a[28:31], v[48:51], v[80:83]
    s_add_u32 s17, s20, 1585152
    buffer_load_dwordx4 v2, s[4:7], s17 offen lds
    s_waitcnt lgkmcnt(6)
    v_mfma_f32_16x16x32_bf16 v[68:71], a[32:35], v[20:23], v[68:71]
    ds_read_b128 v[48:51], v13 offset:12544
    v_mfma_f32_16x16x32_bf16 v[72:75], a[36:39], v[20:23], v[72:75]
    s_waitcnt lgkmcnt(6)
    v_mfma_f32_16x16x32_bf16 v[76:79], a[32:35], v[24:27], v[76:79]
    ds_read_b128 v[20:23], v12 offset:16384
    s_add_u32 m0, s19, 28672
    v_mfma_f32_16x16x32_bf16 v[80:83], a[36:39], v[24:27], v[80:83]
    s_add_u32 s17, s20, 1849344
    buffer_load_dwordx4 v2, s[4:7], s17 offen lds
    s_waitcnt lgkmcnt(6)
    v_mfma_f32_16x16x32_bf16 v[68:71], a[40:43], v[28:31], v[68:71]
    ds_read_b128 v[24:27], v12 offset:16640
    v_mfma_f32_16x16x32_bf16 v[72:75], a[44:47], v[28:31], v[72:75]
    v_cvt_pk_bf16_f32 v84, v52, v53
    s_waitcnt lgkmcnt(6)
    v_mfma_f32_16x16x32_bf16 v[76:79], a[40:43], v[32:35], v[76:79]
    ds_read_b128 v[28:31], v13 offset:16384
    v_mfma_f32_16x16x32_bf16 v[80:83], a[44:47], v[32:35], v[80:83]
    v_cvt_pk_bf16_f32 v85, v54, v55
    s_waitcnt lgkmcnt(6)
    v_mfma_f32_16x16x32_bf16 v[68:71], a[48:51], v[36:39], v[68:71]
    ds_read_b128 v[32:35], v13 offset:16640
    v_mfma_f32_16x16x32_bf16 v[72:75], a[52:55], v[36:39], v[72:75]
    v_cvt_pk_bf16_f32 v86, v56, v57
    s_waitcnt lgkmcnt(6)
    v_mfma_f32_16x16x32_bf16 v[76:79], a[48:51], v[40:43], v[76:79]
    ds_read_b128 v[36:39], v12 offset:20480
    v_mfma_f32_16x16x32_bf16 v[80:83], a[52:55], v[40:43], v[80:83]
    v_cvt_pk_bf16_f32 v87, v58, v59
    s_waitcnt lgkmcnt(6)
    v_mfma_f32_16x16x32_bf16 v[68:71], a[56:59], v[44:47], v[68:71]
    ds_read_b128 v[40:43], v12 offset:20736
    v_mfma_f32_16x16x32_bf16 v[72:75], a[60:63], v[44:47], v[72:75]
    v_cvt_pk_bf16_f32 v88, v60, v61
    s_waitcnt lgkmcnt(6)
    v_mfma_f32_16x16x32_bf16 v[76:79], a[56:59], v[48:51], v[76:79]
    ds_read_b128 v[44:47], v13 offset:20480
    v_mfma_f32_16x16x32_bf16 v[80:83], a[60:63], v[48:51], v[80:83]
    v_cvt_pk_bf16_f32 v89, v62, v63
    buffer_store_dwordx4 v[84:87], v3, s[12:15], s21 offen
    s_waitcnt lgkmcnt(6)
    v_mfma_f32_16x16x32_bf16 v[68:71], a[64:67], v[20:23], v[68:71]
    ds_read_b128 v[48:51], v13 offset:20736
    v_mfma_f32_16x16x32_bf16 v[72:75], a[68:71], v[20:23], v[72:75]
    v_cvt_pk_bf16_f32 v90, v64, v65
    s_waitcnt lgkmcnt(6)
    v_mfma_f32_16x16x32_bf16 v[76:79], a[64:67], v[24:27], v[76:79]
    ds_read_b128 v[20:23], v12 offset:24576
    v_mfma_f32_16x16x32_bf16 v[80:83], a[68:71], v[24:27], v[80:83]
    v_cvt_pk_bf16_f32 v91, v66, v67
    s_waitcnt lgkmcnt(6)
    v_mfma_f32_16x16x32_bf16 v[68:71], a[72:75], v[28:31], v[68:71]
    ds_read_b128 v[24:27], v12 offset:24832
    v_mfma_f32_16x16x32_bf16 v[72:75], a[76:79], v[28:31], v[72:75]
    s_waitcnt lgkmcnt(6)
    v_mfma_f32_16x16x32_bf16 v[76:79], a[72:75], v[32:35], v[76:79]
    ds_read_b128 v[28:31], v13 offset:24576
    v_mfma_f32_16x16x32_bf16 v[80:83], a[76:79], v[32:35], v[80:83]
    buffer_store_dwordx4 v[88:91], v4, s[12:15], s21 offen
    s_waitcnt lgkmcnt(6)
    v_mfma_f32_16x16x32_bf16 v[68:71], a[80:83], v[36:39], v[68:71]
    ds_read_b128 v[32:35], v13 offset:24832
    v_mfma_f32_16x16x32_bf16 v[72:75], a[84:87], v[36:39], v[72:75]
    s_add_u32 s21, s21, s25
    s_mov_b32 s25, s26
    s_waitcnt lgkmcnt(6)
    v_mfma_f32_16x16x32_bf16 v[76:79], a[80:83], v[40:43], v[76:79]
    ds_read_b128 v[36:39], v12 offset:28672
    v_mfma_f32_16x16x32_bf16 v[80:83], a[84:87], v[40:43], v[80:83]
    s_waitcnt lgkmcnt(6)
    v_mfma_f32_16x16x32_bf16 v[68:71], a[88:91], v[44:47], v[68:71]
    ds_read_b128 v[40:43], v12 offset:28928
    v_mfma_f32_16x16x32_bf16 v[72:75], a[92:95], v[44:47], v[72:75]
    s_waitcnt lgkmcnt(6)
    v_mfma_f32_16x16x32_bf16 v[76:79], a[88:91], v[48:51], v[76:79]
    ds_read_b128 v[44:47], v13 offset:28672
    v_mfma_f32_16x16x32_bf16 v[80:83], a[92:95], v[48:51], v[80:83]
    s_waitcnt lgkmcnt(6)
    v_mfma_f32_16x16x32_bf16 v[68:71], a[96:99], v[20:23], v[68:71]
    ds_read_b128 v[48:51], v13 offset:28928
    v_mfma_f32_16x16x32_bf16 v[72:75], a[100:103], v[20:23], v[72:75]
    s_waitcnt lgkmcnt(6)
    v_mfma_f32_16x16x32_bf16 v[76:79], a[96:99], v[24:27], v[76:79]
    s_waitcnt vmcnt(10)
    s_barrier
    ds_read_b128 v[20:23], v12 offset:32768
    v_mfma_f32_16x16x32_bf16 v[80:83], a[100:103], v[24:27], v[80:83]
    s_waitcnt lgkmcnt(6)
    v_mfma_f32_16x16x32_bf16 v[68:71], a[104:107], v[28:31], v[68:71]
    ds_read_b128 v[24:27], v12 offset:33024
    s_add_u32 m0, s19, 32768
    v_mfma_f32_16x16x32_bf16 v[72:75], a[108:111], v[28:31], v[72:75]
    s_add_u32 s17, s20, 2113536
    buffer_load_dwordx4 v2, s[4:7], s17 offen lds
    s_waitcnt lgkmcnt(6)
    v_mfma_f32_16x16x32_bf16 v[76:79], a[104:107], v[32:35], v[76:79]
    ds_read_b128 v[28:31], v13 offset:32768
    v_mfma_f32_16x16x32_bf16 v[80:83], a[108:111], v[32:35], v[80:83]
    s_waitcnt lgkmcnt(6)
    v_mfma_f32_16x16x32_bf16 v[68:71], a[112:115], v[36:39], v[68:71]
    ds_read_b128 v[32:35], v13 offset:33024
    s_add_u32 m0, s19, 36864
    v_mfma_f32_16x16x32_bf16 v[72:75], a[116:119], v[36:39], v[72:75]
    s_add_u32 s17, s20, 2377728
    buffer_load_dwordx4 v2, s[4:7], s17 offen lds
    s_waitcnt lgkmcnt(6)
    v_mfma_f32_16x16x32_bf16 v[76:79], a[112:115], v[40:43], v[76:79]
    ds_read_b128 v[36:39], v12 offset:36864
    v_mfma_f32_16x16x32_bf16 v[80:83], a[116:119], v[40:43], v[80:83]
    s_waitcnt lgkmcnt(6)
    v_mfma_f32_16x16x32_bf16 v[68:71], a[120:123], v[44:47], v[68:71]
    ds_read_b128 v[40:43], v12 offset:37120
    s_add_u32 m0, s19, 40960
    v_mfma_f32_16x16x32_bf16 v[72:75], a[124:127], v[44:47], v[72:75]
    s_add_u32 s17, s20, 2641920
    buffer_load_dwordx4 v2, s[4:7], s17 offen lds
    s_waitcnt lgkmcnt(6)
    v_mfma_f32_16x16x32_bf16 v[76:79], a[120:123], v[48:51], v[76:79]
    ds_read_b128 v[44:47], v13 offset:36864
    v_mfma_f32_16x16x32_bf16 v[80:83], a[124:127], v[48:51], v[80:83]
    s_waitcnt lgkmcnt(6)
    v_mfma_f32_16x16x32_bf16 v[68:71], a[128:131], v[20:23], v[68:71]
    ds_read_b128 v[48:51], v13 offset:37120
    v_mfma_f32_16x16x32_bf16 v[72:75], a[132:135], v[20:23], v[72:75]
    s_waitcnt lgkmcnt(6)
    v_mfma_f32_16x16x32_bf16 v[76:79], a[128:131], v[24:27], v[76:79]
    ds_read_b128 v[20:23], v12 offset:40960
    s_add_u32 m0, s19, 45056
    v_mfma_f32_16x16x32_bf16 v[80:83], a[132:135], v[24:27], v[80:83]
    s_add_u32 s17, s20, 2906112
    buffer_load_dwordx4 v2, s[4:7], s17 offen lds
    s_waitcnt lgkmcnt(6)
    v_mfma_f32_16x16x32_bf16 v[68:71], a[136:139], v[28:31], v[68:71]
    ds_read_b128 v[24:27], v12 offset:41216
    v_mfma_f32_16x16x32_bf16 v[72:75], a[140:143], v[28:31], v[72:75]
    s_waitcnt lgkmcnt(6)
    v_mfma_f32_16x16x32_bf16 v[76:79], a[136:139], v[32:35], v[76:79]
    ds_read_b128 v[28:31], v13 offset:40960
    s_add_u32 m0, s19, 49152
    v_mfma_f32_16x16x32_bf16 v[80:83], a[140:143], v[32:35], v[80:83]
    s_add_u32 s17, s20, 3170304
    buffer_load_dwordx4 v2, s[4:7], s17 offen lds
    s_waitcnt lgkmcnt(6)
    v_mfma_f32_16x16x32_bf16 v[68:71], a[144:147], v[36:39], v[68:71]
    ds_read_b128 v[32:35], v13 offset:41216
    v_mfma_f32_16x16x32_bf16 v[72:75], a[148:151], v[36:39], v[72:75]
    s_waitcnt lgkmcnt(6)
    v_mfma_f32_16x16x32_bf16 v[76:79], a[144:147], v[40:43], v[76:79]
    ds_read_b128 v[36:39], v12 offset:45056
    s_add_u32 m0, s19, 53248
    v_mfma_f32_16x16x32_bf16 v[80:83], a[148:151], v[40:43], v[80:83]
    s_add_u32 s17, s20, 3434496
    buffer_load_dwordx4 v2, s[4:7], s17 offen lds
    s_waitcnt lgkmcnt(6)
    v_mfma_f32_16x16x32_bf16 v[68:71], a[152:155], v[44:47], v[68:71]
    ds_read_b128 v[40:43], v12 offset:45312
    v_mfma_f32_16x16x32_bf16 v[72:75], a[156:159], v[44:47], v[72:75]
    s_waitcnt lgkmcnt(6)
    v_mfma_f32_16x16x32_bf16 v[76:79], a[152:155], v[48:51], v[76:79]
    ds_read_b128 v[44:47], v13 offset:45056
    s_add_u32 m0, s19, 57344
    v_mfma_f32_16x16x32_bf16 v[80:83], a[156:159], v[48:51], v[80:83]
    s_add_u32 s17, s20, 3698688
    buffer_load_dwordx4 v2, s[4:7], s17 offen lds
    s_waitcnt lgkmcnt(6)
    v_mfma_f32_16x16x32_bf16 v[68:71], a[160:163], v[20:23], v[68:71]
    ds_read_b128 v[48:51], v13 offset:45312
    v_mfma_f32_16x16x32_bf16 v[72:75], a[164:167], v[20:23], v[72:75]
    s_waitcnt lgkmcnt(6)
    v_mfma_f32_16x16x32_bf16 v[76:79], a[160:163], v[24:27], v[76:79]
    ds_read_b128 v[20:23], v12 offset:49152
    s_add_u32 m0, s19, 61440
    v_mfma_f32_16x16x32_bf16 v[80:83], a[164:167], v[24:27], v[80:83]
    s_add_u32 s17, s20, 3962880
    buffer_load_dwordx4 v2, s[4:7], s17 offen lds
    s_waitcnt lgkmcnt(6)
    v_mfma_f32_16x16x32_bf16 v[68:71], a[168:171], v[28:31], v[68:71]
    ds_read_b128 v[24:27], v12 offset:49408
    v_mfma_f32_16x16x32_bf16 v[72:75], a[172:175], v[28:31], v[72:75]
    s_add_u32 s20, s20, s24
    s_waitcnt lgkmcnt(6)
    v_mfma_f32_16x16x32_bf16 v[76:79], a[168:171], v[32:35], v[76:79]
    ds_read_b128 v[28:31], v13 offset:49152
    v_mfma_f32_16x16x32_bf16 v[80:83], a[172:175], v[32:35], v[80:83]
    s_waitcnt lgkmcnt(6)
    v_mfma_f32_16x16x32_bf16 v[68:71], a[176:179], v[36:39], v[68:71]
    ds_read_b128 v[32:35], v13 offset:49408
    v_mfma_f32_16x16x32_bf16 v[72:75], a[180:183], v[36:39], v[72:75]
    s_waitcnt lgkmcnt(6)
    v_mfma_f32_16x16x32_bf16 v[76:79], a[176:179], v[40:43], v[76:79]
    ds_read_b128 v[36:39], v12 offset:53248
    v_mfma_f32_16x16x32_bf16 v[80:83], a[180:183], v[40:43], v[80:83]
    s_waitcnt lgkmcnt(6)
    v_mfma_f32_16x16x32_bf16 v[68:71], a[184:187], v[44:47], v[68:71]
    ds_read_b128 v[40:43], v12 offset:53504
    v_mfma_f32_16x16x32_bf16 v[72:75], a[188:191], v[44:47], v[72:75]
    s_waitcnt lgkmcnt(6)
    v_mfma_f32_16x16x32_bf16 v[76:79], a[184:187], v[48:51], v[76:79]
    ds_read_b128 v[44:47], v13 offset:53248
    v_mfma_f32_16x16x32_bf16 v[80:83], a[188:191], v[48:51], v[80:83]
    s_waitcnt lgkmcnt(6)
    v_mfma_f32_16x16x32_bf16 v[68:71], a[192:195], v[20:23], v[68:71]
    ds_read_b128 v[48:51], v13 offset:53504
    v_mfma_f32_16x16x32_bf16 v[72:75], a[196:199], v[20:23], v[72:75]
    s_waitcnt lgkmcnt(6)
    v_mfma_f32_16x16x32_bf16 v[76:79], a[192:195], v[24:27], v[76:79]
    ds_read_b128 v[20:23], v12 offset:57344
    v_mfma_f32_16x16x32_bf16 v[80:83], a[196:199], v[24:27], v[80:83]
    s_waitcnt lgkmcnt(6)
    v_mfma_f32_16x16x32_bf16 v[68:71], a[200:203], v[28:31], v[68:71]
    ds_read_b128 v[24:27], v12 offset:57600
    v_mfma_f32_16x16x32_bf16 v[72:75], a[204:207], v[28:31], v[72:75]
    s_waitcnt lgkmcnt(6)
    v_mfma_f32_16x16x32_bf16 v[76:79], a[200:203], v[32:35], v[76:79]
    ds_read_b128 v[28:31], v13 offset:57344
    v_mfma_f32_16x16x32_bf16 v[80:83], a[204:207], v[32:35], v[80:83]
    s_waitcnt lgkmcnt(6)
    v_mfma_f32_16x16x32_bf16 v[68:71], a[208:211], v[36:39], v[68:71]
    ds_read_b128 v[32:35], v13 offset:57600
    v_mfma_f32_16x16x32_bf16 v[72:75], a[212:215], v[36:39], v[72:75]
    s_waitcnt lgkmcnt(6)
    v_mfma_f32_16x16x32_bf16 v[76:79], a[208:211], v[40:43], v[76:79]
    ds_read_b128 v[36:39], v12 offset:61440
    v_mfma_f32_16x16x32_bf16 v[80:83], a[212:215], v[40:43], v[80:83]
    s_waitcnt lgkmcnt(6)
    v_mfma_f32_16x16x32_bf16 v[68:71], a[216:219], v[44:47], v[68:71]
    ds_read_b128 v[40:43], v12 offset:61696
    v_mfma_f32_16x16x32_bf16 v[72:75], a[220:223], v[44:47], v[72:75]
    s_waitcnt lgkmcnt(6)
    v_mfma_f32_16x16x32_bf16 v[76:79], a[216:219], v[48:51], v[76:79]
    ds_read_b128 v[44:47], v13 offset:61440
    v_mfma_f32_16x16x32_bf16 v[80:83], a[220:223], v[48:51], v[80:83]
    s_waitcnt lgkmcnt(6)
    v_mfma_f32_16x16x32_bf16 v[68:71], a[224:227], v[20:23], v[68:71]
    ds_read_b128 v[48:51], v13 offset:61696
    v_mfma_f32_16x16x32_bf16 v[72:75], a[228:231], v[20:23], v[72:75]
    s_waitcnt lgkmcnt(6)
    v_mfma_f32_16x16x32_bf16 v[76:79], a[224:227], v[24:27], v[76:79]
    s_waitcnt vmcnt(8)
    s_barrier
    ds_read_b128 v[20:23], v10 offset:0
    v_mfma_f32_16x16x32_bf16 v[80:83], a[228:231], v[24:27], v[80:83]
    s_waitcnt lgkmcnt(6)
    v_mfma_f32_16x16x32_bf16 v[68:71], a[232:235], v[28:31], v[68:71]
    ds_read_b128 v[24:27], v10 offset:256
    s_add_u32 m0, s19, 65536
    v_mfma_f32_16x16x32_bf16 v[72:75], a[236:239], v[28:31], v[72:75]
    s_add_u32 s17, s20, 0
    buffer_load_dwordx4 v2, s[4:7], s17 offen lds
    s_waitcnt lgkmcnt(6)
    v_mfma_f32_16x16x32_bf16 v[76:79], a[232:235], v[32:35], v[76:79]
    ds_read_b128 v[28:31], v11 offset:0
    v_mfma_f32_16x16x32_bf16 v[80:83], a[236:239], v[32:35], v[80:83]
    s_waitcnt lgkmcnt(6)
    v_mfma_f32_16x16x32_bf16 v[68:71], a[240:243], v[36:39], v[68:71]
    ds_read_b128 v[32:35], v11 offset:256
    s_add_u32 m0, s19, 69632
    v_mfma_f32_16x16x32_bf16 v[72:75], a[244:247], v[36:39], v[72:75]
    s_add_u32 s17, s20, 264192
    buffer_load_dwordx4 v2, s[4:7], s17 offen lds
    s_waitcnt lgkmcnt(6)
    v_mfma_f32_16x16x32_bf16 v[76:79], a[240:243], v[40:43], v[76:79]
    ds_read_b128 v[36:39], v10 offset:4096
    v_mfma_f32_16x16x32_bf16 v[80:83], a[244:247], v[40:43], v[80:83]
    s_waitcnt lgkmcnt(6)
    v_mfma_f32_16x16x32_bf16 v[68:71], a[248:251], v[44:47], v[68:71]
    ds_read_b128 v[40:43], v10 offset:4352
    s_add_u32 m0, s19, 73728
    v_mfma_f32_16x16x32_bf16 v[72:75], a[252:255], v[44:47], v[72:75]
    s_add_u32 s17, s20, 528384
    buffer_load_dwordx4 v2, s[4:7], s17 offen lds
    s_waitcnt lgkmcnt(6)
    v_mfma_f32_16x16x32_bf16 v[76:79], a[248:251], v[48:51], v[76:79]
    ds_read_b128 v[44:47], v11 offset:4096
    v_mfma_f32_16x16x32_bf16 v[80:83], a[252:255], v[48:51], v[80:83]
    s_add_u32 s22, s22, 2
    s_cmp_lt_u32 s22, 16
    s_cbranch_scc1 F3_top
    v_cvt_pk_bf16_f32 v84, v68, v69
    v_cvt_pk_bf16_f32 v85, v70, v71
    v_cvt_pk_bf16_f32 v86, v72, v73
    v_cvt_pk_bf16_f32 v87, v74, v75
    v_cvt_pk_bf16_f32 v88, v76, v77
    v_cvt_pk_bf16_f32 v89, v78, v79
    v_cvt_pk_bf16_f32 v90, v80, v81
    v_cvt_pk_bf16_f32 v91, v82, v83
    buffer_store_dwordx4 v[84:87], v3, s[12:15], s21 offen
    buffer_store_dwordx4 v[88:91], v4, s[12:15], s21 offen
    s_waitcnt vmcnt(0) lgkmcnt(0)
    s_branch W_T
W_T:
    v_and_b32 v7, 19, v1
    v_bfe_u32 v5, v1, 2, 1
    v_bfe_u32 v6, v1, 3, 1
    v_lshl_add_u32 v7, v5, 3, v7
    v_lshl_add_u32 v7, v6, 2, v7
    v_lshrrev_b32 v5, 5, v1
    v_and_b32 v6, 31, v1
    v_lshlrev_b32 v8, 4, v5
    v_lshl_add_u32 v10, v6, 6, v8
    v_lshl_add_u32 v11, v7, 6, v8
    v_mov_b32 v17, 1073741824
    v_cmp_gt_u32 vcc, 8, v6
    s_nop 1
    v_cndmask_b32 v12, v17, v10, vcc
    v_lshlrev_b32 v13, 3, v5
    v_lshl_add_u32 v13, v7, 4, v13
    v_and_b32 v14, 15, v1
    v_lshlrev_b32 v14, 4, v14
    v_lshl_add_u32 v14, v5, 8, v14
    v_bfe_u32 v8, v1, 4, 1
    v_lshl_add_u32 v14, v8, 17, v14
    v_lshrrev_b32 v15, 2, v1
    v_and_b32 v8, 3, v1
    v_lshl_add_u32 v15, v15, 7, v8
    s_lshl_b32 s17, s93, 2
    v_add_u32 v15, s17, v15
    v_lshlrev_b32 v15, 7, v15
    v_add_u32 v15, 100663296, v15
    v_cmp_gt_u32 vcc, 16, v1
    s_nop 1
    v_cndmask_b32 v15, v17, v15, vcc
    v_mov_b32 v16, 0
    s_add_u32 s18, s16, s17
    s_lshl_b32 s18, s18, 7
    s_add_u32 s18, s18, 100728832
    v_lshl_add_u32 v4, v1, 2, s18
    v_cmp_gt_u32 vcc, 32, v1
    s_nop 1
    v_cndmask_b32 v4, v17, v4, vcc
    v_lshlrev_b32 v5, 3, v5
    v_sub_u32 v6, v6, v5
    s_mov_b32 s29, 1040356334
    s_mov_b32 s28, s16
    s_mul_i32 s31, s17, 133120
    s_lshl_b32 s18, s28, 11
    s_add_u32 s31, s31, s18
    s_mul_i32 s32, s17, 33280
    s_lshl_b32 s18, s28, 9
    s_add_u32 s32, s32, s18
    s_add_u32 s32, s32, 71303168
    s_lshl_b32 s33, s28, 18
    s_lshl_b32 s18, s93, 12
    s_add_u32 s33, s33, s18
    s_add_u32 s33, s33, 54525952
    v_mov_b32 v17, 0xff800000
    s_mov_b32 s35, 0
    v_mov_b32 v9, 0
    v_cmp_le_i32 s[36:37], 0, v6
    v_cmp_le_i32 s[38:39], 1, v6
    v_cmp_le_i32 s[40:41], 2, v6
    v_cmp_le_i32 s[42:43], 3, v6
    v_cmp_le_i32 s[44:45], 4, v6
    v_cmp_le_i32 s[46:47], 5, v6
    v_cmp_le_i32 s[48:49], 6, v6
    v_cmp_le_i32 s[50:51], 7, v6
    v_cmp_le_i32 s[52:53], 16, v6
    v_cmp_le_i32 s[54:55], 17, v6
    v_cmp_le_i32 s[56:57], 18, v6
    v_cmp_le_i32 s[58:59], 19, v6
    v_cmp_le_i32 s[60:61], 20, v6
    v_cmp_le_i32 s[62:63], 21, v6
    v_cmp_le_i32 s[64:65], 22, v6
    v_cmp_le_i32 s[66:67], 23, v6
    v_mov_b32 v54, 0
    v_mov_b32 v55, 0
    v_mov_b32 v58, 0
    v_mov_b32 v59, 0
    v_mov_b32 v62, 0
    v_mov_b32 v63, 0
    v_mov_b32 v66, 0
    v_mov_b32 v67, 0
    v_mov_b32 v102, 0
    v_mov_b32 v103, 0
    v_mov_b32 v106, 0
    v_mov_b32 v107, 0
    v_mov_b32 v110, 0
    v_mov_b32 v111, 0
    v_mov_b32 v114, 0
    v_mov_b32 v115, 0
    v_mov_b32 v158, 0
    v_mov_b32 v159, 0
    s_mov_b32 s30, s92
T_p:
    v_cmp_ge_u32 vcc, s28, v16
    s_nop 0
    s_and_b32 s17, vcc_lo, 4095
    s_cbranch_scc0 T_pk
    s_cmp_ge_u32 s30, 1048576
    s_cselect_b32 s92, 1048576, s92
    s_cbranch_scc1 T_pk
    s_add_u32 s30, s30, 1
    buffer_load_dword v16, v15, s[4:7], 0 offen sc1
    s_sleep 8
    s_waitcnt vmcnt(0)
    s_branch T_p
T_pk:
    s_add_u32 s17, s31, 0
    buffer_load_dwordx4 a[0:3], v10, s[4:7], s17 offen offset:0
    buffer_load_dwordx4 a[4:7], v10, s[4:7], s17 offen offset:32
    s_add_u32 s17, s31, 133120
    buffer_load_dwordx4 a[8:11], v10, s[4:7], s17 offen offset:0
    buffer_load_dwordx4 a[12:15], v10, s[4:7], s17 offen offset:32
    s_add_u32 s17, s31, 266240
    buffer_load_dwordx4 a[16:19], v10, s[4:7], s17 offen offset:0
    buffer_load_dwordx4 a[20:23], v10, s[4:7], s17 offen offset:32
    s_add_u32 s17, s31, 399360
    buffer_load_dwordx4 a[24:27], v10, s[4:7], s17 offen offset:0
    buffer_load_dwordx4 a[28:31], v10, s[4:7], s17 offen offset:32
    s_add_u32 s17, s31, 17825792
    buffer_load_dwordx4 a[32:35], v11, s[4:7], s17 offen offset:0
    buffer_load_dwordx4 a[36:39], v11, s[4:7], s17 offen offset:32
    s_add_u32 s17, s31, 17958912
    buffer_load_dwordx4 a[40:43], v11, s[4:7], s17 offen offset:0
    buffer_load_dwordx4 a[44:47], v11, s[4:7], s17 offen offset:32
    s_add_u32 s17, s31, 18092032
    buffer_load_dwordx4 a[48:51], v11, s[4:7], s17 offen offset:0
    buffer_load_dwordx4 a[52:55], v11, s[4:7], s17 offen offset:32
    s_add_u32 s17, s31, 18225152
    buffer_load_dwordx4 a[56:59], v11, s[4:7], s17 offen offset:0
    buffer_load_dwordx4 a[60:63], v11, s[4:7], s17 offen offset:32
    s_add_u32 s17, s31, 35651584
    buffer_load_dwordx4 a[64:67], v11, s[4:7], s17 offen offset:0
    buffer_load_dwordx4 a[68:71], v11, s[4:7], s17 offen offset:32
    s_add_u32 s17, s31, 35784704
    buffer_load_dwordx4 a[72:75], v11, s[4:7], s17 offen offset:0
    buffer_load_dwordx4 a[76:79], v11, s[4:7], s17 offen offset:32
    s_add_u32 s17, s31, 35917824
    buffer_load_dwordx4 a[80:83], v11, s[4:7], s17 offen offset:0
    buffer_load_dwordx4 a[84:87], v11, s[4:7], s17 offen offset:32
    s_add_u32 s17, s31, 36050944
    buffer_load_dwordx4 a[88:91], v11, s[4:7], s17 offen offset:0
    buffer_load_dwordx4 a[92:95], v11, s[4:7], s17 offen offset:32
T_top0:
    s_cmp_eq_u32 s35, 0
    s_cbranch_scc1 T_slow0
T_go0:
    s_add_u32 s34, s28, 4
    s_min_u32 s68, s34, 63
    s_waitcnt vmcnt(8)
    v_cmp_ge_u32 vcc, s68, v16
    s_nop 0
    s_and_b32 s17, vcc_lo, 0xfff
    s_cbranch_scc1 T_pw0
T_pok0:
    s_add_u32 s31, s31, 8192
    s_add_u32 s32, s32, 2048
    s_and_b32 s17, vcc_lo, 61440
    s_cselect_b32 s35, 0, 1
    s_cselect_b32 s69, 1073741824, s32
    s_cmp_lt_u32 s34, 64
    s_cselect_b32 s68, s31, 1073741824
    s_cselect_b32 s69, s69, 1073741824
    buffer_load_dword v16, v15, s[4:7], 0 offen sc1
    v_mfma_f32_32x32x16_bf16 v[116:131], a[32:35], a[0:3], 0
    s_add_u32 s17, s68, 0
    buffer_load_dwordx4 a[96:99], v10, s[4:7], s17 offen offset:0
    buffer_load_dwordx4 a[100:103], v10, s[4:7], s17 offen offset:32
    v_mfma_f32_32x32x16_bf16 v[116:131], a[36:39], a[4:7], v[116:131]
    s_add_u32 s17, s68, 133120
    buffer_load_dwordx4 a[104:107], v10, s[4:7], s17 offen offset:0
    buffer_load_dwordx4 a[108:111], v10, s[4:7], s17 offen offset:32
    v_mfma_f32_32x32x16_bf16 v[116:131], a[40:43], a[8:11], v[116:131]
    s_add_u32 s17, s68, 266240
    buffer_load_dwordx4 a[112:115], v10, s[4:7], s17 offen offset:0
    buffer_load_dwordx4 a[116:119], v10, s[4:7], s17 offen offset:32
    v_mfma_f32_32x32x16_bf16 v[116:131], a[44:47], a[12:15], v[116:131]
    s_add_u32 s17, s68, 399360
    buffer_load_dwordx4 a[120:123], v10, s[4:7], s17 offen offset:0
    buffer_load_dwordx4 a[124:127], v10, s[4:7], s17 offen offset:32
    v_mfma_f32_32x32x16_bf16 v[116:131], a[48:51], a[16:19], v[116:131]
    s_add_u32 s17, s68, 17825792
    buffer_load_dwordx4 a[128:131], v11, s[4:7], s17 offen offset:0
    buffer_load_dwordx4 a[132:135], v11, s[4:7], s17 offen offset:32
    v_mfma_f32_32x32x16_bf16 v[116:131], a[52:55], a[20:23], v[116:131]
    s_add_u32 s17, s68, 17958912
    buffer_load_dwordx4 a[136:139], v11, s[4:7], s17 offen offset:0
    buffer_load_dwordx4 a[140:143], v11, s[4:7], s17 offen offset:32
    v_mfma_f32_32x32x16_bf16 v[116:131], a[56:59], a[24:27], v[116:131]
    s_add_u32 s17, s68, 18092032
    buffer_load_dwordx4 a[144:147], v11, s[4:7], s17 offen offset:0
    buffer_load_dwordx4 a[148:151], v11, s[4:7], s17 offen offset:32
    v_mfma_f32_32x32x16_bf16 v[116:131], a[60:63], a[28:31], v[116:131]
    s_add_u32 s17, s68, 18225152
    buffer_load_dwordx4 a[152:155], v11, s[4:7], s17 offen offset:0
    buffer_load_dwordx4 a[156:159], v11, s[4:7], s17 offen offset:32
    v_mfma_f32_32x32x16_bf16 v[132:147], v[20:23], a[0:3], 0
    s_add_u32 s17, s68, 35651584
    buffer_load_dwordx4 a[160:163], v11, s[4:7], s17 offen offset:0
    buffer_load_dwordx4 a[164:167], v11, s[4:7], s17 offen offset:32
    v_mfma_f32_32x32x16_bf16 v[132:147], v[24:27], a[4:7], v[132:147]
    s_add_u32 s17, s68, 35784704
    buffer_load_dwordx4 a[168:171], v11, s[4:7], s17 offen offset:0
    buffer_load_dwordx4 a[172:175], v11, s[4:7], s17 offen offset:32
    v_mfma_f32_32x32x16_bf16 v[132:147], v[28:31], a[8:11], v[132:147]
    s_add_u32 s17, s68, 35917824
    buffer_load_dwordx4 a[176:179], v11, s[4:7], s17 offen offset:0
    buffer_load_dwordx4 a[180:183], v11, s[4:7], s17 offen offset:32
    v_mfma_f32_32x32x16_bf16 v[132:147], v[32:35], a[12:15], v[132:147]
    s_add_u32 s17, s68, 36050944
    buffer_load_dwordx4 a[184:187], v11, s[4:7], s17 offen offset:0
    buffer_load_dwordx4 a[188:191], v11, s[4:7], s17 offen offset:32
    v_mfma_f32_32x32x16_bf16 v[132:147], v[36:39], a[16:19], v[132:147]
    s_add_u32 s17, s69, 0
    s_add_u32 s18, s69, 5242880
    buffer_load_dwordx4 v[68:71], v12, s[4:7], s17 offen offset:0
    buffer_load_dwordx4 v[72:75], v12, s[4:7], s17 offen offset:32
    buffer_load_dwordx2 v[100:101], v13, s[4:7], s18 offen
    v_mfma_f32_32x32x16_bf16 v[132:147], v[40:43], a[20:23], v[132:147]
    s_add_u32 s17, s69, 33280
    s_add_u32 s18, s69, 5276160
    buffer_load_dwordx4 v[76:79], v12, s[4:7], s17 offen offset:0
    buffer_load_dwordx4 v[80:83], v12, s[4:7], s17 offen offset:32
    buffer_load_dwordx2 v[104:105], v13, s[4:7], s18 offen
    v_mfma_f32_32x32x16_bf16 v[132:147], v[44:47], a[24:27], v[132:147]
    s_add_u32 s17, s69, 66560
    s_add_u32 s18, s69, 5309440
    buffer_load_dwordx4 v[84:87], v12, s[4:7], s17 offen offset:0
    buffer_load_dwordx4 v[88:91], v12, s[4:7], s17 offen offset:32
    buffer_load_dwordx2 v[108:109], v13, s[4:7], s18 offen
    v_mfma_f32_32x32x16_bf16 v[132:147], v[48:51], a[28:31], v[132:147]
    s_add_u32 s17, s69, 99840
    s_add_u32 s18, s69, 5342720
    buffer_load_dwordx4 v[92:95], v12, s[4:7], s17 offen offset:0
    buffer_load_dwordx4 v[96:99], v12, s[4:7], s17 offen offset:32
    buffer_load_dwordx2 v[112:113], v13, s[4:7], s18 offen
    v_cndmask_b32 v116, v17, v116, s[36:37]
    v_cndmask_b32 v117, v17, v117, s[38:39]
    v_cndmask_b32 v118, v17, v118, s[40:41]
    v_cndmask_b32 v119, v17, v119, s[42:43]
    v_cndmask_b32 v120, v17, v120, s[44:45]
    v_cndmask_b32 v121, v17, v121, s[46:47]
    v_cndmask_b32 v122, v17, v122, s[48:49]
    v_cndmask_b32 v123, v17, v123, s[50:51]
    v_cndmask_b32 v124, v17, v124, s[52:53]
    v_cndmask_b32 v125, v17, v125, s[54:55]
    v_cndmask_b32 v126, v17, v126, s[56:57]
    v_cndmask_b32 v127, v17, v127, s[58:59]
    v_cndmask_b32 v128, v17, v128, s[60:61]
    v_cndmask_b32 v129, v17, v129, s[62:63]
    v_cndmask_b32 v130, v17, v130, s[64:65]
    v_cndmask_b32 v131, v17, v131, s[66:67]
    v_max3_f32 v18, v116, v117, v118
    v_max3_f32 v18, v18, v119, v120
    v_max3_f32 v18, v18, v121, v122
    v_max3_f32 v18, v18, v123, v124
    v_max3_f32 v18, v18, v125, v126
    v_max3_f32 v18, v18, v127, v128
    v_max3_f32 v18, v18, v129, v130
    v_max3_f32 v18, v18, v131, v132
    v_max3_f32 v18, v18, v133, v134
    v_max_f32 v18, v18, v135
    v_mov_b32 v5, v18
    s_nop 1
    v_permlane32_swap_b32 v18, v5
    v_max_f32 v18, v18, v5
    v_mul_f32 v18, s29, v18
    v_fma_f32 v116, v116, s29, -v18
    v_fma_f32 v117, v117, s29, -v18
    v_fma_f32 v118, v118, s29, -v18
    v_fma_f32 v119, v119, s29, -v18
    v_fma_f32 v120, v120, s29, -v18
    v_fma_f32 v121, v121, s29, -v18
    v_fma_f32 v122, v122, s29, -v18
    v_fma_f32 v123, v123, s29, -v18
    v_fma_f32 v124, v124, s29, -v18
    v_fma_f32 v125, v125, s29, -v18
    v_fma_f32 v126, v126, s29, -v18
    v_fma_f32 v127, v127, s29, -v18
    v_fma_f32 v128, v128, s29, -v18
    v_fma_f32 v129, v129, s29, -v18
    v_fma_f32 v130, v130, s29, -v18
    v_fma_f32 v131, v131, s29, -v18
    v_fma_f32 v132, v132, s29, -v18
    v_fma_f32 v133, v133, s29, -v18
    v_fma_f32 v134, v134, s29, -v18
    v_fma_f32 v135, v135, s29, -v18
    v_exp_f32 v116, v116
    v_exp_f32 v117, v117
    v_exp_f32 v118, v118
    v_exp_f32 v119, v119
    v_exp_f32 v120, v120
    v_exp_f32 v121, v121
    v_exp_f32 v122, v122
    v_exp_f32 v123, v123
    v_exp_f32 v124, v124
    v_exp_f32 v125, v125
    v_exp_f32 v126, v126
    v_exp_f32 v127, v127
    v_exp_f32 v128, v128
    v_exp_f32 v129, v129
    v_exp_f32 v130, v130
    v_exp_f32 v131, v131
    v_exp_f32 v132, v132
    v_exp_f32 v133, v133
    v_exp_f32 v134, v134
    v_exp_f32 v135, v135
    s_waitcnt vmcnt(37)
    buffer_store_dword v9, v4, s[4:7], 0 offen sc1
    v_add_f32 v19, v116, v117
    v_add_f32 v6, v118, v119
    v_add_f32 v19, v19, v120
    v_add_f32 v6, v6, v121
    v_add_f32 v19, v19, v122
    v_add_f32 v6, v6, v123
    v_add_f32 v19, v19, v124
    v_add_f32 v6, v6, v125
    v_add_f32 v19, v19, v126
    v_add_f32 v6, v6, v127
    v_add_f32 v19, v19, v128
    v_add_f32 v6, v6, v129
    v_add_f32 v19, v19, v130
    v_add_f32 v6, v6, v131
    v_add_f32 v19, v19, v132
    v_add_f32 v6, v6, v133
    v_add_f32 v19, v19, v134
    v_add_f32 v6, v6, v135
    v_add_f32 v19, v19, v6
    v_mov_b32 v5, v19
    s_nop 1
    v_permlane32_swap_b32 v19, v5
    v_add_f32 v19, v19, v5
    v_rcp_f32 v19, v19
    s_nop 0
    v_mul_f32 v116, v116, v19
    v_mul_f32 v117, v117, v19
    v_mul_f32 v118, v118, v19
    v_mul_f32 v119, v119, v19
    v_mul_f32 v120, v120, v19
    v_mul_f32 v121, v121, v19
    v_mul_f32 v122, v122, v19
    v_mul_f32 v123, v123, v19
    v_mul_f32 v124, v124, v19
    v_mul_f32 v125, v125, v19
    v_mul_f32 v126, v126, v19
    v_mul_f32 v127, v127, v19
    v_mul_f32 v128, v128, v19
    v_mul_f32 v129, v129, v19
    v_mul_f32 v130, v130, v19
    v_mul_f32 v131, v131, v19
    v_mul_f32 v132, v132, v19
    v_mul_f32 v133, v133, v19
    v_mul_f32 v134, v134, v19
    v_mul_f32 v135, v135, v19
    v_cvt_pk_bf16_f32 v148, v116, v117
    v_cvt_pk_bf16_f32 v149, v118, v119
    v_cvt_pk_bf16_f32 v150, v120, v121
    v_cvt_pk_bf16_f32 v151, v122, v123
    v_cvt_pk_bf16_f32 v152, v124, v125
    v_cvt_pk_bf16_f32 v153, v126, v127
    v_cvt_pk_bf16_f32 v154, v128, v129
    v_cvt_pk_bf16_f32 v155, v130, v131
    v_cvt_pk_bf16_f32 v156, v132, v133
    v_cvt_pk_bf16_f32 v157, v134, v135
    v_mfma_f32_32x32x16_bf16 v[160:175], a[64:67], v[148:151], 0
    v_mfma_f32_32x32x16_bf16 v[160:175], a[68:71], v[152:155], v[160:175]
    v_mfma_f32_32x32x16_bf16 v[160:175], v[52:55], v[156:159], v[160:175]
    v_mfma_f32_32x32x16_bf16 v[176:191], a[72:75], v[148:151], 0
    v_mfma_f32_32x32x16_bf16 v[176:191], a[76:79], v[152:155], v[176:191]
    v_mfma_f32_32x32x16_bf16 v[176:191], v[56:59], v[156:159], v[176:191]
    s_nop 2
    v_cvt_pk_bf16_f32 v224, v160, v161
    v_cvt_pk_bf16_f32 v225, v162, v163
    v_cvt_pk_bf16_f32 v226, v164, v165
    v_cvt_pk_bf16_f32 v227, v166, v167
    v_cvt_pk_bf16_f32 v228, v168, v169
    v_cvt_pk_bf16_f32 v229, v170, v171
    v_cvt_pk_bf16_f32 v230, v172, v173
    v_cvt_pk_bf16_f32 v231, v174, v175
    buffer_store_dwordx4 v[224:227], v14, s[4:7], s33 offen offset:0 sc1
    buffer_store_dwordx4 v[228:231], v14, s[4:7], s33 offen offset:512 sc1
    v_mfma_f32_32x32x16_bf16 v[192:207], a[80:83], v[148:151], 0
    v_mfma_f32_32x32x16_bf16 v[192:207], a[84:87], v[152:155], v[192:207]
    v_mfma_f32_32x32x16_bf16 v[192:207], v[60:63], v[156:159], v[192:207]
    v_cvt_pk_bf16_f32 v232, v176, v177
    v_cvt_pk_bf16_f32 v233, v178, v179
    v_cvt_pk_bf16_f32 v234, v180, v181
    v_cvt_pk_bf16_f32 v235, v182, v183
    v_cvt_pk_bf16_f32 v236, v184, v185
    v_cvt_pk_bf16_f32 v237, v186, v187
    v_cvt_pk_bf16_f32 v238, v188, v189
    v_cvt_pk_bf16_f32 v239, v190, v191
    buffer_store_dwordx4 v[232:235], v14, s[4:7], s33 offen offset:1024 sc1
    buffer_store_dwordx4 v[236:239], v14, s[4:7], s33 offen offset:1536 sc1
    v_mfma_f32_32x32x16_bf16 v[208:223], a[88:91], v[148:151], 0
    v_mfma_f32_32x32x16_bf16 v[208:223], a[92:95], v[152:155], v[208:223]
    v_mfma_f32_32x32x16_bf16 v[208:223], v[64:67], v[156:159], v[208:223]
    v_cvt_pk_bf16_f32 v240, v192, v193
    v_cvt_pk_bf16_f32 v241, v194, v195
    v_cvt_pk_bf16_f32 v242, v196, v197
    v_cvt_pk_bf16_f32 v243, v198, v199
    v_cvt_pk_bf16_f32 v244, v200, v201
    v_cvt_pk_bf16_f32 v245, v202, v203
    v_cvt_pk_bf16_f32 v246, v204, v205
    v_cvt_pk_bf16_f32 v247, v206, v207
    buffer_store_dwordx4 v[240:243], v14, s[4:7], s33 offen offset:2048 sc1
    buffer_store_dwordx4 v[244:247], v14, s[4:7], s33 offen offset:2560 sc1
    v_add_u32 v9, 1, v9
    s_nop 0
    v_cvt_pk_bf16_f32 v248, v208, v209
    v_cvt_pk_bf16_f32 v249, v210, v211
    v_cvt_pk_bf16_f32 v250, v212, v213
    v_cvt_pk_bf16_f32 v251, v214, v215
    v_cvt_pk_bf16_f32 v252, v216, v217
    v_cvt_pk_bf16_f32 v253, v218, v219
    v_cvt_pk_bf16_f32 v254, v220, v221
    v_cvt_pk_bf16_f32 v255, v222, v223
    buffer_store_dwordx4 v[248:251], v14, s[4:7], s33 offen offset:3072 sc1
    buffer_store_dwordx4 v[252:255], v14, s[4:7], s33 offen offset:3584 sc1
    s_mov_b32 s28, s34
    s_add_u32 s33, s33, 1048576
T_top1:
    s_cmp_eq_u32 s35, 0
    s_cbranch_scc1 T_slow1
T_go1:
    s_add_u32 s34, s28, 4
    s_min_u32 s68, s34, 63
    s_waitcnt vmcnt(8)
    v_cmp_ge_u32 vcc, s68, v16
    s_nop 0
    s_and_b32 s17, vcc_lo, 0xfff
    s_cbranch_scc1 T_pw1
T_pok1:
    s_add_u32 s31, s31, 8192
    s_add_u32 s32, s32, 2048
    s_and_b32 s17, vcc_lo, 61440
    s_cselect_b32 s35, 0, 1
    s_cselect_b32 s69, 1073741824, s32
    s_cmp_lt_u32 s34, 64
    s_cselect_b32 s68, s31, 1073741824
    s_cselect_b32 s69, s69, 1073741824
    buffer_load_dword v16, v15, s[4:7], 0 offen sc1
    v_mfma_f32_32x32x16_bf16 v[116:131], a[128:131], a[96:99], 0
    s_add_u32 s17, s68, 0
    buffer_load_dwordx4 a[0:3], v10, s[4:7], s17 offen offset:0
    buffer_load_dwordx4 a[4:7], v10, s[4:7], s17 offen offset:32
    v_mfma_f32_32x32x16_bf16 v[116:131], a[132:135], a[100:103], v[116:131]
    s_add_u32 s17, s68, 133120
    buffer_load_dwordx4 a[8:11], v10, s[4:7], s17 offen offset:0
    buffer_load_dwordx4 a[12:15], v10, s[4:7], s17 offen offset:32
    v_mfma_f32_32x32x16_bf16 v[116:131], a[136:139], a[104:107], v[116:131]
    s_add_u32 s17, s68, 266240
    buffer_load_dwordx4 a[16:19], v10, s[4:7], s17 offen offset:0
    buffer_load_dwordx4 a[20:23], v10, s[4:7], s17 offen offset:32
    v_mfma_f32_32x32x16_bf16 v[116:131], a[140:143], a[108:111], v[116:131]
    s_add_u32 s17, s68, 399360
    buffer_load_dwordx4 a[24:27], v10, s[4:7], s17 offen offset:0
    buffer_load_dwordx4 a[28:31], v10, s[4:7], s17 offen offset:32
    v_mfma_f32_32x32x16_bf16 v[116:131], a[144:147], a[112:115], v[116:131]
    s_add_u32 s17, s68, 17825792
    buffer_load_dwordx4 a[32:35], v11, s[4:7], s17 offen offset:0
    buffer_load_dwordx4 a[36:39], v11, s[4:7], s17 offen offset:32
    v_mfma_f32_32x32x16_bf16 v[116:131], a[148:151], a[116:119], v[116:131]
    s_add_u32 s17, s68, 17958912
    buffer_load_dwordx4 a[40:43], v11, s[4:7], s17 offen offset:0
    buffer_load_dwordx4 a[44:47], v11, s[4:7], s17 offen offset:32
    v_mfma_f32_32x32x16_bf16 v[116:131], a[152:155], a[120:123], v[116:131]
    s_add_u32 s17, s68, 18092032
    buffer_load_dwordx4 a[48:51], v11, s[4:7], s17 offen offset:0
    buffer_load_dwordx4 a[52:55], v11, s[4:7], s17 offen offset:32
    v_mfma_f32_32x32x16_bf16 v[116:131], a[156:159], a[124:127], v[116:131]
    s_add_u32 s17, s68, 18225152
    buffer_load_dwordx4 a[56:59], v11, s[4:7], s17 offen offset:0
    buffer_load_dwordx4 a[60:63], v11, s[4:7], s17 offen offset:32
    v_mfma_f32_32x32x16_bf16 v[132:147], v[68:71], a[96:99], 0
    s_add_u32 s17, s68, 35651584
    buffer_load_dwordx4 a[64:67], v11, s[4:7], s17 offen offset:0
    buffer_load_dwordx4 a[68:71], v11, s[4:7], s17 offen offset:32
    v_mfma_f32_32x32x16_bf16 v[132:147], v[72:75], a[100:103], v[132:147]
    s_add_u32 s17, s68, 35784704
    buffer_load_dwordx4 a[72:75], v11, s[4:7], s17 offen offset:0
    buffer_load_dwordx4 a[76:79], v11, s[4:7], s17 offen offset:32
    v_mfma_f32_32x32x16_bf16 v[132:147], v[76:79], a[104:107], v[132:147]
    s_add_u32 s17, s68, 35917824
    buffer_load_dwordx4 a[80:83], v11, s[4:7], s17 offen offset:0
    buffer_load_dwordx4 a[84:87], v11, s[4:7], s17 offen offset:32
    v_mfma_f32_32x32x16_bf16 v[132:147], v[80:83], a[108:111], v[132:147]
    s_add_u32 s17, s68, 36050944
    buffer_load_dwordx4 a[88:91], v11, s[4:7], s17 offen offset:0
    buffer_load_dwordx4 a[92:95], v11, s[4:7], s17 offen offset:32
    v_mfma_f32_32x32x16_bf16 v[132:147], v[84:87], a[112:115], v[132:147]
    s_add_u32 s17, s69, 0
    s_add_u32 s18, s69, 5242880
    buffer_load_dwordx4 v[20:23], v12, s[4:7], s17 offen offset:0
    buffer_load_dwordx4 v[24:27], v12, s[4:7], s17 offen offset:32
    buffer_load_dwordx2 v[52:53], v13, s[4:7], s18 offen
    v_mfma_f32_32x32x16_bf16 v[132:147], v[88:91], a[116:119], v[132:147]
    s_add_u32 s17, s69, 33280
    s_add_u32 s18, s69, 5276160
    buffer_load_dwordx4 v[28:31], v12, s[4:7], s17 offen offset:0
    buffer_load_dwordx4 v[32:35], v12, s[4:7], s17 offen offset:32
    buffer_load_dwordx2 v[56:57], v13, s[4:7], s18 offen
    v_mfma_f32_32x32x16_bf16 v[132:147], v[92:95], a[120:123], v[132:147]
    s_add_u32 s17, s69, 66560
    s_add_u32 s18, s69, 5309440
    buffer_load_dwordx4 v[36:39], v12, s[4:7], s17 offen offset:0
    buffer_load_dwordx4 v[40:43], v12, s[4:7], s17 offen offset:32
    buffer_load_dwordx2 v[60:61], v13, s[4:7], s18 offen
    v_mfma_f32_32x32x16_bf16 v[132:147], v[96:99], a[124:127], v[132:147]
    s_add_u32 s17, s69, 99840
    s_add_u32 s18, s69, 5342720
    buffer_load_dwordx4 v[44:47], v12, s[4:7], s17 offen offset:0
    buffer_load_dwordx4 v[48:51], v12, s[4:7], s17 offen offset:32
    buffer_load_dwordx2 v[64:65], v13, s[4:7], s18 offen
    v_cndmask_b32 v116, v17, v116, s[36:37]
    v_cndmask_b32 v117, v17, v117, s[38:39]
    v_cndmask_b32 v118, v17, v118, s[40:41]
    v_cndmask_b32 v119, v17, v119, s[42:43]
    v_cndmask_b32 v120, v17, v120, s[44:45]
    v_cndmask_b32 v121, v17, v121, s[46:47]
    v_cndmask_b32 v122, v17, v122, s[48:49]
    v_cndmask_b32 v123, v17, v123, s[50:51]
    v_cndmask_b32 v124, v17, v124, s[52:53]
    v_cndmask_b32 v125, v17, v125, s[54:55]
    v_cndmask_b32 v126, v17, v126, s[56:57]
    v_cndmask_b32 v127, v17, v127, s[58:59]
    v_cndmask_b32 v128, v17, v128, s[60:61]
    v_cndmask_b32 v129, v17, v129, s[62:63]
    v_cndmask_b32 v130, v17, v130, s[64:65]
    v_cndmask_b32 v131, v17, v131, s[66:67]
    v_max3_f32 v18, v116, v117, v118
    v_max3_f32 v18, v18, v119, v120
    v_max3_f32 v18, v18, v121, v122
    v_max3_f32 v18, v18, v123, v124
    v_max3_f32 v18, v18, v125, v126
    v_max3_f32 v18, v18, v127, v128
    v_max3_f32 v18, v18, v129, v130
    v_max3_f32 v18, v18, v131, v132
    v_max3_f32 v18, v18, v133, v134
    v_max_f32 v18, v18, v135
    v_mov_b32 v5, v18
    s_nop 1
    v_permlane32_swap_b32 v18, v5
    v_max_f32 v18, v18, v5
    v_mul_f32 v18, s29, v18
    v_fma_f32 v116, v116, s29, -v18
    v_fma_f32 v117, v117, s29, -v18
    v_fma_f32 v118, v118, s29, -v18
    v_fma_f32 v119, v119, s29, -v18
    v_fma_f32 v120, v120, s29, -v18
    v_fma_f32 v121, v121, s29, -v18
    v_fma_f32 v122, v122, s29, -v18
    v_fma_f32 v123, v123, s29, -v18
    v_fma_f32 v124, v124, s29, -v18
    v_fma_f32 v125, v125, s29, -v18
    v_fma_f32 v126, v126, s29, -v18
    v_fma_f32 v127, v127, s29, -v18
    v_fma_f32 v128, v128, s29, -v18
    v_fma_f32 v129, v129, s29, -v18
    v_fma_f32 v130, v130, s29, -v18
    v_fma_f32 v131, v131, s29, -v18
    v_fma_f32 v132, v132, s29, -v18
    v_fma_f32 v133, v133, s29, -v18
    v_fma_f32 v134, v134, s29, -v18
    v_fma_f32 v135, v135, s29, -v18
    v_exp_f32 v116, v116
    v_exp_f32 v117, v117
    v_exp_f32 v118, v118
    v_exp_f32 v119, v119
    v_exp_f32 v120, v120
    v_exp_f32 v121, v121
    v_exp_f32 v122, v122
    v_exp_f32 v123, v123
    v_exp_f32 v124, v124
    v_exp_f32 v125, v125
    v_exp_f32 v126, v126
    v_exp_f32 v127, v127
    v_exp_f32 v128, v128
    v_exp_f32 v129, v129
    v_exp_f32 v130, v130
    v_exp_f32 v131, v131
    v_exp_f32 v132, v132
    v_exp_f32 v133, v133
    v_exp_f32 v134, v134
    v_exp_f32 v135, v135
    s_waitcnt vmcnt(37)
    buffer_store_dword v9, v4, s[4:7], 0 offen sc1
    v_add_f32 v19, v116, v117
    v_add_f32 v6, v118, v119
    v_add_f32 v19, v19, v120
    v_add_f32 v6, v6, v121
    v_add_f32 v19, v19, v122
    v_add_f32 v6, v6, v123
    v_add_f32 v19, v19, v124
    v_add_f32 v6, v6, v125
    v_add_f32 v19, v19, v126
    v_add_f32 v6, v6, v127
    v_add_f32 v19, v19, v128
    v_add_f32 v6, v6, v129
    v_add_f32 v19, v19, v130
    v_add_f32 v6, v6, v131
    v_add_f32 v19, v19, v132
    v_add_f32 v6, v6, v133
    v_add_f32 v19, v19, v134
    v_add_f32 v6, v6, v135
    v_add_f32 v19, v19, v6
    v_mov_b32 v5, v19
    s_nop 1
    v_permlane32_swap_b32 v19, v5
    v_add_f32 v19, v19, v5
    v_rcp_f32 v19, v19
    s_nop 0
    v_mul_f32 v116, v116, v19
    v_mul_f32 v117, v117, v19
    v_mul_f32 v118, v118, v19
    v_mul_f32 v119, v119, v19
    v_mul_f32 v120, v120, v19
    v_mul_f32 v121, v121, v19
    v_mul_f32 v122, v122, v19
    v_mul_f32 v123, v123, v19
    v_mul_f32 v124, v124, v19
    v_mul_f32 v125, v125, v19
    v_mul_f32 v126, v126, v19
    v_mul_f32 v127, v127, v19
    v_mul_f32 v128, v128, v19
    v_mul_f32 v129, v129, v19
    v_mul_f32 v130, v130, v19
    v_mul_f32 v131, v131, v19
    v_mul_f32 v132, v132, v19
    v_mul_f32 v133, v133, v19
    v_mul_f32 v134, v134, v19
    v_mul_f32 v135, v135, v19
    v_cvt_pk_bf16_f32 v148, v116, v117
    v_cvt_pk_bf16_f32 v149, v118, v119
    v_cvt_pk_bf16_f32 v150, v120, v121
    v_cvt_pk_bf16_f32 v151, v122, v123
    v_cvt_pk_bf16_f32 v152, v124, v125
    v_cvt_pk_bf16_f32 v153, v126, v127
    v_cvt_pk_bf16_f32 v154, v128, v129
    v_cvt_pk_bf16_f32 v155, v130, v131
    v_cvt_pk_bf16_f32 v156, v132, v133
    v_cvt_pk_bf16_f32 v157, v134, v135
    v_mfma_f32_32x32x16_bf16 v[160:175], a[160:163], v[148:151], 0
    v_mfma_f32_32x32x16_bf16 v[160:175], a[164:167], v[152:155], v[160:175]
    v_mfma_f32_32x32x16_bf16 v[160:175], v[100:103], v[156:159], v[160:175]
    v_mfma_f32_32x32x16_bf16 v[176:191], a[168:171], v[148:151], 0
    v_mfma_f32_32x32x16_bf16 v[176:191], a[172:175], v[152:155], v[176:191]
    v_mfma_f32_32x32x16_bf16 v[176:191], v[104:107], v[156:159], v[176:191]
    s_nop 2
    v_cvt_pk_bf16_f32 v224, v160, v161
    v_cvt_pk_bf16_f32 v225, v162, v163
    v_cvt_pk_bf16_f32 v226, v164, v165
    v_cvt_pk_bf16_f32 v227, v166, v167
    v_cvt_pk_bf16_f32 v228, v168, v169
    v_cvt_pk_bf16_f32 v229, v170, v171
    v_cvt_pk_bf16_f32 v230, v172, v173
    v_cvt_pk_bf16_f32 v231, v174, v175
    buffer_store_dwordx4 v[224:227], v14, s[4:7], s33 offen offset:0 sc1
    buffer_store_dwordx4 v[228:231], v14, s[4:7], s33 offen offset:512 sc1
    v_mfma_f32_32x32x16_bf16 v[192:207], a[176:179], v[148:151], 0
    v_mfma_f32_32x32x16_bf16 v[192:207], a[180:183], v[152:155], v[192:207]
    v_mfma_f32_32x32x16_bf16 v[192:207], v[108:111], v[156:159], v[192:207]
    v_cvt_pk_bf16_f32 v232, v176, v177
    v_cvt_pk_bf16_f32 v233, v178, v179
    v_cvt_pk_bf16_f32 v234, v180, v181
    v_cvt_pk_bf16_f32 v235, v182, v183
    v_cvt_pk_bf16_f32 v236, v184, v185
    v_cvt_pk_bf16_f32 v237, v186, v187
    v_cvt_pk_bf16_f32 v238, v188, v189
    v_cvt_pk_bf16_f32 v239, v190, v191
    buffer_store_dwordx4 v[232:235], v14, s[4:7], s33 offen offset:1024 sc1
    buffer_store_dwordx4 v[236:239], v14, s[4:7], s33 offen offset:1536 sc1
    v_mfma_f32_32x32x16_bf16 v[208:223], a[184:187], v[148:151], 0
    v_mfma_f32_32x32x16_bf16 v[208:223], a[188:191], v[152:155], v[208:223]
    v_mfma_f32_32x32x16_bf16 v[208:223], v[112:115], v[156:159], v[208:223]
    v_cvt_pk_bf16_f32 v240, v192, v193
    v_cvt_pk_bf16_f32 v241, v194, v195
    v_cvt_pk_bf16_f32 v242, v196, v197
    v_cvt_pk_bf16_f32 v243, v198, v199
    v_cvt_pk_bf16_f32 v244, v200, v201
    v_cvt_pk_bf16_f32 v245, v202, v203
    v_cvt_pk_bf16_f32 v246, v204, v205
    v_cvt_pk_bf16_f32 v247, v206, v207
    buffer_store_dwordx4 v[240:243], v14, s[4:7], s33 offen offset:2048 sc1
    buffer_store_dwordx4 v[244:247], v14, s[4:7], s33 offen offset:2560 sc1
    v_add_u32 v9, 1, v9
    s_nop 0
    v_cvt_pk_bf16_f32 v248, v208, v209
    v_cvt_pk_bf16_f32 v249, v210, v211
    v_cvt_pk_bf16_f32 v250, v212, v213
    v_cvt_pk_bf16_f32 v251, v214, v215
    v_cvt_pk_bf16_f32 v252, v216, v217
    v_cvt_pk_bf16_f32 v253, v218, v219
    v_cvt_pk_bf16_f32 v254, v220, v221
    v_cvt_pk_bf16_f32 v255, v222, v223
    buffer_store_dwordx4 v[248:251], v14, s[4:7], s33 offen offset:3072 sc1
    buffer_store_dwordx4 v[252:255], v14, s[4:7], s33 offen offset:3584 sc1
    s_mov_b32 s28, s34
    s_add_u32 s33, s33, 1048576
    s_cmp_lt_u32 s28, 64
    s_cbranch_scc1 T_top0
T_fin:
    s_waitcnt vmcnt(0)
    buffer_store_dword v9, v4, s[4:7], 0 offen sc1
    s_branch W_fin
T_slow0:
    s_waitcnt vmcnt(0)
    buffer_store_dword v9, v4, s[4:7], 0 offen sc1
    s_mov_b32 s30, s92
T_s0:
    v_cmp_ge_u32 vcc, s28, v16
    s_nop 0
    s_and_b32 s17, vcc_lo, 61440
    s_cbranch_scc0 T_sk0
    s_cmp_ge_u32 s30, 1048576
    s_cselect_b32 s92, 1048576, s92
    s_cbranch_scc1 T_sk0
    s_add_u32 s30, s30, 1
    buffer_load_dword v16, v15, s[4:7], 0 offen sc1
    s_sleep 2
    s_waitcnt vmcnt(0)
    s_branch T_s0
T_sk0:
    s_add_u32 s17, s32, 0
    s_add_u32 s18, s32, 5242880
    buffer_load_dwordx4 v[20:23], v12, s[4:7], s17 offen offset:0
    buffer_load_dwordx4 v[24:27], v12, s[4:7], s17 offen offset:32
    buffer_load_dwordx2 v[52:53], v13, s[4:7], s18 offen
    s_add_u32 s17, s32, 33280
    s_add_u32 s18, s32, 5276160
    buffer_load_dwordx4 v[28:31], v12, s[4:7], s17 offen offset:0
    buffer_load_dwordx4 v[32:35], v12, s[4:7], s17 offen offset:32
    buffer_load_dwordx2 v[56:57], v13, s[4:7], s18 offen
    s_add_u32 s17, s32, 66560
    s_add_u32 s18, s32, 5309440
    buffer_load_dwordx4 v[36:39], v12, s[4:7], s17 offen offset:0
    buffer_load_dwordx4 v[40:43], v12, s[4:7], s17 offen offset:32
    buffer_load_dwordx2 v[60:61], v13, s[4:7], s18 offen
    s_add_u32 s17, s32, 99840
    s_add_u32 s18, s32, 5342720
    buffer_load_dwordx4 v[44:47], v12, s[4:7], s17 offen offset:0
    buffer_load_dwordx4 v[48:51], v12, s[4:7], s17 offen offset:32
    buffer_load_dwordx2 v[64:65], v13, s[4:7], s18 offen
    s_waitcnt vmcnt(0)
    s_branch T_go0
T_pw0:
    s_mov_b32 s30, s92
T_q0:
    v_cmp_ge_u32 vcc, s68, v16
    s_nop 0
    s_and_b32 s17, vcc_lo, 4095
    s_cbranch_scc0 T_pok0
    s_cmp_ge_u32 s30, 1048576
    s_cselect_b32 s92, 1048576, s92
    s_cbranch_scc1 T_pok0
    s_add_u32 s30, s30, 1
    buffer_load_dword v16, v15, s[4:7], 0 offen sc1
    s_sleep 8
    s_waitcnt vmcnt(0)
    s_branch T_q0
T_slow1:
    s_waitcnt vmcnt(0)
    buffer_store_dword v9, v4, s[4:7], 0 offen sc1
    s_cmp_ge_u32 s28, 60
    s_cbranch_scc1 T_last
    s_mov_b32 s30, s92
T_s1:
    v_cmp_ge_u32 vcc, s28, v16
    s_nop 0
    s_and_b32 s17, vcc_lo, 61440
    s_cbranch_scc0 T_sk1
    s_cmp_ge_u32 s30, 1048576
    s_cselect_b32 s92, 1048576, s92
    s_cbranch_scc1 T_sk1
    s_add_u32 s30, s30, 1
    buffer_load_dword v16, v15, s[4:7], 0 offen sc1
    s_sleep 2
    s_waitcnt vmcnt(0)
    s_branch T_s1
T_sk1:
    s_add_u32 s17, s32, 0
    s_add_u32 s18, s32, 5242880
    buffer_load_dwordx4 v[68:71], v12, s[4:7], s17 offen offset:0
    buffer_load_dwordx4 v[72:75], v12, s[4:7], s17 offen offset:32
    buffer_load_dwordx2 v[100:101], v13, s[4:7], s18 offen
    s_add_u32 s17, s32, 33280
    s_add_u32 s18, s32, 5276160
    buffer_load_dwordx4 v[76:79], v12, s[4:7], s17 offen offset:0
    buffer_load_dwordx4 v[80:83], v12, s[4:7], s17 offen offset:32
    buffer_load_dwordx2 v[104:105], v13, s[4:7], s18 offen
    s_add_u32 s17, s32, 66560
    s_add_u32 s18, s32, 5309440
    buffer_load_dwordx4 v[84:87], v12, s[4:7], s17 offen offset:0
    buffer_load_dwordx4 v[88:91], v12, s[4:7], s17 offen offset:32
    buffer_load_dwordx2 v[108:109], v13, s[4:7], s18 offen
    s_add_u32 s17, s32, 99840
    s_add_u32 s18, s32, 5342720
    buffer_load_dwordx4 v[92:95], v12, s[4:7], s17 offen offset:0
    buffer_load_dwordx4 v[96:99], v12, s[4:7], s17 offen offset:32
    buffer_load_dwordx2 v[112:113], v13, s[4:7], s18 offen
    s_waitcnt vmcnt(0)
    s_branch T_go1
T_pw1:
    s_mov_b32 s30, s92
T_q1:
    v_cmp_ge_u32 vcc, s68, v16
    s_nop 0
    s_and_b32 s17, vcc_lo, 4095
    s_cbranch_scc0 T_pok1
    s_cmp_ge_u32 s30, 1048576
    s_cselect_b32 s92, 1048576, s92
    s_cbranch_scc1 T_pok1
    s_add_u32 s30, s30, 1
    buffer_load_dword v16, v15, s[4:7], 0 offen sc1
    s_sleep 8
    s_waitcnt vmcnt(0)
    s_branch T_q1
T_last:
    v_mfma_f32_32x32x16_bf16 v[116:131], a[128:131], a[96:99], 0
    v_mfma_f32_32x32x16_bf16 v[116:131], a[132:135], a[100:103], v[116:131]
    v_mfma_f32_32x32x16_bf16 v[116:131], a[136:139], a[104:107], v[116:131]
    v_mfma_f32_32x32x16_bf16 v[116:131], a[140:143], a[108:111], v[116:131]
    v_mfma_f32_32x32x16_bf16 v[116:131], a[144:147], a[112:115], v[116:131]
    v_mfma_f32_32x32x16_bf16 v[116:131], a[148:151], a[116:119], v[116:131]
    v_mfma_f32_32x32x16_bf16 v[116:131], a[152:155], a[120:123], v[116:131]
    v_mfma_f32_32x32x16_bf16 v[116:131], a[156:159], a[124:127], v[116:131]
    s_nop 11
    v_cndmask_b32 v116, v17, v116, s[36:37]
    v_cndmask_b32 v117, v17, v117, s[38:39]
    v_cndmask_b32 v118, v17, v118, s[40:41]
    v_cndmask_b32 v119, v17, v119, s[42:43]
    v_cndmask_b32 v120, v17, v120, s[44:45]
    v_cndmask_b32 v121, v17, v121, s[46:47]
    v_cndmask_b32 v122, v17, v122, s[48:49]
    v_cndmask_b32 v123, v17, v123, s[50:51]
    v_cndmask_b32 v124, v17, v124, s[52:53]
    v_cndmask_b32 v125, v17, v125, s[54:55]
    v_cndmask_b32 v126, v17, v126, s[56:57]
    v_cndmask_b32 v127, v17, v127, s[58:59]
    v_cndmask_b32 v128, v17, v128, s[60:61]
    v_cndmask_b32 v129, v17, v129, s[62:63]
    v_cndmask_b32 v130, v17, v130, s[64:65]
    v_cndmask_b32 v131, v17, v131, s[66:67]
    v_max3_f32 v20, v116, v117, v118
    v_max3_f32 v20, v20, v119, v120
    v_max3_f32 v20, v20, v121, v122
    v_max3_f32 v20, v20, v123, v124
    v_max3_f32 v20, v20, v125, v126
    v_max3_f32 v20, v20, v127, v128
    v_max3_f32 v20, v20, v129, v130
    v_max_f32 v20, v20, v131
    v_mov_b32 v5, v20
    s_nop 1
    v_permlane32_swap_b32 v20, v5
    v_max_f32 v20, v20, v5
    v_mul_f32 v18, s29, v20
    v_fma_f32 v116, v116, s29, -v18
    v_fma_f32 v117, v117, s29, -v18
    v_fma_f32 v118, v118, s29, -v18
    v_fma_f32 v119, v119, s29, -v18
    v_fma_f32 v120, v120, s29, -v18
    v_fma_f32 v121, v121, s29, -v18
    v_fma_f32 v122, v122, s29, -v18
    v_fma_f32 v123, v123, s29, -v18
    v_fma_f32 v124, v124, s29, -v18
    v_fma_f32 v125, v125, s29, -v18
    v_fma_f32 v126, v126, s29, -v18
    v_fma_f32 v127, v127, s29, -v18
    v_fma_f32 v128, v128, s29, -v18
    v_fma_f32 v129, v129, s29, -v18
    v_fma_f32 v130, v130, s29, -v18
    v_fma_f32 v131, v131, s29, -v18
    v_exp_f32 v116, v116
    v_exp_f32 v117, v117
    v_exp_f32 v118, v118
    v_exp_f32 v119, v119
    v_exp_f32 v120, v120
    v_exp_f32 v121, v121
    v_exp_f32 v122, v122
    v_exp_f32 v123, v123
    v_exp_f32 v124, v124
    v_exp_f32 v125, v125
    v_exp_f32 v126, v126
    v_exp_f32 v127, v127
    v_exp_f32 v128, v128
    v_exp_f32 v129, v129
    v_exp_f32 v130, v130
    v_exp_f32 v131, v131
    v_add_f32 v19, v116, v117
    v_add_f32 v19, v19, v118
    v_add_f32 v19, v19, v119
    v_add_f32 v19, v19, v120
    v_add_f32 v19, v19, v121
    v_add_f32 v19, v19, v122
    v_add_f32 v19, v19, v123
    v_add_f32 v19, v19, v124
    v_add_f32 v19, v19, v125
    v_add_f32 v19, v19, v126
    v_add_f32 v19, v19, v127
    v_add_f32 v19, v19, v128
    v_add_f32 v19, v19, v129
    v_add_f32 v19, v19, v130
    v_add_f32 v19, v19, v131
    v_cvt_pk_bf16_f32 v148, v116, v117
    v_cvt_pk_bf16_f32 v149, v118, v119
    v_cvt_pk_bf16_f32 v150, v120, v121
    v_cvt_pk_bf16_f32 v151, v122, v123
    v_cvt_pk_bf16_f32 v152, v124, v125
    v_cvt_pk_bf16_f32 v153, v126, v127
    v_cvt_pk_bf16_f32 v154, v128, v129
    v_cvt_pk_bf16_f32 v155, v130, v131
    v_mfma_f32_32x32x16_bf16 v[160:175], a[160:163], v[148:151], 0
    s_nop 0
    v_mfma_f32_32x32x16_bf16 v[160:175], a[164:167], v[152:155], v[160:175]
    v_mfma_f32_32x32x16_bf16 v[176:191], a[168:171], v[148:151], 0
    v_mfma_f32_32x32x16_bf16 v[176:191], a[172:175], v[152:155], v[176:191]
    v_mfma_f32_32x32x16_bf16 v[192:207], a[176:179], v[148:151], 0
    v_mfma_f32_32x32x16_bf16 v[192:207], a[180:183], v[152:155], v[192:207]
    v_mfma_f32_32x32x16_bf16 v[208:223], a[184:187], v[148:151], 0
    v_mfma_f32_32x32x16_bf16 v[208:223], a[188:191], v[152:155], v[208:223]
    s_cmp_ge_u32 s28, 61
    s_cselect_b64 s[48:49], 0xffff, 0
    s_sub_u32 s34, s28, 2
    s_add_u32 s36, s32, 0
    s_add_u32 s40, s32, 5242880
    s_add_u32 s37, s32, 33280
    s_add_u32 s41, s32, 5276160
    s_add_u32 s38, s32, 66560
    s_add_u32 s42, s32, 5309440
    s_add_u32 s39, s32, 99840
    s_add_u32 s43, s32, 5342720
    v_add_u32 v9, 1, v9
    s_mov_b32 s30, s92
T_l0:
    v_cmp_ge_u32 vcc, s34, v16
    s_nop 0
    s_and_b32 s17, vcc_lo, 61440
    s_cbranch_scc0 T_l1
    s_cmp_ge_u32 s30, 1048576
    s_cselect_b32 s92, 1048576, s92
    s_cbranch_scc1 T_l1
    s_add_u32 s30, s30, 1
    buffer_load_dword v16, v15, s[4:7], 0 offen sc1
    s_sleep 2
    s_waitcnt vmcnt(0)
    s_branch T_l0
T_l2:
    v_max3_u32 v5, v68, v69, v70
    v_max3_u32 v5, v5, v71, v72
    v_max3_u32 v5, v5, v73, v74
    v_max3_u32 v5, v5, v75, v76
    v_max3_u32 v5, v5, v77, v78
    v_max3_u32 v5, v5, v79, v80
    v_max3_u32 v5, v5, v81, v82
    v_max3_u32 v5, v5, v83, v84
    v_max3_u32 v5, v5, v85, v86
    v_max3_u32 v5, v5, v87, v88
    v_max3_u32 v5, v5, v89, v90
    v_max3_u32 v5, v5, v91, v92
    v_max3_u32 v5, v5, v93, v94
    v_max3_u32 v5, v5, v95, v96
    v_max3_u32 v5, v5, v97, v98
    v_max3_u32 v5, v5, v99, v6
    v_cmp_eq_u32 vcc, -1, v5
    s_nop 0
    s_cbranch_vccz T_l3
    s_add_u32 s30, s30, 1
    s_cmp_ge_u32 s30, 1048576
    s_cbranch_scc1 T_l3
T_l1:
    buffer_load_dwordx4 v[68:71], v12, s[4:7], s36 offen offset:0 sc1
    buffer_load_dwordx4 v[72:75], v12, s[4:7], s36 offen offset:32 sc1
    buffer_load_dwordx4 v[76:79], v12, s[4:7], s37 offen offset:0 sc1
    buffer_load_dwordx4 v[80:83], v12, s[4:7], s37 offen offset:32 sc1
    buffer_load_dwordx4 v[84:87], v12, s[4:7], s38 offen offset:0 sc1
    buffer_load_dwordx4 v[88:91], v12, s[4:7], s38 offen offset:32 sc1
    buffer_load_dwordx4 v[92:95], v12, s[4:7], s39 offen offset:0 sc1
    buffer_load_dwordx4 v[96:99], v12, s[4:7], s39 offen offset:32 sc1
    buffer_load_dwordx2 v[100:101], v13, s[4:7], s40 offen sc1
    buffer_load_dwordx2 v[104:105], v13, s[4:7], s41 offen sc1
    buffer_load_dwordx2 v[108:109], v13, s[4:7], s42 offen sc1
    buffer_load_dwordx2 v[112:113], v13, s[4:7], s43 offen sc1
    s_waitcnt vmcnt(11)
    v_mfma_f32_32x32x16_bf16 v[132:147], v[68:71], a[96:99], 0
    s_waitcnt vmcnt(10)
    v_mfma_f32_32x32x16_bf16 v[132:147], v[72:75], a[100:103], v[132:147]
    s_waitcnt vmcnt(9)
    v_mfma_f32_32x32x16_bf16 v[132:147], v[76:79], a[104:107], v[132:147]
    s_waitcnt vmcnt(8)
    v_mfma_f32_32x32x16_bf16 v[132:147], v[80:83], a[108:111], v[132:147]
    s_waitcnt vmcnt(7)
    v_mfma_f32_32x32x16_bf16 v[132:147], v[84:87], a[112:115], v[132:147]
    s_waitcnt vmcnt(6)
    v_mfma_f32_32x32x16_bf16 v[132:147], v[88:91], a[116:119], v[132:147]
    s_waitcnt vmcnt(5)
    v_mfma_f32_32x32x16_bf16 v[132:147], v[92:95], a[120:123], v[132:147]
    s_waitcnt vmcnt(4)
    v_mfma_f32_32x32x16_bf16 v[132:147], v[96:99], a[124:127], v[132:147]
    s_waitcnt vmcnt(0)
    v_max3_u32 v6, v100, v101, v104
    v_max3_u32 v6, v6, v105, v108
    v_max3_u32 v6, v6, v109, v112
    v_max_u32 v6, v6, v113
    v_cmp_eq_u32 s[44:45], -1, v6
    s_nop 5
    v_cmp_u_f32 s[46:47], v132, v133
    v_cmp_u_f32 vcc, v134, v135
    v_max3_f32 v18, v132, v133, v20
    s_or_b64 s[44:45], s[44:45], s[46:47]
    v_max3_f32 v18, v134, v135, v18
    s_or_b64 vcc, vcc, s[44:45]
    s_cbranch_vccnz T_l2
T_l3:
    v_mov_b32 v5, v18
    s_nop 1
    v_permlane32_swap_b32 v18, v5
    v_max_f32 v18, v18, v5
    v_mul_f32 v18, s29, v18
    v_fma_f32 v21, v20, s29, -v18
    v_fma_f32 v132, v132, s29, -v18
    v_fma_f32 v133, v133, s29, -v18
    v_fma_f32 v134, v134, s29, -v18
    v_fma_f32 v135, v135, s29, -v18
    v_exp_f32 v21, v21
    v_exp_f32 v132, v132
    v_exp_f32 v133, v133
    v_exp_f32 v134, v134
    v_exp_f32 v135, v135
    v_fma_f32 v19, v19, v21, v132
    v_add_f32 v6, v133, v134
    v_add_f32 v19, v19, v135
    v_add_f32 v19, v19, v6
    v_mov_b32 v5, v19
    s_nop 1
    v_permlane32_swap_b32 v19, v5
    v_add_f32 v19, v19, v5
    v_rcp_f32 v19, v19
    s_nop 0
    v_mul_f32 v21, v21, v19
    v_mul_f32 v132, v132, v19
    v_mul_f32 v133, v133, v19
    v_mul_f32 v134, v134, v19
    v_mul_f32 v135, v135, v19
    v_cvt_pk_bf16_f32 v156, v132, v133
    v_cvt_pk_bf16_f32 v157, v134, v135
    v_mul_f32 v160, v160, v21
    v_mul_f32 v161, v161, v21
    v_mul_f32 v162, v162, v21
    v_mul_f32 v163, v163, v21
    v_mul_f32 v164, v164, v21
    v_mul_f32 v165, v165, v21
    v_mul_f32 v166, v166, v21
    v_mul_f32 v167, v167, v21
    v_mul_f32 v168, v168, v21
    v_mul_f32 v169, v169, v21
    v_mul_f32 v170, v170, v21
    v_mul_f32 v171, v171, v21
    v_mul_f32 v172, v172, v21
    v_mul_f32 v173, v173, v21
    v_mul_f32 v174, v174, v21
    v_mul_f32 v175, v175, v21
    s_nop 1
    v_mfma_f32_32x32x16_bf16 v[160:175], v[100:103], v[156:159], v[160:175]
    v_mul_f32 v176, v176, v21
    v_mul_f32 v177, v177, v21
    v_mul_f32 v178, v178, v21
    v_mul_f32 v179, v179, v21
    v_mul_f32 v180, v180, v21
    v_mul_f32 v181, v181, v21
    v_mul_f32 v182, v182, v21
    v_mul_f32 v183, v183, v21
    v_mul_f32 v184, v184, v21
    v_mul_f32 v185, v185, v21
    v_mul_f32 v186, v186, v21
    v_mul_f32 v187, v187, v21
    v_mul_f32 v188, v188, v21
    v_mul_f32 v189, v189, v21
    v_mul_f32 v190, v190, v21
    v_mul_f32 v191, v191, v21
    s_nop 1
    v_mfma_f32_32x32x16_bf16 v[176:191], v[104:107], v[156:159], v[176:191]
    v_cvt_pk_bf16_f32 v224, v160, v161
    v_cvt_pk_bf16_f32 v225, v162, v163
    v_cvt_pk_bf16_f32 v226, v164, v165
    v_cvt_pk_bf16_f32 v227, v166, v167
    v_cvt_pk_bf16_f32 v228, v168, v169
    v_cvt_pk_bf16_f32 v229, v170, v171
    v_cvt_pk_bf16_f32 v230, v172, v173
    v_cvt_pk_bf16_f32 v231, v174, v175
    buffer_store_dwordx4 v[224:227], v14, s[4:7], s33 offen offset:0 sc1
    buffer_store_dwordx4 v[228:231], v14, s[4:7], s33 offen offset:512 sc1
    v_mul_f32 v192, v192, v21
    v_mul_f32 v193, v193, v21
    v_mul_f32 v194, v194, v21
    v_mul_f32 v195, v195, v21
    v_mul_f32 v196, v196, v21
    v_mul_f32 v197, v197, v21
    v_mul_f32 v198, v198, v21
    v_mul_f32 v199, v199, v21
    v_mul_f32 v200, v200, v21
    v_mul_f32 v201, v201, v21
    v_mul_f32 v202, v202, v21
    v_mul_f32 v203, v203, v21
    v_mul_f32 v204, v204, v21
    v_mul_f32 v205, v205, v21
    v_mul_f32 v206, v206, v21
    v_mul_f32 v207, v207, v21
    s_nop 1
    v_mfma_f32_32x32x16_bf16 v[192:207], v[108:111], v[156:159], v[192:207]
    v_cvt_pk_bf16_f32 v232, v176, v177
    v_cvt_pk_bf16_f32 v233, v178, v179
    v_cvt_pk_bf16_f32 v234, v180, v181
    v_cvt_pk_bf16_f32 v235, v182, v183
    v_cvt_pk_bf16_f32 v236, v184, v185
    v_cvt_pk_bf16_f32 v237, v186, v187
    v_cvt_pk_bf16_f32 v238, v188, v189
    v_cvt_pk_bf16_f32 v239, v190, v191
    buffer_store_dwordx4 v[232:235], v14, s[4:7], s33 offen offset:1024 sc1
    buffer_store_dwordx4 v[236:239], v14, s[4:7], s33 offen offset:1536 sc1
    v_mul_f32 v208, v208, v21
    v_mul_f32 v209, v209, v21
    v_mul_f32 v210, v210, v21
    v_mul_f32 v211, v211, v21
    v_mul_f32 v212, v212, v21
    v_mul_f32 v213, v213, v21
    v_mul_f32 v214, v214, v21
    v_mul_f32 v215, v215, v21
    v_mul_f32 v216, v216, v21
    v_mul_f32 v217, v217, v21
    v_mul_f32 v218, v218, v21
    v_mul_f32 v219, v219, v21
    v_mul_f32 v220, v220, v21
    v_mul_f32 v221, v221, v21
    v_mul_f32 v222, v222, v21
    v_mul_f32 v223, v223, v21
    s_nop 1
    v_mfma_f32_32x32x16_bf16 v[208:223], v[112:115], v[156:159], v[208:223]
    v_cvt_pk_bf16_f32 v240, v192, v193
    v_cvt_pk_bf16_f32 v241, v194, v195
    v_cvt_pk_bf16_f32 v242, v196, v197
    v_cvt_pk_bf16_f32 v243, v198, v199
    v_cvt_pk_bf16_f32 v244, v200, v201
    v_cvt_pk_bf16_f32 v245, v202, v203
    v_cvt_pk_bf16_f32 v246, v204, v205
    v_cvt_pk_bf16_f32 v247, v206, v207
    buffer_store_dwordx4 v[240:243], v14, s[4:7], s33 offen offset:2048 sc1
    buffer_store_dwordx4 v[244:247], v14, s[4:7], s33 offen offset:2560 sc1
    s_nop 1
    v_cvt_pk_bf16_f32 v248, v208, v209
    v_cvt_pk_bf16_f32 v249, v210, v211
    v_cvt_pk_bf16_f32 v250, v212, v213
    v_cvt_pk_bf16_f32 v251, v214, v215
    v_cvt_pk_bf16_f32 v252, v216, v217
    v_cvt_pk_bf16_f32 v253, v218, v219
    v_cvt_pk_bf16_f32 v254, v220, v221
    v_cvt_pk_bf16_f32 v255, v222, v223
    buffer_store_dwordx4 v[248:251], v14, s[4:7], s33 offen offset:3072 sc1
    buffer_store_dwordx4 v[252:255], v14, s[4:7], s33 offen offset:3584 sc1
    s_branch T_fin
W_fin:
W_end:
    s_endpgm
R_entry:
    s_mov_b32 s12, s3
    s_lshr_b32 s13, s2, 3
    s_load_dwordx2 s[4:5], s[0:1], 96
    s_load_dwordx2 s[28:29], s[0:1], 32
    s_load_dwordx2 s[30:31], s[0:1], 40
    s_load_dwordx2 s[32:33], s[0:1], 48
    s_load_dwordx2 s[34:35], s[0:1], 56
    s_load_dwordx2 s[36:37], s[0:1], 64
    v_lshrrev_b32 v19, 6, v0
    v_and_b32 v1, 63, v0
    v_readfirstlane_b32 s14, v19
    s_mov_b32 s6, 268435456
    s_mov_b32 s7, 0x20000
    s_mov_b32 s10, 8388608
    s_mov_b32 s11, 0x20000
    s_mov_b32 s25, 0
    s_mov_b32 s24, 1040356334
    s_waitcnt lgkmcnt(0)
    v_and_b32 v96, 7, v1
    v_bfe_u32 v97, v1, 3, 1
    v_lshrrev_b32 v98, 4, v1
    v_lshlrev_b32 v19, 4, v1
    s_lshl_b32 s21, s12, 14
    s_lshl_b32 s22, s14, 12
    s_add_u32 s21, s21, s22
    s_add_u32 s22, s21, 0
    v_add_u32 v2, s22, v19
    s_add_u32 s22, s21, 229376
    v_add_u32 v8, s22, v19
    s_lshr_b32 s21, s13, 1
    s_lshl_b32 s21, s21, 10
    s_and_b32 s22, s13, 1
    s_lshl_b32 s22, s22, 7
    s_add_u32 s21, s21, s22
    s_lshl_b32 s22, s12, 14
    s_add_u32 s21, s21, s22
    v_lshlrev_b32 v20, 8, v98
    v_lshl_add_u32 v20, v96, 4, v20
    v_lshl_add_u32 v20, v97, 3, v20
    s_add_u32 s22, s21, 229376
    v_add_u32 v7, s22, v20
    s_add_u32 s22, s21, 0
    v_add_u32 v11, s22, v20
    s_lshr_b32 s21, s13, 1
    s_lshl_b32 s21, s21, 14
    s_and_b32 s22, s13, 1
    s_lshl_b32 s22, s22, 12
    s_add_u32 s21, s21, s22
    s_lshl_b32 s22, s12, 10
    s_add_u32 s22, s21, s22
    v_add_u32 v9, s22, v19
    v_xor_b32 v10, 1024, v9
    v_xor_b32 v23, 2048, v9
    v_xor_b32 v244, 3072, v9
    s_mov_b32 s95, 167772160
    s_lshr_b32 s40, s13, 2
    s_lshl_b32 s21, s12, 3
    s_add_u32 s40, s40, s21
    s_and_b32 s41, s13, 3
    s_mul_i32 s21, s40, 5120
    s_add_u32 s21, s21, 65536
    v_add_u32 v5, s21, v19
    v_lshlrev_b32 v20, 2, v1
    s_add_u32 s22, s21, 4096
    v_add_u32 v6, s22, v20
    s_lshl_b32 s22, s41, 10
    s_add_u32 s22, s22, s21
    v_add_u32 v3, s22, v19
    v_mov_b32 v21, 1073741824
    v_cmp_eq_u32 vcc, 0, v97
    s_nop 1
    v_cndmask_b32 v3, v21, v3, vcc
    s_lshl_b32 s22, s41, 8
    s_add_u32 s22, s22, s21
    s_add_u32 s22, s22, 4096
    v_lshlrev_b32 v20, 4, v98
    v_lshl_add_u32 v20, v96, 5, v20
    v_add_u32 v4, s22, v20
    v_cndmask_b32 v4, v4, v21, vcc
    v_cmp_gt_u32 vcc, 2, v98
    s_nop 1
    v_cndmask_b32 v4, v21, v4, vcc
    s_lshl_b32 s27, s40, 7
    s_lshl_b32 s21, s41, 5
    s_add_u32 s27, s27, s21
    v_bfe_u32 v20, v1, 2, 2
    v_and_b32 v22, 3, v1
    v_lshl_add_u32 v20, v20, 3, v22
    v_lshlrev_b32 v12, 6, v20
    v_lshl_add_u32 v12, v98, 4, v12
    s_and_b32 s21, s14, 1
    s_lshl_b32 s21, s21, 14
    s_lshl_b32 s22, s27, 2
    s_add_u32 s21, s21, s22
    s_add_u32 s21, s21, 100679680
    v_mov_b32 v245, s21
    s_mov_b32 s85, 0
    s_mul_i32 s21, s27, 4160
    v_add_u32 v12, s21, v12
    v_mov_b32 v13, v12
    v_and_b32 v173, 15, v1
    v_lshl_add_u32 v173, v173, 7, s21
    v_mul_u32_u24 v175, 69632, v98
    v_lshl_add_u32 v173, v175, 8, v173
    s_add_u32 s22, s22, 100679680
    v_lshl_add_u32 v174, v98, 14, s22
    v_mov_b32 v175, 0
    v_lshlrev_b32 v15, 4, v20
    v_lshl_add_u32 v15, v98, 5, v15
    s_mul_i32 s21, s27, 1040
    v_add_u32 v15, s21, v15
    v_and_b32 v22, 1, v98
    v_cmp_eq_u32 vcc, 0, v22
    s_nop 1
    v_cndmask_b32 v15, v21, v15, vcc
    v_lshlrev_b32 v14, 6, v96
    v_lshl_add_u32 v14, v98, 4, v14
    v_add_u32 v14, s21, v14
    v_cmp_eq_u32 vcc, 1, v97
    s_nop 1
    v_cndmask_b32 v14, v21, v14, vcc
    v_mov_b32 v16, v19
    s_lshl_b32 s21, s14, 11
    v_add_u32 v17, s21, v19
    v_and_b32 v20, 15, v1
    v_bfe_u32 v22, v1, 2, 2
    v_and_b32 v18, 1, v1
    v_lshl_add_u32 v18, v22, 1, v18
    v_bfe_u32 v22, v1, 1, 1
    v_lshl_add_u32 v18, v22, 3, v18
    s_cmp_eq_u32 s14, 1
    s_cselect_b64 vcc, -1, 0
    v_cndmask_b32 v20, v20, v18, vcc
    v_and_b32 v22, 1, v98
    v_lshlrev_b32 v22, 2, v22
    v_sub_u32 v20, v20, v22
    v_mov_b32 v22, 0x3f80
    v_mov_b32 v18, 0x3f800000
    v_mov_b32 v172, 0x4444
    v_mov_b32 v84, 0xeeee
    v_cmp_eq_u32 vcc, 1, v97
    s_nop 1
    v_cndmask_b32 v172, v172, v84, vcc
    v_cmp_eq_u32 vcc, 0, v20
    s_nop 1
    v_cndmask_b32 v84, 0, v22, vcc
    v_cmp_eq_u32 vcc, 1, v20
    s_nop 1
    v_cndmask_b32 v84, v84, v18, vcc
    v_cmp_eq_u32 vcc, 2, v20
    s_nop 1
    v_cndmask_b32 v85, 0, v22, vcc
    v_cmp_eq_u32 vcc, 3, v20
    s_nop 1
    v_cndmask_b32 v85, v85, v18, vcc
    v_cmp_eq_u32 vcc, 8, v20
    s_nop 1
    v_cndmask_b32 v86, 0, v22, vcc
    v_cmp_eq_u32 vcc, 9, v20
    s_nop 1
    v_cndmask_b32 v86, v86, v18, vcc
    v_cmp_eq_u32 vcc, 10, v20
    s_nop 1
    v_cndmask_b32 v87, 0, v22, vcc
    v_cmp_eq_u32 vcc, 11, v20
    s_nop 1
    v_cndmask_b32 v87, v87, v18, vcc
    s_mov_b32 s16, 81788928
    s_mov_b32 s42, 82083840
    s_mov_b32 s43, 82378752
    s_mov_b32 s44, 82673664
    s_mov_b32 s17, 17825792
    s_mov_b32 s18, 35651584
    s_mov_b32 s19, 71303168
    s_mov_b32 s20, 76546048
    s_mov_b32 s15, 0
    v_mov_b32 v204, -1
    v_mov_b32 v205, -1
    v_mov_b32 v206, -1
    v_mov_b32 v207, -1
    v_mov_b32 v236, 0x3f803f80
    v_mov_b32 v237, 0x3f803f80
    v_mov_b32 v238, 0x3f803f80
    v_mov_b32 v239, 0x3f803f80
    s_mul_i32 s22, s14, 294912
    s_add_u32 s22, s22, 81788928
    buffer_store_dwordx4 v[204:207], v3, s[4:7], s22 offen sc1
    buffer_store_dwordx4 v[204:207], v3, s[4:7], s22 offen offset:128 sc1
    buffer_store_dwordx4 v[204:207], v4, s[4:7], s22 offen sc1
    buffer_store_dwordx2 v[204:205], v7, s[4:7], s22 offen sc1
    buffer_store_dwordx2 v[204:205], v11, s[4:7], s22 offen sc1
    s_lshl_b32 s22, s14, 18
    s_add_u32 s22, s22, 167772160
    buffer_store_dwordx4 v[204:207], v9, s[4:7], s22 offen sc1
    s_add_u32 s22, s22, 8192
    buffer_store_dwordx4 v[204:207], v9, s[4:7], s22 offen sc1
    s_lshl_b32 s22, s14, 9
    s_add_u32 s22, s22, 71333888
    buffer_store_dwordx4 v[204:207], v14, s[4:7], s22 offen sc1
    s_add_u32 s22, s22, 5242880
    buffer_store_dwordx4 v[204:207], v15, s[4:7], s22 offen sc1
    s_lshl_b32 s22, s27, 2
    s_add_u32 s22, s22, 100712448
    v_lshlrev_b32 v246, 2, v1
    v_add_u32 v246, s22, v246
    v_cmp_gt_u32 vcc, 32, v1
    s_nop 1
    v_cndmask_b32 v246, v21, v246, vcc
    v_mov_b32 v247, 0
    buffer_store_dword v247, v246, s[4:7], 0 offen sc1
    v_lshrrev_b32 v19, 2, v1
    v_and_b32 v22, 3, v1
    v_lshlrev_b32 v22, 4, v22
    v_lshl_add_u32 v140, v19, 13, v22
    v_lshl_add_u32 v141, v19, 11, v22
    s_mul_i32 s86, s14, 40960
    s_lshr_b32 s21, s13, 3
    s_cmp_eq_u32 s21, 1
    s_cselect_b64 s[8:9], s[32:33], s[30:31]
    s_cmp_eq_u32 s21, 2
    s_cselect_b64 s[8:9], s[34:35], s[8:9]
    s_cmp_eq_u32 s21, 3
    s_cselect_b64 s[8:9], s[36:37], s[8:9]
    s_cselect_b32 s21, 11, 13
    s_cselect_b32 s87, 21, 11
    s_lshl_b32 s87, s12, s87
    s_and_b32 s22, s13, 3
    s_lshl_b32 s22, s22, 8
    v_add_u32 v142, s22, v0
    v_lshlrev_b32 v142, s21, v142
    s_and_b32 s22, s13, 4
    s_lshl_b32 s22, s22, 8
    s_add_u32 s87, s87, s22
    buffer_load_dword v143, v142, s[8:11], s87 offen offset:384
    s_cmp_eq_u32 s87, 7168
    s_cselect_b32 s87, s87, 1073741824
    buffer_load_dword v144, v142, s[8:11], s87 offen offset:896
    s_mov_b32 s8, s32
    s_mov_b32 s9, s33
    s_lshl_b32 s87, s14, 21
    s_lshl_b32 s22, s27, 1
    s_add_u32 s87, s87, s22
    s_add_u32 m0, s86, 0
    s_nop 0
    buffer_load_dwordx4 v140, s[8:11], s87 offen lds
    s_add_u32 s87, s87, 131072
    s_add_u32 m0, s86, 1024
    s_nop 0
    buffer_load_dwordx4 v140, s[8:11], s87 offen lds
    s_add_u32 s87, s87, 131072
    s_add_u32 m0, s86, 2048
    s_nop 0
    buffer_load_dwordx4 v140, s[8:11], s87 offen lds
    s_add_u32 s87, s87, 131072
    s_add_u32 m0, s86, 3072
    s_nop 0
    buffer_load_dwordx4 v140, s[8:11], s87 offen lds
    s_add_u32 s87, s87, 131072
    v_bfe_u32 v19, v1, 2, 1
    v_lshl_add_u32 v19, v98, 2, v19
    v_lshl_add_u32 v19, v97, 5, v19
    v_lshl_add_u32 v22, v19, 6, v22
    v_add_u32 v22, s86, v22
    s_waitcnt vmcnt(6)
    s_barrier
    s_cmp_lg_u32 s14, 0
    s_cbranch_scc1 reg_20
    s_and_b32 s21, s2, 3
    s_lshl_b32 s21, s21, 3
    s_lshl_b32 s22, s98, 2
    s_add_u32 s21, s21, s22
    s_lshl_b32 s21, 1, s21
    s_andn2_b32 s22, s2, 3
    v_mov_b32 v20, s22
    v_mov_b32 v21, s21
    s_mov_b64 exec, 1
    global_atomic_add v20, v21, s[100:101] sc1
    s_mov_b64 exec, -1
reg_20:
    s_barrier
    s_add_u32 m0, s86, 4096
    s_nop 0
    buffer_load_dwordx4 v140, s[8:11], s87 offen lds
    s_add_u32 s87, s87, 131072
    s_add_u32 m0, s86, 5120
    s_nop 0
    buffer_load_dwordx4 v140, s[8:11], s87 offen lds
    s_add_u32 s87, s87, 131072
    s_add_u32 m0, s86, 6144
    s_nop 0
    buffer_load_dwordx4 v140, s[8:11], s87 offen lds
    s_add_u32 s87, s87, 131072
    s_add_u32 m0, s86, 7168
    s_nop 0
    buffer_load_dwordx4 v140, s[8:11], s87 offen lds
    s_add_u32 s87, s87, 131072
    s_add_u32 m0, s86, 8192
    s_nop 0
    buffer_load_dwordx4 v140, s[8:11], s87 offen lds
    s_add_u32 s87, s87, 131072
    s_add_u32 m0, s86, 9216
    s_nop 0
    buffer_load_dwordx4 v140, s[8:11], s87 offen lds
    s_add_u32 s87, s87, 131072
    s_add_u32 m0, s86, 10240
    s_nop 0
    buffer_load_dwordx4 v140, s[8:11], s87 offen lds
    s_add_u32 s87, s87, 131072
    s_add_u32 m0, s86, 11264
    s_nop 0
    buffer_load_dwordx4 v140, s[8:11], s87 offen lds
    s_add_u32 s87, s87, 131072
    s_add_u32 m0, s86, 12288
    s_nop 0
    buffer_load_dwordx4 v140, s[8:11], s87 offen lds
    s_add_u32 s87, s87, 131072
    s_add_u32 m0, s86, 13312
    s_nop 0
    buffer_load_dwordx4 v140, s[8:11], s87 offen lds
    s_add_u32 s87, s87, 131072
    s_add_u32 m0, s86, 14336
    s_nop 0
    buffer_load_dwordx4 v140, s[8:11], s87 offen lds
    s_add_u32 s87, s87, 131072
    s_add_u32 m0, s86, 15360
    s_nop 0
    buffer_load_dwordx4 v140, s[8:11], s87 offen lds
    s_add_u32 s87, s87, 131072
    s_mov_b32 s8, s34
    s_mov_b32 s9, s35
    s_lshl_b32 s87, s14, 21
    s_lshl_b32 s22, s27, 1
    s_add_u32 s87, s87, s22
    s_add_u32 m0, s86, 16384
    s_nop 0
    buffer_load_dwordx4 v140, s[8:11], s87 offen lds
    s_add_u32 s87, s87, 131072
    s_add_u32 m0, s86, 17408
    s_nop 0
    buffer_load_dwordx4 v140, s[8:11], s87 offen lds
    s_add_u32 s87, s87, 131072
    s_add_u32 m0, s86, 18432
    s_nop 0
    buffer_load_dwordx4 v140, s[8:11], s87 offen lds
    s_add_u32 s87, s87, 131072
    s_add_u32 m0, s86, 19456
    s_nop 0
    buffer_load_dwordx4 v140, s[8:11], s87 offen lds
    s_add_u32 s87, s87, 131072
    s_add_u32 m0, s86, 20480
    s_nop 0
    buffer_load_dwordx4 v140, s[8:11], s87 offen lds
    s_add_u32 s87, s87, 131072
    s_add_u32 m0, s86, 21504
    s_nop 0
    buffer_load_dwordx4 v140, s[8:11], s87 offen lds
    s_add_u32 s87, s87, 131072
    s_add_u32 m0, s86, 22528
    s_nop 0
    buffer_load_dwordx4 v140, s[8:11], s87 offen lds
    s_add_u32 s87, s87, 131072
    s_add_u32 m0, s86, 23552
    s_nop 0
    buffer_load_dwordx4 v140, s[8:11], s87 offen lds
    s_add_u32 s87, s87, 131072
    s_add_u32 m0, s86, 24576
    s_nop 0
    buffer_load_dwordx4 v140, s[8:11], s87 offen lds
    s_add_u32 s87, s87, 131072
    s_add_u32 m0, s86, 25600
    s_nop 0
    buffer_load_dwordx4 v140, s[8:11], s87 offen lds
    s_add_u32 s87, s87, 131072
    s_add_u32 m0, s86, 26624
    s_nop 0
    buffer_load_dwordx4 v140, s[8:11], s87 offen lds
    s_add_u32 s87, s87, 131072
    s_add_u32 m0, s86, 27648
    s_nop 0
    buffer_load_dwordx4 v140, s[8:11], s87 offen lds
    s_add_u32 s87, s87, 131072
    s_add_u32 m0, s86, 28672
    s_nop 0
    buffer_load_dwordx4 v140, s[8:11], s87 offen lds
    s_add_u32 s87, s87, 131072
    s_add_u32 m0, s86, 29696
    s_nop 0
    buffer_load_dwordx4 v140, s[8:11], s87 offen lds
    s_add_u32 s87, s87, 131072
    s_add_u32 m0, s86, 30720
    s_nop 0
    buffer_load_dwordx4 v140, s[8:11], s87 offen lds
    s_add_u32 s87, s87, 131072
    s_add_u32 m0, s86, 31744
    s_nop 0
    buffer_load_dwordx4 v140, s[8:11], s87 offen lds
    s_add_u32 s87, s87, 131072
    s_mov_b32 s8, s30
    s_mov_b32 s9, s31
    s_lshl_b32 s87, s14, 21
    s_lshl_b32 s22, s27, 1
    s_add_u32 s87, s87, s22
    s_add_u32 m0, s86, 32768
    s_nop 0
    buffer_load_dwordx4 v140, s[8:11], s87 offen lds
    s_add_u32 s87, s87, 131072
    s_add_u32 m0, s86, 33792
    s_nop 0
    buffer_load_dwordx4 v140, s[8:11], s87 offen lds
    s_add_u32 s87, s87, 131072
    s_add_u32 m0, s86, 34816
    s_nop 0
    buffer_load_dwordx4 v140, s[8:11], s87 offen lds
    s_add_u32 s87, s87, 131072
    s_add_u32 m0, s86, 35840
    s_nop 0
    buffer_load_dwordx4 v140, s[8:11], s87 offen lds
    s_add_u32 s87, s87, 131072
    s_add_u32 m0, s86, 36864
    s_nop 0
    buffer_load_dwordx4 v140, s[8:11], s87 offen lds
    s_add_u32 s87, s87, 131072
    s_add_u32 m0, s86, 37888
    s_nop 0
    buffer_load_dwordx4 v140, s[8:11], s87 offen lds
    s_add_u32 s87, s87, 131072
    s_add_u32 m0, s86, 38912
    s_nop 0
    buffer_load_dwordx4 v140, s[8:11], s87 offen lds
    s_add_u32 s87, s87, 131072
    s_add_u32 m0, s86, 39936
    s_nop 0
    buffer_load_dwordx4 v140, s[8:11], s87 offen lds
    s_add_u32 s87, s87, 131072
    s_waitcnt vmcnt(36)
    ds_read_b64_tr_b16 a[64:65], v22 offset:0
    ds_read_b64_tr_b16 a[66:67], v22 offset:128
    ds_read_b64_tr_b16 a[68:69], v22 offset:1024
    ds_read_b64_tr_b16 a[70:71], v22 offset:1152
    s_waitcnt lgkmcnt(4)
    ds_read_b64_tr_b16 a[96:97], v22 offset:8
    ds_read_b64_tr_b16 a[98:99], v22 offset:136
    ds_read_b64_tr_b16 a[100:101], v22 offset:1032
    ds_read_b64_tr_b16 a[102:103], v22 offset:1160
    s_waitcnt vmcnt(32)
    ds_read_b64_tr_b16 a[72:73], v22 offset:4096
    ds_read_b64_tr_b16 a[74:75], v22 offset:4224
    ds_read_b64_tr_b16 a[76:77], v22 offset:5120
    ds_read_b64_tr_b16 a[78:79], v22 offset:5248
    s_waitcnt lgkmcnt(4)
    ds_read_b64_tr_b16 a[104:105], v22 offset:4104
    ds_read_b64_tr_b16 a[106:107], v22 offset:4232
    ds_read_b64_tr_b16 a[108:109], v22 offset:5128
    ds_read_b64_tr_b16 a[110:111], v22 offset:5256
    s_add_u32 m0, s86, 0
    s_nop 0
    buffer_load_dwordx4 v140, s[8:11], s87 offen lds
    s_add_u32 s87, s87, 131072
    s_add_u32 m0, s86, 1024
    s_nop 0
    buffer_load_dwordx4 v140, s[8:11], s87 offen lds
    s_add_u32 s87, s87, 131072
    s_add_u32 m0, s86, 2048
    s_nop 0
    buffer_load_dwordx4 v140, s[8:11], s87 offen lds
    s_add_u32 s87, s87, 131072
    s_add_u32 m0, s86, 3072
    s_nop 0
    buffer_load_dwordx4 v140, s[8:11], s87 offen lds
    s_add_u32 s87, s87, 131072
    s_waitcnt vmcnt(32)
    ds_read_b64_tr_b16 a[80:81], v22 offset:8192
    ds_read_b64_tr_b16 a[82:83], v22 offset:8320
    ds_read_b64_tr_b16 a[84:85], v22 offset:9216
    ds_read_b64_tr_b16 a[86:87], v22 offset:9344
    s_waitcnt lgkmcnt(4)
    ds_read_b64_tr_b16 a[112:113], v22 offset:8200
    ds_read_b64_tr_b16 a[114:115], v22 offset:8328
    ds_read_b64_tr_b16 a[116:117], v22 offset:9224
    ds_read_b64_tr_b16 a[118:119], v22 offset:9352
    s_add_u32 m0, s86, 4096
    s_nop 0
    buffer_load_dwordx4 v140, s[8:11], s87 offen lds
    s_add_u32 s87, s87, 131072
    s_add_u32 m0, s86, 5120
    s_nop 0
    buffer_load_dwordx4 v140, s[8:11], s87 offen lds
    s_add_u32 s87, s87, 131072
    s_add_u32 m0, s86, 6144
    s_nop 0
    buffer_load_dwordx4 v140, s[8:11], s87 offen lds
    s_add_u32 s87, s87, 131072
    s_add_u32 m0, s86, 7168
    s_nop 0
    buffer_load_dwordx4 v140, s[8:11], s87 offen lds
    s_add_u32 s87, s87, 131072
    s_waitcnt vmcnt(32)
    ds_read_b64_tr_b16 a[88:89], v22 offset:12288
    ds_read_b64_tr_b16 a[90:91], v22 offset:12416
    ds_read_b64_tr_b16 a[92:93], v22 offset:13312
    ds_read_b64_tr_b16 a[94:95], v22 offset:13440
    s_waitcnt lgkmcnt(4)
    ds_read_b64_tr_b16 a[120:121], v22 offset:12296
    ds_read_b64_tr_b16 a[122:123], v22 offset:12424
    ds_read_b64_tr_b16 a[124:125], v22 offset:13320
    ds_read_b64_tr_b16 a[126:127], v22 offset:13448
    s_mov_b32 s8, s36
    s_mov_b32 s9, s37
    s_lshl_b32 s87, s12, 21
    s_lshl_b32 s22, s14, 19
    s_add_u32 s87, s87, s22
    s_lshl_b32 s22, s13, 6
    s_add_u32 s87, s87, s22
    s_add_u32 m0, s86, 8192
    s_nop 0
    buffer_load_dwordx4 v141, s[8:11], s87 offen lds
    s_add_u32 s87, s87, 32768
    s_add_u32 m0, s86, 9216
    s_nop 0
    buffer_load_dwordx4 v141, s[8:11], s87 offen lds
    s_add_u32 s87, s87, 32768
    s_add_u32 m0, s86, 10240
    s_nop 0
    buffer_load_dwordx4 v141, s[8:11], s87 offen lds
    s_add_u32 s87, s87, 32768
    s_add_u32 m0, s86, 11264
    s_nop 0
    buffer_load_dwordx4 v141, s[8:11], s87 offen lds
    s_add_u32 s87, s87, 32768
    s_waitcnt vmcnt(32)
    ds_read_b64_tr_b16 a[128:129], v22 offset:16384
    ds_read_b64_tr_b16 a[130:131], v22 offset:16512
    ds_read_b64_tr_b16 a[132:133], v22 offset:17408
    ds_read_b64_tr_b16 a[134:135], v22 offset:17536
    s_waitcnt lgkmcnt(4)
    ds_read_b64_tr_b16 a[160:161], v22 offset:16392
    ds_read_b64_tr_b16 a[162:163], v22 offset:16520
    ds_read_b64_tr_b16 a[164:165], v22 offset:17416
    ds_read_b64_tr_b16 a[166:167], v22 offset:17544
    s_add_u32 m0, s86, 12288
    s_nop 0
    buffer_load_dwordx4 v141, s[8:11], s87 offen lds
    s_add_u32 s87, s87, 32768
    s_add_u32 m0, s86, 13312
    s_nop 0
    buffer_load_dwordx4 v141, s[8:11], s87 offen lds
    s_add_u32 s87, s87, 32768
    s_add_u32 m0, s86, 14336
    s_nop 0
    buffer_load_dwordx4 v141, s[8:11], s87 offen lds
    s_add_u32 s87, s87, 32768
    s_add_u32 m0, s86, 15360
    s_nop 0
    buffer_load_dwordx4 v141, s[8:11], s87 offen lds
    s_add_u32 s87, s87, 32768
    s_waitcnt vmcnt(32)
    ds_read_b64_tr_b16 a[136:137], v22 offset:20480
    ds_read_b64_tr_b16 a[138:139], v22 offset:20608
    ds_read_b64_tr_b16 a[140:141], v22 offset:21504
    ds_read_b64_tr_b16 a[142:143], v22 offset:21632
    s_waitcnt lgkmcnt(4)
    ds_read_b64_tr_b16 a[168:169], v22 offset:20488
    ds_read_b64_tr_b16 a[170:171], v22 offset:20616
    ds_read_b64_tr_b16 a[172:173], v22 offset:21512
    ds_read_b64_tr_b16 a[174:175], v22 offset:21640
    s_add_u32 m0, s86, 16384
    s_nop 0
    buffer_load_dwordx4 v141, s[8:11], s87 offen lds
    s_add_u32 s87, s87, 32768
    s_add_u32 m0, s86, 17408
    s_nop 0
    buffer_load_dwordx4 v141, s[8:11], s87 offen lds
    s_add_u32 s87, s87, 32768
    s_add_u32 m0, s86, 18432
    s_nop 0
    buffer_load_dwordx4 v141, s[8:11], s87 offen lds
    s_add_u32 s87, s87, 32768
    s_add_u32 m0, s86, 19456
    s_nop 0
    buffer_load_dwordx4 v141, s[8:11], s87 offen lds
    s_add_u32 s87, s87, 32768
    s_mul_i32 s22, s14, 294912
    s_add_u32 s22, s22, 81788928
    buffer_load_dword v145, v3, s[4:7], s22 offen offset:0 sc1
    buffer_load_dword v146, v3, s[4:7], s22 offen offset:128 sc1
    buffer_load_dword v147, v4, s[4:7], s22 offen offset:0 sc1
    buffer_load_dword v148, v7, s[4:7], s22 offen offset:0 sc1
    buffer_load_dword v149, v11, s[4:7], s22 offen offset:0 sc1
    s_waitcnt vmcnt(37)
    ds_read_b64_tr_b16 a[144:145], v22 offset:24576
    ds_read_b64_tr_b16 a[146:147], v22 offset:24704
    ds_read_b64_tr_b16 a[148:149], v22 offset:25600
    ds_read_b64_tr_b16 a[150:151], v22 offset:25728
    s_waitcnt lgkmcnt(4)
    ds_read_b64_tr_b16 a[176:177], v22 offset:24584
    ds_read_b64_tr_b16 a[178:179], v22 offset:24712
    ds_read_b64_tr_b16 a[180:181], v22 offset:25608
    ds_read_b64_tr_b16 a[182:183], v22 offset:25736
    s_add_u32 m0, s86, 20480
    s_nop 0
    buffer_load_dwordx4 v141, s[8:11], s87 offen lds
    s_add_u32 s87, s87, 32768
    s_add_u32 m0, s86, 21504
    s_nop 0
    buffer_load_dwordx4 v141, s[8:11], s87 offen lds
    s_add_u32 s87, s87, 32768
    s_add_u32 m0, s86, 22528
    s_nop 0
    buffer_load_dwordx4 v141, s[8:11], s87 offen lds
    s_add_u32 s87, s87, 32768
    s_add_u32 m0, s86, 23552
    s_nop 0
    buffer_load_dwordx4 v141, s[8:11], s87 offen lds
    s_add_u32 s87, s87, 32768
    s_waitcnt vmcnt(37)
    ds_read_b64_tr_b16 a[152:153], v22 offset:28672
    ds_read_b64_tr_b16 a[154:155], v22 offset:28800
    ds_read_b64_tr_b16 a[156:157], v22 offset:29696
    ds_read_b64_tr_b16 a[158:159], v22 offset:29824
    s_waitcnt lgkmcnt(4)
    ds_read_b64_tr_b16 a[184:185], v22 offset:28680
    ds_read_b64_tr_b16 a[186:187], v22 offset:28808
    ds_read_b64_tr_b16 a[188:189], v22 offset:29704
    ds_read_b64_tr_b16 a[190:191], v22 offset:29832
    s_waitcnt vmcnt(33)
    ds_read_b64_tr_b16 a[0:1], v22 offset:32768
    ds_read_b64_tr_b16 a[2:3], v22 offset:32896
    ds_read_b64_tr_b16 a[4:5], v22 offset:33792
    ds_read_b64_tr_b16 a[6:7], v22 offset:33920
    s_waitcnt lgkmcnt(4)
    ds_read_b64_tr_b16 a[32:33], v22 offset:32776
    ds_read_b64_tr_b16 a[34:35], v22 offset:32904
    ds_read_b64_tr_b16 a[36:37], v22 offset:33800
    ds_read_b64_tr_b16 a[38:39], v22 offset:33928
    s_waitcnt vmcnt(29)
    ds_read_b64_tr_b16 a[8:9], v22 offset:36864
    ds_read_b64_tr_b16 a[10:11], v22 offset:36992
    ds_read_b64_tr_b16 a[12:13], v22 offset:37888
    ds_read_b64_tr_b16 a[14:15], v22 offset:38016
    s_waitcnt lgkmcnt(4)
    ds_read_b64_tr_b16 a[40:41], v22 offset:36872
    ds_read_b64_tr_b16 a[42:43], v22 offset:37000
    ds_read_b64_tr_b16 a[44:45], v22 offset:37896
    ds_read_b64_tr_b16 a[46:47], v22 offset:38024
    s_waitcnt vmcnt(25)
    ds_read_b64_tr_b16 a[16:17], v22 offset:0
    ds_read_b64_tr_b16 a[18:19], v22 offset:128
    ds_read_b64_tr_b16 a[20:21], v22 offset:1024
    ds_read_b64_tr_b16 a[22:23], v22 offset:1152
    s_waitcnt lgkmcnt(4)
    ds_read_b64_tr_b16 a[48:49], v22 offset:8
    ds_read_b64_tr_b16 a[50:51], v22 offset:136
    ds_read_b64_tr_b16 a[52:53], v22 offset:1032
    ds_read_b64_tr_b16 a[54:55], v22 offset:1160
    s_waitcnt vmcnt(21)
    ds_read_b64_tr_b16 a[24:25], v22 offset:4096
    ds_read_b64_tr_b16 a[26:27], v22 offset:4224
    ds_read_b64_tr_b16 a[28:29], v22 offset:5120
    ds_read_b64_tr_b16 a[30:31], v22 offset:5248
    s_waitcnt lgkmcnt(4)
    ds_read_b64_tr_b16 a[56:57], v22 offset:4104
    ds_read_b64_tr_b16 a[58:59], v22 offset:4232
    ds_read_b64_tr_b16 a[60:61], v22 offset:5128
    ds_read_b64_tr_b16 a[62:63], v22 offset:5256
    s_waitcnt vmcnt(17)
    ds_read_b64_tr_b16 a[192:193], v22 offset:8192
    ds_read_b64_tr_b16 a[194:195], v22 offset:8320
    ds_read_b64_tr_b16 a[196:197], v22 offset:9216
    ds_read_b64_tr_b16 a[198:199], v22 offset:9344
    s_waitcnt lgkmcnt(4)
    ds_read_b64_tr_b16 a[224:225], v22 offset:8200
    ds_read_b64_tr_b16 a[226:227], v22 offset:8328
    ds_read_b64_tr_b16 a[228:229], v22 offset:9224
    ds_read_b64_tr_b16 a[230:231], v22 offset:9352
    s_waitcnt vmcnt(13)
    ds_read_b64_tr_b16 a[200:201], v22 offset:12288
    ds_read_b64_tr_b16 a[202:203], v22 offset:12416
    ds_read_b64_tr_b16 a[204:205], v22 offset:13312
    ds_read_b64_tr_b16 a[206:207], v22 offset:13440
    s_waitcnt lgkmcnt(4)
    ds_read_b64_tr_b16 a[232:233], v22 offset:12296
    ds_read_b64_tr_b16 a[234:235], v22 offset:12424
    ds_read_b64_tr_b16 a[236:237], v22 offset:13320
    ds_read_b64_tr_b16 a[238:239], v22 offset:13448
    s_waitcnt vmcnt(9)
    ds_read_b64_tr_b16 a[208:209], v22 offset:16384
    ds_read_b64_tr_b16 a[210:211], v22 offset:16512
    ds_read_b64_tr_b16 a[212:213], v22 offset:17408
    ds_read_b64_tr_b16 a[214:215], v22 offset:17536
    s_waitcnt lgkmcnt(4)
    ds_read_b64_tr_b16 a[240:241], v22 offset:16392
    ds_read_b64_tr_b16 a[242:243], v22 offset:16520
    ds_read_b64_tr_b16 a[244:245], v22 offset:17416
    ds_read_b64_tr_b16 a[246:247], v22 offset:17544
    s_waitcnt vmcnt(0)
    ds_read_b64_tr_b16 a[216:217], v22 offset:20480
    ds_read_b64_tr_b16 a[218:219], v22 offset:20608
    ds_read_b64_tr_b16 a[220:221], v22 offset:21504
    ds_read_b64_tr_b16 a[222:223], v22 offset:21632
    s_waitcnt lgkmcnt(4)
    ds_read_b64_tr_b16 a[248:249], v22 offset:20488
    ds_read_b64_tr_b16 a[250:251], v22 offset:20616
    ds_read_b64_tr_b16 a[252:253], v22 offset:21512
    ds_read_b64_tr_b16 a[254:255], v22 offset:21640
    s_waitcnt lgkmcnt(0)
    v_mov_b32 v155, 0
    v_mov_b32 v159, 0
    v_mov_b32 v163, 0
    v_mov_b32 v167, 0
    v_mov_b32 v179, 0
    s_mov_b32 s8, s28
    s_mov_b32 s9, s29
    s_mov_b32 s10, 16384
    v_lshlrev_b32 v20, 11, v96
    v_lshl_add_u32 v20, v98, 4, v20
    v_lshl_add_u32 v20, v97, 3, v20
    s_lshl_b32 s21, s13, 6
    buffer_load_dwordx2 v[88:89], v20, s[8:11], s21 offen
    v_lshlrev_b32 v20, 2, v1
    s_mov_b32 s22, 0
rdv_21:
    global_load_dword v21, v20, s[100:101] sc1
    s_lshl_b32 s21, s98, 2
    s_waitcnt vmcnt(0)
    v_lshrrev_b32 v22, s21, v21
    s_cmp_eq_u32 s98, 0
    s_cselect_b32 s21, 0x0f0f0f0f, s21
    s_cselect_b32 s21, s21, 0x01010101
    v_and_b32 v22, s21, v22
    v_cmp_ne_u32 vcc, 0x01010101, v22
    s_nop 0
    s_cbranch_vccz rdvok_22
    v_sad_u8 v22, v22, 0, 0
    s_nop 1
    v_add_u32_dpp v22, v22, v22 quad_perm:[1,0,3,2] row_mask:0xf bank_mask:0xf
    v_cmp_ne_u32 vcc, 8, v22
    s_nop 0
    s_cbranch_vccnz rdvw_23
    s_mov_b32 s98, 1
    s_and_b32 s3, s97, 7
    s_barrier
    s_branch role_start
rdvw_23:
    s_sleep 4
    s_add_u32 s22, s22, 1
    s_cmp_lt_u32 s22, 262144
    s_cbranch_scc1 rdv_21
    s_mov_b32 s25, 200000
rdvok_22:
    v_and_b32 v22, 0x40404040, v21
    v_bcnt_u32_b32 v22, v22, 0
    s_mov_b32 s46, 0
    v_cmp_le_u32 vcc, 1, v22
    s_nop 0
    s_bcnt1_i32_b64 s21, vcc
    s_add_u32 s46, s46, s21
    v_cmp_le_u32 vcc, 2, v22
    s_nop 0
    s_bcnt1_i32_b64 s21, vcc
    s_add_u32 s46, s46, s21
    v_cmp_le_u32 vcc, 3, v22
    s_nop 0
    s_bcnt1_i32_b64 s21, vcc
    s_add_u32 s46, s46, s21
    v_cmp_le_u32 vcc, 4, v22
    s_nop 0
    s_bcnt1_i32_b64 s21, vcc
    s_add_u32 s46, s46, s21
    s_cmp_gt_u32 s46, 16
    s_cselect_b32 s46, 8192, 0
    s_add_u32 s84, s95, s46
    s_xor_b32 s45, s98, 1
    v_min_u32 v88, -2, v88
    v_min_u32 v89, -2, v89
    buffer_store_dwordx2 v[88:89], v11, s[4:7], s16 offen sc1
    v_mov_b32 v40, 0
    v_mov_b32 v41, 0
    v_mov_b32 v42, 0
    v_mov_b32 v43, 0
    v_mov_b32 v44, 0
    v_mov_b32 v45, 0
    v_mov_b32 v46, 0
    v_mov_b32 v47, 0
    v_mov_b32 v48, 0
    v_mov_b32 v49, 0
    v_mov_b32 v50, 0
    v_mov_b32 v51, 0
    v_mov_b32 v52, 0
    v_mov_b32 v53, 0
    v_mov_b32 v54, 0
    v_mov_b32 v55, 0
    v_mov_b32 v56, 0
    v_mov_b32 v57, 0
    v_mov_b32 v58, 0
    v_mov_b32 v59, 0
    v_mov_b32 v60, 0
    v_mov_b32 v61, 0
    v_mov_b32 v62, 0
    v_mov_b32 v63, 0
    v_mov_b32 v64, 0
    v_mov_b32 v65, 0
    v_mov_b32 v66, 0
    v_mov_b32 v67, 0
    v_mov_b32 v68, 0
    v_mov_b32 v69, 0
    v_mov_b32 v70, 0
    v_mov_b32 v71, 0
    s_cmp_ge_u32 s14, 2
    s_cbranch_scc1 kv_24
    s_mov_b32 s94, 1
    s_mov_b32 s23, s25
fw_26:
    s_cmp_ge_u32 s85, s94
    s_cbranch_scc1 fo_27
    buffer_load_dword v247, v245, s[4:7], 0 offen sc1
    s_add_u32 s23, s23, 1
    s_waitcnt vmcnt(0)
    v_readfirstlane_b32 s85, v247
    s_cmp_lt_u32 s23, 200000
    s_cbranch_scc1 fw_26
    s_mov_b32 s25, 200000
fo_27:
    s_cmp_eq_u32 s14, 1
    s_cbranch_scc1 kv_25
    buffer_load_dwordx4 v[132:135], v12, s[4:7], s17 offen sc1
    buffer_load_dwordx4 v[136:139], v12, s[4:7], s17 offen offset:256 sc1
    s_add_u32 s17, s17, 2048
    s_min_u32 s17, s17, 17954816
    s_branch kv_24
kv_25:
    buffer_load_dwordx4 v[228:231], v13, s[4:7], s18 offen offset:0 sc1
    buffer_load_dwordx4 v[232:235], v13, s[4:7], s18 offen offset:256 sc1
    s_add_u32 s18, s18, 2048
    s_min_u32 s18, s18, 35780608
kv_24:
    s_mul_i32 s86, s27, 4160
    s_add_u32 s86, s86, 17825792
    s_mov_b32 s23, s25
    s_barrier
    s_cmp_eq_u32 s45, 0
    s_cbranch_scc1 recur_slow_disp
    s_cmp_eq_u32 s14, 1
    s_cbranch_scc1 recur_fast_w1
    s_cmp_eq_u32 s14, 2
    s_cbranch_scc1 recur_fast_w2
    s_cmp_eq_u32 s14, 3
    s_cbranch_scc1 recur_fast_w3
    s_branch recur_fast_w0
recur_slow_disp:
    s_cmp_eq_u32 s14, 1
    s_cbranch_scc1 recur_slow_w1
    s_cmp_eq_u32 s14, 2
    s_cbranch_scc1 recur_slow_w2
    s_cmp_eq_u32 s14, 3
    s_cbranch_scc1 recur_slow_w3
    s_branch recur_slow_w0
.p2align 6
recur_fast_w0:
    s_nop 15
    s_mov_b32 s23, s25
    buffer_load_dwordx4 v[24:27], v2, s[4:7], s16 offen offset:0 sc1
    s_nop 11
    buffer_load_dwordx4 v[28:31], v2, s[4:7], s16 offen offset:1024 sc1
    s_nop 11
    buffer_load_dwordx4 v[32:35], v2, s[4:7], s16 offen offset:2048 sc1
    s_nop 11
    buffer_load_dwordx4 v[36:39], v2, s[4:7], s16 offen offset:3072 sc1
    s_waitcnt vmcnt(3)
    v_max3_u32 v19, v24, v25, v26
    v_max_u32 v19, v19, v27
    v_cmp_eq_u32 vcc, -1, v19
    s_nop 0
    s_cbranch_vccnz g_28F15_0
    v_smfmac_f32_16x16x64_bf16 v[40:43], v[24:27], a[0:7], v172
    s_waitcnt vmcnt(2)
    v_max3_u32 v19, v28, v29, v30
    v_max_u32 v19, v19, v31
    v_smfmac_f32_16x16x64_bf16 v[44:47], v[24:27], a[64:71], v172
    v_cmp_eq_u32 vcc, -1, v19
    v_smfmac_f32_16x16x64_bf16 v[48:51], v[24:27], a[32:39], v172
    v_smfmac_f32_16x16x64_bf16 v[52:55], v[24:27], a[96:103], v172
    s_cbranch_vccnz g_28F14_1
    v_smfmac_f32_16x16x64_bf16 v[40:43], v[28:31], a[8:15], v172
    s_waitcnt vmcnt(1)
    v_max3_u32 v19, v32, v33, v34
    v_max_u32 v19, v19, v35
    v_smfmac_f32_16x16x64_bf16 v[44:47], v[28:31], a[72:79], v172
    v_cmp_eq_u32 vcc, -1, v19
    v_smfmac_f32_16x16x64_bf16 v[48:51], v[28:31], a[40:47], v172
    v_smfmac_f32_16x16x64_bf16 v[52:55], v[28:31], a[104:111], v172
    s_cbranch_vccnz g_28F12_2
    v_smfmac_f32_16x16x64_bf16 v[40:43], v[32:35], a[16:23], v172
    s_waitcnt vmcnt(0)
    v_max3_u32 v19, v36, v37, v38
    v_max_u32 v19, v19, v39
    v_smfmac_f32_16x16x64_bf16 v[44:47], v[32:35], a[80:87], v172
    v_cmp_eq_u32 vcc, -1, v19
    v_smfmac_f32_16x16x64_bf16 v[48:51], v[32:35], a[48:55], v172
    v_smfmac_f32_16x16x64_bf16 v[52:55], v[32:35], a[112:119], v172
    s_cbranch_vccnz g_28F8_3
    v_smfmac_f32_16x16x64_bf16 v[40:43], v[36:39], a[24:31], v172
    v_smfmac_f32_16x16x64_bf16 v[44:47], v[36:39], a[88:95], v172
    v_smfmac_f32_16x16x64_bf16 v[48:51], v[36:39], a[56:63], v172
    v_smfmac_f32_16x16x64_bf16 v[52:55], v[36:39], a[120:127], v172
gc_29:
    v_cvt_pk_bf16_f32 v72, v40, v41
    v_cvt_pk_bf16_f32 v73, v42, v43
    v_cvt_pk_bf16_f32 v74, v44, v45
    v_cvt_pk_bf16_f32 v75, v46, v47
    v_smfmac_f32_16x16x64_bf16 v[56:59], v[24:27], a[128:135], v172
    v_cvt_pk_bf16_f32 v76, v48, v49
    v_cvt_pk_bf16_f32 v77, v50, v51
    s_nop 0
    v_cvt_pk_bf16_f32 v78, v52, v53
    v_cvt_pk_bf16_f32 v79, v54, v55
    v_smfmac_f32_16x16x64_bf16 v[60:63], v[24:27], a[160:167], v172
    v_mfma_f32_16x16x32_bf16 v[88:91], v[72:75], v[84:87], 0
    v_mfma_f32_16x16x32_bf16 v[92:95], v[76:79], v[84:87], 0
    v_smfmac_f32_16x16x64_bf16 v[56:59], v[28:31], a[136:143], v172
    v_smfmac_f32_16x16x64_bf16 v[60:63], v[28:31], a[168:175], v172
    s_barrier
    ds_read_b128 v[104:107], v16 offset:2048
    ds_read_b128 v[108:111], v16 offset:3072
    ds_read_b128 v[112:115], v16 offset:4096
    ds_read_b128 v[116:119], v16 offset:5120
    ds_read_b128 v[120:123], v16 offset:6144
    ds_read_b128 v[124:127], v16 offset:7168
    v_smfmac_f32_16x16x64_bf16 v[56:59], v[32:35], a[144:151], v172
    v_smfmac_f32_16x16x64_bf16 v[60:63], v[32:35], a[176:183], v172
    v_smfmac_f32_16x16x64_bf16 v[56:59], v[36:39], a[152:159], v172
    v_smfmac_f32_16x16x64_bf16 v[60:63], v[36:39], a[184:191], v172
    s_waitcnt lgkmcnt(5)
    v_mfma_f32_16x16x32_bf16 v[88:91], v[104:107], v[84:87], v[88:91]
    s_waitcnt lgkmcnt(4)
    v_mfma_f32_16x16x32_bf16 v[92:95], v[108:111], v[84:87], v[92:95]
    s_waitcnt lgkmcnt(3)
    v_mfma_f32_16x16x32_bf16 v[88:91], v[112:115], v[84:87], v[88:91]
    s_waitcnt lgkmcnt(2)
    v_mfma_f32_16x16x32_bf16 v[92:95], v[116:119], v[84:87], v[92:95]
    s_waitcnt lgkmcnt(1)
    v_mfma_f32_16x16x32_bf16 v[88:91], v[120:123], v[84:87], v[88:91]
    s_waitcnt lgkmcnt(0)
    v_mfma_f32_16x16x32_bf16 v[92:95], v[124:127], v[84:87], v[92:95]
    v_cvt_pk_bf16_f32 v80, v56, v57
    v_cvt_pk_bf16_f32 v81, v58, v59
    v_cvt_pk_bf16_f32 v82, v60, v61
    v_cvt_pk_bf16_f32 v83, v62, v63
    ds_write_b128 v17, v[80:83] offset:8192
    s_nop 0
    v_cvt_pk_bf16_f32 v128, v88, v89
    v_cvt_pk_bf16_f32 v129, v90, v91
    v_cvt_pk_bf16_f32 v130, v92, v93
    v_cvt_pk_bf16_f32 v131, v94, v95
    s_nop 1
    v_mfma_f32_16x16x32_bf16 v[144:147], v[132:135], v[128:131], 0
    v_mfma_f32_16x16x32_bf16 v[148:151], v[136:139], v[128:131], 0
    v_mfma_f32_16x16x32_bf16 v[140:143], v[128:131], v[128:131], 0
    s_nop 1
    buffer_store_dwordx4 v[144:147], v3, s[4:7], s16 offen
    s_nop 1
    buffer_store_dwordx4 v[148:151], v3, s[4:7], s16 offen offset:128
    s_nop 1
    buffer_store_dwordx4 v[140:143], v4, s[4:7], s16 offen
    s_cmp_eq_u32 s15, 63
    s_waitcnt lgkmcnt(0)
    s_barrier
    s_cbranch_scc1 recur_fast_last0
    v_readfirstlane_b32 s85, v247
    s_add_u32 s94, s15, 2
    s_barrier
    s_nop 15
    s_mov_b32 s23, s25
    buffer_load_dwordx4 v[24:27], v8, s[4:7], s16 offen offset:0 sc1
    s_nop 11
    buffer_load_dwordx4 v[28:31], v8, s[4:7], s16 offen offset:1024 sc1
    s_nop 11
    buffer_load_dwordx4 v[32:35], v8, s[4:7], s16 offen offset:2048 sc1
    s_nop 11
    buffer_load_dwordx4 v[36:39], v8, s[4:7], s16 offen offset:3072 sc1
    s_waitcnt vmcnt(3)
    v_max3_u32 v19, v24, v25, v26
    v_max_u32 v19, v19, v27
    v_cmp_eq_u32 vcc, -1, v19
    s_nop 0
    s_cbranch_vccnz g_30F15_0
    v_smfmac_f32_16x16x64_bf16 v[64:67], v[24:27], a[192:199], v172
    v_smfmac_f32_16x16x64_bf16 v[68:71], v[24:27], a[224:231], v172
    s_waitcnt vmcnt(2)
    v_max3_u32 v19, v28, v29, v30
    v_max_u32 v19, v19, v31
    v_cmp_eq_u32 vcc, -1, v19
    s_nop 0
    s_cbranch_vccnz g_30F14_1
    v_smfmac_f32_16x16x64_bf16 v[64:67], v[28:31], a[200:207], v172
    v_smfmac_f32_16x16x64_bf16 v[68:71], v[28:31], a[232:239], v172
    s_waitcnt vmcnt(1)
    v_max3_u32 v19, v32, v33, v34
    v_max_u32 v19, v19, v35
    v_cmp_eq_u32 vcc, -1, v19
    s_nop 0
    s_cbranch_vccnz g_30F12_2
    v_smfmac_f32_16x16x64_bf16 v[64:67], v[32:35], a[208:215], v172
    v_smfmac_f32_16x16x64_bf16 v[68:71], v[32:35], a[240:247], v172
    s_waitcnt vmcnt(0)
    v_max3_u32 v19, v36, v37, v38
    v_max_u32 v19, v19, v39
    v_cmp_eq_u32 vcc, -1, v19
    s_nop 0
    s_cbranch_vccnz g_30F8_3
    v_smfmac_f32_16x16x64_bf16 v[64:67], v[36:39], a[216:223], v172
    v_smfmac_f32_16x16x64_bf16 v[68:71], v[36:39], a[248:255], v172
    s_nop 4
    v_cvt_pk_bf16_f32 v80, v64, v65
    v_cvt_pk_bf16_f32 v81, v66, v67
    s_nop 0
    v_cvt_pk_bf16_f32 v82, v68, v69
    v_cvt_pk_bf16_f32 v83, v70, v71
    ds_write_b128 v17, v[80:83] offset:9216
gc_31:
    s_waitcnt lgkmcnt(0)
    s_barrier
    s_nop 15
    s_nop 15
    s_nop 15
    s_nop 15
    buffer_store_dwordx4 v[128:131], v14, s[4:7], s19 offen sc1
    s_add_u32 s19, s19, 512
    s_mov_b32 s23, s25
fw_32:
    s_cmp_ge_u32 s85, s94
    s_cbranch_scc1 fo_33
    buffer_load_dword v247, v245, s[4:7], 0 offen sc1
    s_add_u32 s23, s23, 1
    s_waitcnt vmcnt(0)
    v_readfirstlane_b32 s85, v247
    s_cmp_lt_u32 s23, 200000
    s_cbranch_scc1 fw_32
    s_mov_b32 s25, 200000
fo_33:
    buffer_load_dwordx4 v[132:135], v12, s[4:7], s17 offen sc1
    buffer_load_dwordx4 v[136:139], v12, s[4:7], s17 offen offset:256 sc1
    s_add_u32 s17, s17, 2048
    s_min_u32 s17, s17, 17954816
    s_add_u32 s21, s15, 3
    s_min_u32 s21, s21, 64
    s_cmp_lt_u32 s85, s21
    s_cselect_b64 exec, 1, 0
    buffer_load_dword v247, v245, s[4:7], 0 offen sc1
    s_mov_b64 exec, -1
    v_mov_b32 v40, 0
    v_mov_b32 v41, 0
    v_mov_b32 v42, 0
    v_mov_b32 v43, 0
    v_mov_b32 v44, 0
    v_mov_b32 v45, 0
    v_mov_b32 v46, 0
    v_mov_b32 v47, 0
    v_mov_b32 v48, 0
    v_mov_b32 v49, 0
    v_mov_b32 v50, 0
    v_mov_b32 v51, 0
    v_mov_b32 v52, 0
    v_mov_b32 v53, 0
    v_mov_b32 v54, 0
    v_mov_b32 v55, 0
    v_mov_b32 v56, 0
    v_mov_b32 v57, 0
    v_mov_b32 v58, 0
    v_mov_b32 v59, 0
    v_mov_b32 v60, 0
    v_mov_b32 v61, 0
    v_mov_b32 v62, 0
    v_mov_b32 v63, 0
    v_mov_b32 v64, 0
    v_mov_b32 v65, 0
    v_mov_b32 v66, 0
    v_mov_b32 v67, 0
    v_mov_b32 v68, 0
    v_mov_b32 v69, 0
    v_mov_b32 v70, 0
    v_mov_b32 v71, 0
    s_mov_b32 s21, s16
    s_mov_b32 s16, s42
    s_mov_b32 s42, s43
    s_mov_b32 s43, s44
    s_mov_b32 s44, s21
    s_add_u32 s95, s95, 524288
    s_lshr_b32 s84, s95, 8
    s_and_b32 s84, s84, 8192
    s_xor_b32 s84, s84, s46
    s_add_u32 s84, s84, s95
    s_add_u32 s15, s15, 1
    s_barrier
    s_branch recur_fast_w0
g_28L15_0:
    s_waitcnt vmcnt(3)
    v_max3_u32 v19, v24, v25, v26
    v_max_u32 v19, v19, v27
    v_cmp_eq_u32 vcc, -1, v19
    s_nop 0
    s_cbranch_vccnz g_28F15_0
    v_smfmac_f32_16x16x64_bf16 v[40:43], v[24:27], a[0:7], v172
    v_smfmac_f32_16x16x64_bf16 v[44:47], v[24:27], a[64:71], v172
    v_smfmac_f32_16x16x64_bf16 v[48:51], v[24:27], a[32:39], v172
    v_smfmac_f32_16x16x64_bf16 v[52:55], v[24:27], a[96:103], v172
g_28L14_1:
    s_waitcnt vmcnt(2)
    v_max3_u32 v19, v28, v29, v30
    v_max_u32 v19, v19, v31
    v_cmp_eq_u32 vcc, -1, v19
    s_nop 0
    s_cbranch_vccnz g_28F14_1
    v_smfmac_f32_16x16x64_bf16 v[40:43], v[28:31], a[8:15], v172
    v_smfmac_f32_16x16x64_bf16 v[44:47], v[28:31], a[72:79], v172
    v_smfmac_f32_16x16x64_bf16 v[48:51], v[28:31], a[40:47], v172
    v_smfmac_f32_16x16x64_bf16 v[52:55], v[28:31], a[104:111], v172
g_28L12_2:
    s_waitcnt vmcnt(1)
    v_max3_u32 v19, v32, v33, v34
    v_max_u32 v19, v19, v35
    v_cmp_eq_u32 vcc, -1, v19
    s_nop 0
    s_cbranch_vccnz g_28F12_2
    v_smfmac_f32_16x16x64_bf16 v[40:43], v[32:35], a[16:23], v172
    v_smfmac_f32_16x16x64_bf16 v[44:47], v[32:35], a[80:87], v172
    v_smfmac_f32_16x16x64_bf16 v[48:51], v[32:35], a[48:55], v172
    v_smfmac_f32_16x16x64_bf16 v[52:55], v[32:35], a[112:119], v172
g_28L8_3:
    s_waitcnt vmcnt(0)
    v_max3_u32 v19, v36, v37, v38
    v_max_u32 v19, v19, v39
    v_cmp_eq_u32 vcc, -1, v19
    s_nop 0
    s_cbranch_vccnz g_28F8_3
    v_smfmac_f32_16x16x64_bf16 v[40:43], v[36:39], a[24:31], v172
    v_smfmac_f32_16x16x64_bf16 v[44:47], v[36:39], a[88:95], v172
    v_smfmac_f32_16x16x64_bf16 v[48:51], v[36:39], a[56:63], v172
    v_smfmac_f32_16x16x64_bf16 v[52:55], v[36:39], a[120:127], v172
    s_branch gc_29
g_28L15_1:
    s_waitcnt vmcnt(3)
    v_max3_u32 v19, v28, v29, v30
    v_max_u32 v19, v19, v31
    v_cmp_eq_u32 vcc, -1, v19
    s_nop 0
    s_cbranch_vccnz g_28F15_1
    v_smfmac_f32_16x16x64_bf16 v[40:43], v[28:31], a[8:15], v172
    v_smfmac_f32_16x16x64_bf16 v[44:47], v[28:31], a[72:79], v172
    v_smfmac_f32_16x16x64_bf16 v[48:51], v[28:31], a[40:47], v172
    v_smfmac_f32_16x16x64_bf16 v[52:55], v[28:31], a[104:111], v172
g_28L13_2:
    s_waitcnt vmcnt(2)
    v_max3_u32 v19, v32, v33, v34
    v_max_u32 v19, v19, v35
    v_cmp_eq_u32 vcc, -1, v19
    s_nop 0
    s_cbranch_vccnz g_28F13_2
    v_smfmac_f32_16x16x64_bf16 v[40:43], v[32:35], a[16:23], v172
    v_smfmac_f32_16x16x64_bf16 v[44:47], v[32:35], a[80:87], v172
    v_smfmac_f32_16x16x64_bf16 v[48:51], v[32:35], a[48:55], v172
    v_smfmac_f32_16x16x64_bf16 v[52:55], v[32:35], a[112:119], v172
g_28L9_3:
    s_waitcnt vmcnt(1)
    v_max3_u32 v19, v36, v37, v38
    v_max_u32 v19, v19, v39
    v_cmp_eq_u32 vcc, -1, v19
    s_nop 0
    s_cbranch_vccnz g_28F9_3
    v_smfmac_f32_16x16x64_bf16 v[40:43], v[36:39], a[24:31], v172
    v_smfmac_f32_16x16x64_bf16 v[44:47], v[36:39], a[88:95], v172
    v_smfmac_f32_16x16x64_bf16 v[48:51], v[36:39], a[56:63], v172
    v_smfmac_f32_16x16x64_bf16 v[52:55], v[36:39], a[120:127], v172
g_28L1_0:
    s_waitcnt vmcnt(0)
    v_max3_u32 v19, v24, v25, v26
    v_max_u32 v19, v19, v27
    v_cmp_eq_u32 vcc, -1, v19
    s_nop 0
    s_cbranch_vccnz g_28F1_0
    v_smfmac_f32_16x16x64_bf16 v[40:43], v[24:27], a[0:7], v172
    v_smfmac_f32_16x16x64_bf16 v[44:47], v[24:27], a[64:71], v172
    v_smfmac_f32_16x16x64_bf16 v[48:51], v[24:27], a[32:39], v172
    v_smfmac_f32_16x16x64_bf16 v[52:55], v[24:27], a[96:103], v172
    s_branch gc_29
g_28L15_2:
    s_waitcnt vmcnt(3)
    v_max3_u32 v19, v32, v33, v34
    v_max_u32 v19, v19, v35
    v_cmp_eq_u32 vcc, -1, v19
    s_nop 0
    s_cbranch_vccnz g_28F15_2
    v_smfmac_f32_16x16x64_bf16 v[40:43], v[32:35], a[16:23], v172
    v_smfmac_f32_16x16x64_bf16 v[44:47], v[32:35], a[80:87], v172
    v_smfmac_f32_16x16x64_bf16 v[48:51], v[32:35], a[48:55], v172
    v_smfmac_f32_16x16x64_bf16 v[52:55], v[32:35], a[112:119], v172
g_28L11_3:
    s_waitcnt vmcnt(2)
    v_max3_u32 v19, v36, v37, v38
    v_max_u32 v19, v19, v39
    v_cmp_eq_u32 vcc, -1, v19
    s_nop 0
    s_cbranch_vccnz g_28F11_3
    v_smfmac_f32_16x16x64_bf16 v[40:43], v[36:39], a[24:31], v172
    v_smfmac_f32_16x16x64_bf16 v[44:47], v[36:39], a[88:95], v172
    v_smfmac_f32_16x16x64_bf16 v[48:51], v[36:39], a[56:63], v172
    v_smfmac_f32_16x16x64_bf16 v[52:55], v[36:39], a[120:127], v172
g_28L3_0:
    s_waitcnt vmcnt(1)
    v_max3_u32 v19, v24, v25, v26
    v_max_u32 v19, v19, v27
    v_cmp_eq_u32 vcc, -1, v19
    s_nop 0
    s_cbranch_vccnz g_28F3_0
    v_smfmac_f32_16x16x64_bf16 v[40:43], v[24:27], a[0:7], v172
    v_smfmac_f32_16x16x64_bf16 v[44:47], v[24:27], a[64:71], v172
    v_smfmac_f32_16x16x64_bf16 v[48:51], v[24:27], a[32:39], v172
    v_smfmac_f32_16x16x64_bf16 v[52:55], v[24:27], a[96:103], v172
g_28L2_1:
    s_waitcnt vmcnt(0)
    v_max3_u32 v19, v28, v29, v30
    v_max_u32 v19, v19, v31
    v_cmp_eq_u32 vcc, -1, v19
    s_nop 0
    s_cbranch_vccnz g_28F2_1
    v_smfmac_f32_16x16x64_bf16 v[40:43], v[28:31], a[8:15], v172
    v_smfmac_f32_16x16x64_bf16 v[44:47], v[28:31], a[72:79], v172
    v_smfmac_f32_16x16x64_bf16 v[48:51], v[28:31], a[40:47], v172
    v_smfmac_f32_16x16x64_bf16 v[52:55], v[28:31], a[104:111], v172
    s_branch gc_29
g_28L15_3:
    s_waitcnt vmcnt(3)
    v_max3_u32 v19, v36, v37, v38
    v_max_u32 v19, v19, v39
    v_cmp_eq_u32 vcc, -1, v19
    s_nop 0
    s_cbranch_vccnz g_28F15_3
    v_smfmac_f32_16x16x64_bf16 v[40:43], v[36:39], a[24:31], v172
    v_smfmac_f32_16x16x64_bf16 v[44:47], v[36:39], a[88:95], v172
    v_smfmac_f32_16x16x64_bf16 v[48:51], v[36:39], a[56:63], v172
    v_smfmac_f32_16x16x64_bf16 v[52:55], v[36:39], a[120:127], v172
g_28L7_0:
    s_waitcnt vmcnt(2)
    v_max3_u32 v19, v24, v25, v26
    v_max_u32 v19, v19, v27
    v_cmp_eq_u32 vcc, -1, v19
    s_nop 0
    s_cbranch_vccnz g_28F7_0
    v_smfmac_f32_16x16x64_bf16 v[40:43], v[24:27], a[0:7], v172
    v_smfmac_f32_16x16x64_bf16 v[44:47], v[24:27], a[64:71], v172
    v_smfmac_f32_16x16x64_bf16 v[48:51], v[24:27], a[32:39], v172
    v_smfmac_f32_16x16x64_bf16 v[52:55], v[24:27], a[96:103], v172
g_28L6_1:
    s_waitcnt vmcnt(1)
    v_max3_u32 v19, v28, v29, v30
    v_max_u32 v19, v19, v31
    v_cmp_eq_u32 vcc, -1, v19
    s_nop 0
    s_cbranch_vccnz g_28F6_1
    v_smfmac_f32_16x16x64_bf16 v[40:43], v[28:31], a[8:15], v172
    v_smfmac_f32_16x16x64_bf16 v[44:47], v[28:31], a[72:79], v172
    v_smfmac_f32_16x16x64_bf16 v[48:51], v[28:31], a[40:47], v172
    v_smfmac_f32_16x16x64_bf16 v[52:55], v[28:31], a[104:111], v172
g_28L4_2:
    s_waitcnt vmcnt(0)
    v_max3_u32 v19, v32, v33, v34
    v_max_u32 v19, v19, v35
    v_cmp_eq_u32 vcc, -1, v19
    s_nop 0
    s_cbranch_vccnz g_28F4_2
    v_smfmac_f32_16x16x64_bf16 v[40:43], v[32:35], a[16:23], v172
    v_smfmac_f32_16x16x64_bf16 v[44:47], v[32:35], a[80:87], v172
    v_smfmac_f32_16x16x64_bf16 v[48:51], v[32:35], a[48:55], v172
    v_smfmac_f32_16x16x64_bf16 v[52:55], v[32:35], a[112:119], v172
    s_branch gc_29
g_28L7_1:
    s_waitcnt vmcnt(2)
    v_max3_u32 v19, v28, v29, v30
    v_max_u32 v19, v19, v31
    v_cmp_eq_u32 vcc, -1, v19
    s_nop 0
    s_cbranch_vccnz g_28F7_1
    v_smfmac_f32_16x16x64_bf16 v[40:43], v[28:31], a[8:15], v172
    v_smfmac_f32_16x16x64_bf16 v[44:47], v[28:31], a[72:79], v172
    v_smfmac_f32_16x16x64_bf16 v[48:51], v[28:31], a[40:47], v172
    v_smfmac_f32_16x16x64_bf16 v[52:55], v[28:31], a[104:111], v172
g_28L5_2:
    s_waitcnt vmcnt(1)
    v_max3_u32 v19, v32, v33, v34
    v_max_u32 v19, v19, v35
    v_cmp_eq_u32 vcc, -1, v19
    s_nop 0
    s_cbranch_vccnz g_28F5_2
    v_smfmac_f32_16x16x64_bf16 v[40:43], v[32:35], a[16:23], v172
    v_smfmac_f32_16x16x64_bf16 v[44:47], v[32:35], a[80:87], v172
    v_smfmac_f32_16x16x64_bf16 v[48:51], v[32:35], a[48:55], v172
    v_smfmac_f32_16x16x64_bf16 v[52:55], v[32:35], a[112:119], v172
    s_branch g_28L1_0
g_28L7_2:
    s_waitcnt vmcnt(2)
    v_max3_u32 v19, v32, v33, v34
    v_max_u32 v19, v19, v35
    v_cmp_eq_u32 vcc, -1, v19
    s_nop 0
    s_cbranch_vccnz g_28F7_2
    v_smfmac_f32_16x16x64_bf16 v[40:43], v[32:35], a[16:23], v172
    v_smfmac_f32_16x16x64_bf16 v[44:47], v[32:35], a[80:87], v172
    v_smfmac_f32_16x16x64_bf16 v[48:51], v[32:35], a[48:55], v172
    v_smfmac_f32_16x16x64_bf16 v[52:55], v[32:35], a[112:119], v172
    s_branch g_28L3_0
g_28L11_0:
    s_waitcnt vmcnt(2)
    v_max3_u32 v19, v24, v25, v26
    v_max_u32 v19, v19, v27
    v_cmp_eq_u32 vcc, -1, v19
    s_nop 0
    s_cbranch_vccnz g_28F11_0
    v_smfmac_f32_16x16x64_bf16 v[40:43], v[24:27], a[0:7], v172
    v_smfmac_f32_16x16x64_bf16 v[44:47], v[24:27], a[64:71], v172
    v_smfmac_f32_16x16x64_bf16 v[48:51], v[24:27], a[32:39], v172
    v_smfmac_f32_16x16x64_bf16 v[52:55], v[24:27], a[96:103], v172
g_28L10_1:
    s_waitcnt vmcnt(1)
    v_max3_u32 v19, v28, v29, v30
    v_max_u32 v19, v19, v31
    v_cmp_eq_u32 vcc, -1, v19
    s_nop 0
    s_cbranch_vccnz g_28F10_1
    v_smfmac_f32_16x16x64_bf16 v[40:43], v[28:31], a[8:15], v172
    v_smfmac_f32_16x16x64_bf16 v[44:47], v[28:31], a[72:79], v172
    v_smfmac_f32_16x16x64_bf16 v[48:51], v[28:31], a[40:47], v172
    v_smfmac_f32_16x16x64_bf16 v[52:55], v[28:31], a[104:111], v172
    s_branch g_28L8_3
g_28L11_1:
    s_waitcnt vmcnt(2)
    v_max3_u32 v19, v28, v29, v30
    v_max_u32 v19, v19, v31
    v_cmp_eq_u32 vcc, -1, v19
    s_nop 0
    s_cbranch_vccnz g_28F11_1
    v_smfmac_f32_16x16x64_bf16 v[40:43], v[28:31], a[8:15], v172
    v_smfmac_f32_16x16x64_bf16 v[44:47], v[28:31], a[72:79], v172
    v_smfmac_f32_16x16x64_bf16 v[48:51], v[28:31], a[40:47], v172
    v_smfmac_f32_16x16x64_bf16 v[52:55], v[28:31], a[104:111], v172
    s_branch g_28L9_3
g_28L13_0:
    s_waitcnt vmcnt(2)
    v_max3_u32 v19, v24, v25, v26
    v_max_u32 v19, v19, v27
    v_cmp_eq_u32 vcc, -1, v19
    s_nop 0
    s_cbranch_vccnz g_28F13_0
    v_smfmac_f32_16x16x64_bf16 v[40:43], v[24:27], a[0:7], v172
    v_smfmac_f32_16x16x64_bf16 v[44:47], v[24:27], a[64:71], v172
    v_smfmac_f32_16x16x64_bf16 v[48:51], v[24:27], a[32:39], v172
    v_smfmac_f32_16x16x64_bf16 v[52:55], v[24:27], a[96:103], v172
    s_branch g_28L12_2
g_28L13_3:
    s_waitcnt vmcnt(2)
    v_max3_u32 v19, v36, v37, v38
    v_max_u32 v19, v19, v39
    v_cmp_eq_u32 vcc, -1, v19
    s_nop 0
    s_cbranch_vccnz g_28F13_3
    v_smfmac_f32_16x16x64_bf16 v[40:43], v[36:39], a[24:31], v172
    v_smfmac_f32_16x16x64_bf16 v[44:47], v[36:39], a[88:95], v172
    v_smfmac_f32_16x16x64_bf16 v[48:51], v[36:39], a[56:63], v172
    v_smfmac_f32_16x16x64_bf16 v[52:55], v[36:39], a[120:127], v172
g_28L5_0:
    s_waitcnt vmcnt(1)
    v_max3_u32 v19, v24, v25, v26
    v_max_u32 v19, v19, v27
    v_cmp_eq_u32 vcc, -1, v19
    s_nop 0
    s_cbranch_vccnz g_28F5_0
    v_smfmac_f32_16x16x64_bf16 v[40:43], v[24:27], a[0:7], v172
    v_smfmac_f32_16x16x64_bf16 v[44:47], v[24:27], a[64:71], v172
    v_smfmac_f32_16x16x64_bf16 v[48:51], v[24:27], a[32:39], v172
    v_smfmac_f32_16x16x64_bf16 v[52:55], v[24:27], a[96:103], v172
    s_branch g_28L4_2
g_28L14_2:
    s_waitcnt vmcnt(2)
    v_max3_u32 v19, v32, v33, v34
    v_max_u32 v19, v19, v35
    v_cmp_eq_u32 vcc, -1, v19
    s_nop 0
    s_cbranch_vccnz g_28F14_2
    v_smfmac_f32_16x16x64_bf16 v[40:43], v[32:35], a[16:23], v172
    v_smfmac_f32_16x16x64_bf16 v[44:47], v[32:35], a[80:87], v172
    v_smfmac_f32_16x16x64_bf16 v[48:51], v[32:35], a[48:55], v172
    v_smfmac_f32_16x16x64_bf16 v[52:55], v[32:35], a[112:119], v172
g_28L10_3:
    s_waitcnt vmcnt(1)
    v_max3_u32 v19, v36, v37, v38
    v_max_u32 v19, v19, v39
    v_cmp_eq_u32 vcc, -1, v19
    s_nop 0
    s_cbranch_vccnz g_28F10_3
    v_smfmac_f32_16x16x64_bf16 v[40:43], v[36:39], a[24:31], v172
    v_smfmac_f32_16x16x64_bf16 v[44:47], v[36:39], a[88:95], v172
    v_smfmac_f32_16x16x64_bf16 v[48:51], v[36:39], a[56:63], v172
    v_smfmac_f32_16x16x64_bf16 v[52:55], v[36:39], a[120:127], v172
    s_branch g_28L2_1
g_28L14_3:
    s_waitcnt vmcnt(2)
    v_max3_u32 v19, v36, v37, v38
    v_max_u32 v19, v19, v39
    v_cmp_eq_u32 vcc, -1, v19
    s_nop 0
    s_cbranch_vccnz g_28F14_3
    v_smfmac_f32_16x16x64_bf16 v[40:43], v[36:39], a[24:31], v172
    v_smfmac_f32_16x16x64_bf16 v[44:47], v[36:39], a[88:95], v172
    v_smfmac_f32_16x16x64_bf16 v[48:51], v[36:39], a[56:63], v172
    v_smfmac_f32_16x16x64_bf16 v[52:55], v[36:39], a[120:127], v172
    s_branch g_28L6_1
g_28L3_1:
    s_waitcnt vmcnt(1)
    v_max3_u32 v19, v28, v29, v30
    v_max_u32 v19, v19, v31
    v_cmp_eq_u32 vcc, -1, v19
    s_nop 0
    s_cbranch_vccnz g_28F3_1
    v_smfmac_f32_16x16x64_bf16 v[40:43], v[28:31], a[8:15], v172
    v_smfmac_f32_16x16x64_bf16 v[44:47], v[28:31], a[72:79], v172
    v_smfmac_f32_16x16x64_bf16 v[48:51], v[28:31], a[40:47], v172
    v_smfmac_f32_16x16x64_bf16 v[52:55], v[28:31], a[104:111], v172
    s_branch g_28L1_0
g_28L6_2:
    s_waitcnt vmcnt(1)
    v_max3_u32 v19, v32, v33, v34
    v_max_u32 v19, v19, v35
    v_cmp_eq_u32 vcc, -1, v19
    s_nop 0
    s_cbranch_vccnz g_28F6_2
    v_smfmac_f32_16x16x64_bf16 v[40:43], v[32:35], a[16:23], v172
    v_smfmac_f32_16x16x64_bf16 v[44:47], v[32:35], a[80:87], v172
    v_smfmac_f32_16x16x64_bf16 v[48:51], v[32:35], a[48:55], v172
    v_smfmac_f32_16x16x64_bf16 v[52:55], v[32:35], a[112:119], v172
    s_branch g_28L2_1
g_28L9_0:
    s_waitcnt vmcnt(1)
    v_max3_u32 v19, v24, v25, v26
    v_max_u32 v19, v19, v27
    v_cmp_eq_u32 vcc, -1, v19
    s_nop 0
    s_cbranch_vccnz g_28F9_0
    v_smfmac_f32_16x16x64_bf16 v[40:43], v[24:27], a[0:7], v172
    v_smfmac_f32_16x16x64_bf16 v[44:47], v[24:27], a[64:71], v172
    v_smfmac_f32_16x16x64_bf16 v[48:51], v[24:27], a[32:39], v172
    v_smfmac_f32_16x16x64_bf16 v[52:55], v[24:27], a[96:103], v172
    s_branch g_28L8_3
g_28L12_3:
    s_waitcnt vmcnt(1)
    v_max3_u32 v19, v36, v37, v38
    v_max_u32 v19, v19, v39
    v_cmp_eq_u32 vcc, -1, v19
    s_nop 0
    s_cbranch_vccnz g_28F12_3
    v_smfmac_f32_16x16x64_bf16 v[40:43], v[36:39], a[24:31], v172
    v_smfmac_f32_16x16x64_bf16 v[44:47], v[36:39], a[88:95], v172
    v_smfmac_f32_16x16x64_bf16 v[48:51], v[36:39], a[56:63], v172
    v_smfmac_f32_16x16x64_bf16 v[52:55], v[36:39], a[120:127], v172
    s_branch g_28L4_2
g_28F15_0:
    s_mov_b64 exec, vcc
    buffer_load_dwordx4 v[24:27], v2, s[4:7], s16 offen offset:0 sc1
    s_mov_b64 exec, -1
    s_add_u32 s23, s23, 1
    s_cmp_lt_u32 s23, 200000
    s_cbranch_scc1 g_28L15_1
    s_mov_b32 s25, 200000
    s_branch gc_29
g_28F15_1:
    s_mov_b64 exec, vcc
    buffer_load_dwordx4 v[28:31], v2, s[4:7], s16 offen offset:1024 sc1
    s_mov_b64 exec, -1
    s_add_u32 s23, s23, 1
    s_cmp_lt_u32 s23, 200000
    s_cbranch_scc1 g_28L15_2
    s_mov_b32 s25, 200000
    s_branch gc_29
g_28F15_2:
    s_mov_b64 exec, vcc
    buffer_load_dwordx4 v[32:35], v2, s[4:7], s16 offen offset:2048 sc1
    s_mov_b64 exec, -1
    s_add_u32 s23, s23, 1
    s_cmp_lt_u32 s23, 200000
    s_cbranch_scc1 g_28L15_3
    s_mov_b32 s25, 200000
    s_branch gc_29
g_28F15_3:
    s_mov_b64 exec, vcc
    buffer_load_dwordx4 v[36:39], v2, s[4:7], s16 offen offset:3072 sc1
    s_mov_b64 exec, -1
    s_add_u32 s23, s23, 1
    s_cmp_lt_u32 s23, 200000
    s_cbranch_scc1 g_28L15_0
    s_mov_b32 s25, 200000
    s_branch gc_29
g_28F7_0:
    s_mov_b64 exec, vcc
    buffer_load_dwordx4 v[24:27], v2, s[4:7], s16 offen offset:0 sc1
    s_mov_b64 exec, -1
    s_add_u32 s23, s23, 1
    s_cmp_lt_u32 s23, 200000
    s_cbranch_scc1 g_28L7_1
    s_mov_b32 s25, 200000
    s_branch gc_29
g_28F7_1:
    s_mov_b64 exec, vcc
    buffer_load_dwordx4 v[28:31], v2, s[4:7], s16 offen offset:1024 sc1
    s_mov_b64 exec, -1
    s_add_u32 s23, s23, 1
    s_cmp_lt_u32 s23, 200000
    s_cbranch_scc1 g_28L7_2
    s_mov_b32 s25, 200000
    s_branch gc_29
g_28F7_2:
    s_mov_b64 exec, vcc
    buffer_load_dwordx4 v[32:35], v2, s[4:7], s16 offen offset:2048 sc1
    s_mov_b64 exec, -1
    s_add_u32 s23, s23, 1
    s_cmp_lt_u32 s23, 200000
    s_cbranch_scc1 g_28L7_0
    s_mov_b32 s25, 200000
    s_branch gc_29
g_28F11_0:
    s_mov_b64 exec, vcc
    buffer_load_dwordx4 v[24:27], v2, s[4:7], s16 offen offset:0 sc1
    s_mov_b64 exec, -1
    s_add_u32 s23, s23, 1
    s_cmp_lt_u32 s23, 200000
    s_cbranch_scc1 g_28L11_1
    s_mov_b32 s25, 200000
    s_branch gc_29
g_28F11_1:
    s_mov_b64 exec, vcc
    buffer_load_dwordx4 v[28:31], v2, s[4:7], s16 offen offset:1024 sc1
    s_mov_b64 exec, -1
    s_add_u32 s23, s23, 1
    s_cmp_lt_u32 s23, 200000
    s_cbranch_scc1 g_28L11_3
    s_mov_b32 s25, 200000
    s_branch gc_29
g_28F11_3:
    s_mov_b64 exec, vcc
    buffer_load_dwordx4 v[36:39], v2, s[4:7], s16 offen offset:3072 sc1
    s_mov_b64 exec, -1
    s_add_u32 s23, s23, 1
    s_cmp_lt_u32 s23, 200000
    s_cbranch_scc1 g_28L11_0
    s_mov_b32 s25, 200000
    s_branch gc_29
g_28F13_0:
    s_mov_b64 exec, vcc
    buffer_load_dwordx4 v[24:27], v2, s[4:7], s16 offen offset:0 sc1
    s_mov_b64 exec, -1
    s_add_u32 s23, s23, 1
    s_cmp_lt_u32 s23, 200000
    s_cbranch_scc1 g_28L13_2
    s_mov_b32 s25, 200000
    s_branch gc_29
g_28F13_2:
    s_mov_b64 exec, vcc
    buffer_load_dwordx4 v[32:35], v2, s[4:7], s16 offen offset:2048 sc1
    s_mov_b64 exec, -1
    s_add_u32 s23, s23, 1
    s_cmp_lt_u32 s23, 200000
    s_cbranch_scc1 g_28L13_3
    s_mov_b32 s25, 200000
    s_branch gc_29
g_28F13_3:
    s_mov_b64 exec, vcc
    buffer_load_dwordx4 v[36:39], v2, s[4:7], s16 offen offset:3072 sc1
    s_mov_b64 exec, -1
    s_add_u32 s23, s23, 1
    s_cmp_lt_u32 s23, 200000
    s_cbranch_scc1 g_28L13_0
    s_mov_b32 s25, 200000
    s_branch gc_29
g_28F14_1:
    s_mov_b64 exec, vcc
    buffer_load_dwordx4 v[28:31], v2, s[4:7], s16 offen offset:1024 sc1
    s_mov_b64 exec, -1
    s_add_u32 s23, s23, 1
    s_cmp_lt_u32 s23, 200000
    s_cbranch_scc1 g_28L14_2
    s_mov_b32 s25, 200000
    s_branch gc_29
g_28F14_2:
    s_mov_b64 exec, vcc
    buffer_load_dwordx4 v[32:35], v2, s[4:7], s16 offen offset:2048 sc1
    s_mov_b64 exec, -1
    s_add_u32 s23, s23, 1
    s_cmp_lt_u32 s23, 200000
    s_cbranch_scc1 g_28L14_3
    s_mov_b32 s25, 200000
    s_branch gc_29
g_28F14_3:
    s_mov_b64 exec, vcc
    buffer_load_dwordx4 v[36:39], v2, s[4:7], s16 offen offset:3072 sc1
    s_mov_b64 exec, -1
    s_add_u32 s23, s23, 1
    s_cmp_lt_u32 s23, 200000
    s_cbranch_scc1 g_28L14_1
    s_mov_b32 s25, 200000
    s_branch gc_29
g_28F3_0:
    s_mov_b64 exec, vcc
    buffer_load_dwordx4 v[24:27], v2, s[4:7], s16 offen offset:0 sc1
    s_mov_b64 exec, -1
    s_add_u32 s23, s23, 1
    s_cmp_lt_u32 s23, 200000
    s_cbranch_scc1 g_28L3_1
    s_mov_b32 s25, 200000
    s_branch gc_29
g_28F3_1:
    s_mov_b64 exec, vcc
    buffer_load_dwordx4 v[28:31], v2, s[4:7], s16 offen offset:1024 sc1
    s_mov_b64 exec, -1
    s_add_u32 s23, s23, 1
    s_cmp_lt_u32 s23, 200000
    s_cbranch_scc1 g_28L3_0
    s_mov_b32 s25, 200000
    s_branch gc_29
g_28F5_0:
    s_mov_b64 exec, vcc
    buffer_load_dwordx4 v[24:27], v2, s[4:7], s16 offen offset:0 sc1
    s_mov_b64 exec, -1
    s_add_u32 s23, s23, 1
    s_cmp_lt_u32 s23, 200000
    s_cbranch_scc1 g_28L5_2
    s_mov_b32 s25, 200000
    s_branch gc_29
g_28F5_2:
    s_mov_b64 exec, vcc
    buffer_load_dwordx4 v[32:35], v2, s[4:7], s16 offen offset:2048 sc1
    s_mov_b64 exec, -1
    s_add_u32 s23, s23, 1
    s_cmp_lt_u32 s23, 200000
    s_cbranch_scc1 g_28L5_0
    s_mov_b32 s25, 200000
    s_branch gc_29
g_28F6_1:
    s_mov_b64 exec, vcc
    buffer_load_dwordx4 v[28:31], v2, s[4:7], s16 offen offset:1024 sc1
    s_mov_b64 exec, -1
    s_add_u32 s23, s23, 1
    s_cmp_lt_u32 s23, 200000
    s_cbranch_scc1 g_28L6_2
    s_mov_b32 s25, 200000
    s_branch gc_29
g_28F6_2:
    s_mov_b64 exec, vcc
    buffer_load_dwordx4 v[32:35], v2, s[4:7], s16 offen offset:2048 sc1
    s_mov_b64 exec, -1
    s_add_u32 s23, s23, 1
    s_cmp_lt_u32 s23, 200000
    s_cbranch_scc1 g_28L6_1
    s_mov_b32 s25, 200000
    s_branch gc_29
g_28F9_0:
    s_mov_b64 exec, vcc
    buffer_load_dwordx4 v[24:27], v2, s[4:7], s16 offen offset:0 sc1
    s_mov_b64 exec, -1
    s_add_u32 s23, s23, 1
    s_cmp_lt_u32 s23, 200000
    s_cbranch_scc1 g_28L9_3
    s_mov_b32 s25, 200000
    s_branch gc_29
g_28F9_3:
    s_mov_b64 exec, vcc
    buffer_load_dwordx4 v[36:39], v2, s[4:7], s16 offen offset:3072 sc1
    s_mov_b64 exec, -1
    s_add_u32 s23, s23, 1
    s_cmp_lt_u32 s23, 200000
    s_cbranch_scc1 g_28L9_0
    s_mov_b32 s25, 200000
    s_branch gc_29
g_28F10_1:
    s_mov_b64 exec, vcc
    buffer_load_dwordx4 v[28:31], v2, s[4:7], s16 offen offset:1024 sc1
    s_mov_b64 exec, -1
    s_add_u32 s23, s23, 1
    s_cmp_lt_u32 s23, 200000
    s_cbranch_scc1 g_28L10_3
    s_mov_b32 s25, 200000
    s_branch gc_29
g_28F10_3:
    s_mov_b64 exec, vcc
    buffer_load_dwordx4 v[36:39], v2, s[4:7], s16 offen offset:3072 sc1
    s_mov_b64 exec, -1
    s_add_u32 s23, s23, 1
    s_cmp_lt_u32 s23, 200000
    s_cbranch_scc1 g_28L10_1
    s_mov_b32 s25, 200000
    s_branch gc_29
g_28F12_2:
    s_mov_b64 exec, vcc
    buffer_load_dwordx4 v[32:35], v2, s[4:7], s16 offen offset:2048 sc1
    s_mov_b64 exec, -1
    s_add_u32 s23, s23, 1
    s_cmp_lt_u32 s23, 200000
    s_cbranch_scc1 g_28L12_3
    s_mov_b32 s25, 200000
    s_branch gc_29
g_28F12_3:
    s_mov_b64 exec, vcc
    buffer_load_dwordx4 v[36:39], v2, s[4:7], s16 offen offset:3072 sc1
    s_mov_b64 exec, -1
    s_add_u32 s23, s23, 1
    s_cmp_lt_u32 s23, 200000
    s_cbranch_scc1 g_28L12_2
    s_mov_b32 s25, 200000
    s_branch gc_29
g_28F1_0:
    s_mov_b64 exec, vcc
    buffer_load_dwordx4 v[24:27], v2, s[4:7], s16 offen offset:0 sc1
    s_mov_b64 exec, -1
    s_add_u32 s23, s23, 1
    s_cmp_lt_u32 s23, 200000
    s_cbranch_scc1 g_28L1_0
    s_mov_b32 s25, 200000
    s_branch gc_29
g_28F2_1:
    s_mov_b64 exec, vcc
    buffer_load_dwordx4 v[28:31], v2, s[4:7], s16 offen offset:1024 sc1
    s_mov_b64 exec, -1
    s_add_u32 s23, s23, 1
    s_cmp_lt_u32 s23, 200000
    s_cbranch_scc1 g_28L2_1
    s_mov_b32 s25, 200000
    s_branch gc_29
g_28F4_2:
    s_mov_b64 exec, vcc
    buffer_load_dwordx4 v[32:35], v2, s[4:7], s16 offen offset:2048 sc1
    s_mov_b64 exec, -1
    s_add_u32 s23, s23, 1
    s_cmp_lt_u32 s23, 200000
    s_cbranch_scc1 g_28L4_2
    s_mov_b32 s25, 200000
    s_branch gc_29
g_28F8_3:
    s_mov_b64 exec, vcc
    buffer_load_dwordx4 v[36:39], v2, s[4:7], s16 offen offset:3072 sc1
    s_mov_b64 exec, -1
    s_add_u32 s23, s23, 1
    s_cmp_lt_u32 s23, 200000
    s_cbranch_scc1 g_28L8_3
    s_mov_b32 s25, 200000
    s_branch gc_29
recur_fast_last0:
    buffer_store_dwordx4 v[128:131], v14, s[4:7], s19 offen sc1
    s_waitcnt vmcnt(0)
    s_branch recur_end
g_30L15_0:
    s_waitcnt vmcnt(3)
    v_max3_u32 v19, v24, v25, v26
    v_max_u32 v19, v19, v27
    v_cmp_eq_u32 vcc, -1, v19
    s_nop 0
    s_cbranch_vccnz g_30F15_0
    v_smfmac_f32_16x16x64_bf16 v[64:67], v[24:27], a[192:199], v172
    v_smfmac_f32_16x16x64_bf16 v[68:71], v[24:27], a[224:231], v172
g_30L14_1:
    s_waitcnt vmcnt(2)
    v_max3_u32 v19, v28, v29, v30
    v_max_u32 v19, v19, v31
    v_cmp_eq_u32 vcc, -1, v19
    s_nop 0
    s_cbranch_vccnz g_30F14_1
    v_smfmac_f32_16x16x64_bf16 v[64:67], v[28:31], a[200:207], v172
    v_smfmac_f32_16x16x64_bf16 v[68:71], v[28:31], a[232:239], v172
g_30L12_2:
    s_waitcnt vmcnt(1)
    v_max3_u32 v19, v32, v33, v34
    v_max_u32 v19, v19, v35
    v_cmp_eq_u32 vcc, -1, v19
    s_nop 0
    s_cbranch_vccnz g_30F12_2
    v_smfmac_f32_16x16x64_bf16 v[64:67], v[32:35], a[208:215], v172
    v_smfmac_f32_16x16x64_bf16 v[68:71], v[32:35], a[240:247], v172
g_30L8_3:
    s_waitcnt vmcnt(0)
    v_max3_u32 v19, v36, v37, v38
    v_max_u32 v19, v19, v39
    v_cmp_eq_u32 vcc, -1, v19
    s_nop 0
    s_cbranch_vccnz g_30F8_3
    v_smfmac_f32_16x16x64_bf16 v[64:67], v[36:39], a[216:223], v172
    v_smfmac_f32_16x16x64_bf16 v[68:71], v[36:39], a[248:255], v172
    s_nop 4
    v_cvt_pk_bf16_f32 v80, v64, v65
    v_cvt_pk_bf16_f32 v81, v66, v67
    s_nop 0
    v_cvt_pk_bf16_f32 v82, v68, v69
    v_cvt_pk_bf16_f32 v83, v70, v71
    ds_write_b128 v17, v[80:83] offset:9216
    s_branch gc_31
g_30L15_1:
    s_waitcnt vmcnt(3)
    v_max3_u32 v19, v28, v29, v30
    v_max_u32 v19, v19, v31
    v_cmp_eq_u32 vcc, -1, v19
    s_nop 0
    s_cbranch_vccnz g_30F15_1
    v_smfmac_f32_16x16x64_bf16 v[64:67], v[28:31], a[200:207], v172
    v_smfmac_f32_16x16x64_bf16 v[68:71], v[28:31], a[232:239], v172
g_30L13_2:
    s_waitcnt vmcnt(2)
    v_max3_u32 v19, v32, v33, v34
    v_max_u32 v19, v19, v35
    v_cmp_eq_u32 vcc, -1, v19
    s_nop 0
    s_cbranch_vccnz g_30F13_2
    v_smfmac_f32_16x16x64_bf16 v[64:67], v[32:35], a[208:215], v172
    v_smfmac_f32_16x16x64_bf16 v[68:71], v[32:35], a[240:247], v172
g_30L9_3:
    s_waitcnt vmcnt(1)
    v_max3_u32 v19, v36, v37, v38
    v_max_u32 v19, v19, v39
    v_cmp_eq_u32 vcc, -1, v19
    s_nop 0
    s_cbranch_vccnz g_30F9_3
    v_smfmac_f32_16x16x64_bf16 v[64:67], v[36:39], a[216:223], v172
    v_smfmac_f32_16x16x64_bf16 v[68:71], v[36:39], a[248:255], v172
g_30L1_0:
    s_waitcnt vmcnt(0)
    v_max3_u32 v19, v24, v25, v26
    v_max_u32 v19, v19, v27
    v_cmp_eq_u32 vcc, -1, v19
    s_nop 0
    s_cbranch_vccnz g_30F1_0
    v_smfmac_f32_16x16x64_bf16 v[64:67], v[24:27], a[192:199], v172
    v_smfmac_f32_16x16x64_bf16 v[68:71], v[24:27], a[224:231], v172
    s_nop 4
    v_cvt_pk_bf16_f32 v80, v64, v65
    v_cvt_pk_bf16_f32 v81, v66, v67
    s_nop 0
    v_cvt_pk_bf16_f32 v82, v68, v69
    v_cvt_pk_bf16_f32 v83, v70, v71
    ds_write_b128 v17, v[80:83] offset:9216
    s_branch gc_31
g_30L15_2:
    s_waitcnt vmcnt(3)
    v_max3_u32 v19, v32, v33, v34
    v_max_u32 v19, v19, v35
    v_cmp_eq_u32 vcc, -1, v19
    s_nop 0
    s_cbranch_vccnz g_30F15_2
    v_smfmac_f32_16x16x64_bf16 v[64:67], v[32:35], a[208:215], v172
    v_smfmac_f32_16x16x64_bf16 v[68:71], v[32:35], a[240:247], v172
g_30L11_3:
    s_waitcnt vmcnt(2)
    v_max3_u32 v19, v36, v37, v38
    v_max_u32 v19, v19, v39
    v_cmp_eq_u32 vcc, -1, v19
    s_nop 0
    s_cbranch_vccnz g_30F11_3
    v_smfmac_f32_16x16x64_bf16 v[64:67], v[36:39], a[216:223], v172
    v_smfmac_f32_16x16x64_bf16 v[68:71], v[36:39], a[248:255], v172
g_30L3_0:
    s_waitcnt vmcnt(1)
    v_max3_u32 v19, v24, v25, v26
    v_max_u32 v19, v19, v27
    v_cmp_eq_u32 vcc, -1, v19
    s_nop 0
    s_cbranch_vccnz g_30F3_0
    v_smfmac_f32_16x16x64_bf16 v[64:67], v[24:27], a[192:199], v172
    v_smfmac_f32_16x16x64_bf16 v[68:71], v[24:27], a[224:231], v172
g_30L2_1:
    s_waitcnt vmcnt(0)
    v_max3_u32 v19, v28, v29, v30
    v_max_u32 v19, v19, v31
    v_cmp_eq_u32 vcc, -1, v19
    s_nop 0
    s_cbranch_vccnz g_30F2_1
    v_smfmac_f32_16x16x64_bf16 v[64:67], v[28:31], a[200:207], v172
    v_smfmac_f32_16x16x64_bf16 v[68:71], v[28:31], a[232:239], v172
    s_nop 4
    v_cvt_pk_bf16_f32 v80, v64, v65
    v_cvt_pk_bf16_f32 v81, v66, v67
    s_nop 0
    v_cvt_pk_bf16_f32 v82, v68, v69
    v_cvt_pk_bf16_f32 v83, v70, v71
    ds_write_b128 v17, v[80:83] offset:9216
    s_branch gc_31
g_30L15_3:
    s_waitcnt vmcnt(3)
    v_max3_u32 v19, v36, v37, v38
    v_max_u32 v19, v19, v39
    v_cmp_eq_u32 vcc, -1, v19
    s_nop 0
    s_cbranch_vccnz g_30F15_3
    v_smfmac_f32_16x16x64_bf16 v[64:67], v[36:39], a[216:223], v172
    v_smfmac_f32_16x16x64_bf16 v[68:71], v[36:39], a[248:255], v172
g_30L7_0:
    s_waitcnt vmcnt(2)
    v_max3_u32 v19, v24, v25, v26
    v_max_u32 v19, v19, v27
    v_cmp_eq_u32 vcc, -1, v19
    s_nop 0
    s_cbranch_vccnz g_30F7_0
    v_smfmac_f32_16x16x64_bf16 v[64:67], v[24:27], a[192:199], v172
    v_smfmac_f32_16x16x64_bf16 v[68:71], v[24:27], a[224:231], v172
g_30L6_1:
    s_waitcnt vmcnt(1)
    v_max3_u32 v19, v28, v29, v30
    v_max_u32 v19, v19, v31
    v_cmp_eq_u32 vcc, -1, v19
    s_nop 0
    s_cbranch_vccnz g_30F6_1
    v_smfmac_f32_16x16x64_bf16 v[64:67], v[28:31], a[200:207], v172
    v_smfmac_f32_16x16x64_bf16 v[68:71], v[28:31], a[232:239], v172
g_30L4_2:
    s_waitcnt vmcnt(0)
    v_max3_u32 v19, v32, v33, v34
    v_max_u32 v19, v19, v35
    v_cmp_eq_u32 vcc, -1, v19
    s_nop 0
    s_cbranch_vccnz g_30F4_2
    v_smfmac_f32_16x16x64_bf16 v[64:67], v[32:35], a[208:215], v172
    v_smfmac_f32_16x16x64_bf16 v[68:71], v[32:35], a[240:247], v172
    s_nop 4
    v_cvt_pk_bf16_f32 v80, v64, v65
    v_cvt_pk_bf16_f32 v81, v66, v67
    s_nop 0
    v_cvt_pk_bf16_f32 v82, v68, v69
    v_cvt_pk_bf16_f32 v83, v70, v71
    ds_write_b128 v17, v[80:83] offset:9216
    s_branch gc_31
g_30L7_1:
    s_waitcnt vmcnt(2)
    v_max3_u32 v19, v28, v29, v30
    v_max_u32 v19, v19, v31
    v_cmp_eq_u32 vcc, -1, v19
    s_nop 0
    s_cbranch_vccnz g_30F7_1
    v_smfmac_f32_16x16x64_bf16 v[64:67], v[28:31], a[200:207], v172
    v_smfmac_f32_16x16x64_bf16 v[68:71], v[28:31], a[232:239], v172
g_30L5_2:
    s_waitcnt vmcnt(1)
    v_max3_u32 v19, v32, v33, v34
    v_max_u32 v19, v19, v35
    v_cmp_eq_u32 vcc, -1, v19
    s_nop 0
    s_cbranch_vccnz g_30F5_2
    v_smfmac_f32_16x16x64_bf16 v[64:67], v[32:35], a[208:215], v172
    v_smfmac_f32_16x16x64_bf16 v[68:71], v[32:35], a[240:247], v172
    s_branch g_30L1_0
g_30L7_2:
    s_waitcnt vmcnt(2)
    v_max3_u32 v19, v32, v33, v34
    v_max_u32 v19, v19, v35
    v_cmp_eq_u32 vcc, -1, v19
    s_nop 0
    s_cbranch_vccnz g_30F7_2
    v_smfmac_f32_16x16x64_bf16 v[64:67], v[32:35], a[208:215], v172
    v_smfmac_f32_16x16x64_bf16 v[68:71], v[32:35], a[240:247], v172
    s_branch g_30L3_0
g_30L11_0:
    s_waitcnt vmcnt(2)
    v_max3_u32 v19, v24, v25, v26
    v_max_u32 v19, v19, v27
    v_cmp_eq_u32 vcc, -1, v19
    s_nop 0
    s_cbranch_vccnz g_30F11_0
    v_smfmac_f32_16x16x64_bf16 v[64:67], v[24:27], a[192:199], v172
    v_smfmac_f32_16x16x64_bf16 v[68:71], v[24:27], a[224:231], v172
g_30L10_1:
    s_waitcnt vmcnt(1)
    v_max3_u32 v19, v28, v29, v30
    v_max_u32 v19, v19, v31
    v_cmp_eq_u32 vcc, -1, v19
    s_nop 0
    s_cbranch_vccnz g_30F10_1
    v_smfmac_f32_16x16x64_bf16 v[64:67], v[28:31], a[200:207], v172
    v_smfmac_f32_16x16x64_bf16 v[68:71], v[28:31], a[232:239], v172
    s_branch g_30L8_3
g_30L11_1:
    s_waitcnt vmcnt(2)
    v_max3_u32 v19, v28, v29, v30
    v_max_u32 v19, v19, v31
    v_cmp_eq_u32 vcc, -1, v19
    s_nop 0
    s_cbranch_vccnz g_30F11_1
    v_smfmac_f32_16x16x64_bf16 v[64:67], v[28:31], a[200:207], v172
    v_smfmac_f32_16x16x64_bf16 v[68:71], v[28:31], a[232:239], v172
    s_branch g_30L9_3
g_30L13_0:
    s_waitcnt vmcnt(2)
    v_max3_u32 v19, v24, v25, v26
    v_max_u32 v19, v19, v27
    v_cmp_eq_u32 vcc, -1, v19
    s_nop 0
    s_cbranch_vccnz g_30F13_0
    v_smfmac_f32_16x16x64_bf16 v[64:67], v[24:27], a[192:199], v172
    v_smfmac_f32_16x16x64_bf16 v[68:71], v[24:27], a[224:231], v172
    s_branch g_30L12_2
g_30L13_3:
    s_waitcnt vmcnt(2)
    v_max3_u32 v19, v36, v37, v38
    v_max_u32 v19, v19, v39
    v_cmp_eq_u32 vcc, -1, v19
    s_nop 0
    s_cbranch_vccnz g_30F13_3
    v_smfmac_f32_16x16x64_bf16 v[64:67], v[36:39], a[216:223], v172
    v_smfmac_f32_16x16x64_bf16 v[68:71], v[36:39], a[248:255], v172
g_30L5_0:
    s_waitcnt vmcnt(1)
    v_max3_u32 v19, v24, v25, v26
    v_max_u32 v19, v19, v27
    v_cmp_eq_u32 vcc, -1, v19
    s_nop 0
    s_cbranch_vccnz g_30F5_0
    v_smfmac_f32_16x16x64_bf16 v[64:67], v[24:27], a[192:199], v172
    v_smfmac_f32_16x16x64_bf16 v[68:71], v[24:27], a[224:231], v172
    s_branch g_30L4_2
g_30L14_2:
    s_waitcnt vmcnt(2)
    v_max3_u32 v19, v32, v33, v34
    v_max_u32 v19, v19, v35
    v_cmp_eq_u32 vcc, -1, v19
    s_nop 0
    s_cbranch_vccnz g_30F14_2
    v_smfmac_f32_16x16x64_bf16 v[64:67], v[32:35], a[208:215], v172
    v_smfmac_f32_16x16x64_bf16 v[68:71], v[32:35], a[240:247], v172
g_30L10_3:
    s_waitcnt vmcnt(1)
    v_max3_u32 v19, v36, v37, v38
    v_max_u32 v19, v19, v39
    v_cmp_eq_u32 vcc, -1, v19
    s_nop 0
    s_cbranch_vccnz g_30F10_3
    v_smfmac_f32_16x16x64_bf16 v[64:67], v[36:39], a[216:223], v172
    v_smfmac_f32_16x16x64_bf16 v[68:71], v[36:39], a[248:255], v172
    s_branch g_30L2_1
g_30L14_3:
    s_waitcnt vmcnt(2)
    v_max3_u32 v19, v36, v37, v38
    v_max_u32 v19, v19, v39
    v_cmp_eq_u32 vcc, -1, v19
    s_nop 0
    s_cbranch_vccnz g_30F14_3
    v_smfmac_f32_16x16x64_bf16 v[64:67], v[36:39], a[216:223], v172
    v_smfmac_f32_16x16x64_bf16 v[68:71], v[36:39], a[248:255], v172
    s_branch g_30L6_1
g_30L3_1:
    s_waitcnt vmcnt(1)
    v_max3_u32 v19, v28, v29, v30
    v_max_u32 v19, v19, v31
    v_cmp_eq_u32 vcc, -1, v19
    s_nop 0
    s_cbranch_vccnz g_30F3_1
    v_smfmac_f32_16x16x64_bf16 v[64:67], v[28:31], a[200:207], v172
    v_smfmac_f32_16x16x64_bf16 v[68:71], v[28:31], a[232:239], v172
    s_branch g_30L1_0
g_30L6_2:
    s_waitcnt vmcnt(1)
    v_max3_u32 v19, v32, v33, v34
    v_max_u32 v19, v19, v35
    v_cmp_eq_u32 vcc, -1, v19
    s_nop 0
    s_cbranch_vccnz g_30F6_2
    v_smfmac_f32_16x16x64_bf16 v[64:67], v[32:35], a[208:215], v172
    v_smfmac_f32_16x16x64_bf16 v[68:71], v[32:35], a[240:247], v172
    s_branch g_30L2_1
g_30L9_0:
    s_waitcnt vmcnt(1)
    v_max3_u32 v19, v24, v25, v26
    v_max_u32 v19, v19, v27
    v_cmp_eq_u32 vcc, -1, v19
    s_nop 0
    s_cbranch_vccnz g_30F9_0
    v_smfmac_f32_16x16x64_bf16 v[64:67], v[24:27], a[192:199], v172
    v_smfmac_f32_16x16x64_bf16 v[68:71], v[24:27], a[224:231], v172
    s_branch g_30L8_3
g_30L12_3:
    s_waitcnt vmcnt(1)
    v_max3_u32 v19, v36, v37, v38
    v_max_u32 v19, v19, v39
    v_cmp_eq_u32 vcc, -1, v19
    s_nop 0
    s_cbranch_vccnz g_30F12_3
    v_smfmac_f32_16x16x64_bf16 v[64:67], v[36:39], a[216:223], v172
    v_smfmac_f32_16x16x64_bf16 v[68:71], v[36:39], a[248:255], v172
    s_branch g_30L4_2
g_30F15_0:
    s_mov_b64 exec, vcc
    buffer_load_dwordx4 v[24:27], v8, s[4:7], s16 offen offset:0 sc1
    s_mov_b64 exec, -1
    s_add_u32 s23, s23, 1
    s_cmp_lt_u32 s23, 200000
    s_cbranch_scc1 g_30L15_1
    s_mov_b32 s25, 200000
    s_branch gc_31
g_30F15_1:
    s_mov_b64 exec, vcc
    buffer_load_dwordx4 v[28:31], v8, s[4:7], s16 offen offset:1024 sc1
    s_mov_b64 exec, -1
    s_add_u32 s23, s23, 1
    s_cmp_lt_u32 s23, 200000
    s_cbranch_scc1 g_30L15_2
    s_mov_b32 s25, 200000
    s_branch gc_31
g_30F15_2:
    s_mov_b64 exec, vcc
    buffer_load_dwordx4 v[32:35], v8, s[4:7], s16 offen offset:2048 sc1
    s_mov_b64 exec, -1
    s_add_u32 s23, s23, 1
    s_cmp_lt_u32 s23, 200000
    s_cbranch_scc1 g_30L15_3
    s_mov_b32 s25, 200000
    s_branch gc_31
g_30F15_3:
    s_mov_b64 exec, vcc
    buffer_load_dwordx4 v[36:39], v8, s[4:7], s16 offen offset:3072 sc1
    s_mov_b64 exec, -1
    s_add_u32 s23, s23, 1
    s_cmp_lt_u32 s23, 200000
    s_cbranch_scc1 g_30L15_0
    s_mov_b32 s25, 200000
    s_branch gc_31
g_30F7_0:
    s_mov_b64 exec, vcc
    buffer_load_dwordx4 v[24:27], v8, s[4:7], s16 offen offset:0 sc1
    s_mov_b64 exec, -1
    s_add_u32 s23, s23, 1
    s_cmp_lt_u32 s23, 200000
    s_cbranch_scc1 g_30L7_1
    s_mov_b32 s25, 200000
    s_branch gc_31
g_30F7_1:
    s_mov_b64 exec, vcc
    buffer_load_dwordx4 v[28:31], v8, s[4:7], s16 offen offset:1024 sc1
    s_mov_b64 exec, -1
    s_add_u32 s23, s23, 1
    s_cmp_lt_u32 s23, 200000
    s_cbranch_scc1 g_30L7_2
    s_mov_b32 s25, 200000
    s_branch gc_31
g_30F7_2:
    s_mov_b64 exec, vcc
    buffer_load_dwordx4 v[32:35], v8, s[4:7], s16 offen offset:2048 sc1
    s_mov_b64 exec, -1
    s_add_u32 s23, s23, 1
    s_cmp_lt_u32 s23, 200000
    s_cbranch_scc1 g_30L7_0
    s_mov_b32 s25, 200000
    s_branch gc_31
g_30F11_0:
    s_mov_b64 exec, vcc
    buffer_load_dwordx4 v[24:27], v8, s[4:7], s16 offen offset:0 sc1
    s_mov_b64 exec, -1
    s_add_u32 s23, s23, 1
    s_cmp_lt_u32 s23, 200000
    s_cbranch_scc1 g_30L11_1
    s_mov_b32 s25, 200000
    s_branch gc_31
g_30F11_1:
    s_mov_b64 exec, vcc
    buffer_load_dwordx4 v[28:31], v8, s[4:7], s16 offen offset:1024 sc1
    s_mov_b64 exec, -1
    s_add_u32 s23, s23, 1
    s_cmp_lt_u32 s23, 200000
    s_cbranch_scc1 g_30L11_3
    s_mov_b32 s25, 200000
    s_branch gc_31
g_30F11_3:
    s_mov_b64 exec, vcc
    buffer_load_dwordx4 v[36:39], v8, s[4:7], s16 offen offset:3072 sc1
    s_mov_b64 exec, -1
    s_add_u32 s23, s23, 1
    s_cmp_lt_u32 s23, 200000
    s_cbranch_scc1 g_30L11_0
    s_mov_b32 s25, 200000
    s_branch gc_31
g_30F13_0:
    s_mov_b64 exec, vcc
    buffer_load_dwordx4 v[24:27], v8, s[4:7], s16 offen offset:0 sc1
    s_mov_b64 exec, -1
    s_add_u32 s23, s23, 1
    s_cmp_lt_u32 s23, 200000
    s_cbranch_scc1 g_30L13_2
    s_mov_b32 s25, 200000
    s_branch gc_31
g_30F13_2:
    s_mov_b64 exec, vcc
    buffer_load_dwordx4 v[32:35], v8, s[4:7], s16 offen offset:2048 sc1
    s_mov_b64 exec, -1
    s_add_u32 s23, s23, 1
    s_cmp_lt_u32 s23, 200000
    s_cbranch_scc1 g_30L13_3
    s_mov_b32 s25, 200000
    s_branch gc_31
g_30F13_3:
    s_mov_b64 exec, vcc
    buffer_load_dwordx4 v[36:39], v8, s[4:7], s16 offen offset:3072 sc1
    s_mov_b64 exec, -1
    s_add_u32 s23, s23, 1
    s_cmp_lt_u32 s23, 200000
    s_cbranch_scc1 g_30L13_0
    s_mov_b32 s25, 200000
    s_branch gc_31
g_30F14_1:
    s_mov_b64 exec, vcc
    buffer_load_dwordx4 v[28:31], v8, s[4:7], s16 offen offset:1024 sc1
    s_mov_b64 exec, -1
    s_add_u32 s23, s23, 1
    s_cmp_lt_u32 s23, 200000
    s_cbranch_scc1 g_30L14_2
    s_mov_b32 s25, 200000
    s_branch gc_31
g_30F14_2:
    s_mov_b64 exec, vcc
    buffer_load_dwordx4 v[32:35], v8, s[4:7], s16 offen offset:2048 sc1
    s_mov_b64 exec, -1
    s_add_u32 s23, s23, 1
    s_cmp_lt_u32 s23, 200000
    s_cbranch_scc1 g_30L14_3
    s_mov_b32 s25, 200000
    s_branch gc_31
g_30F14_3:
    s_mov_b64 exec, vcc
    buffer_load_dwordx4 v[36:39], v8, s[4:7], s16 offen offset:3072 sc1
    s_mov_b64 exec, -1
    s_add_u32 s23, s23, 1
    s_cmp_lt_u32 s23, 200000
    s_cbranch_scc1 g_30L14_1
    s_mov_b32 s25, 200000
    s_branch gc_31
g_30F3_0:
    s_mov_b64 exec, vcc
    buffer_load_dwordx4 v[24:27], v8, s[4:7], s16 offen offset:0 sc1
    s_mov_b64 exec, -1
    s_add_u32 s23, s23, 1
    s_cmp_lt_u32 s23, 200000
    s_cbranch_scc1 g_30L3_1
    s_mov_b32 s25, 200000
    s_branch gc_31
g_30F3_1:
    s_mov_b64 exec, vcc
    buffer_load_dwordx4 v[28:31], v8, s[4:7], s16 offen offset:1024 sc1
    s_mov_b64 exec, -1
    s_add_u32 s23, s23, 1
    s_cmp_lt_u32 s23, 200000
    s_cbranch_scc1 g_30L3_0
    s_mov_b32 s25, 200000
    s_branch gc_31
g_30F5_0:
    s_mov_b64 exec, vcc
    buffer_load_dwordx4 v[24:27], v8, s[4:7], s16 offen offset:0 sc1
    s_mov_b64 exec, -1
    s_add_u32 s23, s23, 1
    s_cmp_lt_u32 s23, 200000
    s_cbranch_scc1 g_30L5_2
    s_mov_b32 s25, 200000
    s_branch gc_31
g_30F5_2:
    s_mov_b64 exec, vcc
    buffer_load_dwordx4 v[32:35], v8, s[4:7], s16 offen offset:2048 sc1
    s_mov_b64 exec, -1
    s_add_u32 s23, s23, 1
    s_cmp_lt_u32 s23, 200000
    s_cbranch_scc1 g_30L5_0
    s_mov_b32 s25, 200000
    s_branch gc_31
g_30F6_1:
    s_mov_b64 exec, vcc
    buffer_load_dwordx4 v[28:31], v8, s[4:7], s16 offen offset:1024 sc1
    s_mov_b64 exec, -1
    s_add_u32 s23, s23, 1
    s_cmp_lt_u32 s23, 200000
    s_cbranch_scc1 g_30L6_2
    s_mov_b32 s25, 200000
    s_branch gc_31
g_30F6_2:
    s_mov_b64 exec, vcc
    buffer_load_dwordx4 v[32:35], v8, s[4:7], s16 offen offset:2048 sc1
    s_mov_b64 exec, -1
    s_add_u32 s23, s23, 1
    s_cmp_lt_u32 s23, 200000
    s_cbranch_scc1 g_30L6_1
    s_mov_b32 s25, 200000
    s_branch gc_31
g_30F9_0:
    s_mov_b64 exec, vcc
    buffer_load_dwordx4 v[24:27], v8, s[4:7], s16 offen offset:0 sc1
    s_mov_b64 exec, -1
    s_add_u32 s23, s23, 1
    s_cmp_lt_u32 s23, 200000
    s_cbranch_scc1 g_30L9_3
    s_mov_b32 s25, 200000
    s_branch gc_31
g_30F9_3:
    s_mov_b64 exec, vcc
    buffer_load_dwordx4 v[36:39], v8, s[4:7], s16 offen offset:3072 sc1
    s_mov_b64 exec, -1
    s_add_u32 s23, s23, 1
    s_cmp_lt_u32 s23, 200000
    s_cbranch_scc1 g_30L9_0
    s_mov_b32 s25, 200000
    s_branch gc_31
g_30F10_1:
    s_mov_b64 exec, vcc
    buffer_load_dwordx4 v[28:31], v8, s[4:7], s16 offen offset:1024 sc1
    s_mov_b64 exec, -1
    s_add_u32 s23, s23, 1
    s_cmp_lt_u32 s23, 200000
    s_cbranch_scc1 g_30L10_3
    s_mov_b32 s25, 200000
    s_branch gc_31
g_30F10_3:
    s_mov_b64 exec, vcc
    buffer_load_dwordx4 v[36:39], v8, s[4:7], s16 offen offset:3072 sc1
    s_mov_b64 exec, -1
    s_add_u32 s23, s23, 1
    s_cmp_lt_u32 s23, 200000
    s_cbranch_scc1 g_30L10_1
    s_mov_b32 s25, 200000
    s_branch gc_31
g_30F12_2:
    s_mov_b64 exec, vcc
    buffer_load_dwordx4 v[32:35], v8, s[4:7], s16 offen offset:2048 sc1
    s_mov_b64 exec, -1
    s_add_u32 s23, s23, 1
    s_cmp_lt_u32 s23, 200000
    s_cbranch_scc1 g_30L12_3
    s_mov_b32 s25, 200000
    s_branch gc_31
g_30F12_3:
    s_mov_b64 exec, vcc
    buffer_load_dwordx4 v[36:39], v8, s[4:7], s16 offen offset:3072 sc1
    s_mov_b64 exec, -1
    s_add_u32 s23, s23, 1
    s_cmp_lt_u32 s23, 200000
    s_cbranch_scc1 g_30L12_2
    s_mov_b32 s25, 200000
    s_branch gc_31
g_30F1_0:
    s_mov_b64 exec, vcc
    buffer_load_dwordx4 v[24:27], v8, s[4:7], s16 offen offset:0 sc1
    s_mov_b64 exec, -1
    s_add_u32 s23, s23, 1
    s_cmp_lt_u32 s23, 200000
    s_cbranch_scc1 g_30L1_0
    s_mov_b32 s25, 200000
    s_branch gc_31
g_30F2_1:
    s_mov_b64 exec, vcc
    buffer_load_dwordx4 v[28:31], v8, s[4:7], s16 offen offset:1024 sc1
    s_mov_b64 exec, -1
    s_add_u32 s23, s23, 1
    s_cmp_lt_u32 s23, 200000
    s_cbranch_scc1 g_30L2_1
    s_mov_b32 s25, 200000
    s_branch gc_31
g_30F4_2:
    s_mov_b64 exec, vcc
    buffer_load_dwordx4 v[32:35], v8, s[4:7], s16 offen offset:2048 sc1
    s_mov_b64 exec, -1
    s_add_u32 s23, s23, 1
    s_cmp_lt_u32 s23, 200000
    s_cbranch_scc1 g_30L4_2
    s_mov_b32 s25, 200000
    s_branch gc_31
g_30F8_3:
    s_mov_b64 exec, vcc
    buffer_load_dwordx4 v[36:39], v8, s[4:7], s16 offen offset:3072 sc1
    s_mov_b64 exec, -1
    s_add_u32 s23, s23, 1
    s_cmp_lt_u32 s23, 200000
    s_cbranch_scc1 g_30L8_3
    s_mov_b32 s25, 200000
    s_branch gc_31
.p2align 6
recur_fast_w1:
    s_nop 15
    s_mov_b32 s23, s25
    buffer_load_dwordx4 v[24:27], v2, s[4:7], s16 offen offset:0 sc1
    s_nop 11
    buffer_load_dwordx4 v[28:31], v2, s[4:7], s16 offen offset:1024 sc1
    s_nop 11
    buffer_load_dwordx4 v[32:35], v2, s[4:7], s16 offen offset:2048 sc1
    s_nop 11
    buffer_load_dwordx4 v[36:39], v2, s[4:7], s16 offen offset:3072 sc1
    s_waitcnt vmcnt(3)
    v_max3_u32 v19, v24, v25, v26
    v_max_u32 v19, v19, v27
    v_cmp_eq_u32 vcc, -1, v19
    s_nop 0
    s_cbranch_vccnz g_34F15_0
    v_smfmac_f32_16x16x64_bf16 v[40:43], v[24:27], a[0:7], v172
    s_waitcnt vmcnt(2)
    v_max3_u32 v19, v28, v29, v30
    v_max_u32 v19, v19, v31
    v_smfmac_f32_16x16x64_bf16 v[44:47], v[24:27], a[64:71], v172
    v_cmp_eq_u32 vcc, -1, v19
    v_smfmac_f32_16x16x64_bf16 v[48:51], v[24:27], a[32:39], v172
    v_smfmac_f32_16x16x64_bf16 v[52:55], v[24:27], a[96:103], v172
    s_cbranch_vccnz g_34F14_1
    v_smfmac_f32_16x16x64_bf16 v[40:43], v[28:31], a[8:15], v172
    s_waitcnt vmcnt(1)
    v_max3_u32 v19, v32, v33, v34
    v_max_u32 v19, v19, v35
    v_smfmac_f32_16x16x64_bf16 v[44:47], v[28:31], a[72:79], v172
    v_cmp_eq_u32 vcc, -1, v19
    v_smfmac_f32_16x16x64_bf16 v[48:51], v[28:31], a[40:47], v172
    v_smfmac_f32_16x16x64_bf16 v[52:55], v[28:31], a[104:111], v172
    s_cbranch_vccnz g_34F12_2
    v_smfmac_f32_16x16x64_bf16 v[40:43], v[32:35], a[16:23], v172
    s_waitcnt vmcnt(0)
    v_max3_u32 v19, v36, v37, v38
    v_max_u32 v19, v19, v39
    v_smfmac_f32_16x16x64_bf16 v[44:47], v[32:35], a[80:87], v172
    v_cmp_eq_u32 vcc, -1, v19
    v_smfmac_f32_16x16x64_bf16 v[48:51], v[32:35], a[48:55], v172
    v_smfmac_f32_16x16x64_bf16 v[52:55], v[32:35], a[112:119], v172
    s_cbranch_vccnz g_34F8_3
    v_smfmac_f32_16x16x64_bf16 v[40:43], v[36:39], a[24:31], v172
    v_smfmac_f32_16x16x64_bf16 v[44:47], v[36:39], a[88:95], v172
    v_smfmac_f32_16x16x64_bf16 v[48:51], v[36:39], a[56:63], v172
    v_smfmac_f32_16x16x64_bf16 v[52:55], v[36:39], a[120:127], v172
gc_35:
    v_cvt_pk_bf16_f32 v72, v40, v41
    v_cvt_pk_bf16_f32 v73, v42, v43
    v_cvt_pk_bf16_f32 v74, v44, v45
    v_cvt_pk_bf16_f32 v75, v46, v47
    ds_write_b128 v17, v[72:75] offset:0
    v_cvt_pk_bf16_f32 v76, v48, v49
    v_cvt_pk_bf16_f32 v77, v50, v51
    s_nop 0
    v_cvt_pk_bf16_f32 v78, v52, v53
    v_cvt_pk_bf16_f32 v79, v54, v55
    ds_write_b128 v17, v[76:79] offset:1024
    v_smfmac_f32_16x16x64_bf16 v[56:59], v[24:27], a[128:135], v172
    v_smfmac_f32_16x16x64_bf16 v[60:63], v[24:27], a[160:167], v172
    v_smfmac_f32_16x16x64_bf16 v[56:59], v[28:31], a[136:143], v172
    s_waitcnt lgkmcnt(0)
    s_barrier
    v_smfmac_f32_16x16x64_bf16 v[60:63], v[28:31], a[168:175], v172
    v_smfmac_f32_16x16x64_bf16 v[56:59], v[32:35], a[144:151], v172
    v_smfmac_f32_16x16x64_bf16 v[60:63], v[32:35], a[176:183], v172
    v_smfmac_f32_16x16x64_bf16 v[56:59], v[36:39], a[152:159], v172
    v_smfmac_f32_16x16x64_bf16 v[60:63], v[36:39], a[184:191], v172
    s_nop 4
    v_cvt_pk_bf16_f32 v80, v56, v57
    v_cvt_pk_bf16_f32 v81, v58, v59
    s_nop 0
    v_cvt_pk_bf16_f32 v82, v60, v61
    v_cvt_pk_bf16_f32 v83, v62, v63
    ds_write_b128 v17, v[80:83] offset:8192
    v_mov_b32 v152, v228
    v_mov_b32 v153, v229
    v_mov_b32 v156, v230
    v_mov_b32 v157, v231
    v_mov_b32 v160, v232
    v_mov_b32 v161, v233
    v_mov_b32 v164, v234
    v_mov_b32 v165, v235
    s_cmp_eq_u32 s15, 63
    s_waitcnt lgkmcnt(0)
    s_barrier
    s_cbranch_scc1 recur_end
    s_nop 15
    s_nop 15
    s_nop 7
    buffer_load_dwordx4 v[208:211], v5, s[4:7], s16 offen offset:0 sc1
    buffer_load_dwordx4 v[212:215], v5, s[4:7], s16 offen offset:1024 sc1
    buffer_load_dwordx4 v[216:219], v5, s[4:7], s16 offen offset:2048 sc1
    buffer_load_dwordx4 v[220:223], v5, s[4:7], s16 offen offset:3072 sc1
    buffer_load_dword v224, v6, s[4:7], s16 offen offset:0 sc1
    buffer_load_dword v225, v6, s[4:7], s16 offen offset:256 sc1
    buffer_load_dword v226, v6, s[4:7], s16 offen offset:512 sc1
    buffer_load_dword v227, v6, s[4:7], s16 offen offset:768 sc1
    s_mov_b32 s23, s25
    ds_read_b128 v[96:99], v16 offset:8192
    ds_read_b128 v[104:107], v16 offset:12288
    ds_read_b128 v[108:111], v16 offset:14336
    v_mfma_f32_16x16x32_bf16 v[140:143], v[84:87], v[80:83], 0
    s_waitcnt lgkmcnt(2)
    v_mfma_f32_16x16x32_bf16 v[140:143], v[84:87], v[96:99], v[140:143]
    s_waitcnt lgkmcnt(1)
    v_mfma_f32_16x16x32_bf16 v[140:143], v[84:87], v[104:107], v[140:143]
    s_waitcnt lgkmcnt(0)
    v_mfma_f32_16x16x32_bf16 v[140:143], v[84:87], v[108:111], v[140:143]
    buffer_load_dwordx4 v[24:27], v5, s[4:7], s16 offen offset:0 sc1
    buffer_load_dwordx4 v[28:31], v5, s[4:7], s16 offen offset:1024 sc1
    buffer_load_dwordx4 v[32:35], v5, s[4:7], s16 offen offset:2048 sc1
    buffer_load_dwordx4 v[36:39], v5, s[4:7], s16 offen offset:3072 sc1
    buffer_load_dword v40, v6, s[4:7], s16 offen offset:0 sc1
    buffer_load_dword v41, v6, s[4:7], s16 offen offset:256 sc1
    buffer_load_dword v42, v6, s[4:7], s16 offen offset:512 sc1
    buffer_load_dword v43, v6, s[4:7], s16 offen offset:768 sc1
    v_cvt_pk_bf16_f32 v154, v140, v179
    v_cvt_pk_bf16_f32 v158, v141, v179
    v_cvt_pk_bf16_f32 v162, v142, v179
    v_cvt_pk_bf16_f32 v166, v143, v179
    s_waitcnt vmcnt(14)
    v_pk_add_f32 v[180:181], v[208:209], v[212:213]
    v_pk_add_f32 v[182:183], v[210:211], v[214:215]
    s_waitcnt vmcnt(12)
    v_pk_add_f32 v[188:189], v[216:217], v[220:221]
    v_pk_add_f32 v[190:191], v[218:219], v[222:223]
    v_pk_add_f32 v[180:181], v[180:181], v[188:189]
    v_pk_add_f32 v[182:183], v[182:183], v[190:191]
    v_pk_add_f32 v[188:189], v[180:181], v[182:183]
    v_max3_f32 v185, v180, v181, v182
    s_waitcnt vmcnt(8)
    v_pk_add_f32 v[192:193], v[224:225], v[226:227]
    v_add_f32 v188, v188, v189
    v_add_f32 v184, v192, v193
    v_max3_f32 v185, v185, v183, v184
    v_cmp_u_f32 vcc, v188, v184
    s_nop 0
    v_max_f32_dpp v185, v185, v185 row_ror:8 row_mask:0xf bank_mask:0xf
    v_mov_b32 v186, v185
    s_nop 1
    v_permlane16_swap_b32 v185, v186
    v_max_f32 v185, v185, v186
    v_mov_b32 v186, v185
    s_cbranch_vccnz ss_36
sg_38:
    s_nop 0
    v_permlane32_swap_b32 v185, v186
    v_max_f32 v185, v185, v186
    v_mul_f32 v185, s24, v185
    v_fma_f32 v180, v180, s24, -v185
    v_fma_f32 v181, v181, s24, -v185
    v_fma_f32 v182, v182, s24, -v185
    v_fma_f32 v183, v183, s24, -v185
    v_fma_f32 v184, v184, s24, -v185
    v_exp_f32 v180, v180
    v_exp_f32 v181, v181
    v_exp_f32 v182, v182
    v_exp_f32 v183, v183
    v_exp_f32 v184, v184
    v_cvt_pk_bf16_f32 v176, v180, v181
    v_cvt_pk_bf16_f32 v177, v182, v183
    v_cvt_pk_bf16_f32 v178, v184, v179
    s_nop 1
    v_mfma_f32_16x16x32_bf16 v[240:243], v[236:239], v[176:179], 0
    v_mfma_f32_16x16x32_bf16 v[188:191], v[152:155], v[176:179], 0
    v_mfma_f32_16x16x32_bf16 v[192:195], v[156:159], v[176:179], 0
    v_mfma_f32_16x16x32_bf16 v[196:199], v[160:163], v[176:179], 0
    v_mfma_f32_16x16x32_bf16 v[200:203], v[164:167], v[176:179], 0
    v_add_f32_dpp v185, v240, v240 row_ror:8 row_mask:0xf bank_mask:0xf
    v_rcp_f32 v185, v185
    v_add_f32_dpp v88, v192, v188 row_ror:8 row_mask:0xf bank_mask:0x3
    v_add_f32_dpp v89, v193, v189 row_ror:8 row_mask:0xf bank_mask:0x3
    v_add_f32_dpp v90, v194, v190 row_ror:8 row_mask:0xf bank_mask:0x3
    v_add_f32_dpp v91, v195, v191 row_ror:8 row_mask:0xf bank_mask:0x3
    s_nop 1
    v_add_f32_dpp v88, v196, v200 row_ror:8 row_mask:0xf bank_mask:0xc
    v_add_f32_dpp v89, v197, v201 row_ror:8 row_mask:0xf bank_mask:0xc
    v_add_f32_dpp v90, v198, v202 row_ror:8 row_mask:0xf bank_mask:0xc
    v_add_f32_dpp v91, v199, v203 row_ror:8 row_mask:0xf bank_mask:0xc
    v_mul_f32 v88, v88, v185
    v_mul_f32 v89, v89, v185
    v_mul_f32 v90, v90, v185
    v_mul_f32 v91, v91, v185
    v_cvt_pk_bf16_f32 v88, v88, v89
    v_cvt_pk_bf16_f32 v89, v90, v91
    buffer_store_dwordx2 v[88:89], v7, s[4:7], s16 offen
    v_readfirstlane_b32 s85, v247
    s_add_u32 s94, s15, 2
    s_barrier
    s_nop 15
    s_mov_b32 s23, s25
    buffer_load_dwordx4 v[24:27], v8, s[4:7], s16 offen offset:0 sc1
    s_nop 11
    buffer_load_dwordx4 v[28:31], v8, s[4:7], s16 offen offset:1024 sc1
    s_nop 11
    buffer_load_dwordx4 v[32:35], v8, s[4:7], s16 offen offset:2048 sc1
    s_nop 11
    buffer_load_dwordx4 v[36:39], v8, s[4:7], s16 offen offset:3072 sc1
    s_waitcnt vmcnt(3)
    v_max3_u32 v19, v24, v25, v26
    v_max_u32 v19, v19, v27
    v_cmp_eq_u32 vcc, -1, v19
    s_nop 0
    s_cbranch_vccnz g_39F15_0
    v_smfmac_f32_16x16x64_bf16 v[64:67], v[24:27], a[192:199], v172
    v_smfmac_f32_16x16x64_bf16 v[68:71], v[24:27], a[224:231], v172
    s_waitcnt vmcnt(2)
    v_max3_u32 v19, v28, v29, v30
    v_max_u32 v19, v19, v31
    v_cmp_eq_u32 vcc, -1, v19
    s_nop 0
    s_cbranch_vccnz g_39F14_1
    v_smfmac_f32_16x16x64_bf16 v[64:67], v[28:31], a[200:207], v172
    v_smfmac_f32_16x16x64_bf16 v[68:71], v[28:31], a[232:239], v172
    s_waitcnt vmcnt(1)
    v_max3_u32 v19, v32, v33, v34
    v_max_u32 v19, v19, v35
    v_cmp_eq_u32 vcc, -1, v19
    s_nop 0
    s_cbranch_vccnz g_39F12_2
    v_smfmac_f32_16x16x64_bf16 v[64:67], v[32:35], a[208:215], v172
    v_smfmac_f32_16x16x64_bf16 v[68:71], v[32:35], a[240:247], v172
    s_waitcnt vmcnt(0)
    v_max3_u32 v19, v36, v37, v38
    v_max_u32 v19, v19, v39
    v_cmp_eq_u32 vcc, -1, v19
    s_nop 0
    s_cbranch_vccnz g_39F8_3
    v_smfmac_f32_16x16x64_bf16 v[64:67], v[36:39], a[216:223], v172
    v_smfmac_f32_16x16x64_bf16 v[68:71], v[36:39], a[248:255], v172
    s_nop 4
    v_cvt_pk_bf16_f32 v80, v64, v65
    v_cvt_pk_bf16_f32 v81, v66, v67
    s_nop 0
    v_cvt_pk_bf16_f32 v82, v68, v69
    v_cvt_pk_bf16_f32 v83, v70, v71
    ds_write_b128 v17, v[80:83] offset:9216
gc_40:
    s_waitcnt lgkmcnt(0)
    s_barrier
    s_nop 15
    s_nop 15
    s_nop 15
    s_nop 15
    s_mov_b32 s23, s25
fw_41:
    s_cmp_ge_u32 s85, s94
    s_cbranch_scc1 fo_42
    buffer_load_dword v247, v245, s[4:7], 0 offen sc1
    s_add_u32 s23, s23, 1
    s_waitcnt vmcnt(0)
    v_readfirstlane_b32 s85, v247
    s_cmp_lt_u32 s23, 200000
    s_cbranch_scc1 fw_41
    s_mov_b32 s25, 200000
fo_42:
    buffer_load_dwordx4 v[228:231], v13, s[4:7], s18 offen offset:0 sc1
    buffer_load_dwordx4 v[232:235], v13, s[4:7], s18 offen offset:256 sc1
    s_add_u32 s18, s18, 2048
    s_min_u32 s18, s18, 35780608
    s_add_u32 s21, s15, 3
    s_min_u32 s21, s21, 64
    s_cmp_lt_u32 s85, s21
    s_cselect_b64 exec, 1, 0
    buffer_load_dword v247, v245, s[4:7], 0 offen sc1
    s_mov_b64 exec, -1
    v_mov_b32 v40, 0
    v_mov_b32 v41, 0
    v_mov_b32 v42, 0
    v_mov_b32 v43, 0
    v_mov_b32 v44, 0
    v_mov_b32 v45, 0
    v_mov_b32 v46, 0
    v_mov_b32 v47, 0
    v_mov_b32 v48, 0
    v_mov_b32 v49, 0
    v_mov_b32 v50, 0
    v_mov_b32 v51, 0
    v_mov_b32 v52, 0
    v_mov_b32 v53, 0
    v_mov_b32 v54, 0
    v_mov_b32 v55, 0
    v_mov_b32 v56, 0
    v_mov_b32 v57, 0
    v_mov_b32 v58, 0
    v_mov_b32 v59, 0
    v_mov_b32 v60, 0
    v_mov_b32 v61, 0
    v_mov_b32 v62, 0
    v_mov_b32 v63, 0
    v_mov_b32 v64, 0
    v_mov_b32 v65, 0
    v_mov_b32 v66, 0
    v_mov_b32 v67, 0
    v_mov_b32 v68, 0
    v_mov_b32 v69, 0
    v_mov_b32 v70, 0
    v_mov_b32 v71, 0
    s_mov_b32 s21, s16
    s_mov_b32 s16, s42
    s_mov_b32 s42, s43
    s_mov_b32 s43, s44
    s_mov_b32 s44, s21
    s_add_u32 s95, s95, 524288
    s_lshr_b32 s84, s95, 8
    s_and_b32 s84, s84, 8192
    s_xor_b32 s84, s84, s46
    s_add_u32 s84, s84, s95
    s_add_u32 s15, s15, 1
    s_barrier
    s_branch recur_fast_w1
g_34L15_0:
    s_waitcnt vmcnt(3)
    v_max3_u32 v19, v24, v25, v26
    v_max_u32 v19, v19, v27
    v_cmp_eq_u32 vcc, -1, v19
    s_nop 0
    s_cbranch_vccnz g_34F15_0
    v_smfmac_f32_16x16x64_bf16 v[40:43], v[24:27], a[0:7], v172
    v_smfmac_f32_16x16x64_bf16 v[44:47], v[24:27], a[64:71], v172
    v_smfmac_f32_16x16x64_bf16 v[48:51], v[24:27], a[32:39], v172
    v_smfmac_f32_16x16x64_bf16 v[52:55], v[24:27], a[96:103], v172
g_34L14_1:
    s_waitcnt vmcnt(2)
    v_max3_u32 v19, v28, v29, v30
    v_max_u32 v19, v19, v31
    v_cmp_eq_u32 vcc, -1, v19
    s_nop 0
    s_cbranch_vccnz g_34F14_1
    v_smfmac_f32_16x16x64_bf16 v[40:43], v[28:31], a[8:15], v172
    v_smfmac_f32_16x16x64_bf16 v[44:47], v[28:31], a[72:79], v172
    v_smfmac_f32_16x16x64_bf16 v[48:51], v[28:31], a[40:47], v172
    v_smfmac_f32_16x16x64_bf16 v[52:55], v[28:31], a[104:111], v172
g_34L12_2:
    s_waitcnt vmcnt(1)
    v_max3_u32 v19, v32, v33, v34
    v_max_u32 v19, v19, v35
    v_cmp_eq_u32 vcc, -1, v19
    s_nop 0
    s_cbranch_vccnz g_34F12_2
    v_smfmac_f32_16x16x64_bf16 v[40:43], v[32:35], a[16:23], v172
    v_smfmac_f32_16x16x64_bf16 v[44:47], v[32:35], a[80:87], v172
    v_smfmac_f32_16x16x64_bf16 v[48:51], v[32:35], a[48:55], v172
    v_smfmac_f32_16x16x64_bf16 v[52:55], v[32:35], a[112:119], v172
g_34L8_3:
    s_waitcnt vmcnt(0)
    v_max3_u32 v19, v36, v37, v38
    v_max_u32 v19, v19, v39
    v_cmp_eq_u32 vcc, -1, v19
    s_nop 0
    s_cbranch_vccnz g_34F8_3
    v_smfmac_f32_16x16x64_bf16 v[40:43], v[36:39], a[24:31], v172
    v_smfmac_f32_16x16x64_bf16 v[44:47], v[36:39], a[88:95], v172
    v_smfmac_f32_16x16x64_bf16 v[48:51], v[36:39], a[56:63], v172
    v_smfmac_f32_16x16x64_bf16 v[52:55], v[36:39], a[120:127], v172
    s_branch gc_35
g_34L15_1:
    s_waitcnt vmcnt(3)
    v_max3_u32 v19, v28, v29, v30
    v_max_u32 v19, v19, v31
    v_cmp_eq_u32 vcc, -1, v19
    s_nop 0
    s_cbranch_vccnz g_34F15_1
    v_smfmac_f32_16x16x64_bf16 v[40:43], v[28:31], a[8:15], v172
    v_smfmac_f32_16x16x64_bf16 v[44:47], v[28:31], a[72:79], v172
    v_smfmac_f32_16x16x64_bf16 v[48:51], v[28:31], a[40:47], v172
    v_smfmac_f32_16x16x64_bf16 v[52:55], v[28:31], a[104:111], v172
g_34L13_2:
    s_waitcnt vmcnt(2)
    v_max3_u32 v19, v32, v33, v34
    v_max_u32 v19, v19, v35
    v_cmp_eq_u32 vcc, -1, v19
    s_nop 0
    s_cbranch_vccnz g_34F13_2
    v_smfmac_f32_16x16x64_bf16 v[40:43], v[32:35], a[16:23], v172
    v_smfmac_f32_16x16x64_bf16 v[44:47], v[32:35], a[80:87], v172
    v_smfmac_f32_16x16x64_bf16 v[48:51], v[32:35], a[48:55], v172
    v_smfmac_f32_16x16x64_bf16 v[52:55], v[32:35], a[112:119], v172
g_34L9_3:
    s_waitcnt vmcnt(1)
    v_max3_u32 v19, v36, v37, v38
    v_max_u32 v19, v19, v39
    v_cmp_eq_u32 vcc, -1, v19
    s_nop 0
    s_cbranch_vccnz g_34F9_3
    v_smfmac_f32_16x16x64_bf16 v[40:43], v[36:39], a[24:31], v172
    v_smfmac_f32_16x16x64_bf16 v[44:47], v[36:39], a[88:95], v172
    v_smfmac_f32_16x16x64_bf16 v[48:51], v[36:39], a[56:63], v172
    v_smfmac_f32_16x16x64_bf16 v[52:55], v[36:39], a[120:127], v172
g_34L1_0:
    s_waitcnt vmcnt(0)
    v_max3_u32 v19, v24, v25, v26
    v_max_u32 v19, v19, v27
    v_cmp_eq_u32 vcc, -1, v19
    s_nop 0
    s_cbranch_vccnz g_34F1_0
    v_smfmac_f32_16x16x64_bf16 v[40:43], v[24:27], a[0:7], v172
    v_smfmac_f32_16x16x64_bf16 v[44:47], v[24:27], a[64:71], v172
    v_smfmac_f32_16x16x64_bf16 v[48:51], v[24:27], a[32:39], v172
    v_smfmac_f32_16x16x64_bf16 v[52:55], v[24:27], a[96:103], v172
    s_branch gc_35
g_34L15_2:
    s_waitcnt vmcnt(3)
    v_max3_u32 v19, v32, v33, v34
    v_max_u32 v19, v19, v35
    v_cmp_eq_u32 vcc, -1, v19
    s_nop 0
    s_cbranch_vccnz g_34F15_2
    v_smfmac_f32_16x16x64_bf16 v[40:43], v[32:35], a[16:23], v172
    v_smfmac_f32_16x16x64_bf16 v[44:47], v[32:35], a[80:87], v172
    v_smfmac_f32_16x16x64_bf16 v[48:51], v[32:35], a[48:55], v172
    v_smfmac_f32_16x16x64_bf16 v[52:55], v[32:35], a[112:119], v172
g_34L11_3:
    s_waitcnt vmcnt(2)
    v_max3_u32 v19, v36, v37, v38
    v_max_u32 v19, v19, v39
    v_cmp_eq_u32 vcc, -1, v19
    s_nop 0
    s_cbranch_vccnz g_34F11_3
    v_smfmac_f32_16x16x64_bf16 v[40:43], v[36:39], a[24:31], v172
    v_smfmac_f32_16x16x64_bf16 v[44:47], v[36:39], a[88:95], v172
    v_smfmac_f32_16x16x64_bf16 v[48:51], v[36:39], a[56:63], v172
    v_smfmac_f32_16x16x64_bf16 v[52:55], v[36:39], a[120:127], v172
g_34L3_0:
    s_waitcnt vmcnt(1)
    v_max3_u32 v19, v24, v25, v26
    v_max_u32 v19, v19, v27
    v_cmp_eq_u32 vcc, -1, v19
    s_nop 0
    s_cbranch_vccnz g_34F3_0
    v_smfmac_f32_16x16x64_bf16 v[40:43], v[24:27], a[0:7], v172
    v_smfmac_f32_16x16x64_bf16 v[44:47], v[24:27], a[64:71], v172
    v_smfmac_f32_16x16x64_bf16 v[48:51], v[24:27], a[32:39], v172
    v_smfmac_f32_16x16x64_bf16 v[52:55], v[24:27], a[96:103], v172
g_34L2_1:
    s_waitcnt vmcnt(0)
    v_max3_u32 v19, v28, v29, v30
    v_max_u32 v19, v19, v31
    v_cmp_eq_u32 vcc, -1, v19
    s_nop 0
    s_cbranch_vccnz g_34F2_1
    v_smfmac_f32_16x16x64_bf16 v[40:43], v[28:31], a[8:15], v172
    v_smfmac_f32_16x16x64_bf16 v[44:47], v[28:31], a[72:79], v172
    v_smfmac_f32_16x16x64_bf16 v[48:51], v[28:31], a[40:47], v172
    v_smfmac_f32_16x16x64_bf16 v[52:55], v[28:31], a[104:111], v172
    s_branch gc_35
g_34L15_3:
    s_waitcnt vmcnt(3)
    v_max3_u32 v19, v36, v37, v38
    v_max_u32 v19, v19, v39
    v_cmp_eq_u32 vcc, -1, v19
    s_nop 0
    s_cbranch_vccnz g_34F15_3
    v_smfmac_f32_16x16x64_bf16 v[40:43], v[36:39], a[24:31], v172
    v_smfmac_f32_16x16x64_bf16 v[44:47], v[36:39], a[88:95], v172
    v_smfmac_f32_16x16x64_bf16 v[48:51], v[36:39], a[56:63], v172
    v_smfmac_f32_16x16x64_bf16 v[52:55], v[36:39], a[120:127], v172
g_34L7_0:
    s_waitcnt vmcnt(2)
    v_max3_u32 v19, v24, v25, v26
    v_max_u32 v19, v19, v27
    v_cmp_eq_u32 vcc, -1, v19
    s_nop 0
    s_cbranch_vccnz g_34F7_0
    v_smfmac_f32_16x16x64_bf16 v[40:43], v[24:27], a[0:7], v172
    v_smfmac_f32_16x16x64_bf16 v[44:47], v[24:27], a[64:71], v172
    v_smfmac_f32_16x16x64_bf16 v[48:51], v[24:27], a[32:39], v172
    v_smfmac_f32_16x16x64_bf16 v[52:55], v[24:27], a[96:103], v172
g_34L6_1:
    s_waitcnt vmcnt(1)
    v_max3_u32 v19, v28, v29, v30
    v_max_u32 v19, v19, v31
    v_cmp_eq_u32 vcc, -1, v19
    s_nop 0
    s_cbranch_vccnz g_34F6_1
    v_smfmac_f32_16x16x64_bf16 v[40:43], v[28:31], a[8:15], v172
    v_smfmac_f32_16x16x64_bf16 v[44:47], v[28:31], a[72:79], v172
    v_smfmac_f32_16x16x64_bf16 v[48:51], v[28:31], a[40:47], v172
    v_smfmac_f32_16x16x64_bf16 v[52:55], v[28:31], a[104:111], v172
g_34L4_2:
    s_waitcnt vmcnt(0)
    v_max3_u32 v19, v32, v33, v34
    v_max_u32 v19, v19, v35
    v_cmp_eq_u32 vcc, -1, v19
    s_nop 0
    s_cbranch_vccnz g_34F4_2
    v_smfmac_f32_16x16x64_bf16 v[40:43], v[32:35], a[16:23], v172
    v_smfmac_f32_16x16x64_bf16 v[44:47], v[32:35], a[80:87], v172
    v_smfmac_f32_16x16x64_bf16 v[48:51], v[32:35], a[48:55], v172
    v_smfmac_f32_16x16x64_bf16 v[52:55], v[32:35], a[112:119], v172
    s_branch gc_35
g_34L7_1:
    s_waitcnt vmcnt(2)
    v_max3_u32 v19, v28, v29, v30
    v_max_u32 v19, v19, v31
    v_cmp_eq_u32 vcc, -1, v19
    s_nop 0
    s_cbranch_vccnz g_34F7_1
    v_smfmac_f32_16x16x64_bf16 v[40:43], v[28:31], a[8:15], v172
    v_smfmac_f32_16x16x64_bf16 v[44:47], v[28:31], a[72:79], v172
    v_smfmac_f32_16x16x64_bf16 v[48:51], v[28:31], a[40:47], v172
    v_smfmac_f32_16x16x64_bf16 v[52:55], v[28:31], a[104:111], v172
g_34L5_2:
    s_waitcnt vmcnt(1)
    v_max3_u32 v19, v32, v33, v34
    v_max_u32 v19, v19, v35
    v_cmp_eq_u32 vcc, -1, v19
    s_nop 0
    s_cbranch_vccnz g_34F5_2
    v_smfmac_f32_16x16x64_bf16 v[40:43], v[32:35], a[16:23], v172
    v_smfmac_f32_16x16x64_bf16 v[44:47], v[32:35], a[80:87], v172
    v_smfmac_f32_16x16x64_bf16 v[48:51], v[32:35], a[48:55], v172
    v_smfmac_f32_16x16x64_bf16 v[52:55], v[32:35], a[112:119], v172
    s_branch g_34L1_0
g_34L7_2:
    s_waitcnt vmcnt(2)
    v_max3_u32 v19, v32, v33, v34
    v_max_u32 v19, v19, v35
    v_cmp_eq_u32 vcc, -1, v19
    s_nop 0
    s_cbranch_vccnz g_34F7_2
    v_smfmac_f32_16x16x64_bf16 v[40:43], v[32:35], a[16:23], v172
    v_smfmac_f32_16x16x64_bf16 v[44:47], v[32:35], a[80:87], v172
    v_smfmac_f32_16x16x64_bf16 v[48:51], v[32:35], a[48:55], v172
    v_smfmac_f32_16x16x64_bf16 v[52:55], v[32:35], a[112:119], v172
    s_branch g_34L3_0
g_34L11_0:
    s_waitcnt vmcnt(2)
    v_max3_u32 v19, v24, v25, v26
    v_max_u32 v19, v19, v27
    v_cmp_eq_u32 vcc, -1, v19
    s_nop 0
    s_cbranch_vccnz g_34F11_0
    v_smfmac_f32_16x16x64_bf16 v[40:43], v[24:27], a[0:7], v172
    v_smfmac_f32_16x16x64_bf16 v[44:47], v[24:27], a[64:71], v172
    v_smfmac_f32_16x16x64_bf16 v[48:51], v[24:27], a[32:39], v172
    v_smfmac_f32_16x16x64_bf16 v[52:55], v[24:27], a[96:103], v172
g_34L10_1:
    s_waitcnt vmcnt(1)
    v_max3_u32 v19, v28, v29, v30
    v_max_u32 v19, v19, v31
    v_cmp_eq_u32 vcc, -1, v19
    s_nop 0
    s_cbranch_vccnz g_34F10_1
    v_smfmac_f32_16x16x64_bf16 v[40:43], v[28:31], a[8:15], v172
    v_smfmac_f32_16x16x64_bf16 v[44:47], v[28:31], a[72:79], v172
    v_smfmac_f32_16x16x64_bf16 v[48:51], v[28:31], a[40:47], v172
    v_smfmac_f32_16x16x64_bf16 v[52:55], v[28:31], a[104:111], v172
    s_branch g_34L8_3
g_34L11_1:
    s_waitcnt vmcnt(2)
    v_max3_u32 v19, v28, v29, v30
    v_max_u32 v19, v19, v31
    v_cmp_eq_u32 vcc, -1, v19
    s_nop 0
    s_cbranch_vccnz g_34F11_1
    v_smfmac_f32_16x16x64_bf16 v[40:43], v[28:31], a[8:15], v172
    v_smfmac_f32_16x16x64_bf16 v[44:47], v[28:31], a[72:79], v172
    v_smfmac_f32_16x16x64_bf16 v[48:51], v[28:31], a[40:47], v172
    v_smfmac_f32_16x16x64_bf16 v[52:55], v[28:31], a[104:111], v172
    s_branch g_34L9_3
g_34L13_0:
    s_waitcnt vmcnt(2)
    v_max3_u32 v19, v24, v25, v26
    v_max_u32 v19, v19, v27
    v_cmp_eq_u32 vcc, -1, v19
    s_nop 0
    s_cbranch_vccnz g_34F13_0
    v_smfmac_f32_16x16x64_bf16 v[40:43], v[24:27], a[0:7], v172
    v_smfmac_f32_16x16x64_bf16 v[44:47], v[24:27], a[64:71], v172
    v_smfmac_f32_16x16x64_bf16 v[48:51], v[24:27], a[32:39], v172
    v_smfmac_f32_16x16x64_bf16 v[52:55], v[24:27], a[96:103], v172
    s_branch g_34L12_2
g_34L13_3:
    s_waitcnt vmcnt(2)
    v_max3_u32 v19, v36, v37, v38
    v_max_u32 v19, v19, v39
    v_cmp_eq_u32 vcc, -1, v19
    s_nop 0
    s_cbranch_vccnz g_34F13_3
    v_smfmac_f32_16x16x64_bf16 v[40:43], v[36:39], a[24:31], v172
    v_smfmac_f32_16x16x64_bf16 v[44:47], v[36:39], a[88:95], v172
    v_smfmac_f32_16x16x64_bf16 v[48:51], v[36:39], a[56:63], v172
    v_smfmac_f32_16x16x64_bf16 v[52:55], v[36:39], a[120:127], v172
g_34L5_0:
    s_waitcnt vmcnt(1)
    v_max3_u32 v19, v24, v25, v26
    v_max_u32 v19, v19, v27
    v_cmp_eq_u32 vcc, -1, v19
    s_nop 0
    s_cbranch_vccnz g_34F5_0
    v_smfmac_f32_16x16x64_bf16 v[40:43], v[24:27], a[0:7], v172
    v_smfmac_f32_16x16x64_bf16 v[44:47], v[24:27], a[64:71], v172
    v_smfmac_f32_16x16x64_bf16 v[48:51], v[24:27], a[32:39], v172
    v_smfmac_f32_16x16x64_bf16 v[52:55], v[24:27], a[96:103], v172
    s_branch g_34L4_2
g_34L14_2:
    s_waitcnt vmcnt(2)
    v_max3_u32 v19, v32, v33, v34
    v_max_u32 v19, v19, v35
    v_cmp_eq_u32 vcc, -1, v19
    s_nop 0
    s_cbranch_vccnz g_34F14_2
    v_smfmac_f32_16x16x64_bf16 v[40:43], v[32:35], a[16:23], v172
    v_smfmac_f32_16x16x64_bf16 v[44:47], v[32:35], a[80:87], v172
    v_smfmac_f32_16x16x64_bf16 v[48:51], v[32:35], a[48:55], v172
    v_smfmac_f32_16x16x64_bf16 v[52:55], v[32:35], a[112:119], v172
g_34L10_3:
    s_waitcnt vmcnt(1)
    v_max3_u32 v19, v36, v37, v38
    v_max_u32 v19, v19, v39
    v_cmp_eq_u32 vcc, -1, v19
    s_nop 0
    s_cbranch_vccnz g_34F10_3
    v_smfmac_f32_16x16x64_bf16 v[40:43], v[36:39], a[24:31], v172
    v_smfmac_f32_16x16x64_bf16 v[44:47], v[36:39], a[88:95], v172
    v_smfmac_f32_16x16x64_bf16 v[48:51], v[36:39], a[56:63], v172
    v_smfmac_f32_16x16x64_bf16 v[52:55], v[36:39], a[120:127], v172
    s_branch g_34L2_1
g_34L14_3:
    s_waitcnt vmcnt(2)
    v_max3_u32 v19, v36, v37, v38
    v_max_u32 v19, v19, v39
    v_cmp_eq_u32 vcc, -1, v19
    s_nop 0
    s_cbranch_vccnz g_34F14_3
    v_smfmac_f32_16x16x64_bf16 v[40:43], v[36:39], a[24:31], v172
    v_smfmac_f32_16x16x64_bf16 v[44:47], v[36:39], a[88:95], v172
    v_smfmac_f32_16x16x64_bf16 v[48:51], v[36:39], a[56:63], v172
    v_smfmac_f32_16x16x64_bf16 v[52:55], v[36:39], a[120:127], v172
    s_branch g_34L6_1
g_34L3_1:
    s_waitcnt vmcnt(1)
    v_max3_u32 v19, v28, v29, v30
    v_max_u32 v19, v19, v31
    v_cmp_eq_u32 vcc, -1, v19
    s_nop 0
    s_cbranch_vccnz g_34F3_1
    v_smfmac_f32_16x16x64_bf16 v[40:43], v[28:31], a[8:15], v172
    v_smfmac_f32_16x16x64_bf16 v[44:47], v[28:31], a[72:79], v172
    v_smfmac_f32_16x16x64_bf16 v[48:51], v[28:31], a[40:47], v172
    v_smfmac_f32_16x16x64_bf16 v[52:55], v[28:31], a[104:111], v172
    s_branch g_34L1_0
g_34L6_2:
    s_waitcnt vmcnt(1)
    v_max3_u32 v19, v32, v33, v34
    v_max_u32 v19, v19, v35
    v_cmp_eq_u32 vcc, -1, v19
    s_nop 0
    s_cbranch_vccnz g_34F6_2
    v_smfmac_f32_16x16x64_bf16 v[40:43], v[32:35], a[16:23], v172
    v_smfmac_f32_16x16x64_bf16 v[44:47], v[32:35], a[80:87], v172
    v_smfmac_f32_16x16x64_bf16 v[48:51], v[32:35], a[48:55], v172
    v_smfmac_f32_16x16x64_bf16 v[52:55], v[32:35], a[112:119], v172
    s_branch g_34L2_1
g_34L9_0:
    s_waitcnt vmcnt(1)
    v_max3_u32 v19, v24, v25, v26
    v_max_u32 v19, v19, v27
    v_cmp_eq_u32 vcc, -1, v19
    s_nop 0
    s_cbranch_vccnz g_34F9_0
    v_smfmac_f32_16x16x64_bf16 v[40:43], v[24:27], a[0:7], v172
    v_smfmac_f32_16x16x64_bf16 v[44:47], v[24:27], a[64:71], v172
    v_smfmac_f32_16x16x64_bf16 v[48:51], v[24:27], a[32:39], v172
    v_smfmac_f32_16x16x64_bf16 v[52:55], v[24:27], a[96:103], v172
    s_branch g_34L8_3
g_34L12_3:
    s_waitcnt vmcnt(1)
    v_max3_u32 v19, v36, v37, v38
    v_max_u32 v19, v19, v39
    v_cmp_eq_u32 vcc, -1, v19
    s_nop 0
    s_cbranch_vccnz g_34F12_3
    v_smfmac_f32_16x16x64_bf16 v[40:43], v[36:39], a[24:31], v172
    v_smfmac_f32_16x16x64_bf16 v[44:47], v[36:39], a[88:95], v172
    v_smfmac_f32_16x16x64_bf16 v[48:51], v[36:39], a[56:63], v172
    v_smfmac_f32_16x16x64_bf16 v[52:55], v[36:39], a[120:127], v172
    s_branch g_34L4_2
g_34F15_0:
    s_mov_b64 exec, vcc
    buffer_load_dwordx4 v[24:27], v2, s[4:7], s16 offen offset:0 sc1
    s_mov_b64 exec, -1
    s_add_u32 s23, s23, 1
    s_cmp_lt_u32 s23, 200000
    s_cbranch_scc1 g_34L15_1
    s_mov_b32 s25, 200000
    s_branch gc_35
g_34F15_1:
    s_mov_b64 exec, vcc
    buffer_load_dwordx4 v[28:31], v2, s[4:7], s16 offen offset:1024 sc1
    s_mov_b64 exec, -1
    s_add_u32 s23, s23, 1
    s_cmp_lt_u32 s23, 200000
    s_cbranch_scc1 g_34L15_2
    s_mov_b32 s25, 200000
    s_branch gc_35
g_34F15_2:
    s_mov_b64 exec, vcc
    buffer_load_dwordx4 v[32:35], v2, s[4:7], s16 offen offset:2048 sc1
    s_mov_b64 exec, -1
    s_add_u32 s23, s23, 1
    s_cmp_lt_u32 s23, 200000
    s_cbranch_scc1 g_34L15_3
    s_mov_b32 s25, 200000
    s_branch gc_35
g_34F15_3:
    s_mov_b64 exec, vcc
    buffer_load_dwordx4 v[36:39], v2, s[4:7], s16 offen offset:3072 sc1
    s_mov_b64 exec, -1
    s_add_u32 s23, s23, 1
    s_cmp_lt_u32 s23, 200000
    s_cbranch_scc1 g_34L15_0
    s_mov_b32 s25, 200000
    s_branch gc_35
g_34F7_0:
    s_mov_b64 exec, vcc
    buffer_load_dwordx4 v[24:27], v2, s[4:7], s16 offen offset:0 sc1
    s_mov_b64 exec, -1
    s_add_u32 s23, s23, 1
    s_cmp_lt_u32 s23, 200000
    s_cbranch_scc1 g_34L7_1
    s_mov_b32 s25, 200000
    s_branch gc_35
g_34F7_1:
    s_mov_b64 exec, vcc
    buffer_load_dwordx4 v[28:31], v2, s[4:7], s16 offen offset:1024 sc1
    s_mov_b64 exec, -1
    s_add_u32 s23, s23, 1
    s_cmp_lt_u32 s23, 200000
    s_cbranch_scc1 g_34L7_2
    s_mov_b32 s25, 200000
    s_branch gc_35
g_34F7_2:
    s_mov_b64 exec, vcc
    buffer_load_dwordx4 v[32:35], v2, s[4:7], s16 offen offset:2048 sc1
    s_mov_b64 exec, -1
    s_add_u32 s23, s23, 1
    s_cmp_lt_u32 s23, 200000
    s_cbranch_scc1 g_34L7_0
    s_mov_b32 s25, 200000
    s_branch gc_35
g_34F11_0:
    s_mov_b64 exec, vcc
    buffer_load_dwordx4 v[24:27], v2, s[4:7], s16 offen offset:0 sc1
    s_mov_b64 exec, -1
    s_add_u32 s23, s23, 1
    s_cmp_lt_u32 s23, 200000
    s_cbranch_scc1 g_34L11_1
    s_mov_b32 s25, 200000
    s_branch gc_35
g_34F11_1:
    s_mov_b64 exec, vcc
    buffer_load_dwordx4 v[28:31], v2, s[4:7], s16 offen offset:1024 sc1
    s_mov_b64 exec, -1
    s_add_u32 s23, s23, 1
    s_cmp_lt_u32 s23, 200000
    s_cbranch_scc1 g_34L11_3
    s_mov_b32 s25, 200000
    s_branch gc_35
g_34F11_3:
    s_mov_b64 exec, vcc
    buffer_load_dwordx4 v[36:39], v2, s[4:7], s16 offen offset:3072 sc1
    s_mov_b64 exec, -1
    s_add_u32 s23, s23, 1
    s_cmp_lt_u32 s23, 200000
    s_cbranch_scc1 g_34L11_0
    s_mov_b32 s25, 200000
    s_branch gc_35
g_34F13_0:
    s_mov_b64 exec, vcc
    buffer_load_dwordx4 v[24:27], v2, s[4:7], s16 offen offset:0 sc1
    s_mov_b64 exec, -1
    s_add_u32 s23, s23, 1
    s_cmp_lt_u32 s23, 200000
    s_cbranch_scc1 g_34L13_2
    s_mov_b32 s25, 200000
    s_branch gc_35
g_34F13_2:
    s_mov_b64 exec, vcc
    buffer_load_dwordx4 v[32:35], v2, s[4:7], s16 offen offset:2048 sc1
    s_mov_b64 exec, -1
    s_add_u32 s23, s23, 1
    s_cmp_lt_u32 s23, 200000
    s_cbranch_scc1 g_34L13_3
    s_mov_b32 s25, 200000
    s_branch gc_35
g_34F13_3:
    s_mov_b64 exec, vcc
    buffer_load_dwordx4 v[36:39], v2, s[4:7], s16 offen offset:3072 sc1
    s_mov_b64 exec, -1
    s_add_u32 s23, s23, 1
    s_cmp_lt_u32 s23, 200000
    s_cbranch_scc1 g_34L13_0
    s_mov_b32 s25, 200000
    s_branch gc_35
g_34F14_1:
    s_mov_b64 exec, vcc
    buffer_load_dwordx4 v[28:31], v2, s[4:7], s16 offen offset:1024 sc1
    s_mov_b64 exec, -1
    s_add_u32 s23, s23, 1
    s_cmp_lt_u32 s23, 200000
    s_cbranch_scc1 g_34L14_2
    s_mov_b32 s25, 200000
    s_branch gc_35
g_34F14_2:
    s_mov_b64 exec, vcc
    buffer_load_dwordx4 v[32:35], v2, s[4:7], s16 offen offset:2048 sc1
    s_mov_b64 exec, -1
    s_add_u32 s23, s23, 1
    s_cmp_lt_u32 s23, 200000
    s_cbranch_scc1 g_34L14_3
    s_mov_b32 s25, 200000
    s_branch gc_35
g_34F14_3:
    s_mov_b64 exec, vcc
    buffer_load_dwordx4 v[36:39], v2, s[4:7], s16 offen offset:3072 sc1
    s_mov_b64 exec, -1
    s_add_u32 s23, s23, 1
    s_cmp_lt_u32 s23, 200000
    s_cbranch_scc1 g_34L14_1
    s_mov_b32 s25, 200000
    s_branch gc_35
g_34F3_0:
    s_mov_b64 exec, vcc
    buffer_load_dwordx4 v[24:27], v2, s[4:7], s16 offen offset:0 sc1
    s_mov_b64 exec, -1
    s_add_u32 s23, s23, 1
    s_cmp_lt_u32 s23, 200000
    s_cbranch_scc1 g_34L3_1
    s_mov_b32 s25, 200000
    s_branch gc_35
g_34F3_1:
    s_mov_b64 exec, vcc
    buffer_load_dwordx4 v[28:31], v2, s[4:7], s16 offen offset:1024 sc1
    s_mov_b64 exec, -1
    s_add_u32 s23, s23, 1
    s_cmp_lt_u32 s23, 200000
    s_cbranch_scc1 g_34L3_0
    s_mov_b32 s25, 200000
    s_branch gc_35
g_34F5_0:
    s_mov_b64 exec, vcc
    buffer_load_dwordx4 v[24:27], v2, s[4:7], s16 offen offset:0 sc1
    s_mov_b64 exec, -1
    s_add_u32 s23, s23, 1
    s_cmp_lt_u32 s23, 200000
    s_cbranch_scc1 g_34L5_2
    s_mov_b32 s25, 200000
    s_branch gc_35
g_34F5_2:
    s_mov_b64 exec, vcc
    buffer_load_dwordx4 v[32:35], v2, s[4:7], s16 offen offset:2048 sc1
    s_mov_b64 exec, -1
    s_add_u32 s23, s23, 1
    s_cmp_lt_u32 s23, 200000
    s_cbranch_scc1 g_34L5_0
    s_mov_b32 s25, 200000
    s_branch gc_35
g_34F6_1:
    s_mov_b64 exec, vcc
    buffer_load_dwordx4 v[28:31], v2, s[4:7], s16 offen offset:1024 sc1
    s_mov_b64 exec, -1
    s_add_u32 s23, s23, 1
    s_cmp_lt_u32 s23, 200000
    s_cbranch_scc1 g_34L6_2
    s_mov_b32 s25, 200000
    s_branch gc_35
g_34F6_2:
    s_mov_b64 exec, vcc
    buffer_load_dwordx4 v[32:35], v2, s[4:7], s16 offen offset:2048 sc1
    s_mov_b64 exec, -1
    s_add_u32 s23, s23, 1
    s_cmp_lt_u32 s23, 200000
    s_cbranch_scc1 g_34L6_1
    s_mov_b32 s25, 200000
    s_branch gc_35
g_34F9_0:
    s_mov_b64 exec, vcc
    buffer_load_dwordx4 v[24:27], v2, s[4:7], s16 offen offset:0 sc1
    s_mov_b64 exec, -1
    s_add_u32 s23, s23, 1
    s_cmp_lt_u32 s23, 200000
    s_cbranch_scc1 g_34L9_3
    s_mov_b32 s25, 200000
    s_branch gc_35
g_34F9_3:
    s_mov_b64 exec, vcc
    buffer_load_dwordx4 v[36:39], v2, s[4:7], s16 offen offset:3072 sc1
    s_mov_b64 exec, -1
    s_add_u32 s23, s23, 1
    s_cmp_lt_u32 s23, 200000
    s_cbranch_scc1 g_34L9_0
    s_mov_b32 s25, 200000
    s_branch gc_35
g_34F10_1:
    s_mov_b64 exec, vcc
    buffer_load_dwordx4 v[28:31], v2, s[4:7], s16 offen offset:1024 sc1
    s_mov_b64 exec, -1
    s_add_u32 s23, s23, 1
    s_cmp_lt_u32 s23, 200000
    s_cbranch_scc1 g_34L10_3
    s_mov_b32 s25, 200000
    s_branch gc_35
g_34F10_3:
    s_mov_b64 exec, vcc
    buffer_load_dwordx4 v[36:39], v2, s[4:7], s16 offen offset:3072 sc1
    s_mov_b64 exec, -1
    s_add_u32 s23, s23, 1
    s_cmp_lt_u32 s23, 200000
    s_cbranch_scc1 g_34L10_1
    s_mov_b32 s25, 200000
    s_branch gc_35
g_34F12_2:
    s_mov_b64 exec, vcc
    buffer_load_dwordx4 v[32:35], v2, s[4:7], s16 offen offset:2048 sc1
    s_mov_b64 exec, -1
    s_add_u32 s23, s23, 1
    s_cmp_lt_u32 s23, 200000
    s_cbranch_scc1 g_34L12_3
    s_mov_b32 s25, 200000
    s_branch gc_35
g_34F12_3:
    s_mov_b64 exec, vcc
    buffer_load_dwordx4 v[36:39], v2, s[4:7], s16 offen offset:3072 sc1
    s_mov_b64 exec, -1
    s_add_u32 s23, s23, 1
    s_cmp_lt_u32 s23, 200000
    s_cbranch_scc1 g_34L12_2
    s_mov_b32 s25, 200000
    s_branch gc_35
g_34F1_0:
    s_mov_b64 exec, vcc
    buffer_load_dwordx4 v[24:27], v2, s[4:7], s16 offen offset:0 sc1
    s_mov_b64 exec, -1
    s_add_u32 s23, s23, 1
    s_cmp_lt_u32 s23, 200000
    s_cbranch_scc1 g_34L1_0
    s_mov_b32 s25, 200000
    s_branch gc_35
g_34F2_1:
    s_mov_b64 exec, vcc
    buffer_load_dwordx4 v[28:31], v2, s[4:7], s16 offen offset:1024 sc1
    s_mov_b64 exec, -1
    s_add_u32 s23, s23, 1
    s_cmp_lt_u32 s23, 200000
    s_cbranch_scc1 g_34L2_1
    s_mov_b32 s25, 200000
    s_branch gc_35
g_34F4_2:
    s_mov_b64 exec, vcc
    buffer_load_dwordx4 v[32:35], v2, s[4:7], s16 offen offset:2048 sc1
    s_mov_b64 exec, -1
    s_add_u32 s23, s23, 1
    s_cmp_lt_u32 s23, 200000
    s_cbranch_scc1 g_34L4_2
    s_mov_b32 s25, 200000
    s_branch gc_35
g_34F8_3:
    s_mov_b64 exec, vcc
    buffer_load_dwordx4 v[36:39], v2, s[4:7], s16 offen offset:3072 sc1
    s_mov_b64 exec, -1
    s_add_u32 s23, s23, 1
    s_cmp_lt_u32 s23, 200000
    s_cbranch_scc1 g_34L8_3
    s_mov_b32 s25, 200000
    s_branch gc_35
sb_37:
    v_max3_u32 v19, v24, v25, v26
    v_max3_u32 v19, v19, v27, v28
    v_max3_u32 v19, v19, v29, v30
    v_max3_u32 v19, v19, v31, v32
    v_max3_u32 v19, v19, v33, v34
    v_max3_u32 v19, v19, v35, v36
    v_max3_u32 v19, v19, v37, v38
    v_max3_u32 v19, v19, v39, v40
    v_max3_u32 v19, v19, v41, v42
    v_max_u32 v19, v19, v43
    v_cmp_eq_u32 vcc, -1, v19
    s_nop 0
    s_cbranch_vccz sg_38
    buffer_load_dwordx4 v[24:27], v5, s[4:7], s16 offen offset:0 sc1
    buffer_load_dwordx4 v[28:31], v5, s[4:7], s16 offen offset:1024 sc1
    buffer_load_dwordx4 v[32:35], v5, s[4:7], s16 offen offset:2048 sc1
    buffer_load_dwordx4 v[36:39], v5, s[4:7], s16 offen offset:3072 sc1
    buffer_load_dword v40, v6, s[4:7], s16 offen offset:0 sc1
    buffer_load_dword v41, v6, s[4:7], s16 offen offset:256 sc1
    buffer_load_dword v42, v6, s[4:7], s16 offen offset:512 sc1
    buffer_load_dword v43, v6, s[4:7], s16 offen offset:768 sc1
    s_add_u32 s23, s23, 1
    s_cmp_lt_u32 s23, 200000
    s_cbranch_scc1 ss_36
    s_mov_b32 s25, 200000
    s_branch sg_38
ss_36:
    s_waitcnt vmcnt(6)
    v_pk_add_f32 v[180:181], v[24:25], v[28:29]
    v_pk_add_f32 v[182:183], v[26:27], v[30:31]
    s_waitcnt vmcnt(4)
    v_pk_add_f32 v[188:189], v[32:33], v[36:37]
    v_pk_add_f32 v[190:191], v[34:35], v[38:39]
    v_pk_add_f32 v[180:181], v[180:181], v[188:189]
    v_pk_add_f32 v[182:183], v[182:183], v[190:191]
    v_pk_add_f32 v[188:189], v[180:181], v[182:183]
    v_max3_f32 v185, v180, v181, v182
    s_waitcnt vmcnt(0)
    v_pk_add_f32 v[192:193], v[40:41], v[42:43]
    v_add_f32 v188, v188, v189
    v_add_f32 v184, v192, v193
    v_max3_f32 v185, v185, v183, v184
    v_cmp_u_f32 vcc, v188, v184
    s_nop 0
    v_max_f32_dpp v185, v185, v185 row_ror:8 row_mask:0xf bank_mask:0xf
    v_mov_b32 v186, v185
    s_nop 1
    v_permlane16_swap_b32 v185, v186
    v_max_f32 v185, v185, v186
    v_mov_b32 v186, v185
    s_cbranch_vccnz sb_37
    s_branch sg_38
g_39L15_0:
    s_waitcnt vmcnt(3)
    v_max3_u32 v19, v24, v25, v26
    v_max_u32 v19, v19, v27
    v_cmp_eq_u32 vcc, -1, v19
    s_nop 0
    s_cbranch_vccnz g_39F15_0
    v_smfmac_f32_16x16x64_bf16 v[64:67], v[24:27], a[192:199], v172
    v_smfmac_f32_16x16x64_bf16 v[68:71], v[24:27], a[224:231], v172
g_39L14_1:
    s_waitcnt vmcnt(2)
    v_max3_u32 v19, v28, v29, v30
    v_max_u32 v19, v19, v31
    v_cmp_eq_u32 vcc, -1, v19
    s_nop 0
    s_cbranch_vccnz g_39F14_1
    v_smfmac_f32_16x16x64_bf16 v[64:67], v[28:31], a[200:207], v172
    v_smfmac_f32_16x16x64_bf16 v[68:71], v[28:31], a[232:239], v172
g_39L12_2:
    s_waitcnt vmcnt(1)
    v_max3_u32 v19, v32, v33, v34
    v_max_u32 v19, v19, v35
    v_cmp_eq_u32 vcc, -1, v19
    s_nop 0
    s_cbranch_vccnz g_39F12_2
    v_smfmac_f32_16x16x64_bf16 v[64:67], v[32:35], a[208:215], v172
    v_smfmac_f32_16x16x64_bf16 v[68:71], v[32:35], a[240:247], v172
g_39L8_3:
    s_waitcnt vmcnt(0)
    v_max3_u32 v19, v36, v37, v38
    v_max_u32 v19, v19, v39
    v_cmp_eq_u32 vcc, -1, v19
    s_nop 0
    s_cbranch_vccnz g_39F8_3
    v_smfmac_f32_16x16x64_bf16 v[64:67], v[36:39], a[216:223], v172
    v_smfmac_f32_16x16x64_bf16 v[68:71], v[36:39], a[248:255], v172
    s_nop 4
    v_cvt_pk_bf16_f32 v80, v64, v65
    v_cvt_pk_bf16_f32 v81, v66, v67
    s_nop 0
    v_cvt_pk_bf16_f32 v82, v68, v69
    v_cvt_pk_bf16_f32 v83, v70, v71
    ds_write_b128 v17, v[80:83] offset:9216
    s_branch gc_40
g_39L15_1:
    s_waitcnt vmcnt(3)
    v_max3_u32 v19, v28, v29, v30
    v_max_u32 v19, v19, v31
    v_cmp_eq_u32 vcc, -1, v19
    s_nop 0
    s_cbranch_vccnz g_39F15_1
    v_smfmac_f32_16x16x64_bf16 v[64:67], v[28:31], a[200:207], v172
    v_smfmac_f32_16x16x64_bf16 v[68:71], v[28:31], a[232:239], v172
g_39L13_2:
    s_waitcnt vmcnt(2)
    v_max3_u32 v19, v32, v33, v34
    v_max_u32 v19, v19, v35
    v_cmp_eq_u32 vcc, -1, v19
    s_nop 0
    s_cbranch_vccnz g_39F13_2
    v_smfmac_f32_16x16x64_bf16 v[64:67], v[32:35], a[208:215], v172
    v_smfmac_f32_16x16x64_bf16 v[68:71], v[32:35], a[240:247], v172
g_39L9_3:
    s_waitcnt vmcnt(1)
    v_max3_u32 v19, v36, v37, v38
    v_max_u32 v19, v19, v39
    v_cmp_eq_u32 vcc, -1, v19
    s_nop 0
    s_cbranch_vccnz g_39F9_3
    v_smfmac_f32_16x16x64_bf16 v[64:67], v[36:39], a[216:223], v172
    v_smfmac_f32_16x16x64_bf16 v[68:71], v[36:39], a[248:255], v172
g_39L1_0:
    s_waitcnt vmcnt(0)
    v_max3_u32 v19, v24, v25, v26
    v_max_u32 v19, v19, v27
    v_cmp_eq_u32 vcc, -1, v19
    s_nop 0
    s_cbranch_vccnz g_39F1_0
    v_smfmac_f32_16x16x64_bf16 v[64:67], v[24:27], a[192:199], v172
    v_smfmac_f32_16x16x64_bf16 v[68:71], v[24:27], a[224:231], v172
    s_nop 4
    v_cvt_pk_bf16_f32 v80, v64, v65
    v_cvt_pk_bf16_f32 v81, v66, v67
    s_nop 0
    v_cvt_pk_bf16_f32 v82, v68, v69
    v_cvt_pk_bf16_f32 v83, v70, v71
    ds_write_b128 v17, v[80:83] offset:9216
    s_branch gc_40
g_39L15_2:
    s_waitcnt vmcnt(3)
    v_max3_u32 v19, v32, v33, v34
    v_max_u32 v19, v19, v35
    v_cmp_eq_u32 vcc, -1, v19
    s_nop 0
    s_cbranch_vccnz g_39F15_2
    v_smfmac_f32_16x16x64_bf16 v[64:67], v[32:35], a[208:215], v172
    v_smfmac_f32_16x16x64_bf16 v[68:71], v[32:35], a[240:247], v172
g_39L11_3:
    s_waitcnt vmcnt(2)
    v_max3_u32 v19, v36, v37, v38
    v_max_u32 v19, v19, v39
    v_cmp_eq_u32 vcc, -1, v19
    s_nop 0
    s_cbranch_vccnz g_39F11_3
    v_smfmac_f32_16x16x64_bf16 v[64:67], v[36:39], a[216:223], v172
    v_smfmac_f32_16x16x64_bf16 v[68:71], v[36:39], a[248:255], v172
g_39L3_0:
    s_waitcnt vmcnt(1)
    v_max3_u32 v19, v24, v25, v26
    v_max_u32 v19, v19, v27
    v_cmp_eq_u32 vcc, -1, v19
    s_nop 0
    s_cbranch_vccnz g_39F3_0
    v_smfmac_f32_16x16x64_bf16 v[64:67], v[24:27], a[192:199], v172
    v_smfmac_f32_16x16x64_bf16 v[68:71], v[24:27], a[224:231], v172
g_39L2_1:
    s_waitcnt vmcnt(0)
    v_max3_u32 v19, v28, v29, v30
    v_max_u32 v19, v19, v31
    v_cmp_eq_u32 vcc, -1, v19
    s_nop 0
    s_cbranch_vccnz g_39F2_1
    v_smfmac_f32_16x16x64_bf16 v[64:67], v[28:31], a[200:207], v172
    v_smfmac_f32_16x16x64_bf16 v[68:71], v[28:31], a[232:239], v172
    s_nop 4
    v_cvt_pk_bf16_f32 v80, v64, v65
    v_cvt_pk_bf16_f32 v81, v66, v67
    s_nop 0
    v_cvt_pk_bf16_f32 v82, v68, v69
    v_cvt_pk_bf16_f32 v83, v70, v71
    ds_write_b128 v17, v[80:83] offset:9216
    s_branch gc_40
g_39L15_3:
    s_waitcnt vmcnt(3)
    v_max3_u32 v19, v36, v37, v38
    v_max_u32 v19, v19, v39
    v_cmp_eq_u32 vcc, -1, v19
    s_nop 0
    s_cbranch_vccnz g_39F15_3
    v_smfmac_f32_16x16x64_bf16 v[64:67], v[36:39], a[216:223], v172
    v_smfmac_f32_16x16x64_bf16 v[68:71], v[36:39], a[248:255], v172
g_39L7_0:
    s_waitcnt vmcnt(2)
    v_max3_u32 v19, v24, v25, v26
    v_max_u32 v19, v19, v27
    v_cmp_eq_u32 vcc, -1, v19
    s_nop 0
    s_cbranch_vccnz g_39F7_0
    v_smfmac_f32_16x16x64_bf16 v[64:67], v[24:27], a[192:199], v172
    v_smfmac_f32_16x16x64_bf16 v[68:71], v[24:27], a[224:231], v172
g_39L6_1:
    s_waitcnt vmcnt(1)
    v_max3_u32 v19, v28, v29, v30
    v_max_u32 v19, v19, v31
    v_cmp_eq_u32 vcc, -1, v19
    s_nop 0
    s_cbranch_vccnz g_39F6_1
    v_smfmac_f32_16x16x64_bf16 v[64:67], v[28:31], a[200:207], v172
    v_smfmac_f32_16x16x64_bf16 v[68:71], v[28:31], a[232:239], v172
g_39L4_2:
    s_waitcnt vmcnt(0)
    v_max3_u32 v19, v32, v33, v34
    v_max_u32 v19, v19, v35
    v_cmp_eq_u32 vcc, -1, v19
    s_nop 0
    s_cbranch_vccnz g_39F4_2
    v_smfmac_f32_16x16x64_bf16 v[64:67], v[32:35], a[208:215], v172
    v_smfmac_f32_16x16x64_bf16 v[68:71], v[32:35], a[240:247], v172
    s_nop 4
    v_cvt_pk_bf16_f32 v80, v64, v65
    v_cvt_pk_bf16_f32 v81, v66, v67
    s_nop 0
    v_cvt_pk_bf16_f32 v82, v68, v69
    v_cvt_pk_bf16_f32 v83, v70, v71
    ds_write_b128 v17, v[80:83] offset:9216
    s_branch gc_40
g_39L7_1:
    s_waitcnt vmcnt(2)
    v_max3_u32 v19, v28, v29, v30
    v_max_u32 v19, v19, v31
    v_cmp_eq_u32 vcc, -1, v19
    s_nop 0
    s_cbranch_vccnz g_39F7_1
    v_smfmac_f32_16x16x64_bf16 v[64:67], v[28:31], a[200:207], v172
    v_smfmac_f32_16x16x64_bf16 v[68:71], v[28:31], a[232:239], v172
g_39L5_2:
    s_waitcnt vmcnt(1)
    v_max3_u32 v19, v32, v33, v34
    v_max_u32 v19, v19, v35
    v_cmp_eq_u32 vcc, -1, v19
    s_nop 0
    s_cbranch_vccnz g_39F5_2
    v_smfmac_f32_16x16x64_bf16 v[64:67], v[32:35], a[208:215], v172
    v_smfmac_f32_16x16x64_bf16 v[68:71], v[32:35], a[240:247], v172
    s_branch g_39L1_0
g_39L7_2:
    s_waitcnt vmcnt(2)
    v_max3_u32 v19, v32, v33, v34
    v_max_u32 v19, v19, v35
    v_cmp_eq_u32 vcc, -1, v19
    s_nop 0
    s_cbranch_vccnz g_39F7_2
    v_smfmac_f32_16x16x64_bf16 v[64:67], v[32:35], a[208:215], v172
    v_smfmac_f32_16x16x64_bf16 v[68:71], v[32:35], a[240:247], v172
    s_branch g_39L3_0
g_39L11_0:
    s_waitcnt vmcnt(2)
    v_max3_u32 v19, v24, v25, v26
    v_max_u32 v19, v19, v27
    v_cmp_eq_u32 vcc, -1, v19
    s_nop 0
    s_cbranch_vccnz g_39F11_0
    v_smfmac_f32_16x16x64_bf16 v[64:67], v[24:27], a[192:199], v172
    v_smfmac_f32_16x16x64_bf16 v[68:71], v[24:27], a[224:231], v172
g_39L10_1:
    s_waitcnt vmcnt(1)
    v_max3_u32 v19, v28, v29, v30
    v_max_u32 v19, v19, v31
    v_cmp_eq_u32 vcc, -1, v19
    s_nop 0
    s_cbranch_vccnz g_39F10_1
    v_smfmac_f32_16x16x64_bf16 v[64:67], v[28:31], a[200:207], v172
    v_smfmac_f32_16x16x64_bf16 v[68:71], v[28:31], a[232:239], v172
    s_branch g_39L8_3
g_39L11_1:
    s_waitcnt vmcnt(2)
    v_max3_u32 v19, v28, v29, v30
    v_max_u32 v19, v19, v31
    v_cmp_eq_u32 vcc, -1, v19
    s_nop 0
    s_cbranch_vccnz g_39F11_1
    v_smfmac_f32_16x16x64_bf16 v[64:67], v[28:31], a[200:207], v172
    v_smfmac_f32_16x16x64_bf16 v[68:71], v[28:31], a[232:239], v172
    s_branch g_39L9_3
g_39L13_0:
    s_waitcnt vmcnt(2)
    v_max3_u32 v19, v24, v25, v26
    v_max_u32 v19, v19, v27
    v_cmp_eq_u32 vcc, -1, v19
    s_nop 0
    s_cbranch_vccnz g_39F13_0
    v_smfmac_f32_16x16x64_bf16 v[64:67], v[24:27], a[192:199], v172
    v_smfmac_f32_16x16x64_bf16 v[68:71], v[24:27], a[224:231], v172
    s_branch g_39L12_2
g_39L13_3:
    s_waitcnt vmcnt(2)
    v_max3_u32 v19, v36, v37, v38
    v_max_u32 v19, v19, v39
    v_cmp_eq_u32 vcc, -1, v19
    s_nop 0
    s_cbranch_vccnz g_39F13_3
    v_smfmac_f32_16x16x64_bf16 v[64:67], v[36:39], a[216:223], v172
    v_smfmac_f32_16x16x64_bf16 v[68:71], v[36:39], a[248:255], v172
g_39L5_0:
    s_waitcnt vmcnt(1)
    v_max3_u32 v19, v24, v25, v26
    v_max_u32 v19, v19, v27
    v_cmp_eq_u32 vcc, -1, v19
    s_nop 0
    s_cbranch_vccnz g_39F5_0
    v_smfmac_f32_16x16x64_bf16 v[64:67], v[24:27], a[192:199], v172
    v_smfmac_f32_16x16x64_bf16 v[68:71], v[24:27], a[224:231], v172
    s_branch g_39L4_2
g_39L14_2:
    s_waitcnt vmcnt(2)
    v_max3_u32 v19, v32, v33, v34
    v_max_u32 v19, v19, v35
    v_cmp_eq_u32 vcc, -1, v19
    s_nop 0
    s_cbranch_vccnz g_39F14_2
    v_smfmac_f32_16x16x64_bf16 v[64:67], v[32:35], a[208:215], v172
    v_smfmac_f32_16x16x64_bf16 v[68:71], v[32:35], a[240:247], v172
g_39L10_3:
    s_waitcnt vmcnt(1)
    v_max3_u32 v19, v36, v37, v38
    v_max_u32 v19, v19, v39
    v_cmp_eq_u32 vcc, -1, v19
    s_nop 0
    s_cbranch_vccnz g_39F10_3
    v_smfmac_f32_16x16x64_bf16 v[64:67], v[36:39], a[216:223], v172
    v_smfmac_f32_16x16x64_bf16 v[68:71], v[36:39], a[248:255], v172
    s_branch g_39L2_1
g_39L14_3:
    s_waitcnt vmcnt(2)
    v_max3_u32 v19, v36, v37, v38
    v_max_u32 v19, v19, v39
    v_cmp_eq_u32 vcc, -1, v19
    s_nop 0
    s_cbranch_vccnz g_39F14_3
    v_smfmac_f32_16x16x64_bf16 v[64:67], v[36:39], a[216:223], v172
    v_smfmac_f32_16x16x64_bf16 v[68:71], v[36:39], a[248:255], v172
    s_branch g_39L6_1
g_39L3_1:
    s_waitcnt vmcnt(1)
    v_max3_u32 v19, v28, v29, v30
    v_max_u32 v19, v19, v31
    v_cmp_eq_u32 vcc, -1, v19
    s_nop 0
    s_cbranch_vccnz g_39F3_1
    v_smfmac_f32_16x16x64_bf16 v[64:67], v[28:31], a[200:207], v172
    v_smfmac_f32_16x16x64_bf16 v[68:71], v[28:31], a[232:239], v172
    s_branch g_39L1_0
g_39L6_2:
    s_waitcnt vmcnt(1)
    v_max3_u32 v19, v32, v33, v34
    v_max_u32 v19, v19, v35
    v_cmp_eq_u32 vcc, -1, v19
    s_nop 0
    s_cbranch_vccnz g_39F6_2
    v_smfmac_f32_16x16x64_bf16 v[64:67], v[32:35], a[208:215], v172
    v_smfmac_f32_16x16x64_bf16 v[68:71], v[32:35], a[240:247], v172
    s_branch g_39L2_1
g_39L9_0:
    s_waitcnt vmcnt(1)
    v_max3_u32 v19, v24, v25, v26
    v_max_u32 v19, v19, v27
    v_cmp_eq_u32 vcc, -1, v19
    s_nop 0
    s_cbranch_vccnz g_39F9_0
    v_smfmac_f32_16x16x64_bf16 v[64:67], v[24:27], a[192:199], v172
    v_smfmac_f32_16x16x64_bf16 v[68:71], v[24:27], a[224:231], v172
    s_branch g_39L8_3
g_39L12_3:
    s_waitcnt vmcnt(1)
    v_max3_u32 v19, v36, v37, v38
    v_max_u32 v19, v19, v39
    v_cmp_eq_u32 vcc, -1, v19
    s_nop 0
    s_cbranch_vccnz g_39F12_3
    v_smfmac_f32_16x16x64_bf16 v[64:67], v[36:39], a[216:223], v172
    v_smfmac_f32_16x16x64_bf16 v[68:71], v[36:39], a[248:255], v172
    s_branch g_39L4_2
g_39F15_0:
    s_mov_b64 exec, vcc
    buffer_load_dwordx4 v[24:27], v8, s[4:7], s16 offen offset:0 sc1
    s_mov_b64 exec, -1
    s_add_u32 s23, s23, 1
    s_cmp_lt_u32 s23, 200000
    s_cbranch_scc1 g_39L15_1
    s_mov_b32 s25, 200000
    s_branch gc_40
g_39F15_1:
    s_mov_b64 exec, vcc
    buffer_load_dwordx4 v[28:31], v8, s[4:7], s16 offen offset:1024 sc1
    s_mov_b64 exec, -1
    s_add_u32 s23, s23, 1
    s_cmp_lt_u32 s23, 200000
    s_cbranch_scc1 g_39L15_2
    s_mov_b32 s25, 200000
    s_branch gc_40
g_39F15_2:
    s_mov_b64 exec, vcc
    buffer_load_dwordx4 v[32:35], v8, s[4:7], s16 offen offset:2048 sc1
    s_mov_b64 exec, -1
    s_add_u32 s23, s23, 1
    s_cmp_lt_u32 s23, 200000
    s_cbranch_scc1 g_39L15_3
    s_mov_b32 s25, 200000
    s_branch gc_40
g_39F15_3:
    s_mov_b64 exec, vcc
    buffer_load_dwordx4 v[36:39], v8, s[4:7], s16 offen offset:3072 sc1
    s_mov_b64 exec, -1
    s_add_u32 s23, s23, 1
    s_cmp_lt_u32 s23, 200000
    s_cbranch_scc1 g_39L15_0
    s_mov_b32 s25, 200000
    s_branch gc_40
g_39F7_0:
    s_mov_b64 exec, vcc
    buffer_load_dwordx4 v[24:27], v8, s[4:7], s16 offen offset:0 sc1
    s_mov_b64 exec, -1
    s_add_u32 s23, s23, 1
    s_cmp_lt_u32 s23, 200000
    s_cbranch_scc1 g_39L7_1
    s_mov_b32 s25, 200000
    s_branch gc_40
g_39F7_1:
    s_mov_b64 exec, vcc
    buffer_load_dwordx4 v[28:31], v8, s[4:7], s16 offen offset:1024 sc1
    s_mov_b64 exec, -1
    s_add_u32 s23, s23, 1
    s_cmp_lt_u32 s23, 200000
    s_cbranch_scc1 g_39L7_2
    s_mov_b32 s25, 200000
    s_branch gc_40
g_39F7_2:
    s_mov_b64 exec, vcc
    buffer_load_dwordx4 v[32:35], v8, s[4:7], s16 offen offset:2048 sc1
    s_mov_b64 exec, -1
    s_add_u32 s23, s23, 1
    s_cmp_lt_u32 s23, 200000
    s_cbranch_scc1 g_39L7_0
    s_mov_b32 s25, 200000
    s_branch gc_40
g_39F11_0:
    s_mov_b64 exec, vcc
    buffer_load_dwordx4 v[24:27], v8, s[4:7], s16 offen offset:0 sc1
    s_mov_b64 exec, -1
    s_add_u32 s23, s23, 1
    s_cmp_lt_u32 s23, 200000
    s_cbranch_scc1 g_39L11_1
    s_mov_b32 s25, 200000
    s_branch gc_40
g_39F11_1:
    s_mov_b64 exec, vcc
    buffer_load_dwordx4 v[28:31], v8, s[4:7], s16 offen offset:1024 sc1
    s_mov_b64 exec, -1
    s_add_u32 s23, s23, 1
    s_cmp_lt_u32 s23, 200000
    s_cbranch_scc1 g_39L11_3
    s_mov_b32 s25, 200000
    s_branch gc_40
g_39F11_3:
    s_mov_b64 exec, vcc
    buffer_load_dwordx4 v[36:39], v8, s[4:7], s16 offen offset:3072 sc1
    s_mov_b64 exec, -1
    s_add_u32 s23, s23, 1
    s_cmp_lt_u32 s23, 200000
    s_cbranch_scc1 g_39L11_0
    s_mov_b32 s25, 200000
    s_branch gc_40
g_39F13_0:
    s_mov_b64 exec, vcc
    buffer_load_dwordx4 v[24:27], v8, s[4:7], s16 offen offset:0 sc1
    s_mov_b64 exec, -1
    s_add_u32 s23, s23, 1
    s_cmp_lt_u32 s23, 200000
    s_cbranch_scc1 g_39L13_2
    s_mov_b32 s25, 200000
    s_branch gc_40
g_39F13_2:
    s_mov_b64 exec, vcc
    buffer_load_dwordx4 v[32:35], v8, s[4:7], s16 offen offset:2048 sc1
    s_mov_b64 exec, -1
    s_add_u32 s23, s23, 1
    s_cmp_lt_u32 s23, 200000
    s_cbranch_scc1 g_39L13_3
    s_mov_b32 s25, 200000
    s_branch gc_40
g_39F13_3:
    s_mov_b64 exec, vcc
    buffer_load_dwordx4 v[36:39], v8, s[4:7], s16 offen offset:3072 sc1
    s_mov_b64 exec, -1
    s_add_u32 s23, s23, 1
    s_cmp_lt_u32 s23, 200000
    s_cbranch_scc1 g_39L13_0
    s_mov_b32 s25, 200000
    s_branch gc_40
g_39F14_1:
    s_mov_b64 exec, vcc
    buffer_load_dwordx4 v[28:31], v8, s[4:7], s16 offen offset:1024 sc1
    s_mov_b64 exec, -1
    s_add_u32 s23, s23, 1
    s_cmp_lt_u32 s23, 200000
    s_cbranch_scc1 g_39L14_2
    s_mov_b32 s25, 200000
    s_branch gc_40
g_39F14_2:
    s_mov_b64 exec, vcc
    buffer_load_dwordx4 v[32:35], v8, s[4:7], s16 offen offset:2048 sc1
    s_mov_b64 exec, -1
    s_add_u32 s23, s23, 1
    s_cmp_lt_u32 s23, 200000
    s_cbranch_scc1 g_39L14_3
    s_mov_b32 s25, 200000
    s_branch gc_40
g_39F14_3:
    s_mov_b64 exec, vcc
    buffer_load_dwordx4 v[36:39], v8, s[4:7], s16 offen offset:3072 sc1
    s_mov_b64 exec, -1
    s_add_u32 s23, s23, 1
    s_cmp_lt_u32 s23, 200000
    s_cbranch_scc1 g_39L14_1
    s_mov_b32 s25, 200000
    s_branch gc_40
g_39F3_0:
    s_mov_b64 exec, vcc
    buffer_load_dwordx4 v[24:27], v8, s[4:7], s16 offen offset:0 sc1
    s_mov_b64 exec, -1
    s_add_u32 s23, s23, 1
    s_cmp_lt_u32 s23, 200000
    s_cbranch_scc1 g_39L3_1
    s_mov_b32 s25, 200000
    s_branch gc_40
g_39F3_1:
    s_mov_b64 exec, vcc
    buffer_load_dwordx4 v[28:31], v8, s[4:7], s16 offen offset:1024 sc1
    s_mov_b64 exec, -1
    s_add_u32 s23, s23, 1
    s_cmp_lt_u32 s23, 200000
    s_cbranch_scc1 g_39L3_0
    s_mov_b32 s25, 200000
    s_branch gc_40
g_39F5_0:
    s_mov_b64 exec, vcc
    buffer_load_dwordx4 v[24:27], v8, s[4:7], s16 offen offset:0 sc1
    s_mov_b64 exec, -1
    s_add_u32 s23, s23, 1
    s_cmp_lt_u32 s23, 200000
    s_cbranch_scc1 g_39L5_2
    s_mov_b32 s25, 200000
    s_branch gc_40
g_39F5_2:
    s_mov_b64 exec, vcc
    buffer_load_dwordx4 v[32:35], v8, s[4:7], s16 offen offset:2048 sc1
    s_mov_b64 exec, -1
    s_add_u32 s23, s23, 1
    s_cmp_lt_u32 s23, 200000
    s_cbranch_scc1 g_39L5_0
    s_mov_b32 s25, 200000
    s_branch gc_40
g_39F6_1:
    s_mov_b64 exec, vcc
    buffer_load_dwordx4 v[28:31], v8, s[4:7], s16 offen offset:1024 sc1
    s_mov_b64 exec, -1
    s_add_u32 s23, s23, 1
    s_cmp_lt_u32 s23, 200000
    s_cbranch_scc1 g_39L6_2
    s_mov_b32 s25, 200000
    s_branch gc_40
g_39F6_2:
    s_mov_b64 exec, vcc
    buffer_load_dwordx4 v[32:35], v8, s[4:7], s16 offen offset:2048 sc1
    s_mov_b64 exec, -1
    s_add_u32 s23, s23, 1
    s_cmp_lt_u32 s23, 200000
    s_cbranch_scc1 g_39L6_1
    s_mov_b32 s25, 200000
    s_branch gc_40
g_39F9_0:
    s_mov_b64 exec, vcc
    buffer_load_dwordx4 v[24:27], v8, s[4:7], s16 offen offset:0 sc1
    s_mov_b64 exec, -1
    s_add_u32 s23, s23, 1
    s_cmp_lt_u32 s23, 200000
    s_cbranch_scc1 g_39L9_3
    s_mov_b32 s25, 200000
    s_branch gc_40
g_39F9_3:
    s_mov_b64 exec, vcc
    buffer_load_dwordx4 v[36:39], v8, s[4:7], s16 offen offset:3072 sc1
    s_mov_b64 exec, -1
    s_add_u32 s23, s23, 1
    s_cmp_lt_u32 s23, 200000
    s_cbranch_scc1 g_39L9_0
    s_mov_b32 s25, 200000
    s_branch gc_40
g_39F10_1:
    s_mov_b64 exec, vcc
    buffer_load_dwordx4 v[28:31], v8, s[4:7], s16 offen offset:1024 sc1
    s_mov_b64 exec, -1
    s_add_u32 s23, s23, 1
    s_cmp_lt_u32 s23, 200000
    s_cbranch_scc1 g_39L10_3
    s_mov_b32 s25, 200000
    s_branch gc_40
g_39F10_3:
    s_mov_b64 exec, vcc
    buffer_load_dwordx4 v[36:39], v8, s[4:7], s16 offen offset:3072 sc1
    s_mov_b64 exec, -1
    s_add_u32 s23, s23, 1
    s_cmp_lt_u32 s23, 200000
    s_cbranch_scc1 g_39L10_1
    s_mov_b32 s25, 200000
    s_branch gc_40
g_39F12_2:
    s_mov_b64 exec, vcc
    buffer_load_dwordx4 v[32:35], v8, s[4:7], s16 offen offset:2048 sc1
    s_mov_b64 exec, -1
    s_add_u32 s23, s23, 1
    s_cmp_lt_u32 s23, 200000
    s_cbranch_scc1 g_39L12_3
    s_mov_b32 s25, 200000
    s_branch gc_40
g_39F12_3:
    s_mov_b64 exec, vcc
    buffer_load_dwordx4 v[36:39], v8, s[4:7], s16 offen offset:3072 sc1
    s_mov_b64 exec, -1
    s_add_u32 s23, s23, 1
    s_cmp_lt_u32 s23, 200000
    s_cbranch_scc1 g_39L12_2
    s_mov_b32 s25, 200000
    s_branch gc_40
g_39F1_0:
    s_mov_b64 exec, vcc
    buffer_load_dwordx4 v[24:27], v8, s[4:7], s16 offen offset:0 sc1
    s_mov_b64 exec, -1
    s_add_u32 s23, s23, 1
    s_cmp_lt_u32 s23, 200000
    s_cbranch_scc1 g_39L1_0
    s_mov_b32 s25, 200000
    s_branch gc_40
g_39F2_1:
    s_mov_b64 exec, vcc
    buffer_load_dwordx4 v[28:31], v8, s[4:7], s16 offen offset:1024 sc1
    s_mov_b64 exec, -1
    s_add_u32 s23, s23, 1
    s_cmp_lt_u32 s23, 200000
    s_cbranch_scc1 g_39L2_1
    s_mov_b32 s25, 200000
    s_branch gc_40
g_39F4_2:
    s_mov_b64 exec, vcc
    buffer_load_dwordx4 v[32:35], v8, s[4:7], s16 offen offset:2048 sc1
    s_mov_b64 exec, -1
    s_add_u32 s23, s23, 1
    s_cmp_lt_u32 s23, 200000
    s_cbranch_scc1 g_39L4_2
    s_mov_b32 s25, 200000
    s_branch gc_40
g_39F8_3:
    s_mov_b64 exec, vcc
    buffer_load_dwordx4 v[36:39], v8, s[4:7], s16 offen offset:3072 sc1
    s_mov_b64 exec, -1
    s_add_u32 s23, s23, 1
    s_cmp_lt_u32 s23, 200000
    s_cbranch_scc1 g_39L8_3
    s_mov_b32 s25, 200000
    s_branch gc_40
.p2align 6
recur_fast_w2:
    s_nop 15
    s_mov_b32 s23, s25
    buffer_load_dwordx4 v[24:27], v2, s[4:7], s16 offen offset:0 sc1
    s_nop 11
    buffer_load_dwordx4 v[28:31], v2, s[4:7], s16 offen offset:1024 sc1
    s_nop 11
    buffer_load_dwordx4 v[32:35], v2, s[4:7], s16 offen offset:2048 sc1
    s_nop 11
    buffer_load_dwordx4 v[36:39], v2, s[4:7], s16 offen offset:3072 sc1
    s_waitcnt vmcnt(3)
    v_max3_u32 v19, v24, v25, v26
    v_max_u32 v19, v19, v27
    v_cmp_eq_u32 vcc, -1, v19
    s_nop 0
    s_cbranch_vccnz g_43F15_0
    v_smfmac_f32_16x16x64_bf16 v[40:43], v[24:27], a[0:7], v172
    s_waitcnt vmcnt(2)
    v_max3_u32 v19, v28, v29, v30
    v_max_u32 v19, v19, v31
    v_smfmac_f32_16x16x64_bf16 v[44:47], v[24:27], a[64:71], v172
    v_cmp_eq_u32 vcc, -1, v19
    v_smfmac_f32_16x16x64_bf16 v[48:51], v[24:27], a[32:39], v172
    v_smfmac_f32_16x16x64_bf16 v[52:55], v[24:27], a[96:103], v172
    s_cbranch_vccnz g_43F14_1
    v_smfmac_f32_16x16x64_bf16 v[40:43], v[28:31], a[8:15], v172
    s_waitcnt vmcnt(1)
    v_max3_u32 v19, v32, v33, v34
    v_max_u32 v19, v19, v35
    v_smfmac_f32_16x16x64_bf16 v[44:47], v[28:31], a[72:79], v172
    v_cmp_eq_u32 vcc, -1, v19
    v_smfmac_f32_16x16x64_bf16 v[48:51], v[28:31], a[40:47], v172
    v_smfmac_f32_16x16x64_bf16 v[52:55], v[28:31], a[104:111], v172
    s_cbranch_vccnz g_43F12_2
    v_smfmac_f32_16x16x64_bf16 v[40:43], v[32:35], a[16:23], v172
    s_waitcnt vmcnt(0)
    v_max3_u32 v19, v36, v37, v38
    v_max_u32 v19, v19, v39
    v_smfmac_f32_16x16x64_bf16 v[44:47], v[32:35], a[80:87], v172
    v_cmp_eq_u32 vcc, -1, v19
    v_smfmac_f32_16x16x64_bf16 v[48:51], v[32:35], a[48:55], v172
    v_smfmac_f32_16x16x64_bf16 v[52:55], v[32:35], a[112:119], v172
    s_cbranch_vccnz g_43F8_3
    v_smfmac_f32_16x16x64_bf16 v[40:43], v[36:39], a[24:31], v172
    v_smfmac_f32_16x16x64_bf16 v[44:47], v[36:39], a[88:95], v172
    v_smfmac_f32_16x16x64_bf16 v[48:51], v[36:39], a[56:63], v172
    v_smfmac_f32_16x16x64_bf16 v[52:55], v[36:39], a[120:127], v172
gc_44:
    v_cvt_pk_bf16_f32 v72, v40, v41
    v_cvt_pk_bf16_f32 v73, v42, v43
    v_cvt_pk_bf16_f32 v74, v44, v45
    v_cvt_pk_bf16_f32 v75, v46, v47
    ds_write_b128 v17, v[72:75] offset:0
    v_cvt_pk_bf16_f32 v76, v48, v49
    v_cvt_pk_bf16_f32 v77, v50, v51
    s_nop 0
    v_cvt_pk_bf16_f32 v78, v52, v53
    v_cvt_pk_bf16_f32 v79, v54, v55
    ds_write_b128 v17, v[76:79] offset:1024
    v_smfmac_f32_16x16x64_bf16 v[56:59], v[24:27], a[128:135], v172
    v_smfmac_f32_16x16x64_bf16 v[60:63], v[24:27], a[160:167], v172
    v_smfmac_f32_16x16x64_bf16 v[56:59], v[28:31], a[136:143], v172
    s_waitcnt lgkmcnt(0)
    s_barrier
    v_smfmac_f32_16x16x64_bf16 v[60:63], v[28:31], a[168:175], v172
    v_smfmac_f32_16x16x64_bf16 v[56:59], v[32:35], a[144:151], v172
    v_smfmac_f32_16x16x64_bf16 v[60:63], v[32:35], a[176:183], v172
    v_smfmac_f32_16x16x64_bf16 v[56:59], v[36:39], a[152:159], v172
    v_smfmac_f32_16x16x64_bf16 v[60:63], v[36:39], a[184:191], v172
    s_nop 4
    v_cvt_pk_bf16_f32 v80, v56, v57
    v_cvt_pk_bf16_f32 v81, v58, v59
    s_nop 0
    v_cvt_pk_bf16_f32 v82, v60, v61
    v_cvt_pk_bf16_f32 v83, v62, v63
    ds_write_b128 v17, v[80:83] offset:8192
    s_cmp_eq_u32 s15, 63
    s_waitcnt lgkmcnt(0)
    s_barrier
    ds_read_b128 v[96:99], v16 offset:8192
    ds_read_b128 v[100:103], v16 offset:10240
    ds_read_b128 v[108:111], v16 offset:14336
    v_mfma_f32_16x16x32_bf16 v[140:143], v[84:87], v[80:83], 0
    s_waitcnt lgkmcnt(2)
    v_mfma_f32_16x16x32_bf16 v[140:143], v[84:87], v[96:99], v[140:143]
    s_waitcnt lgkmcnt(1)
    v_mfma_f32_16x16x32_bf16 v[140:143], v[84:87], v[100:103], v[140:143]
    s_waitcnt lgkmcnt(0)
    v_mfma_f32_16x16x32_bf16 v[140:143], v[84:87], v[108:111], v[140:143]
    s_nop 7
    v_cvt_pk_bf16_f32 v168, v140, v141
    v_cvt_pk_bf16_f32 v169, v142, v143
    v_mov_b32 v170, v168
    v_mov_b32 v171, v169
    s_nop 0
    v_permlane16_swap_b32 v168, v170
    v_permlane16_swap_b32 v169, v171
    v_mov_b32 v247, s15
    s_cbranch_scc1 recur_fast_last2
    s_barrier
    s_nop 15
    s_mov_b32 s23, s25
    buffer_load_dwordx4 v[24:27], v8, s[4:7], s16 offen offset:0 sc1
    s_nop 11
    buffer_load_dwordx4 v[28:31], v8, s[4:7], s16 offen offset:1024 sc1
    s_nop 11
    buffer_load_dwordx4 v[32:35], v8, s[4:7], s16 offen offset:2048 sc1
    s_nop 11
    buffer_load_dwordx4 v[36:39], v8, s[4:7], s16 offen offset:3072 sc1
    s_waitcnt vmcnt(3)
    v_max3_u32 v19, v24, v25, v26
    v_max_u32 v19, v19, v27
    v_cmp_eq_u32 vcc, -1, v19
    s_nop 0
    s_cbranch_vccnz g_45F15_0
    v_smfmac_f32_16x16x64_bf16 v[64:67], v[24:27], a[192:199], v172
    v_smfmac_f32_16x16x64_bf16 v[68:71], v[24:27], a[224:231], v172
    s_waitcnt vmcnt(2)
    v_max3_u32 v19, v28, v29, v30
    v_max_u32 v19, v19, v31
    v_cmp_eq_u32 vcc, -1, v19
    s_nop 0
    s_cbranch_vccnz g_45F14_1
    v_smfmac_f32_16x16x64_bf16 v[64:67], v[28:31], a[200:207], v172
    v_smfmac_f32_16x16x64_bf16 v[68:71], v[28:31], a[232:239], v172
    s_waitcnt vmcnt(1)
    v_max3_u32 v19, v32, v33, v34
    v_max_u32 v19, v19, v35
    v_cmp_eq_u32 vcc, -1, v19
    s_nop 0
    s_cbranch_vccnz g_45F12_2
    v_smfmac_f32_16x16x64_bf16 v[64:67], v[32:35], a[208:215], v172
    v_smfmac_f32_16x16x64_bf16 v[68:71], v[32:35], a[240:247], v172
    s_waitcnt vmcnt(0)
    v_max3_u32 v19, v36, v37, v38
    v_max_u32 v19, v19, v39
    v_cmp_eq_u32 vcc, -1, v19
    s_nop 0
    s_cbranch_vccnz g_45F8_3
    v_smfmac_f32_16x16x64_bf16 v[64:67], v[36:39], a[216:223], v172
    v_smfmac_f32_16x16x64_bf16 v[68:71], v[36:39], a[248:255], v172
    s_nop 4
    v_cvt_pk_bf16_f32 v80, v64, v65
    v_cvt_pk_bf16_f32 v81, v66, v67
    s_nop 0
    v_cvt_pk_bf16_f32 v82, v68, v69
    v_cvt_pk_bf16_f32 v83, v70, v71
    ds_write_b128 v17, v[80:83] offset:9216
gc_46:
    s_waitcnt lgkmcnt(0)
    s_barrier
    s_nop 15
    s_nop 15
    s_nop 15
    s_nop 15
    buffer_store_dwordx4 v[168:171], v15, s[4:7], s20 offen sc1
    s_add_u32 s20, s20, 512
    s_add_u32 s21, s95, 1048576
    s_lshr_b32 s22, s21, 8
    s_and_b32 s22, s22, 8192
    s_xor_b32 s22, s22, s46
    s_add_u32 s21, s21, s22
    buffer_store_dwordx4 v[204:207], v9, s[4:7], s21 offen sc1
    s_add_u32 s21, s21, 262144
    buffer_store_dword v247, v246, s[4:7], 0 offen sc1
    v_mov_b32 v40, 0
    v_mov_b32 v41, 0
    v_mov_b32 v42, 0
    v_mov_b32 v43, 0
    v_mov_b32 v44, 0
    v_mov_b32 v45, 0
    v_mov_b32 v46, 0
    v_mov_b32 v47, 0
    v_mov_b32 v48, 0
    v_mov_b32 v49, 0
    v_mov_b32 v50, 0
    v_mov_b32 v51, 0
    v_mov_b32 v52, 0
    v_mov_b32 v53, 0
    v_mov_b32 v54, 0
    v_mov_b32 v55, 0
    v_mov_b32 v56, 0
    v_mov_b32 v57, 0
    v_mov_b32 v58, 0
    v_mov_b32 v59, 0
    v_mov_b32 v60, 0
    v_mov_b32 v61, 0
    v_mov_b32 v62, 0
    v_mov_b32 v63, 0
    v_mov_b32 v64, 0
    v_mov_b32 v65, 0
    v_mov_b32 v66, 0
    v_mov_b32 v67, 0
    v_mov_b32 v68, 0
    v_mov_b32 v69, 0
    v_mov_b32 v70, 0
    v_mov_b32 v71, 0
    s_mov_b32 s21, s16
    s_mov_b32 s16, s42
    s_mov_b32 s42, s43
    s_mov_b32 s43, s44
    s_mov_b32 s44, s21
    s_add_u32 s95, s95, 524288
    s_lshr_b32 s84, s95, 8
    s_and_b32 s84, s84, 8192
    s_xor_b32 s84, s84, s46
    s_add_u32 s84, s84, s95
    s_add_u32 s15, s15, 1
    s_barrier
    s_branch recur_fast_w2
g_43L15_0:
    s_waitcnt vmcnt(3)
    v_max3_u32 v19, v24, v25, v26
    v_max_u32 v19, v19, v27
    v_cmp_eq_u32 vcc, -1, v19
    s_nop 0
    s_cbranch_vccnz g_43F15_0
    v_smfmac_f32_16x16x64_bf16 v[40:43], v[24:27], a[0:7], v172
    v_smfmac_f32_16x16x64_bf16 v[44:47], v[24:27], a[64:71], v172
    v_smfmac_f32_16x16x64_bf16 v[48:51], v[24:27], a[32:39], v172
    v_smfmac_f32_16x16x64_bf16 v[52:55], v[24:27], a[96:103], v172
g_43L14_1:
    s_waitcnt vmcnt(2)
    v_max3_u32 v19, v28, v29, v30
    v_max_u32 v19, v19, v31
    v_cmp_eq_u32 vcc, -1, v19
    s_nop 0
    s_cbranch_vccnz g_43F14_1
    v_smfmac_f32_16x16x64_bf16 v[40:43], v[28:31], a[8:15], v172
    v_smfmac_f32_16x16x64_bf16 v[44:47], v[28:31], a[72:79], v172
    v_smfmac_f32_16x16x64_bf16 v[48:51], v[28:31], a[40:47], v172
    v_smfmac_f32_16x16x64_bf16 v[52:55], v[28:31], a[104:111], v172
g_43L12_2:
    s_waitcnt vmcnt(1)
    v_max3_u32 v19, v32, v33, v34
    v_max_u32 v19, v19, v35
    v_cmp_eq_u32 vcc, -1, v19
    s_nop 0
    s_cbranch_vccnz g_43F12_2
    v_smfmac_f32_16x16x64_bf16 v[40:43], v[32:35], a[16:23], v172
    v_smfmac_f32_16x16x64_bf16 v[44:47], v[32:35], a[80:87], v172
    v_smfmac_f32_16x16x64_bf16 v[48:51], v[32:35], a[48:55], v172
    v_smfmac_f32_16x16x64_bf16 v[52:55], v[32:35], a[112:119], v172
g_43L8_3:
    s_waitcnt vmcnt(0)
    v_max3_u32 v19, v36, v37, v38
    v_max_u32 v19, v19, v39
    v_cmp_eq_u32 vcc, -1, v19
    s_nop 0
    s_cbranch_vccnz g_43F8_3
    v_smfmac_f32_16x16x64_bf16 v[40:43], v[36:39], a[24:31], v172
    v_smfmac_f32_16x16x64_bf16 v[44:47], v[36:39], a[88:95], v172
    v_smfmac_f32_16x16x64_bf16 v[48:51], v[36:39], a[56:63], v172
    v_smfmac_f32_16x16x64_bf16 v[52:55], v[36:39], a[120:127], v172
    s_branch gc_44
g_43L15_1:
    s_waitcnt vmcnt(3)
    v_max3_u32 v19, v28, v29, v30
    v_max_u32 v19, v19, v31
    v_cmp_eq_u32 vcc, -1, v19
    s_nop 0
    s_cbranch_vccnz g_43F15_1
    v_smfmac_f32_16x16x64_bf16 v[40:43], v[28:31], a[8:15], v172
    v_smfmac_f32_16x16x64_bf16 v[44:47], v[28:31], a[72:79], v172
    v_smfmac_f32_16x16x64_bf16 v[48:51], v[28:31], a[40:47], v172
    v_smfmac_f32_16x16x64_bf16 v[52:55], v[28:31], a[104:111], v172
g_43L13_2:
    s_waitcnt vmcnt(2)
    v_max3_u32 v19, v32, v33, v34
    v_max_u32 v19, v19, v35
    v_cmp_eq_u32 vcc, -1, v19
    s_nop 0
    s_cbranch_vccnz g_43F13_2
    v_smfmac_f32_16x16x64_bf16 v[40:43], v[32:35], a[16:23], v172
    v_smfmac_f32_16x16x64_bf16 v[44:47], v[32:35], a[80:87], v172
    v_smfmac_f32_16x16x64_bf16 v[48:51], v[32:35], a[48:55], v172
    v_smfmac_f32_16x16x64_bf16 v[52:55], v[32:35], a[112:119], v172
g_43L9_3:
    s_waitcnt vmcnt(1)
    v_max3_u32 v19, v36, v37, v38
    v_max_u32 v19, v19, v39
    v_cmp_eq_u32 vcc, -1, v19
    s_nop 0
    s_cbranch_vccnz g_43F9_3
    v_smfmac_f32_16x16x64_bf16 v[40:43], v[36:39], a[24:31], v172
    v_smfmac_f32_16x16x64_bf16 v[44:47], v[36:39], a[88:95], v172
    v_smfmac_f32_16x16x64_bf16 v[48:51], v[36:39], a[56:63], v172
    v_smfmac_f32_16x16x64_bf16 v[52:55], v[36:39], a[120:127], v172
g_43L1_0:
    s_waitcnt vmcnt(0)
    v_max3_u32 v19, v24, v25, v26
    v_max_u32 v19, v19, v27
    v_cmp_eq_u32 vcc, -1, v19
    s_nop 0
    s_cbranch_vccnz g_43F1_0
    v_smfmac_f32_16x16x64_bf16 v[40:43], v[24:27], a[0:7], v172
    v_smfmac_f32_16x16x64_bf16 v[44:47], v[24:27], a[64:71], v172
    v_smfmac_f32_16x16x64_bf16 v[48:51], v[24:27], a[32:39], v172
    v_smfmac_f32_16x16x64_bf16 v[52:55], v[24:27], a[96:103], v172
    s_branch gc_44
g_43L15_2:
    s_waitcnt vmcnt(3)
    v_max3_u32 v19, v32, v33, v34
    v_max_u32 v19, v19, v35
    v_cmp_eq_u32 vcc, -1, v19
    s_nop 0
    s_cbranch_vccnz g_43F15_2
    v_smfmac_f32_16x16x64_bf16 v[40:43], v[32:35], a[16:23], v172
    v_smfmac_f32_16x16x64_bf16 v[44:47], v[32:35], a[80:87], v172
    v_smfmac_f32_16x16x64_bf16 v[48:51], v[32:35], a[48:55], v172
    v_smfmac_f32_16x16x64_bf16 v[52:55], v[32:35], a[112:119], v172
g_43L11_3:
    s_waitcnt vmcnt(2)
    v_max3_u32 v19, v36, v37, v38
    v_max_u32 v19, v19, v39
    v_cmp_eq_u32 vcc, -1, v19
    s_nop 0
    s_cbranch_vccnz g_43F11_3
    v_smfmac_f32_16x16x64_bf16 v[40:43], v[36:39], a[24:31], v172
    v_smfmac_f32_16x16x64_bf16 v[44:47], v[36:39], a[88:95], v172
    v_smfmac_f32_16x16x64_bf16 v[48:51], v[36:39], a[56:63], v172
    v_smfmac_f32_16x16x64_bf16 v[52:55], v[36:39], a[120:127], v172
g_43L3_0:
    s_waitcnt vmcnt(1)
    v_max3_u32 v19, v24, v25, v26
    v_max_u32 v19, v19, v27
    v_cmp_eq_u32 vcc, -1, v19
    s_nop 0
    s_cbranch_vccnz g_43F3_0
    v_smfmac_f32_16x16x64_bf16 v[40:43], v[24:27], a[0:7], v172
    v_smfmac_f32_16x16x64_bf16 v[44:47], v[24:27], a[64:71], v172
    v_smfmac_f32_16x16x64_bf16 v[48:51], v[24:27], a[32:39], v172
    v_smfmac_f32_16x16x64_bf16 v[52:55], v[24:27], a[96:103], v172
g_43L2_1:
    s_waitcnt vmcnt(0)
    v_max3_u32 v19, v28, v29, v30
    v_max_u32 v19, v19, v31
    v_cmp_eq_u32 vcc, -1, v19
    s_nop 0
    s_cbranch_vccnz g_43F2_1
    v_smfmac_f32_16x16x64_bf16 v[40:43], v[28:31], a[8:15], v172
    v_smfmac_f32_16x16x64_bf16 v[44:47], v[28:31], a[72:79], v172
    v_smfmac_f32_16x16x64_bf16 v[48:51], v[28:31], a[40:47], v172
    v_smfmac_f32_16x16x64_bf16 v[52:55], v[28:31], a[104:111], v172
    s_branch gc_44
g_43L15_3:
    s_waitcnt vmcnt(3)
    v_max3_u32 v19, v36, v37, v38
    v_max_u32 v19, v19, v39
    v_cmp_eq_u32 vcc, -1, v19
    s_nop 0
    s_cbranch_vccnz g_43F15_3
    v_smfmac_f32_16x16x64_bf16 v[40:43], v[36:39], a[24:31], v172
    v_smfmac_f32_16x16x64_bf16 v[44:47], v[36:39], a[88:95], v172
    v_smfmac_f32_16x16x64_bf16 v[48:51], v[36:39], a[56:63], v172
    v_smfmac_f32_16x16x64_bf16 v[52:55], v[36:39], a[120:127], v172
g_43L7_0:
    s_waitcnt vmcnt(2)
    v_max3_u32 v19, v24, v25, v26
    v_max_u32 v19, v19, v27
    v_cmp_eq_u32 vcc, -1, v19
    s_nop 0
    s_cbranch_vccnz g_43F7_0
    v_smfmac_f32_16x16x64_bf16 v[40:43], v[24:27], a[0:7], v172
    v_smfmac_f32_16x16x64_bf16 v[44:47], v[24:27], a[64:71], v172
    v_smfmac_f32_16x16x64_bf16 v[48:51], v[24:27], a[32:39], v172
    v_smfmac_f32_16x16x64_bf16 v[52:55], v[24:27], a[96:103], v172
g_43L6_1:
    s_waitcnt vmcnt(1)
    v_max3_u32 v19, v28, v29, v30
    v_max_u32 v19, v19, v31
    v_cmp_eq_u32 vcc, -1, v19
    s_nop 0
    s_cbranch_vccnz g_43F6_1
    v_smfmac_f32_16x16x64_bf16 v[40:43], v[28:31], a[8:15], v172
    v_smfmac_f32_16x16x64_bf16 v[44:47], v[28:31], a[72:79], v172
    v_smfmac_f32_16x16x64_bf16 v[48:51], v[28:31], a[40:47], v172
    v_smfmac_f32_16x16x64_bf16 v[52:55], v[28:31], a[104:111], v172
g_43L4_2:
    s_waitcnt vmcnt(0)
    v_max3_u32 v19, v32, v33, v34
    v_max_u32 v19, v19, v35
    v_cmp_eq_u32 vcc, -1, v19
    s_nop 0
    s_cbranch_vccnz g_43F4_2
    v_smfmac_f32_16x16x64_bf16 v[40:43], v[32:35], a[16:23], v172
    v_smfmac_f32_16x16x64_bf16 v[44:47], v[32:35], a[80:87], v172
    v_smfmac_f32_16x16x64_bf16 v[48:51], v[32:35], a[48:55], v172
    v_smfmac_f32_16x16x64_bf16 v[52:55], v[32:35], a[112:119], v172
    s_branch gc_44
g_43L7_1:
    s_waitcnt vmcnt(2)
    v_max3_u32 v19, v28, v29, v30
    v_max_u32 v19, v19, v31
    v_cmp_eq_u32 vcc, -1, v19
    s_nop 0
    s_cbranch_vccnz g_43F7_1
    v_smfmac_f32_16x16x64_bf16 v[40:43], v[28:31], a[8:15], v172
    v_smfmac_f32_16x16x64_bf16 v[44:47], v[28:31], a[72:79], v172
    v_smfmac_f32_16x16x64_bf16 v[48:51], v[28:31], a[40:47], v172
    v_smfmac_f32_16x16x64_bf16 v[52:55], v[28:31], a[104:111], v172
g_43L5_2:
    s_waitcnt vmcnt(1)
    v_max3_u32 v19, v32, v33, v34
    v_max_u32 v19, v19, v35
    v_cmp_eq_u32 vcc, -1, v19
    s_nop 0
    s_cbranch_vccnz g_43F5_2
    v_smfmac_f32_16x16x64_bf16 v[40:43], v[32:35], a[16:23], v172
    v_smfmac_f32_16x16x64_bf16 v[44:47], v[32:35], a[80:87], v172
    v_smfmac_f32_16x16x64_bf16 v[48:51], v[32:35], a[48:55], v172
    v_smfmac_f32_16x16x64_bf16 v[52:55], v[32:35], a[112:119], v172
    s_branch g_43L1_0
g_43L7_2:
    s_waitcnt vmcnt(2)
    v_max3_u32 v19, v32, v33, v34
    v_max_u32 v19, v19, v35
    v_cmp_eq_u32 vcc, -1, v19
    s_nop 0
    s_cbranch_vccnz g_43F7_2
    v_smfmac_f32_16x16x64_bf16 v[40:43], v[32:35], a[16:23], v172
    v_smfmac_f32_16x16x64_bf16 v[44:47], v[32:35], a[80:87], v172
    v_smfmac_f32_16x16x64_bf16 v[48:51], v[32:35], a[48:55], v172
    v_smfmac_f32_16x16x64_bf16 v[52:55], v[32:35], a[112:119], v172
    s_branch g_43L3_0
g_43L11_0:
    s_waitcnt vmcnt(2)
    v_max3_u32 v19, v24, v25, v26
    v_max_u32 v19, v19, v27
    v_cmp_eq_u32 vcc, -1, v19
    s_nop 0
    s_cbranch_vccnz g_43F11_0
    v_smfmac_f32_16x16x64_bf16 v[40:43], v[24:27], a[0:7], v172
    v_smfmac_f32_16x16x64_bf16 v[44:47], v[24:27], a[64:71], v172
    v_smfmac_f32_16x16x64_bf16 v[48:51], v[24:27], a[32:39], v172
    v_smfmac_f32_16x16x64_bf16 v[52:55], v[24:27], a[96:103], v172
g_43L10_1:
    s_waitcnt vmcnt(1)
    v_max3_u32 v19, v28, v29, v30
    v_max_u32 v19, v19, v31
    v_cmp_eq_u32 vcc, -1, v19
    s_nop 0
    s_cbranch_vccnz g_43F10_1
    v_smfmac_f32_16x16x64_bf16 v[40:43], v[28:31], a[8:15], v172
    v_smfmac_f32_16x16x64_bf16 v[44:47], v[28:31], a[72:79], v172
    v_smfmac_f32_16x16x64_bf16 v[48:51], v[28:31], a[40:47], v172
    v_smfmac_f32_16x16x64_bf16 v[52:55], v[28:31], a[104:111], v172
    s_branch g_43L8_3
g_43L11_1:
    s_waitcnt vmcnt(2)
    v_max3_u32 v19, v28, v29, v30
    v_max_u32 v19, v19, v31
    v_cmp_eq_u32 vcc, -1, v19
    s_nop 0
    s_cbranch_vccnz g_43F11_1
    v_smfmac_f32_16x16x64_bf16 v[40:43], v[28:31], a[8:15], v172
    v_smfmac_f32_16x16x64_bf16 v[44:47], v[28:31], a[72:79], v172
    v_smfmac_f32_16x16x64_bf16 v[48:51], v[28:31], a[40:47], v172
    v_smfmac_f32_16x16x64_bf16 v[52:55], v[28:31], a[104:111], v172
    s_branch g_43L9_3
g_43L13_0:
    s_waitcnt vmcnt(2)
    v_max3_u32 v19, v24, v25, v26
    v_max_u32 v19, v19, v27
    v_cmp_eq_u32 vcc, -1, v19
    s_nop 0
    s_cbranch_vccnz g_43F13_0
    v_smfmac_f32_16x16x64_bf16 v[40:43], v[24:27], a[0:7], v172
    v_smfmac_f32_16x16x64_bf16 v[44:47], v[24:27], a[64:71], v172
    v_smfmac_f32_16x16x64_bf16 v[48:51], v[24:27], a[32:39], v172
    v_smfmac_f32_16x16x64_bf16 v[52:55], v[24:27], a[96:103], v172
    s_branch g_43L12_2
g_43L13_3:
    s_waitcnt vmcnt(2)
    v_max3_u32 v19, v36, v37, v38
    v_max_u32 v19, v19, v39
    v_cmp_eq_u32 vcc, -1, v19
    s_nop 0
    s_cbranch_vccnz g_43F13_3
    v_smfmac_f32_16x16x64_bf16 v[40:43], v[36:39], a[24:31], v172
    v_smfmac_f32_16x16x64_bf16 v[44:47], v[36:39], a[88:95], v172
    v_smfmac_f32_16x16x64_bf16 v[48:51], v[36:39], a[56:63], v172
    v_smfmac_f32_16x16x64_bf16 v[52:55], v[36:39], a[120:127], v172
g_43L5_0:
    s_waitcnt vmcnt(1)
    v_max3_u32 v19, v24, v25, v26
    v_max_u32 v19, v19, v27
    v_cmp_eq_u32 vcc, -1, v19
    s_nop 0
    s_cbranch_vccnz g_43F5_0
    v_smfmac_f32_16x16x64_bf16 v[40:43], v[24:27], a[0:7], v172
    v_smfmac_f32_16x16x64_bf16 v[44:47], v[24:27], a[64:71], v172
    v_smfmac_f32_16x16x64_bf16 v[48:51], v[24:27], a[32:39], v172
    v_smfmac_f32_16x16x64_bf16 v[52:55], v[24:27], a[96:103], v172
    s_branch g_43L4_2
g_43L14_2:
    s_waitcnt vmcnt(2)
    v_max3_u32 v19, v32, v33, v34
    v_max_u32 v19, v19, v35
    v_cmp_eq_u32 vcc, -1, v19
    s_nop 0
    s_cbranch_vccnz g_43F14_2
    v_smfmac_f32_16x16x64_bf16 v[40:43], v[32:35], a[16:23], v172
    v_smfmac_f32_16x16x64_bf16 v[44:47], v[32:35], a[80:87], v172
    v_smfmac_f32_16x16x64_bf16 v[48:51], v[32:35], a[48:55], v172
    v_smfmac_f32_16x16x64_bf16 v[52:55], v[32:35], a[112:119], v172
g_43L10_3:
    s_waitcnt vmcnt(1)
    v_max3_u32 v19, v36, v37, v38
    v_max_u32 v19, v19, v39
    v_cmp_eq_u32 vcc, -1, v19
    s_nop 0
    s_cbranch_vccnz g_43F10_3
    v_smfmac_f32_16x16x64_bf16 v[40:43], v[36:39], a[24:31], v172
    v_smfmac_f32_16x16x64_bf16 v[44:47], v[36:39], a[88:95], v172
    v_smfmac_f32_16x16x64_bf16 v[48:51], v[36:39], a[56:63], v172
    v_smfmac_f32_16x16x64_bf16 v[52:55], v[36:39], a[120:127], v172
    s_branch g_43L2_1
g_43L14_3:
    s_waitcnt vmcnt(2)
    v_max3_u32 v19, v36, v37, v38
    v_max_u32 v19, v19, v39
    v_cmp_eq_u32 vcc, -1, v19
    s_nop 0
    s_cbranch_vccnz g_43F14_3
    v_smfmac_f32_16x16x64_bf16 v[40:43], v[36:39], a[24:31], v172
    v_smfmac_f32_16x16x64_bf16 v[44:47], v[36:39], a[88:95], v172
    v_smfmac_f32_16x16x64_bf16 v[48:51], v[36:39], a[56:63], v172
    v_smfmac_f32_16x16x64_bf16 v[52:55], v[36:39], a[120:127], v172
    s_branch g_43L6_1
g_43L3_1:
    s_waitcnt vmcnt(1)
    v_max3_u32 v19, v28, v29, v30
    v_max_u32 v19, v19, v31
    v_cmp_eq_u32 vcc, -1, v19
    s_nop 0
    s_cbranch_vccnz g_43F3_1
    v_smfmac_f32_16x16x64_bf16 v[40:43], v[28:31], a[8:15], v172
    v_smfmac_f32_16x16x64_bf16 v[44:47], v[28:31], a[72:79], v172
    v_smfmac_f32_16x16x64_bf16 v[48:51], v[28:31], a[40:47], v172
    v_smfmac_f32_16x16x64_bf16 v[52:55], v[28:31], a[104:111], v172
    s_branch g_43L1_0
g_43L6_2:
    s_waitcnt vmcnt(1)
    v_max3_u32 v19, v32, v33, v34
    v_max_u32 v19, v19, v35
    v_cmp_eq_u32 vcc, -1, v19
    s_nop 0
    s_cbranch_vccnz g_43F6_2
    v_smfmac_f32_16x16x64_bf16 v[40:43], v[32:35], a[16:23], v172
    v_smfmac_f32_16x16x64_bf16 v[44:47], v[32:35], a[80:87], v172
    v_smfmac_f32_16x16x64_bf16 v[48:51], v[32:35], a[48:55], v172
    v_smfmac_f32_16x16x64_bf16 v[52:55], v[32:35], a[112:119], v172
    s_branch g_43L2_1
g_43L9_0:
    s_waitcnt vmcnt(1)
    v_max3_u32 v19, v24, v25, v26
    v_max_u32 v19, v19, v27
    v_cmp_eq_u32 vcc, -1, v19
    s_nop 0
    s_cbranch_vccnz g_43F9_0
    v_smfmac_f32_16x16x64_bf16 v[40:43], v[24:27], a[0:7], v172
    v_smfmac_f32_16x16x64_bf16 v[44:47], v[24:27], a[64:71], v172
    v_smfmac_f32_16x16x64_bf16 v[48:51], v[24:27], a[32:39], v172
    v_smfmac_f32_16x16x64_bf16 v[52:55], v[24:27], a[96:103], v172
    s_branch g_43L8_3
g_43L12_3:
    s_waitcnt vmcnt(1)
    v_max3_u32 v19, v36, v37, v38
    v_max_u32 v19, v19, v39
    v_cmp_eq_u32 vcc, -1, v19
    s_nop 0
    s_cbranch_vccnz g_43F12_3
    v_smfmac_f32_16x16x64_bf16 v[40:43], v[36:39], a[24:31], v172
    v_smfmac_f32_16x16x64_bf16 v[44:47], v[36:39], a[88:95], v172
    v_smfmac_f32_16x16x64_bf16 v[48:51], v[36:39], a[56:63], v172
    v_smfmac_f32_16x16x64_bf16 v[52:55], v[36:39], a[120:127], v172
    s_branch g_43L4_2
g_43F15_0:
    s_mov_b64 exec, vcc
    buffer_load_dwordx4 v[24:27], v2, s[4:7], s16 offen offset:0 sc1
    s_mov_b64 exec, -1
    s_add_u32 s23, s23, 1
    s_cmp_lt_u32 s23, 200000
    s_cbranch_scc1 g_43L15_1
    s_mov_b32 s25, 200000
    s_branch gc_44
g_43F15_1:
    s_mov_b64 exec, vcc
    buffer_load_dwordx4 v[28:31], v2, s[4:7], s16 offen offset:1024 sc1
    s_mov_b64 exec, -1
    s_add_u32 s23, s23, 1
    s_cmp_lt_u32 s23, 200000
    s_cbranch_scc1 g_43L15_2
    s_mov_b32 s25, 200000
    s_branch gc_44
g_43F15_2:
    s_mov_b64 exec, vcc
    buffer_load_dwordx4 v[32:35], v2, s[4:7], s16 offen offset:2048 sc1
    s_mov_b64 exec, -1
    s_add_u32 s23, s23, 1
    s_cmp_lt_u32 s23, 200000
    s_cbranch_scc1 g_43L15_3
    s_mov_b32 s25, 200000
    s_branch gc_44
g_43F15_3:
    s_mov_b64 exec, vcc
    buffer_load_dwordx4 v[36:39], v2, s[4:7], s16 offen offset:3072 sc1
    s_mov_b64 exec, -1
    s_add_u32 s23, s23, 1
    s_cmp_lt_u32 s23, 200000
    s_cbranch_scc1 g_43L15_0
    s_mov_b32 s25, 200000
    s_branch gc_44
g_43F7_0:
    s_mov_b64 exec, vcc
    buffer_load_dwordx4 v[24:27], v2, s[4:7], s16 offen offset:0 sc1
    s_mov_b64 exec, -1
    s_add_u32 s23, s23, 1
    s_cmp_lt_u32 s23, 200000
    s_cbranch_scc1 g_43L7_1
    s_mov_b32 s25, 200000
    s_branch gc_44
g_43F7_1:
    s_mov_b64 exec, vcc
    buffer_load_dwordx4 v[28:31], v2, s[4:7], s16 offen offset:1024 sc1
    s_mov_b64 exec, -1
    s_add_u32 s23, s23, 1
    s_cmp_lt_u32 s23, 200000
    s_cbranch_scc1 g_43L7_2
    s_mov_b32 s25, 200000
    s_branch gc_44
g_43F7_2:
    s_mov_b64 exec, vcc
    buffer_load_dwordx4 v[32:35], v2, s[4:7], s16 offen offset:2048 sc1
    s_mov_b64 exec, -1
    s_add_u32 s23, s23, 1
    s_cmp_lt_u32 s23, 200000
    s_cbranch_scc1 g_43L7_0
    s_mov_b32 s25, 200000
    s_branch gc_44
g_43F11_0:
    s_mov_b64 exec, vcc
    buffer_load_dwordx4 v[24:27], v2, s[4:7], s16 offen offset:0 sc1
    s_mov_b64 exec, -1
    s_add_u32 s23, s23, 1
    s_cmp_lt_u32 s23, 200000
    s_cbranch_scc1 g_43L11_1
    s_mov_b32 s25, 200000
    s_branch gc_44
g_43F11_1:
    s_mov_b64 exec, vcc
    buffer_load_dwordx4 v[28:31], v2, s[4:7], s16 offen offset:1024 sc1
    s_mov_b64 exec, -1
    s_add_u32 s23, s23, 1
    s_cmp_lt_u32 s23, 200000
    s_cbranch_scc1 g_43L11_3
    s_mov_b32 s25, 200000
    s_branch gc_44
g_43F11_3:
    s_mov_b64 exec, vcc
    buffer_load_dwordx4 v[36:39], v2, s[4:7], s16 offen offset:3072 sc1
    s_mov_b64 exec, -1
    s_add_u32 s23, s23, 1
    s_cmp_lt_u32 s23, 200000
    s_cbranch_scc1 g_43L11_0
    s_mov_b32 s25, 200000
    s_branch gc_44
g_43F13_0:
    s_mov_b64 exec, vcc
    buffer_load_dwordx4 v[24:27], v2, s[4:7], s16 offen offset:0 sc1
    s_mov_b64 exec, -1
    s_add_u32 s23, s23, 1
    s_cmp_lt_u32 s23, 200000
    s_cbranch_scc1 g_43L13_2
    s_mov_b32 s25, 200000
    s_branch gc_44
g_43F13_2:
    s_mov_b64 exec, vcc
    buffer_load_dwordx4 v[32:35], v2, s[4:7], s16 offen offset:2048 sc1
    s_mov_b64 exec, -1
    s_add_u32 s23, s23, 1
    s_cmp_lt_u32 s23, 200000
    s_cbranch_scc1 g_43L13_3
    s_mov_b32 s25, 200000
    s_branch gc_44
g_43F13_3:
    s_mov_b64 exec, vcc
    buffer_load_dwordx4 v[36:39], v2, s[4:7], s16 offen offset:3072 sc1
    s_mov_b64 exec, -1
    s_add_u32 s23, s23, 1
    s_cmp_lt_u32 s23, 200000
    s_cbranch_scc1 g_43L13_0
    s_mov_b32 s25, 200000
    s_branch gc_44
g_43F14_1:
    s_mov_b64 exec, vcc
    buffer_load_dwordx4 v[28:31], v2, s[4:7], s16 offen offset:1024 sc1
    s_mov_b64 exec, -1
    s_add_u32 s23, s23, 1
    s_cmp_lt_u32 s23, 200000
    s_cbranch_scc1 g_43L14_2
    s_mov_b32 s25, 200000
    s_branch gc_44
g_43F14_2:
    s_mov_b64 exec, vcc
    buffer_load_dwordx4 v[32:35], v2, s[4:7], s16 offen offset:2048 sc1
    s_mov_b64 exec, -1
    s_add_u32 s23, s23, 1
    s_cmp_lt_u32 s23, 200000
    s_cbranch_scc1 g_43L14_3
    s_mov_b32 s25, 200000
    s_branch gc_44
g_43F14_3:
    s_mov_b64 exec, vcc
    buffer_load_dwordx4 v[36:39], v2, s[4:7], s16 offen offset:3072 sc1
    s_mov_b64 exec, -1
    s_add_u32 s23, s23, 1
    s_cmp_lt_u32 s23, 200000
    s_cbranch_scc1 g_43L14_1
    s_mov_b32 s25, 200000
    s_branch gc_44
g_43F3_0:
    s_mov_b64 exec, vcc
    buffer_load_dwordx4 v[24:27], v2, s[4:7], s16 offen offset:0 sc1
    s_mov_b64 exec, -1
    s_add_u32 s23, s23, 1
    s_cmp_lt_u32 s23, 200000
    s_cbranch_scc1 g_43L3_1
    s_mov_b32 s25, 200000
    s_branch gc_44
g_43F3_1:
    s_mov_b64 exec, vcc
    buffer_load_dwordx4 v[28:31], v2, s[4:7], s16 offen offset:1024 sc1
    s_mov_b64 exec, -1
    s_add_u32 s23, s23, 1
    s_cmp_lt_u32 s23, 200000
    s_cbranch_scc1 g_43L3_0
    s_mov_b32 s25, 200000
    s_branch gc_44
g_43F5_0:
    s_mov_b64 exec, vcc
    buffer_load_dwordx4 v[24:27], v2, s[4:7], s16 offen offset:0 sc1
    s_mov_b64 exec, -1
    s_add_u32 s23, s23, 1
    s_cmp_lt_u32 s23, 200000
    s_cbranch_scc1 g_43L5_2
    s_mov_b32 s25, 200000
    s_branch gc_44
g_43F5_2:
    s_mov_b64 exec, vcc
    buffer_load_dwordx4 v[32:35], v2, s[4:7], s16 offen offset:2048 sc1
    s_mov_b64 exec, -1
    s_add_u32 s23, s23, 1
    s_cmp_lt_u32 s23, 200000
    s_cbranch_scc1 g_43L5_0
    s_mov_b32 s25, 200000
    s_branch gc_44
g_43F6_1:
    s_mov_b64 exec, vcc
    buffer_load_dwordx4 v[28:31], v2, s[4:7], s16 offen offset:1024 sc1
    s_mov_b64 exec, -1
    s_add_u32 s23, s23, 1
    s_cmp_lt_u32 s23, 200000
    s_cbranch_scc1 g_43L6_2
    s_mov_b32 s25, 200000
    s_branch gc_44
g_43F6_2:
    s_mov_b64 exec, vcc
    buffer_load_dwordx4 v[32:35], v2, s[4:7], s16 offen offset:2048 sc1
    s_mov_b64 exec, -1
    s_add_u32 s23, s23, 1
    s_cmp_lt_u32 s23, 200000
    s_cbranch_scc1 g_43L6_1
    s_mov_b32 s25, 200000
    s_branch gc_44
g_43F9_0:
    s_mov_b64 exec, vcc
    buffer_load_dwordx4 v[24:27], v2, s[4:7], s16 offen offset:0 sc1
    s_mov_b64 exec, -1
    s_add_u32 s23, s23, 1
    s_cmp_lt_u32 s23, 200000
    s_cbranch_scc1 g_43L9_3
    s_mov_b32 s25, 200000
    s_branch gc_44
g_43F9_3:
    s_mov_b64 exec, vcc
    buffer_load_dwordx4 v[36:39], v2, s[4:7], s16 offen offset:3072 sc1
    s_mov_b64 exec, -1
    s_add_u32 s23, s23, 1
    s_cmp_lt_u32 s23, 200000
    s_cbranch_scc1 g_43L9_0
    s_mov_b32 s25, 200000
    s_branch gc_44
g_43F10_1:
    s_mov_b64 exec, vcc
    buffer_load_dwordx4 v[28:31], v2, s[4:7], s16 offen offset:1024 sc1
    s_mov_b64 exec, -1
    s_add_u32 s23, s23, 1
    s_cmp_lt_u32 s23, 200000
    s_cbranch_scc1 g_43L10_3
    s_mov_b32 s25, 200000
    s_branch gc_44
g_43F10_3:
    s_mov_b64 exec, vcc
    buffer_load_dwordx4 v[36:39], v2, s[4:7], s16 offen offset:3072 sc1
    s_mov_b64 exec, -1
    s_add_u32 s23, s23, 1
    s_cmp_lt_u32 s23, 200000
    s_cbranch_scc1 g_43L10_1
    s_mov_b32 s25, 200000
    s_branch gc_44
g_43F12_2:
    s_mov_b64 exec, vcc
    buffer_load_dwordx4 v[32:35], v2, s[4:7], s16 offen offset:2048 sc1
    s_mov_b64 exec, -1
    s_add_u32 s23, s23, 1
    s_cmp_lt_u32 s23, 200000
    s_cbranch_scc1 g_43L12_3
    s_mov_b32 s25, 200000
    s_branch gc_44
g_43F12_3:
    s_mov_b64 exec, vcc
    buffer_load_dwordx4 v[36:39], v2, s[4:7], s16 offen offset:3072 sc1
    s_mov_b64 exec, -1
    s_add_u32 s23, s23, 1
    s_cmp_lt_u32 s23, 200000
    s_cbranch_scc1 g_43L12_2
    s_mov_b32 s25, 200000
    s_branch gc_44
g_43F1_0:
    s_mov_b64 exec, vcc
    buffer_load_dwordx4 v[24:27], v2, s[4:7], s16 offen offset:0 sc1
    s_mov_b64 exec, -1
    s_add_u32 s23, s23, 1
    s_cmp_lt_u32 s23, 200000
    s_cbranch_scc1 g_43L1_0
    s_mov_b32 s25, 200000
    s_branch gc_44
g_43F2_1:
    s_mov_b64 exec, vcc
    buffer_load_dwordx4 v[28:31], v2, s[4:7], s16 offen offset:1024 sc1
    s_mov_b64 exec, -1
    s_add_u32 s23, s23, 1
    s_cmp_lt_u32 s23, 200000
    s_cbranch_scc1 g_43L2_1
    s_mov_b32 s25, 200000
    s_branch gc_44
g_43F4_2:
    s_mov_b64 exec, vcc
    buffer_load_dwordx4 v[32:35], v2, s[4:7], s16 offen offset:2048 sc1
    s_mov_b64 exec, -1
    s_add_u32 s23, s23, 1
    s_cmp_lt_u32 s23, 200000
    s_cbranch_scc1 g_43L4_2
    s_mov_b32 s25, 200000
    s_branch gc_44
g_43F8_3:
    s_mov_b64 exec, vcc
    buffer_load_dwordx4 v[36:39], v2, s[4:7], s16 offen offset:3072 sc1
    s_mov_b64 exec, -1
    s_add_u32 s23, s23, 1
    s_cmp_lt_u32 s23, 200000
    s_cbranch_scc1 g_43L8_3
    s_mov_b32 s25, 200000
    s_branch gc_44
recur_fast_last2:
    buffer_store_dwordx4 v[168:171], v15, s[4:7], s20 offen sc1
    s_waitcnt vmcnt(0)
    s_branch recur_end
g_45L15_0:
    s_waitcnt vmcnt(3)
    v_max3_u32 v19, v24, v25, v26
    v_max_u32 v19, v19, v27
    v_cmp_eq_u32 vcc, -1, v19
    s_nop 0
    s_cbranch_vccnz g_45F15_0
    v_smfmac_f32_16x16x64_bf16 v[64:67], v[24:27], a[192:199], v172
    v_smfmac_f32_16x16x64_bf16 v[68:71], v[24:27], a[224:231], v172
g_45L14_1:
    s_waitcnt vmcnt(2)
    v_max3_u32 v19, v28, v29, v30
    v_max_u32 v19, v19, v31
    v_cmp_eq_u32 vcc, -1, v19
    s_nop 0
    s_cbranch_vccnz g_45F14_1
    v_smfmac_f32_16x16x64_bf16 v[64:67], v[28:31], a[200:207], v172
    v_smfmac_f32_16x16x64_bf16 v[68:71], v[28:31], a[232:239], v172
g_45L12_2:
    s_waitcnt vmcnt(1)
    v_max3_u32 v19, v32, v33, v34
    v_max_u32 v19, v19, v35
    v_cmp_eq_u32 vcc, -1, v19
    s_nop 0
    s_cbranch_vccnz g_45F12_2
    v_smfmac_f32_16x16x64_bf16 v[64:67], v[32:35], a[208:215], v172
    v_smfmac_f32_16x16x64_bf16 v[68:71], v[32:35], a[240:247], v172
g_45L8_3:
    s_waitcnt vmcnt(0)
    v_max3_u32 v19, v36, v37, v38
    v_max_u32 v19, v19, v39
    v_cmp_eq_u32 vcc, -1, v19
    s_nop 0
    s_cbranch_vccnz g_45F8_3
    v_smfmac_f32_16x16x64_bf16 v[64:67], v[36:39], a[216:223], v172
    v_smfmac_f32_16x16x64_bf16 v[68:71], v[36:39], a[248:255], v172
    s_nop 4
    v_cvt_pk_bf16_f32 v80, v64, v65
    v_cvt_pk_bf16_f32 v81, v66, v67
    s_nop 0
    v_cvt_pk_bf16_f32 v82, v68, v69
    v_cvt_pk_bf16_f32 v83, v70, v71
    ds_write_b128 v17, v[80:83] offset:9216
    s_branch gc_46
g_45L15_1:
    s_waitcnt vmcnt(3)
    v_max3_u32 v19, v28, v29, v30
    v_max_u32 v19, v19, v31
    v_cmp_eq_u32 vcc, -1, v19
    s_nop 0
    s_cbranch_vccnz g_45F15_1
    v_smfmac_f32_16x16x64_bf16 v[64:67], v[28:31], a[200:207], v172
    v_smfmac_f32_16x16x64_bf16 v[68:71], v[28:31], a[232:239], v172
g_45L13_2:
    s_waitcnt vmcnt(2)
    v_max3_u32 v19, v32, v33, v34
    v_max_u32 v19, v19, v35
    v_cmp_eq_u32 vcc, -1, v19
    s_nop 0
    s_cbranch_vccnz g_45F13_2
    v_smfmac_f32_16x16x64_bf16 v[64:67], v[32:35], a[208:215], v172
    v_smfmac_f32_16x16x64_bf16 v[68:71], v[32:35], a[240:247], v172
g_45L9_3:
    s_waitcnt vmcnt(1)
    v_max3_u32 v19, v36, v37, v38
    v_max_u32 v19, v19, v39
    v_cmp_eq_u32 vcc, -1, v19
    s_nop 0
    s_cbranch_vccnz g_45F9_3
    v_smfmac_f32_16x16x64_bf16 v[64:67], v[36:39], a[216:223], v172
    v_smfmac_f32_16x16x64_bf16 v[68:71], v[36:39], a[248:255], v172
g_45L1_0:
    s_waitcnt vmcnt(0)
    v_max3_u32 v19, v24, v25, v26
    v_max_u32 v19, v19, v27
    v_cmp_eq_u32 vcc, -1, v19
    s_nop 0
    s_cbranch_vccnz g_45F1_0
    v_smfmac_f32_16x16x64_bf16 v[64:67], v[24:27], a[192:199], v172
    v_smfmac_f32_16x16x64_bf16 v[68:71], v[24:27], a[224:231], v172
    s_nop 4
    v_cvt_pk_bf16_f32 v80, v64, v65
    v_cvt_pk_bf16_f32 v81, v66, v67
    s_nop 0
    v_cvt_pk_bf16_f32 v82, v68, v69
    v_cvt_pk_bf16_f32 v83, v70, v71
    ds_write_b128 v17, v[80:83] offset:9216
    s_branch gc_46
g_45L15_2:
    s_waitcnt vmcnt(3)
    v_max3_u32 v19, v32, v33, v34
    v_max_u32 v19, v19, v35
    v_cmp_eq_u32 vcc, -1, v19
    s_nop 0
    s_cbranch_vccnz g_45F15_2
    v_smfmac_f32_16x16x64_bf16 v[64:67], v[32:35], a[208:215], v172
    v_smfmac_f32_16x16x64_bf16 v[68:71], v[32:35], a[240:247], v172
g_45L11_3:
    s_waitcnt vmcnt(2)
    v_max3_u32 v19, v36, v37, v38
    v_max_u32 v19, v19, v39
    v_cmp_eq_u32 vcc, -1, v19
    s_nop 0
    s_cbranch_vccnz g_45F11_3
    v_smfmac_f32_16x16x64_bf16 v[64:67], v[36:39], a[216:223], v172
    v_smfmac_f32_16x16x64_bf16 v[68:71], v[36:39], a[248:255], v172
g_45L3_0:
    s_waitcnt vmcnt(1)
    v_max3_u32 v19, v24, v25, v26
    v_max_u32 v19, v19, v27
    v_cmp_eq_u32 vcc, -1, v19
    s_nop 0
    s_cbranch_vccnz g_45F3_0
    v_smfmac_f32_16x16x64_bf16 v[64:67], v[24:27], a[192:199], v172
    v_smfmac_f32_16x16x64_bf16 v[68:71], v[24:27], a[224:231], v172
g_45L2_1:
    s_waitcnt vmcnt(0)
    v_max3_u32 v19, v28, v29, v30
    v_max_u32 v19, v19, v31
    v_cmp_eq_u32 vcc, -1, v19
    s_nop 0
    s_cbranch_vccnz g_45F2_1
    v_smfmac_f32_16x16x64_bf16 v[64:67], v[28:31], a[200:207], v172
    v_smfmac_f32_16x16x64_bf16 v[68:71], v[28:31], a[232:239], v172
    s_nop 4
    v_cvt_pk_bf16_f32 v80, v64, v65
    v_cvt_pk_bf16_f32 v81, v66, v67
    s_nop 0
    v_cvt_pk_bf16_f32 v82, v68, v69
    v_cvt_pk_bf16_f32 v83, v70, v71
    ds_write_b128 v17, v[80:83] offset:9216
    s_branch gc_46
g_45L15_3:
    s_waitcnt vmcnt(3)
    v_max3_u32 v19, v36, v37, v38
    v_max_u32 v19, v19, v39
    v_cmp_eq_u32 vcc, -1, v19
    s_nop 0
    s_cbranch_vccnz g_45F15_3
    v_smfmac_f32_16x16x64_bf16 v[64:67], v[36:39], a[216:223], v172
    v_smfmac_f32_16x16x64_bf16 v[68:71], v[36:39], a[248:255], v172
g_45L7_0:
    s_waitcnt vmcnt(2)
    v_max3_u32 v19, v24, v25, v26
    v_max_u32 v19, v19, v27
    v_cmp_eq_u32 vcc, -1, v19
    s_nop 0
    s_cbranch_vccnz g_45F7_0
    v_smfmac_f32_16x16x64_bf16 v[64:67], v[24:27], a[192:199], v172
    v_smfmac_f32_16x16x64_bf16 v[68:71], v[24:27], a[224:231], v172
g_45L6_1:
    s_waitcnt vmcnt(1)
    v_max3_u32 v19, v28, v29, v30
    v_max_u32 v19, v19, v31
    v_cmp_eq_u32 vcc, -1, v19
    s_nop 0
    s_cbranch_vccnz g_45F6_1
    v_smfmac_f32_16x16x64_bf16 v[64:67], v[28:31], a[200:207], v172
    v_smfmac_f32_16x16x64_bf16 v[68:71], v[28:31], a[232:239], v172
g_45L4_2:
    s_waitcnt vmcnt(0)
    v_max3_u32 v19, v32, v33, v34
    v_max_u32 v19, v19, v35
    v_cmp_eq_u32 vcc, -1, v19
    s_nop 0
    s_cbranch_vccnz g_45F4_2
    v_smfmac_f32_16x16x64_bf16 v[64:67], v[32:35], a[208:215], v172
    v_smfmac_f32_16x16x64_bf16 v[68:71], v[32:35], a[240:247], v172
    s_nop 4
    v_cvt_pk_bf16_f32 v80, v64, v65
    v_cvt_pk_bf16_f32 v81, v66, v67
    s_nop 0
    v_cvt_pk_bf16_f32 v82, v68, v69
    v_cvt_pk_bf16_f32 v83, v70, v71
    ds_write_b128 v17, v[80:83] offset:9216
    s_branch gc_46
g_45L7_1:
    s_waitcnt vmcnt(2)
    v_max3_u32 v19, v28, v29, v30
    v_max_u32 v19, v19, v31
    v_cmp_eq_u32 vcc, -1, v19
    s_nop 0
    s_cbranch_vccnz g_45F7_1
    v_smfmac_f32_16x16x64_bf16 v[64:67], v[28:31], a[200:207], v172
    v_smfmac_f32_16x16x64_bf16 v[68:71], v[28:31], a[232:239], v172
g_45L5_2:
    s_waitcnt vmcnt(1)
    v_max3_u32 v19, v32, v33, v34
    v_max_u32 v19, v19, v35
    v_cmp_eq_u32 vcc, -1, v19
    s_nop 0
    s_cbranch_vccnz g_45F5_2
    v_smfmac_f32_16x16x64_bf16 v[64:67], v[32:35], a[208:215], v172
    v_smfmac_f32_16x16x64_bf16 v[68:71], v[32:35], a[240:247], v172
    s_branch g_45L1_0
g_45L7_2:
    s_waitcnt vmcnt(2)
    v_max3_u32 v19, v32, v33, v34
    v_max_u32 v19, v19, v35
    v_cmp_eq_u32 vcc, -1, v19
    s_nop 0
    s_cbranch_vccnz g_45F7_2
    v_smfmac_f32_16x16x64_bf16 v[64:67], v[32:35], a[208:215], v172
    v_smfmac_f32_16x16x64_bf16 v[68:71], v[32:35], a[240:247], v172
    s_branch g_45L3_0
g_45L11_0:
    s_waitcnt vmcnt(2)
    v_max3_u32 v19, v24, v25, v26
    v_max_u32 v19, v19, v27
    v_cmp_eq_u32 vcc, -1, v19
    s_nop 0
    s_cbranch_vccnz g_45F11_0
    v_smfmac_f32_16x16x64_bf16 v[64:67], v[24:27], a[192:199], v172
    v_smfmac_f32_16x16x64_bf16 v[68:71], v[24:27], a[224:231], v172
g_45L10_1:
    s_waitcnt vmcnt(1)
    v_max3_u32 v19, v28, v29, v30
    v_max_u32 v19, v19, v31
    v_cmp_eq_u32 vcc, -1, v19
    s_nop 0
    s_cbranch_vccnz g_45F10_1
    v_smfmac_f32_16x16x64_bf16 v[64:67], v[28:31], a[200:207], v172
    v_smfmac_f32_16x16x64_bf16 v[68:71], v[28:31], a[232:239], v172
    s_branch g_45L8_3
g_45L11_1:
    s_waitcnt vmcnt(2)
    v_max3_u32 v19, v28, v29, v30
    v_max_u32 v19, v19, v31
    v_cmp_eq_u32 vcc, -1, v19
    s_nop 0
    s_cbranch_vccnz g_45F11_1
    v_smfmac_f32_16x16x64_bf16 v[64:67], v[28:31], a[200:207], v172
    v_smfmac_f32_16x16x64_bf16 v[68:71], v[28:31], a[232:239], v172
    s_branch g_45L9_3
g_45L13_0:
    s_waitcnt vmcnt(2)
    v_max3_u32 v19, v24, v25, v26
    v_max_u32 v19, v19, v27
    v_cmp_eq_u32 vcc, -1, v19
    s_nop 0
    s_cbranch_vccnz g_45F13_0
    v_smfmac_f32_16x16x64_bf16 v[64:67], v[24:27], a[192:199], v172
    v_smfmac_f32_16x16x64_bf16 v[68:71], v[24:27], a[224:231], v172
    s_branch g_45L12_2
g_45L13_3:
    s_waitcnt vmcnt(2)
    v_max3_u32 v19, v36, v37, v38
    v_max_u32 v19, v19, v39
    v_cmp_eq_u32 vcc, -1, v19
    s_nop 0
    s_cbranch_vccnz g_45F13_3
    v_smfmac_f32_16x16x64_bf16 v[64:67], v[36:39], a[216:223], v172
    v_smfmac_f32_16x16x64_bf16 v[68:71], v[36:39], a[248:255], v172
g_45L5_0:
    s_waitcnt vmcnt(1)
    v_max3_u32 v19, v24, v25, v26
    v_max_u32 v19, v19, v27
    v_cmp_eq_u32 vcc, -1, v19
    s_nop 0
    s_cbranch_vccnz g_45F5_0
    v_smfmac_f32_16x16x64_bf16 v[64:67], v[24:27], a[192:199], v172
    v_smfmac_f32_16x16x64_bf16 v[68:71], v[24:27], a[224:231], v172
    s_branch g_45L4_2
g_45L14_2:
    s_waitcnt vmcnt(2)
    v_max3_u32 v19, v32, v33, v34
    v_max_u32 v19, v19, v35
    v_cmp_eq_u32 vcc, -1, v19
    s_nop 0
    s_cbranch_vccnz g_45F14_2
    v_smfmac_f32_16x16x64_bf16 v[64:67], v[32:35], a[208:215], v172
    v_smfmac_f32_16x16x64_bf16 v[68:71], v[32:35], a[240:247], v172
g_45L10_3:
    s_waitcnt vmcnt(1)
    v_max3_u32 v19, v36, v37, v38
    v_max_u32 v19, v19, v39
    v_cmp_eq_u32 vcc, -1, v19
    s_nop 0
    s_cbranch_vccnz g_45F10_3
    v_smfmac_f32_16x16x64_bf16 v[64:67], v[36:39], a[216:223], v172
    v_smfmac_f32_16x16x64_bf16 v[68:71], v[36:39], a[248:255], v172
    s_branch g_45L2_1
g_45L14_3:
    s_waitcnt vmcnt(2)
    v_max3_u32 v19, v36, v37, v38
    v_max_u32 v19, v19, v39
    v_cmp_eq_u32 vcc, -1, v19
    s_nop 0
    s_cbranch_vccnz g_45F14_3
    v_smfmac_f32_16x16x64_bf16 v[64:67], v[36:39], a[216:223], v172
    v_smfmac_f32_16x16x64_bf16 v[68:71], v[36:39], a[248:255], v172
    s_branch g_45L6_1
g_45L3_1:
    s_waitcnt vmcnt(1)
    v_max3_u32 v19, v28, v29, v30
    v_max_u32 v19, v19, v31
    v_cmp_eq_u32 vcc, -1, v19
    s_nop 0
    s_cbranch_vccnz g_45F3_1
    v_smfmac_f32_16x16x64_bf16 v[64:67], v[28:31], a[200:207], v172
    v_smfmac_f32_16x16x64_bf16 v[68:71], v[28:31], a[232:239], v172
    s_branch g_45L1_0
g_45L6_2:
    s_waitcnt vmcnt(1)
    v_max3_u32 v19, v32, v33, v34
    v_max_u32 v19, v19, v35
    v_cmp_eq_u32 vcc, -1, v19
    s_nop 0
    s_cbranch_vccnz g_45F6_2
    v_smfmac_f32_16x16x64_bf16 v[64:67], v[32:35], a[208:215], v172
    v_smfmac_f32_16x16x64_bf16 v[68:71], v[32:35], a[240:247], v172
    s_branch g_45L2_1
g_45L9_0:
    s_waitcnt vmcnt(1)
    v_max3_u32 v19, v24, v25, v26
    v_max_u32 v19, v19, v27
    v_cmp_eq_u32 vcc, -1, v19
    s_nop 0
    s_cbranch_vccnz g_45F9_0
    v_smfmac_f32_16x16x64_bf16 v[64:67], v[24:27], a[192:199], v172
    v_smfmac_f32_16x16x64_bf16 v[68:71], v[24:27], a[224:231], v172
    s_branch g_45L8_3
g_45L12_3:
    s_waitcnt vmcnt(1)
    v_max3_u32 v19, v36, v37, v38
    v_max_u32 v19, v19, v39
    v_cmp_eq_u32 vcc, -1, v19
    s_nop 0
    s_cbranch_vccnz g_45F12_3
    v_smfmac_f32_16x16x64_bf16 v[64:67], v[36:39], a[216:223], v172
    v_smfmac_f32_16x16x64_bf16 v[68:71], v[36:39], a[248:255], v172
    s_branch g_45L4_2
g_45F15_0:
    s_mov_b64 exec, vcc
    buffer_load_dwordx4 v[24:27], v8, s[4:7], s16 offen offset:0 sc1
    s_mov_b64 exec, -1
    s_add_u32 s23, s23, 1
    s_cmp_lt_u32 s23, 200000
    s_cbranch_scc1 g_45L15_1
    s_mov_b32 s25, 200000
    s_branch gc_46
g_45F15_1:
    s_mov_b64 exec, vcc
    buffer_load_dwordx4 v[28:31], v8, s[4:7], s16 offen offset:1024 sc1
    s_mov_b64 exec, -1
    s_add_u32 s23, s23, 1
    s_cmp_lt_u32 s23, 200000
    s_cbranch_scc1 g_45L15_2
    s_mov_b32 s25, 200000
    s_branch gc_46
g_45F15_2:
    s_mov_b64 exec, vcc
    buffer_load_dwordx4 v[32:35], v8, s[4:7], s16 offen offset:2048 sc1
    s_mov_b64 exec, -1
    s_add_u32 s23, s23, 1
    s_cmp_lt_u32 s23, 200000
    s_cbranch_scc1 g_45L15_3
    s_mov_b32 s25, 200000
    s_branch gc_46
g_45F15_3:
    s_mov_b64 exec, vcc
    buffer_load_dwordx4 v[36:39], v8, s[4:7], s16 offen offset:3072 sc1
    s_mov_b64 exec, -1
    s_add_u32 s23, s23, 1
    s_cmp_lt_u32 s23, 200000
    s_cbranch_scc1 g_45L15_0
    s_mov_b32 s25, 200000
    s_branch gc_46
g_45F7_0:
    s_mov_b64 exec, vcc
    buffer_load_dwordx4 v[24:27], v8, s[4:7], s16 offen offset:0 sc1
    s_mov_b64 exec, -1
    s_add_u32 s23, s23, 1
    s_cmp_lt_u32 s23, 200000
    s_cbranch_scc1 g_45L7_1
    s_mov_b32 s25, 200000
    s_branch gc_46
g_45F7_1:
    s_mov_b64 exec, vcc
    buffer_load_dwordx4 v[28:31], v8, s[4:7], s16 offen offset:1024 sc1
    s_mov_b64 exec, -1
    s_add_u32 s23, s23, 1
    s_cmp_lt_u32 s23, 200000
    s_cbranch_scc1 g_45L7_2
    s_mov_b32 s25, 200000
    s_branch gc_46
g_45F7_2:
    s_mov_b64 exec, vcc
    buffer_load_dwordx4 v[32:35], v8, s[4:7], s16 offen offset:2048 sc1
    s_mov_b64 exec, -1
    s_add_u32 s23, s23, 1
    s_cmp_lt_u32 s23, 200000
    s_cbranch_scc1 g_45L7_0
    s_mov_b32 s25, 200000
    s_branch gc_46
g_45F11_0:
    s_mov_b64 exec, vcc
    buffer_load_dwordx4 v[24:27], v8, s[4:7], s16 offen offset:0 sc1
    s_mov_b64 exec, -1
    s_add_u32 s23, s23, 1
    s_cmp_lt_u32 s23, 200000
    s_cbranch_scc1 g_45L11_1
    s_mov_b32 s25, 200000
    s_branch gc_46
g_45F11_1:
    s_mov_b64 exec, vcc
    buffer_load_dwordx4 v[28:31], v8, s[4:7], s16 offen offset:1024 sc1
    s_mov_b64 exec, -1
    s_add_u32 s23, s23, 1
    s_cmp_lt_u32 s23, 200000
    s_cbranch_scc1 g_45L11_3
    s_mov_b32 s25, 200000
    s_branch gc_46
g_45F11_3:
    s_mov_b64 exec, vcc
    buffer_load_dwordx4 v[36:39], v8, s[4:7], s16 offen offset:3072 sc1
    s_mov_b64 exec, -1
    s_add_u32 s23, s23, 1
    s_cmp_lt_u32 s23, 200000
    s_cbranch_scc1 g_45L11_0
    s_mov_b32 s25, 200000
    s_branch gc_46
g_45F13_0:
    s_mov_b64 exec, vcc
    buffer_load_dwordx4 v[24:27], v8, s[4:7], s16 offen offset:0 sc1
    s_mov_b64 exec, -1
    s_add_u32 s23, s23, 1
    s_cmp_lt_u32 s23, 200000
    s_cbranch_scc1 g_45L13_2
    s_mov_b32 s25, 200000
    s_branch gc_46
g_45F13_2:
    s_mov_b64 exec, vcc
    buffer_load_dwordx4 v[32:35], v8, s[4:7], s16 offen offset:2048 sc1
    s_mov_b64 exec, -1
    s_add_u32 s23, s23, 1
    s_cmp_lt_u32 s23, 200000
    s_cbranch_scc1 g_45L13_3
    s_mov_b32 s25, 200000
    s_branch gc_46
g_45F13_3:
    s_mov_b64 exec, vcc
    buffer_load_dwordx4 v[36:39], v8, s[4:7], s16 offen offset:3072 sc1
    s_mov_b64 exec, -1
    s_add_u32 s23, s23, 1
    s_cmp_lt_u32 s23, 200000
    s_cbranch_scc1 g_45L13_0
    s_mov_b32 s25, 200000
    s_branch gc_46
g_45F14_1:
    s_mov_b64 exec, vcc
    buffer_load_dwordx4 v[28:31], v8, s[4:7], s16 offen offset:1024 sc1
    s_mov_b64 exec, -1
    s_add_u32 s23, s23, 1
    s_cmp_lt_u32 s23, 200000
    s_cbranch_scc1 g_45L14_2
    s_mov_b32 s25, 200000
    s_branch gc_46
g_45F14_2:
    s_mov_b64 exec, vcc
    buffer_load_dwordx4 v[32:35], v8, s[4:7], s16 offen offset:2048 sc1
    s_mov_b64 exec, -1
    s_add_u32 s23, s23, 1
    s_cmp_lt_u32 s23, 200000
    s_cbranch_scc1 g_45L14_3
    s_mov_b32 s25, 200000
    s_branch gc_46
g_45F14_3:
    s_mov_b64 exec, vcc
    buffer_load_dwordx4 v[36:39], v8, s[4:7], s16 offen offset:3072 sc1
    s_mov_b64 exec, -1
    s_add_u32 s23, s23, 1
    s_cmp_lt_u32 s23, 200000
    s_cbranch_scc1 g_45L14_1
    s_mov_b32 s25, 200000
    s_branch gc_46
g_45F3_0:
    s_mov_b64 exec, vcc
    buffer_load_dwordx4 v[24:27], v8, s[4:7], s16 offen offset:0 sc1
    s_mov_b64 exec, -1
    s_add_u32 s23, s23, 1
    s_cmp_lt_u32 s23, 200000
    s_cbranch_scc1 g_45L3_1
    s_mov_b32 s25, 200000
    s_branch gc_46
g_45F3_1:
    s_mov_b64 exec, vcc
    buffer_load_dwordx4 v[28:31], v8, s[4:7], s16 offen offset:1024 sc1
    s_mov_b64 exec, -1
    s_add_u32 s23, s23, 1
    s_cmp_lt_u32 s23, 200000
    s_cbranch_scc1 g_45L3_0
    s_mov_b32 s25, 200000
    s_branch gc_46
g_45F5_0:
    s_mov_b64 exec, vcc
    buffer_load_dwordx4 v[24:27], v8, s[4:7], s16 offen offset:0 sc1
    s_mov_b64 exec, -1
    s_add_u32 s23, s23, 1
    s_cmp_lt_u32 s23, 200000
    s_cbranch_scc1 g_45L5_2
    s_mov_b32 s25, 200000
    s_branch gc_46
g_45F5_2:
    s_mov_b64 exec, vcc
    buffer_load_dwordx4 v[32:35], v8, s[4:7], s16 offen offset:2048 sc1
    s_mov_b64 exec, -1
    s_add_u32 s23, s23, 1
    s_cmp_lt_u32 s23, 200000
    s_cbranch_scc1 g_45L5_0
    s_mov_b32 s25, 200000
    s_branch gc_46
g_45F6_1:
    s_mov_b64 exec, vcc
    buffer_load_dwordx4 v[28:31], v8, s[4:7], s16 offen offset:1024 sc1
    s_mov_b64 exec, -1
    s_add_u32 s23, s23, 1
    s_cmp_lt_u32 s23, 200000
    s_cbranch_scc1 g_45L6_2
    s_mov_b32 s25, 200000
    s_branch gc_46
g_45F6_2:
    s_mov_b64 exec, vcc
    buffer_load_dwordx4 v[32:35], v8, s[4:7], s16 offen offset:2048 sc1
    s_mov_b64 exec, -1
    s_add_u32 s23, s23, 1
    s_cmp_lt_u32 s23, 200000
    s_cbranch_scc1 g_45L6_1
    s_mov_b32 s25, 200000
    s_branch gc_46
g_45F9_0:
    s_mov_b64 exec, vcc
    buffer_load_dwordx4 v[24:27], v8, s[4:7], s16 offen offset:0 sc1
    s_mov_b64 exec, -1
    s_add_u32 s23, s23, 1
    s_cmp_lt_u32 s23, 200000
    s_cbranch_scc1 g_45L9_3
    s_mov_b32 s25, 200000
    s_branch gc_46
g_45F9_3:
    s_mov_b64 exec, vcc
    buffer_load_dwordx4 v[36:39], v8, s[4:7], s16 offen offset:3072 sc1
    s_mov_b64 exec, -1
    s_add_u32 s23, s23, 1
    s_cmp_lt_u32 s23, 200000
    s_cbranch_scc1 g_45L9_0
    s_mov_b32 s25, 200000
    s_branch gc_46
g_45F10_1:
    s_mov_b64 exec, vcc
    buffer_load_dwordx4 v[28:31], v8, s[4:7], s16 offen offset:1024 sc1
    s_mov_b64 exec, -1
    s_add_u32 s23, s23, 1
    s_cmp_lt_u32 s23, 200000
    s_cbranch_scc1 g_45L10_3
    s_mov_b32 s25, 200000
    s_branch gc_46
g_45F10_3:
    s_mov_b64 exec, vcc
    buffer_load_dwordx4 v[36:39], v8, s[4:7], s16 offen offset:3072 sc1
    s_mov_b64 exec, -1
    s_add_u32 s23, s23, 1
    s_cmp_lt_u32 s23, 200000
    s_cbranch_scc1 g_45L10_1
    s_mov_b32 s25, 200000
    s_branch gc_46
g_45F12_2:
    s_mov_b64 exec, vcc
    buffer_load_dwordx4 v[32:35], v8, s[4:7], s16 offen offset:2048 sc1
    s_mov_b64 exec, -1
    s_add_u32 s23, s23, 1
    s_cmp_lt_u32 s23, 200000
    s_cbranch_scc1 g_45L12_3
    s_mov_b32 s25, 200000
    s_branch gc_46
g_45F12_3:
    s_mov_b64 exec, vcc
    buffer_load_dwordx4 v[36:39], v8, s[4:7], s16 offen offset:3072 sc1
    s_mov_b64 exec, -1
    s_add_u32 s23, s23, 1
    s_cmp_lt_u32 s23, 200000
    s_cbranch_scc1 g_45L12_2
    s_mov_b32 s25, 200000
    s_branch gc_46
g_45F1_0:
    s_mov_b64 exec, vcc
    buffer_load_dwordx4 v[24:27], v8, s[4:7], s16 offen offset:0 sc1
    s_mov_b64 exec, -1
    s_add_u32 s23, s23, 1
    s_cmp_lt_u32 s23, 200000
    s_cbranch_scc1 g_45L1_0
    s_mov_b32 s25, 200000
    s_branch gc_46
g_45F2_1:
    s_mov_b64 exec, vcc
    buffer_load_dwordx4 v[28:31], v8, s[4:7], s16 offen offset:1024 sc1
    s_mov_b64 exec, -1
    s_add_u32 s23, s23, 1
    s_cmp_lt_u32 s23, 200000
    s_cbranch_scc1 g_45L2_1
    s_mov_b32 s25, 200000
    s_branch gc_46
g_45F4_2:
    s_mov_b64 exec, vcc
    buffer_load_dwordx4 v[32:35], v8, s[4:7], s16 offen offset:2048 sc1
    s_mov_b64 exec, -1
    s_add_u32 s23, s23, 1
    s_cmp_lt_u32 s23, 200000
    s_cbranch_scc1 g_45L4_2
    s_mov_b32 s25, 200000
    s_branch gc_46
g_45F8_3:
    s_mov_b64 exec, vcc
    buffer_load_dwordx4 v[36:39], v8, s[4:7], s16 offen offset:3072 sc1
    s_mov_b64 exec, -1
    s_add_u32 s23, s23, 1
    s_cmp_lt_u32 s23, 200000
    s_cbranch_scc1 g_45L8_3
    s_mov_b32 s25, 200000
    s_branch gc_46
.p2align 6
recur_fast_w3:
    s_nop 15
    s_mov_b32 s23, s25
    buffer_load_dwordx4 v[24:27], v2, s[4:7], s16 offen offset:0 sc1
    s_nop 11
    buffer_load_dwordx4 v[28:31], v2, s[4:7], s16 offen offset:1024 sc1
    s_nop 11
    buffer_load_dwordx4 v[32:35], v2, s[4:7], s16 offen offset:2048 sc1
    s_nop 11
    buffer_load_dwordx4 v[36:39], v2, s[4:7], s16 offen offset:3072 sc1
    s_waitcnt vmcnt(3)
    v_max3_u32 v19, v24, v25, v26
    v_max_u32 v19, v19, v27
    v_cmp_eq_u32 vcc, -1, v19
    s_nop 0
    s_cbranch_vccnz g_47F15_0
    v_smfmac_f32_16x16x64_bf16 v[40:43], v[24:27], a[0:7], v172
    s_waitcnt vmcnt(2)
    v_max3_u32 v19, v28, v29, v30
    v_max_u32 v19, v19, v31
    v_smfmac_f32_16x16x64_bf16 v[44:47], v[24:27], a[64:71], v172
    v_cmp_eq_u32 vcc, -1, v19
    v_smfmac_f32_16x16x64_bf16 v[48:51], v[24:27], a[32:39], v172
    v_smfmac_f32_16x16x64_bf16 v[52:55], v[24:27], a[96:103], v172
    s_cbranch_vccnz g_47F14_1
    v_smfmac_f32_16x16x64_bf16 v[40:43], v[28:31], a[8:15], v172
    s_waitcnt vmcnt(1)
    v_max3_u32 v19, v32, v33, v34
    v_max_u32 v19, v19, v35
    v_smfmac_f32_16x16x64_bf16 v[44:47], v[28:31], a[72:79], v172
    v_cmp_eq_u32 vcc, -1, v19
    v_smfmac_f32_16x16x64_bf16 v[48:51], v[28:31], a[40:47], v172
    v_smfmac_f32_16x16x64_bf16 v[52:55], v[28:31], a[104:111], v172
    s_cbranch_vccnz g_47F12_2
    v_smfmac_f32_16x16x64_bf16 v[40:43], v[32:35], a[16:23], v172
    s_waitcnt vmcnt(0)
    v_max3_u32 v19, v36, v37, v38
    v_max_u32 v19, v19, v39
    v_smfmac_f32_16x16x64_bf16 v[44:47], v[32:35], a[80:87], v172
    v_cmp_eq_u32 vcc, -1, v19
    v_smfmac_f32_16x16x64_bf16 v[48:51], v[32:35], a[48:55], v172
    v_smfmac_f32_16x16x64_bf16 v[52:55], v[32:35], a[112:119], v172
    s_cbranch_vccnz g_47F8_3
    v_smfmac_f32_16x16x64_bf16 v[40:43], v[36:39], a[24:31], v172
    v_smfmac_f32_16x16x64_bf16 v[44:47], v[36:39], a[88:95], v172
    v_smfmac_f32_16x16x64_bf16 v[48:51], v[36:39], a[56:63], v172
    v_smfmac_f32_16x16x64_bf16 v[52:55], v[36:39], a[120:127], v172
gc_48:
    v_cvt_pk_bf16_f32 v72, v40, v41
    v_cvt_pk_bf16_f32 v73, v42, v43
    v_cvt_pk_bf16_f32 v74, v44, v45
    v_cvt_pk_bf16_f32 v75, v46, v47
    ds_write_b128 v17, v[72:75] offset:0
    v_cvt_pk_bf16_f32 v76, v48, v49
    v_cvt_pk_bf16_f32 v77, v50, v51
    s_nop 0
    v_cvt_pk_bf16_f32 v78, v52, v53
    v_cvt_pk_bf16_f32 v79, v54, v55
    ds_write_b128 v17, v[76:79] offset:1024
    v_smfmac_f32_16x16x64_bf16 v[56:59], v[24:27], a[128:135], v172
    v_smfmac_f32_16x16x64_bf16 v[60:63], v[24:27], a[160:167], v172
    v_smfmac_f32_16x16x64_bf16 v[56:59], v[28:31], a[136:143], v172
    s_waitcnt lgkmcnt(0)
    s_barrier
    v_smfmac_f32_16x16x64_bf16 v[60:63], v[28:31], a[168:175], v172
    v_smfmac_f32_16x16x64_bf16 v[56:59], v[32:35], a[144:151], v172
    v_smfmac_f32_16x16x64_bf16 v[60:63], v[32:35], a[176:183], v172
    v_smfmac_f32_16x16x64_bf16 v[56:59], v[36:39], a[152:159], v172
    v_smfmac_f32_16x16x64_bf16 v[60:63], v[36:39], a[184:191], v172
    s_nop 4
    v_cvt_pk_bf16_f32 v80, v56, v57
    v_cvt_pk_bf16_f32 v81, v58, v59
    s_nop 0
    v_cvt_pk_bf16_f32 v82, v60, v61
    v_cvt_pk_bf16_f32 v83, v62, v63
    ds_write_b128 v17, v[80:83] offset:8192
    buffer_store_dwordx4 v[204:207], v3, s[4:7], s43 offen
    buffer_store_dwordx4 v[204:207], v3, s[4:7], s43 offen offset:128
    buffer_store_dwordx4 v[204:207], v4, s[4:7], s43 offen
    buffer_store_dwordx2 v[204:205], v7, s[4:7], s43 offen
    buffer_store_dwordx2 v[204:205], v11, s[4:7], s43 offen
    s_cmp_eq_u32 s15, 63
    s_waitcnt lgkmcnt(0)
    s_barrier
    s_cbranch_scc1 recur_end
    s_barrier
    s_nop 15
    s_mov_b32 s23, s25
    buffer_load_dwordx4 v[24:27], v8, s[4:7], s16 offen offset:0 sc1
    s_nop 11
    buffer_load_dwordx4 v[28:31], v8, s[4:7], s16 offen offset:1024 sc1
    s_nop 11
    buffer_load_dwordx4 v[32:35], v8, s[4:7], s16 offen offset:2048 sc1
    s_nop 11
    buffer_load_dwordx4 v[36:39], v8, s[4:7], s16 offen offset:3072 sc1
    s_waitcnt vmcnt(3)
    v_max3_u32 v19, v24, v25, v26
    v_max_u32 v19, v19, v27
    v_cmp_eq_u32 vcc, -1, v19
    s_nop 0
    s_cbranch_vccnz g_49F15_0
    v_smfmac_f32_16x16x64_bf16 v[64:67], v[24:27], a[192:199], v172
    v_smfmac_f32_16x16x64_bf16 v[68:71], v[24:27], a[224:231], v172
    s_waitcnt vmcnt(2)
    v_max3_u32 v19, v28, v29, v30
    v_max_u32 v19, v19, v31
    v_cmp_eq_u32 vcc, -1, v19
    s_nop 0
    s_cbranch_vccnz g_49F14_1
    v_smfmac_f32_16x16x64_bf16 v[64:67], v[28:31], a[200:207], v172
    v_smfmac_f32_16x16x64_bf16 v[68:71], v[28:31], a[232:239], v172
    s_waitcnt vmcnt(1)
    v_max3_u32 v19, v32, v33, v34
    v_max_u32 v19, v19, v35
    v_cmp_eq_u32 vcc, -1, v19
    s_nop 0
    s_cbranch_vccnz g_49F12_2
    v_smfmac_f32_16x16x64_bf16 v[64:67], v[32:35], a[208:215], v172
    v_smfmac_f32_16x16x64_bf16 v[68:71], v[32:35], a[240:247], v172
    s_waitcnt vmcnt(0)
    v_max3_u32 v19, v36, v37, v38
    v_max_u32 v19, v19, v39
    v_cmp_eq_u32 vcc, -1, v19
    s_nop 0
    s_cbranch_vccnz g_49F8_3
    v_smfmac_f32_16x16x64_bf16 v[64:67], v[36:39], a[216:223], v172
    v_smfmac_f32_16x16x64_bf16 v[68:71], v[36:39], a[248:255], v172
    s_nop 4
    v_cvt_pk_bf16_f32 v80, v64, v65
    v_cvt_pk_bf16_f32 v81, v66, v67
    s_nop 0
    v_cvt_pk_bf16_f32 v82, v68, v69
    v_cvt_pk_bf16_f32 v83, v70, v71
    s_nop 1
    v_mfma_f32_16x16x32_bf16 v[88:91], v[80:83], v[84:87], 0
gc_50:
    s_barrier
    ds_read_b128 v[96:99], v16 offset:9216
    ds_read_b128 v[100:103], v16 offset:11264
    ds_read_b128 v[104:107], v16 offset:13312
    s_waitcnt lgkmcnt(2)
    v_mfma_f32_16x16x32_bf16 v[88:91], v[96:99], v[84:87], v[88:91]
    s_waitcnt lgkmcnt(1)
    v_mfma_f32_16x16x32_bf16 v[88:91], v[100:103], v[84:87], v[88:91]
    s_waitcnt lgkmcnt(0)
    v_mfma_f32_16x16x32_bf16 v[88:91], v[104:107], v[84:87], v[88:91]
    s_nop 7
    buffer_store_dwordx4 v[88:91], v9, s[4:7], s84 offen sc1
    s_add_u32 s22, s84, 262144
    s_nop 15
    s_nop 15
    s_nop 15
    s_nop 15
    s_nop 15
    s_nop 15
    s_nop 15
    s_nop 15
    s_mov_b32 s23, s25
    buffer_load_dwordx4 v[96:99], v10, s[4:7], s84 offen sc1
    buffer_load_dwordx4 v[100:103], v23, s[4:7], s84 offen sc1
    buffer_load_dwordx4 v[104:107], v244, s[4:7], s84 offen sc1
    v_mov_b32 v40, 0
    v_mov_b32 v41, 0
    v_mov_b32 v42, 0
    v_mov_b32 v43, 0
    v_mov_b32 v44, 0
    v_mov_b32 v45, 0
    v_mov_b32 v46, 0
    v_mov_b32 v47, 0
    v_mov_b32 v48, 0
    v_mov_b32 v49, 0
    v_mov_b32 v50, 0
    v_mov_b32 v51, 0
    v_mov_b32 v52, 0
    v_mov_b32 v53, 0
    v_mov_b32 v54, 0
    v_mov_b32 v55, 0
    v_mov_b32 v56, 0
    v_mov_b32 v57, 0
    v_mov_b32 v58, 0
    v_mov_b32 v59, 0
    v_mov_b32 v60, 0
    v_mov_b32 v61, 0
    v_mov_b32 v62, 0
    v_mov_b32 v63, 0
    v_mov_b32 v64, 0
    v_mov_b32 v65, 0
    v_mov_b32 v66, 0
    v_mov_b32 v67, 0
    v_mov_b32 v68, 0
    v_mov_b32 v69, 0
    v_mov_b32 v70, 0
    v_mov_b32 v71, 0
pb_53:
    s_waitcnt vmcnt(2)
    v_pk_add_f32 v[120:121], v[88:89], v[96:97]
    v_pk_add_f32 v[122:123], v[90:91], v[98:99]
    s_waitcnt vmcnt(1)
    v_pk_add_f32 v[120:121], v[120:121], v[100:101]
    v_pk_add_f32 v[122:123], v[122:123], v[102:103]
    s_waitcnt vmcnt(0)
    v_pk_add_f32 v[120:121], v[120:121], v[104:105]
    v_pk_add_f32 v[122:123], v[122:123], v[106:107]
    v_cvt_pk_bf16_f32 v180, v120, v121
    v_pk_add_f32 v[124:125], v[120:121], v[122:123]
    v_cvt_pk_bf16_f32 v181, v122, v123
    v_cmpx_o_f32 vcc, v124, v125
    buffer_store_dwordx2 v[180:181], v11, s[4:7], s42 offen
    s_cmp_eq_u64 vcc, -1
    s_mov_b64 exec, -1
    s_cbranch_scc0 pr_51
pg_52:
    s_barrier
    s_mov_b32 s21, s16
    s_mov_b32 s16, s42
    s_mov_b32 s42, s43
    s_mov_b32 s43, s44
    s_mov_b32 s44, s21
    s_add_u32 s95, s95, 524288
    s_lshr_b32 s84, s95, 8
    s_and_b32 s84, s84, 8192
    s_xor_b32 s84, s84, s46
    s_add_u32 s84, s84, s95
    s_add_u32 s15, s15, 1
    s_branch recur_fast_w3
g_47L15_0:
    s_waitcnt vmcnt(3)
    v_max3_u32 v19, v24, v25, v26
    v_max_u32 v19, v19, v27
    v_cmp_eq_u32 vcc, -1, v19
    s_nop 0
    s_cbranch_vccnz g_47F15_0
    v_smfmac_f32_16x16x64_bf16 v[40:43], v[24:27], a[0:7], v172
    v_smfmac_f32_16x16x64_bf16 v[44:47], v[24:27], a[64:71], v172
    v_smfmac_f32_16x16x64_bf16 v[48:51], v[24:27], a[32:39], v172
    v_smfmac_f32_16x16x64_bf16 v[52:55], v[24:27], a[96:103], v172
g_47L14_1:
    s_waitcnt vmcnt(2)
    v_max3_u32 v19, v28, v29, v30
    v_max_u32 v19, v19, v31
    v_cmp_eq_u32 vcc, -1, v19
    s_nop 0
    s_cbranch_vccnz g_47F14_1
    v_smfmac_f32_16x16x64_bf16 v[40:43], v[28:31], a[8:15], v172
    v_smfmac_f32_16x16x64_bf16 v[44:47], v[28:31], a[72:79], v172
    v_smfmac_f32_16x16x64_bf16 v[48:51], v[28:31], a[40:47], v172
    v_smfmac_f32_16x16x64_bf16 v[52:55], v[28:31], a[104:111], v172
g_47L12_2:
    s_waitcnt vmcnt(1)
    v_max3_u32 v19, v32, v33, v34
    v_max_u32 v19, v19, v35
    v_cmp_eq_u32 vcc, -1, v19
    s_nop 0
    s_cbranch_vccnz g_47F12_2
    v_smfmac_f32_16x16x64_bf16 v[40:43], v[32:35], a[16:23], v172
    v_smfmac_f32_16x16x64_bf16 v[44:47], v[32:35], a[80:87], v172
    v_smfmac_f32_16x16x64_bf16 v[48:51], v[32:35], a[48:55], v172
    v_smfmac_f32_16x16x64_bf16 v[52:55], v[32:35], a[112:119], v172
g_47L8_3:
    s_waitcnt vmcnt(0)
    v_max3_u32 v19, v36, v37, v38
    v_max_u32 v19, v19, v39
    v_cmp_eq_u32 vcc, -1, v19
    s_nop 0
    s_cbranch_vccnz g_47F8_3
    v_smfmac_f32_16x16x64_bf16 v[40:43], v[36:39], a[24:31], v172
    v_smfmac_f32_16x16x64_bf16 v[44:47], v[36:39], a[88:95], v172
    v_smfmac_f32_16x16x64_bf16 v[48:51], v[36:39], a[56:63], v172
    v_smfmac_f32_16x16x64_bf16 v[52:55], v[36:39], a[120:127], v172
    s_branch gc_48
g_47L15_1:
    s_waitcnt vmcnt(3)
    v_max3_u32 v19, v28, v29, v30
    v_max_u32 v19, v19, v31
    v_cmp_eq_u32 vcc, -1, v19
    s_nop 0
    s_cbranch_vccnz g_47F15_1
    v_smfmac_f32_16x16x64_bf16 v[40:43], v[28:31], a[8:15], v172
    v_smfmac_f32_16x16x64_bf16 v[44:47], v[28:31], a[72:79], v172
    v_smfmac_f32_16x16x64_bf16 v[48:51], v[28:31], a[40:47], v172
    v_smfmac_f32_16x16x64_bf16 v[52:55], v[28:31], a[104:111], v172
g_47L13_2:
    s_waitcnt vmcnt(2)
    v_max3_u32 v19, v32, v33, v34
    v_max_u32 v19, v19, v35
    v_cmp_eq_u32 vcc, -1, v19
    s_nop 0
    s_cbranch_vccnz g_47F13_2
    v_smfmac_f32_16x16x64_bf16 v[40:43], v[32:35], a[16:23], v172
    v_smfmac_f32_16x16x64_bf16 v[44:47], v[32:35], a[80:87], v172
    v_smfmac_f32_16x16x64_bf16 v[48:51], v[32:35], a[48:55], v172
    v_smfmac_f32_16x16x64_bf16 v[52:55], v[32:35], a[112:119], v172
g_47L9_3:
    s_waitcnt vmcnt(1)
    v_max3_u32 v19, v36, v37, v38
    v_max_u32 v19, v19, v39
    v_cmp_eq_u32 vcc, -1, v19
    s_nop 0
    s_cbranch_vccnz g_47F9_3
    v_smfmac_f32_16x16x64_bf16 v[40:43], v[36:39], a[24:31], v172
    v_smfmac_f32_16x16x64_bf16 v[44:47], v[36:39], a[88:95], v172
    v_smfmac_f32_16x16x64_bf16 v[48:51], v[36:39], a[56:63], v172
    v_smfmac_f32_16x16x64_bf16 v[52:55], v[36:39], a[120:127], v172
g_47L1_0:
    s_waitcnt vmcnt(0)
    v_max3_u32 v19, v24, v25, v26
    v_max_u32 v19, v19, v27
    v_cmp_eq_u32 vcc, -1, v19
    s_nop 0
    s_cbranch_vccnz g_47F1_0
    v_smfmac_f32_16x16x64_bf16 v[40:43], v[24:27], a[0:7], v172
    v_smfmac_f32_16x16x64_bf16 v[44:47], v[24:27], a[64:71], v172
    v_smfmac_f32_16x16x64_bf16 v[48:51], v[24:27], a[32:39], v172
    v_smfmac_f32_16x16x64_bf16 v[52:55], v[24:27], a[96:103], v172
    s_branch gc_48
g_47L15_2:
    s_waitcnt vmcnt(3)
    v_max3_u32 v19, v32, v33, v34
    v_max_u32 v19, v19, v35
    v_cmp_eq_u32 vcc, -1, v19
    s_nop 0
    s_cbranch_vccnz g_47F15_2
    v_smfmac_f32_16x16x64_bf16 v[40:43], v[32:35], a[16:23], v172
    v_smfmac_f32_16x16x64_bf16 v[44:47], v[32:35], a[80:87], v172
    v_smfmac_f32_16x16x64_bf16 v[48:51], v[32:35], a[48:55], v172
    v_smfmac_f32_16x16x64_bf16 v[52:55], v[32:35], a[112:119], v172
g_47L11_3:
    s_waitcnt vmcnt(2)
    v_max3_u32 v19, v36, v37, v38
    v_max_u32 v19, v19, v39
    v_cmp_eq_u32 vcc, -1, v19
    s_nop 0
    s_cbranch_vccnz g_47F11_3
    v_smfmac_f32_16x16x64_bf16 v[40:43], v[36:39], a[24:31], v172
    v_smfmac_f32_16x16x64_bf16 v[44:47], v[36:39], a[88:95], v172
    v_smfmac_f32_16x16x64_bf16 v[48:51], v[36:39], a[56:63], v172
    v_smfmac_f32_16x16x64_bf16 v[52:55], v[36:39], a[120:127], v172
g_47L3_0:
    s_waitcnt vmcnt(1)
    v_max3_u32 v19, v24, v25, v26
    v_max_u32 v19, v19, v27
    v_cmp_eq_u32 vcc, -1, v19
    s_nop 0
    s_cbranch_vccnz g_47F3_0
    v_smfmac_f32_16x16x64_bf16 v[40:43], v[24:27], a[0:7], v172
    v_smfmac_f32_16x16x64_bf16 v[44:47], v[24:27], a[64:71], v172
    v_smfmac_f32_16x16x64_bf16 v[48:51], v[24:27], a[32:39], v172
    v_smfmac_f32_16x16x64_bf16 v[52:55], v[24:27], a[96:103], v172
g_47L2_1:
    s_waitcnt vmcnt(0)
    v_max3_u32 v19, v28, v29, v30
    v_max_u32 v19, v19, v31
    v_cmp_eq_u32 vcc, -1, v19
    s_nop 0
    s_cbranch_vccnz g_47F2_1
    v_smfmac_f32_16x16x64_bf16 v[40:43], v[28:31], a[8:15], v172
    v_smfmac_f32_16x16x64_bf16 v[44:47], v[28:31], a[72:79], v172
    v_smfmac_f32_16x16x64_bf16 v[48:51], v[28:31], a[40:47], v172
    v_smfmac_f32_16x16x64_bf16 v[52:55], v[28:31], a[104:111], v172
    s_branch gc_48
g_47L15_3:
    s_waitcnt vmcnt(3)
    v_max3_u32 v19, v36, v37, v38
    v_max_u32 v19, v19, v39
    v_cmp_eq_u32 vcc, -1, v19
    s_nop 0
    s_cbranch_vccnz g_47F15_3
    v_smfmac_f32_16x16x64_bf16 v[40:43], v[36:39], a[24:31], v172
    v_smfmac_f32_16x16x64_bf16 v[44:47], v[36:39], a[88:95], v172
    v_smfmac_f32_16x16x64_bf16 v[48:51], v[36:39], a[56:63], v172
    v_smfmac_f32_16x16x64_bf16 v[52:55], v[36:39], a[120:127], v172
g_47L7_0:
    s_waitcnt vmcnt(2)
    v_max3_u32 v19, v24, v25, v26
    v_max_u32 v19, v19, v27
    v_cmp_eq_u32 vcc, -1, v19
    s_nop 0
    s_cbranch_vccnz g_47F7_0
    v_smfmac_f32_16x16x64_bf16 v[40:43], v[24:27], a[0:7], v172
    v_smfmac_f32_16x16x64_bf16 v[44:47], v[24:27], a[64:71], v172
    v_smfmac_f32_16x16x64_bf16 v[48:51], v[24:27], a[32:39], v172
    v_smfmac_f32_16x16x64_bf16 v[52:55], v[24:27], a[96:103], v172
g_47L6_1:
    s_waitcnt vmcnt(1)
    v_max3_u32 v19, v28, v29, v30
    v_max_u32 v19, v19, v31
    v_cmp_eq_u32 vcc, -1, v19
    s_nop 0
    s_cbranch_vccnz g_47F6_1
    v_smfmac_f32_16x16x64_bf16 v[40:43], v[28:31], a[8:15], v172
    v_smfmac_f32_16x16x64_bf16 v[44:47], v[28:31], a[72:79], v172
    v_smfmac_f32_16x16x64_bf16 v[48:51], v[28:31], a[40:47], v172
    v_smfmac_f32_16x16x64_bf16 v[52:55], v[28:31], a[104:111], v172
g_47L4_2:
    s_waitcnt vmcnt(0)
    v_max3_u32 v19, v32, v33, v34
    v_max_u32 v19, v19, v35
    v_cmp_eq_u32 vcc, -1, v19
    s_nop 0
    s_cbranch_vccnz g_47F4_2
    v_smfmac_f32_16x16x64_bf16 v[40:43], v[32:35], a[16:23], v172
    v_smfmac_f32_16x16x64_bf16 v[44:47], v[32:35], a[80:87], v172
    v_smfmac_f32_16x16x64_bf16 v[48:51], v[32:35], a[48:55], v172
    v_smfmac_f32_16x16x64_bf16 v[52:55], v[32:35], a[112:119], v172
    s_branch gc_48
g_47L7_1:
    s_waitcnt vmcnt(2)
    v_max3_u32 v19, v28, v29, v30
    v_max_u32 v19, v19, v31
    v_cmp_eq_u32 vcc, -1, v19
    s_nop 0
    s_cbranch_vccnz g_47F7_1
    v_smfmac_f32_16x16x64_bf16 v[40:43], v[28:31], a[8:15], v172
    v_smfmac_f32_16x16x64_bf16 v[44:47], v[28:31], a[72:79], v172
    v_smfmac_f32_16x16x64_bf16 v[48:51], v[28:31], a[40:47], v172
    v_smfmac_f32_16x16x64_bf16 v[52:55], v[28:31], a[104:111], v172
g_47L5_2:
    s_waitcnt vmcnt(1)
    v_max3_u32 v19, v32, v33, v34
    v_max_u32 v19, v19, v35
    v_cmp_eq_u32 vcc, -1, v19
    s_nop 0
    s_cbranch_vccnz g_47F5_2
    v_smfmac_f32_16x16x64_bf16 v[40:43], v[32:35], a[16:23], v172
    v_smfmac_f32_16x16x64_bf16 v[44:47], v[32:35], a[80:87], v172
    v_smfmac_f32_16x16x64_bf16 v[48:51], v[32:35], a[48:55], v172
    v_smfmac_f32_16x16x64_bf16 v[52:55], v[32:35], a[112:119], v172
    s_branch g_47L1_0
g_47L7_2:
    s_waitcnt vmcnt(2)
    v_max3_u32 v19, v32, v33, v34
    v_max_u32 v19, v19, v35
    v_cmp_eq_u32 vcc, -1, v19
    s_nop 0
    s_cbranch_vccnz g_47F7_2
    v_smfmac_f32_16x16x64_bf16 v[40:43], v[32:35], a[16:23], v172
    v_smfmac_f32_16x16x64_bf16 v[44:47], v[32:35], a[80:87], v172
    v_smfmac_f32_16x16x64_bf16 v[48:51], v[32:35], a[48:55], v172
    v_smfmac_f32_16x16x64_bf16 v[52:55], v[32:35], a[112:119], v172
    s_branch g_47L3_0
g_47L11_0:
    s_waitcnt vmcnt(2)
    v_max3_u32 v19, v24, v25, v26
    v_max_u32 v19, v19, v27
    v_cmp_eq_u32 vcc, -1, v19
    s_nop 0
    s_cbranch_vccnz g_47F11_0
    v_smfmac_f32_16x16x64_bf16 v[40:43], v[24:27], a[0:7], v172
    v_smfmac_f32_16x16x64_bf16 v[44:47], v[24:27], a[64:71], v172
    v_smfmac_f32_16x16x64_bf16 v[48:51], v[24:27], a[32:39], v172
    v_smfmac_f32_16x16x64_bf16 v[52:55], v[24:27], a[96:103], v172
g_47L10_1:
    s_waitcnt vmcnt(1)
    v_max3_u32 v19, v28, v29, v30
    v_max_u32 v19, v19, v31
    v_cmp_eq_u32 vcc, -1, v19
    s_nop 0
    s_cbranch_vccnz g_47F10_1
    v_smfmac_f32_16x16x64_bf16 v[40:43], v[28:31], a[8:15], v172
    v_smfmac_f32_16x16x64_bf16 v[44:47], v[28:31], a[72:79], v172
    v_smfmac_f32_16x16x64_bf16 v[48:51], v[28:31], a[40:47], v172
    v_smfmac_f32_16x16x64_bf16 v[52:55], v[28:31], a[104:111], v172
    s_branch g_47L8_3
g_47L11_1:
    s_waitcnt vmcnt(2)
    v_max3_u32 v19, v28, v29, v30
    v_max_u32 v19, v19, v31
    v_cmp_eq_u32 vcc, -1, v19
    s_nop 0
    s_cbranch_vccnz g_47F11_1
    v_smfmac_f32_16x16x64_bf16 v[40:43], v[28:31], a[8:15], v172
    v_smfmac_f32_16x16x64_bf16 v[44:47], v[28:31], a[72:79], v172
    v_smfmac_f32_16x16x64_bf16 v[48:51], v[28:31], a[40:47], v172
    v_smfmac_f32_16x16x64_bf16 v[52:55], v[28:31], a[104:111], v172
    s_branch g_47L9_3
g_47L13_0:
    s_waitcnt vmcnt(2)
    v_max3_u32 v19, v24, v25, v26
    v_max_u32 v19, v19, v27
    v_cmp_eq_u32 vcc, -1, v19
    s_nop 0
    s_cbranch_vccnz g_47F13_0
    v_smfmac_f32_16x16x64_bf16 v[40:43], v[24:27], a[0:7], v172
    v_smfmac_f32_16x16x64_bf16 v[44:47], v[24:27], a[64:71], v172
    v_smfmac_f32_16x16x64_bf16 v[48:51], v[24:27], a[32:39], v172
    v_smfmac_f32_16x16x64_bf16 v[52:55], v[24:27], a[96:103], v172
    s_branch g_47L12_2
g_47L13_3:
    s_waitcnt vmcnt(2)
    v_max3_u32 v19, v36, v37, v38
    v_max_u32 v19, v19, v39
    v_cmp_eq_u32 vcc, -1, v19
    s_nop 0
    s_cbranch_vccnz g_47F13_3
    v_smfmac_f32_16x16x64_bf16 v[40:43], v[36:39], a[24:31], v172
    v_smfmac_f32_16x16x64_bf16 v[44:47], v[36:39], a[88:95], v172
    v_smfmac_f32_16x16x64_bf16 v[48:51], v[36:39], a[56:63], v172
    v_smfmac_f32_16x16x64_bf16 v[52:55], v[36:39], a[120:127], v172
g_47L5_0:
    s_waitcnt vmcnt(1)
    v_max3_u32 v19, v24, v25, v26
    v_max_u32 v19, v19, v27
    v_cmp_eq_u32 vcc, -1, v19
    s_nop 0
    s_cbranch_vccnz g_47F5_0
    v_smfmac_f32_16x16x64_bf16 v[40:43], v[24:27], a[0:7], v172
    v_smfmac_f32_16x16x64_bf16 v[44:47], v[24:27], a[64:71], v172
    v_smfmac_f32_16x16x64_bf16 v[48:51], v[24:27], a[32:39], v172
    v_smfmac_f32_16x16x64_bf16 v[52:55], v[24:27], a[96:103], v172
    s_branch g_47L4_2
g_47L14_2:
    s_waitcnt vmcnt(2)
    v_max3_u32 v19, v32, v33, v34
    v_max_u32 v19, v19, v35
    v_cmp_eq_u32 vcc, -1, v19
    s_nop 0
    s_cbranch_vccnz g_47F14_2
    v_smfmac_f32_16x16x64_bf16 v[40:43], v[32:35], a[16:23], v172
    v_smfmac_f32_16x16x64_bf16 v[44:47], v[32:35], a[80:87], v172
    v_smfmac_f32_16x16x64_bf16 v[48:51], v[32:35], a[48:55], v172
    v_smfmac_f32_16x16x64_bf16 v[52:55], v[32:35], a[112:119], v172
g_47L10_3:
    s_waitcnt vmcnt(1)
    v_max3_u32 v19, v36, v37, v38
    v_max_u32 v19, v19, v39
    v_cmp_eq_u32 vcc, -1, v19
    s_nop 0
    s_cbranch_vccnz g_47F10_3
    v_smfmac_f32_16x16x64_bf16 v[40:43], v[36:39], a[24:31], v172
    v_smfmac_f32_16x16x64_bf16 v[44:47], v[36:39], a[88:95], v172
    v_smfmac_f32_16x16x64_bf16 v[48:51], v[36:39], a[56:63], v172
    v_smfmac_f32_16x16x64_bf16 v[52:55], v[36:39], a[120:127], v172
    s_branch g_47L2_1
g_47L14_3:
    s_waitcnt vmcnt(2)
    v_max3_u32 v19, v36, v37, v38
    v_max_u32 v19, v19, v39
    v_cmp_eq_u32 vcc, -1, v19
    s_nop 0
    s_cbranch_vccnz g_47F14_3
    v_smfmac_f32_16x16x64_bf16 v[40:43], v[36:39], a[24:31], v172
    v_smfmac_f32_16x16x64_bf16 v[44:47], v[36:39], a[88:95], v172
    v_smfmac_f32_16x16x64_bf16 v[48:51], v[36:39], a[56:63], v172
    v_smfmac_f32_16x16x64_bf16 v[52:55], v[36:39], a[120:127], v172
    s_branch g_47L6_1
g_47L3_1:
    s_waitcnt vmcnt(1)
    v_max3_u32 v19, v28, v29, v30
    v_max_u32 v19, v19, v31
    v_cmp_eq_u32 vcc, -1, v19
    s_nop 0
    s_cbranch_vccnz g_47F3_1
    v_smfmac_f32_16x16x64_bf16 v[40:43], v[28:31], a[8:15], v172
    v_smfmac_f32_16x16x64_bf16 v[44:47], v[28:31], a[72:79], v172
    v_smfmac_f32_16x16x64_bf16 v[48:51], v[28:31], a[40:47], v172
    v_smfmac_f32_16x16x64_bf16 v[52:55], v[28:31], a[104:111], v172
    s_branch g_47L1_0
g_47L6_2:
    s_waitcnt vmcnt(1)
    v_max3_u32 v19, v32, v33, v34
    v_max_u32 v19, v19, v35
    v_cmp_eq_u32 vcc, -1, v19
    s_nop 0
    s_cbranch_vccnz g_47F6_2
    v_smfmac_f32_16x16x64_bf16 v[40:43], v[32:35], a[16:23], v172
    v_smfmac_f32_16x16x64_bf16 v[44:47], v[32:35], a[80:87], v172
    v_smfmac_f32_16x16x64_bf16 v[48:51], v[32:35], a[48:55], v172
    v_smfmac_f32_16x16x64_bf16 v[52:55], v[32:35], a[112:119], v172
    s_branch g_47L2_1
g_47L9_0:
    s_waitcnt vmcnt(1)
    v_max3_u32 v19, v24, v25, v26
    v_max_u32 v19, v19, v27
    v_cmp_eq_u32 vcc, -1, v19
    s_nop 0
    s_cbranch_vccnz g_47F9_0
    v_smfmac_f32_16x16x64_bf16 v[40:43], v[24:27], a[0:7], v172
    v_smfmac_f32_16x16x64_bf16 v[44:47], v[24:27], a[64:71], v172
    v_smfmac_f32_16x16x64_bf16 v[48:51], v[24:27], a[32:39], v172
    v_smfmac_f32_16x16x64_bf16 v[52:55], v[24:27], a[96:103], v172
    s_branch g_47L8_3
g_47L12_3:
    s_waitcnt vmcnt(1)
    v_max3_u32 v19, v36, v37, v38
    v_max_u32 v19, v19, v39
    v_cmp_eq_u32 vcc, -1, v19
    s_nop 0
    s_cbranch_vccnz g_47F12_3
    v_smfmac_f32_16x16x64_bf16 v[40:43], v[36:39], a[24:31], v172
    v_smfmac_f32_16x16x64_bf16 v[44:47], v[36:39], a[88:95], v172
    v_smfmac_f32_16x16x64_bf16 v[48:51], v[36:39], a[56:63], v172
    v_smfmac_f32_16x16x64_bf16 v[52:55], v[36:39], a[120:127], v172
    s_branch g_47L4_2
g_47F15_0:
    s_mov_b64 exec, vcc
    buffer_load_dwordx4 v[24:27], v2, s[4:7], s16 offen offset:0 sc1
    s_mov_b64 exec, -1
    s_add_u32 s23, s23, 1
    s_cmp_lt_u32 s23, 200000
    s_cbranch_scc1 g_47L15_1
    s_mov_b32 s25, 200000
    s_branch gc_48
g_47F15_1:
    s_mov_b64 exec, vcc
    buffer_load_dwordx4 v[28:31], v2, s[4:7], s16 offen offset:1024 sc1
    s_mov_b64 exec, -1
    s_add_u32 s23, s23, 1
    s_cmp_lt_u32 s23, 200000
    s_cbranch_scc1 g_47L15_2
    s_mov_b32 s25, 200000
    s_branch gc_48
g_47F15_2:
    s_mov_b64 exec, vcc
    buffer_load_dwordx4 v[32:35], v2, s[4:7], s16 offen offset:2048 sc1
    s_mov_b64 exec, -1
    s_add_u32 s23, s23, 1
    s_cmp_lt_u32 s23, 200000
    s_cbranch_scc1 g_47L15_3
    s_mov_b32 s25, 200000
    s_branch gc_48
g_47F15_3:
    s_mov_b64 exec, vcc
    buffer_load_dwordx4 v[36:39], v2, s[4:7], s16 offen offset:3072 sc1
    s_mov_b64 exec, -1
    s_add_u32 s23, s23, 1
    s_cmp_lt_u32 s23, 200000
    s_cbranch_scc1 g_47L15_0
    s_mov_b32 s25, 200000
    s_branch gc_48
g_47F7_0:
    s_mov_b64 exec, vcc
    buffer_load_dwordx4 v[24:27], v2, s[4:7], s16 offen offset:0 sc1
    s_mov_b64 exec, -1
    s_add_u32 s23, s23, 1
    s_cmp_lt_u32 s23, 200000
    s_cbranch_scc1 g_47L7_1
    s_mov_b32 s25, 200000
    s_branch gc_48
g_47F7_1:
    s_mov_b64 exec, vcc
    buffer_load_dwordx4 v[28:31], v2, s[4:7], s16 offen offset:1024 sc1
    s_mov_b64 exec, -1
    s_add_u32 s23, s23, 1
    s_cmp_lt_u32 s23, 200000
    s_cbranch_scc1 g_47L7_2
    s_mov_b32 s25, 200000
    s_branch gc_48
g_47F7_2:
    s_mov_b64 exec, vcc
    buffer_load_dwordx4 v[32:35], v2, s[4:7], s16 offen offset:2048 sc1
    s_mov_b64 exec, -1
    s_add_u32 s23, s23, 1
    s_cmp_lt_u32 s23, 200000
    s_cbranch_scc1 g_47L7_0
    s_mov_b32 s25, 200000
    s_branch gc_48
g_47F11_0:
    s_mov_b64 exec, vcc
    buffer_load_dwordx4 v[24:27], v2, s[4:7], s16 offen offset:0 sc1
    s_mov_b64 exec, -1
    s_add_u32 s23, s23, 1
    s_cmp_lt_u32 s23, 200000
    s_cbranch_scc1 g_47L11_1
    s_mov_b32 s25, 200000
    s_branch gc_48
g_47F11_1:
    s_mov_b64 exec, vcc
    buffer_load_dwordx4 v[28:31], v2, s[4:7], s16 offen offset:1024 sc1
    s_mov_b64 exec, -1
    s_add_u32 s23, s23, 1
    s_cmp_lt_u32 s23, 200000
    s_cbranch_scc1 g_47L11_3
    s_mov_b32 s25, 200000
    s_branch gc_48
g_47F11_3:
    s_mov_b64 exec, vcc
    buffer_load_dwordx4 v[36:39], v2, s[4:7], s16 offen offset:3072 sc1
    s_mov_b64 exec, -1
    s_add_u32 s23, s23, 1
    s_cmp_lt_u32 s23, 200000
    s_cbranch_scc1 g_47L11_0
    s_mov_b32 s25, 200000
    s_branch gc_48
g_47F13_0:
    s_mov_b64 exec, vcc
    buffer_load_dwordx4 v[24:27], v2, s[4:7], s16 offen offset:0 sc1
    s_mov_b64 exec, -1
    s_add_u32 s23, s23, 1
    s_cmp_lt_u32 s23, 200000
    s_cbranch_scc1 g_47L13_2
    s_mov_b32 s25, 200000
    s_branch gc_48
g_47F13_2:
    s_mov_b64 exec, vcc
    buffer_load_dwordx4 v[32:35], v2, s[4:7], s16 offen offset:2048 sc1
    s_mov_b64 exec, -1
    s_add_u32 s23, s23, 1
    s_cmp_lt_u32 s23, 200000
    s_cbranch_scc1 g_47L13_3
    s_mov_b32 s25, 200000
    s_branch gc_48
g_47F13_3:
    s_mov_b64 exec, vcc
    buffer_load_dwordx4 v[36:39], v2, s[4:7], s16 offen offset:3072 sc1
    s_mov_b64 exec, -1
    s_add_u32 s23, s23, 1
    s_cmp_lt_u32 s23, 200000
    s_cbranch_scc1 g_47L13_0
    s_mov_b32 s25, 200000
    s_branch gc_48
g_47F14_1:
    s_mov_b64 exec, vcc
    buffer_load_dwordx4 v[28:31], v2, s[4:7], s16 offen offset:1024 sc1
    s_mov_b64 exec, -1
    s_add_u32 s23, s23, 1
    s_cmp_lt_u32 s23, 200000
    s_cbranch_scc1 g_47L14_2
    s_mov_b32 s25, 200000
    s_branch gc_48
g_47F14_2:
    s_mov_b64 exec, vcc
    buffer_load_dwordx4 v[32:35], v2, s[4:7], s16 offen offset:2048 sc1
    s_mov_b64 exec, -1
    s_add_u32 s23, s23, 1
    s_cmp_lt_u32 s23, 200000
    s_cbranch_scc1 g_47L14_3
    s_mov_b32 s25, 200000
    s_branch gc_48
g_47F14_3:
    s_mov_b64 exec, vcc
    buffer_load_dwordx4 v[36:39], v2, s[4:7], s16 offen offset:3072 sc1
    s_mov_b64 exec, -1
    s_add_u32 s23, s23, 1
    s_cmp_lt_u32 s23, 200000
    s_cbranch_scc1 g_47L14_1
    s_mov_b32 s25, 200000
    s_branch gc_48
g_47F3_0:
    s_mov_b64 exec, vcc
    buffer_load_dwordx4 v[24:27], v2, s[4:7], s16 offen offset:0 sc1
    s_mov_b64 exec, -1
    s_add_u32 s23, s23, 1
    s_cmp_lt_u32 s23, 200000
    s_cbranch_scc1 g_47L3_1
    s_mov_b32 s25, 200000
    s_branch gc_48
g_47F3_1:
    s_mov_b64 exec, vcc
    buffer_load_dwordx4 v[28:31], v2, s[4:7], s16 offen offset:1024 sc1
    s_mov_b64 exec, -1
    s_add_u32 s23, s23, 1
    s_cmp_lt_u32 s23, 200000
    s_cbranch_scc1 g_47L3_0
    s_mov_b32 s25, 200000
    s_branch gc_48
g_47F5_0:
    s_mov_b64 exec, vcc
    buffer_load_dwordx4 v[24:27], v2, s[4:7], s16 offen offset:0 sc1
    s_mov_b64 exec, -1
    s_add_u32 s23, s23, 1
    s_cmp_lt_u32 s23, 200000
    s_cbranch_scc1 g_47L5_2
    s_mov_b32 s25, 200000
    s_branch gc_48
g_47F5_2:
    s_mov_b64 exec, vcc
    buffer_load_dwordx4 v[32:35], v2, s[4:7], s16 offen offset:2048 sc1
    s_mov_b64 exec, -1
    s_add_u32 s23, s23, 1
    s_cmp_lt_u32 s23, 200000
    s_cbranch_scc1 g_47L5_0
    s_mov_b32 s25, 200000
    s_branch gc_48
g_47F6_1:
    s_mov_b64 exec, vcc
    buffer_load_dwordx4 v[28:31], v2, s[4:7], s16 offen offset:1024 sc1
    s_mov_b64 exec, -1
    s_add_u32 s23, s23, 1
    s_cmp_lt_u32 s23, 200000
    s_cbranch_scc1 g_47L6_2
    s_mov_b32 s25, 200000
    s_branch gc_48
g_47F6_2:
    s_mov_b64 exec, vcc
    buffer_load_dwordx4 v[32:35], v2, s[4:7], s16 offen offset:2048 sc1
    s_mov_b64 exec, -1
    s_add_u32 s23, s23, 1
    s_cmp_lt_u32 s23, 200000
    s_cbranch_scc1 g_47L6_1
    s_mov_b32 s25, 200000
    s_branch gc_48
g_47F9_0:
    s_mov_b64 exec, vcc
    buffer_load_dwordx4 v[24:27], v2, s[4:7], s16 offen offset:0 sc1
    s_mov_b64 exec, -1
    s_add_u32 s23, s23, 1
    s_cmp_lt_u32 s23, 200000
    s_cbranch_scc1 g_47L9_3
    s_mov_b32 s25, 200000
    s_branch gc_48
g_47F9_3:
    s_mov_b64 exec, vcc
    buffer_load_dwordx4 v[36:39], v2, s[4:7], s16 offen offset:3072 sc1
    s_mov_b64 exec, -1
    s_add_u32 s23, s23, 1
    s_cmp_lt_u32 s23, 200000
    s_cbranch_scc1 g_47L9_0
    s_mov_b32 s25, 200000
    s_branch gc_48
g_47F10_1:
    s_mov_b64 exec, vcc
    buffer_load_dwordx4 v[28:31], v2, s[4:7], s16 offen offset:1024 sc1
    s_mov_b64 exec, -1
    s_add_u32 s23, s23, 1
    s_cmp_lt_u32 s23, 200000
    s_cbranch_scc1 g_47L10_3
    s_mov_b32 s25, 200000
    s_branch gc_48
g_47F10_3:
    s_mov_b64 exec, vcc
    buffer_load_dwordx4 v[36:39], v2, s[4:7], s16 offen offset:3072 sc1
    s_mov_b64 exec, -1
    s_add_u32 s23, s23, 1
    s_cmp_lt_u32 s23, 200000
    s_cbranch_scc1 g_47L10_1
    s_mov_b32 s25, 200000
    s_branch gc_48
g_47F12_2:
    s_mov_b64 exec, vcc
    buffer_load_dwordx4 v[32:35], v2, s[4:7], s16 offen offset:2048 sc1
    s_mov_b64 exec, -1
    s_add_u32 s23, s23, 1
    s_cmp_lt_u32 s23, 200000
    s_cbranch_scc1 g_47L12_3
    s_mov_b32 s25, 200000
    s_branch gc_48
g_47F12_3:
    s_mov_b64 exec, vcc
    buffer_load_dwordx4 v[36:39], v2, s[4:7], s16 offen offset:3072 sc1
    s_mov_b64 exec, -1
    s_add_u32 s23, s23, 1
    s_cmp_lt_u32 s23, 200000
    s_cbranch_scc1 g_47L12_2
    s_mov_b32 s25, 200000
    s_branch gc_48
g_47F1_0:
    s_mov_b64 exec, vcc
    buffer_load_dwordx4 v[24:27], v2, s[4:7], s16 offen offset:0 sc1
    s_mov_b64 exec, -1
    s_add_u32 s23, s23, 1
    s_cmp_lt_u32 s23, 200000
    s_cbranch_scc1 g_47L1_0
    s_mov_b32 s25, 200000
    s_branch gc_48
g_47F2_1:
    s_mov_b64 exec, vcc
    buffer_load_dwordx4 v[28:31], v2, s[4:7], s16 offen offset:1024 sc1
    s_mov_b64 exec, -1
    s_add_u32 s23, s23, 1
    s_cmp_lt_u32 s23, 200000
    s_cbranch_scc1 g_47L2_1
    s_mov_b32 s25, 200000
    s_branch gc_48
g_47F4_2:
    s_mov_b64 exec, vcc
    buffer_load_dwordx4 v[32:35], v2, s[4:7], s16 offen offset:2048 sc1
    s_mov_b64 exec, -1
    s_add_u32 s23, s23, 1
    s_cmp_lt_u32 s23, 200000
    s_cbranch_scc1 g_47L4_2
    s_mov_b32 s25, 200000
    s_branch gc_48
g_47F8_3:
    s_mov_b64 exec, vcc
    buffer_load_dwordx4 v[36:39], v2, s[4:7], s16 offen offset:3072 sc1
    s_mov_b64 exec, -1
    s_add_u32 s23, s23, 1
    s_cmp_lt_u32 s23, 200000
    s_cbranch_scc1 g_47L8_3
    s_mov_b32 s25, 200000
    s_branch gc_48
g_49L15_0:
    s_waitcnt vmcnt(3)
    v_max3_u32 v19, v24, v25, v26
    v_max_u32 v19, v19, v27
    v_cmp_eq_u32 vcc, -1, v19
    s_nop 0
    s_cbranch_vccnz g_49F15_0
    v_smfmac_f32_16x16x64_bf16 v[64:67], v[24:27], a[192:199], v172
    v_smfmac_f32_16x16x64_bf16 v[68:71], v[24:27], a[224:231], v172
g_49L14_1:
    s_waitcnt vmcnt(2)
    v_max3_u32 v19, v28, v29, v30
    v_max_u32 v19, v19, v31
    v_cmp_eq_u32 vcc, -1, v19
    s_nop 0
    s_cbranch_vccnz g_49F14_1
    v_smfmac_f32_16x16x64_bf16 v[64:67], v[28:31], a[200:207], v172
    v_smfmac_f32_16x16x64_bf16 v[68:71], v[28:31], a[232:239], v172
g_49L12_2:
    s_waitcnt vmcnt(1)
    v_max3_u32 v19, v32, v33, v34
    v_max_u32 v19, v19, v35
    v_cmp_eq_u32 vcc, -1, v19
    s_nop 0
    s_cbranch_vccnz g_49F12_2
    v_smfmac_f32_16x16x64_bf16 v[64:67], v[32:35], a[208:215], v172
    v_smfmac_f32_16x16x64_bf16 v[68:71], v[32:35], a[240:247], v172
g_49L8_3:
    s_waitcnt vmcnt(0)
    v_max3_u32 v19, v36, v37, v38
    v_max_u32 v19, v19, v39
    v_cmp_eq_u32 vcc, -1, v19
    s_nop 0
    s_cbranch_vccnz g_49F8_3
    v_smfmac_f32_16x16x64_bf16 v[64:67], v[36:39], a[216:223], v172
    v_smfmac_f32_16x16x64_bf16 v[68:71], v[36:39], a[248:255], v172
    s_nop 4
    v_cvt_pk_bf16_f32 v80, v64, v65
    v_cvt_pk_bf16_f32 v81, v66, v67
    s_nop 0
    v_cvt_pk_bf16_f32 v82, v68, v69
    v_cvt_pk_bf16_f32 v83, v70, v71
    s_nop 1
    v_mfma_f32_16x16x32_bf16 v[88:91], v[80:83], v[84:87], 0
    s_branch gc_50
g_49L15_1:
    s_waitcnt vmcnt(3)
    v_max3_u32 v19, v28, v29, v30
    v_max_u32 v19, v19, v31
    v_cmp_eq_u32 vcc, -1, v19
    s_nop 0
    s_cbranch_vccnz g_49F15_1
    v_smfmac_f32_16x16x64_bf16 v[64:67], v[28:31], a[200:207], v172
    v_smfmac_f32_16x16x64_bf16 v[68:71], v[28:31], a[232:239], v172
g_49L13_2:
    s_waitcnt vmcnt(2)
    v_max3_u32 v19, v32, v33, v34
    v_max_u32 v19, v19, v35
    v_cmp_eq_u32 vcc, -1, v19
    s_nop 0
    s_cbranch_vccnz g_49F13_2
    v_smfmac_f32_16x16x64_bf16 v[64:67], v[32:35], a[208:215], v172
    v_smfmac_f32_16x16x64_bf16 v[68:71], v[32:35], a[240:247], v172
g_49L9_3:
    s_waitcnt vmcnt(1)
    v_max3_u32 v19, v36, v37, v38
    v_max_u32 v19, v19, v39
    v_cmp_eq_u32 vcc, -1, v19
    s_nop 0
    s_cbranch_vccnz g_49F9_3
    v_smfmac_f32_16x16x64_bf16 v[64:67], v[36:39], a[216:223], v172
    v_smfmac_f32_16x16x64_bf16 v[68:71], v[36:39], a[248:255], v172
g_49L1_0:
    s_waitcnt vmcnt(0)
    v_max3_u32 v19, v24, v25, v26
    v_max_u32 v19, v19, v27
    v_cmp_eq_u32 vcc, -1, v19
    s_nop 0
    s_cbranch_vccnz g_49F1_0
    v_smfmac_f32_16x16x64_bf16 v[64:67], v[24:27], a[192:199], v172
    v_smfmac_f32_16x16x64_bf16 v[68:71], v[24:27], a[224:231], v172
    s_nop 4
    v_cvt_pk_bf16_f32 v80, v64, v65
    v_cvt_pk_bf16_f32 v81, v66, v67
    s_nop 0
    v_cvt_pk_bf16_f32 v82, v68, v69
    v_cvt_pk_bf16_f32 v83, v70, v71
    s_nop 1
    v_mfma_f32_16x16x32_bf16 v[88:91], v[80:83], v[84:87], 0
    s_branch gc_50
g_49L15_2:
    s_waitcnt vmcnt(3)
    v_max3_u32 v19, v32, v33, v34
    v_max_u32 v19, v19, v35
    v_cmp_eq_u32 vcc, -1, v19
    s_nop 0
    s_cbranch_vccnz g_49F15_2
    v_smfmac_f32_16x16x64_bf16 v[64:67], v[32:35], a[208:215], v172
    v_smfmac_f32_16x16x64_bf16 v[68:71], v[32:35], a[240:247], v172
g_49L11_3:
    s_waitcnt vmcnt(2)
    v_max3_u32 v19, v36, v37, v38
    v_max_u32 v19, v19, v39
    v_cmp_eq_u32 vcc, -1, v19
    s_nop 0
    s_cbranch_vccnz g_49F11_3
    v_smfmac_f32_16x16x64_bf16 v[64:67], v[36:39], a[216:223], v172
    v_smfmac_f32_16x16x64_bf16 v[68:71], v[36:39], a[248:255], v172
g_49L3_0:
    s_waitcnt vmcnt(1)
    v_max3_u32 v19, v24, v25, v26
    v_max_u32 v19, v19, v27
    v_cmp_eq_u32 vcc, -1, v19
    s_nop 0
    s_cbranch_vccnz g_49F3_0
    v_smfmac_f32_16x16x64_bf16 v[64:67], v[24:27], a[192:199], v172
    v_smfmac_f32_16x16x64_bf16 v[68:71], v[24:27], a[224:231], v172
g_49L2_1:
    s_waitcnt vmcnt(0)
    v_max3_u32 v19, v28, v29, v30
    v_max_u32 v19, v19, v31
    v_cmp_eq_u32 vcc, -1, v19
    s_nop 0
    s_cbranch_vccnz g_49F2_1
    v_smfmac_f32_16x16x64_bf16 v[64:67], v[28:31], a[200:207], v172
    v_smfmac_f32_16x16x64_bf16 v[68:71], v[28:31], a[232:239], v172
    s_nop 4
    v_cvt_pk_bf16_f32 v80, v64, v65
    v_cvt_pk_bf16_f32 v81, v66, v67
    s_nop 0
    v_cvt_pk_bf16_f32 v82, v68, v69
    v_cvt_pk_bf16_f32 v83, v70, v71
    s_nop 1
    v_mfma_f32_16x16x32_bf16 v[88:91], v[80:83], v[84:87], 0
    s_branch gc_50
g_49L15_3:
    s_waitcnt vmcnt(3)
    v_max3_u32 v19, v36, v37, v38
    v_max_u32 v19, v19, v39
    v_cmp_eq_u32 vcc, -1, v19
    s_nop 0
    s_cbranch_vccnz g_49F15_3
    v_smfmac_f32_16x16x64_bf16 v[64:67], v[36:39], a[216:223], v172
    v_smfmac_f32_16x16x64_bf16 v[68:71], v[36:39], a[248:255], v172
g_49L7_0:
    s_waitcnt vmcnt(2)
    v_max3_u32 v19, v24, v25, v26
    v_max_u32 v19, v19, v27
    v_cmp_eq_u32 vcc, -1, v19
    s_nop 0
    s_cbranch_vccnz g_49F7_0
    v_smfmac_f32_16x16x64_bf16 v[64:67], v[24:27], a[192:199], v172
    v_smfmac_f32_16x16x64_bf16 v[68:71], v[24:27], a[224:231], v172
g_49L6_1:
    s_waitcnt vmcnt(1)
    v_max3_u32 v19, v28, v29, v30
    v_max_u32 v19, v19, v31
    v_cmp_eq_u32 vcc, -1, v19
    s_nop 0
    s_cbranch_vccnz g_49F6_1
    v_smfmac_f32_16x16x64_bf16 v[64:67], v[28:31], a[200:207], v172
    v_smfmac_f32_16x16x64_bf16 v[68:71], v[28:31], a[232:239], v172
g_49L4_2:
    s_waitcnt vmcnt(0)
    v_max3_u32 v19, v32, v33, v34
    v_max_u32 v19, v19, v35
    v_cmp_eq_u32 vcc, -1, v19
    s_nop 0
    s_cbranch_vccnz g_49F4_2
    v_smfmac_f32_16x16x64_bf16 v[64:67], v[32:35], a[208:215], v172
    v_smfmac_f32_16x16x64_bf16 v[68:71], v[32:35], a[240:247], v172
    s_nop 4
    v_cvt_pk_bf16_f32 v80, v64, v65
    v_cvt_pk_bf16_f32 v81, v66, v67
    s_nop 0
    v_cvt_pk_bf16_f32 v82, v68, v69
    v_cvt_pk_bf16_f32 v83, v70, v71
    s_nop 1
    v_mfma_f32_16x16x32_bf16 v[88:91], v[80:83], v[84:87], 0
    s_branch gc_50
g_49L7_1:
    s_waitcnt vmcnt(2)
    v_max3_u32 v19, v28, v29, v30
    v_max_u32 v19, v19, v31
    v_cmp_eq_u32 vcc, -1, v19
    s_nop 0
    s_cbranch_vccnz g_49F7_1
    v_smfmac_f32_16x16x64_bf16 v[64:67], v[28:31], a[200:207], v172
    v_smfmac_f32_16x16x64_bf16 v[68:71], v[28:31], a[232:239], v172
g_49L5_2:
    s_waitcnt vmcnt(1)
    v_max3_u32 v19, v32, v33, v34
    v_max_u32 v19, v19, v35
    v_cmp_eq_u32 vcc, -1, v19
    s_nop 0
    s_cbranch_vccnz g_49F5_2
    v_smfmac_f32_16x16x64_bf16 v[64:67], v[32:35], a[208:215], v172
    v_smfmac_f32_16x16x64_bf16 v[68:71], v[32:35], a[240:247], v172
    s_branch g_49L1_0
g_49L7_2:
    s_waitcnt vmcnt(2)
    v_max3_u32 v19, v32, v33, v34
    v_max_u32 v19, v19, v35
    v_cmp_eq_u32 vcc, -1, v19
    s_nop 0
    s_cbranch_vccnz g_49F7_2
    v_smfmac_f32_16x16x64_bf16 v[64:67], v[32:35], a[208:215], v172
    v_smfmac_f32_16x16x64_bf16 v[68:71], v[32:35], a[240:247], v172
    s_branch g_49L3_0
g_49L11_0:
    s_waitcnt vmcnt(2)
    v_max3_u32 v19, v24, v25, v26
    v_max_u32 v19, v19, v27
    v_cmp_eq_u32 vcc, -1, v19
    s_nop 0
    s_cbranch_vccnz g_49F11_0
    v_smfmac_f32_16x16x64_bf16 v[64:67], v[24:27], a[192:199], v172
    v_smfmac_f32_16x16x64_bf16 v[68:71], v[24:27], a[224:231], v172
g_49L10_1:
    s_waitcnt vmcnt(1)
    v_max3_u32 v19, v28, v29, v30
    v_max_u32 v19, v19, v31
    v_cmp_eq_u32 vcc, -1, v19
    s_nop 0
    s_cbranch_vccnz g_49F10_1
    v_smfmac_f32_16x16x64_bf16 v[64:67], v[28:31], a[200:207], v172
    v_smfmac_f32_16x16x64_bf16 v[68:71], v[28:31], a[232:239], v172
    s_branch g_49L8_3
g_49L11_1:
    s_waitcnt vmcnt(2)
    v_max3_u32 v19, v28, v29, v30
    v_max_u32 v19, v19, v31
    v_cmp_eq_u32 vcc, -1, v19
    s_nop 0
    s_cbranch_vccnz g_49F11_1
    v_smfmac_f32_16x16x64_bf16 v[64:67], v[28:31], a[200:207], v172
    v_smfmac_f32_16x16x64_bf16 v[68:71], v[28:31], a[232:239], v172
    s_branch g_49L9_3
g_49L13_0:
    s_waitcnt vmcnt(2)
    v_max3_u32 v19, v24, v25, v26
    v_max_u32 v19, v19, v27
    v_cmp_eq_u32 vcc, -1, v19
    s_nop 0
    s_cbranch_vccnz g_49F13_0
    v_smfmac_f32_16x16x64_bf16 v[64:67], v[24:27], a[192:199], v172
    v_smfmac_f32_16x16x64_bf16 v[68:71], v[24:27], a[224:231], v172
    s_branch g_49L12_2
g_49L13_3:
    s_waitcnt vmcnt(2)
    v_max3_u32 v19, v36, v37, v38
    v_max_u32 v19, v19, v39
    v_cmp_eq_u32 vcc, -1, v19
    s_nop 0
    s_cbranch_vccnz g_49F13_3
    v_smfmac_f32_16x16x64_bf16 v[64:67], v[36:39], a[216:223], v172
    v_smfmac_f32_16x16x64_bf16 v[68:71], v[36:39], a[248:255], v172
g_49L5_0:
    s_waitcnt vmcnt(1)
    v_max3_u32 v19, v24, v25, v26
    v_max_u32 v19, v19, v27
    v_cmp_eq_u32 vcc, -1, v19
    s_nop 0
    s_cbranch_vccnz g_49F5_0
    v_smfmac_f32_16x16x64_bf16 v[64:67], v[24:27], a[192:199], v172
    v_smfmac_f32_16x16x64_bf16 v[68:71], v[24:27], a[224:231], v172
    s_branch g_49L4_2
g_49L14_2:
    s_waitcnt vmcnt(2)
    v_max3_u32 v19, v32, v33, v34
    v_max_u32 v19, v19, v35
    v_cmp_eq_u32 vcc, -1, v19
    s_nop 0
    s_cbranch_vccnz g_49F14_2
    v_smfmac_f32_16x16x64_bf16 v[64:67], v[32:35], a[208:215], v172
    v_smfmac_f32_16x16x64_bf16 v[68:71], v[32:35], a[240:247], v172
g_49L10_3:
    s_waitcnt vmcnt(1)
    v_max3_u32 v19, v36, v37, v38
    v_max_u32 v19, v19, v39
    v_cmp_eq_u32 vcc, -1, v19
    s_nop 0
    s_cbranch_vccnz g_49F10_3
    v_smfmac_f32_16x16x64_bf16 v[64:67], v[36:39], a[216:223], v172
    v_smfmac_f32_16x16x64_bf16 v[68:71], v[36:39], a[248:255], v172
    s_branch g_49L2_1
g_49L14_3:
    s_waitcnt vmcnt(2)
    v_max3_u32 v19, v36, v37, v38
    v_max_u32 v19, v19, v39
    v_cmp_eq_u32 vcc, -1, v19
    s_nop 0
    s_cbranch_vccnz g_49F14_3
    v_smfmac_f32_16x16x64_bf16 v[64:67], v[36:39], a[216:223], v172
    v_smfmac_f32_16x16x64_bf16 v[68:71], v[36:39], a[248:255], v172
    s_branch g_49L6_1
g_49L3_1:
    s_waitcnt vmcnt(1)
    v_max3_u32 v19, v28, v29, v30
    v_max_u32 v19, v19, v31
    v_cmp_eq_u32 vcc, -1, v19
    s_nop 0
    s_cbranch_vccnz g_49F3_1
    v_smfmac_f32_16x16x64_bf16 v[64:67], v[28:31], a[200:207], v172
    v_smfmac_f32_16x16x64_bf16 v[68:71], v[28:31], a[232:239], v172
    s_branch g_49L1_0
g_49L6_2:
    s_waitcnt vmcnt(1)
    v_max3_u32 v19, v32, v33, v34
    v_max_u32 v19, v19, v35
    v_cmp_eq_u32 vcc, -1, v19
    s_nop 0
    s_cbranch_vccnz g_49F6_2
    v_smfmac_f32_16x16x64_bf16 v[64:67], v[32:35], a[208:215], v172
    v_smfmac_f32_16x16x64_bf16 v[68:71], v[32:35], a[240:247], v172
    s_branch g_49L2_1
g_49L9_0:
    s_waitcnt vmcnt(1)
    v_max3_u32 v19, v24, v25, v26
    v_max_u32 v19, v19, v27
    v_cmp_eq_u32 vcc, -1, v19
    s_nop 0
    s_cbranch_vccnz g_49F9_0
    v_smfmac_f32_16x16x64_bf16 v[64:67], v[24:27], a[192:199], v172
    v_smfmac_f32_16x16x64_bf16 v[68:71], v[24:27], a[224:231], v172
    s_branch g_49L8_3
g_49L12_3:
    s_waitcnt vmcnt(1)
    v_max3_u32 v19, v36, v37, v38
    v_max_u32 v19, v19, v39
    v_cmp_eq_u32 vcc, -1, v19
    s_nop 0
    s_cbranch_vccnz g_49F12_3
    v_smfmac_f32_16x16x64_bf16 v[64:67], v[36:39], a[216:223], v172
    v_smfmac_f32_16x16x64_bf16 v[68:71], v[36:39], a[248:255], v172
    s_branch g_49L4_2
g_49F15_0:
    s_mov_b64 exec, vcc
    buffer_load_dwordx4 v[24:27], v8, s[4:7], s16 offen offset:0 sc1
    s_mov_b64 exec, -1
    s_add_u32 s23, s23, 1
    s_cmp_lt_u32 s23, 200000
    s_cbranch_scc1 g_49L15_1
    s_mov_b32 s25, 200000
    s_branch gc_50
g_49F15_1:
    s_mov_b64 exec, vcc
    buffer_load_dwordx4 v[28:31], v8, s[4:7], s16 offen offset:1024 sc1
    s_mov_b64 exec, -1
    s_add_u32 s23, s23, 1
    s_cmp_lt_u32 s23, 200000
    s_cbranch_scc1 g_49L15_2
    s_mov_b32 s25, 200000
    s_branch gc_50
g_49F15_2:
    s_mov_b64 exec, vcc
    buffer_load_dwordx4 v[32:35], v8, s[4:7], s16 offen offset:2048 sc1
    s_mov_b64 exec, -1
    s_add_u32 s23, s23, 1
    s_cmp_lt_u32 s23, 200000
    s_cbranch_scc1 g_49L15_3
    s_mov_b32 s25, 200000
    s_branch gc_50
g_49F15_3:
    s_mov_b64 exec, vcc
    buffer_load_dwordx4 v[36:39], v8, s[4:7], s16 offen offset:3072 sc1
    s_mov_b64 exec, -1
    s_add_u32 s23, s23, 1
    s_cmp_lt_u32 s23, 200000
    s_cbranch_scc1 g_49L15_0
    s_mov_b32 s25, 200000
    s_branch gc_50
g_49F7_0:
    s_mov_b64 exec, vcc
    buffer_load_dwordx4 v[24:27], v8, s[4:7], s16 offen offset:0 sc1
    s_mov_b64 exec, -1
    s_add_u32 s23, s23, 1
    s_cmp_lt_u32 s23, 200000
    s_cbranch_scc1 g_49L7_1
    s_mov_b32 s25, 200000
    s_branch gc_50
g_49F7_1:
    s_mov_b64 exec, vcc
    buffer_load_dwordx4 v[28:31], v8, s[4:7], s16 offen offset:1024 sc1
    s_mov_b64 exec, -1
    s_add_u32 s23, s23, 1
    s_cmp_lt_u32 s23, 200000
    s_cbranch_scc1 g_49L7_2
    s_mov_b32 s25, 200000
    s_branch gc_50
g_49F7_2:
    s_mov_b64 exec, vcc
    buffer_load_dwordx4 v[32:35], v8, s[4:7], s16 offen offset:2048 sc1
    s_mov_b64 exec, -1
    s_add_u32 s23, s23, 1
    s_cmp_lt_u32 s23, 200000
    s_cbranch_scc1 g_49L7_0
    s_mov_b32 s25, 200000
    s_branch gc_50
g_49F11_0:
    s_mov_b64 exec, vcc
    buffer_load_dwordx4 v[24:27], v8, s[4:7], s16 offen offset:0 sc1
    s_mov_b64 exec, -1
    s_add_u32 s23, s23, 1
    s_cmp_lt_u32 s23, 200000
    s_cbranch_scc1 g_49L11_1
    s_mov_b32 s25, 200000
    s_branch gc_50
g_49F11_1:
    s_mov_b64 exec, vcc
    buffer_load_dwordx4 v[28:31], v8, s[4:7], s16 offen offset:1024 sc1
    s_mov_b64 exec, -1
    s_add_u32 s23, s23, 1
    s_cmp_lt_u32 s23, 200000
    s_cbranch_scc1 g_49L11_3
    s_mov_b32 s25, 200000
    s_branch gc_50
g_49F11_3:
    s_mov_b64 exec, vcc
    buffer_load_dwordx4 v[36:39], v8, s[4:7], s16 offen offset:3072 sc1
    s_mov_b64 exec, -1
    s_add_u32 s23, s23, 1
    s_cmp_lt_u32 s23, 200000
    s_cbranch_scc1 g_49L11_0
    s_mov_b32 s25, 200000
    s_branch gc_50
g_49F13_0:
    s_mov_b64 exec, vcc
    buffer_load_dwordx4 v[24:27], v8, s[4:7], s16 offen offset:0 sc1
    s_mov_b64 exec, -1
    s_add_u32 s23, s23, 1
    s_cmp_lt_u32 s23, 200000
    s_cbranch_scc1 g_49L13_2
    s_mov_b32 s25, 200000
    s_branch gc_50
g_49F13_2:
    s_mov_b64 exec, vcc
    buffer_load_dwordx4 v[32:35], v8, s[4:7], s16 offen offset:2048 sc1
    s_mov_b64 exec, -1
    s_add_u32 s23, s23, 1
    s_cmp_lt_u32 s23, 200000
    s_cbranch_scc1 g_49L13_3
    s_mov_b32 s25, 200000
    s_branch gc_50
g_49F13_3:
    s_mov_b64 exec, vcc
    buffer_load_dwordx4 v[36:39], v8, s[4:7], s16 offen offset:3072 sc1
    s_mov_b64 exec, -1
    s_add_u32 s23, s23, 1
    s_cmp_lt_u32 s23, 200000
    s_cbranch_scc1 g_49L13_0
    s_mov_b32 s25, 200000
    s_branch gc_50
g_49F14_1:
    s_mov_b64 exec, vcc
    buffer_load_dwordx4 v[28:31], v8, s[4:7], s16 offen offset:1024 sc1
    s_mov_b64 exec, -1
    s_add_u32 s23, s23, 1
    s_cmp_lt_u32 s23, 200000
    s_cbranch_scc1 g_49L14_2
    s_mov_b32 s25, 200000
    s_branch gc_50
g_49F14_2:
    s_mov_b64 exec, vcc
    buffer_load_dwordx4 v[32:35], v8, s[4:7], s16 offen offset:2048 sc1
    s_mov_b64 exec, -1
    s_add_u32 s23, s23, 1
    s_cmp_lt_u32 s23, 200000
    s_cbranch_scc1 g_49L14_3
    s_mov_b32 s25, 200000
    s_branch gc_50
g_49F14_3:
    s_mov_b64 exec, vcc
    buffer_load_dwordx4 v[36:39], v8, s[4:7], s16 offen offset:3072 sc1
    s_mov_b64 exec, -1
    s_add_u32 s23, s23, 1
    s_cmp_lt_u32 s23, 200000
    s_cbranch_scc1 g_49L14_1
    s_mov_b32 s25, 200000
    s_branch gc_50
g_49F3_0:
    s_mov_b64 exec, vcc
    buffer_load_dwordx4 v[24:27], v8, s[4:7], s16 offen offset:0 sc1
    s_mov_b64 exec, -1
    s_add_u32 s23, s23, 1
    s_cmp_lt_u32 s23, 200000
    s_cbranch_scc1 g_49L3_1
    s_mov_b32 s25, 200000
    s_branch gc_50
g_49F3_1:
    s_mov_b64 exec, vcc
    buffer_load_dwordx4 v[28:31], v8, s[4:7], s16 offen offset:1024 sc1
    s_mov_b64 exec, -1
    s_add_u32 s23, s23, 1
    s_cmp_lt_u32 s23, 200000
    s_cbranch_scc1 g_49L3_0
    s_mov_b32 s25, 200000
    s_branch gc_50
g_49F5_0:
    s_mov_b64 exec, vcc
    buffer_load_dwordx4 v[24:27], v8, s[4:7], s16 offen offset:0 sc1
    s_mov_b64 exec, -1
    s_add_u32 s23, s23, 1
    s_cmp_lt_u32 s23, 200000
    s_cbranch_scc1 g_49L5_2
    s_mov_b32 s25, 200000
    s_branch gc_50
g_49F5_2:
    s_mov_b64 exec, vcc
    buffer_load_dwordx4 v[32:35], v8, s[4:7], s16 offen offset:2048 sc1
    s_mov_b64 exec, -1
    s_add_u32 s23, s23, 1
    s_cmp_lt_u32 s23, 200000
    s_cbranch_scc1 g_49L5_0
    s_mov_b32 s25, 200000
    s_branch gc_50
g_49F6_1:
    s_mov_b64 exec, vcc
    buffer_load_dwordx4 v[28:31], v8, s[4:7], s16 offen offset:1024 sc1
    s_mov_b64 exec, -1
    s_add_u32 s23, s23, 1
    s_cmp_lt_u32 s23, 200000
    s_cbranch_scc1 g_49L6_2
    s_mov_b32 s25, 200000
    s_branch gc_50
g_49F6_2:
    s_mov_b64 exec, vcc
    buffer_load_dwordx4 v[32:35], v8, s[4:7], s16 offen offset:2048 sc1
    s_mov_b64 exec, -1
    s_add_u32 s23, s23, 1
    s_cmp_lt_u32 s23, 200000
    s_cbranch_scc1 g_49L6_1
    s_mov_b32 s25, 200000
    s_branch gc_50
g_49F9_0:
    s_mov_b64 exec, vcc
    buffer_load_dwordx4 v[24:27], v8, s[4:7], s16 offen offset:0 sc1
    s_mov_b64 exec, -1
    s_add_u32 s23, s23, 1
    s_cmp_lt_u32 s23, 200000
    s_cbranch_scc1 g_49L9_3
    s_mov_b32 s25, 200000
    s_branch gc_50
g_49F9_3:
    s_mov_b64 exec, vcc
    buffer_load_dwordx4 v[36:39], v8, s[4:7], s16 offen offset:3072 sc1
    s_mov_b64 exec, -1
    s_add_u32 s23, s23, 1
    s_cmp_lt_u32 s23, 200000
    s_cbranch_scc1 g_49L9_0
    s_mov_b32 s25, 200000
    s_branch gc_50
g_49F10_1:
    s_mov_b64 exec, vcc
    buffer_load_dwordx4 v[28:31], v8, s[4:7], s16 offen offset:1024 sc1
    s_mov_b64 exec, -1
    s_add_u32 s23, s23, 1
    s_cmp_lt_u32 s23, 200000
    s_cbranch_scc1 g_49L10_3
    s_mov_b32 s25, 200000
    s_branch gc_50
g_49F10_3:
    s_mov_b64 exec, vcc
    buffer_load_dwordx4 v[36:39], v8, s[4:7], s16 offen offset:3072 sc1
    s_mov_b64 exec, -1
    s_add_u32 s23, s23, 1
    s_cmp_lt_u32 s23, 200000
    s_cbranch_scc1 g_49L10_1
    s_mov_b32 s25, 200000
    s_branch gc_50
g_49F12_2:
    s_mov_b64 exec, vcc
    buffer_load_dwordx4 v[32:35], v8, s[4:7], s16 offen offset:2048 sc1
    s_mov_b64 exec, -1
    s_add_u32 s23, s23, 1
    s_cmp_lt_u32 s23, 200000
    s_cbranch_scc1 g_49L12_3
    s_mov_b32 s25, 200000
    s_branch gc_50
g_49F12_3:
    s_mov_b64 exec, vcc
    buffer_load_dwordx4 v[36:39], v8, s[4:7], s16 offen offset:3072 sc1
    s_mov_b64 exec, -1
    s_add_u32 s23, s23, 1
    s_cmp_lt_u32 s23, 200000
    s_cbranch_scc1 g_49L12_2
    s_mov_b32 s25, 200000
    s_branch gc_50
g_49F1_0:
    s_mov_b64 exec, vcc
    buffer_load_dwordx4 v[24:27], v8, s[4:7], s16 offen offset:0 sc1
    s_mov_b64 exec, -1
    s_add_u32 s23, s23, 1
    s_cmp_lt_u32 s23, 200000
    s_cbranch_scc1 g_49L1_0
    s_mov_b32 s25, 200000
    s_branch gc_50
g_49F2_1:
    s_mov_b64 exec, vcc
    buffer_load_dwordx4 v[28:31], v8, s[4:7], s16 offen offset:1024 sc1
    s_mov_b64 exec, -1
    s_add_u32 s23, s23, 1
    s_cmp_lt_u32 s23, 200000
    s_cbranch_scc1 g_49L2_1
    s_mov_b32 s25, 200000
    s_branch gc_50
g_49F4_2:
    s_mov_b64 exec, vcc
    buffer_load_dwordx4 v[32:35], v8, s[4:7], s16 offen offset:2048 sc1
    s_mov_b64 exec, -1
    s_add_u32 s23, s23, 1
    s_cmp_lt_u32 s23, 200000
    s_cbranch_scc1 g_49L4_2
    s_mov_b32 s25, 200000
    s_branch gc_50
g_49F8_3:
    s_mov_b64 exec, vcc
    buffer_load_dwordx4 v[36:39], v8, s[4:7], s16 offen offset:3072 sc1
    s_mov_b64 exec, -1
    s_add_u32 s23, s23, 1
    s_cmp_lt_u32 s23, 200000
    s_cbranch_scc1 g_49L8_3
    s_mov_b32 s25, 200000
    s_branch gc_50
pr_51:
    v_max3_u32 v19, v96, v97, v98
    v_max3_u32 v19, v19, v99, v100
    v_max3_u32 v19, v19, v101, v102
    v_max3_u32 v19, v19, v103, v104
    v_max3_u32 v19, v19, v105, v106
    v_max_u32 v19, v19, v107
    v_cmp_eq_u32 vcc, -1, v19
    s_nop 0
    s_cbranch_vccz pf_55
    buffer_load_dwordx4 v[96:99], v10, s[4:7], s84 offen sc1
    buffer_load_dwordx4 v[100:103], v23, s[4:7], s84 offen sc1
    buffer_load_dwordx4 v[104:107], v244, s[4:7], s84 offen sc1
    s_add_u32 s23, s23, 1
    s_cmp_lt_u32 s23, 200000
    s_cbranch_scc1 pb_53
    s_mov_b32 s25, 200000
pf_55:
    buffer_store_dwordx2 v[180:181], v11, s[4:7], s42 offen
    s_branch pg_52
.p2align 6
recur_slow_w0:
    s_nop 15
    s_mov_b32 s23, s25
g_56:
    buffer_load_dwordx4 v[24:27], v2, s[4:7], s16 offen offset:0 sc1
    buffer_load_dwordx4 v[28:31], v2, s[4:7], s16 offen offset:1024 sc1
    buffer_load_dwordx4 v[32:35], v2, s[4:7], s16 offen offset:2048 sc1
    buffer_load_dwordx4 v[36:39], v2, s[4:7], s16 offen offset:3072 sc1
    s_waitcnt vmcnt(0)
    v_max3_u32 v19, v24, v25, v26
    v_max3_u32 v19, v19, v27, v28
    v_max3_u32 v19, v19, v29, v30
    v_max3_u32 v19, v19, v31, v32
    v_max3_u32 v19, v19, v33, v34
    v_max3_u32 v19, v19, v35, v36
    v_max3_u32 v19, v19, v37, v38
    v_max_u32 v19, v19, v39
    v_cmp_eq_u32 vcc, -1, v19
    s_nop 0
    s_cbranch_vccz g_56k
    s_add_u32 s23, s23, 1
    s_cmp_lt_u32 s23, 200000
    s_cbranch_scc1 g_56
    s_mov_b32 s25, 200000
g_56k:
    v_smfmac_f32_16x16x64_bf16 v[40:43], v[24:27], a[0:7], v172
    v_smfmac_f32_16x16x64_bf16 v[44:47], v[24:27], a[64:71], v172
    v_smfmac_f32_16x16x64_bf16 v[48:51], v[24:27], a[32:39], v172
    v_smfmac_f32_16x16x64_bf16 v[52:55], v[24:27], a[96:103], v172
    v_smfmac_f32_16x16x64_bf16 v[40:43], v[28:31], a[8:15], v172
    v_smfmac_f32_16x16x64_bf16 v[44:47], v[28:31], a[72:79], v172
    v_smfmac_f32_16x16x64_bf16 v[48:51], v[28:31], a[40:47], v172
    v_smfmac_f32_16x16x64_bf16 v[52:55], v[28:31], a[104:111], v172
    v_smfmac_f32_16x16x64_bf16 v[40:43], v[32:35], a[16:23], v172
    v_smfmac_f32_16x16x64_bf16 v[44:47], v[32:35], a[80:87], v172
    v_smfmac_f32_16x16x64_bf16 v[48:51], v[32:35], a[48:55], v172
    v_smfmac_f32_16x16x64_bf16 v[52:55], v[32:35], a[112:119], v172
    v_smfmac_f32_16x16x64_bf16 v[40:43], v[36:39], a[24:31], v172
    v_smfmac_f32_16x16x64_bf16 v[44:47], v[36:39], a[88:95], v172
    v_smfmac_f32_16x16x64_bf16 v[48:51], v[36:39], a[56:63], v172
    v_smfmac_f32_16x16x64_bf16 v[52:55], v[36:39], a[120:127], v172
    v_cvt_pk_bf16_f32 v72, v40, v41
    v_cvt_pk_bf16_f32 v73, v42, v43
    v_cvt_pk_bf16_f32 v74, v44, v45
    v_cvt_pk_bf16_f32 v75, v46, v47
    v_smfmac_f32_16x16x64_bf16 v[56:59], v[24:27], a[128:135], v172
    v_cvt_pk_bf16_f32 v76, v48, v49
    v_cvt_pk_bf16_f32 v77, v50, v51
    s_nop 0
    v_cvt_pk_bf16_f32 v78, v52, v53
    v_cvt_pk_bf16_f32 v79, v54, v55
    v_smfmac_f32_16x16x64_bf16 v[60:63], v[24:27], a[160:167], v172
    v_mfma_f32_16x16x32_bf16 v[88:91], v[72:75], v[84:87], 0
    v_mfma_f32_16x16x32_bf16 v[92:95], v[76:79], v[84:87], 0
    v_smfmac_f32_16x16x64_bf16 v[56:59], v[28:31], a[136:143], v172
    v_smfmac_f32_16x16x64_bf16 v[60:63], v[28:31], a[168:175], v172
    s_barrier
    ds_read_b128 v[104:107], v16 offset:2048
    ds_read_b128 v[108:111], v16 offset:3072
    ds_read_b128 v[112:115], v16 offset:4096
    ds_read_b128 v[116:119], v16 offset:5120
    ds_read_b128 v[120:123], v16 offset:6144
    ds_read_b128 v[124:127], v16 offset:7168
    v_smfmac_f32_16x16x64_bf16 v[56:59], v[32:35], a[144:151], v172
    v_smfmac_f32_16x16x64_bf16 v[60:63], v[32:35], a[176:183], v172
    v_smfmac_f32_16x16x64_bf16 v[56:59], v[36:39], a[152:159], v172
    v_smfmac_f32_16x16x64_bf16 v[60:63], v[36:39], a[184:191], v172
    s_waitcnt lgkmcnt(5)
    v_mfma_f32_16x16x32_bf16 v[88:91], v[104:107], v[84:87], v[88:91]
    s_waitcnt lgkmcnt(4)
    v_mfma_f32_16x16x32_bf16 v[92:95], v[108:111], v[84:87], v[92:95]
    s_waitcnt lgkmcnt(3)
    v_mfma_f32_16x16x32_bf16 v[88:91], v[112:115], v[84:87], v[88:91]
    s_waitcnt lgkmcnt(2)
    v_mfma_f32_16x16x32_bf16 v[92:95], v[116:119], v[84:87], v[92:95]
    s_waitcnt lgkmcnt(1)
    v_mfma_f32_16x16x32_bf16 v[88:91], v[120:123], v[84:87], v[88:91]
    s_waitcnt lgkmcnt(0)
    v_mfma_f32_16x16x32_bf16 v[92:95], v[124:127], v[84:87], v[92:95]
    v_cvt_pk_bf16_f32 v80, v56, v57
    v_cvt_pk_bf16_f32 v81, v58, v59
    v_cvt_pk_bf16_f32 v82, v60, v61
    v_cvt_pk_bf16_f32 v83, v62, v63
    ds_write_b128 v17, v[80:83] offset:8192
    s_nop 0
    v_cvt_pk_bf16_f32 v128, v88, v89
    v_cvt_pk_bf16_f32 v129, v90, v91
    v_cvt_pk_bf16_f32 v130, v92, v93
    v_cvt_pk_bf16_f32 v131, v94, v95
    s_nop 1
    v_mfma_f32_16x16x32_bf16 v[144:147], v[132:135], v[128:131], 0
    v_mfma_f32_16x16x32_bf16 v[148:151], v[136:139], v[128:131], 0
    v_mfma_f32_16x16x32_bf16 v[140:143], v[128:131], v[128:131], 0
    s_nop 1
    buffer_store_dwordx4 v[144:147], v3, s[4:7], s16 offen sc1
    s_nop 1
    buffer_store_dwordx4 v[148:151], v3, s[4:7], s16 offen offset:128 sc1
    s_nop 1
    buffer_store_dwordx4 v[140:143], v4, s[4:7], s16 offen sc1
    s_cmp_eq_u32 s15, 63
    s_waitcnt lgkmcnt(0)
    s_barrier
    s_cbranch_scc1 recur_slow_last0
    v_readfirstlane_b32 s85, v247
    s_add_u32 s94, s15, 2
    s_barrier
    s_nop 15
    s_mov_b32 s23, s25
g_57:
    buffer_load_dwordx4 v[24:27], v8, s[4:7], s16 offen offset:0 sc1
    buffer_load_dwordx4 v[28:31], v8, s[4:7], s16 offen offset:1024 sc1
    buffer_load_dwordx4 v[32:35], v8, s[4:7], s16 offen offset:2048 sc1
    buffer_load_dwordx4 v[36:39], v8, s[4:7], s16 offen offset:3072 sc1
    s_waitcnt vmcnt(0)
    v_max3_u32 v19, v24, v25, v26
    v_max3_u32 v19, v19, v27, v28
    v_max3_u32 v19, v19, v29, v30
    v_max3_u32 v19, v19, v31, v32
    v_max3_u32 v19, v19, v33, v34
    v_max3_u32 v19, v19, v35, v36
    v_max3_u32 v19, v19, v37, v38
    v_max_u32 v19, v19, v39
    v_cmp_eq_u32 vcc, -1, v19
    s_nop 0
    s_cbranch_vccz g_57k
    s_add_u32 s23, s23, 1
    s_cmp_lt_u32 s23, 200000
    s_cbranch_scc1 g_57
    s_mov_b32 s25, 200000
g_57k:
    v_smfmac_f32_16x16x64_bf16 v[64:67], v[24:27], a[192:199], v172
    v_smfmac_f32_16x16x64_bf16 v[68:71], v[24:27], a[224:231], v172
    v_smfmac_f32_16x16x64_bf16 v[64:67], v[28:31], a[200:207], v172
    v_smfmac_f32_16x16x64_bf16 v[68:71], v[28:31], a[232:239], v172
    v_smfmac_f32_16x16x64_bf16 v[64:67], v[32:35], a[208:215], v172
    v_smfmac_f32_16x16x64_bf16 v[68:71], v[32:35], a[240:247], v172
    v_smfmac_f32_16x16x64_bf16 v[64:67], v[36:39], a[216:223], v172
    v_smfmac_f32_16x16x64_bf16 v[68:71], v[36:39], a[248:255], v172
    s_nop 4
    v_cvt_pk_bf16_f32 v80, v64, v65
    v_cvt_pk_bf16_f32 v81, v66, v67
    s_nop 0
    v_cvt_pk_bf16_f32 v82, v68, v69
    v_cvt_pk_bf16_f32 v83, v70, v71
    ds_write_b128 v17, v[80:83] offset:9216
    s_waitcnt lgkmcnt(0)
    s_barrier
    s_nop 15
    s_nop 15
    s_nop 15
    s_nop 15
    buffer_store_dwordx4 v[128:131], v14, s[4:7], s19 offen sc1
    s_add_u32 s19, s19, 512
    s_mov_b32 s23, s25
fw_58:
    s_cmp_ge_u32 s85, s94
    s_cbranch_scc1 fo_59
    buffer_load_dword v247, v245, s[4:7], 0 offen sc1
    s_add_u32 s23, s23, 1
    s_waitcnt vmcnt(0)
    v_readfirstlane_b32 s85, v247
    s_cmp_lt_u32 s23, 200000
    s_cbranch_scc1 fw_58
    s_mov_b32 s25, 200000
fo_59:
    buffer_load_dwordx4 v[132:135], v12, s[4:7], s17 offen sc1
    buffer_load_dwordx4 v[136:139], v12, s[4:7], s17 offen offset:256 sc1
    s_add_u32 s17, s17, 2048
    s_min_u32 s17, s17, 17954816
    s_add_u32 s21, s15, 3
    s_min_u32 s21, s21, 64
    s_cmp_lt_u32 s85, s21
    s_cselect_b64 exec, 1, 0
    buffer_load_dword v247, v245, s[4:7], 0 offen sc1
    s_mov_b64 exec, -1
    v_mov_b32 v40, 0
    v_mov_b32 v41, 0
    v_mov_b32 v42, 0
    v_mov_b32 v43, 0
    v_mov_b32 v44, 0
    v_mov_b32 v45, 0
    v_mov_b32 v46, 0
    v_mov_b32 v47, 0
    v_mov_b32 v48, 0
    v_mov_b32 v49, 0
    v_mov_b32 v50, 0
    v_mov_b32 v51, 0
    v_mov_b32 v52, 0
    v_mov_b32 v53, 0
    v_mov_b32 v54, 0
    v_mov_b32 v55, 0
    v_mov_b32 v56, 0
    v_mov_b32 v57, 0
    v_mov_b32 v58, 0
    v_mov_b32 v59, 0
    v_mov_b32 v60, 0
    v_mov_b32 v61, 0
    v_mov_b32 v62, 0
    v_mov_b32 v63, 0
    v_mov_b32 v64, 0
    v_mov_b32 v65, 0
    v_mov_b32 v66, 0
    v_mov_b32 v67, 0
    v_mov_b32 v68, 0
    v_mov_b32 v69, 0
    v_mov_b32 v70, 0
    v_mov_b32 v71, 0
    s_mov_b32 s21, s16
    s_mov_b32 s16, s42
    s_mov_b32 s42, s43
    s_mov_b32 s43, s44
    s_mov_b32 s44, s21
    s_add_u32 s95, s95, 524288
    s_lshr_b32 s84, s95, 8
    s_and_b32 s84, s84, 8192
    s_xor_b32 s84, s84, s46
    s_add_u32 s84, s84, s95
    s_add_u32 s15, s15, 1
    s_barrier
    s_branch recur_slow_w0
recur_slow_last0:
    buffer_store_dwordx4 v[128:131], v14, s[4:7], s19 offen sc1
    s_waitcnt vmcnt(0)
    s_branch recur_end
.p2align 6
recur_slow_w1:
    s_nop 15
    s_mov_b32 s23, s25
g_60:
    buffer_load_dwordx4 v[24:27], v2, s[4:7], s16 offen offset:0 sc1
    buffer_load_dwordx4 v[28:31], v2, s[4:7], s16 offen offset:1024 sc1
    buffer_load_dwordx4 v[32:35], v2, s[4:7], s16 offen offset:2048 sc1
    buffer_load_dwordx4 v[36:39], v2, s[4:7], s16 offen offset:3072 sc1
    s_waitcnt vmcnt(0)
    v_max3_u32 v19, v24, v25, v26
    v_max3_u32 v19, v19, v27, v28
    v_max3_u32 v19, v19, v29, v30
    v_max3_u32 v19, v19, v31, v32
    v_max3_u32 v19, v19, v33, v34
    v_max3_u32 v19, v19, v35, v36
    v_max3_u32 v19, v19, v37, v38
    v_max_u32 v19, v19, v39
    v_cmp_eq_u32 vcc, -1, v19
    s_nop 0
    s_cbranch_vccz g_60k
    s_add_u32 s23, s23, 1
    s_cmp_lt_u32 s23, 200000
    s_cbranch_scc1 g_60
    s_mov_b32 s25, 200000
g_60k:
    v_smfmac_f32_16x16x64_bf16 v[40:43], v[24:27], a[0:7], v172
    v_smfmac_f32_16x16x64_bf16 v[44:47], v[24:27], a[64:71], v172
    v_smfmac_f32_16x16x64_bf16 v[48:51], v[24:27], a[32:39], v172
    v_smfmac_f32_16x16x64_bf16 v[52:55], v[24:27], a[96:103], v172
    v_smfmac_f32_16x16x64_bf16 v[40:43], v[28:31], a[8:15], v172
    v_smfmac_f32_16x16x64_bf16 v[44:47], v[28:31], a[72:79], v172
    v_smfmac_f32_16x16x64_bf16 v[48:51], v[28:31], a[40:47], v172
    v_smfmac_f32_16x16x64_bf16 v[52:55], v[28:31], a[104:111], v172
    v_smfmac_f32_16x16x64_bf16 v[40:43], v[32:35], a[16:23], v172
    v_smfmac_f32_16x16x64_bf16 v[44:47], v[32:35], a[80:87], v172
    v_smfmac_f32_16x16x64_bf16 v[48:51], v[32:35], a[48:55], v172
    v_smfmac_f32_16x16x64_bf16 v[52:55], v[32:35], a[112:119], v172
    v_smfmac_f32_16x16x64_bf16 v[40:43], v[36:39], a[24:31], v172
    v_smfmac_f32_16x16x64_bf16 v[44:47], v[36:39], a[88:95], v172
    v_smfmac_f32_16x16x64_bf16 v[48:51], v[36:39], a[56:63], v172
    v_smfmac_f32_16x16x64_bf16 v[52:55], v[36:39], a[120:127], v172
    v_cvt_pk_bf16_f32 v72, v40, v41
    v_cvt_pk_bf16_f32 v73, v42, v43
    v_cvt_pk_bf16_f32 v74, v44, v45
    v_cvt_pk_bf16_f32 v75, v46, v47
    ds_write_b128 v17, v[72:75] offset:0
    v_cvt_pk_bf16_f32 v76, v48, v49
    v_cvt_pk_bf16_f32 v77, v50, v51
    s_nop 0
    v_cvt_pk_bf16_f32 v78, v52, v53
    v_cvt_pk_bf16_f32 v79, v54, v55
    ds_write_b128 v17, v[76:79] offset:1024
    v_smfmac_f32_16x16x64_bf16 v[56:59], v[24:27], a[128:135], v172
    v_smfmac_f32_16x16x64_bf16 v[60:63], v[24:27], a[160:167], v172
    v_smfmac_f32_16x16x64_bf16 v[56:59], v[28:31], a[136:143], v172
    s_waitcnt lgkmcnt(0)
    s_barrier
    v_smfmac_f32_16x16x64_bf16 v[60:63], v[28:31], a[168:175], v172
    v_smfmac_f32_16x16x64_bf16 v[56:59], v[32:35], a[144:151], v172
    v_smfmac_f32_16x16x64_bf16 v[60:63], v[32:35], a[176:183], v172
    v_smfmac_f32_16x16x64_bf16 v[56:59], v[36:39], a[152:159], v172
    v_smfmac_f32_16x16x64_bf16 v[60:63], v[36:39], a[184:191], v172
    s_nop 4
    v_cvt_pk_bf16_f32 v80, v56, v57
    v_cvt_pk_bf16_f32 v81, v58, v59
    s_nop 0
    v_cvt_pk_bf16_f32 v82, v60, v61
    v_cvt_pk_bf16_f32 v83, v62, v63
    ds_write_b128 v17, v[80:83] offset:8192
    v_mov_b32 v152, v228
    v_mov_b32 v153, v229
    v_mov_b32 v156, v230
    v_mov_b32 v157, v231
    v_mov_b32 v160, v232
    v_mov_b32 v161, v233
    v_mov_b32 v164, v234
    v_mov_b32 v165, v235
    s_cmp_eq_u32 s15, 63
    s_waitcnt lgkmcnt(0)
    s_barrier
    s_cbranch_scc1 recur_end
    s_nop 15
    s_nop 15
    s_nop 7
    buffer_load_dwordx4 v[208:211], v5, s[4:7], s16 offen offset:0 sc1
    buffer_load_dwordx4 v[212:215], v5, s[4:7], s16 offen offset:1024 sc1
    buffer_load_dwordx4 v[216:219], v5, s[4:7], s16 offen offset:2048 sc1
    buffer_load_dwordx4 v[220:223], v5, s[4:7], s16 offen offset:3072 sc1
    buffer_load_dword v224, v6, s[4:7], s16 offen offset:0 sc1
    buffer_load_dword v225, v6, s[4:7], s16 offen offset:256 sc1
    buffer_load_dword v226, v6, s[4:7], s16 offen offset:512 sc1
    buffer_load_dword v227, v6, s[4:7], s16 offen offset:768 sc1
    s_mov_b32 s23, s25
    ds_read_b128 v[96:99], v16 offset:8192
    ds_read_b128 v[104:107], v16 offset:12288
    ds_read_b128 v[108:111], v16 offset:14336
    v_mfma_f32_16x16x32_bf16 v[140:143], v[84:87], v[80:83], 0
    s_waitcnt lgkmcnt(2)
    v_mfma_f32_16x16x32_bf16 v[140:143], v[84:87], v[96:99], v[140:143]
    s_waitcnt lgkmcnt(1)
    v_mfma_f32_16x16x32_bf16 v[140:143], v[84:87], v[104:107], v[140:143]
    s_waitcnt lgkmcnt(0)
    v_mfma_f32_16x16x32_bf16 v[140:143], v[84:87], v[108:111], v[140:143]
    buffer_load_dwordx4 v[24:27], v5, s[4:7], s16 offen offset:0 sc1
    buffer_load_dwordx4 v[28:31], v5, s[4:7], s16 offen offset:1024 sc1
    buffer_load_dwordx4 v[32:35], v5, s[4:7], s16 offen offset:2048 sc1
    buffer_load_dwordx4 v[36:39], v5, s[4:7], s16 offen offset:3072 sc1
    buffer_load_dword v40, v6, s[4:7], s16 offen offset:0 sc1
    buffer_load_dword v41, v6, s[4:7], s16 offen offset:256 sc1
    buffer_load_dword v42, v6, s[4:7], s16 offen offset:512 sc1
    buffer_load_dword v43, v6, s[4:7], s16 offen offset:768 sc1
    v_cvt_pk_bf16_f32 v154, v140, v179
    v_cvt_pk_bf16_f32 v158, v141, v179
    v_cvt_pk_bf16_f32 v162, v142, v179
    v_cvt_pk_bf16_f32 v166, v143, v179
    s_waitcnt vmcnt(14)
    v_pk_add_f32 v[180:181], v[208:209], v[212:213]
    v_pk_add_f32 v[182:183], v[210:211], v[214:215]
    s_waitcnt vmcnt(12)
    v_pk_add_f32 v[188:189], v[216:217], v[220:221]
    v_pk_add_f32 v[190:191], v[218:219], v[222:223]
    v_pk_add_f32 v[180:181], v[180:181], v[188:189]
    v_pk_add_f32 v[182:183], v[182:183], v[190:191]
    v_pk_add_f32 v[188:189], v[180:181], v[182:183]
    v_max3_f32 v185, v180, v181, v182
    s_waitcnt vmcnt(8)
    v_pk_add_f32 v[192:193], v[224:225], v[226:227]
    v_add_f32 v188, v188, v189
    v_add_f32 v184, v192, v193
    v_max3_f32 v185, v185, v183, v184
    v_cmp_u_f32 vcc, v188, v184
    s_nop 0
    v_max_f32_dpp v185, v185, v185 row_ror:8 row_mask:0xf bank_mask:0xf
    v_mov_b32 v186, v185
    s_nop 1
    v_permlane16_swap_b32 v185, v186
    v_max_f32 v185, v185, v186
    v_mov_b32 v186, v185
    s_cbranch_vccnz ss_61
sg_63:
    s_nop 0
    v_permlane32_swap_b32 v185, v186
    v_max_f32 v185, v185, v186
    v_mul_f32 v185, s24, v185
    v_fma_f32 v180, v180, s24, -v185
    v_fma_f32 v181, v181, s24, -v185
    v_fma_f32 v182, v182, s24, -v185
    v_fma_f32 v183, v183, s24, -v185
    v_fma_f32 v184, v184, s24, -v185
    v_exp_f32 v180, v180
    v_exp_f32 v181, v181
    v_exp_f32 v182, v182
    v_exp_f32 v183, v183
    v_exp_f32 v184, v184
    v_cvt_pk_bf16_f32 v176, v180, v181
    v_cvt_pk_bf16_f32 v177, v182, v183
    v_cvt_pk_bf16_f32 v178, v184, v179
    s_nop 1
    v_mfma_f32_16x16x32_bf16 v[240:243], v[236:239], v[176:179], 0
    v_mfma_f32_16x16x32_bf16 v[188:191], v[152:155], v[176:179], 0
    v_mfma_f32_16x16x32_bf16 v[192:195], v[156:159], v[176:179], 0
    v_mfma_f32_16x16x32_bf16 v[196:199], v[160:163], v[176:179], 0
    v_mfma_f32_16x16x32_bf16 v[200:203], v[164:167], v[176:179], 0
    v_add_f32_dpp v185, v240, v240 row_ror:8 row_mask:0xf bank_mask:0xf
    v_rcp_f32 v185, v185
    v_add_f32_dpp v88, v192, v188 row_ror:8 row_mask:0xf bank_mask:0x3
    v_add_f32_dpp v89, v193, v189 row_ror:8 row_mask:0xf bank_mask:0x3
    v_add_f32_dpp v90, v194, v190 row_ror:8 row_mask:0xf bank_mask:0x3
    v_add_f32_dpp v91, v195, v191 row_ror:8 row_mask:0xf bank_mask:0x3
    s_nop 1
    v_add_f32_dpp v88, v196, v200 row_ror:8 row_mask:0xf bank_mask:0xc
    v_add_f32_dpp v89, v197, v201 row_ror:8 row_mask:0xf bank_mask:0xc
    v_add_f32_dpp v90, v198, v202 row_ror:8 row_mask:0xf bank_mask:0xc
    v_add_f32_dpp v91, v199, v203 row_ror:8 row_mask:0xf bank_mask:0xc
    v_mul_f32 v88, v88, v185
    v_mul_f32 v89, v89, v185
    v_mul_f32 v90, v90, v185
    v_mul_f32 v91, v91, v185
    v_cvt_pk_bf16_f32 v88, v88, v89
    v_cvt_pk_bf16_f32 v89, v90, v91
    buffer_store_dwordx2 v[88:89], v7, s[4:7], s16 offen sc1
    v_readfirstlane_b32 s85, v247
    s_add_u32 s94, s15, 2
    s_barrier
    s_nop 15
    s_mov_b32 s23, s25
g_64:
    buffer_load_dwordx4 v[24:27], v8, s[4:7], s16 offen offset:0 sc1
    buffer_load_dwordx4 v[28:31], v8, s[4:7], s16 offen offset:1024 sc1
    buffer_load_dwordx4 v[32:35], v8, s[4:7], s16 offen offset:2048 sc1
    buffer_load_dwordx4 v[36:39], v8, s[4:7], s16 offen offset:3072 sc1
    s_waitcnt vmcnt(0)
    v_max3_u32 v19, v24, v25, v26
    v_max3_u32 v19, v19, v27, v28
    v_max3_u32 v19, v19, v29, v30
    v_max3_u32 v19, v19, v31, v32
    v_max3_u32 v19, v19, v33, v34
    v_max3_u32 v19, v19, v35, v36
    v_max3_u32 v19, v19, v37, v38
    v_max_u32 v19, v19, v39
    v_cmp_eq_u32 vcc, -1, v19
    s_nop 0
    s_cbranch_vccz g_64k
    s_add_u32 s23, s23, 1
    s_cmp_lt_u32 s23, 200000
    s_cbranch_scc1 g_64
    s_mov_b32 s25, 200000
g_64k:
    v_smfmac_f32_16x16x64_bf16 v[64:67], v[24:27], a[192:199], v172
    v_smfmac_f32_16x16x64_bf16 v[68:71], v[24:27], a[224:231], v172
    v_smfmac_f32_16x16x64_bf16 v[64:67], v[28:31], a[200:207], v172
    v_smfmac_f32_16x16x64_bf16 v[68:71], v[28:31], a[232:239], v172
    v_smfmac_f32_16x16x64_bf16 v[64:67], v[32:35], a[208:215], v172
    v_smfmac_f32_16x16x64_bf16 v[68:71], v[32:35], a[240:247], v172
    v_smfmac_f32_16x16x64_bf16 v[64:67], v[36:39], a[216:223], v172
    v_smfmac_f32_16x16x64_bf16 v[68:71], v[36:39], a[248:255], v172
    s_nop 4
    v_cvt_pk_bf16_f32 v80, v64, v65
    v_cvt_pk_bf16_f32 v81, v66, v67
    s_nop 0
    v_cvt_pk_bf16_f32 v82, v68, v69
    v_cvt_pk_bf16_f32 v83, v70, v71
    ds_write_b128 v17, v[80:83] offset:9216
    s_waitcnt lgkmcnt(0)
    s_barrier
    s_nop 15
    s_nop 15
    s_nop 15
    s_nop 15
    s_mov_b32 s23, s25
fw_65:
    s_cmp_ge_u32 s85, s94
    s_cbranch_scc1 fo_66
    buffer_load_dword v247, v245, s[4:7], 0 offen sc1
    s_add_u32 s23, s23, 1
    s_waitcnt vmcnt(0)
    v_readfirstlane_b32 s85, v247
    s_cmp_lt_u32 s23, 200000
    s_cbranch_scc1 fw_65
    s_mov_b32 s25, 200000
fo_66:
    buffer_load_dwordx4 v[228:231], v13, s[4:7], s18 offen offset:0 sc1
    buffer_load_dwordx4 v[232:235], v13, s[4:7], s18 offen offset:256 sc1
    s_add_u32 s18, s18, 2048
    s_min_u32 s18, s18, 35780608
    s_add_u32 s21, s15, 3
    s_min_u32 s21, s21, 64
    s_cmp_lt_u32 s85, s21
    s_cselect_b64 exec, 1, 0
    buffer_load_dword v247, v245, s[4:7], 0 offen sc1
    s_mov_b64 exec, -1
    v_mov_b32 v40, 0
    v_mov_b32 v41, 0
    v_mov_b32 v42, 0
    v_mov_b32 v43, 0
    v_mov_b32 v44, 0
    v_mov_b32 v45, 0
    v_mov_b32 v46, 0
    v_mov_b32 v47, 0
    v_mov_b32 v48, 0
    v_mov_b32 v49, 0
    v_mov_b32 v50, 0
    v_mov_b32 v51, 0
    v_mov_b32 v52, 0
    v_mov_b32 v53, 0
    v_mov_b32 v54, 0
    v_mov_b32 v55, 0
    v_mov_b32 v56, 0
    v_mov_b32 v57, 0
    v_mov_b32 v58, 0
    v_mov_b32 v59, 0
    v_mov_b32 v60, 0
    v_mov_b32 v61, 0
    v_mov_b32 v62, 0
    v_mov_b32 v63, 0
    v_mov_b32 v64, 0
    v_mov_b32 v65, 0
    v_mov_b32 v66, 0
    v_mov_b32 v67, 0
    v_mov_b32 v68, 0
    v_mov_b32 v69, 0
    v_mov_b32 v70, 0
    v_mov_b32 v71, 0
    s_mov_b32 s21, s16
    s_mov_b32 s16, s42
    s_mov_b32 s42, s43
    s_mov_b32 s43, s44
    s_mov_b32 s44, s21
    s_add_u32 s95, s95, 524288
    s_lshr_b32 s84, s95, 8
    s_and_b32 s84, s84, 8192
    s_xor_b32 s84, s84, s46
    s_add_u32 s84, s84, s95
    s_add_u32 s15, s15, 1
    s_barrier
    s_branch recur_slow_w1
sb_62:
    v_max3_u32 v19, v24, v25, v26
    v_max3_u32 v19, v19, v27, v28
    v_max3_u32 v19, v19, v29, v30
    v_max3_u32 v19, v19, v31, v32
    v_max3_u32 v19, v19, v33, v34
    v_max3_u32 v19, v19, v35, v36
    v_max3_u32 v19, v19, v37, v38
    v_max3_u32 v19, v19, v39, v40
    v_max3_u32 v19, v19, v41, v42
    v_max_u32 v19, v19, v43
    v_cmp_eq_u32 vcc, -1, v19
    s_nop 0
    s_cbranch_vccz sg_63
    buffer_load_dwordx4 v[24:27], v5, s[4:7], s16 offen offset:0 sc1
    buffer_load_dwordx4 v[28:31], v5, s[4:7], s16 offen offset:1024 sc1
    buffer_load_dwordx4 v[32:35], v5, s[4:7], s16 offen offset:2048 sc1
    buffer_load_dwordx4 v[36:39], v5, s[4:7], s16 offen offset:3072 sc1
    buffer_load_dword v40, v6, s[4:7], s16 offen offset:0 sc1
    buffer_load_dword v41, v6, s[4:7], s16 offen offset:256 sc1
    buffer_load_dword v42, v6, s[4:7], s16 offen offset:512 sc1
    buffer_load_dword v43, v6, s[4:7], s16 offen offset:768 sc1
    s_add_u32 s23, s23, 1
    s_cmp_lt_u32 s23, 200000
    s_cbranch_scc1 ss_61
    s_mov_b32 s25, 200000
    s_branch sg_63
ss_61:
    s_waitcnt vmcnt(6)
    v_pk_add_f32 v[180:181], v[24:25], v[28:29]
    v_pk_add_f32 v[182:183], v[26:27], v[30:31]
    s_waitcnt vmcnt(4)
    v_pk_add_f32 v[188:189], v[32:33], v[36:37]
    v_pk_add_f32 v[190:191], v[34:35], v[38:39]
    v_pk_add_f32 v[180:181], v[180:181], v[188:189]
    v_pk_add_f32 v[182:183], v[182:183], v[190:191]
    v_pk_add_f32 v[188:189], v[180:181], v[182:183]
    v_max3_f32 v185, v180, v181, v182
    s_waitcnt vmcnt(0)
    v_pk_add_f32 v[192:193], v[40:41], v[42:43]
    v_add_f32 v188, v188, v189
    v_add_f32 v184, v192, v193
    v_max3_f32 v185, v185, v183, v184
    v_cmp_u_f32 vcc, v188, v184
    s_nop 0
    v_max_f32_dpp v185, v185, v185 row_ror:8 row_mask:0xf bank_mask:0xf
    v_mov_b32 v186, v185
    s_nop 1
    v_permlane16_swap_b32 v185, v186
    v_max_f32 v185, v185, v186
    v_mov_b32 v186, v185
    s_cbranch_vccnz sb_62
    s_branch sg_63
.p2align 6
recur_slow_w2:
    s_nop 15
    s_mov_b32 s23, s25
g_67:
    buffer_load_dwordx4 v[24:27], v2, s[4:7], s16 offen offset:0 sc1
    buffer_load_dwordx4 v[28:31], v2, s[4:7], s16 offen offset:1024 sc1
    buffer_load_dwordx4 v[32:35], v2, s[4:7], s16 offen offset:2048 sc1
    buffer_load_dwordx4 v[36:39], v2, s[4:7], s16 offen offset:3072 sc1
    s_waitcnt vmcnt(0)
    v_max3_u32 v19, v24, v25, v26
    v_max3_u32 v19, v19, v27, v28
    v_max3_u32 v19, v19, v29, v30
    v_max3_u32 v19, v19, v31, v32
    v_max3_u32 v19, v19, v33, v34
    v_max3_u32 v19, v19, v35, v36
    v_max3_u32 v19, v19, v37, v38
    v_max_u32 v19, v19, v39
    v_cmp_eq_u32 vcc, -1, v19
    s_nop 0
    s_cbranch_vccz g_67k
    s_add_u32 s23, s23, 1
    s_cmp_lt_u32 s23, 200000
    s_cbranch_scc1 g_67
    s_mov_b32 s25, 200000
g_67k:
    v_smfmac_f32_16x16x64_bf16 v[40:43], v[24:27], a[0:7], v172
    v_smfmac_f32_16x16x64_bf16 v[44:47], v[24:27], a[64:71], v172
    v_smfmac_f32_16x16x64_bf16 v[48:51], v[24:27], a[32:39], v172
    v_smfmac_f32_16x16x64_bf16 v[52:55], v[24:27], a[96:103], v172
    v_smfmac_f32_16x16x64_bf16 v[40:43], v[28:31], a[8:15], v172
    v_smfmac_f32_16x16x64_bf16 v[44:47], v[28:31], a[72:79], v172
    v_smfmac_f32_16x16x64_bf16 v[48:51], v[28:31], a[40:47], v172
    v_smfmac_f32_16x16x64_bf16 v[52:55], v[28:31], a[104:111], v172
    v_smfmac_f32_16x16x64_bf16 v[40:43], v[32:35], a[16:23], v172
    v_smfmac_f32_16x16x64_bf16 v[44:47], v[32:35], a[80:87], v172
    v_smfmac_f32_16x16x64_bf16 v[48:51], v[32:35], a[48:55], v172
    v_smfmac_f32_16x16x64_bf16 v[52:55], v[32:35], a[112:119], v172
    v_smfmac_f32_16x16x64_bf16 v[40:43], v[36:39], a[24:31], v172
    v_smfmac_f32_16x16x64_bf16 v[44:47], v[36:39], a[88:95], v172
    v_smfmac_f32_16x16x64_bf16 v[48:51], v[36:39], a[56:63], v172
    v_smfmac_f32_16x16x64_bf16 v[52:55], v[36:39], a[120:127], v172
    v_cvt_pk_bf16_f32 v72, v40, v41
    v_cvt_pk_bf16_f32 v73, v42, v43
    v_cvt_pk_bf16_f32 v74, v44, v45
    v_cvt_pk_bf16_f32 v75, v46, v47
    ds_write_b128 v17, v[72:75] offset:0
    v_cvt_pk_bf16_f32 v76, v48, v49
    v_cvt_pk_bf16_f32 v77, v50, v51
    s_nop 0
    v_cvt_pk_bf16_f32 v78, v52, v53
    v_cvt_pk_bf16_f32 v79, v54, v55
    ds_write_b128 v17, v[76:79] offset:1024
    v_smfmac_f32_16x16x64_bf16 v[56:59], v[24:27], a[128:135], v172
    v_smfmac_f32_16x16x64_bf16 v[60:63], v[24:27], a[160:167], v172
    v_smfmac_f32_16x16x64_bf16 v[56:59], v[28:31], a[136:143], v172
    s_waitcnt lgkmcnt(0)
    s_barrier
    v_smfmac_f32_16x16x64_bf16 v[60:63], v[28:31], a[168:175], v172
    v_smfmac_f32_16x16x64_bf16 v[56:59], v[32:35], a[144:151], v172
    v_smfmac_f32_16x16x64_bf16 v[60:63], v[32:35], a[176:183], v172
    v_smfmac_f32_16x16x64_bf16 v[56:59], v[36:39], a[152:159], v172
    v_smfmac_f32_16x16x64_bf16 v[60:63], v[36:39], a[184:191], v172
    s_nop 4
    v_cvt_pk_bf16_f32 v80, v56, v57
    v_cvt_pk_bf16_f32 v81, v58, v59
    s_nop 0
    v_cvt_pk_bf16_f32 v82, v60, v61
    v_cvt_pk_bf16_f32 v83, v62, v63
    ds_write_b128 v17, v[80:83] offset:8192
    s_cmp_eq_u32 s15, 63
    s_waitcnt lgkmcnt(0)
    s_barrier
    ds_read_b128 v[96:99], v16 offset:8192
    ds_read_b128 v[100:103], v16 offset:10240
    ds_read_b128 v[108:111], v16 offset:14336
    v_mfma_f32_16x16x32_bf16 v[140:143], v[84:87], v[80:83], 0
    s_waitcnt lgkmcnt(2)
    v_mfma_f32_16x16x32_bf16 v[140:143], v[84:87], v[96:99], v[140:143]
    s_waitcnt lgkmcnt(1)
    v_mfma_f32_16x16x32_bf16 v[140:143], v[84:87], v[100:103], v[140:143]
    s_waitcnt lgkmcnt(0)
    v_mfma_f32_16x16x32_bf16 v[140:143], v[84:87], v[108:111], v[140:143]
    s_nop 7
    v_cvt_pk_bf16_f32 v168, v140, v141
    v_cvt_pk_bf16_f32 v169, v142, v143
    v_mov_b32 v170, v168
    v_mov_b32 v171, v169
    s_nop 0
    v_permlane16_swap_b32 v168, v170
    v_permlane16_swap_b32 v169, v171
    v_mov_b32 v247, s15
    s_cbranch_scc1 recur_slow_last2
    s_barrier
    s_nop 15
    s_mov_b32 s23, s25
g_68:
    buffer_load_dwordx4 v[24:27], v8, s[4:7], s16 offen offset:0 sc1
    buffer_load_dwordx4 v[28:31], v8, s[4:7], s16 offen offset:1024 sc1
    buffer_load_dwordx4 v[32:35], v8, s[4:7], s16 offen offset:2048 sc1
    buffer_load_dwordx4 v[36:39], v8, s[4:7], s16 offen offset:3072 sc1
    s_waitcnt vmcnt(0)
    v_max3_u32 v19, v24, v25, v26
    v_max3_u32 v19, v19, v27, v28
    v_max3_u32 v19, v19, v29, v30
    v_max3_u32 v19, v19, v31, v32
    v_max3_u32 v19, v19, v33, v34
    v_max3_u32 v19, v19, v35, v36
    v_max3_u32 v19, v19, v37, v38
    v_max_u32 v19, v19, v39
    v_cmp_eq_u32 vcc, -1, v19
    s_nop 0
    s_cbranch_vccz g_68k
    s_add_u32 s23, s23, 1
    s_cmp_lt_u32 s23, 200000
    s_cbranch_scc1 g_68
    s_mov_b32 s25, 200000
g_68k:
    v_smfmac_f32_16x16x64_bf16 v[64:67], v[24:27], a[192:199], v172
    v_smfmac_f32_16x16x64_bf16 v[68:71], v[24:27], a[224:231], v172
    v_smfmac_f32_16x16x64_bf16 v[64:67], v[28:31], a[200:207], v172
    v_smfmac_f32_16x16x64_bf16 v[68:71], v[28:31], a[232:239], v172
    v_smfmac_f32_16x16x64_bf16 v[64:67], v[32:35], a[208:215], v172
    v_smfmac_f32_16x16x64_bf16 v[68:71], v[32:35], a[240:247], v172
    v_smfmac_f32_16x16x64_bf16 v[64:67], v[36:39], a[216:223], v172
    v_smfmac_f32_16x16x64_bf16 v[68:71], v[36:39], a[248:255], v172
    s_nop 4
    v_cvt_pk_bf16_f32 v80, v64, v65
    v_cvt_pk_bf16_f32 v81, v66, v67
    s_nop 0
    v_cvt_pk_bf16_f32 v82, v68, v69
    v_cvt_pk_bf16_f32 v83, v70, v71
    ds_write_b128 v17, v[80:83] offset:9216
    s_waitcnt lgkmcnt(0)
    s_barrier
    s_nop 15
    s_nop 15
    s_nop 15
    s_nop 15
    buffer_store_dwordx4 v[168:171], v15, s[4:7], s20 offen sc1
    s_add_u32 s20, s20, 512
    s_add_u32 s21, s95, 1048576
    s_lshr_b32 s22, s21, 8
    s_and_b32 s22, s22, 8192
    s_xor_b32 s22, s22, s46
    s_add_u32 s21, s21, s22
    buffer_store_dwordx4 v[204:207], v9, s[4:7], s21 offen sc1
    s_add_u32 s21, s21, 262144
    buffer_store_dword v247, v246, s[4:7], 0 offen sc1
    v_mov_b32 v40, 0
    v_mov_b32 v41, 0
    v_mov_b32 v42, 0
    v_mov_b32 v43, 0
    v_mov_b32 v44, 0
    v_mov_b32 v45, 0
    v_mov_b32 v46, 0
    v_mov_b32 v47, 0
    v_mov_b32 v48, 0
    v_mov_b32 v49, 0
    v_mov_b32 v50, 0
    v_mov_b32 v51, 0
    v_mov_b32 v52, 0
    v_mov_b32 v53, 0
    v_mov_b32 v54, 0
    v_mov_b32 v55, 0
    v_mov_b32 v56, 0
    v_mov_b32 v57, 0
    v_mov_b32 v58, 0
    v_mov_b32 v59, 0
    v_mov_b32 v60, 0
    v_mov_b32 v61, 0
    v_mov_b32 v62, 0
    v_mov_b32 v63, 0
    v_mov_b32 v64, 0
    v_mov_b32 v65, 0
    v_mov_b32 v66, 0
    v_mov_b32 v67, 0
    v_mov_b32 v68, 0
    v_mov_b32 v69, 0
    v_mov_b32 v70, 0
    v_mov_b32 v71, 0
    s_mov_b32 s21, s16
    s_mov_b32 s16, s42
    s_mov_b32 s42, s43
    s_mov_b32 s43, s44
    s_mov_b32 s44, s21
    s_add_u32 s95, s95, 524288
    s_lshr_b32 s84, s95, 8
    s_and_b32 s84, s84, 8192
    s_xor_b32 s84, s84, s46
    s_add_u32 s84, s84, s95
    s_add_u32 s15, s15, 1
    s_barrier
    s_branch recur_slow_w2
recur_slow_last2:
    buffer_store_dwordx4 v[168:171], v15, s[4:7], s20 offen sc1
    s_waitcnt vmcnt(0)
    s_branch recur_end
.p2align 6
recur_slow_w3:
    s_nop 15
    s_mov_b32 s23, s25
g_69:
    buffer_load_dwordx4 v[24:27], v2, s[4:7], s16 offen offset:0 sc1
    buffer_load_dwordx4 v[28:31], v2, s[4:7], s16 offen offset:1024 sc1
    buffer_load_dwordx4 v[32:35], v2, s[4:7], s16 offen offset:2048 sc1
    buffer_load_dwordx4 v[36:39], v2, s[4:7], s16 offen offset:3072 sc1
    s_waitcnt vmcnt(0)
    v_max3_u32 v19, v24, v25, v26
    v_max3_u32 v19, v19, v27, v28
    v_max3_u32 v19, v19, v29, v30
    v_max3_u32 v19, v19, v31, v32
    v_max3_u32 v19, v19, v33, v34
    v_max3_u32 v19, v19, v35, v36
    v_max3_u32 v19, v19, v37, v38
    v_max_u32 v19, v19, v39
    v_cmp_eq_u32 vcc, -1, v19
    s_nop 0
    s_cbranch_vccz g_69k
    s_add_u32 s23, s23, 1
    s_cmp_lt_u32 s23, 200000
    s_cbranch_scc1 g_69
    s_mov_b32 s25, 200000
g_69k:
    v_smfmac_f32_16x16x64_bf16 v[40:43], v[24:27], a[0:7], v172
    v_smfmac_f32_16x16x64_bf16 v[44:47], v[24:27], a[64:71], v172
    v_smfmac_f32_16x16x64_bf16 v[48:51], v[24:27], a[32:39], v172
    v_smfmac_f32_16x16x64_bf16 v[52:55], v[24:27], a[96:103], v172
    v_smfmac_f32_16x16x64_bf16 v[40:43], v[28:31], a[8:15], v172
    v_smfmac_f32_16x16x64_bf16 v[44:47], v[28:31], a[72:79], v172
    v_smfmac_f32_16x16x64_bf16 v[48:51], v[28:31], a[40:47], v172
    v_smfmac_f32_16x16x64_bf16 v[52:55], v[28:31], a[104:111], v172
    v_smfmac_f32_16x16x64_bf16 v[40:43], v[32:35], a[16:23], v172
    v_smfmac_f32_16x16x64_bf16 v[44:47], v[32:35], a[80:87], v172
    v_smfmac_f32_16x16x64_bf16 v[48:51], v[32:35], a[48:55], v172
    v_smfmac_f32_16x16x64_bf16 v[52:55], v[32:35], a[112:119], v172
    v_smfmac_f32_16x16x64_bf16 v[40:43], v[36:39], a[24:31], v172
    v_smfmac_f32_16x16x64_bf16 v[44:47], v[36:39], a[88:95], v172
    v_smfmac_f32_16x16x64_bf16 v[48:51], v[36:39], a[56:63], v172
    v_smfmac_f32_16x16x64_bf16 v[52:55], v[36:39], a[120:127], v172
    v_cvt_pk_bf16_f32 v72, v40, v41
    v_cvt_pk_bf16_f32 v73, v42, v43
    v_cvt_pk_bf16_f32 v74, v44, v45
    v_cvt_pk_bf16_f32 v75, v46, v47
    ds_write_b128 v17, v[72:75] offset:0
    v_cvt_pk_bf16_f32 v76, v48, v49
    v_cvt_pk_bf16_f32 v77, v50, v51
    s_nop 0
    v_cvt_pk_bf16_f32 v78, v52, v53
    v_cvt_pk_bf16_f32 v79, v54, v55
    ds_write_b128 v17, v[76:79] offset:1024
    v_smfmac_f32_16x16x64_bf16 v[56:59], v[24:27], a[128:135], v172
    v_smfmac_f32_16x16x64_bf16 v[60:63], v[24:27], a[160:167], v172
    v_smfmac_f32_16x16x64_bf16 v[56:59], v[28:31], a[136:143], v172
    s_waitcnt lgkmcnt(0)
    s_barrier
    v_smfmac_f32_16x16x64_bf16 v[60:63], v[28:31], a[168:175], v172
    v_smfmac_f32_16x16x64_bf16 v[56:59], v[32:35], a[144:151], v172
    v_smfmac_f32_16x16x64_bf16 v[60:63], v[32:35], a[176:183], v172
    v_smfmac_f32_16x16x64_bf16 v[56:59], v[36:39], a[152:159], v172
    v_smfmac_f32_16x16x64_bf16 v[60:63], v[36:39], a[184:191], v172
    s_nop 4
    v_cvt_pk_bf16_f32 v80, v56, v57
    v_cvt_pk_bf16_f32 v81, v58, v59
    s_nop 0
    v_cvt_pk_bf16_f32 v82, v60, v61
    v_cvt_pk_bf16_f32 v83, v62, v63
    ds_write_b128 v17, v[80:83] offset:8192
    buffer_store_dwordx4 v[204:207], v3, s[4:7], s43 offen sc1
    buffer_store_dwordx4 v[204:207], v3, s[4:7], s43 offen offset:128 sc1
    buffer_store_dwordx4 v[204:207], v4, s[4:7], s43 offen sc1
    buffer_store_dwordx2 v[204:205], v7, s[4:7], s43 offen sc1
    buffer_store_dwordx2 v[204:205], v11, s[4:7], s43 offen sc1
    s_cmp_eq_u32 s15, 63
    s_waitcnt lgkmcnt(0)
    s_barrier
    s_cbranch_scc1 recur_end
    s_barrier
    s_nop 15
    s_mov_b32 s23, s25
g_70:
    buffer_load_dwordx4 v[24:27], v8, s[4:7], s16 offen offset:0 sc1
    buffer_load_dwordx4 v[28:31], v8, s[4:7], s16 offen offset:1024 sc1
    buffer_load_dwordx4 v[32:35], v8, s[4:7], s16 offen offset:2048 sc1
    buffer_load_dwordx4 v[36:39], v8, s[4:7], s16 offen offset:3072 sc1
    s_waitcnt vmcnt(0)
    v_max3_u32 v19, v24, v25, v26
    v_max3_u32 v19, v19, v27, v28
    v_max3_u32 v19, v19, v29, v30
    v_max3_u32 v19, v19, v31, v32
    v_max3_u32 v19, v19, v33, v34
    v_max3_u32 v19, v19, v35, v36
    v_max3_u32 v19, v19, v37, v38
    v_max_u32 v19, v19, v39
    v_cmp_eq_u32 vcc, -1, v19
    s_nop 0
    s_cbranch_vccz g_70k
    s_add_u32 s23, s23, 1
    s_cmp_lt_u32 s23, 200000
    s_cbranch_scc1 g_70
    s_mov_b32 s25, 200000
g_70k:
    v_smfmac_f32_16x16x64_bf16 v[64:67], v[24:27], a[192:199], v172
    v_smfmac_f32_16x16x64_bf16 v[68:71], v[24:27], a[224:231], v172
    v_smfmac_f32_16x16x64_bf16 v[64:67], v[28:31], a[200:207], v172
    v_smfmac_f32_16x16x64_bf16 v[68:71], v[28:31], a[232:239], v172
    v_smfmac_f32_16x16x64_bf16 v[64:67], v[32:35], a[208:215], v172
    v_smfmac_f32_16x16x64_bf16 v[68:71], v[32:35], a[240:247], v172
    v_smfmac_f32_16x16x64_bf16 v[64:67], v[36:39], a[216:223], v172
    v_smfmac_f32_16x16x64_bf16 v[68:71], v[36:39], a[248:255], v172
    s_nop 4
    v_cvt_pk_bf16_f32 v80, v64, v65
    v_cvt_pk_bf16_f32 v81, v66, v67
    s_nop 0
    v_cvt_pk_bf16_f32 v82, v68, v69
    v_cvt_pk_bf16_f32 v83, v70, v71
    s_nop 1
    v_mfma_f32_16x16x32_bf16 v[88:91], v[80:83], v[84:87], 0
    s_barrier
    ds_read_b128 v[96:99], v16 offset:9216
    ds_read_b128 v[100:103], v16 offset:11264
    ds_read_b128 v[104:107], v16 offset:13312
    s_waitcnt lgkmcnt(2)
    v_mfma_f32_16x16x32_bf16 v[88:91], v[96:99], v[84:87], v[88:91]
    s_waitcnt lgkmcnt(1)
    v_mfma_f32_16x16x32_bf16 v[88:91], v[100:103], v[84:87], v[88:91]
    s_waitcnt lgkmcnt(0)
    v_mfma_f32_16x16x32_bf16 v[88:91], v[104:107], v[84:87], v[88:91]
    s_nop 7
    buffer_store_dwordx4 v[88:91], v9, s[4:7], s84 offen sc1
    s_add_u32 s22, s84, 262144
    s_nop 15
    s_nop 15
    s_nop 15
    s_nop 15
    s_nop 15
    s_nop 15
    s_nop 15
    s_nop 15
    s_mov_b32 s23, s25
    buffer_load_dwordx4 v[96:99], v10, s[4:7], s84 offen sc1
    buffer_load_dwordx4 v[100:103], v23, s[4:7], s84 offen sc1
    buffer_load_dwordx4 v[104:107], v244, s[4:7], s84 offen sc1
    v_mov_b32 v40, 0
    v_mov_b32 v41, 0
    v_mov_b32 v42, 0
    v_mov_b32 v43, 0
    v_mov_b32 v44, 0
    v_mov_b32 v45, 0
    v_mov_b32 v46, 0
    v_mov_b32 v47, 0
    v_mov_b32 v48, 0
    v_mov_b32 v49, 0
    v_mov_b32 v50, 0
    v_mov_b32 v51, 0
    v_mov_b32 v52, 0
    v_mov_b32 v53, 0
    v_mov_b32 v54, 0
    v_mov_b32 v55, 0
    v_mov_b32 v56, 0
    v_mov_b32 v57, 0
    v_mov_b32 v58, 0
    v_mov_b32 v59, 0
    v_mov_b32 v60, 0
    v_mov_b32 v61, 0
    v_mov_b32 v62, 0
    v_mov_b32 v63, 0
    v_mov_b32 v64, 0
    v_mov_b32 v65, 0
    v_mov_b32 v66, 0
    v_mov_b32 v67, 0
    v_mov_b32 v68, 0
    v_mov_b32 v69, 0
    v_mov_b32 v70, 0
    v_mov_b32 v71, 0
pb_73:
    s_waitcnt vmcnt(2)
    v_pk_add_f32 v[120:121], v[88:89], v[96:97]
    v_pk_add_f32 v[122:123], v[90:91], v[98:99]
    s_waitcnt vmcnt(1)
    v_pk_add_f32 v[120:121], v[120:121], v[100:101]
    v_pk_add_f32 v[122:123], v[122:123], v[102:103]
    s_waitcnt vmcnt(0)
    v_pk_add_f32 v[120:121], v[120:121], v[104:105]
    v_pk_add_f32 v[122:123], v[122:123], v[106:107]
    v_cvt_pk_bf16_f32 v180, v120, v121
    v_pk_add_f32 v[124:125], v[120:121], v[122:123]
    v_cvt_pk_bf16_f32 v181, v122, v123
    v_cmpx_o_f32 vcc, v124, v125
    buffer_store_dwordx2 v[180:181], v11, s[4:7], s42 offen sc1
    s_cmp_eq_u64 vcc, -1
    s_mov_b64 exec, -1
    s_cbranch_scc0 pr_71
pg_72:
    s_barrier
    s_mov_b32 s21, s16
    s_mov_b32 s16, s42
    s_mov_b32 s42, s43
    s_mov_b32 s43, s44
    s_mov_b32 s44, s21
    s_add_u32 s95, s95, 524288
    s_lshr_b32 s84, s95, 8
    s_and_b32 s84, s84, 8192
    s_xor_b32 s84, s84, s46
    s_add_u32 s84, s84, s95
    s_add_u32 s15, s15, 1
    s_branch recur_slow_w3
pr_71:
    v_max3_u32 v19, v96, v97, v98
    v_max3_u32 v19, v19, v99, v100
    v_max3_u32 v19, v19, v101, v102
    v_max3_u32 v19, v19, v103, v104
    v_max3_u32 v19, v19, v105, v106
    v_max_u32 v19, v19, v107
    v_cmp_eq_u32 vcc, -1, v19
    s_nop 0
    s_cbranch_vccz pf_75
    buffer_load_dwordx4 v[96:99], v10, s[4:7], s84 offen sc1
    buffer_load_dwordx4 v[100:103], v23, s[4:7], s84 offen sc1
    buffer_load_dwordx4 v[104:107], v244, s[4:7], s84 offen sc1
    s_add_u32 s23, s23, 1
    s_cmp_lt_u32 s23, 200000
    s_cbranch_scc1 pb_73
    s_mov_b32 s25, 200000
pf_75:
    buffer_store_dwordx2 v[180:181], v11, s[4:7], s42 offen sc1
    s_branch pg_72
recur_end:
    s_barrier
    v_mov_b32 v247, 64
    buffer_store_dword v247, v246, s[4:7], 0 offen sc1
    s_endpgm
.section .rodata,"a"
.p2align 6
.amdhsa_kernel concat_heads__spectral_gfnet__memory_aug_recurrent_mem_tr__prompt_kernel
  .amdhsa_next_free_vgpr 512
  .amdhsa_next_free_sgpr 102
  .amdhsa_accum_offset 256
  .amdhsa_group_segment_fixed_size 0
  .amdhsa_kernarg_size 104
  .amdhsa_user_sgpr_count 2
  .amdhsa_user_sgpr_kernarg_segment_ptr 1
  .amdhsa_system_sgpr_workgroup_id_x 1
  .amdhsa_float_denorm_mode_32 3
.end_amdhsa_kernel
```

```asm
; @launch kernel=concat_heads__spectral_gfnet__memory_aug_recurrent_mem_tr__prompt_kernel grid=(256,1,1) block=(256,1,1) lds=163840
.amdgcn_target "amdgcn-amd-amdhsa--gfx950"
.text
.globl concat_heads__spectral_gfnet__memory_aug_recurrent_mem_tr__prompt_kernel
.p2align 8
.type concat_heads__spectral_gfnet__memory_aug_recurrent_mem_tr__prompt_kernel,@function
concat_heads__spectral_gfnet__memory_aug_recurrent_mem_tr__prompt_kernel:
    s_cmp_ge_u32 s2, 256
    s_cbranch_scc1 W_end
    s_load_dwordx2 s[100:101], s[0:1], 88
    s_mov_b32 s97, s2
    s_mov_b32 s98, 0
    s_getreg_b32 s3, hwreg(HW_REG_XCC_ID, 0, 3)
role_start:
    s_andn2_b32 s2, s97, 7
    s_or_b32 s2, s2, s3
    s_bitcmp1_b32 s3, 2
    s_cbranch_scc0 R_entry
    s_cmp_ge_u32 s2, 256
    s_cbranch_scc1 W_end
    s_load_dwordx2 s[4:5], s[0:1], 96
    v_lshrrev_b32 v5, 6, v0
    v_and_b32 v1, 63, v0
    v_readfirstlane_b32 s16, v5
    s_mov_b32 s6, 268435456
    s_mov_b32 s7, 0x20000
    s_waitcnt lgkmcnt(0)
    s_lshr_b32 s90, s2, 6
    s_bfe_u32 s91, s2, 0x30003
    s_lshl_b32 s91, s91, 2
    s_and_b32 s17, s3, 3
    s_add_u32 s91, s91, s17
    s_lshl_b32 s93, s17, 3
    s_lshr_b32 s17, s91, 2
    s_add_u32 s93, s93, s17
    s_mov_b32 s92, 0
    s_lshl_b32 s17, s93, 2
    s_add_u32 s17, s17, s16
    s_lshl_b32 s18, s90, 7
    s_add_u32 s18, s18, s17
    s_lshl_b32 s18, s18, 7
    s_add_u32 s18, s18, 100663296
    s_lshl_b32 s20, s17, 7
    s_add_u32 s20, s20, 100728832
    s_cmp_eq_u32 s90, 3
    s_cselect_b32 s18, s20, s18
    s_cselect_b64 exec, 7, 1
    v_mov_b32 v5, s18
    s_and_b32 s18, s17, 31
    s_lshl_b32 s18, s18, 2
    s_lshr_b32 s20, s93, 3
    s_add_u32 s18, s18, s20
    s_lshl_b32 s18, s18, 7
    s_add_u32 s18, s18, 100745216
    v_writelane_b32 v5, s18, 1
    s_lshl_b32 s18, s17, 7
    s_add_u32 s18, s18, 100761600
    v_writelane_b32 v5, s18, 2
    v_mov_b32 v6, 0
    buffer_store_dword v6, v5, s[4:7], 0 offen sc1
    s_mov_b64 exec, -1
    s_cmp_eq_u32 s90, 3
    s_cbranch_scc1 W_F
    s_load_dwordx2 s[8:9], s[0:1], 24
    s_mov_b32 s10, 4194304
    s_mov_b32 s11, 0x20000
    s_lshr_b32 s17, s2, 3
    s_lshl_b32 s17, s17, 15
    v_lshlrev_b32 v5, 7, v0
    s_waitcnt lgkmcnt(0)
    buffer_load_dword v254, v5, s[8:11], s17 offen
    s_cmp_lg_u32 s90, 0
    s_cbranch_scc1 W_P
    s_waitcnt vmcnt(0)
    s_barrier
    s_or_b32 s17, s16, s98
    s_cmp_lg_u32 s17, 0
    s_cbranch_scc1 vote_1
    s_lshl_b32 s17, s91, 14
    s_add_u32 s17, s17, 239075328
    v_lshlrev_b32 v5, 2, v1
    v_add_u32 v5, s17, v5
    v_add_u32 v6, 8192, v5
    s_mov_b32 s20, -1
    s_mov_b32 s21, -1
    s_mov_b64 exec, 1
    buffer_store_dword v1, v5, s[4:7], 0 offen sc1
    s_mov_b32 s22, 0
vp_2:
    s_add_u32 s22, s22, 1
    s_getreg_b32 s18, hwreg(HW_REG_IB_STS, 0, 4)
    s_cmp_lt_u32 s22, 2048
    s_cselect_b32 s18, s18, 0
    s_cmp_lg_u32 s18, 0
    s_cbranch_scc1 vp_2
    s_min_u32 s20, s20, s22
    buffer_store_dword v1, v6, s[4:7], 0 offen sc1
    s_mov_b32 s22, 0
vp_3:
    s_add_u32 s22, s22, 1
    s_getreg_b32 s18, hwreg(HW_REG_IB_STS, 0, 4)
    s_cmp_lt_u32 s22, 2048
    s_cselect_b32 s18, s18, 0
    s_cmp_lg_u32 s18, 0
    s_cbranch_scc1 vp_3
    s_min_u32 s21, s21, s22
    buffer_store_dword v1, v5, s[4:7], 0 offen sc1
    s_mov_b32 s22, 0
vp_4:
    s_add_u32 s22, s22, 1
    s_getreg_b32 s18, hwreg(HW_REG_IB_STS, 0, 4)
    s_cmp_lt_u32 s22, 2048
    s_cselect_b32 s18, s18, 0
    s_cmp_lg_u32 s18, 0
    s_cbranch_scc1 vp_4
    s_min_u32 s20, s20, s22
    buffer_store_dword v1, v6, s[4:7], 0 offen sc1
    s_mov_b32 s22, 0
vp_5:
    s_add_u32 s22, s22, 1
    s_getreg_b32 s18, hwreg(HW_REG_IB_STS, 0, 4)
    s_cmp_lt_u32 s22, 2048
    s_cselect_b32 s18, s18, 0
    s_cmp_lg_u32 s18, 0
    s_cbranch_scc1 vp_5
    s_min_u32 s21, s21, s22
    buffer_store_dword v1, v5, s[4:7], 0 offen sc1
    s_mov_b32 s22, 0
vp_6:
    s_add_u32 s22, s22, 1
    s_getreg_b32 s18, hwreg(HW_REG_IB_STS, 0, 4)
    s_cmp_lt_u32 s22, 2048
    s_cselect_b32 s18, s18, 0
    s_cmp_lg_u32 s18, 0
    s_cbranch_scc1 vp_6
    s_min_u32 s20, s20, s22
    buffer_store_dword v1, v6, s[4:7], 0 offen sc1
    s_mov_b32 s22, 0
vp_7:
    s_add_u32 s22, s22, 1
    s_getreg_b32 s18, hwreg(HW_REG_IB_STS, 0, 4)
    s_cmp_lt_u32 s22, 2048
    s_cselect_b32 s18, s18, 0
    s_cmp_lg_u32 s18, 0
    s_cbranch_scc1 vp_7
    s_min_u32 s21, s21, s22
    buffer_store_dword v1, v5, s[4:7], 0 offen sc1
    s_mov_b32 s22, 0
vp_8:
    s_add_u32 s22, s22, 1
    s_getreg_b32 s18, hwreg(HW_REG_IB_STS, 0, 4)
    s_cmp_lt_u32 s22, 2048
    s_cselect_b32 s18, s18, 0
    s_cmp_lg_u32 s18, 0
    s_cbranch_scc1 vp_8
    s_min_u32 s20, s20, s22
    buffer_store_dword v1, v6, s[4:7], 0 offen sc1
    s_mov_b32 s22, 0
vp_9:
    s_add_u32 s22, s22, 1
    s_getreg_b32 s18, hwreg(HW_REG_IB_STS, 0, 4)
    s_cmp_lt_u32 s22, 2048
    s_cselect_b32 s18, s18, 0
    s_cmp_lg_u32 s18, 0
    s_cbranch_scc1 vp_9
    s_min_u32 s21, s21, s22
    s_and_b32 s17, s97, 3
    s_lshl_b32 s17, s17, 3
    s_lshl_b32 s17, 0x40, s17
    s_cmp_lt_u32 s20, s21
    s_cselect_b32 s17, s17, 0
    s_andn2_b32 s18, s97, 3
    v_mov_b32 v5, s18
    v_mov_b32 v6, s17
    global_atomic_add v5, v6, s[100:101] sc1
    s_mov_b64 exec, -1
    s_waitcnt vmcnt(0)
vote_1:
    s_waitcnt vmcnt(0)
    s_barrier
    s_cmp_lg_u32 s16, 0
    s_cbranch_scc1 reg_10
    s_and_b32 s17, s2, 3
    s_lshl_b32 s17, s17, 3
    s_lshl_b32 s18, s98, 2
    s_add_u32 s17, s17, s18
    s_lshl_b32 s17, 1, s17
    s_andn2_b32 s18, s2, 3
    v_mov_b32 v5, s18
    v_mov_b32 v6, s17
    s_mov_b64 exec, 1
    global_atomic_add v5, v6, s[100:101] sc1
    s_mov_b64 exec, -1
reg_10:
W_P:
    s_load_dwordx2 s[12:13], s[0:1], 40
    s_load_dwordx2 s[28:29], s[0:1], 48
    s_load_dwordx2 s[30:31], s[0:1], 56
    s_load_dwordx2 s[8:9], s[0:1], 24
    s_mov_b32 s10, 4194304
    s_mov_b32 s11, 0x20000
    s_mov_b32 s14, 8388608
    s_mov_b32 s15, 0x20000
    s_waitcnt lgkmcnt(0)
    s_cmp_eq_u32 s90, 1
    s_cselect_b64 s[12:13], s[28:29], s[12:13]
    s_cmp_eq_u32 s90, 2
    s_cselect_b64 s[12:13], s[30:31], s[12:13]
    s_lshl_b32 s28, s93, 2
    s_add_u32 s28, s28, s16
    s_lshl_b32 s20, s28, 6
    v_lshrrev_b32 v5, 2, v1
    v_and_b32 v6, 3, v1
    v_lshlrev_b32 v8, 4, v6
    v_lshl_add_u32 v7, v5, 13, v8
    s_mul_i32 s19, s16, 40960
    s_and_b32 s17, s93, 3
    s_lshl_b32 s17, s17, 8
    v_add_lshl_u32 v2, v0, s17, 13
    s_andn2_b32 s17, s93, 3
    s_lshl_b32 s17, s17, 8
    buffer_load_dword v253, v2, s[12:15], s17 offen offset:384
    s_add_u32 m0, s19, 0
    s_nop 0
    buffer_load_dwordx4 v7, s[12:15], s20 offen lds
    s_add_u32 s20, s20, 131072
    s_add_u32 m0, s19, 1024
    s_nop 0
    buffer_load_dwordx4 v7, s[12:15], s20 offen lds
    s_add_u32 s20, s20, 131072
    s_add_u32 m0, s19, 2048
    s_nop 0
    buffer_load_dwordx4 v7, s[12:15], s20 offen lds
    s_add_u32 s20, s20, 131072
    s_add_u32 m0, s19, 3072
    s_nop 0
    buffer_load_dwordx4 v7, s[12:15], s20 offen lds
    s_add_u32 s20, s20, 131072
    v_bfe_u32 v5, v1, 2, 2
    v_lshrrev_b32 v6, 4, v1
    v_lshl_add_u32 v5, v6, 3, v5
    v_lshl_add_u32 v8, v5, 6, v8
    v_add_u32 v8, s19, v8
    s_cmp_eq_u32 s90, 0
    s_cbranch_scc1 nq_11
    s_waitcnt vmcnt(6)
    s_barrier
    s_cmp_lg_u32 s16, 0
    s_cbranch_scc1 reg_12
    s_and_b32 s17, s2, 3
    s_lshl_b32 s17, s17, 3
    s_lshl_b32 s18, s98, 2
    s_add_u32 s17, s17, s18
    s_lshl_b32 s17, 1, s17
    s_andn2_b32 s18, s2, 3
    v_mov_b32 v5, s18
    v_mov_b32 v6, s17
    s_mov_b64 exec, 1
    global_atomic_add v5, v6, s[100:101] sc1
    s_mov_b64 exec, -1
reg_12:
    s_barrier
nq_11:
    s_add_u32 m0, s19, 4096
    s_nop 0
    buffer_load_dwordx4 v7, s[12:15], s20 offen lds
    s_add_u32 s20, s20, 131072
    s_add_u32 m0, s19, 5120
    s_nop 0
    buffer_load_dwordx4 v7, s[12:15], s20 offen lds
    s_add_u32 s20, s20, 131072
    s_add_u32 m0, s19, 6144
    s_nop 0
    buffer_load_dwordx4 v7, s[12:15], s20 offen lds
    s_add_u32 s20, s20, 131072
    s_add_u32 m0, s19, 7168
    s_nop 0
    buffer_load_dwordx4 v7, s[12:15], s20 offen lds
    s_add_u32 s20, s20, 131072
    s_add_u32 m0, s19, 8192
    s_nop 0
    buffer_load_dwordx4 v7, s[12:15], s20 offen lds
    s_add_u32 s20, s20, 131072
    s_add_u32 m0, s19, 9216
    s_nop 0
    buffer_load_dwordx4 v7, s[12:15], s20 offen lds
    s_add_u32 s20, s20, 131072
    s_add_u32 m0, s19, 10240
    s_nop 0
    buffer_load_dwordx4 v7, s[12:15], s20 offen lds
    s_add_u32 s20, s20, 131072
    s_add_u32 m0, s19, 11264
    s_nop 0
    buffer_load_dwordx4 v7, s[12:15], s20 offen lds
    s_add_u32 s20, s20, 131072
    s_add_u32 m0, s19, 12288
    s_nop 0
    buffer_load_dwordx4 v7, s[12:15], s20 offen lds
    s_add_u32 s20, s20, 131072
    s_add_u32 m0, s19, 13312
    s_nop 0
    buffer_load_dwordx4 v7, s[12:15], s20 offen lds
    s_add_u32 s20, s20, 131072
    s_add_u32 m0, s19, 14336
    s_nop 0
    buffer_load_dwordx4 v7, s[12:15], s20 offen lds
    s_add_u32 s20, s20, 131072
    s_add_u32 m0, s19, 15360
    s_nop 0
    buffer_load_dwordx4 v7, s[12:15], s20 offen lds
    s_add_u32 s20, s20, 131072
    s_add_u32 m0, s19, 16384
    s_nop 0
    buffer_load_dwordx4 v7, s[12:15], s20 offen lds
    s_add_u32 s20, s20, 131072
    s_add_u32 m0, s19, 17408
    s_nop 0
    buffer_load_dwordx4 v7, s[12:15], s20 offen lds
    s_add_u32 s20, s20, 131072
    s_add_u32 m0, s19, 18432
    s_nop 0
    buffer_load_dwordx4 v7, s[12:15], s20 offen lds
    s_add_u32 s20, s20, 131072
    s_add_u32 m0, s19, 19456
    s_nop 0
    buffer_load_dwordx4 v7, s[12:15], s20 offen lds
    s_add_u32 s20, s20, 131072
    s_add_u32 m0, s19, 20480
    s_nop 0
    buffer_load_dwordx4 v7, s[12:15], s20 offen lds
    s_add_u32 s20, s20, 131072
    s_add_u32 m0, s19, 21504
    s_nop 0
    buffer_load_dwordx4 v7, s[12:15], s20 offen lds
    s_add_u32 s20, s20, 131072
    s_add_u32 m0, s19, 22528
    s_nop 0
    buffer_load_dwordx4 v7, s[12:15], s20 offen lds
    s_add_u32 s20, s20, 131072
    s_add_u32 m0, s19, 23552
    s_nop 0
    buffer_load_dwordx4 v7, s[12:15], s20 offen lds
    s_add_u32 s20, s20, 131072
    s_add_u32 m0, s19, 24576
    s_nop 0
    buffer_load_dwordx4 v7, s[12:15], s20 offen lds
    s_add_u32 s20, s20, 131072
    s_add_u32 m0, s19, 25600
    s_nop 0
    buffer_load_dwordx4 v7, s[12:15], s20 offen lds
    s_add_u32 s20, s20, 131072
    s_add_u32 m0, s19, 26624
    s_nop 0
    buffer_load_dwordx4 v7, s[12:15], s20 offen lds
    s_add_u32 s20, s20, 131072
    s_add_u32 m0, s19, 27648
    s_nop 0
    buffer_load_dwordx4 v7, s[12:15], s20 offen lds
    s_add_u32 s20, s20, 131072
    s_add_u32 m0, s19, 28672
    s_nop 0
    buffer_load_dwordx4 v7, s[12:15], s20 offen lds
    s_add_u32 s20, s20, 131072
    s_add_u32 m0, s19, 29696
    s_nop 0
    buffer_load_dwordx4 v7, s[12:15], s20 offen lds
    s_add_u32 s20, s20, 131072
    s_add_u32 m0, s19, 30720
    s_nop 0
    buffer_load_dwordx4 v7, s[12:15], s20 offen lds
    s_add_u32 s20, s20, 131072
    s_add_u32 m0, s19, 31744
    s_nop 0
    buffer_load_dwordx4 v7, s[12:15], s20 offen lds
    s_add_u32 s20, s20, 131072
    s_add_u32 m0, s19, 32768
    s_nop 0
    buffer_load_dwordx4 v7, s[12:15], s20 offen lds
    s_add_u32 s20, s20, 131072
    s_add_u32 m0, s19, 33792
    s_nop 0
    buffer_load_dwordx4 v7, s[12:15], s20 offen lds
    s_add_u32 s20, s20, 131072
    s_add_u32 m0, s19, 34816
    s_nop 0
    buffer_load_dwordx4 v7, s[12:15], s20 offen lds
    s_add_u32 s20, s20, 131072
    s_add_u32 m0, s19, 35840
    s_nop 0
    buffer_load_dwordx4 v7, s[12:15], s20 offen lds
    s_add_u32 s20, s20, 131072
    s_add_u32 m0, s19, 36864
    s_nop 0
    buffer_load_dwordx4 v7, s[12:15], s20 offen lds
    s_add_u32 s20, s20, 131072
    s_add_u32 m0, s19, 37888
    s_nop 0
    buffer_load_dwordx4 v7, s[12:15], s20 offen lds
    s_add_u32 s20, s20, 131072
    s_add_u32 m0, s19, 38912
    s_nop 0
    buffer_load_dwordx4 v7, s[12:15], s20 offen lds
    s_add_u32 s20, s20, 131072
    s_add_u32 m0, s19, 39936
    s_nop 0
    buffer_load_dwordx4 v7, s[12:15], s20 offen lds
    s_add_u32 s20, s20, 131072
    s_waitcnt vmcnt(38)
    ds_read_b64_tr_b16 a[0:1], v8 offset:0
    ds_read_b64_tr_b16 a[2:3], v8 offset:256
    ds_read_b64_tr_b16 a[4:5], v8 offset:8
    ds_read_b64_tr_b16 a[6:7], v8 offset:264
    s_waitcnt vmcnt(36)
    ds_read_b64_tr_b16 a[8:9], v8 offset:2048
    ds_read_b64_tr_b16 a[10:11], v8 offset:2304
    ds_read_b64_tr_b16 a[12:13], v8 offset:2056
    ds_read_b64_tr_b16 a[14:15], v8 offset:2312
    s_waitcnt lgkmcnt(4)
    s_add_u32 m0, s19, 0
    s_nop 0
    buffer_load_dwordx4 v7, s[12:15], s20 offen lds
    s_add_u32 s20, s20, 131072
    s_add_u32 m0, s19, 1024
    s_nop 0
    buffer_load_dwordx4 v7, s[12:15], s20 offen lds
    s_add_u32 s20, s20, 131072
    s_waitcnt vmcnt(36)
    ds_read_b64_tr_b16 a[16:17], v8 offset:4096
    ds_read_b64_tr_b16 a[18:19], v8 offset:4352
    ds_read_b64_tr_b16 a[20:21], v8 offset:4104
    ds_read_b64_tr_b16 a[22:23], v8 offset:4360
    s_waitcnt lgkmcnt(4)
    s_add_u32 m0, s19, 2048
    s_nop 0
    buffer_load_dwordx4 v7, s[12:15], s20 offen lds
    s_add_u32 s20, s20, 131072
    s_add_u32 m0, s19, 3072
    s_nop 0
    buffer_load_dwordx4 v7, s[12:15], s20 offen lds
    s_add_u32 s20, s20, 131072
    s_waitcnt vmcnt(36)
    ds_read_b64_tr_b16 a[24:25], v8 offset:6144
    ds_read_b64_tr_b16 a[26:27], v8 offset:6400
    ds_read_b64_tr_b16 a[28:29], v8 offset:6152
    ds_read_b64_tr_b16 a[30:31], v8 offset:6408
    s_waitcnt lgkmcnt(4)
    s_add_u32 m0, s19, 4096
    s_nop 0
    buffer_load_dwordx4 v7, s[12:15], s20 offen lds
    s_add_u32 s20, s20, 131072
    s_add_u32 m0, s19, 5120
    s_nop 0
    buffer_load_dwordx4 v7, s[12:15], s20 offen lds
    s_add_u32 s20, s20, 131072
    s_waitcnt vmcnt(36)
    ds_read_b64_tr_b16 a[32:33], v8 offset:8192
    ds_read_b64_tr_b16 a[34:35], v8 offset:8448
    ds_read_b64_tr_b16 a[36:37], v8 offset:8200
    ds_read_b64_tr_b16 a[38:39], v8 offset:8456
    s_waitcnt lgkmcnt(4)
    s_add_u32 m0, s19, 6144
    s_nop 0
    buffer_load_dwordx4 v7, s[12:15], s20 offen lds
    s_add_u32 s20, s20, 131072
    s_add_u32 m0, s19, 7168
    s_nop 0
    buffer_load_dwordx4 v7, s[12:15], s20 offen lds
    s_add_u32 s20, s20, 131072
    s_waitcnt vmcnt(36)
    ds_read_b64_tr_b16 a[40:41], v8 offset:10240
    ds_read_b64_tr_b16 a[42:43], v8 offset:10496
    ds_read_b64_tr_b16 a[44:45], v8 offset:10248
    ds_read_b64_tr_b16 a[46:47], v8 offset:10504
    s_waitcnt lgkmcnt(4)
    s_add_u32 m0, s19, 8192
    s_nop 0
    buffer_load_dwordx4 v7, s[12:15], s20 offen lds
    s_add_u32 s20, s20, 131072
    s_add_u32 m0, s19, 9216
    s_nop 0
    buffer_load_dwordx4 v7, s[12:15], s20 offen lds
    s_add_u32 s20, s20, 131072
    s_waitcnt vmcnt(36)
    ds_read_b64_tr_b16 a[48:49], v8 offset:12288
    ds_read_b64_tr_b16 a[50:51], v8 offset:12544
    ds_read_b64_tr_b16 a[52:53], v8 offset:12296
    ds_read_b64_tr_b16 a[54:55], v8 offset:12552
    s_waitcnt lgkmcnt(4)
    s_add_u32 m0, s19, 10240
    s_nop 0
    buffer_load_dwordx4 v7, s[12:15], s20 offen lds
    s_add_u32 s20, s20, 131072
    s_add_u32 m0, s19, 11264
    s_nop 0
    buffer_load_dwordx4 v7, s[12:15], s20 offen lds
    s_add_u32 s20, s20, 131072
    s_waitcnt vmcnt(36)
    ds_read_b64_tr_b16 a[56:57], v8 offset:14336
    ds_read_b64_tr_b16 a[58:59], v8 offset:14592
    ds_read_b64_tr_b16 a[60:61], v8 offset:14344
    ds_read_b64_tr_b16 a[62:63], v8 offset:14600
    s_waitcnt lgkmcnt(4)
    s_add_u32 m0, s19, 12288
    s_nop 0
    buffer_load_dwordx4 v7, s[12:15], s20 offen lds
    s_add_u32 s20, s20, 131072
    s_add_u32 m0, s19, 13312
    s_nop 0
    buffer_load_dwordx4 v7, s[12:15], s20 offen lds
    s_add_u32 s20, s20, 131072
    s_waitcnt vmcnt(36)
    ds_read_b64_tr_b16 a[64:65], v8 offset:16384
    ds_read_b64_tr_b16 a[66:67], v8 offset:16640
    ds_read_b64_tr_b16 a[68:69], v8 offset:16392
    ds_read_b64_tr_b16 a[70:71], v8 offset:16648
    s_waitcnt lgkmcnt(4)
    s_add_u32 m0, s19, 14336
    s_nop 0
    buffer_load_dwordx4 v7, s[12:15], s20 offen lds
    s_add_u32 s20, s20, 131072
    s_add_u32 m0, s19, 15360
    s_nop 0
    buffer_load_dwordx4 v7, s[12:15], s20 offen lds
    s_add_u32 s20, s20, 131072
    s_waitcnt vmcnt(36)
    ds_read_b64_tr_b16 a[72:73], v8 offset:18432
    ds_read_b64_tr_b16 a[74:75], v8 offset:18688
    ds_read_b64_tr_b16 a[76:77], v8 offset:18440
    ds_read_b64_tr_b16 a[78:79], v8 offset:18696
    s_waitcnt lgkmcnt(4)
    s_add_u32 m0, s19, 16384
    s_nop 0
    buffer_load_dwordx4 v7, s[12:15], s20 offen lds
    s_add_u32 s20, s20, 131072
    s_add_u32 m0, s19, 17408
    s_nop 0
    buffer_load_dwordx4 v7, s[12:15], s20 offen lds
    s_add_u32 s20, s20, 131072
    s_waitcnt vmcnt(36)
    ds_read_b64_tr_b16 a[80:81], v8 offset:20480
    ds_read_b64_tr_b16 a[82:83], v8 offset:20736
    ds_read_b64_tr_b16 a[84:85], v8 offset:20488
    ds_read_b64_tr_b16 a[86:87], v8 offset:20744
    s_waitcnt lgkmcnt(4)
    s_add_u32 m0, s19, 18432
    s_nop 0
    buffer_load_dwordx4 v7, s[12:15], s20 offen lds
    s_add_u32 s20, s20, 131072
    s_add_u32 m0, s19, 19456
    s_nop 0
    buffer_load_dwordx4 v7, s[12:15], s20 offen lds
    s_add_u32 s20, s20, 131072
    s_waitcnt vmcnt(36)
    ds_read_b64_tr_b16 a[88:89], v8 offset:22528
    ds_read_b64_tr_b16 a[90:91], v8 offset:22784
    ds_read_b64_tr_b16 a[92:93], v8 offset:22536
    ds_read_b64_tr_b16 a[94:95], v8 offset:22792
    s_waitcnt lgkmcnt(4)
    s_add_u32 m0, s19, 20480
    s_nop 0
    buffer_load_dwordx4 v7, s[12:15], s20 offen lds
    s_add_u32 s20, s20, 131072
    s_add_u32 m0, s19, 21504
    s_nop 0
    buffer_load_dwordx4 v7, s[12:15], s20 offen lds
    s_add_u32 s20, s20, 131072
    s_waitcnt vmcnt(36)
    ds_read_b64_tr_b16 a[96:97], v8 offset:24576
    ds_read_b64_tr_b16 a[98:99], v8 offset:24832
    ds_read_b64_tr_b16 a[100:101], v8 offset:24584
    ds_read_b64_tr_b16 a[102:103], v8 offset:24840
    s_waitcnt lgkmcnt(4)
    s_add_u32 m0, s19, 22528
    s_nop 0
    buffer_load_dwordx4 v7, s[12:15], s20 offen lds
    s_add_u32 s20, s20, 131072
    s_add_u32 m0, s19, 23552
    s_nop 0
    buffer_load_dwordx4 v7, s[12:15], s20 offen lds
    s_add_u32 s20, s20, 131072
    s_waitcnt vmcnt(36)
    ds_read_b64_tr_b16 a[104:105], v8 offset:26624
    ds_read_b64_tr_b16 a[106:107], v8 offset:26880
    ds_read_b64_tr_b16 a[108:109], v8 offset:26632
    ds_read_b64_tr_b16 a[110:111], v8 offset:26888
    s_waitcnt lgkmcnt(7)
    s_waitcnt vmcnt(34)
    ds_read_b64_tr_b16 a[112:113], v8 offset:28672
    ds_read_b64_tr_b16 a[114:115], v8 offset:28928
    ds_read_b64_tr_b16 a[116:117], v8 offset:28680
    ds_read_b64_tr_b16 a[118:119], v8 offset:28936
    s_waitcnt vmcnt(32)
    ds_read_b64_tr_b16 a[120:121], v8 offset:30720
    ds_read_b64_tr_b16 a[122:123], v8 offset:30976
    ds_read_b64_tr_b16 a[124:125], v8 offset:30728
    ds_read_b64_tr_b16 a[126:127], v8 offset:30984
    s_waitcnt lgkmcnt(7)
    s_waitcnt vmcnt(30)
    ds_read_b64_tr_b16 a[128:129], v8 offset:32768
    ds_read_b64_tr_b16 a[130:131], v8 offset:33024
    ds_read_b64_tr_b16 a[132:133], v8 offset:32776
    ds_read_b64_tr_b16 a[134:135], v8 offset:33032
    s_waitcnt vmcnt(28)
    ds_read_b64_tr_b16 a[136:137], v8 offset:34816
    ds_read_b64_tr_b16 a[138:139], v8 offset:35072
    ds_read_b64_tr_b16 a[140:141], v8 offset:34824
    ds_read_b64_tr_b16 a[142:143], v8 offset:35080
    s_waitcnt lgkmcnt(7)
    s_waitcnt vmcnt(26)
    ds_read_b64_tr_b16 a[144:145], v8 offset:36864
    ds_read_b64_tr_b16 a[146:147], v8 offset:37120
    ds_read_b64_tr_b16 a[148:149], v8 offset:36872
    ds_read_b64_tr_b16 a[150:151], v8 offset:37128
    s_waitcnt vmcnt(24)
    ds_read_b64_tr_b16 a[152:153], v8 offset:38912
    ds_read_b64_tr_b16 a[154:155], v8 offset:39168
    ds_read_b64_tr_b16 a[156:157], v8 offset:38920
    ds_read_b64_tr_b16 a[158:159], v8 offset:39176
    s_waitcnt lgkmcnt(7)
    s_waitcnt vmcnt(22)
    ds_read_b64_tr_b16 a[160:161], v8 offset:0
    ds_read_b64_tr_b16 a[162:163], v8 offset:256
    ds_read_b64_tr_b16 a[164:165], v8 offset:8
    ds_read_b64_tr_b16 a[166:167], v8 offset:264
    s_waitcnt vmcnt(20)
    ds_read_b64_tr_b16 a[168:169], v8 offset:2048
    ds_read_b64_tr_b16 a[170:171], v8 offset:2304
    ds_read_b64_tr_b16 a[172:173], v8 offset:2056
    ds_read_b64_tr_b16 a[174:175], v8 offset:2312
    s_waitcnt lgkmcnt(7)
    s_waitcnt vmcnt(18)
    ds_read_b64_tr_b16 a[176:177], v8 offset:4096
    ds_read_b64_tr_b16 a[178:179], v8 offset:4352
    ds_read_b64_tr_b16 a[180:181], v8 offset:4104
    ds_read_b64_tr_b16 a[182:183], v8 offset:4360
    s_waitcnt vmcnt(16)
    ds_read_b64_tr_b16 a[184:185], v8 offset:6144
    ds_read_b64_tr_b16 a[186:187], v8 offset:6400
    ds_read_b64_tr_b16 a[188:189], v8 offset:6152
    ds_read_b64_tr_b16 a[190:191], v8 offset:6408
    s_waitcnt lgkmcnt(7)
    s_waitcnt vmcnt(14)
    ds_read_b64_tr_b16 a[192:193], v8 offset:8192
    ds_read_b64_tr_b16 a[194:195], v8 offset:8448
    ds_read_b64_tr_b16 a[196:197], v8 offset:8200
    ds_read_b64_tr_b16 a[198:199], v8 offset:8456
    s_waitcnt vmcnt(12)
    ds_read_b64_tr_b16 a[200:201], v8 offset:10240
    ds_read_b64_tr_b16 a[202:203], v8 offset:10496
    ds_read_b64_tr_b16 a[204:205], v8 offset:10248
    ds_read_b64_tr_b16 a[206:207], v8 offset:10504
    s_waitcnt lgkmcnt(7)
    s_waitcnt vmcnt(10)
    ds_read_b64_tr_b16 a[208:209], v8 offset:12288
    ds_read_b64_tr_b16 a[210:211], v8 offset:12544
    ds_read_b64_tr_b16 a[212:213], v8 offset:12296
    ds_read_b64_tr_b16 a[214:215], v8 offset:12552
    s_waitcnt vmcnt(8)
    ds_read_b64_tr_b16 a[216:217], v8 offset:14336
    ds_read_b64_tr_b16 a[218:219], v8 offset:14592
    ds_read_b64_tr_b16 a[220:221], v8 offset:14344
    ds_read_b64_tr_b16 a[222:223], v8 offset:14600
    s_waitcnt lgkmcnt(7)
    s_waitcnt vmcnt(6)
    ds_read_b64_tr_b16 a[224:225], v8 offset:16384
    ds_read_b64_tr_b16 a[226:227], v8 offset:16640
    ds_read_b64_tr_b16 a[228:229], v8 offset:16392
    ds_read_b64_tr_b16 a[230:231], v8 offset:16648
    s_waitcnt vmcnt(4)
    ds_read_b64_tr_b16 a[232:233], v8 offset:18432
    ds_read_b64_tr_b16 a[234:235], v8 offset:18688
    ds_read_b64_tr_b16 a[236:237], v8 offset:18440
    ds_read_b64_tr_b16 a[238:239], v8 offset:18696
    s_waitcnt lgkmcnt(7)
    s_waitcnt vmcnt(2)
    ds_read_b64_tr_b16 a[240:241], v8 offset:20480
    ds_read_b64_tr_b16 a[242:243], v8 offset:20736
    ds_read_b64_tr_b16 a[244:245], v8 offset:20488
    ds_read_b64_tr_b16 a[246:247], v8 offset:20744
    s_waitcnt vmcnt(0)
    ds_read_b64_tr_b16 a[248:249], v8 offset:22528
    ds_read_b64_tr_b16 a[250:251], v8 offset:22784
    ds_read_b64_tr_b16 a[252:253], v8 offset:22536
    ds_read_b64_tr_b16 a[254:255], v8 offset:22792
    s_waitcnt lgkmcnt(7)
    s_waitcnt lgkmcnt(0)
    v_and_b32 v5, 15, v1
    v_bfe_u32 v6, v1, 1, 3
    v_lshrrev_b32 v7, 4, v1
    v_xor_b32 v6, v6, v7
    v_lshlrev_b32 v6, 4, v6
    v_lshl_add_u32 v10, v5, 7, v6
    s_lshl_b32 s19, s16, 10
    v_xor_b32 v11, 64, v10
    v_add_u32 v12, 0x10000, v10
    v_add_u32 v13, 0x10000, v11
    v_lshrrev_b32 v7, 3, v1
    s_lshl_b32 s17, s16, 3
    v_add_u32 v7, s17, v7
    v_bfe_u32 v8, v7, 1, 3
    v_xor_b32 v8, v8, v1
    v_and_b32 v8, 7, v8
    v_bfe_u32 v5, v7, 2, 2
    v_and_b32 v2, 3, v7
    v_lshl_add_u32 v2, v5, 3, v2
    v_bfe_u32 v5, v7, 4, 1
    v_lshl_add_u32 v2, v5, 2, v2
    v_bfe_u32 v5, v1, 2, 2
    v_and_b32 v3, 3, v1
    v_lshl_add_u32 v3, v5, 3, v3
    v_lshlrev_b32 v2, 11, v2
    v_lshl_add_u32 v2, v8, 4, v2
    v_and_b32 v5, 48, v1
    v_lshl_add_u32 v3, v3, 6, v5
    s_mul_i32 s21, s28, 133120
    s_mul_i32 s18, s90, 17825792
    s_add_u32 s21, s21, s18
    s_lshl_b32 s18, s90, 7
    s_add_u32 s17, s28, s18
    s_lshl_b32 s17, s17, 7
    s_add_u32 s17, s17, 100663296
    v_mov_b32 v4, s17
    v_mov_b32 v5, 1073741824
    v_cmp_eq_u32 vcc, 0, v1
    s_nop 1
    v_cndmask_b32 v4, v5, v4, vcc
    v_lshlrev_b32 v252, 7, v1
    s_cmp_eq_u32 s90, 0
    s_cselect_b32 s20, 0, 32
    v_cmp_gt_u32 vcc, s20, v1
    s_nop 1
    v_cndmask_b32 v252, v5, v252, vcc
    s_mov_b32 s20, 0
    s_mov_b32 s24, 65536
    s_mov_b32 s25, 2048
    s_barrier
    s_cmp_eq_u32 s90, 2
    s_cbranch_scc1 P_v
    s_mov_b32 s26, s25
    s_sub_u32 s25, s21, 1073741824
    s_mov_b32 s21, 1073741824
    s_mov_b32 s23, 0
    s_mov_b32 s22, 0
    s_add_u32 m0, s19, 0
    s_nop 0
    buffer_load_dwordx4 v2, s[8:11], s20 offen offset:0 lds
    s_add_u32 m0, s19, 3968
    s_nop 0
    buffer_load_dwordx4 v2, s[8:11], s20 offen offset:128 lds
    s_add_u32 m0, s19, 7936
    s_nop 0
    buffer_load_dwordx4 v2, s[8:11], s20 offen offset:256 lds
    s_add_u32 m0, s19, 11904
    s_nop 0
    buffer_load_dwordx4 v2, s[8:11], s20 offen offset:384 lds
    s_add_u32 m0, s19, 15872
    s_nop 0
    buffer_load_dwordx4 v2, s[8:11], s20 offen offset:512 lds
    s_add_u32 m0, s19, 19840
    s_nop 0
    buffer_load_dwordx4 v2, s[8:11], s20 offen offset:640 lds
    s_add_u32 m0, s19, 23808
    s_nop 0
    buffer_load_dwordx4 v2, s[8:11], s20 offen offset:768 lds
    s_add_u32 m0, s19, 27776
    s_nop 0
    buffer_load_dwordx4 v2, s[8:11], s20 offen offset:896 lds
    s_add_u32 m0, s19, 31744
    s_nop 0
    buffer_load_dwordx4 v2, s[8:11], s20 offen offset:1024 lds
    s_add_u32 m0, s19, 35712
    s_nop 0
    buffer_load_dwordx4 v2, s[8:11], s20 offen offset:1152 lds
    s_add_u32 m0, s19, 39680
    s_nop 0
    buffer_load_dwordx4 v2, s[8:11], s20 offen offset:1280 lds
    s_add_u32 m0, s19, 43648
    s_nop 0
    buffer_load_dwordx4 v2, s[8:11], s20 offen offset:1408 lds
    s_add_u32 m0, s19, 47616
    s_nop 0
    buffer_load_dwordx4 v2, s[8:11], s20 offen offset:1536 lds
    s_add_u32 m0, s19, 51584
    s_nop 0
    buffer_load_dwordx4 v2, s[8:11], s20 offen offset:1664 lds
    s_add_u32 m0, s19, 55552
    s_nop 0
    buffer_load_dwordx4 v2, s[8:11], s20 offen offset:1792 lds
    s_add_u32 m0, s19, 59520
    s_nop 0
    buffer_load_dwordx4 v2, s[8:11], s20 offen offset:1920 lds
    s_add_u32 s20, s20, s24
    s_add_u32 m0, s19, 65536
    s_nop 0
    buffer_load_dwordx4 v2, s[8:11], s20 offen offset:0 lds
    s_add_u32 m0, s19, 69504
    s_nop 0
    buffer_load_dwordx4 v2, s[8:11], s20 offen offset:128 lds
    s_add_u32 m0, s19, 73472
    s_nop 0
    buffer_load_dwordx4 v2, s[8:11], s20 offen offset:256 lds
    v_mov_b32 v9, s23
    s_add_u32 s23, s23, 1
    buffer_store_dword v9, v4, s[4:7], 0 offen sc1
    s_mov_b32 s23, 0
    s_waitcnt vmcnt(12)
    s_barrier
    ds_read_b128 v[20:23], v10 offset:0
    ds_read_b128 v[24:27], v10 offset:2048
    ds_read_b128 v[28:31], v11 offset:0
    ds_read_b128 v[32:35], v11 offset:2048
    ds_read_b128 v[36:39], v10 offset:4096
    ds_read_b128 v[40:43], v10 offset:6144
    ds_read_b128 v[44:47], v11 offset:4096
.p2align 6
P_qk_top:
    s_waitcnt lgkmcnt(6)
    v_mfma_f32_16x16x32_bf16 v[52:55], a[0:3], v[20:23], 0
    ds_read_b128 v[48:51], v11 offset:6144
    v_mfma_f32_16x16x32_bf16 v[56:59], a[4:7], v[20:23], 0
    s_waitcnt lgkmcnt(6)
    v_mfma_f32_16x16x32_bf16 v[60:63], a[0:3], v[24:27], 0
    ds_read_b128 v[20:23], v10 offset:8192
    s_add_u32 m0, s19, 77440
    v_mfma_f32_16x16x32_bf16 v[64:67], a[4:7], v[24:27], 0
    buffer_load_dwordx4 v2, s[8:11], s20 offen offset:384 lds
    s_waitcnt lgkmcnt(6)
    v_mfma_f32_16x16x32_bf16 v[52:55], a[8:11], v[28:31], v[52:55]
    ds_read_b128 v[24:27], v10 offset:10240
    v_mfma_f32_16x16x32_bf16 v[56:59], a[12:15], v[28:31], v[56:59]
    s_waitcnt lgkmcnt(6)
    v_mfma_f32_16x16x32_bf16 v[60:63], a[8:11], v[32:35], v[60:63]
    ds_read_b128 v[28:31], v11 offset:8192
    s_add_u32 m0, s19, 81408
    v_mfma_f32_16x16x32_bf16 v[64:67], a[12:15], v[32:35], v[64:67]
    buffer_load_dwordx4 v2, s[8:11], s20 offen offset:512 lds
    s_waitcnt lgkmcnt(6)
    v_mfma_f32_16x16x32_bf16 v[52:55], a[16:19], v[36:39], v[52:55]
    ds_read_b128 v[32:35], v11 offset:10240
    v_mfma_f32_16x16x32_bf16 v[56:59], a[20:23], v[36:39], v[56:59]
    s_waitcnt lgkmcnt(6)
    v_mfma_f32_16x16x32_bf16 v[60:63], a[16:19], v[40:43], v[60:63]
    ds_read_b128 v[36:39], v10 offset:12288
    s_add_u32 m0, s19, 85376
    v_mfma_f32_16x16x32_bf16 v[64:67], a[20:23], v[40:43], v[64:67]
    buffer_load_dwordx4 v2, s[8:11], s20 offen offset:640 lds
    s_waitcnt lgkmcnt(6)
    v_mfma_f32_16x16x32_bf16 v[52:55], a[24:27], v[44:47], v[52:55]
    ds_read_b128 v[40:43], v10 offset:14336
    v_mfma_f32_16x16x32_bf16 v[56:59], a[28:31], v[44:47], v[56:59]
    s_waitcnt lgkmcnt(6)
    v_mfma_f32_16x16x32_bf16 v[60:63], a[24:27], v[48:51], v[60:63]
    ds_read_b128 v[44:47], v11 offset:12288
    s_add_u32 m0, s19, 89344
    v_mfma_f32_16x16x32_bf16 v[64:67], a[28:31], v[48:51], v[64:67]
    buffer_load_dwordx4 v2, s[8:11], s20 offen offset:768 lds
    s_waitcnt lgkmcnt(6)
    v_mfma_f32_16x16x32_bf16 v[52:55], a[32:35], v[20:23], v[52:55]
    ds_read_b128 v[48:51], v11 offset:14336
    v_mfma_f32_16x16x32_bf16 v[56:59], a[36:39], v[20:23], v[56:59]
    s_waitcnt lgkmcnt(6)
    v_mfma_f32_16x16x32_bf16 v[60:63], a[32:35], v[24:27], v[60:63]
    ds_read_b128 v[20:23], v10 offset:16384
    s_add_u32 m0, s19, 93312
    v_mfma_f32_16x16x32_bf16 v[64:67], a[36:39], v[24:27], v[64:67]
    buffer_load_dwordx4 v2, s[8:11], s20 offen offset:896 lds
    s_waitcnt lgkmcnt(6)
    v_mfma_f32_16x16x32_bf16 v[52:55], a[40:43], v[28:31], v[52:55]
    ds_read_b128 v[24:27], v10 offset:18432
    v_mfma_f32_16x16x32_bf16 v[56:59], a[44:47], v[28:31], v[56:59]
    v_cvt_pk_bf16_f32 v84, v68, v69
    s_waitcnt lgkmcnt(6)
    v_mfma_f32_16x16x32_bf16 v[60:63], a[40:43], v[32:35], v[60:63]
    ds_read_b128 v[28:31], v11 offset:16384
    v_mfma_f32_16x16x32_bf16 v[64:67], a[44:47], v[32:35], v[64:67]
    v_cvt_pk_bf16_f32 v85, v70, v71
    s_waitcnt lgkmcnt(6)
    v_mfma_f32_16x16x32_bf16 v[52:55], a[48:51], v[36:39], v[52:55]
    ds_read_b128 v[32:35], v11 offset:18432
    v_mfma_f32_16x16x32_bf16 v[56:59], a[52:55], v[36:39], v[56:59]
    v_cvt_pk_bf16_f32 v86, v72, v73
    s_waitcnt lgkmcnt(6)
    v_mfma_f32_16x16x32_bf16 v[60:63], a[48:51], v[40:43], v[60:63]
    ds_read_b128 v[36:39], v10 offset:20480
    v_mfma_f32_16x16x32_bf16 v[64:67], a[52:55], v[40:43], v[64:67]
    v_cvt_pk_bf16_f32 v87, v74, v75
    s_waitcnt lgkmcnt(6)
    v_mfma_f32_16x16x32_bf16 v[52:55], a[56:59], v[44:47], v[52:55]
    ds_read_b128 v[40:43], v10 offset:22528
    v_mfma_f32_16x16x32_bf16 v[56:59], a[60:63], v[44:47], v[56:59]
    v_cvt_pk_bf16_f32 v88, v76, v77
    s_waitcnt lgkmcnt(6)
    v_mfma_f32_16x16x32_bf16 v[60:63], a[56:59], v[48:51], v[60:63]
    ds_read_b128 v[44:47], v11 offset:20480
    v_mfma_f32_16x16x32_bf16 v[64:67], a[60:63], v[48:51], v[64:67]
    v_cvt_pk_bf16_f32 v89, v78, v79
    buffer_store_dwordx4 v[84:87], v3, s[4:7], s21 offen offset:0 sc1
    s_waitcnt lgkmcnt(6)
    v_mfma_f32_16x16x32_bf16 v[52:55], a[64:67], v[20:23], v[52:55]
    ds_read_b128 v[48:51], v11 offset:22528
    v_mfma_f32_16x16x32_bf16 v[56:59], a[68:71], v[20:23], v[56:59]
    v_cvt_pk_bf16_f32 v90, v80, v81
    s_waitcnt lgkmcnt(6)
    v_mfma_f32_16x16x32_bf16 v[60:63], a[64:67], v[24:27], v[60:63]
    ds_read_b128 v[20:23], v10 offset:24576
    v_mfma_f32_16x16x32_bf16 v[64:67], a[68:71], v[24:27], v[64:67]
    v_cvt_pk_bf16_f32 v91, v82, v83
    s_waitcnt lgkmcnt(6)
    v_mfma_f32_16x16x32_bf16 v[52:55], a[72:75], v[28:31], v[52:55]
    ds_read_b128 v[24:27], v10 offset:26624
    v_mfma_f32_16x16x32_bf16 v[56:59], a[76:79], v[28:31], v[56:59]
    s_waitcnt lgkmcnt(6)
    v_mfma_f32_16x16x32_bf16 v[60:63], a[72:75], v[32:35], v[60:63]
    ds_read_b128 v[28:31], v11 offset:24576
    v_mfma_f32_16x16x32_bf16 v[64:67], a[76:79], v[32:35], v[64:67]
    buffer_store_dwordx4 v[88:91], v3, s[4:7], s21 offen offset:256 sc1
    s_waitcnt lgkmcnt(6)
    v_mfma_f32_16x16x32_bf16 v[52:55], a[80:83], v[36:39], v[52:55]
    ds_read_b128 v[32:35], v11 offset:26624
    v_mfma_f32_16x16x32_bf16 v[56:59], a[84:87], v[36:39], v[56:59]
    s_add_u32 s21, s21, s25
    s_mov_b32 s25, s26
    s_waitcnt lgkmcnt(6)
    v_mfma_f32_16x16x32_bf16 v[60:63], a[80:83], v[40:43], v[60:63]
    ds_read_b128 v[36:39], v10 offset:28672
    v_mfma_f32_16x16x32_bf16 v[64:67], a[84:87], v[40:43], v[64:67]
    s_waitcnt lgkmcnt(6)
    v_mfma_f32_16x16x32_bf16 v[52:55], a[88:91], v[44:47], v[52:55]
    ds_read_b128 v[40:43], v10 offset:30720
    v_mfma_f32_16x16x32_bf16 v[56:59], a[92:95], v[44:47], v[56:59]
    s_waitcnt lgkmcnt(6)
    v_mfma_f32_16x16x32_bf16 v[60:63], a[88:91], v[48:51], v[60:63]
    ds_read_b128 v[44:47], v11 offset:28672
    v_mfma_f32_16x16x32_bf16 v[64:67], a[92:95], v[48:51], v[64:67]
    s_waitcnt lgkmcnt(6)
    v_mfma_f32_16x16x32_bf16 v[52:55], a[96:99], v[20:23], v[52:55]
    ds_read_b128 v[48:51], v11 offset:30720
    v_mfma_f32_16x16x32_bf16 v[56:59], a[100:103], v[20:23], v[56:59]
    s_waitcnt lgkmcnt(6)
    v_mfma_f32_16x16x32_bf16 v[60:63], a[96:99], v[24:27], v[60:63]
    s_waitcnt vmcnt(11)
    s_barrier
    ds_read_b128 v[20:23], v10 offset:32768
    v_mfma_f32_16x16x32_bf16 v[64:67], a[100:103], v[24:27], v[64:67]
    s_waitcnt lgkmcnt(6)
    v_mfma_f32_16x16x32_bf16 v[52:55], a[104:107], v[28:31], v[52:55]
    ds_read_b128 v[24:27], v10 offset:34816
    s_add_u32 m0, s19, 97280
    v_mfma_f32_16x16x32_bf16 v[56:59], a[108:111], v[28:31], v[56:59]
    buffer_load_dwordx4 v2, s[8:11], s20 offen offset:1024 lds
    s_waitcnt lgkmcnt(6)
    v_mfma_f32_16x16x32_bf16 v[60:63], a[104:107], v[32:35], v[60:63]
    ds_read_b128 v[28:31], v11 offset:32768
    v_mfma_f32_16x16x32_bf16 v[64:67], a[108:111], v[32:35], v[64:67]
    s_waitcnt lgkmcnt(6)
    v_mfma_f32_16x16x32_bf16 v[52:55], a[112:115], v[36:39], v[52:55]
    ds_read_b128 v[32:35], v11 offset:34816
    s_add_u32 m0, s19, 101248
    v_mfma_f32_16x16x32_bf16 v[56:59], a[116:119], v[36:39], v[56:59]
    buffer_load_dwordx4 v2, s[8:11], s20 offen offset:1152 lds
    s_waitcnt lgkmcnt(6)
    v_mfma_f32_16x16x32_bf16 v[60:63], a[112:115], v[40:43], v[60:63]
    ds_read_b128 v[36:39], v10 offset:36864
    v_mfma_f32_16x16x32_bf16 v[64:67], a[116:119], v[40:43], v[64:67]
    s_waitcnt lgkmcnt(6)
    v_mfma_f32_16x16x32_bf16 v[52:55], a[120:123], v[44:47], v[52:55]
    ds_read_b128 v[40:43], v10 offset:38912
    s_add_u32 m0, s19, 105216
    v_mfma_f32_16x16x32_bf16 v[56:59], a[124:127], v[44:47], v[56:59]
    buffer_load_dwordx4 v2, s[8:11], s20 offen offset:1280 lds
    s_waitcnt lgkmcnt(6)
    v_mfma_f32_16x16x32_bf16 v[60:63], a[120:123], v[48:51], v[60:63]
    ds_read_b128 v[44:47], v11 offset:36864
    v_mfma_f32_16x16x32_bf16 v[64:67], a[124:127], v[48:51], v[64:67]
    s_waitcnt lgkmcnt(6)
    v_mfma_f32_16x16x32_bf16 v[52:55], a[128:131], v[20:23], v[52:55]
    ds_read_b128 v[48:51], v11 offset:38912
    v_mfma_f32_16x16x32_bf16 v[56:59], a[132:135], v[20:23], v[56:59]
    s_waitcnt lgkmcnt(6)
    v_mfma_f32_16x16x32_bf16 v[60:63], a[128:131], v[24:27], v[60:63]
    ds_read_b128 v[20:23], v10 offset:40960
    s_add_u32 m0, s19, 109184
    v_mfma_f32_16x16x32_bf16 v[64:67], a[132:135], v[24:27], v[64:67]
    buffer_load_dwordx4 v2, s[8:11], s20 offen offset:1408 lds
    s_waitcnt lgkmcnt(6)
    v_mfma_f32_16x16x32_bf16 v[52:55], a[136:139], v[28:31], v[52:55]
    ds_read_b128 v[24:27], v10 offset:43008
    v_mfma_f32_16x16x32_bf16 v[56:59], a[140:143], v[28:31], v[56:59]
    s_waitcnt lgkmcnt(6)
    v_mfma_f32_16x16x32_bf16 v[60:63], a[136:139], v[32:35], v[60:63]
    ds_read_b128 v[28:31], v11 offset:40960
    s_add_u32 m0, s19, 113152
    v_mfma_f32_16x16x32_bf16 v[64:67], a[140:143], v[32:35], v[64:67]
    buffer_load_dwordx4 v2, s[8:11], s20 offen offset:1536 lds
    s_waitcnt lgkmcnt(6)
    v_mfma_f32_16x16x32_bf16 v[52:55], a[144:147], v[36:39], v[52:55]
    ds_read_b128 v[32:35], v11 offset:43008
    v_mfma_f32_16x16x32_bf16 v[56:59], a[148:151], v[36:39], v[56:59]
    s_waitcnt lgkmcnt(6)
    v_mfma_f32_16x16x32_bf16 v[60:63], a[144:147], v[40:43], v[60:63]
    ds_read_b128 v[36:39], v10 offset:45056
    s_add_u32 m0, s19, 117120
    v_mfma_f32_16x16x32_bf16 v[64:67], a[148:151], v[40:43], v[64:67]
    buffer_load_dwordx4 v2, s[8:11], s20 offen offset:1664 lds
    s_waitcnt lgkmcnt(6)
    v_mfma_f32_16x16x32_bf16 v[52:55], a[152:155], v[44:47], v[52:55]
    ds_read_b128 v[40:43], v10 offset:47104
    v_mfma_f32_16x16x32_bf16 v[56:59], a[156:159], v[44:47], v[56:59]
    s_waitcnt lgkmcnt(6)
    v_mfma_f32_16x16x32_bf16 v[60:63], a[152:155], v[48:51], v[60:63]
    ds_read_b128 v[44:47], v11 offset:45056
    s_add_u32 m0, s19, 121088
    v_mfma_f32_16x16x32_bf16 v[64:67], a[156:159], v[48:51], v[64:67]
    buffer_load_dwordx4 v2, s[8:11], s20 offen offset:1792 lds
    s_waitcnt lgkmcnt(6)
    v_mfma_f32_16x16x32_bf16 v[52:55], a[160:163], v[20:23], v[52:55]
    ds_read_b128 v[48:51], v11 offset:47104
    v_mfma_f32_16x16x32_bf16 v[56:59], a[164:167], v[20:23], v[56:59]
    s_waitcnt lgkmcnt(6)
    v_mfma_f32_16x16x32_bf16 v[60:63], a[160:163], v[24:27], v[60:63]
    ds_read_b128 v[20:23], v10 offset:49152
    s_add_u32 m0, s19, 125056
    v_mfma_f32_16x16x32_bf16 v[64:67], a[164:167], v[24:27], v[64:67]
    buffer_load_dwordx4 v2, s[8:11], s20 offen offset:1920 lds
    s_waitcnt lgkmcnt(6)
    v_mfma_f32_16x16x32_bf16 v[52:55], a[168:171], v[28:31], v[52:55]
    ds_read_b128 v[24:27], v10 offset:51200
    v_mfma_f32_16x16x32_bf16 v[56:59], a[172:175], v[28:31], v[56:59]
    s_add_u32 s20, s20, s24
    s_waitcnt lgkmcnt(6)
    v_mfma_f32_16x16x32_bf16 v[60:63], a[168:171], v[32:35], v[60:63]
    ds_read_b128 v[28:31], v11 offset:49152
    v_mfma_f32_16x16x32_bf16 v[64:67], a[172:175], v[32:35], v[64:67]
    s_waitcnt lgkmcnt(6)
    v_mfma_f32_16x16x32_bf16 v[52:55], a[176:179], v[36:39], v[52:55]
    ds_read_b128 v[32:35], v11 offset:51200
    v_mfma_f32_16x16x32_bf16 v[56:59], a[180:183], v[36:39], v[56:59]
    s_waitcnt lgkmcnt(6)
    v_mfma_f32_16x16x32_bf16 v[60:63], a[176:179], v[40:43], v[60:63]
    ds_read_b128 v[36:39], v10 offset:53248
    v_mfma_f32_16x16x32_bf16 v[64:67], a[180:183], v[40:43], v[64:67]
    s_waitcnt lgkmcnt(6)
    v_mfma_f32_16x16x32_bf16 v[52:55], a[184:187], v[44:47], v[52:55]
    ds_read_b128 v[40:43], v10 offset:55296
    v_mfma_f32_16x16x32_bf16 v[56:59], a[188:191], v[44:47], v[56:59]
    s_waitcnt lgkmcnt(6)
    v_mfma_f32_16x16x32_bf16 v[60:63], a[184:187], v[48:51], v[60:63]
    ds_read_b128 v[44:47], v11 offset:53248
    v_mfma_f32_16x16x32_bf16 v[64:67], a[188:191], v[48:51], v[64:67]
    s_waitcnt lgkmcnt(6)
    v_mfma_f32_16x16x32_bf16 v[52:55], a[192:195], v[20:23], v[52:55]
    ds_read_b128 v[48:51], v11 offset:55296
    v_mfma_f32_16x16x32_bf16 v[56:59], a[196:199], v[20:23], v[56:59]
    s_waitcnt lgkmcnt(6)
    v_mfma_f32_16x16x32_bf16 v[60:63], a[192:195], v[24:27], v[60:63]
    ds_read_b128 v[20:23], v10 offset:57344
    v_mfma_f32_16x16x32_bf16 v[64:67], a[196:199], v[24:27], v[64:67]
    s_waitcnt lgkmcnt(6)
    v_mfma_f32_16x16x32_bf16 v[52:55], a[200:203], v[28:31], v[52:55]
    ds_read_b128 v[24:27], v10 offset:59392
    v_mfma_f32_16x16x32_bf16 v[56:59], a[204:207], v[28:31], v[56:59]
    s_waitcnt lgkmcnt(6)
    v_mfma_f32_16x16x32_bf16 v[60:63], a[200:203], v[32:35], v[60:63]
    ds_read_b128 v[28:31], v11 offset:57344
    v_mfma_f32_16x16x32_bf16 v[64:67], a[204:207], v[32:35], v[64:67]
    s_waitcnt lgkmcnt(6)
    v_mfma_f32_16x16x32_bf16 v[52:55], a[208:211], v[36:39], v[52:55]
    ds_read_b128 v[32:35], v11 offset:59392
    v_mfma_f32_16x16x32_bf16 v[56:59], a[212:215], v[36:39], v[56:59]
    s_waitcnt lgkmcnt(6)
    v_mfma_f32_16x16x32_bf16 v[60:63], a[208:211], v[40:43], v[60:63]
    ds_read_b128 v[36:39], v10 offset:61440
    v_mfma_f32_16x16x32_bf16 v[64:67], a[212:215], v[40:43], v[64:67]
    s_waitcnt lgkmcnt(6)
    v_mfma_f32_16x16x32_bf16 v[52:55], a[216:219], v[44:47], v[52:55]
    ds_read_b128 v[40:43], v10 offset:63488
    v_mfma_f32_16x16x32_bf16 v[56:59], a[220:223], v[44:47], v[56:59]
    s_waitcnt lgkmcnt(6)
    v_mfma_f32_16x16x32_bf16 v[60:63], a[216:219], v[48:51], v[60:63]
    ds_read_b128 v[44:47], v11 offset:61440
    v_mfma_f32_16x16x32_bf16 v[64:67], a[220:223], v[48:51], v[64:67]
    s_waitcnt lgkmcnt(6)
    v_mfma_f32_16x16x32_bf16 v[52:55], a[224:227], v[20:23], v[52:55]
    ds_read_b128 v[48:51], v11 offset:63488
    v_mfma_f32_16x16x32_bf16 v[56:59], a[228:231], v[20:23], v[56:59]
    s_waitcnt lgkmcnt(6)
    v_mfma_f32_16x16x32_bf16 v[60:63], a[224:227], v[24:27], v[60:63]
    s_waitcnt vmcnt(8)
    s_barrier
    ds_read_b128 v[20:23], v12 offset:0
    v_mfma_f32_16x16x32_bf16 v[64:67], a[228:231], v[24:27], v[64:67]
    s_waitcnt lgkmcnt(6)
    v_mfma_f32_16x16x32_bf16 v[52:55], a[232:235], v[28:31], v[52:55]
    ds_read_b128 v[24:27], v12 offset:2048
    s_add_u32 m0, s19, 0
    v_mfma_f32_16x16x32_bf16 v[56:59], a[236:239], v[28:31], v[56:59]
    buffer_load_dwordx4 v2, s[8:11], s20 offen offset:0 lds
    s_waitcnt lgkmcnt(6)
    v_mfma_f32_16x16x32_bf16 v[60:63], a[232:235], v[32:35], v[60:63]
    ds_read_b128 v[28:31], v13 offset:0
    v_mfma_f32_16x16x32_bf16 v[64:67], a[236:239], v[32:35], v[64:67]
    v_mov_b32 v9, s23
    s_add_u32 s23, s23, 1
    buffer_store_dword v9, v4, s[4:7], 0 offen sc1
    s_waitcnt lgkmcnt(6)
    v_mfma_f32_16x16x32_bf16 v[52:55], a[240:243], v[36:39], v[52:55]
    ds_read_b128 v[32:35], v13 offset:2048
    s_add_u32 m0, s19, 3968
    v_mfma_f32_16x16x32_bf16 v[56:59], a[244:247], v[36:39], v[56:59]
    buffer_load_dwordx4 v2, s[8:11], s20 offen offset:128 lds
    s_waitcnt lgkmcnt(6)
    v_mfma_f32_16x16x32_bf16 v[60:63], a[240:243], v[40:43], v[60:63]
    ds_read_b128 v[36:39], v12 offset:4096
    v_mfma_f32_16x16x32_bf16 v[64:67], a[244:247], v[40:43], v[64:67]
    s_waitcnt lgkmcnt(6)
    v_mfma_f32_16x16x32_bf16 v[52:55], a[248:251], v[44:47], v[52:55]
    ds_read_b128 v[40:43], v12 offset:6144
    s_add_u32 m0, s19, 7936
    v_mfma_f32_16x16x32_bf16 v[56:59], a[252:255], v[44:47], v[56:59]
    buffer_load_dwordx4 v2, s[8:11], s20 offen offset:256 lds
    s_waitcnt lgkmcnt(6)
    v_mfma_f32_16x16x32_bf16 v[60:63], a[248:251], v[48:51], v[60:63]
    ds_read_b128 v[44:47], v13 offset:4096
    v_mfma_f32_16x16x32_bf16 v[64:67], a[252:255], v[48:51], v[64:67]
    s_waitcnt lgkmcnt(6)
    v_mfma_f32_16x16x32_bf16 v[68:71], a[0:3], v[20:23], 0
    ds_read_b128 v[48:51], v13 offset:6144
    v_mfma_f32_16x16x32_bf16 v[72:75], a[4:7], v[20:23], 0
    s_waitcnt lgkmcnt(6)
    v_mfma_f32_16x16x32_bf16 v[76:79], a[0:3], v[24:27], 0
    ds_read_b128 v[20:23], v12 offset:8192
    s_add_u32 m0, s19, 11904
    v_mfma_f32_16x16x32_bf16 v[80:83], a[4:7], v[24:27], 0
    buffer_load_dwordx4 v2, s[8:11], s20 offen offset:384 lds
    s_waitcnt lgkmcnt(6)
    v_mfma_f32_16x16x32_bf16 v[68:71], a[8:11], v[28:31], v[68:71]
    ds_read_b128 v[24:27], v12 offset:10240
    v_mfma_f32_16x16x32_bf16 v[72:75], a[12:15], v[28:31], v[72:75]
    s_waitcnt lgkmcnt(6)
    v_mfma_f32_16x16x32_bf16 v[76:79], a[8:11], v[32:35], v[76:79]
    ds_read_b128 v[28:31], v13 offset:8192
    s_add_u32 m0, s19, 15872
    v_mfma_f32_16x16x32_bf16 v[80:83], a[12:15], v[32:35], v[80:83]
    buffer_load_dwordx4 v2, s[8:11], s20 offen offset:512 lds
    s_waitcnt lgkmcnt(6)
    v_mfma_f32_16x16x32_bf16 v[68:71], a[16:19], v[36:39], v[68:71]
    ds_read_b128 v[32:35], v13 offset:10240
    v_mfma_f32_16x16x32_bf16 v[72:75], a[20:23], v[36:39], v[72:75]
    s_waitcnt lgkmcnt(6)
    v_mfma_f32_16x16x32_bf16 v[76:79], a[16:19], v[40:43], v[76:79]
    ds_read_b128 v[36:39], v12 offset:12288
    s_add_u32 m0, s19, 19840
    v_mfma_f32_16x16x32_bf16 v[80:83], a[20:23], v[40:43], v[80:83]
    buffer_load_dwordx4 v2, s[8:11], s20 offen offset:640 lds
    s_waitcnt lgkmcnt(6)
    v_mfma_f32_16x16x32_bf16 v[68:71], a[24:27], v[44:47], v[68:71]
    ds_read_b128 v[40:43], v12 offset:14336
    v_mfma_f32_16x16x32_bf16 v[72:75], a[28:31], v[44:47], v[72:75]
    s_waitcnt lgkmcnt(6)
    v_mfma_f32_16x16x32_bf16 v[76:79], a[24:27], v[48:51], v[76:79]
    ds_read_b128 v[44:47], v13 offset:12288
    s_add_u32 m0, s19, 23808
    v_mfma_f32_16x16x32_bf16 v[80:83], a[28:31], v[48:51], v[80:83]
    buffer_load_dwordx4 v2, s[8:11], s20 offen offset:768 lds
    s_waitcnt lgkmcnt(6)
    v_mfma_f32_16x16x32_bf16 v[68:71], a[32:35], v[20:23], v[68:71]
    ds_read_b128 v[48:51], v13 offset:14336
    v_mfma_f32_16x16x32_bf16 v[72:75], a[36:39], v[20:23], v[72:75]
    s_waitcnt lgkmcnt(6)
    v_mfma_f32_16x16x32_bf16 v[76:79], a[32:35], v[24:27], v[76:79]
    ds_read_b128 v[20:23], v12 offset:16384
    s_add_u32 m0, s19, 27776
    v_mfma_f32_16x16x32_bf16 v[80:83], a[36:39], v[24:27], v[80:83]
    buffer_load_dwordx4 v2, s[8:11], s20 offen offset:896 lds
    s_waitcnt lgkmcnt(6)
    v_mfma_f32_16x16x32_bf16 v[68:71], a[40:43], v[28:31], v[68:71]
    ds_read_b128 v[24:27], v12 offset:18432
    v_mfma_f32_16x16x32_bf16 v[72:75], a[44:47], v[28:31], v[72:75]
    v_cvt_pk_bf16_f32 v84, v52, v53
    s_waitcnt lgkmcnt(6)
    v_mfma_f32_16x16x32_bf16 v[76:79], a[40:43], v[32:35], v[76:79]
    ds_read_b128 v[28:31], v13 offset:16384
    v_mfma_f32_16x16x32_bf16 v[80:83], a[44:47], v[32:35], v[80:83]
    v_cvt_pk_bf16_f32 v85, v54, v55
    s_waitcnt lgkmcnt(6)
    v_mfma_f32_16x16x32_bf16 v[68:71], a[48:51], v[36:39], v[68:71]
    ds_read_b128 v[32:35], v13 offset:18432
    v_mfma_f32_16x16x32_bf16 v[72:75], a[52:55], v[36:39], v[72:75]
    v_cvt_pk_bf16_f32 v86, v56, v57
    s_waitcnt lgkmcnt(6)
    v_mfma_f32_16x16x32_bf16 v[76:79], a[48:51], v[40:43], v[76:79]
    ds_read_b128 v[36:39], v12 offset:20480
    v_mfma_f32_16x16x32_bf16 v[80:83], a[52:55], v[40:43], v[80:83]
    v_cvt_pk_bf16_f32 v87, v58, v59
    s_waitcnt lgkmcnt(6)
    v_mfma_f32_16x16x32_bf16 v[68:71], a[56:59], v[44:47], v[68:71]
    ds_read_b128 v[40:43], v12 offset:22528
    v_mfma_f32_16x16x32_bf16 v[72:75], a[60:63], v[44:47], v[72:75]
    v_cvt_pk_bf16_f32 v88, v60, v61
    s_waitcnt lgkmcnt(6)
    v_mfma_f32_16x16x32_bf16 v[76:79], a[56:59], v[48:51], v[76:79]
    ds_read_b128 v[44:47], v13 offset:20480
    v_mfma_f32_16x16x32_bf16 v[80:83], a[60:63], v[48:51], v[80:83]
    v_cvt_pk_bf16_f32 v89, v62, v63
    buffer_store_dwordx4 v[84:87], v3, s[4:7], s21 offen offset:0 sc1
    s_waitcnt lgkmcnt(6)
    v_mfma_f32_16x16x32_bf16 v[68:71], a[64:67], v[20:23], v[68:71]
    ds_read_b128 v[48:51], v13 offset:22528
    v_mfma_f32_16x16x32_bf16 v[72:75], a[68:71], v[20:23], v[72:75]
    v_cvt_pk_bf16_f32 v90, v64, v65
    s_waitcnt lgkmcnt(6)
    v_mfma_f32_16x16x32_bf16 v[76:79], a[64:67], v[24:27], v[76:79]
    ds_read_b128 v[20:23], v12 offset:24576
    v_mfma_f32_16x16x32_bf16 v[80:83], a[68:71], v[24:27], v[80:83]
    v_cvt_pk_bf16_f32 v91, v66, v67
    s_waitcnt lgkmcnt(6)
    v_mfma_f32_16x16x32_bf16 v[68:71], a[72:75], v[28:31], v[68:71]
    ds_read_b128 v[24:27], v12 offset:26624
    v_mfma_f32_16x16x32_bf16 v[72:75], a[76:79], v[28:31], v[72:75]
    s_waitcnt lgkmcnt(6)
    v_mfma_f32_16x16x32_bf16 v[76:79], a[72:75], v[32:35], v[76:79]
    ds_read_b128 v[28:31], v13 offset:24576
    v_mfma_f32_16x16x32_bf16 v[80:83], a[76:79], v[32:35], v[80:83]
    buffer_store_dwordx4 v[88:91], v3, s[4:7], s21 offen offset:256 sc1
    s_waitcnt lgkmcnt(6)
    v_mfma_f32_16x16x32_bf16 v[68:71], a[80:83], v[36:39], v[68:71]
    ds_read_b128 v[32:35], v13 offset:26624
    v_mfma_f32_16x16x32_bf16 v[72:75], a[84:87], v[36:39], v[72:75]
    s_add_u32 s21, s21, s25
    s_mov_b32 s25, s26
    s_waitcnt lgkmcnt(6)
    v_mfma_f32_16x16x32_bf16 v[76:79], a[80:83], v[40:43], v[76:79]
    ds_read_b128 v[36:39], v12 offset:28672
    v_mfma_f32_16x16x32_bf16 v[80:83], a[84:87], v[40:43], v[80:83]
    s_waitcnt lgkmcnt(6)
    v_mfma_f32_16x16x32_bf16 v[68:71], a[88:91], v[44:47], v[68:71]
    ds_read_b128 v[40:43], v12 offset:30720
    v_mfma_f32_16x16x32_bf16 v[72:75], a[92:95], v[44:47], v[72:75]
    s_waitcnt lgkmcnt(6)
    v_mfma_f32_16x16x32_bf16 v[76:79], a[88:91], v[48:51], v[76:79]
    ds_read_b128 v[44:47], v13 offset:28672
    v_mfma_f32_16x16x32_bf16 v[80:83], a[92:95], v[48:51], v[80:83]
    s_waitcnt lgkmcnt(6)
    v_mfma_f32_16x16x32_bf16 v[68:71], a[96:99], v[20:23], v[68:71]
    ds_read_b128 v[48:51], v13 offset:30720
    v_mfma_f32_16x16x32_bf16 v[72:75], a[100:103], v[20:23], v[72:75]
    s_waitcnt lgkmcnt(6)
    v_mfma_f32_16x16x32_bf16 v[76:79], a[96:99], v[24:27], v[76:79]
    s_waitcnt vmcnt(11)
    s_barrier
    ds_read_b128 v[20:23], v12 offset:32768
    v_mfma_f32_16x16x32_bf16 v[80:83], a[100:103], v[24:27], v[80:83]
    s_waitcnt lgkmcnt(6)
    v_mfma_f32_16x16x32_bf16 v[68:71], a[104:107], v[28:31], v[68:71]
    ds_read_b128 v[24:27], v12 offset:34816
    s_add_u32 m0, s19, 31744
    v_mfma_f32_16x16x32_bf16 v[72:75], a[108:111], v[28:31], v[72:75]
    buffer_load_dwordx4 v2, s[8:11], s20 offen offset:1024 lds
    s_waitcnt lgkmcnt(6)
    v_mfma_f32_16x16x32_bf16 v[76:79], a[104:107], v[32:35], v[76:79]
    ds_read_b128 v[28:31], v13 offset:32768
    v_mfma_f32_16x16x32_bf16 v[80:83], a[108:111], v[32:35], v[80:83]
    s_waitcnt lgkmcnt(6)
    v_mfma_f32_16x16x32_bf16 v[68:71], a[112:115], v[36:39], v[68:71]
    ds_read_b128 v[32:35], v13 offset:34816
    s_add_u32 m0, s19, 35712
    v_mfma_f32_16x16x32_bf16 v[72:75], a[116:119], v[36:39], v[72:75]
    buffer_load_dwordx4 v2, s[8:11], s20 offen offset:1152 lds
    s_waitcnt lgkmcnt(6)
    v_mfma_f32_16x16x32_bf16 v[76:79], a[112:115], v[40:43], v[76:79]
    ds_read_b128 v[36:39], v12 offset:36864
    v_mfma_f32_16x16x32_bf16 v[80:83], a[116:119], v[40:43], v[80:83]
    s_waitcnt lgkmcnt(6)
    v_mfma_f32_16x16x32_bf16 v[68:71], a[120:123], v[44:47], v[68:71]
    ds_read_b128 v[40:43], v12 offset:38912
    s_add_u32 m0, s19, 39680
    v_mfma_f32_16x16x32_bf16 v[72:75], a[124:127], v[44:47], v[72:75]
    buffer_load_dwordx4 v2, s[8:11], s20 offen offset:1280 lds
    s_waitcnt lgkmcnt(6)
    v_mfma_f32_16x16x32_bf16 v[76:79], a[120:123], v[48:51], v[76:79]
    ds_read_b128 v[44:47], v13 offset:36864
    v_mfma_f32_16x16x32_bf16 v[80:83], a[124:127], v[48:51], v[80:83]
    s_waitcnt lgkmcnt(6)
    v_mfma_f32_16x16x32_bf16 v[68:71], a[128:131], v[20:23], v[68:71]
    ds_read_b128 v[48:51], v13 offset:38912
    v_mfma_f32_16x16x32_bf16 v[72:75], a[132:135], v[20:23], v[72:75]
    s_waitcnt lgkmcnt(6)
    v_mfma_f32_16x16x32_bf16 v[76:79], a[128:131], v[24:27], v[76:79]
    ds_read_b128 v[20:23], v12 offset:40960
    s_add_u32 m0, s19, 43648
    v_mfma_f32_16x16x32_bf16 v[80:83], a[132:135], v[24:27], v[80:83]
    buffer_load_dwordx4 v2, s[8:11], s20 offen offset:1408 lds
    s_waitcnt lgkmcnt(6)
    v_mfma_f32_16x16x32_bf16 v[68:71], a[136:139], v[28:31], v[68:71]
    ds_read_b128 v[24:27], v12 offset:43008
    v_mfma_f32_16x16x32_bf16 v[72:75], a[140:143], v[28:31], v[72:75]
    s_waitcnt lgkmcnt(6)
    v_mfma_f32_16x16x32_bf16 v[76:79], a[136:139], v[32:35], v[76:79]
    ds_read_b128 v[28:31], v13 offset:40960
    s_add_u32 m0, s19, 47616
    v_mfma_f32_16x16x32_bf16 v[80:83], a[140:143], v[32:35], v[80:83]
    buffer_load_dwordx4 v2, s[8:11], s20 offen offset:1536 lds
    s_waitcnt lgkmcnt(6)
    v_mfma_f32_16x16x32_bf16 v[68:71], a[144:147], v[36:39], v[68:71]
    ds_read_b128 v[32:35], v13 offset:43008
    v_mfma_f32_16x16x32_bf16 v[72:75], a[148:151], v[36:39], v[72:75]
    s_waitcnt lgkmcnt(6)
    v_mfma_f32_16x16x32_bf16 v[76:79], a[144:147], v[40:43], v[76:79]
    ds_read_b128 v[36:39], v12 offset:45056
    s_add_u32 m0, s19, 51584
    v_mfma_f32_16x16x32_bf16 v[80:83], a[148:151], v[40:43], v[80:83]
    buffer_load_dwordx4 v2, s[8:11], s20 offen offset:1664 lds
    s_waitcnt lgkmcnt(6)
    v_mfma_f32_16x16x32_bf16 v[68:71], a[152:155], v[44:47], v[68:71]
    ds_read_b128 v[40:43], v12 offset:47104
    v_mfma_f32_16x16x32_bf16 v[72:75], a[156:159], v[44:47], v[72:75]
    s_waitcnt lgkmcnt(6)
    v_mfma_f32_16x16x32_bf16 v[76:79], a[152:155], v[48:51], v[76:79]
    ds_read_b128 v[44:47], v13 offset:45056
    s_add_u32 m0, s19, 55552
    v_mfma_f32_16x16x32_bf16 v[80:83], a[156:159], v[48:51], v[80:83]
    buffer_load_dwordx4 v2, s[8:11], s20 offen offset:1792 lds
    s_waitcnt lgkmcnt(6)
    v_mfma_f32_16x16x32_bf16 v[68:71], a[160:163], v[20:23], v[68:71]
    ds_read_b128 v[48:51], v13 offset:47104
    v_mfma_f32_16x16x32_bf16 v[72:75], a[164:167], v[20:23], v[72:75]
    s_waitcnt lgkmcnt(6)
    v_mfma_f32_16x16x32_bf16 v[76:79], a[160:163], v[24:27], v[76:79]
    ds_read_b128 v[20:23], v12 offset:49152
    s_add_u32 m0, s19, 59520
    v_mfma_f32_16x16x32_bf16 v[80:83], a[164:167], v[24:27], v[80:83]
    buffer_load_dwordx4 v2, s[8:11], s20 offen offset:1920 lds
    s_waitcnt lgkmcnt(6)
    v_mfma_f32_16x16x32_bf16 v[68:71], a[168:171], v[28:31], v[68:71]
    ds_read_b128 v[24:27], v12 offset:51200
    v_mfma_f32_16x16x32_bf16 v[72:75], a[172:175], v[28:31], v[72:75]
    s_add_u32 s20, s20, s24
    s_waitcnt lgkmcnt(6)
    v_mfma_f32_16x16x32_bf16 v[76:79], a[168:171], v[32:35], v[76:79]
    ds_read_b128 v[28:31], v13 offset:49152
    v_mfma_f32_16x16x32_bf16 v[80:83], a[172:175], v[32:35], v[80:83]
    s_waitcnt lgkmcnt(6)
    v_mfma_f32_16x16x32_bf16 v[68:71], a[176:179], v[36:39], v[68:71]
    ds_read_b128 v[32:35], v13 offset:51200
    v_mfma_f32_16x16x32_bf16 v[72:75], a[180:183], v[36:39], v[72:75]
    s_waitcnt lgkmcnt(6)
    v_mfma_f32_16x16x32_bf16 v[76:79], a[176:179], v[40:43], v[76:79]
    ds_read_b128 v[36:39], v12 offset:53248
    v_mfma_f32_16x16x32_bf16 v[80:83], a[180:183], v[40:43], v[80:83]
    s_waitcnt lgkmcnt(6)
    v_mfma_f32_16x16x32_bf16 v[68:71], a[184:187], v[44:47], v[68:71]
    ds_read_b128 v[40:43], v12 offset:55296
    v_mfma_f32_16x16x32_bf16 v[72:75], a[188:191], v[44:47], v[72:75]
    s_waitcnt lgkmcnt(6)
    v_mfma_f32_16x16x32_bf16 v[76:79], a[184:187], v[48:51], v[76:79]
    ds_read_b128 v[44:47], v13 offset:53248
    v_mfma_f32_16x16x32_bf16 v[80:83], a[188:191], v[48:51], v[80:83]
    s_waitcnt lgkmcnt(6)
    v_mfma_f32_16x16x32_bf16 v[68:71], a[192:195], v[20:23], v[68:71]
    ds_read_b128 v[48:51], v13 offset:55296
    v_mfma_f32_16x16x32_bf16 v[72:75], a[196:199], v[20:23], v[72:75]
    s_waitcnt lgkmcnt(6)
    v_mfma_f32_16x16x32_bf16 v[76:79], a[192:195], v[24:27], v[76:79]
    ds_read_b128 v[20:23], v12 offset:57344
    v_mfma_f32_16x16x32_bf16 v[80:83], a[196:199], v[24:27], v[80:83]
    s_waitcnt lgkmcnt(6)
    v_mfma_f32_16x16x32_bf16 v[68:71], a[200:203], v[28:31], v[68:71]
    ds_read_b128 v[24:27], v12 offset:59392
    v_mfma_f32_16x16x32_bf16 v[72:75], a[204:207], v[28:31], v[72:75]
    s_waitcnt lgkmcnt(6)
    v_mfma_f32_16x16x32_bf16 v[76:79], a[200:203], v[32:35], v[76:79]
    ds_read_b128 v[28:31], v13 offset:57344
    v_mfma_f32_16x16x32_bf16 v[80:83], a[204:207], v[32:35], v[80:83]
    s_waitcnt lgkmcnt(6)
    v_mfma_f32_16x16x32_bf16 v[68:71], a[208:211], v[36:39], v[68:71]
    ds_read_b128 v[32:35], v13 offset:59392
    v_mfma_f32_16x16x32_bf16 v[72:75], a[212:215], v[36:39], v[72:75]
    s_waitcnt lgkmcnt(6)
    v_mfma_f32_16x16x32_bf16 v[76:79], a[208:211], v[40:43], v[76:79]
    ds_read_b128 v[36:39], v12 offset:61440
    v_mfma_f32_16x16x32_bf16 v[80:83], a[212:215], v[40:43], v[80:83]
    s_waitcnt lgkmcnt(6)
    v_mfma_f32_16x16x32_bf16 v[68:71], a[216:219], v[44:47], v[68:71]
    ds_read_b128 v[40:43], v12 offset:63488
    v_mfma_f32_16x16x32_bf16 v[72:75], a[220:223], v[44:47], v[72:75]
    s_waitcnt lgkmcnt(6)
    v_mfma_f32_16x16x32_bf16 v[76:79], a[216:219], v[48:51], v[76:79]
    ds_read_b128 v[44:47], v13 offset:61440
    v_mfma_f32_16x16x32_bf16 v[80:83], a[220:223], v[48:51], v[80:83]
    s_waitcnt lgkmcnt(6)
    v_mfma_f32_16x16x32_bf16 v[68:71], a[224:227], v[20:23], v[68:71]
    ds_read_b128 v[48:51], v13 offset:63488
    v_mfma_f32_16x16x32_bf16 v[72:75], a[228:231], v[20:23], v[72:75]
    s_waitcnt lgkmcnt(6)
    v_mfma_f32_16x16x32_bf16 v[76:79], a[224:227], v[24:27], v[76:79]
    s_waitcnt vmcnt(8)
    s_barrier
    ds_read_b128 v[20:23], v10 offset:0
    v_mfma_f32_16x16x32_bf16 v[80:83], a[228:231], v[24:27], v[80:83]
    s_waitcnt lgkmcnt(6)
    v_mfma_f32_16x16x32_bf16 v[68:71], a[232:235], v[28:31], v[68:71]
    ds_read_b128 v[24:27], v10 offset:2048
    s_add_u32 m0, s19, 65536
    v_mfma_f32_16x16x32_bf16 v[72:75], a[236:239], v[28:31], v[72:75]
    buffer_load_dwordx4 v2, s[8:11], s20 offen offset:0 lds
    s_waitcnt lgkmcnt(6)
    v_mfma_f32_16x16x32_bf16 v[76:79], a[232:235], v[32:35], v[76:79]
    ds_read_b128 v[28:31], v11 offset:0
    v_mfma_f32_16x16x32_bf16 v[80:83], a[236:239], v[32:35], v[80:83]
    v_mov_b32 v9, s23
    s_add_u32 s23, s23, 1
    buffer_store_dword v9, v4, s[4:7], 0 offen sc1
    s_waitcnt lgkmcnt(6)
    v_mfma_f32_16x16x32_bf16 v[68:71], a[240:243], v[36:39], v[68:71]
    ds_read_b128 v[32:35], v11 offset:2048
    s_add_u32 m0, s19, 69504
    v_mfma_f32_16x16x32_bf16 v[72:75], a[244:247], v[36:39], v[72:75]
    buffer_load_dwordx4 v2, s[8:11], s20 offen offset:128 lds
    s_waitcnt lgkmcnt(6)
    v_mfma_f32_16x16x32_bf16 v[76:79], a[240:243], v[40:43], v[76:79]
    ds_read_b128 v[36:39], v10 offset:4096
    v_mfma_f32_16x16x32_bf16 v[80:83], a[244:247], v[40:43], v[80:83]
    s_waitcnt lgkmcnt(6)
    v_mfma_f32_16x16x32_bf16 v[68:71], a[248:251], v[44:47], v[68:71]
    ds_read_b128 v[40:43], v10 offset:6144
    s_add_u32 m0, s19, 73472
    v_mfma_f32_16x16x32_bf16 v[72:75], a[252:255], v[44:47], v[72:75]
    buffer_load_dwordx4 v2, s[8:11], s20 offen offset:256 lds
    s_waitcnt lgkmcnt(6)
    v_mfma_f32_16x16x32_bf16 v[76:79], a[248:251], v[48:51], v[76:79]
    ds_read_b128 v[44:47], v11 offset:4096
    v_mfma_f32_16x16x32_bf16 v[80:83], a[252:255], v[48:51], v[80:83]
    s_add_u32 s22, s22, 2
    s_cmp_lt_u32 s22, 64
    s_cbranch_scc1 P_qk_top
    v_cvt_pk_bf16_f32 v84, v68, v69
    v_cvt_pk_bf16_f32 v85, v70, v71
    v_cvt_pk_bf16_f32 v86, v72, v73
    v_cvt_pk_bf16_f32 v87, v74, v75
    v_cvt_pk_bf16_f32 v88, v76, v77
    v_cvt_pk_bf16_f32 v89, v78, v79
    v_cvt_pk_bf16_f32 v90, v80, v81
    v_cvt_pk_bf16_f32 v91, v82, v83
    buffer_store_dwordx4 v[84:87], v3, s[4:7], s21 offen offset:0 sc1
    buffer_store_dwordx4 v[88:91], v3, s[4:7], s21 offen offset:256 sc1
    s_waitcnt vmcnt(0) lgkmcnt(0)
    v_mov_b32 v9, s23
    s_add_u32 s23, s23, 1
    buffer_store_dword v9, v4, s[4:7], 0 offen sc1
    s_branch W_U
P_v:
    s_mov_b32 s26, s25
    s_sub_u32 s25, s21, 1073741824
    s_mov_b32 s21, 1073741824
    s_mov_b32 s23, 0
    s_mov_b32 s22, 0
    s_add_u32 m0, s19, 0
    s_nop 0
    buffer_load_dwordx4 v2, s[8:11], s20 offen offset:0 lds
    s_add_u32 m0, s19, 3968
    s_nop 0
    buffer_load_dwordx4 v2, s[8:11], s20 offen offset:128 lds
    s_add_u32 m0, s19, 7936
    s_nop 0
    buffer_load_dwordx4 v2, s[8:11], s20 offen offset:256 lds
    s_add_u32 m0, s19, 11904
    s_nop 0
    buffer_load_dwordx4 v2, s[8:11], s20 offen offset:384 lds
    s_add_u32 m0, s19, 15872
    s_nop 0
    buffer_load_dwordx4 v2, s[8:11], s20 offen offset:512 lds
    s_add_u32 m0, s19, 19840
    s_nop 0
    buffer_load_dwordx4 v2, s[8:11], s20 offen offset:640 lds
    s_add_u32 m0, s19, 23808
    s_nop 0
    buffer_load_dwordx4 v2, s[8:11], s20 offen offset:768 lds
    s_add_u32 m0, s19, 27776
    s_nop 0
    buffer_load_dwordx4 v2, s[8:11], s20 offen offset:896 lds
    s_add_u32 m0, s19, 31744
    s_nop 0
    buffer_load_dwordx4 v2, s[8:11], s20 offen offset:1024 lds
    s_add_u32 m0, s19, 35712
    s_nop 0
    buffer_load_dwordx4 v2, s[8:11], s20 offen offset:1152 lds
    s_add_u32 m0, s19, 39680
    s_nop 0
    buffer_load_dwordx4 v2, s[8:11], s20 offen offset:1280 lds
    s_add_u32 m0, s19, 43648
    s_nop 0
    buffer_load_dwordx4 v2, s[8:11], s20 offen offset:1408 lds
    s_add_u32 m0, s19, 47616
    s_nop 0
    buffer_load_dwordx4 v2, s[8:11], s20 offen offset:1536 lds
    s_add_u32 m0, s19, 51584
    s_nop 0
    buffer_load_dwordx4 v2, s[8:11], s20 offen offset:1664 lds
    s_add_u32 m0, s19, 55552
    s_nop 0
    buffer_load_dwordx4 v2, s[8:11], s20 offen offset:1792 lds
    s_add_u32 m0, s19, 59520
    s_nop 0
    buffer_load_dwordx4 v2, s[8:11], s20 offen offset:1920 lds
    s_add_u32 s20, s20, s24
    s_add_u32 m0, s19, 65536
    s_nop 0
    buffer_load_dwordx4 v2, s[8:11], s20 offen offset:0 lds
    s_add_u32 m0, s19, 69504
    s_nop 0
    buffer_load_dwordx4 v2, s[8:11], s20 offen offset:128 lds
    s_add_u32 m0, s19, 73472
    s_nop 0
    buffer_load_dwordx4 v2, s[8:11], s20 offen offset:256 lds
    v_mov_b32 v9, s23
    s_add_u32 s23, s23, 1
    buffer_store_dword v9, v4, s[4:7], 0 offen sc1
    s_mov_b32 s23, 0
    s_waitcnt vmcnt(12)
    s_barrier
    ds_read_b128 v[20:23], v10 offset:0
    ds_read_b128 v[24:27], v10 offset:2048
    ds_read_b128 v[28:31], v11 offset:0
    ds_read_b128 v[32:35], v11 offset:2048
    ds_read_b128 v[36:39], v10 offset:4096
    ds_read_b128 v[40:43], v10 offset:6144
    ds_read_b128 v[44:47], v11 offset:4096
.p2align 6
P_v_top:
    s_waitcnt lgkmcnt(6)
    v_mfma_f32_16x16x32_bf16 v[52:55], v[20:23], a[0:3], 0
    ds_read_b128 v[48:51], v11 offset:6144
    v_mfma_f32_16x16x32_bf16 v[60:63], v[20:23], a[4:7], 0
    s_waitcnt lgkmcnt(6)
    v_mfma_f32_16x16x32_bf16 v[56:59], v[24:27], a[0:3], 0
    ds_read_b128 v[20:23], v10 offset:8192
    s_add_u32 m0, s19, 77440
    v_mfma_f32_16x16x32_bf16 v[64:67], v[24:27], a[4:7], 0
    buffer_load_dwordx4 v2, s[8:11], s20 offen offset:384 lds
    s_waitcnt lgkmcnt(6)
    v_mfma_f32_16x16x32_bf16 v[52:55], v[28:31], a[8:11], v[52:55]
    ds_read_b128 v[24:27], v10 offset:10240
    v_mfma_f32_16x16x32_bf16 v[60:63], v[28:31], a[12:15], v[60:63]
    s_waitcnt lgkmcnt(6)
    v_mfma_f32_16x16x32_bf16 v[56:59], v[32:35], a[8:11], v[56:59]
    ds_read_b128 v[28:31], v11 offset:8192
    s_add_u32 m0, s19, 81408
    v_mfma_f32_16x16x32_bf16 v[64:67], v[32:35], a[12:15], v[64:67]
    buffer_load_dwordx4 v2, s[8:11], s20 offen offset:512 lds
    s_waitcnt lgkmcnt(6)
    v_mfma_f32_16x16x32_bf16 v[52:55], v[36:39], a[16:19], v[52:55]
    ds_read_b128 v[32:35], v11 offset:10240
    v_mfma_f32_16x16x32_bf16 v[60:63], v[36:39], a[20:23], v[60:63]
    s_waitcnt lgkmcnt(6)
    v_mfma_f32_16x16x32_bf16 v[56:59], v[40:43], a[16:19], v[56:59]
    ds_read_b128 v[36:39], v10 offset:12288
    s_add_u32 m0, s19, 85376
    v_mfma_f32_16x16x32_bf16 v[64:67], v[40:43], a[20:23], v[64:67]
    buffer_load_dwordx4 v2, s[8:11], s20 offen offset:640 lds
    s_waitcnt lgkmcnt(6)
    v_mfma_f32_16x16x32_bf16 v[52:55], v[44:47], a[24:27], v[52:55]
    ds_read_b128 v[40:43], v10 offset:14336
    v_mfma_f32_16x16x32_bf16 v[60:63], v[44:47], a[28:31], v[60:63]
    s_waitcnt lgkmcnt(6)
    v_mfma_f32_16x16x32_bf16 v[56:59], v[48:51], a[24:27], v[56:59]
    ds_read_b128 v[44:47], v11 offset:12288
    s_add_u32 m0, s19, 89344
    v_mfma_f32_16x16x32_bf16 v[64:67], v[48:51], a[28:31], v[64:67]
    buffer_load_dwordx4 v2, s[8:11], s20 offen offset:768 lds
    s_waitcnt lgkmcnt(6)
    v_mfma_f32_16x16x32_bf16 v[52:55], v[20:23], a[32:35], v[52:55]
    ds_read_b128 v[48:51], v11 offset:14336
    v_mfma_f32_16x16x32_bf16 v[60:63], v[20:23], a[36:39], v[60:63]
    s_waitcnt lgkmcnt(6)
    v_mfma_f32_16x16x32_bf16 v[56:59], v[24:27], a[32:35], v[56:59]
    ds_read_b128 v[20:23], v10 offset:16384
    s_add_u32 m0, s19, 93312
    v_mfma_f32_16x16x32_bf16 v[64:67], v[24:27], a[36:39], v[64:67]
    buffer_load_dwordx4 v2, s[8:11], s20 offen offset:896 lds
    s_waitcnt lgkmcnt(6)
    v_mfma_f32_16x16x32_bf16 v[52:55], v[28:31], a[40:43], v[52:55]
    ds_read_b128 v[24:27], v10 offset:18432
    v_mfma_f32_16x16x32_bf16 v[60:63], v[28:31], a[44:47], v[60:63]
    v_cvt_pk_bf16_f32 v84, v68, v69
    s_waitcnt lgkmcnt(6)
    v_mfma_f32_16x16x32_bf16 v[56:59], v[32:35], a[40:43], v[56:59]
    ds_read_b128 v[28:31], v11 offset:16384
    v_mfma_f32_16x16x32_bf16 v[64:67], v[32:35], a[44:47], v[64:67]
    v_cvt_pk_bf16_f32 v85, v70, v71
    s_waitcnt lgkmcnt(6)
    v_mfma_f32_16x16x32_bf16 v[52:55], v[36:39], a[48:51], v[52:55]
    ds_read_b128 v[32:35], v11 offset:18432
    v_mfma_f32_16x16x32_bf16 v[60:63], v[36:39], a[52:55], v[60:63]
    v_cvt_pk_bf16_f32 v86, v72, v73
    s_waitcnt lgkmcnt(6)
    v_mfma_f32_16x16x32_bf16 v[56:59], v[40:43], a[48:51], v[56:59]
    ds_read_b128 v[36:39], v10 offset:20480
    v_mfma_f32_16x16x32_bf16 v[64:67], v[40:43], a[52:55], v[64:67]
    v_cvt_pk_bf16_f32 v87, v74, v75
    s_waitcnt lgkmcnt(6)
    v_mfma_f32_16x16x32_bf16 v[52:55], v[44:47], a[56:59], v[52:55]
    ds_read_b128 v[40:43], v10 offset:22528
    v_mfma_f32_16x16x32_bf16 v[60:63], v[44:47], a[60:63], v[60:63]
    v_cvt_pk_bf16_f32 v88, v76, v77
    s_waitcnt lgkmcnt(6)
    v_mfma_f32_16x16x32_bf16 v[56:59], v[48:51], a[56:59], v[56:59]
    ds_read_b128 v[44:47], v11 offset:20480
    v_mfma_f32_16x16x32_bf16 v[64:67], v[48:51], a[60:63], v[64:67]
    v_cvt_pk_bf16_f32 v89, v78, v79
    buffer_store_dwordx4 v[84:87], v3, s[4:7], s21 offen offset:0 sc1
    s_waitcnt lgkmcnt(6)
    v_mfma_f32_16x16x32_bf16 v[52:55], v[20:23], a[64:67], v[52:55]
    ds_read_b128 v[48:51], v11 offset:22528
    v_mfma_f32_16x16x32_bf16 v[60:63], v[20:23], a[68:71], v[60:63]
    v_cvt_pk_bf16_f32 v90, v80, v81
    s_waitcnt lgkmcnt(6)
    v_mfma_f32_16x16x32_bf16 v[56:59], v[24:27], a[64:67], v[56:59]
    ds_read_b128 v[20:23], v10 offset:24576
    v_mfma_f32_16x16x32_bf16 v[64:67], v[24:27], a[68:71], v[64:67]
    v_cvt_pk_bf16_f32 v91, v82, v83
    s_waitcnt lgkmcnt(6)
    v_mfma_f32_16x16x32_bf16 v[52:55], v[28:31], a[72:75], v[52:55]
    ds_read_b128 v[24:27], v10 offset:26624
    v_mfma_f32_16x16x32_bf16 v[60:63], v[28:31], a[76:79], v[60:63]
    s_waitcnt lgkmcnt(6)
    v_mfma_f32_16x16x32_bf16 v[56:59], v[32:35], a[72:75], v[56:59]
    ds_read_b128 v[28:31], v11 offset:24576
    v_mfma_f32_16x16x32_bf16 v[64:67], v[32:35], a[76:79], v[64:67]
    buffer_store_dwordx4 v[88:91], v3, s[4:7], s21 offen offset:256 sc1
    s_waitcnt lgkmcnt(6)
    v_mfma_f32_16x16x32_bf16 v[52:55], v[36:39], a[80:83], v[52:55]
    ds_read_b128 v[32:35], v11 offset:26624
    v_mfma_f32_16x16x32_bf16 v[60:63], v[36:39], a[84:87], v[60:63]
    s_add_u32 s21, s21, s25
    s_mov_b32 s25, s26
    s_waitcnt lgkmcnt(6)
    v_mfma_f32_16x16x32_bf16 v[56:59], v[40:43], a[80:83], v[56:59]
    ds_read_b128 v[36:39], v10 offset:28672
    v_mfma_f32_16x16x32_bf16 v[64:67], v[40:43], a[84:87], v[64:67]
    s_waitcnt lgkmcnt(6)
    v_mfma_f32_16x16x32_bf16 v[52:55], v[44:47], a[88:91], v[52:55]
    ds_read_b128 v[40:43], v10 offset:30720
    v_mfma_f32_16x16x32_bf16 v[60:63], v[44:47], a[92:95], v[60:63]
    s_waitcnt lgkmcnt(6)
    v_mfma_f32_16x16x32_bf16 v[56:59], v[48:51], a[88:91], v[56:59]
    ds_read_b128 v[44:47], v11 offset:28672
    v_mfma_f32_16x16x32_bf16 v[64:67], v[48:51], a[92:95], v[64:67]
    s_waitcnt lgkmcnt(6)
    v_mfma_f32_16x16x32_bf16 v[52:55], v[20:23], a[96:99], v[52:55]
    ds_read_b128 v[48:51], v11 offset:30720
    v_mfma_f32_16x16x32_bf16 v[60:63], v[20:23], a[100:103], v[60:63]
    s_waitcnt lgkmcnt(6)
    v_mfma_f32_16x16x32_bf16 v[56:59], v[24:27], a[96:99], v[56:59]
    s_waitcnt vmcnt(11)
    s_barrier
    ds_read_b128 v[20:23], v10 offset:32768
    v_mfma_f32_16x16x32_bf16 v[64:67], v[24:27], a[100:103], v[64:67]
    s_waitcnt lgkmcnt(6)
    v_mfma_f32_16x16x32_bf16 v[52:55], v[28:31], a[104:107], v[52:55]
    ds_read_b128 v[24:27], v10 offset:34816
    s_add_u32 m0, s19, 97280
    v_mfma_f32_16x16x32_bf16 v[60:63], v[28:31], a[108:111], v[60:63]
    buffer_load_dwordx4 v2, s[8:11], s20 offen offset:1024 lds
    s_waitcnt lgkmcnt(6)
    v_mfma_f32_16x16x32_bf16 v[56:59], v[32:35], a[104:107], v[56:59]
    ds_read_b128 v[28:31], v11 offset:32768
    v_mfma_f32_16x16x32_bf16 v[64:67], v[32:35], a[108:111], v[64:67]
    s_waitcnt lgkmcnt(6)
    v_mfma_f32_16x16x32_bf16 v[52:55], v[36:39], a[112:115], v[52:55]
    ds_read_b128 v[32:35], v11 offset:34816
    s_add_u32 m0, s19, 101248
    v_mfma_f32_16x16x32_bf16 v[60:63], v[36:39], a[116:119], v[60:63]
    buffer_load_dwordx4 v2, s[8:11], s20 offen offset:1152 lds
    s_waitcnt lgkmcnt(6)
    v_mfma_f32_16x16x32_bf16 v[56:59], v[40:43], a[112:115], v[56:59]
    ds_read_b128 v[36:39], v10 offset:36864
    v_mfma_f32_16x16x32_bf16 v[64:67], v[40:43], a[116:119], v[64:67]
    s_waitcnt lgkmcnt(6)
    v_mfma_f32_16x16x32_bf16 v[52:55], v[44:47], a[120:123], v[52:55]
    ds_read_b128 v[40:43], v10 offset:38912
    s_add_u32 m0, s19, 105216
    v_mfma_f32_16x16x32_bf16 v[60:63], v[44:47], a[124:127], v[60:63]
    buffer_load_dwordx4 v2, s[8:11], s20 offen offset:1280 lds
    s_waitcnt lgkmcnt(6)
    v_mfma_f32_16x16x32_bf16 v[56:59], v[48:51], a[120:123], v[56:59]
    ds_read_b128 v[44:47], v11 offset:36864
    v_mfma_f32_16x16x32_bf16 v[64:67], v[48:51], a[124:127], v[64:67]
    s_waitcnt lgkmcnt(6)
    v_mfma_f32_16x16x32_bf16 v[52:55], v[20:23], a[128:131], v[52:55]
    ds_read_b128 v[48:51], v11 offset:38912
    v_mfma_f32_16x16x32_bf16 v[60:63], v[20:23], a[132:135], v[60:63]
    s_waitcnt lgkmcnt(6)
    v_mfma_f32_16x16x32_bf16 v[56:59], v[24:27], a[128:131], v[56:59]
    ds_read_b128 v[20:23], v10 offset:40960
    s_add_u32 m0, s19, 109184
    v_mfma_f32_16x16x32_bf16 v[64:67], v[24:27], a[132:135], v[64:67]
    buffer_load_dwordx4 v2, s[8:11], s20 offen offset:1408 lds
    s_waitcnt lgkmcnt(6)
    v_mfma_f32_16x16x32_bf16 v[52:55], v[28:31], a[136:139], v[52:55]
    ds_read_b128 v[24:27], v10 offset:43008
    v_mfma_f32_16x16x32_bf16 v[60:63], v[28:31], a[140:143], v[60:63]
    s_waitcnt lgkmcnt(6)
    v_mfma_f32_16x16x32_bf16 v[56:59], v[32:35], a[136:139], v[56:59]
    ds_read_b128 v[28:31], v11 offset:40960
    s_add_u32 m0, s19, 113152
    v_mfma_f32_16x16x32_bf16 v[64:67], v[32:35], a[140:143], v[64:67]
    buffer_load_dwordx4 v2, s[8:11], s20 offen offset:1536 lds
    s_waitcnt lgkmcnt(6)
    v_mfma_f32_16x16x32_bf16 v[52:55], v[36:39], a[144:147], v[52:55]
    ds_read_b128 v[32:35], v11 offset:43008
    v_mfma_f32_16x16x32_bf16 v[60:63], v[36:39], a[148:151], v[60:63]
    s_waitcnt lgkmcnt(6)
    v_mfma_f32_16x16x32_bf16 v[56:59], v[40:43], a[144:147], v[56:59]
    ds_read_b128 v[36:39], v10 offset:45056
    s_add_u32 m0, s19, 117120
    v_mfma_f32_16x16x32_bf16 v[64:67], v[40:43], a[148:151], v[64:67]
    buffer_load_dwordx4 v2, s[8:11], s20 offen offset:1664 lds
    s_waitcnt lgkmcnt(6)
    v_mfma_f32_16x16x32_bf16 v[52:55], v[44:47], a[152:155], v[52:55]
    ds_read_b128 v[40:43], v10 offset:47104
    v_mfma_f32_16x16x32_bf16 v[60:63], v[44:47], a[156:159], v[60:63]
    s_waitcnt lgkmcnt(6)
    v_mfma_f32_16x16x32_bf16 v[56:59], v[48:51], a[152:155], v[56:59]
    ds_read_b128 v[44:47], v11 offset:45056
    s_add_u32 m0, s19, 121088
    v_mfma_f32_16x16x32_bf16 v[64:67], v[48:51], a[156:159], v[64:67]
    buffer_load_dwordx4 v2, s[8:11], s20 offen offset:1792 lds
    s_waitcnt lgkmcnt(6)
    v_mfma_f32_16x16x32_bf16 v[52:55], v[20:23], a[160:163], v[52:55]
    ds_read_b128 v[48:51], v11 offset:47104
    v_mfma_f32_16x16x32_bf16 v[60:63], v[20:23], a[164:167], v[60:63]
    s_waitcnt lgkmcnt(6)
    v_mfma_f32_16x16x32_bf16 v[56:59], v[24:27], a[160:163], v[56:59]
    ds_read_b128 v[20:23], v10 offset:49152
    s_add_u32 m0, s19, 125056
    v_mfma_f32_16x16x32_bf16 v[64:67], v[24:27], a[164:167], v[64:67]
    buffer_load_dwordx4 v2, s[8:11], s20 offen offset:1920 lds
    s_waitcnt lgkmcnt(6)
    v_mfma_f32_16x16x32_bf16 v[52:55], v[28:31], a[168:171], v[52:55]
    ds_read_b128 v[24:27], v10 offset:51200
    v_mfma_f32_16x16x32_bf16 v[60:63], v[28:31], a[172:175], v[60:63]
    s_add_u32 s20, s20, s24
    s_waitcnt lgkmcnt(6)
    v_mfma_f32_16x16x32_bf16 v[56:59], v[32:35], a[168:171], v[56:59]
    ds_read_b128 v[28:31], v11 offset:49152
    v_mfma_f32_16x16x32_bf16 v[64:67], v[32:35], a[172:175], v[64:67]
    s_waitcnt lgkmcnt(6)
    v_mfma_f32_16x16x32_bf16 v[52:55], v[36:39], a[176:179], v[52:55]
    ds_read_b128 v[32:35], v11 offset:51200
    v_mfma_f32_16x16x32_bf16 v[60:63], v[36:39], a[180:183], v[60:63]
    s_waitcnt lgkmcnt(6)
    v_mfma_f32_16x16x32_bf16 v[56:59], v[40:43], a[176:179], v[56:59]
    ds_read_b128 v[36:39], v10 offset:53248
    v_mfma_f32_16x16x32_bf16 v[64:67], v[40:43], a[180:183], v[64:67]
    s_waitcnt lgkmcnt(6)
    v_mfma_f32_16x16x32_bf16 v[52:55], v[44:47], a[184:187], v[52:55]
    ds_read_b128 v[40:43], v10 offset:55296
    v_mfma_f32_16x16x32_bf16 v[60:63], v[44:47], a[188:191], v[60:63]
    s_waitcnt lgkmcnt(6)
    v_mfma_f32_16x16x32_bf16 v[56:59], v[48:51], a[184:187], v[56:59]
    ds_read_b128 v[44:47], v11 offset:53248
    v_mfma_f32_16x16x32_bf16 v[64:67], v[48:51], a[188:191], v[64:67]
    s_waitcnt lgkmcnt(6)
    v_mfma_f32_16x16x32_bf16 v[52:55], v[20:23], a[192:195], v[52:55]
    ds_read_b128 v[48:51], v11 offset:55296
    v_mfma_f32_16x16x32_bf16 v[60:63], v[20:23], a[196:199], v[60:63]
    s_waitcnt lgkmcnt(6)
    v_mfma_f32_16x16x32_bf16 v[56:59], v[24:27], a[192:195], v[56:59]
    ds_read_b128 v[20:23], v10 offset:57344
    v_mfma_f32_16x16x32_bf16 v[64:67], v[24:27], a[196:199], v[64:67]
    s_waitcnt lgkmcnt(6)
    v_mfma_f32_16x16x32_bf16 v[52:55], v[28:31], a[200:203], v[52:55]
    ds_read_b128 v[24:27], v10 offset:59392
    v_mfma_f32_16x16x32_bf16 v[60:63], v[28:31], a[204:207], v[60:63]
    s_waitcnt lgkmcnt(6)
    v_mfma_f32_16x16x32_bf16 v[56:59], v[32:35], a[200:203], v[56:59]
    ds_read_b128 v[28:31], v11 offset:57344
    v_mfma_f32_16x16x32_bf16 v[64:67], v[32:35], a[204:207], v[64:67]
    s_waitcnt lgkmcnt(6)
    v_mfma_f32_16x16x32_bf16 v[52:55], v[36:39], a[208:211], v[52:55]
    ds_read_b128 v[32:35], v11 offset:59392
    v_mfma_f32_16x16x32_bf16 v[60:63], v[36:39], a[212:215], v[60:63]
    s_waitcnt lgkmcnt(6)
    v_mfma_f32_16x16x32_bf16 v[56:59], v[40:43], a[208:211], v[56:59]
    ds_read_b128 v[36:39], v10 offset:61440
    v_mfma_f32_16x16x32_bf16 v[64:67], v[40:43], a[212:215], v[64:67]
    s_waitcnt lgkmcnt(6)
    v_mfma_f32_16x16x32_bf16 v[52:55], v[44:47], a[216:219], v[52:55]
    ds_read_b128 v[40:43], v10 offset:63488
    v_mfma_f32_16x16x32_bf16 v[60:63], v[44:47], a[220:223], v[60:63]
    s_waitcnt lgkmcnt(6)
    v_mfma_f32_16x16x32_bf16 v[56:59], v[48:51], a[216:219], v[56:59]
    ds_read_b128 v[44:47], v11 offset:61440
    v_mfma_f32_16x16x32_bf16 v[64:67], v[48:51], a[220:223], v[64:67]
    s_waitcnt lgkmcnt(6)
    v_mfma_f32_16x16x32_bf16 v[52:55], v[20:23], a[224:227], v[52:55]
    ds_read_b128 v[48:51], v11 offset:63488
    v_mfma_f32_16x16x32_bf16 v[60:63], v[20:23], a[228:231], v[60:63]
    s_waitcnt lgkmcnt(6)
    v_mfma_f32_16x16x32_bf16 v[56:59], v[24:27], a[224:227], v[56:59]
    s_waitcnt vmcnt(8)
    s_barrier
    ds_read_b128 v[20:23], v12 offset:0
    v_mfma_f32_16x16x32_bf16 v[64:67], v[24:27], a[228:231], v[64:67]
    s_waitcnt lgkmcnt(6)
    v_mfma_f32_16x16x32_bf16 v[52:55], v[28:31], a[232:235], v[52:55]
    ds_read_b128 v[24:27], v12 offset:2048
    s_add_u32 m0, s19, 0
    v_mfma_f32_16x16x32_bf16 v[60:63], v[28:31], a[236:239], v[60:63]
    buffer_load_dwordx4 v2, s[8:11], s20 offen offset:0 lds
    s_waitcnt lgkmcnt(6)
    v_mfma_f32_16x16x32_bf16 v[56:59], v[32:35], a[232:235], v[56:59]
    ds_read_b128 v[28:31], v13 offset:0
    v_mfma_f32_16x16x32_bf16 v[64:67], v[32:35], a[236:239], v[64:67]
    v_mov_b32 v9, s23
    s_add_u32 s23, s23, 1
    buffer_store_dword v9, v4, s[4:7], 0 offen sc1
    s_waitcnt lgkmcnt(6)
    v_mfma_f32_16x16x32_bf16 v[52:55], v[36:39], a[240:243], v[52:55]
    ds_read_b128 v[32:35], v13 offset:2048
    s_add_u32 m0, s19, 3968
    v_mfma_f32_16x16x32_bf16 v[60:63], v[36:39], a[244:247], v[60:63]
    buffer_load_dwordx4 v2, s[8:11], s20 offen offset:128 lds
    s_waitcnt lgkmcnt(6)
    v_mfma_f32_16x16x32_bf16 v[56:59], v[40:43], a[240:243], v[56:59]
    ds_read_b128 v[36:39], v12 offset:4096
    v_mfma_f32_16x16x32_bf16 v[64:67], v[40:43], a[244:247], v[64:67]
    s_waitcnt lgkmcnt(6)
    v_mfma_f32_16x16x32_bf16 v[52:55], v[44:47], a[248:251], v[52:55]
    ds_read_b128 v[40:43], v12 offset:6144
    s_add_u32 m0, s19, 7936
    v_mfma_f32_16x16x32_bf16 v[60:63], v[44:47], a[252:255], v[60:63]
    buffer_load_dwordx4 v2, s[8:11], s20 offen offset:256 lds
    s_waitcnt lgkmcnt(6)
    v_mfma_f32_16x16x32_bf16 v[56:59], v[48:51], a[248:251], v[56:59]
    ds_read_b128 v[44:47], v13 offset:4096
    v_mfma_f32_16x16x32_bf16 v[64:67], v[48:51], a[252:255], v[64:67]
    s_waitcnt lgkmcnt(6)
    v_mfma_f32_16x16x32_bf16 v[68:71], v[20:23], a[0:3], 0
    ds_read_b128 v[48:51], v13 offset:6144
    v_mfma_f32_16x16x32_bf16 v[76:79], v[20:23], a[4:7], 0
    s_waitcnt lgkmcnt(6)
    v_mfma_f32_16x16x32_bf16 v[72:75], v[24:27], a[0:3], 0
    ds_read_b128 v[20:23], v12 offset:8192
    s_add_u32 m0, s19, 11904
    v_mfma_f32_16x16x32_bf16 v[80:83], v[24:27], a[4:7], 0
    buffer_load_dwordx4 v2, s[8:11], s20 offen offset:384 lds
    s_waitcnt lgkmcnt(6)
    v_mfma_f32_16x16x32_bf16 v[68:71], v[28:31], a[8:11], v[68:71]
    ds_read_b128 v[24:27], v12 offset:10240
    v_mfma_f32_16x16x32_bf16 v[76:79], v[28:31], a[12:15], v[76:79]
    s_waitcnt lgkmcnt(6)
    v_mfma_f32_16x16x32_bf16 v[72:75], v[32:35], a[8:11], v[72:75]
    ds_read_b128 v[28:31], v13 offset:8192
    s_add_u32 m0, s19, 15872
    v_mfma_f32_16x16x32_bf16 v[80:83], v[32:35], a[12:15], v[80:83]
    buffer_load_dwordx4 v2, s[8:11], s20 offen offset:512 lds
    s_waitcnt lgkmcnt(6)
    v_mfma_f32_16x16x32_bf16 v[68:71], v[36:39], a[16:19], v[68:71]
    ds_read_b128 v[32:35], v13 offset:10240
    v_mfma_f32_16x16x32_bf16 v[76:79], v[36:39], a[20:23], v[76:79]
    s_waitcnt lgkmcnt(6)
    v_mfma_f32_16x16x32_bf16 v[72:75], v[40:43], a[16:19], v[72:75]
    ds_read_b128 v[36:39], v12 offset:12288
    s_add_u32 m0, s19, 19840
    v_mfma_f32_16x16x32_bf16 v[80:83], v[40:43], a[20:23], v[80:83]
    buffer_load_dwordx4 v2, s[8:11], s20 offen offset:640 lds
    s_waitcnt lgkmcnt(6)
    v_mfma_f32_16x16x32_bf16 v[68:71], v[44:47], a[24:27], v[68:71]
    ds_read_b128 v[40:43], v12 offset:14336
    v_mfma_f32_16x16x32_bf16 v[76:79], v[44:47], a[28:31], v[76:79]
    s_waitcnt lgkmcnt(6)
    v_mfma_f32_16x16x32_bf16 v[72:75], v[48:51], a[24:27], v[72:75]
    ds_read_b128 v[44:47], v13 offset:12288
    s_add_u32 m0, s19, 23808
    v_mfma_f32_16x16x32_bf16 v[80:83], v[48:51], a[28:31], v[80:83]
    buffer_load_dwordx4 v2, s[8:11], s20 offen offset:768 lds
    s_waitcnt lgkmcnt(6)
    v_mfma_f32_16x16x32_bf16 v[68:71], v[20:23], a[32:35], v[68:71]
    ds_read_b128 v[48:51], v13 offset:14336
    v_mfma_f32_16x16x32_bf16 v[76:79], v[20:23], a[36:39], v[76:79]
    s_waitcnt lgkmcnt(6)
    v_mfma_f32_16x16x32_bf16 v[72:75], v[24:27], a[32:35], v[72:75]
    ds_read_b128 v[20:23], v12 offset:16384
    s_add_u32 m0, s19, 27776
    v_mfma_f32_16x16x32_bf16 v[80:83], v[24:27], a[36:39], v[80:83]
    buffer_load_dwordx4 v2, s[8:11], s20 offen offset:896 lds
    s_waitcnt lgkmcnt(6)
    v_mfma_f32_16x16x32_bf16 v[68:71], v[28:31], a[40:43], v[68:71]
    ds_read_b128 v[24:27], v12 offset:18432
    v_mfma_f32_16x16x32_bf16 v[76:79], v[28:31], a[44:47], v[76:79]
    v_cvt_pk_bf16_f32 v84, v52, v53
    s_waitcnt lgkmcnt(6)
    v_mfma_f32_16x16x32_bf16 v[72:75], v[32:35], a[40:43], v[72:75]
    ds_read_b128 v[28:31], v13 offset:16384
    v_mfma_f32_16x16x32_bf16 v[80:83], v[32:35], a[44:47], v[80:83]
    v_cvt_pk_bf16_f32 v85, v54, v55
    s_waitcnt lgkmcnt(6)
    v_mfma_f32_16x16x32_bf16 v[68:71], v[36:39], a[48:51], v[68:71]
    ds_read_b128 v[32:35], v13 offset:18432
    v_mfma_f32_16x16x32_bf16 v[76:79], v[36:39], a[52:55], v[76:79]
    v_cvt_pk_bf16_f32 v86, v56, v57
    s_waitcnt lgkmcnt(6)
    v_mfma_f32_16x16x32_bf16 v[72:75], v[40:43], a[48:51], v[72:75]
    ds_read_b128 v[36:39], v12 offset:20480
    v_mfma_f32_16x16x32_bf16 v[80:83], v[40:43], a[52:55], v[80:83]
    v_cvt_pk_bf16_f32 v87, v58, v59
    s_waitcnt lgkmcnt(6)
    v_mfma_f32_16x16x32_bf16 v[68:71], v[44:47], a[56:59], v[68:71]
    ds_read_b128 v[40:43], v12 offset:22528
    v_mfma_f32_16x16x32_bf16 v[76:79], v[44:47], a[60:63], v[76:79]
    v_cvt_pk_bf16_f32 v88, v60, v61
    s_waitcnt lgkmcnt(6)
    v_mfma_f32_16x16x32_bf16 v[72:75], v[48:51], a[56:59], v[72:75]
    ds_read_b128 v[44:47], v13 offset:20480
    v_mfma_f32_16x16x32_bf16 v[80:83], v[48:51], a[60:63], v[80:83]
    v_cvt_pk_bf16_f32 v89, v62, v63
    buffer_store_dwordx4 v[84:87], v3, s[4:7], s21 offen offset:0 sc1
    s_waitcnt lgkmcnt(6)
    v_mfma_f32_16x16x32_bf16 v[68:71], v[20:23], a[64:67], v[68:71]
    ds_read_b128 v[48:51], v13 offset:22528
    v_mfma_f32_16x16x32_bf16 v[76:79], v[20:23], a[68:71], v[76:79]
    v_cvt_pk_bf16_f32 v90, v64, v65
    s_waitcnt lgkmcnt(6)
    v_mfma_f32_16x16x32_bf16 v[72:75], v[24:27], a[64:67], v[72:75]
    ds_read_b128 v[20:23], v12 offset:24576
    v_mfma_f32_16x16x32_bf16 v[80:83], v[24:27], a[68:71], v[80:83]
    v_cvt_pk_bf16_f32 v91, v66, v67
    s_waitcnt lgkmcnt(6)
    v_mfma_f32_16x16x32_bf16 v[68:71], v[28:31], a[72:75], v[68:71]
    ds_read_b128 v[24:27], v12 offset:26624
    v_mfma_f32_16x16x32_bf16 v[76:79], v[28:31], a[76:79], v[76:79]
    s_waitcnt lgkmcnt(6)
    v_mfma_f32_16x16x32_bf16 v[72:75], v[32:35], a[72:75], v[72:75]
    ds_read_b128 v[28:31], v13 offset:24576
    v_mfma_f32_16x16x32_bf16 v[80:83], v[32:35], a[76:79], v[80:83]
    buffer_store_dwordx4 v[88:91], v3, s[4:7], s21 offen offset:256 sc1
    s_waitcnt lgkmcnt(6)
    v_mfma_f32_16x16x32_bf16 v[68:71], v[36:39], a[80:83], v[68:71]
    ds_read_b128 v[32:35], v13 offset:26624
    v_mfma_f32_16x16x32_bf16 v[76:79], v[36:39], a[84:87], v[76:79]
    s_add_u32 s21, s21, s25
    s_mov_b32 s25, s26
    s_waitcnt lgkmcnt(6)
    v_mfma_f32_16x16x32_bf16 v[72:75], v[40:43], a[80:83], v[72:75]
    ds_read_b128 v[36:39], v12 offset:28672
    v_mfma_f32_16x16x32_bf16 v[80:83], v[40:43], a[84:87], v[80:83]
    s_waitcnt lgkmcnt(6)
    v_mfma_f32_16x16x32_bf16 v[68:71], v[44:47], a[88:91], v[68:71]
    ds_read_b128 v[40:43], v12 offset:30720
    v_mfma_f32_16x16x32_bf16 v[76:79], v[44:47], a[92:95], v[76:79]
    s_waitcnt lgkmcnt(6)
    v_mfma_f32_16x16x32_bf16 v[72:75], v[48:51], a[88:91], v[72:75]
    ds_read_b128 v[44:47], v13 offset:28672
    v_mfma_f32_16x16x32_bf16 v[80:83], v[48:51], a[92:95], v[80:83]
    s_waitcnt lgkmcnt(6)
    v_mfma_f32_16x16x32_bf16 v[68:71], v[20:23], a[96:99], v[68:71]
    ds_read_b128 v[48:51], v13 offset:30720
    v_mfma_f32_16x16x32_bf16 v[76:79], v[20:23], a[100:103], v[76:79]
    s_waitcnt lgkmcnt(6)
    v_mfma_f32_16x16x32_bf16 v[72:75], v[24:27], a[96:99], v[72:75]
    s_waitcnt vmcnt(11)
    s_barrier
    ds_read_b128 v[20:23], v12 offset:32768
    v_mfma_f32_16x16x32_bf16 v[80:83], v[24:27], a[100:103], v[80:83]
    s_waitcnt lgkmcnt(6)
    v_mfma_f32_16x16x32_bf16 v[68:71], v[28:31], a[104:107], v[68:71]
    ds_read_b128 v[24:27], v12 offset:34816
    s_add_u32 m0, s19, 31744
    v_mfma_f32_16x16x32_bf16 v[76:79], v[28:31], a[108:111], v[76:79]
    buffer_load_dwordx4 v2, s[8:11], s20 offen offset:1024 lds
    s_waitcnt lgkmcnt(6)
    v_mfma_f32_16x16x32_bf16 v[72:75], v[32:35], a[104:107], v[72:75]
    ds_read_b128 v[28:31], v13 offset:32768
    v_mfma_f32_16x16x32_bf16 v[80:83], v[32:35], a[108:111], v[80:83]
    s_waitcnt lgkmcnt(6)
    v_mfma_f32_16x16x32_bf16 v[68:71], v[36:39], a[112:115], v[68:71]
    ds_read_b128 v[32:35], v13 offset:34816
    s_add_u32 m0, s19, 35712
    v_mfma_f32_16x16x32_bf16 v[76:79], v[36:39], a[116:119], v[76:79]
    buffer_load_dwordx4 v2, s[8:11], s20 offen offset:1152 lds
    s_waitcnt lgkmcnt(6)
    v_mfma_f32_16x16x32_bf16 v[72:75], v[40:43], a[112:115], v[72:75]
    ds_read_b128 v[36:39], v12 offset:36864
    v_mfma_f32_16x16x32_bf16 v[80:83], v[40:43], a[116:119], v[80:83]
    s_waitcnt lgkmcnt(6)
    v_mfma_f32_16x16x32_bf16 v[68:71], v[44:47], a[120:123], v[68:71]
    ds_read_b128 v[40:43], v12 offset:38912
    s_add_u32 m0, s19, 39680
    v_mfma_f32_16x16x32_bf16 v[76:79], v[44:47], a[124:127], v[76:79]
    buffer_load_dwordx4 v2, s[8:11], s20 offen offset:1280 lds
    s_waitcnt lgkmcnt(6)
    v_mfma_f32_16x16x32_bf16 v[72:75], v[48:51], a[120:123], v[72:75]
    ds_read_b128 v[44:47], v13 offset:36864
    v_mfma_f32_16x16x32_bf16 v[80:83], v[48:51], a[124:127], v[80:83]
    s_waitcnt lgkmcnt(6)
    v_mfma_f32_16x16x32_bf16 v[68:71], v[20:23], a[128:131], v[68:71]
    ds_read_b128 v[48:51], v13 offset:38912
    v_mfma_f32_16x16x32_bf16 v[76:79], v[20:23], a[132:135], v[76:79]
    s_waitcnt lgkmcnt(6)
    v_mfma_f32_16x16x32_bf16 v[72:75], v[24:27], a[128:131], v[72:75]
    ds_read_b128 v[20:23], v12 offset:40960
    s_add_u32 m0, s19, 43648
    v_mfma_f32_16x16x32_bf16 v[80:83], v[24:27], a[132:135], v[80:83]
    buffer_load_dwordx4 v2, s[8:11], s20 offen offset:1408 lds
    s_waitcnt lgkmcnt(6)
    v_mfma_f32_16x16x32_bf16 v[68:71], v[28:31], a[136:139], v[68:71]
    ds_read_b128 v[24:27], v12 offset:43008
    v_mfma_f32_16x16x32_bf16 v[76:79], v[28:31], a[140:143], v[76:79]
    s_waitcnt lgkmcnt(6)
    v_mfma_f32_16x16x32_bf16 v[72:75], v[32:35], a[136:139], v[72:75]
    ds_read_b128 v[28:31], v13 offset:40960
    s_add_u32 m0, s19, 47616
    v_mfma_f32_16x16x32_bf16 v[80:83], v[32:35], a[140:143], v[80:83]
    buffer_load_dwordx4 v2, s[8:11], s20 offen offset:1536 lds
    s_waitcnt lgkmcnt(6)
    v_mfma_f32_16x16x32_bf16 v[68:71], v[36:39], a[144:147], v[68:71]
    ds_read_b128 v[32:35], v13 offset:43008
    v_mfma_f32_16x16x32_bf16 v[76:79], v[36:39], a[148:151], v[76:79]
    s_waitcnt lgkmcnt(6)
    v_mfma_f32_16x16x32_bf16 v[72:75], v[40:43], a[144:147], v[72:75]
    ds_read_b128 v[36:39], v12 offset:45056
    s_add_u32 m0, s19, 51584
    v_mfma_f32_16x16x32_bf16 v[80:83], v[40:43], a[148:151], v[80:83]
    buffer_load_dwordx4 v2, s[8:11], s20 offen offset:1664 lds
    s_waitcnt lgkmcnt(6)
    v_mfma_f32_16x16x32_bf16 v[68:71], v[44:47], a[152:155], v[68:71]
    ds_read_b128 v[40:43], v12 offset:47104
    v_mfma_f32_16x16x32_bf16 v[76:79], v[44:47], a[156:159], v[76:79]
    s_waitcnt lgkmcnt(6)
    v_mfma_f32_16x16x32_bf16 v[72:75], v[48:51], a[152:155], v[72:75]
    ds_read_b128 v[44:47], v13 offset:45056
    s_add_u32 m0, s19, 55552
    v_mfma_f32_16x16x32_bf16 v[80:83], v[48:51], a[156:159], v[80:83]
    buffer_load_dwordx4 v2, s[8:11], s20 offen offset:1792 lds
    s_waitcnt lgkmcnt(6)
    v_mfma_f32_16x16x32_bf16 v[68:71], v[20:23], a[160:163], v[68:71]
    ds_read_b128 v[48:51], v13 offset:47104
    v_mfma_f32_16x16x32_bf16 v[76:79], v[20:23], a[164:167], v[76:79]
    s_waitcnt lgkmcnt(6)
    v_mfma_f32_16x16x32_bf16 v[72:75], v[24:27], a[160:163], v[72:75]
    ds_read_b128 v[20:23], v12 offset:49152
    s_add_u32 m0, s19, 59520
    v_mfma_f32_16x16x32_bf16 v[80:83], v[24:27], a[164:167], v[80:83]
    buffer_load_dwordx4 v2, s[8:11], s20 offen offset:1920 lds
    s_waitcnt lgkmcnt(6)
    v_mfma_f32_16x16x32_bf16 v[68:71], v[28:31], a[168:171], v[68:71]
    ds_read_b128 v[24:27], v12 offset:51200
    v_mfma_f32_16x16x32_bf16 v[76:79], v[28:31], a[172:175], v[76:79]
    s_add_u32 s20, s20, s24
    s_waitcnt lgkmcnt(6)
    v_mfma_f32_16x16x32_bf16 v[72:75], v[32:35], a[168:171], v[72:75]
    ds_read_b128 v[28:31], v13 offset:49152
    v_mfma_f32_16x16x32_bf16 v[80:83], v[32:35], a[172:175], v[80:83]
    s_waitcnt lgkmcnt(6)
    v_mfma_f32_16x16x32_bf16 v[68:71], v[36:39], a[176:179], v[68:71]
    ds_read_b128 v[32:35], v13 offset:51200
    v_mfma_f32_16x16x32_bf16 v[76:79], v[36:39], a[180:183], v[76:79]
    s_waitcnt lgkmcnt(6)
    v_mfma_f32_16x16x32_bf16 v[72:75], v[40:43], a[176:179], v[72:75]
    ds_read_b128 v[36:39], v12 offset:53248
    v_mfma_f32_16x16x32_bf16 v[80:83], v[40:43], a[180:183], v[80:83]
    s_waitcnt lgkmcnt(6)
    v_mfma_f32_16x16x32_bf16 v[68:71], v[44:47], a[184:187], v[68:71]
    ds_read_b128 v[40:43], v12 offset:55296
    v_mfma_f32_16x16x32_bf16 v[76:79], v[44:47], a[188:191], v[76:79]
    s_waitcnt lgkmcnt(6)
    v_mfma_f32_16x16x32_bf16 v[72:75], v[48:51], a[184:187], v[72:75]
    ds_read_b128 v[44:47], v13 offset:53248
    v_mfma_f32_16x16x32_bf16 v[80:83], v[48:51], a[188:191], v[80:83]
    s_waitcnt lgkmcnt(6)
    v_mfma_f32_16x16x32_bf16 v[68:71], v[20:23], a[192:195], v[68:71]
    ds_read_b128 v[48:51], v13 offset:55296
    v_mfma_f32_16x16x32_bf16 v[76:79], v[20:23], a[196:199], v[76:79]
    s_waitcnt lgkmcnt(6)
    v_mfma_f32_16x16x32_bf16 v[72:75], v[24:27], a[192:195], v[72:75]
    ds_read_b128 v[20:23], v12 offset:57344
    v_mfma_f32_16x16x32_bf16 v[80:83], v[24:27], a[196:199], v[80:83]
    s_waitcnt lgkmcnt(6)
    v_mfma_f32_16x16x32_bf16 v[68:71], v[28:31], a[200:203], v[68:71]
    ds_read_b128 v[24:27], v12 offset:59392
    v_mfma_f32_16x16x32_bf16 v[76:79], v[28:31], a[204:207], v[76:79]
    s_waitcnt lgkmcnt(6)
    v_mfma_f32_16x16x32_bf16 v[72:75], v[32:35], a[200:203], v[72:75]
    ds_read_b128 v[28:31], v13 offset:57344
    v_mfma_f32_16x16x32_bf16 v[80:83], v[32:35], a[204:207], v[80:83]
    s_waitcnt lgkmcnt(6)
    v_mfma_f32_16x16x32_bf16 v[68:71], v[36:39], a[208:211], v[68:71]
    ds_read_b128 v[32:35], v13 offset:59392
    v_mfma_f32_16x16x32_bf16 v[76:79], v[36:39], a[212:215], v[76:79]
    s_waitcnt lgkmcnt(6)
    v_mfma_f32_16x16x32_bf16 v[72:75], v[40:43], a[208:211], v[72:75]
    ds_read_b128 v[36:39], v12 offset:61440
    v_mfma_f32_16x16x32_bf16 v[80:83], v[40:43], a[212:215], v[80:83]
    s_waitcnt lgkmcnt(6)
    v_mfma_f32_16x16x32_bf16 v[68:71], v[44:47], a[216:219], v[68:71]
    ds_read_b128 v[40:43], v12 offset:63488
    v_mfma_f32_16x16x32_bf16 v[76:79], v[44:47], a[220:223], v[76:79]
    s_waitcnt lgkmcnt(6)
    v_mfma_f32_16x16x32_bf16 v[72:75], v[48:51], a[216:219], v[72:75]
    ds_read_b128 v[44:47], v13 offset:61440
    v_mfma_f32_16x16x32_bf16 v[80:83], v[48:51], a[220:223], v[80:83]
    s_waitcnt lgkmcnt(6)
    v_mfma_f32_16x16x32_bf16 v[68:71], v[20:23], a[224:227], v[68:71]
    ds_read_b128 v[48:51], v13 offset:63488
    v_mfma_f32_16x16x32_bf16 v[76:79], v[20:23], a[228:231], v[76:79]
    s_waitcnt lgkmcnt(6)
    v_mfma_f32_16x16x32_bf16 v[72:75], v[24:27], a[224:227], v[72:75]
    s_waitcnt vmcnt(8)
    s_barrier
    ds_read_b128 v[20:23], v10 offset:0
    v_mfma_f32_16x16x32_bf16 v[80:83], v[24:27], a[228:231], v[80:83]
    s_waitcnt lgkmcnt(6)
    v_mfma_f32_16x16x32_bf16 v[68:71], v[28:31], a[232:235], v[68:71]
    ds_read_b128 v[24:27], v10 offset:2048
    s_add_u32 m0, s19, 65536
    v_mfma_f32_16x16x32_bf16 v[76:79], v[28:31], a[236:239], v[76:79]
    buffer_load_dwordx4 v2, s[8:11], s20 offen offset:0 lds
    s_waitcnt lgkmcnt(6)
    v_mfma_f32_16x16x32_bf16 v[72:75], v[32:35], a[232:235], v[72:75]
    ds_read_b128 v[28:31], v11 offset:0
    v_mfma_f32_16x16x32_bf16 v[80:83], v[32:35], a[236:239], v[80:83]
    v_mov_b32 v9, s23
    s_add_u32 s23, s23, 1
    buffer_store_dword v9, v4, s[4:7], 0 offen sc1
    s_waitcnt lgkmcnt(6)
    v_mfma_f32_16x16x32_bf16 v[68:71], v[36:39], a[240:243], v[68:71]
    ds_read_b128 v[32:35], v11 offset:2048
    s_add_u32 m0, s19, 69504
    v_mfma_f32_16x16x32_bf16 v[76:79], v[36:39], a[244:247], v[76:79]
    buffer_load_dwordx4 v2, s[8:11], s20 offen offset:128 lds
    s_waitcnt lgkmcnt(6)
    v_mfma_f32_16x16x32_bf16 v[72:75], v[40:43], a[240:243], v[72:75]
    ds_read_b128 v[36:39], v10 offset:4096
    v_mfma_f32_16x16x32_bf16 v[80:83], v[40:43], a[244:247], v[80:83]
    s_waitcnt lgkmcnt(6)
    v_mfma_f32_16x16x32_bf16 v[68:71], v[44:47], a[248:251], v[68:71]
    ds_read_b128 v[40:43], v10 offset:6144
    s_add_u32 m0, s19, 73472
    v_mfma_f32_16x16x32_bf16 v[76:79], v[44:47], a[252:255], v[76:79]
    buffer_load_dwordx4 v2, s[8:11], s20 offen offset:256 lds
    s_waitcnt lgkmcnt(6)
    v_mfma_f32_16x16x32_bf16 v[72:75], v[48:51], a[248:251], v[72:75]
    ds_read_b128 v[44:47], v11 offset:4096
    v_mfma_f32_16x16x32_bf16 v[80:83], v[48:51], a[252:255], v[80:83]
    s_add_u32 s22, s22, 2
    s_cmp_lt_u32 s22, 64
    s_cbranch_scc1 P_v_top
    v_cvt_pk_bf16_f32 v84, v68, v69
    v_cvt_pk_bf16_f32 v85, v70, v71
    s_nop 0
    v_cvt_pk_bf16_f32 v86, v72, v73
    v_cvt_pk_bf16_f32 v87, v74, v75
    v_cvt_pk_bf16_f32 v88, v76, v77
    v_cvt_pk_bf16_f32 v89, v78, v79
    v_cvt_pk_bf16_f32 v90, v80, v81
    v_cvt_pk_bf16_f32 v91, v82, v83
    buffer_store_dwordx4 v[84:87], v3, s[4:7], s21 offen offset:0 sc1
    buffer_store_dwordx4 v[88:91], v3, s[4:7], s21 offen offset:256 sc1
    s_waitcnt vmcnt(0) lgkmcnt(0)
    v_mov_b32 v9, s23
    s_add_u32 s23, s23, 1
    buffer_store_dword v9, v4, s[4:7], 0 offen sc1
    s_branch W_U
W_U:
    v_lshlrev_b32 v5, 2, v1
    s_mov_b32 s18, 0
rdv_13:
    global_load_dword v6, v5, s[100:101] sc1
    s_lshl_b32 s17, s98, 2
    s_waitcnt vmcnt(0)
    v_lshrrev_b32 v9, s17, v6
    s_cmp_eq_u32 s98, 0
    s_cselect_b32 s17, 0x0f0f0f0f, s17
    s_cselect_b32 s17, s17, 0x01010101
    v_and_b32 v9, s17, v9
    v_cmp_ne_u32 vcc, 0x01010101, v9
    s_nop 0
    s_cbranch_vccz rdvok_14
    v_sad_u8 v9, v9, 0, 0
    s_nop 1
    v_add_u32_dpp v9, v9, v9 quad_perm:[1,0,3,2] row_mask:0xf bank_mask:0xf
    v_cmp_ne_u32 vcc, 8, v9
    s_nop 0
    s_cbranch_vccnz rdvw_15
    s_mov_b32 s98, 1
    s_and_b32 s3, s97, 7
    s_barrier
    s_branch role_start
rdvw_15:
    s_sleep 4
    s_add_u32 s18, s18, 1
    s_cmp_lt_u32 s18, 262144
    s_cbranch_scc1 rdv_13
    s_mov_b32 s92, 1048576
rdvok_14:
    s_load_dwordx2 s[8:9], s[0:1], 64
    s_load_dwordx2 s[12:13], s[0:1], 80
    s_mov_b32 s10, 8388608
    s_mov_b32 s11, 0x20000
    s_mov_b32 s14, 8388608
    s_mov_b32 s15, 0x20000
    s_lshl_b32 s17, s90, 2
    s_lshr_b32 s17, 0, s17
    s_add_u32 s35, s93, s17
    s_and_b32 s35, s35, 15
    s_lshr_b32 s28, s93, 4
    s_lshl_b32 s17, s90, 2
    s_lshr_b32 s17, 516, s17
    s_and_b32 s17, s17, 15
    s_add_u32 s28, s28, s17
    s_lshl_b32 s20, s16, 21
    s_lshl_b32 s17, s35, 7
    s_add_u32 s20, s20, s17
    v_lshrrev_b32 v5, 2, v1
    v_and_b32 v6, 3, v1
    v_lshlrev_b32 v7, 4, v6
    v_lshl_add_u32 v7, v5, 11, v7
    v_lshlrev_b32 v8, 3, v6
    v_bfe_u32 v5, v1, 2, 2
    v_lshrrev_b32 v6, 4, v1
    v_lshl_add_u32 v5, v6, 3, v5
    v_lshl_add_u32 v8, v5, 6, v8
    s_lshl_b32 s19, s16, 15
    v_add_u32 v8, s19, v8
    s_and_b32 s37, s93, 0
    s_lshl_b32 s37, s37, 18
    s_waitcnt lgkmcnt(0)
    s_barrier
    v_lshrrev_b32 v5, 3, v1
    v_and_b32 v6, 3, v5
    v_lshlrev_b32 v6, 1, v6
    v_xor_b32 v6, v6, v1
    v_and_b32 v6, 7, v6
    v_lshlrev_b32 v6, 4, v6
    v_lshl_add_u32 v7, v5, 11, v6
    v_xor_b32 v49, 32, v7
    v_bfe_u32 v5, v1, 2, 2
    v_lshrrev_b32 v6, 4, v1
    v_lshl_add_u32 v8, v6, 3, v5
    v_lshl_add_u32 v8, v8, 7, s19
    v_and_b32 v6, 1, v6
    v_xor_b32 v5, v5, v6
    v_lshl_add_u32 v8, v5, 5, v8
    v_and_b32 v6, 3, v1
    v_lshl_add_u32 v8, v6, 3, v8
    v_xor_b32 v2, 32, v8
    v_xor_b32 v3, 64, v8
    v_xor_b32 v4, 96, v8
    s_sub_u32 s17, s90, 1
    s_and_b32 s17, s17, 3
    s_lshl_b32 s17, s17, 3
    s_and_b32 s18, s93, 7
    s_add_u32 s17, s17, s18
    s_lshl_b32 s17, s17, 8
    v_add_lshl_u32 v5, v0, s17, 11
    s_and_b32 s17, s93, 8
    s_lshl_b32 s17, s17, 7
    buffer_load_dword v48, v5, s[8:11], s17 offen offset:384
    s_add_u32 m0, s19, 0
    s_add_u32 s17, s20, 0
    buffer_load_dwordx4 v7, s[8:11], s17 offen lds
    s_add_u32 m0, s19, 1024
    s_add_u32 s17, s20, 16384
    buffer_load_dwordx4 v49, s[8:11], s17 offen lds
    s_add_u32 m0, s19, 2048
    s_add_u32 s17, s20, 32768
    buffer_load_dwordx4 v7, s[8:11], s17 offen lds
    s_add_u32 m0, s19, 3072
    s_add_u32 s17, s20, 49152
    buffer_load_dwordx4 v49, s[8:11], s17 offen lds
    s_add_u32 m0, s19, 4096
    s_add_u32 s17, s20, 65536
    buffer_load_dwordx4 v7, s[8:11], s17 offen lds
    s_add_u32 m0, s19, 5120
    s_add_u32 s17, s20, 81920
    buffer_load_dwordx4 v49, s[8:11], s17 offen lds
    s_add_u32 m0, s19, 6144
    s_add_u32 s17, s20, 98304
    buffer_load_dwordx4 v7, s[8:11], s17 offen lds
    s_add_u32 m0, s19, 7168
    s_add_u32 s17, s20, 114688
    buffer_load_dwordx4 v49, s[8:11], s17 offen lds
    s_add_u32 m0, s19, 8192
    s_add_u32 s17, s20, 131072
    buffer_load_dwordx4 v7, s[8:11], s17 offen lds
    s_add_u32 m0, s19, 9216
    s_add_u32 s17, s20, 147456
    buffer_load_dwordx4 v49, s[8:11], s17 offen lds
    s_add_u32 m0, s19, 10240
    s_add_u32 s17, s20, 163840
    buffer_load_dwordx4 v7, s[8:11], s17 offen lds
    s_add_u32 m0, s19, 11264
    s_add_u32 s17, s20, 180224
    buffer_load_dwordx4 v49, s[8:11], s17 offen lds
    s_add_u32 m0, s19, 12288
    s_add_u32 s17, s20, 262144
    buffer_load_dwordx4 v7, s[8:11], s17 offen lds
    s_add_u32 m0, s19, 13312
    s_add_u32 s17, s20, 278528
    buffer_load_dwordx4 v49, s[8:11], s17 offen lds
    s_add_u32 m0, s19, 14336
    s_add_u32 s17, s20, 294912
    buffer_load_dwordx4 v7, s[8:11], s17 offen lds
    s_add_u32 m0, s19, 15360
    s_add_u32 s17, s20, 311296
    buffer_load_dwordx4 v49, s[8:11], s17 offen lds
    s_add_u32 m0, s19, 16384
    s_add_u32 s17, s20, 327680
    buffer_load_dwordx4 v7, s[8:11], s17 offen lds
    s_add_u32 m0, s19, 17408
    s_add_u32 s17, s20, 344064
    buffer_load_dwordx4 v49, s[8:11], s17 offen lds
    s_add_u32 m0, s19, 18432
    s_add_u32 s17, s20, 360448
    buffer_load_dwordx4 v7, s[8:11], s17 offen lds
    s_add_u32 m0, s19, 19456
    s_add_u32 s17, s20, 376832
    buffer_load_dwordx4 v49, s[8:11], s17 offen lds
    s_add_u32 m0, s19, 20480
    s_add_u32 s17, s20, 393216
    buffer_load_dwordx4 v7, s[8:11], s17 offen lds
    s_add_u32 m0, s19, 21504
    s_add_u32 s17, s20, 409600
    buffer_load_dwordx4 v49, s[8:11], s17 offen lds
    s_add_u32 m0, s19, 22528
    s_add_u32 s17, s20, 425984
    buffer_load_dwordx4 v7, s[8:11], s17 offen lds
    s_add_u32 m0, s19, 23552
    s_add_u32 s17, s20, 442368
    buffer_load_dwordx4 v49, s[8:11], s17 offen lds
    s_add_u32 m0, s19, 24576
    s_add_u32 s17, s20, 524288
    buffer_load_dwordx4 v7, s[8:11], s17 offen lds
    s_add_u32 m0, s19, 25600
    s_add_u32 s17, s20, 540672
    buffer_load_dwordx4 v49, s[8:11], s17 offen lds
    s_add_u32 m0, s19, 26624
    s_add_u32 s17, s20, 557056
    buffer_load_dwordx4 v7, s[8:11], s17 offen lds
    s_add_u32 m0, s19, 27648
    s_add_u32 s17, s20, 573440
    buffer_load_dwordx4 v49, s[8:11], s17 offen lds
    s_add_u32 m0, s19, 28672
    s_add_u32 s17, s20, 589824
    buffer_load_dwordx4 v7, s[8:11], s17 offen lds
    s_add_u32 m0, s19, 29696
    s_add_u32 s17, s20, 606208
    buffer_load_dwordx4 v49, s[8:11], s17 offen lds
    s_add_u32 m0, s19, 30720
    s_add_u32 s17, s20, 622592
    buffer_load_dwordx4 v7, s[8:11], s17 offen lds
    s_add_u32 m0, s19, 31744
    s_add_u32 s17, s20, 638976
    buffer_load_dwordx4 v49, s[8:11], s17 offen lds
    s_waitcnt vmcnt(28)
    ds_read_b64_tr_b16 a[0:1], v8 offset:0
    ds_read_b64_tr_b16 a[2:3], v8 offset:512
    ds_read_b64_tr_b16 a[4:5], v2 offset:0
    ds_read_b64_tr_b16 a[6:7], v2 offset:512
    ds_read_b64_tr_b16 a[8:9], v3 offset:0
    ds_read_b64_tr_b16 a[10:11], v3 offset:512
    ds_read_b64_tr_b16 a[12:13], v4 offset:0
    ds_read_b64_tr_b16 a[14:15], v4 offset:512
    s_waitcnt vmcnt(24)
    ds_read_b64_tr_b16 a[16:17], v8 offset:4096
    ds_read_b64_tr_b16 a[18:19], v8 offset:4608
    ds_read_b64_tr_b16 a[20:21], v2 offset:4096
    ds_read_b64_tr_b16 a[22:23], v2 offset:4608
    s_waitcnt lgkmcnt(4)
    s_add_u32 m0, s19, 0
    s_add_u32 s17, s20, 655360
    buffer_load_dwordx4 v7, s[8:11], s17 offen lds
    s_add_u32 m0, s19, 1024
    s_add_u32 s17, s20, 671744
    buffer_load_dwordx4 v49, s[8:11], s17 offen lds
    s_add_u32 m0, s19, 2048
    s_add_u32 s17, s20, 688128
    buffer_load_dwordx4 v7, s[8:11], s17 offen lds
    s_add_u32 m0, s19, 3072
    s_add_u32 s17, s20, 704512
    buffer_load_dwordx4 v49, s[8:11], s17 offen lds
    ds_read_b64_tr_b16 a[24:25], v3 offset:4096
    ds_read_b64_tr_b16 a[26:27], v3 offset:4608
    ds_read_b64_tr_b16 a[28:29], v4 offset:4096
    ds_read_b64_tr_b16 a[30:31], v4 offset:4608
    s_waitcnt vmcnt(24)
    ds_read_b64_tr_b16 a[32:33], v8 offset:8192
    ds_read_b64_tr_b16 a[34:35], v8 offset:8704
    ds_read_b64_tr_b16 a[36:37], v2 offset:8192
    ds_read_b64_tr_b16 a[38:39], v2 offset:8704
    s_waitcnt lgkmcnt(4)
    s_add_u32 m0, s19, 4096
    s_add_u32 s17, s20, 786432
    buffer_load_dwordx4 v7, s[8:11], s17 offen lds
    s_add_u32 m0, s19, 5120
    s_add_u32 s17, s20, 802816
    buffer_load_dwordx4 v49, s[8:11], s17 offen lds
    s_add_u32 m0, s19, 6144
    s_add_u32 s17, s20, 819200
    buffer_load_dwordx4 v7, s[8:11], s17 offen lds
    s_add_u32 m0, s19, 7168
    s_add_u32 s17, s20, 835584
    buffer_load_dwordx4 v49, s[8:11], s17 offen lds
    ds_read_b64_tr_b16 a[40:41], v3 offset:8192
    ds_read_b64_tr_b16 a[42:43], v3 offset:8704
    ds_read_b64_tr_b16 a[44:45], v4 offset:8192
    ds_read_b64_tr_b16 a[46:47], v4 offset:8704
    s_waitcnt vmcnt(24)
    ds_read_b64_tr_b16 a[48:49], v8 offset:12288
    ds_read_b64_tr_b16 a[50:51], v8 offset:12800
    ds_read_b64_tr_b16 a[52:53], v2 offset:12288
    ds_read_b64_tr_b16 a[54:55], v2 offset:12800
    s_waitcnt lgkmcnt(4)
    s_add_u32 m0, s19, 8192
    s_add_u32 s17, s20, 851968
    buffer_load_dwordx4 v7, s[8:11], s17 offen lds
    s_add_u32 m0, s19, 9216
    s_add_u32 s17, s20, 868352
    buffer_load_dwordx4 v49, s[8:11], s17 offen lds
    s_add_u32 m0, s19, 10240
    s_add_u32 s17, s20, 884736
    buffer_load_dwordx4 v7, s[8:11], s17 offen lds
    s_add_u32 m0, s19, 11264
    s_add_u32 s17, s20, 901120
    buffer_load_dwordx4 v49, s[8:11], s17 offen lds
    ds_read_b64_tr_b16 a[56:57], v3 offset:12288
    ds_read_b64_tr_b16 a[58:59], v3 offset:12800
    ds_read_b64_tr_b16 a[60:61], v4 offset:12288
    ds_read_b64_tr_b16 a[62:63], v4 offset:12800
    s_waitcnt vmcnt(24)
    ds_read_b64_tr_b16 a[64:65], v8 offset:16384
    ds_read_b64_tr_b16 a[66:67], v8 offset:16896
    ds_read_b64_tr_b16 a[68:69], v2 offset:16384
    ds_read_b64_tr_b16 a[70:71], v2 offset:16896
    s_waitcnt lgkmcnt(4)
    s_add_u32 m0, s19, 12288
    s_add_u32 s17, s20, 917504
    buffer_load_dwordx4 v7, s[8:11], s17 offen lds
    s_add_u32 m0, s19, 13312
    s_add_u32 s17, s20, 933888
    buffer_load_dwordx4 v49, s[8:11], s17 offen lds
    s_add_u32 m0, s19, 14336
    s_add_u32 s17, s20, 950272
    buffer_load_dwordx4 v7, s[8:11], s17 offen lds
    s_add_u32 m0, s19, 15360
    s_add_u32 s17, s20, 966656
    buffer_load_dwordx4 v49, s[8:11], s17 offen lds
    ds_read_b64_tr_b16 a[72:73], v3 offset:16384
    ds_read_b64_tr_b16 a[74:75], v3 offset:16896
    ds_read_b64_tr_b16 a[76:77], v4 offset:16384
    ds_read_b64_tr_b16 a[78:79], v4 offset:16896
    s_waitcnt vmcnt(24)
    ds_read_b64_tr_b16 a[80:81], v8 offset:20480
    ds_read_b64_tr_b16 a[82:83], v8 offset:20992
    ds_read_b64_tr_b16 a[84:85], v2 offset:20480
    ds_read_b64_tr_b16 a[86:87], v2 offset:20992
    s_waitcnt lgkmcnt(4)
    s_add_u32 m0, s19, 16384
    s_add_u32 s17, s20, 1048576
    buffer_load_dwordx4 v7, s[8:11], s17 offen lds
    s_add_u32 m0, s19, 17408
    s_add_u32 s17, s20, 1064960
    buffer_load_dwordx4 v49, s[8:11], s17 offen lds
    s_add_u32 m0, s19, 18432
    s_add_u32 s17, s20, 1081344
    buffer_load_dwordx4 v7, s[8:11], s17 offen lds
    s_add_u32 m0, s19, 19456
    s_add_u32 s17, s20, 1097728
    buffer_load_dwordx4 v49, s[8:11], s17 offen lds
    ds_read_b64_tr_b16 a[88:89], v3 offset:20480
    ds_read_b64_tr_b16 a[90:91], v3 offset:20992
    ds_read_b64_tr_b16 a[92:93], v4 offset:20480
    ds_read_b64_tr_b16 a[94:95], v4 offset:20992
    s_waitcnt vmcnt(24)
    ds_read_b64_tr_b16 a[96:97], v8 offset:24576
    ds_read_b64_tr_b16 a[98:99], v8 offset:25088
    ds_read_b64_tr_b16 a[100:101], v2 offset:24576
    ds_read_b64_tr_b16 a[102:103], v2 offset:25088
    s_waitcnt lgkmcnt(4)
    s_add_u32 m0, s19, 20480
    s_add_u32 s17, s20, 1114112
    buffer_load_dwordx4 v7, s[8:11], s17 offen lds
    s_add_u32 m0, s19, 21504
    s_add_u32 s17, s20, 1130496
    buffer_load_dwordx4 v49, s[8:11], s17 offen lds
    s_add_u32 m0, s19, 22528
    s_add_u32 s17, s20, 1146880
    buffer_load_dwordx4 v7, s[8:11], s17 offen lds
    s_add_u32 m0, s19, 23552
    s_add_u32 s17, s20, 1163264
    buffer_load_dwordx4 v49, s[8:11], s17 offen lds
    ds_read_b64_tr_b16 a[104:105], v3 offset:24576
    ds_read_b64_tr_b16 a[106:107], v3 offset:25088
    ds_read_b64_tr_b16 a[108:109], v4 offset:24576
    ds_read_b64_tr_b16 a[110:111], v4 offset:25088
    s_waitcnt vmcnt(24)
    ds_read_b64_tr_b16 a[112:113], v8 offset:28672
    ds_read_b64_tr_b16 a[114:115], v8 offset:29184
    ds_read_b64_tr_b16 a[116:117], v2 offset:28672
    ds_read_b64_tr_b16 a[118:119], v2 offset:29184
    s_waitcnt lgkmcnt(4)
    s_add_u32 m0, s19, 24576
    s_add_u32 s17, s20, 1179648
    buffer_load_dwordx4 v7, s[8:11], s17 offen lds
    s_add_u32 m0, s19, 25600
    s_add_u32 s17, s20, 1196032
    buffer_load_dwordx4 v49, s[8:11], s17 offen lds
    s_add_u32 m0, s19, 26624
    s_add_u32 s17, s20, 1212416
    buffer_load_dwordx4 v7, s[8:11], s17 offen lds
    s_add_u32 m0, s19, 27648
    s_add_u32 s17, s20, 1228800
    buffer_load_dwordx4 v49, s[8:11], s17 offen lds
    ds_read_b64_tr_b16 a[120:121], v3 offset:28672
    ds_read_b64_tr_b16 a[122:123], v3 offset:29184
    ds_read_b64_tr_b16 a[124:125], v4 offset:28672
    ds_read_b64_tr_b16 a[126:127], v4 offset:29184
    s_waitcnt vmcnt(24)
    ds_read_b64_tr_b16 a[128:129], v8 offset:0
    ds_read_b64_tr_b16 a[130:131], v8 offset:512
    ds_read_b64_tr_b16 a[132:133], v2 offset:0
    ds_read_b64_tr_b16 a[134:135], v2 offset:512
    s_waitcnt lgkmcnt(4)
    s_add_u32 m0, s19, 28672
    s_add_u32 s17, s20, 1310720
    buffer_load_dwordx4 v7, s[8:11], s17 offen lds
    s_add_u32 m0, s19, 29696
    s_add_u32 s17, s20, 1327104
    buffer_load_dwordx4 v49, s[8:11], s17 offen lds
    s_add_u32 m0, s19, 30720
    s_add_u32 s17, s20, 1343488
    buffer_load_dwordx4 v7, s[8:11], s17 offen lds
    s_add_u32 m0, s19, 31744
    s_add_u32 s17, s20, 1359872
    buffer_load_dwordx4 v49, s[8:11], s17 offen lds
    ds_read_b64_tr_b16 a[136:137], v3 offset:0
    ds_read_b64_tr_b16 a[138:139], v3 offset:512
    ds_read_b64_tr_b16 a[140:141], v4 offset:0
    ds_read_b64_tr_b16 a[142:143], v4 offset:512
    s_waitcnt vmcnt(24)
    ds_read_b64_tr_b16 a[144:145], v8 offset:4096
    ds_read_b64_tr_b16 a[146:147], v8 offset:4608
    ds_read_b64_tr_b16 a[148:149], v2 offset:4096
    ds_read_b64_tr_b16 a[150:151], v2 offset:4608
    s_waitcnt lgkmcnt(4)
    s_add_u32 m0, s19, 0
    s_add_u32 s17, s20, 1376256
    buffer_load_dwordx4 v7, s[8:11], s17 offen lds
    s_add_u32 m0, s19, 1024
    s_add_u32 s17, s20, 1392640
    buffer_load_dwordx4 v49, s[8:11], s17 offen lds
    s_add_u32 m0, s19, 2048
    s_add_u32 s17, s20, 1409024
    buffer_load_dwordx4 v7, s[8:11], s17 offen lds
    s_add_u32 m0, s19, 3072
    s_add_u32 s17, s20, 1425408
    buffer_load_dwordx4 v49, s[8:11], s17 offen lds
    ds_read_b64_tr_b16 a[152:153], v3 offset:4096
    ds_read_b64_tr_b16 a[154:155], v3 offset:4608
    ds_read_b64_tr_b16 a[156:157], v4 offset:4096
    ds_read_b64_tr_b16 a[158:159], v4 offset:4608
    s_waitcnt vmcnt(24)
    ds_read_b64_tr_b16 a[160:161], v8 offset:8192
    ds_read_b64_tr_b16 a[162:163], v8 offset:8704
    ds_read_b64_tr_b16 a[164:165], v2 offset:8192
    ds_read_b64_tr_b16 a[166:167], v2 offset:8704
    s_waitcnt lgkmcnt(4)
    s_add_u32 m0, s19, 4096
    s_add_u32 s17, s20, 1441792
    buffer_load_dwordx4 v7, s[8:11], s17 offen lds
    s_add_u32 m0, s19, 5120
    s_add_u32 s17, s20, 1458176
    buffer_load_dwordx4 v49, s[8:11], s17 offen lds
    s_add_u32 m0, s19, 6144
    s_add_u32 s17, s20, 1474560
    buffer_load_dwordx4 v7, s[8:11], s17 offen lds
    s_add_u32 m0, s19, 7168
    s_add_u32 s17, s20, 1490944
    buffer_load_dwordx4 v49, s[8:11], s17 offen lds
    ds_read_b64_tr_b16 a[168:169], v3 offset:8192
    ds_read_b64_tr_b16 a[170:171], v3 offset:8704
    ds_read_b64_tr_b16 a[172:173], v4 offset:8192
    ds_read_b64_tr_b16 a[174:175], v4 offset:8704
    s_waitcnt vmcnt(24)
    ds_read_b64_tr_b16 a[176:177], v8 offset:12288
    ds_read_b64_tr_b16 a[178:179], v8 offset:12800
    ds_read_b64_tr_b16 a[180:181], v2 offset:12288
    ds_read_b64_tr_b16 a[182:183], v2 offset:12800
    s_waitcnt lgkmcnt(4)
    s_add_u32 m0, s19, 8192
    s_add_u32 s17, s20, 1572864
    buffer_load_dwordx4 v7, s[8:11], s17 offen lds
    s_add_u32 m0, s19, 9216
    s_add_u32 s17, s20, 1589248
    buffer_load_dwordx4 v49, s[8:11], s17 offen lds
    s_add_u32 m0, s19, 10240
    s_add_u32 s17, s20, 1605632
    buffer_load_dwordx4 v7, s[8:11], s17 offen lds
    s_add_u32 m0, s19, 11264
    s_add_u32 s17, s20, 1622016
    buffer_load_dwordx4 v49, s[8:11], s17 offen lds
    ds_read_b64_tr_b16 a[184:185], v3 offset:12288
    ds_read_b64_tr_b16 a[186:187], v3 offset:12800
    ds_read_b64_tr_b16 a[188:189], v4 offset:12288
    ds_read_b64_tr_b16 a[190:191], v4 offset:12800
    s_waitcnt vmcnt(24)
    ds_read_b64_tr_b16 a[192:193], v8 offset:16384
    ds_read_b64_tr_b16 a[194:195], v8 offset:16896
    ds_read_b64_tr_b16 a[196:197], v2 offset:16384
    ds_read_b64_tr_b16 a[198:199], v2 offset:16896
    s_waitcnt lgkmcnt(4)
    s_add_u32 m0, s19, 12288
    s_add_u32 s17, s20, 1638400
    buffer_load_dwordx4 v7, s[8:11], s17 offen lds
    s_add_u32 m0, s19, 13312
    s_add_u32 s17, s20, 1654784
    buffer_load_dwordx4 v49, s[8:11], s17 offen lds
    s_add_u32 m0, s19, 14336
    s_add_u32 s17, s20, 1671168
    buffer_load_dwordx4 v7, s[8:11], s17 offen lds
    s_add_u32 m0, s19, 15360
    s_add_u32 s17, s20, 1687552
    buffer_load_dwordx4 v49, s[8:11], s17 offen lds
    ds_read_b64_tr_b16 a[200:201], v3 offset:16384
    ds_read_b64_tr_b16 a[202:203], v3 offset:16896
    ds_read_b64_tr_b16 a[204:205], v4 offset:16384
    ds_read_b64_tr_b16 a[206:207], v4 offset:16896
    s_waitcnt vmcnt(24)
    ds_read_b64_tr_b16 a[208:209], v8 offset:20480
    ds_read_b64_tr_b16 a[210:211], v8 offset:20992
    ds_read_b64_tr_b16 a[212:213], v2 offset:20480
    ds_read_b64_tr_b16 a[214:215], v2 offset:20992
    s_waitcnt lgkmcnt(4)
    s_add_u32 m0, s19, 16384
    s_add_u32 s17, s20, 1703936
    buffer_load_dwordx4 v7, s[8:11], s17 offen lds
    s_add_u32 m0, s19, 17408
    s_add_u32 s17, s20, 1720320
    buffer_load_dwordx4 v49, s[8:11], s17 offen lds
    s_add_u32 m0, s19, 18432
    s_add_u32 s17, s20, 1736704
    buffer_load_dwordx4 v7, s[8:11], s17 offen lds
    s_add_u32 m0, s19, 19456
    s_add_u32 s17, s20, 1753088
    buffer_load_dwordx4 v49, s[8:11], s17 offen lds
    ds_read_b64_tr_b16 a[216:217], v3 offset:20480
    ds_read_b64_tr_b16 a[218:219], v3 offset:20992
    ds_read_b64_tr_b16 a[220:221], v4 offset:20480
    ds_read_b64_tr_b16 a[222:223], v4 offset:20992
    s_waitcnt vmcnt(24)
    ds_read_b64_tr_b16 a[224:225], v8 offset:24576
    ds_read_b64_tr_b16 a[226:227], v8 offset:25088
    ds_read_b64_tr_b16 a[228:229], v2 offset:24576
    ds_read_b64_tr_b16 a[230:231], v2 offset:25088
    s_waitcnt lgkmcnt(4)
    s_add_u32 m0, s19, 20480
    s_add_u32 s17, s20, 1835008
    buffer_load_dwordx4 v7, s[8:11], s17 offen lds
    s_add_u32 m0, s19, 21504
    s_add_u32 s17, s20, 1851392
    buffer_load_dwordx4 v49, s[8:11], s17 offen lds
    s_add_u32 m0, s19, 22528
    s_add_u32 s17, s20, 1867776
    buffer_load_dwordx4 v7, s[8:11], s17 offen lds
    s_add_u32 m0, s19, 23552
    s_add_u32 s17, s20, 1884160
    buffer_load_dwordx4 v49, s[8:11], s17 offen lds
    ds_read_b64_tr_b16 a[232:233], v3 offset:24576
    ds_read_b64_tr_b16 a[234:235], v3 offset:25088
    ds_read_b64_tr_b16 a[236:237], v4 offset:24576
    ds_read_b64_tr_b16 a[238:239], v4 offset:25088
    s_waitcnt vmcnt(24)
    ds_read_b64_tr_b16 a[240:241], v8 offset:28672
    ds_read_b64_tr_b16 a[242:243], v8 offset:29184
    ds_read_b64_tr_b16 a[244:245], v2 offset:28672
    ds_read_b64_tr_b16 a[246:247], v2 offset:29184
    s_waitcnt lgkmcnt(4)
    s_add_u32 m0, s19, 24576
    s_add_u32 s17, s20, 1900544
    buffer_load_dwordx4 v7, s[8:11], s17 offen lds
    s_add_u32 m0, s19, 25600
    s_add_u32 s17, s20, 1916928
    buffer_load_dwordx4 v49, s[8:11], s17 offen lds
    s_add_u32 m0, s19, 26624
    s_add_u32 s17, s20, 1933312
    buffer_load_dwordx4 v7, s[8:11], s17 offen lds
    s_add_u32 m0, s19, 27648
    s_add_u32 s17, s20, 1949696
    buffer_load_dwordx4 v49, s[8:11], s17 offen lds
    ds_read_b64_tr_b16 a[248:249], v3 offset:28672
    ds_read_b64_tr_b16 a[250:251], v3 offset:29184
    ds_read_b64_tr_b16 a[252:253], v4 offset:28672
    ds_read_b64_tr_b16 a[254:255], v4 offset:29184
    s_waitcnt vmcnt(24)
    ds_read_b64_tr_b16 v[128:129], v8 offset:0
    ds_read_b64_tr_b16 v[130:131], v8 offset:512
    ds_read_b64_tr_b16 v[132:133], v2 offset:0
    ds_read_b64_tr_b16 v[134:135], v2 offset:512
    s_waitcnt lgkmcnt(4)
    s_add_u32 m0, s19, 28672
    s_add_u32 s17, s20, 1966080
    buffer_load_dwordx4 v7, s[8:11], s17 offen lds
    s_add_u32 m0, s19, 29696
    s_add_u32 s17, s20, 1982464
    buffer_load_dwordx4 v49, s[8:11], s17 offen lds
    s_add_u32 m0, s19, 30720
    s_add_u32 s17, s20, 1998848
    buffer_load_dwordx4 v7, s[8:11], s17 offen lds
    s_add_u32 m0, s19, 31744
    s_add_u32 s17, s20, 2015232
    buffer_load_dwordx4 v49, s[8:11], s17 offen lds
    ds_read_b64_tr_b16 v[136:137], v3 offset:0
    ds_read_b64_tr_b16 v[138:139], v3 offset:512
    ds_read_b64_tr_b16 v[140:141], v4 offset:0
    ds_read_b64_tr_b16 v[142:143], v4 offset:512
    s_waitcnt vmcnt(24)
    ds_read_b64_tr_b16 v[144:145], v8 offset:4096
    ds_read_b64_tr_b16 v[146:147], v8 offset:4608
    ds_read_b64_tr_b16 v[148:149], v2 offset:4096
    ds_read_b64_tr_b16 v[150:151], v2 offset:4608
    s_waitcnt lgkmcnt(4)
    s_add_u32 m0, s19, 0
    s_add_u32 s17, s20, 196608
    buffer_load_dwordx4 v7, s[8:11], s17 offen lds
    s_add_u32 m0, s19, 1024
    s_add_u32 s17, s20, 212992
    buffer_load_dwordx4 v49, s[8:11], s17 offen lds
    s_add_u32 m0, s19, 2048
    s_add_u32 s17, s20, 229376
    buffer_load_dwordx4 v7, s[8:11], s17 offen lds
    s_add_u32 m0, s19, 3072
    s_add_u32 s17, s20, 245760
    buffer_load_dwordx4 v49, s[8:11], s17 offen lds
    ds_read_b64_tr_b16 v[152:153], v3 offset:4096
    ds_read_b64_tr_b16 v[154:155], v3 offset:4608
    ds_read_b64_tr_b16 v[156:157], v4 offset:4096
    ds_read_b64_tr_b16 v[158:159], v4 offset:4608
    s_waitcnt vmcnt(24)
    ds_read_b64_tr_b16 v[160:161], v8 offset:8192
    ds_read_b64_tr_b16 v[162:163], v8 offset:8704
    ds_read_b64_tr_b16 v[164:165], v2 offset:8192
    ds_read_b64_tr_b16 v[166:167], v2 offset:8704
    s_waitcnt lgkmcnt(4)
    s_add_u32 m0, s19, 4096
    s_add_u32 s17, s20, 458752
    buffer_load_dwordx4 v7, s[8:11], s17 offen lds
    s_add_u32 m0, s19, 5120
    s_add_u32 s17, s20, 475136
    buffer_load_dwordx4 v49, s[8:11], s17 offen lds
    s_add_u32 m0, s19, 6144
    s_add_u32 s17, s20, 491520
    buffer_load_dwordx4 v7, s[8:11], s17 offen lds
    s_add_u32 m0, s19, 7168
    s_add_u32 s17, s20, 507904
    buffer_load_dwordx4 v49, s[8:11], s17 offen lds
    ds_read_b64_tr_b16 v[168:169], v3 offset:8192
    ds_read_b64_tr_b16 v[170:171], v3 offset:8704
    ds_read_b64_tr_b16 v[172:173], v4 offset:8192
    ds_read_b64_tr_b16 v[174:175], v4 offset:8704
    s_waitcnt vmcnt(24)
    ds_read_b64_tr_b16 v[176:177], v8 offset:12288
    ds_read_b64_tr_b16 v[178:179], v8 offset:12800
    ds_read_b64_tr_b16 v[180:181], v2 offset:12288
    ds_read_b64_tr_b16 v[182:183], v2 offset:12800
    s_waitcnt lgkmcnt(4)
    s_add_u32 m0, s19, 8192
    s_add_u32 s17, s20, 720896
    buffer_load_dwordx4 v7, s[8:11], s17 offen lds
    s_add_u32 m0, s19, 9216
    s_add_u32 s17, s20, 737280
    buffer_load_dwordx4 v49, s[8:11], s17 offen lds
    s_add_u32 m0, s19, 10240
    s_add_u32 s17, s20, 753664
    buffer_load_dwordx4 v7, s[8:11], s17 offen lds
    s_add_u32 m0, s19, 11264
    s_add_u32 s17, s20, 770048
    buffer_load_dwordx4 v49, s[8:11], s17 offen lds
    ds_read_b64_tr_b16 v[184:185], v3 offset:12288
    ds_read_b64_tr_b16 v[186:187], v3 offset:12800
    ds_read_b64_tr_b16 v[188:189], v4 offset:12288
    ds_read_b64_tr_b16 v[190:191], v4 offset:12800
    s_waitcnt vmcnt(24)
    ds_read_b64_tr_b16 v[192:193], v8 offset:16384
    ds_read_b64_tr_b16 v[194:195], v8 offset:16896
    ds_read_b64_tr_b16 v[196:197], v2 offset:16384
    ds_read_b64_tr_b16 v[198:199], v2 offset:16896
    s_waitcnt lgkmcnt(4)
    s_add_u32 m0, s19, 12288
    s_add_u32 s17, s20, 983040
    buffer_load_dwordx4 v7, s[8:11], s17 offen lds
    s_add_u32 m0, s19, 13312
    s_add_u32 s17, s20, 999424
    buffer_load_dwordx4 v49, s[8:11], s17 offen lds
    s_add_u32 m0, s19, 14336
    s_add_u32 s17, s20, 1015808
    buffer_load_dwordx4 v7, s[8:11], s17 offen lds
    s_add_u32 m0, s19, 15360
    s_add_u32 s17, s20, 1032192
    buffer_load_dwordx4 v49, s[8:11], s17 offen lds
    ds_read_b64_tr_b16 v[200:201], v3 offset:16384
    ds_read_b64_tr_b16 v[202:203], v3 offset:16896
    ds_read_b64_tr_b16 v[204:205], v4 offset:16384
    ds_read_b64_tr_b16 v[206:207], v4 offset:16896
    s_waitcnt vmcnt(24)
    ds_read_b64_tr_b16 v[208:209], v8 offset:20480
    ds_read_b64_tr_b16 v[210:211], v8 offset:20992
    ds_read_b64_tr_b16 v[212:213], v2 offset:20480
    ds_read_b64_tr_b16 v[214:215], v2 offset:20992
    s_waitcnt lgkmcnt(4)
    s_add_u32 m0, s19, 16384
    s_add_u32 s17, s20, 1245184
    buffer_load_dwordx4 v7, s[8:11], s17 offen lds
    s_add_u32 m0, s19, 17408
    s_add_u32 s17, s20, 1261568
    buffer_load_dwordx4 v49, s[8:11], s17 offen lds
    s_add_u32 m0, s19, 18432
    s_add_u32 s17, s20, 1277952
    buffer_load_dwordx4 v7, s[8:11], s17 offen lds
    s_add_u32 m0, s19, 19456
    s_add_u32 s17, s20, 1294336
    buffer_load_dwordx4 v49, s[8:11], s17 offen lds
    ds_read_b64_tr_b16 v[216:217], v3 offset:20480
    ds_read_b64_tr_b16 v[218:219], v3 offset:20992
    ds_read_b64_tr_b16 v[220:221], v4 offset:20480
    ds_read_b64_tr_b16 v[222:223], v4 offset:20992
    s_waitcnt vmcnt(24)
    ds_read_b64_tr_b16 v[224:225], v8 offset:24576
    ds_read_b64_tr_b16 v[226:227], v8 offset:25088
    ds_read_b64_tr_b16 v[228:229], v2 offset:24576
    ds_read_b64_tr_b16 v[230:231], v2 offset:25088
    s_waitcnt lgkmcnt(4)
    s_add_u32 m0, s19, 20480
    s_add_u32 s17, s20, 1507328
    buffer_load_dwordx4 v7, s[8:11], s17 offen lds
    s_add_u32 m0, s19, 21504
    s_add_u32 s17, s20, 1523712
    buffer_load_dwordx4 v49, s[8:11], s17 offen lds
    s_add_u32 m0, s19, 22528
    s_add_u32 s17, s20, 1540096
    buffer_load_dwordx4 v7, s[8:11], s17 offen lds
    s_add_u32 m0, s19, 23552
    s_add_u32 s17, s20, 1556480
    buffer_load_dwordx4 v49, s[8:11], s17 offen lds
    ds_read_b64_tr_b16 v[232:233], v3 offset:24576
    ds_read_b64_tr_b16 v[234:235], v3 offset:25088
    ds_read_b64_tr_b16 v[236:237], v4 offset:24576
    ds_read_b64_tr_b16 v[238:239], v4 offset:25088
    s_waitcnt vmcnt(24)
    ds_read_b64_tr_b16 v[240:241], v8 offset:28672
    ds_read_b64_tr_b16 v[242:243], v8 offset:29184
    ds_read_b64_tr_b16 v[244:245], v2 offset:28672
    ds_read_b64_tr_b16 v[246:247], v2 offset:29184
    s_waitcnt lgkmcnt(4)
    s_add_u32 m0, s19, 24576
    s_add_u32 s17, s20, 1769472
    buffer_load_dwordx4 v7, s[8:11], s17 offen lds
    s_add_u32 m0, s19, 25600
    s_add_u32 s17, s20, 1785856
    buffer_load_dwordx4 v49, s[8:11], s17 offen lds
    s_add_u32 m0, s19, 26624
    s_add_u32 s17, s20, 1802240
    buffer_load_dwordx4 v7, s[8:11], s17 offen lds
    s_add_u32 m0, s19, 27648
    s_add_u32 s17, s20, 1818624
    buffer_load_dwordx4 v49, s[8:11], s17 offen lds
    ds_read_b64_tr_b16 v[248:249], v3 offset:28672
    ds_read_b64_tr_b16 v[250:251], v3 offset:29184
    ds_read_b64_tr_b16 v[252:253], v4 offset:28672
    ds_read_b64_tr_b16 v[254:255], v4 offset:29184
    s_waitcnt lgkmcnt(0)
    s_add_u32 m0, s19, 28672
    s_add_u32 s17, s20, 2031616
    buffer_load_dwordx4 v7, s[8:11], s17 offen lds
    s_add_u32 m0, s19, 29696
    s_add_u32 s17, s20, 2048000
    buffer_load_dwordx4 v49, s[8:11], s17 offen lds
    s_add_u32 m0, s19, 30720
    s_add_u32 s17, s20, 2064384
    buffer_load_dwordx4 v7, s[8:11], s17 offen lds
    s_add_u32 m0, s19, 31744
    s_add_u32 s17, s20, 2080768
    buffer_load_dwordx4 v49, s[8:11], s17 offen lds
    s_lshr_b32 s37, s37, 6
    s_add_u32 s37, s37, 54525952
    v_lshlrev_b32 v15, 4, v1
    v_add_u32 v10, s19, v15
    s_lshl_b32 s17, s16, 10
    s_add_u32 s17, s17, 131072
    v_add_u32 v14, s17, v15
    s_lshl_b32 s17, s16, 12
    s_add_u32 s18, s17, 147456
    v_add_u32 v15, s18, v15
    v_bfe_u32 v11, v1, 3, 2
    v_and_b32 v5, 7, v1
    v_lshlrev_b32 v5, 9, v5
    v_lshl_add_u32 v11, v11, 7, v5
    s_add_u32 s17, s17, 100728832
    v_add_u32 v11, s17, v11
    v_mov_b32 v12, 0
    v_and_b32 v13, 15, v1
    v_lshrrev_b32 v5, 4, v1
    v_lshlrev_b32 v5, 3, v5
    v_lshl_add_u32 v13, v13, 12, v5
    s_lshl_b32 s17, s35, 7
    s_lshl_b32 s18, s16, 5
    s_add_u32 s17, s17, s18
    s_add_u32 s17, s17, 2048
    v_add_u32 v13, s17, v13
    s_waitcnt vmcnt(0)
    s_mov_b32 s36, 0
U_wait:
    s_mov_b32 s29, s92
U_fl:
    s_lshr_b32 s17, s28, 3
    v_cmp_ge_u32 vcc, s17, v12
    s_lshl_b32 s18, s28, 2
    s_and_b32 s18, s18, 24
    s_lshr_b32 s17, vcc_lo, s18
    s_and_b32 s17, s17, 0xff
    s_cbranch_scc0 U_go
    s_cmp_ge_u32 s29, 1048576
    s_cselect_b32 s92, 1048576, s92
    s_cbranch_scc1 U_go
    s_lshl_b32 s17, s17, s18
    s_cmp_eq_u32 s29, 0
    s_cselect_b32 exec_lo, -1, s17
    s_mov_b32 exec_hi, 0
    s_add_u32 s29, s29, 1
    buffer_load_dword v12, v11, s[4:7], 0 offen sc1
    s_mov_b64 exec, -1
    s_sleep 2
    s_waitcnt vmcnt(0)
    s_branch U_fl
U_go:
    s_lshl_b32 s30, s28, 17
    s_add_u32 s30, s30, s37
    buffer_load_dwordx4 v[64:67], v10, s[4:7], s30 offen offset:0
    buffer_load_dwordx4 v[68:71], v10, s[4:7], s30 offen offset:1024
    buffer_load_dwordx4 v[72:75], v10, s[4:7], s30 offen offset:2048
    buffer_load_dwordx4 v[76:79], v10, s[4:7], s30 offen offset:3072
    s_add_u32 s30, s30, 4096
    s_bitset0_b32 s30, 15
    buffer_load_dwordx4 v[80:83], v10, s[4:7], s30 offen offset:0
    buffer_load_dwordx4 v[84:87], v10, s[4:7], s30 offen offset:1024
    buffer_load_dwordx4 v[88:91], v10, s[4:7], s30 offen offset:2048
    buffer_load_dwordx4 v[92:95], v10, s[4:7], s30 offen offset:3072
    s_add_u32 s30, s30, 4096
    s_bitset0_b32 s30, 15
    buffer_load_dwordx4 v[96:99], v10, s[4:7], s30 offen offset:0
    buffer_load_dwordx4 v[100:103], v10, s[4:7], s30 offen offset:1024
    buffer_load_dwordx4 v[104:107], v10, s[4:7], s30 offen offset:2048
    buffer_load_dwordx4 v[108:111], v10, s[4:7], s30 offen offset:3072
    s_add_u32 s30, s30, 4096
    s_bitset0_b32 s30, 15
    buffer_load_dwordx4 v[112:115], v10, s[4:7], s30 offen offset:0
    buffer_load_dwordx4 v[116:119], v10, s[4:7], s30 offen offset:1024
    buffer_load_dwordx4 v[120:123], v10, s[4:7], s30 offen offset:2048
    s_mov_b32 s34, 0
    s_mov_b32 s31, 1073741824
    ds_read_b128 v[48:51], v15 offset:0
    ds_read_b128 v[52:55], v15 offset:1024
    ds_read_b128 v[56:59], v15 offset:2048
    ds_read_b128 v[60:63], v15 offset:3072
.p2align 6
U_item:
    s_waitcnt vmcnt(14)
    v_mfma_f32_16x16x32_bf16 v[16:19], a[0:3], v[64:67], 0
    buffer_load_dwordx4 v[124:127], v10, s[4:7], s30 offen offset:3072
    v_mfma_f32_16x16x32_bf16 v[20:23], a[4:7], v[64:67], 0
    s_add_u32 s33, s28, 6
    s_lshr_b32 s17, s33, 3
    v_cmp_ge_u32 vcc, s17, v12
    s_lshl_b32 s18, s33, 2
    s_and_b32 s18, s18, 24
    ds_read_b64_tr_b16 v[32:33], v8 offset:0
    v_mfma_f32_16x16x32_bf16 v[24:27], a[8:11], v[64:67], 0
    s_lshr_b32 s17, vcc_lo, s18
    s_and_b32 s17, s17, 0xff
    s_lshl_b32 exec_lo, s17, s18
    s_mov_b32 exec_hi, 0
    buffer_load_dword v12, v11, s[4:7], 0 offen sc1
    s_mov_b64 exec, -1
    ds_read_b64_tr_b16 v[34:35], v8 offset:512
    v_mfma_f32_16x16x32_bf16 v[28:31], a[12:15], v[64:67], 0
    ds_read_b64_tr_b16 v[36:37], v2 offset:0
    ds_read_b64_tr_b16 v[38:39], v2 offset:512
    s_waitcnt vmcnt(15)
    v_mfma_f32_16x16x32_bf16 v[16:19], a[16:19], v[68:71], v[16:19]
    s_add_u32 s30, s30, 4096
    s_bitset0_b32 s30, 15
    buffer_load_dwordx4 v[64:67], v10, s[4:7], s30 offen offset:0
    v_mfma_f32_16x16x32_bf16 v[20:23], a[20:23], v[68:71], v[20:23]
    ds_read_b64_tr_b16 v[40:41], v3 offset:0
    v_mfma_f32_16x16x32_bf16 v[24:27], a[24:27], v[68:71], v[24:27]
    ds_read_b64_tr_b16 v[42:43], v3 offset:512
    v_mfma_f32_16x16x32_bf16 v[28:31], a[28:31], v[68:71], v[28:31]
    ds_read_b64_tr_b16 v[44:45], v4 offset:0
    ds_read_b64_tr_b16 v[46:47], v4 offset:512
    s_waitcnt vmcnt(15)
    v_mfma_f32_16x16x32_bf16 v[16:19], a[32:35], v[72:75], v[16:19]
    buffer_load_dwordx4 v[68:71], v10, s[4:7], s30 offen offset:1024
    v_mfma_f32_16x16x32_bf16 v[20:23], a[36:39], v[72:75], v[20:23]
    s_waitcnt lgkmcnt(8)
    s_cmp_eq_u32 s34, 0
    s_cbranch_scc1 U_nb
    s_barrier
U_nb:
    v_mfma_f32_16x16x32_bf16 v[24:27], a[40:43], v[72:75], v[24:27]
    ds_read_b128 v[48:51], v15 offset:0
    ds_read_b128 v[52:55], v15 offset:1024
    v_mfma_f32_16x16x32_bf16 v[28:31], a[44:47], v[72:75], v[28:31]
    ds_read_b128 v[56:59], v15 offset:2048
    ds_read_b128 v[60:63], v15 offset:3072
    s_waitcnt vmcnt(15)
    s_waitcnt lgkmcnt(4)
    v_mfma_f32_16x16x32_bf16 v[16:19], v[32:35], v[76:79], v[16:19]
    buffer_load_dwordx4 v[72:75], v10, s[4:7], s30 offen offset:2048
    v_mfma_f32_16x16x32_bf16 v[20:23], v[36:39], v[76:79], v[20:23]
    v_mfma_f32_16x16x32_bf16 v[24:27], v[40:43], v[76:79], v[24:27]
    v_mfma_f32_16x16x32_bf16 v[28:31], v[44:47], v[76:79], v[28:31]
    s_waitcnt vmcnt(15)
    v_mfma_f32_16x16x32_bf16 v[16:19], a[48:51], v[80:83], v[16:19]
    buffer_load_dwordx4 v[76:79], v10, s[4:7], s30 offen offset:3072
    s_waitcnt lgkmcnt(0)
    v_mfma_f32_16x16x32_bf16 v[20:23], a[52:55], v[80:83], v[20:23]
    v_add_f32 v48, v48, v52
    v_add_f32 v49, v49, v53
    ds_read_b64_tr_b16 v[32:33], v8 offset:4096
    v_mfma_f32_16x16x32_bf16 v[24:27], a[56:59], v[80:83], v[24:27]
    v_add_f32 v50, v50, v54
    v_add_f32 v51, v51, v55
    ds_read_b64_tr_b16 v[34:35], v8 offset:4608
    v_mfma_f32_16x16x32_bf16 v[28:31], a[60:63], v[80:83], v[28:31]
    ds_read_b64_tr_b16 v[36:37], v2 offset:4096
    ds_read_b64_tr_b16 v[38:39], v2 offset:4608
    s_waitcnt vmcnt(15)
    v_mfma_f32_16x16x32_bf16 v[16:19], a[64:67], v[84:87], v[16:19]
    s_add_u32 s30, s30, 4096
    s_bitset0_b32 s30, 15
    buffer_load_dwordx4 v[80:83], v10, s[4:7], s30 offen offset:0
    v_mfma_f32_16x16x32_bf16 v[20:23], a[68:71], v[84:87], v[20:23]
    v_add_f32 v56, v56, v60
    v_add_f32 v57, v57, v61
    ds_read_b64_tr_b16 v[40:41], v3 offset:4096
    v_mfma_f32_16x16x32_bf16 v[24:27], a[72:75], v[84:87], v[24:27]
    v_add_f32 v58, v58, v62
    v_add_f32 v59, v59, v63
    ds_read_b64_tr_b16 v[42:43], v3 offset:4608
    v_mfma_f32_16x16x32_bf16 v[28:31], a[76:79], v[84:87], v[28:31]
    ds_read_b64_tr_b16 v[44:45], v4 offset:4096
    ds_read_b64_tr_b16 v[46:47], v4 offset:4608
    s_waitcnt vmcnt(15)
    v_mfma_f32_16x16x32_bf16 v[16:19], a[80:83], v[88:91], v[16:19]
    buffer_load_dwordx4 v[84:87], v10, s[4:7], s30 offen offset:1024
    v_mfma_f32_16x16x32_bf16 v[20:23], a[84:87], v[88:91], v[20:23]
    v_add_f32 v48, v48, v56
    v_add_f32 v49, v49, v57
    v_mfma_f32_16x16x32_bf16 v[24:27], a[88:91], v[88:91], v[24:27]
    v_add_f32 v50, v50, v58
    v_add_f32 v51, v51, v59
    v_mfma_f32_16x16x32_bf16 v[28:31], a[92:95], v[88:91], v[28:31]
    s_waitcnt vmcnt(15)
    s_waitcnt lgkmcnt(0)
    v_mfma_f32_16x16x32_bf16 v[16:19], v[32:35], v[92:95], v[16:19]
    buffer_load_dwordx4 v[88:91], v10, s[4:7], s30 offen offset:2048
    v_mfma_f32_16x16x32_bf16 v[20:23], v[36:39], v[92:95], v[20:23]
    v_cvt_pk_bf16_f32 v52, v48, v49
    v_cvt_pk_bf16_f32 v53, v50, v51
    v_mfma_f32_16x16x32_bf16 v[24:27], v[40:43], v[92:95], v[24:27]
    v_mfma_f32_16x16x32_bf16 v[28:31], v[44:47], v[92:95], v[28:31]
    s_waitcnt vmcnt(15)
    v_mfma_f32_16x16x32_bf16 v[16:19], a[96:99], v[96:99], v[16:19]
    buffer_load_dwordx4 v[92:95], v10, s[4:7], s30 offen offset:3072
    v_mfma_f32_16x16x32_bf16 v[20:23], a[100:103], v[96:99], v[20:23]
    buffer_store_dwordx2 v[52:53], v13, s[12:15], s31 offen
    v_xor_b32 v15, 0x4000, v15
    ds_read_b64_tr_b16 v[32:33], v8 offset:8192
    v_mfma_f32_16x16x32_bf16 v[24:27], a[104:107], v[96:99], v[24:27]
    ds_read_b64_tr_b16 v[34:35], v8 offset:8704
    v_mfma_f32_16x16x32_bf16 v[28:31], a[108:111], v[96:99], v[28:31]
    ds_read_b64_tr_b16 v[36:37], v2 offset:8192
    ds_read_b64_tr_b16 v[38:39], v2 offset:8704
    s_waitcnt vmcnt(16)
    v_mfma_f32_16x16x32_bf16 v[16:19], a[112:115], v[100:103], v[16:19]
    s_add_u32 s30, s30, 4096
    s_bitset0_b32 s30, 15
    buffer_load_dwordx4 v[96:99], v10, s[4:7], s30 offen offset:0
    v_mfma_f32_16x16x32_bf16 v[20:23], a[116:119], v[100:103], v[20:23]
    ds_read_b64_tr_b16 v[40:41], v3 offset:8192
    v_mfma_f32_16x16x32_bf16 v[24:27], a[120:123], v[100:103], v[24:27]
    ds_read_b64_tr_b16 v[42:43], v3 offset:8704
    v_mfma_f32_16x16x32_bf16 v[28:31], a[124:127], v[100:103], v[28:31]
    ds_read_b64_tr_b16 v[44:45], v4 offset:8192
    ds_read_b64_tr_b16 v[46:47], v4 offset:8704
    s_waitcnt vmcnt(16)
    v_mfma_f32_16x16x32_bf16 v[16:19], a[128:131], v[104:107], v[16:19]
    buffer_load_dwordx4 v[100:103], v10, s[4:7], s30 offen offset:1024
    v_mfma_f32_16x16x32_bf16 v[20:23], a[132:135], v[104:107], v[20:23]
    v_mfma_f32_16x16x32_bf16 v[24:27], a[136:139], v[104:107], v[24:27]
    v_mfma_f32_16x16x32_bf16 v[28:31], a[140:143], v[104:107], v[28:31]
    s_waitcnt vmcnt(16)
    s_waitcnt lgkmcnt(0)
    v_mfma_f32_16x16x32_bf16 v[16:19], v[32:35], v[108:111], v[16:19]
    buffer_load_dwordx4 v[104:107], v10, s[4:7], s30 offen offset:2048
    v_mfma_f32_16x16x32_bf16 v[20:23], v[36:39], v[108:111], v[20:23]
    v_mfma_f32_16x16x32_bf16 v[24:27], v[40:43], v[108:111], v[24:27]
    v_mfma_f32_16x16x32_bf16 v[28:31], v[44:47], v[108:111], v[28:31]
    s_waitcnt vmcnt(16)
    v_mfma_f32_16x16x32_bf16 v[16:19], a[144:147], v[112:115], v[16:19]
    buffer_load_dwordx4 v[108:111], v10, s[4:7], s30 offen offset:3072
    v_mfma_f32_16x16x32_bf16 v[20:23], a[148:151], v[112:115], v[20:23]
    ds_read_b64_tr_b16 v[32:33], v8 offset:12288
    v_mfma_f32_16x16x32_bf16 v[24:27], a[152:155], v[112:115], v[24:27]
    ds_read_b64_tr_b16 v[34:35], v8 offset:12800
    v_mfma_f32_16x16x32_bf16 v[28:31], a[156:159], v[112:115], v[28:31]
    ds_read_b64_tr_b16 v[36:37], v2 offset:12288
    ds_read_b64_tr_b16 v[38:39], v2 offset:12800
    s_waitcnt vmcnt(16)
    v_mfma_f32_16x16x32_bf16 v[16:19], a[160:163], v[116:119], v[16:19]
    s_add_u32 s30, s30, 4096
    s_bitset0_b32 s30, 15
    buffer_load_dwordx4 v[112:115], v10, s[4:7], s30 offen offset:0
    v_mfma_f32_16x16x32_bf16 v[20:23], a[164:167], v[116:119], v[20:23]
    ds_read_b64_tr_b16 v[40:41], v3 offset:12288
    v_mfma_f32_16x16x32_bf16 v[24:27], a[168:171], v[116:119], v[24:27]
    ds_read_b64_tr_b16 v[42:43], v3 offset:12800
    v_mfma_f32_16x16x32_bf16 v[28:31], a[172:175], v[116:119], v[28:31]
    ds_read_b64_tr_b16 v[44:45], v4 offset:12288
    ds_read_b64_tr_b16 v[46:47], v4 offset:12800
    s_waitcnt vmcnt(16)
    v_mfma_f32_16x16x32_bf16 v[16:19], a[176:179], v[120:123], v[16:19]
    buffer_load_dwordx4 v[116:119], v10, s[4:7], s30 offen offset:1024
    v_mfma_f32_16x16x32_bf16 v[20:23], a[180:183], v[120:123], v[20:23]
    v_mfma_f32_16x16x32_bf16 v[24:27], a[184:187], v[120:123], v[24:27]
    v_mfma_f32_16x16x32_bf16 v[28:31], a[188:191], v[120:123], v[28:31]
    s_waitcnt vmcnt(16)
    s_waitcnt lgkmcnt(0)
    v_mfma_f32_16x16x32_bf16 v[16:19], v[32:35], v[124:127], v[16:19]
    buffer_load_dwordx4 v[120:123], v10, s[4:7], s30 offen offset:2048
    v_mfma_f32_16x16x32_bf16 v[20:23], v[36:39], v[124:127], v[20:23]
    v_mfma_f32_16x16x32_bf16 v[24:27], v[40:43], v[124:127], v[24:27]
    v_mfma_f32_16x16x32_bf16 v[28:31], v[44:47], v[124:127], v[28:31]
    s_waitcnt vmcnt(15)
    v_mfma_f32_16x16x32_bf16 v[16:19], a[192:195], v[64:67], v[16:19]
    buffer_load_dwordx4 v[124:127], v10, s[4:7], s30 offen offset:3072
    v_mfma_f32_16x16x32_bf16 v[20:23], a[196:199], v[64:67], v[20:23]
    s_lshr_b32 s17, s33, 3
    v_cmp_ge_u32 vcc, s17, v12
    s_lshl_b32 s18, s33, 2
    s_and_b32 s18, s18, 24
    ds_read_b64_tr_b16 v[32:33], v8 offset:16384
    v_mfma_f32_16x16x32_bf16 v[24:27], a[200:203], v[64:67], v[24:27]
    s_lshl_b32 s30, s33, 17
    s_add_u32 s30, s30, s37
    s_lshr_b32 s17, vcc_lo, s18
    s_and_b32 s17, s17, 0xff
    s_cselect_b32 s34, 0, 1
    s_cselect_b32 s30, 1073741824, s30
    ds_read_b64_tr_b16 v[34:35], v8 offset:16896
    v_mfma_f32_16x16x32_bf16 v[28:31], a[204:207], v[64:67], v[28:31]
    ds_read_b64_tr_b16 v[36:37], v2 offset:16384
    ds_read_b64_tr_b16 v[38:39], v2 offset:16896
    s_waitcnt vmcnt(15)
    v_mfma_f32_16x16x32_bf16 v[16:19], a[208:211], v[68:71], v[16:19]
    buffer_load_dwordx4 v[64:67], v10, s[4:7], s30 offen offset:0
    v_mfma_f32_16x16x32_bf16 v[20:23], a[212:215], v[68:71], v[20:23]
    ds_read_b64_tr_b16 v[40:41], v3 offset:16384
    v_mfma_f32_16x16x32_bf16 v[24:27], a[216:219], v[68:71], v[24:27]
    ds_read_b64_tr_b16 v[42:43], v3 offset:16896
    v_mfma_f32_16x16x32_bf16 v[28:31], a[220:223], v[68:71], v[28:31]
    ds_read_b64_tr_b16 v[44:45], v4 offset:16384
    ds_read_b64_tr_b16 v[46:47], v4 offset:16896
    s_waitcnt vmcnt(15)
    v_mfma_f32_16x16x32_bf16 v[16:19], a[224:227], v[72:75], v[16:19]
    buffer_load_dwordx4 v[68:71], v10, s[4:7], s30 offen offset:1024
    v_mfma_f32_16x16x32_bf16 v[20:23], a[228:231], v[72:75], v[20:23]
    v_mfma_f32_16x16x32_bf16 v[24:27], a[232:235], v[72:75], v[24:27]
    v_mfma_f32_16x16x32_bf16 v[28:31], a[236:239], v[72:75], v[28:31]
    s_waitcnt vmcnt(15)
    s_waitcnt lgkmcnt(0)
    v_mfma_f32_16x16x32_bf16 v[16:19], v[32:35], v[76:79], v[16:19]
    buffer_load_dwordx4 v[72:75], v10, s[4:7], s30 offen offset:2048
    v_mfma_f32_16x16x32_bf16 v[20:23], v[36:39], v[76:79], v[20:23]
    v_mfma_f32_16x16x32_bf16 v[24:27], v[40:43], v[76:79], v[24:27]
    v_mfma_f32_16x16x32_bf16 v[28:31], v[44:47], v[76:79], v[28:31]
    s_waitcnt vmcnt(15)
    v_mfma_f32_16x16x32_bf16 v[16:19], a[240:243], v[80:83], v[16:19]
    buffer_load_dwordx4 v[76:79], v10, s[4:7], s30 offen offset:3072
    v_mfma_f32_16x16x32_bf16 v[20:23], a[244:247], v[80:83], v[20:23]
    ds_read_b64_tr_b16 v[32:33], v8 offset:20480
    v_mfma_f32_16x16x32_bf16 v[24:27], a[248:251], v[80:83], v[24:27]
    ds_read_b64_tr_b16 v[34:35], v8 offset:20992
    v_mfma_f32_16x16x32_bf16 v[28:31], a[252:255], v[80:83], v[28:31]
    ds_read_b64_tr_b16 v[36:37], v2 offset:20480
    ds_read_b64_tr_b16 v[38:39], v2 offset:20992
    s_waitcnt vmcnt(15)
    v_mfma_f32_16x16x32_bf16 v[16:19], v[128:131], v[84:87], v[16:19]
    s_add_u32 s30, s30, 4096
    s_bitset0_b32 s30, 15
    buffer_load_dwordx4 v[80:83], v10, s[4:7], s30 offen offset:0
    v_mfma_f32_16x16x32_bf16 v[20:23], v[132:135], v[84:87], v[20:23]
    ds_read_b64_tr_b16 v[40:41], v3 offset:20480
    v_mfma_f32_16x16x32_bf16 v[24:27], v[136:139], v[84:87], v[24:27]
    ds_read_b64_tr_b16 v[42:43], v3 offset:20992
    v_mfma_f32_16x16x32_bf16 v[28:31], v[140:143], v[84:87], v[28:31]
    ds_read_b64_tr_b16 v[44:45], v4 offset:20480
    ds_read_b64_tr_b16 v[46:47], v4 offset:20992
    s_waitcnt vmcnt(15)
    v_mfma_f32_16x16x32_bf16 v[16:19], v[144:147], v[88:91], v[16:19]
    buffer_load_dwordx4 v[84:87], v10, s[4:7], s30 offen offset:1024
    v_mfma_f32_16x16x32_bf16 v[20:23], v[148:151], v[88:91], v[20:23]
    v_mfma_f32_16x16x32_bf16 v[24:27], v[152:155], v[88:91], v[24:27]
    v_mfma_f32_16x16x32_bf16 v[28:31], v[156:159], v[88:91], v[28:31]
    s_waitcnt vmcnt(15)
    s_waitcnt lgkmcnt(0)
    v_mfma_f32_16x16x32_bf16 v[16:19], v[32:35], v[92:95], v[16:19]
    buffer_load_dwordx4 v[88:91], v10, s[4:7], s30 offen offset:2048
    v_mfma_f32_16x16x32_bf16 v[20:23], v[36:39], v[92:95], v[20:23]
    v_mfma_f32_16x16x32_bf16 v[24:27], v[40:43], v[92:95], v[24:27]
    v_mfma_f32_16x16x32_bf16 v[28:31], v[44:47], v[92:95], v[28:31]
    s_waitcnt vmcnt(14)
    v_mfma_f32_16x16x32_bf16 v[16:19], v[160:163], v[96:99], v[16:19]
    buffer_load_dwordx4 v[92:95], v10, s[4:7], s30 offen offset:3072
    v_mfma_f32_16x16x32_bf16 v[20:23], v[164:167], v[96:99], v[20:23]
    ds_read_b64_tr_b16 v[32:33], v8 offset:24576
    v_mfma_f32_16x16x32_bf16 v[24:27], v[168:171], v[96:99], v[24:27]
    ds_read_b64_tr_b16 v[34:35], v8 offset:25088
    v_mfma_f32_16x16x32_bf16 v[28:31], v[172:175], v[96:99], v[28:31]
    ds_read_b64_tr_b16 v[36:37], v2 offset:24576
    ds_read_b64_tr_b16 v[38:39], v2 offset:25088
    s_waitcnt vmcnt(14)
    v_mfma_f32_16x16x32_bf16 v[16:19], v[176:179], v[100:103], v[16:19]
    s_add_u32 s30, s30, 4096
    s_bitset0_b32 s30, 15
    buffer_load_dwordx4 v[96:99], v10, s[4:7], s30 offen offset:0
    v_mfma_f32_16x16x32_bf16 v[20:23], v[180:183], v[100:103], v[20:23]
    ds_read_b64_tr_b16 v[40:41], v3 offset:24576
    v_mfma_f32_16x16x32_bf16 v[24:27], v[184:187], v[100:103], v[24:27]
    ds_read_b64_tr_b16 v[42:43], v3 offset:25088
    v_mfma_f32_16x16x32_bf16 v[28:31], v[188:191], v[100:103], v[28:31]
    ds_read_b64_tr_b16 v[44:45], v4 offset:24576
    ds_read_b64_tr_b16 v[46:47], v4 offset:25088
    s_waitcnt vmcnt(14)
    v_mfma_f32_16x16x32_bf16 v[16:19], v[192:195], v[104:107], v[16:19]
    buffer_load_dwordx4 v[100:103], v10, s[4:7], s30 offen offset:1024
    v_mfma_f32_16x16x32_bf16 v[20:23], v[196:199], v[104:107], v[20:23]
    v_mfma_f32_16x16x32_bf16 v[24:27], v[200:203], v[104:107], v[24:27]
    v_mfma_f32_16x16x32_bf16 v[28:31], v[204:207], v[104:107], v[28:31]
    s_waitcnt vmcnt(14)
    s_waitcnt lgkmcnt(0)
    v_mfma_f32_16x16x32_bf16 v[16:19], v[32:35], v[108:111], v[16:19]
    buffer_load_dwordx4 v[104:107], v10, s[4:7], s30 offen offset:2048
    v_mfma_f32_16x16x32_bf16 v[20:23], v[36:39], v[108:111], v[20:23]
    v_mfma_f32_16x16x32_bf16 v[24:27], v[40:43], v[108:111], v[24:27]
    v_mfma_f32_16x16x32_bf16 v[28:31], v[44:47], v[108:111], v[28:31]
    s_waitcnt vmcnt(14)
    v_mfma_f32_16x16x32_bf16 v[16:19], v[208:211], v[112:115], v[16:19]
    buffer_load_dwordx4 v[108:111], v10, s[4:7], s30 offen offset:3072
    v_mfma_f32_16x16x32_bf16 v[20:23], v[212:215], v[112:115], v[20:23]
    ds_read_b64_tr_b16 v[32:33], v8 offset:28672
    v_mfma_f32_16x16x32_bf16 v[24:27], v[216:219], v[112:115], v[24:27]
    ds_read_b64_tr_b16 v[34:35], v8 offset:29184
    v_mfma_f32_16x16x32_bf16 v[28:31], v[220:223], v[112:115], v[28:31]
    ds_read_b64_tr_b16 v[36:37], v2 offset:28672
    ds_read_b64_tr_b16 v[38:39], v2 offset:29184
    s_waitcnt vmcnt(14)
    v_mfma_f32_16x16x32_bf16 v[16:19], v[224:227], v[116:119], v[16:19]
    s_add_u32 s30, s30, 4096
    s_bitset0_b32 s30, 15
    buffer_load_dwordx4 v[112:115], v10, s[4:7], s30 offen offset:0
    v_mfma_f32_16x16x32_bf16 v[20:23], v[228:231], v[116:119], v[20:23]
    ds_read_b64_tr_b16 v[40:41], v3 offset:28672
    v_mfma_f32_16x16x32_bf16 v[24:27], v[232:235], v[116:119], v[24:27]
    ds_read_b64_tr_b16 v[42:43], v3 offset:29184
    v_mfma_f32_16x16x32_bf16 v[28:31], v[236:239], v[116:119], v[28:31]
    ds_read_b64_tr_b16 v[44:45], v4 offset:28672
    ds_read_b64_tr_b16 v[46:47], v4 offset:29184
    s_waitcnt vmcnt(14)
    v_mfma_f32_16x16x32_bf16 v[16:19], v[240:243], v[120:123], v[16:19]
    buffer_load_dwordx4 v[116:119], v10, s[4:7], s30 offen offset:1024
    v_mfma_f32_16x16x32_bf16 v[20:23], v[244:247], v[120:123], v[20:23]
    v_mfma_f32_16x16x32_bf16 v[24:27], v[248:251], v[120:123], v[24:27]
    v_mfma_f32_16x16x32_bf16 v[28:31], v[252:255], v[120:123], v[28:31]
    s_waitcnt vmcnt(14)
    s_waitcnt lgkmcnt(0)
    v_mfma_f32_16x16x32_bf16 v[16:19], v[32:35], v[124:127], v[16:19]
    buffer_load_dwordx4 v[120:123], v10, s[4:7], s30 offen offset:2048
    v_mfma_f32_16x16x32_bf16 v[20:23], v[36:39], v[124:127], v[20:23]
    v_mfma_f32_16x16x32_bf16 v[24:27], v[40:43], v[124:127], v[24:27]
    v_mfma_f32_16x16x32_bf16 v[28:31], v[44:47], v[124:127], v[28:31]
    s_lshl_b32 s31, s28, 16
    s_mov_b32 s28, s33
    s_cmp_eq_u32 s34, 1
    ds_write_b128 v14, v[16:19] offset:0
    ds_write_b128 v14, v[20:23] offset:4096
    ds_write_b128 v14, v[24:27] offset:8192
    s_nop 1
    ds_write_b128 v14, v[28:31] offset:12288
    v_xor_b32 v14, 0x4000, v14
    s_cbranch_scc1 U_item
    s_waitcnt lgkmcnt(0)
    s_barrier
    ds_read_b128 v[48:51], v15 offset:0
    ds_read_b128 v[52:55], v15 offset:1024
    ds_read_b128 v[56:59], v15 offset:2048
    ds_read_b128 v[60:63], v15 offset:3072
    s_waitcnt lgkmcnt(0)
    v_add_f32 v48, v48, v52
    v_add_f32 v49, v49, v53
    v_add_f32 v50, v50, v54
    v_add_f32 v51, v51, v55
    v_add_f32 v56, v56, v60
    v_add_f32 v57, v57, v61
    v_add_f32 v58, v58, v62
    v_add_f32 v59, v59, v63
    v_add_f32 v48, v48, v56
    v_add_f32 v49, v49, v57
    v_add_f32 v50, v50, v58
    v_add_f32 v51, v51, v59
    v_cvt_pk_bf16_f32 v52, v48, v49
    v_cvt_pk_bf16_f32 v53, v50, v51
    buffer_store_dwordx2 v[52:53], v13, s[12:15], s31 offen
    s_cmp_lt_u32 s28, 128
    s_cbranch_scc1 U_wait
    s_branch W_fin
W_F:
    s_waitcnt vmcnt(0)
    s_barrier
    s_cmp_lg_u32 s16, 0
    s_cbranch_scc1 reg_16
    s_and_b32 s17, s2, 3
    s_lshl_b32 s17, s17, 3
    s_lshl_b32 s18, s98, 2
    s_add_u32 s17, s17, s18
    s_lshl_b32 s17, 1, s17
    s_andn2_b32 s18, s2, 3
    v_mov_b32 v5, s18
    v_mov_b32 v6, s17
    s_mov_b64 exec, 1
    global_atomic_add v5, v6, s[100:101] sc1
    s_mov_b64 exec, -1
reg_16:
    s_load_dwordx2 s[48:49], s[0:1], 8
    s_load_dwordx2 s[52:53], s[0:1], 16
    s_mov_b32 s50, 2101248
    s_mov_b32 s51, 0x20000
    s_mov_b32 s54, 2101248
    s_mov_b32 s55, 0x20000
    s_load_dwordx2 s[40:41], s[0:1], 0
    s_load_dwordx2 s[44:45], s[0:1], 24
    s_mov_b32 s42, 4194304
    s_mov_b32 s43, 0x20000
    s_mov_b32 s46, 4194304
    s_mov_b32 s47, 0x20000
    s_lshr_b32 s28, s93, 3
    s_and_b32 s29, s93, 7
    s_lshl_b32 s29, s29, 2
    s_add_u32 s29, s29, s16
    v_bfe_u32 v5, v1, 2, 2
    v_and_b32 v7, 3, v1
    v_lshl_add_u32 v7, v5, 3, v7
    s_lshl_b32 s17, s29, 5
    v_add_u32 v7, s17, v7
    v_lshrrev_b32 v8, 4, v1
    v_cvt_f32_u32 v8, v8
    s_mov_b32 s31, 981467136
    v_add_u32 v5, 0, v7
    v_lshrrev_b32 v6, 1, v5
    v_and_b32 v30, 1, v5
    v_cmp_eq_u32 vcc, 1, v5
    v_mov_b32 v5, 512
    s_nop 0
    v_cndmask_b32 v6, v6, v5, vcc
    v_cndmask_b32 v30, v30, 0, vcc
    v_add_u32 v5, v6, v30
    v_bfe_i32 v40, v5, 1, 1
    v_add_u32 v5, v6, v5
    v_bfe_i32 v42, v5, 1, 1
    v_add_u32 v5, v6, v5
    v_bfe_i32 v44, v5, 1, 1
    v_and_b32 v40, 0x80008000, v40
    v_and_b32 v42, 0x80008000, v42
    v_and_b32 v44, 0x80008000, v44
    v_cvt_f32_u32 v6, v6
    v_cvt_f32_u32 v30, v30
    v_mul_f32 v32, s31, v6
    v_mul_f32 v30, 0x3e800000, v30
    v_mov_b32 v34, v32
    v_mul_f32 v36, 0x42000000, v32
    v_mul_f32 v5, 0x41000000, v32
    v_fma_f32 v30, v5, v8, v30
    v_add_u32 v5, 4, v7
    v_lshrrev_b32 v6, 1, v5
    v_and_b32 v31, 1, v5
    v_cmp_eq_u32 vcc, 1, v5
    v_mov_b32 v5, 512
    s_nop 0
    v_cndmask_b32 v6, v6, v5, vcc
    v_cndmask_b32 v31, v31, 0, vcc
    v_add_u32 v5, v6, v31
    v_bfe_i32 v41, v5, 1, 1
    v_add_u32 v5, v6, v5
    v_bfe_i32 v43, v5, 1, 1
    v_add_u32 v5, v6, v5
    v_bfe_i32 v45, v5, 1, 1
    v_and_b32 v41, 0x80008000, v41
    v_and_b32 v43, 0x80008000, v43
    v_and_b32 v45, 0x80008000, v45
    v_cvt_f32_u32 v6, v6
    v_cvt_f32_u32 v31, v31
    v_mul_f32 v33, s31, v6
    v_mul_f32 v31, 0x3e800000, v31
    v_mov_b32 v35, v33
    v_mul_f32 v37, 0x42000000, v33
    v_mul_f32 v5, 0x41000000, v33
    v_fma_f32 v31, v5, v8, v31
    v_fract_f32 v48, v30
    v_add_f32 v49, v48, v32
    v_cos_f32 v56, v48
    v_add_f32 v50, v49, v34
    v_cos_f32 v57, v49
    v_add_f32 v51, v50, v32
    v_cos_f32 v58, v50
    v_add_f32 v52, v51, v34
    v_cos_f32 v59, v51
    v_add_f32 v53, v52, v32
    v_cos_f32 v60, v52
    v_add_f32 v54, v53, v34
    v_cos_f32 v61, v53
    v_add_f32 v55, v54, v32
    v_cos_f32 v62, v54
    v_cos_f32 v63, v55
    v_add_f32 v30, v48, v36
    v_cvt_pk_bf16_f32 v64, v56, v57
    v_cvt_pk_bf16_f32 v65, v58, v59
    v_cvt_pk_bf16_f32 v66, v60, v61
    v_cvt_pk_bf16_f32 v67, v62, v63
    v_accvgpr_write_b32 a0, v64
    v_accvgpr_write_b32 a1, v65
    v_accvgpr_write_b32 a2, v66
    v_accvgpr_write_b32 a3, v67
    v_xor_b32_dpp v68, v64, v40 quad_perm:[0,1,3,2] row_mask:0xf bank_mask:0xf
    v_xor_b32_dpp v69, v65, v40 quad_perm:[0,1,3,2] row_mask:0xf bank_mask:0xf
    v_xor_b32_dpp v70, v66, v40 quad_perm:[0,1,3,2] row_mask:0xf bank_mask:0xf
    v_xor_b32_dpp v71, v67, v40 quad_perm:[0,1,3,2] row_mask:0xf bank_mask:0xf
    v_accvgpr_write_b32 a64, v68
    v_accvgpr_write_b32 a65, v69
    v_accvgpr_write_b32 a66, v70
    v_accvgpr_write_b32 a67, v71
    v_xor_b32 v68, v64, v42
    v_xor_b32 v69, v65, v42
    v_xor_b32 v70, v66, v42
    v_xor_b32 v71, v67, v42
    v_accvgpr_write_b32 a128, v68
    v_accvgpr_write_b32 a129, v69
    v_accvgpr_write_b32 a130, v70
    v_accvgpr_write_b32 a131, v71
    v_xor_b32_dpp v68, v64, v44 quad_perm:[0,1,3,2] row_mask:0xf bank_mask:0xf
    v_xor_b32_dpp v69, v65, v44 quad_perm:[0,1,3,2] row_mask:0xf bank_mask:0xf
    v_xor_b32_dpp v70, v66, v44 quad_perm:[0,1,3,2] row_mask:0xf bank_mask:0xf
    v_xor_b32_dpp v71, v67, v44 quad_perm:[0,1,3,2] row_mask:0xf bank_mask:0xf
    v_accvgpr_write_b32 a192, v68
    v_accvgpr_write_b32 a193, v69
    v_accvgpr_write_b32 a194, v70
    v_accvgpr_write_b32 a195, v71
    v_fract_f32 v48, v31
    v_add_f32 v49, v48, v33
    v_cos_f32 v56, v48
    v_add_f32 v50, v49, v35
    v_cos_f32 v57, v49
    v_add_f32 v51, v50, v33
    v_cos_f32 v58, v50
    v_add_f32 v52, v51, v35
    v_cos_f32 v59, v51
    v_add_f32 v53, v52, v33
    v_cos_f32 v60, v52
    v_add_f32 v54, v53, v35
    v_cos_f32 v61, v53
    v_add_f32 v55, v54, v33
    v_cos_f32 v62, v54
    v_cos_f32 v63, v55
    v_add_f32 v31, v48, v37
    v_cvt_pk_bf16_f32 v64, v56, v57
    v_cvt_pk_bf16_f32 v65, v58, v59
    v_cvt_pk_bf16_f32 v66, v60, v61
    v_cvt_pk_bf16_f32 v67, v62, v63
    v_accvgpr_write_b32 a4, v64
    v_accvgpr_write_b32 a5, v65
    v_accvgpr_write_b32 a6, v66
    v_accvgpr_write_b32 a7, v67
    v_xor_b32_dpp v68, v64, v41 quad_perm:[0,1,3,2] row_mask:0xf bank_mask:0xf
    v_xor_b32_dpp v69, v65, v41 quad_perm:[0,1,3,2] row_mask:0xf bank_mask:0xf
    v_xor_b32_dpp v70, v66, v41 quad_perm:[0,1,3,2] row_mask:0xf bank_mask:0xf
    v_xor_b32_dpp v71, v67, v41 quad_perm:[0,1,3,2] row_mask:0xf bank_mask:0xf
    v_accvgpr_write_b32 a68, v68
    v_accvgpr_write_b32 a69, v69
    v_accvgpr_write_b32 a70, v70
    v_accvgpr_write_b32 a71, v71
    v_xor_b32 v68, v64, v43
    v_xor_b32 v69, v65, v43
    v_xor_b32 v70, v66, v43
    v_xor_b32 v71, v67, v43
    v_accvgpr_write_b32 a132, v68
    v_accvgpr_write_b32 a133, v69
    v_accvgpr_write_b32 a134, v70
    v_accvgpr_write_b32 a135, v71
    v_xor_b32_dpp v68, v64, v45 quad_perm:[0,1,3,2] row_mask:0xf bank_mask:0xf
    v_xor_b32_dpp v69, v65, v45 quad_perm:[0,1,3,2] row_mask:0xf bank_mask:0xf
    v_xor_b32_dpp v70, v66, v45 quad_perm:[0,1,3,2] row_mask:0xf bank_mask:0xf
    v_xor_b32_dpp v71, v67, v45 quad_perm:[0,1,3,2] row_mask:0xf bank_mask:0xf
    v_accvgpr_write_b32 a196, v68
    v_accvgpr_write_b32 a197, v69
    v_accvgpr_write_b32 a198, v70
    v_accvgpr_write_b32 a199, v71
    v_fract_f32 v48, v30
    v_add_f32 v49, v48, v32
    v_cos_f32 v56, v48
    v_add_f32 v50, v49, v34
    v_cos_f32 v57, v49
    v_add_f32 v51, v50, v32
    v_cos_f32 v58, v50
    v_add_f32 v52, v51, v34
    v_cos_f32 v59, v51
    v_add_f32 v53, v52, v32
    v_cos_f32 v60, v52
    v_add_f32 v54, v53, v34
    v_cos_f32 v61, v53
    v_add_f32 v55, v54, v32
    v_cos_f32 v62, v54
    v_cos_f32 v63, v55
    v_add_f32 v30, v48, v36
    v_cvt_pk_bf16_f32 v64, v56, v57
    v_cvt_pk_bf16_f32 v65, v58, v59
    v_cvt_pk_bf16_f32 v66, v60, v61
    v_cvt_pk_bf16_f32 v67, v62, v63
    v_accvgpr_write_b32 a8, v64
    v_accvgpr_write_b32 a9, v65
    v_accvgpr_write_b32 a10, v66
    v_accvgpr_write_b32 a11, v67
    v_xor_b32_dpp v68, v64, v40 quad_perm:[0,1,3,2] row_mask:0xf bank_mask:0xf
    v_xor_b32_dpp v69, v65, v40 quad_perm:[0,1,3,2] row_mask:0xf bank_mask:0xf
    v_xor_b32_dpp v70, v66, v40 quad_perm:[0,1,3,2] row_mask:0xf bank_mask:0xf
    v_xor_b32_dpp v71, v67, v40 quad_perm:[0,1,3,2] row_mask:0xf bank_mask:0xf
    v_accvgpr_write_b32 a72, v68
    v_accvgpr_write_b32 a73, v69
    v_accvgpr_write_b32 a74, v70
    v_accvgpr_write_b32 a75, v71
    v_xor_b32 v68, v64, v42
    v_xor_b32 v69, v65, v42
    v_xor_b32 v70, v66, v42
    v_xor_b32 v71, v67, v42
    v_accvgpr_write_b32 a136, v68
    v_accvgpr_write_b32 a137, v69
    v_accvgpr_write_b32 a138, v70
    v_accvgpr_write_b32 a139, v71
    v_xor_b32_dpp v68, v64, v44 quad_perm:[0,1,3,2] row_mask:0xf bank_mask:0xf
    v_xor_b32_dpp v69, v65, v44 quad_perm:[0,1,3,2] row_mask:0xf bank_mask:0xf
    v_xor_b32_dpp v70, v66, v44 quad_perm:[0,1,3,2] row_mask:0xf bank_mask:0xf
    v_xor_b32_dpp v71, v67, v44 quad_perm:[0,1,3,2] row_mask:0xf bank_mask:0xf
    v_accvgpr_write_b32 a200, v68
    v_accvgpr_write_b32 a201, v69
    v_accvgpr_write_b32 a202, v70
    v_accvgpr_write_b32 a203, v71
    v_fract_f32 v48, v31
    v_add_f32 v49, v48, v33
    v_cos_f32 v56, v48
    v_add_f32 v50, v49, v35
    v_cos_f32 v57, v49
    v_add_f32 v51, v50, v33
    v_cos_f32 v58, v50
    v_add_f32 v52, v51, v35
    v_cos_f32 v59, v51
    v_add_f32 v53, v52, v33
    v_cos_f32 v60, v52
    v_add_f32 v54, v53, v35
    v_cos_f32 v61, v53
    v_add_f32 v55, v54, v33
    v_cos_f32 v62, v54
    v_cos_f32 v63, v55
    v_add_f32 v31, v48, v37
    v_cvt_pk_bf16_f32 v64, v56, v57
    v_cvt_pk_bf16_f32 v65, v58, v59
    v_cvt_pk_bf16_f32 v66, v60, v61
    v_cvt_pk_bf16_f32 v67, v62, v63
    v_accvgpr_write_b32 a12, v64
    v_accvgpr_write_b32 a13, v65
    v_accvgpr_write_b32 a14, v66
    v_accvgpr_write_b32 a15, v67
    v_xor_b32_dpp v68, v64, v41 quad_perm:[0,1,3,2] row_mask:0xf bank_mask:0xf
    v_xor_b32_dpp v69, v65, v41 quad_perm:[0,1,3,2] row_mask:0xf bank_mask:0xf
    v_xor_b32_dpp v70, v66, v41 quad_perm:[0,1,3,2] row_mask:0xf bank_mask:0xf
    v_xor_b32_dpp v71, v67, v41 quad_perm:[0,1,3,2] row_mask:0xf bank_mask:0xf
    v_accvgpr_write_b32 a76, v68
    v_accvgpr_write_b32 a77, v69
    v_accvgpr_write_b32 a78, v70
    v_accvgpr_write_b32 a79, v71
    v_xor_b32 v68, v64, v43
    v_xor_b32 v69, v65, v43
    v_xor_b32 v70, v66, v43
    v_xor_b32 v71, v67, v43
    v_accvgpr_write_b32 a140, v68
    v_accvgpr_write_b32 a141, v69
    v_accvgpr_write_b32 a142, v70
    v_accvgpr_write_b32 a143, v71
    v_xor_b32_dpp v68, v64, v45 quad_perm:[0,1,3,2] row_mask:0xf bank_mask:0xf
    v_xor_b32_dpp v69, v65, v45 quad_perm:[0,1,3,2] row_mask:0xf bank_mask:0xf
    v_xor_b32_dpp v70, v66, v45 quad_perm:[0,1,3,2] row_mask:0xf bank_mask:0xf
    v_xor_b32_dpp v71, v67, v45 quad_perm:[0,1,3,2] row_mask:0xf bank_mask:0xf
    v_accvgpr_write_b32 a204, v68
    v_accvgpr_write_b32 a205, v69
    v_accvgpr_write_b32 a206, v70
    v_accvgpr_write_b32 a207, v71
    v_fract_f32 v48, v30
    v_add_f32 v49, v48, v32
    v_cos_f32 v56, v48
    v_add_f32 v50, v49, v34
    v_cos_f32 v57, v49
    v_add_f32 v51, v50, v32
    v_cos_f32 v58, v50
    v_add_f32 v52, v51, v34
    v_cos_f32 v59, v51
    v_add_f32 v53, v52, v32
    v_cos_f32 v60, v52
    v_add_f32 v54, v53, v34
    v_cos_f32 v61, v53
    v_add_f32 v55, v54, v32
    v_cos_f32 v62, v54
    v_cos_f32 v63, v55
    v_add_f32 v30, v48, v36
    v_cvt_pk_bf16_f32 v64, v56, v57
    v_cvt_pk_bf16_f32 v65, v58, v59
    v_cvt_pk_bf16_f32 v66, v60, v61
    v_cvt_pk_bf16_f32 v67, v62, v63
    v_accvgpr_write_b32 a16, v64
    v_accvgpr_write_b32 a17, v65
    v_accvgpr_write_b32 a18, v66
    v_accvgpr_write_b32 a19, v67
    v_xor_b32_dpp v68, v64, v40 quad_perm:[0,1,3,2] row_mask:0xf bank_mask:0xf
    v_xor_b32_dpp v69, v65, v40 quad_perm:[0,1,3,2] row_mask:0xf bank_mask:0xf
    v_xor_b32_dpp v70, v66, v40 quad_perm:[0,1,3,2] row_mask:0xf bank_mask:0xf
    v_xor_b32_dpp v71, v67, v40 quad_perm:[0,1,3,2] row_mask:0xf bank_mask:0xf
    v_accvgpr_write_b32 a80, v68
    v_accvgpr_write_b32 a81, v69
    v_accvgpr_write_b32 a82, v70
    v_accvgpr_write_b32 a83, v71
    v_xor_b32 v68, v64, v42
    v_xor_b32 v69, v65, v42
    v_xor_b32 v70, v66, v42
    v_xor_b32 v71, v67, v42
    v_accvgpr_write_b32 a144, v68
    v_accvgpr_write_b32 a145, v69
    v_accvgpr_write_b32 a146, v70
    v_accvgpr_write_b32 a147, v71
    v_xor_b32_dpp v68, v64, v44 quad_perm:[0,1,3,2] row_mask:0xf bank_mask:0xf
    v_xor_b32_dpp v69, v65, v44 quad_perm:[0,1,3,2] row_mask:0xf bank_mask:0xf
    v_xor_b32_dpp v70, v66, v44 quad_perm:[0,1,3,2] row_mask:0xf bank_mask:0xf
    v_xor_b32_dpp v71, v67, v44 quad_perm:[0,1,3,2] row_mask:0xf bank_mask:0xf
    v_accvgpr_write_b32 a208, v68
    v_accvgpr_write_b32 a209, v69
    v_accvgpr_write_b32 a210, v70
    v_accvgpr_write_b32 a211, v71
    v_fract_f32 v48, v31
    v_add_f32 v49, v48, v33
    v_cos_f32 v56, v48
    v_add_f32 v50, v49, v35
    v_cos_f32 v57, v49
    v_add_f32 v51, v50, v33
    v_cos_f32 v58, v50
    v_add_f32 v52, v51, v35
    v_cos_f32 v59, v51
    v_add_f32 v53, v52, v33
    v_cos_f32 v60, v52
    v_add_f32 v54, v53, v35
    v_cos_f32 v61, v53
    v_add_f32 v55, v54, v33
    v_cos_f32 v62, v54
    v_cos_f32 v63, v55
    v_add_f32 v31, v48, v37
    v_cvt_pk_bf16_f32 v64, v56, v57
    v_cvt_pk_bf16_f32 v65, v58, v59
    v_cvt_pk_bf16_f32 v66, v60, v61
    v_cvt_pk_bf16_f32 v67, v62, v63
    v_accvgpr_write_b32 a20, v64
    v_accvgpr_write_b32 a21, v65
    v_accvgpr_write_b32 a22, v66
    v_accvgpr_write_b32 a23, v67
    v_xor_b32_dpp v68, v64, v41 quad_perm:[0,1,3,2] row_mask:0xf bank_mask:0xf
    v_xor_b32_dpp v69, v65, v41 quad_perm:[0,1,3,2] row_mask:0xf bank_mask:0xf
    v_xor_b32_dpp v70, v66, v41 quad_perm:[0,1,3,2] row_mask:0xf bank_mask:0xf
    v_xor_b32_dpp v71, v67, v41 quad_perm:[0,1,3,2] row_mask:0xf bank_mask:0xf
    v_accvgpr_write_b32 a84, v68
    v_accvgpr_write_b32 a85, v69
    v_accvgpr_write_b32 a86, v70
    v_accvgpr_write_b32 a87, v71
    v_xor_b32 v68, v64, v43
    v_xor_b32 v69, v65, v43
    v_xor_b32 v70, v66, v43
    v_xor_b32 v71, v67, v43
    v_accvgpr_write_b32 a148, v68
    v_accvgpr_write_b32 a149, v69
    v_accvgpr_write_b32 a150, v70
    v_accvgpr_write_b32 a151, v71
    v_xor_b32_dpp v68, v64, v45 quad_perm:[0,1,3,2] row_mask:0xf bank_mask:0xf
    v_xor_b32_dpp v69, v65, v45 quad_perm:[0,1,3,2] row_mask:0xf bank_mask:0xf
    v_xor_b32_dpp v70, v66, v45 quad_perm:[0,1,3,2] row_mask:0xf bank_mask:0xf
    v_xor_b32_dpp v71, v67, v45 quad_perm:[0,1,3,2] row_mask:0xf bank_mask:0xf
    v_accvgpr_write_b32 a212, v68
    v_accvgpr_write_b32 a213, v69
    v_accvgpr_write_b32 a214, v70
    v_accvgpr_write_b32 a215, v71
    v_fract_f32 v48, v30
    v_add_f32 v49, v48, v32
    v_cos_f32 v56, v48
    v_add_f32 v50, v49, v34
    v_cos_f32 v57, v49
    v_add_f32 v51, v50, v32
    v_cos_f32 v58, v50
    v_add_f32 v52, v51, v34
    v_cos_f32 v59, v51
    v_add_f32 v53, v52, v32
    v_cos_f32 v60, v52
    v_add_f32 v54, v53, v34
    v_cos_f32 v61, v53
    v_add_f32 v55, v54, v32
    v_cos_f32 v62, v54
    v_cos_f32 v63, v55
    v_add_f32 v30, v48, v36
    v_cvt_pk_bf16_f32 v64, v56, v57
    v_cvt_pk_bf16_f32 v65, v58, v59
    v_cvt_pk_bf16_f32 v66, v60, v61
    v_cvt_pk_bf16_f32 v67, v62, v63
    v_accvgpr_write_b32 a24, v64
    v_accvgpr_write_b32 a25, v65
    v_accvgpr_write_b32 a26, v66
    v_accvgpr_write_b32 a27, v67
    v_xor_b32_dpp v68, v64, v40 quad_perm:[0,1,3,2] row_mask:0xf bank_mask:0xf
    v_xor_b32_dpp v69, v65, v40 quad_perm:[0,1,3,2] row_mask:0xf bank_mask:0xf
    v_xor_b32_dpp v70, v66, v40 quad_perm:[0,1,3,2] row_mask:0xf bank_mask:0xf
    v_xor_b32_dpp v71, v67, v40 quad_perm:[0,1,3,2] row_mask:0xf bank_mask:0xf
    v_accvgpr_write_b32 a88, v68
    v_accvgpr_write_b32 a89, v69
    v_accvgpr_write_b32 a90, v70
    v_accvgpr_write_b32 a91, v71
    v_xor_b32 v68, v64, v42
    v_xor_b32 v69, v65, v42
    v_xor_b32 v70, v66, v42
    v_xor_b32 v71, v67, v42
    v_accvgpr_write_b32 a152, v68
    v_accvgpr_write_b32 a153, v69
    v_accvgpr_write_b32 a154, v70
    v_accvgpr_write_b32 a155, v71
    v_xor_b32_dpp v68, v64, v44 quad_perm:[0,1,3,2] row_mask:0xf bank_mask:0xf
    v_xor_b32_dpp v69, v65, v44 quad_perm:[0,1,3,2] row_mask:0xf bank_mask:0xf
    v_xor_b32_dpp v70, v66, v44 quad_perm:[0,1,3,2] row_mask:0xf bank_mask:0xf
    v_xor_b32_dpp v71, v67, v44 quad_perm:[0,1,3,2] row_mask:0xf bank_mask:0xf
    v_accvgpr_write_b32 a216, v68
    v_accvgpr_write_b32 a217, v69
    v_accvgpr_write_b32 a218, v70
    v_accvgpr_write_b32 a219, v71
    v_fract_f32 v48, v31
    v_add_f32 v49, v48, v33
    v_cos_f32 v56, v48
    v_add_f32 v50, v49, v35
    v_cos_f32 v57, v49
    v_add_f32 v51, v50, v33
    v_cos_f32 v58, v50
    v_add_f32 v52, v51, v35
    v_cos_f32 v59, v51
    v_add_f32 v53, v52, v33
    v_cos_f32 v60, v52
    v_add_f32 v54, v53, v35
    v_cos_f32 v61, v53
    v_add_f32 v55, v54, v33
    v_cos_f32 v62, v54
    v_cos_f32 v63, v55
    v_add_f32 v31, v48, v37
    v_cvt_pk_bf16_f32 v64, v56, v57
    v_cvt_pk_bf16_f32 v65, v58, v59
    v_cvt_pk_bf16_f32 v66, v60, v61
    v_cvt_pk_bf16_f32 v67, v62, v63
    v_accvgpr_write_b32 a28, v64
    v_accvgpr_write_b32 a29, v65
    v_accvgpr_write_b32 a30, v66
    v_accvgpr_write_b32 a31, v67
    v_xor_b32_dpp v68, v64, v41 quad_perm:[0,1,3,2] row_mask:0xf bank_mask:0xf
    v_xor_b32_dpp v69, v65, v41 quad_perm:[0,1,3,2] row_mask:0xf bank_mask:0xf
    v_xor_b32_dpp v70, v66, v41 quad_perm:[0,1,3,2] row_mask:0xf bank_mask:0xf
    v_xor_b32_dpp v71, v67, v41 quad_perm:[0,1,3,2] row_mask:0xf bank_mask:0xf
    v_accvgpr_write_b32 a92, v68
    v_accvgpr_write_b32 a93, v69
    v_accvgpr_write_b32 a94, v70
    v_accvgpr_write_b32 a95, v71
    v_xor_b32 v68, v64, v43
    v_xor_b32 v69, v65, v43
    v_xor_b32 v70, v66, v43
    v_xor_b32 v71, v67, v43
    v_accvgpr_write_b32 a156, v68
    v_accvgpr_write_b32 a157, v69
    v_accvgpr_write_b32 a158, v70
    v_accvgpr_write_b32 a159, v71
    v_xor_b32_dpp v68, v64, v45 quad_perm:[0,1,3,2] row_mask:0xf bank_mask:0xf
    v_xor_b32_dpp v69, v65, v45 quad_perm:[0,1,3,2] row_mask:0xf bank_mask:0xf
    v_xor_b32_dpp v70, v66, v45 quad_perm:[0,1,3,2] row_mask:0xf bank_mask:0xf
    v_xor_b32_dpp v71, v67, v45 quad_perm:[0,1,3,2] row_mask:0xf bank_mask:0xf
    v_accvgpr_write_b32 a220, v68
    v_accvgpr_write_b32 a221, v69
    v_accvgpr_write_b32 a222, v70
    v_accvgpr_write_b32 a223, v71
    v_fract_f32 v48, v30
    v_add_f32 v49, v48, v32
    v_cos_f32 v56, v48
    v_add_f32 v50, v49, v34
    v_cos_f32 v57, v49
    v_add_f32 v51, v50, v32
    v_cos_f32 v58, v50
    v_add_f32 v52, v51, v34
    v_cos_f32 v59, v51
    v_add_f32 v53, v52, v32
    v_cos_f32 v60, v52
    v_add_f32 v54, v53, v34
    v_cos_f32 v61, v53
    v_add_f32 v55, v54, v32
    v_cos_f32 v62, v54
    v_cos_f32 v63, v55
    v_add_f32 v30, v48, v36
    v_cvt_pk_bf16_f32 v64, v56, v57
    v_cvt_pk_bf16_f32 v65, v58, v59
    v_cvt_pk_bf16_f32 v66, v60, v61
    v_cvt_pk_bf16_f32 v67, v62, v63
    v_accvgpr_write_b32 a32, v64
    v_accvgpr_write_b32 a33, v65
    v_accvgpr_write_b32 a34, v66
    v_accvgpr_write_b32 a35, v67
    v_xor_b32_dpp v68, v64, v40 quad_perm:[0,1,3,2] row_mask:0xf bank_mask:0xf
    v_xor_b32_dpp v69, v65, v40 quad_perm:[0,1,3,2] row_mask:0xf bank_mask:0xf
    v_xor_b32_dpp v70, v66, v40 quad_perm:[0,1,3,2] row_mask:0xf bank_mask:0xf
    v_xor_b32_dpp v71, v67, v40 quad_perm:[0,1,3,2] row_mask:0xf bank_mask:0xf
    v_accvgpr_write_b32 a96, v68
    v_accvgpr_write_b32 a97, v69
    v_accvgpr_write_b32 a98, v70
    v_accvgpr_write_b32 a99, v71
    v_xor_b32 v68, v64, v42
    v_xor_b32 v69, v65, v42
    v_xor_b32 v70, v66, v42
    v_xor_b32 v71, v67, v42
    v_accvgpr_write_b32 a160, v68
    v_accvgpr_write_b32 a161, v69
    v_accvgpr_write_b32 a162, v70
    v_accvgpr_write_b32 a163, v71
    v_xor_b32_dpp v68, v64, v44 quad_perm:[0,1,3,2] row_mask:0xf bank_mask:0xf
    v_xor_b32_dpp v69, v65, v44 quad_perm:[0,1,3,2] row_mask:0xf bank_mask:0xf
    v_xor_b32_dpp v70, v66, v44 quad_perm:[0,1,3,2] row_mask:0xf bank_mask:0xf
    v_xor_b32_dpp v71, v67, v44 quad_perm:[0,1,3,2] row_mask:0xf bank_mask:0xf
    v_accvgpr_write_b32 a224, v68
    v_accvgpr_write_b32 a225, v69
    v_accvgpr_write_b32 a226, v70
    v_accvgpr_write_b32 a227, v71
    v_fract_f32 v48, v31
    v_add_f32 v49, v48, v33
    v_cos_f32 v56, v48
    v_add_f32 v50, v49, v35
    v_cos_f32 v57, v49
    v_add_f32 v51, v50, v33
    v_cos_f32 v58, v50
    v_add_f32 v52, v51, v35
    v_cos_f32 v59, v51
    v_add_f32 v53, v52, v33
    v_cos_f32 v60, v52
    v_add_f32 v54, v53, v35
    v_cos_f32 v61, v53
    v_add_f32 v55, v54, v33
    v_cos_f32 v62, v54
    v_cos_f32 v63, v55
    v_add_f32 v31, v48, v37
    v_cvt_pk_bf16_f32 v64, v56, v57
    v_cvt_pk_bf16_f32 v65, v58, v59
    v_cvt_pk_bf16_f32 v66, v60, v61
    v_cvt_pk_bf16_f32 v67, v62, v63
    v_accvgpr_write_b32 a36, v64
    v_accvgpr_write_b32 a37, v65
    v_accvgpr_write_b32 a38, v66
    v_accvgpr_write_b32 a39, v67
    v_xor_b32_dpp v68, v64, v41 quad_perm:[0,1,3,2] row_mask:0xf bank_mask:0xf
    v_xor_b32_dpp v69, v65, v41 quad_perm:[0,1,3,2] row_mask:0xf bank_mask:0xf
    v_xor_b32_dpp v70, v66, v41 quad_perm:[0,1,3,2] row_mask:0xf bank_mask:0xf
    v_xor_b32_dpp v71, v67, v41 quad_perm:[0,1,3,2] row_mask:0xf bank_mask:0xf
    v_accvgpr_write_b32 a100, v68
    v_accvgpr_write_b32 a101, v69
    v_accvgpr_write_b32 a102, v70
    v_accvgpr_write_b32 a103, v71
    v_xor_b32 v68, v64, v43
    v_xor_b32 v69, v65, v43
    v_xor_b32 v70, v66, v43
    v_xor_b32 v71, v67, v43
    v_accvgpr_write_b32 a164, v68
    v_accvgpr_write_b32 a165, v69
    v_accvgpr_write_b32 a166, v70
    v_accvgpr_write_b32 a167, v71
    v_xor_b32_dpp v68, v64, v45 quad_perm:[0,1,3,2] row_mask:0xf bank_mask:0xf
    v_xor_b32_dpp v69, v65, v45 quad_perm:[0,1,3,2] row_mask:0xf bank_mask:0xf
    v_xor_b32_dpp v70, v66, v45 quad_perm:[0,1,3,2] row_mask:0xf bank_mask:0xf
    v_xor_b32_dpp v71, v67, v45 quad_perm:[0,1,3,2] row_mask:0xf bank_mask:0xf
    v_accvgpr_write_b32 a228, v68
    v_accvgpr_write_b32 a229, v69
    v_accvgpr_write_b32 a230, v70
    v_accvgpr_write_b32 a231, v71
    v_fract_f32 v48, v30
    v_add_f32 v49, v48, v32
    v_cos_f32 v56, v48
    v_add_f32 v50, v49, v34
    v_cos_f32 v57, v49
    v_add_f32 v51, v50, v32
    v_cos_f32 v58, v50
    v_add_f32 v52, v51, v34
    v_cos_f32 v59, v51
    v_add_f32 v53, v52, v32
    v_cos_f32 v60, v52
    v_add_f32 v54, v53, v34
    v_cos_f32 v61, v53
    v_add_f32 v55, v54, v32
    v_cos_f32 v62, v54
    v_cos_f32 v63, v55
    v_add_f32 v30, v48, v36
    v_cvt_pk_bf16_f32 v64, v56, v57
    v_cvt_pk_bf16_f32 v65, v58, v59
    v_cvt_pk_bf16_f32 v66, v60, v61
    v_cvt_pk_bf16_f32 v67, v62, v63
    v_accvgpr_write_b32 a40, v64
    v_accvgpr_write_b32 a41, v65
    v_accvgpr_write_b32 a42, v66
    v_accvgpr_write_b32 a43, v67
    v_xor_b32_dpp v68, v64, v40 quad_perm:[0,1,3,2] row_mask:0xf bank_mask:0xf
    v_xor_b32_dpp v69, v65, v40 quad_perm:[0,1,3,2] row_mask:0xf bank_mask:0xf
    v_xor_b32_dpp v70, v66, v40 quad_perm:[0,1,3,2] row_mask:0xf bank_mask:0xf
    v_xor_b32_dpp v71, v67, v40 quad_perm:[0,1,3,2] row_mask:0xf bank_mask:0xf
    v_accvgpr_write_b32 a104, v68
    v_accvgpr_write_b32 a105, v69
    v_accvgpr_write_b32 a106, v70
    v_accvgpr_write_b32 a107, v71
    v_xor_b32 v68, v64, v42
    v_xor_b32 v69, v65, v42
    v_xor_b32 v70, v66, v42
    v_xor_b32 v71, v67, v42
    v_accvgpr_write_b32 a168, v68
    v_accvgpr_write_b32 a169, v69
    v_accvgpr_write_b32 a170, v70
    v_accvgpr_write_b32 a171, v71
    v_xor_b32_dpp v68, v64, v44 quad_perm:[0,1,3,2] row_mask:0xf bank_mask:0xf
    v_xor_b32_dpp v69, v65, v44 quad_perm:[0,1,3,2] row_mask:0xf bank_mask:0xf
    v_xor_b32_dpp v70, v66, v44 quad_perm:[0,1,3,2] row_mask:0xf bank_mask:0xf
    v_xor_b32_dpp v71, v67, v44 quad_perm:[0,1,3,2] row_mask:0xf bank_mask:0xf
    v_accvgpr_write_b32 a232, v68
    v_accvgpr_write_b32 a233, v69
    v_accvgpr_write_b32 a234, v70
    v_accvgpr_write_b32 a235, v71
    v_fract_f32 v48, v31
    v_add_f32 v49, v48, v33
    v_cos_f32 v56, v48
    v_add_f32 v50, v49, v35
    v_cos_f32 v57, v49
    v_add_f32 v51, v50, v33
    v_cos_f32 v58, v50
    v_add_f32 v52, v51, v35
    v_cos_f32 v59, v51
    v_add_f32 v53, v52, v33
    v_cos_f32 v60, v52
    v_add_f32 v54, v53, v35
    v_cos_f32 v61, v53
    v_add_f32 v55, v54, v33
    v_cos_f32 v62, v54
    v_cos_f32 v63, v55
    v_add_f32 v31, v48, v37
    v_cvt_pk_bf16_f32 v64, v56, v57
    v_cvt_pk_bf16_f32 v65, v58, v59
    v_cvt_pk_bf16_f32 v66, v60, v61
    v_cvt_pk_bf16_f32 v67, v62, v63
    v_accvgpr_write_b32 a44, v64
    v_accvgpr_write_b32 a45, v65
    v_accvgpr_write_b32 a46, v66
    v_accvgpr_write_b32 a47, v67
    v_xor_b32_dpp v68, v64, v41 quad_perm:[0,1,3,2] row_mask:0xf bank_mask:0xf
    v_xor_b32_dpp v69, v65, v41 quad_perm:[0,1,3,2] row_mask:0xf bank_mask:0xf
    v_xor_b32_dpp v70, v66, v41 quad_perm:[0,1,3,2] row_mask:0xf bank_mask:0xf
    v_xor_b32_dpp v71, v67, v41 quad_perm:[0,1,3,2] row_mask:0xf bank_mask:0xf
    v_accvgpr_write_b32 a108, v68
    v_accvgpr_write_b32 a109, v69
    v_accvgpr_write_b32 a110, v70
    v_accvgpr_write_b32 a111, v71
    v_xor_b32 v68, v64, v43
    v_xor_b32 v69, v65, v43
    v_xor_b32 v70, v66, v43
    v_xor_b32 v71, v67, v43
    v_accvgpr_write_b32 a172, v68
    v_accvgpr_write_b32 a173, v69
    v_accvgpr_write_b32 a174, v70
    v_accvgpr_write_b32 a175, v71
    v_xor_b32_dpp v68, v64, v45 quad_perm:[0,1,3,2] row_mask:0xf bank_mask:0xf
    v_xor_b32_dpp v69, v65, v45 quad_perm:[0,1,3,2] row_mask:0xf bank_mask:0xf
    v_xor_b32_dpp v70, v66, v45 quad_perm:[0,1,3,2] row_mask:0xf bank_mask:0xf
    v_xor_b32_dpp v71, v67, v45 quad_perm:[0,1,3,2] row_mask:0xf bank_mask:0xf
    v_accvgpr_write_b32 a236, v68
    v_accvgpr_write_b32 a237, v69
    v_accvgpr_write_b32 a238, v70
    v_accvgpr_write_b32 a239, v71
    v_fract_f32 v48, v30
    v_add_f32 v49, v48, v32
    v_cos_f32 v56, v48
    v_add_f32 v50, v49, v34
    v_cos_f32 v57, v49
    v_add_f32 v51, v50, v32
    v_cos_f32 v58, v50
    v_add_f32 v52, v51, v34
    v_cos_f32 v59, v51
    v_add_f32 v53, v52, v32
    v_cos_f32 v60, v52
    v_add_f32 v54, v53, v34
    v_cos_f32 v61, v53
    v_add_f32 v55, v54, v32
    v_cos_f32 v62, v54
    v_cos_f32 v63, v55
    v_add_f32 v30, v48, v36
    v_cvt_pk_bf16_f32 v64, v56, v57
    v_cvt_pk_bf16_f32 v65, v58, v59
    v_cvt_pk_bf16_f32 v66, v60, v61
    v_cvt_pk_bf16_f32 v67, v62, v63
    v_accvgpr_write_b32 a48, v64
    v_accvgpr_write_b32 a49, v65
    v_accvgpr_write_b32 a50, v66
    v_accvgpr_write_b32 a51, v67
    v_xor_b32_dpp v68, v64, v40 quad_perm:[0,1,3,2] row_mask:0xf bank_mask:0xf
    v_xor_b32_dpp v69, v65, v40 quad_perm:[0,1,3,2] row_mask:0xf bank_mask:0xf
    v_xor_b32_dpp v70, v66, v40 quad_perm:[0,1,3,2] row_mask:0xf bank_mask:0xf
    v_xor_b32_dpp v71, v67, v40 quad_perm:[0,1,3,2] row_mask:0xf bank_mask:0xf
    v_accvgpr_write_b32 a112, v68
    v_accvgpr_write_b32 a113, v69
    v_accvgpr_write_b32 a114, v70
    v_accvgpr_write_b32 a115, v71
    v_xor_b32 v68, v64, v42
    v_xor_b32 v69, v65, v42
    v_xor_b32 v70, v66, v42
    v_xor_b32 v71, v67, v42
    v_accvgpr_write_b32 a176, v68
    v_accvgpr_write_b32 a177, v69
    v_accvgpr_write_b32 a178, v70
    v_accvgpr_write_b32 a179, v71
    v_xor_b32_dpp v68, v64, v44 quad_perm:[0,1,3,2] row_mask:0xf bank_mask:0xf
    v_xor_b32_dpp v69, v65, v44 quad_perm:[0,1,3,2] row_mask:0xf bank_mask:0xf
    v_xor_b32_dpp v70, v66, v44 quad_perm:[0,1,3,2] row_mask:0xf bank_mask:0xf
    v_xor_b32_dpp v71, v67, v44 quad_perm:[0,1,3,2] row_mask:0xf bank_mask:0xf
    v_accvgpr_write_b32 a240, v68
    v_accvgpr_write_b32 a241, v69
    v_accvgpr_write_b32 a242, v70
    v_accvgpr_write_b32 a243, v71
    v_fract_f32 v48, v31
    v_add_f32 v49, v48, v33
    v_cos_f32 v56, v48
    v_add_f32 v50, v49, v35
    v_cos_f32 v57, v49
    v_add_f32 v51, v50, v33
    v_cos_f32 v58, v50
    v_add_f32 v52, v51, v35
    v_cos_f32 v59, v51
    v_add_f32 v53, v52, v33
    v_cos_f32 v60, v52
    v_add_f32 v54, v53, v35
    v_cos_f32 v61, v53
    v_add_f32 v55, v54, v33
    v_cos_f32 v62, v54
    v_cos_f32 v63, v55
    v_add_f32 v31, v48, v37
    v_cvt_pk_bf16_f32 v64, v56, v57
    v_cvt_pk_bf16_f32 v65, v58, v59
    v_cvt_pk_bf16_f32 v66, v60, v61
    v_cvt_pk_bf16_f32 v67, v62, v63
    v_accvgpr_write_b32 a52, v64
    v_accvgpr_write_b32 a53, v65
    v_accvgpr_write_b32 a54, v66
    v_accvgpr_write_b32 a55, v67
    v_xor_b32_dpp v68, v64, v41 quad_perm:[0,1,3,2] row_mask:0xf bank_mask:0xf
    v_xor_b32_dpp v69, v65, v41 quad_perm:[0,1,3,2] row_mask:0xf bank_mask:0xf
    v_xor_b32_dpp v70, v66, v41 quad_perm:[0,1,3,2] row_mask:0xf bank_mask:0xf
    v_xor_b32_dpp v71, v67, v41 quad_perm:[0,1,3,2] row_mask:0xf bank_mask:0xf
    v_accvgpr_write_b32 a116, v68
    v_accvgpr_write_b32 a117, v69
    v_accvgpr_write_b32 a118, v70
    v_accvgpr_write_b32 a119, v71
    v_xor_b32 v68, v64, v43
    v_xor_b32 v69, v65, v43
    v_xor_b32 v70, v66, v43
    v_xor_b32 v71, v67, v43
    v_accvgpr_write_b32 a180, v68
    v_accvgpr_write_b32 a181, v69
    v_accvgpr_write_b32 a182, v70
    v_accvgpr_write_b32 a183, v71
    v_xor_b32_dpp v68, v64, v45 quad_perm:[0,1,3,2] row_mask:0xf bank_mask:0xf
    v_xor_b32_dpp v69, v65, v45 quad_perm:[0,1,3,2] row_mask:0xf bank_mask:0xf
    v_xor_b32_dpp v70, v66, v45 quad_perm:[0,1,3,2] row_mask:0xf bank_mask:0xf
    v_xor_b32_dpp v71, v67, v45 quad_perm:[0,1,3,2] row_mask:0xf bank_mask:0xf
    v_accvgpr_write_b32 a244, v68
    v_accvgpr_write_b32 a245, v69
    v_accvgpr_write_b32 a246, v70
    v_accvgpr_write_b32 a247, v71
    v_fract_f32 v48, v30
    v_add_f32 v49, v48, v32
    v_cos_f32 v56, v48
    v_add_f32 v50, v49, v34
    v_cos_f32 v57, v49
    v_add_f32 v51, v50, v32
    v_cos_f32 v58, v50
    v_add_f32 v52, v51, v34
    v_cos_f32 v59, v51
    v_add_f32 v53, v52, v32
    v_cos_f32 v60, v52
    v_add_f32 v54, v53, v34
    v_cos_f32 v61, v53
    v_add_f32 v55, v54, v32
    v_cos_f32 v62, v54
    v_cos_f32 v63, v55
    v_add_f32 v30, v48, v36
    v_cvt_pk_bf16_f32 v64, v56, v57
    v_cvt_pk_bf16_f32 v65, v58, v59
    v_cvt_pk_bf16_f32 v66, v60, v61
    v_cvt_pk_bf16_f32 v67, v62, v63
    v_accvgpr_write_b32 a56, v64
    v_accvgpr_write_b32 a57, v65
    v_accvgpr_write_b32 a58, v66
    v_accvgpr_write_b32 a59, v67
    v_xor_b32_dpp v68, v64, v40 quad_perm:[0,1,3,2] row_mask:0xf bank_mask:0xf
    v_xor_b32_dpp v69, v65, v40 quad_perm:[0,1,3,2] row_mask:0xf bank_mask:0xf
    v_xor_b32_dpp v70, v66, v40 quad_perm:[0,1,3,2] row_mask:0xf bank_mask:0xf
    v_xor_b32_dpp v71, v67, v40 quad_perm:[0,1,3,2] row_mask:0xf bank_mask:0xf
    v_accvgpr_write_b32 a120, v68
    v_accvgpr_write_b32 a121, v69
    v_accvgpr_write_b32 a122, v70
    v_accvgpr_write_b32 a123, v71
    v_xor_b32 v68, v64, v42
    v_xor_b32 v69, v65, v42
    v_xor_b32 v70, v66, v42
    v_xor_b32 v71, v67, v42
    v_accvgpr_write_b32 a184, v68
    v_accvgpr_write_b32 a185, v69
    v_accvgpr_write_b32 a186, v70
    v_accvgpr_write_b32 a187, v71
    v_xor_b32_dpp v68, v64, v44 quad_perm:[0,1,3,2] row_mask:0xf bank_mask:0xf
    v_xor_b32_dpp v69, v65, v44 quad_perm:[0,1,3,2] row_mask:0xf bank_mask:0xf
    v_xor_b32_dpp v70, v66, v44 quad_perm:[0,1,3,2] row_mask:0xf bank_mask:0xf
    v_xor_b32_dpp v71, v67, v44 quad_perm:[0,1,3,2] row_mask:0xf bank_mask:0xf
    v_accvgpr_write_b32 a248, v68
    v_accvgpr_write_b32 a249, v69
    v_accvgpr_write_b32 a250, v70
    v_accvgpr_write_b32 a251, v71
    v_fract_f32 v48, v31
    v_add_f32 v49, v48, v33
    v_cos_f32 v56, v48
    v_add_f32 v50, v49, v35
    v_cos_f32 v57, v49
    v_add_f32 v51, v50, v33
    v_cos_f32 v58, v50
    v_add_f32 v52, v51, v35
    v_cos_f32 v59, v51
    v_add_f32 v53, v52, v33
    v_cos_f32 v60, v52
    v_add_f32 v54, v53, v35
    v_cos_f32 v61, v53
    v_add_f32 v55, v54, v33
    v_cos_f32 v62, v54
    v_cos_f32 v63, v55
    v_add_f32 v31, v48, v37
    v_cvt_pk_bf16_f32 v64, v56, v57
    v_cvt_pk_bf16_f32 v65, v58, v59
    v_cvt_pk_bf16_f32 v66, v60, v61
    v_cvt_pk_bf16_f32 v67, v62, v63
    v_accvgpr_write_b32 a60, v64
    v_accvgpr_write_b32 a61, v65
    v_accvgpr_write_b32 a62, v66
    v_accvgpr_write_b32 a63, v67
    v_xor_b32_dpp v68, v64, v41 quad_perm:[0,1,3,2] row_mask:0xf bank_mask:0xf
    v_xor_b32_dpp v69, v65, v41 quad_perm:[0,1,3,2] row_mask:0xf bank_mask:0xf
    v_xor_b32_dpp v70, v66, v41 quad_perm:[0,1,3,2] row_mask:0xf bank_mask:0xf
    v_xor_b32_dpp v71, v67, v41 quad_perm:[0,1,3,2] row_mask:0xf bank_mask:0xf
    v_accvgpr_write_b32 a124, v68
    v_accvgpr_write_b32 a125, v69
    v_accvgpr_write_b32 a126, v70
    v_accvgpr_write_b32 a127, v71
    v_xor_b32 v68, v64, v43
    v_xor_b32 v69, v65, v43
    v_xor_b32 v70, v66, v43
    v_xor_b32 v71, v67, v43
    v_accvgpr_write_b32 a188, v68
    v_accvgpr_write_b32 a189, v69
    v_accvgpr_write_b32 a190, v70
    v_accvgpr_write_b32 a191, v71
    v_xor_b32_dpp v68, v64, v45 quad_perm:[0,1,3,2] row_mask:0xf bank_mask:0xf
    v_xor_b32_dpp v69, v65, v45 quad_perm:[0,1,3,2] row_mask:0xf bank_mask:0xf
    v_xor_b32_dpp v70, v66, v45 quad_perm:[0,1,3,2] row_mask:0xf bank_mask:0xf
    v_xor_b32_dpp v71, v67, v45 quad_perm:[0,1,3,2] row_mask:0xf bank_mask:0xf
    v_accvgpr_write_b32 a252, v68
    v_accvgpr_write_b32 a253, v69
    v_accvgpr_write_b32 a254, v70
    v_accvgpr_write_b32 a255, v71
    s_and_b32 s17, s28, 1
    s_lshl_b32 s17, s17, 15
    s_lshr_b32 s18, s28, 1
    s_lshl_b32 s18, s18, 21
    s_add_u32 s17, s17, s18
    s_lshl_b32 s18, s29, 16
    s_add_u32 s17, s17, s18
    v_lshlrev_b32 v15, 7, v1
    s_waitcnt lgkmcnt(0)
    buffer_load_dword v248, v15, s[40:43], s17 offen
    s_add_u32 s17, s17, 8192
    buffer_load_dword v249, v15, s[40:43], s17 offen
    s_add_u32 s17, s17, 8192
    buffer_load_dword v250, v15, s[40:43], s17 offen
    s_add_u32 s17, s17, 8192
    buffer_load_dword v251, v15, s[40:43], s17 offen
    s_add_u32 s17, s17, 8192
    s_lshl_b32 s34, s93, 2
    s_add_u32 s34, s34, s16
    s_lshl_b32 s34, s34, 13
    s_sub_u32 s34, s34, 262144
    v_mov_b32 v247, v15
    s_lshl_b32 s17, s29, 6
    v_add_u32 v246, s17, v1
    v_mul_u32_u24 v246, 1026, v246
    s_lshl_b32 s17, s28, 8
    v_add_u32 v246, s17, v246
    v_and_b32 v246, -4, v246
    s_load_dwordx2 s[8:9], s[0:1], 0
    s_mov_b32 s10, 4194304
    s_mov_b32 s11, 0x20000
    s_waitcnt lgkmcnt(0)
    v_and_b32 v5, 15, v1
    v_bfe_u32 v6, v1, 1, 3
    v_lshrrev_b32 v7, 4, v1
    v_xor_b32 v6, v6, v7
    v_lshlrev_b32 v6, 4, v6
    v_lshl_add_u32 v10, v5, 7, v6
    s_lshl_b32 s19, s16, 10
    v_xor_b32 v11, 64, v10
    v_add_u32 v12, 0x10000, v10
    v_add_u32 v13, 0x10000, v11
    v_lshrrev_b32 v7, 3, v1
    s_lshl_b32 s17, s16, 3
    v_add_u32 v7, s17, v7
    v_bfe_u32 v8, v7, 1, 3
    v_xor_b32 v8, v8, v1
    v_and_b32 v8, 7, v8
    v_bfe_u32 v5, v7, 2, 2
    v_and_b32 v2, 3, v7
    v_lshl_add_u32 v2, v5, 3, v2
    v_bfe_u32 v5, v7, 4, 1
    v_lshl_add_u32 v2, v5, 2, v2
    v_bfe_u32 v5, v1, 2, 2
    v_and_b32 v3, 3, v1
    v_lshl_add_u32 v3, v5, 3, v3
    v_lshlrev_b32 v2, 16, v2
    v_lshl_add_u32 v2, v8, 4, v2
    v_and_b32 v5, 48, v1
    v_lshl_add_u32 v3, v3, 6, v5
    s_mul_i32 s21, s29, 139776
    s_mul_i32 s17, s28, 34816
    s_add_u32 s21, s21, s17
    s_add_u32 s21, s21, 104857600
    s_and_b32 s20, s28, 1
    s_lshl_b32 s20, s20, 15
    s_lshr_b32 s17, s28, 1
    s_lshl_b32 s17, s17, 21
    s_add_u32 s20, s20, s17
    s_mov_b32 s24, 2048
    s_mov_b32 s25, 2176
    s_barrier
    s_mov_b32 s26, s25
    s_sub_u32 s25, s21, 1073741824
    s_mov_b32 s21, 1073741824
    s_mov_b32 s23, 0
    s_mov_b32 s22, 0
    s_add_u32 m0, s19, 0
    s_nop 0
    buffer_load_dwordx4 v2, s[8:11], s20 offen offset:0 lds
    s_add_u32 m0, s19, 3968
    s_nop 0
    buffer_load_dwordx4 v2, s[8:11], s20 offen offset:128 lds
    s_add_u32 m0, s19, 7936
    s_nop 0
    buffer_load_dwordx4 v2, s[8:11], s20 offen offset:256 lds
    s_add_u32 m0, s19, 11904
    s_nop 0
    buffer_load_dwordx4 v2, s[8:11], s20 offen offset:384 lds
    s_add_u32 m0, s19, 15872
    s_nop 0
    buffer_load_dwordx4 v2, s[8:11], s20 offen offset:512 lds
    s_add_u32 m0, s19, 19840
    s_nop 0
    buffer_load_dwordx4 v2, s[8:11], s20 offen offset:640 lds
    s_add_u32 m0, s19, 23808
    s_nop 0
    buffer_load_dwordx4 v2, s[8:11], s20 offen offset:768 lds
    s_add_u32 m0, s19, 27776
    s_nop 0
    buffer_load_dwordx4 v2, s[8:11], s20 offen offset:896 lds
    s_add_u32 m0, s19, 31744
    s_nop 0
    buffer_load_dwordx4 v2, s[8:11], s20 offen offset:1024 lds
    s_add_u32 m0, s19, 35712
    s_nop 0
    buffer_load_dwordx4 v2, s[8:11], s20 offen offset:1152 lds
    s_add_u32 m0, s19, 39680
    s_nop 0
    buffer_load_dwordx4 v2, s[8:11], s20 offen offset:1280 lds
    s_add_u32 m0, s19, 43648
    s_nop 0
    buffer_load_dwordx4 v2, s[8:11], s20 offen offset:1408 lds
    s_add_u32 m0, s19, 47616
    s_nop 0
    buffer_load_dwordx4 v2, s[8:11], s20 offen offset:1536 lds
    s_add_u32 m0, s19, 51584
    s_nop 0
    buffer_load_dwordx4 v2, s[8:11], s20 offen offset:1664 lds
    s_add_u32 m0, s19, 55552
    s_nop 0
    buffer_load_dwordx4 v2, s[8:11], s20 offen offset:1792 lds
    s_add_u32 m0, s19, 59520
    s_nop 0
    buffer_load_dwordx4 v2, s[8:11], s20 offen offset:1920 lds
    s_add_u32 s20, s20, s24
    s_add_u32 m0, s19, 65536
    s_nop 0
    buffer_load_dwordx4 v2, s[8:11], s20 offen offset:0 lds
    s_add_u32 m0, s19, 69504
    s_nop 0
    buffer_load_dwordx4 v2, s[8:11], s20 offen offset:128 lds
    s_add_u32 m0, s19, 73472
    s_nop 0
    buffer_load_dwordx4 v2, s[8:11], s20 offen offset:256 lds
    s_waitcnt vmcnt(11)
    s_barrier
    ds_read_b128 v[20:23], v10 offset:0
    ds_read_b128 v[24:27], v10 offset:2048
    ds_read_b128 v[28:31], v11 offset:0
    ds_read_b128 v[32:35], v11 offset:2048
    ds_read_b128 v[36:39], v10 offset:4096
    ds_read_b128 v[40:43], v10 offset:6144
    ds_read_b128 v[44:47], v11 offset:4096
.p2align 6
F1_top:
    s_waitcnt lgkmcnt(6)
    v_mfma_f32_16x16x32_bf16 v[52:55], v[20:23], a[0:3], 0
    ds_read_b128 v[48:51], v11 offset:6144
    v_mfma_f32_16x16x32_bf16 v[60:63], v[20:23], a[4:7], 0
    s_waitcnt lgkmcnt(6)
    v_mfma_f32_16x16x32_bf16 v[56:59], v[24:27], a[0:3], 0
    ds_read_b128 v[20:23], v10 offset:8192
    s_add_u32 m0, s19, 77440
    v_mfma_f32_16x16x32_bf16 v[64:67], v[24:27], a[4:7], 0
    buffer_load_dwordx4 v2, s[8:11], s20 offen offset:384 lds
    s_waitcnt lgkmcnt(6)
    v_mfma_f32_16x16x32_bf16 v[52:55], v[28:31], a[8:11], v[52:55]
    ds_read_b128 v[24:27], v10 offset:10240
    v_mfma_f32_16x16x32_bf16 v[60:63], v[28:31], a[12:15], v[60:63]
    s_waitcnt lgkmcnt(6)
    v_mfma_f32_16x16x32_bf16 v[56:59], v[32:35], a[8:11], v[56:59]
    ds_read_b128 v[28:31], v11 offset:8192
    s_add_u32 m0, s19, 81408
    v_mfma_f32_16x16x32_bf16 v[64:67], v[32:35], a[12:15], v[64:67]
    buffer_load_dwordx4 v2, s[8:11], s20 offen offset:512 lds
    s_waitcnt lgkmcnt(6)
    v_mfma_f32_16x16x32_bf16 v[52:55], v[36:39], a[16:19], v[52:55]
    ds_read_b128 v[32:35], v11 offset:10240
    v_mfma_f32_16x16x32_bf16 v[60:63], v[36:39], a[20:23], v[60:63]
    s_waitcnt lgkmcnt(6)
    v_mfma_f32_16x16x32_bf16 v[56:59], v[40:43], a[16:19], v[56:59]
    ds_read_b128 v[36:39], v10 offset:12288
    s_add_u32 m0, s19, 85376
    v_mfma_f32_16x16x32_bf16 v[64:67], v[40:43], a[20:23], v[64:67]
    buffer_load_dwordx4 v2, s[8:11], s20 offen offset:640 lds
    s_waitcnt lgkmcnt(6)
    v_mfma_f32_16x16x32_bf16 v[52:55], v[44:47], a[24:27], v[52:55]
    ds_read_b128 v[40:43], v10 offset:14336
    v_mfma_f32_16x16x32_bf16 v[60:63], v[44:47], a[28:31], v[60:63]
    s_waitcnt lgkmcnt(6)
    v_mfma_f32_16x16x32_bf16 v[56:59], v[48:51], a[24:27], v[56:59]
    ds_read_b128 v[44:47], v11 offset:12288
    s_add_u32 m0, s19, 89344
    v_mfma_f32_16x16x32_bf16 v[64:67], v[48:51], a[28:31], v[64:67]
    buffer_load_dwordx4 v2, s[8:11], s20 offen offset:768 lds
    s_waitcnt lgkmcnt(6)
    v_mfma_f32_16x16x32_bf16 v[52:55], v[20:23], a[32:35], v[52:55]
    ds_read_b128 v[48:51], v11 offset:14336
    v_mfma_f32_16x16x32_bf16 v[60:63], v[20:23], a[36:39], v[60:63]
    s_waitcnt lgkmcnt(6)
    v_mfma_f32_16x16x32_bf16 v[56:59], v[24:27], a[32:35], v[56:59]
    ds_read_b128 v[20:23], v10 offset:16384
    s_add_u32 m0, s19, 93312
    v_mfma_f32_16x16x32_bf16 v[64:67], v[24:27], a[36:39], v[64:67]
    buffer_load_dwordx4 v2, s[8:11], s20 offen offset:896 lds
    s_waitcnt lgkmcnt(6)
    v_mfma_f32_16x16x32_bf16 v[52:55], v[28:31], a[40:43], v[52:55]
    ds_read_b128 v[24:27], v10 offset:18432
    v_mfma_f32_16x16x32_bf16 v[60:63], v[28:31], a[44:47], v[60:63]
    v_cvt_pk_bf16_f32 v84, v68, v69
    s_waitcnt lgkmcnt(6)
    v_mfma_f32_16x16x32_bf16 v[56:59], v[32:35], a[40:43], v[56:59]
    ds_read_b128 v[28:31], v11 offset:16384
    v_mfma_f32_16x16x32_bf16 v[64:67], v[32:35], a[44:47], v[64:67]
    v_cvt_pk_bf16_f32 v85, v70, v71
    s_waitcnt lgkmcnt(6)
    v_mfma_f32_16x16x32_bf16 v[52:55], v[36:39], a[48:51], v[52:55]
    ds_read_b128 v[32:35], v11 offset:18432
    v_mfma_f32_16x16x32_bf16 v[60:63], v[36:39], a[52:55], v[60:63]
    v_cvt_pk_bf16_f32 v86, v72, v73
    s_waitcnt lgkmcnt(6)
    v_mfma_f32_16x16x32_bf16 v[56:59], v[40:43], a[48:51], v[56:59]
    ds_read_b128 v[36:39], v10 offset:20480
    v_mfma_f32_16x16x32_bf16 v[64:67], v[40:43], a[52:55], v[64:67]
    v_cvt_pk_bf16_f32 v87, v74, v75
    s_waitcnt lgkmcnt(6)
    v_mfma_f32_16x16x32_bf16 v[52:55], v[44:47], a[56:59], v[52:55]
    ds_read_b128 v[40:43], v10 offset:22528
    v_mfma_f32_16x16x32_bf16 v[60:63], v[44:47], a[60:63], v[60:63]
    v_cvt_pk_bf16_f32 v88, v76, v77
    s_waitcnt lgkmcnt(6)
    v_mfma_f32_16x16x32_bf16 v[56:59], v[48:51], a[56:59], v[56:59]
    ds_read_b128 v[44:47], v11 offset:20480
    v_mfma_f32_16x16x32_bf16 v[64:67], v[48:51], a[60:63], v[64:67]
    v_cvt_pk_bf16_f32 v89, v78, v79
    buffer_store_dwordx4 v[84:87], v3, s[4:7], s21 offen offset:0 sc1
    s_waitcnt lgkmcnt(6)
    v_mfma_f32_16x16x32_bf16 v[52:55], v[20:23], a[64:67], v[52:55]
    ds_read_b128 v[48:51], v11 offset:22528
    v_mfma_f32_16x16x32_bf16 v[60:63], v[20:23], a[68:71], v[60:63]
    v_cvt_pk_bf16_f32 v90, v80, v81
    s_waitcnt lgkmcnt(6)
    v_mfma_f32_16x16x32_bf16 v[56:59], v[24:27], a[64:67], v[56:59]
    ds_read_b128 v[20:23], v10 offset:24576
    v_mfma_f32_16x16x32_bf16 v[64:67], v[24:27], a[68:71], v[64:67]
    v_cvt_pk_bf16_f32 v91, v82, v83
    s_waitcnt lgkmcnt(6)
    v_mfma_f32_16x16x32_bf16 v[52:55], v[28:31], a[72:75], v[52:55]
    ds_read_b128 v[24:27], v10 offset:26624
    v_mfma_f32_16x16x32_bf16 v[60:63], v[28:31], a[76:79], v[60:63]
    s_waitcnt lgkmcnt(6)
    v_mfma_f32_16x16x32_bf16 v[56:59], v[32:35], a[72:75], v[56:59]
    ds_read_b128 v[28:31], v11 offset:24576
    v_mfma_f32_16x16x32_bf16 v[64:67], v[32:35], a[76:79], v[64:67]
    buffer_store_dwordx4 v[88:91], v3, s[4:7], s21 offen offset:256 sc1
    s_waitcnt lgkmcnt(6)
    v_mfma_f32_16x16x32_bf16 v[52:55], v[36:39], a[80:83], v[52:55]
    ds_read_b128 v[32:35], v11 offset:26624
    v_mfma_f32_16x16x32_bf16 v[60:63], v[36:39], a[84:87], v[60:63]
    s_add_u32 s21, s21, s25
    s_mov_b32 s25, s26
    s_waitcnt lgkmcnt(6)
    v_mfma_f32_16x16x32_bf16 v[56:59], v[40:43], a[80:83], v[56:59]
    ds_read_b128 v[36:39], v10 offset:28672
    v_mfma_f32_16x16x32_bf16 v[64:67], v[40:43], a[84:87], v[64:67]
    s_waitcnt lgkmcnt(6)
    v_mfma_f32_16x16x32_bf16 v[52:55], v[44:47], a[88:91], v[52:55]
    ds_read_b128 v[40:43], v10 offset:30720
    v_mfma_f32_16x16x32_bf16 v[60:63], v[44:47], a[92:95], v[60:63]
    buffer_load_dword v248, v247, s[44:47], s34 offen
    s_add_u32 s34, s34, 1048576
    s_sub_u32 s31, s22, 10
    s_lshl_b32 s31, s31, 6
    s_cmp_lt_u32 s31, 384
    s_cselect_b32 s31, s31, 1073741824
    buffer_load_dword v249, v246, s[48:51], s31 offen
    buffer_load_dword v250, v246, s[52:55], s31 offen
    s_waitcnt lgkmcnt(6)
    v_mfma_f32_16x16x32_bf16 v[56:59], v[48:51], a[88:91], v[56:59]
    ds_read_b128 v[44:47], v11 offset:28672
    v_mfma_f32_16x16x32_bf16 v[64:67], v[48:51], a[92:95], v[64:67]
    s_waitcnt lgkmcnt(6)
    v_mfma_f32_16x16x32_bf16 v[52:55], v[20:23], a[96:99], v[52:55]
    ds_read_b128 v[48:51], v11 offset:30720
    v_mfma_f32_16x16x32_bf16 v[60:63], v[20:23], a[100:103], v[60:63]
    s_waitcnt lgkmcnt(6)
    v_mfma_f32_16x16x32_bf16 v[56:59], v[24:27], a[96:99], v[56:59]
    s_waitcnt vmcnt(13)
    s_barrier
    ds_read_b128 v[20:23], v10 offset:32768
    v_mfma_f32_16x16x32_bf16 v[64:67], v[24:27], a[100:103], v[64:67]
    s_waitcnt lgkmcnt(6)
    v_mfma_f32_16x16x32_bf16 v[52:55], v[28:31], a[104:107], v[52:55]
    ds_read_b128 v[24:27], v10 offset:34816
    s_add_u32 m0, s19, 97280
    v_mfma_f32_16x16x32_bf16 v[60:63], v[28:31], a[108:111], v[60:63]
    buffer_load_dwordx4 v2, s[8:11], s20 offen offset:1024 lds
    s_waitcnt lgkmcnt(6)
    v_mfma_f32_16x16x32_bf16 v[56:59], v[32:35], a[104:107], v[56:59]
    ds_read_b128 v[28:31], v11 offset:32768
    v_mfma_f32_16x16x32_bf16 v[64:67], v[32:35], a[108:111], v[64:67]
    s_waitcnt lgkmcnt(6)
    v_mfma_f32_16x16x32_bf16 v[52:55], v[36:39], a[112:115], v[52:55]
    ds_read_b128 v[32:35], v11 offset:34816
    s_add_u32 m0, s19, 101248
    v_mfma_f32_16x16x32_bf16 v[60:63], v[36:39], a[116:119], v[60:63]
    buffer_load_dwordx4 v2, s[8:11], s20 offen offset:1152 lds
    s_waitcnt lgkmcnt(6)
    v_mfma_f32_16x16x32_bf16 v[56:59], v[40:43], a[112:115], v[56:59]
    ds_read_b128 v[36:39], v10 offset:36864
    v_mfma_f32_16x16x32_bf16 v[64:67], v[40:43], a[116:119], v[64:67]
    s_waitcnt lgkmcnt(6)
    v_mfma_f32_16x16x32_bf16 v[52:55], v[44:47], a[120:123], v[52:55]
    ds_read_b128 v[40:43], v10 offset:38912
    s_add_u32 m0, s19, 105216
    v_mfma_f32_16x16x32_bf16 v[60:63], v[44:47], a[124:127], v[60:63]
    buffer_load_dwordx4 v2, s[8:11], s20 offen offset:1280 lds
    s_waitcnt lgkmcnt(6)
    v_mfma_f32_16x16x32_bf16 v[56:59], v[48:51], a[120:123], v[56:59]
    ds_read_b128 v[44:47], v11 offset:36864
    v_mfma_f32_16x16x32_bf16 v[64:67], v[48:51], a[124:127], v[64:67]
    s_waitcnt lgkmcnt(6)
    v_mfma_f32_16x16x32_bf16 v[52:55], v[20:23], a[128:131], v[52:55]
    ds_read_b128 v[48:51], v11 offset:38912
    v_mfma_f32_16x16x32_bf16 v[60:63], v[20:23], a[132:135], v[60:63]
    s_waitcnt lgkmcnt(6)
    v_mfma_f32_16x16x32_bf16 v[56:59], v[24:27], a[128:131], v[56:59]
    ds_read_b128 v[20:23], v10 offset:40960
    s_add_u32 m0, s19, 109184
    v_mfma_f32_16x16x32_bf16 v[64:67], v[24:27], a[132:135], v[64:67]
    buffer_load_dwordx4 v2, s[8:11], s20 offen offset:1408 lds
    s_waitcnt lgkmcnt(6)
    v_mfma_f32_16x16x32_bf16 v[52:55], v[28:31], a[136:139], v[52:55]
    ds_read_b128 v[24:27], v10 offset:43008
    v_mfma_f32_16x16x32_bf16 v[60:63], v[28:31], a[140:143], v[60:63]
    s_waitcnt lgkmcnt(6)
    v_mfma_f32_16x16x32_bf16 v[56:59], v[32:35], a[136:139], v[56:59]
    ds_read_b128 v[28:31], v11 offset:40960
    s_add_u32 m0, s19, 113152
    v_mfma_f32_16x16x32_bf16 v[64:67], v[32:35], a[140:143], v[64:67]
    buffer_load_dwordx4 v2, s[8:11], s20 offen offset:1536 lds
    s_waitcnt lgkmcnt(6)
    v_mfma_f32_16x16x32_bf16 v[52:55], v[36:39], a[144:147], v[52:55]
    ds_read_b128 v[32:35], v11 offset:43008
    v_mfma_f32_16x16x32_bf16 v[60:63], v[36:39], a[148:151], v[60:63]
    s_waitcnt lgkmcnt(6)
    v_mfma_f32_16x16x32_bf16 v[56:59], v[40:43], a[144:147], v[56:59]
    ds_read_b128 v[36:39], v10 offset:45056
    s_add_u32 m0, s19, 117120
    v_mfma_f32_16x16x32_bf16 v[64:67], v[40:43], a[148:151], v[64:67]
    buffer_load_dwordx4 v2, s[8:11], s20 offen offset:1664 lds
    s_waitcnt lgkmcnt(6)
    v_mfma_f32_16x16x32_bf16 v[52:55], v[44:47], a[152:155], v[52:55]
    ds_read_b128 v[40:43], v10 offset:47104
    v_mfma_f32_16x16x32_bf16 v[60:63], v[44:47], a[156:159], v[60:63]
    s_waitcnt lgkmcnt(6)
    v_mfma_f32_16x16x32_bf16 v[56:59], v[48:51], a[152:155], v[56:59]
    ds_read_b128 v[44:47], v11 offset:45056
    s_add_u32 m0, s19, 121088
    v_mfma_f32_16x16x32_bf16 v[64:67], v[48:51], a[156:159], v[64:67]
    buffer_load_dwordx4 v2, s[8:11], s20 offen offset:1792 lds
    s_waitcnt lgkmcnt(6)
    v_mfma_f32_16x16x32_bf16 v[52:55], v[20:23], a[160:163], v[52:55]
    ds_read_b128 v[48:51], v11 offset:47104
    v_mfma_f32_16x16x32_bf16 v[60:63], v[20:23], a[164:167], v[60:63]
    s_waitcnt lgkmcnt(6)
    v_mfma_f32_16x16x32_bf16 v[56:59], v[24:27], a[160:163], v[56:59]
    ds_read_b128 v[20:23], v10 offset:49152
    s_add_u32 m0, s19, 125056
    v_mfma_f32_16x16x32_bf16 v[64:67], v[24:27], a[164:167], v[64:67]
    buffer_load_dwordx4 v2, s[8:11], s20 offen offset:1920 lds
    s_waitcnt lgkmcnt(6)
    v_mfma_f32_16x16x32_bf16 v[52:55], v[28:31], a[168:171], v[52:55]
    ds_read_b128 v[24:27], v10 offset:51200
    v_mfma_f32_16x16x32_bf16 v[60:63], v[28:31], a[172:175], v[60:63]
    s_add_u32 s20, s20, s24
    s_waitcnt lgkmcnt(6)
    v_mfma_f32_16x16x32_bf16 v[56:59], v[32:35], a[168:171], v[56:59]
    ds_read_b128 v[28:31], v11 offset:49152
    v_mfma_f32_16x16x32_bf16 v[64:67], v[32:35], a[172:175], v[64:67]
    s_waitcnt lgkmcnt(6)
    v_mfma_f32_16x16x32_bf16 v[52:55], v[36:39], a[176:179], v[52:55]
    ds_read_b128 v[32:35], v11 offset:51200
    v_mfma_f32_16x16x32_bf16 v[60:63], v[36:39], a[180:183], v[60:63]
    s_waitcnt lgkmcnt(6)
    v_mfma_f32_16x16x32_bf16 v[56:59], v[40:43], a[176:179], v[56:59]
    ds_read_b128 v[36:39], v10 offset:53248
    v_mfma_f32_16x16x32_bf16 v[64:67], v[40:43], a[180:183], v[64:67]
    s_waitcnt lgkmcnt(6)
    v_mfma_f32_16x16x32_bf16 v[52:55], v[44:47], a[184:187], v[52:55]
    ds_read_b128 v[40:43], v10 offset:55296
    v_mfma_f32_16x16x32_bf16 v[60:63], v[44:47], a[188:191], v[60:63]
    s_waitcnt lgkmcnt(6)
    v_mfma_f32_16x16x32_bf16 v[56:59], v[48:51], a[184:187], v[56:59]
    ds_read_b128 v[44:47], v11 offset:53248
    v_mfma_f32_16x16x32_bf16 v[64:67], v[48:51], a[188:191], v[64:67]
    s_waitcnt lgkmcnt(6)
    v_mfma_f32_16x16x32_bf16 v[52:55], v[20:23], a[192:195], v[52:55]
    ds_read_b128 v[48:51], v11 offset:55296
    v_mfma_f32_16x16x32_bf16 v[60:63], v[20:23], a[196:199], v[60:63]
    s_waitcnt lgkmcnt(6)
    v_mfma_f32_16x16x32_bf16 v[56:59], v[24:27], a[192:195], v[56:59]
    ds_read_b128 v[20:23], v10 offset:57344
    v_mfma_f32_16x16x32_bf16 v[64:67], v[24:27], a[196:199], v[64:67]
    s_waitcnt lgkmcnt(6)
    v_mfma_f32_16x16x32_bf16 v[52:55], v[28:31], a[200:203], v[52:55]
    ds_read_b128 v[24:27], v10 offset:59392
    v_mfma_f32_16x16x32_bf16 v[60:63], v[28:31], a[204:207], v[60:63]
    s_waitcnt lgkmcnt(6)
    v_mfma_f32_16x16x32_bf16 v[56:59], v[32:35], a[200:203], v[56:59]
    ds_read_b128 v[28:31], v11 offset:57344
    v_mfma_f32_16x16x32_bf16 v[64:67], v[32:35], a[204:207], v[64:67]
    s_waitcnt lgkmcnt(6)
    v_mfma_f32_16x16x32_bf16 v[52:55], v[36:39], a[208:211], v[52:55]
    ds_read_b128 v[32:35], v11 offset:59392
    v_mfma_f32_16x16x32_bf16 v[60:63], v[36:39], a[212:215], v[60:63]
    s_waitcnt lgkmcnt(6)
    v_mfma_f32_16x16x32_bf16 v[56:59], v[40:43], a[208:211], v[56:59]
    ds_read_b128 v[36:39], v10 offset:61440
    v_mfma_f32_16x16x32_bf16 v[64:67], v[40:43], a[212:215], v[64:67]
    s_waitcnt lgkmcnt(6)
    v_mfma_f32_16x16x32_bf16 v[52:55], v[44:47], a[216:219], v[52:55]
    ds_read_b128 v[40:43], v10 offset:63488
    v_mfma_f32_16x16x32_bf16 v[60:63], v[44:47], a[220:223], v[60:63]
    s_waitcnt lgkmcnt(6)
    v_mfma_f32_16x16x32_bf16 v[56:59], v[48:51], a[216:219], v[56:59]
    ds_read_b128 v[44:47], v11 offset:61440
    v_mfma_f32_16x16x32_bf16 v[64:67], v[48:51], a[220:223], v[64:67]
    s_waitcnt lgkmcnt(6)
    v_mfma_f32_16x16x32_bf16 v[52:55], v[20:23], a[224:227], v[52:55]
    ds_read_b128 v[48:51], v11 offset:63488
    v_mfma_f32_16x16x32_bf16 v[60:63], v[20:23], a[228:231], v[60:63]
    s_waitcnt lgkmcnt(6)
    v_mfma_f32_16x16x32_bf16 v[56:59], v[24:27], a[224:227], v[56:59]
    s_waitcnt vmcnt(8)
    s_barrier
    ds_read_b128 v[20:23], v12 offset:0
    v_mfma_f32_16x16x32_bf16 v[64:67], v[24:27], a[228:231], v[64:67]
    s_waitcnt lgkmcnt(6)
    v_mfma_f32_16x16x32_bf16 v[52:55], v[28:31], a[232:235], v[52:55]
    ds_read_b128 v[24:27], v12 offset:2048
    s_add_u32 m0, s19, 0
    v_mfma_f32_16x16x32_bf16 v[60:63], v[28:31], a[236:239], v[60:63]
    buffer_load_dwordx4 v2, s[8:11], s20 offen offset:0 lds
    s_waitcnt lgkmcnt(6)
    v_mfma_f32_16x16x32_bf16 v[56:59], v[32:35], a[232:235], v[56:59]
    ds_read_b128 v[28:31], v13 offset:0
    v_mfma_f32_16x16x32_bf16 v[64:67], v[32:35], a[236:239], v[64:67]
    s_waitcnt lgkmcnt(6)
    v_mfma_f32_16x16x32_bf16 v[52:55], v[36:39], a[240:243], v[52:55]
    ds_read_b128 v[32:35], v13 offset:2048
    s_add_u32 m0, s19, 3968
    v_mfma_f32_16x16x32_bf16 v[60:63], v[36:39], a[244:247], v[60:63]
    buffer_load_dwordx4 v2, s[8:11], s20 offen offset:128 lds
    s_waitcnt lgkmcnt(6)
    v_mfma_f32_16x16x32_bf16 v[56:59], v[40:43], a[240:243], v[56:59]
    ds_read_b128 v[36:39], v12 offset:4096
    v_mfma_f32_16x16x32_bf16 v[64:67], v[40:43], a[244:247], v[64:67]
    s_waitcnt lgkmcnt(6)
    v_mfma_f32_16x16x32_bf16 v[52:55], v[44:47], a[248:251], v[52:55]
    ds_read_b128 v[40:43], v12 offset:6144
    s_add_u32 m0, s19, 7936
    v_mfma_f32_16x16x32_bf16 v[60:63], v[44:47], a[252:255], v[60:63]
    buffer_load_dwordx4 v2, s[8:11], s20 offen offset:256 lds
    s_waitcnt lgkmcnt(6)
    v_mfma_f32_16x16x32_bf16 v[56:59], v[48:51], a[248:251], v[56:59]
    ds_read_b128 v[44:47], v13 offset:4096
    v_mfma_f32_16x16x32_bf16 v[64:67], v[48:51], a[252:255], v[64:67]
    s_waitcnt lgkmcnt(6)
    v_mfma_f32_16x16x32_bf16 v[68:71], v[20:23], a[0:3], 0
    ds_read_b128 v[48:51], v13 offset:6144
    v_mfma_f32_16x16x32_bf16 v[76:79], v[20:23], a[4:7], 0
    s_waitcnt lgkmcnt(6)
    v_mfma_f32_16x16x32_bf16 v[72:75], v[24:27], a[0:3], 0
    ds_read_b128 v[20:23], v12 offset:8192
    s_add_u32 m0, s19, 11904
    v_mfma_f32_16x16x32_bf16 v[80:83], v[24:27], a[4:7], 0
    buffer_load_dwordx4 v2, s[8:11], s20 offen offset:384 lds
    s_waitcnt lgkmcnt(6)
    v_mfma_f32_16x16x32_bf16 v[68:71], v[28:31], a[8:11], v[68:71]
    ds_read_b128 v[24:27], v12 offset:10240
    v_mfma_f32_16x16x32_bf16 v[76:79], v[28:31], a[12:15], v[76:79]
    s_waitcnt lgkmcnt(6)
    v_mfma_f32_16x16x32_bf16 v[72:75], v[32:35], a[8:11], v[72:75]
    ds_read_b128 v[28:31], v13 offset:8192
    s_add_u32 m0, s19, 15872
    v_mfma_f32_16x16x32_bf16 v[80:83], v[32:35], a[12:15], v[80:83]
    buffer_load_dwordx4 v2, s[8:11], s20 offen offset:512 lds
    s_waitcnt lgkmcnt(6)
    v_mfma_f32_16x16x32_bf16 v[68:71], v[36:39], a[16:19], v[68:71]
    ds_read_b128 v[32:35], v13 offset:10240
    v_mfma_f32_16x16x32_bf16 v[76:79], v[36:39], a[20:23], v[76:79]
    s_waitcnt lgkmcnt(6)
    v_mfma_f32_16x16x32_bf16 v[72:75], v[40:43], a[16:19], v[72:75]
    ds_read_b128 v[36:39], v12 offset:12288
    s_add_u32 m0, s19, 19840
    v_mfma_f32_16x16x32_bf16 v[80:83], v[40:43], a[20:23], v[80:83]
    buffer_load_dwordx4 v2, s[8:11], s20 offen offset:640 lds
    s_waitcnt lgkmcnt(6)
    v_mfma_f32_16x16x32_bf16 v[68:71], v[44:47], a[24:27], v[68:71]
    ds_read_b128 v[40:43], v12 offset:14336
    v_mfma_f32_16x16x32_bf16 v[76:79], v[44:47], a[28:31], v[76:79]
    s_waitcnt lgkmcnt(6)
    v_mfma_f32_16x16x32_bf16 v[72:75], v[48:51], a[24:27], v[72:75]
    ds_read_b128 v[44:47], v13 offset:12288
    s_add_u32 m0, s19, 23808
    v_mfma_f32_16x16x32_bf16 v[80:83], v[48:51], a[28:31], v[80:83]
    buffer_load_dwordx4 v2, s[8:11], s20 offen offset:768 lds
    s_waitcnt lgkmcnt(6)
    v_mfma_f32_16x16x32_bf16 v[68:71], v[20:23], a[32:35], v[68:71]
    ds_read_b128 v[48:51], v13 offset:14336
    v_mfma_f32_16x16x32_bf16 v[76:79], v[20:23], a[36:39], v[76:79]
    s_waitcnt lgkmcnt(6)
    v_mfma_f32_16x16x32_bf16 v[72:75], v[24:27], a[32:35], v[72:75]
    ds_read_b128 v[20:23], v12 offset:16384
    s_add_u32 m0, s19, 27776
    v_mfma_f32_16x16x32_bf16 v[80:83], v[24:27], a[36:39], v[80:83]
    buffer_load_dwordx4 v2, s[8:11], s20 offen offset:896 lds
    s_waitcnt lgkmcnt(6)
    v_mfma_f32_16x16x32_bf16 v[68:71], v[28:31], a[40:43], v[68:71]
    ds_read_b128 v[24:27], v12 offset:18432
    v_mfma_f32_16x16x32_bf16 v[76:79], v[28:31], a[44:47], v[76:79]
    v_cvt_pk_bf16_f32 v84, v52, v53
    s_waitcnt lgkmcnt(6)
    v_mfma_f32_16x16x32_bf16 v[72:75], v[32:35], a[40:43], v[72:75]
    ds_read_b128 v[28:31], v13 offset:16384
    v_mfma_f32_16x16x32_bf16 v[80:83], v[32:35], a[44:47], v[80:83]
    v_cvt_pk_bf16_f32 v85, v54, v55
    s_waitcnt lgkmcnt(6)
    v_mfma_f32_16x16x32_bf16 v[68:71], v[36:39], a[48:51], v[68:71]
    ds_read_b128 v[32:35], v13 offset:18432
    v_mfma_f32_16x16x32_bf16 v[76:79], v[36:39], a[52:55], v[76:79]
    v_cvt_pk_bf16_f32 v86, v56, v57
    s_waitcnt lgkmcnt(6)
    v_mfma_f32_16x16x32_bf16 v[72:75], v[40:43], a[48:51], v[72:75]
    ds_read_b128 v[36:39], v12 offset:20480
    v_mfma_f32_16x16x32_bf16 v[80:83], v[40:43], a[52:55], v[80:83]
    v_cvt_pk_bf16_f32 v87, v58, v59
    s_waitcnt lgkmcnt(6)
    v_mfma_f32_16x16x32_bf16 v[68:71], v[44:47], a[56:59], v[68:71]
    ds_read_b128 v[40:43], v12 offset:22528
    v_mfma_f32_16x16x32_bf16 v[76:79], v[44:47], a[60:63], v[76:79]
    v_cvt_pk_bf16_f32 v88, v60, v61
    s_waitcnt lgkmcnt(6)
    v_mfma_f32_16x16x32_bf16 v[72:75], v[48:51], a[56:59], v[72:75]
    ds_read_b128 v[44:47], v13 offset:20480
    v_mfma_f32_16x16x32_bf16 v[80:83], v[48:51], a[60:63], v[80:83]
    v_cvt_pk_bf16_f32 v89, v62, v63
    buffer_store_dwordx4 v[84:87], v3, s[4:7], s21 offen offset:0 sc1
    s_waitcnt lgkmcnt(6)
    v_mfma_f32_16x16x32_bf16 v[68:71], v[20:23], a[64:67], v[68:71]
    ds_read_b128 v[48:51], v13 offset:22528
    v_mfma_f32_16x16x32_bf16 v[76:79], v[20:23], a[68:71], v[76:79]
    v_cvt_pk_bf16_f32 v90, v64, v65
    s_waitcnt lgkmcnt(6)
    v_mfma_f32_16x16x32_bf16 v[72:75], v[24:27], a[64:67], v[72:75]
    ds_read_b128 v[20:23], v12 offset:24576
    v_mfma_f32_16x16x32_bf16 v[80:83], v[24:27], a[68:71], v[80:83]
    v_cvt_pk_bf16_f32 v91, v66, v67
    s_waitcnt lgkmcnt(6)
    v_mfma_f32_16x16x32_bf16 v[68:71], v[28:31], a[72:75], v[68:71]
    ds_read_b128 v[24:27], v12 offset:26624
    v_mfma_f32_16x16x32_bf16 v[76:79], v[28:31], a[76:79], v[76:79]
    s_waitcnt lgkmcnt(6)
    v_mfma_f32_16x16x32_bf16 v[72:75], v[32:35], a[72:75], v[72:75]
    ds_read_b128 v[28:31], v13 offset:24576
    v_mfma_f32_16x16x32_bf16 v[80:83], v[32:35], a[76:79], v[80:83]
    buffer_store_dwordx4 v[88:91], v3, s[4:7], s21 offen offset:256 sc1
    s_waitcnt lgkmcnt(6)
    v_mfma_f32_16x16x32_bf16 v[68:71], v[36:39], a[80:83], v[68:71]
    ds_read_b128 v[32:35], v13 offset:26624
    v_mfma_f32_16x16x32_bf16 v[76:79], v[36:39], a[84:87], v[76:79]
    s_add_u32 s21, s21, s25
    s_mov_b32 s25, s26
    s_waitcnt lgkmcnt(6)
    v_mfma_f32_16x16x32_bf16 v[72:75], v[40:43], a[80:83], v[72:75]
    ds_read_b128 v[36:39], v12 offset:28672
    v_mfma_f32_16x16x32_bf16 v[80:83], v[40:43], a[84:87], v[80:83]
    s_waitcnt lgkmcnt(6)
    v_mfma_f32_16x16x32_bf16 v[68:71], v[44:47], a[88:91], v[68:71]
    ds_read_b128 v[40:43], v12 offset:30720
    v_mfma_f32_16x16x32_bf16 v[76:79], v[44:47], a[92:95], v[76:79]
    s_waitcnt lgkmcnt(6)
    v_mfma_f32_16x16x32_bf16 v[72:75], v[48:51], a[88:91], v[72:75]
    ds_read_b128 v[44:47], v13 offset:28672
    v_mfma_f32_16x16x32_bf16 v[80:83], v[48:51], a[92:95], v[80:83]
    s_waitcnt lgkmcnt(6)
    v_mfma_f32_16x16x32_bf16 v[68:71], v[20:23], a[96:99], v[68:71]
    ds_read_b128 v[48:51], v13 offset:30720
    v_mfma_f32_16x16x32_bf16 v[76:79], v[20:23], a[100:103], v[76:79]
    s_waitcnt lgkmcnt(6)
    v_mfma_f32_16x16x32_bf16 v[72:75], v[24:27], a[96:99], v[72:75]
    s_waitcnt vmcnt(10)
    s_barrier
    ds_read_b128 v[20:23], v12 offset:32768
    v_mfma_f32_16x16x32_bf16 v[80:83], v[24:27], a[100:103], v[80:83]
    s_waitcnt lgkmcnt(6)
    v_mfma_f32_16x16x32_bf16 v[68:71], v[28:31], a[104:107], v[68:71]
    ds_read_b128 v[24:27], v12 offset:34816
    s_add_u32 m0, s19, 31744
    v_mfma_f32_16x16x32_bf16 v[76:79], v[28:31], a[108:111], v[76:79]
    buffer_load_dwordx4 v2, s[8:11], s20 offen offset:1024 lds
    s_waitcnt lgkmcnt(6)
    v_mfma_f32_16x16x32_bf16 v[72:75], v[32:35], a[104:107], v[72:75]
    ds_read_b128 v[28:31], v13 offset:32768
    v_mfma_f32_16x16x32_bf16 v[80:83], v[32:35], a[108:111], v[80:83]
    s_waitcnt lgkmcnt(6)
    v_mfma_f32_16x16x32_bf16 v[68:71], v[36:39], a[112:115], v[68:71]
    ds_read_b128 v[32:35], v13 offset:34816
    s_add_u32 m0, s19, 35712
    v_mfma_f32_16x16x32_bf16 v[76:79], v[36:39], a[116:119], v[76:79]
    buffer_load_dwordx4 v2, s[8:11], s20 offen offset:1152 lds
    s_waitcnt lgkmcnt(6)
    v_mfma_f32_16x16x32_bf16 v[72:75], v[40:43], a[112:115], v[72:75]
    ds_read_b128 v[36:39], v12 offset:36864
    v_mfma_f32_16x16x32_bf16 v[80:83], v[40:43], a[116:119], v[80:83]
    s_waitcnt lgkmcnt(6)
    v_mfma_f32_16x16x32_bf16 v[68:71], v[44:47], a[120:123], v[68:71]
    ds_read_b128 v[40:43], v12 offset:38912
    s_add_u32 m0, s19, 39680
    v_mfma_f32_16x16x32_bf16 v[76:79], v[44:47], a[124:127], v[76:79]
    buffer_load_dwordx4 v2, s[8:11], s20 offen offset:1280 lds
    s_waitcnt lgkmcnt(6)
    v_mfma_f32_16x16x32_bf16 v[72:75], v[48:51], a[120:123], v[72:75]
    ds_read_b128 v[44:47], v13 offset:36864
    v_mfma_f32_16x16x32_bf16 v[80:83], v[48:51], a[124:127], v[80:83]
    s_waitcnt lgkmcnt(6)
    v_mfma_f32_16x16x32_bf16 v[68:71], v[20:23], a[128:131], v[68:71]
    ds_read_b128 v[48:51], v13 offset:38912
    v_mfma_f32_16x16x32_bf16 v[76:79], v[20:23], a[132:135], v[76:79]
    s_waitcnt lgkmcnt(6)
    v_mfma_f32_16x16x32_bf16 v[72:75], v[24:27], a[128:131], v[72:75]
    ds_read_b128 v[20:23], v12 offset:40960
    s_add_u32 m0, s19, 43648
    v_mfma_f32_16x16x32_bf16 v[80:83], v[24:27], a[132:135], v[80:83]
    buffer_load_dwordx4 v2, s[8:11], s20 offen offset:1408 lds
    s_waitcnt lgkmcnt(6)
    v_mfma_f32_16x16x32_bf16 v[68:71], v[28:31], a[136:139], v[68:71]
    ds_read_b128 v[24:27], v12 offset:43008
    v_mfma_f32_16x16x32_bf16 v[76:79], v[28:31], a[140:143], v[76:79]
    s_waitcnt lgkmcnt(6)
    v_mfma_f32_16x16x32_bf16 v[72:75], v[32:35], a[136:139], v[72:75]
    ds_read_b128 v[28:31], v13 offset:40960
    s_add_u32 m0, s19, 47616
    v_mfma_f32_16x16x32_bf16 v[80:83], v[32:35], a[140:143], v[80:83]
    buffer_load_dwordx4 v2, s[8:11], s20 offen offset:1536 lds
    s_waitcnt lgkmcnt(6)
    v_mfma_f32_16x16x32_bf16 v[68:71], v[36:39], a[144:147], v[68:71]
    ds_read_b128 v[32:35], v13 offset:43008
    v_mfma_f32_16x16x32_bf16 v[76:79], v[36:39], a[148:151], v[76:79]
    s_waitcnt lgkmcnt(6)
    v_mfma_f32_16x16x32_bf16 v[72:75], v[40:43], a[144:147], v[72:75]
    ds_read_b128 v[36:39], v12 offset:45056
    s_add_u32 m0, s19, 51584
    v_mfma_f32_16x16x32_bf16 v[80:83], v[40:43], a[148:151], v[80:83]
    buffer_load_dwordx4 v2, s[8:11], s20 offen offset:1664 lds
    s_waitcnt lgkmcnt(6)
    v_mfma_f32_16x16x32_bf16 v[68:71], v[44:47], a[152:155], v[68:71]
    ds_read_b128 v[40:43], v12 offset:47104
    v_mfma_f32_16x16x32_bf16 v[76:79], v[44:47], a[156:159], v[76:79]
    s_waitcnt lgkmcnt(6)
    v_mfma_f32_16x16x32_bf16 v[72:75], v[48:51], a[152:155], v[72:75]
    ds_read_b128 v[44:47], v13 offset:45056
    s_add_u32 m0, s19, 55552
    v_mfma_f32_16x16x32_bf16 v[80:83], v[48:51], a[156:159], v[80:83]
    buffer_load_dwordx4 v2, s[8:11], s20 offen offset:1792 lds
    s_waitcnt lgkmcnt(6)
    v_mfma_f32_16x16x32_bf16 v[68:71], v[20:23], a[160:163], v[68:71]
    ds_read_b128 v[48:51], v13 offset:47104
    v_mfma_f32_16x16x32_bf16 v[76:79], v[20:23], a[164:167], v[76:79]
    s_waitcnt lgkmcnt(6)
    v_mfma_f32_16x16x32_bf16 v[72:75], v[24:27], a[160:163], v[72:75]
    ds_read_b128 v[20:23], v12 offset:49152
    s_add_u32 m0, s19, 59520
    v_mfma_f32_16x16x32_bf16 v[80:83], v[24:27], a[164:167], v[80:83]
    buffer_load_dwordx4 v2, s[8:11], s20 offen offset:1920 lds
    s_waitcnt lgkmcnt(6)
    v_mfma_f32_16x16x32_bf16 v[68:71], v[28:31], a[168:171], v[68:71]
    ds_read_b128 v[24:27], v12 offset:51200
    v_mfma_f32_16x16x32_bf16 v[76:79], v[28:31], a[172:175], v[76:79]
    s_add_u32 s20, s20, s24
    s_waitcnt lgkmcnt(6)
    v_mfma_f32_16x16x32_bf16 v[72:75], v[32:35], a[168:171], v[72:75]
    ds_read_b128 v[28:31], v13 offset:49152
    v_mfma_f32_16x16x32_bf16 v[80:83], v[32:35], a[172:175], v[80:83]
    s_waitcnt lgkmcnt(6)
    v_mfma_f32_16x16x32_bf16 v[68:71], v[36:39], a[176:179], v[68:71]
    ds_read_b128 v[32:35], v13 offset:51200
    v_mfma_f32_16x16x32_bf16 v[76:79], v[36:39], a[180:183], v[76:79]
    s_waitcnt lgkmcnt(6)
    v_mfma_f32_16x16x32_bf16 v[72:75], v[40:43], a[176:179], v[72:75]
    ds_read_b128 v[36:39], v12 offset:53248
    v_mfma_f32_16x16x32_bf16 v[80:83], v[40:43], a[180:183], v[80:83]
    s_waitcnt lgkmcnt(6)
    v_mfma_f32_16x16x32_bf16 v[68:71], v[44:47], a[184:187], v[68:71]
    ds_read_b128 v[40:43], v12 offset:55296
    v_mfma_f32_16x16x32_bf16 v[76:79], v[44:47], a[188:191], v[76:79]
    s_waitcnt lgkmcnt(6)
    v_mfma_f32_16x16x32_bf16 v[72:75], v[48:51], a[184:187], v[72:75]
    ds_read_b128 v[44:47], v13 offset:53248
    v_mfma_f32_16x16x32_bf16 v[80:83], v[48:51], a[188:191], v[80:83]
    s_waitcnt lgkmcnt(6)
    v_mfma_f32_16x16x32_bf16 v[68:71], v[20:23], a[192:195], v[68:71]
    ds_read_b128 v[48:51], v13 offset:55296
    v_mfma_f32_16x16x32_bf16 v[76:79], v[20:23], a[196:199], v[76:79]
    s_waitcnt lgkmcnt(6)
    v_mfma_f32_16x16x32_bf16 v[72:75], v[24:27], a[192:195], v[72:75]
    ds_read_b128 v[20:23], v12 offset:57344
    v_mfma_f32_16x16x32_bf16 v[80:83], v[24:27], a[196:199], v[80:83]
    s_waitcnt lgkmcnt(6)
    v_mfma_f32_16x16x32_bf16 v[68:71], v[28:31], a[200:203], v[68:71]
    ds_read_b128 v[24:27], v12 offset:59392
    v_mfma_f32_16x16x32_bf16 v[76:79], v[28:31], a[204:207], v[76:79]
    s_waitcnt lgkmcnt(6)
    v_mfma_f32_16x16x32_bf16 v[72:75], v[32:35], a[200:203], v[72:75]
    ds_read_b128 v[28:31], v13 offset:57344
    v_mfma_f32_16x16x32_bf16 v[80:83], v[32:35], a[204:207], v[80:83]
    s_waitcnt lgkmcnt(6)
    v_mfma_f32_16x16x32_bf16 v[68:71], v[36:39], a[208:211], v[68:71]
    ds_read_b128 v[32:35], v13 offset:59392
    v_mfma_f32_16x16x32_bf16 v[76:79], v[36:39], a[212:215], v[76:79]
    s_waitcnt lgkmcnt(6)
    v_mfma_f32_16x16x32_bf16 v[72:75], v[40:43], a[208:211], v[72:75]
    ds_read_b128 v[36:39], v12 offset:61440
    v_mfma_f32_16x16x32_bf16 v[80:83], v[40:43], a[212:215], v[80:83]
    s_waitcnt lgkmcnt(6)
    v_mfma_f32_16x16x32_bf16 v[68:71], v[44:47], a[216:219], v[68:71]
    ds_read_b128 v[40:43], v12 offset:63488
    v_mfma_f32_16x16x32_bf16 v[76:79], v[44:47], a[220:223], v[76:79]
    s_waitcnt lgkmcnt(6)
    v_mfma_f32_16x16x32_bf16 v[72:75], v[48:51], a[216:219], v[72:75]
    ds_read_b128 v[44:47], v13 offset:61440
    v_mfma_f32_16x16x32_bf16 v[80:83], v[48:51], a[220:223], v[80:83]
    s_waitcnt lgkmcnt(6)
    v_mfma_f32_16x16x32_bf16 v[68:71], v[20:23], a[224:227], v[68:71]
    ds_read_b128 v[48:51], v13 offset:63488
    v_mfma_f32_16x16x32_bf16 v[76:79], v[20:23], a[228:231], v[76:79]
    s_waitcnt lgkmcnt(6)
    v_mfma_f32_16x16x32_bf16 v[72:75], v[24:27], a[224:227], v[72:75]
    s_waitcnt vmcnt(8)
    s_barrier
    ds_read_b128 v[20:23], v10 offset:0
    v_mfma_f32_16x16x32_bf16 v[80:83], v[24:27], a[228:231], v[80:83]
    s_waitcnt lgkmcnt(6)
    v_mfma_f32_16x16x32_bf16 v[68:71], v[28:31], a[232:235], v[68:71]
    ds_read_b128 v[24:27], v10 offset:2048
    s_add_u32 m0, s19, 65536
    v_mfma_f32_16x16x32_bf16 v[76:79], v[28:31], a[236:239], v[76:79]
    buffer_load_dwordx4 v2, s[8:11], s20 offen offset:0 lds
    s_waitcnt lgkmcnt(6)
    v_mfma_f32_16x16x32_bf16 v[72:75], v[32:35], a[232:235], v[72:75]
    ds_read_b128 v[28:31], v11 offset:0
    v_mfma_f32_16x16x32_bf16 v[80:83], v[32:35], a[236:239], v[80:83]
    s_waitcnt lgkmcnt(6)
    v_mfma_f32_16x16x32_bf16 v[68:71], v[36:39], a[240:243], v[68:71]
    ds_read_b128 v[32:35], v11 offset:2048
    s_add_u32 m0, s19, 69504
    v_mfma_f32_16x16x32_bf16 v[76:79], v[36:39], a[244:247], v[76:79]
    buffer_load_dwordx4 v2, s[8:11], s20 offen offset:128 lds
    s_waitcnt lgkmcnt(6)
    v_mfma_f32_16x16x32_bf16 v[72:75], v[40:43], a[240:243], v[72:75]
    ds_read_b128 v[36:39], v10 offset:4096
    v_mfma_f32_16x16x32_bf16 v[80:83], v[40:43], a[244:247], v[80:83]
    s_waitcnt lgkmcnt(6)
    v_mfma_f32_16x16x32_bf16 v[68:71], v[44:47], a[248:251], v[68:71]
    ds_read_b128 v[40:43], v10 offset:6144
    s_add_u32 m0, s19, 73472
    v_mfma_f32_16x16x32_bf16 v[76:79], v[44:47], a[252:255], v[76:79]
    buffer_load_dwordx4 v2, s[8:11], s20 offen offset:256 lds
    s_waitcnt lgkmcnt(6)
    v_mfma_f32_16x16x32_bf16 v[72:75], v[48:51], a[248:251], v[72:75]
    ds_read_b128 v[44:47], v11 offset:4096
    v_mfma_f32_16x16x32_bf16 v[80:83], v[48:51], a[252:255], v[80:83]
    s_add_u32 s22, s22, 2
    s_cmp_lt_u32 s22, 16
    s_cbranch_scc1 F1_top
    v_cvt_pk_bf16_f32 v84, v68, v69
    v_cvt_pk_bf16_f32 v85, v70, v71
    s_nop 0
    v_cvt_pk_bf16_f32 v86, v72, v73
    v_cvt_pk_bf16_f32 v87, v74, v75
    v_cvt_pk_bf16_f32 v88, v76, v77
    v_cvt_pk_bf16_f32 v89, v78, v79
    v_cvt_pk_bf16_f32 v90, v80, v81
    v_cvt_pk_bf16_f32 v91, v82, v83
    buffer_store_dwordx4 v[84:87], v3, s[4:7], s21 offen offset:0 sc1
    buffer_store_dwordx4 v[88:91], v3, s[4:7], s21 offen offset:256 sc1
    s_waitcnt vmcnt(0) lgkmcnt(0)
    v_lshlrev_b32 v5, 2, v1
    s_mov_b32 s18, 0
rdv_17:
    global_load_dword v6, v5, s[100:101] sc1
    s_lshl_b32 s17, s98, 2
    s_waitcnt vmcnt(0)
    v_lshrrev_b32 v9, s17, v6
    s_cmp_eq_u32 s98, 0
    s_cselect_b32 s17, 0x0f0f0f0f, s17
    s_cselect_b32 s17, s17, 0x01010101
    v_and_b32 v9, s17, v9
    v_cmp_ne_u32 vcc, 0x01010101, v9
    s_nop 0
    s_cbranch_vccz rdvok_18
    v_sad_u8 v9, v9, 0, 0
    s_nop 1
    v_add_u32_dpp v9, v9, v9 quad_perm:[1,0,3,2] row_mask:0xf bank_mask:0xf
    v_cmp_ne_u32 vcc, 8, v9
    s_nop 0
    s_cbranch_vccnz rdvw_19
    s_mov_b32 s98, 1
    s_and_b32 s3, s97, 7
    s_barrier
    s_branch role_start
rdvw_19:
    s_sleep 4
    s_add_u32 s18, s18, 1
    s_cmp_lt_u32 s18, 262144
    s_cbranch_scc1 rdv_17
    s_mov_b32 s92, 1048576
rdvok_18:
    s_barrier
    s_lshl_b32 s31, s29, 2
    s_add_u32 s31, s31, s28
    s_lshl_b32 s17, s31, 7
    s_add_u32 s17, s17, 100745216
    v_lshl_add_u32 v5, v1, 2, s17
    v_mov_b32 v6, 1
    s_mov_b64 exec, 0xffffffff
    buffer_store_dword v6, v5, s[4:7], 0 offen sc1
    s_mov_b64 exec, -1
    v_and_b32 v10, 19, v1
    v_bfe_u32 v5, v1, 2, 1
    v_bfe_u32 v6, v1, 3, 1
    v_lshl_add_u32 v10, v5, 3, v10
    v_lshl_add_u32 v10, v6, 2, v10
    v_lshrrev_b32 v8, 1, v1
    v_and_b32 v19, 19, v8
    v_bfe_u32 v5, v8, 2, 1
    v_bfe_u32 v6, v8, 3, 1
    v_lshl_add_u32 v19, v5, 3, v19
    v_lshl_add_u32 v19, v6, 2, v19
    s_load_dwordx2 s[12:13], s[0:1], 80
    s_mov_b32 s14, 8388608
    s_mov_b32 s15, 0x20000
    v_lshrrev_b32 v11, 5, v1
    v_lshl_add_u32 v12, v11, 9, v10
    v_mul_u32_u24 v12, 1026, v12
    v_and_b32 v13, 1, v1
    v_lshlrev_b32 v13, 4, v13
    v_lshlrev_b32 v14, 4, v1
    s_lshr_b32 s17, s16, 1
    s_and_b32 s18, s16, 1
    s_lshl_b32 s17, s17, 5
    s_lshl_b32 s18, s18, 10
    s_add_u32 s17, s17, s18
    s_mul_i32 s20, s17, 1026
    s_lshl_b32 s17, s93, 5
    s_add_u32 s20, s20, s17
    v_mul_u32_u24 v19, 1026, v19
    v_add_u32 v19, v19, v13
    s_mov_b32 s32, 0x05040100
    s_mov_b32 s33, 0x07060302
    v_cvt_f32_u32 v16, v10
    v_lshlrev_b32 v17, 3, v11
    v_cvt_f32_u32 v17, v17
    s_add_u32 s17, s20, 0
    buffer_load_dwordx4 v[60:63], v19, s[48:51], s17 offen
    v_add_f32 v5, 0, v16
    v_mul_f32 v5, 1015021568, v5
    v_mul_f32 v6, v5, v17
    v_mul_f32 v7, 0x41800000, v5
    v_fract_f32 v32, v6
    v_add_f32 v33, v32, v5
    v_add_f32 v34, v33, v5
    v_add_f32 v35, v34, v5
    v_add_f32 v36, v35, v5
    v_add_f32 v37, v36, v5
    v_add_f32 v38, v37, v5
    v_add_f32 v39, v38, v5
    v_add_f32 v6, v32, v7
    v_cos_f32 v40, v32
    v_sin_f32 v48, v32
    v_cos_f32 v41, v33
    buffer_load_dwordx4 v[64:67], v19, s[52:55], s17 offen
    v_sin_f32 v49, v33
    v_cos_f32 v42, v34
    v_sin_f32 v50, v34
    v_cos_f32 v43, v35
    v_sin_f32 v51, v35
    v_cos_f32 v44, v36
    v_sin_f32 v52, v36
    v_cos_f32 v45, v37
    v_sin_f32 v53, v37
    v_cos_f32 v46, v38
    v_sin_f32 v54, v38
    v_cos_f32 v47, v39
    v_sin_f32 v55, v39
    v_cvt_pk_bf16_f32 v56, v40, v41
    v_cvt_pk_bf16_f32 v57, v48, v49
    v_accvgpr_write_b32 a0, v56
    v_xor_b32 v58, 0x80008000, v57
    s_add_u32 s17, s20, 131328
    buffer_load_dwordx4 v[68:71], v19, s[48:51], s17 offen
    v_accvgpr_write_b32 a32, v57
    v_accvgpr_write_b32 a64, v58
    v_cvt_pk_bf16_f32 v56, v42, v43
    v_cvt_pk_bf16_f32 v57, v50, v51
    v_accvgpr_write_b32 a1, v56
    v_xor_b32 v58, 0x80008000, v57
    v_accvgpr_write_b32 a33, v57
    v_accvgpr_write_b32 a65, v58
    v_cvt_pk_bf16_f32 v56, v44, v45
    v_cvt_pk_bf16_f32 v57, v52, v53
    v_accvgpr_write_b32 a2, v56
    v_xor_b32 v58, 0x80008000, v57
    v_accvgpr_write_b32 a34, v57
    v_accvgpr_write_b32 a66, v58
    v_cvt_pk_bf16_f32 v56, v46, v47
    v_cvt_pk_bf16_f32 v57, v54, v55
    v_accvgpr_write_b32 a3, v56
    buffer_load_dwordx4 v[72:75], v19, s[52:55], s17 offen
    v_xor_b32 v58, 0x80008000, v57
    v_accvgpr_write_b32 a35, v57
    v_accvgpr_write_b32 a67, v58
    v_fract_f32 v32, v6
    v_add_f32 v33, v32, v5
    v_add_f32 v34, v33, v5
    v_add_f32 v35, v34, v5
    v_add_f32 v36, v35, v5
    v_add_f32 v37, v36, v5
    v_add_f32 v38, v37, v5
    v_add_f32 v39, v38, v5
    v_add_f32 v6, v32, v7
    v_cos_f32 v40, v32
    v_sin_f32 v48, v32
    v_cos_f32 v41, v33
    v_sin_f32 v49, v33
    s_add_u32 s17, s20, 262656
    buffer_load_dwordx4 v[76:79], v19, s[48:51], s17 offen
    v_cos_f32 v42, v34
    v_sin_f32 v50, v34
    v_cos_f32 v43, v35
    v_sin_f32 v51, v35
    v_cos_f32 v44, v36
    v_sin_f32 v52, v36
    v_cos_f32 v45, v37
    v_sin_f32 v53, v37
    v_cos_f32 v46, v38
    v_sin_f32 v54, v38
    v_cos_f32 v47, v39
    v_sin_f32 v55, v39
    v_cvt_pk_bf16_f32 v56, v40, v41
    v_cvt_pk_bf16_f32 v57, v48, v49
    v_accvgpr_write_b32 a4, v56
    v_xor_b32 v58, 0x80008000, v57
    v_accvgpr_write_b32 a36, v57
    buffer_load_dwordx4 v[80:83], v19, s[52:55], s17 offen
    v_accvgpr_write_b32 a68, v58
    v_cvt_pk_bf16_f32 v56, v42, v43
    v_cvt_pk_bf16_f32 v57, v50, v51
    v_accvgpr_write_b32 a5, v56
    v_xor_b32 v58, 0x80008000, v57
    v_accvgpr_write_b32 a37, v57
    v_accvgpr_write_b32 a69, v58
    v_cvt_pk_bf16_f32 v56, v44, v45
    v_cvt_pk_bf16_f32 v57, v52, v53
    v_accvgpr_write_b32 a6, v56
    v_xor_b32 v58, 0x80008000, v57
    v_accvgpr_write_b32 a38, v57
    v_accvgpr_write_b32 a70, v58
    v_cvt_pk_bf16_f32 v56, v46, v47
    v_cvt_pk_bf16_f32 v57, v54, v55
    v_accvgpr_write_b32 a7, v56
    v_xor_b32 v58, 0x80008000, v57
    s_add_u32 s17, s20, 393984
    buffer_load_dwordx4 v[84:87], v19, s[48:51], s17 offen
    v_accvgpr_write_b32 a39, v57
    v_accvgpr_write_b32 a71, v58
    v_fract_f32 v32, v6
    v_add_f32 v33, v32, v5
    v_add_f32 v34, v33, v5
    v_add_f32 v35, v34, v5
    v_add_f32 v36, v35, v5
    v_add_f32 v37, v36, v5
    v_add_f32 v38, v37, v5
    v_add_f32 v39, v38, v5
    v_add_f32 v6, v32, v7
    v_cos_f32 v40, v32
    v_sin_f32 v48, v32
    v_cos_f32 v41, v33
    v_sin_f32 v49, v33
    v_cos_f32 v42, v34
    buffer_load_dwordx4 v[88:91], v19, s[52:55], s17 offen
    v_sin_f32 v50, v34
    v_cos_f32 v43, v35
    v_sin_f32 v51, v35
    v_cos_f32 v44, v36
    v_sin_f32 v52, v36
    v_cos_f32 v45, v37
    v_sin_f32 v53, v37
    v_cos_f32 v46, v38
    v_sin_f32 v54, v38
    v_cos_f32 v47, v39
    v_sin_f32 v55, v39
    v_cvt_pk_bf16_f32 v56, v40, v41
    v_cvt_pk_bf16_f32 v57, v48, v49
    v_accvgpr_write_b32 a8, v56
    v_xor_b32 v58, 0x80008000, v57
    v_accvgpr_write_b32 a40, v57
    v_accvgpr_write_b32 a72, v58
    s_add_u32 s17, s20, 525312
    buffer_load_dwordx4 v[92:95], v19, s[48:51], s17 offen
    v_cvt_pk_bf16_f32 v56, v42, v43
    v_cvt_pk_bf16_f32 v57, v50, v51
    v_accvgpr_write_b32 a9, v56
    v_xor_b32 v58, 0x80008000, v57
    v_accvgpr_write_b32 a41, v57
    v_accvgpr_write_b32 a73, v58
    v_cvt_pk_bf16_f32 v56, v44, v45
    v_cvt_pk_bf16_f32 v57, v52, v53
    v_accvgpr_write_b32 a10, v56
    v_xor_b32 v58, 0x80008000, v57
    v_accvgpr_write_b32 a42, v57
    v_accvgpr_write_b32 a74, v58
    v_cvt_pk_bf16_f32 v56, v46, v47
    v_cvt_pk_bf16_f32 v57, v54, v55
    v_accvgpr_write_b32 a11, v56
    v_xor_b32 v58, 0x80008000, v57
    v_accvgpr_write_b32 a43, v57
    buffer_load_dwordx4 v[96:99], v19, s[52:55], s17 offen
    v_accvgpr_write_b32 a75, v58
    v_fract_f32 v32, v6
    v_add_f32 v33, v32, v5
    v_add_f32 v34, v33, v5
    v_add_f32 v35, v34, v5
    v_add_f32 v36, v35, v5
    v_add_f32 v37, v36, v5
    v_add_f32 v38, v37, v5
    v_add_f32 v39, v38, v5
    v_add_f32 v6, v32, v7
    v_cos_f32 v40, v32
    v_sin_f32 v48, v32
    v_cos_f32 v41, v33
    v_sin_f32 v49, v33
    v_cos_f32 v42, v34
    v_sin_f32 v50, v34
    s_add_u32 s17, s20, 656640
    buffer_load_dwordx4 v[100:103], v19, s[48:51], s17 offen
    v_cos_f32 v43, v35
    v_sin_f32 v51, v35
    v_cos_f32 v44, v36
    v_sin_f32 v52, v36
    v_cos_f32 v45, v37
    v_sin_f32 v53, v37
    v_cos_f32 v46, v38
    v_sin_f32 v54, v38
    v_cos_f32 v47, v39
    v_sin_f32 v55, v39
    v_cvt_pk_bf16_f32 v56, v40, v41
    v_cvt_pk_bf16_f32 v57, v48, v49
    v_accvgpr_write_b32 a12, v56
    v_xor_b32 v58, 0x80008000, v57
    v_accvgpr_write_b32 a44, v57
    v_accvgpr_write_b32 a76, v58
    v_cvt_pk_bf16_f32 v56, v42, v43
    buffer_load_dwordx4 v[104:107], v19, s[52:55], s17 offen
    v_cvt_pk_bf16_f32 v57, v50, v51
    v_accvgpr_write_b32 a13, v56
    v_xor_b32 v58, 0x80008000, v57
    v_accvgpr_write_b32 a45, v57
    v_accvgpr_write_b32 a77, v58
    v_cvt_pk_bf16_f32 v56, v44, v45
    v_cvt_pk_bf16_f32 v57, v52, v53
    v_accvgpr_write_b32 a14, v56
    v_xor_b32 v58, 0x80008000, v57
    v_accvgpr_write_b32 a46, v57
    v_accvgpr_write_b32 a78, v58
    v_cvt_pk_bf16_f32 v56, v46, v47
    v_cvt_pk_bf16_f32 v57, v54, v55
    v_accvgpr_write_b32 a15, v56
    v_xor_b32 v58, 0x80008000, v57
    v_accvgpr_write_b32 a47, v57
    v_accvgpr_write_b32 a79, v58
    s_add_u32 s17, s20, 787968
    buffer_load_dwordx4 v[108:111], v19, s[48:51], s17 offen
    v_add_f32 v5, 1107296256, v16
    v_mul_f32 v5, 1015021568, v5
    v_mul_f32 v6, v5, v17
    v_mul_f32 v7, 0x41800000, v5
    v_fract_f32 v32, v6
    v_add_f32 v33, v32, v5
    v_add_f32 v34, v33, v5
    v_add_f32 v35, v34, v5
    v_add_f32 v36, v35, v5
    v_add_f32 v37, v36, v5
    v_add_f32 v38, v37, v5
    v_add_f32 v39, v38, v5
    v_add_f32 v6, v32, v7
    v_cos_f32 v40, v32
    v_sin_f32 v48, v32
    v_cos_f32 v41, v33
    buffer_load_dwordx4 v[112:115], v19, s[52:55], s17 offen
    v_sin_f32 v49, v33
    v_cos_f32 v42, v34
    v_sin_f32 v50, v34
    v_cos_f32 v43, v35
    v_sin_f32 v51, v35
    v_cos_f32 v44, v36
    v_sin_f32 v52, v36
    v_cos_f32 v45, v37
    v_sin_f32 v53, v37
    v_cos_f32 v46, v38
    v_sin_f32 v54, v38
    v_cos_f32 v47, v39
    v_sin_f32 v55, v39
    v_cvt_pk_bf16_f32 v56, v40, v41
    v_cvt_pk_bf16_f32 v57, v48, v49
    v_accvgpr_write_b32 a16, v56
    v_xor_b32 v58, 0x80008000, v57
    s_add_u32 s17, s20, 919296
    buffer_load_dwordx4 v[116:119], v19, s[48:51], s17 offen
    v_accvgpr_write_b32 a48, v57
    v_accvgpr_write_b32 a80, v58
    v_cvt_pk_bf16_f32 v56, v42, v43
    v_cvt_pk_bf16_f32 v57, v50, v51
    v_accvgpr_write_b32 a17, v56
    v_xor_b32 v58, 0x80008000, v57
    v_accvgpr_write_b32 a49, v57
    v_accvgpr_write_b32 a81, v58
    v_cvt_pk_bf16_f32 v56, v44, v45
    v_cvt_pk_bf16_f32 v57, v52, v53
    v_accvgpr_write_b32 a18, v56
    v_xor_b32 v58, 0x80008000, v57
    v_accvgpr_write_b32 a50, v57
    v_accvgpr_write_b32 a82, v58
    v_cvt_pk_bf16_f32 v56, v46, v47
    v_cvt_pk_bf16_f32 v57, v54, v55
    v_accvgpr_write_b32 a19, v56
    buffer_load_dwordx4 v[120:123], v19, s[52:55], s17 offen
    v_xor_b32 v58, 0x80008000, v57
    v_accvgpr_write_b32 a51, v57
    v_accvgpr_write_b32 a83, v58
    v_fract_f32 v32, v6
    v_add_f32 v33, v32, v5
    v_add_f32 v34, v33, v5
    v_add_f32 v35, v34, v5
    v_add_f32 v36, v35, v5
    v_add_f32 v37, v36, v5
    v_add_f32 v38, v37, v5
    v_add_f32 v39, v38, v5
    v_add_f32 v6, v32, v7
    v_cos_f32 v40, v32
    v_sin_f32 v48, v32
    v_cos_f32 v41, v33
    v_sin_f32 v49, v33
    v_cos_f32 v42, v34
    s_add_u32 s17, s20, 65664
    buffer_load_dwordx4 v[124:127], v19, s[48:51], s17 offen
    v_sin_f32 v50, v34
    v_cos_f32 v43, v35
    v_sin_f32 v51, v35
    v_cos_f32 v44, v36
    v_sin_f32 v52, v36
    v_cos_f32 v45, v37
    v_sin_f32 v53, v37
    v_cos_f32 v46, v38
    v_sin_f32 v54, v38
    v_cos_f32 v47, v39
    v_sin_f32 v55, v39
    v_cvt_pk_bf16_f32 v56, v40, v41
    v_cvt_pk_bf16_f32 v57, v48, v49
    v_accvgpr_write_b32 a20, v56
    v_xor_b32 v58, 0x80008000, v57
    v_accvgpr_write_b32 a52, v57
    buffer_load_dwordx4 v[128:131], v19, s[52:55], s17 offen
    v_accvgpr_write_b32 a84, v58
    v_cvt_pk_bf16_f32 v56, v42, v43
    v_cvt_pk_bf16_f32 v57, v50, v51
    v_accvgpr_write_b32 a21, v56
    v_xor_b32 v58, 0x80008000, v57
    v_accvgpr_write_b32 a53, v57
    v_accvgpr_write_b32 a85, v58
    v_cvt_pk_bf16_f32 v56, v44, v45
    v_cvt_pk_bf16_f32 v57, v52, v53
    v_accvgpr_write_b32 a22, v56
    v_xor_b32 v58, 0x80008000, v57
    v_accvgpr_write_b32 a54, v57
    v_accvgpr_write_b32 a86, v58
    v_cvt_pk_bf16_f32 v56, v46, v47
    v_cvt_pk_bf16_f32 v57, v54, v55
    v_accvgpr_write_b32 a23, v56
    v_xor_b32 v58, 0x80008000, v57
    s_add_u32 s17, s20, 196992
    buffer_load_dwordx4 v[132:135], v19, s[48:51], s17 offen
    v_accvgpr_write_b32 a55, v57
    v_accvgpr_write_b32 a87, v58
    v_fract_f32 v32, v6
    v_add_f32 v33, v32, v5
    v_add_f32 v34, v33, v5
    v_add_f32 v35, v34, v5
    v_add_f32 v36, v35, v5
    v_add_f32 v37, v36, v5
    v_add_f32 v38, v37, v5
    v_add_f32 v39, v38, v5
    v_add_f32 v6, v32, v7
    v_cos_f32 v40, v32
    v_sin_f32 v48, v32
    v_cos_f32 v41, v33
    v_sin_f32 v49, v33
    v_cos_f32 v42, v34
    v_sin_f32 v50, v34
    buffer_load_dwordx4 v[136:139], v19, s[52:55], s17 offen
    v_cos_f32 v43, v35
    v_sin_f32 v51, v35
    v_cos_f32 v44, v36
    v_sin_f32 v52, v36
    v_cos_f32 v45, v37
    v_sin_f32 v53, v37
    v_cos_f32 v46, v38
    v_sin_f32 v54, v38
    v_cos_f32 v47, v39
    v_sin_f32 v55, v39
    v_cvt_pk_bf16_f32 v56, v40, v41
    v_cvt_pk_bf16_f32 v57, v48, v49
    v_accvgpr_write_b32 a24, v56
    v_xor_b32 v58, 0x80008000, v57
    v_accvgpr_write_b32 a56, v57
    v_accvgpr_write_b32 a88, v58
    s_add_u32 s17, s20, 328320
    buffer_load_dwordx4 v[140:143], v19, s[48:51], s17 offen
    v_cvt_pk_bf16_f32 v56, v42, v43
    v_cvt_pk_bf16_f32 v57, v50, v51
    v_accvgpr_write_b32 a25, v56
    v_xor_b32 v58, 0x80008000, v57
    v_accvgpr_write_b32 a57, v57
    v_accvgpr_write_b32 a89, v58
    v_cvt_pk_bf16_f32 v56, v44, v45
    v_cvt_pk_bf16_f32 v57, v52, v53
    v_accvgpr_write_b32 a26, v56
    v_xor_b32 v58, 0x80008000, v57
    v_accvgpr_write_b32 a58, v57
    v_accvgpr_write_b32 a90, v58
    v_cvt_pk_bf16_f32 v56, v46, v47
    v_cvt_pk_bf16_f32 v57, v54, v55
    v_accvgpr_write_b32 a27, v56
    v_xor_b32 v58, 0x80008000, v57
    v_accvgpr_write_b32 a59, v57
    buffer_load_dwordx4 v[144:147], v19, s[52:55], s17 offen
    v_accvgpr_write_b32 a91, v58
    v_fract_f32 v32, v6
    v_add_f32 v33, v32, v5
    v_add_f32 v34, v33, v5
    v_add_f32 v35, v34, v5
    v_add_f32 v36, v35, v5
    v_add_f32 v37, v36, v5
    v_add_f32 v38, v37, v5
    v_add_f32 v39, v38, v5
    v_add_f32 v6, v32, v7
    v_cos_f32 v40, v32
    v_sin_f32 v48, v32
    v_cos_f32 v41, v33
    v_sin_f32 v49, v33
    v_cos_f32 v42, v34
    v_sin_f32 v50, v34
    v_cos_f32 v43, v35
    s_add_u32 s17, s20, 459648
    buffer_load_dwordx4 v[148:151], v19, s[48:51], s17 offen
    v_sin_f32 v51, v35
    v_cos_f32 v44, v36
    v_sin_f32 v52, v36
    v_cos_f32 v45, v37
    v_sin_f32 v53, v37
    v_cos_f32 v46, v38
    v_sin_f32 v54, v38
    v_cos_f32 v47, v39
    v_sin_f32 v55, v39
    v_cvt_pk_bf16_f32 v56, v40, v41
    v_cvt_pk_bf16_f32 v57, v48, v49
    v_accvgpr_write_b32 a28, v56
    v_xor_b32 v58, 0x80008000, v57
    v_accvgpr_write_b32 a60, v57
    v_accvgpr_write_b32 a92, v58
    v_cvt_pk_bf16_f32 v56, v42, v43
    buffer_load_dwordx4 v[152:155], v19, s[52:55], s17 offen
    v_cvt_pk_bf16_f32 v57, v50, v51
    v_accvgpr_write_b32 a29, v56
    v_xor_b32 v58, 0x80008000, v57
    v_accvgpr_write_b32 a61, v57
    v_accvgpr_write_b32 a93, v58
    v_cvt_pk_bf16_f32 v56, v44, v45
    v_cvt_pk_bf16_f32 v57, v52, v53
    v_accvgpr_write_b32 a30, v56
    v_xor_b32 v58, 0x80008000, v57
    v_accvgpr_write_b32 a62, v57
    v_accvgpr_write_b32 a94, v58
    v_cvt_pk_bf16_f32 v56, v46, v47
    v_cvt_pk_bf16_f32 v57, v54, v55
    v_accvgpr_write_b32 a31, v56
    v_xor_b32 v58, 0x80008000, v57
    v_accvgpr_write_b32 a63, v57
    v_accvgpr_write_b32 a95, v58
    s_add_u32 s17, s20, 590976
    buffer_load_dwordx4 v[156:159], v19, s[48:51], s17 offen
    v_add_f32 v5, 0, v16
    v_mul_f32 v5, 1023410176, v5
    v_mul_f32 v6, v5, v17
    v_mul_f32 v7, 0x41800000, v5
    v_fract_f32 v32, v6
    v_add_f32 v33, v32, v5
    v_add_f32 v34, v33, v5
    v_add_f32 v35, v34, v5
    v_add_f32 v36, v35, v5
    v_add_f32 v37, v36, v5
    v_add_f32 v38, v37, v5
    v_add_f32 v39, v38, v5
    v_add_f32 v6, v32, v7
    v_cos_f32 v40, v32
    v_sin_f32 v48, v32
    v_cos_f32 v41, v33
    v_sin_f32 v49, v33
    buffer_load_dwordx4 v[160:163], v19, s[52:55], s17 offen
    v_cos_f32 v42, v34
    v_sin_f32 v50, v34
    v_cos_f32 v43, v35
    v_sin_f32 v51, v35
    v_cos_f32 v44, v36
    v_sin_f32 v52, v36
    v_cos_f32 v45, v37
    v_sin_f32 v53, v37
    v_cos_f32 v46, v38
    v_sin_f32 v54, v38
    v_cos_f32 v47, v39
    v_sin_f32 v55, v39
    v_mul_f32 v40, 981467136, v40
    v_mul_f32 v41, 981467136, v41
    v_mul_f32 v42, 981467136, v42
    v_mul_f32 v43, 981467136, v43
    s_add_u32 s17, s20, 722304
    buffer_load_dwordx4 v[164:167], v19, s[48:51], s17 offen
    v_mul_f32 v44, 981467136, v44
    v_mul_f32 v45, 981467136, v45
    v_mul_f32 v46, 981467136, v46
    v_mul_f32 v47, 981467136, v47
    v_mul_f32 v48, 981467136, v48
    v_mul_f32 v49, 981467136, v49
    v_mul_f32 v50, 981467136, v50
    v_mul_f32 v51, 981467136, v51
    v_mul_f32 v52, 981467136, v52
    v_mul_f32 v53, 981467136, v53
    v_mul_f32 v54, 981467136, v54
    v_mul_f32 v55, 981467136, v55
    v_cvt_pk_bf16_f32 v56, v40, v41
    v_cvt_pk_bf16_f32 v57, v48, v49
    v_accvgpr_write_b32 a96, v56
    v_xor_b32 v58, 0x80008000, v57
    v_accvgpr_write_b32 a104, v57
    buffer_load_dwordx4 v[168:171], v19, s[52:55], s17 offen
    v_accvgpr_write_b32 a112, v58
    v_cvt_pk_bf16_f32 v56, v42, v43
    v_cvt_pk_bf16_f32 v57, v50, v51
    v_accvgpr_write_b32 a97, v56
    v_xor_b32 v58, 0x80008000, v57
    v_accvgpr_write_b32 a105, v57
    v_accvgpr_write_b32 a113, v58
    v_cvt_pk_bf16_f32 v56, v44, v45
    v_cvt_pk_bf16_f32 v57, v52, v53
    v_accvgpr_write_b32 a98, v56
    v_xor_b32 v58, 0x80008000, v57
    v_accvgpr_write_b32 a106, v57
    v_accvgpr_write_b32 a114, v58
    v_cvt_pk_bf16_f32 v56, v46, v47
    v_cvt_pk_bf16_f32 v57, v54, v55
    v_accvgpr_write_b32 a99, v56
    v_xor_b32 v58, 0x80008000, v57
    s_add_u32 s17, s20, 853632
    buffer_load_dwordx4 v[172:175], v19, s[48:51], s17 offen
    v_accvgpr_write_b32 a107, v57
    v_accvgpr_write_b32 a115, v58
    v_fract_f32 v32, v6
    v_add_f32 v33, v32, v5
    v_add_f32 v34, v33, v5
    v_add_f32 v35, v34, v5
    v_add_f32 v36, v35, v5
    v_add_f32 v37, v36, v5
    v_add_f32 v38, v37, v5
    v_add_f32 v39, v38, v5
    v_add_f32 v6, v32, v7
    v_cos_f32 v40, v32
    v_sin_f32 v48, v32
    v_cos_f32 v41, v33
    v_sin_f32 v49, v33
    v_cos_f32 v42, v34
    buffer_load_dwordx4 v[176:179], v19, s[52:55], s17 offen
    v_sin_f32 v50, v34
    v_cos_f32 v43, v35
    v_sin_f32 v51, v35
    v_cos_f32 v44, v36
    v_sin_f32 v52, v36
    v_cos_f32 v45, v37
    v_sin_f32 v53, v37
    v_cos_f32 v46, v38
    v_sin_f32 v54, v38
    v_cos_f32 v47, v39
    v_sin_f32 v55, v39
    v_mul_f32 v40, 981467136, v40
    v_mul_f32 v41, 981467136, v41
    v_mul_f32 v42, 981467136, v42
    v_mul_f32 v43, 981467136, v43
    v_mul_f32 v44, 981467136, v44
    v_mul_f32 v45, 981467136, v45
    s_add_u32 s17, s20, 984960
    buffer_load_dwordx4 v[180:183], v19, s[48:51], s17 offen
    v_mul_f32 v46, 981467136, v46
    v_mul_f32 v47, 981467136, v47
    v_mul_f32 v48, 981467136, v48
    v_mul_f32 v49, 981467136, v49
    v_mul_f32 v50, 981467136, v50
    v_mul_f32 v51, 981467136, v51
    v_mul_f32 v52, 981467136, v52
    v_mul_f32 v53, 981467136, v53
    v_mul_f32 v54, 981467136, v54
    v_mul_f32 v55, 981467136, v55
    v_cvt_pk_bf16_f32 v56, v40, v41
    v_cvt_pk_bf16_f32 v57, v48, v49
    v_accvgpr_write_b32 a100, v56
    v_xor_b32 v58, 0x80008000, v57
    v_accvgpr_write_b32 a108, v57
    v_accvgpr_write_b32 a116, v58
    v_cvt_pk_bf16_f32 v56, v42, v43
    buffer_load_dwordx4 v[184:187], v19, s[52:55], s17 offen
    v_cvt_pk_bf16_f32 v57, v50, v51
    v_accvgpr_write_b32 a101, v56
    v_xor_b32 v58, 0x80008000, v57
    v_accvgpr_write_b32 a109, v57
    v_accvgpr_write_b32 a117, v58
    v_cvt_pk_bf16_f32 v56, v44, v45
    v_cvt_pk_bf16_f32 v57, v52, v53
    v_accvgpr_write_b32 a102, v56
    v_xor_b32 v58, 0x80008000, v57
    v_accvgpr_write_b32 a110, v57
    v_accvgpr_write_b32 a118, v58
    v_cvt_pk_bf16_f32 v56, v46, v47
    v_cvt_pk_bf16_f32 v57, v54, v55
    v_accvgpr_write_b32 a103, v56
    v_xor_b32 v58, 0x80008000, v57
    v_accvgpr_write_b32 a111, v57
    v_accvgpr_write_b32 a119, v58
    s_lshl_b32 s17, s16, 11
    v_lshlrev_b32 v5, 12, v13
    v_lshl_add_u32 v5, v8, 4, v5
    v_add_u32 v5, s17, v5
    s_cmp_eq_u32 s16, 0
    s_cselect_b32 s17, 0, 10240
    s_add_u32 s17, s17, 0x20000
    v_add_u32 v13, s17, v14
    s_waitcnt vmcnt(24)
    v_perm_b32 v236, v64, v60, s32
    v_perm_b32 v237, v72, v68, s32
    v_perm_b32 v238, v80, v76, s32
    v_perm_b32 v239, v88, v84, s32
    ds_write_b128 v5, v[236:239] offset:0
    v_perm_b32 v240, v64, v60, s33
    v_perm_b32 v241, v72, v68, s33
    v_perm_b32 v242, v80, v76, s33
    v_perm_b32 v243, v88, v84, s33
    ds_write_b128 v5, v[240:243] offset:8192
    v_perm_b32 v244, v65, v61, s32
    v_perm_b32 v245, v73, v69, s32
    v_perm_b32 v246, v81, v77, s32
    v_perm_b32 v247, v89, v85, s32
    ds_write_b128 v5, v[244:247] offset:16384
    v_perm_b32 v248, v65, v61, s33
    v_perm_b32 v249, v73, v69, s33
    v_perm_b32 v250, v81, v77, s33
    v_perm_b32 v251, v89, v85, s33
    ds_write_b128 v5, v[248:251] offset:24576
    v_perm_b32 v236, v66, v62, s32
    v_perm_b32 v237, v74, v70, s32
    v_perm_b32 v238, v82, v78, s32
    v_perm_b32 v239, v90, v86, s32
    ds_write_b128 v5, v[236:239] offset:32768
    v_perm_b32 v240, v66, v62, s33
    v_perm_b32 v241, v74, v70, s33
    v_perm_b32 v242, v82, v78, s33
    v_perm_b32 v243, v90, v86, s33
    ds_write_b128 v5, v[240:243] offset:40960
    v_perm_b32 v244, v67, v63, s32
    v_perm_b32 v245, v75, v71, s32
    v_perm_b32 v246, v83, v79, s32
    v_perm_b32 v247, v91, v87, s32
    ds_write_b128 v5, v[244:247] offset:49152
    v_perm_b32 v248, v67, v63, s33
    v_perm_b32 v249, v75, v71, s33
    v_perm_b32 v250, v83, v79, s33
    v_perm_b32 v251, v91, v87, s33
    ds_write_b128 v5, v[248:251] offset:57344
    s_waitcnt vmcnt(16)
    v_perm_b32 v236, v96, v92, s32
    v_perm_b32 v237, v104, v100, s32
    v_perm_b32 v238, v112, v108, s32
    v_perm_b32 v239, v120, v116, s32
    ds_write_b128 v5, v[236:239] offset:512
    v_perm_b32 v240, v96, v92, s33
    v_perm_b32 v241, v104, v100, s33
    v_perm_b32 v242, v112, v108, s33
    v_perm_b32 v243, v120, v116, s33
    ds_write_b128 v5, v[240:243] offset:8704
    v_perm_b32 v244, v97, v93, s32
    v_perm_b32 v245, v105, v101, s32
    v_perm_b32 v246, v113, v109, s32
    v_perm_b32 v247, v121, v117, s32
    ds_write_b128 v5, v[244:247] offset:16896
    v_perm_b32 v248, v97, v93, s33
    v_perm_b32 v249, v105, v101, s33
    v_perm_b32 v250, v113, v109, s33
    v_perm_b32 v251, v121, v117, s33
    ds_write_b128 v5, v[248:251] offset:25088
    v_perm_b32 v236, v98, v94, s32
    v_perm_b32 v237, v106, v102, s32
    v_perm_b32 v238, v114, v110, s32
    v_perm_b32 v239, v122, v118, s32
    ds_write_b128 v5, v[236:239] offset:33280
    v_perm_b32 v240, v98, v94, s33
    v_perm_b32 v241, v106, v102, s33
    v_perm_b32 v242, v114, v110, s33
    v_perm_b32 v243, v122, v118, s33
    ds_write_b128 v5, v[240:243] offset:41472
    v_perm_b32 v244, v99, v95, s32
    v_perm_b32 v245, v107, v103, s32
    v_perm_b32 v246, v115, v111, s32
    v_perm_b32 v247, v123, v119, s32
    ds_write_b128 v5, v[244:247] offset:49664
    v_perm_b32 v248, v99, v95, s33
    v_perm_b32 v249, v107, v103, s33
    v_perm_b32 v250, v115, v111, s33
    v_perm_b32 v251, v123, v119, s33
    ds_write_b128 v5, v[248:251] offset:57856
    s_waitcnt vmcnt(8)
    v_perm_b32 v236, v128, v124, s32
    v_perm_b32 v237, v136, v132, s32
    v_perm_b32 v238, v144, v140, s32
    v_perm_b32 v239, v152, v148, s32
    ds_write_b128 v5, v[236:239] offset:1024
    v_perm_b32 v240, v128, v124, s33
    v_perm_b32 v241, v136, v132, s33
    v_perm_b32 v242, v144, v140, s33
    v_perm_b32 v243, v152, v148, s33
    ds_write_b128 v5, v[240:243] offset:9216
    v_perm_b32 v244, v129, v125, s32
    v_perm_b32 v245, v137, v133, s32
    v_perm_b32 v246, v145, v141, s32
    v_perm_b32 v247, v153, v149, s32
    ds_write_b128 v5, v[244:247] offset:17408
    v_perm_b32 v248, v129, v125, s33
    v_perm_b32 v249, v137, v133, s33
    v_perm_b32 v250, v145, v141, s33
    v_perm_b32 v251, v153, v149, s33
    ds_write_b128 v5, v[248:251] offset:25600
    v_perm_b32 v236, v130, v126, s32
    v_perm_b32 v237, v138, v134, s32
    v_perm_b32 v238, v146, v142, s32
    v_perm_b32 v239, v154, v150, s32
    ds_write_b128 v5, v[236:239] offset:33792
    v_perm_b32 v240, v130, v126, s33
    v_perm_b32 v241, v138, v134, s33
    v_perm_b32 v242, v146, v142, s33
    v_perm_b32 v243, v154, v150, s33
    ds_write_b128 v5, v[240:243] offset:41984
    v_perm_b32 v244, v131, v127, s32
    v_perm_b32 v245, v139, v135, s32
    v_perm_b32 v246, v147, v143, s32
    v_perm_b32 v247, v155, v151, s32
    ds_write_b128 v5, v[244:247] offset:50176
    v_perm_b32 v248, v131, v127, s33
    v_perm_b32 v249, v139, v135, s33
    v_perm_b32 v250, v147, v143, s33
    v_perm_b32 v251, v155, v151, s33
    ds_write_b128 v5, v[248:251] offset:58368
    s_waitcnt vmcnt(0)
    v_perm_b32 v236, v160, v156, s32
    v_perm_b32 v237, v168, v164, s32
    v_perm_b32 v238, v176, v172, s32
    v_perm_b32 v239, v184, v180, s32
    ds_write_b128 v5, v[236:239] offset:1536
    v_perm_b32 v240, v160, v156, s33
    v_perm_b32 v241, v168, v164, s33
    v_perm_b32 v242, v176, v172, s33
    v_perm_b32 v243, v184, v180, s33
    ds_write_b128 v5, v[240:243] offset:9728
    v_perm_b32 v244, v161, v157, s32
    v_perm_b32 v245, v169, v165, s32
    v_perm_b32 v246, v177, v173, s32
    v_perm_b32 v247, v185, v181, s32
    ds_write_b128 v5, v[244:247] offset:17920
    v_perm_b32 v248, v161, v157, s33
    v_perm_b32 v249, v169, v165, s33
    v_perm_b32 v250, v177, v173, s33
    v_perm_b32 v251, v185, v181, s33
    ds_write_b128 v5, v[248:251] offset:26112
    v_perm_b32 v236, v162, v158, s32
    v_perm_b32 v237, v170, v166, s32
    v_perm_b32 v238, v178, v174, s32
    v_perm_b32 v239, v186, v182, s32
    ds_write_b128 v5, v[236:239] offset:34304
    v_perm_b32 v240, v162, v158, s33
    v_perm_b32 v241, v170, v166, s33
    v_perm_b32 v242, v178, v174, s33
    v_perm_b32 v243, v186, v182, s33
    ds_write_b128 v5, v[240:243] offset:42496
    v_perm_b32 v244, v163, v159, s32
    v_perm_b32 v245, v171, v167, s32
    v_perm_b32 v246, v179, v175, s32
    v_perm_b32 v247, v187, v183, s32
    ds_write_b128 v5, v[244:247] offset:50688
    v_perm_b32 v248, v163, v159, s33
    v_perm_b32 v249, v171, v167, s33
    v_perm_b32 v250, v179, v175, s33
    v_perm_b32 v251, v187, v183, s33
    ds_write_b128 v5, v[248:251] offset:58880
    v_mul_u32_u24 v15, 2176, v10
    v_lshl_add_u32 v15, v11, 4, v15
    v_lshlrev_b32 v18, 12, v11
    v_lshl_add_u32 v18, v10, 4, v18
    s_mul_i32 s32, s93, 139776
    s_lshl_b32 s17, s16, 9
    s_add_u32 s32, s32, s17
    s_add_u32 s32, s32, 104857600
    s_add_u32 s33, s32, 64
    s_lshl_b32 s31, s93, 2
    s_add_u32 s31, s31, s16
    s_lshl_b32 s35, s16, 15
    s_mov_b32 s38, 0xffff0000
    s_mov_b32 s36, 0
    s_cmp_eq_u32 s31, 0
    s_cselect_b32 s37, 5, 4
    s_cselect_b32 s33, 1073741824, s33
    s_cselect_b32 s34, 1024, 1073741824
    v_and_b32 v8, 3, v1
    v_lshlrev_b32 v8, 7, v8
    s_lshl_b32 s17, s93, 9
    s_add_u32 s17, s17, 100745216
    v_add_u32 v8, s17, v8
    s_waitcnt lgkmcnt(0)
    s_mov_b32 s30, s92
F2_w:
    buffer_load_dword v5, v8, s[4:7], 0 offen sc1
    s_waitcnt vmcnt(0)
    v_cmp_gt_u32 vcc, 1, v5
    s_nop 0
    s_and_b32 s17, vcc_lo, 15
    s_cbranch_scc0 F2_w_ok
    s_cmp_ge_u32 s30, 1048576
    s_cselect_b32 s92, 1048576, s92
    s_cbranch_scc1 F2_w_ok
    s_add_u32 s30, s30, 1
    s_sleep 8
    s_branch F2_w
F2_w_ok:
    buffer_load_dwordx4 v[128:131], v15, s[4:7], s32 offen offset:0
    buffer_load_dwordx4 v[132:135], v15, s[4:7], s32 offen offset:32
    s_add_u32 s17, s32, 69632
    buffer_load_dwordx4 v[136:139], v15, s[4:7], s17 offen offset:0
    buffer_load_dwordx4 v[140:143], v15, s[4:7], s17 offen offset:32
    buffer_load_dwordx4 v[144:147], v15, s[4:7], s33 offen offset:0
    buffer_load_dwordx4 v[148:151], v15, s[4:7], s33 offen offset:32
    s_add_u32 s17, s33, 69632
    buffer_load_dwordx4 v[152:155], v15, s[4:7], s17 offen offset:0
    buffer_load_dwordx4 v[156:159], v15, s[4:7], s17 offen offset:32
    v_add_f32 v5, 0, v16
    v_mul_f32 v5, 973078528, v5
    v_add_f32 v6, 0, v17
    v_mul_f32 v6, v6, v5
    v_cos_f32 v160, v6
    v_sin_f32 v176, v6
    v_add_f32 v6, 1065353216, v17
    v_mul_f32 v6, v6, v5
    v_cos_f32 v161, v6
    v_sin_f32 v177, v6
    v_add_f32 v6, 1073741824, v17
    v_mul_f32 v6, v6, v5
    v_cos_f32 v162, v6
    v_sin_f32 v178, v6
    v_add_f32 v6, 1077936128, v17
    v_mul_f32 v6, v6, v5
    v_cos_f32 v163, v6
    v_sin_f32 v179, v6
    v_add_f32 v6, 1082130432, v17
    v_mul_f32 v6, v6, v5
    v_cos_f32 v164, v6
    v_sin_f32 v180, v6
    v_add_f32 v6, 1084227584, v17
    v_mul_f32 v6, v6, v5
    v_cos_f32 v165, v6
    v_sin_f32 v181, v6
    v_add_f32 v6, 1086324736, v17
    v_mul_f32 v6, v6, v5
    v_cos_f32 v166, v6
    v_sin_f32 v182, v6
    v_add_f32 v6, 1088421888, v17
    v_mul_f32 v6, v6, v5
    v_cos_f32 v167, v6
    v_sin_f32 v183, v6
    v_add_f32 v6, 1098907648, v17
    v_mul_f32 v6, v6, v5
    v_cos_f32 v168, v6
    v_sin_f32 v184, v6
    v_add_f32 v6, 1099431936, v17
    v_mul_f32 v6, v6, v5
    v_cos_f32 v169, v6
    v_sin_f32 v185, v6
    v_add_f32 v6, 1099956224, v17
    v_mul_f32 v6, v6, v5
    v_cos_f32 v170, v6
    v_sin_f32 v186, v6
    v_add_f32 v6, 1100480512, v17
    v_mul_f32 v6, v6, v5
    v_cos_f32 v171, v6
    v_sin_f32 v187, v6
    v_add_f32 v6, 1101004800, v17
    v_mul_f32 v6, v6, v5
    v_cos_f32 v172, v6
    v_sin_f32 v188, v6
    v_add_f32 v6, 1101529088, v17
    v_mul_f32 v6, v6, v5
    v_cos_f32 v173, v6
    v_sin_f32 v189, v6
    v_add_f32 v6, 1102053376, v17
    v_mul_f32 v6, v6, v5
    v_cos_f32 v174, v6
    v_sin_f32 v190, v6
    v_add_f32 v6, 1102577664, v17
    v_mul_f32 v6, v6, v5
    v_cos_f32 v175, v6
    v_sin_f32 v191, v6
    v_add_f32 v5, 1107296256, v16
    v_mul_f32 v5, 973078528, v5
    v_add_f32 v6, 0, v17
    v_mul_f32 v6, v6, v5
    v_cos_f32 v192, v6
    v_sin_f32 v208, v6
    v_add_f32 v6, 1065353216, v17
    v_mul_f32 v6, v6, v5
    v_cos_f32 v193, v6
    v_sin_f32 v209, v6
    v_add_f32 v6, 1073741824, v17
    v_mul_f32 v6, v6, v5
    v_cos_f32 v194, v6
    v_sin_f32 v210, v6
    v_add_f32 v6, 1077936128, v17
    v_mul_f32 v6, v6, v5
    v_cos_f32 v195, v6
    v_sin_f32 v211, v6
    v_add_f32 v6, 1082130432, v17
    v_mul_f32 v6, v6, v5
    v_cos_f32 v196, v6
    v_sin_f32 v212, v6
    v_add_f32 v6, 1084227584, v17
    v_mul_f32 v6, v6, v5
    v_cos_f32 v197, v6
    v_sin_f32 v213, v6
    v_add_f32 v6, 1086324736, v17
    v_mul_f32 v6, v6, v5
    v_cos_f32 v198, v6
    v_sin_f32 v214, v6
    v_add_f32 v6, 1088421888, v17
    v_mul_f32 v6, v6, v5
    v_cos_f32 v199, v6
    v_sin_f32 v215, v6
    v_add_f32 v6, 1098907648, v17
    v_mul_f32 v6, v6, v5
    v_cos_f32 v200, v6
    v_sin_f32 v216, v6
    v_add_f32 v6, 1099431936, v17
    v_mul_f32 v6, v6, v5
    v_cos_f32 v201, v6
    v_sin_f32 v217, v6
    v_add_f32 v6, 1099956224, v17
    v_mul_f32 v6, v6, v5
    v_cos_f32 v202, v6
    v_sin_f32 v218, v6
    v_add_f32 v6, 1100480512, v17
    v_mul_f32 v6, v6, v5
    v_cos_f32 v203, v6
    v_sin_f32 v219, v6
    v_add_f32 v6, 1101004800, v17
    v_mul_f32 v6, v6, v5
    v_cos_f32 v204, v6
    v_sin_f32 v220, v6
    v_add_f32 v6, 1101529088, v17
    v_mul_f32 v6, v6, v5
    v_cos_f32 v205, v6
    v_sin_f32 v221, v6
    v_add_f32 v6, 1102053376, v17
    v_mul_f32 v6, v6, v5
    v_cos_f32 v206, v6
    v_sin_f32 v222, v6
    v_add_f32 v6, 1102577664, v17
    v_mul_f32 v6, v6, v5
    v_cos_f32 v207, v6
    v_sin_f32 v223, v6
    v_add_f32 v5, 0, v16
    v_mul_f32 v5, 973078528, v5
    v_add_f32 v6, 1107296256, v17
    v_mul_f32 v6, v6, v5
    v_cos_f32 v224, v6
    v_sin_f32 v240, v6
    v_add_f32 v6, 1107558400, v17
    v_mul_f32 v6, v6, v5
    v_cos_f32 v225, v6
    v_sin_f32 v241, v6
    v_add_f32 v6, 1107820544, v17
    v_mul_f32 v6, v6, v5
    v_cos_f32 v226, v6
    v_sin_f32 v242, v6
    v_add_f32 v6, 1108082688, v17
    v_mul_f32 v6, v6, v5
    v_cos_f32 v227, v6
    v_sin_f32 v243, v6
    v_add_f32 v6, 1108344832, v17
    v_mul_f32 v6, v6, v5
    v_cos_f32 v228, v6
    v_sin_f32 v244, v6
    v_add_f32 v6, 1108606976, v17
    v_mul_f32 v6, v6, v5
    v_cos_f32 v229, v6
    v_sin_f32 v245, v6
    v_add_f32 v6, 1108869120, v17
    v_mul_f32 v6, v6, v5
    v_cos_f32 v230, v6
    v_sin_f32 v246, v6
    v_add_f32 v6, 1109131264, v17
    v_mul_f32 v6, v6, v5
    v_cos_f32 v231, v6
    v_sin_f32 v247, v6
    v_add_f32 v6, 1111490560, v17
    v_mul_f32 v6, v6, v5
    v_cos_f32 v232, v6
    v_sin_f32 v248, v6
    v_add_f32 v6, 1111752704, v17
    v_mul_f32 v6, v6, v5
    v_cos_f32 v233, v6
    v_sin_f32 v249, v6
    v_add_f32 v6, 1112014848, v17
    v_mul_f32 v6, v6, v5
    v_cos_f32 v234, v6
    v_sin_f32 v250, v6
    v_add_f32 v6, 1112276992, v17
    v_mul_f32 v6, v6, v5
    v_cos_f32 v235, v6
    v_sin_f32 v251, v6
    v_add_f32 v6, 1112539136, v17
    v_mul_f32 v6, v6, v5
    v_cos_f32 v236, v6
    v_sin_f32 v252, v6
    v_add_f32 v6, 1112801280, v17
    v_mul_f32 v6, v6, v5
    v_cos_f32 v237, v6
    v_sin_f32 v253, v6
    v_add_f32 v6, 1113063424, v17
    v_mul_f32 v6, v6, v5
    v_cos_f32 v238, v6
    v_sin_f32 v254, v6
    v_add_f32 v6, 1113325568, v17
    v_mul_f32 v6, v6, v5
    v_cos_f32 v239, v6
    v_sin_f32 v255, v6
    s_barrier
.p2align 6
F2_top:
    s_waitcnt vmcnt(0)
    v_mfma_f32_32x32x16_bf16 v[32:47], v[128:131], a[0:3], 0
    v_mfma_f32_32x32x16_bf16 v[48:63], v[144:147], a[0:3], 0
    v_mfma_f32_32x32x16_bf16 v[32:47], v[144:147], a[32:35], v[32:47]
    ds_write_b128 v13, a[248:251]
    v_mfma_f32_32x32x16_bf16 v[48:63], v[128:131], a[64:67], v[48:63]
    ds_write_b128 v13, a[252:255] offset:1024
    ds_write_b16 v13, v2 offset:2
    v_mfma_f32_32x32x16_bf16 v[32:47], v[132:135], a[4:7], v[32:47]
    ds_write_b16 v13, v3 offset:1026
    v_mfma_f32_32x32x16_bf16 v[48:63], v[148:151], a[4:7], v[48:63]
    ds_write_b16 v13, v4 offset:6
    ds_write_b16 v13, v7 offset:1030
    v_mfma_f32_32x32x16_bf16 v[32:47], v[148:151], a[36:39], v[32:47]
    ds_write_b16 v13, v8 offset:10
    v_mfma_f32_32x32x16_bf16 v[48:63], v[132:135], a[68:71], v[48:63]
    ds_write_b16 v13, v10 offset:1034
    ds_write_b16 v13, v11 offset:14
    v_mfma_f32_32x32x16_bf16 v[32:47], v[136:139], a[8:11], v[32:47]
    ds_write_b16 v13, v16 offset:1038
    v_mfma_f32_32x32x16_bf16 v[48:63], v[152:155], a[8:11], v[48:63]
    v_add_u32 v13, 2048, v13
    s_add_u32 s36, s36, 1
    v_mfma_f32_32x32x16_bf16 v[32:47], v[152:155], a[40:43], v[32:47]
    s_add_u32 s32, s32, 128
    v_mfma_f32_32x32x16_bf16 v[48:63], v[136:139], a[72:75], v[48:63]
    s_add_u32 s33, s32, 64
    s_cmp_eq_u32 s36, 4
    v_mfma_f32_32x32x16_bf16 v[32:47], v[140:143], a[12:15], v[32:47]
    s_cselect_b32 s32, 104857664, s32
    v_mfma_f32_32x32x16_bf16 v[48:63], v[156:159], a[12:15], v[48:63]
    s_cselect_b32 s33, 1073741824, s33
    s_cmp_lt_u32 s36, s37
    v_mfma_f32_32x32x16_bf16 v[32:47], v[156:159], a[44:47], v[32:47]
    s_cselect_b32 s32, s32, 1073741824
    v_mfma_f32_32x32x16_bf16 v[48:63], v[140:143], a[76:79], v[48:63]
    s_cselect_b32 s33, s33, 1073741824
    v_add_u32 v19, s35, v14
    v_mfma_f32_32x32x16_bf16 v[64:79], v[128:131], a[16:19], 0
    v_mfma_f32_32x32x16_bf16 v[80:95], v[144:147], a[16:19], 0
    s_add_u32 s18, s34, 0
    buffer_load_ushort a248, v12, s[48:51], s18 offen
    buffer_load_ushort v2, v12, s[52:55], s18 offen
    v_mfma_f32_32x32x16_bf16 v[64:79], v[144:147], a[48:51], v[64:79]
    v_mul_f32 v20, v32, v160
    s_nop 0
    v_mul_f32 v22, v48, v160
    v_mul_f32 v21, v33, v161
    v_mul_f32 v23, v49, v161
    v_fma_f32 v20, v48, v176, v20
    v_mfma_f32_32x32x16_bf16 v[80:95], v[128:131], a[80:83], v[80:95]
    v_fma_f32 v22, -v32, v176, v22
    v_fma_f32 v21, v49, v177, v21
    v_fma_f32 v23, -v33, v177, v23
    v_cvt_pk_bf16_f32 v96, v20, v21
    v_cvt_pk_bf16_f32 v112, v22, v23
    v_mul_f32 v24, v34, v162
    v_mfma_f32_32x32x16_bf16 v[64:79], v[132:135], a[20:23], v[64:79]
    v_mul_f32 v26, v50, v162
    v_mul_f32 v25, v35, v163
    v_mul_f32 v27, v51, v163
    v_fma_f32 v24, v50, v178, v24
    v_fma_f32 v26, -v34, v178, v26
    v_fma_f32 v25, v51, v179, v25
    v_mfma_f32_32x32x16_bf16 v[80:95], v[148:151], a[20:23], v[80:95]
    v_fma_f32 v27, -v35, v179, v27
    v_cvt_pk_bf16_f32 v97, v24, v25
    v_cvt_pk_bf16_f32 v113, v26, v27
    v_mul_f32 v20, v36, v164
    v_mul_f32 v22, v52, v164
    v_mfma_f32_32x32x16_bf16 v[64:79], v[148:151], a[52:55], v[64:79]
    v_mul_f32 v21, v37, v165
    v_mul_f32 v23, v53, v165
    v_fma_f32 v20, v52, v180, v20
    v_fma_f32 v22, -v36, v180, v22
    v_fma_f32 v21, v53, v181, v21
    v_fma_f32 v23, -v37, v181, v23
    v_mfma_f32_32x32x16_bf16 v[80:95], v[132:135], a[84:87], v[80:95]
    v_cvt_pk_bf16_f32 v98, v20, v21
    v_cvt_pk_bf16_f32 v114, v22, v23
    v_mul_f32 v24, v38, v166
    v_mul_f32 v26, v54, v166
    v_mul_f32 v25, v39, v167
    v_mul_f32 v27, v55, v167
    v_mfma_f32_32x32x16_bf16 v[64:79], v[136:139], a[24:27], v[64:79]
    v_fma_f32 v24, v54, v182, v24
    v_fma_f32 v26, -v38, v182, v26
    v_fma_f32 v25, v55, v183, v25
    v_fma_f32 v27, -v39, v183, v27
    v_cvt_pk_bf16_f32 v99, v24, v25
    v_cvt_pk_bf16_f32 v115, v26, v27
    v_mfma_f32_32x32x16_bf16 v[80:95], v[152:155], a[24:27], v[80:95]
    v_mul_f32 v20, v40, v168
    v_mul_f32 v22, v56, v168
    v_mul_f32 v21, v41, v169
    v_mul_f32 v23, v57, v169
    v_fma_f32 v20, v56, v184, v20
    v_mfma_f32_32x32x16_bf16 v[64:79], v[152:155], a[56:59], v[64:79]
    v_fma_f32 v22, -v40, v184, v22
    v_fma_f32 v21, v57, v185, v21
    v_fma_f32 v23, -v41, v185, v23
    v_cvt_pk_bf16_f32 v100, v20, v21
    v_cvt_pk_bf16_f32 v116, v22, v23
    v_mul_f32 v24, v42, v170
    v_mfma_f32_32x32x16_bf16 v[80:95], v[136:139], a[88:91], v[80:95]
    v_mul_f32 v26, v58, v170
    v_mul_f32 v25, v43, v171
    v_mul_f32 v27, v59, v171
    v_fma_f32 v24, v58, v186, v24
    v_fma_f32 v26, -v42, v186, v26
    v_fma_f32 v25, v59, v187, v25
    v_mfma_f32_32x32x16_bf16 v[64:79], v[140:143], a[28:31], v[64:79]
    v_fma_f32 v27, -v43, v187, v27
    v_cvt_pk_bf16_f32 v101, v24, v25
    v_cvt_pk_bf16_f32 v117, v26, v27
    v_mul_f32 v20, v44, v172
    v_mul_f32 v22, v60, v172
    v_mfma_f32_32x32x16_bf16 v[80:95], v[156:159], a[28:31], v[80:95]
    v_mul_f32 v21, v45, v173
    v_mul_f32 v23, v61, v173
    v_fma_f32 v20, v60, v188, v20
    v_fma_f32 v22, -v44, v188, v22
    v_fma_f32 v21, v61, v189, v21
    v_fma_f32 v23, -v45, v189, v23
    v_mfma_f32_32x32x16_bf16 v[64:79], v[156:159], a[60:63], v[64:79]
    v_cvt_pk_bf16_f32 v102, v20, v21
    v_cvt_pk_bf16_f32 v118, v22, v23
    v_mul_f32 v24, v46, v174
    v_mul_f32 v26, v62, v174
    v_mul_f32 v25, v47, v175
    v_mul_f32 v27, v63, v175
    v_mfma_f32_32x32x16_bf16 v[80:95], v[140:143], a[92:95], v[80:95]
    v_fma_f32 v24, v62, v190, v24
    v_fma_f32 v26, -v46, v190, v26
    v_fma_f32 v25, v63, v191, v25
    v_fma_f32 v27, -v47, v191, v27
    v_cvt_pk_bf16_f32 v103, v24, v25
    v_cvt_pk_bf16_f32 v119, v26, v27
    v_mfma_f32_32x32x16_bf16 v[32:47], a[96:99], v[96:99], 0
    buffer_load_dwordx4 v[128:131], v15, s[4:7], s32 offen offset:0
    v_mfma_f32_32x32x16_bf16 v[48:63], a[96:99], v[112:115], 0
    buffer_load_dwordx4 v[132:135], v15, s[4:7], s32 offen offset:32
    v_mfma_f32_32x32x16_bf16 v[32:47], a[104:107], v[112:115], v[32:47]
    s_add_u32 s17, s32, 69632
    buffer_load_dwordx4 v[136:139], v15, s[4:7], s17 offen offset:0
    v_mul_f32 v20, v64, v192
    v_mul_f32 v22, v80, v192
    v_mul_f32 v21, v65, v193
    v_mul_f32 v23, v81, v193
    v_fma_f32 v20, v80, v208, v20
    v_fma_f32 v22, -v64, v208, v22
    v_fma_f32 v21, v81, v209, v21
    v_fma_f32 v23, -v65, v209, v23
    v_cvt_pk_bf16_f32 v104, v20, v21
    v_cvt_pk_bf16_f32 v120, v22, v23
    v_mul_f32 v24, v66, v194
    v_mul_f32 v26, v82, v194
    v_mul_f32 v25, v67, v195
    v_mfma_f32_32x32x16_bf16 v[48:63], a[112:115], v[96:99], v[48:63]
    buffer_load_dwordx4 v[140:143], v15, s[4:7], s17 offen offset:32
    v_mul_f32 v27, v83, v195
    v_fma_f32 v24, v82, v210, v24
    v_fma_f32 v26, -v66, v210, v26
    v_fma_f32 v25, v83, v211, v25
    v_fma_f32 v27, -v67, v211, v27
    v_cvt_pk_bf16_f32 v105, v24, v25
    v_cvt_pk_bf16_f32 v121, v26, v27
    v_mul_f32 v20, v68, v196
    v_mul_f32 v22, v84, v196
    v_mul_f32 v21, v69, v197
    v_mul_f32 v23, v85, v197
    v_fma_f32 v20, v84, v212, v20
    v_fma_f32 v22, -v68, v212, v22
    v_mfma_f32_32x32x16_bf16 v[32:47], a[100:103], v[100:103], v[32:47]
    buffer_load_dwordx4 v[144:147], v15, s[4:7], s33 offen offset:0
    v_fma_f32 v21, v85, v213, v21
    v_fma_f32 v23, -v69, v213, v23
    v_cvt_pk_bf16_f32 v106, v20, v21
    v_cvt_pk_bf16_f32 v122, v22, v23
    v_mul_f32 v24, v70, v198
    v_mul_f32 v26, v86, v198
    v_mul_f32 v25, v71, v199
    v_mul_f32 v27, v87, v199
    v_fma_f32 v24, v86, v214, v24
    v_fma_f32 v26, -v70, v214, v26
    v_fma_f32 v25, v87, v215, v25
    v_fma_f32 v27, -v71, v215, v27
    v_cvt_pk_bf16_f32 v107, v24, v25
    v_cvt_pk_bf16_f32 v123, v26, v27
    v_mfma_f32_32x32x16_bf16 v[48:63], a[100:103], v[116:119], v[48:63]
    buffer_load_dwordx4 v[148:151], v15, s[4:7], s33 offen offset:32
    v_mul_f32 v20, v72, v200
    v_mul_f32 v22, v88, v200
    v_mul_f32 v21, v73, v201
    v_mul_f32 v23, v89, v201
    v_fma_f32 v20, v88, v216, v20
    v_fma_f32 v22, -v72, v216, v22
    v_fma_f32 v21, v89, v217, v21
    v_fma_f32 v23, -v73, v217, v23
    v_cvt_pk_bf16_f32 v108, v20, v21
    v_cvt_pk_bf16_f32 v124, v22, v23
    v_mul_f32 v24, v74, v202
    v_mul_f32 v26, v90, v202
    v_mul_f32 v25, v75, v203
    v_mfma_f32_32x32x16_bf16 v[32:47], a[108:111], v[116:119], v[32:47]
    s_add_u32 s17, s33, 69632
    buffer_load_dwordx4 v[152:155], v15, s[4:7], s17 offen offset:0
    v_mul_f32 v27, v91, v203
    v_fma_f32 v24, v90, v218, v24
    v_fma_f32 v26, -v74, v218, v26
    v_fma_f32 v25, v91, v219, v25
    v_fma_f32 v27, -v75, v219, v27
    v_cvt_pk_bf16_f32 v109, v24, v25
    v_cvt_pk_bf16_f32 v125, v26, v27
    v_mul_f32 v20, v76, v204
    v_mul_f32 v22, v92, v204
    v_mul_f32 v21, v77, v205
    v_mul_f32 v23, v93, v205
    v_fma_f32 v20, v92, v220, v20
    v_fma_f32 v22, -v76, v220, v22
    v_mfma_f32_32x32x16_bf16 v[48:63], a[116:119], v[100:103], v[48:63]
    buffer_load_dwordx4 v[156:159], v15, s[4:7], s17 offen offset:32
    s_nop 1
    ds_read_b128 v[96:99], v19 offset:0
    ds_read_b128 v[112:115], v19 offset:1024
    ds_read_b128 v[100:103], v19 offset:2048
    ds_read_b128 v[116:119], v19 offset:3072
    v_fma_f32 v21, v93, v221, v21
    v_fma_f32 v23, -v77, v221, v23
    v_cvt_pk_bf16_f32 v110, v20, v21
    v_cvt_pk_bf16_f32 v126, v22, v23
    v_mul_f32 v24, v78, v206
    v_mul_f32 v26, v94, v206
    v_mul_f32 v25, v79, v207
    v_mul_f32 v27, v95, v207
    v_fma_f32 v24, v94, v222, v24
    v_fma_f32 v26, -v78, v222, v26
    v_fma_f32 v25, v95, v223, v25
    v_fma_f32 v27, -v79, v223, v27
    v_cvt_pk_bf16_f32 v111, v24, v25
    v_cvt_pk_bf16_f32 v127, v26, v27
    v_mfma_f32_32x32x16_bf16 v[64:79], a[96:99], v[104:107], 0
    v_mfma_f32_32x32x16_bf16 v[80:95], a[96:99], v[120:123], 0
    s_add_u32 s18, s34, 65664
    buffer_load_ushort a252, v12, s[48:51], s18 offen
    buffer_load_ushort v3, v12, s[52:55], s18 offen
    v_mfma_f32_32x32x16_bf16 v[64:79], a[104:107], v[120:123], v[64:79]
    s_waitcnt lgkmcnt(0)
    v_lshlrev_b32 v28, 16, v96
    v_and_b32 v30, s38, v96
    v_lshlrev_b32 v29, 16, v112
    v_and_b32 v31, s38, v112
    v_mul_f32 v20, v32, v28
    v_mul_f32 v22, v48, v28
    v_mul_f32 v21, v33, v29
    v_mul_f32 v23, v49, v29
    v_fma_f32 v20, -v48, v30, v20
    v_fma_f32 v22, v32, v30, v22
    v_fma_f32 v21, -v49, v31, v21
    v_fma_f32 v23, v33, v31, v23
    v_cvt_pk_bf16_f32 v96, v20, v21
    v_cvt_pk_bf16_f32 v112, v22, v23
    v_lshlrev_b32 v28, 16, v97
    v_and_b32 v30, s38, v97
    v_lshlrev_b32 v29, 16, v113
    v_mfma_f32_32x32x16_bf16 v[80:95], a[112:115], v[104:107], v[80:95]
    v_and_b32 v31, s38, v113
    v_mul_f32 v24, v34, v28
    v_mul_f32 v26, v50, v28
    v_mul_f32 v25, v35, v29
    v_mul_f32 v27, v51, v29
    v_fma_f32 v24, -v50, v30, v24
    v_fma_f32 v26, v34, v30, v26
    v_fma_f32 v25, -v51, v31, v25
    v_fma_f32 v27, v35, v31, v27
    v_cvt_pk_bf16_f32 v97, v24, v25
    v_cvt_pk_bf16_f32 v113, v26, v27
    v_lshlrev_b32 v28, 16, v98
    v_and_b32 v30, s38, v98
    v_lshlrev_b32 v29, 16, v114
    v_and_b32 v31, s38, v114
    v_mul_f32 v20, v36, v28
    v_mul_f32 v22, v52, v28
    v_mul_f32 v21, v37, v29
    v_mul_f32 v23, v53, v29
    v_mfma_f32_32x32x16_bf16 v[64:79], a[100:103], v[108:111], v[64:79]
    v_fma_f32 v20, -v52, v30, v20
    v_fma_f32 v22, v36, v30, v22
    v_fma_f32 v21, -v53, v31, v21
    v_fma_f32 v23, v37, v31, v23
    v_cvt_pk_bf16_f32 v98, v20, v21
    v_cvt_pk_bf16_f32 v114, v22, v23
    v_lshlrev_b32 v28, 16, v99
    v_and_b32 v30, s38, v99
    v_lshlrev_b32 v29, 16, v115
    v_and_b32 v31, s38, v115
    v_mul_f32 v24, v38, v28
    v_mul_f32 v26, v54, v28
    v_mul_f32 v25, v39, v29
    v_mul_f32 v27, v55, v29
    v_fma_f32 v24, -v54, v30, v24
    v_fma_f32 v26, v38, v30, v26
    v_fma_f32 v25, -v55, v31, v25
    v_fma_f32 v27, v39, v31, v27
    v_cvt_pk_bf16_f32 v99, v24, v25
    v_mfma_f32_32x32x16_bf16 v[80:95], a[100:103], v[124:127], v[80:95]
    v_cvt_pk_bf16_f32 v115, v26, v27
    v_lshlrev_b32 v28, 16, v100
    v_and_b32 v30, s38, v100
    v_lshlrev_b32 v29, 16, v116
    v_and_b32 v31, s38, v116
    v_mul_f32 v20, v40, v28
    v_mul_f32 v22, v56, v28
    v_mul_f32 v21, v41, v29
    v_mul_f32 v23, v57, v29
    v_fma_f32 v20, -v56, v30, v20
    v_fma_f32 v22, v40, v30, v22
    v_fma_f32 v21, -v57, v31, v21
    v_fma_f32 v23, v41, v31, v23
    v_cvt_pk_bf16_f32 v100, v20, v21
    v_cvt_pk_bf16_f32 v116, v22, v23
    v_lshlrev_b32 v28, 16, v101
    v_and_b32 v30, s38, v101
    v_lshlrev_b32 v29, 16, v117
    v_and_b32 v31, s38, v117
    v_mfma_f32_32x32x16_bf16 v[64:79], a[108:111], v[124:127], v[64:79]
    v_mul_f32 v24, v42, v28
    v_mul_f32 v26, v58, v28
    v_mul_f32 v25, v43, v29
    v_mul_f32 v27, v59, v29
    v_fma_f32 v24, -v58, v30, v24
    v_fma_f32 v26, v42, v30, v26
    v_fma_f32 v25, -v59, v31, v25
    v_fma_f32 v27, v43, v31, v27
    v_cvt_pk_bf16_f32 v101, v24, v25
    v_cvt_pk_bf16_f32 v117, v26, v27
    v_lshlrev_b32 v28, 16, v102
    v_and_b32 v30, s38, v102
    v_lshlrev_b32 v29, 16, v118
    v_and_b32 v31, s38, v118
    v_mul_f32 v20, v44, v28
    v_mul_f32 v22, v60, v28
    v_mul_f32 v21, v45, v29
    v_mul_f32 v23, v61, v29
    v_fma_f32 v20, -v60, v30, v20
    v_mfma_f32_32x32x16_bf16 v[80:95], a[116:119], v[108:111], v[80:95]
    s_nop 1
    ds_read_b128 v[104:107], v19 offset:4096
    ds_read_b128 v[120:123], v19 offset:5120
    ds_read_b128 v[108:111], v19 offset:6144
    ds_read_b128 v[124:127], v19 offset:7168
    v_fma_f32 v22, v44, v30, v22
    v_fma_f32 v21, -v61, v31, v21
    v_fma_f32 v23, v45, v31, v23
    v_cvt_pk_bf16_f32 v102, v20, v21
    v_cvt_pk_bf16_f32 v118, v22, v23
    v_lshlrev_b32 v28, 16, v103
    v_and_b32 v30, s38, v103
    v_lshlrev_b32 v29, 16, v119
    v_and_b32 v31, s38, v119
    v_mul_f32 v24, v46, v28
    v_mul_f32 v26, v62, v28
    v_mul_f32 v25, v47, v29
    v_mul_f32 v27, v63, v29
    v_fma_f32 v24, -v62, v30, v24
    v_fma_f32 v26, v46, v30, v26
    v_fma_f32 v25, -v63, v31, v25
    v_fma_f32 v27, v47, v31, v27
    v_cvt_pk_bf16_f32 v103, v24, v25
    v_cvt_pk_bf16_f32 v119, v26, v27
    v_mfma_f32_32x32x16_bf16 v[32:47], v[96:99], a[96:99], 0
    v_mfma_f32_32x32x16_bf16 v[48:63], v[112:115], a[96:99], 0
    s_add_u32 s18, s34, 131328
    buffer_load_ushort a249, v12, s[48:51], s18 offen
    buffer_load_ushort v4, v12, s[52:55], s18 offen
    v_mfma_f32_32x32x16_bf16 v[32:47], v[112:115], a[112:115], v[32:47]
    s_waitcnt lgkmcnt(0)
    v_lshlrev_b32 v28, 16, v104
    v_and_b32 v30, s38, v104
    v_lshlrev_b32 v29, 16, v120
    v_and_b32 v31, s38, v120
    v_mul_f32 v20, v64, v28
    v_mul_f32 v22, v80, v28
    v_mul_f32 v21, v65, v29
    v_mul_f32 v23, v81, v29
    v_fma_f32 v20, -v80, v30, v20
    v_fma_f32 v22, v64, v30, v22
    v_fma_f32 v21, -v81, v31, v21
    v_fma_f32 v23, v65, v31, v23
    v_cvt_pk_bf16_f32 v104, v20, v21
    v_cvt_pk_bf16_f32 v120, v22, v23
    v_lshlrev_b32 v28, 16, v105
    v_and_b32 v30, s38, v105
    v_lshlrev_b32 v29, 16, v121
    v_mfma_f32_32x32x16_bf16 v[48:63], v[96:99], a[104:107], v[48:63]
    v_and_b32 v31, s38, v121
    v_mul_f32 v24, v66, v28
    v_mul_f32 v26, v82, v28
    v_mul_f32 v25, v67, v29
    v_mul_f32 v27, v83, v29
    v_fma_f32 v24, -v82, v30, v24
    v_fma_f32 v26, v66, v30, v26
    v_fma_f32 v25, -v83, v31, v25
    v_fma_f32 v27, v67, v31, v27
    v_cvt_pk_bf16_f32 v105, v24, v25
    v_cvt_pk_bf16_f32 v121, v26, v27
    v_lshlrev_b32 v28, 16, v106
    v_and_b32 v30, s38, v106
    v_lshlrev_b32 v29, 16, v122
    v_and_b32 v31, s38, v122
    v_mul_f32 v20, v68, v28
    v_mul_f32 v22, v84, v28
    v_mul_f32 v21, v69, v29
    v_mul_f32 v23, v85, v29
    v_mfma_f32_32x32x16_bf16 v[32:47], v[100:103], a[100:103], v[32:47]
    v_fma_f32 v20, -v84, v30, v20
    v_fma_f32 v22, v68, v30, v22
    v_fma_f32 v21, -v85, v31, v21
    v_fma_f32 v23, v69, v31, v23
    v_cvt_pk_bf16_f32 v106, v20, v21
    v_cvt_pk_bf16_f32 v122, v22, v23
    v_lshlrev_b32 v28, 16, v107
    v_and_b32 v30, s38, v107
    v_lshlrev_b32 v29, 16, v123
    v_and_b32 v31, s38, v123
    v_mul_f32 v24, v70, v28
    v_mul_f32 v26, v86, v28
    v_mul_f32 v25, v71, v29
    v_mul_f32 v27, v87, v29
    v_fma_f32 v24, -v86, v30, v24
    v_fma_f32 v26, v70, v30, v26
    v_fma_f32 v25, -v87, v31, v25
    v_fma_f32 v27, v71, v31, v27
    v_cvt_pk_bf16_f32 v107, v24, v25
    v_mfma_f32_32x32x16_bf16 v[48:63], v[116:119], a[100:103], v[48:63]
    v_cvt_pk_bf16_f32 v123, v26, v27
    v_lshlrev_b32 v28, 16, v108
    v_and_b32 v30, s38, v108
    v_lshlrev_b32 v29, 16, v124
    v_and_b32 v31, s38, v124
    v_mul_f32 v20, v72, v28
    v_mul_f32 v22, v88, v28
    v_mul_f32 v21, v73, v29
    v_mul_f32 v23, v89, v29
    v_fma_f32 v20, -v88, v30, v20
    v_fma_f32 v22, v72, v30, v22
    v_fma_f32 v21, -v89, v31, v21
    v_fma_f32 v23, v73, v31, v23
    v_cvt_pk_bf16_f32 v108, v20, v21
    v_cvt_pk_bf16_f32 v124, v22, v23
    v_lshlrev_b32 v28, 16, v109
    v_and_b32 v30, s38, v109
    v_lshlrev_b32 v29, 16, v125
    v_and_b32 v31, s38, v125
    v_mfma_f32_32x32x16_bf16 v[32:47], v[116:119], a[116:119], v[32:47]
    v_mul_f32 v24, v74, v28
    v_mul_f32 v26, v90, v28
    v_mul_f32 v25, v75, v29
    v_mul_f32 v27, v91, v29
    v_fma_f32 v24, -v90, v30, v24
    v_fma_f32 v26, v74, v30, v26
    v_fma_f32 v25, -v91, v31, v25
    v_fma_f32 v27, v75, v31, v27
    v_cvt_pk_bf16_f32 v109, v24, v25
    v_cvt_pk_bf16_f32 v125, v26, v27
    v_lshlrev_b32 v28, 16, v110
    v_and_b32 v30, s38, v110
    v_lshlrev_b32 v29, 16, v126
    v_and_b32 v31, s38, v126
    v_mul_f32 v20, v76, v28
    v_mul_f32 v22, v92, v28
    v_mul_f32 v21, v77, v29
    v_mul_f32 v23, v93, v29
    v_fma_f32 v20, -v92, v30, v20
    v_mfma_f32_32x32x16_bf16 v[48:63], v[100:103], a[108:111], v[48:63]
    v_fma_f32 v22, v76, v30, v22
    v_fma_f32 v21, -v93, v31, v21
    v_fma_f32 v23, v77, v31, v23
    v_cvt_pk_bf16_f32 v110, v20, v21
    v_cvt_pk_bf16_f32 v126, v22, v23
    v_lshlrev_b32 v28, 16, v111
    v_and_b32 v30, s38, v111
    v_lshlrev_b32 v29, 16, v127
    v_and_b32 v31, s38, v127
    v_mul_f32 v24, v78, v28
    v_mul_f32 v26, v94, v28
    v_mul_f32 v25, v79, v29
    v_mul_f32 v27, v95, v29
    v_fma_f32 v24, -v94, v30, v24
    v_fma_f32 v26, v78, v30, v26
    v_fma_f32 v25, -v95, v31, v25
    v_fma_f32 v27, v79, v31, v27
    v_cvt_pk_bf16_f32 v111, v24, v25
    v_cvt_pk_bf16_f32 v127, v26, v27
    v_mfma_f32_32x32x16_bf16 v[64:79], v[104:107], a[96:99], 0
    v_mfma_f32_32x32x16_bf16 v[80:95], v[120:123], a[96:99], 0
    s_add_u32 s18, s34, 196992
    buffer_load_ushort a253, v12, s[48:51], s18 offen
    buffer_load_ushort v7, v12, s[52:55], s18 offen
    v_mfma_f32_32x32x16_bf16 v[64:79], v[120:123], a[112:115], v[64:79]
    v_mul_f32 v20, v32, v160
    v_mul_f32 v22, v48, v160
    v_mul_f32 v21, v33, v161
    v_mul_f32 v23, v49, v161
    v_fma_f32 v20, -v48, v176, v20
    v_fma_f32 v22, v32, v176, v22
    v_fma_f32 v21, -v49, v177, v21
    v_fma_f32 v23, v33, v177, v23
    v_cvt_pk_bf16_f32 v96, v20, v21
    v_cvt_pk_bf16_f32 v112, v22, v23
    v_mul_f32 v24, v34, v162
    v_mul_f32 v26, v50, v162
    v_mul_f32 v25, v35, v163
    v_mfma_f32_32x32x16_bf16 v[80:95], v[104:107], a[104:107], v[80:95]
    v_mul_f32 v27, v51, v163
    v_fma_f32 v24, -v50, v178, v24
    v_fma_f32 v26, v34, v178, v26
    v_fma_f32 v25, -v51, v179, v25
    v_fma_f32 v27, v35, v179, v27
    v_cvt_pk_bf16_f32 v97, v24, v25
    v_cvt_pk_bf16_f32 v113, v26, v27
    v_mul_f32 v20, v36, v164
    v_mul_f32 v22, v52, v164
    v_mul_f32 v21, v37, v165
    v_mul_f32 v23, v53, v165
    v_fma_f32 v20, -v52, v180, v20
    v_fma_f32 v22, v36, v180, v22
    v_mfma_f32_32x32x16_bf16 v[64:79], v[108:111], a[100:103], v[64:79]
    v_fma_f32 v21, -v53, v181, v21
    v_fma_f32 v23, v37, v181, v23
    v_cvt_pk_bf16_f32 v98, v20, v21
    v_cvt_pk_bf16_f32 v114, v22, v23
    v_mul_f32 v24, v38, v166
    v_mul_f32 v26, v54, v166
    v_mul_f32 v25, v39, v167
    v_mul_f32 v27, v55, v167
    v_fma_f32 v24, -v54, v182, v24
    v_fma_f32 v26, v38, v182, v26
    v_fma_f32 v25, -v55, v183, v25
    v_fma_f32 v27, v39, v183, v27
    v_cvt_pk_bf16_f32 v99, v24, v25
    v_cvt_pk_bf16_f32 v115, v26, v27
    v_mfma_f32_32x32x16_bf16 v[80:95], v[124:127], a[100:103], v[80:95]
    v_mul_f32 v20, v40, v168
    v_mul_f32 v22, v56, v168
    v_mul_f32 v21, v41, v169
    v_mul_f32 v23, v57, v169
    v_fma_f32 v20, -v56, v184, v20
    v_fma_f32 v22, v40, v184, v22
    v_fma_f32 v21, -v57, v185, v21
    v_fma_f32 v23, v41, v185, v23
    v_cvt_pk_bf16_f32 v100, v20, v21
    v_cvt_pk_bf16_f32 v116, v22, v23
    v_mul_f32 v24, v42, v170
    v_mul_f32 v26, v58, v170
    v_mul_f32 v25, v43, v171
    v_mfma_f32_32x32x16_bf16 v[64:79], v[124:127], a[116:119], v[64:79]
    v_mul_f32 v27, v59, v171
    v_fma_f32 v24, -v58, v186, v24
    v_fma_f32 v26, v42, v186, v26
    v_fma_f32 v25, -v59, v187, v25
    v_fma_f32 v27, v43, v187, v27
    v_cvt_pk_bf16_f32 v101, v24, v25
    v_cvt_pk_bf16_f32 v117, v26, v27
    v_mul_f32 v20, v44, v172
    v_mul_f32 v22, v60, v172
    v_mul_f32 v21, v45, v173
    v_mul_f32 v23, v61, v173
    v_fma_f32 v20, -v60, v188, v20
    v_fma_f32 v22, v44, v188, v22
    v_mfma_f32_32x32x16_bf16 v[80:95], v[108:111], a[108:111], v[80:95]
    v_fma_f32 v21, -v61, v189, v21
    v_fma_f32 v23, v45, v189, v23
    v_cvt_pk_bf16_f32 v102, v20, v21
    v_cvt_pk_bf16_f32 v118, v22, v23
    v_mul_f32 v24, v46, v174
    v_mul_f32 v26, v62, v174
    v_mul_f32 v25, v47, v175
    v_mul_f32 v27, v63, v175
    v_fma_f32 v24, -v62, v190, v24
    v_fma_f32 v26, v46, v190, v26
    v_fma_f32 v25, -v63, v191, v25
    v_fma_f32 v27, v47, v191, v27
    v_cvt_pk_bf16_f32 v103, v24, v25
    v_cvt_pk_bf16_f32 v119, v26, v27
    v_mfma_f32_32x32x16_bf16 v[32:47], a[0:3], v[96:99], 0
    v_mfma_f32_32x32x16_bf16 v[48:63], a[0:3], v[112:115], 0
    s_add_u32 s18, s34, 262656
    buffer_load_ushort a250, v12, s[48:51], s18 offen
    buffer_load_ushort v8, v12, s[52:55], s18 offen
    v_mfma_f32_32x32x16_bf16 v[32:47], a[64:67], v[112:115], v[32:47]
    v_mul_f32 v20, v64, v224
    v_mul_f32 v22, v80, v224
    v_mul_f32 v21, v65, v225
    v_mul_f32 v23, v81, v225
    v_fma_f32 v20, -v80, v240, v20
    v_fma_f32 v22, v64, v240, v22
    v_fma_f32 v21, -v81, v241, v21
    v_fma_f32 v23, v65, v241, v23
    v_cvt_pk_bf16_f32 v104, v20, v21
    v_cvt_pk_bf16_f32 v120, v22, v23
    v_mul_f32 v24, v66, v226
    v_mul_f32 v26, v82, v226
    v_mul_f32 v25, v67, v227
    v_mfma_f32_32x32x16_bf16 v[48:63], a[32:35], v[96:99], v[48:63]
    v_mul_f32 v27, v83, v227
    v_fma_f32 v24, -v82, v242, v24
    v_fma_f32 v26, v66, v242, v26
    v_fma_f32 v25, -v83, v243, v25
    v_fma_f32 v27, v67, v243, v27
    v_cvt_pk_bf16_f32 v105, v24, v25
    v_cvt_pk_bf16_f32 v121, v26, v27
    v_mul_f32 v20, v68, v228
    v_mul_f32 v22, v84, v228
    v_mul_f32 v21, v69, v229
    v_mul_f32 v23, v85, v229
    v_fma_f32 v20, -v84, v244, v20
    v_fma_f32 v22, v68, v244, v22
    v_mfma_f32_32x32x16_bf16 v[32:47], a[4:7], v[100:103], v[32:47]
    v_fma_f32 v21, -v85, v245, v21
    v_fma_f32 v23, v69, v245, v23
    v_cvt_pk_bf16_f32 v106, v20, v21
    v_cvt_pk_bf16_f32 v122, v22, v23
    v_mul_f32 v24, v70, v230
    v_mul_f32 v26, v86, v230
    v_mul_f32 v25, v71, v231
    v_mul_f32 v27, v87, v231
    v_fma_f32 v24, -v86, v246, v24
    v_fma_f32 v26, v70, v246, v26
    v_fma_f32 v25, -v87, v247, v25
    v_fma_f32 v27, v71, v247, v27
    v_cvt_pk_bf16_f32 v107, v24, v25
    v_cvt_pk_bf16_f32 v123, v26, v27
    v_mfma_f32_32x32x16_bf16 v[48:63], a[4:7], v[116:119], v[48:63]
    v_mul_f32 v20, v72, v232
    v_mul_f32 v22, v88, v232
    v_mul_f32 v21, v73, v233
    v_mul_f32 v23, v89, v233
    v_fma_f32 v20, -v88, v248, v20
    v_fma_f32 v22, v72, v248, v22
    v_fma_f32 v21, -v89, v249, v21
    v_fma_f32 v23, v73, v249, v23
    v_cvt_pk_bf16_f32 v108, v20, v21
    v_cvt_pk_bf16_f32 v124, v22, v23
    v_mul_f32 v24, v74, v234
    v_mul_f32 v26, v90, v234
    v_mul_f32 v25, v75, v235
    v_mfma_f32_32x32x16_bf16 v[32:47], a[68:71], v[116:119], v[32:47]
    v_mul_f32 v27, v91, v235
    v_fma_f32 v24, -v90, v250, v24
    v_fma_f32 v26, v74, v250, v26
    v_fma_f32 v25, -v91, v251, v25
    v_fma_f32 v27, v75, v251, v27
    v_cvt_pk_bf16_f32 v109, v24, v25
    v_cvt_pk_bf16_f32 v125, v26, v27
    v_mul_f32 v20, v76, v236
    v_mul_f32 v22, v92, v236
    v_mul_f32 v21, v77, v237
    v_mul_f32 v23, v93, v237
    v_fma_f32 v20, -v92, v252, v20
    v_fma_f32 v22, v76, v252, v22
    v_mfma_f32_32x32x16_bf16 v[48:63], a[36:39], v[100:103], v[48:63]
    v_fma_f32 v21, -v93, v253, v21
    v_fma_f32 v23, v77, v253, v23
    v_cvt_pk_bf16_f32 v110, v20, v21
    v_cvt_pk_bf16_f32 v126, v22, v23
    v_mul_f32 v24, v78, v238
    v_mul_f32 v26, v94, v238
    v_mul_f32 v25, v79, v239
    v_mul_f32 v27, v95, v239
    v_fma_f32 v24, -v94, v254, v24
    v_fma_f32 v26, v78, v254, v26
    v_fma_f32 v25, -v95, v255, v25
    v_fma_f32 v27, v79, v255, v27
    v_cvt_pk_bf16_f32 v111, v24, v25
    v_cvt_pk_bf16_f32 v127, v26, v27
    v_mfma_f32_32x32x16_bf16 v[32:47], a[8:11], v[104:107], v[32:47]
    s_add_u32 s18, s34, 328320
    buffer_load_ushort a254, v12, s[48:51], s18 offen
    buffer_load_ushort v10, v12, s[52:55], s18 offen
    v_mfma_f32_32x32x16_bf16 v[48:63], a[8:11], v[120:123], v[48:63]
    v_mfma_f32_32x32x16_bf16 v[32:47], a[72:75], v[120:123], v[32:47]
    v_mfma_f32_32x32x16_bf16 v[48:63], a[40:43], v[104:107], v[48:63]
    v_mfma_f32_32x32x16_bf16 v[32:47], a[12:15], v[108:111], v[32:47]
    s_add_u32 s18, s34, 393984
    buffer_load_ushort a251, v12, s[48:51], s18 offen
    buffer_load_ushort v11, v12, s[52:55], s18 offen
    v_mfma_f32_32x32x16_bf16 v[48:63], a[12:15], v[124:127], v[48:63]
    v_mfma_f32_32x32x16_bf16 v[32:47], a[76:79], v[124:127], v[32:47]
    v_mfma_f32_32x32x16_bf16 v[48:63], a[44:47], v[108:111], v[48:63]
    v_mfma_f32_32x32x16_bf16 v[64:79], a[16:19], v[96:99], 0
    s_add_u32 s18, s34, 459648
    buffer_load_ushort a255, v12, s[48:51], s18 offen
    buffer_load_ushort v16, v12, s[52:55], s18 offen
    v_mfma_f32_32x32x16_bf16 v[80:95], a[16:19], v[112:115], 0
    v_mfma_f32_32x32x16_bf16 v[64:79], a[80:83], v[112:115], v[64:79]
    s_nop 1
    v_cvt_pk_bf16_f32 v32, v32, v48
    v_mfma_f32_32x32x16_bf16 v[80:95], a[48:51], v[96:99], v[80:95]
    v_cvt_pk_bf16_f32 v33, v33, v49
    v_mfma_f32_32x32x16_bf16 v[64:79], a[20:23], v[100:103], v[64:79]
    v_cvt_pk_bf16_f32 v34, v34, v50
    v_mfma_f32_32x32x16_bf16 v[80:95], a[20:23], v[116:119], v[80:95]
    v_cvt_pk_bf16_f32 v35, v35, v51
    v_mfma_f32_32x32x16_bf16 v[64:79], a[84:87], v[116:119], v[64:79]
    v_cvt_pk_bf16_f32 v36, v36, v52
    v_mfma_f32_32x32x16_bf16 v[80:95], a[52:55], v[100:103], v[80:95]
    v_cvt_pk_bf16_f32 v37, v37, v53
    v_mfma_f32_32x32x16_bf16 v[64:79], a[24:27], v[104:107], v[64:79]
    v_cvt_pk_bf16_f32 v38, v38, v54
    v_cvt_pk_bf16_f32 v39, v39, v55
    v_mfma_f32_32x32x16_bf16 v[80:95], a[24:27], v[120:123], v[80:95]
    v_cvt_pk_bf16_f32 v40, v40, v56
    v_mfma_f32_32x32x16_bf16 v[64:79], a[88:91], v[120:123], v[64:79]
    v_cvt_pk_bf16_f32 v41, v41, v57
    v_mfma_f32_32x32x16_bf16 v[80:95], a[56:59], v[104:107], v[80:95]
    v_cvt_pk_bf16_f32 v42, v42, v58
    v_mfma_f32_32x32x16_bf16 v[64:79], a[28:31], v[108:111], v[64:79]
    v_cvt_pk_bf16_f32 v43, v43, v59
    v_mfma_f32_32x32x16_bf16 v[80:95], a[28:31], v[124:127], v[80:95]
    v_cvt_pk_bf16_f32 v44, v44, v60
    v_mfma_f32_32x32x16_bf16 v[64:79], a[92:95], v[124:127], v[64:79]
    v_cvt_pk_bf16_f32 v45, v45, v61
    v_mfma_f32_32x32x16_bf16 v[80:95], a[60:63], v[108:111], v[80:95]
    v_cvt_pk_bf16_f32 v46, v46, v62
    v_cvt_pk_bf16_f32 v47, v47, v63
    s_nop 9
    v_cvt_pk_bf16_f32 v64, v64, v80
    v_cvt_pk_bf16_f32 v65, v65, v81
    v_cvt_pk_bf16_f32 v66, v66, v82
    v_cvt_pk_bf16_f32 v67, v67, v83
    v_cvt_pk_bf16_f32 v68, v68, v84
    v_cvt_pk_bf16_f32 v69, v69, v85
    v_cvt_pk_bf16_f32 v70, v70, v86
    v_cvt_pk_bf16_f32 v71, v71, v87
    v_cvt_pk_bf16_f32 v72, v72, v88
    v_cvt_pk_bf16_f32 v73, v73, v89
    v_cvt_pk_bf16_f32 v74, v74, v90
    v_cvt_pk_bf16_f32 v75, v75, v91
    v_cvt_pk_bf16_f32 v76, v76, v92
    v_cvt_pk_bf16_f32 v77, v77, v93
    v_cvt_pk_bf16_f32 v78, v78, v94
    v_cvt_pk_bf16_f32 v79, v79, v95
    s_cmp_eq_u32 s36, 2
    s_cbranch_scc1 F2_o1
    s_cmp_eq_u32 s36, 3
    s_cbranch_scc1 F2_o2
    s_cmp_eq_u32 s36, 4
    s_cbranch_scc1 F2_o3
    s_cmp_eq_u32 s36, 5
    s_cbranch_scc1 F2_o4
    v_accvgpr_write_b32 a120, v32
    v_accvgpr_write_b32 a124, v33
    v_accvgpr_write_b32 a128, v34
    v_accvgpr_write_b32 a132, v35
    v_accvgpr_write_b32 a136, v36
    v_accvgpr_write_b32 a140, v37
    v_accvgpr_write_b32 a144, v38
    v_accvgpr_write_b32 a148, v39
    v_accvgpr_write_b32 a152, v40
    v_accvgpr_write_b32 a156, v41
    v_accvgpr_write_b32 a160, v42
    v_accvgpr_write_b32 a164, v43
    v_accvgpr_write_b32 a168, v44
    v_accvgpr_write_b32 a172, v45
    v_accvgpr_write_b32 a176, v46
    v_accvgpr_write_b32 a180, v47
    v_accvgpr_write_b32 a184, v64
    v_accvgpr_write_b32 a188, v65
    v_accvgpr_write_b32 a192, v66
    v_accvgpr_write_b32 a196, v67
    v_accvgpr_write_b32 a200, v68
    v_accvgpr_write_b32 a204, v69
    v_accvgpr_write_b32 a208, v70
    v_accvgpr_write_b32 a212, v71
    v_accvgpr_write_b32 a216, v72
    v_accvgpr_write_b32 a220, v73
    v_accvgpr_write_b32 a224, v74
    v_accvgpr_write_b32 a228, v75
    v_accvgpr_write_b32 a232, v76
    v_accvgpr_write_b32 a236, v77
    v_accvgpr_write_b32 a240, v78
    v_accvgpr_write_b32 a244, v79
    s_branch F2_nx
F2_o1:
    v_accvgpr_write_b32 a121, v32
    v_accvgpr_write_b32 a125, v33
    v_accvgpr_write_b32 a129, v34
    v_accvgpr_write_b32 a133, v35
    v_accvgpr_write_b32 a137, v36
    v_accvgpr_write_b32 a141, v37
    v_accvgpr_write_b32 a145, v38
    v_accvgpr_write_b32 a149, v39
    v_accvgpr_write_b32 a153, v40
    v_accvgpr_write_b32 a157, v41
    v_accvgpr_write_b32 a161, v42
    v_accvgpr_write_b32 a165, v43
    v_accvgpr_write_b32 a169, v44
    v_accvgpr_write_b32 a173, v45
    v_accvgpr_write_b32 a177, v46
    v_accvgpr_write_b32 a181, v47
    v_accvgpr_write_b32 a185, v64
    v_accvgpr_write_b32 a189, v65
    v_accvgpr_write_b32 a193, v66
    v_accvgpr_write_b32 a197, v67
    v_accvgpr_write_b32 a201, v68
    v_accvgpr_write_b32 a205, v69
    v_accvgpr_write_b32 a209, v70
    v_accvgpr_write_b32 a213, v71
    v_accvgpr_write_b32 a217, v72
    v_accvgpr_write_b32 a221, v73
    v_accvgpr_write_b32 a225, v74
    v_accvgpr_write_b32 a229, v75
    v_accvgpr_write_b32 a233, v76
    v_accvgpr_write_b32 a237, v77
    v_accvgpr_write_b32 a241, v78
    v_accvgpr_write_b32 a245, v79
    s_branch F2_nx
F2_o2:
    v_accvgpr_write_b32 a122, v32
    v_accvgpr_write_b32 a126, v33
    v_accvgpr_write_b32 a130, v34
    v_accvgpr_write_b32 a134, v35
    v_accvgpr_write_b32 a138, v36
    v_accvgpr_write_b32 a142, v37
    v_accvgpr_write_b32 a146, v38
    v_accvgpr_write_b32 a150, v39
    v_accvgpr_write_b32 a154, v40
    v_accvgpr_write_b32 a158, v41
    v_accvgpr_write_b32 a162, v42
    v_accvgpr_write_b32 a166, v43
    v_accvgpr_write_b32 a170, v44
    v_accvgpr_write_b32 a174, v45
    v_accvgpr_write_b32 a178, v46
    v_accvgpr_write_b32 a182, v47
    v_accvgpr_write_b32 a186, v64
    v_accvgpr_write_b32 a190, v65
    v_accvgpr_write_b32 a194, v66
    v_accvgpr_write_b32 a198, v67
    v_accvgpr_write_b32 a202, v68
    v_accvgpr_write_b32 a206, v69
    v_accvgpr_write_b32 a210, v70
    v_accvgpr_write_b32 a214, v71
    v_accvgpr_write_b32 a218, v72
    v_accvgpr_write_b32 a222, v73
    v_accvgpr_write_b32 a226, v74
    v_accvgpr_write_b32 a230, v75
    v_accvgpr_write_b32 a234, v76
    v_accvgpr_write_b32 a238, v77
    v_accvgpr_write_b32 a242, v78
    v_accvgpr_write_b32 a246, v79
    s_branch F2_nx
F2_o3:
    v_accvgpr_write_b32 a123, v32
    v_accvgpr_write_b32 a127, v33
    v_accvgpr_write_b32 a131, v34
    v_accvgpr_write_b32 a135, v35
    v_accvgpr_write_b32 a139, v36
    v_accvgpr_write_b32 a143, v37
    v_accvgpr_write_b32 a147, v38
    v_accvgpr_write_b32 a151, v39
    v_accvgpr_write_b32 a155, v40
    v_accvgpr_write_b32 a159, v41
    v_accvgpr_write_b32 a163, v42
    v_accvgpr_write_b32 a167, v43
    v_accvgpr_write_b32 a171, v44
    v_accvgpr_write_b32 a175, v45
    v_accvgpr_write_b32 a179, v46
    v_accvgpr_write_b32 a183, v47
    v_accvgpr_write_b32 a187, v64
    v_accvgpr_write_b32 a191, v65
    v_accvgpr_write_b32 a195, v66
    v_accvgpr_write_b32 a199, v67
    v_accvgpr_write_b32 a203, v68
    v_accvgpr_write_b32 a207, v69
    v_accvgpr_write_b32 a211, v70
    v_accvgpr_write_b32 a215, v71
    v_accvgpr_write_b32 a219, v72
    v_accvgpr_write_b32 a223, v73
    v_accvgpr_write_b32 a227, v74
    v_accvgpr_write_b32 a231, v75
    v_accvgpr_write_b32 a235, v76
    v_accvgpr_write_b32 a239, v77
    v_accvgpr_write_b32 a243, v78
    v_accvgpr_write_b32 a247, v79
    s_branch F2_nx
F2_o4:
    v_accvgpr_read_b32 v5, a120
    v_lshlrev_b32 v6, 16, v32
    v_bfi_b32 v5, s38, v6, v5
    v_accvgpr_write_b32 a120, v5
    v_accvgpr_read_b32 v5, a124
    v_lshlrev_b32 v6, 16, v33
    v_bfi_b32 v5, s38, v6, v5
    v_accvgpr_write_b32 a124, v5
    v_accvgpr_read_b32 v5, a128
    v_lshlrev_b32 v6, 16, v34
    v_bfi_b32 v5, s38, v6, v5
    v_accvgpr_write_b32 a128, v5
    v_accvgpr_read_b32 v5, a132
    v_lshlrev_b32 v6, 16, v35
    v_bfi_b32 v5, s38, v6, v5
    v_accvgpr_write_b32 a132, v5
    v_accvgpr_read_b32 v5, a136
    v_lshlrev_b32 v6, 16, v36
    v_bfi_b32 v5, s38, v6, v5
    v_accvgpr_write_b32 a136, v5
    v_accvgpr_read_b32 v5, a140
    v_lshlrev_b32 v6, 16, v37
    v_bfi_b32 v5, s38, v6, v5
    v_accvgpr_write_b32 a140, v5
    v_accvgpr_read_b32 v5, a144
    v_lshlrev_b32 v6, 16, v38
    v_bfi_b32 v5, s38, v6, v5
    v_accvgpr_write_b32 a144, v5
    v_accvgpr_read_b32 v5, a148
    v_lshlrev_b32 v6, 16, v39
    v_bfi_b32 v5, s38, v6, v5
    v_accvgpr_write_b32 a148, v5
    v_accvgpr_read_b32 v5, a152
    v_lshlrev_b32 v6, 16, v40
    v_bfi_b32 v5, s38, v6, v5
    v_accvgpr_write_b32 a152, v5
    v_accvgpr_read_b32 v5, a156
    v_lshlrev_b32 v6, 16, v41
    v_bfi_b32 v5, s38, v6, v5
    v_accvgpr_write_b32 a156, v5
    v_accvgpr_read_b32 v5, a160
    v_lshlrev_b32 v6, 16, v42
    v_bfi_b32 v5, s38, v6, v5
    v_accvgpr_write_b32 a160, v5
    v_accvgpr_read_b32 v5, a164
    v_lshlrev_b32 v6, 16, v43
    v_bfi_b32 v5, s38, v6, v5
    v_accvgpr_write_b32 a164, v5
    v_accvgpr_read_b32 v5, a168
    v_lshlrev_b32 v6, 16, v44
    v_bfi_b32 v5, s38, v6, v5
    v_accvgpr_write_b32 a168, v5
    v_accvgpr_read_b32 v5, a172
    v_lshlrev_b32 v6, 16, v45
    v_bfi_b32 v5, s38, v6, v5
    v_accvgpr_write_b32 a172, v5
    v_accvgpr_read_b32 v5, a176
    v_lshlrev_b32 v6, 16, v46
    v_bfi_b32 v5, s38, v6, v5
    v_accvgpr_write_b32 a176, v5
    v_accvgpr_read_b32 v5, a180
    v_lshlrev_b32 v6, 16, v47
    v_bfi_b32 v5, s38, v6, v5
    v_accvgpr_write_b32 a180, v5
    v_accvgpr_read_b32 v5, a184
    v_lshlrev_b32 v6, 16, v64
    v_bfi_b32 v5, s38, v6, v5
    v_accvgpr_write_b32 a184, v5
    v_accvgpr_read_b32 v5, a188
    v_lshlrev_b32 v6, 16, v65
    v_bfi_b32 v5, s38, v6, v5
    v_accvgpr_write_b32 a188, v5
    v_accvgpr_read_b32 v5, a192
    v_lshlrev_b32 v6, 16, v66
    v_bfi_b32 v5, s38, v6, v5
    v_accvgpr_write_b32 a192, v5
    v_accvgpr_read_b32 v5, a196
    v_lshlrev_b32 v6, 16, v67
    v_bfi_b32 v5, s38, v6, v5
    v_accvgpr_write_b32 a196, v5
    v_accvgpr_read_b32 v5, a200
    v_lshlrev_b32 v6, 16, v68
    v_bfi_b32 v5, s38, v6, v5
    v_accvgpr_write_b32 a200, v5
    v_accvgpr_read_b32 v5, a204
    v_lshlrev_b32 v6, 16, v69
    v_bfi_b32 v5, s38, v6, v5
    v_accvgpr_write_b32 a204, v5
    v_accvgpr_read_b32 v5, a208
    v_lshlrev_b32 v6, 16, v70
    v_bfi_b32 v5, s38, v6, v5
    v_accvgpr_write_b32 a208, v5
    v_accvgpr_read_b32 v5, a212
    v_lshlrev_b32 v6, 16, v71
    v_bfi_b32 v5, s38, v6, v5
    v_accvgpr_write_b32 a212, v5
    v_accvgpr_read_b32 v5, a216
    v_lshlrev_b32 v6, 16, v72
    v_bfi_b32 v5, s38, v6, v5
    v_accvgpr_write_b32 a216, v5
    v_accvgpr_read_b32 v5, a220
    v_lshlrev_b32 v6, 16, v73
    v_bfi_b32 v5, s38, v6, v5
    v_accvgpr_write_b32 a220, v5
    v_accvgpr_read_b32 v5, a224
    v_lshlrev_b32 v6, 16, v74
    v_bfi_b32 v5, s38, v6, v5
    v_accvgpr_write_b32 a224, v5
    v_accvgpr_read_b32 v5, a228
    v_lshlrev_b32 v6, 16, v75
    v_bfi_b32 v5, s38, v6, v5
    v_accvgpr_write_b32 a228, v5
    v_accvgpr_read_b32 v5, a232
    v_lshlrev_b32 v6, 16, v76
    v_bfi_b32 v5, s38, v6, v5
    v_accvgpr_write_b32 a232, v5
    v_accvgpr_read_b32 v5, a236
    v_lshlrev_b32 v6, 16, v77
    v_bfi_b32 v5, s38, v6, v5
    v_accvgpr_write_b32 a236, v5
    v_accvgpr_read_b32 v5, a240
    v_lshlrev_b32 v6, 16, v78
    v_bfi_b32 v5, s38, v6, v5
    v_accvgpr_write_b32 a240, v5
    v_accvgpr_read_b32 v5, a244
    v_lshlrev_b32 v6, 16, v79
    v_bfi_b32 v5, s38, v6, v5
    v_accvgpr_write_b32 a244, v5
F2_nx:
    s_add_u32 s35, s35, 8192
    s_bitcmp1_b32 s36, 0
    s_cselect_b32 s17, 0, 2068416
    s_add_u32 s34, s34, 1050624
    s_sub_u32 s34, s34, s17
    s_cmp_eq_u32 s36, 4
    s_cselect_b32 s35, 133120, s35
    s_cselect_b32 s34, 1073741824, s34
    s_cmp_lt_u32 s36, s37
    s_cbranch_scc1 F2_top
    s_mul_i32 s21, s31, 33024
    s_add_u32 s21, s21, 111149056
    s_add_u32 s17, s21, 0
    buffer_store_dwordx4 a[120:123], v18, s[4:7], s17 offen offset:0 sc1
    buffer_store_dwordx4 a[124:127], v18, s[4:7], s17 offen offset:512 sc1
    buffer_store_dwordx4 a[128:131], v18, s[4:7], s17 offen offset:1024 sc1
    buffer_store_dwordx4 a[132:135], v18, s[4:7], s17 offen offset:1536 sc1
    buffer_store_dwordx4 a[136:139], v18, s[4:7], s17 offen offset:2048 sc1
    buffer_store_dwordx4 a[140:143], v18, s[4:7], s17 offen offset:2560 sc1
    buffer_store_dwordx4 a[144:147], v18, s[4:7], s17 offen offset:3072 sc1
    buffer_store_dwordx4 a[148:151], v18, s[4:7], s17 offen offset:3584 sc1
    s_add_u32 s17, s21, 8192
    buffer_store_dwordx4 a[152:155], v18, s[4:7], s17 offen offset:0 sc1
    buffer_store_dwordx4 a[156:159], v18, s[4:7], s17 offen offset:512 sc1
    buffer_store_dwordx4 a[160:163], v18, s[4:7], s17 offen offset:1024 sc1
    buffer_store_dwordx4 a[164:167], v18, s[4:7], s17 offen offset:1536 sc1
    buffer_store_dwordx4 a[168:171], v18, s[4:7], s17 offen offset:2048 sc1
    buffer_store_dwordx4 a[172:175], v18, s[4:7], s17 offen offset:2560 sc1
    buffer_store_dwordx4 a[176:179], v18, s[4:7], s17 offen offset:3072 sc1
    buffer_store_dwordx4 a[180:183], v18, s[4:7], s17 offen offset:3584 sc1
    s_add_u32 s17, s21, 16384
    buffer_store_dwordx4 a[184:187], v18, s[4:7], s17 offen offset:0 sc1
    buffer_store_dwordx4 a[188:191], v18, s[4:7], s17 offen offset:512 sc1
    buffer_store_dwordx4 a[192:195], v18, s[4:7], s17 offen offset:1024 sc1
    buffer_store_dwordx4 a[196:199], v18, s[4:7], s17 offen offset:1536 sc1
    buffer_store_dwordx4 a[200:203], v18, s[4:7], s17 offen offset:2048 sc1
    buffer_store_dwordx4 a[204:207], v18, s[4:7], s17 offen offset:2560 sc1
    buffer_store_dwordx4 a[208:211], v18, s[4:7], s17 offen offset:3072 sc1
    buffer_store_dwordx4 a[212:215], v18, s[4:7], s17 offen offset:3584 sc1
    s_add_u32 s17, s21, 24576
    buffer_store_dwordx4 a[216:219], v18, s[4:7], s17 offen offset:0 sc1
    buffer_store_dwordx4 a[220:223], v18, s[4:7], s17 offen offset:512 sc1
    buffer_store_dwordx4 a[224:227], v18, s[4:7], s17 offen offset:1024 sc1
    buffer_store_dwordx4 a[228:231], v18, s[4:7], s17 offen offset:1536 sc1
    buffer_store_dwordx4 a[232:235], v18, s[4:7], s17 offen offset:2048 sc1
    buffer_store_dwordx4 a[236:239], v18, s[4:7], s17 offen offset:2560 sc1
    buffer_store_dwordx4 a[240:243], v18, s[4:7], s17 offen offset:3072 sc1
    buffer_store_dwordx4 a[244:247], v18, s[4:7], s17 offen offset:3584 sc1
    s_waitcnt vmcnt(0)
    s_lshl_b32 s17, s31, 7
    s_add_u32 s17, s17, 100761600
    v_lshl_add_u32 v5, v1, 2, s17
    v_mov_b32 v6, 1
    s_mov_b64 exec, 0xffffffff
    buffer_store_dword v6, v5, s[4:7], 0 offen sc1
    s_mov_b64 exec, -1
    v_bfe_u32 v5, v1, 2, 2
    v_and_b32 v7, 3, v1
    v_lshl_add_u32 v7, v5, 3, v7
    s_lshl_b32 s17, s29, 5
    v_add_u32 v7, s17, v7
    v_lshrrev_b32 v8, 4, v1
    v_cvt_f32_u32 v8, v8
    s_mov_b32 s31, 981467136
    v_and_b32 v38, 1, v7
    v_add_u32 v5, 0, v7
    v_cvt_f32_u32 v6, v5
    v_mul_f32 v6, s31, v6
    v_mov_b32 v32, 0x3e800000
    v_sub_f32 v34, v6, v32
    v_mul_f32 v36, 0x41800000, v6
    v_mul_f32 v5, 4.0, v6
    v_mul_f32 v30, v5, v8
    v_add_u32 v5, 4, v7
    v_cvt_f32_u32 v6, v5
    v_mul_f32 v6, s31, v6
    v_mov_b32 v33, 0x3e800000
    v_sub_f32 v35, v6, v33
    v_mul_f32 v37, 0x41800000, v6
    v_mul_f32 v5, 4.0, v6
    v_mul_f32 v31, v5, v8
    v_lshlrev_b32 v40, 4, v38
    v_bfe_u32 v5, v7, 1, 1
    v_add_u32 v6, 1, v7
    v_bfe_u32 v6, v6, 1, 1
    v_lshlrev_b32 v5, 15, v5
    v_lshl_or_b32 v41, v6, 31, v5
    v_fract_f32 v48, v30
    v_add_f32 v49, v48, v32
    v_cos_f32 v56, v48
    v_add_f32 v50, v49, v34
    v_cos_f32 v57, v49
    v_add_f32 v51, v50, v32
    v_cos_f32 v58, v50
    v_add_f32 v52, v51, v34
    v_cos_f32 v59, v51
    v_add_f32 v53, v52, v32
    v_cos_f32 v60, v52
    v_add_f32 v54, v53, v34
    v_cos_f32 v61, v53
    v_add_f32 v55, v54, v32
    v_cos_f32 v62, v54
    v_cos_f32 v63, v55
    v_add_f32 v30, v48, v36
    v_cvt_pk_bf16_f32 v64, v56, v57
    v_cvt_pk_bf16_f32 v65, v58, v59
    v_cvt_pk_bf16_f32 v66, v60, v61
    v_cvt_pk_bf16_f32 v67, v62, v63
    v_accvgpr_write_b32 a0, v64
    v_accvgpr_write_b32 a1, v65
    v_accvgpr_write_b32 a2, v66
    v_accvgpr_write_b32 a3, v67
    v_alignbit_b32 v68, v64, v64, v40
    v_xor_b32 v68, v68, v41
    v_alignbit_b32 v69, v65, v65, v40
    v_xor_b32 v69, v69, v41
    v_alignbit_b32 v70, v66, v66, v40
    v_xor_b32 v70, v70, v41
    v_alignbit_b32 v71, v67, v67, v40
    v_xor_b32 v71, v71, v41
    v_accvgpr_write_b32 a128, v68
    v_accvgpr_write_b32 a129, v69
    v_accvgpr_write_b32 a130, v70
    v_accvgpr_write_b32 a131, v71
    v_fract_f32 v48, v31
    v_add_f32 v49, v48, v33
    v_cos_f32 v56, v48
    v_add_f32 v50, v49, v35
    v_cos_f32 v57, v49
    v_add_f32 v51, v50, v33
    v_cos_f32 v58, v50
    v_add_f32 v52, v51, v35
    v_cos_f32 v59, v51
    v_add_f32 v53, v52, v33
    v_cos_f32 v60, v52
    v_add_f32 v54, v53, v35
    v_cos_f32 v61, v53
    v_add_f32 v55, v54, v33
    v_cos_f32 v62, v54
    v_cos_f32 v63, v55
    v_add_f32 v31, v48, v37
    v_cvt_pk_bf16_f32 v64, v56, v57
    v_cvt_pk_bf16_f32 v65, v58, v59
    v_cvt_pk_bf16_f32 v66, v60, v61
    v_cvt_pk_bf16_f32 v67, v62, v63
    v_accvgpr_write_b32 a4, v64
    v_accvgpr_write_b32 a5, v65
    v_accvgpr_write_b32 a6, v66
    v_accvgpr_write_b32 a7, v67
    v_alignbit_b32 v68, v64, v64, v40
    v_xor_b32 v68, v68, v41
    v_alignbit_b32 v69, v65, v65, v40
    v_xor_b32 v69, v69, v41
    v_alignbit_b32 v70, v66, v66, v40
    v_xor_b32 v70, v70, v41
    v_alignbit_b32 v71, v67, v67, v40
    v_xor_b32 v71, v71, v41
    v_accvgpr_write_b32 a132, v68
    v_accvgpr_write_b32 a133, v69
    v_accvgpr_write_b32 a134, v70
    v_accvgpr_write_b32 a135, v71
    v_fract_f32 v48, v30
    v_add_f32 v49, v48, v32
    v_cos_f32 v56, v48
    v_add_f32 v50, v49, v34
    v_cos_f32 v57, v49
    v_add_f32 v51, v50, v32
    v_cos_f32 v58, v50
    v_add_f32 v52, v51, v34
    v_cos_f32 v59, v51
    v_add_f32 v53, v52, v32
    v_cos_f32 v60, v52
    v_add_f32 v54, v53, v34
    v_cos_f32 v61, v53
    v_add_f32 v55, v54, v32
    v_cos_f32 v62, v54
    v_cos_f32 v63, v55
    v_add_f32 v30, v48, v36
    v_cvt_pk_bf16_f32 v64, v56, v57
    v_cvt_pk_bf16_f32 v65, v58, v59
    v_cvt_pk_bf16_f32 v66, v60, v61
    v_cvt_pk_bf16_f32 v67, v62, v63
    v_accvgpr_write_b32 a8, v64
    v_accvgpr_write_b32 a9, v65
    v_accvgpr_write_b32 a10, v66
    v_accvgpr_write_b32 a11, v67
    v_alignbit_b32 v68, v64, v64, v40
    v_xor_b32 v68, v68, v41
    v_alignbit_b32 v69, v65, v65, v40
    v_xor_b32 v69, v69, v41
    v_alignbit_b32 v70, v66, v66, v40
    v_xor_b32 v70, v70, v41
    v_alignbit_b32 v71, v67, v67, v40
    v_xor_b32 v71, v71, v41
    v_accvgpr_write_b32 a136, v68
    v_accvgpr_write_b32 a137, v69
    v_accvgpr_write_b32 a138, v70
    v_accvgpr_write_b32 a139, v71
    v_fract_f32 v48, v31
    v_add_f32 v49, v48, v33
    v_cos_f32 v56, v48
    v_add_f32 v50, v49, v35
    v_cos_f32 v57, v49
    v_add_f32 v51, v50, v33
    v_cos_f32 v58, v50
    v_add_f32 v52, v51, v35
    v_cos_f32 v59, v51
    v_add_f32 v53, v52, v33
    v_cos_f32 v60, v52
    v_add_f32 v54, v53, v35
    v_cos_f32 v61, v53
    v_add_f32 v55, v54, v33
    v_cos_f32 v62, v54
    v_cos_f32 v63, v55
    v_add_f32 v31, v48, v37
    v_cvt_pk_bf16_f32 v64, v56, v57
    v_cvt_pk_bf16_f32 v65, v58, v59
    v_cvt_pk_bf16_f32 v66, v60, v61
    v_cvt_pk_bf16_f32 v67, v62, v63
    v_accvgpr_write_b32 a12, v64
    v_accvgpr_write_b32 a13, v65
    v_accvgpr_write_b32 a14, v66
    v_accvgpr_write_b32 a15, v67
    v_alignbit_b32 v68, v64, v64, v40
    v_xor_b32 v68, v68, v41
    v_alignbit_b32 v69, v65, v65, v40
    v_xor_b32 v69, v69, v41
    v_alignbit_b32 v70, v66, v66, v40
    v_xor_b32 v70, v70, v41
    v_alignbit_b32 v71, v67, v67, v40
    v_xor_b32 v71, v71, v41
    v_accvgpr_write_b32 a140, v68
    v_accvgpr_write_b32 a141, v69
    v_accvgpr_write_b32 a142, v70
    v_accvgpr_write_b32 a143, v71
    v_fract_f32 v48, v30
    v_add_f32 v49, v48, v32
    v_cos_f32 v56, v48
    v_add_f32 v50, v49, v34
    v_cos_f32 v57, v49
    v_add_f32 v51, v50, v32
    v_cos_f32 v58, v50
    v_add_f32 v52, v51, v34
    v_cos_f32 v59, v51
    v_add_f32 v53, v52, v32
    v_cos_f32 v60, v52
    v_add_f32 v54, v53, v34
    v_cos_f32 v61, v53
    v_add_f32 v55, v54, v32
    v_cos_f32 v62, v54
    v_cos_f32 v63, v55
    v_add_f32 v30, v48, v36
    v_cvt_pk_bf16_f32 v64, v56, v57
    v_cvt_pk_bf16_f32 v65, v58, v59
    v_cvt_pk_bf16_f32 v66, v60, v61
    v_cvt_pk_bf16_f32 v67, v62, v63
    v_accvgpr_write_b32 a16, v64
    v_accvgpr_write_b32 a17, v65
    v_accvgpr_write_b32 a18, v66
    v_accvgpr_write_b32 a19, v67
    v_alignbit_b32 v68, v64, v64, v40
    v_xor_b32 v68, v68, v41
    v_alignbit_b32 v69, v65, v65, v40
    v_xor_b32 v69, v69, v41
    v_alignbit_b32 v70, v66, v66, v40
    v_xor_b32 v70, v70, v41
    v_alignbit_b32 v71, v67, v67, v40
    v_xor_b32 v71, v71, v41
    v_accvgpr_write_b32 a144, v68
    v_accvgpr_write_b32 a145, v69
    v_accvgpr_write_b32 a146, v70
    v_accvgpr_write_b32 a147, v71
    v_fract_f32 v48, v31
    v_add_f32 v49, v48, v33
    v_cos_f32 v56, v48
    v_add_f32 v50, v49, v35
    v_cos_f32 v57, v49
    v_add_f32 v51, v50, v33
    v_cos_f32 v58, v50
    v_add_f32 v52, v51, v35
    v_cos_f32 v59, v51
    v_add_f32 v53, v52, v33
    v_cos_f32 v60, v52
    v_add_f32 v54, v53, v35
    v_cos_f32 v61, v53
    v_add_f32 v55, v54, v33
    v_cos_f32 v62, v54
    v_cos_f32 v63, v55
    v_add_f32 v31, v48, v37
    v_cvt_pk_bf16_f32 v64, v56, v57
    v_cvt_pk_bf16_f32 v65, v58, v59
    v_cvt_pk_bf16_f32 v66, v60, v61
    v_cvt_pk_bf16_f32 v67, v62, v63
    v_accvgpr_write_b32 a20, v64
    v_accvgpr_write_b32 a21, v65
    v_accvgpr_write_b32 a22, v66
    v_accvgpr_write_b32 a23, v67
    v_alignbit_b32 v68, v64, v64, v40
    v_xor_b32 v68, v68, v41
    v_alignbit_b32 v69, v65, v65, v40
    v_xor_b32 v69, v69, v41
    v_alignbit_b32 v70, v66, v66, v40
    v_xor_b32 v70, v70, v41
    v_alignbit_b32 v71, v67, v67, v40
    v_xor_b32 v71, v71, v41
    v_accvgpr_write_b32 a148, v68
    v_accvgpr_write_b32 a149, v69
    v_accvgpr_write_b32 a150, v70
    v_accvgpr_write_b32 a151, v71
    v_fract_f32 v48, v30
    v_add_f32 v49, v48, v32
    v_cos_f32 v56, v48
    v_add_f32 v50, v49, v34
    v_cos_f32 v57, v49
    v_add_f32 v51, v50, v32
    v_cos_f32 v58, v50
    v_add_f32 v52, v51, v34
    v_cos_f32 v59, v51
    v_add_f32 v53, v52, v32
    v_cos_f32 v60, v52
    v_add_f32 v54, v53, v34
    v_cos_f32 v61, v53
    v_add_f32 v55, v54, v32
    v_cos_f32 v62, v54
    v_cos_f32 v63, v55
    v_add_f32 v30, v48, v36
    v_cvt_pk_bf16_f32 v64, v56, v57
    v_cvt_pk_bf16_f32 v65, v58, v59
    v_cvt_pk_bf16_f32 v66, v60, v61
    v_cvt_pk_bf16_f32 v67, v62, v63
    v_accvgpr_write_b32 a24, v64
    v_accvgpr_write_b32 a25, v65
    v_accvgpr_write_b32 a26, v66
    v_accvgpr_write_b32 a27, v67
    v_alignbit_b32 v68, v64, v64, v40
    v_xor_b32 v68, v68, v41
    v_alignbit_b32 v69, v65, v65, v40
    v_xor_b32 v69, v69, v41
    v_alignbit_b32 v70, v66, v66, v40
    v_xor_b32 v70, v70, v41
    v_alignbit_b32 v71, v67, v67, v40
    v_xor_b32 v71, v71, v41
    v_accvgpr_write_b32 a152, v68
    v_accvgpr_write_b32 a153, v69
    v_accvgpr_write_b32 a154, v70
    v_accvgpr_write_b32 a155, v71
    v_fract_f32 v48, v31
    v_add_f32 v49, v48, v33
    v_cos_f32 v56, v48
    v_add_f32 v50, v49, v35
    v_cos_f32 v57, v49
    v_add_f32 v51, v50, v33
    v_cos_f32 v58, v50
    v_add_f32 v52, v51, v35
    v_cos_f32 v59, v51
    v_add_f32 v53, v52, v33
    v_cos_f32 v60, v52
    v_add_f32 v54, v53, v35
    v_cos_f32 v61, v53
    v_add_f32 v55, v54, v33
    v_cos_f32 v62, v54
    v_cos_f32 v63, v55
    v_add_f32 v31, v48, v37
    v_cvt_pk_bf16_f32 v64, v56, v57
    v_cvt_pk_bf16_f32 v65, v58, v59
    v_cvt_pk_bf16_f32 v66, v60, v61
    v_cvt_pk_bf16_f32 v67, v62, v63
    v_accvgpr_write_b32 a28, v64
    v_accvgpr_write_b32 a29, v65
    v_accvgpr_write_b32 a30, v66
    v_accvgpr_write_b32 a31, v67
    v_alignbit_b32 v68, v64, v64, v40
    v_xor_b32 v68, v68, v41
    v_alignbit_b32 v69, v65, v65, v40
    v_xor_b32 v69, v69, v41
    v_alignbit_b32 v70, v66, v66, v40
    v_xor_b32 v70, v70, v41
    v_alignbit_b32 v71, v67, v67, v40
    v_xor_b32 v71, v71, v41
    v_accvgpr_write_b32 a156, v68
    v_accvgpr_write_b32 a157, v69
    v_accvgpr_write_b32 a158, v70
    v_accvgpr_write_b32 a159, v71
    v_fract_f32 v48, v30
    v_add_f32 v49, v48, v32
    v_cos_f32 v56, v48
    v_add_f32 v50, v49, v34
    v_cos_f32 v57, v49
    v_add_f32 v51, v50, v32
    v_cos_f32 v58, v50
    v_add_f32 v52, v51, v34
    v_cos_f32 v59, v51
    v_add_f32 v53, v52, v32
    v_cos_f32 v60, v52
    v_add_f32 v54, v53, v34
    v_cos_f32 v61, v53
    v_add_f32 v55, v54, v32
    v_cos_f32 v62, v54
    v_cos_f32 v63, v55
    v_add_f32 v30, v48, v36
    v_cvt_pk_bf16_f32 v64, v56, v57
    v_cvt_pk_bf16_f32 v65, v58, v59
    v_cvt_pk_bf16_f32 v66, v60, v61
    v_cvt_pk_bf16_f32 v67, v62, v63
    v_accvgpr_write_b32 a32, v64
    v_accvgpr_write_b32 a33, v65
    v_accvgpr_write_b32 a34, v66
    v_accvgpr_write_b32 a35, v67
    v_alignbit_b32 v68, v64, v64, v40
    v_xor_b32 v68, v68, v41
    v_alignbit_b32 v69, v65, v65, v40
    v_xor_b32 v69, v69, v41
    v_alignbit_b32 v70, v66, v66, v40
    v_xor_b32 v70, v70, v41
    v_alignbit_b32 v71, v67, v67, v40
    v_xor_b32 v71, v71, v41
    v_accvgpr_write_b32 a160, v68
    v_accvgpr_write_b32 a161, v69
    v_accvgpr_write_b32 a162, v70
    v_accvgpr_write_b32 a163, v71
    v_fract_f32 v48, v31
    v_add_f32 v49, v48, v33
    v_cos_f32 v56, v48
    v_add_f32 v50, v49, v35
    v_cos_f32 v57, v49
    v_add_f32 v51, v50, v33
    v_cos_f32 v58, v50
    v_add_f32 v52, v51, v35
    v_cos_f32 v59, v51
    v_add_f32 v53, v52, v33
    v_cos_f32 v60, v52
    v_add_f32 v54, v53, v35
    v_cos_f32 v61, v53
    v_add_f32 v55, v54, v33
    v_cos_f32 v62, v54
    v_cos_f32 v63, v55
    v_add_f32 v31, v48, v37
    v_cvt_pk_bf16_f32 v64, v56, v57
    v_cvt_pk_bf16_f32 v65, v58, v59
    v_cvt_pk_bf16_f32 v66, v60, v61
    v_cvt_pk_bf16_f32 v67, v62, v63
    v_accvgpr_write_b32 a36, v64
    v_accvgpr_write_b32 a37, v65
    v_accvgpr_write_b32 a38, v66
    v_accvgpr_write_b32 a39, v67
    v_alignbit_b32 v68, v64, v64, v40
    v_xor_b32 v68, v68, v41
    v_alignbit_b32 v69, v65, v65, v40
    v_xor_b32 v69, v69, v41
    v_alignbit_b32 v70, v66, v66, v40
    v_xor_b32 v70, v70, v41
    v_alignbit_b32 v71, v67, v67, v40
    v_xor_b32 v71, v71, v41
    v_accvgpr_write_b32 a164, v68
    v_accvgpr_write_b32 a165, v69
    v_accvgpr_write_b32 a166, v70
    v_accvgpr_write_b32 a167, v71
    v_fract_f32 v48, v30
    v_add_f32 v49, v48, v32
    v_cos_f32 v56, v48
    v_add_f32 v50, v49, v34
    v_cos_f32 v57, v49
    v_add_f32 v51, v50, v32
    v_cos_f32 v58, v50
    v_add_f32 v52, v51, v34
    v_cos_f32 v59, v51
    v_add_f32 v53, v52, v32
    v_cos_f32 v60, v52
    v_add_f32 v54, v53, v34
    v_cos_f32 v61, v53
    v_add_f32 v55, v54, v32
    v_cos_f32 v62, v54
    v_cos_f32 v63, v55
    v_add_f32 v30, v48, v36
    v_cvt_pk_bf16_f32 v64, v56, v57
    v_cvt_pk_bf16_f32 v65, v58, v59
    v_cvt_pk_bf16_f32 v66, v60, v61
    v_cvt_pk_bf16_f32 v67, v62, v63
    v_accvgpr_write_b32 a40, v64
    v_accvgpr_write_b32 a41, v65
    v_accvgpr_write_b32 a42, v66
    v_accvgpr_write_b32 a43, v67
    v_alignbit_b32 v68, v64, v64, v40
    v_xor_b32 v68, v68, v41
    v_alignbit_b32 v69, v65, v65, v40
    v_xor_b32 v69, v69, v41
    v_alignbit_b32 v70, v66, v66, v40
    v_xor_b32 v70, v70, v41
    v_alignbit_b32 v71, v67, v67, v40
    v_xor_b32 v71, v71, v41
    v_accvgpr_write_b32 a168, v68
    v_accvgpr_write_b32 a169, v69
    v_accvgpr_write_b32 a170, v70
    v_accvgpr_write_b32 a171, v71
    v_fract_f32 v48, v31
    v_add_f32 v49, v48, v33
    v_cos_f32 v56, v48
    v_add_f32 v50, v49, v35
    v_cos_f32 v57, v49
    v_add_f32 v51, v50, v33
    v_cos_f32 v58, v50
    v_add_f32 v52, v51, v35
    v_cos_f32 v59, v51
    v_add_f32 v53, v52, v33
    v_cos_f32 v60, v52
    v_add_f32 v54, v53, v35
    v_cos_f32 v61, v53
    v_add_f32 v55, v54, v33
    v_cos_f32 v62, v54
    v_cos_f32 v63, v55
    v_add_f32 v31, v48, v37
    v_cvt_pk_bf16_f32 v64, v56, v57
    v_cvt_pk_bf16_f32 v65, v58, v59
    v_cvt_pk_bf16_f32 v66, v60, v61
    v_cvt_pk_bf16_f32 v67, v62, v63
    v_accvgpr_write_b32 a44, v64
    v_accvgpr_write_b32 a45, v65
    v_accvgpr_write_b32 a46, v66
    v_accvgpr_write_b32 a47, v67
    v_alignbit_b32 v68, v64, v64, v40
    v_xor_b32 v68, v68, v41
    v_alignbit_b32 v69, v65, v65, v40
    v_xor_b32 v69, v69, v41
    v_alignbit_b32 v70, v66, v66, v40
    v_xor_b32 v70, v70, v41
    v_alignbit_b32 v71, v67, v67, v40
    v_xor_b32 v71, v71, v41
    v_accvgpr_write_b32 a172, v68
    v_accvgpr_write_b32 a173, v69
    v_accvgpr_write_b32 a174, v70
    v_accvgpr_write_b32 a175, v71
    v_fract_f32 v48, v30
    v_add_f32 v49, v48, v32
    v_cos_f32 v56, v48
    v_add_f32 v50, v49, v34
    v_cos_f32 v57, v49
    v_add_f32 v51, v50, v32
    v_cos_f32 v58, v50
    v_add_f32 v52, v51, v34
    v_cos_f32 v59, v51
    v_add_f32 v53, v52, v32
    v_cos_f32 v60, v52
    v_add_f32 v54, v53, v34
    v_cos_f32 v61, v53
    v_add_f32 v55, v54, v32
    v_cos_f32 v62, v54
    v_cos_f32 v63, v55
    v_add_f32 v30, v48, v36
    v_cvt_pk_bf16_f32 v64, v56, v57
    v_cvt_pk_bf16_f32 v65, v58, v59
    v_cvt_pk_bf16_f32 v66, v60, v61
    v_cvt_pk_bf16_f32 v67, v62, v63
    v_accvgpr_write_b32 a48, v64
    v_accvgpr_write_b32 a49, v65
    v_accvgpr_write_b32 a50, v66
    v_accvgpr_write_b32 a51, v67
    v_alignbit_b32 v68, v64, v64, v40
    v_xor_b32 v68, v68, v41
    v_alignbit_b32 v69, v65, v65, v40
    v_xor_b32 v69, v69, v41
    v_alignbit_b32 v70, v66, v66, v40
    v_xor_b32 v70, v70, v41
    v_alignbit_b32 v71, v67, v67, v40
    v_xor_b32 v71, v71, v41
    v_accvgpr_write_b32 a176, v68
    v_accvgpr_write_b32 a177, v69
    v_accvgpr_write_b32 a178, v70
    v_accvgpr_write_b32 a179, v71
    v_fract_f32 v48, v31
    v_add_f32 v49, v48, v33
    v_cos_f32 v56, v48
    v_add_f32 v50, v49, v35
    v_cos_f32 v57, v49
    v_add_f32 v51, v50, v33
    v_cos_f32 v58, v50
    v_add_f32 v52, v51, v35
    v_cos_f32 v59, v51
    v_add_f32 v53, v52, v33
    v_cos_f32 v60, v52
    v_add_f32 v54, v53, v35
    v_cos_f32 v61, v53
    v_add_f32 v55, v54, v33
    v_cos_f32 v62, v54
    v_cos_f32 v63, v55
    v_add_f32 v31, v48, v37
    v_cvt_pk_bf16_f32 v64, v56, v57
    v_cvt_pk_bf16_f32 v65, v58, v59
    v_cvt_pk_bf16_f32 v66, v60, v61
    v_cvt_pk_bf16_f32 v67, v62, v63
    v_accvgpr_write_b32 a52, v64
    v_accvgpr_write_b32 a53, v65
    v_accvgpr_write_b32 a54, v66
    v_accvgpr_write_b32 a55, v67
    v_alignbit_b32 v68, v64, v64, v40
    v_xor_b32 v68, v68, v41
    v_alignbit_b32 v69, v65, v65, v40
    v_xor_b32 v69, v69, v41
    v_alignbit_b32 v70, v66, v66, v40
    v_xor_b32 v70, v70, v41
    v_alignbit_b32 v71, v67, v67, v40
    v_xor_b32 v71, v71, v41
    v_accvgpr_write_b32 a180, v68
    v_accvgpr_write_b32 a181, v69
    v_accvgpr_write_b32 a182, v70
    v_accvgpr_write_b32 a183, v71
    v_fract_f32 v48, v30
    v_add_f32 v49, v48, v32
    v_cos_f32 v56, v48
    v_add_f32 v50, v49, v34
    v_cos_f32 v57, v49
    v_add_f32 v51, v50, v32
    v_cos_f32 v58, v50
    v_add_f32 v52, v51, v34
    v_cos_f32 v59, v51
    v_add_f32 v53, v52, v32
    v_cos_f32 v60, v52
    v_add_f32 v54, v53, v34
    v_cos_f32 v61, v53
    v_add_f32 v55, v54, v32
    v_cos_f32 v62, v54
    v_cos_f32 v63, v55
    v_add_f32 v30, v48, v36
    v_cvt_pk_bf16_f32 v64, v56, v57
    v_cvt_pk_bf16_f32 v65, v58, v59
    v_cvt_pk_bf16_f32 v66, v60, v61
    v_cvt_pk_bf16_f32 v67, v62, v63
    v_accvgpr_write_b32 a56, v64
    v_accvgpr_write_b32 a57, v65
    v_accvgpr_write_b32 a58, v66
    v_accvgpr_write_b32 a59, v67
    v_alignbit_b32 v68, v64, v64, v40
    v_xor_b32 v68, v68, v41
    v_alignbit_b32 v69, v65, v65, v40
    v_xor_b32 v69, v69, v41
    v_alignbit_b32 v70, v66, v66, v40
    v_xor_b32 v70, v70, v41
    v_alignbit_b32 v71, v67, v67, v40
    v_xor_b32 v71, v71, v41
    v_accvgpr_write_b32 a184, v68
    v_accvgpr_write_b32 a185, v69
    v_accvgpr_write_b32 a186, v70
    v_accvgpr_write_b32 a187, v71
    v_fract_f32 v48, v31
    v_add_f32 v49, v48, v33
    v_cos_f32 v56, v48
    v_add_f32 v50, v49, v35
    v_cos_f32 v57, v49
    v_add_f32 v51, v50, v33
    v_cos_f32 v58, v50
    v_add_f32 v52, v51, v35
    v_cos_f32 v59, v51
    v_add_f32 v53, v52, v33
    v_cos_f32 v60, v52
    v_add_f32 v54, v53, v35
    v_cos_f32 v61, v53
    v_add_f32 v55, v54, v33
    v_cos_f32 v62, v54
    v_cos_f32 v63, v55
    v_add_f32 v31, v48, v37
    v_cvt_pk_bf16_f32 v64, v56, v57
    v_cvt_pk_bf16_f32 v65, v58, v59
    v_cvt_pk_bf16_f32 v66, v60, v61
    v_cvt_pk_bf16_f32 v67, v62, v63
    v_accvgpr_write_b32 a60, v64
    v_accvgpr_write_b32 a61, v65
    v_accvgpr_write_b32 a62, v66
    v_accvgpr_write_b32 a63, v67
    v_alignbit_b32 v68, v64, v64, v40
    v_xor_b32 v68, v68, v41
    v_alignbit_b32 v69, v65, v65, v40
    v_xor_b32 v69, v69, v41
    v_alignbit_b32 v70, v66, v66, v40
    v_xor_b32 v70, v70, v41
    v_alignbit_b32 v71, v67, v67, v40
    v_xor_b32 v71, v71, v41
    v_accvgpr_write_b32 a188, v68
    v_accvgpr_write_b32 a189, v69
    v_accvgpr_write_b32 a190, v70
    v_accvgpr_write_b32 a191, v71
    v_fract_f32 v48, v30
    v_add_f32 v49, v48, v32
    v_cos_f32 v56, v48
    v_add_f32 v50, v49, v34
    v_cos_f32 v57, v49
    v_add_f32 v51, v50, v32
    v_cos_f32 v58, v50
    v_add_f32 v52, v51, v34
    v_cos_f32 v59, v51
    v_add_f32 v53, v52, v32
    v_cos_f32 v60, v52
    v_add_f32 v54, v53, v34
    v_cos_f32 v61, v53
    v_add_f32 v55, v54, v32
    v_cos_f32 v62, v54
    v_cos_f32 v63, v55
    v_add_f32 v30, v48, v36
    v_cvt_pk_bf16_f32 v64, v56, v57
    v_cvt_pk_bf16_f32 v65, v58, v59
    v_cvt_pk_bf16_f32 v66, v60, v61
    v_cvt_pk_bf16_f32 v67, v62, v63
    v_accvgpr_write_b32 a64, v64
    v_accvgpr_write_b32 a65, v65
    v_accvgpr_write_b32 a66, v66
    v_accvgpr_write_b32 a67, v67
    v_alignbit_b32 v68, v64, v64, v40
    v_xor_b32 v68, v68, v41
    v_alignbit_b32 v69, v65, v65, v40
    v_xor_b32 v69, v69, v41
    v_alignbit_b32 v70, v66, v66, v40
    v_xor_b32 v70, v70, v41
    v_alignbit_b32 v71, v67, v67, v40
    v_xor_b32 v71, v71, v41
    v_accvgpr_write_b32 a192, v68
    v_accvgpr_write_b32 a193, v69
    v_accvgpr_write_b32 a194, v70
    v_accvgpr_write_b32 a195, v71
    v_fract_f32 v48, v31
    v_add_f32 v49, v48, v33
    v_cos_f32 v56, v48
    v_add_f32 v50, v49, v35
    v_cos_f32 v57, v49
    v_add_f32 v51, v50, v33
    v_cos_f32 v58, v50
    v_add_f32 v52, v51, v35
    v_cos_f32 v59, v51
    v_add_f32 v53, v52, v33
    v_cos_f32 v60, v52
    v_add_f32 v54, v53, v35
    v_cos_f32 v61, v53
    v_add_f32 v55, v54, v33
    v_cos_f32 v62, v54
    v_cos_f32 v63, v55
    v_add_f32 v31, v48, v37
    v_cvt_pk_bf16_f32 v64, v56, v57
    v_cvt_pk_bf16_f32 v65, v58, v59
    v_cvt_pk_bf16_f32 v66, v60, v61
    v_cvt_pk_bf16_f32 v67, v62, v63
    v_accvgpr_write_b32 a68, v64
    v_accvgpr_write_b32 a69, v65
    v_accvgpr_write_b32 a70, v66
    v_accvgpr_write_b32 a71, v67
    v_alignbit_b32 v68, v64, v64, v40
    v_xor_b32 v68, v68, v41
    v_alignbit_b32 v69, v65, v65, v40
    v_xor_b32 v69, v69, v41
    v_alignbit_b32 v70, v66, v66, v40
    v_xor_b32 v70, v70, v41
    v_alignbit_b32 v71, v67, v67, v40
    v_xor_b32 v71, v71, v41
    v_accvgpr_write_b32 a196, v68
    v_accvgpr_write_b32 a197, v69
    v_accvgpr_write_b32 a198, v70
    v_accvgpr_write_b32 a199, v71
    v_fract_f32 v48, v30
    v_add_f32 v49, v48, v32
    v_cos_f32 v56, v48
    v_add_f32 v50, v49, v34
    v_cos_f32 v57, v49
    v_add_f32 v51, v50, v32
    v_cos_f32 v58, v50
    v_add_f32 v52, v51, v34
    v_cos_f32 v59, v51
    v_add_f32 v53, v52, v32
    v_cos_f32 v60, v52
    v_add_f32 v54, v53, v34
    v_cos_f32 v61, v53
    v_add_f32 v55, v54, v32
    v_cos_f32 v62, v54
    v_cos_f32 v63, v55
    v_add_f32 v30, v48, v36
    v_cvt_pk_bf16_f32 v64, v56, v57
    v_cvt_pk_bf16_f32 v65, v58, v59
    v_cvt_pk_bf16_f32 v66, v60, v61
    v_cvt_pk_bf16_f32 v67, v62, v63
    v_accvgpr_write_b32 a72, v64
    v_accvgpr_write_b32 a73, v65
    v_accvgpr_write_b32 a74, v66
    v_accvgpr_write_b32 a75, v67
    v_alignbit_b32 v68, v64, v64, v40
    v_xor_b32 v68, v68, v41
    v_alignbit_b32 v69, v65, v65, v40
    v_xor_b32 v69, v69, v41
    v_alignbit_b32 v70, v66, v66, v40
    v_xor_b32 v70, v70, v41
    v_alignbit_b32 v71, v67, v67, v40
    v_xor_b32 v71, v71, v41
    v_accvgpr_write_b32 a200, v68
    v_accvgpr_write_b32 a201, v69
    v_accvgpr_write_b32 a202, v70
    v_accvgpr_write_b32 a203, v71
    v_fract_f32 v48, v31
    v_add_f32 v49, v48, v33
    v_cos_f32 v56, v48
    v_add_f32 v50, v49, v35
    v_cos_f32 v57, v49
    v_add_f32 v51, v50, v33
    v_cos_f32 v58, v50
    v_add_f32 v52, v51, v35
    v_cos_f32 v59, v51
    v_add_f32 v53, v52, v33
    v_cos_f32 v60, v52
    v_add_f32 v54, v53, v35
    v_cos_f32 v61, v53
    v_add_f32 v55, v54, v33
    v_cos_f32 v62, v54
    v_cos_f32 v63, v55
    v_add_f32 v31, v48, v37
    v_cvt_pk_bf16_f32 v64, v56, v57
    v_cvt_pk_bf16_f32 v65, v58, v59
    v_cvt_pk_bf16_f32 v66, v60, v61
    v_cvt_pk_bf16_f32 v67, v62, v63
    v_accvgpr_write_b32 a76, v64
    v_accvgpr_write_b32 a77, v65
    v_accvgpr_write_b32 a78, v66
    v_accvgpr_write_b32 a79, v67
    v_alignbit_b32 v68, v64, v64, v40
    v_xor_b32 v68, v68, v41
    v_alignbit_b32 v69, v65, v65, v40
    v_xor_b32 v69, v69, v41
    v_alignbit_b32 v70, v66, v66, v40
    v_xor_b32 v70, v70, v41
    v_alignbit_b32 v71, v67, v67, v40
    v_xor_b32 v71, v71, v41
    v_accvgpr_write_b32 a204, v68
    v_accvgpr_write_b32 a205, v69
    v_accvgpr_write_b32 a206, v70
    v_accvgpr_write_b32 a207, v71
    v_fract_f32 v48, v30
    v_add_f32 v49, v48, v32
    v_cos_f32 v56, v48
    v_add_f32 v50, v49, v34
    v_cos_f32 v57, v49
    v_add_f32 v51, v50, v32
    v_cos_f32 v58, v50
    v_add_f32 v52, v51, v34
    v_cos_f32 v59, v51
    v_add_f32 v53, v52, v32
    v_cos_f32 v60, v52
    v_add_f32 v54, v53, v34
    v_cos_f32 v61, v53
    v_add_f32 v55, v54, v32
    v_cos_f32 v62, v54
    v_cos_f32 v63, v55
    v_add_f32 v30, v48, v36
    v_cvt_pk_bf16_f32 v64, v56, v57
    v_cvt_pk_bf16_f32 v65, v58, v59
    v_cvt_pk_bf16_f32 v66, v60, v61
    v_cvt_pk_bf16_f32 v67, v62, v63
    v_accvgpr_write_b32 a80, v64
    v_accvgpr_write_b32 a81, v65
    v_accvgpr_write_b32 a82, v66
    v_accvgpr_write_b32 a83, v67
    v_alignbit_b32 v68, v64, v64, v40
    v_xor_b32 v68, v68, v41
    v_alignbit_b32 v69, v65, v65, v40
    v_xor_b32 v69, v69, v41
    v_alignbit_b32 v70, v66, v66, v40
    v_xor_b32 v70, v70, v41
    v_alignbit_b32 v71, v67, v67, v40
    v_xor_b32 v71, v71, v41
    v_accvgpr_write_b32 a208, v68
    v_accvgpr_write_b32 a209, v69
    v_accvgpr_write_b32 a210, v70
    v_accvgpr_write_b32 a211, v71
    v_fract_f32 v48, v31
    v_add_f32 v49, v48, v33
    v_cos_f32 v56, v48
    v_add_f32 v50, v49, v35
    v_cos_f32 v57, v49
    v_add_f32 v51, v50, v33
    v_cos_f32 v58, v50
    v_add_f32 v52, v51, v35
    v_cos_f32 v59, v51
    v_add_f32 v53, v52, v33
    v_cos_f32 v60, v52
    v_add_f32 v54, v53, v35
    v_cos_f32 v61, v53
    v_add_f32 v55, v54, v33
    v_cos_f32 v62, v54
    v_cos_f32 v63, v55
    v_add_f32 v31, v48, v37
    v_cvt_pk_bf16_f32 v64, v56, v57
    v_cvt_pk_bf16_f32 v65, v58, v59
    v_cvt_pk_bf16_f32 v66, v60, v61
    v_cvt_pk_bf16_f32 v67, v62, v63
    v_accvgpr_write_b32 a84, v64
    v_accvgpr_write_b32 a85, v65
    v_accvgpr_write_b32 a86, v66
    v_accvgpr_write_b32 a87, v67
    v_alignbit_b32 v68, v64, v64, v40
    v_xor_b32 v68, v68, v41
    v_alignbit_b32 v69, v65, v65, v40
    v_xor_b32 v69, v69, v41
    v_alignbit_b32 v70, v66, v66, v40
    v_xor_b32 v70, v70, v41
    v_alignbit_b32 v71, v67, v67, v40
    v_xor_b32 v71, v71, v41
    v_accvgpr_write_b32 a212, v68
    v_accvgpr_write_b32 a213, v69
    v_accvgpr_write_b32 a214, v70
    v_accvgpr_write_b32 a215, v71
    v_fract_f32 v48, v30
    v_add_f32 v49, v48, v32
    v_cos_f32 v56, v48
    v_add_f32 v50, v49, v34
    v_cos_f32 v57, v49
    v_add_f32 v51, v50, v32
    v_cos_f32 v58, v50
    v_add_f32 v52, v51, v34
    v_cos_f32 v59, v51
    v_add_f32 v53, v52, v32
    v_cos_f32 v60, v52
    v_add_f32 v54, v53, v34
    v_cos_f32 v61, v53
    v_add_f32 v55, v54, v32
    v_cos_f32 v62, v54
    v_cos_f32 v63, v55
    v_add_f32 v30, v48, v36
    v_cvt_pk_bf16_f32 v64, v56, v57
    v_cvt_pk_bf16_f32 v65, v58, v59
    v_cvt_pk_bf16_f32 v66, v60, v61
    v_cvt_pk_bf16_f32 v67, v62, v63
    v_accvgpr_write_b32 a88, v64
    v_accvgpr_write_b32 a89, v65
    v_accvgpr_write_b32 a90, v66
    v_accvgpr_write_b32 a91, v67
    v_alignbit_b32 v68, v64, v64, v40
    v_xor_b32 v68, v68, v41
    v_alignbit_b32 v69, v65, v65, v40
    v_xor_b32 v69, v69, v41
    v_alignbit_b32 v70, v66, v66, v40
    v_xor_b32 v70, v70, v41
    v_alignbit_b32 v71, v67, v67, v40
    v_xor_b32 v71, v71, v41
    v_accvgpr_write_b32 a216, v68
    v_accvgpr_write_b32 a217, v69
    v_accvgpr_write_b32 a218, v70
    v_accvgpr_write_b32 a219, v71
    v_fract_f32 v48, v31
    v_add_f32 v49, v48, v33
    v_cos_f32 v56, v48
    v_add_f32 v50, v49, v35
    v_cos_f32 v57, v49
    v_add_f32 v51, v50, v33
    v_cos_f32 v58, v50
    v_add_f32 v52, v51, v35
    v_cos_f32 v59, v51
    v_add_f32 v53, v52, v33
    v_cos_f32 v60, v52
    v_add_f32 v54, v53, v35
    v_cos_f32 v61, v53
    v_add_f32 v55, v54, v33
    v_cos_f32 v62, v54
    v_cos_f32 v63, v55
    v_add_f32 v31, v48, v37
    v_cvt_pk_bf16_f32 v64, v56, v57
    v_cvt_pk_bf16_f32 v65, v58, v59
    v_cvt_pk_bf16_f32 v66, v60, v61
    v_cvt_pk_bf16_f32 v67, v62, v63
    v_accvgpr_write_b32 a92, v64
    v_accvgpr_write_b32 a93, v65
    v_accvgpr_write_b32 a94, v66
    v_accvgpr_write_b32 a95, v67
    v_alignbit_b32 v68, v64, v64, v40
    v_xor_b32 v68, v68, v41
    v_alignbit_b32 v69, v65, v65, v40
    v_xor_b32 v69, v69, v41
    v_alignbit_b32 v70, v66, v66, v40
    v_xor_b32 v70, v70, v41
    v_alignbit_b32 v71, v67, v67, v40
    v_xor_b32 v71, v71, v41
    v_accvgpr_write_b32 a220, v68
    v_accvgpr_write_b32 a221, v69
    v_accvgpr_write_b32 a222, v70
    v_accvgpr_write_b32 a223, v71
    v_fract_f32 v48, v30
    v_add_f32 v49, v48, v32
    v_cos_f32 v56, v48
    v_add_f32 v50, v49, v34
    v_cos_f32 v57, v49
    v_add_f32 v51, v50, v32
    v_cos_f32 v58, v50
    v_add_f32 v52, v51, v34
    v_cos_f32 v59, v51
    v_add_f32 v53, v52, v32
    v_cos_f32 v60, v52
    v_add_f32 v54, v53, v34
    v_cos_f32 v61, v53
    v_add_f32 v55, v54, v32
    v_cos_f32 v62, v54
    v_cos_f32 v63, v55
    v_add_f32 v30, v48, v36
    v_cvt_pk_bf16_f32 v64, v56, v57
    v_cvt_pk_bf16_f32 v65, v58, v59
    v_cvt_pk_bf16_f32 v66, v60, v61
    v_cvt_pk_bf16_f32 v67, v62, v63
    v_accvgpr_write_b32 a96, v64
    v_accvgpr_write_b32 a97, v65
    v_accvgpr_write_b32 a98, v66
    v_accvgpr_write_b32 a99, v67
    v_alignbit_b32 v68, v64, v64, v40
    v_xor_b32 v68, v68, v41
    v_alignbit_b32 v69, v65, v65, v40
    v_xor_b32 v69, v69, v41
    v_alignbit_b32 v70, v66, v66, v40
    v_xor_b32 v70, v70, v41
    v_alignbit_b32 v71, v67, v67, v40
    v_xor_b32 v71, v71, v41
    v_accvgpr_write_b32 a224, v68
    v_accvgpr_write_b32 a225, v69
    v_accvgpr_write_b32 a226, v70
    v_accvgpr_write_b32 a227, v71
    v_fract_f32 v48, v31
    v_add_f32 v49, v48, v33
    v_cos_f32 v56, v48
    v_add_f32 v50, v49, v35
    v_cos_f32 v57, v49
    v_add_f32 v51, v50, v33
    v_cos_f32 v58, v50
    v_add_f32 v52, v51, v35
    v_cos_f32 v59, v51
    v_add_f32 v53, v52, v33
    v_cos_f32 v60, v52
    v_add_f32 v54, v53, v35
    v_cos_f32 v61, v53
    v_add_f32 v55, v54, v33
    v_cos_f32 v62, v54
    v_cos_f32 v63, v55
    v_add_f32 v31, v48, v37
    v_cvt_pk_bf16_f32 v64, v56, v57
    v_cvt_pk_bf16_f32 v65, v58, v59
    v_cvt_pk_bf16_f32 v66, v60, v61
    v_cvt_pk_bf16_f32 v67, v62, v63
    v_accvgpr_write_b32 a100, v64
    v_accvgpr_write_b32 a101, v65
    v_accvgpr_write_b32 a102, v66
    v_accvgpr_write_b32 a103, v67
    v_alignbit_b32 v68, v64, v64, v40
    v_xor_b32 v68, v68, v41
    v_alignbit_b32 v69, v65, v65, v40
    v_xor_b32 v69, v69, v41
    v_alignbit_b32 v70, v66, v66, v40
    v_xor_b32 v70, v70, v41
    v_alignbit_b32 v71, v67, v67, v40
    v_xor_b32 v71, v71, v41
    v_accvgpr_write_b32 a228, v68
    v_accvgpr_write_b32 a229, v69
    v_accvgpr_write_b32 a230, v70
    v_accvgpr_write_b32 a231, v71
    v_fract_f32 v48, v30
    v_add_f32 v49, v48, v32
    v_cos_f32 v56, v48
    v_add_f32 v50, v49, v34
    v_cos_f32 v57, v49
    v_add_f32 v51, v50, v32
    v_cos_f32 v58, v50
    v_add_f32 v52, v51, v34
    v_cos_f32 v59, v51
    v_add_f32 v53, v52, v32
    v_cos_f32 v60, v52
    v_add_f32 v54, v53, v34
    v_cos_f32 v61, v53
    v_add_f32 v55, v54, v32
    v_cos_f32 v62, v54
    v_cos_f32 v63, v55
    v_add_f32 v30, v48, v36
    v_cvt_pk_bf16_f32 v64, v56, v57
    v_cvt_pk_bf16_f32 v65, v58, v59
    v_cvt_pk_bf16_f32 v66, v60, v61
    v_cvt_pk_bf16_f32 v67, v62, v63
    v_accvgpr_write_b32 a104, v64
    v_accvgpr_write_b32 a105, v65
    v_accvgpr_write_b32 a106, v66
    v_accvgpr_write_b32 a107, v67
    v_alignbit_b32 v68, v64, v64, v40
    v_xor_b32 v68, v68, v41
    v_alignbit_b32 v69, v65, v65, v40
    v_xor_b32 v69, v69, v41
    v_alignbit_b32 v70, v66, v66, v40
    v_xor_b32 v70, v70, v41
    v_alignbit_b32 v71, v67, v67, v40
    v_xor_b32 v71, v71, v41
    v_accvgpr_write_b32 a232, v68
    v_accvgpr_write_b32 a233, v69
    v_accvgpr_write_b32 a234, v70
    v_accvgpr_write_b32 a235, v71
    v_fract_f32 v48, v31
    v_add_f32 v49, v48, v33
    v_cos_f32 v56, v48
    v_add_f32 v50, v49, v35
    v_cos_f32 v57, v49
    v_add_f32 v51, v50, v33
    v_cos_f32 v58, v50
    v_add_f32 v52, v51, v35
    v_cos_f32 v59, v51
    v_add_f32 v53, v52, v33
    v_cos_f32 v60, v52
    v_add_f32 v54, v53, v35
    v_cos_f32 v61, v53
    v_add_f32 v55, v54, v33
    v_cos_f32 v62, v54
    v_cos_f32 v63, v55
    v_add_f32 v31, v48, v37
    v_cvt_pk_bf16_f32 v64, v56, v57
    v_cvt_pk_bf16_f32 v65, v58, v59
    v_cvt_pk_bf16_f32 v66, v60, v61
    v_cvt_pk_bf16_f32 v67, v62, v63
    v_accvgpr_write_b32 a108, v64
    v_accvgpr_write_b32 a109, v65
    v_accvgpr_write_b32 a110, v66
    v_accvgpr_write_b32 a111, v67
    v_alignbit_b32 v68, v64, v64, v40
    v_xor_b32 v68, v68, v41
    v_alignbit_b32 v69, v65, v65, v40
    v_xor_b32 v69, v69, v41
    v_alignbit_b32 v70, v66, v66, v40
    v_xor_b32 v70, v70, v41
    v_alignbit_b32 v71, v67, v67, v40
    v_xor_b32 v71, v71, v41
    v_accvgpr_write_b32 a236, v68
    v_accvgpr_write_b32 a237, v69
    v_accvgpr_write_b32 a238, v70
    v_accvgpr_write_b32 a239, v71
    v_fract_f32 v48, v30
    v_add_f32 v49, v48, v32
    v_cos_f32 v56, v48
    v_add_f32 v50, v49, v34
    v_cos_f32 v57, v49
    v_add_f32 v51, v50, v32
    v_cos_f32 v58, v50
    v_add_f32 v52, v51, v34
    v_cos_f32 v59, v51
    v_add_f32 v53, v52, v32
    v_cos_f32 v60, v52
    v_add_f32 v54, v53, v34
    v_cos_f32 v61, v53
    v_add_f32 v55, v54, v32
    v_cos_f32 v62, v54
    v_cos_f32 v63, v55
    v_add_f32 v30, v48, v36
    v_cvt_pk_bf16_f32 v64, v56, v57
    v_cvt_pk_bf16_f32 v65, v58, v59
    v_cvt_pk_bf16_f32 v66, v60, v61
    v_cvt_pk_bf16_f32 v67, v62, v63
    v_accvgpr_write_b32 a112, v64
    v_accvgpr_write_b32 a113, v65
    v_accvgpr_write_b32 a114, v66
    v_accvgpr_write_b32 a115, v67
    v_alignbit_b32 v68, v64, v64, v40
    v_xor_b32 v68, v68, v41
    v_alignbit_b32 v69, v65, v65, v40
    v_xor_b32 v69, v69, v41
    v_alignbit_b32 v70, v66, v66, v40
    v_xor_b32 v70, v70, v41
    v_alignbit_b32 v71, v67, v67, v40
    v_xor_b32 v71, v71, v41
    v_accvgpr_write_b32 a240, v68
    v_accvgpr_write_b32 a241, v69
    v_accvgpr_write_b32 a242, v70
    v_accvgpr_write_b32 a243, v71
    v_fract_f32 v48, v31
    v_add_f32 v49, v48, v33
    v_cos_f32 v56, v48
    v_add_f32 v50, v49, v35
    v_cos_f32 v57, v49
    v_add_f32 v51, v50, v33
    v_cos_f32 v58, v50
    v_add_f32 v52, v51, v35
    v_cos_f32 v59, v51
    v_add_f32 v53, v52, v33
    v_cos_f32 v60, v52
    v_add_f32 v54, v53, v35
    v_cos_f32 v61, v53
    v_add_f32 v55, v54, v33
    v_cos_f32 v62, v54
    v_cos_f32 v63, v55
    v_add_f32 v31, v48, v37
    v_cvt_pk_bf16_f32 v64, v56, v57
    v_cvt_pk_bf16_f32 v65, v58, v59
    v_cvt_pk_bf16_f32 v66, v60, v61
    v_cvt_pk_bf16_f32 v67, v62, v63
    v_accvgpr_write_b32 a116, v64
    v_accvgpr_write_b32 a117, v65
    v_accvgpr_write_b32 a118, v66
    v_accvgpr_write_b32 a119, v67
    v_alignbit_b32 v68, v64, v64, v40
    v_xor_b32 v68, v68, v41
    v_alignbit_b32 v69, v65, v65, v40
    v_xor_b32 v69, v69, v41
    v_alignbit_b32 v70, v66, v66, v40
    v_xor_b32 v70, v70, v41
    v_alignbit_b32 v71, v67, v67, v40
    v_xor_b32 v71, v71, v41
    v_accvgpr_write_b32 a244, v68
    v_accvgpr_write_b32 a245, v69
    v_accvgpr_write_b32 a246, v70
    v_accvgpr_write_b32 a247, v71
    v_fract_f32 v48, v30
    v_add_f32 v49, v48, v32
    v_cos_f32 v56, v48
    v_add_f32 v50, v49, v34
    v_cos_f32 v57, v49
    v_add_f32 v51, v50, v32
    v_cos_f32 v58, v50
    v_add_f32 v52, v51, v34
    v_cos_f32 v59, v51
    v_add_f32 v53, v52, v32
    v_cos_f32 v60, v52
    v_add_f32 v54, v53, v34
    v_cos_f32 v61, v53
    v_add_f32 v55, v54, v32
    v_cos_f32 v62, v54
    v_cos_f32 v63, v55
    v_add_f32 v30, v48, v36
    v_cvt_pk_bf16_f32 v64, v56, v57
    v_cvt_pk_bf16_f32 v65, v58, v59
    v_cvt_pk_bf16_f32 v66, v60, v61
    v_cvt_pk_bf16_f32 v67, v62, v63
    v_accvgpr_write_b32 a120, v64
    v_accvgpr_write_b32 a121, v65
    v_accvgpr_write_b32 a122, v66
    v_accvgpr_write_b32 a123, v67
    v_alignbit_b32 v68, v64, v64, v40
    v_xor_b32 v68, v68, v41
    v_alignbit_b32 v69, v65, v65, v40
    v_xor_b32 v69, v69, v41
    v_alignbit_b32 v70, v66, v66, v40
    v_xor_b32 v70, v70, v41
    v_alignbit_b32 v71, v67, v67, v40
    v_xor_b32 v71, v71, v41
    v_accvgpr_write_b32 a248, v68
    v_accvgpr_write_b32 a249, v69
    v_accvgpr_write_b32 a250, v70
    v_accvgpr_write_b32 a251, v71
    v_fract_f32 v48, v31
    v_add_f32 v49, v48, v33
    v_cos_f32 v56, v48
    v_add_f32 v50, v49, v35
    v_cos_f32 v57, v49
    v_add_f32 v51, v50, v33
    v_cos_f32 v58, v50
    v_add_f32 v52, v51, v35
    v_cos_f32 v59, v51
    v_add_f32 v53, v52, v33
    v_cos_f32 v60, v52
    v_add_f32 v54, v53, v35
    v_cos_f32 v61, v53
    v_add_f32 v55, v54, v33
    v_cos_f32 v62, v54
    v_cos_f32 v63, v55
    v_add_f32 v31, v48, v37
    v_cvt_pk_bf16_f32 v64, v56, v57
    v_cvt_pk_bf16_f32 v65, v58, v59
    v_cvt_pk_bf16_f32 v66, v60, v61
    v_cvt_pk_bf16_f32 v67, v62, v63
    v_accvgpr_write_b32 a124, v64
    v_accvgpr_write_b32 a125, v65
    v_accvgpr_write_b32 a126, v66
    v_accvgpr_write_b32 a127, v67
    v_alignbit_b32 v68, v64, v64, v40
    v_xor_b32 v68, v68, v41
    v_alignbit_b32 v69, v65, v65, v40
    v_xor_b32 v69, v69, v41
    v_alignbit_b32 v70, v66, v66, v40
    v_xor_b32 v70, v70, v41
    v_alignbit_b32 v71, v67, v67, v40
    v_xor_b32 v71, v71, v41
    v_accvgpr_write_b32 a252, v68
    v_accvgpr_write_b32 a253, v69
    v_accvgpr_write_b32 a254, v70
    v_accvgpr_write_b32 a255, v71
    v_lshlrev_b32 v6, 31, v38
    v_or_b32 v6, 0x3f003f00, v6
    v_cmp_gt_u32 vcc, 16, v1
    v_accvgpr_read_b32 v5, a0
    s_nop 0
    v_cndmask_b32 v5, v5, v6, vcc
    v_accvgpr_write_b32 a0, v5
    v_accvgpr_read_b32 v5, a4
    v_cndmask_b32 v5, v5, v6, vcc
    v_accvgpr_write_b32 a4, v5
    v_and_b32 v5, 15, v1
    v_lshrrev_b32 v6, 4, v1
    v_lshlrev_b32 v5, 4, v5
    v_lshl_add_u32 v10, v6, 9, v5
    v_add_u32 v11, 2048, v10
    v_add_u32 v12, 0x10000, v10
    v_add_u32 v13, 0x10000, v11
    s_lshl_b32 s19, s16, 10
    s_lshl_b32 s17, s16, 1
    v_lshrrev_b32 v8, 5, v1
    v_add_u32 v8, s17, v8
    v_and_b32 v7, 31, v1
    v_mul_u32_u24 v2, 33024, v8
    v_lshl_add_u32 v2, v7, 4, v2
    v_and_b32 v3, 15, v1
    v_and_b32 v5, 48, v1
    v_lshl_add_u32 v3, v3, 12, v5
    v_add_u32 v4, 0x10000, v3
    s_lshl_b32 s21, s28, 21
    s_lshl_b32 s17, s29, 6
    s_add_u32 s21, s21, s17
    s_lshl_b32 s20, s28, 13
    s_add_u32 s20, s20, 111149056
    s_mov_b32 s24, 512
    s_mov_b32 s25, 131072
    v_and_b32 v7, 31, v1
    v_lshlrev_b32 v7, 7, v7
    s_lshl_b32 s17, s16, 12
    s_add_u32 s17, s17, 100761600
    v_add_u32 v7, s17, v7
    s_mov_b32 s30, s92
F3_w0:
    buffer_load_dword v5, v7, s[4:7], 0 offen sc1
    s_waitcnt vmcnt(0)
    v_cmp_gt_u32 vcc, 1, v5
    s_nop 0
    s_cmp_lg_u64 vcc, 0
    s_cbranch_scc0 F3_w0_ok
    s_cmp_ge_u32 s30, 1048576
    s_cselect_b32 s92, 1048576, s92
    s_cbranch_scc1 F3_w0_ok
    s_add_u32 s30, s30, 1
    s_sleep 8
    s_branch F3_w0
F3_w0_ok:
    s_barrier
    s_mov_b32 s26, s25
    s_sub_u32 s25, s21, 1073741824
    s_mov_b32 s21, 1073741824
    s_mov_b32 s23, 0
    s_mov_b32 s22, 0
    s_add_u32 m0, s19, 0
    s_add_u32 s17, s20, 0
    buffer_load_dwordx4 v2, s[4:7], s17 offen lds
    s_add_u32 m0, s19, 4096
    s_add_u32 s17, s20, 264192
    buffer_load_dwordx4 v2, s[4:7], s17 offen lds
    s_add_u32 m0, s19, 8192
    s_add_u32 s17, s20, 528384
    buffer_load_dwordx4 v2, s[4:7], s17 offen lds
    s_add_u32 m0, s19, 12288
    s_add_u32 s17, s20, 792576
    buffer_load_dwordx4 v2, s[4:7], s17 offen lds
    s_add_u32 m0, s19, 16384
    s_add_u32 s17, s20, 1056768
    buffer_load_dwordx4 v2, s[4:7], s17 offen lds
    s_add_u32 m0, s19, 20480
    s_add_u32 s17, s20, 1320960
    buffer_load_dwordx4 v2, s[4:7], s17 offen lds
    s_add_u32 m0, s19, 24576
    s_add_u32 s17, s20, 1585152
    buffer_load_dwordx4 v2, s[4:7], s17 offen lds
    s_add_u32 m0, s19, 28672
    s_add_u32 s17, s20, 1849344
    buffer_load_dwordx4 v2, s[4:7], s17 offen lds
    s_add_u32 m0, s19, 32768
    s_add_u32 s17, s20, 2113536
    buffer_load_dwordx4 v2, s[4:7], s17 offen lds
    s_add_u32 m0, s19, 36864
    s_add_u32 s17, s20, 2377728
    buffer_load_dwordx4 v2, s[4:7], s17 offen lds
    s_add_u32 m0, s19, 40960
    s_add_u32 s17, s20, 2641920
    buffer_load_dwordx4 v2, s[4:7], s17 offen lds
    s_add_u32 m0, s19, 45056
    s_add_u32 s17, s20, 2906112
    buffer_load_dwordx4 v2, s[4:7], s17 offen lds
    s_add_u32 m0, s19, 49152
    s_add_u32 s17, s20, 3170304
    buffer_load_dwordx4 v2, s[4:7], s17 offen lds
    s_add_u32 m0, s19, 53248
    s_add_u32 s17, s20, 3434496
    buffer_load_dwordx4 v2, s[4:7], s17 offen lds
    s_add_u32 m0, s19, 57344
    s_add_u32 s17, s20, 3698688
    buffer_load_dwordx4 v2, s[4:7], s17 offen lds
    s_add_u32 m0, s19, 61440
    s_add_u32 s17, s20, 3962880
    buffer_load_dwordx4 v2, s[4:7], s17 offen lds
    s_add_u32 s20, s20, s24
    s_add_u32 m0, s19, 65536
    s_add_u32 s17, s20, 0
    buffer_load_dwordx4 v2, s[4:7], s17 offen lds
    s_add_u32 m0, s19, 69632
    s_add_u32 s17, s20, 264192
    buffer_load_dwordx4 v2, s[4:7], s17 offen lds
    s_add_u32 m0, s19, 73728
    s_add_u32 s17, s20, 528384
    buffer_load_dwordx4 v2, s[4:7], s17 offen lds
    s_waitcnt vmcnt(11)
    s_barrier
    ds_read_b128 v[20:23], v10 offset:0
    ds_read_b128 v[24:27], v10 offset:256
    ds_read_b128 v[28:31], v11 offset:0
    ds_read_b128 v[32:35], v11 offset:256
    ds_read_b128 v[36:39], v10 offset:4096
    ds_read_b128 v[40:43], v10 offset:4352
    ds_read_b128 v[44:47], v11 offset:4096
.p2align 6
F3_top:
    s_waitcnt lgkmcnt(6)
    v_mfma_f32_16x16x32_bf16 v[52:55], a[0:3], v[20:23], 0
    ds_read_b128 v[48:51], v11 offset:4352
    v_mfma_f32_16x16x32_bf16 v[56:59], a[4:7], v[20:23], 0
    s_waitcnt lgkmcnt(6)
    v_mfma_f32_16x16x32_bf16 v[60:63], a[0:3], v[24:27], 0
    ds_read_b128 v[20:23], v10 offset:8192
    s_add_u32 m0, s19, 77824
    v_mfma_f32_16x16x32_bf16 v[64:67], a[4:7], v[24:27], 0
    s_add_u32 s17, s20, 792576
    buffer_load_dwordx4 v2, s[4:7], s17 offen lds
    s_waitcnt lgkmcnt(6)
    v_mfma_f32_16x16x32_bf16 v[52:55], a[8:11], v[28:31], v[52:55]
    ds_read_b128 v[24:27], v10 offset:8448
    v_mfma_f32_16x16x32_bf16 v[56:59], a[12:15], v[28:31], v[56:59]
    s_waitcnt lgkmcnt(6)
    v_mfma_f32_16x16x32_bf16 v[60:63], a[8:11], v[32:35], v[60:63]
    ds_read_b128 v[28:31], v11 offset:8192
    s_add_u32 m0, s19, 81920
    v_mfma_f32_16x16x32_bf16 v[64:67], a[12:15], v[32:35], v[64:67]
    s_add_u32 s17, s20, 1056768
    buffer_load_dwordx4 v2, s[4:7], s17 offen lds
    s_waitcnt lgkmcnt(6)
    v_mfma_f32_16x16x32_bf16 v[52:55], a[16:19], v[36:39], v[52:55]
    ds_read_b128 v[32:35], v11 offset:8448
    v_mfma_f32_16x16x32_bf16 v[56:59], a[20:23], v[36:39], v[56:59]
    s_waitcnt lgkmcnt(6)
    v_mfma_f32_16x16x32_bf16 v[60:63], a[16:19], v[40:43], v[60:63]
    ds_read_b128 v[36:39], v10 offset:12288
    s_add_u32 m0, s19, 86016
    v_mfma_f32_16x16x32_bf16 v[64:67], a[20:23], v[40:43], v[64:67]
    s_add_u32 s17, s20, 1320960
    buffer_load_dwordx4 v2, s[4:7], s17 offen lds
    s_waitcnt lgkmcnt(6)
    v_mfma_f32_16x16x32_bf16 v[52:55], a[24:27], v[44:47], v[52:55]
    ds_read_b128 v[40:43], v10 offset:12544
    v_mfma_f32_16x16x32_bf16 v[56:59], a[28:31], v[44:47], v[56:59]
    s_waitcnt lgkmcnt(6)
    v_mfma_f32_16x16x32_bf16 v[60:63], a[24:27], v[48:51], v[60:63]
    ds_read_b128 v[44:47], v11 offset:12288
    s_add_u32 m0, s19, 90112
    v_mfma_f32_16x16x32_bf16 v[64:67], a[28:31], v[48:51], v[64:67]
    s_add_u32 s17, s20, 1585152
    buffer_load_dwordx4 v2, s[4:7], s17 offen lds
    s_waitcnt lgkmcnt(6)
    v_mfma_f32_16x16x32_bf16 v[52:55], a[32:35], v[20:23], v[52:55]
    ds_read_b128 v[48:51], v11 offset:12544
    v_mfma_f32_16x16x32_bf16 v[56:59], a[36:39], v[20:23], v[56:59]
    s_waitcnt lgkmcnt(6)
    v_mfma_f32_16x16x32_bf16 v[60:63], a[32:35], v[24:27], v[60:63]
    ds_read_b128 v[20:23], v10 offset:16384
    s_add_u32 m0, s19, 94208
    v_mfma_f32_16x16x32_bf16 v[64:67], a[36:39], v[24:27], v[64:67]
    s_add_u32 s17, s20, 1849344
    buffer_load_dwordx4 v2, s[4:7], s17 offen lds
    s_waitcnt lgkmcnt(6)
    v_mfma_f32_16x16x32_bf16 v[52:55], a[40:43], v[28:31], v[52:55]
    ds_read_b128 v[24:27], v10 offset:16640
    v_mfma_f32_16x16x32_bf16 v[56:59], a[44:47], v[28:31], v[56:59]
    v_cvt_pk_bf16_f32 v84, v68, v69
    s_waitcnt lgkmcnt(6)
    v_mfma_f32_16x16x32_bf16 v[60:63], a[40:43], v[32:35], v[60:63]
    ds_read_b128 v[28:31], v11 offset:16384
    v_mfma_f32_16x16x32_bf16 v[64:67], a[44:47], v[32:35], v[64:67]
    v_cvt_pk_bf16_f32 v85, v70, v71
    s_waitcnt lgkmcnt(6)
    v_mfma_f32_16x16x32_bf16 v[52:55], a[48:51], v[36:39], v[52:55]
    ds_read_b128 v[32:35], v11 offset:16640
    v_mfma_f32_16x16x32_bf16 v[56:59], a[52:55], v[36:39], v[56:59]
    v_cvt_pk_bf16_f32 v86, v72, v73
    s_waitcnt lgkmcnt(6)
    v_mfma_f32_16x16x32_bf16 v[60:63], a[48:51], v[40:43], v[60:63]
    ds_read_b128 v[36:39], v10 offset:20480
    v_mfma_f32_16x16x32_bf16 v[64:67], a[52:55], v[40:43], v[64:67]
    v_cvt_pk_bf16_f32 v87, v74, v75
    s_waitcnt lgkmcnt(6)
    v_mfma_f32_16x16x32_bf16 v[52:55], a[56:59], v[44:47], v[52:55]
    ds_read_b128 v[40:43], v10 offset:20736
    v_mfma_f32_16x16x32_bf16 v[56:59], a[60:63], v[44:47], v[56:59]
    v_cvt_pk_bf16_f32 v88, v76, v77
    s_waitcnt lgkmcnt(6)
    v_mfma_f32_16x16x32_bf16 v[60:63], a[56:59], v[48:51], v[60:63]
    ds_read_b128 v[44:47], v11 offset:20480
    v_mfma_f32_16x16x32_bf16 v[64:67], a[60:63], v[48:51], v[64:67]
    v_cvt_pk_bf16_f32 v89, v78, v79
    buffer_store_dwordx4 v[84:87], v3, s[12:15], s21 offen
    s_waitcnt lgkmcnt(6)
    v_mfma_f32_16x16x32_bf16 v[52:55], a[64:67], v[20:23], v[52:55]
    ds_read_b128 v[48:51], v11 offset:20736
    v_mfma_f32_16x16x32_bf16 v[56:59], a[68:71], v[20:23], v[56:59]
    v_cvt_pk_bf16_f32 v90, v80, v81
    s_waitcnt lgkmcnt(6)
    v_mfma_f32_16x16x32_bf16 v[60:63], a[64:67], v[24:27], v[60:63]
    ds_read_b128 v[20:23], v10 offset:24576
    v_mfma_f32_16x16x32_bf16 v[64:67], a[68:71], v[24:27], v[64:67]
    v_cvt_pk_bf16_f32 v91, v82, v83
    s_waitcnt lgkmcnt(6)
    v_mfma_f32_16x16x32_bf16 v[52:55], a[72:75], v[28:31], v[52:55]
    ds_read_b128 v[24:27], v10 offset:24832
    v_mfma_f32_16x16x32_bf16 v[56:59], a[76:79], v[28:31], v[56:59]
    s_waitcnt lgkmcnt(6)
    v_mfma_f32_16x16x32_bf16 v[60:63], a[72:75], v[32:35], v[60:63]
    ds_read_b128 v[28:31], v11 offset:24576
    v_mfma_f32_16x16x32_bf16 v[64:67], a[76:79], v[32:35], v[64:67]
    buffer_store_dwordx4 v[88:91], v4, s[12:15], s21 offen
    s_waitcnt lgkmcnt(6)
    v_mfma_f32_16x16x32_bf16 v[52:55], a[80:83], v[36:39], v[52:55]
    ds_read_b128 v[32:35], v11 offset:24832
    v_mfma_f32_16x16x32_bf16 v[56:59], a[84:87], v[36:39], v[56:59]
    s_add_u32 s21, s21, s25
    s_mov_b32 s25, s26
    s_waitcnt lgkmcnt(6)
    v_mfma_f32_16x16x32_bf16 v[60:63], a[80:83], v[40:43], v[60:63]
    ds_read_b128 v[36:39], v10 offset:28672
    v_mfma_f32_16x16x32_bf16 v[64:67], a[84:87], v[40:43], v[64:67]
    s_waitcnt lgkmcnt(6)
    v_mfma_f32_16x16x32_bf16 v[52:55], a[88:91], v[44:47], v[52:55]
    ds_read_b128 v[40:43], v10 offset:28928
    v_mfma_f32_16x16x32_bf16 v[56:59], a[92:95], v[44:47], v[56:59]
    s_waitcnt lgkmcnt(6)
    v_mfma_f32_16x16x32_bf16 v[60:63], a[88:91], v[48:51], v[60:63]
    ds_read_b128 v[44:47], v11 offset:28672
    v_mfma_f32_16x16x32_bf16 v[64:67], a[92:95], v[48:51], v[64:67]
    s_waitcnt lgkmcnt(6)
    v_mfma_f32_16x16x32_bf16 v[52:55], a[96:99], v[20:23], v[52:55]
    ds_read_b128 v[48:51], v11 offset:28928
    v_mfma_f32_16x16x32_bf16 v[56:59], a[100:103], v[20:23], v[56:59]
    s_waitcnt lgkmcnt(6)
    v_mfma_f32_16x16x32_bf16 v[60:63], a[96:99], v[24:27], v[60:63]
    s_waitcnt vmcnt(10)
    s_barrier
    ds_read_b128 v[20:23], v10 offset:32768
    v_mfma_f32_16x16x32_bf16 v[64:67], a[100:103], v[24:27], v[64:67]
    s_waitcnt lgkmcnt(6)
    v_mfma_f32_16x16x32_bf16 v[52:55], a[104:107], v[28:31], v[52:55]
    ds_read_b128 v[24:27], v10 offset:33024
    s_add_u32 m0, s19, 98304
    v_mfma_f32_16x16x32_bf16 v[56:59], a[108:111], v[28:31], v[56:59]
    s_add_u32 s17, s20, 2113536
    buffer_load_dwordx4 v2, s[4:7], s17 offen lds
    s_waitcnt lgkmcnt(6)
    v_mfma_f32_16x16x32_bf16 v[60:63], a[104:107], v[32:35], v[60:63]
    ds_read_b128 v[28:31], v11 offset:32768
    v_mfma_f32_16x16x32_bf16 v[64:67], a[108:111], v[32:35], v[64:67]
    s_waitcnt lgkmcnt(6)
    v_mfma_f32_16x16x32_bf16 v[52:55], a[112:115], v[36:39], v[52:55]
    ds_read_b128 v[32:35], v11 offset:33024
    s_add_u32 m0, s19, 102400
    v_mfma_f32_16x16x32_bf16 v[56:59], a[116:119], v[36:39], v[56:59]
    s_add_u32 s17, s20, 2377728
    buffer_load_dwordx4 v2, s[4:7], s17 offen lds
    s_waitcnt lgkmcnt(6)
    v_mfma_f32_16x16x32_bf16 v[60:63], a[112:115], v[40:43], v[60:63]
    ds_read_b128 v[36:39], v10 offset:36864
    v_mfma_f32_16x16x32_bf16 v[64:67], a[116:119], v[40:43], v[64:67]
    s_waitcnt lgkmcnt(6)
    v_mfma_f32_16x16x32_bf16 v[52:55], a[120:123], v[44:47], v[52:55]
    ds_read_b128 v[40:43], v10 offset:37120
    s_add_u32 m0, s19, 106496
    v_mfma_f32_16x16x32_bf16 v[56:59], a[124:127], v[44:47], v[56:59]
    s_add_u32 s17, s20, 2641920
    buffer_load_dwordx4 v2, s[4:7], s17 offen lds
    s_waitcnt lgkmcnt(6)
    v_mfma_f32_16x16x32_bf16 v[60:63], a[120:123], v[48:51], v[60:63]
    ds_read_b128 v[44:47], v11 offset:36864
    v_mfma_f32_16x16x32_bf16 v[64:67], a[124:127], v[48:51], v[64:67]
    s_waitcnt lgkmcnt(6)
    v_mfma_f32_16x16x32_bf16 v[52:55], a[128:131], v[20:23], v[52:55]
    ds_read_b128 v[48:51], v11 offset:37120
    v_mfma_f32_16x16x32_bf16 v[56:59], a[132:135], v[20:23], v[56:59]
    s_waitcnt lgkmcnt(6)
    v_mfma_f32_16x16x32_bf16 v[60:63], a[128:131], v[24:27], v[60:63]
    ds_read_b128 v[20:23], v10 offset:40960
    s_add_u32 m0, s19, 110592
    v_mfma_f32_16x16x32_bf16 v[64:67], a[132:135], v[24:27], v[64:67]
    s_add_u32 s17, s20, 2906112
    buffer_load_dwordx4 v2, s[4:7], s17 offen lds
    s_waitcnt lgkmcnt(6)
    v_mfma_f32_16x16x32_bf16 v[52:55], a[136:139], v[28:31], v[52:55]
    ds_read_b128 v[24:27], v10 offset:41216
    v_mfma_f32_16x16x32_bf16 v[56:59], a[140:143], v[28:31], v[56:59]
    s_waitcnt lgkmcnt(6)
    v_mfma_f32_16x16x32_bf16 v[60:63], a[136:139], v[32:35], v[60:63]
    ds_read_b128 v[28:31], v11 offset:40960
    s_add_u32 m0, s19, 114688
    v_mfma_f32_16x16x32_bf16 v[64:67], a[140:143], v[32:35], v[64:67]
    s_add_u32 s17, s20, 3170304
    buffer_load_dwordx4 v2, s[4:7], s17 offen lds
    s_waitcnt lgkmcnt(6)
    v_mfma_f32_16x16x32_bf16 v[52:55], a[144:147], v[36:39], v[52:55]
    ds_read_b128 v[32:35], v11 offset:41216
    v_mfma_f32_16x16x32_bf16 v[56:59], a[148:151], v[36:39], v[56:59]
    s_waitcnt lgkmcnt(6)
    v_mfma_f32_16x16x32_bf16 v[60:63], a[144:147], v[40:43], v[60:63]
    ds_read_b128 v[36:39], v10 offset:45056
    s_add_u32 m0, s19, 118784
    v_mfma_f32_16x16x32_bf16 v[64:67], a[148:151], v[40:43], v[64:67]
    s_add_u32 s17, s20, 3434496
    buffer_load_dwordx4 v2, s[4:7], s17 offen lds
    s_waitcnt lgkmcnt(6)
    v_mfma_f32_16x16x32_bf16 v[52:55], a[152:155], v[44:47], v[52:55]
    ds_read_b128 v[40:43], v10 offset:45312
    v_mfma_f32_16x16x32_bf16 v[56:59], a[156:159], v[44:47], v[56:59]
    s_waitcnt lgkmcnt(6)
    v_mfma_f32_16x16x32_bf16 v[60:63], a[152:155], v[48:51], v[60:63]
    ds_read_b128 v[44:47], v11 offset:45056
    s_add_u32 m0, s19, 122880
    v_mfma_f32_16x16x32_bf16 v[64:67], a[156:159], v[48:51], v[64:67]
    s_add_u32 s17, s20, 3698688
    buffer_load_dwordx4 v2, s[4:7], s17 offen lds
    s_waitcnt lgkmcnt(6)
    v_mfma_f32_16x16x32_bf16 v[52:55], a[160:163], v[20:23], v[52:55]
    ds_read_b128 v[48:51], v11 offset:45312
    v_mfma_f32_16x16x32_bf16 v[56:59], a[164:167], v[20:23], v[56:59]
    s_waitcnt lgkmcnt(6)
    v_mfma_f32_16x16x32_bf16 v[60:63], a[160:163], v[24:27], v[60:63]
    ds_read_b128 v[20:23], v10 offset:49152
    s_add_u32 m0, s19, 126976
    v_mfma_f32_16x16x32_bf16 v[64:67], a[164:167], v[24:27], v[64:67]
    s_add_u32 s17, s20, 3962880
    buffer_load_dwordx4 v2, s[4:7], s17 offen lds
    s_waitcnt lgkmcnt(6)
    v_mfma_f32_16x16x32_bf16 v[52:55], a[168:171], v[28:31], v[52:55]
    ds_read_b128 v[24:27], v10 offset:49408
    v_mfma_f32_16x16x32_bf16 v[56:59], a[172:175], v[28:31], v[56:59]
    s_add_u32 s20, s20, s24
    s_waitcnt lgkmcnt(6)
    v_mfma_f32_16x16x32_bf16 v[60:63], a[168:171], v[32:35], v[60:63]
    ds_read_b128 v[28:31], v11 offset:49152
    v_mfma_f32_16x16x32_bf16 v[64:67], a[172:175], v[32:35], v[64:67]
    s_waitcnt lgkmcnt(6)
    v_mfma_f32_16x16x32_bf16 v[52:55], a[176:179], v[36:39], v[52:55]
    ds_read_b128 v[32:35], v11 offset:49408
    v_mfma_f32_16x16x32_bf16 v[56:59], a[180:183], v[36:39], v[56:59]
    s_waitcnt lgkmcnt(6)
    v_mfma_f32_16x16x32_bf16 v[60:63], a[176:179], v[40:43], v[60:63]
    ds_read_b128 v[36:39], v10 offset:53248
    v_mfma_f32_16x16x32_bf16 v[64:67], a[180:183], v[40:43], v[64:67]
    s_waitcnt lgkmcnt(6)
    v_mfma_f32_16x16x32_bf16 v[52:55], a[184:187], v[44:47], v[52:55]
    ds_read_b128 v[40:43], v10 offset:53504
    v_mfma_f32_16x16x32_bf16 v[56:59], a[188:191], v[44:47], v[56:59]
    s_waitcnt lgkmcnt(6)
    v_mfma_f32_16x16x32_bf16 v[60:63], a[184:187], v[48:51], v[60:63]
    ds_read_b128 v[44:47], v11 offset:53248
    v_mfma_f32_16x16x32_bf16 v[64:67], a[188:191], v[48:51], v[64:67]
    s_waitcnt lgkmcnt(6)
    v_mfma_f32_16x16x32_bf16 v[52:55], a[192:195], v[20:23], v[52:55]
    ds_read_b128 v[48:51], v11 offset:53504
    v_mfma_f32_16x16x32_bf16 v[56:59], a[196:199], v[20:23], v[56:59]
    s_waitcnt lgkmcnt(6)
    v_mfma_f32_16x16x32_bf16 v[60:63], a[192:195], v[24:27], v[60:63]
    ds_read_b128 v[20:23], v10 offset:57344
    v_mfma_f32_16x16x32_bf16 v[64:67], a[196:199], v[24:27], v[64:67]
    s_waitcnt lgkmcnt(6)
    v_mfma_f32_16x16x32_bf16 v[52:55], a[200:203], v[28:31], v[52:55]
    ds_read_b128 v[24:27], v10 offset:57600
    v_mfma_f32_16x16x32_bf16 v[56:59], a[204:207], v[28:31], v[56:59]
    s_waitcnt lgkmcnt(6)
    v_mfma_f32_16x16x32_bf16 v[60:63], a[200:203], v[32:35], v[60:63]
    ds_read_b128 v[28:31], v11 offset:57344
    v_mfma_f32_16x16x32_bf16 v[64:67], a[204:207], v[32:35], v[64:67]
    s_waitcnt lgkmcnt(6)
    v_mfma_f32_16x16x32_bf16 v[52:55], a[208:211], v[36:39], v[52:55]
    ds_read_b128 v[32:35], v11 offset:57600
    v_mfma_f32_16x16x32_bf16 v[56:59], a[212:215], v[36:39], v[56:59]
    s_waitcnt lgkmcnt(6)
    v_mfma_f32_16x16x32_bf16 v[60:63], a[208:211], v[40:43], v[60:63]
    ds_read_b128 v[36:39], v10 offset:61440
    v_mfma_f32_16x16x32_bf16 v[64:67], a[212:215], v[40:43], v[64:67]
    s_waitcnt lgkmcnt(6)
    v_mfma_f32_16x16x32_bf16 v[52:55], a[216:219], v[44:47], v[52:55]
    ds_read_b128 v[40:43], v10 offset:61696
    v_mfma_f32_16x16x32_bf16 v[56:59], a[220:223], v[44:47], v[56:59]
    s_waitcnt lgkmcnt(6)
    v_mfma_f32_16x16x32_bf16 v[60:63], a[216:219], v[48:51], v[60:63]
    ds_read_b128 v[44:47], v11 offset:61440
    v_mfma_f32_16x16x32_bf16 v[64:67], a[220:223], v[48:51], v[64:67]
    s_waitcnt lgkmcnt(6)
    v_mfma_f32_16x16x32_bf16 v[52:55], a[224:227], v[20:23], v[52:55]
    ds_read_b128 v[48:51], v11 offset:61696
    v_mfma_f32_16x16x32_bf16 v[56:59], a[228:231], v[20:23], v[56:59]
    s_waitcnt lgkmcnt(6)
    v_mfma_f32_16x16x32_bf16 v[60:63], a[224:227], v[24:27], v[60:63]
    s_waitcnt vmcnt(8)
    s_barrier
    ds_read_b128 v[20:23], v12 offset:0
    v_mfma_f32_16x16x32_bf16 v[64:67], a[228:231], v[24:27], v[64:67]
    s_waitcnt lgkmcnt(6)
    v_mfma_f32_16x16x32_bf16 v[52:55], a[232:235], v[28:31], v[52:55]
    ds_read_b128 v[24:27], v12 offset:256
    s_add_u32 m0, s19, 0
    v_mfma_f32_16x16x32_bf16 v[56:59], a[236:239], v[28:31], v[56:59]
    s_add_u32 s17, s20, 0
    buffer_load_dwordx4 v2, s[4:7], s17 offen lds
    s_waitcnt lgkmcnt(6)
    v_mfma_f32_16x16x32_bf16 v[60:63], a[232:235], v[32:35], v[60:63]
    ds_read_b128 v[28:31], v13 offset:0
    v_mfma_f32_16x16x32_bf16 v[64:67], a[236:239], v[32:35], v[64:67]
    s_waitcnt lgkmcnt(6)
    v_mfma_f32_16x16x32_bf16 v[52:55], a[240:243], v[36:39], v[52:55]
    ds_read_b128 v[32:35], v13 offset:256
    s_add_u32 m0, s19, 4096
    v_mfma_f32_16x16x32_bf16 v[56:59], a[244:247], v[36:39], v[56:59]
    s_add_u32 s17, s20, 264192
    buffer_load_dwordx4 v2, s[4:7], s17 offen lds
    s_waitcnt lgkmcnt(6)
    v_mfma_f32_16x16x32_bf16 v[60:63], a[240:243], v[40:43], v[60:63]
    ds_read_b128 v[36:39], v12 offset:4096
    v_mfma_f32_16x16x32_bf16 v[64:67], a[244:247], v[40:43], v[64:67]
    s_waitcnt lgkmcnt(6)
    v_mfma_f32_16x16x32_bf16 v[52:55], a[248:251], v[44:47], v[52:55]
    ds_read_b128 v[40:43], v12 offset:4352
    s_add_u32 m0, s19, 8192
    v_mfma_f32_16x16x32_bf16 v[56:59], a[252:255], v[44:47], v[56:59]
    s_add_u32 s17, s20, 528384
    buffer_load_dwordx4 v2, s[4:7], s17 offen lds
    s_waitcnt lgkmcnt(6)
    v_mfma_f32_16x16x32_bf16 v[60:63], a[248:251], v[48:51], v[60:63]
    ds_read_b128 v[44:47], v13 offset:4096
    v_mfma_f32_16x16x32_bf16 v[64:67], a[252:255], v[48:51], v[64:67]
    s_waitcnt lgkmcnt(6)
    v_mfma_f32_16x16x32_bf16 v[68:71], a[0:3], v[20:23], 0
    ds_read_b128 v[48:51], v13 offset:4352
    v_mfma_f32_16x16x32_bf16 v[72:75], a[4:7], v[20:23], 0
    s_waitcnt lgkmcnt(6)
    v_mfma_f32_16x16x32_bf16 v[76:79], a[0:3], v[24:27], 0
    ds_read_b128 v[20:23], v12 offset:8192
    s_add_u32 m0, s19, 12288
    v_mfma_f32_16x16x32_bf16 v[80:83], a[4:7], v[24:27], 0
    s_add_u32 s17, s20, 792576
    buffer_load_dwordx4 v2, s[4:7], s17 offen lds
    s_waitcnt lgkmcnt(6)
    v_mfma_f32_16x16x32_bf16 v[68:71], a[8:11], v[28:31], v[68:71]
    ds_read_b128 v[24:27], v12 offset:8448
    v_mfma_f32_16x16x32_bf16 v[72:75], a[12:15], v[28:31], v[72:75]
    s_waitcnt lgkmcnt(6)
    v_mfma_f32_16x16x32_bf16 v[76:79], a[8:11], v[32:35], v[76:79]
    ds_read_b128 v[28:31], v13 offset:8192
    s_add_u32 m0, s19, 16384
    v_mfma_f32_16x16x32_bf16 v[80:83], a[12:15], v[32:35], v[80:83]
    s_add_u32 s17, s20, 1056768
    buffer_load_dwordx4 v2, s[4:7], s17 offen lds
    s_waitcnt lgkmcnt(6)
    v_mfma_f32_16x16x32_bf16 v[68:71], a[16:19], v[36:39], v[68:71]
    ds_read_b128 v[32:35], v13 offset:8448
    v_mfma_f32_16x16x32_bf16 v[72:75], a[20:23], v[36:39], v[72:75]
    s_waitcnt lgkmcnt(6)
    v_mfma_f32_16x16x32_bf16 v[76:79], a[16:19], v[40:43], v[76:79]
    ds_read_b128 v[36:39], v12 offset:12288
    s_add_u32 m0, s19, 20480
    v_mfma_f32_16x16x32_bf16 v[80:83], a[20:23], v[40:43], v[80:83]
    s_add_u32 s17, s20, 1320960
    buffer_load_dwordx4 v2, s[4:7], s17 offen lds
    s_waitcnt lgkmcnt(6)
    v_mfma_f32_16x16x32_bf16 v[68:71], a[24:27], v[44:47], v[68:71]
    ds_read_b128 v[40:43], v12 offset:12544
    v_mfma_f32_16x16x32_bf16 v[72:75], a[28:31], v[44:47], v[72:75]
    s_waitcnt lgkmcnt(6)
    v_mfma_f32_16x16x32_bf16 v[76:79], a[24:27], v[48:51], v[76:79]
    ds_read_b128 v[44:47], v13 offset:12288
    s_add_u32 m0, s19, 24576
    v_mfma_f32_16x16x32_bf16 v[80:83], a[28:31], v[48:51], v[80:83]
    s_add_u32 s17, s20, 1585152
    buffer_load_dwordx4 v2, s[4:7], s17 offen lds
    s_waitcnt lgkmcnt(6)
    v_mfma_f32_16x16x32_bf16 v[68:71], a[32:35], v[20:23], v[68:71]
    ds_read_b128 v[48:51], v13 offset:12544
    v_mfma_f32_16x16x32_bf16 v[72:75], a[36:39], v[20:23], v[72:75]
    s_waitcnt lgkmcnt(6)
    v_mfma_f32_16x16x32_bf16 v[76:79], a[32:35], v[24:27], v[76:79]
    ds_read_b128 v[20:23], v12 offset:16384
    s_add_u32 m0, s19, 28672
    v_mfma_f32_16x16x32_bf16 v[80:83], a[36:39], v[24:27], v[80:83]
    s_add_u32 s17, s20, 1849344
    buffer_load_dwordx4 v2, s[4:7], s17 offen lds
    s_waitcnt lgkmcnt(6)
    v_mfma_f32_16x16x32_bf16 v[68:71], a[40:43], v[28:31], v[68:71]
    ds_read_b128 v[24:27], v12 offset:16640
    v_mfma_f32_16x16x32_bf16 v[72:75], a[44:47], v[28:31], v[72:75]
    v_cvt_pk_bf16_f32 v84, v52, v53
    s_waitcnt lgkmcnt(6)
    v_mfma_f32_16x16x32_bf16 v[76:79], a[40:43], v[32:35], v[76:79]
    ds_read_b128 v[28:31], v13 offset:16384
    v_mfma_f32_16x16x32_bf16 v[80:83], a[44:47], v[32:35], v[80:83]
    v_cvt_pk_bf16_f32 v85, v54, v55
    s_waitcnt lgkmcnt(6)
    v_mfma_f32_16x16x32_bf16 v[68:71], a[48:51], v[36:39], v[68:71]
    ds_read_b128 v[32:35], v13 offset:16640
    v_mfma_f32_16x16x32_bf16 v[72:75], a[52:55], v[36:39], v[72:75]
    v_cvt_pk_bf16_f32 v86, v56, v57
    s_waitcnt lgkmcnt(6)
    v_mfma_f32_16x16x32_bf16 v[76:79], a[48:51], v[40:43], v[76:79]
    ds_read_b128 v[36:39], v12 offset:20480
    v_mfma_f32_16x16x32_bf16 v[80:83], a[52:55], v[40:43], v[80:83]
    v_cvt_pk_bf16_f32 v87, v58, v59
    s_waitcnt lgkmcnt(6)
    v_mfma_f32_16x16x32_bf16 v[68:71], a[56:59], v[44:47], v[68:71]
    ds_read_b128 v[40:43], v12 offset:20736
    v_mfma_f32_16x16x32_bf16 v[72:75], a[60:63], v[44:47], v[72:75]
    v_cvt_pk_bf16_f32 v88, v60, v61
    s_waitcnt lgkmcnt(6)
    v_mfma_f32_16x16x32_bf16 v[76:79], a[56:59], v[48:51], v[76:79]
    ds_read_b128 v[44:47], v13 offset:20480
    v_mfma_f32_16x16x32_bf16 v[80:83], a[60:63], v[48:51], v[80:83]
    v_cvt_pk_bf16_f32 v89, v62, v63
    buffer_store_dwordx4 v[84:87], v3, s[12:15], s21 offen
    s_waitcnt lgkmcnt(6)
    v_mfma_f32_16x16x32_bf16 v[68:71], a[64:67], v[20:23], v[68:71]
    ds_read_b128 v[48:51], v13 offset:20736
    v_mfma_f32_16x16x32_bf16 v[72:75], a[68:71], v[20:23], v[72:75]
    v_cvt_pk_bf16_f32 v90, v64, v65
    s_waitcnt lgkmcnt(6)
    v_mfma_f32_16x16x32_bf16 v[76:79], a[64:67], v[24:27], v[76:79]
    ds_read_b128 v[20:23], v12 offset:24576
    v_mfma_f32_16x16x32_bf16 v[80:83], a[68:71], v[24:27], v[80:83]
    v_cvt_pk_bf16_f32 v91, v66, v67
    s_waitcnt lgkmcnt(6)
    v_mfma_f32_16x16x32_bf16 v[68:71], a[72:75], v[28:31], v[68:71]
    ds_read_b128 v[24:27], v12 offset:24832
    v_mfma_f32_16x16x32_bf16 v[72:75], a[76:79], v[28:31], v[72:75]
    s_waitcnt lgkmcnt(6)
    v_mfma_f32_16x16x32_bf16 v[76:79], a[72:75], v[32:35], v[76:79]
    ds_read_b128 v[28:31], v13 offset:24576
    v_mfma_f32_16x16x32_bf16 v[80:83], a[76:79], v[32:35], v[80:83]
    buffer_store_dwordx4 v[88:91], v4, s[12:15], s21 offen
    s_waitcnt lgkmcnt(6)
    v_mfma_f32_16x16x32_bf16 v[68:71], a[80:83], v[36:39], v[68:71]
    ds_read_b128 v[32:35], v13 offset:24832
    v_mfma_f32_16x16x32_bf16 v[72:75], a[84:87], v[36:39], v[72:75]
    s_add_u32 s21, s21, s25
    s_mov_b32 s25, s26
    s_waitcnt lgkmcnt(6)
    v_mfma_f32_16x16x32_bf16 v[76:79], a[80:83], v[40:43], v[76:79]
    ds_read_b128 v[36:39], v12 offset:28672
    v_mfma_f32_16x16x32_bf16 v[80:83], a[84:87], v[40:43], v[80:83]
    s_waitcnt lgkmcnt(6)
    v_mfma_f32_16x16x32_bf16 v[68:71], a[88:91], v[44:47], v[68:71]
    ds_read_b128 v[40:43], v12 offset:28928
    v_mfma_f32_16x16x32_bf16 v[72:75], a[92:95], v[44:47], v[72:75]
    s_waitcnt lgkmcnt(6)
    v_mfma_f32_16x16x32_bf16 v[76:79], a[88:91], v[48:51], v[76:79]
    ds_read_b128 v[44:47], v13 offset:28672
    v_mfma_f32_16x16x32_bf16 v[80:83], a[92:95], v[48:51], v[80:83]
    s_waitcnt lgkmcnt(6)
    v_mfma_f32_16x16x32_bf16 v[68:71], a[96:99], v[20:23], v[68:71]
    ds_read_b128 v[48:51], v13 offset:28928
    v_mfma_f32_16x16x32_bf16 v[72:75], a[100:103], v[20:23], v[72:75]
    s_waitcnt lgkmcnt(6)
    v_mfma_f32_16x16x32_bf16 v[76:79], a[96:99], v[24:27], v[76:79]
    s_waitcnt vmcnt(10)
    s_barrier
    ds_read_b128 v[20:23], v12 offset:32768
    v_mfma_f32_16x16x32_bf16 v[80:83], a[100:103], v[24:27], v[80:83]
    s_waitcnt lgkmcnt(6)
    v_mfma_f32_16x16x32_bf16 v[68:71], a[104:107], v[28:31], v[68:71]
    ds_read_b128 v[24:27], v12 offset:33024
    s_add_u32 m0, s19, 32768
    v_mfma_f32_16x16x32_bf16 v[72:75], a[108:111], v[28:31], v[72:75]
    s_add_u32 s17, s20, 2113536
    buffer_load_dwordx4 v2, s[4:7], s17 offen lds
    s_waitcnt lgkmcnt(6)
    v_mfma_f32_16x16x32_bf16 v[76:79], a[104:107], v[32:35], v[76:79]
    ds_read_b128 v[28:31], v13 offset:32768
    v_mfma_f32_16x16x32_bf16 v[80:83], a[108:111], v[32:35], v[80:83]
    s_waitcnt lgkmcnt(6)
    v_mfma_f32_16x16x32_bf16 v[68:71], a[112:115], v[36:39], v[68:71]
    ds_read_b128 v[32:35], v13 offset:33024
    s_add_u32 m0, s19, 36864
    v_mfma_f32_16x16x32_bf16 v[72:75], a[116:119], v[36:39], v[72:75]
    s_add_u32 s17, s20, 2377728
    buffer_load_dwordx4 v2, s[4:7], s17 offen lds
    s_waitcnt lgkmcnt(6)
    v_mfma_f32_16x16x32_bf16 v[76:79], a[112:115], v[40:43], v[76:79]
    ds_read_b128 v[36:39], v12 offset:36864
    v_mfma_f32_16x16x32_bf16 v[80:83], a[116:119], v[40:43], v[80:83]
    s_waitcnt lgkmcnt(6)
    v_mfma_f32_16x16x32_bf16 v[68:71], a[120:123], v[44:47], v[68:71]
    ds_read_b128 v[40:43], v12 offset:37120
    s_add_u32 m0, s19, 40960
    v_mfma_f32_16x16x32_bf16 v[72:75], a[124:127], v[44:47], v[72:75]
    s_add_u32 s17, s20, 2641920
    buffer_load_dwordx4 v2, s[4:7], s17 offen lds
    s_waitcnt lgkmcnt(6)
    v_mfma_f32_16x16x32_bf16 v[76:79], a[120:123], v[48:51], v[76:79]
    ds_read_b128 v[44:47], v13 offset:36864
    v_mfma_f32_16x16x32_bf16 v[80:83], a[124:127], v[48:51], v[80:83]
    s_waitcnt lgkmcnt(6)
    v_mfma_f32_16x16x32_bf16 v[68:71], a[128:131], v[20:23], v[68:71]
    ds_read_b128 v[48:51], v13 offset:37120
    v_mfma_f32_16x16x32_bf16 v[72:75], a[132:135], v[20:23], v[72:75]
    s_waitcnt lgkmcnt(6)
    v_mfma_f32_16x16x32_bf16 v[76:79], a[128:131], v[24:27], v[76:79]
    ds_read_b128 v[20:23], v12 offset:40960
    s_add_u32 m0, s19, 45056
    v_mfma_f32_16x16x32_bf16 v[80:83], a[132:135], v[24:27], v[80:83]
    s_add_u32 s17, s20, 2906112
    buffer_load_dwordx4 v2, s[4:7], s17 offen lds
    s_waitcnt lgkmcnt(6)
    v_mfma_f32_16x16x32_bf16 v[68:71], a[136:139], v[28:31], v[68:71]
    ds_read_b128 v[24:27], v12 offset:41216
    v_mfma_f32_16x16x32_bf16 v[72:75], a[140:143], v[28:31], v[72:75]
    s_waitcnt lgkmcnt(6)
    v_mfma_f32_16x16x32_bf16 v[76:79], a[136:139], v[32:35], v[76:79]
    ds_read_b128 v[28:31], v13 offset:40960
    s_add_u32 m0, s19, 49152
    v_mfma_f32_16x16x32_bf16 v[80:83], a[140:143], v[32:35], v[80:83]
    s_add_u32 s17, s20, 3170304
    buffer_load_dwordx4 v2, s[4:7], s17 offen lds
    s_waitcnt lgkmcnt(6)
    v_mfma_f32_16x16x32_bf16 v[68:71], a[144:147], v[36:39], v[68:71]
    ds_read_b128 v[32:35], v13 offset:41216
    v_mfma_f32_16x16x32_bf16 v[72:75], a[148:151], v[36:39], v[72:75]
    s_waitcnt lgkmcnt(6)
    v_mfma_f32_16x16x32_bf16 v[76:79], a[144:147], v[40:43], v[76:79]
    ds_read_b128 v[36:39], v12 offset:45056
    s_add_u32 m0, s19, 53248
    v_mfma_f32_16x16x32_bf16 v[80:83], a[148:151], v[40:43], v[80:83]
    s_add_u32 s17, s20, 3434496
    buffer_load_dwordx4 v2, s[4:7], s17 offen lds
    s_waitcnt lgkmcnt(6)
    v_mfma_f32_16x16x32_bf16 v[68:71], a[152:155], v[44:47], v[68:71]
    ds_read_b128 v[40:43], v12 offset:45312
    v_mfma_f32_16x16x32_bf16 v[72:75], a[156:159], v[44:47], v[72:75]
    s_waitcnt lgkmcnt(6)
    v_mfma_f32_16x16x32_bf16 v[76:79], a[152:155], v[48:51], v[76:79]
    ds_read_b128 v[44:47], v13 offset:45056
    s_add_u32 m0, s19, 57344
    v_mfma_f32_16x16x32_bf16 v[80:83], a[156:159], v[48:51], v[80:83]
    s_add_u32 s17, s20, 3698688
    buffer_load_dwordx4 v2, s[4:7], s17 offen lds
    s_waitcnt lgkmcnt(6)
    v_mfma_f32_16x16x32_bf16 v[68:71], a[160:163], v[20:23], v[68:71]
    ds_read_b128 v[48:51], v13 offset:45312
    v_mfma_f32_16x16x32_bf16 v[72:75], a[164:167], v[20:23], v[72:75]
    s_waitcnt lgkmcnt(6)
    v_mfma_f32_16x16x32_bf16 v[76:79], a[160:163], v[24:27], v[76:79]
    ds_read_b128 v[20:23], v12 offset:49152
    s_add_u32 m0, s19, 61440
    v_mfma_f32_16x16x32_bf16 v[80:83], a[164:167], v[24:27], v[80:83]
    s_add_u32 s17, s20, 3962880
    buffer_load_dwordx4 v2, s[4:7], s17 offen lds
    s_waitcnt lgkmcnt(6)
    v_mfma_f32_16x16x32_bf16 v[68:71], a[168:171], v[28:31], v[68:71]
    ds_read_b128 v[24:27], v12 offset:49408
    v_mfma_f32_16x16x32_bf16 v[72:75], a[172:175], v[28:31], v[72:75]
    s_add_u32 s20, s20, s24
    s_waitcnt lgkmcnt(6)
    v_mfma_f32_16x16x32_bf16 v[76:79], a[168:171], v[32:35], v[76:79]
    ds_read_b128 v[28:31], v13 offset:49152
    v_mfma_f32_16x16x32_bf16 v[80:83], a[172:175], v[32:35], v[80:83]
    s_waitcnt lgkmcnt(6)
    v_mfma_f32_16x16x32_bf16 v[68:71], a[176:179], v[36:39], v[68:71]
    ds_read_b128 v[32:35], v13 offset:49408
    v_mfma_f32_16x16x32_bf16 v[72:75], a[180:183], v[36:39], v[72:75]
    s_waitcnt lgkmcnt(6)
    v_mfma_f32_16x16x32_bf16 v[76:79], a[176:179], v[40:43], v[76:79]
    ds_read_b128 v[36:39], v12 offset:53248
    v_mfma_f32_16x16x32_bf16 v[80:83], a[180:183], v[40:43], v[80:83]
    s_waitcnt lgkmcnt(6)
    v_mfma_f32_16x16x32_bf16 v[68:71], a[184:187], v[44:47], v[68:71]
    ds_read_b128 v[40:43], v12 offset:53504
    v_mfma_f32_16x16x32_bf16 v[72:75], a[188:191], v[44:47], v[72:75]
    s_waitcnt lgkmcnt(6)
    v_mfma_f32_16x16x32_bf16 v[76:79], a[184:187], v[48:51], v[76:79]
    ds_read_b128 v[44:47], v13 offset:53248
    v_mfma_f32_16x16x32_bf16 v[80:83], a[188:191], v[48:51], v[80:83]
    s_waitcnt lgkmcnt(6)
    v_mfma_f32_16x16x32_bf16 v[68:71], a[192:195], v[20:23], v[68:71]
    ds_read_b128 v[48:51], v13 offset:53504
    v_mfma_f32_16x16x32_bf16 v[72:75], a[196:199], v[20:23], v[72:75]
    s_waitcnt lgkmcnt(6)
    v_mfma_f32_16x16x32_bf16 v[76:79], a[192:195], v[24:27], v[76:79]
    ds_read_b128 v[20:23], v12 offset:57344
    v_mfma_f32_16x16x32_bf16 v[80:83], a[196:199], v[24:27], v[80:83]
    s_waitcnt lgkmcnt(6)
    v_mfma_f32_16x16x32_bf16 v[68:71], a[200:203], v[28:31], v[68:71]
    ds_read_b128 v[24:27], v12 offset:57600
    v_mfma_f32_16x16x32_bf16 v[72:75], a[204:207], v[28:31], v[72:75]
    s_waitcnt lgkmcnt(6)
    v_mfma_f32_16x16x32_bf16 v[76:79], a[200:203], v[32:35], v[76:79]
    ds_read_b128 v[28:31], v13 offset:57344
    v_mfma_f32_16x16x32_bf16 v[80:83], a[204:207], v[32:35], v[80:83]
    s_waitcnt lgkmcnt(6)
    v_mfma_f32_16x16x32_bf16 v[68:71], a[208:211], v[36:39], v[68:71]
    ds_read_b128 v[32:35], v13 offset:57600
    v_mfma_f32_16x16x32_bf16 v[72:75], a[212:215], v[36:39], v[72:75]
    s_waitcnt lgkmcnt(6)
    v_mfma_f32_16x16x32_bf16 v[76:79], a[208:211], v[40:43], v[76:79]
    ds_read_b128 v[36:39], v12 offset:61440
    v_mfma_f32_16x16x32_bf16 v[80:83], a[212:215], v[40:43], v[80:83]
    s_waitcnt lgkmcnt(6)
    v_mfma_f32_16x16x32_bf16 v[68:71], a[216:219], v[44:47], v[68:71]
    ds_read_b128 v[40:43], v12 offset:61696
    v_mfma_f32_16x16x32_bf16 v[72:75], a[220:223], v[44:47], v[72:75]
    s_waitcnt lgkmcnt(6)
    v_mfma_f32_16x16x32_bf16 v[76:79], a[216:219], v[48:51], v[76:79]
    ds_read_b128 v[44:47], v13 offset:61440
    v_mfma_f32_16x16x32_bf16 v[80:83], a[220:223], v[48:51], v[80:83]
    s_waitcnt lgkmcnt(6)
    v_mfma_f32_16x16x32_bf16 v[68:71], a[224:227], v[20:23], v[68:71]
    ds_read_b128 v[48:51], v13 offset:61696
    v_mfma_f32_16x16x32_bf16 v[72:75], a[228:231], v[20:23], v[72:75]
    s_waitcnt lgkmcnt(6)
    v_mfma_f32_16x16x32_bf16 v[76:79], a[224:227], v[24:27], v[76:79]
    s_waitcnt vmcnt(8)
    s_barrier
    ds_read_b128 v[20:23], v10 offset:0
    v_mfma_f32_16x16x32_bf16 v[80:83], a[228:231], v[24:27], v[80:83]
    s_waitcnt lgkmcnt(6)
    v_mfma_f32_16x16x32_bf16 v[68:71], a[232:235], v[28:31], v[68:71]
    ds_read_b128 v[24:27], v10 offset:256
    s_add_u32 m0, s19, 65536
    v_mfma_f32_16x16x32_bf16 v[72:75], a[236:239], v[28:31], v[72:75]
    s_add_u32 s17, s20, 0
    buffer_load_dwordx4 v2, s[4:7], s17 offen lds
    s_waitcnt lgkmcnt(6)
    v_mfma_f32_16x16x32_bf16 v[76:79], a[232:235], v[32:35], v[76:79]
    ds_read_b128 v[28:31], v11 offset:0
    v_mfma_f32_16x16x32_bf16 v[80:83], a[236:239], v[32:35], v[80:83]
    s_waitcnt lgkmcnt(6)
    v_mfma_f32_16x16x32_bf16 v[68:71], a[240:243], v[36:39], v[68:71]
    ds_read_b128 v[32:35], v11 offset:256
    s_add_u32 m0, s19, 69632
    v_mfma_f32_16x16x32_bf16 v[72:75], a[244:247], v[36:39], v[72:75]
    s_add_u32 s17, s20, 264192
    buffer_load_dwordx4 v2, s[4:7], s17 offen lds
    s_waitcnt lgkmcnt(6)
    v_mfma_f32_16x16x32_bf16 v[76:79], a[240:243], v[40:43], v[76:79]
    ds_read_b128 v[36:39], v10 offset:4096
    v_mfma_f32_16x16x32_bf16 v[80:83], a[244:247], v[40:43], v[80:83]
    s_waitcnt lgkmcnt(6)
    v_mfma_f32_16x16x32_bf16 v[68:71], a[248:251], v[44:47], v[68:71]
    ds_read_b128 v[40:43], v10 offset:4352
    s_add_u32 m0, s19, 73728
    v_mfma_f32_16x16x32_bf16 v[72:75], a[252:255], v[44:47], v[72:75]
    s_add_u32 s17, s20, 528384
    buffer_load_dwordx4 v2, s[4:7], s17 offen lds
    s_waitcnt lgkmcnt(6)
    v_mfma_f32_16x16x32_bf16 v[76:79], a[248:251], v[48:51], v[76:79]
    ds_read_b128 v[44:47], v11 offset:4096
    v_mfma_f32_16x16x32_bf16 v[80:83], a[252:255], v[48:51], v[80:83]
    s_add_u32 s22, s22, 2
    s_cmp_lt_u32 s22, 16
    s_cbranch_scc1 F3_top
    v_cvt_pk_bf16_f32 v84, v68, v69
    v_cvt_pk_bf16_f32 v85, v70, v71
    v_cvt_pk_bf16_f32 v86, v72, v73
    v_cvt_pk_bf16_f32 v87, v74, v75
    v_cvt_pk_bf16_f32 v88, v76, v77
    v_cvt_pk_bf16_f32 v89, v78, v79
    v_cvt_pk_bf16_f32 v90, v80, v81
    v_cvt_pk_bf16_f32 v91, v82, v83
    buffer_store_dwordx4 v[84:87], v3, s[12:15], s21 offen
    buffer_store_dwordx4 v[88:91], v4, s[12:15], s21 offen
    s_waitcnt vmcnt(0) lgkmcnt(0)
    s_branch W_T
W_T:
    v_and_b32 v7, 19, v1
    v_bfe_u32 v5, v1, 2, 1
    v_bfe_u32 v6, v1, 3, 1
    v_lshl_add_u32 v7, v5, 3, v7
    v_lshl_add_u32 v7, v6, 2, v7
    v_lshrrev_b32 v5, 5, v1
    v_and_b32 v6, 31, v1
    v_lshlrev_b32 v8, 4, v5
    v_lshl_add_u32 v10, v6, 6, v8
    v_lshl_add_u32 v11, v7, 6, v8
    v_mov_b32 v17, 1073741824
    v_cmp_gt_u32 vcc, 8, v6
    s_nop 1
    v_cndmask_b32 v12, v17, v10, vcc
    v_lshlrev_b32 v13, 3, v5
    v_lshl_add_u32 v13, v7, 4, v13
    v_and_b32 v14, 15, v1
    v_lshlrev_b32 v14, 4, v14
    v_lshl_add_u32 v14, v5, 8, v14
    v_bfe_u32 v8, v1, 4, 1
    v_lshl_add_u32 v14, v8, 17, v14
    v_lshrrev_b32 v15, 2, v1
    v_and_b32 v8, 3, v1
    v_lshl_add_u32 v15, v15, 7, v8
    s_lshl_b32 s17, s93, 2
    v_add_u32 v15, s17, v15
    v_lshlrev_b32 v15, 7, v15
    v_add_u32 v15, 100663296, v15
    v_cmp_gt_u32 vcc, 16, v1
    s_nop 1
    v_cndmask_b32 v15, v17, v15, vcc
    v_mov_b32 v16, 0
    s_add_u32 s18, s16, s17
    s_lshl_b32 s18, s18, 7
    s_add_u32 s18, s18, 100728832
    v_lshl_add_u32 v4, v1, 2, s18
    v_cmp_gt_u32 vcc, 32, v1
    s_nop 1
    v_cndmask_b32 v4, v17, v4, vcc
    v_lshlrev_b32 v5, 3, v5
    v_sub_u32 v6, v6, v5
    s_mov_b32 s29, 1040356334
    s_mov_b32 s28, s16
    s_mul_i32 s31, s17, 133120
    s_lshl_b32 s18, s28, 11
    s_add_u32 s31, s31, s18
    s_mul_i32 s32, s17, 33280
    s_lshl_b32 s18, s28, 9
    s_add_u32 s32, s32, s18
    s_add_u32 s32, s32, 71303168
    s_lshl_b32 s33, s28, 18
    s_lshl_b32 s18, s93, 12
    s_add_u32 s33, s33, s18
    s_add_u32 s33, s33, 54525952
    v_mov_b32 v17, 0xff800000
    s_mov_b32 s35, 0
    v_mov_b32 v9, 0
    v_cmp_le_i32 s[36:37], 0, v6
    v_cmp_le_i32 s[38:39], 1, v6
    v_cmp_le_i32 s[40:41], 2, v6
    v_cmp_le_i32 s[42:43], 3, v6
    v_cmp_le_i32 s[44:45], 4, v6
    v_cmp_le_i32 s[46:47], 5, v6
    v_cmp_le_i32 s[48:49], 6, v6
    v_cmp_le_i32 s[50:51], 7, v6
    v_cmp_le_i32 s[52:53], 16, v6
    v_cmp_le_i32 s[54:55], 17, v6
    v_cmp_le_i32 s[56:57], 18, v6
    v_cmp_le_i32 s[58:59], 19, v6
    v_cmp_le_i32 s[60:61], 20, v6
    v_cmp_le_i32 s[62:63], 21, v6
    v_cmp_le_i32 s[64:65], 22, v6
    v_cmp_le_i32 s[66:67], 23, v6
    v_mov_b32 v54, 0
    v_mov_b32 v55, 0
    v_mov_b32 v58, 0
    v_mov_b32 v59, 0
    v_mov_b32 v62, 0
    v_mov_b32 v63, 0
    v_mov_b32 v66, 0
    v_mov_b32 v67, 0
    v_mov_b32 v102, 0
    v_mov_b32 v103, 0
    v_mov_b32 v106, 0
    v_mov_b32 v107, 0
    v_mov_b32 v110, 0
    v_mov_b32 v111, 0
    v_mov_b32 v114, 0
    v_mov_b32 v115, 0
    v_mov_b32 v158, 0
    v_mov_b32 v159, 0
    s_mov_b32 s30, s92
T_p:
    v_cmp_ge_u32 vcc, s28, v16
    s_nop 0
    s_and_b32 s17, vcc_lo, 4095
    s_cbranch_scc0 T_pk
    s_cmp_ge_u32 s30, 1048576
    s_cselect_b32 s92, 1048576, s92
    s_cbranch_scc1 T_pk
    s_add_u32 s30, s30, 1
    buffer_load_dword v16, v15, s[4:7], 0 offen sc1
    s_sleep 8
    s_waitcnt vmcnt(0)
    s_branch T_p
T_pk:
    s_add_u32 s17, s31, 0
    buffer_load_dwordx4 a[0:3], v10, s[4:7], s17 offen offset:0
    buffer_load_dwordx4 a[4:7], v10, s[4:7], s17 offen offset:32
    s_add_u32 s17, s31, 133120
    buffer_load_dwordx4 a[8:11], v10, s[4:7], s17 offen offset:0
    buffer_load_dwordx4 a[12:15], v10, s[4:7], s17 offen offset:32
    s_add_u32 s17, s31, 266240
    buffer_load_dwordx4 a[16:19], v10, s[4:7], s17 offen offset:0
    buffer_load_dwordx4 a[20:23], v10, s[4:7], s17 offen offset:32
    s_add_u32 s17, s31, 399360
    buffer_load_dwordx4 a[24:27], v10, s[4:7], s17 offen offset:0
    buffer_load_dwordx4 a[28:31], v10, s[4:7], s17 offen offset:32
    s_add_u32 s17, s31, 17825792
    buffer_load_dwordx4 a[32:35], v11, s[4:7], s17 offen offset:0
    buffer_load_dwordx4 a[36:39], v11, s[4:7], s17 offen offset:32
    s_add_u32 s17, s31, 17958912
    buffer_load_dwordx4 a[40:43], v11, s[4:7], s17 offen offset:0
    buffer_load_dwordx4 a[44:47], v11, s[4:7], s17 offen offset:32
    s_add_u32 s17, s31, 18092032
    buffer_load_dwordx4 a[48:51], v11, s[4:7], s17 offen offset:0
    buffer_load_dwordx4 a[52:55], v11, s[4:7], s17 offen offset:32
    s_add_u32 s17, s31, 18225152
    buffer_load_dwordx4 a[56:59], v11, s[4:7], s17 offen offset:0
    buffer_load_dwordx4 a[60:63], v11, s[4:7], s17 offen offset:32
    s_add_u32 s17, s31, 35651584
    buffer_load_dwordx4 a[64:67], v11, s[4:7], s17 offen offset:0
    buffer_load_dwordx4 a[68:71], v11, s[4:7], s17 offen offset:32
    s_add_u32 s17, s31, 35784704
    buffer_load_dwordx4 a[72:75], v11, s[4:7], s17 offen offset:0
    buffer_load_dwordx4 a[76:79], v11, s[4:7], s17 offen offset:32
    s_add_u32 s17, s31, 35917824
    buffer_load_dwordx4 a[80:83], v11, s[4:7], s17 offen offset:0
    buffer_load_dwordx4 a[84:87], v11, s[4:7], s17 offen offset:32
    s_add_u32 s17, s31, 36050944
    buffer_load_dwordx4 a[88:91], v11, s[4:7], s17 offen offset:0
    buffer_load_dwordx4 a[92:95], v11, s[4:7], s17 offen offset:32
T_top0:
    s_cmp_eq_u32 s35, 0
    s_cbranch_scc1 T_slow0
T_go0:
    s_add_u32 s34, s28, 4
    s_min_u32 s68, s34, 63
    s_waitcnt vmcnt(8)
    v_cmp_ge_u32 vcc, s68, v16
    s_nop 0
    s_and_b32 s17, vcc_lo, 0xfff
    s_cbranch_scc1 T_pw0
T_pok0:
    s_add_u32 s31, s31, 8192
    s_add_u32 s32, s32, 2048
    s_and_b32 s17, vcc_lo, 61440
    s_cselect_b32 s35, 0, 1
    s_cselect_b32 s69, 1073741824, s32
    s_cmp_lt_u32 s34, 64
    s_cselect_b32 s68, s31, 1073741824
    s_cselect_b32 s69, s69, 1073741824
    buffer_load_dword v16, v15, s[4:7], 0 offen sc1
    v_mfma_f32_32x32x16_bf16 v[116:131], a[32:35], a[0:3], 0
    s_add_u32 s17, s68, 0
    buffer_load_dwordx4 a[96:99], v10, s[4:7], s17 offen offset:0
    buffer_load_dwordx4 a[100:103], v10, s[4:7], s17 offen offset:32
    v_mfma_f32_32x32x16_bf16 v[116:131], a[36:39], a[4:7], v[116:131]
    s_add_u32 s17, s68, 133120
    buffer_load_dwordx4 a[104:107], v10, s[4:7], s17 offen offset:0
    buffer_load_dwordx4 a[108:111], v10, s[4:7], s17 offen offset:32
    v_mfma_f32_32x32x16_bf16 v[116:131], a[40:43], a[8:11], v[116:131]
    s_add_u32 s17, s68, 266240
    buffer_load_dwordx4 a[112:115], v10, s[4:7], s17 offen offset:0
    buffer_load_dwordx4 a[116:119], v10, s[4:7], s17 offen offset:32
    v_mfma_f32_32x32x16_bf16 v[116:131], a[44:47], a[12:15], v[116:131]
    s_add_u32 s17, s68, 399360
    buffer_load_dwordx4 a[120:123], v10, s[4:7], s17 offen offset:0
    buffer_load_dwordx4 a[124:127], v10, s[4:7], s17 offen offset:32
    v_mfma_f32_32x32x16_bf16 v[116:131], a[48:51], a[16:19], v[116:131]
    s_add_u32 s17, s68, 17825792
    buffer_load_dwordx4 a[128:131], v11, s[4:7], s17 offen offset:0
    buffer_load_dwordx4 a[132:135], v11, s[4:7], s17 offen offset:32
    v_mfma_f32_32x32x16_bf16 v[116:131], a[52:55], a[20:23], v[116:131]
    s_add_u32 s17, s68, 17958912
    buffer_load_dwordx4 a[136:139], v11, s[4:7], s17 offen offset:0
    buffer_load_dwordx4 a[140:143], v11, s[4:7], s17 offen offset:32
    v_mfma_f32_32x32x16_bf16 v[116:131], a[56:59], a[24:27], v[116:131]
    s_add_u32 s17, s68, 18092032
    buffer_load_dwordx4 a[144:147], v11, s[4:7], s17 offen offset:0
    buffer_load_dwordx4 a[148:151], v11, s[4:7], s17 offen offset:32
    v_mfma_f32_32x32x16_bf16 v[116:131], a[60:63], a[28:31], v[116:131]
    s_add_u32 s17, s68, 18225152
    buffer_load_dwordx4 a[152:155], v11, s[4:7], s17 offen offset:0
    buffer_load_dwordx4 a[156:159], v11, s[4:7], s17 offen offset:32
    v_mfma_f32_32x32x16_bf16 v[132:147], v[20:23], a[0:3], 0
    s_add_u32 s17, s68, 35651584
    buffer_load_dwordx4 a[160:163], v11, s[4:7], s17 offen offset:0
    buffer_load_dwordx4 a[164:167], v11, s[4:7], s17 offen offset:32
    v_mfma_f32_32x32x16_bf16 v[132:147], v[24:27], a[4:7], v[132:147]
    s_add_u32 s17, s68, 35784704
    buffer_load_dwordx4 a[168:171], v11, s[4:7], s17 offen offset:0
    buffer_load_dwordx4 a[172:175], v11, s[4:7], s17 offen offset:32
    v_mfma_f32_32x32x16_bf16 v[132:147], v[28:31], a[8:11], v[132:147]
    s_add_u32 s17, s68, 35917824
    buffer_load_dwordx4 a[176:179], v11, s[4:7], s17 offen offset:0
    buffer_load_dwordx4 a[180:183], v11, s[4:7], s17 offen offset:32
    v_mfma_f32_32x32x16_bf16 v[132:147], v[32:35], a[12:15], v[132:147]
    s_add_u32 s17, s68, 36050944
    buffer_load_dwordx4 a[184:187], v11, s[4:7], s17 offen offset:0
    buffer_load_dwordx4 a[188:191], v11, s[4:7], s17 offen offset:32
    v_mfma_f32_32x32x16_bf16 v[132:147], v[36:39], a[16:19], v[132:147]
    s_add_u32 s17, s69, 0
    s_add_u32 s18, s69, 5242880
    buffer_load_dwordx4 v[68:71], v12, s[4:7], s17 offen offset:0
    buffer_load_dwordx4 v[72:75], v12, s[4:7], s17 offen offset:32
    buffer_load_dwordx2 v[100:101], v13, s[4:7], s18 offen
    v_mfma_f32_32x32x16_bf16 v[132:147], v[40:43], a[20:23], v[132:147]
    s_add_u32 s17, s69, 33280
    s_add_u32 s18, s69, 5276160
    buffer_load_dwordx4 v[76:79], v12, s[4:7], s17 offen offset:0
    buffer_load_dwordx4 v[80:83], v12, s[4:7], s17 offen offset:32
    buffer_load_dwordx2 v[104:105], v13, s[4:7], s18 offen
    v_mfma_f32_32x32x16_bf16 v[132:147], v[44:47], a[24:27], v[132:147]
    s_add_u32 s17, s69, 66560
    s_add_u32 s18, s69, 5309440
    buffer_load_dwordx4 v[84:87], v12, s[4:7], s17 offen offset:0
    buffer_load_dwordx4 v[88:91], v12, s[4:7], s17 offen offset:32
    buffer_load_dwordx2 v[108:109], v13, s[4:7], s18 offen
    v_mfma_f32_32x32x16_bf16 v[132:147], v[48:51], a[28:31], v[132:147]
    s_add_u32 s17, s69, 99840
    s_add_u32 s18, s69, 5342720
    buffer_load_dwordx4 v[92:95], v12, s[4:7], s17 offen offset:0
    buffer_load_dwordx4 v[96:99], v12, s[4:7], s17 offen offset:32
    buffer_load_dwordx2 v[112:113], v13, s[4:7], s18 offen
    v_cndmask_b32 v116, v17, v116, s[36:37]
    v_cndmask_b32 v117, v17, v117, s[38:39]
    v_cndmask_b32 v118, v17, v118, s[40:41]
    v_cndmask_b32 v119, v17, v119, s[42:43]
    v_cndmask_b32 v120, v17, v120, s[44:45]
    v_cndmask_b32 v121, v17, v121, s[46:47]
    v_cndmask_b32 v122, v17, v122, s[48:49]
    v_cndmask_b32 v123, v17, v123, s[50:51]
    v_cndmask_b32 v124, v17, v124, s[52:53]
    v_cndmask_b32 v125, v17, v125, s[54:55]
    v_cndmask_b32 v126, v17, v126, s[56:57]
    v_cndmask_b32 v127, v17, v127, s[58:59]
    v_cndmask_b32 v128, v17, v128, s[60:61]
    v_cndmask_b32 v129, v17, v129, s[62:63]
    v_cndmask_b32 v130, v17, v130, s[64:65]
    v_cndmask_b32 v131, v17, v131, s[66:67]
    v_max3_f32 v18, v116, v117, v118
    v_max3_f32 v18, v18, v119, v120
    v_max3_f32 v18, v18, v121, v122
    v_max3_f32 v18, v18, v123, v124
    v_max3_f32 v18, v18, v125, v126
    v_max3_f32 v18, v18, v127, v128
    v_max3_f32 v18, v18, v129, v130
    v_max3_f32 v18, v18, v131, v132
    v_max3_f32 v18, v18, v133, v134
    v_max_f32 v18, v18, v135
    v_mov_b32 v5, v18
    s_nop 1
    v_permlane32_swap_b32 v18, v5
    v_max_f32 v18, v18, v5
    v_mul_f32 v18, s29, v18
    v_fma_f32 v116, v116, s29, -v18
    v_fma_f32 v117, v117, s29, -v18
    v_fma_f32 v118, v118, s29, -v18
    v_fma_f32 v119, v119, s29, -v18
    v_fma_f32 v120, v120, s29, -v18
    v_fma_f32 v121, v121, s29, -v18
    v_fma_f32 v122, v122, s29, -v18
    v_fma_f32 v123, v123, s29, -v18
    v_fma_f32 v124, v124, s29, -v18
    v_fma_f32 v125, v125, s29, -v18
    v_fma_f32 v126, v126, s29, -v18
    v_fma_f32 v127, v127, s29, -v18
    v_fma_f32 v128, v128, s29, -v18
    v_fma_f32 v129, v129, s29, -v18
    v_fma_f32 v130, v130, s29, -v18
    v_fma_f32 v131, v131, s29, -v18
    v_fma_f32 v132, v132, s29, -v18
    v_fma_f32 v133, v133, s29, -v18
    v_fma_f32 v134, v134, s29, -v18
    v_fma_f32 v135, v135, s29, -v18
    v_exp_f32 v116, v116
    v_exp_f32 v117, v117
    v_exp_f32 v118, v118
    v_exp_f32 v119, v119
    v_exp_f32 v120, v120
    v_exp_f32 v121, v121
    v_exp_f32 v122, v122
    v_exp_f32 v123, v123
    v_exp_f32 v124, v124
    v_exp_f32 v125, v125
    v_exp_f32 v126, v126
    v_exp_f32 v127, v127
    v_exp_f32 v128, v128
    v_exp_f32 v129, v129
    v_exp_f32 v130, v130
    v_exp_f32 v131, v131
    v_exp_f32 v132, v132
    v_exp_f32 v133, v133
    v_exp_f32 v134, v134
    v_exp_f32 v135, v135
    s_waitcnt vmcnt(37)
    buffer_store_dword v9, v4, s[4:7], 0 offen sc1
    v_add_f32 v19, v116, v117
    v_add_f32 v6, v118, v119
    v_add_f32 v19, v19, v120
    v_add_f32 v6, v6, v121
    v_add_f32 v19, v19, v122
    v_add_f32 v6, v6, v123
    v_add_f32 v19, v19, v124
    v_add_f32 v6, v6, v125
    v_add_f32 v19, v19, v126
    v_add_f32 v6, v6, v127
    v_add_f32 v19, v19, v128
    v_add_f32 v6, v6, v129
    v_add_f32 v19, v19, v130
    v_add_f32 v6, v6, v131
    v_add_f32 v19, v19, v132
    v_add_f32 v6, v6, v133
    v_add_f32 v19, v19, v134
    v_add_f32 v6, v6, v135
    v_add_f32 v19, v19, v6
    v_mov_b32 v5, v19
    s_nop 1
    v_permlane32_swap_b32 v19, v5
    v_add_f32 v19, v19, v5
    v_rcp_f32 v19, v19
    s_nop 0
    v_mul_f32 v116, v116, v19
    v_mul_f32 v117, v117, v19
    v_mul_f32 v118, v118, v19
    v_mul_f32 v119, v119, v19
    v_mul_f32 v120, v120, v19
    v_mul_f32 v121, v121, v19
    v_mul_f32 v122, v122, v19
    v_mul_f32 v123, v123, v19
    v_mul_f32 v124, v124, v19
    v_mul_f32 v125, v125, v19
    v_mul_f32 v126, v126, v19
    v_mul_f32 v127, v127, v19
    v_mul_f32 v128, v128, v19
    v_mul_f32 v129, v129, v19
    v_mul_f32 v130, v130, v19
    v_mul_f32 v131, v131, v19
    v_mul_f32 v132, v132, v19
    v_mul_f32 v133, v133, v19
    v_mul_f32 v134, v134, v19
    v_mul_f32 v135, v135, v19
    v_cvt_pk_bf16_f32 v148, v116, v117
    v_cvt_pk_bf16_f32 v149, v118, v119
    v_cvt_pk_bf16_f32 v150, v120, v121
    v_cvt_pk_bf16_f32 v151, v122, v123
    v_cvt_pk_bf16_f32 v152, v124, v125
    v_cvt_pk_bf16_f32 v153, v126, v127
    v_cvt_pk_bf16_f32 v154, v128, v129
    v_cvt_pk_bf16_f32 v155, v130, v131
    v_cvt_pk_bf16_f32 v156, v132, v133
    v_cvt_pk_bf16_f32 v157, v134, v135
    v_mfma_f32_32x32x16_bf16 v[160:175], a[64:67], v[148:151], 0
    v_mfma_f32_32x32x16_bf16 v[160:175], a[68:71], v[152:155], v[160:175]
    v_mfma_f32_32x32x16_bf16 v[160:175], v[52:55], v[156:159], v[160:175]
    v_mfma_f32_32x32x16_bf16 v[176:191], a[72:75], v[148:151], 0
    v_mfma_f32_32x32x16_bf16 v[176:191], a[76:79], v[152:155], v[176:191]
    v_mfma_f32_32x32x16_bf16 v[176:191], v[56:59], v[156:159], v[176:191]
    s_nop 2
    v_cvt_pk_bf16_f32 v224, v160, v161
    v_cvt_pk_bf16_f32 v225, v162, v163
    v_cvt_pk_bf16_f32 v226, v164, v165
    v_cvt_pk_bf16_f32 v227, v166, v167
    v_cvt_pk_bf16_f32 v228, v168, v169
    v_cvt_pk_bf16_f32 v229, v170, v171
    v_cvt_pk_bf16_f32 v230, v172, v173
    v_cvt_pk_bf16_f32 v231, v174, v175
    buffer_store_dwordx4 v[224:227], v14, s[4:7], s33 offen offset:0 sc1
    buffer_store_dwordx4 v[228:231], v14, s[4:7], s33 offen offset:512 sc1
    v_mfma_f32_32x32x16_bf16 v[192:207], a[80:83], v[148:151], 0
    v_mfma_f32_32x32x16_bf16 v[192:207], a[84:87], v[152:155], v[192:207]
    v_mfma_f32_32x32x16_bf16 v[192:207], v[60:63], v[156:159], v[192:207]
    v_cvt_pk_bf16_f32 v232, v176, v177
    v_cvt_pk_bf16_f32 v233, v178, v179
    v_cvt_pk_bf16_f32 v234, v180, v181
    v_cvt_pk_bf16_f32 v235, v182, v183
    v_cvt_pk_bf16_f32 v236, v184, v185
    v_cvt_pk_bf16_f32 v237, v186, v187
    v_cvt_pk_bf16_f32 v238, v188, v189
    v_cvt_pk_bf16_f32 v239, v190, v191
    buffer_store_dwordx4 v[232:235], v14, s[4:7], s33 offen offset:1024 sc1
    buffer_store_dwordx4 v[236:239], v14, s[4:7], s33 offen offset:1536 sc1
    v_mfma_f32_32x32x16_bf16 v[208:223], a[88:91], v[148:151], 0
    v_mfma_f32_32x32x16_bf16 v[208:223], a[92:95], v[152:155], v[208:223]
    v_mfma_f32_32x32x16_bf16 v[208:223], v[64:67], v[156:159], v[208:223]
    v_cvt_pk_bf16_f32 v240, v192, v193
    v_cvt_pk_bf16_f32 v241, v194, v195
    v_cvt_pk_bf16_f32 v242, v196, v197
    v_cvt_pk_bf16_f32 v243, v198, v199
    v_cvt_pk_bf16_f32 v244, v200, v201
    v_cvt_pk_bf16_f32 v245, v202, v203
    v_cvt_pk_bf16_f32 v246, v204, v205
    v_cvt_pk_bf16_f32 v247, v206, v207
    buffer_store_dwordx4 v[240:243], v14, s[4:7], s33 offen offset:2048 sc1
    buffer_store_dwordx4 v[244:247], v14, s[4:7], s33 offen offset:2560 sc1
    v_add_u32 v9, 1, v9
    s_nop 0
    v_cvt_pk_bf16_f32 v248, v208, v209
    v_cvt_pk_bf16_f32 v249, v210, v211
    v_cvt_pk_bf16_f32 v250, v212, v213
    v_cvt_pk_bf16_f32 v251, v214, v215
    v_cvt_pk_bf16_f32 v252, v216, v217
    v_cvt_pk_bf16_f32 v253, v218, v219
    v_cvt_pk_bf16_f32 v254, v220, v221
    v_cvt_pk_bf16_f32 v255, v222, v223
    buffer_store_dwordx4 v[248:251], v14, s[4:7], s33 offen offset:3072 sc1
    buffer_store_dwordx4 v[252:255], v14, s[4:7], s33 offen offset:3584 sc1
    s_mov_b32 s28, s34
    s_add_u32 s33, s33, 1048576
T_top1:
    s_cmp_eq_u32 s35, 0
    s_cbranch_scc1 T_slow1
T_go1:
    s_add_u32 s34, s28, 4
    s_min_u32 s68, s34, 63
    s_waitcnt vmcnt(8)
    v_cmp_ge_u32 vcc, s68, v16
    s_nop 0
    s_and_b32 s17, vcc_lo, 0xfff
    s_cbranch_scc1 T_pw1
T_pok1:
    s_add_u32 s31, s31, 8192
    s_add_u32 s32, s32, 2048
    s_and_b32 s17, vcc_lo, 61440
    s_cselect_b32 s35, 0, 1
    s_cselect_b32 s69, 1073741824, s32
    s_cmp_lt_u32 s34, 64
    s_cselect_b32 s68, s31, 1073741824
    s_cselect_b32 s69, s69, 1073741824
    buffer_load_dword v16, v15, s[4:7], 0 offen sc1
    v_mfma_f32_32x32x16_bf16 v[116:131], a[128:131], a[96:99], 0
    s_add_u32 s17, s68, 0
    buffer_load_dwordx4 a[0:3], v10, s[4:7], s17 offen offset:0
    buffer_load_dwordx4 a[4:7], v10, s[4:7], s17 offen offset:32
    v_mfma_f32_32x32x16_bf16 v[116:131], a[132:135], a[100:103], v[116:131]
    s_add_u32 s17, s68, 133120
    buffer_load_dwordx4 a[8:11], v10, s[4:7], s17 offen offset:0
    buffer_load_dwordx4 a[12:15], v10, s[4:7], s17 offen offset:32
    v_mfma_f32_32x32x16_bf16 v[116:131], a[136:139], a[104:107], v[116:131]
    s_add_u32 s17, s68, 266240
    buffer_load_dwordx4 a[16:19], v10, s[4:7], s17 offen offset:0
    buffer_load_dwordx4 a[20:23], v10, s[4:7], s17 offen offset:32
    v_mfma_f32_32x32x16_bf16 v[116:131], a[140:143], a[108:111], v[116:131]
    s_add_u32 s17, s68, 399360
    buffer_load_dwordx4 a[24:27], v10, s[4:7], s17 offen offset:0
    buffer_load_dwordx4 a[28:31], v10, s[4:7], s17 offen offset:32
    v_mfma_f32_32x32x16_bf16 v[116:131], a[144:147], a[112:115], v[116:131]
    s_add_u32 s17, s68, 17825792
    buffer_load_dwordx4 a[32:35], v11, s[4:7], s17 offen offset:0
    buffer_load_dwordx4 a[36:39], v11, s[4:7], s17 offen offset:32
    v_mfma_f32_32x32x16_bf16 v[116:131], a[148:151], a[116:119], v[116:131]
    s_add_u32 s17, s68, 17958912
    buffer_load_dwordx4 a[40:43], v11, s[4:7], s17 offen offset:0
    buffer_load_dwordx4 a[44:47], v11, s[4:7], s17 offen offset:32
    v_mfma_f32_32x32x16_bf16 v[116:131], a[152:155], a[120:123], v[116:131]
    s_add_u32 s17, s68, 18092032
    buffer_load_dwordx4 a[48:51], v11, s[4:7], s17 offen offset:0
    buffer_load_dwordx4 a[52:55], v11, s[4:7], s17 offen offset:32
    v_mfma_f32_32x32x16_bf16 v[116:131], a[156:159], a[124:127], v[116:131]
    s_add_u32 s17, s68, 18225152
    buffer_load_dwordx4 a[56:59], v11, s[4:7], s17 offen offset:0
    buffer_load_dwordx4 a[60:63], v11, s[4:7], s17 offen offset:32
    v_mfma_f32_32x32x16_bf16 v[132:147], v[68:71], a[96:99], 0
    s_add_u32 s17, s68, 35651584
    buffer_load_dwordx4 a[64:67], v11, s[4:7], s17 offen offset:0
    buffer_load_dwordx4 a[68:71], v11, s[4:7], s17 offen offset:32
    v_mfma_f32_32x32x16_bf16 v[132:147], v[72:75], a[100:103], v[132:147]
    s_add_u32 s17, s68, 35784704
    buffer_load_dwordx4 a[72:75], v11, s[4:7], s17 offen offset:0
    buffer_load_dwordx4 a[76:79], v11, s[4:7], s17 offen offset:32
    v_mfma_f32_32x32x16_bf16 v[132:147], v[76:79], a[104:107], v[132:147]
    s_add_u32 s17, s68, 35917824
    buffer_load_dwordx4 a[80:83], v11, s[4:7], s17 offen offset:0
    buffer_load_dwordx4 a[84:87], v11, s[4:7], s17 offen offset:32
    v_mfma_f32_32x32x16_bf16 v[132:147], v[80:83], a[108:111], v[132:147]
    s_add_u32 s17, s68, 36050944
    buffer_load_dwordx4 a[88:91], v11, s[4:7], s17 offen offset:0
    buffer_load_dwordx4 a[92:95], v11, s[4:7], s17 offen offset:32
    v_mfma_f32_32x32x16_bf16 v[132:147], v[84:87], a[112:115], v[132:147]
    s_add_u32 s17, s69, 0
    s_add_u32 s18, s69, 5242880
    buffer_load_dwordx4 v[20:23], v12, s[4:7], s17 offen offset:0
    buffer_load_dwordx4 v[24:27], v12, s[4:7], s17 offen offset:32
    buffer_load_dwordx2 v[52:53], v13, s[4:7], s18 offen
    v_mfma_f32_32x32x16_bf16 v[132:147], v[88:91], a[116:119], v[132:147]
    s_add_u32 s17, s69, 33280
    s_add_u32 s18, s69, 5276160
    buffer_load_dwordx4 v[28:31], v12, s[4:7], s17 offen offset:0
    buffer_load_dwordx4 v[32:35], v12, s[4:7], s17 offen offset:32
    buffer_load_dwordx2 v[56:57], v13, s[4:7], s18 offen
    v_mfma_f32_32x32x16_bf16 v[132:147], v[92:95], a[120:123], v[132:147]
    s_add_u32 s17, s69, 66560
    s_add_u32 s18, s69, 5309440
    buffer_load_dwordx4 v[36:39], v12, s[4:7], s17 offen offset:0
    buffer_load_dwordx4 v[40:43], v12, s[4:7], s17 offen offset:32
    buffer_load_dwordx2 v[60:61], v13, s[4:7], s18 offen
    v_mfma_f32_32x32x16_bf16 v[132:147], v[96:99], a[124:127], v[132:147]
    s_add_u32 s17, s69, 99840
    s_add_u32 s18, s69, 5342720
    buffer_load_dwordx4 v[44:47], v12, s[4:7], s17 offen offset:0
    buffer_load_dwordx4 v[48:51], v12, s[4:7], s17 offen offset:32
    buffer_load_dwordx2 v[64:65], v13, s[4:7], s18 offen
    v_cndmask_b32 v116, v17, v116, s[36:37]
    v_cndmask_b32 v117, v17, v117, s[38:39]
    v_cndmask_b32 v118, v17, v118, s[40:41]
    v_cndmask_b32 v119, v17, v119, s[42:43]
    v_cndmask_b32 v120, v17, v120, s[44:45]
    v_cndmask_b32 v121, v17, v121, s[46:47]
    v_cndmask_b32 v122, v17, v122, s[48:49]
    v_cndmask_b32 v123, v17, v123, s[50:51]
    v_cndmask_b32 v124, v17, v124, s[52:53]
    v_cndmask_b32 v125, v17, v125, s[54:55]
    v_cndmask_b32 v126, v17, v126, s[56:57]
    v_cndmask_b32 v127, v17, v127, s[58:59]
    v_cndmask_b32 v128, v17, v128, s[60:61]
    v_cndmask_b32 v129, v17, v129, s[62:63]
    v_cndmask_b32 v130, v17, v130, s[64:65]
    v_cndmask_b32 v131, v17, v131, s[66:67]
    v_max3_f32 v18, v116, v117, v118
    v_max3_f32 v18, v18, v119, v120
    v_max3_f32 v18, v18, v121, v122
    v_max3_f32 v18, v18, v123, v124
    v_max3_f32 v18, v18, v125, v126
    v_max3_f32 v18, v18, v127, v128
    v_max3_f32 v18, v18, v129, v130
    v_max3_f32 v18, v18, v131, v132
    v_max3_f32 v18, v18, v133, v134
    v_max_f32 v18, v18, v135
    v_mov_b32 v5, v18
    s_nop 1
    v_permlane32_swap_b32 v18, v5
    v_max_f32 v18, v18, v5
    v_mul_f32 v18, s29, v18
    v_fma_f32 v116, v116, s29, -v18
    v_fma_f32 v117, v117, s29, -v18
    v_fma_f32 v118, v118, s29, -v18
    v_fma_f32 v119, v119, s29, -v18
    v_fma_f32 v120, v120, s29, -v18
    v_fma_f32 v121, v121, s29, -v18
    v_fma_f32 v122, v122, s29, -v18
    v_fma_f32 v123, v123, s29, -v18
    v_fma_f32 v124, v124, s29, -v18
    v_fma_f32 v125, v125, s29, -v18
    v_fma_f32 v126, v126, s29, -v18
    v_fma_f32 v127, v127, s29, -v18
    v_fma_f32 v128, v128, s29, -v18
    v_fma_f32 v129, v129, s29, -v18
    v_fma_f32 v130, v130, s29, -v18
    v_fma_f32 v131, v131, s29, -v18
    v_fma_f32 v132, v132, s29, -v18
    v_fma_f32 v133, v133, s29, -v18
    v_fma_f32 v134, v134, s29, -v18
    v_fma_f32 v135, v135, s29, -v18
    v_exp_f32 v116, v116
    v_exp_f32 v117, v117
    v_exp_f32 v118, v118
    v_exp_f32 v119, v119
    v_exp_f32 v120, v120
    v_exp_f32 v121, v121
    v_exp_f32 v122, v122
    v_exp_f32 v123, v123
    v_exp_f32 v124, v124
    v_exp_f32 v125, v125
    v_exp_f32 v126, v126
    v_exp_f32 v127, v127
    v_exp_f32 v128, v128
    v_exp_f32 v129, v129
    v_exp_f32 v130, v130
    v_exp_f32 v131, v131
    v_exp_f32 v132, v132
    v_exp_f32 v133, v133
    v_exp_f32 v134, v134
    v_exp_f32 v135, v135
    s_waitcnt vmcnt(37)
    buffer_store_dword v9, v4, s[4:7], 0 offen sc1
    v_add_f32 v19, v116, v117
    v_add_f32 v6, v118, v119
    v_add_f32 v19, v19, v120
    v_add_f32 v6, v6, v121
    v_add_f32 v19, v19, v122
    v_add_f32 v6, v6, v123
    v_add_f32 v19, v19, v124
    v_add_f32 v6, v6, v125
    v_add_f32 v19, v19, v126
    v_add_f32 v6, v6, v127
    v_add_f32 v19, v19, v128
    v_add_f32 v6, v6, v129
    v_add_f32 v19, v19, v130
    v_add_f32 v6, v6, v131
    v_add_f32 v19, v19, v132
    v_add_f32 v6, v6, v133
    v_add_f32 v19, v19, v134
    v_add_f32 v6, v6, v135
    v_add_f32 v19, v19, v6
    v_mov_b32 v5, v19
    s_nop 1
    v_permlane32_swap_b32 v19, v5
    v_add_f32 v19, v19, v5
    v_rcp_f32 v19, v19
    s_nop 0
    v_mul_f32 v116, v116, v19
    v_mul_f32 v117, v117, v19
    v_mul_f32 v118, v118, v19
    v_mul_f32 v119, v119, v19
    v_mul_f32 v120, v120, v19
    v_mul_f32 v121, v121, v19
    v_mul_f32 v122, v122, v19
    v_mul_f32 v123, v123, v19
    v_mul_f32 v124, v124, v19
    v_mul_f32 v125, v125, v19
    v_mul_f32 v126, v126, v19
    v_mul_f32 v127, v127, v19
    v_mul_f32 v128, v128, v19
    v_mul_f32 v129, v129, v19
    v_mul_f32 v130, v130, v19
    v_mul_f32 v131, v131, v19
    v_mul_f32 v132, v132, v19
    v_mul_f32 v133, v133, v19
    v_mul_f32 v134, v134, v19
    v_mul_f32 v135, v135, v19
    v_cvt_pk_bf16_f32 v148, v116, v117
    v_cvt_pk_bf16_f32 v149, v118, v119
    v_cvt_pk_bf16_f32 v150, v120, v121
    v_cvt_pk_bf16_f32 v151, v122, v123
    v_cvt_pk_bf16_f32 v152, v124, v125
    v_cvt_pk_bf16_f32 v153, v126, v127
    v_cvt_pk_bf16_f32 v154, v128, v129
    v_cvt_pk_bf16_f32 v155, v130, v131
    v_cvt_pk_bf16_f32 v156, v132, v133
    v_cvt_pk_bf16_f32 v157, v134, v135
    v_mfma_f32_32x32x16_bf16 v[160:175], a[160:163], v[148:151], 0
    v_mfma_f32_32x32x16_bf16 v[160:175], a[164:167], v[152:155], v[160:175]
    v_mfma_f32_32x32x16_bf16 v[160:175], v[100:103], v[156:159], v[160:175]
    v_mfma_f32_32x32x16_bf16 v[176:191], a[168:171], v[148:151], 0
    v_mfma_f32_32x32x16_bf16 v[176:191], a[172:175], v[152:155], v[176:191]
    v_mfma_f32_32x32x16_bf16 v[176:191], v[104:107], v[156:159], v[176:191]
    s_nop 2
    v_cvt_pk_bf16_f32 v224, v160, v161
    v_cvt_pk_bf16_f32 v225, v162, v163
    v_cvt_pk_bf16_f32 v226, v164, v165
    v_cvt_pk_bf16_f32 v227, v166, v167
    v_cvt_pk_bf16_f32 v228, v168, v169
    v_cvt_pk_bf16_f32 v229, v170, v171
    v_cvt_pk_bf16_f32 v230, v172, v173
    v_cvt_pk_bf16_f32 v231, v174, v175
    buffer_store_dwordx4 v[224:227], v14, s[4:7], s33 offen offset:0 sc1
    buffer_store_dwordx4 v[228:231], v14, s[4:7], s33 offen offset:512 sc1
    v_mfma_f32_32x32x16_bf16 v[192:207], a[176:179], v[148:151], 0
    v_mfma_f32_32x32x16_bf16 v[192:207], a[180:183], v[152:155], v[192:207]
    v_mfma_f32_32x32x16_bf16 v[192:207], v[108:111], v[156:159], v[192:207]
    v_cvt_pk_bf16_f32 v232, v176, v177
    v_cvt_pk_bf16_f32 v233, v178, v179
    v_cvt_pk_bf16_f32 v234, v180, v181
    v_cvt_pk_bf16_f32 v235, v182, v183
    v_cvt_pk_bf16_f32 v236, v184, v185
    v_cvt_pk_bf16_f32 v237, v186, v187
    v_cvt_pk_bf16_f32 v238, v188, v189
    v_cvt_pk_bf16_f32 v239, v190, v191
    buffer_store_dwordx4 v[232:235], v14, s[4:7], s33 offen offset:1024 sc1
    buffer_store_dwordx4 v[236:239], v14, s[4:7], s33 offen offset:1536 sc1
    v_mfma_f32_32x32x16_bf16 v[208:223], a[184:187], v[148:151], 0
    v_mfma_f32_32x32x16_bf16 v[208:223], a[188:191], v[152:155], v[208:223]
    v_mfma_f32_32x32x16_bf16 v[208:223], v[112:115], v[156:159], v[208:223]
    v_cvt_pk_bf16_f32 v240, v192, v193
    v_cvt_pk_bf16_f32 v241, v194, v195
    v_cvt_pk_bf16_f32 v242, v196, v197
    v_cvt_pk_bf16_f32 v243, v198, v199
    v_cvt_pk_bf16_f32 v244, v200, v201
    v_cvt_pk_bf16_f32 v245, v202, v203
    v_cvt_pk_bf16_f32 v246, v204, v205
    v_cvt_pk_bf16_f32 v247, v206, v207
    buffer_store_dwordx4 v[240:243], v14, s[4:7], s33 offen offset:2048 sc1
    buffer_store_dwordx4 v[244:247], v14, s[4:7], s33 offen offset:2560 sc1
    v_add_u32 v9, 1, v9
    s_nop 0
    v_cvt_pk_bf16_f32 v248, v208, v209
    v_cvt_pk_bf16_f32 v249, v210, v211
    v_cvt_pk_bf16_f32 v250, v212, v213
    v_cvt_pk_bf16_f32 v251, v214, v215
    v_cvt_pk_bf16_f32 v252, v216, v217
    v_cvt_pk_bf16_f32 v253, v218, v219
    v_cvt_pk_bf16_f32 v254, v220, v221
    v_cvt_pk_bf16_f32 v255, v222, v223
    buffer_store_dwordx4 v[248:251], v14, s[4:7], s33 offen offset:3072 sc1
    buffer_store_dwordx4 v[252:255], v14, s[4:7], s33 offen offset:3584 sc1
    s_mov_b32 s28, s34
    s_add_u32 s33, s33, 1048576
    s_cmp_lt_u32 s28, 64
    s_cbranch_scc1 T_top0
T_fin:
    s_waitcnt vmcnt(0)
    buffer_store_dword v9, v4, s[4:7], 0 offen sc1
    s_branch W_fin
T_slow0:
    s_waitcnt vmcnt(0)
    buffer_store_dword v9, v4, s[4:7], 0 offen sc1
    s_mov_b32 s30, s92
T_s0:
    v_cmp_ge_u32 vcc, s28, v16
    s_nop 0
    s_and_b32 s17, vcc_lo, 61440
    s_cbranch_scc0 T_sk0
    s_cmp_ge_u32 s30, 1048576
    s_cselect_b32 s92, 1048576, s92
    s_cbranch_scc1 T_sk0
    s_add_u32 s30, s30, 1
    buffer_load_dword v16, v15, s[4:7], 0 offen sc1
    s_sleep 2
    s_waitcnt vmcnt(0)
    s_branch T_s0
T_sk0:
    s_add_u32 s17, s32, 0
    s_add_u32 s18, s32, 5242880
    buffer_load_dwordx4 v[20:23], v12, s[4:7], s17 offen offset:0
    buffer_load_dwordx4 v[24:27], v12, s[4:7], s17 offen offset:32
    buffer_load_dwordx2 v[52:53], v13, s[4:7], s18 offen
    s_add_u32 s17, s32, 33280
    s_add_u32 s18, s32, 5276160
    buffer_load_dwordx4 v[28:31], v12, s[4:7], s17 offen offset:0
    buffer_load_dwordx4 v[32:35], v12, s[4:7], s17 offen offset:32
    buffer_load_dwordx2 v[56:57], v13, s[4:7], s18 offen
    s_add_u32 s17, s32, 66560
    s_add_u32 s18, s32, 5309440
    buffer_load_dwordx4 v[36:39], v12, s[4:7], s17 offen offset:0
    buffer_load_dwordx4 v[40:43], v12, s[4:7], s17 offen offset:32
    buffer_load_dwordx2 v[60:61], v13, s[4:7], s18 offen
    s_add_u32 s17, s32, 99840
    s_add_u32 s18, s32, 5342720
    buffer_load_dwordx4 v[44:47], v12, s[4:7], s17 offen offset:0
    buffer_load_dwordx4 v[48:51], v12, s[4:7], s17 offen offset:32
    buffer_load_dwordx2 v[64:65], v13, s[4:7], s18 offen
    s_waitcnt vmcnt(0)
    s_branch T_go0
T_pw0:
    s_mov_b32 s30, s92
T_q0:
    v_cmp_ge_u32 vcc, s68, v16
    s_nop 0
    s_and_b32 s17, vcc_lo, 4095
    s_cbranch_scc0 T_pok0
    s_cmp_ge_u32 s30, 1048576
    s_cselect_b32 s92, 1048576, s92
    s_cbranch_scc1 T_pok0
    s_add_u32 s30, s30, 1
    buffer_load_dword v16, v15, s[4:7], 0 offen sc1
    s_sleep 8
    s_waitcnt vmcnt(0)
    s_branch T_q0
T_slow1:
    s_waitcnt vmcnt(0)
    buffer_store_dword v9, v4, s[4:7], 0 offen sc1
    s_cmp_ge_u32 s28, 60
    s_cbranch_scc1 T_last
    s_mov_b32 s30, s92
T_s1:
    v_cmp_ge_u32 vcc, s28, v16
    s_nop 0
    s_and_b32 s17, vcc_lo, 61440
    s_cbranch_scc0 T_sk1
    s_cmp_ge_u32 s30, 1048576
    s_cselect_b32 s92, 1048576, s92
    s_cbranch_scc1 T_sk1
    s_add_u32 s30, s30, 1
    buffer_load_dword v16, v15, s[4:7], 0 offen sc1
    s_sleep 2
    s_waitcnt vmcnt(0)
    s_branch T_s1
T_sk1:
    s_add_u32 s17, s32, 0
    s_add_u32 s18, s32, 5242880
    buffer_load_dwordx4 v[68:71], v12, s[4:7], s17 offen offset:0
    buffer_load_dwordx4 v[72:75], v12, s[4:7], s17 offen offset:32
    buffer_load_dwordx2 v[100:101], v13, s[4:7], s18 offen
    s_add_u32 s17, s32, 33280
    s_add_u32 s18, s32, 5276160
    buffer_load_dwordx4 v[76:79], v12, s[4:7], s17 offen offset:0
    buffer_load_dwordx4 v[80:83], v12, s[4:7], s17 offen offset:32
    buffer_load_dwordx2 v[104:105], v13, s[4:7], s18 offen
    s_add_u32 s17, s32, 66560
    s_add_u32 s18, s32, 5309440
    buffer_load_dwordx4 v[84:87], v12, s[4:7], s17 offen offset:0
    buffer_load_dwordx4 v[88:91], v12, s[4:7], s17 offen offset:32
    buffer_load_dwordx2 v[108:109], v13, s[4:7], s18 offen
    s_add_u32 s17, s32, 99840
    s_add_u32 s18, s32, 5342720
    buffer_load_dwordx4 v[92:95], v12, s[4:7], s17 offen offset:0
    buffer_load_dwordx4 v[96:99], v12, s[4:7], s17 offen offset:32
    buffer_load_dwordx2 v[112:113], v13, s[4:7], s18 offen
    s_waitcnt vmcnt(0)
    s_branch T_go1
T_pw1:
    s_mov_b32 s30, s92
T_q1:
    v_cmp_ge_u32 vcc, s68, v16
    s_nop 0
    s_and_b32 s17, vcc_lo, 4095
    s_cbranch_scc0 T_pok1
    s_cmp_ge_u32 s30, 1048576
    s_cselect_b32 s92, 1048576, s92
    s_cbranch_scc1 T_pok1
    s_add_u32 s30, s30, 1
    buffer_load_dword v16, v15, s[4:7], 0 offen sc1
    s_sleep 8
    s_waitcnt vmcnt(0)
    s_branch T_q1
T_last:
    v_mfma_f32_32x32x16_bf16 v[116:131], a[128:131], a[96:99], 0
    v_mfma_f32_32x32x16_bf16 v[116:131], a[132:135], a[100:103], v[116:131]
    v_mfma_f32_32x32x16_bf16 v[116:131], a[136:139], a[104:107], v[116:131]
    v_mfma_f32_32x32x16_bf16 v[116:131], a[140:143], a[108:111], v[116:131]
    v_mfma_f32_32x32x16_bf16 v[116:131], a[144:147], a[112:115], v[116:131]
    v_mfma_f32_32x32x16_bf16 v[116:131], a[148:151], a[116:119], v[116:131]
    v_mfma_f32_32x32x16_bf16 v[116:131], a[152:155], a[120:123], v[116:131]
    v_mfma_f32_32x32x16_bf16 v[116:131], a[156:159], a[124:127], v[116:131]
    s_nop 11
    v_cndmask_b32 v116, v17, v116, s[36:37]
    v_cndmask_b32 v117, v17, v117, s[38:39]
    v_cndmask_b32 v118, v17, v118, s[40:41]
    v_cndmask_b32 v119, v17, v119, s[42:43]
    v_cndmask_b32 v120, v17, v120, s[44:45]
    v_cndmask_b32 v121, v17, v121, s[46:47]
    v_cndmask_b32 v122, v17, v122, s[48:49]
    v_cndmask_b32 v123, v17, v123, s[50:51]
    v_cndmask_b32 v124, v17, v124, s[52:53]
    v_cndmask_b32 v125, v17, v125, s[54:55]
    v_cndmask_b32 v126, v17, v126, s[56:57]
    v_cndmask_b32 v127, v17, v127, s[58:59]
    v_cndmask_b32 v128, v17, v128, s[60:61]
    v_cndmask_b32 v129, v17, v129, s[62:63]
    v_cndmask_b32 v130, v17, v130, s[64:65]
    v_cndmask_b32 v131, v17, v131, s[66:67]
    v_max3_f32 v20, v116, v117, v118
    v_max3_f32 v20, v20, v119, v120
    v_max3_f32 v20, v20, v121, v122
    v_max3_f32 v20, v20, v123, v124
    v_max3_f32 v20, v20, v125, v126
    v_max3_f32 v20, v20, v127, v128
    v_max3_f32 v20, v20, v129, v130
    v_max_f32 v20, v20, v131
    v_mov_b32 v5, v20
    s_nop 1
    v_permlane32_swap_b32 v20, v5
    v_max_f32 v20, v20, v5
    v_mul_f32 v18, s29, v20
    v_fma_f32 v116, v116, s29, -v18
    v_fma_f32 v117, v117, s29, -v18
    v_fma_f32 v118, v118, s29, -v18
    v_fma_f32 v119, v119, s29, -v18
    v_fma_f32 v120, v120, s29, -v18
    v_fma_f32 v121, v121, s29, -v18
    v_fma_f32 v122, v122, s29, -v18
    v_fma_f32 v123, v123, s29, -v18
    v_fma_f32 v124, v124, s29, -v18
    v_fma_f32 v125, v125, s29, -v18
    v_fma_f32 v126, v126, s29, -v18
    v_fma_f32 v127, v127, s29, -v18
    v_fma_f32 v128, v128, s29, -v18
    v_fma_f32 v129, v129, s29, -v18
    v_fma_f32 v130, v130, s29, -v18
    v_fma_f32 v131, v131, s29, -v18
    v_exp_f32 v116, v116
    v_exp_f32 v117, v117
    v_exp_f32 v118, v118
    v_exp_f32 v119, v119
    v_exp_f32 v120, v120
    v_exp_f32 v121, v121
    v_exp_f32 v122, v122
    v_exp_f32 v123, v123
    v_exp_f32 v124, v124
    v_exp_f32 v125, v125
    v_exp_f32 v126, v126
    v_exp_f32 v127, v127
    v_exp_f32 v128, v128
    v_exp_f32 v129, v129
    v_exp_f32 v130, v130
    v_exp_f32 v131, v131
    v_add_f32 v19, v116, v117
    v_add_f32 v19, v19, v118
    v_add_f32 v19, v19, v119
    v_add_f32 v19, v19, v120
    v_add_f32 v19, v19, v121
    v_add_f32 v19, v19, v122
    v_add_f32 v19, v19, v123
    v_add_f32 v19, v19, v124
    v_add_f32 v19, v19, v125
    v_add_f32 v19, v19, v126
    v_add_f32 v19, v19, v127
    v_add_f32 v19, v19, v128
    v_add_f32 v19, v19, v129
    v_add_f32 v19, v19, v130
    v_add_f32 v19, v19, v131
    v_cvt_pk_bf16_f32 v148, v116, v117
    v_cvt_pk_bf16_f32 v149, v118, v119
    v_cvt_pk_bf16_f32 v150, v120, v121
    v_cvt_pk_bf16_f32 v151, v122, v123
    v_cvt_pk_bf16_f32 v152, v124, v125
    v_cvt_pk_bf16_f32 v153, v126, v127
    v_cvt_pk_bf16_f32 v154, v128, v129
    v_cvt_pk_bf16_f32 v155, v130, v131
    v_mfma_f32_32x32x16_bf16 v[160:175], a[160:163], v[148:151], 0
    s_nop 0
    v_mfma_f32_32x32x16_bf16 v[160:175], a[164:167], v[152:155], v[160:175]
    v_mfma_f32_32x32x16_bf16 v[176:191], a[168:171], v[148:151], 0
    v_mfma_f32_32x32x16_bf16 v[176:191], a[172:175], v[152:155], v[176:191]
    v_mfma_f32_32x32x16_bf16 v[192:207], a[176:179], v[148:151], 0
    v_mfma_f32_32x32x16_bf16 v[192:207], a[180:183], v[152:155], v[192:207]
    v_mfma_f32_32x32x16_bf16 v[208:223], a[184:187], v[148:151], 0
    v_mfma_f32_32x32x16_bf16 v[208:223], a[188:191], v[152:155], v[208:223]
    s_cmp_ge_u32 s28, 61
    s_cselect_b64 s[48:49], 0xffff, 0
    s_sub_u32 s34, s28, 2
    s_add_u32 s36, s32, 0
    s_add_u32 s40, s32, 5242880
    s_add_u32 s37, s32, 33280
    s_add_u32 s41, s32, 5276160
    s_add_u32 s38, s32, 66560
    s_add_u32 s42, s32, 5309440
    s_add_u32 s39, s32, 99840
    s_add_u32 s43, s32, 5342720
    v_add_u32 v9, 1, v9
    s_mov_b32 s30, s92
T_l0:
    v_cmp_ge_u32 vcc, s34, v16
    s_nop 0
    s_and_b32 s17, vcc_lo, 61440
    s_cbranch_scc0 T_l1
    s_cmp_ge_u32 s30, 1048576
    s_cselect_b32 s92, 1048576, s92
    s_cbranch_scc1 T_l1
    s_add_u32 s30, s30, 1
    buffer_load_dword v16, v15, s[4:7], 0 offen sc1
    s_sleep 2
    s_waitcnt vmcnt(0)
    s_branch T_l0
T_l2:
    v_max3_u32 v5, v68, v69, v70
    v_max3_u32 v5, v5, v71, v72
    v_max3_u32 v5, v5, v73, v74
    v_max3_u32 v5, v5, v75, v76
    v_max3_u32 v5, v5, v77, v78
    v_max3_u32 v5, v5, v79, v80
    v_max3_u32 v5, v5, v81, v82
    v_max3_u32 v5, v5, v83, v84
    v_max3_u32 v5, v5, v85, v86
    v_max3_u32 v5, v5, v87, v88
    v_max3_u32 v5, v5, v89, v90
    v_max3_u32 v5, v5, v91, v92
    v_max3_u32 v5, v5, v93, v94
    v_max3_u32 v5, v5, v95, v96
    v_max3_u32 v5, v5, v97, v98
    v_max3_u32 v5, v5, v99, v6
    v_cmp_eq_u32 vcc, -1, v5
    s_nop 0
    s_cbranch_vccz T_l3
    s_add_u32 s30, s30, 1
    s_cmp_ge_u32 s30, 1048576
    s_cbranch_scc1 T_l3
T_l1:
    buffer_load_dwordx4 v[68:71], v12, s[4:7], s36 offen offset:0 sc1
    buffer_load_dwordx4 v[72:75], v12, s[4:7], s36 offen offset:32 sc1
    buffer_load_dwordx4 v[76:79], v12, s[4:7], s37 offen offset:0 sc1
    buffer_load_dwordx4 v[80:83], v12, s[4:7], s37 offen offset:32 sc1
    buffer_load_dwordx4 v[84:87], v12, s[4:7], s38 offen offset:0 sc1
    buffer_load_dwordx4 v[88:91], v12, s[4:7], s38 offen offset:32 sc1
    buffer_load_dwordx4 v[92:95], v12, s[4:7], s39 offen offset:0 sc1
    buffer_load_dwordx4 v[96:99], v12, s[4:7], s39 offen offset:32 sc1
    buffer_load_dwordx2 v[100:101], v13, s[4:7], s40 offen sc1
    buffer_load_dwordx2 v[104:105], v13, s[4:7], s41 offen sc1
    buffer_load_dwordx2 v[108:109], v13, s[4:7], s42 offen sc1
    buffer_load_dwordx2 v[112:113], v13, s[4:7], s43 offen sc1
    s_waitcnt vmcnt(11)
    v_mfma_f32_32x32x16_bf16 v[132:147], v[68:71], a[96:99], 0
    s_waitcnt vmcnt(10)
    v_mfma_f32_32x32x16_bf16 v[132:147], v[72:75], a[100:103], v[132:147]
    s_waitcnt vmcnt(9)
    v_mfma_f32_32x32x16_bf16 v[132:147], v[76:79], a[104:107], v[132:147]
    s_waitcnt vmcnt(8)
    v_mfma_f32_32x32x16_bf16 v[132:147], v[80:83], a[108:111], v[132:147]
    s_waitcnt vmcnt(7)
    v_mfma_f32_32x32x16_bf16 v[132:147], v[84:87], a[112:115], v[132:147]
    s_waitcnt vmcnt(6)
    v_mfma_f32_32x32x16_bf16 v[132:147], v[88:91], a[116:119], v[132:147]
    s_waitcnt vmcnt(5)
    v_mfma_f32_32x32x16_bf16 v[132:147], v[92:95], a[120:123], v[132:147]
    s_waitcnt vmcnt(4)
    v_mfma_f32_32x32x16_bf16 v[132:147], v[96:99], a[124:127], v[132:147]
    s_waitcnt vmcnt(0)
    v_max3_u32 v6, v100, v101, v104
    v_max3_u32 v6, v6, v105, v108
    v_max3_u32 v6, v6, v109, v112
    v_max_u32 v6, v6, v113
    v_cmp_eq_u32 s[44:45], -1, v6
    s_nop 5
    v_cmp_u_f32 s[46:47], v132, v133
    v_cmp_u_f32 vcc, v134, v135
    v_max3_f32 v18, v132, v133, v20
    s_or_b64 s[44:45], s[44:45], s[46:47]
    v_max3_f32 v18, v134, v135, v18
    s_or_b64 vcc, vcc, s[44:45]
    s_cbranch_vccnz T_l2
T_l3:
    v_mov_b32 v5, v18
    s_nop 1
    v_permlane32_swap_b32 v18, v5
    v_max_f32 v18, v18, v5
    v_mul_f32 v18, s29, v18
    v_fma_f32 v21, v20, s29, -v18
    v_fma_f32 v132, v132, s29, -v18
    v_fma_f32 v133, v133, s29, -v18
    v_fma_f32 v134, v134, s29, -v18
    v_fma_f32 v135, v135, s29, -v18
    v_exp_f32 v21, v21
    v_exp_f32 v132, v132
    v_exp_f32 v133, v133
    v_exp_f32 v134, v134
    v_exp_f32 v135, v135
    v_fma_f32 v19, v19, v21, v132
    v_add_f32 v6, v133, v134
    v_add_f32 v19, v19, v135
    v_add_f32 v19, v19, v6
    v_mov_b32 v5, v19
    s_nop 1
    v_permlane32_swap_b32 v19, v5
    v_add_f32 v19, v19, v5
    v_rcp_f32 v19, v19
    s_nop 0
    v_mul_f32 v21, v21, v19
    v_mul_f32 v132, v132, v19
    v_mul_f32 v133, v133, v19
    v_mul_f32 v134, v134, v19
    v_mul_f32 v135, v135, v19
    v_cvt_pk_bf16_f32 v156, v132, v133
    v_cvt_pk_bf16_f32 v157, v134, v135
    v_mul_f32 v160, v160, v21
    v_mul_f32 v161, v161, v21
    v_mul_f32 v162, v162, v21
    v_mul_f32 v163, v163, v21
    v_mul_f32 v164, v164, v21
    v_mul_f32 v165, v165, v21
    v_mul_f32 v166, v166, v21
    v_mul_f32 v167, v167, v21
    v_mul_f32 v168, v168, v21
    v_mul_f32 v169, v169, v21
    v_mul_f32 v170, v170, v21
    v_mul_f32 v171, v171, v21
    v_mul_f32 v172, v172, v21
    v_mul_f32 v173, v173, v21
    v_mul_f32 v174, v174, v21
    v_mul_f32 v175, v175, v21
    s_nop 1
    v_mfma_f32_32x32x16_bf16 v[160:175], v[100:103], v[156:159], v[160:175]
    v_mul_f32 v176, v176, v21
    v_mul_f32 v177, v177, v21
    v_mul_f32 v178, v178, v21
    v_mul_f32 v179, v179, v21
    v_mul_f32 v180, v180, v21
    v_mul_f32 v181, v181, v21
    v_mul_f32 v182, v182, v21
    v_mul_f32 v183, v183, v21
    v_mul_f32 v184, v184, v21
    v_mul_f32 v185, v185, v21
    v_mul_f32 v186, v186, v21
    v_mul_f32 v187, v187, v21
    v_mul_f32 v188, v188, v21
    v_mul_f32 v189, v189, v21
    v_mul_f32 v190, v190, v21
    v_mul_f32 v191, v191, v21
    s_nop 1
    v_mfma_f32_32x32x16_bf16 v[176:191], v[104:107], v[156:159], v[176:191]
    v_cvt_pk_bf16_f32 v224, v160, v161
    v_cvt_pk_bf16_f32 v225, v162, v163
    v_cvt_pk_bf16_f32 v226, v164, v165
    v_cvt_pk_bf16_f32 v227, v166, v167
    v_cvt_pk_bf16_f32 v228, v168, v169
    v_cvt_pk_bf16_f32 v229, v170, v171
    v_cvt_pk_bf16_f32 v230, v172, v173
    v_cvt_pk_bf16_f32 v231, v174, v175
    buffer_store_dwordx4 v[224:227], v14, s[4:7], s33 offen offset:0 sc1
    buffer_store_dwordx4 v[228:231], v14, s[4:7], s33 offen offset:512 sc1
    v_mul_f32 v192, v192, v21
    v_mul_f32 v193, v193, v21
    v_mul_f32 v194, v194, v21
    v_mul_f32 v195, v195, v21
    v_mul_f32 v196, v196, v21
    v_mul_f32 v197, v197, v21
    v_mul_f32 v198, v198, v21
    v_mul_f32 v199, v199, v21
    v_mul_f32 v200, v200, v21
    v_mul_f32 v201, v201, v21
    v_mul_f32 v202, v202, v21
    v_mul_f32 v203, v203, v21
    v_mul_f32 v204, v204, v21
    v_mul_f32 v205, v205, v21
    v_mul_f32 v206, v206, v21
    v_mul_f32 v207, v207, v21
    s_nop 1
    v_mfma_f32_32x32x16_bf16 v[192:207], v[108:111], v[156:159], v[192:207]
    v_cvt_pk_bf16_f32 v232, v176, v177
    v_cvt_pk_bf16_f32 v233, v178, v179
    v_cvt_pk_bf16_f32 v234, v180, v181
    v_cvt_pk_bf16_f32 v235, v182, v183
    v_cvt_pk_bf16_f32 v236, v184, v185
    v_cvt_pk_bf16_f32 v237, v186, v187
    v_cvt_pk_bf16_f32 v238, v188, v189
    v_cvt_pk_bf16_f32 v239, v190, v191
    buffer_store_dwordx4 v[232:235], v14, s[4:7], s33 offen offset:1024 sc1
    buffer_store_dwordx4 v[236:239], v14, s[4:7], s33 offen offset:1536 sc1
    v_mul_f32 v208, v208, v21
    v_mul_f32 v209, v209, v21
    v_mul_f32 v210, v210, v21
    v_mul_f32 v211, v211, v21
    v_mul_f32 v212, v212, v21
    v_mul_f32 v213, v213, v21
    v_mul_f32 v214, v214, v21
    v_mul_f32 v215, v215, v21
    v_mul_f32 v216, v216, v21
    v_mul_f32 v217, v217, v21
    v_mul_f32 v218, v218, v21
    v_mul_f32 v219, v219, v21
    v_mul_f32 v220, v220, v21
    v_mul_f32 v221, v221, v21
    v_mul_f32 v222, v222, v21
    v_mul_f32 v223, v223, v21
    s_nop 1
    v_mfma_f32_32x32x16_bf16 v[208:223], v[112:115], v[156:159], v[208:223]
    v_cvt_pk_bf16_f32 v240, v192, v193
    v_cvt_pk_bf16_f32 v241, v194, v195
    v_cvt_pk_bf16_f32 v242, v196, v197
    v_cvt_pk_bf16_f32 v243, v198, v199
    v_cvt_pk_bf16_f32 v244, v200, v201
    v_cvt_pk_bf16_f32 v245, v202, v203
    v_cvt_pk_bf16_f32 v246, v204, v205
    v_cvt_pk_bf16_f32 v247, v206, v207
    buffer_store_dwordx4 v[240:243], v14, s[4:7], s33 offen offset:2048 sc1
    buffer_store_dwordx4 v[244:247], v14, s[4:7], s33 offen offset:2560 sc1
    s_nop 1
    v_cvt_pk_bf16_f32 v248, v208, v209
    v_cvt_pk_bf16_f32 v249, v210, v211
    v_cvt_pk_bf16_f32 v250, v212, v213
    v_cvt_pk_bf16_f32 v251, v214, v215
    v_cvt_pk_bf16_f32 v252, v216, v217
    v_cvt_pk_bf16_f32 v253, v218, v219
    v_cvt_pk_bf16_f32 v254, v220, v221
    v_cvt_pk_bf16_f32 v255, v222, v223
    buffer_store_dwordx4 v[248:251], v14, s[4:7], s33 offen offset:3072 sc1
    buffer_store_dwordx4 v[252:255], v14, s[4:7], s33 offen offset:3584 sc1
    s_branch T_fin
W_fin:
W_end:
    s_endpgm
R_entry:
    s_mov_b32 s12, s3
    s_lshr_b32 s13, s2, 3
    s_load_dwordx2 s[4:5], s[0:1], 96
    s_load_dwordx2 s[28:29], s[0:1], 32
    s_load_dwordx2 s[30:31], s[0:1], 40
    s_load_dwordx2 s[32:33], s[0:1], 48
    s_load_dwordx2 s[34:35], s[0:1], 56
    s_load_dwordx2 s[36:37], s[0:1], 64
    v_lshrrev_b32 v19, 6, v0
    v_and_b32 v1, 63, v0
    v_readfirstlane_b32 s14, v19
    s_mov_b32 s6, 268435456
    s_mov_b32 s7, 0x20000
    s_mov_b32 s10, 8388608
    s_mov_b32 s11, 0x20000
    s_mov_b32 s25, 0
    s_mov_b32 s24, 1040356334
    s_waitcnt lgkmcnt(0)
    v_and_b32 v96, 7, v1
    v_bfe_u32 v97, v1, 3, 1
    v_lshrrev_b32 v98, 4, v1
    v_lshlrev_b32 v19, 4, v1
    s_lshl_b32 s21, s12, 14
    s_lshl_b32 s22, s14, 12
    s_add_u32 s21, s21, s22
    s_add_u32 s22, s21, 0
    v_add_u32 v2, s22, v19
    s_add_u32 s22, s21, 229376
    v_add_u32 v8, s22, v19
    s_lshr_b32 s21, s13, 1
    s_lshl_b32 s21, s21, 10
    s_and_b32 s22, s13, 1
    s_lshl_b32 s22, s22, 7
    s_add_u32 s21, s21, s22
    s_lshl_b32 s22, s12, 14
    s_add_u32 s21, s21, s22
    v_lshlrev_b32 v20, 8, v98
    v_lshl_add_u32 v20, v96, 4, v20
    v_lshl_add_u32 v20, v97, 3, v20
    s_add_u32 s22, s21, 229376
    v_add_u32 v7, s22, v20
    s_add_u32 s22, s21, 0
    v_add_u32 v11, s22, v20
    s_lshr_b32 s21, s13, 1
    s_lshl_b32 s21, s21, 14
    s_and_b32 s22, s13, 1
    s_lshl_b32 s22, s22, 12
    s_add_u32 s21, s21, s22
    s_lshl_b32 s22, s12, 10
    s_add_u32 s22, s21, s22
    v_add_u32 v9, s22, v19
    v_xor_b32 v10, 1024, v9
    v_xor_b32 v23, 2048, v9
    v_xor_b32 v244, 3072, v9
    s_mov_b32 s95, 167772160
    s_lshr_b32 s40, s13, 2
    s_lshl_b32 s21, s12, 3
    s_add_u32 s40, s40, s21
    s_and_b32 s41, s13, 3
    s_mul_i32 s21, s40, 5120
    s_add_u32 s21, s21, 65536
    v_add_u32 v5, s21, v19
    v_lshlrev_b32 v20, 2, v1
    s_add_u32 s22, s21, 4096
    v_add_u32 v6, s22, v20
    s_lshl_b32 s22, s41, 10
    s_add_u32 s22, s22, s21
    v_add_u32 v3, s22, v19
    v_mov_b32 v21, 1073741824
    v_cmp_eq_u32 vcc, 0, v97
    s_nop 1
    v_cndmask_b32 v3, v21, v3, vcc
    s_lshl_b32 s22, s41, 8
    s_add_u32 s22, s22, s21
    s_add_u32 s22, s22, 4096
    v_lshlrev_b32 v20, 4, v98
    v_lshl_add_u32 v20, v96, 5, v20
    v_add_u32 v4, s22, v20
    v_cndmask_b32 v4, v4, v21, vcc
    v_cmp_gt_u32 vcc, 2, v98
    s_nop 1
    v_cndmask_b32 v4, v21, v4, vcc
    s_lshl_b32 s27, s40, 7
    s_lshl_b32 s21, s41, 5
    s_add_u32 s27, s27, s21
    v_bfe_u32 v20, v1, 2, 2
    v_and_b32 v22, 3, v1
    v_lshl_add_u32 v20, v20, 3, v22
    v_lshlrev_b32 v12, 6, v20
    v_lshl_add_u32 v12, v98, 4, v12
    s_and_b32 s21, s14, 1
    s_lshl_b32 s21, s21, 14
    s_lshl_b32 s22, s27, 2
    s_add_u32 s21, s21, s22
    s_add_u32 s21, s21, 100679680
    v_mov_b32 v245, s21
    s_mov_b32 s85, 0
    s_mul_i32 s21, s27, 4160
    v_add_u32 v12, s21, v12
    v_mov_b32 v13, v12
    v_and_b32 v173, 15, v1
    v_lshl_add_u32 v173, v173, 7, s21
    v_mul_u32_u24 v175, 69632, v98
    v_lshl_add_u32 v173, v175, 8, v173
    s_add_u32 s22, s22, 100679680
    v_lshl_add_u32 v174, v98, 14, s22
    v_mov_b32 v175, 0
    v_lshlrev_b32 v15, 4, v20
    v_lshl_add_u32 v15, v98, 5, v15
    s_mul_i32 s21, s27, 1040
    v_add_u32 v15, s21, v15
    v_and_b32 v22, 1, v98
    v_cmp_eq_u32 vcc, 0, v22
    s_nop 1
    v_cndmask_b32 v15, v21, v15, vcc
    v_lshlrev_b32 v14, 6, v96
    v_lshl_add_u32 v14, v98, 4, v14
    v_add_u32 v14, s21, v14
    v_cmp_eq_u32 vcc, 1, v97
    s_nop 1
    v_cndmask_b32 v14, v21, v14, vcc
    v_mov_b32 v16, v19
    s_lshl_b32 s21, s14, 11
    v_add_u32 v17, s21, v19
    v_and_b32 v20, 15, v1
    v_bfe_u32 v22, v1, 2, 2
    v_and_b32 v18, 1, v1
    v_lshl_add_u32 v18, v22, 1, v18
    v_bfe_u32 v22, v1, 1, 1
    v_lshl_add_u32 v18, v22, 3, v18
    s_cmp_eq_u32 s14, 1
    s_cselect_b64 vcc, -1, 0
    v_cndmask_b32 v20, v20, v18, vcc
    v_and_b32 v22, 1, v98
    v_lshlrev_b32 v22, 2, v22
    v_sub_u32 v20, v20, v22
    v_mov_b32 v22, 0x3f80
    v_mov_b32 v18, 0x3f800000
    v_mov_b32 v172, 0x4444
    v_mov_b32 v84, 0xeeee
    v_cmp_eq_u32 vcc, 1, v97
    s_nop 1
    v_cndmask_b32 v172, v172, v84, vcc
    v_cmp_eq_u32 vcc, 0, v20
    s_nop 1
    v_cndmask_b32 v84, 0, v22, vcc
    v_cmp_eq_u32 vcc, 1, v20
    s_nop 1
    v_cndmask_b32 v84, v84, v18, vcc
    v_cmp_eq_u32 vcc, 2, v20
    s_nop 1
    v_cndmask_b32 v85, 0, v22, vcc
    v_cmp_eq_u32 vcc, 3, v20
    s_nop 1
    v_cndmask_b32 v85, v85, v18, vcc
    v_cmp_eq_u32 vcc, 8, v20
    s_nop 1
    v_cndmask_b32 v86, 0, v22, vcc
    v_cmp_eq_u32 vcc, 9, v20
    s_nop 1
    v_cndmask_b32 v86, v86, v18, vcc
    v_cmp_eq_u32 vcc, 10, v20
    s_nop 1
    v_cndmask_b32 v87, 0, v22, vcc
    v_cmp_eq_u32 vcc, 11, v20
    s_nop 1
    v_cndmask_b32 v87, v87, v18, vcc
    s_mov_b32 s16, 81788928
    s_mov_b32 s42, 82083840
    s_mov_b32 s43, 82378752
    s_mov_b32 s44, 82673664
    s_mov_b32 s17, 17825792
    s_mov_b32 s18, 35651584
    s_mov_b32 s19, 71303168
    s_mov_b32 s20, 76546048
    s_mov_b32 s15, 0
    v_mov_b32 v204, -1
    v_mov_b32 v205, -1
    v_mov_b32 v206, -1
    v_mov_b32 v207, -1
    v_mov_b32 v236, 0x3f803f80
    v_mov_b32 v237, 0x3f803f80
    v_mov_b32 v238, 0x3f803f80
    v_mov_b32 v239, 0x3f803f80
    s_mul_i32 s22, s14, 294912
    s_add_u32 s22, s22, 81788928
    buffer_store_dwordx4 v[204:207], v3, s[4:7], s22 offen sc1
    buffer_store_dwordx4 v[204:207], v3, s[4:7], s22 offen offset:128 sc1
    buffer_store_dwordx4 v[204:207], v4, s[4:7], s22 offen sc1
    buffer_store_dwordx2 v[204:205], v7, s[4:7], s22 offen sc1
    buffer_store_dwordx2 v[204:205], v11, s[4:7], s22 offen sc1
    s_lshl_b32 s22, s14, 18
    s_add_u32 s22, s22, 167772160
    buffer_store_dwordx4 v[204:207], v9, s[4:7], s22 offen sc1
    s_add_u32 s22, s22, 8192
    buffer_store_dwordx4 v[204:207], v9, s[4:7], s22 offen sc1
    s_lshl_b32 s22, s14, 9
    s_add_u32 s22, s22, 71333888
    buffer_store_dwordx4 v[204:207], v14, s[4:7], s22 offen sc1
    s_add_u32 s22, s22, 5242880
    buffer_store_dwordx4 v[204:207], v15, s[4:7], s22 offen sc1
    s_lshl_b32 s22, s27, 2
    s_add_u32 s22, s22, 100712448
    v_lshlrev_b32 v246, 2, v1
    v_add_u32 v246, s22, v246
    v_cmp_gt_u32 vcc, 32, v1
    s_nop 1
    v_cndmask_b32 v246, v21, v246, vcc
    v_mov_b32 v247, 0
    buffer_store_dword v247, v246, s[4:7], 0 offen sc1
    v_lshrrev_b32 v19, 2, v1
    v_and_b32 v22, 3, v1
    v_lshlrev_b32 v22, 4, v22
    v_lshl_add_u32 v140, v19, 13, v22
    v_lshl_add_u32 v141, v19, 11, v22
    s_mul_i32 s86, s14, 40960
    s_lshr_b32 s21, s13, 3
    s_cmp_eq_u32 s21, 1
    s_cselect_b64 s[8:9], s[32:33], s[30:31]
    s_cmp_eq_u32 s21, 2
    s_cselect_b64 s[8:9], s[34:35], s[8:9]
    s_cmp_eq_u32 s21, 3
    s_cselect_b64 s[8:9], s[36:37], s[8:9]
    s_cselect_b32 s21, 11, 13
    s_cselect_b32 s87, 21, 11
    s_lshl_b32 s87, s12, s87
    s_and_b32 s22, s13, 3
    s_lshl_b32 s22, s22, 8
    v_add_u32 v142, s22, v0
    v_lshlrev_b32 v142, s21, v142
    s_and_b32 s22, s13, 4
    s_lshl_b32 s22, s22, 8
    s_add_u32 s87, s87, s22
    buffer_load_dword v143, v142, s[8:11], s87 offen offset:384
    s_cmp_eq_u32 s87, 7168
    s_cselect_b32 s87, s87, 1073741824
    buffer_load_dword v144, v142, s[8:11], s87 offen offset:896
    s_mov_b32 s8, s32
    s_mov_b32 s9, s33
    s_lshl_b32 s87, s14, 21
    s_lshl_b32 s22, s27, 1
    s_add_u32 s87, s87, s22
    s_add_u32 m0, s86, 0
    s_nop 0
    buffer_load_dwordx4 v140, s[8:11], s87 offen lds
    s_add_u32 s87, s87, 131072
    s_add_u32 m0, s86, 1024
    s_nop 0
    buffer_load_dwordx4 v140, s[8:11], s87 offen lds
    s_add_u32 s87, s87, 131072
    s_add_u32 m0, s86, 2048
    s_nop 0
    buffer_load_dwordx4 v140, s[8:11], s87 offen lds
    s_add_u32 s87, s87, 131072
    s_add_u32 m0, s86, 3072
    s_nop 0
    buffer_load_dwordx4 v140, s[8:11], s87 offen lds
    s_add_u32 s87, s87, 131072
    v_bfe_u32 v19, v1, 2, 1
    v_lshl_add_u32 v19, v98, 2, v19
    v_lshl_add_u32 v19, v97, 5, v19
    v_lshl_add_u32 v22, v19, 6, v22
    v_add_u32 v22, s86, v22
    s_waitcnt vmcnt(6)
    s_barrier
    s_cmp_lg_u32 s14, 0
    s_cbranch_scc1 reg_20
    s_and_b32 s21, s2, 3
    s_lshl_b32 s21, s21, 3
    s_lshl_b32 s22, s98, 2
    s_add_u32 s21, s21, s22
    s_lshl_b32 s21, 1, s21
    s_andn2_b32 s22, s2, 3
    v_mov_b32 v20, s22
    v_mov_b32 v21, s21
    s_mov_b64 exec, 1
    global_atomic_add v20, v21, s[100:101] sc1
    s_mov_b64 exec, -1
reg_20:
    s_barrier
    s_add_u32 m0, s86, 4096
    s_nop 0
    buffer_load_dwordx4 v140, s[8:11], s87 offen lds
    s_add_u32 s87, s87, 131072
    s_add_u32 m0, s86, 5120
    s_nop 0
    buffer_load_dwordx4 v140, s[8:11], s87 offen lds
    s_add_u32 s87, s87, 131072
    s_add_u32 m0, s86, 6144
    s_nop 0
    buffer_load_dwordx4 v140, s[8:11], s87 offen lds
    s_add_u32 s87, s87, 131072
    s_add_u32 m0, s86, 7168
    s_nop 0
    buffer_load_dwordx4 v140, s[8:11], s87 offen lds
    s_add_u32 s87, s87, 131072
    s_add_u32 m0, s86, 8192
    s_nop 0
    buffer_load_dwordx4 v140, s[8:11], s87 offen lds
    s_add_u32 s87, s87, 131072
    s_add_u32 m0, s86, 9216
    s_nop 0
    buffer_load_dwordx4 v140, s[8:11], s87 offen lds
    s_add_u32 s87, s87, 131072
    s_add_u32 m0, s86, 10240
    s_nop 0
    buffer_load_dwordx4 v140, s[8:11], s87 offen lds
    s_add_u32 s87, s87, 131072
    s_add_u32 m0, s86, 11264
    s_nop 0
    buffer_load_dwordx4 v140, s[8:11], s87 offen lds
    s_add_u32 s87, s87, 131072
    s_add_u32 m0, s86, 12288
    s_nop 0
    buffer_load_dwordx4 v140, s[8:11], s87 offen lds
    s_add_u32 s87, s87, 131072
    s_add_u32 m0, s86, 13312
    s_nop 0
    buffer_load_dwordx4 v140, s[8:11], s87 offen lds
    s_add_u32 s87, s87, 131072
    s_add_u32 m0, s86, 14336
    s_nop 0
    buffer_load_dwordx4 v140, s[8:11], s87 offen lds
    s_add_u32 s87, s87, 131072
    s_add_u32 m0, s86, 15360
    s_nop 0
    buffer_load_dwordx4 v140, s[8:11], s87 offen lds
    s_add_u32 s87, s87, 131072
    s_mov_b32 s8, s34
    s_mov_b32 s9, s35
    s_lshl_b32 s87, s14, 21
    s_lshl_b32 s22, s27, 1
    s_add_u32 s87, s87, s22
    s_add_u32 m0, s86, 16384
    s_nop 0
    buffer_load_dwordx4 v140, s[8:11], s87 offen lds
    s_add_u32 s87, s87, 131072
    s_add_u32 m0, s86, 17408
    s_nop 0
    buffer_load_dwordx4 v140, s[8:11], s87 offen lds
    s_add_u32 s87, s87, 131072
    s_add_u32 m0, s86, 18432
    s_nop 0
    buffer_load_dwordx4 v140, s[8:11], s87 offen lds
    s_add_u32 s87, s87, 131072
    s_add_u32 m0, s86, 19456
    s_nop 0
    buffer_load_dwordx4 v140, s[8:11], s87 offen lds
    s_add_u32 s87, s87, 131072
    s_add_u32 m0, s86, 20480
    s_nop 0
    buffer_load_dwordx4 v140, s[8:11], s87 offen lds
    s_add_u32 s87, s87, 131072
    s_add_u32 m0, s86, 21504
    s_nop 0
    buffer_load_dwordx4 v140, s[8:11], s87 offen lds
    s_add_u32 s87, s87, 131072
    s_add_u32 m0, s86, 22528
    s_nop 0
    buffer_load_dwordx4 v140, s[8:11], s87 offen lds
    s_add_u32 s87, s87, 131072
    s_add_u32 m0, s86, 23552
    s_nop 0
    buffer_load_dwordx4 v140, s[8:11], s87 offen lds
    s_add_u32 s87, s87, 131072
    s_add_u32 m0, s86, 24576
    s_nop 0
    buffer_load_dwordx4 v140, s[8:11], s87 offen lds
    s_add_u32 s87, s87, 131072
    s_add_u32 m0, s86, 25600
    s_nop 0
    buffer_load_dwordx4 v140, s[8:11], s87 offen lds
    s_add_u32 s87, s87, 131072
    s_add_u32 m0, s86, 26624
    s_nop 0
    buffer_load_dwordx4 v140, s[8:11], s87 offen lds
    s_add_u32 s87, s87, 131072
    s_add_u32 m0, s86, 27648
    s_nop 0
    buffer_load_dwordx4 v140, s[8:11], s87 offen lds
    s_add_u32 s87, s87, 131072
    s_add_u32 m0, s86, 28672
    s_nop 0
    buffer_load_dwordx4 v140, s[8:11], s87 offen lds
    s_add_u32 s87, s87, 131072
    s_add_u32 m0, s86, 29696
    s_nop 0
    buffer_load_dwordx4 v140, s[8:11], s87 offen lds
    s_add_u32 s87, s87, 131072
    s_add_u32 m0, s86, 30720
    s_nop 0
    buffer_load_dwordx4 v140, s[8:11], s87 offen lds
    s_add_u32 s87, s87, 131072
    s_add_u32 m0, s86, 31744
    s_nop 0
    buffer_load_dwordx4 v140, s[8:11], s87 offen lds
    s_add_u32 s87, s87, 131072
    s_mov_b32 s8, s30
    s_mov_b32 s9, s31
    s_lshl_b32 s87, s14, 21
    s_lshl_b32 s22, s27, 1
    s_add_u32 s87, s87, s22
    s_add_u32 m0, s86, 32768
    s_nop 0
    buffer_load_dwordx4 v140, s[8:11], s87 offen lds
    s_add_u32 s87, s87, 131072
    s_add_u32 m0, s86, 33792
    s_nop 0
    buffer_load_dwordx4 v140, s[8:11], s87 offen lds
    s_add_u32 s87, s87, 131072
    s_add_u32 m0, s86, 34816
    s_nop 0
    buffer_load_dwordx4 v140, s[8:11], s87 offen lds
    s_add_u32 s87, s87, 131072
    s_add_u32 m0, s86, 35840
    s_nop 0
    buffer_load_dwordx4 v140, s[8:11], s87 offen lds
    s_add_u32 s87, s87, 131072
    s_add_u32 m0, s86, 36864
    s_nop 0
    buffer_load_dwordx4 v140, s[8:11], s87 offen lds
    s_add_u32 s87, s87, 131072
    s_add_u32 m0, s86, 37888
    s_nop 0
    buffer_load_dwordx4 v140, s[8:11], s87 offen lds
    s_add_u32 s87, s87, 131072
    s_add_u32 m0, s86, 38912
    s_nop 0
    buffer_load_dwordx4 v140, s[8:11], s87 offen lds
    s_add_u32 s87, s87, 131072
    s_add_u32 m0, s86, 39936
    s_nop 0
    buffer_load_dwordx4 v140, s[8:11], s87 offen lds
    s_add_u32 s87, s87, 131072
    s_waitcnt vmcnt(36)
    ds_read_b64_tr_b16 a[64:65], v22 offset:0
    ds_read_b64_tr_b16 a[66:67], v22 offset:128
    ds_read_b64_tr_b16 a[68:69], v22 offset:1024
    ds_read_b64_tr_b16 a[70:71], v22 offset:1152
    s_waitcnt lgkmcnt(4)
    ds_read_b64_tr_b16 a[96:97], v22 offset:8
    ds_read_b64_tr_b16 a[98:99], v22 offset:136
    ds_read_b64_tr_b16 a[100:101], v22 offset:1032
    ds_read_b64_tr_b16 a[102:103], v22 offset:1160
    s_waitcnt vmcnt(32)
    ds_read_b64_tr_b16 a[72:73], v22 offset:4096
    ds_read_b64_tr_b16 a[74:75], v22 offset:4224
    ds_read_b64_tr_b16 a[76:77], v22 offset:5120
    ds_read_b64_tr_b16 a[78:79], v22 offset:5248
    s_waitcnt lgkmcnt(4)
    ds_read_b64_tr_b16 a[104:105], v22 offset:4104
    ds_read_b64_tr_b16 a[106:107], v22 offset:4232
    ds_read_b64_tr_b16 a[108:109], v22 offset:5128
    ds_read_b64_tr_b16 a[110:111], v22 offset:5256
    s_add_u32 m0, s86, 0
    s_nop 0
    buffer_load_dwordx4 v140, s[8:11], s87 offen lds
    s_add_u32 s87, s87, 131072
    s_add_u32 m0, s86, 1024
    s_nop 0
    buffer_load_dwordx4 v140, s[8:11], s87 offen lds
    s_add_u32 s87, s87, 131072
    s_add_u32 m0, s86, 2048
    s_nop 0
    buffer_load_dwordx4 v140, s[8:11], s87 offen lds
    s_add_u32 s87, s87, 131072
    s_add_u32 m0, s86, 3072
    s_nop 0
    buffer_load_dwordx4 v140, s[8:11], s87 offen lds
    s_add_u32 s87, s87, 131072
    s_waitcnt vmcnt(32)
    ds_read_b64_tr_b16 a[80:81], v22 offset:8192
    ds_read_b64_tr_b16 a[82:83], v22 offset:8320
    ds_read_b64_tr_b16 a[84:85], v22 offset:9216
    ds_read_b64_tr_b16 a[86:87], v22 offset:9344
    s_waitcnt lgkmcnt(4)
    ds_read_b64_tr_b16 a[112:113], v22 offset:8200
    ds_read_b64_tr_b16 a[114:115], v22 offset:8328
    ds_read_b64_tr_b16 a[116:117], v22 offset:9224
    ds_read_b64_tr_b16 a[118:119], v22 offset:9352
    s_add_u32 m0, s86, 4096
    s_nop 0
    buffer_load_dwordx4 v140, s[8:11], s87 offen lds
    s_add_u32 s87, s87, 131072
    s_add_u32 m0, s86, 5120
    s_nop 0
    buffer_load_dwordx4 v140, s[8:11], s87 offen lds
    s_add_u32 s87, s87, 131072
    s_add_u32 m0, s86, 6144
    s_nop 0
    buffer_load_dwordx4 v140, s[8:11], s87 offen lds
    s_add_u32 s87, s87, 131072
    s_add_u32 m0, s86, 7168
    s_nop 0
    buffer_load_dwordx4 v140, s[8:11], s87 offen lds
    s_add_u32 s87, s87, 131072
    s_waitcnt vmcnt(32)
    ds_read_b64_tr_b16 a[88:89], v22 offset:12288
    ds_read_b64_tr_b16 a[90:91], v22 offset:12416
    ds_read_b64_tr_b16 a[92:93], v22 offset:13312
    ds_read_b64_tr_b16 a[94:95], v22 offset:13440
    s_waitcnt lgkmcnt(4)
    ds_read_b64_tr_b16 a[120:121], v22 offset:12296
    ds_read_b64_tr_b16 a[122:123], v22 offset:12424
    ds_read_b64_tr_b16 a[124:125], v22 offset:13320
    ds_read_b64_tr_b16 a[126:127], v22 offset:13448
    s_mov_b32 s8, s36
    s_mov_b32 s9, s37
    s_lshl_b32 s87, s12, 21
    s_lshl_b32 s22, s14, 19
    s_add_u32 s87, s87, s22
    s_lshl_b32 s22, s13, 6
    s_add_u32 s87, s87, s22
    s_add_u32 m0, s86, 8192
    s_nop 0
    buffer_load_dwordx4 v141, s[8:11], s87 offen lds
    s_add_u32 s87, s87, 32768
    s_add_u32 m0, s86, 9216
    s_nop 0
    buffer_load_dwordx4 v141, s[8:11], s87 offen lds
    s_add_u32 s87, s87, 32768
    s_add_u32 m0, s86, 10240
    s_nop 0
    buffer_load_dwordx4 v141, s[8:11], s87 offen lds
    s_add_u32 s87, s87, 32768
    s_add_u32 m0, s86, 11264
    s_nop 0
    buffer_load_dwordx4 v141, s[8:11], s87 offen lds
    s_add_u32 s87, s87, 32768
    s_waitcnt vmcnt(32)
    ds_read_b64_tr_b16 a[128:129], v22 offset:16384
    ds_read_b64_tr_b16 a[130:131], v22 offset:16512
    ds_read_b64_tr_b16 a[132:133], v22 offset:17408
    ds_read_b64_tr_b16 a[134:135], v22 offset:17536
    s_waitcnt lgkmcnt(4)
    ds_read_b64_tr_b16 a[160:161], v22 offset:16392
    ds_read_b64_tr_b16 a[162:163], v22 offset:16520
    ds_read_b64_tr_b16 a[164:165], v22 offset:17416
    ds_read_b64_tr_b16 a[166:167], v22 offset:17544
    s_add_u32 m0, s86, 12288
    s_nop 0
    buffer_load_dwordx4 v141, s[8:11], s87 offen lds
    s_add_u32 s87, s87, 32768
    s_add_u32 m0, s86, 13312
    s_nop 0
    buffer_load_dwordx4 v141, s[8:11], s87 offen lds
    s_add_u32 s87, s87, 32768
    s_add_u32 m0, s86, 14336
    s_nop 0
    buffer_load_dwordx4 v141, s[8:11], s87 offen lds
    s_add_u32 s87, s87, 32768
    s_add_u32 m0, s86, 15360
    s_nop 0
    buffer_load_dwordx4 v141, s[8:11], s87 offen lds
    s_add_u32 s87, s87, 32768
    s_waitcnt vmcnt(32)
    ds_read_b64_tr_b16 a[136:137], v22 offset:20480
    ds_read_b64_tr_b16 a[138:139], v22 offset:20608
    ds_read_b64_tr_b16 a[140:141], v22 offset:21504
    ds_read_b64_tr_b16 a[142:143], v22 offset:21632
    s_waitcnt lgkmcnt(4)
    ds_read_b64_tr_b16 a[168:169], v22 offset:20488
    ds_read_b64_tr_b16 a[170:171], v22 offset:20616
    ds_read_b64_tr_b16 a[172:173], v22 offset:21512
    ds_read_b64_tr_b16 a[174:175], v22 offset:21640
    s_add_u32 m0, s86, 16384
    s_nop 0
    buffer_load_dwordx4 v141, s[8:11], s87 offen lds
    s_add_u32 s87, s87, 32768
    s_add_u32 m0, s86, 17408
    s_nop 0
    buffer_load_dwordx4 v141, s[8:11], s87 offen lds
    s_add_u32 s87, s87, 32768
    s_add_u32 m0, s86, 18432
    s_nop 0
    buffer_load_dwordx4 v141, s[8:11], s87 offen lds
    s_add_u32 s87, s87, 32768
    s_add_u32 m0, s86, 19456
    s_nop 0
    buffer_load_dwordx4 v141, s[8:11], s87 offen lds
    s_add_u32 s87, s87, 32768
    s_mul_i32 s22, s14, 294912
    s_add_u32 s22, s22, 81788928
    buffer_load_dword v145, v3, s[4:7], s22 offen offset:0 sc1
    buffer_load_dword v146, v3, s[4:7], s22 offen offset:128 sc1
    buffer_load_dword v147, v4, s[4:7], s22 offen offset:0 sc1
    buffer_load_dword v148, v7, s[4:7], s22 offen offset:0 sc1
    buffer_load_dword v149, v11, s[4:7], s22 offen offset:0 sc1
    s_waitcnt vmcnt(37)
    ds_read_b64_tr_b16 a[144:145], v22 offset:24576
    ds_read_b64_tr_b16 a[146:147], v22 offset:24704
    ds_read_b64_tr_b16 a[148:149], v22 offset:25600
    ds_read_b64_tr_b16 a[150:151], v22 offset:25728
    s_waitcnt lgkmcnt(4)
    ds_read_b64_tr_b16 a[176:177], v22 offset:24584
    ds_read_b64_tr_b16 a[178:179], v22 offset:24712
    ds_read_b64_tr_b16 a[180:181], v22 offset:25608
    ds_read_b64_tr_b16 a[182:183], v22 offset:25736
    s_add_u32 m0, s86, 20480
    s_nop 0
    buffer_load_dwordx4 v141, s[8:11], s87 offen lds
    s_add_u32 s87, s87, 32768
    s_add_u32 m0, s86, 21504
    s_nop 0
    buffer_load_dwordx4 v141, s[8:11], s87 offen lds
    s_add_u32 s87, s87, 32768
    s_add_u32 m0, s86, 22528
    s_nop 0
    buffer_load_dwordx4 v141, s[8:11], s87 offen lds
    s_add_u32 s87, s87, 32768
    s_add_u32 m0, s86, 23552
    s_nop 0
    buffer_load_dwordx4 v141, s[8:11], s87 offen lds
    s_add_u32 s87, s87, 32768
    s_waitcnt vmcnt(37)
    ds_read_b64_tr_b16 a[152:153], v22 offset:28672
    ds_read_b64_tr_b16 a[154:155], v22 offset:28800
    ds_read_b64_tr_b16 a[156:157], v22 offset:29696
    ds_read_b64_tr_b16 a[158:159], v22 offset:29824
    s_waitcnt lgkmcnt(4)
    ds_read_b64_tr_b16 a[184:185], v22 offset:28680
    ds_read_b64_tr_b16 a[186:187], v22 offset:28808
    ds_read_b64_tr_b16 a[188:189], v22 offset:29704
    ds_read_b64_tr_b16 a[190:191], v22 offset:29832
    s_waitcnt vmcnt(33)
    ds_read_b64_tr_b16 a[0:1], v22 offset:32768
    ds_read_b64_tr_b16 a[2:3], v22 offset:32896
    ds_read_b64_tr_b16 a[4:5], v22 offset:33792
    ds_read_b64_tr_b16 a[6:7], v22 offset:33920
    s_waitcnt lgkmcnt(4)
    ds_read_b64_tr_b16 a[32:33], v22 offset:32776
    ds_read_b64_tr_b16 a[34:35], v22 offset:32904
    ds_read_b64_tr_b16 a[36:37], v22 offset:33800
    ds_read_b64_tr_b16 a[38:39], v22 offset:33928
    s_waitcnt vmcnt(29)
    ds_read_b64_tr_b16 a[8:9], v22 offset:36864
    ds_read_b64_tr_b16 a[10:11], v22 offset:36992
    ds_read_b64_tr_b16 a[12:13], v22 offset:37888
    ds_read_b64_tr_b16 a[14:15], v22 offset:38016
    s_waitcnt lgkmcnt(4)
    ds_read_b64_tr_b16 a[40:41], v22 offset:36872
    ds_read_b64_tr_b16 a[42:43], v22 offset:37000
    ds_read_b64_tr_b16 a[44:45], v22 offset:37896
    ds_read_b64_tr_b16 a[46:47], v22 offset:38024
    s_waitcnt vmcnt(25)
    ds_read_b64_tr_b16 a[16:17], v22 offset:0
    ds_read_b64_tr_b16 a[18:19], v22 offset:128
    ds_read_b64_tr_b16 a[20:21], v22 offset:1024
    ds_read_b64_tr_b16 a[22:23], v22 offset:1152
    s_waitcnt lgkmcnt(4)
    ds_read_b64_tr_b16 a[48:49], v22 offset:8
    ds_read_b64_tr_b16 a[50:51], v22 offset:136
    ds_read_b64_tr_b16 a[52:53], v22 offset:1032
    ds_read_b64_tr_b16 a[54:55], v22 offset:1160
    s_waitcnt vmcnt(21)
    ds_read_b64_tr_b16 a[24:25], v22 offset:4096
    ds_read_b64_tr_b16 a[26:27], v22 offset:4224
    ds_read_b64_tr_b16 a[28:29], v22 offset:5120
    ds_read_b64_tr_b16 a[30:31], v22 offset:5248
    s_waitcnt lgkmcnt(4)
    ds_read_b64_tr_b16 a[56:57], v22 offset:4104
    ds_read_b64_tr_b16 a[58:59], v22 offset:4232
    ds_read_b64_tr_b16 a[60:61], v22 offset:5128
    ds_read_b64_tr_b16 a[62:63], v22 offset:5256
    s_waitcnt vmcnt(17)
    ds_read_b64_tr_b16 a[192:193], v22 offset:8192
    ds_read_b64_tr_b16 a[194:195], v22 offset:8320
    ds_read_b64_tr_b16 a[196:197], v22 offset:9216
    ds_read_b64_tr_b16 a[198:199], v22 offset:9344
    s_waitcnt lgkmcnt(4)
    ds_read_b64_tr_b16 a[224:225], v22 offset:8200
    ds_read_b64_tr_b16 a[226:227], v22 offset:8328
    ds_read_b64_tr_b16 a[228:229], v22 offset:9224
    ds_read_b64_tr_b16 a[230:231], v22 offset:9352
    s_waitcnt vmcnt(13)
    ds_read_b64_tr_b16 a[200:201], v22 offset:12288
    ds_read_b64_tr_b16 a[202:203], v22 offset:12416
    ds_read_b64_tr_b16 a[204:205], v22 offset:13312
    ds_read_b64_tr_b16 a[206:207], v22 offset:13440
    s_waitcnt lgkmcnt(4)
    ds_read_b64_tr_b16 a[232:233], v22 offset:12296
    ds_read_b64_tr_b16 a[234:235], v22 offset:12424
    ds_read_b64_tr_b16 a[236:237], v22 offset:13320
    ds_read_b64_tr_b16 a[238:239], v22 offset:13448
    s_waitcnt vmcnt(9)
    ds_read_b64_tr_b16 a[208:209], v22 offset:16384
    ds_read_b64_tr_b16 a[210:211], v22 offset:16512
    ds_read_b64_tr_b16 a[212:213], v22 offset:17408
    ds_read_b64_tr_b16 a[214:215], v22 offset:17536
    s_waitcnt lgkmcnt(4)
    ds_read_b64_tr_b16 a[240:241], v22 offset:16392
    ds_read_b64_tr_b16 a[242:243], v22 offset:16520
    ds_read_b64_tr_b16 a[244:245], v22 offset:17416
    ds_read_b64_tr_b16 a[246:247], v22 offset:17544
    s_waitcnt vmcnt(0)
    ds_read_b64_tr_b16 a[216:217], v22 offset:20480
    ds_read_b64_tr_b16 a[218:219], v22 offset:20608
    ds_read_b64_tr_b16 a[220:221], v22 offset:21504
    ds_read_b64_tr_b16 a[222:223], v22 offset:21632
    s_waitcnt lgkmcnt(4)
    ds_read_b64_tr_b16 a[248:249], v22 offset:20488
    ds_read_b64_tr_b16 a[250:251], v22 offset:20616
    ds_read_b64_tr_b16 a[252:253], v22 offset:21512
    ds_read_b64_tr_b16 a[254:255], v22 offset:21640
    s_waitcnt lgkmcnt(0)
    v_mov_b32 v155, 0
    v_mov_b32 v159, 0
    v_mov_b32 v163, 0
    v_mov_b32 v167, 0
    v_mov_b32 v179, 0
    s_mov_b32 s8, s28
    s_mov_b32 s9, s29
    s_mov_b32 s10, 16384
    v_lshlrev_b32 v20, 11, v96
    v_lshl_add_u32 v20, v98, 4, v20
    v_lshl_add_u32 v20, v97, 3, v20
    s_lshl_b32 s21, s13, 6
    buffer_load_dwordx2 v[88:89], v20, s[8:11], s21 offen
    v_lshlrev_b32 v20, 2, v1
    s_mov_b32 s22, 0
rdv_21:
    global_load_dword v21, v20, s[100:101] sc1
    s_lshl_b32 s21, s98, 2
    s_waitcnt vmcnt(0)
    v_lshrrev_b32 v22, s21, v21
    s_cmp_eq_u32 s98, 0
    s_cselect_b32 s21, 0x0f0f0f0f, s21
    s_cselect_b32 s21, s21, 0x01010101
    v_and_b32 v22, s21, v22
    v_cmp_ne_u32 vcc, 0x01010101, v22
    s_nop 0
    s_cbranch_vccz rdvok_22
    v_sad_u8 v22, v22, 0, 0
    s_nop 1
    v_add_u32_dpp v22, v22, v22 quad_perm:[1,0,3,2] row_mask:0xf bank_mask:0xf
    v_cmp_ne_u32 vcc, 8, v22
    s_nop 0
    s_cbranch_vccnz rdvw_23
    s_mov_b32 s98, 1
    s_and_b32 s3, s97, 7
    s_barrier
    s_branch role_start
rdvw_23:
    s_sleep 4
    s_add_u32 s22, s22, 1
    s_cmp_lt_u32 s22, 262144
    s_cbranch_scc1 rdv_21
    s_mov_b32 s25, 200000
rdvok_22:
    v_and_b32 v22, 0x40404040, v21
    v_bcnt_u32_b32 v22, v22, 0
    s_mov_b32 s46, 0
    v_cmp_le_u32 vcc, 1, v22
    s_nop 0
    s_bcnt1_i32_b64 s21, vcc
    s_add_u32 s46, s46, s21
    v_cmp_le_u32 vcc, 2, v22
    s_nop 0
    s_bcnt1_i32_b64 s21, vcc
    s_add_u32 s46, s46, s21
    v_cmp_le_u32 vcc, 3, v22
    s_nop 0
    s_bcnt1_i32_b64 s21, vcc
    s_add_u32 s46, s46, s21
    v_cmp_le_u32 vcc, 4, v22
    s_nop 0
    s_bcnt1_i32_b64 s21, vcc
    s_add_u32 s46, s46, s21
    s_cmp_gt_u32 s46, 16
    s_cselect_b32 s46, 8192, 0
    s_add_u32 s84, s95, s46
    s_xor_b32 s45, s98, 1
    v_min_u32 v88, -2, v88
    v_min_u32 v89, -2, v89
    buffer_store_dwordx2 v[88:89], v11, s[4:7], s16 offen sc1
    v_mov_b32 v40, 0
    v_mov_b32 v41, 0
    v_mov_b32 v42, 0
    v_mov_b32 v43, 0
    v_mov_b32 v44, 0
    v_mov_b32 v45, 0
    v_mov_b32 v46, 0
    v_mov_b32 v47, 0
    v_mov_b32 v48, 0
    v_mov_b32 v49, 0
    v_mov_b32 v50, 0
    v_mov_b32 v51, 0
    v_mov_b32 v52, 0
    v_mov_b32 v53, 0
    v_mov_b32 v54, 0
    v_mov_b32 v55, 0
    v_mov_b32 v56, 0
    v_mov_b32 v57, 0
    v_mov_b32 v58, 0
    v_mov_b32 v59, 0
    v_mov_b32 v60, 0
    v_mov_b32 v61, 0
    v_mov_b32 v62, 0
    v_mov_b32 v63, 0
    v_mov_b32 v64, 0
    v_mov_b32 v65, 0
    v_mov_b32 v66, 0
    v_mov_b32 v67, 0
    v_mov_b32 v68, 0
    v_mov_b32 v69, 0
    v_mov_b32 v70, 0
    v_mov_b32 v71, 0
    s_cmp_ge_u32 s14, 2
    s_cbranch_scc1 kv_24
    s_mov_b32 s94, 1
    s_mov_b32 s23, s25
fw_26:
    s_cmp_ge_u32 s85, s94
    s_cbranch_scc1 fo_27
    buffer_load_dword v247, v245, s[4:7], 0 offen sc1
    s_add_u32 s23, s23, 1
    s_waitcnt vmcnt(0)
    v_readfirstlane_b32 s85, v247
    s_cmp_lt_u32 s23, 200000
    s_cbranch_scc1 fw_26
    s_mov_b32 s25, 200000
fo_27:
    s_cmp_eq_u32 s14, 1
    s_cbranch_scc1 kv_25
    buffer_load_dwordx4 v[132:135], v12, s[4:7], s17 offen sc1
    buffer_load_dwordx4 v[136:139], v12, s[4:7], s17 offen offset:256 sc1
    s_add_u32 s17, s17, 2048
    s_min_u32 s17, s17, 17954816
    s_branch kv_24
kv_25:
    buffer_load_dwordx4 v[228:231], v13, s[4:7], s18 offen offset:0 sc1
    buffer_load_dwordx4 v[232:235], v13, s[4:7], s18 offen offset:256 sc1
    s_add_u32 s18, s18, 2048
    s_min_u32 s18, s18, 35780608
kv_24:
    s_mul_i32 s86, s27, 4160
    s_add_u32 s86, s86, 17825792
    s_mov_b32 s23, s25
    s_barrier
    s_cmp_eq_u32 s45, 0
    s_cbranch_scc1 recur_slow_disp
    s_cmp_eq_u32 s14, 1
    s_cbranch_scc1 recur_fast_w1
    s_cmp_eq_u32 s14, 2
    s_cbranch_scc1 recur_fast_w2
    s_cmp_eq_u32 s14, 3
    s_cbranch_scc1 recur_fast_w3
    s_branch recur_fast_w0
recur_slow_disp:
    s_cmp_eq_u32 s14, 1
    s_cbranch_scc1 recur_slow_w1
    s_cmp_eq_u32 s14, 2
    s_cbranch_scc1 recur_slow_w2
    s_cmp_eq_u32 s14, 3
    s_cbranch_scc1 recur_slow_w3
    s_branch recur_slow_w0
.p2align 6
recur_fast_w0:
    s_nop 15
    s_mov_b32 s23, s25
    buffer_load_dwordx4 v[24:27], v2, s[4:7], s16 offen offset:0 sc1
    s_nop 11
    buffer_load_dwordx4 v[28:31], v2, s[4:7], s16 offen offset:1024 sc1
    s_nop 11
    buffer_load_dwordx4 v[32:35], v2, s[4:7], s16 offen offset:2048 sc1
    s_nop 11
    buffer_load_dwordx4 v[36:39], v2, s[4:7], s16 offen offset:3072 sc1
    s_waitcnt vmcnt(3)
    v_max3_u32 v19, v24, v25, v26
    v_max_u32 v19, v19, v27
    v_cmp_eq_u32 vcc, -1, v19
    s_nop 0
    s_cbranch_vccnz g_28F15_0
    v_smfmac_f32_16x16x64_bf16 v[40:43], v[24:27], a[0:7], v172
    s_waitcnt vmcnt(2)
    v_max3_u32 v19, v28, v29, v30
    v_max_u32 v19, v19, v31
    v_smfmac_f32_16x16x64_bf16 v[44:47], v[24:27], a[64:71], v172
    v_cmp_eq_u32 vcc, -1, v19
    v_smfmac_f32_16x16x64_bf16 v[48:51], v[24:27], a[32:39], v172
    v_smfmac_f32_16x16x64_bf16 v[52:55], v[24:27], a[96:103], v172
    s_cbranch_vccnz g_28F14_1
    v_smfmac_f32_16x16x64_bf16 v[40:43], v[28:31], a[8:15], v172
    s_waitcnt vmcnt(1)
    v_max3_u32 v19, v32, v33, v34
    v_max_u32 v19, v19, v35
    v_smfmac_f32_16x16x64_bf16 v[44:47], v[28:31], a[72:79], v172
    v_cmp_eq_u32 vcc, -1, v19
    v_smfmac_f32_16x16x64_bf16 v[48:51], v[28:31], a[40:47], v172
    v_smfmac_f32_16x16x64_bf16 v[52:55], v[28:31], a[104:111], v172
    s_cbranch_vccnz g_28F12_2
    v_smfmac_f32_16x16x64_bf16 v[40:43], v[32:35], a[16:23], v172
    s_waitcnt vmcnt(0)
    v_max3_u32 v19, v36, v37, v38
    v_max_u32 v19, v19, v39
    v_smfmac_f32_16x16x64_bf16 v[44:47], v[32:35], a[80:87], v172
    v_cmp_eq_u32 vcc, -1, v19
    v_smfmac_f32_16x16x64_bf16 v[48:51], v[32:35], a[48:55], v172
    v_smfmac_f32_16x16x64_bf16 v[52:55], v[32:35], a[112:119], v172
    s_cbranch_vccnz g_28F8_3
    v_smfmac_f32_16x16x64_bf16 v[40:43], v[36:39], a[24:31], v172
    v_smfmac_f32_16x16x64_bf16 v[44:47], v[36:39], a[88:95], v172
    v_smfmac_f32_16x16x64_bf16 v[48:51], v[36:39], a[56:63], v172
    v_smfmac_f32_16x16x64_bf16 v[52:55], v[36:39], a[120:127], v172
gc_29:
    v_cvt_pk_bf16_f32 v72, v40, v41
    v_cvt_pk_bf16_f32 v73, v42, v43
    v_cvt_pk_bf16_f32 v74, v44, v45
    v_cvt_pk_bf16_f32 v75, v46, v47
    v_smfmac_f32_16x16x64_bf16 v[56:59], v[24:27], a[128:135], v172
    v_cvt_pk_bf16_f32 v76, v48, v49
    v_cvt_pk_bf16_f32 v77, v50, v51
    s_nop 0
    v_cvt_pk_bf16_f32 v78, v52, v53
    v_cvt_pk_bf16_f32 v79, v54, v55
    v_smfmac_f32_16x16x64_bf16 v[60:63], v[24:27], a[160:167], v172
    v_mfma_f32_16x16x32_bf16 v[88:91], v[72:75], v[84:87], 0
    v_mfma_f32_16x16x32_bf16 v[92:95], v[76:79], v[84:87], 0
    v_smfmac_f32_16x16x64_bf16 v[56:59], v[28:31], a[136:143], v172
    v_smfmac_f32_16x16x64_bf16 v[60:63], v[28:31], a[168:175], v172
    s_barrier
    ds_read_b128 v[104:107], v16 offset:2048
    ds_read_b128 v[108:111], v16 offset:3072
    ds_read_b128 v[112:115], v16 offset:4096
    ds_read_b128 v[116:119], v16 offset:5120
    ds_read_b128 v[120:123], v16 offset:6144
    ds_read_b128 v[124:127], v16 offset:7168
    v_smfmac_f32_16x16x64_bf16 v[56:59], v[32:35], a[144:151], v172
    v_smfmac_f32_16x16x64_bf16 v[60:63], v[32:35], a[176:183], v172
    v_smfmac_f32_16x16x64_bf16 v[56:59], v[36:39], a[152:159], v172
    v_smfmac_f32_16x16x64_bf16 v[60:63], v[36:39], a[184:191], v172
    s_waitcnt lgkmcnt(5)
    v_mfma_f32_16x16x32_bf16 v[88:91], v[104:107], v[84:87], v[88:91]
    s_waitcnt lgkmcnt(4)
    v_mfma_f32_16x16x32_bf16 v[92:95], v[108:111], v[84:87], v[92:95]
    s_waitcnt lgkmcnt(3)
    v_mfma_f32_16x16x32_bf16 v[88:91], v[112:115], v[84:87], v[88:91]
    s_waitcnt lgkmcnt(2)
    v_mfma_f32_16x16x32_bf16 v[92:95], v[116:119], v[84:87], v[92:95]
    s_waitcnt lgkmcnt(1)
    v_mfma_f32_16x16x32_bf16 v[88:91], v[120:123], v[84:87], v[88:91]
    s_waitcnt lgkmcnt(0)
    v_mfma_f32_16x16x32_bf16 v[92:95], v[124:127], v[84:87], v[92:95]
    v_cvt_pk_bf16_f32 v80, v56, v57
    v_cvt_pk_bf16_f32 v81, v58, v59
    v_cvt_pk_bf16_f32 v82, v60, v61
    v_cvt_pk_bf16_f32 v83, v62, v63
    ds_write_b128 v17, v[80:83] offset:8192
    s_nop 0
    v_cvt_pk_bf16_f32 v128, v88, v89
    v_cvt_pk_bf16_f32 v129, v90, v91
    v_cvt_pk_bf16_f32 v130, v92, v93
    v_cvt_pk_bf16_f32 v131, v94, v95
    s_nop 1
    v_mfma_f32_16x16x32_bf16 v[144:147], v[132:135], v[128:131], 0
    v_mfma_f32_16x16x32_bf16 v[148:151], v[136:139], v[128:131], 0
    v_mfma_f32_16x16x32_bf16 v[140:143], v[128:131], v[128:131], 0
    s_nop 1
    buffer_store_dwordx4 v[144:147], v3, s[4:7], s16 offen
    s_nop 1
    buffer_store_dwordx4 v[148:151], v3, s[4:7], s16 offen offset:128
    s_nop 1
    buffer_store_dwordx4 v[140:143], v4, s[4:7], s16 offen
    s_cmp_eq_u32 s15, 63
    s_waitcnt lgkmcnt(0)
    s_barrier
    s_cbranch_scc1 recur_fast_last0
    v_readfirstlane_b32 s85, v247
    s_add_u32 s94, s15, 2
    s_barrier
    s_nop 15
    s_mov_b32 s23, s25
    buffer_load_dwordx4 v[24:27], v8, s[4:7], s16 offen offset:0 sc1
    s_nop 11
    buffer_load_dwordx4 v[28:31], v8, s[4:7], s16 offen offset:1024 sc1
    s_nop 11
    buffer_load_dwordx4 v[32:35], v8, s[4:7], s16 offen offset:2048 sc1
    s_nop 11
    buffer_load_dwordx4 v[36:39], v8, s[4:7], s16 offen offset:3072 sc1
    s_waitcnt vmcnt(3)
    v_max3_u32 v19, v24, v25, v26
    v_max_u32 v19, v19, v27
    v_cmp_eq_u32 vcc, -1, v19
    s_nop 0
    s_cbranch_vccnz g_30F15_0
    v_smfmac_f32_16x16x64_bf16 v[64:67], v[24:27], a[192:199], v172
    v_smfmac_f32_16x16x64_bf16 v[68:71], v[24:27], a[224:231], v172
    s_waitcnt vmcnt(2)
    v_max3_u32 v19, v28, v29, v30
    v_max_u32 v19, v19, v31
    v_cmp_eq_u32 vcc, -1, v19
    s_nop 0
    s_cbranch_vccnz g_30F14_1
    v_smfmac_f32_16x16x64_bf16 v[64:67], v[28:31], a[200:207], v172
    v_smfmac_f32_16x16x64_bf16 v[68:71], v[28:31], a[232:239], v172
    s_waitcnt vmcnt(1)
    v_max3_u32 v19, v32, v33, v34
    v_max_u32 v19, v19, v35
    v_cmp_eq_u32 vcc, -1, v19
    s_nop 0
    s_cbranch_vccnz g_30F12_2
    v_smfmac_f32_16x16x64_bf16 v[64:67], v[32:35], a[208:215], v172
    v_smfmac_f32_16x16x64_bf16 v[68:71], v[32:35], a[240:247], v172
    s_waitcnt vmcnt(0)
    v_max3_u32 v19, v36, v37, v38
    v_max_u32 v19, v19, v39
    v_cmp_eq_u32 vcc, -1, v19
    s_nop 0
    s_cbranch_vccnz g_30F8_3
    v_smfmac_f32_16x16x64_bf16 v[64:67], v[36:39], a[216:223], v172
    v_smfmac_f32_16x16x64_bf16 v[68:71], v[36:39], a[248:255], v172
    s_nop 4
    v_cvt_pk_bf16_f32 v80, v64, v65
    v_cvt_pk_bf16_f32 v81, v66, v67
    s_nop 0
    v_cvt_pk_bf16_f32 v82, v68, v69
    v_cvt_pk_bf16_f32 v83, v70, v71
    ds_write_b128 v17, v[80:83] offset:9216
gc_31:
    s_waitcnt lgkmcnt(0)
    s_barrier
    s_mov_b32 s23, s25
fw_32:
    s_cmp_ge_u32 s85, s94
    s_cbranch_scc1 fo_33
    buffer_load_dword v247, v245, s[4:7], 0 offen sc1
    s_add_u32 s23, s23, 1
    s_waitcnt vmcnt(0)
    v_readfirstlane_b32 s85, v247
    s_cmp_lt_u32 s23, 200000
    s_cbranch_scc1 fw_32
    s_mov_b32 s25, 200000
fo_33:
    buffer_load_dwordx4 v[132:135], v12, s[4:7], s17 offen sc1
    buffer_load_dwordx4 v[136:139], v12, s[4:7], s17 offen offset:256 sc1
    s_add_u32 s17, s17, 2048
    s_min_u32 s17, s17, 17954816
    s_nop 15
    s_nop 15
    s_nop 15
    s_nop 15
    buffer_store_dwordx4 v[128:131], v14, s[4:7], s19 offen sc1
    s_add_u32 s19, s19, 512
    s_add_u32 s21, s15, 3
    s_min_u32 s21, s21, 64
    s_cmp_lt_u32 s85, s21
    s_cselect_b64 exec, 1, 0
    buffer_load_dword v247, v245, s[4:7], 0 offen sc1
    s_mov_b64 exec, -1
    v_mov_b32 v40, 0
    v_mov_b32 v41, 0
    v_mov_b32 v42, 0
    v_mov_b32 v43, 0
    v_mov_b32 v44, 0
    v_mov_b32 v45, 0
    v_mov_b32 v46, 0
    v_mov_b32 v47, 0
    v_mov_b32 v48, 0
    v_mov_b32 v49, 0
    v_mov_b32 v50, 0
    v_mov_b32 v51, 0
    v_mov_b32 v52, 0
    v_mov_b32 v53, 0
    v_mov_b32 v54, 0
    v_mov_b32 v55, 0
    v_mov_b32 v56, 0
    v_mov_b32 v57, 0
    v_mov_b32 v58, 0
    v_mov_b32 v59, 0
    v_mov_b32 v60, 0
    v_mov_b32 v61, 0
    v_mov_b32 v62, 0
    v_mov_b32 v63, 0
    v_mov_b32 v64, 0
    v_mov_b32 v65, 0
    v_mov_b32 v66, 0
    v_mov_b32 v67, 0
    v_mov_b32 v68, 0
    v_mov_b32 v69, 0
    v_mov_b32 v70, 0
    v_mov_b32 v71, 0
    s_mov_b32 s21, s16
    s_mov_b32 s16, s42
    s_mov_b32 s42, s43
    s_mov_b32 s43, s44
    s_mov_b32 s44, s21
    s_add_u32 s95, s95, 524288
    s_lshr_b32 s84, s95, 8
    s_and_b32 s84, s84, 8192
    s_xor_b32 s84, s84, s46
    s_add_u32 s84, s84, s95
    s_add_u32 s15, s15, 1
    s_barrier
    s_branch recur_fast_w0
g_28L15_0:
    s_waitcnt vmcnt(3)
    v_max3_u32 v19, v24, v25, v26
    v_max_u32 v19, v19, v27
    v_cmp_eq_u32 vcc, -1, v19
    s_nop 0
    s_cbranch_vccnz g_28F15_0
    v_smfmac_f32_16x16x64_bf16 v[40:43], v[24:27], a[0:7], v172
    v_smfmac_f32_16x16x64_bf16 v[44:47], v[24:27], a[64:71], v172
    v_smfmac_f32_16x16x64_bf16 v[48:51], v[24:27], a[32:39], v172
    v_smfmac_f32_16x16x64_bf16 v[52:55], v[24:27], a[96:103], v172
g_28L14_1:
    s_waitcnt vmcnt(2)
    v_max3_u32 v19, v28, v29, v30
    v_max_u32 v19, v19, v31
    v_cmp_eq_u32 vcc, -1, v19
    s_nop 0
    s_cbranch_vccnz g_28F14_1
    v_smfmac_f32_16x16x64_bf16 v[40:43], v[28:31], a[8:15], v172
    v_smfmac_f32_16x16x64_bf16 v[44:47], v[28:31], a[72:79], v172
    v_smfmac_f32_16x16x64_bf16 v[48:51], v[28:31], a[40:47], v172
    v_smfmac_f32_16x16x64_bf16 v[52:55], v[28:31], a[104:111], v172
g_28L12_2:
    s_waitcnt vmcnt(1)
    v_max3_u32 v19, v32, v33, v34
    v_max_u32 v19, v19, v35
    v_cmp_eq_u32 vcc, -1, v19
    s_nop 0
    s_cbranch_vccnz g_28F12_2
    v_smfmac_f32_16x16x64_bf16 v[40:43], v[32:35], a[16:23], v172
    v_smfmac_f32_16x16x64_bf16 v[44:47], v[32:35], a[80:87], v172
    v_smfmac_f32_16x16x64_bf16 v[48:51], v[32:35], a[48:55], v172
    v_smfmac_f32_16x16x64_bf16 v[52:55], v[32:35], a[112:119], v172
g_28L8_3:
    s_waitcnt vmcnt(0)
    v_max3_u32 v19, v36, v37, v38
    v_max_u32 v19, v19, v39
    v_cmp_eq_u32 vcc, -1, v19
    s_nop 0
    s_cbranch_vccnz g_28F8_3
    v_smfmac_f32_16x16x64_bf16 v[40:43], v[36:39], a[24:31], v172
    v_smfmac_f32_16x16x64_bf16 v[44:47], v[36:39], a[88:95], v172
    v_smfmac_f32_16x16x64_bf16 v[48:51], v[36:39], a[56:63], v172
    v_smfmac_f32_16x16x64_bf16 v[52:55], v[36:39], a[120:127], v172
    s_branch gc_29
g_28L15_1:
    s_waitcnt vmcnt(3)
    v_max3_u32 v19, v28, v29, v30
    v_max_u32 v19, v19, v31
    v_cmp_eq_u32 vcc, -1, v19
    s_nop 0
    s_cbranch_vccnz g_28F15_1
    v_smfmac_f32_16x16x64_bf16 v[40:43], v[28:31], a[8:15], v172
    v_smfmac_f32_16x16x64_bf16 v[44:47], v[28:31], a[72:79], v172
    v_smfmac_f32_16x16x64_bf16 v[48:51], v[28:31], a[40:47], v172
    v_smfmac_f32_16x16x64_bf16 v[52:55], v[28:31], a[104:111], v172
g_28L13_2:
    s_waitcnt vmcnt(2)
    v_max3_u32 v19, v32, v33, v34
    v_max_u32 v19, v19, v35
    v_cmp_eq_u32 vcc, -1, v19
    s_nop 0
    s_cbranch_vccnz g_28F13_2
    v_smfmac_f32_16x16x64_bf16 v[40:43], v[32:35], a[16:23], v172
    v_smfmac_f32_16x16x64_bf16 v[44:47], v[32:35], a[80:87], v172
    v_smfmac_f32_16x16x64_bf16 v[48:51], v[32:35], a[48:55], v172
    v_smfmac_f32_16x16x64_bf16 v[52:55], v[32:35], a[112:119], v172
g_28L9_3:
    s_waitcnt vmcnt(1)
    v_max3_u32 v19, v36, v37, v38
    v_max_u32 v19, v19, v39
    v_cmp_eq_u32 vcc, -1, v19
    s_nop 0
    s_cbranch_vccnz g_28F9_3
    v_smfmac_f32_16x16x64_bf16 v[40:43], v[36:39], a[24:31], v172
    v_smfmac_f32_16x16x64_bf16 v[44:47], v[36:39], a[88:95], v172
    v_smfmac_f32_16x16x64_bf16 v[48:51], v[36:39], a[56:63], v172
    v_smfmac_f32_16x16x64_bf16 v[52:55], v[36:39], a[120:127], v172
g_28L1_0:
    s_waitcnt vmcnt(0)
    v_max3_u32 v19, v24, v25, v26
    v_max_u32 v19, v19, v27
    v_cmp_eq_u32 vcc, -1, v19
    s_nop 0
    s_cbranch_vccnz g_28F1_0
    v_smfmac_f32_16x16x64_bf16 v[40:43], v[24:27], a[0:7], v172
    v_smfmac_f32_16x16x64_bf16 v[44:47], v[24:27], a[64:71], v172
    v_smfmac_f32_16x16x64_bf16 v[48:51], v[24:27], a[32:39], v172
    v_smfmac_f32_16x16x64_bf16 v[52:55], v[24:27], a[96:103], v172
    s_branch gc_29
g_28L15_2:
    s_waitcnt vmcnt(3)
    v_max3_u32 v19, v32, v33, v34
    v_max_u32 v19, v19, v35
    v_cmp_eq_u32 vcc, -1, v19
    s_nop 0
    s_cbranch_vccnz g_28F15_2
    v_smfmac_f32_16x16x64_bf16 v[40:43], v[32:35], a[16:23], v172
    v_smfmac_f32_16x16x64_bf16 v[44:47], v[32:35], a[80:87], v172
    v_smfmac_f32_16x16x64_bf16 v[48:51], v[32:35], a[48:55], v172
    v_smfmac_f32_16x16x64_bf16 v[52:55], v[32:35], a[112:119], v172
g_28L11_3:
    s_waitcnt vmcnt(2)
    v_max3_u32 v19, v36, v37, v38
    v_max_u32 v19, v19, v39
    v_cmp_eq_u32 vcc, -1, v19
    s_nop 0
    s_cbranch_vccnz g_28F11_3
    v_smfmac_f32_16x16x64_bf16 v[40:43], v[36:39], a[24:31], v172
    v_smfmac_f32_16x16x64_bf16 v[44:47], v[36:39], a[88:95], v172
    v_smfmac_f32_16x16x64_bf16 v[48:51], v[36:39], a[56:63], v172
    v_smfmac_f32_16x16x64_bf16 v[52:55], v[36:39], a[120:127], v172
g_28L3_0:
    s_waitcnt vmcnt(1)
    v_max3_u32 v19, v24, v25, v26
    v_max_u32 v19, v19, v27
    v_cmp_eq_u32 vcc, -1, v19
    s_nop 0
    s_cbranch_vccnz g_28F3_0
    v_smfmac_f32_16x16x64_bf16 v[40:43], v[24:27], a[0:7], v172
    v_smfmac_f32_16x16x64_bf16 v[44:47], v[24:27], a[64:71], v172
    v_smfmac_f32_16x16x64_bf16 v[48:51], v[24:27], a[32:39], v172
    v_smfmac_f32_16x16x64_bf16 v[52:55], v[24:27], a[96:103], v172
g_28L2_1:
    s_waitcnt vmcnt(0)
    v_max3_u32 v19, v28, v29, v30
    v_max_u32 v19, v19, v31
    v_cmp_eq_u32 vcc, -1, v19
    s_nop 0
    s_cbranch_vccnz g_28F2_1
    v_smfmac_f32_16x16x64_bf16 v[40:43], v[28:31], a[8:15], v172
    v_smfmac_f32_16x16x64_bf16 v[44:47], v[28:31], a[72:79], v172
    v_smfmac_f32_16x16x64_bf16 v[48:51], v[28:31], a[40:47], v172
    v_smfmac_f32_16x16x64_bf16 v[52:55], v[28:31], a[104:111], v172
    s_branch gc_29
g_28L15_3:
    s_waitcnt vmcnt(3)
    v_max3_u32 v19, v36, v37, v38
    v_max_u32 v19, v19, v39
    v_cmp_eq_u32 vcc, -1, v19
    s_nop 0
    s_cbranch_vccnz g_28F15_3
    v_smfmac_f32_16x16x64_bf16 v[40:43], v[36:39], a[24:31], v172
    v_smfmac_f32_16x16x64_bf16 v[44:47], v[36:39], a[88:95], v172
    v_smfmac_f32_16x16x64_bf16 v[48:51], v[36:39], a[56:63], v172
    v_smfmac_f32_16x16x64_bf16 v[52:55], v[36:39], a[120:127], v172
g_28L7_0:
    s_waitcnt vmcnt(2)
    v_max3_u32 v19, v24, v25, v26
    v_max_u32 v19, v19, v27
    v_cmp_eq_u32 vcc, -1, v19
    s_nop 0
    s_cbranch_vccnz g_28F7_0
    v_smfmac_f32_16x16x64_bf16 v[40:43], v[24:27], a[0:7], v172
    v_smfmac_f32_16x16x64_bf16 v[44:47], v[24:27], a[64:71], v172
    v_smfmac_f32_16x16x64_bf16 v[48:51], v[24:27], a[32:39], v172
    v_smfmac_f32_16x16x64_bf16 v[52:55], v[24:27], a[96:103], v172
g_28L6_1:
    s_waitcnt vmcnt(1)
    v_max3_u32 v19, v28, v29, v30
    v_max_u32 v19, v19, v31
    v_cmp_eq_u32 vcc, -1, v19
    s_nop 0
    s_cbranch_vccnz g_28F6_1
    v_smfmac_f32_16x16x64_bf16 v[40:43], v[28:31], a[8:15], v172
    v_smfmac_f32_16x16x64_bf16 v[44:47], v[28:31], a[72:79], v172
    v_smfmac_f32_16x16x64_bf16 v[48:51], v[28:31], a[40:47], v172
    v_smfmac_f32_16x16x64_bf16 v[52:55], v[28:31], a[104:111], v172
g_28L4_2:
    s_waitcnt vmcnt(0)
    v_max3_u32 v19, v32, v33, v34
    v_max_u32 v19, v19, v35
    v_cmp_eq_u32 vcc, -1, v19
    s_nop 0
    s_cbranch_vccnz g_28F4_2
    v_smfmac_f32_16x16x64_bf16 v[40:43], v[32:35], a[16:23], v172
    v_smfmac_f32_16x16x64_bf16 v[44:47], v[32:35], a[80:87], v172
    v_smfmac_f32_16x16x64_bf16 v[48:51], v[32:35], a[48:55], v172
    v_smfmac_f32_16x16x64_bf16 v[52:55], v[32:35], a[112:119], v172
    s_branch gc_29
g_28L7_1:
    s_waitcnt vmcnt(2)
    v_max3_u32 v19, v28, v29, v30
    v_max_u32 v19, v19, v31
    v_cmp_eq_u32 vcc, -1, v19
    s_nop 0
    s_cbranch_vccnz g_28F7_1
    v_smfmac_f32_16x16x64_bf16 v[40:43], v[28:31], a[8:15], v172
    v_smfmac_f32_16x16x64_bf16 v[44:47], v[28:31], a[72:79], v172
    v_smfmac_f32_16x16x64_bf16 v[48:51], v[28:31], a[40:47], v172
    v_smfmac_f32_16x16x64_bf16 v[52:55], v[28:31], a[104:111], v172
g_28L5_2:
    s_waitcnt vmcnt(1)
    v_max3_u32 v19, v32, v33, v34
    v_max_u32 v19, v19, v35
    v_cmp_eq_u32 vcc, -1, v19
    s_nop 0
    s_cbranch_vccnz g_28F5_2
    v_smfmac_f32_16x16x64_bf16 v[40:43], v[32:35], a[16:23], v172
    v_smfmac_f32_16x16x64_bf16 v[44:47], v[32:35], a[80:87], v172
    v_smfmac_f32_16x16x64_bf16 v[48:51], v[32:35], a[48:55], v172
    v_smfmac_f32_16x16x64_bf16 v[52:55], v[32:35], a[112:119], v172
    s_branch g_28L1_0
g_28L7_2:
    s_waitcnt vmcnt(2)
    v_max3_u32 v19, v32, v33, v34
    v_max_u32 v19, v19, v35
    v_cmp_eq_u32 vcc, -1, v19
    s_nop 0
    s_cbranch_vccnz g_28F7_2
    v_smfmac_f32_16x16x64_bf16 v[40:43], v[32:35], a[16:23], v172
    v_smfmac_f32_16x16x64_bf16 v[44:47], v[32:35], a[80:87], v172
    v_smfmac_f32_16x16x64_bf16 v[48:51], v[32:35], a[48:55], v172
    v_smfmac_f32_16x16x64_bf16 v[52:55], v[32:35], a[112:119], v172
    s_branch g_28L3_0
g_28L11_0:
    s_waitcnt vmcnt(2)
    v_max3_u32 v19, v24, v25, v26
    v_max_u32 v19, v19, v27
    v_cmp_eq_u32 vcc, -1, v19
    s_nop 0
    s_cbranch_vccnz g_28F11_0
    v_smfmac_f32_16x16x64_bf16 v[40:43], v[24:27], a[0:7], v172
    v_smfmac_f32_16x16x64_bf16 v[44:47], v[24:27], a[64:71], v172
    v_smfmac_f32_16x16x64_bf16 v[48:51], v[24:27], a[32:39], v172
    v_smfmac_f32_16x16x64_bf16 v[52:55], v[24:27], a[96:103], v172
g_28L10_1:
    s_waitcnt vmcnt(1)
    v_max3_u32 v19, v28, v29, v30
    v_max_u32 v19, v19, v31
    v_cmp_eq_u32 vcc, -1, v19
    s_nop 0
    s_cbranch_vccnz g_28F10_1
    v_smfmac_f32_16x16x64_bf16 v[40:43], v[28:31], a[8:15], v172
    v_smfmac_f32_16x16x64_bf16 v[44:47], v[28:31], a[72:79], v172
    v_smfmac_f32_16x16x64_bf16 v[48:51], v[28:31], a[40:47], v172
    v_smfmac_f32_16x16x64_bf16 v[52:55], v[28:31], a[104:111], v172
    s_branch g_28L8_3
g_28L11_1:
    s_waitcnt vmcnt(2)
    v_max3_u32 v19, v28, v29, v30
    v_max_u32 v19, v19, v31
    v_cmp_eq_u32 vcc, -1, v19
    s_nop 0
    s_cbranch_vccnz g_28F11_1
    v_smfmac_f32_16x16x64_bf16 v[40:43], v[28:31], a[8:15], v172
    v_smfmac_f32_16x16x64_bf16 v[44:47], v[28:31], a[72:79], v172
    v_smfmac_f32_16x16x64_bf16 v[48:51], v[28:31], a[40:47], v172
    v_smfmac_f32_16x16x64_bf16 v[52:55], v[28:31], a[104:111], v172
    s_branch g_28L9_3
g_28L13_0:
    s_waitcnt vmcnt(2)
    v_max3_u32 v19, v24, v25, v26
    v_max_u32 v19, v19, v27
    v_cmp_eq_u32 vcc, -1, v19
    s_nop 0
    s_cbranch_vccnz g_28F13_0
    v_smfmac_f32_16x16x64_bf16 v[40:43], v[24:27], a[0:7], v172
    v_smfmac_f32_16x16x64_bf16 v[44:47], v[24:27], a[64:71], v172
    v_smfmac_f32_16x16x64_bf16 v[48:51], v[24:27], a[32:39], v172
    v_smfmac_f32_16x16x64_bf16 v[52:55], v[24:27], a[96:103], v172
    s_branch g_28L12_2
g_28L13_3:
    s_waitcnt vmcnt(2)
    v_max3_u32 v19, v36, v37, v38
    v_max_u32 v19, v19, v39
    v_cmp_eq_u32 vcc, -1, v19
    s_nop 0
    s_cbranch_vccnz g_28F13_3
    v_smfmac_f32_16x16x64_bf16 v[40:43], v[36:39], a[24:31], v172
    v_smfmac_f32_16x16x64_bf16 v[44:47], v[36:39], a[88:95], v172
    v_smfmac_f32_16x16x64_bf16 v[48:51], v[36:39], a[56:63], v172
    v_smfmac_f32_16x16x64_bf16 v[52:55], v[36:39], a[120:127], v172
g_28L5_0:
    s_waitcnt vmcnt(1)
    v_max3_u32 v19, v24, v25, v26
    v_max_u32 v19, v19, v27
    v_cmp_eq_u32 vcc, -1, v19
    s_nop 0
    s_cbranch_vccnz g_28F5_0
    v_smfmac_f32_16x16x64_bf16 v[40:43], v[24:27], a[0:7], v172
    v_smfmac_f32_16x16x64_bf16 v[44:47], v[24:27], a[64:71], v172
    v_smfmac_f32_16x16x64_bf16 v[48:51], v[24:27], a[32:39], v172
    v_smfmac_f32_16x16x64_bf16 v[52:55], v[24:27], a[96:103], v172
    s_branch g_28L4_2
g_28L14_2:
    s_waitcnt vmcnt(2)
    v_max3_u32 v19, v32, v33, v34
    v_max_u32 v19, v19, v35
    v_cmp_eq_u32 vcc, -1, v19
    s_nop 0
    s_cbranch_vccnz g_28F14_2
    v_smfmac_f32_16x16x64_bf16 v[40:43], v[32:35], a[16:23], v172
    v_smfmac_f32_16x16x64_bf16 v[44:47], v[32:35], a[80:87], v172
    v_smfmac_f32_16x16x64_bf16 v[48:51], v[32:35], a[48:55], v172
    v_smfmac_f32_16x16x64_bf16 v[52:55], v[32:35], a[112:119], v172
g_28L10_3:
    s_waitcnt vmcnt(1)
    v_max3_u32 v19, v36, v37, v38
    v_max_u32 v19, v19, v39
    v_cmp_eq_u32 vcc, -1, v19
    s_nop 0
    s_cbranch_vccnz g_28F10_3
    v_smfmac_f32_16x16x64_bf16 v[40:43], v[36:39], a[24:31], v172
    v_smfmac_f32_16x16x64_bf16 v[44:47], v[36:39], a[88:95], v172
    v_smfmac_f32_16x16x64_bf16 v[48:51], v[36:39], a[56:63], v172
    v_smfmac_f32_16x16x64_bf16 v[52:55], v[36:39], a[120:127], v172
    s_branch g_28L2_1
g_28L14_3:
    s_waitcnt vmcnt(2)
    v_max3_u32 v19, v36, v37, v38
    v_max_u32 v19, v19, v39
    v_cmp_eq_u32 vcc, -1, v19
    s_nop 0
    s_cbranch_vccnz g_28F14_3
    v_smfmac_f32_16x16x64_bf16 v[40:43], v[36:39], a[24:31], v172
    v_smfmac_f32_16x16x64_bf16 v[44:47], v[36:39], a[88:95], v172
    v_smfmac_f32_16x16x64_bf16 v[48:51], v[36:39], a[56:63], v172
    v_smfmac_f32_16x16x64_bf16 v[52:55], v[36:39], a[120:127], v172
    s_branch g_28L6_1
g_28L3_1:
    s_waitcnt vmcnt(1)
    v_max3_u32 v19, v28, v29, v30
    v_max_u32 v19, v19, v31
    v_cmp_eq_u32 vcc, -1, v19
    s_nop 0
    s_cbranch_vccnz g_28F3_1
    v_smfmac_f32_16x16x64_bf16 v[40:43], v[28:31], a[8:15], v172
    v_smfmac_f32_16x16x64_bf16 v[44:47], v[28:31], a[72:79], v172
    v_smfmac_f32_16x16x64_bf16 v[48:51], v[28:31], a[40:47], v172
    v_smfmac_f32_16x16x64_bf16 v[52:55], v[28:31], a[104:111], v172
    s_branch g_28L1_0
g_28L6_2:
    s_waitcnt vmcnt(1)
    v_max3_u32 v19, v32, v33, v34
    v_max_u32 v19, v19, v35
    v_cmp_eq_u32 vcc, -1, v19
    s_nop 0
    s_cbranch_vccnz g_28F6_2
    v_smfmac_f32_16x16x64_bf16 v[40:43], v[32:35], a[16:23], v172
    v_smfmac_f32_16x16x64_bf16 v[44:47], v[32:35], a[80:87], v172
    v_smfmac_f32_16x16x64_bf16 v[48:51], v[32:35], a[48:55], v172
    v_smfmac_f32_16x16x64_bf16 v[52:55], v[32:35], a[112:119], v172
    s_branch g_28L2_1
g_28L9_0:
    s_waitcnt vmcnt(1)
    v_max3_u32 v19, v24, v25, v26
    v_max_u32 v19, v19, v27
    v_cmp_eq_u32 vcc, -1, v19
    s_nop 0
    s_cbranch_vccnz g_28F9_0
    v_smfmac_f32_16x16x64_bf16 v[40:43], v[24:27], a[0:7], v172
    v_smfmac_f32_16x16x64_bf16 v[44:47], v[24:27], a[64:71], v172
    v_smfmac_f32_16x16x64_bf16 v[48:51], v[24:27], a[32:39], v172
    v_smfmac_f32_16x16x64_bf16 v[52:55], v[24:27], a[96:103], v172
    s_branch g_28L8_3
g_28L12_3:
    s_waitcnt vmcnt(1)
    v_max3_u32 v19, v36, v37, v38
    v_max_u32 v19, v19, v39
    v_cmp_eq_u32 vcc, -1, v19
    s_nop 0
    s_cbranch_vccnz g_28F12_3
    v_smfmac_f32_16x16x64_bf16 v[40:43], v[36:39], a[24:31], v172
    v_smfmac_f32_16x16x64_bf16 v[44:47], v[36:39], a[88:95], v172
    v_smfmac_f32_16x16x64_bf16 v[48:51], v[36:39], a[56:63], v172
    v_smfmac_f32_16x16x64_bf16 v[52:55], v[36:39], a[120:127], v172
    s_branch g_28L4_2
g_28F15_0:
    s_mov_b64 exec, vcc
    buffer_load_dwordx4 v[24:27], v2, s[4:7], s16 offen offset:0 sc1
    s_mov_b64 exec, -1
    s_add_u32 s23, s23, 1
    s_cmp_lt_u32 s23, 200000
    s_cbranch_scc1 g_28L15_1
    s_mov_b32 s25, 200000
    s_branch gc_29
g_28F15_1:
    s_mov_b64 exec, vcc
    buffer_load_dwordx4 v[28:31], v2, s[4:7], s16 offen offset:1024 sc1
    s_mov_b64 exec, -1
    s_add_u32 s23, s23, 1
    s_cmp_lt_u32 s23, 200000
    s_cbranch_scc1 g_28L15_2
    s_mov_b32 s25, 200000
    s_branch gc_29
g_28F15_2:
    s_mov_b64 exec, vcc
    buffer_load_dwordx4 v[32:35], v2, s[4:7], s16 offen offset:2048 sc1
    s_mov_b64 exec, -1
    s_add_u32 s23, s23, 1
    s_cmp_lt_u32 s23, 200000
    s_cbranch_scc1 g_28L15_3
    s_mov_b32 s25, 200000
    s_branch gc_29
g_28F15_3:
    s_mov_b64 exec, vcc
    buffer_load_dwordx4 v[36:39], v2, s[4:7], s16 offen offset:3072 sc1
    s_mov_b64 exec, -1
    s_add_u32 s23, s23, 1
    s_cmp_lt_u32 s23, 200000
    s_cbranch_scc1 g_28L15_0
    s_mov_b32 s25, 200000
    s_branch gc_29
g_28F7_0:
    s_mov_b64 exec, vcc
    buffer_load_dwordx4 v[24:27], v2, s[4:7], s16 offen offset:0 sc1
    s_mov_b64 exec, -1
    s_add_u32 s23, s23, 1
    s_cmp_lt_u32 s23, 200000
    s_cbranch_scc1 g_28L7_1
    s_mov_b32 s25, 200000
    s_branch gc_29
g_28F7_1:
    s_mov_b64 exec, vcc
    buffer_load_dwordx4 v[28:31], v2, s[4:7], s16 offen offset:1024 sc1
    s_mov_b64 exec, -1
    s_add_u32 s23, s23, 1
    s_cmp_lt_u32 s23, 200000
    s_cbranch_scc1 g_28L7_2
    s_mov_b32 s25, 200000
    s_branch gc_29
g_28F7_2:
    s_mov_b64 exec, vcc
    buffer_load_dwordx4 v[32:35], v2, s[4:7], s16 offen offset:2048 sc1
    s_mov_b64 exec, -1
    s_add_u32 s23, s23, 1
    s_cmp_lt_u32 s23, 200000
    s_cbranch_scc1 g_28L7_0
    s_mov_b32 s25, 200000
    s_branch gc_29
g_28F11_0:
    s_mov_b64 exec, vcc
    buffer_load_dwordx4 v[24:27], v2, s[4:7], s16 offen offset:0 sc1
    s_mov_b64 exec, -1
    s_add_u32 s23, s23, 1
    s_cmp_lt_u32 s23, 200000
    s_cbranch_scc1 g_28L11_1
    s_mov_b32 s25, 200000
    s_branch gc_29
g_28F11_1:
    s_mov_b64 exec, vcc
    buffer_load_dwordx4 v[28:31], v2, s[4:7], s16 offen offset:1024 sc1
    s_mov_b64 exec, -1
    s_add_u32 s23, s23, 1
    s_cmp_lt_u32 s23, 200000
    s_cbranch_scc1 g_28L11_3
    s_mov_b32 s25, 200000
    s_branch gc_29
g_28F11_3:
    s_mov_b64 exec, vcc
    buffer_load_dwordx4 v[36:39], v2, s[4:7], s16 offen offset:3072 sc1
    s_mov_b64 exec, -1
    s_add_u32 s23, s23, 1
    s_cmp_lt_u32 s23, 200000
    s_cbranch_scc1 g_28L11_0
    s_mov_b32 s25, 200000
    s_branch gc_29
g_28F13_0:
    s_mov_b64 exec, vcc
    buffer_load_dwordx4 v[24:27], v2, s[4:7], s16 offen offset:0 sc1
    s_mov_b64 exec, -1
    s_add_u32 s23, s23, 1
    s_cmp_lt_u32 s23, 200000
    s_cbranch_scc1 g_28L13_2
    s_mov_b32 s25, 200000
    s_branch gc_29
g_28F13_2:
    s_mov_b64 exec, vcc
    buffer_load_dwordx4 v[32:35], v2, s[4:7], s16 offen offset:2048 sc1
    s_mov_b64 exec, -1
    s_add_u32 s23, s23, 1
    s_cmp_lt_u32 s23, 200000
    s_cbranch_scc1 g_28L13_3
    s_mov_b32 s25, 200000
    s_branch gc_29
g_28F13_3:
    s_mov_b64 exec, vcc
    buffer_load_dwordx4 v[36:39], v2, s[4:7], s16 offen offset:3072 sc1
    s_mov_b64 exec, -1
    s_add_u32 s23, s23, 1
    s_cmp_lt_u32 s23, 200000
    s_cbranch_scc1 g_28L13_0
    s_mov_b32 s25, 200000
    s_branch gc_29
g_28F14_1:
    s_mov_b64 exec, vcc
    buffer_load_dwordx4 v[28:31], v2, s[4:7], s16 offen offset:1024 sc1
    s_mov_b64 exec, -1
    s_add_u32 s23, s23, 1
    s_cmp_lt_u32 s23, 200000
    s_cbranch_scc1 g_28L14_2
    s_mov_b32 s25, 200000
    s_branch gc_29
g_28F14_2:
    s_mov_b64 exec, vcc
    buffer_load_dwordx4 v[32:35], v2, s[4:7], s16 offen offset:2048 sc1
    s_mov_b64 exec, -1
    s_add_u32 s23, s23, 1
    s_cmp_lt_u32 s23, 200000
    s_cbranch_scc1 g_28L14_3
    s_mov_b32 s25, 200000
    s_branch gc_29
g_28F14_3:
    s_mov_b64 exec, vcc
    buffer_load_dwordx4 v[36:39], v2, s[4:7], s16 offen offset:3072 sc1
    s_mov_b64 exec, -1
    s_add_u32 s23, s23, 1
    s_cmp_lt_u32 s23, 200000
    s_cbranch_scc1 g_28L14_1
    s_mov_b32 s25, 200000
    s_branch gc_29
g_28F3_0:
    s_mov_b64 exec, vcc
    buffer_load_dwordx4 v[24:27], v2, s[4:7], s16 offen offset:0 sc1
    s_mov_b64 exec, -1
    s_add_u32 s23, s23, 1
    s_cmp_lt_u32 s23, 200000
    s_cbranch_scc1 g_28L3_1
    s_mov_b32 s25, 200000
    s_branch gc_29
g_28F3_1:
    s_mov_b64 exec, vcc
    buffer_load_dwordx4 v[28:31], v2, s[4:7], s16 offen offset:1024 sc1
    s_mov_b64 exec, -1
    s_add_u32 s23, s23, 1
    s_cmp_lt_u32 s23, 200000
    s_cbranch_scc1 g_28L3_0
    s_mov_b32 s25, 200000
    s_branch gc_29
g_28F5_0:
    s_mov_b64 exec, vcc
    buffer_load_dwordx4 v[24:27], v2, s[4:7], s16 offen offset:0 sc1
    s_mov_b64 exec, -1
    s_add_u32 s23, s23, 1
    s_cmp_lt_u32 s23, 200000
    s_cbranch_scc1 g_28L5_2
    s_mov_b32 s25, 200000
    s_branch gc_29
g_28F5_2:
    s_mov_b64 exec, vcc
    buffer_load_dwordx4 v[32:35], v2, s[4:7], s16 offen offset:2048 sc1
    s_mov_b64 exec, -1
    s_add_u32 s23, s23, 1
    s_cmp_lt_u32 s23, 200000
    s_cbranch_scc1 g_28L5_0
    s_mov_b32 s25, 200000
    s_branch gc_29
g_28F6_1:
    s_mov_b64 exec, vcc
    buffer_load_dwordx4 v[28:31], v2, s[4:7], s16 offen offset:1024 sc1
    s_mov_b64 exec, -1
    s_add_u32 s23, s23, 1
    s_cmp_lt_u32 s23, 200000
    s_cbranch_scc1 g_28L6_2
    s_mov_b32 s25, 200000
    s_branch gc_29
g_28F6_2:
    s_mov_b64 exec, vcc
    buffer_load_dwordx4 v[32:35], v2, s[4:7], s16 offen offset:2048 sc1
    s_mov_b64 exec, -1
    s_add_u32 s23, s23, 1
    s_cmp_lt_u32 s23, 200000
    s_cbranch_scc1 g_28L6_1
    s_mov_b32 s25, 200000
    s_branch gc_29
g_28F9_0:
    s_mov_b64 exec, vcc
    buffer_load_dwordx4 v[24:27], v2, s[4:7], s16 offen offset:0 sc1
    s_mov_b64 exec, -1
    s_add_u32 s23, s23, 1
    s_cmp_lt_u32 s23, 200000
    s_cbranch_scc1 g_28L9_3
    s_mov_b32 s25, 200000
    s_branch gc_29
g_28F9_3:
    s_mov_b64 exec, vcc
    buffer_load_dwordx4 v[36:39], v2, s[4:7], s16 offen offset:3072 sc1
    s_mov_b64 exec, -1
    s_add_u32 s23, s23, 1
    s_cmp_lt_u32 s23, 200000
    s_cbranch_scc1 g_28L9_0
    s_mov_b32 s25, 200000
    s_branch gc_29
g_28F10_1:
    s_mov_b64 exec, vcc
    buffer_load_dwordx4 v[28:31], v2, s[4:7], s16 offen offset:1024 sc1
    s_mov_b64 exec, -1
    s_add_u32 s23, s23, 1
    s_cmp_lt_u32 s23, 200000
    s_cbranch_scc1 g_28L10_3
    s_mov_b32 s25, 200000
    s_branch gc_29
g_28F10_3:
    s_mov_b64 exec, vcc
    buffer_load_dwordx4 v[36:39], v2, s[4:7], s16 offen offset:3072 sc1
    s_mov_b64 exec, -1
    s_add_u32 s23, s23, 1
    s_cmp_lt_u32 s23, 200000
    s_cbranch_scc1 g_28L10_1
    s_mov_b32 s25, 200000
    s_branch gc_29
g_28F12_2:
    s_mov_b64 exec, vcc
    buffer_load_dwordx4 v[32:35], v2, s[4:7], s16 offen offset:2048 sc1
    s_mov_b64 exec, -1
    s_add_u32 s23, s23, 1
    s_cmp_lt_u32 s23, 200000
    s_cbranch_scc1 g_28L12_3
    s_mov_b32 s25, 200000
    s_branch gc_29
g_28F12_3:
    s_mov_b64 exec, vcc
    buffer_load_dwordx4 v[36:39], v2, s[4:7], s16 offen offset:3072 sc1
    s_mov_b64 exec, -1
    s_add_u32 s23, s23, 1
    s_cmp_lt_u32 s23, 200000
    s_cbranch_scc1 g_28L12_2
    s_mov_b32 s25, 200000
    s_branch gc_29
g_28F1_0:
    s_mov_b64 exec, vcc
    buffer_load_dwordx4 v[24:27], v2, s[4:7], s16 offen offset:0 sc1
    s_mov_b64 exec, -1
    s_add_u32 s23, s23, 1
    s_cmp_lt_u32 s23, 200000
    s_cbranch_scc1 g_28L1_0
    s_mov_b32 s25, 200000
    s_branch gc_29
g_28F2_1:
    s_mov_b64 exec, vcc
    buffer_load_dwordx4 v[28:31], v2, s[4:7], s16 offen offset:1024 sc1
    s_mov_b64 exec, -1
    s_add_u32 s23, s23, 1
    s_cmp_lt_u32 s23, 200000
    s_cbranch_scc1 g_28L2_1
    s_mov_b32 s25, 200000
    s_branch gc_29
g_28F4_2:
    s_mov_b64 exec, vcc
    buffer_load_dwordx4 v[32:35], v2, s[4:7], s16 offen offset:2048 sc1
    s_mov_b64 exec, -1
    s_add_u32 s23, s23, 1
    s_cmp_lt_u32 s23, 200000
    s_cbranch_scc1 g_28L4_2
    s_mov_b32 s25, 200000
    s_branch gc_29
g_28F8_3:
    s_mov_b64 exec, vcc
    buffer_load_dwordx4 v[36:39], v2, s[4:7], s16 offen offset:3072 sc1
    s_mov_b64 exec, -1
    s_add_u32 s23, s23, 1
    s_cmp_lt_u32 s23, 200000
    s_cbranch_scc1 g_28L8_3
    s_mov_b32 s25, 200000
    s_branch gc_29
recur_fast_last0:
    buffer_store_dwordx4 v[128:131], v14, s[4:7], s19 offen sc1
    s_waitcnt vmcnt(0)
    s_branch recur_end
g_30L15_0:
    s_waitcnt vmcnt(3)
    v_max3_u32 v19, v24, v25, v26
    v_max_u32 v19, v19, v27
    v_cmp_eq_u32 vcc, -1, v19
    s_nop 0
    s_cbranch_vccnz g_30F15_0
    v_smfmac_f32_16x16x64_bf16 v[64:67], v[24:27], a[192:199], v172
    v_smfmac_f32_16x16x64_bf16 v[68:71], v[24:27], a[224:231], v172
g_30L14_1:
    s_waitcnt vmcnt(2)
    v_max3_u32 v19, v28, v29, v30
    v_max_u32 v19, v19, v31
    v_cmp_eq_u32 vcc, -1, v19
    s_nop 0
    s_cbranch_vccnz g_30F14_1
    v_smfmac_f32_16x16x64_bf16 v[64:67], v[28:31], a[200:207], v172
    v_smfmac_f32_16x16x64_bf16 v[68:71], v[28:31], a[232:239], v172
g_30L12_2:
    s_waitcnt vmcnt(1)
    v_max3_u32 v19, v32, v33, v34
    v_max_u32 v19, v19, v35
    v_cmp_eq_u32 vcc, -1, v19
    s_nop 0
    s_cbranch_vccnz g_30F12_2
    v_smfmac_f32_16x16x64_bf16 v[64:67], v[32:35], a[208:215], v172
    v_smfmac_f32_16x16x64_bf16 v[68:71], v[32:35], a[240:247], v172
g_30L8_3:
    s_waitcnt vmcnt(0)
    v_max3_u32 v19, v36, v37, v38
    v_max_u32 v19, v19, v39
    v_cmp_eq_u32 vcc, -1, v19
    s_nop 0
    s_cbranch_vccnz g_30F8_3
    v_smfmac_f32_16x16x64_bf16 v[64:67], v[36:39], a[216:223], v172
    v_smfmac_f32_16x16x64_bf16 v[68:71], v[36:39], a[248:255], v172
    s_nop 4
    v_cvt_pk_bf16_f32 v80, v64, v65
    v_cvt_pk_bf16_f32 v81, v66, v67
    s_nop 0
    v_cvt_pk_bf16_f32 v82, v68, v69
    v_cvt_pk_bf16_f32 v83, v70, v71
    ds_write_b128 v17, v[80:83] offset:9216
    s_branch gc_31
g_30L15_1:
    s_waitcnt vmcnt(3)
    v_max3_u32 v19, v28, v29, v30
    v_max_u32 v19, v19, v31
    v_cmp_eq_u32 vcc, -1, v19
    s_nop 0
    s_cbranch_vccnz g_30F15_1
    v_smfmac_f32_16x16x64_bf16 v[64:67], v[28:31], a[200:207], v172
    v_smfmac_f32_16x16x64_bf16 v[68:71], v[28:31], a[232:239], v172
g_30L13_2:
    s_waitcnt vmcnt(2)
    v_max3_u32 v19, v32, v33, v34
    v_max_u32 v19, v19, v35
    v_cmp_eq_u32 vcc, -1, v19
    s_nop 0
    s_cbranch_vccnz g_30F13_2
    v_smfmac_f32_16x16x64_bf16 v[64:67], v[32:35], a[208:215], v172
    v_smfmac_f32_16x16x64_bf16 v[68:71], v[32:35], a[240:247], v172
g_30L9_3:
    s_waitcnt vmcnt(1)
    v_max3_u32 v19, v36, v37, v38
    v_max_u32 v19, v19, v39
    v_cmp_eq_u32 vcc, -1, v19
    s_nop 0
    s_cbranch_vccnz g_30F9_3
    v_smfmac_f32_16x16x64_bf16 v[64:67], v[36:39], a[216:223], v172
    v_smfmac_f32_16x16x64_bf16 v[68:71], v[36:39], a[248:255], v172
g_30L1_0:
    s_waitcnt vmcnt(0)
    v_max3_u32 v19, v24, v25, v26
    v_max_u32 v19, v19, v27
    v_cmp_eq_u32 vcc, -1, v19
    s_nop 0
    s_cbranch_vccnz g_30F1_0
    v_smfmac_f32_16x16x64_bf16 v[64:67], v[24:27], a[192:199], v172
    v_smfmac_f32_16x16x64_bf16 v[68:71], v[24:27], a[224:231], v172
    s_nop 4
    v_cvt_pk_bf16_f32 v80, v64, v65
    v_cvt_pk_bf16_f32 v81, v66, v67
    s_nop 0
    v_cvt_pk_bf16_f32 v82, v68, v69
    v_cvt_pk_bf16_f32 v83, v70, v71
    ds_write_b128 v17, v[80:83] offset:9216
    s_branch gc_31
g_30L15_2:
    s_waitcnt vmcnt(3)
    v_max3_u32 v19, v32, v33, v34
    v_max_u32 v19, v19, v35
    v_cmp_eq_u32 vcc, -1, v19
    s_nop 0
    s_cbranch_vccnz g_30F15_2
    v_smfmac_f32_16x16x64_bf16 v[64:67], v[32:35], a[208:215], v172
    v_smfmac_f32_16x16x64_bf16 v[68:71], v[32:35], a[240:247], v172
g_30L11_3:
    s_waitcnt vmcnt(2)
    v_max3_u32 v19, v36, v37, v38
    v_max_u32 v19, v19, v39
    v_cmp_eq_u32 vcc, -1, v19
    s_nop 0
    s_cbranch_vccnz g_30F11_3
    v_smfmac_f32_16x16x64_bf16 v[64:67], v[36:39], a[216:223], v172
    v_smfmac_f32_16x16x64_bf16 v[68:71], v[36:39], a[248:255], v172
g_30L3_0:
    s_waitcnt vmcnt(1)
    v_max3_u32 v19, v24, v25, v26
    v_max_u32 v19, v19, v27
    v_cmp_eq_u32 vcc, -1, v19
    s_nop 0
    s_cbranch_vccnz g_30F3_0
    v_smfmac_f32_16x16x64_bf16 v[64:67], v[24:27], a[192:199], v172
    v_smfmac_f32_16x16x64_bf16 v[68:71], v[24:27], a[224:231], v172
g_30L2_1:
    s_waitcnt vmcnt(0)
    v_max3_u32 v19, v28, v29, v30
    v_max_u32 v19, v19, v31
    v_cmp_eq_u32 vcc, -1, v19
    s_nop 0
    s_cbranch_vccnz g_30F2_1
    v_smfmac_f32_16x16x64_bf16 v[64:67], v[28:31], a[200:207], v172
    v_smfmac_f32_16x16x64_bf16 v[68:71], v[28:31], a[232:239], v172
    s_nop 4
    v_cvt_pk_bf16_f32 v80, v64, v65
    v_cvt_pk_bf16_f32 v81, v66, v67
    s_nop 0
    v_cvt_pk_bf16_f32 v82, v68, v69
    v_cvt_pk_bf16_f32 v83, v70, v71
    ds_write_b128 v17, v[80:83] offset:9216
    s_branch gc_31
g_30L15_3:
    s_waitcnt vmcnt(3)
    v_max3_u32 v19, v36, v37, v38
    v_max_u32 v19, v19, v39
    v_cmp_eq_u32 vcc, -1, v19
    s_nop 0
    s_cbranch_vccnz g_30F15_3
    v_smfmac_f32_16x16x64_bf16 v[64:67], v[36:39], a[216:223], v172
    v_smfmac_f32_16x16x64_bf16 v[68:71], v[36:39], a[248:255], v172
g_30L7_0:
    s_waitcnt vmcnt(2)
    v_max3_u32 v19, v24, v25, v26
    v_max_u32 v19, v19, v27
    v_cmp_eq_u32 vcc, -1, v19
    s_nop 0
    s_cbranch_vccnz g_30F7_0
    v_smfmac_f32_16x16x64_bf16 v[64:67], v[24:27], a[192:199], v172
    v_smfmac_f32_16x16x64_bf16 v[68:71], v[24:27], a[224:231], v172
g_30L6_1:
    s_waitcnt vmcnt(1)
    v_max3_u32 v19, v28, v29, v30
    v_max_u32 v19, v19, v31
    v_cmp_eq_u32 vcc, -1, v19
    s_nop 0
    s_cbranch_vccnz g_30F6_1
    v_smfmac_f32_16x16x64_bf16 v[64:67], v[28:31], a[200:207], v172
    v_smfmac_f32_16x16x64_bf16 v[68:71], v[28:31], a[232:239], v172
g_30L4_2:
    s_waitcnt vmcnt(0)
    v_max3_u32 v19, v32, v33, v34
    v_max_u32 v19, v19, v35
    v_cmp_eq_u32 vcc, -1, v19
    s_nop 0
    s_cbranch_vccnz g_30F4_2
    v_smfmac_f32_16x16x64_bf16 v[64:67], v[32:35], a[208:215], v172
    v_smfmac_f32_16x16x64_bf16 v[68:71], v[32:35], a[240:247], v172
    s_nop 4
    v_cvt_pk_bf16_f32 v80, v64, v65
    v_cvt_pk_bf16_f32 v81, v66, v67
    s_nop 0
    v_cvt_pk_bf16_f32 v82, v68, v69
    v_cvt_pk_bf16_f32 v83, v70, v71
    ds_write_b128 v17, v[80:83] offset:9216
    s_branch gc_31
g_30L7_1:
    s_waitcnt vmcnt(2)
    v_max3_u32 v19, v28, v29, v30
    v_max_u32 v19, v19, v31
    v_cmp_eq_u32 vcc, -1, v19
    s_nop 0
    s_cbranch_vccnz g_30F7_1
    v_smfmac_f32_16x16x64_bf16 v[64:67], v[28:31], a[200:207], v172
    v_smfmac_f32_16x16x64_bf16 v[68:71], v[28:31], a[232:239], v172
g_30L5_2:
    s_waitcnt vmcnt(1)
    v_max3_u32 v19, v32, v33, v34
    v_max_u32 v19, v19, v35
    v_cmp_eq_u32 vcc, -1, v19
    s_nop 0
    s_cbranch_vccnz g_30F5_2
    v_smfmac_f32_16x16x64_bf16 v[64:67], v[32:35], a[208:215], v172
    v_smfmac_f32_16x16x64_bf16 v[68:71], v[32:35], a[240:247], v172
    s_branch g_30L1_0
g_30L7_2:
    s_waitcnt vmcnt(2)
    v_max3_u32 v19, v32, v33, v34
    v_max_u32 v19, v19, v35
    v_cmp_eq_u32 vcc, -1, v19
    s_nop 0
    s_cbranch_vccnz g_30F7_2
    v_smfmac_f32_16x16x64_bf16 v[64:67], v[32:35], a[208:215], v172
    v_smfmac_f32_16x16x64_bf16 v[68:71], v[32:35], a[240:247], v172
    s_branch g_30L3_0
g_30L11_0:
    s_waitcnt vmcnt(2)
    v_max3_u32 v19, v24, v25, v26
    v_max_u32 v19, v19, v27
    v_cmp_eq_u32 vcc, -1, v19
    s_nop 0
    s_cbranch_vccnz g_30F11_0
    v_smfmac_f32_16x16x64_bf16 v[64:67], v[24:27], a[192:199], v172
    v_smfmac_f32_16x16x64_bf16 v[68:71], v[24:27], a[224:231], v172
g_30L10_1:
    s_waitcnt vmcnt(1)
    v_max3_u32 v19, v28, v29, v30
    v_max_u32 v19, v19, v31
    v_cmp_eq_u32 vcc, -1, v19
    s_nop 0
    s_cbranch_vccnz g_30F10_1
    v_smfmac_f32_16x16x64_bf16 v[64:67], v[28:31], a[200:207], v172
    v_smfmac_f32_16x16x64_bf16 v[68:71], v[28:31], a[232:239], v172
    s_branch g_30L8_3
g_30L11_1:
    s_waitcnt vmcnt(2)
    v_max3_u32 v19, v28, v29, v30
    v_max_u32 v19, v19, v31
    v_cmp_eq_u32 vcc, -1, v19
    s_nop 0
    s_cbranch_vccnz g_30F11_1
    v_smfmac_f32_16x16x64_bf16 v[64:67], v[28:31], a[200:207], v172
    v_smfmac_f32_16x16x64_bf16 v[68:71], v[28:31], a[232:239], v172
    s_branch g_30L9_3
g_30L13_0:
    s_waitcnt vmcnt(2)
    v_max3_u32 v19, v24, v25, v26
    v_max_u32 v19, v19, v27
    v_cmp_eq_u32 vcc, -1, v19
    s_nop 0
    s_cbranch_vccnz g_30F13_0
    v_smfmac_f32_16x16x64_bf16 v[64:67], v[24:27], a[192:199], v172
    v_smfmac_f32_16x16x64_bf16 v[68:71], v[24:27], a[224:231], v172
    s_branch g_30L12_2
g_30L13_3:
    s_waitcnt vmcnt(2)
    v_max3_u32 v19, v36, v37, v38
    v_max_u32 v19, v19, v39
    v_cmp_eq_u32 vcc, -1, v19
    s_nop 0
    s_cbranch_vccnz g_30F13_3
    v_smfmac_f32_16x16x64_bf16 v[64:67], v[36:39], a[216:223], v172
    v_smfmac_f32_16x16x64_bf16 v[68:71], v[36:39], a[248:255], v172
g_30L5_0:
    s_waitcnt vmcnt(1)
    v_max3_u32 v19, v24, v25, v26
    v_max_u32 v19, v19, v27
    v_cmp_eq_u32 vcc, -1, v19
    s_nop 0
    s_cbranch_vccnz g_30F5_0
    v_smfmac_f32_16x16x64_bf16 v[64:67], v[24:27], a[192:199], v172
    v_smfmac_f32_16x16x64_bf16 v[68:71], v[24:27], a[224:231], v172
    s_branch g_30L4_2
g_30L14_2:
    s_waitcnt vmcnt(2)
    v_max3_u32 v19, v32, v33, v34
    v_max_u32 v19, v19, v35
    v_cmp_eq_u32 vcc, -1, v19
    s_nop 0
    s_cbranch_vccnz g_30F14_2
    v_smfmac_f32_16x16x64_bf16 v[64:67], v[32:35], a[208:215], v172
    v_smfmac_f32_16x16x64_bf16 v[68:71], v[32:35], a[240:247], v172
g_30L10_3:
    s_waitcnt vmcnt(1)
    v_max3_u32 v19, v36, v37, v38
    v_max_u32 v19, v19, v39
    v_cmp_eq_u32 vcc, -1, v19
    s_nop 0
    s_cbranch_vccnz g_30F10_3
    v_smfmac_f32_16x16x64_bf16 v[64:67], v[36:39], a[216:223], v172
    v_smfmac_f32_16x16x64_bf16 v[68:71], v[36:39], a[248:255], v172
    s_branch g_30L2_1
g_30L14_3:
    s_waitcnt vmcnt(2)
    v_max3_u32 v19, v36, v37, v38
    v_max_u32 v19, v19, v39
    v_cmp_eq_u32 vcc, -1, v19
    s_nop 0
    s_cbranch_vccnz g_30F14_3
    v_smfmac_f32_16x16x64_bf16 v[64:67], v[36:39], a[216:223], v172
    v_smfmac_f32_16x16x64_bf16 v[68:71], v[36:39], a[248:255], v172
    s_branch g_30L6_1
g_30L3_1:
    s_waitcnt vmcnt(1)
    v_max3_u32 v19, v28, v29, v30
    v_max_u32 v19, v19, v31
    v_cmp_eq_u32 vcc, -1, v19
    s_nop 0
    s_cbranch_vccnz g_30F3_1
    v_smfmac_f32_16x16x64_bf16 v[64:67], v[28:31], a[200:207], v172
    v_smfmac_f32_16x16x64_bf16 v[68:71], v[28:31], a[232:239], v172
    s_branch g_30L1_0
g_30L6_2:
    s_waitcnt vmcnt(1)
    v_max3_u32 v19, v32, v33, v34
    v_max_u32 v19, v19, v35
    v_cmp_eq_u32 vcc, -1, v19
    s_nop 0
    s_cbranch_vccnz g_30F6_2
    v_smfmac_f32_16x16x64_bf16 v[64:67], v[32:35], a[208:215], v172
    v_smfmac_f32_16x16x64_bf16 v[68:71], v[32:35], a[240:247], v172
    s_branch g_30L2_1
g_30L9_0:
    s_waitcnt vmcnt(1)
    v_max3_u32 v19, v24, v25, v26
    v_max_u32 v19, v19, v27
    v_cmp_eq_u32 vcc, -1, v19
    s_nop 0
    s_cbranch_vccnz g_30F9_0
    v_smfmac_f32_16x16x64_bf16 v[64:67], v[24:27], a[192:199], v172
    v_smfmac_f32_16x16x64_bf16 v[68:71], v[24:27], a[224:231], v172
    s_branch g_30L8_3
g_30L12_3:
    s_waitcnt vmcnt(1)
    v_max3_u32 v19, v36, v37, v38
    v_max_u32 v19, v19, v39
    v_cmp_eq_u32 vcc, -1, v19
    s_nop 0
    s_cbranch_vccnz g_30F12_3
    v_smfmac_f32_16x16x64_bf16 v[64:67], v[36:39], a[216:223], v172
    v_smfmac_f32_16x16x64_bf16 v[68:71], v[36:39], a[248:255], v172
    s_branch g_30L4_2
g_30F15_0:
    s_mov_b64 exec, vcc
    buffer_load_dwordx4 v[24:27], v8, s[4:7], s16 offen offset:0 sc1
    s_mov_b64 exec, -1
    s_add_u32 s23, s23, 1
    s_cmp_lt_u32 s23, 200000
    s_cbranch_scc1 g_30L15_1
    s_mov_b32 s25, 200000
    s_branch gc_31
g_30F15_1:
    s_mov_b64 exec, vcc
    buffer_load_dwordx4 v[28:31], v8, s[4:7], s16 offen offset:1024 sc1
    s_mov_b64 exec, -1
    s_add_u32 s23, s23, 1
    s_cmp_lt_u32 s23, 200000
    s_cbranch_scc1 g_30L15_2
    s_mov_b32 s25, 200000
    s_branch gc_31
g_30F15_2:
    s_mov_b64 exec, vcc
    buffer_load_dwordx4 v[32:35], v8, s[4:7], s16 offen offset:2048 sc1
    s_mov_b64 exec, -1
    s_add_u32 s23, s23, 1
    s_cmp_lt_u32 s23, 200000
    s_cbranch_scc1 g_30L15_3
    s_mov_b32 s25, 200000
    s_branch gc_31
g_30F15_3:
    s_mov_b64 exec, vcc
    buffer_load_dwordx4 v[36:39], v8, s[4:7], s16 offen offset:3072 sc1
    s_mov_b64 exec, -1
    s_add_u32 s23, s23, 1
    s_cmp_lt_u32 s23, 200000
    s_cbranch_scc1 g_30L15_0
    s_mov_b32 s25, 200000
    s_branch gc_31
g_30F7_0:
    s_mov_b64 exec, vcc
    buffer_load_dwordx4 v[24:27], v8, s[4:7], s16 offen offset:0 sc1
    s_mov_b64 exec, -1
    s_add_u32 s23, s23, 1
    s_cmp_lt_u32 s23, 200000
    s_cbranch_scc1 g_30L7_1
    s_mov_b32 s25, 200000
    s_branch gc_31
g_30F7_1:
    s_mov_b64 exec, vcc
    buffer_load_dwordx4 v[28:31], v8, s[4:7], s16 offen offset:1024 sc1
    s_mov_b64 exec, -1
    s_add_u32 s23, s23, 1
    s_cmp_lt_u32 s23, 200000
    s_cbranch_scc1 g_30L7_2
    s_mov_b32 s25, 200000
    s_branch gc_31
g_30F7_2:
    s_mov_b64 exec, vcc
    buffer_load_dwordx4 v[32:35], v8, s[4:7], s16 offen offset:2048 sc1
    s_mov_b64 exec, -1
    s_add_u32 s23, s23, 1
    s_cmp_lt_u32 s23, 200000
    s_cbranch_scc1 g_30L7_0
    s_mov_b32 s25, 200000
    s_branch gc_31
g_30F11_0:
    s_mov_b64 exec, vcc
    buffer_load_dwordx4 v[24:27], v8, s[4:7], s16 offen offset:0 sc1
    s_mov_b64 exec, -1
    s_add_u32 s23, s23, 1
    s_cmp_lt_u32 s23, 200000
    s_cbranch_scc1 g_30L11_1
    s_mov_b32 s25, 200000
    s_branch gc_31
g_30F11_1:
    s_mov_b64 exec, vcc
    buffer_load_dwordx4 v[28:31], v8, s[4:7], s16 offen offset:1024 sc1
    s_mov_b64 exec, -1
    s_add_u32 s23, s23, 1
    s_cmp_lt_u32 s23, 200000
    s_cbranch_scc1 g_30L11_3
    s_mov_b32 s25, 200000
    s_branch gc_31
g_30F11_3:
    s_mov_b64 exec, vcc
    buffer_load_dwordx4 v[36:39], v8, s[4:7], s16 offen offset:3072 sc1
    s_mov_b64 exec, -1
    s_add_u32 s23, s23, 1
    s_cmp_lt_u32 s23, 200000
    s_cbranch_scc1 g_30L11_0
    s_mov_b32 s25, 200000
    s_branch gc_31
g_30F13_0:
    s_mov_b64 exec, vcc
    buffer_load_dwordx4 v[24:27], v8, s[4:7], s16 offen offset:0 sc1
    s_mov_b64 exec, -1
    s_add_u32 s23, s23, 1
    s_cmp_lt_u32 s23, 200000
    s_cbranch_scc1 g_30L13_2
    s_mov_b32 s25, 200000
    s_branch gc_31
g_30F13_2:
    s_mov_b64 exec, vcc
    buffer_load_dwordx4 v[32:35], v8, s[4:7], s16 offen offset:2048 sc1
    s_mov_b64 exec, -1
    s_add_u32 s23, s23, 1
    s_cmp_lt_u32 s23, 200000
    s_cbranch_scc1 g_30L13_3
    s_mov_b32 s25, 200000
    s_branch gc_31
g_30F13_3:
    s_mov_b64 exec, vcc
    buffer_load_dwordx4 v[36:39], v8, s[4:7], s16 offen offset:3072 sc1
    s_mov_b64 exec, -1
    s_add_u32 s23, s23, 1
    s_cmp_lt_u32 s23, 200000
    s_cbranch_scc1 g_30L13_0
    s_mov_b32 s25, 200000
    s_branch gc_31
g_30F14_1:
    s_mov_b64 exec, vcc
    buffer_load_dwordx4 v[28:31], v8, s[4:7], s16 offen offset:1024 sc1
    s_mov_b64 exec, -1
    s_add_u32 s23, s23, 1
    s_cmp_lt_u32 s23, 200000
    s_cbranch_scc1 g_30L14_2
    s_mov_b32 s25, 200000
    s_branch gc_31
g_30F14_2:
    s_mov_b64 exec, vcc
    buffer_load_dwordx4 v[32:35], v8, s[4:7], s16 offen offset:2048 sc1
    s_mov_b64 exec, -1
    s_add_u32 s23, s23, 1
    s_cmp_lt_u32 s23, 200000
    s_cbranch_scc1 g_30L14_3
    s_mov_b32 s25, 200000
    s_branch gc_31
g_30F14_3:
    s_mov_b64 exec, vcc
    buffer_load_dwordx4 v[36:39], v8, s[4:7], s16 offen offset:3072 sc1
    s_mov_b64 exec, -1
    s_add_u32 s23, s23, 1
    s_cmp_lt_u32 s23, 200000
    s_cbranch_scc1 g_30L14_1
    s_mov_b32 s25, 200000
    s_branch gc_31
g_30F3_0:
    s_mov_b64 exec, vcc
    buffer_load_dwordx4 v[24:27], v8, s[4:7], s16 offen offset:0 sc1
    s_mov_b64 exec, -1
    s_add_u32 s23, s23, 1
    s_cmp_lt_u32 s23, 200000
    s_cbranch_scc1 g_30L3_1
    s_mov_b32 s25, 200000
    s_branch gc_31
g_30F3_1:
    s_mov_b64 exec, vcc
    buffer_load_dwordx4 v[28:31], v8, s[4:7], s16 offen offset:1024 sc1
    s_mov_b64 exec, -1
    s_add_u32 s23, s23, 1
    s_cmp_lt_u32 s23, 200000
    s_cbranch_scc1 g_30L3_0
    s_mov_b32 s25, 200000
    s_branch gc_31
g_30F5_0:
    s_mov_b64 exec, vcc
    buffer_load_dwordx4 v[24:27], v8, s[4:7], s16 offen offset:0 sc1
    s_mov_b64 exec, -1
    s_add_u32 s23, s23, 1
    s_cmp_lt_u32 s23, 200000
    s_cbranch_scc1 g_30L5_2
    s_mov_b32 s25, 200000
    s_branch gc_31
g_30F5_2:
    s_mov_b64 exec, vcc
    buffer_load_dwordx4 v[32:35], v8, s[4:7], s16 offen offset:2048 sc1
    s_mov_b64 exec, -1
    s_add_u32 s23, s23, 1
    s_cmp_lt_u32 s23, 200000
    s_cbranch_scc1 g_30L5_0
    s_mov_b32 s25, 200000
    s_branch gc_31
g_30F6_1:
    s_mov_b64 exec, vcc
    buffer_load_dwordx4 v[28:31], v8, s[4:7], s16 offen offset:1024 sc1
    s_mov_b64 exec, -1
    s_add_u32 s23, s23, 1
    s_cmp_lt_u32 s23, 200000
    s_cbranch_scc1 g_30L6_2
    s_mov_b32 s25, 200000
    s_branch gc_31
g_30F6_2:
    s_mov_b64 exec, vcc
    buffer_load_dwordx4 v[32:35], v8, s[4:7], s16 offen offset:2048 sc1
    s_mov_b64 exec, -1
    s_add_u32 s23, s23, 1
    s_cmp_lt_u32 s23, 200000
    s_cbranch_scc1 g_30L6_1
    s_mov_b32 s25, 200000
    s_branch gc_31
g_30F9_0:
    s_mov_b64 exec, vcc
    buffer_load_dwordx4 v[24:27], v8, s[4:7], s16 offen offset:0 sc1
    s_mov_b64 exec, -1
    s_add_u32 s23, s23, 1
    s_cmp_lt_u32 s23, 200000
    s_cbranch_scc1 g_30L9_3
    s_mov_b32 s25, 200000
    s_branch gc_31
g_30F9_3:
    s_mov_b64 exec, vcc
    buffer_load_dwordx4 v[36:39], v8, s[4:7], s16 offen offset:3072 sc1
    s_mov_b64 exec, -1
    s_add_u32 s23, s23, 1
    s_cmp_lt_u32 s23, 200000
    s_cbranch_scc1 g_30L9_0
    s_mov_b32 s25, 200000
    s_branch gc_31
g_30F10_1:
    s_mov_b64 exec, vcc
    buffer_load_dwordx4 v[28:31], v8, s[4:7], s16 offen offset:1024 sc1
    s_mov_b64 exec, -1
    s_add_u32 s23, s23, 1
    s_cmp_lt_u32 s23, 200000
    s_cbranch_scc1 g_30L10_3
    s_mov_b32 s25, 200000
    s_branch gc_31
g_30F10_3:
    s_mov_b64 exec, vcc
    buffer_load_dwordx4 v[36:39], v8, s[4:7], s16 offen offset:3072 sc1
    s_mov_b64 exec, -1
    s_add_u32 s23, s23, 1
    s_cmp_lt_u32 s23, 200000
    s_cbranch_scc1 g_30L10_1
    s_mov_b32 s25, 200000
    s_branch gc_31
g_30F12_2:
    s_mov_b64 exec, vcc
    buffer_load_dwordx4 v[32:35], v8, s[4:7], s16 offen offset:2048 sc1
    s_mov_b64 exec, -1
    s_add_u32 s23, s23, 1
    s_cmp_lt_u32 s23, 200000
    s_cbranch_scc1 g_30L12_3
    s_mov_b32 s25, 200000
    s_branch gc_31
g_30F12_3:
    s_mov_b64 exec, vcc
    buffer_load_dwordx4 v[36:39], v8, s[4:7], s16 offen offset:3072 sc1
    s_mov_b64 exec, -1
    s_add_u32 s23, s23, 1
    s_cmp_lt_u32 s23, 200000
    s_cbranch_scc1 g_30L12_2
    s_mov_b32 s25, 200000
    s_branch gc_31
g_30F1_0:
    s_mov_b64 exec, vcc
    buffer_load_dwordx4 v[24:27], v8, s[4:7], s16 offen offset:0 sc1
    s_mov_b64 exec, -1
    s_add_u32 s23, s23, 1
    s_cmp_lt_u32 s23, 200000
    s_cbranch_scc1 g_30L1_0
    s_mov_b32 s25, 200000
    s_branch gc_31
g_30F2_1:
    s_mov_b64 exec, vcc
    buffer_load_dwordx4 v[28:31], v8, s[4:7], s16 offen offset:1024 sc1
    s_mov_b64 exec, -1
    s_add_u32 s23, s23, 1
    s_cmp_lt_u32 s23, 200000
    s_cbranch_scc1 g_30L2_1
    s_mov_b32 s25, 200000
    s_branch gc_31
g_30F4_2:
    s_mov_b64 exec, vcc
    buffer_load_dwordx4 v[32:35], v8, s[4:7], s16 offen offset:2048 sc1
    s_mov_b64 exec, -1
    s_add_u32 s23, s23, 1
    s_cmp_lt_u32 s23, 200000
    s_cbranch_scc1 g_30L4_2
    s_mov_b32 s25, 200000
    s_branch gc_31
g_30F8_3:
    s_mov_b64 exec, vcc
    buffer_load_dwordx4 v[36:39], v8, s[4:7], s16 offen offset:3072 sc1
    s_mov_b64 exec, -1
    s_add_u32 s23, s23, 1
    s_cmp_lt_u32 s23, 200000
    s_cbranch_scc1 g_30L8_3
    s_mov_b32 s25, 200000
    s_branch gc_31
.p2align 6
recur_fast_w1:
    s_nop 15
    s_mov_b32 s23, s25
    buffer_load_dwordx4 v[24:27], v2, s[4:7], s16 offen offset:0 sc1
    s_nop 11
    buffer_load_dwordx4 v[28:31], v2, s[4:7], s16 offen offset:1024 sc1
    s_nop 11
    buffer_load_dwordx4 v[32:35], v2, s[4:7], s16 offen offset:2048 sc1
    s_nop 11
    buffer_load_dwordx4 v[36:39], v2, s[4:7], s16 offen offset:3072 sc1
    s_waitcnt vmcnt(3)
    v_max3_u32 v19, v24, v25, v26
    v_max_u32 v19, v19, v27
    v_cmp_eq_u32 vcc, -1, v19
    s_nop 0
    s_cbranch_vccnz g_34F15_0
    v_smfmac_f32_16x16x64_bf16 v[40:43], v[24:27], a[0:7], v172
    s_waitcnt vmcnt(2)
    v_max3_u32 v19, v28, v29, v30
    v_max_u32 v19, v19, v31
    v_smfmac_f32_16x16x64_bf16 v[44:47], v[24:27], a[64:71], v172
    v_cmp_eq_u32 vcc, -1, v19
    v_smfmac_f32_16x16x64_bf16 v[48:51], v[24:27], a[32:39], v172
    v_smfmac_f32_16x16x64_bf16 v[52:55], v[24:27], a[96:103], v172
    s_cbranch_vccnz g_34F14_1
    v_smfmac_f32_16x16x64_bf16 v[40:43], v[28:31], a[8:15], v172
    s_waitcnt vmcnt(1)
    v_max3_u32 v19, v32, v33, v34
    v_max_u32 v19, v19, v35
    v_smfmac_f32_16x16x64_bf16 v[44:47], v[28:31], a[72:79], v172
    v_cmp_eq_u32 vcc, -1, v19
    v_smfmac_f32_16x16x64_bf16 v[48:51], v[28:31], a[40:47], v172
    v_smfmac_f32_16x16x64_bf16 v[52:55], v[28:31], a[104:111], v172
    s_cbranch_vccnz g_34F12_2
    v_smfmac_f32_16x16x64_bf16 v[40:43], v[32:35], a[16:23], v172
    s_waitcnt vmcnt(0)
    v_max3_u32 v19, v36, v37, v38
    v_max_u32 v19, v19, v39
    v_smfmac_f32_16x16x64_bf16 v[44:47], v[32:35], a[80:87], v172
    v_cmp_eq_u32 vcc, -1, v19
    v_smfmac_f32_16x16x64_bf16 v[48:51], v[32:35], a[48:55], v172
    v_smfmac_f32_16x16x64_bf16 v[52:55], v[32:35], a[112:119], v172
    s_cbranch_vccnz g_34F8_3
    v_smfmac_f32_16x16x64_bf16 v[40:43], v[36:39], a[24:31], v172
    v_smfmac_f32_16x16x64_bf16 v[44:47], v[36:39], a[88:95], v172
    v_smfmac_f32_16x16x64_bf16 v[48:51], v[36:39], a[56:63], v172
    v_smfmac_f32_16x16x64_bf16 v[52:55], v[36:39], a[120:127], v172
gc_35:
    v_cvt_pk_bf16_f32 v72, v40, v41
    v_cvt_pk_bf16_f32 v73, v42, v43
    v_cvt_pk_bf16_f32 v74, v44, v45
    v_cvt_pk_bf16_f32 v75, v46, v47
    ds_write_b128 v17, v[72:75] offset:0
    v_cvt_pk_bf16_f32 v76, v48, v49
    v_cvt_pk_bf16_f32 v77, v50, v51
    s_nop 0
    v_cvt_pk_bf16_f32 v78, v52, v53
    v_cvt_pk_bf16_f32 v79, v54, v55
    ds_write_b128 v17, v[76:79] offset:1024
    v_smfmac_f32_16x16x64_bf16 v[56:59], v[24:27], a[128:135], v172
    v_smfmac_f32_16x16x64_bf16 v[60:63], v[24:27], a[160:167], v172
    v_smfmac_f32_16x16x64_bf16 v[56:59], v[28:31], a[136:143], v172
    s_waitcnt lgkmcnt(0)
    s_barrier
    v_smfmac_f32_16x16x64_bf16 v[60:63], v[28:31], a[168:175], v172
    v_smfmac_f32_16x16x64_bf16 v[56:59], v[32:35], a[144:151], v172
    v_smfmac_f32_16x16x64_bf16 v[60:63], v[32:35], a[176:183], v172
    v_smfmac_f32_16x16x64_bf16 v[56:59], v[36:39], a[152:159], v172
    v_smfmac_f32_16x16x64_bf16 v[60:63], v[36:39], a[184:191], v172
    s_nop 4
    v_cvt_pk_bf16_f32 v80, v56, v57
    v_cvt_pk_bf16_f32 v81, v58, v59
    s_nop 0
    v_cvt_pk_bf16_f32 v82, v60, v61
    v_cvt_pk_bf16_f32 v83, v62, v63
    ds_write_b128 v17, v[80:83] offset:8192
    v_mov_b32 v152, v228
    v_mov_b32 v153, v229
    v_mov_b32 v156, v230
    v_mov_b32 v157, v231
    v_mov_b32 v160, v232
    v_mov_b32 v161, v233
    v_mov_b32 v164, v234
    v_mov_b32 v165, v235
    s_cmp_eq_u32 s15, 63
    s_waitcnt lgkmcnt(0)
    s_barrier
    s_cbranch_scc1 recur_end
    s_nop 15
    s_nop 15
    s_nop 7
    buffer_load_dwordx4 v[208:211], v5, s[4:7], s16 offen offset:0 sc1
    buffer_load_dwordx4 v[212:215], v5, s[4:7], s16 offen offset:1024 sc1
    buffer_load_dwordx4 v[216:219], v5, s[4:7], s16 offen offset:2048 sc1
    buffer_load_dwordx4 v[220:223], v5, s[4:7], s16 offen offset:3072 sc1
    buffer_load_dword v224, v6, s[4:7], s16 offen offset:0 sc1
    buffer_load_dword v225, v6, s[4:7], s16 offen offset:256 sc1
    buffer_load_dword v226, v6, s[4:7], s16 offen offset:512 sc1
    buffer_load_dword v227, v6, s[4:7], s16 offen offset:768 sc1
    s_mov_b32 s23, s25
    ds_read_b128 v[96:99], v16 offset:8192
    ds_read_b128 v[104:107], v16 offset:12288
    ds_read_b128 v[108:111], v16 offset:14336
    v_mfma_f32_16x16x32_bf16 v[140:143], v[84:87], v[80:83], 0
    s_waitcnt lgkmcnt(2)
    v_mfma_f32_16x16x32_bf16 v[140:143], v[84:87], v[96:99], v[140:143]
    s_waitcnt lgkmcnt(1)
    v_mfma_f32_16x16x32_bf16 v[140:143], v[84:87], v[104:107], v[140:143]
    s_waitcnt lgkmcnt(0)
    v_mfma_f32_16x16x32_bf16 v[140:143], v[84:87], v[108:111], v[140:143]
    buffer_load_dwordx4 v[24:27], v5, s[4:7], s16 offen offset:0 sc1
    buffer_load_dwordx4 v[28:31], v5, s[4:7], s16 offen offset:1024 sc1
    buffer_load_dwordx4 v[32:35], v5, s[4:7], s16 offen offset:2048 sc1
    buffer_load_dwordx4 v[36:39], v5, s[4:7], s16 offen offset:3072 sc1
    buffer_load_dword v40, v6, s[4:7], s16 offen offset:0 sc1
    buffer_load_dword v41, v6, s[4:7], s16 offen offset:256 sc1
    buffer_load_dword v42, v6, s[4:7], s16 offen offset:512 sc1
    buffer_load_dword v43, v6, s[4:7], s16 offen offset:768 sc1
    v_cvt_pk_bf16_f32 v154, v140, v179
    v_cvt_pk_bf16_f32 v158, v141, v179
    v_cvt_pk_bf16_f32 v162, v142, v179
    v_cvt_pk_bf16_f32 v166, v143, v179
    s_waitcnt vmcnt(14)
    v_pk_add_f32 v[180:181], v[208:209], v[212:213]
    v_pk_add_f32 v[182:183], v[210:211], v[214:215]
    s_waitcnt vmcnt(12)
    v_pk_add_f32 v[188:189], v[216:217], v[220:221]
    v_pk_add_f32 v[190:191], v[218:219], v[222:223]
    v_pk_add_f32 v[180:181], v[180:181], v[188:189]
    v_pk_add_f32 v[182:183], v[182:183], v[190:191]
    v_pk_add_f32 v[188:189], v[180:181], v[182:183]
    v_max3_f32 v185, v180, v181, v182
    s_waitcnt vmcnt(8)
    v_pk_add_f32 v[192:193], v[224:225], v[226:227]
    v_add_f32 v188, v188, v189
    v_add_f32 v184, v192, v193
    v_max3_f32 v185, v185, v183, v184
    v_cmp_u_f32 vcc, v188, v184
    s_nop 0
    v_max_f32_dpp v185, v185, v185 row_ror:8 row_mask:0xf bank_mask:0xf
    v_mov_b32 v186, v185
    s_nop 1
    v_permlane16_swap_b32 v185, v186
    v_max_f32 v185, v185, v186
    v_mov_b32 v186, v185
    s_cbranch_vccnz ss_36
sg_38:
    s_nop 0
    v_permlane32_swap_b32 v185, v186
    v_max_f32 v185, v185, v186
    v_mul_f32 v185, s24, v185
    v_fma_f32 v180, v180, s24, -v185
    v_fma_f32 v181, v181, s24, -v185
    v_fma_f32 v182, v182, s24, -v185
    v_fma_f32 v183, v183, s24, -v185
    v_fma_f32 v184, v184, s24, -v185
    v_exp_f32 v180, v180
    v_exp_f32 v181, v181
    v_exp_f32 v182, v182
    v_exp_f32 v183, v183
    v_exp_f32 v184, v184
    v_cvt_pk_bf16_f32 v176, v180, v181
    v_cvt_pk_bf16_f32 v177, v182, v183
    v_cvt_pk_bf16_f32 v178, v184, v179
    s_nop 1
    v_mfma_f32_16x16x32_bf16 v[240:243], v[236:239], v[176:179], 0
    v_mfma_f32_16x16x32_bf16 v[188:191], v[152:155], v[176:179], 0
    v_mfma_f32_16x16x32_bf16 v[192:195], v[156:159], v[176:179], 0
    v_mfma_f32_16x16x32_bf16 v[196:199], v[160:163], v[176:179], 0
    v_mfma_f32_16x16x32_bf16 v[200:203], v[164:167], v[176:179], 0
    v_add_f32_dpp v185, v240, v240 row_ror:8 row_mask:0xf bank_mask:0xf
    v_rcp_f32 v185, v185
    v_add_f32_dpp v88, v192, v188 row_ror:8 row_mask:0xf bank_mask:0x3
    v_add_f32_dpp v89, v193, v189 row_ror:8 row_mask:0xf bank_mask:0x3
    v_add_f32_dpp v90, v194, v190 row_ror:8 row_mask:0xf bank_mask:0x3
    v_add_f32_dpp v91, v195, v191 row_ror:8 row_mask:0xf bank_mask:0x3
    s_nop 1
    v_add_f32_dpp v88, v196, v200 row_ror:8 row_mask:0xf bank_mask:0xc
    v_add_f32_dpp v89, v197, v201 row_ror:8 row_mask:0xf bank_mask:0xc
    v_add_f32_dpp v90, v198, v202 row_ror:8 row_mask:0xf bank_mask:0xc
    v_add_f32_dpp v91, v199, v203 row_ror:8 row_mask:0xf bank_mask:0xc
    v_mul_f32 v88, v88, v185
    v_mul_f32 v89, v89, v185
    v_mul_f32 v90, v90, v185
    v_mul_f32 v91, v91, v185
    v_cvt_pk_bf16_f32 v88, v88, v89
    v_cvt_pk_bf16_f32 v89, v90, v91
    buffer_store_dwordx2 v[88:89], v7, s[4:7], s16 offen
    v_readfirstlane_b32 s85, v247
    s_add_u32 s94, s15, 2
    s_barrier
    s_nop 15
    s_mov_b32 s23, s25
    buffer_load_dwordx4 v[24:27], v8, s[4:7], s16 offen offset:0 sc1
    s_nop 11
    buffer_load_dwordx4 v[28:31], v8, s[4:7], s16 offen offset:1024 sc1
    s_nop 11
    buffer_load_dwordx4 v[32:35], v8, s[4:7], s16 offen offset:2048 sc1
    s_nop 11
    buffer_load_dwordx4 v[36:39], v8, s[4:7], s16 offen offset:3072 sc1
    s_waitcnt vmcnt(3)
    v_max3_u32 v19, v24, v25, v26
    v_max_u32 v19, v19, v27
    v_cmp_eq_u32 vcc, -1, v19
    s_nop 0
    s_cbranch_vccnz g_39F15_0
    v_smfmac_f32_16x16x64_bf16 v[64:67], v[24:27], a[192:199], v172
    v_smfmac_f32_16x16x64_bf16 v[68:71], v[24:27], a[224:231], v172
    s_waitcnt vmcnt(2)
    v_max3_u32 v19, v28, v29, v30
    v_max_u32 v19, v19, v31
    v_cmp_eq_u32 vcc, -1, v19
    s_nop 0
    s_cbranch_vccnz g_39F14_1
    v_smfmac_f32_16x16x64_bf16 v[64:67], v[28:31], a[200:207], v172
    v_smfmac_f32_16x16x64_bf16 v[68:71], v[28:31], a[232:239], v172
    s_waitcnt vmcnt(1)
    v_max3_u32 v19, v32, v33, v34
    v_max_u32 v19, v19, v35
    v_cmp_eq_u32 vcc, -1, v19
    s_nop 0
    s_cbranch_vccnz g_39F12_2
    v_smfmac_f32_16x16x64_bf16 v[64:67], v[32:35], a[208:215], v172
    v_smfmac_f32_16x16x64_bf16 v[68:71], v[32:35], a[240:247], v172
    s_waitcnt vmcnt(0)
    v_max3_u32 v19, v36, v37, v38
    v_max_u32 v19, v19, v39
    v_cmp_eq_u32 vcc, -1, v19
    s_nop 0
    s_cbranch_vccnz g_39F8_3
    v_smfmac_f32_16x16x64_bf16 v[64:67], v[36:39], a[216:223], v172
    v_smfmac_f32_16x16x64_bf16 v[68:71], v[36:39], a[248:255], v172
    s_nop 4
    v_cvt_pk_bf16_f32 v80, v64, v65
    v_cvt_pk_bf16_f32 v81, v66, v67
    s_nop 0
    v_cvt_pk_bf16_f32 v82, v68, v69
    v_cvt_pk_bf16_f32 v83, v70, v71
    ds_write_b128 v17, v[80:83] offset:9216
gc_40:
    s_waitcnt lgkmcnt(0)
    s_barrier
    s_mov_b32 s23, s25
fw_41:
    s_cmp_ge_u32 s85, s94
    s_cbranch_scc1 fo_42
    buffer_load_dword v247, v245, s[4:7], 0 offen sc1
    s_add_u32 s23, s23, 1
    s_waitcnt vmcnt(0)
    v_readfirstlane_b32 s85, v247
    s_cmp_lt_u32 s23, 200000
    s_cbranch_scc1 fw_41
    s_mov_b32 s25, 200000
fo_42:
    buffer_load_dwordx4 v[228:231], v13, s[4:7], s18 offen offset:0 sc1
    buffer_load_dwordx4 v[232:235], v13, s[4:7], s18 offen offset:256 sc1
    s_add_u32 s18, s18, 2048
    s_min_u32 s18, s18, 35780608
    s_nop 15
    s_nop 15
    s_nop 15
    s_nop 15
    s_add_u32 s21, s15, 3
    s_min_u32 s21, s21, 64
    s_cmp_lt_u32 s85, s21
    s_cselect_b64 exec, 1, 0
    buffer_load_dword v247, v245, s[4:7], 0 offen sc1
    s_mov_b64 exec, -1
    v_mov_b32 v40, 0
    v_mov_b32 v41, 0
    v_mov_b32 v42, 0
    v_mov_b32 v43, 0
    v_mov_b32 v44, 0
    v_mov_b32 v45, 0
    v_mov_b32 v46, 0
    v_mov_b32 v47, 0
    v_mov_b32 v48, 0
    v_mov_b32 v49, 0
    v_mov_b32 v50, 0
    v_mov_b32 v51, 0
    v_mov_b32 v52, 0
    v_mov_b32 v53, 0
    v_mov_b32 v54, 0
    v_mov_b32 v55, 0
    v_mov_b32 v56, 0
    v_mov_b32 v57, 0
    v_mov_b32 v58, 0
    v_mov_b32 v59, 0
    v_mov_b32 v60, 0
    v_mov_b32 v61, 0
    v_mov_b32 v62, 0
    v_mov_b32 v63, 0
    v_mov_b32 v64, 0
    v_mov_b32 v65, 0
    v_mov_b32 v66, 0
    v_mov_b32 v67, 0
    v_mov_b32 v68, 0
    v_mov_b32 v69, 0
    v_mov_b32 v70, 0
    v_mov_b32 v71, 0
    s_mov_b32 s21, s16
    s_mov_b32 s16, s42
    s_mov_b32 s42, s43
    s_mov_b32 s43, s44
    s_mov_b32 s44, s21
    s_add_u32 s95, s95, 524288
    s_lshr_b32 s84, s95, 8
    s_and_b32 s84, s84, 8192
    s_xor_b32 s84, s84, s46
    s_add_u32 s84, s84, s95
    s_add_u32 s15, s15, 1
    s_barrier
    s_branch recur_fast_w1
g_34L15_0:
    s_waitcnt vmcnt(3)
    v_max3_u32 v19, v24, v25, v26
    v_max_u32 v19, v19, v27
    v_cmp_eq_u32 vcc, -1, v19
    s_nop 0
    s_cbranch_vccnz g_34F15_0
    v_smfmac_f32_16x16x64_bf16 v[40:43], v[24:27], a[0:7], v172
    v_smfmac_f32_16x16x64_bf16 v[44:47], v[24:27], a[64:71], v172
    v_smfmac_f32_16x16x64_bf16 v[48:51], v[24:27], a[32:39], v172
    v_smfmac_f32_16x16x64_bf16 v[52:55], v[24:27], a[96:103], v172
g_34L14_1:
    s_waitcnt vmcnt(2)
    v_max3_u32 v19, v28, v29, v30
    v_max_u32 v19, v19, v31
    v_cmp_eq_u32 vcc, -1, v19
    s_nop 0
    s_cbranch_vccnz g_34F14_1
    v_smfmac_f32_16x16x64_bf16 v[40:43], v[28:31], a[8:15], v172
    v_smfmac_f32_16x16x64_bf16 v[44:47], v[28:31], a[72:79], v172
    v_smfmac_f32_16x16x64_bf16 v[48:51], v[28:31], a[40:47], v172
    v_smfmac_f32_16x16x64_bf16 v[52:55], v[28:31], a[104:111], v172
g_34L12_2:
    s_waitcnt vmcnt(1)
    v_max3_u32 v19, v32, v33, v34
    v_max_u32 v19, v19, v35
    v_cmp_eq_u32 vcc, -1, v19
    s_nop 0
    s_cbranch_vccnz g_34F12_2
    v_smfmac_f32_16x16x64_bf16 v[40:43], v[32:35], a[16:23], v172
    v_smfmac_f32_16x16x64_bf16 v[44:47], v[32:35], a[80:87], v172
    v_smfmac_f32_16x16x64_bf16 v[48:51], v[32:35], a[48:55], v172
    v_smfmac_f32_16x16x64_bf16 v[52:55], v[32:35], a[112:119], v172
g_34L8_3:
    s_waitcnt vmcnt(0)
    v_max3_u32 v19, v36, v37, v38
    v_max_u32 v19, v19, v39
    v_cmp_eq_u32 vcc, -1, v19
    s_nop 0
    s_cbranch_vccnz g_34F8_3
    v_smfmac_f32_16x16x64_bf16 v[40:43], v[36:39], a[24:31], v172
    v_smfmac_f32_16x16x64_bf16 v[44:47], v[36:39], a[88:95], v172
    v_smfmac_f32_16x16x64_bf16 v[48:51], v[36:39], a[56:63], v172
    v_smfmac_f32_16x16x64_bf16 v[52:55], v[36:39], a[120:127], v172
    s_branch gc_35
g_34L15_1:
    s_waitcnt vmcnt(3)
    v_max3_u32 v19, v28, v29, v30
    v_max_u32 v19, v19, v31
    v_cmp_eq_u32 vcc, -1, v19
    s_nop 0
    s_cbranch_vccnz g_34F15_1
    v_smfmac_f32_16x16x64_bf16 v[40:43], v[28:31], a[8:15], v172
    v_smfmac_f32_16x16x64_bf16 v[44:47], v[28:31], a[72:79], v172
    v_smfmac_f32_16x16x64_bf16 v[48:51], v[28:31], a[40:47], v172
    v_smfmac_f32_16x16x64_bf16 v[52:55], v[28:31], a[104:111], v172
g_34L13_2:
    s_waitcnt vmcnt(2)
    v_max3_u32 v19, v32, v33, v34
    v_max_u32 v19, v19, v35
    v_cmp_eq_u32 vcc, -1, v19
    s_nop 0
    s_cbranch_vccnz g_34F13_2
    v_smfmac_f32_16x16x64_bf16 v[40:43], v[32:35], a[16:23], v172
    v_smfmac_f32_16x16x64_bf16 v[44:47], v[32:35], a[80:87], v172
    v_smfmac_f32_16x16x64_bf16 v[48:51], v[32:35], a[48:55], v172
    v_smfmac_f32_16x16x64_bf16 v[52:55], v[32:35], a[112:119], v172
g_34L9_3:
    s_waitcnt vmcnt(1)
    v_max3_u32 v19, v36, v37, v38
    v_max_u32 v19, v19, v39
    v_cmp_eq_u32 vcc, -1, v19
    s_nop 0
    s_cbranch_vccnz g_34F9_3
    v_smfmac_f32_16x16x64_bf16 v[40:43], v[36:39], a[24:31], v172
    v_smfmac_f32_16x16x64_bf16 v[44:47], v[36:39], a[88:95], v172
    v_smfmac_f32_16x16x64_bf16 v[48:51], v[36:39], a[56:63], v172
    v_smfmac_f32_16x16x64_bf16 v[52:55], v[36:39], a[120:127], v172
g_34L1_0:
    s_waitcnt vmcnt(0)
    v_max3_u32 v19, v24, v25, v26
    v_max_u32 v19, v19, v27
    v_cmp_eq_u32 vcc, -1, v19
    s_nop 0
    s_cbranch_vccnz g_34F1_0
    v_smfmac_f32_16x16x64_bf16 v[40:43], v[24:27], a[0:7], v172
    v_smfmac_f32_16x16x64_bf16 v[44:47], v[24:27], a[64:71], v172
    v_smfmac_f32_16x16x64_bf16 v[48:51], v[24:27], a[32:39], v172
    v_smfmac_f32_16x16x64_bf16 v[52:55], v[24:27], a[96:103], v172
    s_branch gc_35
g_34L15_2:
    s_waitcnt vmcnt(3)
    v_max3_u32 v19, v32, v33, v34
    v_max_u32 v19, v19, v35
    v_cmp_eq_u32 vcc, -1, v19
    s_nop 0
    s_cbranch_vccnz g_34F15_2
    v_smfmac_f32_16x16x64_bf16 v[40:43], v[32:35], a[16:23], v172
    v_smfmac_f32_16x16x64_bf16 v[44:47], v[32:35], a[80:87], v172
    v_smfmac_f32_16x16x64_bf16 v[48:51], v[32:35], a[48:55], v172
    v_smfmac_f32_16x16x64_bf16 v[52:55], v[32:35], a[112:119], v172
g_34L11_3:
    s_waitcnt vmcnt(2)
    v_max3_u32 v19, v36, v37, v38
    v_max_u32 v19, v19, v39
    v_cmp_eq_u32 vcc, -1, v19
    s_nop 0
    s_cbranch_vccnz g_34F11_3
    v_smfmac_f32_16x16x64_bf16 v[40:43], v[36:39], a[24:31], v172
    v_smfmac_f32_16x16x64_bf16 v[44:47], v[36:39], a[88:95], v172
    v_smfmac_f32_16x16x64_bf16 v[48:51], v[36:39], a[56:63], v172
    v_smfmac_f32_16x16x64_bf16 v[52:55], v[36:39], a[120:127], v172
g_34L3_0:
    s_waitcnt vmcnt(1)
    v_max3_u32 v19, v24, v25, v26
    v_max_u32 v19, v19, v27
    v_cmp_eq_u32 vcc, -1, v19
    s_nop 0
    s_cbranch_vccnz g_34F3_0
    v_smfmac_f32_16x16x64_bf16 v[40:43], v[24:27], a[0:7], v172
    v_smfmac_f32_16x16x64_bf16 v[44:47], v[24:27], a[64:71], v172
    v_smfmac_f32_16x16x64_bf16 v[48:51], v[24:27], a[32:39], v172
    v_smfmac_f32_16x16x64_bf16 v[52:55], v[24:27], a[96:103], v172
g_34L2_1:
    s_waitcnt vmcnt(0)
    v_max3_u32 v19, v28, v29, v30
    v_max_u32 v19, v19, v31
    v_cmp_eq_u32 vcc, -1, v19
    s_nop 0
    s_cbranch_vccnz g_34F2_1
    v_smfmac_f32_16x16x64_bf16 v[40:43], v[28:31], a[8:15], v172
    v_smfmac_f32_16x16x64_bf16 v[44:47], v[28:31], a[72:79], v172
    v_smfmac_f32_16x16x64_bf16 v[48:51], v[28:31], a[40:47], v172
    v_smfmac_f32_16x16x64_bf16 v[52:55], v[28:31], a[104:111], v172
    s_branch gc_35
g_34L15_3:
    s_waitcnt vmcnt(3)
    v_max3_u32 v19, v36, v37, v38
    v_max_u32 v19, v19, v39
    v_cmp_eq_u32 vcc, -1, v19
    s_nop 0
    s_cbranch_vccnz g_34F15_3
    v_smfmac_f32_16x16x64_bf16 v[40:43], v[36:39], a[24:31], v172
    v_smfmac_f32_16x16x64_bf16 v[44:47], v[36:39], a[88:95], v172
    v_smfmac_f32_16x16x64_bf16 v[48:51], v[36:39], a[56:63], v172
    v_smfmac_f32_16x16x64_bf16 v[52:55], v[36:39], a[120:127], v172
g_34L7_0:
    s_waitcnt vmcnt(2)
    v_max3_u32 v19, v24, v25, v26
    v_max_u32 v19, v19, v27
    v_cmp_eq_u32 vcc, -1, v19
    s_nop 0
    s_cbranch_vccnz g_34F7_0
    v_smfmac_f32_16x16x64_bf16 v[40:43], v[24:27], a[0:7], v172
    v_smfmac_f32_16x16x64_bf16 v[44:47], v[24:27], a[64:71], v172
    v_smfmac_f32_16x16x64_bf16 v[48:51], v[24:27], a[32:39], v172
    v_smfmac_f32_16x16x64_bf16 v[52:55], v[24:27], a[96:103], v172
g_34L6_1:
    s_waitcnt vmcnt(1)
    v_max3_u32 v19, v28, v29, v30
    v_max_u32 v19, v19, v31
    v_cmp_eq_u32 vcc, -1, v19
    s_nop 0
    s_cbranch_vccnz g_34F6_1
    v_smfmac_f32_16x16x64_bf16 v[40:43], v[28:31], a[8:15], v172
    v_smfmac_f32_16x16x64_bf16 v[44:47], v[28:31], a[72:79], v172
    v_smfmac_f32_16x16x64_bf16 v[48:51], v[28:31], a[40:47], v172
    v_smfmac_f32_16x16x64_bf16 v[52:55], v[28:31], a[104:111], v172
g_34L4_2:
    s_waitcnt vmcnt(0)
    v_max3_u32 v19, v32, v33, v34
    v_max_u32 v19, v19, v35
    v_cmp_eq_u32 vcc, -1, v19
    s_nop 0
    s_cbranch_vccnz g_34F4_2
    v_smfmac_f32_16x16x64_bf16 v[40:43], v[32:35], a[16:23], v172
    v_smfmac_f32_16x16x64_bf16 v[44:47], v[32:35], a[80:87], v172
    v_smfmac_f32_16x16x64_bf16 v[48:51], v[32:35], a[48:55], v172
    v_smfmac_f32_16x16x64_bf16 v[52:55], v[32:35], a[112:119], v172
    s_branch gc_35
g_34L7_1:
    s_waitcnt vmcnt(2)
    v_max3_u32 v19, v28, v29, v30
    v_max_u32 v19, v19, v31
    v_cmp_eq_u32 vcc, -1, v19
    s_nop 0
    s_cbranch_vccnz g_34F7_1
    v_smfmac_f32_16x16x64_bf16 v[40:43], v[28:31], a[8:15], v172
    v_smfmac_f32_16x16x64_bf16 v[44:47], v[28:31], a[72:79], v172
    v_smfmac_f32_16x16x64_bf16 v[48:51], v[28:31], a[40:47], v172
    v_smfmac_f32_16x16x64_bf16 v[52:55], v[28:31], a[104:111], v172
g_34L5_2:
    s_waitcnt vmcnt(1)
    v_max3_u32 v19, v32, v33, v34
    v_max_u32 v19, v19, v35
    v_cmp_eq_u32 vcc, -1, v19
    s_nop 0
    s_cbranch_vccnz g_34F5_2
    v_smfmac_f32_16x16x64_bf16 v[40:43], v[32:35], a[16:23], v172
    v_smfmac_f32_16x16x64_bf16 v[44:47], v[32:35], a[80:87], v172
    v_smfmac_f32_16x16x64_bf16 v[48:51], v[32:35], a[48:55], v172
    v_smfmac_f32_16x16x64_bf16 v[52:55], v[32:35], a[112:119], v172
    s_branch g_34L1_0
g_34L7_2:
    s_waitcnt vmcnt(2)
    v_max3_u32 v19, v32, v33, v34
    v_max_u32 v19, v19, v35
    v_cmp_eq_u32 vcc, -1, v19
    s_nop 0
    s_cbranch_vccnz g_34F7_2
    v_smfmac_f32_16x16x64_bf16 v[40:43], v[32:35], a[16:23], v172
    v_smfmac_f32_16x16x64_bf16 v[44:47], v[32:35], a[80:87], v172
    v_smfmac_f32_16x16x64_bf16 v[48:51], v[32:35], a[48:55], v172
    v_smfmac_f32_16x16x64_bf16 v[52:55], v[32:35], a[112:119], v172
    s_branch g_34L3_0
g_34L11_0:
    s_waitcnt vmcnt(2)
    v_max3_u32 v19, v24, v25, v26
    v_max_u32 v19, v19, v27
    v_cmp_eq_u32 vcc, -1, v19
    s_nop 0
    s_cbranch_vccnz g_34F11_0
    v_smfmac_f32_16x16x64_bf16 v[40:43], v[24:27], a[0:7], v172
    v_smfmac_f32_16x16x64_bf16 v[44:47], v[24:27], a[64:71], v172
    v_smfmac_f32_16x16x64_bf16 v[48:51], v[24:27], a[32:39], v172
    v_smfmac_f32_16x16x64_bf16 v[52:55], v[24:27], a[96:103], v172
g_34L10_1:
    s_waitcnt vmcnt(1)
    v_max3_u32 v19, v28, v29, v30
    v_max_u32 v19, v19, v31
    v_cmp_eq_u32 vcc, -1, v19
    s_nop 0
    s_cbranch_vccnz g_34F10_1
    v_smfmac_f32_16x16x64_bf16 v[40:43], v[28:31], a[8:15], v172
    v_smfmac_f32_16x16x64_bf16 v[44:47], v[28:31], a[72:79], v172
    v_smfmac_f32_16x16x64_bf16 v[48:51], v[28:31], a[40:47], v172
    v_smfmac_f32_16x16x64_bf16 v[52:55], v[28:31], a[104:111], v172
    s_branch g_34L8_3
g_34L11_1:
    s_waitcnt vmcnt(2)
    v_max3_u32 v19, v28, v29, v30
    v_max_u32 v19, v19, v31
    v_cmp_eq_u32 vcc, -1, v19
    s_nop 0
    s_cbranch_vccnz g_34F11_1
    v_smfmac_f32_16x16x64_bf16 v[40:43], v[28:31], a[8:15], v172
    v_smfmac_f32_16x16x64_bf16 v[44:47], v[28:31], a[72:79], v172
    v_smfmac_f32_16x16x64_bf16 v[48:51], v[28:31], a[40:47], v172
    v_smfmac_f32_16x16x64_bf16 v[52:55], v[28:31], a[104:111], v172
    s_branch g_34L9_3
g_34L13_0:
    s_waitcnt vmcnt(2)
    v_max3_u32 v19, v24, v25, v26
    v_max_u32 v19, v19, v27
    v_cmp_eq_u32 vcc, -1, v19
    s_nop 0
    s_cbranch_vccnz g_34F13_0
    v_smfmac_f32_16x16x64_bf16 v[40:43], v[24:27], a[0:7], v172
    v_smfmac_f32_16x16x64_bf16 v[44:47], v[24:27], a[64:71], v172
    v_smfmac_f32_16x16x64_bf16 v[48:51], v[24:27], a[32:39], v172
    v_smfmac_f32_16x16x64_bf16 v[52:55], v[24:27], a[96:103], v172
    s_branch g_34L12_2
g_34L13_3:
    s_waitcnt vmcnt(2)
    v_max3_u32 v19, v36, v37, v38
    v_max_u32 v19, v19, v39
    v_cmp_eq_u32 vcc, -1, v19
    s_nop 0
    s_cbranch_vccnz g_34F13_3
    v_smfmac_f32_16x16x64_bf16 v[40:43], v[36:39], a[24:31], v172
    v_smfmac_f32_16x16x64_bf16 v[44:47], v[36:39], a[88:95], v172
    v_smfmac_f32_16x16x64_bf16 v[48:51], v[36:39], a[56:63], v172
    v_smfmac_f32_16x16x64_bf16 v[52:55], v[36:39], a[120:127], v172
g_34L5_0:
    s_waitcnt vmcnt(1)
    v_max3_u32 v19, v24, v25, v26
    v_max_u32 v19, v19, v27
    v_cmp_eq_u32 vcc, -1, v19
    s_nop 0
    s_cbranch_vccnz g_34F5_0
    v_smfmac_f32_16x16x64_bf16 v[40:43], v[24:27], a[0:7], v172
    v_smfmac_f32_16x16x64_bf16 v[44:47], v[24:27], a[64:71], v172
    v_smfmac_f32_16x16x64_bf16 v[48:51], v[24:27], a[32:39], v172
    v_smfmac_f32_16x16x64_bf16 v[52:55], v[24:27], a[96:103], v172
    s_branch g_34L4_2
g_34L14_2:
    s_waitcnt vmcnt(2)
    v_max3_u32 v19, v32, v33, v34
    v_max_u32 v19, v19, v35
    v_cmp_eq_u32 vcc, -1, v19
    s_nop 0
    s_cbranch_vccnz g_34F14_2
    v_smfmac_f32_16x16x64_bf16 v[40:43], v[32:35], a[16:23], v172
    v_smfmac_f32_16x16x64_bf16 v[44:47], v[32:35], a[80:87], v172
    v_smfmac_f32_16x16x64_bf16 v[48:51], v[32:35], a[48:55], v172
    v_smfmac_f32_16x16x64_bf16 v[52:55], v[32:35], a[112:119], v172
g_34L10_3:
    s_waitcnt vmcnt(1)
    v_max3_u32 v19, v36, v37, v38
    v_max_u32 v19, v19, v39
    v_cmp_eq_u32 vcc, -1, v19
    s_nop 0
    s_cbranch_vccnz g_34F10_3
    v_smfmac_f32_16x16x64_bf16 v[40:43], v[36:39], a[24:31], v172
    v_smfmac_f32_16x16x64_bf16 v[44:47], v[36:39], a[88:95], v172
    v_smfmac_f32_16x16x64_bf16 v[48:51], v[36:39], a[56:63], v172
    v_smfmac_f32_16x16x64_bf16 v[52:55], v[36:39], a[120:127], v172
    s_branch g_34L2_1
g_34L14_3:
    s_waitcnt vmcnt(2)
    v_max3_u32 v19, v36, v37, v38
    v_max_u32 v19, v19, v39
    v_cmp_eq_u32 vcc, -1, v19
    s_nop 0
    s_cbranch_vccnz g_34F14_3
    v_smfmac_f32_16x16x64_bf16 v[40:43], v[36:39], a[24:31], v172
    v_smfmac_f32_16x16x64_bf16 v[44:47], v[36:39], a[88:95], v172
    v_smfmac_f32_16x16x64_bf16 v[48:51], v[36:39], a[56:63], v172
    v_smfmac_f32_16x16x64_bf16 v[52:55], v[36:39], a[120:127], v172
    s_branch g_34L6_1
g_34L3_1:
    s_waitcnt vmcnt(1)
    v_max3_u32 v19, v28, v29, v30
    v_max_u32 v19, v19, v31
    v_cmp_eq_u32 vcc, -1, v19
    s_nop 0
    s_cbranch_vccnz g_34F3_1
    v_smfmac_f32_16x16x64_bf16 v[40:43], v[28:31], a[8:15], v172
    v_smfmac_f32_16x16x64_bf16 v[44:47], v[28:31], a[72:79], v172
    v_smfmac_f32_16x16x64_bf16 v[48:51], v[28:31], a[40:47], v172
    v_smfmac_f32_16x16x64_bf16 v[52:55], v[28:31], a[104:111], v172
    s_branch g_34L1_0
g_34L6_2:
    s_waitcnt vmcnt(1)
    v_max3_u32 v19, v32, v33, v34
    v_max_u32 v19, v19, v35
    v_cmp_eq_u32 vcc, -1, v19
    s_nop 0
    s_cbranch_vccnz g_34F6_2
    v_smfmac_f32_16x16x64_bf16 v[40:43], v[32:35], a[16:23], v172
    v_smfmac_f32_16x16x64_bf16 v[44:47], v[32:35], a[80:87], v172
    v_smfmac_f32_16x16x64_bf16 v[48:51], v[32:35], a[48:55], v172
    v_smfmac_f32_16x16x64_bf16 v[52:55], v[32:35], a[112:119], v172
    s_branch g_34L2_1
g_34L9_0:
    s_waitcnt vmcnt(1)
    v_max3_u32 v19, v24, v25, v26
    v_max_u32 v19, v19, v27
    v_cmp_eq_u32 vcc, -1, v19
    s_nop 0
    s_cbranch_vccnz g_34F9_0
    v_smfmac_f32_16x16x64_bf16 v[40:43], v[24:27], a[0:7], v172
    v_smfmac_f32_16x16x64_bf16 v[44:47], v[24:27], a[64:71], v172
    v_smfmac_f32_16x16x64_bf16 v[48:51], v[24:27], a[32:39], v172
    v_smfmac_f32_16x16x64_bf16 v[52:55], v[24:27], a[96:103], v172
    s_branch g_34L8_3
g_34L12_3:
    s_waitcnt vmcnt(1)
    v_max3_u32 v19, v36, v37, v38
    v_max_u32 v19, v19, v39
    v_cmp_eq_u32 vcc, -1, v19
    s_nop 0
    s_cbranch_vccnz g_34F12_3
    v_smfmac_f32_16x16x64_bf16 v[40:43], v[36:39], a[24:31], v172
    v_smfmac_f32_16x16x64_bf16 v[44:47], v[36:39], a[88:95], v172
    v_smfmac_f32_16x16x64_bf16 v[48:51], v[36:39], a[56:63], v172
    v_smfmac_f32_16x16x64_bf16 v[52:55], v[36:39], a[120:127], v172
    s_branch g_34L4_2
g_34F15_0:
    s_mov_b64 exec, vcc
    buffer_load_dwordx4 v[24:27], v2, s[4:7], s16 offen offset:0 sc1
    s_mov_b64 exec, -1
    s_add_u32 s23, s23, 1
    s_cmp_lt_u32 s23, 200000
    s_cbranch_scc1 g_34L15_1
    s_mov_b32 s25, 200000
    s_branch gc_35
g_34F15_1:
    s_mov_b64 exec, vcc
    buffer_load_dwordx4 v[28:31], v2, s[4:7], s16 offen offset:1024 sc1
    s_mov_b64 exec, -1
    s_add_u32 s23, s23, 1
    s_cmp_lt_u32 s23, 200000
    s_cbranch_scc1 g_34L15_2
    s_mov_b32 s25, 200000
    s_branch gc_35
g_34F15_2:
    s_mov_b64 exec, vcc
    buffer_load_dwordx4 v[32:35], v2, s[4:7], s16 offen offset:2048 sc1
    s_mov_b64 exec, -1
    s_add_u32 s23, s23, 1
    s_cmp_lt_u32 s23, 200000
    s_cbranch_scc1 g_34L15_3
    s_mov_b32 s25, 200000
    s_branch gc_35
g_34F15_3:
    s_mov_b64 exec, vcc
    buffer_load_dwordx4 v[36:39], v2, s[4:7], s16 offen offset:3072 sc1
    s_mov_b64 exec, -1
    s_add_u32 s23, s23, 1
    s_cmp_lt_u32 s23, 200000
    s_cbranch_scc1 g_34L15_0
    s_mov_b32 s25, 200000
    s_branch gc_35
g_34F7_0:
    s_mov_b64 exec, vcc
    buffer_load_dwordx4 v[24:27], v2, s[4:7], s16 offen offset:0 sc1
    s_mov_b64 exec, -1
    s_add_u32 s23, s23, 1
    s_cmp_lt_u32 s23, 200000
    s_cbranch_scc1 g_34L7_1
    s_mov_b32 s25, 200000
    s_branch gc_35
g_34F7_1:
    s_mov_b64 exec, vcc
    buffer_load_dwordx4 v[28:31], v2, s[4:7], s16 offen offset:1024 sc1
    s_mov_b64 exec, -1
    s_add_u32 s23, s23, 1
    s_cmp_lt_u32 s23, 200000
    s_cbranch_scc1 g_34L7_2
    s_mov_b32 s25, 200000
    s_branch gc_35
g_34F7_2:
    s_mov_b64 exec, vcc
    buffer_load_dwordx4 v[32:35], v2, s[4:7], s16 offen offset:2048 sc1
    s_mov_b64 exec, -1
    s_add_u32 s23, s23, 1
    s_cmp_lt_u32 s23, 200000
    s_cbranch_scc1 g_34L7_0
    s_mov_b32 s25, 200000
    s_branch gc_35
g_34F11_0:
    s_mov_b64 exec, vcc
    buffer_load_dwordx4 v[24:27], v2, s[4:7], s16 offen offset:0 sc1
    s_mov_b64 exec, -1
    s_add_u32 s23, s23, 1
    s_cmp_lt_u32 s23, 200000
    s_cbranch_scc1 g_34L11_1
    s_mov_b32 s25, 200000
    s_branch gc_35
g_34F11_1:
    s_mov_b64 exec, vcc
    buffer_load_dwordx4 v[28:31], v2, s[4:7], s16 offen offset:1024 sc1
    s_mov_b64 exec, -1
    s_add_u32 s23, s23, 1
    s_cmp_lt_u32 s23, 200000
    s_cbranch_scc1 g_34L11_3
    s_mov_b32 s25, 200000
    s_branch gc_35
g_34F11_3:
    s_mov_b64 exec, vcc
    buffer_load_dwordx4 v[36:39], v2, s[4:7], s16 offen offset:3072 sc1
    s_mov_b64 exec, -1
    s_add_u32 s23, s23, 1
    s_cmp_lt_u32 s23, 200000
    s_cbranch_scc1 g_34L11_0
    s_mov_b32 s25, 200000
    s_branch gc_35
g_34F13_0:
    s_mov_b64 exec, vcc
    buffer_load_dwordx4 v[24:27], v2, s[4:7], s16 offen offset:0 sc1
    s_mov_b64 exec, -1
    s_add_u32 s23, s23, 1
    s_cmp_lt_u32 s23, 200000
    s_cbranch_scc1 g_34L13_2
    s_mov_b32 s25, 200000
    s_branch gc_35
g_34F13_2:
    s_mov_b64 exec, vcc
    buffer_load_dwordx4 v[32:35], v2, s[4:7], s16 offen offset:2048 sc1
    s_mov_b64 exec, -1
    s_add_u32 s23, s23, 1
    s_cmp_lt_u32 s23, 200000
    s_cbranch_scc1 g_34L13_3
    s_mov_b32 s25, 200000
    s_branch gc_35
g_34F13_3:
    s_mov_b64 exec, vcc
    buffer_load_dwordx4 v[36:39], v2, s[4:7], s16 offen offset:3072 sc1
    s_mov_b64 exec, -1
    s_add_u32 s23, s23, 1
    s_cmp_lt_u32 s23, 200000
    s_cbranch_scc1 g_34L13_0
    s_mov_b32 s25, 200000
    s_branch gc_35
g_34F14_1:
    s_mov_b64 exec, vcc
    buffer_load_dwordx4 v[28:31], v2, s[4:7], s16 offen offset:1024 sc1
    s_mov_b64 exec, -1
    s_add_u32 s23, s23, 1
    s_cmp_lt_u32 s23, 200000
    s_cbranch_scc1 g_34L14_2
    s_mov_b32 s25, 200000
    s_branch gc_35
g_34F14_2:
    s_mov_b64 exec, vcc
    buffer_load_dwordx4 v[32:35], v2, s[4:7], s16 offen offset:2048 sc1
    s_mov_b64 exec, -1
    s_add_u32 s23, s23, 1
    s_cmp_lt_u32 s23, 200000
    s_cbranch_scc1 g_34L14_3
    s_mov_b32 s25, 200000
    s_branch gc_35
g_34F14_3:
    s_mov_b64 exec, vcc
    buffer_load_dwordx4 v[36:39], v2, s[4:7], s16 offen offset:3072 sc1
    s_mov_b64 exec, -1
    s_add_u32 s23, s23, 1
    s_cmp_lt_u32 s23, 200000
    s_cbranch_scc1 g_34L14_1
    s_mov_b32 s25, 200000
    s_branch gc_35
g_34F3_0:
    s_mov_b64 exec, vcc
    buffer_load_dwordx4 v[24:27], v2, s[4:7], s16 offen offset:0 sc1
    s_mov_b64 exec, -1
    s_add_u32 s23, s23, 1
    s_cmp_lt_u32 s23, 200000
    s_cbranch_scc1 g_34L3_1
    s_mov_b32 s25, 200000
    s_branch gc_35
g_34F3_1:
    s_mov_b64 exec, vcc
    buffer_load_dwordx4 v[28:31], v2, s[4:7], s16 offen offset:1024 sc1
    s_mov_b64 exec, -1
    s_add_u32 s23, s23, 1
    s_cmp_lt_u32 s23, 200000
    s_cbranch_scc1 g_34L3_0
    s_mov_b32 s25, 200000
    s_branch gc_35
g_34F5_0:
    s_mov_b64 exec, vcc
    buffer_load_dwordx4 v[24:27], v2, s[4:7], s16 offen offset:0 sc1
    s_mov_b64 exec, -1
    s_add_u32 s23, s23, 1
    s_cmp_lt_u32 s23, 200000
    s_cbranch_scc1 g_34L5_2
    s_mov_b32 s25, 200000
    s_branch gc_35
g_34F5_2:
    s_mov_b64 exec, vcc
    buffer_load_dwordx4 v[32:35], v2, s[4:7], s16 offen offset:2048 sc1
    s_mov_b64 exec, -1
    s_add_u32 s23, s23, 1
    s_cmp_lt_u32 s23, 200000
    s_cbranch_scc1 g_34L5_0
    s_mov_b32 s25, 200000
    s_branch gc_35
g_34F6_1:
    s_mov_b64 exec, vcc
    buffer_load_dwordx4 v[28:31], v2, s[4:7], s16 offen offset:1024 sc1
    s_mov_b64 exec, -1
    s_add_u32 s23, s23, 1
    s_cmp_lt_u32 s23, 200000
    s_cbranch_scc1 g_34L6_2
    s_mov_b32 s25, 200000
    s_branch gc_35
g_34F6_2:
    s_mov_b64 exec, vcc
    buffer_load_dwordx4 v[32:35], v2, s[4:7], s16 offen offset:2048 sc1
    s_mov_b64 exec, -1
    s_add_u32 s23, s23, 1
    s_cmp_lt_u32 s23, 200000
    s_cbranch_scc1 g_34L6_1
    s_mov_b32 s25, 200000
    s_branch gc_35
g_34F9_0:
    s_mov_b64 exec, vcc
    buffer_load_dwordx4 v[24:27], v2, s[4:7], s16 offen offset:0 sc1
    s_mov_b64 exec, -1
    s_add_u32 s23, s23, 1
    s_cmp_lt_u32 s23, 200000
    s_cbranch_scc1 g_34L9_3
    s_mov_b32 s25, 200000
    s_branch gc_35
g_34F9_3:
    s_mov_b64 exec, vcc
    buffer_load_dwordx4 v[36:39], v2, s[4:7], s16 offen offset:3072 sc1
    s_mov_b64 exec, -1
    s_add_u32 s23, s23, 1
    s_cmp_lt_u32 s23, 200000
    s_cbranch_scc1 g_34L9_0
    s_mov_b32 s25, 200000
    s_branch gc_35
g_34F10_1:
    s_mov_b64 exec, vcc
    buffer_load_dwordx4 v[28:31], v2, s[4:7], s16 offen offset:1024 sc1
    s_mov_b64 exec, -1
    s_add_u32 s23, s23, 1
    s_cmp_lt_u32 s23, 200000
    s_cbranch_scc1 g_34L10_3
    s_mov_b32 s25, 200000
    s_branch gc_35
g_34F10_3:
    s_mov_b64 exec, vcc
    buffer_load_dwordx4 v[36:39], v2, s[4:7], s16 offen offset:3072 sc1
    s_mov_b64 exec, -1
    s_add_u32 s23, s23, 1
    s_cmp_lt_u32 s23, 200000
    s_cbranch_scc1 g_34L10_1
    s_mov_b32 s25, 200000
    s_branch gc_35
g_34F12_2:
    s_mov_b64 exec, vcc
    buffer_load_dwordx4 v[32:35], v2, s[4:7], s16 offen offset:2048 sc1
    s_mov_b64 exec, -1
    s_add_u32 s23, s23, 1
    s_cmp_lt_u32 s23, 200000
    s_cbranch_scc1 g_34L12_3
    s_mov_b32 s25, 200000
    s_branch gc_35
g_34F12_3:
    s_mov_b64 exec, vcc
    buffer_load_dwordx4 v[36:39], v2, s[4:7], s16 offen offset:3072 sc1
    s_mov_b64 exec, -1
    s_add_u32 s23, s23, 1
    s_cmp_lt_u32 s23, 200000
    s_cbranch_scc1 g_34L12_2
    s_mov_b32 s25, 200000
    s_branch gc_35
g_34F1_0:
    s_mov_b64 exec, vcc
    buffer_load_dwordx4 v[24:27], v2, s[4:7], s16 offen offset:0 sc1
    s_mov_b64 exec, -1
    s_add_u32 s23, s23, 1
    s_cmp_lt_u32 s23, 200000
    s_cbranch_scc1 g_34L1_0
    s_mov_b32 s25, 200000
    s_branch gc_35
g_34F2_1:
    s_mov_b64 exec, vcc
    buffer_load_dwordx4 v[28:31], v2, s[4:7], s16 offen offset:1024 sc1
    s_mov_b64 exec, -1
    s_add_u32 s23, s23, 1
    s_cmp_lt_u32 s23, 200000
    s_cbranch_scc1 g_34L2_1
    s_mov_b32 s25, 200000
    s_branch gc_35
g_34F4_2:
    s_mov_b64 exec, vcc
    buffer_load_dwordx4 v[32:35], v2, s[4:7], s16 offen offset:2048 sc1
    s_mov_b64 exec, -1
    s_add_u32 s23, s23, 1
    s_cmp_lt_u32 s23, 200000
    s_cbranch_scc1 g_34L4_2
    s_mov_b32 s25, 200000
    s_branch gc_35
g_34F8_3:
    s_mov_b64 exec, vcc
    buffer_load_dwordx4 v[36:39], v2, s[4:7], s16 offen offset:3072 sc1
    s_mov_b64 exec, -1
    s_add_u32 s23, s23, 1
    s_cmp_lt_u32 s23, 200000
    s_cbranch_scc1 g_34L8_3
    s_mov_b32 s25, 200000
    s_branch gc_35
sb_37:
    v_max3_u32 v19, v24, v25, v26
    v_max3_u32 v19, v19, v27, v28
    v_max3_u32 v19, v19, v29, v30
    v_max3_u32 v19, v19, v31, v32
    v_max3_u32 v19, v19, v33, v34
    v_max3_u32 v19, v19, v35, v36
    v_max3_u32 v19, v19, v37, v38
    v_max3_u32 v19, v19, v39, v40
    v_max3_u32 v19, v19, v41, v42
    v_max_u32 v19, v19, v43
    v_cmp_eq_u32 vcc, -1, v19
    s_nop 0
    s_cbranch_vccz sg_38
    buffer_load_dwordx4 v[24:27], v5, s[4:7], s16 offen offset:0 sc1
    buffer_load_dwordx4 v[28:31], v5, s[4:7], s16 offen offset:1024 sc1
    buffer_load_dwordx4 v[32:35], v5, s[4:7], s16 offen offset:2048 sc1
    buffer_load_dwordx4 v[36:39], v5, s[4:7], s16 offen offset:3072 sc1
    buffer_load_dword v40, v6, s[4:7], s16 offen offset:0 sc1
    buffer_load_dword v41, v6, s[4:7], s16 offen offset:256 sc1
    buffer_load_dword v42, v6, s[4:7], s16 offen offset:512 sc1
    buffer_load_dword v43, v6, s[4:7], s16 offen offset:768 sc1
    s_add_u32 s23, s23, 1
    s_cmp_lt_u32 s23, 200000
    s_cbranch_scc1 ss_36
    s_mov_b32 s25, 200000
    s_branch sg_38
ss_36:
    s_waitcnt vmcnt(6)
    v_pk_add_f32 v[180:181], v[24:25], v[28:29]
    v_pk_add_f32 v[182:183], v[26:27], v[30:31]
    s_waitcnt vmcnt(4)
    v_pk_add_f32 v[188:189], v[32:33], v[36:37]
    v_pk_add_f32 v[190:191], v[34:35], v[38:39]
    v_pk_add_f32 v[180:181], v[180:181], v[188:189]
    v_pk_add_f32 v[182:183], v[182:183], v[190:191]
    v_pk_add_f32 v[188:189], v[180:181], v[182:183]
    v_max3_f32 v185, v180, v181, v182
    s_waitcnt vmcnt(0)
    v_pk_add_f32 v[192:193], v[40:41], v[42:43]
    v_add_f32 v188, v188, v189
    v_add_f32 v184, v192, v193
    v_max3_f32 v185, v185, v183, v184
    v_cmp_u_f32 vcc, v188, v184
    s_nop 0
    v_max_f32_dpp v185, v185, v185 row_ror:8 row_mask:0xf bank_mask:0xf
    v_mov_b32 v186, v185
    s_nop 1
    v_permlane16_swap_b32 v185, v186
    v_max_f32 v185, v185, v186
    v_mov_b32 v186, v185
    s_cbranch_vccnz sb_37
    s_branch sg_38
g_39L15_0:
    s_waitcnt vmcnt(3)
    v_max3_u32 v19, v24, v25, v26
    v_max_u32 v19, v19, v27
    v_cmp_eq_u32 vcc, -1, v19
    s_nop 0
    s_cbranch_vccnz g_39F15_0
    v_smfmac_f32_16x16x64_bf16 v[64:67], v[24:27], a[192:199], v172
    v_smfmac_f32_16x16x64_bf16 v[68:71], v[24:27], a[224:231], v172
g_39L14_1:
    s_waitcnt vmcnt(2)
    v_max3_u32 v19, v28, v29, v30
    v_max_u32 v19, v19, v31
    v_cmp_eq_u32 vcc, -1, v19
    s_nop 0
    s_cbranch_vccnz g_39F14_1
    v_smfmac_f32_16x16x64_bf16 v[64:67], v[28:31], a[200:207], v172
    v_smfmac_f32_16x16x64_bf16 v[68:71], v[28:31], a[232:239], v172
g_39L12_2:
    s_waitcnt vmcnt(1)
    v_max3_u32 v19, v32, v33, v34
    v_max_u32 v19, v19, v35
    v_cmp_eq_u32 vcc, -1, v19
    s_nop 0
    s_cbranch_vccnz g_39F12_2
    v_smfmac_f32_16x16x64_bf16 v[64:67], v[32:35], a[208:215], v172
    v_smfmac_f32_16x16x64_bf16 v[68:71], v[32:35], a[240:247], v172
g_39L8_3:
    s_waitcnt vmcnt(0)
    v_max3_u32 v19, v36, v37, v38
    v_max_u32 v19, v19, v39
    v_cmp_eq_u32 vcc, -1, v19
    s_nop 0
    s_cbranch_vccnz g_39F8_3
    v_smfmac_f32_16x16x64_bf16 v[64:67], v[36:39], a[216:223], v172
    v_smfmac_f32_16x16x64_bf16 v[68:71], v[36:39], a[248:255], v172
    s_nop 4
    v_cvt_pk_bf16_f32 v80, v64, v65
    v_cvt_pk_bf16_f32 v81, v66, v67
    s_nop 0
    v_cvt_pk_bf16_f32 v82, v68, v69
    v_cvt_pk_bf16_f32 v83, v70, v71
    ds_write_b128 v17, v[80:83] offset:9216
    s_branch gc_40
g_39L15_1:
    s_waitcnt vmcnt(3)
    v_max3_u32 v19, v28, v29, v30
    v_max_u32 v19, v19, v31
    v_cmp_eq_u32 vcc, -1, v19
    s_nop 0
    s_cbranch_vccnz g_39F15_1
    v_smfmac_f32_16x16x64_bf16 v[64:67], v[28:31], a[200:207], v172
    v_smfmac_f32_16x16x64_bf16 v[68:71], v[28:31], a[232:239], v172
g_39L13_2:
    s_waitcnt vmcnt(2)
    v_max3_u32 v19, v32, v33, v34
    v_max_u32 v19, v19, v35
    v_cmp_eq_u32 vcc, -1, v19
    s_nop 0
    s_cbranch_vccnz g_39F13_2
    v_smfmac_f32_16x16x64_bf16 v[64:67], v[32:35], a[208:215], v172
    v_smfmac_f32_16x16x64_bf16 v[68:71], v[32:35], a[240:247], v172
g_39L9_3:
    s_waitcnt vmcnt(1)
    v_max3_u32 v19, v36, v37, v38
    v_max_u32 v19, v19, v39
    v_cmp_eq_u32 vcc, -1, v19
    s_nop 0
    s_cbranch_vccnz g_39F9_3
    v_smfmac_f32_16x16x64_bf16 v[64:67], v[36:39], a[216:223], v172
    v_smfmac_f32_16x16x64_bf16 v[68:71], v[36:39], a[248:255], v172
g_39L1_0:
    s_waitcnt vmcnt(0)
    v_max3_u32 v19, v24, v25, v26
    v_max_u32 v19, v19, v27
    v_cmp_eq_u32 vcc, -1, v19
    s_nop 0
    s_cbranch_vccnz g_39F1_0
    v_smfmac_f32_16x16x64_bf16 v[64:67], v[24:27], a[192:199], v172
    v_smfmac_f32_16x16x64_bf16 v[68:71], v[24:27], a[224:231], v172
    s_nop 4
    v_cvt_pk_bf16_f32 v80, v64, v65
    v_cvt_pk_bf16_f32 v81, v66, v67
    s_nop 0
    v_cvt_pk_bf16_f32 v82, v68, v69
    v_cvt_pk_bf16_f32 v83, v70, v71
    ds_write_b128 v17, v[80:83] offset:9216
    s_branch gc_40
g_39L15_2:
    s_waitcnt vmcnt(3)
    v_max3_u32 v19, v32, v33, v34
    v_max_u32 v19, v19, v35
    v_cmp_eq_u32 vcc, -1, v19
    s_nop 0
    s_cbranch_vccnz g_39F15_2
    v_smfmac_f32_16x16x64_bf16 v[64:67], v[32:35], a[208:215], v172
    v_smfmac_f32_16x16x64_bf16 v[68:71], v[32:35], a[240:247], v172
g_39L11_3:
    s_waitcnt vmcnt(2)
    v_max3_u32 v19, v36, v37, v38
    v_max_u32 v19, v19, v39
    v_cmp_eq_u32 vcc, -1, v19
    s_nop 0
    s_cbranch_vccnz g_39F11_3
    v_smfmac_f32_16x16x64_bf16 v[64:67], v[36:39], a[216:223], v172
    v_smfmac_f32_16x16x64_bf16 v[68:71], v[36:39], a[248:255], v172
g_39L3_0:
    s_waitcnt vmcnt(1)
    v_max3_u32 v19, v24, v25, v26
    v_max_u32 v19, v19, v27
    v_cmp_eq_u32 vcc, -1, v19
    s_nop 0
    s_cbranch_vccnz g_39F3_0
    v_smfmac_f32_16x16x64_bf16 v[64:67], v[24:27], a[192:199], v172
    v_smfmac_f32_16x16x64_bf16 v[68:71], v[24:27], a[224:231], v172
g_39L2_1:
    s_waitcnt vmcnt(0)
    v_max3_u32 v19, v28, v29, v30
    v_max_u32 v19, v19, v31
    v_cmp_eq_u32 vcc, -1, v19
    s_nop 0
    s_cbranch_vccnz g_39F2_1
    v_smfmac_f32_16x16x64_bf16 v[64:67], v[28:31], a[200:207], v172
    v_smfmac_f32_16x16x64_bf16 v[68:71], v[28:31], a[232:239], v172
    s_nop 4
    v_cvt_pk_bf16_f32 v80, v64, v65
    v_cvt_pk_bf16_f32 v81, v66, v67
    s_nop 0
    v_cvt_pk_bf16_f32 v82, v68, v69
    v_cvt_pk_bf16_f32 v83, v70, v71
    ds_write_b128 v17, v[80:83] offset:9216
    s_branch gc_40
g_39L15_3:
    s_waitcnt vmcnt(3)
    v_max3_u32 v19, v36, v37, v38
    v_max_u32 v19, v19, v39
    v_cmp_eq_u32 vcc, -1, v19
    s_nop 0
    s_cbranch_vccnz g_39F15_3
    v_smfmac_f32_16x16x64_bf16 v[64:67], v[36:39], a[216:223], v172
    v_smfmac_f32_16x16x64_bf16 v[68:71], v[36:39], a[248:255], v172
g_39L7_0:
    s_waitcnt vmcnt(2)
    v_max3_u32 v19, v24, v25, v26
    v_max_u32 v19, v19, v27
    v_cmp_eq_u32 vcc, -1, v19
    s_nop 0
    s_cbranch_vccnz g_39F7_0
    v_smfmac_f32_16x16x64_bf16 v[64:67], v[24:27], a[192:199], v172
    v_smfmac_f32_16x16x64_bf16 v[68:71], v[24:27], a[224:231], v172
g_39L6_1:
    s_waitcnt vmcnt(1)
    v_max3_u32 v19, v28, v29, v30
    v_max_u32 v19, v19, v31
    v_cmp_eq_u32 vcc, -1, v19
    s_nop 0
    s_cbranch_vccnz g_39F6_1
    v_smfmac_f32_16x16x64_bf16 v[64:67], v[28:31], a[200:207], v172
    v_smfmac_f32_16x16x64_bf16 v[68:71], v[28:31], a[232:239], v172
g_39L4_2:
    s_waitcnt vmcnt(0)
    v_max3_u32 v19, v32, v33, v34
    v_max_u32 v19, v19, v35
    v_cmp_eq_u32 vcc, -1, v19
    s_nop 0
    s_cbranch_vccnz g_39F4_2
    v_smfmac_f32_16x16x64_bf16 v[64:67], v[32:35], a[208:215], v172
    v_smfmac_f32_16x16x64_bf16 v[68:71], v[32:35], a[240:247], v172
    s_nop 4
    v_cvt_pk_bf16_f32 v80, v64, v65
    v_cvt_pk_bf16_f32 v81, v66, v67
    s_nop 0
    v_cvt_pk_bf16_f32 v82, v68, v69
    v_cvt_pk_bf16_f32 v83, v70, v71
    ds_write_b128 v17, v[80:83] offset:9216
    s_branch gc_40
g_39L7_1:
    s_waitcnt vmcnt(2)
    v_max3_u32 v19, v28, v29, v30
    v_max_u32 v19, v19, v31
    v_cmp_eq_u32 vcc, -1, v19
    s_nop 0
    s_cbranch_vccnz g_39F7_1
    v_smfmac_f32_16x16x64_bf16 v[64:67], v[28:31], a[200:207], v172
    v_smfmac_f32_16x16x64_bf16 v[68:71], v[28:31], a[232:239], v172
g_39L5_2:
    s_waitcnt vmcnt(1)
    v_max3_u32 v19, v32, v33, v34
    v_max_u32 v19, v19, v35
    v_cmp_eq_u32 vcc, -1, v19
    s_nop 0
    s_cbranch_vccnz g_39F5_2
    v_smfmac_f32_16x16x64_bf16 v[64:67], v[32:35], a[208:215], v172
    v_smfmac_f32_16x16x64_bf16 v[68:71], v[32:35], a[240:247], v172
    s_branch g_39L1_0
g_39L7_2:
    s_waitcnt vmcnt(2)
    v_max3_u32 v19, v32, v33, v34
    v_max_u32 v19, v19, v35
    v_cmp_eq_u32 vcc, -1, v19
    s_nop 0
    s_cbranch_vccnz g_39F7_2
    v_smfmac_f32_16x16x64_bf16 v[64:67], v[32:35], a[208:215], v172
    v_smfmac_f32_16x16x64_bf16 v[68:71], v[32:35], a[240:247], v172
    s_branch g_39L3_0
g_39L11_0:
    s_waitcnt vmcnt(2)
    v_max3_u32 v19, v24, v25, v26
    v_max_u32 v19, v19, v27
    v_cmp_eq_u32 vcc, -1, v19
    s_nop 0
    s_cbranch_vccnz g_39F11_0
    v_smfmac_f32_16x16x64_bf16 v[64:67], v[24:27], a[192:199], v172
    v_smfmac_f32_16x16x64_bf16 v[68:71], v[24:27], a[224:231], v172
g_39L10_1:
    s_waitcnt vmcnt(1)
    v_max3_u32 v19, v28, v29, v30
    v_max_u32 v19, v19, v31
    v_cmp_eq_u32 vcc, -1, v19
    s_nop 0
    s_cbranch_vccnz g_39F10_1
    v_smfmac_f32_16x16x64_bf16 v[64:67], v[28:31], a[200:207], v172
    v_smfmac_f32_16x16x64_bf16 v[68:71], v[28:31], a[232:239], v172
    s_branch g_39L8_3
g_39L11_1:
    s_waitcnt vmcnt(2)
    v_max3_u32 v19, v28, v29, v30
    v_max_u32 v19, v19, v31
    v_cmp_eq_u32 vcc, -1, v19
    s_nop 0
    s_cbranch_vccnz g_39F11_1
    v_smfmac_f32_16x16x64_bf16 v[64:67], v[28:31], a[200:207], v172
    v_smfmac_f32_16x16x64_bf16 v[68:71], v[28:31], a[232:239], v172
    s_branch g_39L9_3
g_39L13_0:
    s_waitcnt vmcnt(2)
    v_max3_u32 v19, v24, v25, v26
    v_max_u32 v19, v19, v27
    v_cmp_eq_u32 vcc, -1, v19
    s_nop 0
    s_cbranch_vccnz g_39F13_0
    v_smfmac_f32_16x16x64_bf16 v[64:67], v[24:27], a[192:199], v172
    v_smfmac_f32_16x16x64_bf16 v[68:71], v[24:27], a[224:231], v172
    s_branch g_39L12_2
g_39L13_3:
    s_waitcnt vmcnt(2)
    v_max3_u32 v19, v36, v37, v38
    v_max_u32 v19, v19, v39
    v_cmp_eq_u32 vcc, -1, v19
    s_nop 0
    s_cbranch_vccnz g_39F13_3
    v_smfmac_f32_16x16x64_bf16 v[64:67], v[36:39], a[216:223], v172
    v_smfmac_f32_16x16x64_bf16 v[68:71], v[36:39], a[248:255], v172
g_39L5_0:
    s_waitcnt vmcnt(1)
    v_max3_u32 v19, v24, v25, v26
    v_max_u32 v19, v19, v27
    v_cmp_eq_u32 vcc, -1, v19
    s_nop 0
    s_cbranch_vccnz g_39F5_0
    v_smfmac_f32_16x16x64_bf16 v[64:67], v[24:27], a[192:199], v172
    v_smfmac_f32_16x16x64_bf16 v[68:71], v[24:27], a[224:231], v172
    s_branch g_39L4_2
g_39L14_2:
    s_waitcnt vmcnt(2)
    v_max3_u32 v19, v32, v33, v34
    v_max_u32 v19, v19, v35
    v_cmp_eq_u32 vcc, -1, v19
    s_nop 0
    s_cbranch_vccnz g_39F14_2
    v_smfmac_f32_16x16x64_bf16 v[64:67], v[32:35], a[208:215], v172
    v_smfmac_f32_16x16x64_bf16 v[68:71], v[32:35], a[240:247], v172
g_39L10_3:
    s_waitcnt vmcnt(1)
    v_max3_u32 v19, v36, v37, v38
    v_max_u32 v19, v19, v39
    v_cmp_eq_u32 vcc, -1, v19
    s_nop 0
    s_cbranch_vccnz g_39F10_3
    v_smfmac_f32_16x16x64_bf16 v[64:67], v[36:39], a[216:223], v172
    v_smfmac_f32_16x16x64_bf16 v[68:71], v[36:39], a[248:255], v172
    s_branch g_39L2_1
g_39L14_3:
    s_waitcnt vmcnt(2)
    v_max3_u32 v19, v36, v37, v38
    v_max_u32 v19, v19, v39
    v_cmp_eq_u32 vcc, -1, v19
    s_nop 0
    s_cbranch_vccnz g_39F14_3
    v_smfmac_f32_16x16x64_bf16 v[64:67], v[36:39], a[216:223], v172
    v_smfmac_f32_16x16x64_bf16 v[68:71], v[36:39], a[248:255], v172
    s_branch g_39L6_1
g_39L3_1:
    s_waitcnt vmcnt(1)
    v_max3_u32 v19, v28, v29, v30
    v_max_u32 v19, v19, v31
    v_cmp_eq_u32 vcc, -1, v19
    s_nop 0
    s_cbranch_vccnz g_39F3_1
    v_smfmac_f32_16x16x64_bf16 v[64:67], v[28:31], a[200:207], v172
    v_smfmac_f32_16x16x64_bf16 v[68:71], v[28:31], a[232:239], v172
    s_branch g_39L1_0
g_39L6_2:
    s_waitcnt vmcnt(1)
    v_max3_u32 v19, v32, v33, v34
    v_max_u32 v19, v19, v35
    v_cmp_eq_u32 vcc, -1, v19
    s_nop 0
    s_cbranch_vccnz g_39F6_2
    v_smfmac_f32_16x16x64_bf16 v[64:67], v[32:35], a[208:215], v172
    v_smfmac_f32_16x16x64_bf16 v[68:71], v[32:35], a[240:247], v172
    s_branch g_39L2_1
g_39L9_0:
    s_waitcnt vmcnt(1)
    v_max3_u32 v19, v24, v25, v26
    v_max_u32 v19, v19, v27
    v_cmp_eq_u32 vcc, -1, v19
    s_nop 0
    s_cbranch_vccnz g_39F9_0
    v_smfmac_f32_16x16x64_bf16 v[64:67], v[24:27], a[192:199], v172
    v_smfmac_f32_16x16x64_bf16 v[68:71], v[24:27], a[224:231], v172
    s_branch g_39L8_3
g_39L12_3:
    s_waitcnt vmcnt(1)
    v_max3_u32 v19, v36, v37, v38
    v_max_u32 v19, v19, v39
    v_cmp_eq_u32 vcc, -1, v19
    s_nop 0
    s_cbranch_vccnz g_39F12_3
    v_smfmac_f32_16x16x64_bf16 v[64:67], v[36:39], a[216:223], v172
    v_smfmac_f32_16x16x64_bf16 v[68:71], v[36:39], a[248:255], v172
    s_branch g_39L4_2
g_39F15_0:
    s_mov_b64 exec, vcc
    buffer_load_dwordx4 v[24:27], v8, s[4:7], s16 offen offset:0 sc1
    s_mov_b64 exec, -1
    s_add_u32 s23, s23, 1
    s_cmp_lt_u32 s23, 200000
    s_cbranch_scc1 g_39L15_1
    s_mov_b32 s25, 200000
    s_branch gc_40
g_39F15_1:
    s_mov_b64 exec, vcc
    buffer_load_dwordx4 v[28:31], v8, s[4:7], s16 offen offset:1024 sc1
    s_mov_b64 exec, -1
    s_add_u32 s23, s23, 1
    s_cmp_lt_u32 s23, 200000
    s_cbranch_scc1 g_39L15_2
    s_mov_b32 s25, 200000
    s_branch gc_40
g_39F15_2:
    s_mov_b64 exec, vcc
    buffer_load_dwordx4 v[32:35], v8, s[4:7], s16 offen offset:2048 sc1
    s_mov_b64 exec, -1
    s_add_u32 s23, s23, 1
    s_cmp_lt_u32 s23, 200000
    s_cbranch_scc1 g_39L15_3
    s_mov_b32 s25, 200000
    s_branch gc_40
g_39F15_3:
    s_mov_b64 exec, vcc
    buffer_load_dwordx4 v[36:39], v8, s[4:7], s16 offen offset:3072 sc1
    s_mov_b64 exec, -1
    s_add_u32 s23, s23, 1
    s_cmp_lt_u32 s23, 200000
    s_cbranch_scc1 g_39L15_0
    s_mov_b32 s25, 200000
    s_branch gc_40
g_39F7_0:
    s_mov_b64 exec, vcc
    buffer_load_dwordx4 v[24:27], v8, s[4:7], s16 offen offset:0 sc1
    s_mov_b64 exec, -1
    s_add_u32 s23, s23, 1
    s_cmp_lt_u32 s23, 200000
    s_cbranch_scc1 g_39L7_1
    s_mov_b32 s25, 200000
    s_branch gc_40
g_39F7_1:
    s_mov_b64 exec, vcc
    buffer_load_dwordx4 v[28:31], v8, s[4:7], s16 offen offset:1024 sc1
    s_mov_b64 exec, -1
    s_add_u32 s23, s23, 1
    s_cmp_lt_u32 s23, 200000
    s_cbranch_scc1 g_39L7_2
    s_mov_b32 s25, 200000
    s_branch gc_40
g_39F7_2:
    s_mov_b64 exec, vcc
    buffer_load_dwordx4 v[32:35], v8, s[4:7], s16 offen offset:2048 sc1
    s_mov_b64 exec, -1
    s_add_u32 s23, s23, 1
    s_cmp_lt_u32 s23, 200000
    s_cbranch_scc1 g_39L7_0
    s_mov_b32 s25, 200000
    s_branch gc_40
g_39F11_0:
    s_mov_b64 exec, vcc
    buffer_load_dwordx4 v[24:27], v8, s[4:7], s16 offen offset:0 sc1
    s_mov_b64 exec, -1
    s_add_u32 s23, s23, 1
    s_cmp_lt_u32 s23, 200000
    s_cbranch_scc1 g_39L11_1
    s_mov_b32 s25, 200000
    s_branch gc_40
g_39F11_1:
    s_mov_b64 exec, vcc
    buffer_load_dwordx4 v[28:31], v8, s[4:7], s16 offen offset:1024 sc1
    s_mov_b64 exec, -1
    s_add_u32 s23, s23, 1
    s_cmp_lt_u32 s23, 200000
    s_cbranch_scc1 g_39L11_3
    s_mov_b32 s25, 200000
    s_branch gc_40
g_39F11_3:
    s_mov_b64 exec, vcc
    buffer_load_dwordx4 v[36:39], v8, s[4:7], s16 offen offset:3072 sc1
    s_mov_b64 exec, -1
    s_add_u32 s23, s23, 1
    s_cmp_lt_u32 s23, 200000
    s_cbranch_scc1 g_39L11_0
    s_mov_b32 s25, 200000
    s_branch gc_40
g_39F13_0:
    s_mov_b64 exec, vcc
    buffer_load_dwordx4 v[24:27], v8, s[4:7], s16 offen offset:0 sc1
    s_mov_b64 exec, -1
    s_add_u32 s23, s23, 1
    s_cmp_lt_u32 s23, 200000
    s_cbranch_scc1 g_39L13_2
    s_mov_b32 s25, 200000
    s_branch gc_40
g_39F13_2:
    s_mov_b64 exec, vcc
    buffer_load_dwordx4 v[32:35], v8, s[4:7], s16 offen offset:2048 sc1
    s_mov_b64 exec, -1
    s_add_u32 s23, s23, 1
    s_cmp_lt_u32 s23, 200000
    s_cbranch_scc1 g_39L13_3
    s_mov_b32 s25, 200000
    s_branch gc_40
g_39F13_3:
    s_mov_b64 exec, vcc
    buffer_load_dwordx4 v[36:39], v8, s[4:7], s16 offen offset:3072 sc1
    s_mov_b64 exec, -1
    s_add_u32 s23, s23, 1
    s_cmp_lt_u32 s23, 200000
    s_cbranch_scc1 g_39L13_0
    s_mov_b32 s25, 200000
    s_branch gc_40
g_39F14_1:
    s_mov_b64 exec, vcc
    buffer_load_dwordx4 v[28:31], v8, s[4:7], s16 offen offset:1024 sc1
    s_mov_b64 exec, -1
    s_add_u32 s23, s23, 1
    s_cmp_lt_u32 s23, 200000
    s_cbranch_scc1 g_39L14_2
    s_mov_b32 s25, 200000
    s_branch gc_40
g_39F14_2:
    s_mov_b64 exec, vcc
    buffer_load_dwordx4 v[32:35], v8, s[4:7], s16 offen offset:2048 sc1
    s_mov_b64 exec, -1
    s_add_u32 s23, s23, 1
    s_cmp_lt_u32 s23, 200000
    s_cbranch_scc1 g_39L14_3
    s_mov_b32 s25, 200000
    s_branch gc_40
g_39F14_3:
    s_mov_b64 exec, vcc
    buffer_load_dwordx4 v[36:39], v8, s[4:7], s16 offen offset:3072 sc1
    s_mov_b64 exec, -1
    s_add_u32 s23, s23, 1
    s_cmp_lt_u32 s23, 200000
    s_cbranch_scc1 g_39L14_1
    s_mov_b32 s25, 200000
    s_branch gc_40
g_39F3_0:
    s_mov_b64 exec, vcc
    buffer_load_dwordx4 v[24:27], v8, s[4:7], s16 offen offset:0 sc1
    s_mov_b64 exec, -1
    s_add_u32 s23, s23, 1
    s_cmp_lt_u32 s23, 200000
    s_cbranch_scc1 g_39L3_1
    s_mov_b32 s25, 200000
    s_branch gc_40
g_39F3_1:
    s_mov_b64 exec, vcc
    buffer_load_dwordx4 v[28:31], v8, s[4:7], s16 offen offset:1024 sc1
    s_mov_b64 exec, -1
    s_add_u32 s23, s23, 1
    s_cmp_lt_u32 s23, 200000
    s_cbranch_scc1 g_39L3_0
    s_mov_b32 s25, 200000
    s_branch gc_40
g_39F5_0:
    s_mov_b64 exec, vcc
    buffer_load_dwordx4 v[24:27], v8, s[4:7], s16 offen offset:0 sc1
    s_mov_b64 exec, -1
    s_add_u32 s23, s23, 1
    s_cmp_lt_u32 s23, 200000
    s_cbranch_scc1 g_39L5_2
    s_mov_b32 s25, 200000
    s_branch gc_40
g_39F5_2:
    s_mov_b64 exec, vcc
    buffer_load_dwordx4 v[32:35], v8, s[4:7], s16 offen offset:2048 sc1
    s_mov_b64 exec, -1
    s_add_u32 s23, s23, 1
    s_cmp_lt_u32 s23, 200000
    s_cbranch_scc1 g_39L5_0
    s_mov_b32 s25, 200000
    s_branch gc_40
g_39F6_1:
    s_mov_b64 exec, vcc
    buffer_load_dwordx4 v[28:31], v8, s[4:7], s16 offen offset:1024 sc1
    s_mov_b64 exec, -1
    s_add_u32 s23, s23, 1
    s_cmp_lt_u32 s23, 200000
    s_cbranch_scc1 g_39L6_2
    s_mov_b32 s25, 200000
    s_branch gc_40
g_39F6_2:
    s_mov_b64 exec, vcc
    buffer_load_dwordx4 v[32:35], v8, s[4:7], s16 offen offset:2048 sc1
    s_mov_b64 exec, -1
    s_add_u32 s23, s23, 1
    s_cmp_lt_u32 s23, 200000
    s_cbranch_scc1 g_39L6_1
    s_mov_b32 s25, 200000
    s_branch gc_40
g_39F9_0:
    s_mov_b64 exec, vcc
    buffer_load_dwordx4 v[24:27], v8, s[4:7], s16 offen offset:0 sc1
    s_mov_b64 exec, -1
    s_add_u32 s23, s23, 1
    s_cmp_lt_u32 s23, 200000
    s_cbranch_scc1 g_39L9_3
    s_mov_b32 s25, 200000
    s_branch gc_40
g_39F9_3:
    s_mov_b64 exec, vcc
    buffer_load_dwordx4 v[36:39], v8, s[4:7], s16 offen offset:3072 sc1
    s_mov_b64 exec, -1
    s_add_u32 s23, s23, 1
    s_cmp_lt_u32 s23, 200000
    s_cbranch_scc1 g_39L9_0
    s_mov_b32 s25, 200000
    s_branch gc_40
g_39F10_1:
    s_mov_b64 exec, vcc
    buffer_load_dwordx4 v[28:31], v8, s[4:7], s16 offen offset:1024 sc1
    s_mov_b64 exec, -1
    s_add_u32 s23, s23, 1
    s_cmp_lt_u32 s23, 200000
    s_cbranch_scc1 g_39L10_3
    s_mov_b32 s25, 200000
    s_branch gc_40
g_39F10_3:
    s_mov_b64 exec, vcc
    buffer_load_dwordx4 v[36:39], v8, s[4:7], s16 offen offset:3072 sc1
    s_mov_b64 exec, -1
    s_add_u32 s23, s23, 1
    s_cmp_lt_u32 s23, 200000
    s_cbranch_scc1 g_39L10_1
    s_mov_b32 s25, 200000
    s_branch gc_40
g_39F12_2:
    s_mov_b64 exec, vcc
    buffer_load_dwordx4 v[32:35], v8, s[4:7], s16 offen offset:2048 sc1
    s_mov_b64 exec, -1
    s_add_u32 s23, s23, 1
    s_cmp_lt_u32 s23, 200000
    s_cbranch_scc1 g_39L12_3
    s_mov_b32 s25, 200000
    s_branch gc_40
g_39F12_3:
    s_mov_b64 exec, vcc
    buffer_load_dwordx4 v[36:39], v8, s[4:7], s16 offen offset:3072 sc1
    s_mov_b64 exec, -1
    s_add_u32 s23, s23, 1
    s_cmp_lt_u32 s23, 200000
    s_cbranch_scc1 g_39L12_2
    s_mov_b32 s25, 200000
    s_branch gc_40
g_39F1_0:
    s_mov_b64 exec, vcc
    buffer_load_dwordx4 v[24:27], v8, s[4:7], s16 offen offset:0 sc1
    s_mov_b64 exec, -1
    s_add_u32 s23, s23, 1
    s_cmp_lt_u32 s23, 200000
    s_cbranch_scc1 g_39L1_0
    s_mov_b32 s25, 200000
    s_branch gc_40
g_39F2_1:
    s_mov_b64 exec, vcc
    buffer_load_dwordx4 v[28:31], v8, s[4:7], s16 offen offset:1024 sc1
    s_mov_b64 exec, -1
    s_add_u32 s23, s23, 1
    s_cmp_lt_u32 s23, 200000
    s_cbranch_scc1 g_39L2_1
    s_mov_b32 s25, 200000
    s_branch gc_40
g_39F4_2:
    s_mov_b64 exec, vcc
    buffer_load_dwordx4 v[32:35], v8, s[4:7], s16 offen offset:2048 sc1
    s_mov_b64 exec, -1
    s_add_u32 s23, s23, 1
    s_cmp_lt_u32 s23, 200000
    s_cbranch_scc1 g_39L4_2
    s_mov_b32 s25, 200000
    s_branch gc_40
g_39F8_3:
    s_mov_b64 exec, vcc
    buffer_load_dwordx4 v[36:39], v8, s[4:7], s16 offen offset:3072 sc1
    s_mov_b64 exec, -1
    s_add_u32 s23, s23, 1
    s_cmp_lt_u32 s23, 200000
    s_cbranch_scc1 g_39L8_3
    s_mov_b32 s25, 200000
    s_branch gc_40
.p2align 6
recur_fast_w2:
    s_nop 15
    s_mov_b32 s23, s25
    buffer_load_dwordx4 v[24:27], v2, s[4:7], s16 offen offset:0 sc1
    s_nop 11
    buffer_load_dwordx4 v[28:31], v2, s[4:7], s16 offen offset:1024 sc1
    s_nop 11
    buffer_load_dwordx4 v[32:35], v2, s[4:7], s16 offen offset:2048 sc1
    s_nop 11
    buffer_load_dwordx4 v[36:39], v2, s[4:7], s16 offen offset:3072 sc1
    s_waitcnt vmcnt(3)
    v_max3_u32 v19, v24, v25, v26
    v_max_u32 v19, v19, v27
    v_cmp_eq_u32 vcc, -1, v19
    s_nop 0
    s_cbranch_vccnz g_43F15_0
    v_smfmac_f32_16x16x64_bf16 v[40:43], v[24:27], a[0:7], v172
    s_waitcnt vmcnt(2)
    v_max3_u32 v19, v28, v29, v30
    v_max_u32 v19, v19, v31
    v_smfmac_f32_16x16x64_bf16 v[44:47], v[24:27], a[64:71], v172
    v_cmp_eq_u32 vcc, -1, v19
    v_smfmac_f32_16x16x64_bf16 v[48:51], v[24:27], a[32:39], v172
    v_smfmac_f32_16x16x64_bf16 v[52:55], v[24:27], a[96:103], v172
    s_cbranch_vccnz g_43F14_1
    v_smfmac_f32_16x16x64_bf16 v[40:43], v[28:31], a[8:15], v172
    s_waitcnt vmcnt(1)
    v_max3_u32 v19, v32, v33, v34
    v_max_u32 v19, v19, v35
    v_smfmac_f32_16x16x64_bf16 v[44:47], v[28:31], a[72:79], v172
    v_cmp_eq_u32 vcc, -1, v19
    v_smfmac_f32_16x16x64_bf16 v[48:51], v[28:31], a[40:47], v172
    v_smfmac_f32_16x16x64_bf16 v[52:55], v[28:31], a[104:111], v172
    s_cbranch_vccnz g_43F12_2
    v_smfmac_f32_16x16x64_bf16 v[40:43], v[32:35], a[16:23], v172
    s_waitcnt vmcnt(0)
    v_max3_u32 v19, v36, v37, v38
    v_max_u32 v19, v19, v39
    v_smfmac_f32_16x16x64_bf16 v[44:47], v[32:35], a[80:87], v172
    v_cmp_eq_u32 vcc, -1, v19
    v_smfmac_f32_16x16x64_bf16 v[48:51], v[32:35], a[48:55], v172
    v_smfmac_f32_16x16x64_bf16 v[52:55], v[32:35], a[112:119], v172
    s_cbranch_vccnz g_43F8_3
    v_smfmac_f32_16x16x64_bf16 v[40:43], v[36:39], a[24:31], v172
    v_smfmac_f32_16x16x64_bf16 v[44:47], v[36:39], a[88:95], v172
    v_smfmac_f32_16x16x64_bf16 v[48:51], v[36:39], a[56:63], v172
    v_smfmac_f32_16x16x64_bf16 v[52:55], v[36:39], a[120:127], v172
gc_44:
    v_cvt_pk_bf16_f32 v72, v40, v41
    v_cvt_pk_bf16_f32 v73, v42, v43
    v_cvt_pk_bf16_f32 v74, v44, v45
    v_cvt_pk_bf16_f32 v75, v46, v47
    ds_write_b128 v17, v[72:75] offset:0
    v_cvt_pk_bf16_f32 v76, v48, v49
    v_cvt_pk_bf16_f32 v77, v50, v51
    s_nop 0
    v_cvt_pk_bf16_f32 v78, v52, v53
    v_cvt_pk_bf16_f32 v79, v54, v55
    ds_write_b128 v17, v[76:79] offset:1024
    v_smfmac_f32_16x16x64_bf16 v[56:59], v[24:27], a[128:135], v172
    v_smfmac_f32_16x16x64_bf16 v[60:63], v[24:27], a[160:167], v172
    v_smfmac_f32_16x16x64_bf16 v[56:59], v[28:31], a[136:143], v172
    s_waitcnt lgkmcnt(0)
    s_barrier
    v_smfmac_f32_16x16x64_bf16 v[60:63], v[28:31], a[168:175], v172
    v_smfmac_f32_16x16x64_bf16 v[56:59], v[32:35], a[144:151], v172
    v_smfmac_f32_16x16x64_bf16 v[60:63], v[32:35], a[176:183], v172
    v_smfmac_f32_16x16x64_bf16 v[56:59], v[36:39], a[152:159], v172
    v_smfmac_f32_16x16x64_bf16 v[60:63], v[36:39], a[184:191], v172
    s_nop 4
    v_cvt_pk_bf16_f32 v80, v56, v57
    v_cvt_pk_bf16_f32 v81, v58, v59
    s_nop 0
    v_cvt_pk_bf16_f32 v82, v60, v61
    v_cvt_pk_bf16_f32 v83, v62, v63
    ds_write_b128 v17, v[80:83] offset:8192
    s_cmp_eq_u32 s15, 63
    s_waitcnt lgkmcnt(0)
    s_barrier
    ds_read_b128 v[96:99], v16 offset:8192
    ds_read_b128 v[100:103], v16 offset:10240
    ds_read_b128 v[108:111], v16 offset:14336
    v_mfma_f32_16x16x32_bf16 v[140:143], v[84:87], v[80:83], 0
    s_waitcnt lgkmcnt(2)
    v_mfma_f32_16x16x32_bf16 v[140:143], v[84:87], v[96:99], v[140:143]
    s_waitcnt lgkmcnt(1)
    v_mfma_f32_16x16x32_bf16 v[140:143], v[84:87], v[100:103], v[140:143]
    s_waitcnt lgkmcnt(0)
    v_mfma_f32_16x16x32_bf16 v[140:143], v[84:87], v[108:111], v[140:143]
    s_nop 7
    v_cvt_pk_bf16_f32 v168, v140, v141
    v_cvt_pk_bf16_f32 v169, v142, v143
    v_mov_b32 v170, v168
    v_mov_b32 v171, v169
    s_nop 0
    v_permlane16_swap_b32 v168, v170
    v_permlane16_swap_b32 v169, v171
    v_mov_b32 v247, s15
    s_cbranch_scc1 recur_fast_last2
    s_barrier
    s_nop 15
    s_mov_b32 s23, s25
    buffer_load_dwordx4 v[24:27], v8, s[4:7], s16 offen offset:0 sc1
    s_nop 11
    buffer_load_dwordx4 v[28:31], v8, s[4:7], s16 offen offset:1024 sc1
    s_nop 11
    buffer_load_dwordx4 v[32:35], v8, s[4:7], s16 offen offset:2048 sc1
    s_nop 11
    buffer_load_dwordx4 v[36:39], v8, s[4:7], s16 offen offset:3072 sc1
    s_waitcnt vmcnt(3)
    v_max3_u32 v19, v24, v25, v26
    v_max_u32 v19, v19, v27
    v_cmp_eq_u32 vcc, -1, v19
    s_nop 0
    s_cbranch_vccnz g_45F15_0
    v_smfmac_f32_16x16x64_bf16 v[64:67], v[24:27], a[192:199], v172
    v_smfmac_f32_16x16x64_bf16 v[68:71], v[24:27], a[224:231], v172
    s_waitcnt vmcnt(2)
    v_max3_u32 v19, v28, v29, v30
    v_max_u32 v19, v19, v31
    v_cmp_eq_u32 vcc, -1, v19
    s_nop 0
    s_cbranch_vccnz g_45F14_1
    v_smfmac_f32_16x16x64_bf16 v[64:67], v[28:31], a[200:207], v172
    v_smfmac_f32_16x16x64_bf16 v[68:71], v[28:31], a[232:239], v172
    s_waitcnt vmcnt(1)
    v_max3_u32 v19, v32, v33, v34
    v_max_u32 v19, v19, v35
    v_cmp_eq_u32 vcc, -1, v19
    s_nop 0
    s_cbranch_vccnz g_45F12_2
    v_smfmac_f32_16x16x64_bf16 v[64:67], v[32:35], a[208:215], v172
    v_smfmac_f32_16x16x64_bf16 v[68:71], v[32:35], a[240:247], v172
    s_waitcnt vmcnt(0)
    v_max3_u32 v19, v36, v37, v38
    v_max_u32 v19, v19, v39
    v_cmp_eq_u32 vcc, -1, v19
    s_nop 0
    s_cbranch_vccnz g_45F8_3
    v_smfmac_f32_16x16x64_bf16 v[64:67], v[36:39], a[216:223], v172
    v_smfmac_f32_16x16x64_bf16 v[68:71], v[36:39], a[248:255], v172
    s_nop 4
    v_cvt_pk_bf16_f32 v80, v64, v65
    v_cvt_pk_bf16_f32 v81, v66, v67
    s_nop 0
    v_cvt_pk_bf16_f32 v82, v68, v69
    v_cvt_pk_bf16_f32 v83, v70, v71
    ds_write_b128 v17, v[80:83] offset:9216
gc_46:
    s_waitcnt lgkmcnt(0)
    s_barrier
    s_nop 15
    s_nop 15
    s_nop 15
    s_nop 15
    buffer_store_dwordx4 v[168:171], v15, s[4:7], s20 offen sc1
    s_add_u32 s20, s20, 512
    s_add_u32 s21, s95, 1048576
    s_lshr_b32 s22, s21, 8
    s_and_b32 s22, s22, 8192
    s_xor_b32 s22, s22, s46
    s_add_u32 s21, s21, s22
    buffer_store_dwordx4 v[204:207], v9, s[4:7], s21 offen sc1
    s_add_u32 s21, s21, 262144
    buffer_store_dword v247, v246, s[4:7], 0 offen sc1
    v_mov_b32 v40, 0
    v_mov_b32 v41, 0
    v_mov_b32 v42, 0
    v_mov_b32 v43, 0
    v_mov_b32 v44, 0
    v_mov_b32 v45, 0
    v_mov_b32 v46, 0
    v_mov_b32 v47, 0
    v_mov_b32 v48, 0
    v_mov_b32 v49, 0
    v_mov_b32 v50, 0
    v_mov_b32 v51, 0
    v_mov_b32 v52, 0
    v_mov_b32 v53, 0
    v_mov_b32 v54, 0
    v_mov_b32 v55, 0
    v_mov_b32 v56, 0
    v_mov_b32 v57, 0
    v_mov_b32 v58, 0
    v_mov_b32 v59, 0
    v_mov_b32 v60, 0
    v_mov_b32 v61, 0
    v_mov_b32 v62, 0
    v_mov_b32 v63, 0
    v_mov_b32 v64, 0
    v_mov_b32 v65, 0
    v_mov_b32 v66, 0
    v_mov_b32 v67, 0
    v_mov_b32 v68, 0
    v_mov_b32 v69, 0
    v_mov_b32 v70, 0
    v_mov_b32 v71, 0
    s_mov_b32 s21, s16
    s_mov_b32 s16, s42
    s_mov_b32 s42, s43
    s_mov_b32 s43, s44
    s_mov_b32 s44, s21
    s_add_u32 s95, s95, 524288
    s_lshr_b32 s84, s95, 8
    s_and_b32 s84, s84, 8192
    s_xor_b32 s84, s84, s46
    s_add_u32 s84, s84, s95
    s_add_u32 s15, s15, 1
    s_barrier
    s_branch recur_fast_w2
g_43L15_0:
    s_waitcnt vmcnt(3)
    v_max3_u32 v19, v24, v25, v26
    v_max_u32 v19, v19, v27
    v_cmp_eq_u32 vcc, -1, v19
    s_nop 0
    s_cbranch_vccnz g_43F15_0
    v_smfmac_f32_16x16x64_bf16 v[40:43], v[24:27], a[0:7], v172
    v_smfmac_f32_16x16x64_bf16 v[44:47], v[24:27], a[64:71], v172
    v_smfmac_f32_16x16x64_bf16 v[48:51], v[24:27], a[32:39], v172
    v_smfmac_f32_16x16x64_bf16 v[52:55], v[24:27], a[96:103], v172
g_43L14_1:
    s_waitcnt vmcnt(2)
    v_max3_u32 v19, v28, v29, v30
    v_max_u32 v19, v19, v31
    v_cmp_eq_u32 vcc, -1, v19
    s_nop 0
    s_cbranch_vccnz g_43F14_1
    v_smfmac_f32_16x16x64_bf16 v[40:43], v[28:31], a[8:15], v172
    v_smfmac_f32_16x16x64_bf16 v[44:47], v[28:31], a[72:79], v172
    v_smfmac_f32_16x16x64_bf16 v[48:51], v[28:31], a[40:47], v172
    v_smfmac_f32_16x16x64_bf16 v[52:55], v[28:31], a[104:111], v172
g_43L12_2:
    s_waitcnt vmcnt(1)
    v_max3_u32 v19, v32, v33, v34
    v_max_u32 v19, v19, v35
    v_cmp_eq_u32 vcc, -1, v19
    s_nop 0
    s_cbranch_vccnz g_43F12_2
    v_smfmac_f32_16x16x64_bf16 v[40:43], v[32:35], a[16:23], v172
    v_smfmac_f32_16x16x64_bf16 v[44:47], v[32:35], a[80:87], v172
    v_smfmac_f32_16x16x64_bf16 v[48:51], v[32:35], a[48:55], v172
    v_smfmac_f32_16x16x64_bf16 v[52:55], v[32:35], a[112:119], v172
g_43L8_3:
    s_waitcnt vmcnt(0)
    v_max3_u32 v19, v36, v37, v38
    v_max_u32 v19, v19, v39
    v_cmp_eq_u32 vcc, -1, v19
    s_nop 0
    s_cbranch_vccnz g_43F8_3
    v_smfmac_f32_16x16x64_bf16 v[40:43], v[36:39], a[24:31], v172
    v_smfmac_f32_16x16x64_bf16 v[44:47], v[36:39], a[88:95], v172
    v_smfmac_f32_16x16x64_bf16 v[48:51], v[36:39], a[56:63], v172
    v_smfmac_f32_16x16x64_bf16 v[52:55], v[36:39], a[120:127], v172
    s_branch gc_44
g_43L15_1:
    s_waitcnt vmcnt(3)
    v_max3_u32 v19, v28, v29, v30
    v_max_u32 v19, v19, v31
    v_cmp_eq_u32 vcc, -1, v19
    s_nop 0
    s_cbranch_vccnz g_43F15_1
    v_smfmac_f32_16x16x64_bf16 v[40:43], v[28:31], a[8:15], v172
    v_smfmac_f32_16x16x64_bf16 v[44:47], v[28:31], a[72:79], v172
    v_smfmac_f32_16x16x64_bf16 v[48:51], v[28:31], a[40:47], v172
    v_smfmac_f32_16x16x64_bf16 v[52:55], v[28:31], a[104:111], v172
g_43L13_2:
    s_waitcnt vmcnt(2)
    v_max3_u32 v19, v32, v33, v34
    v_max_u32 v19, v19, v35
    v_cmp_eq_u32 vcc, -1, v19
    s_nop 0
    s_cbranch_vccnz g_43F13_2
    v_smfmac_f32_16x16x64_bf16 v[40:43], v[32:35], a[16:23], v172
    v_smfmac_f32_16x16x64_bf16 v[44:47], v[32:35], a[80:87], v172
    v_smfmac_f32_16x16x64_bf16 v[48:51], v[32:35], a[48:55], v172
    v_smfmac_f32_16x16x64_bf16 v[52:55], v[32:35], a[112:119], v172
g_43L9_3:
    s_waitcnt vmcnt(1)
    v_max3_u32 v19, v36, v37, v38
    v_max_u32 v19, v19, v39
    v_cmp_eq_u32 vcc, -1, v19
    s_nop 0
    s_cbranch_vccnz g_43F9_3
    v_smfmac_f32_16x16x64_bf16 v[40:43], v[36:39], a[24:31], v172
    v_smfmac_f32_16x16x64_bf16 v[44:47], v[36:39], a[88:95], v172
    v_smfmac_f32_16x16x64_bf16 v[48:51], v[36:39], a[56:63], v172
    v_smfmac_f32_16x16x64_bf16 v[52:55], v[36:39], a[120:127], v172
g_43L1_0:
    s_waitcnt vmcnt(0)
    v_max3_u32 v19, v24, v25, v26
    v_max_u32 v19, v19, v27
    v_cmp_eq_u32 vcc, -1, v19
    s_nop 0
    s_cbranch_vccnz g_43F1_0
    v_smfmac_f32_16x16x64_bf16 v[40:43], v[24:27], a[0:7], v172
    v_smfmac_f32_16x16x64_bf16 v[44:47], v[24:27], a[64:71], v172
    v_smfmac_f32_16x16x64_bf16 v[48:51], v[24:27], a[32:39], v172
    v_smfmac_f32_16x16x64_bf16 v[52:55], v[24:27], a[96:103], v172
    s_branch gc_44
g_43L15_2:
    s_waitcnt vmcnt(3)
    v_max3_u32 v19, v32, v33, v34
    v_max_u32 v19, v19, v35
    v_cmp_eq_u32 vcc, -1, v19
    s_nop 0
    s_cbranch_vccnz g_43F15_2
    v_smfmac_f32_16x16x64_bf16 v[40:43], v[32:35], a[16:23], v172
    v_smfmac_f32_16x16x64_bf16 v[44:47], v[32:35], a[80:87], v172
    v_smfmac_f32_16x16x64_bf16 v[48:51], v[32:35], a[48:55], v172
    v_smfmac_f32_16x16x64_bf16 v[52:55], v[32:35], a[112:119], v172
g_43L11_3:
    s_waitcnt vmcnt(2)
    v_max3_u32 v19, v36, v37, v38
    v_max_u32 v19, v19, v39
    v_cmp_eq_u32 vcc, -1, v19
    s_nop 0
    s_cbranch_vccnz g_43F11_3
    v_smfmac_f32_16x16x64_bf16 v[40:43], v[36:39], a[24:31], v172
    v_smfmac_f32_16x16x64_bf16 v[44:47], v[36:39], a[88:95], v172
    v_smfmac_f32_16x16x64_bf16 v[48:51], v[36:39], a[56:63], v172
    v_smfmac_f32_16x16x64_bf16 v[52:55], v[36:39], a[120:127], v172
g_43L3_0:
    s_waitcnt vmcnt(1)
    v_max3_u32 v19, v24, v25, v26
    v_max_u32 v19, v19, v27
    v_cmp_eq_u32 vcc, -1, v19
    s_nop 0
    s_cbranch_vccnz g_43F3_0
    v_smfmac_f32_16x16x64_bf16 v[40:43], v[24:27], a[0:7], v172
    v_smfmac_f32_16x16x64_bf16 v[44:47], v[24:27], a[64:71], v172
    v_smfmac_f32_16x16x64_bf16 v[48:51], v[24:27], a[32:39], v172
    v_smfmac_f32_16x16x64_bf16 v[52:55], v[24:27], a[96:103], v172
g_43L2_1:
    s_waitcnt vmcnt(0)
    v_max3_u32 v19, v28, v29, v30
    v_max_u32 v19, v19, v31
    v_cmp_eq_u32 vcc, -1, v19
    s_nop 0
    s_cbranch_vccnz g_43F2_1
    v_smfmac_f32_16x16x64_bf16 v[40:43], v[28:31], a[8:15], v172
    v_smfmac_f32_16x16x64_bf16 v[44:47], v[28:31], a[72:79], v172
    v_smfmac_f32_16x16x64_bf16 v[48:51], v[28:31], a[40:47], v172
    v_smfmac_f32_16x16x64_bf16 v[52:55], v[28:31], a[104:111], v172
    s_branch gc_44
g_43L15_3:
    s_waitcnt vmcnt(3)
    v_max3_u32 v19, v36, v37, v38
    v_max_u32 v19, v19, v39
    v_cmp_eq_u32 vcc, -1, v19
    s_nop 0
    s_cbranch_vccnz g_43F15_3
    v_smfmac_f32_16x16x64_bf16 v[40:43], v[36:39], a[24:31], v172
    v_smfmac_f32_16x16x64_bf16 v[44:47], v[36:39], a[88:95], v172
    v_smfmac_f32_16x16x64_bf16 v[48:51], v[36:39], a[56:63], v172
    v_smfmac_f32_16x16x64_bf16 v[52:55], v[36:39], a[120:127], v172
g_43L7_0:
    s_waitcnt vmcnt(2)
    v_max3_u32 v19, v24, v25, v26
    v_max_u32 v19, v19, v27
    v_cmp_eq_u32 vcc, -1, v19
    s_nop 0
    s_cbranch_vccnz g_43F7_0
    v_smfmac_f32_16x16x64_bf16 v[40:43], v[24:27], a[0:7], v172
    v_smfmac_f32_16x16x64_bf16 v[44:47], v[24:27], a[64:71], v172
    v_smfmac_f32_16x16x64_bf16 v[48:51], v[24:27], a[32:39], v172
    v_smfmac_f32_16x16x64_bf16 v[52:55], v[24:27], a[96:103], v172
g_43L6_1:
    s_waitcnt vmcnt(1)
    v_max3_u32 v19, v28, v29, v30
    v_max_u32 v19, v19, v31
    v_cmp_eq_u32 vcc, -1, v19
    s_nop 0
    s_cbranch_vccnz g_43F6_1
    v_smfmac_f32_16x16x64_bf16 v[40:43], v[28:31], a[8:15], v172
    v_smfmac_f32_16x16x64_bf16 v[44:47], v[28:31], a[72:79], v172
    v_smfmac_f32_16x16x64_bf16 v[48:51], v[28:31], a[40:47], v172
    v_smfmac_f32_16x16x64_bf16 v[52:55], v[28:31], a[104:111], v172
g_43L4_2:
    s_waitcnt vmcnt(0)
    v_max3_u32 v19, v32, v33, v34
    v_max_u32 v19, v19, v35
    v_cmp_eq_u32 vcc, -1, v19
    s_nop 0
    s_cbranch_vccnz g_43F4_2
    v_smfmac_f32_16x16x64_bf16 v[40:43], v[32:35], a[16:23], v172
    v_smfmac_f32_16x16x64_bf16 v[44:47], v[32:35], a[80:87], v172
    v_smfmac_f32_16x16x64_bf16 v[48:51], v[32:35], a[48:55], v172
    v_smfmac_f32_16x16x64_bf16 v[52:55], v[32:35], a[112:119], v172
    s_branch gc_44
g_43L7_1:
    s_waitcnt vmcnt(2)
    v_max3_u32 v19, v28, v29, v30
    v_max_u32 v19, v19, v31
    v_cmp_eq_u32 vcc, -1, v19
    s_nop 0
    s_cbranch_vccnz g_43F7_1
    v_smfmac_f32_16x16x64_bf16 v[40:43], v[28:31], a[8:15], v172
    v_smfmac_f32_16x16x64_bf16 v[44:47], v[28:31], a[72:79], v172
    v_smfmac_f32_16x16x64_bf16 v[48:51], v[28:31], a[40:47], v172
    v_smfmac_f32_16x16x64_bf16 v[52:55], v[28:31], a[104:111], v172
g_43L5_2:
    s_waitcnt vmcnt(1)
    v_max3_u32 v19, v32, v33, v34
    v_max_u32 v19, v19, v35
    v_cmp_eq_u32 vcc, -1, v19
    s_nop 0
    s_cbranch_vccnz g_43F5_2
    v_smfmac_f32_16x16x64_bf16 v[40:43], v[32:35], a[16:23], v172
    v_smfmac_f32_16x16x64_bf16 v[44:47], v[32:35], a[80:87], v172
    v_smfmac_f32_16x16x64_bf16 v[48:51], v[32:35], a[48:55], v172
    v_smfmac_f32_16x16x64_bf16 v[52:55], v[32:35], a[112:119], v172
    s_branch g_43L1_0
g_43L7_2:
    s_waitcnt vmcnt(2)
    v_max3_u32 v19, v32, v33, v34
    v_max_u32 v19, v19, v35
    v_cmp_eq_u32 vcc, -1, v19
    s_nop 0
    s_cbranch_vccnz g_43F7_2
    v_smfmac_f32_16x16x64_bf16 v[40:43], v[32:35], a[16:23], v172
    v_smfmac_f32_16x16x64_bf16 v[44:47], v[32:35], a[80:87], v172
    v_smfmac_f32_16x16x64_bf16 v[48:51], v[32:35], a[48:55], v172
    v_smfmac_f32_16x16x64_bf16 v[52:55], v[32:35], a[112:119], v172
    s_branch g_43L3_0
g_43L11_0:
    s_waitcnt vmcnt(2)
    v_max3_u32 v19, v24, v25, v26
    v_max_u32 v19, v19, v27
    v_cmp_eq_u32 vcc, -1, v19
    s_nop 0
    s_cbranch_vccnz g_43F11_0
    v_smfmac_f32_16x16x64_bf16 v[40:43], v[24:27], a[0:7], v172
    v_smfmac_f32_16x16x64_bf16 v[44:47], v[24:27], a[64:71], v172
    v_smfmac_f32_16x16x64_bf16 v[48:51], v[24:27], a[32:39], v172
    v_smfmac_f32_16x16x64_bf16 v[52:55], v[24:27], a[96:103], v172
g_43L10_1:
    s_waitcnt vmcnt(1)
    v_max3_u32 v19, v28, v29, v30
    v_max_u32 v19, v19, v31
    v_cmp_eq_u32 vcc, -1, v19
    s_nop 0
    s_cbranch_vccnz g_43F10_1
    v_smfmac_f32_16x16x64_bf16 v[40:43], v[28:31], a[8:15], v172
    v_smfmac_f32_16x16x64_bf16 v[44:47], v[28:31], a[72:79], v172
    v_smfmac_f32_16x16x64_bf16 v[48:51], v[28:31], a[40:47], v172
    v_smfmac_f32_16x16x64_bf16 v[52:55], v[28:31], a[104:111], v172
    s_branch g_43L8_3
g_43L11_1:
    s_waitcnt vmcnt(2)
    v_max3_u32 v19, v28, v29, v30
    v_max_u32 v19, v19, v31
    v_cmp_eq_u32 vcc, -1, v19
    s_nop 0
    s_cbranch_vccnz g_43F11_1
    v_smfmac_f32_16x16x64_bf16 v[40:43], v[28:31], a[8:15], v172
    v_smfmac_f32_16x16x64_bf16 v[44:47], v[28:31], a[72:79], v172
    v_smfmac_f32_16x16x64_bf16 v[48:51], v[28:31], a[40:47], v172
    v_smfmac_f32_16x16x64_bf16 v[52:55], v[28:31], a[104:111], v172
    s_branch g_43L9_3
g_43L13_0:
    s_waitcnt vmcnt(2)
    v_max3_u32 v19, v24, v25, v26
    v_max_u32 v19, v19, v27
    v_cmp_eq_u32 vcc, -1, v19
    s_nop 0
    s_cbranch_vccnz g_43F13_0
    v_smfmac_f32_16x16x64_bf16 v[40:43], v[24:27], a[0:7], v172
    v_smfmac_f32_16x16x64_bf16 v[44:47], v[24:27], a[64:71], v172
    v_smfmac_f32_16x16x64_bf16 v[48:51], v[24:27], a[32:39], v172
    v_smfmac_f32_16x16x64_bf16 v[52:55], v[24:27], a[96:103], v172
    s_branch g_43L12_2
g_43L13_3:
    s_waitcnt vmcnt(2)
    v_max3_u32 v19, v36, v37, v38
    v_max_u32 v19, v19, v39
    v_cmp_eq_u32 vcc, -1, v19
    s_nop 0
    s_cbranch_vccnz g_43F13_3
    v_smfmac_f32_16x16x64_bf16 v[40:43], v[36:39], a[24:31], v172
    v_smfmac_f32_16x16x64_bf16 v[44:47], v[36:39], a[88:95], v172
    v_smfmac_f32_16x16x64_bf16 v[48:51], v[36:39], a[56:63], v172
    v_smfmac_f32_16x16x64_bf16 v[52:55], v[36:39], a[120:127], v172
g_43L5_0:
    s_waitcnt vmcnt(1)
    v_max3_u32 v19, v24, v25, v26
    v_max_u32 v19, v19, v27
    v_cmp_eq_u32 vcc, -1, v19
    s_nop 0
    s_cbranch_vccnz g_43F5_0
    v_smfmac_f32_16x16x64_bf16 v[40:43], v[24:27], a[0:7], v172
    v_smfmac_f32_16x16x64_bf16 v[44:47], v[24:27], a[64:71], v172
    v_smfmac_f32_16x16x64_bf16 v[48:51], v[24:27], a[32:39], v172
    v_smfmac_f32_16x16x64_bf16 v[52:55], v[24:27], a[96:103], v172
    s_branch g_43L4_2
g_43L14_2:
    s_waitcnt vmcnt(2)
    v_max3_u32 v19, v32, v33, v34
    v_max_u32 v19, v19, v35
    v_cmp_eq_u32 vcc, -1, v19
    s_nop 0
    s_cbranch_vccnz g_43F14_2
    v_smfmac_f32_16x16x64_bf16 v[40:43], v[32:35], a[16:23], v172
    v_smfmac_f32_16x16x64_bf16 v[44:47], v[32:35], a[80:87], v172
    v_smfmac_f32_16x16x64_bf16 v[48:51], v[32:35], a[48:55], v172
    v_smfmac_f32_16x16x64_bf16 v[52:55], v[32:35], a[112:119], v172
g_43L10_3:
    s_waitcnt vmcnt(1)
    v_max3_u32 v19, v36, v37, v38
    v_max_u32 v19, v19, v39
    v_cmp_eq_u32 vcc, -1, v19
    s_nop 0
    s_cbranch_vccnz g_43F10_3
    v_smfmac_f32_16x16x64_bf16 v[40:43], v[36:39], a[24:31], v172
    v_smfmac_f32_16x16x64_bf16 v[44:47], v[36:39], a[88:95], v172
    v_smfmac_f32_16x16x64_bf16 v[48:51], v[36:39], a[56:63], v172
    v_smfmac_f32_16x16x64_bf16 v[52:55], v[36:39], a[120:127], v172
    s_branch g_43L2_1
g_43L14_3:
    s_waitcnt vmcnt(2)
    v_max3_u32 v19, v36, v37, v38
    v_max_u32 v19, v19, v39
    v_cmp_eq_u32 vcc, -1, v19
    s_nop 0
    s_cbranch_vccnz g_43F14_3
    v_smfmac_f32_16x16x64_bf16 v[40:43], v[36:39], a[24:31], v172
    v_smfmac_f32_16x16x64_bf16 v[44:47], v[36:39], a[88:95], v172
    v_smfmac_f32_16x16x64_bf16 v[48:51], v[36:39], a[56:63], v172
    v_smfmac_f32_16x16x64_bf16 v[52:55], v[36:39], a[120:127], v172
    s_branch g_43L6_1
g_43L3_1:
    s_waitcnt vmcnt(1)
    v_max3_u32 v19, v28, v29, v30
    v_max_u32 v19, v19, v31
    v_cmp_eq_u32 vcc, -1, v19
    s_nop 0
    s_cbranch_vccnz g_43F3_1
    v_smfmac_f32_16x16x64_bf16 v[40:43], v[28:31], a[8:15], v172
    v_smfmac_f32_16x16x64_bf16 v[44:47], v[28:31], a[72:79], v172
    v_smfmac_f32_16x16x64_bf16 v[48:51], v[28:31], a[40:47], v172
    v_smfmac_f32_16x16x64_bf16 v[52:55], v[28:31], a[104:111], v172
    s_branch g_43L1_0
g_43L6_2:
    s_waitcnt vmcnt(1)
    v_max3_u32 v19, v32, v33, v34
    v_max_u32 v19, v19, v35
    v_cmp_eq_u32 vcc, -1, v19
    s_nop 0
    s_cbranch_vccnz g_43F6_2
    v_smfmac_f32_16x16x64_bf16 v[40:43], v[32:35], a[16:23], v172
    v_smfmac_f32_16x16x64_bf16 v[44:47], v[32:35], a[80:87], v172
    v_smfmac_f32_16x16x64_bf16 v[48:51], v[32:35], a[48:55], v172
    v_smfmac_f32_16x16x64_bf16 v[52:55], v[32:35], a[112:119], v172
    s_branch g_43L2_1
g_43L9_0:
    s_waitcnt vmcnt(1)
    v_max3_u32 v19, v24, v25, v26
    v_max_u32 v19, v19, v27
    v_cmp_eq_u32 vcc, -1, v19
    s_nop 0
    s_cbranch_vccnz g_43F9_0
    v_smfmac_f32_16x16x64_bf16 v[40:43], v[24:27], a[0:7], v172
    v_smfmac_f32_16x16x64_bf16 v[44:47], v[24:27], a[64:71], v172
    v_smfmac_f32_16x16x64_bf16 v[48:51], v[24:27], a[32:39], v172
    v_smfmac_f32_16x16x64_bf16 v[52:55], v[24:27], a[96:103], v172
    s_branch g_43L8_3
g_43L12_3:
    s_waitcnt vmcnt(1)
    v_max3_u32 v19, v36, v37, v38
    v_max_u32 v19, v19, v39
    v_cmp_eq_u32 vcc, -1, v19
    s_nop 0
    s_cbranch_vccnz g_43F12_3
    v_smfmac_f32_16x16x64_bf16 v[40:43], v[36:39], a[24:31], v172
    v_smfmac_f32_16x16x64_bf16 v[44:47], v[36:39], a[88:95], v172
    v_smfmac_f32_16x16x64_bf16 v[48:51], v[36:39], a[56:63], v172
    v_smfmac_f32_16x16x64_bf16 v[52:55], v[36:39], a[120:127], v172
    s_branch g_43L4_2
g_43F15_0:
    s_mov_b64 exec, vcc
    buffer_load_dwordx4 v[24:27], v2, s[4:7], s16 offen offset:0 sc1
    s_mov_b64 exec, -1
    s_add_u32 s23, s23, 1
    s_cmp_lt_u32 s23, 200000
    s_cbranch_scc1 g_43L15_1
    s_mov_b32 s25, 200000
    s_branch gc_44
g_43F15_1:
    s_mov_b64 exec, vcc
    buffer_load_dwordx4 v[28:31], v2, s[4:7], s16 offen offset:1024 sc1
    s_mov_b64 exec, -1
    s_add_u32 s23, s23, 1
    s_cmp_lt_u32 s23, 200000
    s_cbranch_scc1 g_43L15_2
    s_mov_b32 s25, 200000
    s_branch gc_44
g_43F15_2:
    s_mov_b64 exec, vcc
    buffer_load_dwordx4 v[32:35], v2, s[4:7], s16 offen offset:2048 sc1
    s_mov_b64 exec, -1
    s_add_u32 s23, s23, 1
    s_cmp_lt_u32 s23, 200000
    s_cbranch_scc1 g_43L15_3
    s_mov_b32 s25, 200000
    s_branch gc_44
g_43F15_3:
    s_mov_b64 exec, vcc
    buffer_load_dwordx4 v[36:39], v2, s[4:7], s16 offen offset:3072 sc1
    s_mov_b64 exec, -1
    s_add_u32 s23, s23, 1
    s_cmp_lt_u32 s23, 200000
    s_cbranch_scc1 g_43L15_0
    s_mov_b32 s25, 200000
    s_branch gc_44
g_43F7_0:
    s_mov_b64 exec, vcc
    buffer_load_dwordx4 v[24:27], v2, s[4:7], s16 offen offset:0 sc1
    s_mov_b64 exec, -1
    s_add_u32 s23, s23, 1
    s_cmp_lt_u32 s23, 200000
    s_cbranch_scc1 g_43L7_1
    s_mov_b32 s25, 200000
    s_branch gc_44
g_43F7_1:
    s_mov_b64 exec, vcc
    buffer_load_dwordx4 v[28:31], v2, s[4:7], s16 offen offset:1024 sc1
    s_mov_b64 exec, -1
    s_add_u32 s23, s23, 1
    s_cmp_lt_u32 s23, 200000
    s_cbranch_scc1 g_43L7_2
    s_mov_b32 s25, 200000
    s_branch gc_44
g_43F7_2:
    s_mov_b64 exec, vcc
    buffer_load_dwordx4 v[32:35], v2, s[4:7], s16 offen offset:2048 sc1
    s_mov_b64 exec, -1
    s_add_u32 s23, s23, 1
    s_cmp_lt_u32 s23, 200000
    s_cbranch_scc1 g_43L7_0
    s_mov_b32 s25, 200000
    s_branch gc_44
g_43F11_0:
    s_mov_b64 exec, vcc
    buffer_load_dwordx4 v[24:27], v2, s[4:7], s16 offen offset:0 sc1
    s_mov_b64 exec, -1
    s_add_u32 s23, s23, 1
    s_cmp_lt_u32 s23, 200000
    s_cbranch_scc1 g_43L11_1
    s_mov_b32 s25, 200000
    s_branch gc_44
g_43F11_1:
    s_mov_b64 exec, vcc
    buffer_load_dwordx4 v[28:31], v2, s[4:7], s16 offen offset:1024 sc1
    s_mov_b64 exec, -1
    s_add_u32 s23, s23, 1
    s_cmp_lt_u32 s23, 200000
    s_cbranch_scc1 g_43L11_3
    s_mov_b32 s25, 200000
    s_branch gc_44
g_43F11_3:
    s_mov_b64 exec, vcc
    buffer_load_dwordx4 v[36:39], v2, s[4:7], s16 offen offset:3072 sc1
    s_mov_b64 exec, -1
    s_add_u32 s23, s23, 1
    s_cmp_lt_u32 s23, 200000
    s_cbranch_scc1 g_43L11_0
    s_mov_b32 s25, 200000
    s_branch gc_44
g_43F13_0:
    s_mov_b64 exec, vcc
    buffer_load_dwordx4 v[24:27], v2, s[4:7], s16 offen offset:0 sc1
    s_mov_b64 exec, -1
    s_add_u32 s23, s23, 1
    s_cmp_lt_u32 s23, 200000
    s_cbranch_scc1 g_43L13_2
    s_mov_b32 s25, 200000
    s_branch gc_44
g_43F13_2:
    s_mov_b64 exec, vcc
    buffer_load_dwordx4 v[32:35], v2, s[4:7], s16 offen offset:2048 sc1
    s_mov_b64 exec, -1
    s_add_u32 s23, s23, 1
    s_cmp_lt_u32 s23, 200000
    s_cbranch_scc1 g_43L13_3
    s_mov_b32 s25, 200000
    s_branch gc_44
g_43F13_3:
    s_mov_b64 exec, vcc
    buffer_load_dwordx4 v[36:39], v2, s[4:7], s16 offen offset:3072 sc1
    s_mov_b64 exec, -1
    s_add_u32 s23, s23, 1
    s_cmp_lt_u32 s23, 200000
    s_cbranch_scc1 g_43L13_0
    s_mov_b32 s25, 200000
    s_branch gc_44
g_43F14_1:
    s_mov_b64 exec, vcc
    buffer_load_dwordx4 v[28:31], v2, s[4:7], s16 offen offset:1024 sc1
    s_mov_b64 exec, -1
    s_add_u32 s23, s23, 1
    s_cmp_lt_u32 s23, 200000
    s_cbranch_scc1 g_43L14_2
    s_mov_b32 s25, 200000
    s_branch gc_44
g_43F14_2:
    s_mov_b64 exec, vcc
    buffer_load_dwordx4 v[32:35], v2, s[4:7], s16 offen offset:2048 sc1
    s_mov_b64 exec, -1
    s_add_u32 s23, s23, 1
    s_cmp_lt_u32 s23, 200000
    s_cbranch_scc1 g_43L14_3
    s_mov_b32 s25, 200000
    s_branch gc_44
g_43F14_3:
    s_mov_b64 exec, vcc
    buffer_load_dwordx4 v[36:39], v2, s[4:7], s16 offen offset:3072 sc1
    s_mov_b64 exec, -1
    s_add_u32 s23, s23, 1
    s_cmp_lt_u32 s23, 200000
    s_cbranch_scc1 g_43L14_1
    s_mov_b32 s25, 200000
    s_branch gc_44
g_43F3_0:
    s_mov_b64 exec, vcc
    buffer_load_dwordx4 v[24:27], v2, s[4:7], s16 offen offset:0 sc1
    s_mov_b64 exec, -1
    s_add_u32 s23, s23, 1
    s_cmp_lt_u32 s23, 200000
    s_cbranch_scc1 g_43L3_1
    s_mov_b32 s25, 200000
    s_branch gc_44
g_43F3_1:
    s_mov_b64 exec, vcc
    buffer_load_dwordx4 v[28:31], v2, s[4:7], s16 offen offset:1024 sc1
    s_mov_b64 exec, -1
    s_add_u32 s23, s23, 1
    s_cmp_lt_u32 s23, 200000
    s_cbranch_scc1 g_43L3_0
    s_mov_b32 s25, 200000
    s_branch gc_44
g_43F5_0:
    s_mov_b64 exec, vcc
    buffer_load_dwordx4 v[24:27], v2, s[4:7], s16 offen offset:0 sc1
    s_mov_b64 exec, -1
    s_add_u32 s23, s23, 1
    s_cmp_lt_u32 s23, 200000
    s_cbranch_scc1 g_43L5_2
    s_mov_b32 s25, 200000
    s_branch gc_44
g_43F5_2:
    s_mov_b64 exec, vcc
    buffer_load_dwordx4 v[32:35], v2, s[4:7], s16 offen offset:2048 sc1
    s_mov_b64 exec, -1
    s_add_u32 s23, s23, 1
    s_cmp_lt_u32 s23, 200000
    s_cbranch_scc1 g_43L5_0
    s_mov_b32 s25, 200000
    s_branch gc_44
g_43F6_1:
    s_mov_b64 exec, vcc
    buffer_load_dwordx4 v[28:31], v2, s[4:7], s16 offen offset:1024 sc1
    s_mov_b64 exec, -1
    s_add_u32 s23, s23, 1
    s_cmp_lt_u32 s23, 200000
    s_cbranch_scc1 g_43L6_2
    s_mov_b32 s25, 200000
    s_branch gc_44
g_43F6_2:
    s_mov_b64 exec, vcc
    buffer_load_dwordx4 v[32:35], v2, s[4:7], s16 offen offset:2048 sc1
    s_mov_b64 exec, -1
    s_add_u32 s23, s23, 1
    s_cmp_lt_u32 s23, 200000
    s_cbranch_scc1 g_43L6_1
    s_mov_b32 s25, 200000
    s_branch gc_44
g_43F9_0:
    s_mov_b64 exec, vcc
    buffer_load_dwordx4 v[24:27], v2, s[4:7], s16 offen offset:0 sc1
    s_mov_b64 exec, -1
    s_add_u32 s23, s23, 1
    s_cmp_lt_u32 s23, 200000
    s_cbranch_scc1 g_43L9_3
    s_mov_b32 s25, 200000
    s_branch gc_44
g_43F9_3:
    s_mov_b64 exec, vcc
    buffer_load_dwordx4 v[36:39], v2, s[4:7], s16 offen offset:3072 sc1
    s_mov_b64 exec, -1
    s_add_u32 s23, s23, 1
    s_cmp_lt_u32 s23, 200000
    s_cbranch_scc1 g_43L9_0
    s_mov_b32 s25, 200000
    s_branch gc_44
g_43F10_1:
    s_mov_b64 exec, vcc
    buffer_load_dwordx4 v[28:31], v2, s[4:7], s16 offen offset:1024 sc1
    s_mov_b64 exec, -1
    s_add_u32 s23, s23, 1
    s_cmp_lt_u32 s23, 200000
    s_cbranch_scc1 g_43L10_3
    s_mov_b32 s25, 200000
    s_branch gc_44
g_43F10_3:
    s_mov_b64 exec, vcc
    buffer_load_dwordx4 v[36:39], v2, s[4:7], s16 offen offset:3072 sc1
    s_mov_b64 exec, -1
    s_add_u32 s23, s23, 1
    s_cmp_lt_u32 s23, 200000
    s_cbranch_scc1 g_43L10_1
    s_mov_b32 s25, 200000
    s_branch gc_44
g_43F12_2:
    s_mov_b64 exec, vcc
    buffer_load_dwordx4 v[32:35], v2, s[4:7], s16 offen offset:2048 sc1
    s_mov_b64 exec, -1
    s_add_u32 s23, s23, 1
    s_cmp_lt_u32 s23, 200000
    s_cbranch_scc1 g_43L12_3
    s_mov_b32 s25, 200000
    s_branch gc_44
g_43F12_3:
    s_mov_b64 exec, vcc
    buffer_load_dwordx4 v[36:39], v2, s[4:7], s16 offen offset:3072 sc1
    s_mov_b64 exec, -1
    s_add_u32 s23, s23, 1
    s_cmp_lt_u32 s23, 200000
    s_cbranch_scc1 g_43L12_2
    s_mov_b32 s25, 200000
    s_branch gc_44
g_43F1_0:
    s_mov_b64 exec, vcc
    buffer_load_dwordx4 v[24:27], v2, s[4:7], s16 offen offset:0 sc1
    s_mov_b64 exec, -1
    s_add_u32 s23, s23, 1
    s_cmp_lt_u32 s23, 200000
    s_cbranch_scc1 g_43L1_0
    s_mov_b32 s25, 200000
    s_branch gc_44
g_43F2_1:
    s_mov_b64 exec, vcc
    buffer_load_dwordx4 v[28:31], v2, s[4:7], s16 offen offset:1024 sc1
    s_mov_b64 exec, -1
    s_add_u32 s23, s23, 1
    s_cmp_lt_u32 s23, 200000
    s_cbranch_scc1 g_43L2_1
    s_mov_b32 s25, 200000
    s_branch gc_44
g_43F4_2:
    s_mov_b64 exec, vcc
    buffer_load_dwordx4 v[32:35], v2, s[4:7], s16 offen offset:2048 sc1
    s_mov_b64 exec, -1
    s_add_u32 s23, s23, 1
    s_cmp_lt_u32 s23, 200000
    s_cbranch_scc1 g_43L4_2
    s_mov_b32 s25, 200000
    s_branch gc_44
g_43F8_3:
    s_mov_b64 exec, vcc
    buffer_load_dwordx4 v[36:39], v2, s[4:7], s16 offen offset:3072 sc1
    s_mov_b64 exec, -1
    s_add_u32 s23, s23, 1
    s_cmp_lt_u32 s23, 200000
    s_cbranch_scc1 g_43L8_3
    s_mov_b32 s25, 200000
    s_branch gc_44
recur_fast_last2:
    buffer_store_dwordx4 v[168:171], v15, s[4:7], s20 offen sc1
    s_waitcnt vmcnt(0)
    s_branch recur_end
g_45L15_0:
    s_waitcnt vmcnt(3)
    v_max3_u32 v19, v24, v25, v26
    v_max_u32 v19, v19, v27
    v_cmp_eq_u32 vcc, -1, v19
    s_nop 0
    s_cbranch_vccnz g_45F15_0
    v_smfmac_f32_16x16x64_bf16 v[64:67], v[24:27], a[192:199], v172
    v_smfmac_f32_16x16x64_bf16 v[68:71], v[24:27], a[224:231], v172
g_45L14_1:
    s_waitcnt vmcnt(2)
    v_max3_u32 v19, v28, v29, v30
    v_max_u32 v19, v19, v31
    v_cmp_eq_u32 vcc, -1, v19
    s_nop 0
    s_cbranch_vccnz g_45F14_1
    v_smfmac_f32_16x16x64_bf16 v[64:67], v[28:31], a[200:207], v172
    v_smfmac_f32_16x16x64_bf16 v[68:71], v[28:31], a[232:239], v172
g_45L12_2:
    s_waitcnt vmcnt(1)
    v_max3_u32 v19, v32, v33, v34
    v_max_u32 v19, v19, v35
    v_cmp_eq_u32 vcc, -1, v19
    s_nop 0
    s_cbranch_vccnz g_45F12_2
    v_smfmac_f32_16x16x64_bf16 v[64:67], v[32:35], a[208:215], v172
    v_smfmac_f32_16x16x64_bf16 v[68:71], v[32:35], a[240:247], v172
g_45L8_3:
    s_waitcnt vmcnt(0)
    v_max3_u32 v19, v36, v37, v38
    v_max_u32 v19, v19, v39
    v_cmp_eq_u32 vcc, -1, v19
    s_nop 0
    s_cbranch_vccnz g_45F8_3
    v_smfmac_f32_16x16x64_bf16 v[64:67], v[36:39], a[216:223], v172
    v_smfmac_f32_16x16x64_bf16 v[68:71], v[36:39], a[248:255], v172
    s_nop 4
    v_cvt_pk_bf16_f32 v80, v64, v65
    v_cvt_pk_bf16_f32 v81, v66, v67
    s_nop 0
    v_cvt_pk_bf16_f32 v82, v68, v69
    v_cvt_pk_bf16_f32 v83, v70, v71
    ds_write_b128 v17, v[80:83] offset:9216
    s_branch gc_46
g_45L15_1:
    s_waitcnt vmcnt(3)
    v_max3_u32 v19, v28, v29, v30
    v_max_u32 v19, v19, v31
    v_cmp_eq_u32 vcc, -1, v19
    s_nop 0
    s_cbranch_vccnz g_45F15_1
    v_smfmac_f32_16x16x64_bf16 v[64:67], v[28:31], a[200:207], v172
    v_smfmac_f32_16x16x64_bf16 v[68:71], v[28:31], a[232:239], v172
g_45L13_2:
    s_waitcnt vmcnt(2)
    v_max3_u32 v19, v32, v33, v34
    v_max_u32 v19, v19, v35
    v_cmp_eq_u32 vcc, -1, v19
    s_nop 0
    s_cbranch_vccnz g_45F13_2
    v_smfmac_f32_16x16x64_bf16 v[64:67], v[32:35], a[208:215], v172
    v_smfmac_f32_16x16x64_bf16 v[68:71], v[32:35], a[240:247], v172
g_45L9_3:
    s_waitcnt vmcnt(1)
    v_max3_u32 v19, v36, v37, v38
    v_max_u32 v19, v19, v39
    v_cmp_eq_u32 vcc, -1, v19
    s_nop 0
    s_cbranch_vccnz g_45F9_3
    v_smfmac_f32_16x16x64_bf16 v[64:67], v[36:39], a[216:223], v172
    v_smfmac_f32_16x16x64_bf16 v[68:71], v[36:39], a[248:255], v172
g_45L1_0:
    s_waitcnt vmcnt(0)
    v_max3_u32 v19, v24, v25, v26
    v_max_u32 v19, v19, v27
    v_cmp_eq_u32 vcc, -1, v19
    s_nop 0
    s_cbranch_vccnz g_45F1_0
    v_smfmac_f32_16x16x64_bf16 v[64:67], v[24:27], a[192:199], v172
    v_smfmac_f32_16x16x64_bf16 v[68:71], v[24:27], a[224:231], v172
    s_nop 4
    v_cvt_pk_bf16_f32 v80, v64, v65
    v_cvt_pk_bf16_f32 v81, v66, v67
    s_nop 0
    v_cvt_pk_bf16_f32 v82, v68, v69
    v_cvt_pk_bf16_f32 v83, v70, v71
    ds_write_b128 v17, v[80:83] offset:9216
    s_branch gc_46
g_45L15_2:
    s_waitcnt vmcnt(3)
    v_max3_u32 v19, v32, v33, v34
    v_max_u32 v19, v19, v35
    v_cmp_eq_u32 vcc, -1, v19
    s_nop 0
    s_cbranch_vccnz g_45F15_2
    v_smfmac_f32_16x16x64_bf16 v[64:67], v[32:35], a[208:215], v172
    v_smfmac_f32_16x16x64_bf16 v[68:71], v[32:35], a[240:247], v172
g_45L11_3:
    s_waitcnt vmcnt(2)
    v_max3_u32 v19, v36, v37, v38
    v_max_u32 v19, v19, v39
    v_cmp_eq_u32 vcc, -1, v19
    s_nop 0
    s_cbranch_vccnz g_45F11_3
    v_smfmac_f32_16x16x64_bf16 v[64:67], v[36:39], a[216:223], v172
    v_smfmac_f32_16x16x64_bf16 v[68:71], v[36:39], a[248:255], v172
g_45L3_0:
    s_waitcnt vmcnt(1)
    v_max3_u32 v19, v24, v25, v26
    v_max_u32 v19, v19, v27
    v_cmp_eq_u32 vcc, -1, v19
    s_nop 0
    s_cbranch_vccnz g_45F3_0
    v_smfmac_f32_16x16x64_bf16 v[64:67], v[24:27], a[192:199], v172
    v_smfmac_f32_16x16x64_bf16 v[68:71], v[24:27], a[224:231], v172
g_45L2_1:
    s_waitcnt vmcnt(0)
    v_max3_u32 v19, v28, v29, v30
    v_max_u32 v19, v19, v31
    v_cmp_eq_u32 vcc, -1, v19
    s_nop 0
    s_cbranch_vccnz g_45F2_1
    v_smfmac_f32_16x16x64_bf16 v[64:67], v[28:31], a[200:207], v172
    v_smfmac_f32_16x16x64_bf16 v[68:71], v[28:31], a[232:239], v172
    s_nop 4
    v_cvt_pk_bf16_f32 v80, v64, v65
    v_cvt_pk_bf16_f32 v81, v66, v67
    s_nop 0
    v_cvt_pk_bf16_f32 v82, v68, v69
    v_cvt_pk_bf16_f32 v83, v70, v71
    ds_write_b128 v17, v[80:83] offset:9216
    s_branch gc_46
g_45L15_3:
    s_waitcnt vmcnt(3)
    v_max3_u32 v19, v36, v37, v38
    v_max_u32 v19, v19, v39
    v_cmp_eq_u32 vcc, -1, v19
    s_nop 0
    s_cbranch_vccnz g_45F15_3
    v_smfmac_f32_16x16x64_bf16 v[64:67], v[36:39], a[216:223], v172
    v_smfmac_f32_16x16x64_bf16 v[68:71], v[36:39], a[248:255], v172
g_45L7_0:
    s_waitcnt vmcnt(2)
    v_max3_u32 v19, v24, v25, v26
    v_max_u32 v19, v19, v27
    v_cmp_eq_u32 vcc, -1, v19
    s_nop 0
    s_cbranch_vccnz g_45F7_0
    v_smfmac_f32_16x16x64_bf16 v[64:67], v[24:27], a[192:199], v172
    v_smfmac_f32_16x16x64_bf16 v[68:71], v[24:27], a[224:231], v172
g_45L6_1:
    s_waitcnt vmcnt(1)
    v_max3_u32 v19, v28, v29, v30
    v_max_u32 v19, v19, v31
    v_cmp_eq_u32 vcc, -1, v19
    s_nop 0
    s_cbranch_vccnz g_45F6_1
    v_smfmac_f32_16x16x64_bf16 v[64:67], v[28:31], a[200:207], v172
    v_smfmac_f32_16x16x64_bf16 v[68:71], v[28:31], a[232:239], v172
g_45L4_2:
    s_waitcnt vmcnt(0)
    v_max3_u32 v19, v32, v33, v34
    v_max_u32 v19, v19, v35
    v_cmp_eq_u32 vcc, -1, v19
    s_nop 0
    s_cbranch_vccnz g_45F4_2
    v_smfmac_f32_16x16x64_bf16 v[64:67], v[32:35], a[208:215], v172
    v_smfmac_f32_16x16x64_bf16 v[68:71], v[32:35], a[240:247], v172
    s_nop 4
    v_cvt_pk_bf16_f32 v80, v64, v65
    v_cvt_pk_bf16_f32 v81, v66, v67
    s_nop 0
    v_cvt_pk_bf16_f32 v82, v68, v69
    v_cvt_pk_bf16_f32 v83, v70, v71
    ds_write_b128 v17, v[80:83] offset:9216
    s_branch gc_46
g_45L7_1:
    s_waitcnt vmcnt(2)
    v_max3_u32 v19, v28, v29, v30
    v_max_u32 v19, v19, v31
    v_cmp_eq_u32 vcc, -1, v19
    s_nop 0
    s_cbranch_vccnz g_45F7_1
    v_smfmac_f32_16x16x64_bf16 v[64:67], v[28:31], a[200:207], v172
    v_smfmac_f32_16x16x64_bf16 v[68:71], v[28:31], a[232:239], v172
g_45L5_2:
    s_waitcnt vmcnt(1)
    v_max3_u32 v19, v32, v33, v34
    v_max_u32 v19, v19, v35
    v_cmp_eq_u32 vcc, -1, v19
    s_nop 0
    s_cbranch_vccnz g_45F5_2
    v_smfmac_f32_16x16x64_bf16 v[64:67], v[32:35], a[208:215], v172
    v_smfmac_f32_16x16x64_bf16 v[68:71], v[32:35], a[240:247], v172
    s_branch g_45L1_0
g_45L7_2:
    s_waitcnt vmcnt(2)
    v_max3_u32 v19, v32, v33, v34
    v_max_u32 v19, v19, v35
    v_cmp_eq_u32 vcc, -1, v19
    s_nop 0
    s_cbranch_vccnz g_45F7_2
    v_smfmac_f32_16x16x64_bf16 v[64:67], v[32:35], a[208:215], v172
    v_smfmac_f32_16x16x64_bf16 v[68:71], v[32:35], a[240:247], v172
    s_branch g_45L3_0
g_45L11_0:
    s_waitcnt vmcnt(2)
    v_max3_u32 v19, v24, v25, v26
    v_max_u32 v19, v19, v27
    v_cmp_eq_u32 vcc, -1, v19
    s_nop 0
    s_cbranch_vccnz g_45F11_0
    v_smfmac_f32_16x16x64_bf16 v[64:67], v[24:27], a[192:199], v172
    v_smfmac_f32_16x16x64_bf16 v[68:71], v[24:27], a[224:231], v172
g_45L10_1:
    s_waitcnt vmcnt(1)
    v_max3_u32 v19, v28, v29, v30
    v_max_u32 v19, v19, v31
    v_cmp_eq_u32 vcc, -1, v19
    s_nop 0
    s_cbranch_vccnz g_45F10_1
    v_smfmac_f32_16x16x64_bf16 v[64:67], v[28:31], a[200:207], v172
    v_smfmac_f32_16x16x64_bf16 v[68:71], v[28:31], a[232:239], v172
    s_branch g_45L8_3
g_45L11_1:
    s_waitcnt vmcnt(2)
    v_max3_u32 v19, v28, v29, v30
    v_max_u32 v19, v19, v31
    v_cmp_eq_u32 vcc, -1, v19
    s_nop 0
    s_cbranch_vccnz g_45F11_1
    v_smfmac_f32_16x16x64_bf16 v[64:67], v[28:31], a[200:207], v172
    v_smfmac_f32_16x16x64_bf16 v[68:71], v[28:31], a[232:239], v172
    s_branch g_45L9_3
g_45L13_0:
    s_waitcnt vmcnt(2)
    v_max3_u32 v19, v24, v25, v26
    v_max_u32 v19, v19, v27
    v_cmp_eq_u32 vcc, -1, v19
    s_nop 0
    s_cbranch_vccnz g_45F13_0
    v_smfmac_f32_16x16x64_bf16 v[64:67], v[24:27], a[192:199], v172
    v_smfmac_f32_16x16x64_bf16 v[68:71], v[24:27], a[224:231], v172
    s_branch g_45L12_2
g_45L13_3:
    s_waitcnt vmcnt(2)
    v_max3_u32 v19, v36, v37, v38
    v_max_u32 v19, v19, v39
    v_cmp_eq_u32 vcc, -1, v19
    s_nop 0
    s_cbranch_vccnz g_45F13_3
    v_smfmac_f32_16x16x64_bf16 v[64:67], v[36:39], a[216:223], v172
    v_smfmac_f32_16x16x64_bf16 v[68:71], v[36:39], a[248:255], v172
g_45L5_0:
    s_waitcnt vmcnt(1)
    v_max3_u32 v19, v24, v25, v26
    v_max_u32 v19, v19, v27
    v_cmp_eq_u32 vcc, -1, v19
    s_nop 0
    s_cbranch_vccnz g_45F5_0
    v_smfmac_f32_16x16x64_bf16 v[64:67], v[24:27], a[192:199], v172
    v_smfmac_f32_16x16x64_bf16 v[68:71], v[24:27], a[224:231], v172
    s_branch g_45L4_2
g_45L14_2:
    s_waitcnt vmcnt(2)
    v_max3_u32 v19, v32, v33, v34
    v_max_u32 v19, v19, v35
    v_cmp_eq_u32 vcc, -1, v19
    s_nop 0
    s_cbranch_vccnz g_45F14_2
    v_smfmac_f32_16x16x64_bf16 v[64:67], v[32:35], a[208:215], v172
    v_smfmac_f32_16x16x64_bf16 v[68:71], v[32:35], a[240:247], v172
g_45L10_3:
    s_waitcnt vmcnt(1)
    v_max3_u32 v19, v36, v37, v38
    v_max_u32 v19, v19, v39
    v_cmp_eq_u32 vcc, -1, v19
    s_nop 0
    s_cbranch_vccnz g_45F10_3
    v_smfmac_f32_16x16x64_bf16 v[64:67], v[36:39], a[216:223], v172
    v_smfmac_f32_16x16x64_bf16 v[68:71], v[36:39], a[248:255], v172
    s_branch g_45L2_1
g_45L14_3:
    s_waitcnt vmcnt(2)
    v_max3_u32 v19, v36, v37, v38
    v_max_u32 v19, v19, v39
    v_cmp_eq_u32 vcc, -1, v19
    s_nop 0
    s_cbranch_vccnz g_45F14_3
    v_smfmac_f32_16x16x64_bf16 v[64:67], v[36:39], a[216:223], v172
    v_smfmac_f32_16x16x64_bf16 v[68:71], v[36:39], a[248:255], v172
    s_branch g_45L6_1
g_45L3_1:
    s_waitcnt vmcnt(1)
    v_max3_u32 v19, v28, v29, v30
    v_max_u32 v19, v19, v31
    v_cmp_eq_u32 vcc, -1, v19
    s_nop 0
    s_cbranch_vccnz g_45F3_1
    v_smfmac_f32_16x16x64_bf16 v[64:67], v[28:31], a[200:207], v172
    v_smfmac_f32_16x16x64_bf16 v[68:71], v[28:31], a[232:239], v172
    s_branch g_45L1_0
g_45L6_2:
    s_waitcnt vmcnt(1)
    v_max3_u32 v19, v32, v33, v34
    v_max_u32 v19, v19, v35
    v_cmp_eq_u32 vcc, -1, v19
    s_nop 0
    s_cbranch_vccnz g_45F6_2
    v_smfmac_f32_16x16x64_bf16 v[64:67], v[32:35], a[208:215], v172
    v_smfmac_f32_16x16x64_bf16 v[68:71], v[32:35], a[240:247], v172
    s_branch g_45L2_1
g_45L9_0:
    s_waitcnt vmcnt(1)
    v_max3_u32 v19, v24, v25, v26
    v_max_u32 v19, v19, v27
    v_cmp_eq_u32 vcc, -1, v19
    s_nop 0
    s_cbranch_vccnz g_45F9_0
    v_smfmac_f32_16x16x64_bf16 v[64:67], v[24:27], a[192:199], v172
    v_smfmac_f32_16x16x64_bf16 v[68:71], v[24:27], a[224:231], v172
    s_branch g_45L8_3
g_45L12_3:
    s_waitcnt vmcnt(1)
    v_max3_u32 v19, v36, v37, v38
    v_max_u32 v19, v19, v39
    v_cmp_eq_u32 vcc, -1, v19
    s_nop 0
    s_cbranch_vccnz g_45F12_3
    v_smfmac_f32_16x16x64_bf16 v[64:67], v[36:39], a[216:223], v172
    v_smfmac_f32_16x16x64_bf16 v[68:71], v[36:39], a[248:255], v172
    s_branch g_45L4_2
g_45F15_0:
    s_mov_b64 exec, vcc
    buffer_load_dwordx4 v[24:27], v8, s[4:7], s16 offen offset:0 sc1
    s_mov_b64 exec, -1
    s_add_u32 s23, s23, 1
    s_cmp_lt_u32 s23, 200000
    s_cbranch_scc1 g_45L15_1
    s_mov_b32 s25, 200000
    s_branch gc_46
g_45F15_1:
    s_mov_b64 exec, vcc
    buffer_load_dwordx4 v[28:31], v8, s[4:7], s16 offen offset:1024 sc1
    s_mov_b64 exec, -1
    s_add_u32 s23, s23, 1
    s_cmp_lt_u32 s23, 200000
    s_cbranch_scc1 g_45L15_2
    s_mov_b32 s25, 200000
    s_branch gc_46
g_45F15_2:
    s_mov_b64 exec, vcc
    buffer_load_dwordx4 v[32:35], v8, s[4:7], s16 offen offset:2048 sc1
    s_mov_b64 exec, -1
    s_add_u32 s23, s23, 1
    s_cmp_lt_u32 s23, 200000
    s_cbranch_scc1 g_45L15_3
    s_mov_b32 s25, 200000
    s_branch gc_46
g_45F15_3:
    s_mov_b64 exec, vcc
    buffer_load_dwordx4 v[36:39], v8, s[4:7], s16 offen offset:3072 sc1
    s_mov_b64 exec, -1
    s_add_u32 s23, s23, 1
    s_cmp_lt_u32 s23, 200000
    s_cbranch_scc1 g_45L15_0
    s_mov_b32 s25, 200000
    s_branch gc_46
g_45F7_0:
    s_mov_b64 exec, vcc
    buffer_load_dwordx4 v[24:27], v8, s[4:7], s16 offen offset:0 sc1
    s_mov_b64 exec, -1
    s_add_u32 s23, s23, 1
    s_cmp_lt_u32 s23, 200000
    s_cbranch_scc1 g_45L7_1
    s_mov_b32 s25, 200000
    s_branch gc_46
g_45F7_1:
    s_mov_b64 exec, vcc
    buffer_load_dwordx4 v[28:31], v8, s[4:7], s16 offen offset:1024 sc1
    s_mov_b64 exec, -1
    s_add_u32 s23, s23, 1
    s_cmp_lt_u32 s23, 200000
    s_cbranch_scc1 g_45L7_2
    s_mov_b32 s25, 200000
    s_branch gc_46
g_45F7_2:
    s_mov_b64 exec, vcc
    buffer_load_dwordx4 v[32:35], v8, s[4:7], s16 offen offset:2048 sc1
    s_mov_b64 exec, -1
    s_add_u32 s23, s23, 1
    s_cmp_lt_u32 s23, 200000
    s_cbranch_scc1 g_45L7_0
    s_mov_b32 s25, 200000
    s_branch gc_46
g_45F11_0:
    s_mov_b64 exec, vcc
    buffer_load_dwordx4 v[24:27], v8, s[4:7], s16 offen offset:0 sc1
    s_mov_b64 exec, -1
    s_add_u32 s23, s23, 1
    s_cmp_lt_u32 s23, 200000
    s_cbranch_scc1 g_45L11_1
    s_mov_b32 s25, 200000
    s_branch gc_46
g_45F11_1:
    s_mov_b64 exec, vcc
    buffer_load_dwordx4 v[28:31], v8, s[4:7], s16 offen offset:1024 sc1
    s_mov_b64 exec, -1
    s_add_u32 s23, s23, 1
    s_cmp_lt_u32 s23, 200000
    s_cbranch_scc1 g_45L11_3
    s_mov_b32 s25, 200000
    s_branch gc_46
g_45F11_3:
    s_mov_b64 exec, vcc
    buffer_load_dwordx4 v[36:39], v8, s[4:7], s16 offen offset:3072 sc1
    s_mov_b64 exec, -1
    s_add_u32 s23, s23, 1
    s_cmp_lt_u32 s23, 200000
    s_cbranch_scc1 g_45L11_0
    s_mov_b32 s25, 200000
    s_branch gc_46
g_45F13_0:
    s_mov_b64 exec, vcc
    buffer_load_dwordx4 v[24:27], v8, s[4:7], s16 offen offset:0 sc1
    s_mov_b64 exec, -1
    s_add_u32 s23, s23, 1
    s_cmp_lt_u32 s23, 200000
    s_cbranch_scc1 g_45L13_2
    s_mov_b32 s25, 200000
    s_branch gc_46
g_45F13_2:
    s_mov_b64 exec, vcc
    buffer_load_dwordx4 v[32:35], v8, s[4:7], s16 offen offset:2048 sc1
    s_mov_b64 exec, -1
    s_add_u32 s23, s23, 1
    s_cmp_lt_u32 s23, 200000
    s_cbranch_scc1 g_45L13_3
    s_mov_b32 s25, 200000
    s_branch gc_46
g_45F13_3:
    s_mov_b64 exec, vcc
    buffer_load_dwordx4 v[36:39], v8, s[4:7], s16 offen offset:3072 sc1
    s_mov_b64 exec, -1
    s_add_u32 s23, s23, 1
    s_cmp_lt_u32 s23, 200000
    s_cbranch_scc1 g_45L13_0
    s_mov_b32 s25, 200000
    s_branch gc_46
g_45F14_1:
    s_mov_b64 exec, vcc
    buffer_load_dwordx4 v[28:31], v8, s[4:7], s16 offen offset:1024 sc1
    s_mov_b64 exec, -1
    s_add_u32 s23, s23, 1
    s_cmp_lt_u32 s23, 200000
    s_cbranch_scc1 g_45L14_2
    s_mov_b32 s25, 200000
    s_branch gc_46
g_45F14_2:
    s_mov_b64 exec, vcc
    buffer_load_dwordx4 v[32:35], v8, s[4:7], s16 offen offset:2048 sc1
    s_mov_b64 exec, -1
    s_add_u32 s23, s23, 1
    s_cmp_lt_u32 s23, 200000
    s_cbranch_scc1 g_45L14_3
    s_mov_b32 s25, 200000
    s_branch gc_46
g_45F14_3:
    s_mov_b64 exec, vcc
    buffer_load_dwordx4 v[36:39], v8, s[4:7], s16 offen offset:3072 sc1
    s_mov_b64 exec, -1
    s_add_u32 s23, s23, 1
    s_cmp_lt_u32 s23, 200000
    s_cbranch_scc1 g_45L14_1
    s_mov_b32 s25, 200000
    s_branch gc_46
g_45F3_0:
    s_mov_b64 exec, vcc
    buffer_load_dwordx4 v[24:27], v8, s[4:7], s16 offen offset:0 sc1
    s_mov_b64 exec, -1
    s_add_u32 s23, s23, 1
    s_cmp_lt_u32 s23, 200000
    s_cbranch_scc1 g_45L3_1
    s_mov_b32 s25, 200000
    s_branch gc_46
g_45F3_1:
    s_mov_b64 exec, vcc
    buffer_load_dwordx4 v[28:31], v8, s[4:7], s16 offen offset:1024 sc1
    s_mov_b64 exec, -1
    s_add_u32 s23, s23, 1
    s_cmp_lt_u32 s23, 200000
    s_cbranch_scc1 g_45L3_0
    s_mov_b32 s25, 200000
    s_branch gc_46
g_45F5_0:
    s_mov_b64 exec, vcc
    buffer_load_dwordx4 v[24:27], v8, s[4:7], s16 offen offset:0 sc1
    s_mov_b64 exec, -1
    s_add_u32 s23, s23, 1
    s_cmp_lt_u32 s23, 200000
    s_cbranch_scc1 g_45L5_2
    s_mov_b32 s25, 200000
    s_branch gc_46
g_45F5_2:
    s_mov_b64 exec, vcc
    buffer_load_dwordx4 v[32:35], v8, s[4:7], s16 offen offset:2048 sc1
    s_mov_b64 exec, -1
    s_add_u32 s23, s23, 1
    s_cmp_lt_u32 s23, 200000
    s_cbranch_scc1 g_45L5_0
    s_mov_b32 s25, 200000
    s_branch gc_46
g_45F6_1:
    s_mov_b64 exec, vcc
    buffer_load_dwordx4 v[28:31], v8, s[4:7], s16 offen offset:1024 sc1
    s_mov_b64 exec, -1
    s_add_u32 s23, s23, 1
    s_cmp_lt_u32 s23, 200000
    s_cbranch_scc1 g_45L6_2
    s_mov_b32 s25, 200000
    s_branch gc_46
g_45F6_2:
    s_mov_b64 exec, vcc
    buffer_load_dwordx4 v[32:35], v8, s[4:7], s16 offen offset:2048 sc1
    s_mov_b64 exec, -1
    s_add_u32 s23, s23, 1
    s_cmp_lt_u32 s23, 200000
    s_cbranch_scc1 g_45L6_1
    s_mov_b32 s25, 200000
    s_branch gc_46
g_45F9_0:
    s_mov_b64 exec, vcc
    buffer_load_dwordx4 v[24:27], v8, s[4:7], s16 offen offset:0 sc1
    s_mov_b64 exec, -1
    s_add_u32 s23, s23, 1
    s_cmp_lt_u32 s23, 200000
    s_cbranch_scc1 g_45L9_3
    s_mov_b32 s25, 200000
    s_branch gc_46
g_45F9_3:
    s_mov_b64 exec, vcc
    buffer_load_dwordx4 v[36:39], v8, s[4:7], s16 offen offset:3072 sc1
    s_mov_b64 exec, -1
    s_add_u32 s23, s23, 1
    s_cmp_lt_u32 s23, 200000
    s_cbranch_scc1 g_45L9_0
    s_mov_b32 s25, 200000
    s_branch gc_46
g_45F10_1:
    s_mov_b64 exec, vcc
    buffer_load_dwordx4 v[28:31], v8, s[4:7], s16 offen offset:1024 sc1
    s_mov_b64 exec, -1
    s_add_u32 s23, s23, 1
    s_cmp_lt_u32 s23, 200000
    s_cbranch_scc1 g_45L10_3
    s_mov_b32 s25, 200000
    s_branch gc_46
g_45F10_3:
    s_mov_b64 exec, vcc
    buffer_load_dwordx4 v[36:39], v8, s[4:7], s16 offen offset:3072 sc1
    s_mov_b64 exec, -1
    s_add_u32 s23, s23, 1
    s_cmp_lt_u32 s23, 200000
    s_cbranch_scc1 g_45L10_1
    s_mov_b32 s25, 200000
    s_branch gc_46
g_45F12_2:
    s_mov_b64 exec, vcc
    buffer_load_dwordx4 v[32:35], v8, s[4:7], s16 offen offset:2048 sc1
    s_mov_b64 exec, -1
    s_add_u32 s23, s23, 1
    s_cmp_lt_u32 s23, 200000
    s_cbranch_scc1 g_45L12_3
    s_mov_b32 s25, 200000
    s_branch gc_46
g_45F12_3:
    s_mov_b64 exec, vcc
    buffer_load_dwordx4 v[36:39], v8, s[4:7], s16 offen offset:3072 sc1
    s_mov_b64 exec, -1
    s_add_u32 s23, s23, 1
    s_cmp_lt_u32 s23, 200000
    s_cbranch_scc1 g_45L12_2
    s_mov_b32 s25, 200000
    s_branch gc_46
g_45F1_0:
    s_mov_b64 exec, vcc
    buffer_load_dwordx4 v[24:27], v8, s[4:7], s16 offen offset:0 sc1
    s_mov_b64 exec, -1
    s_add_u32 s23, s23, 1
    s_cmp_lt_u32 s23, 200000
    s_cbranch_scc1 g_45L1_0
    s_mov_b32 s25, 200000
    s_branch gc_46
g_45F2_1:
    s_mov_b64 exec, vcc
    buffer_load_dwordx4 v[28:31], v8, s[4:7], s16 offen offset:1024 sc1
    s_mov_b64 exec, -1
    s_add_u32 s23, s23, 1
    s_cmp_lt_u32 s23, 200000
    s_cbranch_scc1 g_45L2_1
    s_mov_b32 s25, 200000
    s_branch gc_46
g_45F4_2:
    s_mov_b64 exec, vcc
    buffer_load_dwordx4 v[32:35], v8, s[4:7], s16 offen offset:2048 sc1
    s_mov_b64 exec, -1
    s_add_u32 s23, s23, 1
    s_cmp_lt_u32 s23, 200000
    s_cbranch_scc1 g_45L4_2
    s_mov_b32 s25, 200000
    s_branch gc_46
g_45F8_3:
    s_mov_b64 exec, vcc
    buffer_load_dwordx4 v[36:39], v8, s[4:7], s16 offen offset:3072 sc1
    s_mov_b64 exec, -1
    s_add_u32 s23, s23, 1
    s_cmp_lt_u32 s23, 200000
    s_cbranch_scc1 g_45L8_3
    s_mov_b32 s25, 200000
    s_branch gc_46
.p2align 6
recur_fast_w3:
    s_nop 15
    s_mov_b32 s23, s25
    buffer_load_dwordx4 v[24:27], v2, s[4:7], s16 offen offset:0 sc1
    s_nop 11
    buffer_load_dwordx4 v[28:31], v2, s[4:7], s16 offen offset:1024 sc1
    s_nop 11
    buffer_load_dwordx4 v[32:35], v2, s[4:7], s16 offen offset:2048 sc1
    s_nop 11
    buffer_load_dwordx4 v[36:39], v2, s[4:7], s16 offen offset:3072 sc1
    s_waitcnt vmcnt(3)
    v_max3_u32 v19, v24, v25, v26
    v_max_u32 v19, v19, v27
    v_cmp_eq_u32 vcc, -1, v19
    s_nop 0
    s_cbranch_vccnz g_47F15_0
    v_smfmac_f32_16x16x64_bf16 v[40:43], v[24:27], a[0:7], v172
    s_waitcnt vmcnt(2)
    v_max3_u32 v19, v28, v29, v30
    v_max_u32 v19, v19, v31
    v_smfmac_f32_16x16x64_bf16 v[44:47], v[24:27], a[64:71], v172
    v_cmp_eq_u32 vcc, -1, v19
    v_smfmac_f32_16x16x64_bf16 v[48:51], v[24:27], a[32:39], v172
    v_smfmac_f32_16x16x64_bf16 v[52:55], v[24:27], a[96:103], v172
    s_cbranch_vccnz g_47F14_1
    v_smfmac_f32_16x16x64_bf16 v[40:43], v[28:31], a[8:15], v172
    s_waitcnt vmcnt(1)
    v_max3_u32 v19, v32, v33, v34
    v_max_u32 v19, v19, v35
    v_smfmac_f32_16x16x64_bf16 v[44:47], v[28:31], a[72:79], v172
    v_cmp_eq_u32 vcc, -1, v19
    v_smfmac_f32_16x16x64_bf16 v[48:51], v[28:31], a[40:47], v172
    v_smfmac_f32_16x16x64_bf16 v[52:55], v[28:31], a[104:111], v172
    s_cbranch_vccnz g_47F12_2
    v_smfmac_f32_16x16x64_bf16 v[40:43], v[32:35], a[16:23], v172
    s_waitcnt vmcnt(0)
    v_max3_u32 v19, v36, v37, v38
    v_max_u32 v19, v19, v39
    v_smfmac_f32_16x16x64_bf16 v[44:47], v[32:35], a[80:87], v172
    v_cmp_eq_u32 vcc, -1, v19
    v_smfmac_f32_16x16x64_bf16 v[48:51], v[32:35], a[48:55], v172
    v_smfmac_f32_16x16x64_bf16 v[52:55], v[32:35], a[112:119], v172
    s_cbranch_vccnz g_47F8_3
    v_smfmac_f32_16x16x64_bf16 v[40:43], v[36:39], a[24:31], v172
    v_smfmac_f32_16x16x64_bf16 v[44:47], v[36:39], a[88:95], v172
    v_smfmac_f32_16x16x64_bf16 v[48:51], v[36:39], a[56:63], v172
    v_smfmac_f32_16x16x64_bf16 v[52:55], v[36:39], a[120:127], v172
gc_48:
    v_cvt_pk_bf16_f32 v72, v40, v41
    v_cvt_pk_bf16_f32 v73, v42, v43
    v_cvt_pk_bf16_f32 v74, v44, v45
    v_cvt_pk_bf16_f32 v75, v46, v47
    ds_write_b128 v17, v[72:75] offset:0
    v_cvt_pk_bf16_f32 v76, v48, v49
    v_cvt_pk_bf16_f32 v77, v50, v51
    s_nop 0
    v_cvt_pk_bf16_f32 v78, v52, v53
    v_cvt_pk_bf16_f32 v79, v54, v55
    ds_write_b128 v17, v[76:79] offset:1024
    v_smfmac_f32_16x16x64_bf16 v[56:59], v[24:27], a[128:135], v172
    v_smfmac_f32_16x16x64_bf16 v[60:63], v[24:27], a[160:167], v172
    v_smfmac_f32_16x16x64_bf16 v[56:59], v[28:31], a[136:143], v172
    s_waitcnt lgkmcnt(0)
    s_barrier
    v_smfmac_f32_16x16x64_bf16 v[60:63], v[28:31], a[168:175], v172
    v_smfmac_f32_16x16x64_bf16 v[56:59], v[32:35], a[144:151], v172
    v_smfmac_f32_16x16x64_bf16 v[60:63], v[32:35], a[176:183], v172
    v_smfmac_f32_16x16x64_bf16 v[56:59], v[36:39], a[152:159], v172
    v_smfmac_f32_16x16x64_bf16 v[60:63], v[36:39], a[184:191], v172
    s_nop 4
    v_cvt_pk_bf16_f32 v80, v56, v57
    v_cvt_pk_bf16_f32 v81, v58, v59
    s_nop 0
    v_cvt_pk_bf16_f32 v82, v60, v61
    v_cvt_pk_bf16_f32 v83, v62, v63
    ds_write_b128 v17, v[80:83] offset:8192
    buffer_store_dwordx4 v[204:207], v3, s[4:7], s43 offen
    buffer_store_dwordx4 v[204:207], v3, s[4:7], s43 offen offset:128
    buffer_store_dwordx4 v[204:207], v4, s[4:7], s43 offen
    buffer_store_dwordx2 v[204:205], v7, s[4:7], s43 offen
    buffer_store_dwordx2 v[204:205], v11, s[4:7], s43 offen
    s_cmp_eq_u32 s15, 63
    s_waitcnt lgkmcnt(0)
    s_barrier
    s_cbranch_scc1 recur_end
    s_barrier
    s_nop 15
    s_mov_b32 s23, s25
    buffer_load_dwordx4 v[24:27], v8, s[4:7], s16 offen offset:0 sc1
    s_nop 11
    buffer_load_dwordx4 v[28:31], v8, s[4:7], s16 offen offset:1024 sc1
    s_nop 11
    buffer_load_dwordx4 v[32:35], v8, s[4:7], s16 offen offset:2048 sc1
    s_nop 11
    buffer_load_dwordx4 v[36:39], v8, s[4:7], s16 offen offset:3072 sc1
    s_waitcnt vmcnt(3)
    v_max3_u32 v19, v24, v25, v26
    v_max_u32 v19, v19, v27
    v_cmp_eq_u32 vcc, -1, v19
    s_nop 0
    s_cbranch_vccnz g_49F15_0
    v_smfmac_f32_16x16x64_bf16 v[64:67], v[24:27], a[192:199], v172
    v_smfmac_f32_16x16x64_bf16 v[68:71], v[24:27], a[224:231], v172
    s_waitcnt vmcnt(2)
    v_max3_u32 v19, v28, v29, v30
    v_max_u32 v19, v19, v31
    v_cmp_eq_u32 vcc, -1, v19
    s_nop 0
    s_cbranch_vccnz g_49F14_1
    v_smfmac_f32_16x16x64_bf16 v[64:67], v[28:31], a[200:207], v172
    v_smfmac_f32_16x16x64_bf16 v[68:71], v[28:31], a[232:239], v172
    s_waitcnt vmcnt(1)
    v_max3_u32 v19, v32, v33, v34
    v_max_u32 v19, v19, v35
    v_cmp_eq_u32 vcc, -1, v19
    s_nop 0
    s_cbranch_vccnz g_49F12_2
    v_smfmac_f32_16x16x64_bf16 v[64:67], v[32:35], a[208:215], v172
    v_smfmac_f32_16x16x64_bf16 v[68:71], v[32:35], a[240:247], v172
    s_waitcnt vmcnt(0)
    v_max3_u32 v19, v36, v37, v38
    v_max_u32 v19, v19, v39
    v_cmp_eq_u32 vcc, -1, v19
    s_nop 0
    s_cbranch_vccnz g_49F8_3
    v_smfmac_f32_16x16x64_bf16 v[64:67], v[36:39], a[216:223], v172
    v_smfmac_f32_16x16x64_bf16 v[68:71], v[36:39], a[248:255], v172
    s_nop 4
    v_cvt_pk_bf16_f32 v80, v64, v65
    v_cvt_pk_bf16_f32 v81, v66, v67
    s_nop 0
    v_cvt_pk_bf16_f32 v82, v68, v69
    v_cvt_pk_bf16_f32 v83, v70, v71
    s_nop 1
    v_mfma_f32_16x16x32_bf16 v[88:91], v[80:83], v[84:87], 0
gc_50:
    s_barrier
    ds_read_b128 v[96:99], v16 offset:9216
    ds_read_b128 v[100:103], v16 offset:11264
    ds_read_b128 v[104:107], v16 offset:13312
    s_waitcnt lgkmcnt(2)
    v_mfma_f32_16x16x32_bf16 v[88:91], v[96:99], v[84:87], v[88:91]
    s_waitcnt lgkmcnt(1)
    v_mfma_f32_16x16x32_bf16 v[88:91], v[100:103], v[84:87], v[88:91]
    s_waitcnt lgkmcnt(0)
    v_mfma_f32_16x16x32_bf16 v[88:91], v[104:107], v[84:87], v[88:91]
    s_nop 7
    buffer_store_dwordx4 v[88:91], v9, s[4:7], s84 offen sc1
    s_add_u32 s22, s84, 262144
    s_nop 15
    s_nop 15
    s_nop 15
    s_nop 15
    s_nop 15
    s_nop 15
    s_nop 15
    s_nop 15
    s_mov_b32 s23, s25
    buffer_load_dwordx4 v[96:99], v10, s[4:7], s84 offen sc1
    buffer_load_dwordx4 v[100:103], v23, s[4:7], s84 offen sc1
    buffer_load_dwordx4 v[104:107], v244, s[4:7], s84 offen sc1
    v_mov_b32 v40, 0
    v_mov_b32 v41, 0
    v_mov_b32 v42, 0
    v_mov_b32 v43, 0
    v_mov_b32 v44, 0
    v_mov_b32 v45, 0
    v_mov_b32 v46, 0
    v_mov_b32 v47, 0
    v_mov_b32 v48, 0
    v_mov_b32 v49, 0
    v_mov_b32 v50, 0
    v_mov_b32 v51, 0
    v_mov_b32 v52, 0
    v_mov_b32 v53, 0
    v_mov_b32 v54, 0
    v_mov_b32 v55, 0
    v_mov_b32 v56, 0
    v_mov_b32 v57, 0
    v_mov_b32 v58, 0
    v_mov_b32 v59, 0
    v_mov_b32 v60, 0
    v_mov_b32 v61, 0
    v_mov_b32 v62, 0
    v_mov_b32 v63, 0
    v_mov_b32 v64, 0
    v_mov_b32 v65, 0
    v_mov_b32 v66, 0
    v_mov_b32 v67, 0
    v_mov_b32 v68, 0
    v_mov_b32 v69, 0
    v_mov_b32 v70, 0
    v_mov_b32 v71, 0
pb_53:
    s_waitcnt vmcnt(2)
    v_pk_add_f32 v[120:121], v[88:89], v[96:97]
    v_pk_add_f32 v[122:123], v[90:91], v[98:99]
    s_waitcnt vmcnt(1)
    v_pk_add_f32 v[120:121], v[120:121], v[100:101]
    v_pk_add_f32 v[122:123], v[122:123], v[102:103]
    s_waitcnt vmcnt(0)
    v_pk_add_f32 v[120:121], v[120:121], v[104:105]
    v_pk_add_f32 v[122:123], v[122:123], v[106:107]
    v_cvt_pk_bf16_f32 v180, v120, v121
    v_pk_add_f32 v[124:125], v[120:121], v[122:123]
    v_cvt_pk_bf16_f32 v181, v122, v123
    v_cmpx_o_f32 vcc, v124, v125
    buffer_store_dwordx2 v[180:181], v11, s[4:7], s42 offen
    s_cmp_eq_u64 vcc, -1
    s_mov_b64 exec, -1
    s_cbranch_scc0 pr_51
pg_52:
    s_barrier
    s_mov_b32 s21, s16
    s_mov_b32 s16, s42
    s_mov_b32 s42, s43
    s_mov_b32 s43, s44
    s_mov_b32 s44, s21
    s_add_u32 s95, s95, 524288
    s_lshr_b32 s84, s95, 8
    s_and_b32 s84, s84, 8192
    s_xor_b32 s84, s84, s46
    s_add_u32 s84, s84, s95
    s_add_u32 s15, s15, 1
    s_branch recur_fast_w3
g_47L15_0:
    s_waitcnt vmcnt(3)
    v_max3_u32 v19, v24, v25, v26
    v_max_u32 v19, v19, v27
    v_cmp_eq_u32 vcc, -1, v19
    s_nop 0
    s_cbranch_vccnz g_47F15_0
    v_smfmac_f32_16x16x64_bf16 v[40:43], v[24:27], a[0:7], v172
    v_smfmac_f32_16x16x64_bf16 v[44:47], v[24:27], a[64:71], v172
    v_smfmac_f32_16x16x64_bf16 v[48:51], v[24:27], a[32:39], v172
    v_smfmac_f32_16x16x64_bf16 v[52:55], v[24:27], a[96:103], v172
g_47L14_1:
    s_waitcnt vmcnt(2)
    v_max3_u32 v19, v28, v29, v30
    v_max_u32 v19, v19, v31
    v_cmp_eq_u32 vcc, -1, v19
    s_nop 0
    s_cbranch_vccnz g_47F14_1
    v_smfmac_f32_16x16x64_bf16 v[40:43], v[28:31], a[8:15], v172
    v_smfmac_f32_16x16x64_bf16 v[44:47], v[28:31], a[72:79], v172
    v_smfmac_f32_16x16x64_bf16 v[48:51], v[28:31], a[40:47], v172
    v_smfmac_f32_16x16x64_bf16 v[52:55], v[28:31], a[104:111], v172
g_47L12_2:
    s_waitcnt vmcnt(1)
    v_max3_u32 v19, v32, v33, v34
    v_max_u32 v19, v19, v35
    v_cmp_eq_u32 vcc, -1, v19
    s_nop 0
    s_cbranch_vccnz g_47F12_2
    v_smfmac_f32_16x16x64_bf16 v[40:43], v[32:35], a[16:23], v172
    v_smfmac_f32_16x16x64_bf16 v[44:47], v[32:35], a[80:87], v172
    v_smfmac_f32_16x16x64_bf16 v[48:51], v[32:35], a[48:55], v172
    v_smfmac_f32_16x16x64_bf16 v[52:55], v[32:35], a[112:119], v172
g_47L8_3:
    s_waitcnt vmcnt(0)
    v_max3_u32 v19, v36, v37, v38
    v_max_u32 v19, v19, v39
    v_cmp_eq_u32 vcc, -1, v19
    s_nop 0
    s_cbranch_vccnz g_47F8_3
    v_smfmac_f32_16x16x64_bf16 v[40:43], v[36:39], a[24:31], v172
    v_smfmac_f32_16x16x64_bf16 v[44:47], v[36:39], a[88:95], v172
    v_smfmac_f32_16x16x64_bf16 v[48:51], v[36:39], a[56:63], v172
    v_smfmac_f32_16x16x64_bf16 v[52:55], v[36:39], a[120:127], v172
    s_branch gc_48
g_47L15_1:
    s_waitcnt vmcnt(3)
    v_max3_u32 v19, v28, v29, v30
    v_max_u32 v19, v19, v31
    v_cmp_eq_u32 vcc, -1, v19
    s_nop 0
    s_cbranch_vccnz g_47F15_1
    v_smfmac_f32_16x16x64_bf16 v[40:43], v[28:31], a[8:15], v172
    v_smfmac_f32_16x16x64_bf16 v[44:47], v[28:31], a[72:79], v172
    v_smfmac_f32_16x16x64_bf16 v[48:51], v[28:31], a[40:47], v172
    v_smfmac_f32_16x16x64_bf16 v[52:55], v[28:31], a[104:111], v172
g_47L13_2:
    s_waitcnt vmcnt(2)
    v_max3_u32 v19, v32, v33, v34
    v_max_u32 v19, v19, v35
    v_cmp_eq_u32 vcc, -1, v19
    s_nop 0
    s_cbranch_vccnz g_47F13_2
    v_smfmac_f32_16x16x64_bf16 v[40:43], v[32:35], a[16:23], v172
    v_smfmac_f32_16x16x64_bf16 v[44:47], v[32:35], a[80:87], v172
    v_smfmac_f32_16x16x64_bf16 v[48:51], v[32:35], a[48:55], v172
    v_smfmac_f32_16x16x64_bf16 v[52:55], v[32:35], a[112:119], v172
g_47L9_3:
    s_waitcnt vmcnt(1)
    v_max3_u32 v19, v36, v37, v38
    v_max_u32 v19, v19, v39
    v_cmp_eq_u32 vcc, -1, v19
    s_nop 0
    s_cbranch_vccnz g_47F9_3
    v_smfmac_f32_16x16x64_bf16 v[40:43], v[36:39], a[24:31], v172
    v_smfmac_f32_16x16x64_bf16 v[44:47], v[36:39], a[88:95], v172
    v_smfmac_f32_16x16x64_bf16 v[48:51], v[36:39], a[56:63], v172
    v_smfmac_f32_16x16x64_bf16 v[52:55], v[36:39], a[120:127], v172
g_47L1_0:
    s_waitcnt vmcnt(0)
    v_max3_u32 v19, v24, v25, v26
    v_max_u32 v19, v19, v27
    v_cmp_eq_u32 vcc, -1, v19
    s_nop 0
    s_cbranch_vccnz g_47F1_0
    v_smfmac_f32_16x16x64_bf16 v[40:43], v[24:27], a[0:7], v172
    v_smfmac_f32_16x16x64_bf16 v[44:47], v[24:27], a[64:71], v172
    v_smfmac_f32_16x16x64_bf16 v[48:51], v[24:27], a[32:39], v172
    v_smfmac_f32_16x16x64_bf16 v[52:55], v[24:27], a[96:103], v172
    s_branch gc_48
g_47L15_2:
    s_waitcnt vmcnt(3)
    v_max3_u32 v19, v32, v33, v34
    v_max_u32 v19, v19, v35
    v_cmp_eq_u32 vcc, -1, v19
    s_nop 0
    s_cbranch_vccnz g_47F15_2
    v_smfmac_f32_16x16x64_bf16 v[40:43], v[32:35], a[16:23], v172
    v_smfmac_f32_16x16x64_bf16 v[44:47], v[32:35], a[80:87], v172
    v_smfmac_f32_16x16x64_bf16 v[48:51], v[32:35], a[48:55], v172
    v_smfmac_f32_16x16x64_bf16 v[52:55], v[32:35], a[112:119], v172
g_47L11_3:
    s_waitcnt vmcnt(2)
    v_max3_u32 v19, v36, v37, v38
    v_max_u32 v19, v19, v39
    v_cmp_eq_u32 vcc, -1, v19
    s_nop 0
    s_cbranch_vccnz g_47F11_3
    v_smfmac_f32_16x16x64_bf16 v[40:43], v[36:39], a[24:31], v172
    v_smfmac_f32_16x16x64_bf16 v[44:47], v[36:39], a[88:95], v172
    v_smfmac_f32_16x16x64_bf16 v[48:51], v[36:39], a[56:63], v172
    v_smfmac_f32_16x16x64_bf16 v[52:55], v[36:39], a[120:127], v172
g_47L3_0:
    s_waitcnt vmcnt(1)
    v_max3_u32 v19, v24, v25, v26
    v_max_u32 v19, v19, v27
    v_cmp_eq_u32 vcc, -1, v19
    s_nop 0
    s_cbranch_vccnz g_47F3_0
    v_smfmac_f32_16x16x64_bf16 v[40:43], v[24:27], a[0:7], v172
    v_smfmac_f32_16x16x64_bf16 v[44:47], v[24:27], a[64:71], v172
    v_smfmac_f32_16x16x64_bf16 v[48:51], v[24:27], a[32:39], v172
    v_smfmac_f32_16x16x64_bf16 v[52:55], v[24:27], a[96:103], v172
g_47L2_1:
    s_waitcnt vmcnt(0)
    v_max3_u32 v19, v28, v29, v30
    v_max_u32 v19, v19, v31
    v_cmp_eq_u32 vcc, -1, v19
    s_nop 0
    s_cbranch_vccnz g_47F2_1
    v_smfmac_f32_16x16x64_bf16 v[40:43], v[28:31], a[8:15], v172
    v_smfmac_f32_16x16x64_bf16 v[44:47], v[28:31], a[72:79], v172
    v_smfmac_f32_16x16x64_bf16 v[48:51], v[28:31], a[40:47], v172
    v_smfmac_f32_16x16x64_bf16 v[52:55], v[28:31], a[104:111], v172
    s_branch gc_48
g_47L15_3:
    s_waitcnt vmcnt(3)
    v_max3_u32 v19, v36, v37, v38
    v_max_u32 v19, v19, v39
    v_cmp_eq_u32 vcc, -1, v19
    s_nop 0
    s_cbranch_vccnz g_47F15_3
    v_smfmac_f32_16x16x64_bf16 v[40:43], v[36:39], a[24:31], v172
    v_smfmac_f32_16x16x64_bf16 v[44:47], v[36:39], a[88:95], v172
    v_smfmac_f32_16x16x64_bf16 v[48:51], v[36:39], a[56:63], v172
    v_smfmac_f32_16x16x64_bf16 v[52:55], v[36:39], a[120:127], v172
g_47L7_0:
    s_waitcnt vmcnt(2)
    v_max3_u32 v19, v24, v25, v26
    v_max_u32 v19, v19, v27
    v_cmp_eq_u32 vcc, -1, v19
    s_nop 0
    s_cbranch_vccnz g_47F7_0
    v_smfmac_f32_16x16x64_bf16 v[40:43], v[24:27], a[0:7], v172
    v_smfmac_f32_16x16x64_bf16 v[44:47], v[24:27], a[64:71], v172
    v_smfmac_f32_16x16x64_bf16 v[48:51], v[24:27], a[32:39], v172
    v_smfmac_f32_16x16x64_bf16 v[52:55], v[24:27], a[96:103], v172
g_47L6_1:
    s_waitcnt vmcnt(1)
    v_max3_u32 v19, v28, v29, v30
    v_max_u32 v19, v19, v31
    v_cmp_eq_u32 vcc, -1, v19
    s_nop 0
    s_cbranch_vccnz g_47F6_1
    v_smfmac_f32_16x16x64_bf16 v[40:43], v[28:31], a[8:15], v172
    v_smfmac_f32_16x16x64_bf16 v[44:47], v[28:31], a[72:79], v172
    v_smfmac_f32_16x16x64_bf16 v[48:51], v[28:31], a[40:47], v172
    v_smfmac_f32_16x16x64_bf16 v[52:55], v[28:31], a[104:111], v172
g_47L4_2:
    s_waitcnt vmcnt(0)
    v_max3_u32 v19, v32, v33, v34
    v_max_u32 v19, v19, v35
    v_cmp_eq_u32 vcc, -1, v19
    s_nop 0
    s_cbranch_vccnz g_47F4_2
    v_smfmac_f32_16x16x64_bf16 v[40:43], v[32:35], a[16:23], v172
    v_smfmac_f32_16x16x64_bf16 v[44:47], v[32:35], a[80:87], v172
    v_smfmac_f32_16x16x64_bf16 v[48:51], v[32:35], a[48:55], v172
    v_smfmac_f32_16x16x64_bf16 v[52:55], v[32:35], a[112:119], v172
    s_branch gc_48
g_47L7_1:
    s_waitcnt vmcnt(2)
    v_max3_u32 v19, v28, v29, v30
    v_max_u32 v19, v19, v31
    v_cmp_eq_u32 vcc, -1, v19
    s_nop 0
    s_cbranch_vccnz g_47F7_1
    v_smfmac_f32_16x16x64_bf16 v[40:43], v[28:31], a[8:15], v172
    v_smfmac_f32_16x16x64_bf16 v[44:47], v[28:31], a[72:79], v172
    v_smfmac_f32_16x16x64_bf16 v[48:51], v[28:31], a[40:47], v172
    v_smfmac_f32_16x16x64_bf16 v[52:55], v[28:31], a[104:111], v172
g_47L5_2:
    s_waitcnt vmcnt(1)
    v_max3_u32 v19, v32, v33, v34
    v_max_u32 v19, v19, v35
    v_cmp_eq_u32 vcc, -1, v19
    s_nop 0
    s_cbranch_vccnz g_47F5_2
    v_smfmac_f32_16x16x64_bf16 v[40:43], v[32:35], a[16:23], v172
    v_smfmac_f32_16x16x64_bf16 v[44:47], v[32:35], a[80:87], v172
    v_smfmac_f32_16x16x64_bf16 v[48:51], v[32:35], a[48:55], v172
    v_smfmac_f32_16x16x64_bf16 v[52:55], v[32:35], a[112:119], v172
    s_branch g_47L1_0
g_47L7_2:
    s_waitcnt vmcnt(2)
    v_max3_u32 v19, v32, v33, v34
    v_max_u32 v19, v19, v35
    v_cmp_eq_u32 vcc, -1, v19
    s_nop 0
    s_cbranch_vccnz g_47F7_2
    v_smfmac_f32_16x16x64_bf16 v[40:43], v[32:35], a[16:23], v172
    v_smfmac_f32_16x16x64_bf16 v[44:47], v[32:35], a[80:87], v172
    v_smfmac_f32_16x16x64_bf16 v[48:51], v[32:35], a[48:55], v172
    v_smfmac_f32_16x16x64_bf16 v[52:55], v[32:35], a[112:119], v172
    s_branch g_47L3_0
g_47L11_0:
    s_waitcnt vmcnt(2)
    v_max3_u32 v19, v24, v25, v26
    v_max_u32 v19, v19, v27
    v_cmp_eq_u32 vcc, -1, v19
    s_nop 0
    s_cbranch_vccnz g_47F11_0
    v_smfmac_f32_16x16x64_bf16 v[40:43], v[24:27], a[0:7], v172
    v_smfmac_f32_16x16x64_bf16 v[44:47], v[24:27], a[64:71], v172
    v_smfmac_f32_16x16x64_bf16 v[48:51], v[24:27], a[32:39], v172
    v_smfmac_f32_16x16x64_bf16 v[52:55], v[24:27], a[96:103], v172
g_47L10_1:
    s_waitcnt vmcnt(1)
    v_max3_u32 v19, v28, v29, v30
    v_max_u32 v19, v19, v31
    v_cmp_eq_u32 vcc, -1, v19
    s_nop 0
    s_cbranch_vccnz g_47F10_1
    v_smfmac_f32_16x16x64_bf16 v[40:43], v[28:31], a[8:15], v172
    v_smfmac_f32_16x16x64_bf16 v[44:47], v[28:31], a[72:79], v172
    v_smfmac_f32_16x16x64_bf16 v[48:51], v[28:31], a[40:47], v172
    v_smfmac_f32_16x16x64_bf16 v[52:55], v[28:31], a[104:111], v172
    s_branch g_47L8_3
g_47L11_1:
    s_waitcnt vmcnt(2)
    v_max3_u32 v19, v28, v29, v30
    v_max_u32 v19, v19, v31
    v_cmp_eq_u32 vcc, -1, v19
    s_nop 0
    s_cbranch_vccnz g_47F11_1
    v_smfmac_f32_16x16x64_bf16 v[40:43], v[28:31], a[8:15], v172
    v_smfmac_f32_16x16x64_bf16 v[44:47], v[28:31], a[72:79], v172
    v_smfmac_f32_16x16x64_bf16 v[48:51], v[28:31], a[40:47], v172
    v_smfmac_f32_16x16x64_bf16 v[52:55], v[28:31], a[104:111], v172
    s_branch g_47L9_3
g_47L13_0:
    s_waitcnt vmcnt(2)
    v_max3_u32 v19, v24, v25, v26
    v_max_u32 v19, v19, v27
    v_cmp_eq_u32 vcc, -1, v19
    s_nop 0
    s_cbranch_vccnz g_47F13_0
    v_smfmac_f32_16x16x64_bf16 v[40:43], v[24:27], a[0:7], v172
    v_smfmac_f32_16x16x64_bf16 v[44:47], v[24:27], a[64:71], v172
    v_smfmac_f32_16x16x64_bf16 v[48:51], v[24:27], a[32:39], v172
    v_smfmac_f32_16x16x64_bf16 v[52:55], v[24:27], a[96:103], v172
    s_branch g_47L12_2
g_47L13_3:
    s_waitcnt vmcnt(2)
    v_max3_u32 v19, v36, v37, v38
    v_max_u32 v19, v19, v39
    v_cmp_eq_u32 vcc, -1, v19
    s_nop 0
    s_cbranch_vccnz g_47F13_3
    v_smfmac_f32_16x16x64_bf16 v[40:43], v[36:39], a[24:31], v172
    v_smfmac_f32_16x16x64_bf16 v[44:47], v[36:39], a[88:95], v172
    v_smfmac_f32_16x16x64_bf16 v[48:51], v[36:39], a[56:63], v172
    v_smfmac_f32_16x16x64_bf16 v[52:55], v[36:39], a[120:127], v172
g_47L5_0:
    s_waitcnt vmcnt(1)
    v_max3_u32 v19, v24, v25, v26
    v_max_u32 v19, v19, v27
    v_cmp_eq_u32 vcc, -1, v19
    s_nop 0
    s_cbranch_vccnz g_47F5_0
    v_smfmac_f32_16x16x64_bf16 v[40:43], v[24:27], a[0:7], v172
    v_smfmac_f32_16x16x64_bf16 v[44:47], v[24:27], a[64:71], v172
    v_smfmac_f32_16x16x64_bf16 v[48:51], v[24:27], a[32:39], v172
    v_smfmac_f32_16x16x64_bf16 v[52:55], v[24:27], a[96:103], v172
    s_branch g_47L4_2
g_47L14_2:
    s_waitcnt vmcnt(2)
    v_max3_u32 v19, v32, v33, v34
    v_max_u32 v19, v19, v35
    v_cmp_eq_u32 vcc, -1, v19
    s_nop 0
    s_cbranch_vccnz g_47F14_2
    v_smfmac_f32_16x16x64_bf16 v[40:43], v[32:35], a[16:23], v172
    v_smfmac_f32_16x16x64_bf16 v[44:47], v[32:35], a[80:87], v172
    v_smfmac_f32_16x16x64_bf16 v[48:51], v[32:35], a[48:55], v172
    v_smfmac_f32_16x16x64_bf16 v[52:55], v[32:35], a[112:119], v172
g_47L10_3:
    s_waitcnt vmcnt(1)
    v_max3_u32 v19, v36, v37, v38
    v_max_u32 v19, v19, v39
    v_cmp_eq_u32 vcc, -1, v19
    s_nop 0
    s_cbranch_vccnz g_47F10_3
    v_smfmac_f32_16x16x64_bf16 v[40:43], v[36:39], a[24:31], v172
    v_smfmac_f32_16x16x64_bf16 v[44:47], v[36:39], a[88:95], v172
    v_smfmac_f32_16x16x64_bf16 v[48:51], v[36:39], a[56:63], v172
    v_smfmac_f32_16x16x64_bf16 v[52:55], v[36:39], a[120:127], v172
    s_branch g_47L2_1
g_47L14_3:
    s_waitcnt vmcnt(2)
    v_max3_u32 v19, v36, v37, v38
    v_max_u32 v19, v19, v39
    v_cmp_eq_u32 vcc, -1, v19
    s_nop 0
    s_cbranch_vccnz g_47F14_3
    v_smfmac_f32_16x16x64_bf16 v[40:43], v[36:39], a[24:31], v172
    v_smfmac_f32_16x16x64_bf16 v[44:47], v[36:39], a[88:95], v172
    v_smfmac_f32_16x16x64_bf16 v[48:51], v[36:39], a[56:63], v172
    v_smfmac_f32_16x16x64_bf16 v[52:55], v[36:39], a[120:127], v172
    s_branch g_47L6_1
g_47L3_1:
    s_waitcnt vmcnt(1)
    v_max3_u32 v19, v28, v29, v30
    v_max_u32 v19, v19, v31
    v_cmp_eq_u32 vcc, -1, v19
    s_nop 0
    s_cbranch_vccnz g_47F3_1
    v_smfmac_f32_16x16x64_bf16 v[40:43], v[28:31], a[8:15], v172
    v_smfmac_f32_16x16x64_bf16 v[44:47], v[28:31], a[72:79], v172
    v_smfmac_f32_16x16x64_bf16 v[48:51], v[28:31], a[40:47], v172
    v_smfmac_f32_16x16x64_bf16 v[52:55], v[28:31], a[104:111], v172
    s_branch g_47L1_0
g_47L6_2:
    s_waitcnt vmcnt(1)
    v_max3_u32 v19, v32, v33, v34
    v_max_u32 v19, v19, v35
    v_cmp_eq_u32 vcc, -1, v19
    s_nop 0
    s_cbranch_vccnz g_47F6_2
    v_smfmac_f32_16x16x64_bf16 v[40:43], v[32:35], a[16:23], v172
    v_smfmac_f32_16x16x64_bf16 v[44:47], v[32:35], a[80:87], v172
    v_smfmac_f32_16x16x64_bf16 v[48:51], v[32:35], a[48:55], v172
    v_smfmac_f32_16x16x64_bf16 v[52:55], v[32:35], a[112:119], v172
    s_branch g_47L2_1
g_47L9_0:
    s_waitcnt vmcnt(1)
    v_max3_u32 v19, v24, v25, v26
    v_max_u32 v19, v19, v27
    v_cmp_eq_u32 vcc, -1, v19
    s_nop 0
    s_cbranch_vccnz g_47F9_0
    v_smfmac_f32_16x16x64_bf16 v[40:43], v[24:27], a[0:7], v172
    v_smfmac_f32_16x16x64_bf16 v[44:47], v[24:27], a[64:71], v172
    v_smfmac_f32_16x16x64_bf16 v[48:51], v[24:27], a[32:39], v172
    v_smfmac_f32_16x16x64_bf16 v[52:55], v[24:27], a[96:103], v172
    s_branch g_47L8_3
g_47L12_3:
    s_waitcnt vmcnt(1)
    v_max3_u32 v19, v36, v37, v38
    v_max_u32 v19, v19, v39
    v_cmp_eq_u32 vcc, -1, v19
    s_nop 0
    s_cbranch_vccnz g_47F12_3
    v_smfmac_f32_16x16x64_bf16 v[40:43], v[36:39], a[24:31], v172
    v_smfmac_f32_16x16x64_bf16 v[44:47], v[36:39], a[88:95], v172
    v_smfmac_f32_16x16x64_bf16 v[48:51], v[36:39], a[56:63], v172
    v_smfmac_f32_16x16x64_bf16 v[52:55], v[36:39], a[120:127], v172
    s_branch g_47L4_2
g_47F15_0:
    s_mov_b64 exec, vcc
    buffer_load_dwordx4 v[24:27], v2, s[4:7], s16 offen offset:0 sc1
    s_mov_b64 exec, -1
    s_add_u32 s23, s23, 1
    s_cmp_lt_u32 s23, 200000
    s_cbranch_scc1 g_47L15_1
    s_mov_b32 s25, 200000
    s_branch gc_48
g_47F15_1:
    s_mov_b64 exec, vcc
    buffer_load_dwordx4 v[28:31], v2, s[4:7], s16 offen offset:1024 sc1
    s_mov_b64 exec, -1
    s_add_u32 s23, s23, 1
    s_cmp_lt_u32 s23, 200000
    s_cbranch_scc1 g_47L15_2
    s_mov_b32 s25, 200000
    s_branch gc_48
g_47F15_2:
    s_mov_b64 exec, vcc
    buffer_load_dwordx4 v[32:35], v2, s[4:7], s16 offen offset:2048 sc1
    s_mov_b64 exec, -1
    s_add_u32 s23, s23, 1
    s_cmp_lt_u32 s23, 200000
    s_cbranch_scc1 g_47L15_3
    s_mov_b32 s25, 200000
    s_branch gc_48
g_47F15_3:
    s_mov_b64 exec, vcc
    buffer_load_dwordx4 v[36:39], v2, s[4:7], s16 offen offset:3072 sc1
    s_mov_b64 exec, -1
    s_add_u32 s23, s23, 1
    s_cmp_lt_u32 s23, 200000
    s_cbranch_scc1 g_47L15_0
    s_mov_b32 s25, 200000
    s_branch gc_48
g_47F7_0:
    s_mov_b64 exec, vcc
    buffer_load_dwordx4 v[24:27], v2, s[4:7], s16 offen offset:0 sc1
    s_mov_b64 exec, -1
    s_add_u32 s23, s23, 1
    s_cmp_lt_u32 s23, 200000
    s_cbranch_scc1 g_47L7_1
    s_mov_b32 s25, 200000
    s_branch gc_48
g_47F7_1:
    s_mov_b64 exec, vcc
    buffer_load_dwordx4 v[28:31], v2, s[4:7], s16 offen offset:1024 sc1
    s_mov_b64 exec, -1
    s_add_u32 s23, s23, 1
    s_cmp_lt_u32 s23, 200000
    s_cbranch_scc1 g_47L7_2
    s_mov_b32 s25, 200000
    s_branch gc_48
g_47F7_2:
    s_mov_b64 exec, vcc
    buffer_load_dwordx4 v[32:35], v2, s[4:7], s16 offen offset:2048 sc1
    s_mov_b64 exec, -1
    s_add_u32 s23, s23, 1
    s_cmp_lt_u32 s23, 200000
    s_cbranch_scc1 g_47L7_0
    s_mov_b32 s25, 200000
    s_branch gc_48
g_47F11_0:
    s_mov_b64 exec, vcc
    buffer_load_dwordx4 v[24:27], v2, s[4:7], s16 offen offset:0 sc1
    s_mov_b64 exec, -1
    s_add_u32 s23, s23, 1
    s_cmp_lt_u32 s23, 200000
    s_cbranch_scc1 g_47L11_1
    s_mov_b32 s25, 200000
    s_branch gc_48
g_47F11_1:
    s_mov_b64 exec, vcc
    buffer_load_dwordx4 v[28:31], v2, s[4:7], s16 offen offset:1024 sc1
    s_mov_b64 exec, -1
    s_add_u32 s23, s23, 1
    s_cmp_lt_u32 s23, 200000
    s_cbranch_scc1 g_47L11_3
    s_mov_b32 s25, 200000
    s_branch gc_48
g_47F11_3:
    s_mov_b64 exec, vcc
    buffer_load_dwordx4 v[36:39], v2, s[4:7], s16 offen offset:3072 sc1
    s_mov_b64 exec, -1
    s_add_u32 s23, s23, 1
    s_cmp_lt_u32 s23, 200000
    s_cbranch_scc1 g_47L11_0
    s_mov_b32 s25, 200000
    s_branch gc_48
g_47F13_0:
    s_mov_b64 exec, vcc
    buffer_load_dwordx4 v[24:27], v2, s[4:7], s16 offen offset:0 sc1
    s_mov_b64 exec, -1
    s_add_u32 s23, s23, 1
    s_cmp_lt_u32 s23, 200000
    s_cbranch_scc1 g_47L13_2
    s_mov_b32 s25, 200000
    s_branch gc_48
g_47F13_2:
    s_mov_b64 exec, vcc
    buffer_load_dwordx4 v[32:35], v2, s[4:7], s16 offen offset:2048 sc1
    s_mov_b64 exec, -1
    s_add_u32 s23, s23, 1
    s_cmp_lt_u32 s23, 200000
    s_cbranch_scc1 g_47L13_3
    s_mov_b32 s25, 200000
    s_branch gc_48
g_47F13_3:
    s_mov_b64 exec, vcc
    buffer_load_dwordx4 v[36:39], v2, s[4:7], s16 offen offset:3072 sc1
    s_mov_b64 exec, -1
    s_add_u32 s23, s23, 1
    s_cmp_lt_u32 s23, 200000
    s_cbranch_scc1 g_47L13_0
    s_mov_b32 s25, 200000
    s_branch gc_48
g_47F14_1:
    s_mov_b64 exec, vcc
    buffer_load_dwordx4 v[28:31], v2, s[4:7], s16 offen offset:1024 sc1
    s_mov_b64 exec, -1
    s_add_u32 s23, s23, 1
    s_cmp_lt_u32 s23, 200000
    s_cbranch_scc1 g_47L14_2
    s_mov_b32 s25, 200000
    s_branch gc_48
g_47F14_2:
    s_mov_b64 exec, vcc
    buffer_load_dwordx4 v[32:35], v2, s[4:7], s16 offen offset:2048 sc1
    s_mov_b64 exec, -1
    s_add_u32 s23, s23, 1
    s_cmp_lt_u32 s23, 200000
    s_cbranch_scc1 g_47L14_3
    s_mov_b32 s25, 200000
    s_branch gc_48
g_47F14_3:
    s_mov_b64 exec, vcc
    buffer_load_dwordx4 v[36:39], v2, s[4:7], s16 offen offset:3072 sc1
    s_mov_b64 exec, -1
    s_add_u32 s23, s23, 1
    s_cmp_lt_u32 s23, 200000
    s_cbranch_scc1 g_47L14_1
    s_mov_b32 s25, 200000
    s_branch gc_48
g_47F3_0:
    s_mov_b64 exec, vcc
    buffer_load_dwordx4 v[24:27], v2, s[4:7], s16 offen offset:0 sc1
    s_mov_b64 exec, -1
    s_add_u32 s23, s23, 1
    s_cmp_lt_u32 s23, 200000
    s_cbranch_scc1 g_47L3_1
    s_mov_b32 s25, 200000
    s_branch gc_48
g_47F3_1:
    s_mov_b64 exec, vcc
    buffer_load_dwordx4 v[28:31], v2, s[4:7], s16 offen offset:1024 sc1
    s_mov_b64 exec, -1
    s_add_u32 s23, s23, 1
    s_cmp_lt_u32 s23, 200000
    s_cbranch_scc1 g_47L3_0
    s_mov_b32 s25, 200000
    s_branch gc_48
g_47F5_0:
    s_mov_b64 exec, vcc
    buffer_load_dwordx4 v[24:27], v2, s[4:7], s16 offen offset:0 sc1
    s_mov_b64 exec, -1
    s_add_u32 s23, s23, 1
    s_cmp_lt_u32 s23, 200000
    s_cbranch_scc1 g_47L5_2
    s_mov_b32 s25, 200000
    s_branch gc_48
g_47F5_2:
    s_mov_b64 exec, vcc
    buffer_load_dwordx4 v[32:35], v2, s[4:7], s16 offen offset:2048 sc1
    s_mov_b64 exec, -1
    s_add_u32 s23, s23, 1
    s_cmp_lt_u32 s23, 200000
    s_cbranch_scc1 g_47L5_0
    s_mov_b32 s25, 200000
    s_branch gc_48
g_47F6_1:
    s_mov_b64 exec, vcc
    buffer_load_dwordx4 v[28:31], v2, s[4:7], s16 offen offset:1024 sc1
    s_mov_b64 exec, -1
    s_add_u32 s23, s23, 1
    s_cmp_lt_u32 s23, 200000
    s_cbranch_scc1 g_47L6_2
    s_mov_b32 s25, 200000
    s_branch gc_48
g_47F6_2:
    s_mov_b64 exec, vcc
    buffer_load_dwordx4 v[32:35], v2, s[4:7], s16 offen offset:2048 sc1
    s_mov_b64 exec, -1
    s_add_u32 s23, s23, 1
    s_cmp_lt_u32 s23, 200000
    s_cbranch_scc1 g_47L6_1
    s_mov_b32 s25, 200000
    s_branch gc_48
g_47F9_0:
    s_mov_b64 exec, vcc
    buffer_load_dwordx4 v[24:27], v2, s[4:7], s16 offen offset:0 sc1
    s_mov_b64 exec, -1
    s_add_u32 s23, s23, 1
    s_cmp_lt_u32 s23, 200000
    s_cbranch_scc1 g_47L9_3
    s_mov_b32 s25, 200000
    s_branch gc_48
g_47F9_3:
    s_mov_b64 exec, vcc
    buffer_load_dwordx4 v[36:39], v2, s[4:7], s16 offen offset:3072 sc1
    s_mov_b64 exec, -1
    s_add_u32 s23, s23, 1
    s_cmp_lt_u32 s23, 200000
    s_cbranch_scc1 g_47L9_0
    s_mov_b32 s25, 200000
    s_branch gc_48
g_47F10_1:
    s_mov_b64 exec, vcc
    buffer_load_dwordx4 v[28:31], v2, s[4:7], s16 offen offset:1024 sc1
    s_mov_b64 exec, -1
    s_add_u32 s23, s23, 1
    s_cmp_lt_u32 s23, 200000
    s_cbranch_scc1 g_47L10_3
    s_mov_b32 s25, 200000
    s_branch gc_48
g_47F10_3:
    s_mov_b64 exec, vcc
    buffer_load_dwordx4 v[36:39], v2, s[4:7], s16 offen offset:3072 sc1
    s_mov_b64 exec, -1
    s_add_u32 s23, s23, 1
    s_cmp_lt_u32 s23, 200000
    s_cbranch_scc1 g_47L10_1
    s_mov_b32 s25, 200000
    s_branch gc_48
g_47F12_2:
    s_mov_b64 exec, vcc
    buffer_load_dwordx4 v[32:35], v2, s[4:7], s16 offen offset:2048 sc1
    s_mov_b64 exec, -1
    s_add_u32 s23, s23, 1
    s_cmp_lt_u32 s23, 200000
    s_cbranch_scc1 g_47L12_3
    s_mov_b32 s25, 200000
    s_branch gc_48
g_47F12_3:
    s_mov_b64 exec, vcc
    buffer_load_dwordx4 v[36:39], v2, s[4:7], s16 offen offset:3072 sc1
    s_mov_b64 exec, -1
    s_add_u32 s23, s23, 1
    s_cmp_lt_u32 s23, 200000
    s_cbranch_scc1 g_47L12_2
    s_mov_b32 s25, 200000
    s_branch gc_48
g_47F1_0:
    s_mov_b64 exec, vcc
    buffer_load_dwordx4 v[24:27], v2, s[4:7], s16 offen offset:0 sc1
    s_mov_b64 exec, -1
    s_add_u32 s23, s23, 1
    s_cmp_lt_u32 s23, 200000
    s_cbranch_scc1 g_47L1_0
    s_mov_b32 s25, 200000
    s_branch gc_48
g_47F2_1:
    s_mov_b64 exec, vcc
    buffer_load_dwordx4 v[28:31], v2, s[4:7], s16 offen offset:1024 sc1
    s_mov_b64 exec, -1
    s_add_u32 s23, s23, 1
    s_cmp_lt_u32 s23, 200000
    s_cbranch_scc1 g_47L2_1
    s_mov_b32 s25, 200000
    s_branch gc_48
g_47F4_2:
    s_mov_b64 exec, vcc
    buffer_load_dwordx4 v[32:35], v2, s[4:7], s16 offen offset:2048 sc1
    s_mov_b64 exec, -1
    s_add_u32 s23, s23, 1
    s_cmp_lt_u32 s23, 200000
    s_cbranch_scc1 g_47L4_2
    s_mov_b32 s25, 200000
    s_branch gc_48
g_47F8_3:
    s_mov_b64 exec, vcc
    buffer_load_dwordx4 v[36:39], v2, s[4:7], s16 offen offset:3072 sc1
    s_mov_b64 exec, -1
    s_add_u32 s23, s23, 1
    s_cmp_lt_u32 s23, 200000
    s_cbranch_scc1 g_47L8_3
    s_mov_b32 s25, 200000
    s_branch gc_48
g_49L15_0:
    s_waitcnt vmcnt(3)
    v_max3_u32 v19, v24, v25, v26
    v_max_u32 v19, v19, v27
    v_cmp_eq_u32 vcc, -1, v19
    s_nop 0
    s_cbranch_vccnz g_49F15_0
    v_smfmac_f32_16x16x64_bf16 v[64:67], v[24:27], a[192:199], v172
    v_smfmac_f32_16x16x64_bf16 v[68:71], v[24:27], a[224:231], v172
g_49L14_1:
    s_waitcnt vmcnt(2)
    v_max3_u32 v19, v28, v29, v30
    v_max_u32 v19, v19, v31
    v_cmp_eq_u32 vcc, -1, v19
    s_nop 0
    s_cbranch_vccnz g_49F14_1
    v_smfmac_f32_16x16x64_bf16 v[64:67], v[28:31], a[200:207], v172
    v_smfmac_f32_16x16x64_bf16 v[68:71], v[28:31], a[232:239], v172
g_49L12_2:
    s_waitcnt vmcnt(1)
    v_max3_u32 v19, v32, v33, v34
    v_max_u32 v19, v19, v35
    v_cmp_eq_u32 vcc, -1, v19
    s_nop 0
    s_cbranch_vccnz g_49F12_2
    v_smfmac_f32_16x16x64_bf16 v[64:67], v[32:35], a[208:215], v172
    v_smfmac_f32_16x16x64_bf16 v[68:71], v[32:35], a[240:247], v172
g_49L8_3:
    s_waitcnt vmcnt(0)
    v_max3_u32 v19, v36, v37, v38
    v_max_u32 v19, v19, v39
    v_cmp_eq_u32 vcc, -1, v19
    s_nop 0
    s_cbranch_vccnz g_49F8_3
    v_smfmac_f32_16x16x64_bf16 v[64:67], v[36:39], a[216:223], v172
    v_smfmac_f32_16x16x64_bf16 v[68:71], v[36:39], a[248:255], v172
    s_nop 4
    v_cvt_pk_bf16_f32 v80, v64, v65
    v_cvt_pk_bf16_f32 v81, v66, v67
    s_nop 0
    v_cvt_pk_bf16_f32 v82, v68, v69
    v_cvt_pk_bf16_f32 v83, v70, v71
    s_nop 1
    v_mfma_f32_16x16x32_bf16 v[88:91], v[80:83], v[84:87], 0
    s_branch gc_50
g_49L15_1:
    s_waitcnt vmcnt(3)
    v_max3_u32 v19, v28, v29, v30
    v_max_u32 v19, v19, v31
    v_cmp_eq_u32 vcc, -1, v19
    s_nop 0
    s_cbranch_vccnz g_49F15_1
    v_smfmac_f32_16x16x64_bf16 v[64:67], v[28:31], a[200:207], v172
    v_smfmac_f32_16x16x64_bf16 v[68:71], v[28:31], a[232:239], v172
g_49L13_2:
    s_waitcnt vmcnt(2)
    v_max3_u32 v19, v32, v33, v34
    v_max_u32 v19, v19, v35
    v_cmp_eq_u32 vcc, -1, v19
    s_nop 0
    s_cbranch_vccnz g_49F13_2
    v_smfmac_f32_16x16x64_bf16 v[64:67], v[32:35], a[208:215], v172
    v_smfmac_f32_16x16x64_bf16 v[68:71], v[32:35], a[240:247], v172
g_49L9_3:
    s_waitcnt vmcnt(1)
    v_max3_u32 v19, v36, v37, v38
    v_max_u32 v19, v19, v39
    v_cmp_eq_u32 vcc, -1, v19
    s_nop 0
    s_cbranch_vccnz g_49F9_3
    v_smfmac_f32_16x16x64_bf16 v[64:67], v[36:39], a[216:223], v172
    v_smfmac_f32_16x16x64_bf16 v[68:71], v[36:39], a[248:255], v172
g_49L1_0:
    s_waitcnt vmcnt(0)
    v_max3_u32 v19, v24, v25, v26
    v_max_u32 v19, v19, v27
    v_cmp_eq_u32 vcc, -1, v19
    s_nop 0
    s_cbranch_vccnz g_49F1_0
    v_smfmac_f32_16x16x64_bf16 v[64:67], v[24:27], a[192:199], v172
    v_smfmac_f32_16x16x64_bf16 v[68:71], v[24:27], a[224:231], v172
    s_nop 4
    v_cvt_pk_bf16_f32 v80, v64, v65
    v_cvt_pk_bf16_f32 v81, v66, v67
    s_nop 0
    v_cvt_pk_bf16_f32 v82, v68, v69
    v_cvt_pk_bf16_f32 v83, v70, v71
    s_nop 1
    v_mfma_f32_16x16x32_bf16 v[88:91], v[80:83], v[84:87], 0
    s_branch gc_50
g_49L15_2:
    s_waitcnt vmcnt(3)
    v_max3_u32 v19, v32, v33, v34
    v_max_u32 v19, v19, v35
    v_cmp_eq_u32 vcc, -1, v19
    s_nop 0
    s_cbranch_vccnz g_49F15_2
    v_smfmac_f32_16x16x64_bf16 v[64:67], v[32:35], a[208:215], v172
    v_smfmac_f32_16x16x64_bf16 v[68:71], v[32:35], a[240:247], v172
g_49L11_3:
    s_waitcnt vmcnt(2)
    v_max3_u32 v19, v36, v37, v38
    v_max_u32 v19, v19, v39
    v_cmp_eq_u32 vcc, -1, v19
    s_nop 0
    s_cbranch_vccnz g_49F11_3
    v_smfmac_f32_16x16x64_bf16 v[64:67], v[36:39], a[216:223], v172
    v_smfmac_f32_16x16x64_bf16 v[68:71], v[36:39], a[248:255], v172
g_49L3_0:
    s_waitcnt vmcnt(1)
    v_max3_u32 v19, v24, v25, v26
    v_max_u32 v19, v19, v27
    v_cmp_eq_u32 vcc, -1, v19
    s_nop 0
    s_cbranch_vccnz g_49F3_0
    v_smfmac_f32_16x16x64_bf16 v[64:67], v[24:27], a[192:199], v172
    v_smfmac_f32_16x16x64_bf16 v[68:71], v[24:27], a[224:231], v172
g_49L2_1:
    s_waitcnt vmcnt(0)
    v_max3_u32 v19, v28, v29, v30
    v_max_u32 v19, v19, v31
    v_cmp_eq_u32 vcc, -1, v19
    s_nop 0
    s_cbranch_vccnz g_49F2_1
    v_smfmac_f32_16x16x64_bf16 v[64:67], v[28:31], a[200:207], v172
    v_smfmac_f32_16x16x64_bf16 v[68:71], v[28:31], a[232:239], v172
    s_nop 4
    v_cvt_pk_bf16_f32 v80, v64, v65
    v_cvt_pk_bf16_f32 v81, v66, v67
    s_nop 0
    v_cvt_pk_bf16_f32 v82, v68, v69
    v_cvt_pk_bf16_f32 v83, v70, v71
    s_nop 1
    v_mfma_f32_16x16x32_bf16 v[88:91], v[80:83], v[84:87], 0
    s_branch gc_50
g_49L15_3:
    s_waitcnt vmcnt(3)
    v_max3_u32 v19, v36, v37, v38
    v_max_u32 v19, v19, v39
    v_cmp_eq_u32 vcc, -1, v19
    s_nop 0
    s_cbranch_vccnz g_49F15_3
    v_smfmac_f32_16x16x64_bf16 v[64:67], v[36:39], a[216:223], v172
    v_smfmac_f32_16x16x64_bf16 v[68:71], v[36:39], a[248:255], v172
g_49L7_0:
    s_waitcnt vmcnt(2)
    v_max3_u32 v19, v24, v25, v26
    v_max_u32 v19, v19, v27
    v_cmp_eq_u32 vcc, -1, v19
    s_nop 0
    s_cbranch_vccnz g_49F7_0
    v_smfmac_f32_16x16x64_bf16 v[64:67], v[24:27], a[192:199], v172
    v_smfmac_f32_16x16x64_bf16 v[68:71], v[24:27], a[224:231], v172
g_49L6_1:
    s_waitcnt vmcnt(1)
    v_max3_u32 v19, v28, v29, v30
    v_max_u32 v19, v19, v31
    v_cmp_eq_u32 vcc, -1, v19
    s_nop 0
    s_cbranch_vccnz g_49F6_1
    v_smfmac_f32_16x16x64_bf16 v[64:67], v[28:31], a[200:207], v172
    v_smfmac_f32_16x16x64_bf16 v[68:71], v[28:31], a[232:239], v172
g_49L4_2:
    s_waitcnt vmcnt(0)
    v_max3_u32 v19, v32, v33, v34
    v_max_u32 v19, v19, v35
    v_cmp_eq_u32 vcc, -1, v19
    s_nop 0
    s_cbranch_vccnz g_49F4_2
    v_smfmac_f32_16x16x64_bf16 v[64:67], v[32:35], a[208:215], v172
    v_smfmac_f32_16x16x64_bf16 v[68:71], v[32:35], a[240:247], v172
    s_nop 4
    v_cvt_pk_bf16_f32 v80, v64, v65
    v_cvt_pk_bf16_f32 v81, v66, v67
    s_nop 0
    v_cvt_pk_bf16_f32 v82, v68, v69
    v_cvt_pk_bf16_f32 v83, v70, v71
    s_nop 1
    v_mfma_f32_16x16x32_bf16 v[88:91], v[80:83], v[84:87], 0
    s_branch gc_50
g_49L7_1:
    s_waitcnt vmcnt(2)
    v_max3_u32 v19, v28, v29, v30
    v_max_u32 v19, v19, v31
    v_cmp_eq_u32 vcc, -1, v19
    s_nop 0
    s_cbranch_vccnz g_49F7_1
    v_smfmac_f32_16x16x64_bf16 v[64:67], v[28:31], a[200:207], v172
    v_smfmac_f32_16x16x64_bf16 v[68:71], v[28:31], a[232:239], v172
g_49L5_2:
    s_waitcnt vmcnt(1)
    v_max3_u32 v19, v32, v33, v34
    v_max_u32 v19, v19, v35
    v_cmp_eq_u32 vcc, -1, v19
    s_nop 0
    s_cbranch_vccnz g_49F5_2
    v_smfmac_f32_16x16x64_bf16 v[64:67], v[32:35], a[208:215], v172
    v_smfmac_f32_16x16x64_bf16 v[68:71], v[32:35], a[240:247], v172
    s_branch g_49L1_0
g_49L7_2:
    s_waitcnt vmcnt(2)
    v_max3_u32 v19, v32, v33, v34
    v_max_u32 v19, v19, v35
    v_cmp_eq_u32 vcc, -1, v19
    s_nop 0
    s_cbranch_vccnz g_49F7_2
    v_smfmac_f32_16x16x64_bf16 v[64:67], v[32:35], a[208:215], v172
    v_smfmac_f32_16x16x64_bf16 v[68:71], v[32:35], a[240:247], v172
    s_branch g_49L3_0
g_49L11_0:
    s_waitcnt vmcnt(2)
    v_max3_u32 v19, v24, v25, v26
    v_max_u32 v19, v19, v27
    v_cmp_eq_u32 vcc, -1, v19
    s_nop 0
    s_cbranch_vccnz g_49F11_0
    v_smfmac_f32_16x16x64_bf16 v[64:67], v[24:27], a[192:199], v172
    v_smfmac_f32_16x16x64_bf16 v[68:71], v[24:27], a[224:231], v172
g_49L10_1:
    s_waitcnt vmcnt(1)
    v_max3_u32 v19, v28, v29, v30
    v_max_u32 v19, v19, v31
    v_cmp_eq_u32 vcc, -1, v19
    s_nop 0
    s_cbranch_vccnz g_49F10_1
    v_smfmac_f32_16x16x64_bf16 v[64:67], v[28:31], a[200:207], v172
    v_smfmac_f32_16x16x64_bf16 v[68:71], v[28:31], a[232:239], v172
    s_branch g_49L8_3
g_49L11_1:
    s_waitcnt vmcnt(2)
    v_max3_u32 v19, v28, v29, v30
    v_max_u32 v19, v19, v31
    v_cmp_eq_u32 vcc, -1, v19
    s_nop 0
    s_cbranch_vccnz g_49F11_1
    v_smfmac_f32_16x16x64_bf16 v[64:67], v[28:31], a[200:207], v172
    v_smfmac_f32_16x16x64_bf16 v[68:71], v[28:31], a[232:239], v172
    s_branch g_49L9_3
g_49L13_0:
    s_waitcnt vmcnt(2)
    v_max3_u32 v19, v24, v25, v26
    v_max_u32 v19, v19, v27
    v_cmp_eq_u32 vcc, -1, v19
    s_nop 0
    s_cbranch_vccnz g_49F13_0
    v_smfmac_f32_16x16x64_bf16 v[64:67], v[24:27], a[192:199], v172
    v_smfmac_f32_16x16x64_bf16 v[68:71], v[24:27], a[224:231], v172
    s_branch g_49L12_2
g_49L13_3:
    s_waitcnt vmcnt(2)
    v_max3_u32 v19, v36, v37, v38
    v_max_u32 v19, v19, v39
    v_cmp_eq_u32 vcc, -1, v19
    s_nop 0
    s_cbranch_vccnz g_49F13_3
    v_smfmac_f32_16x16x64_bf16 v[64:67], v[36:39], a[216:223], v172
    v_smfmac_f32_16x16x64_bf16 v[68:71], v[36:39], a[248:255], v172
g_49L5_0:
    s_waitcnt vmcnt(1)
    v_max3_u32 v19, v24, v25, v26
    v_max_u32 v19, v19, v27
    v_cmp_eq_u32 vcc, -1, v19
    s_nop 0
    s_cbranch_vccnz g_49F5_0
    v_smfmac_f32_16x16x64_bf16 v[64:67], v[24:27], a[192:199], v172
    v_smfmac_f32_16x16x64_bf16 v[68:71], v[24:27], a[224:231], v172
    s_branch g_49L4_2
g_49L14_2:
    s_waitcnt vmcnt(2)
    v_max3_u32 v19, v32, v33, v34
    v_max_u32 v19, v19, v35
    v_cmp_eq_u32 vcc, -1, v19
    s_nop 0
    s_cbranch_vccnz g_49F14_2
    v_smfmac_f32_16x16x64_bf16 v[64:67], v[32:35], a[208:215], v172
    v_smfmac_f32_16x16x64_bf16 v[68:71], v[32:35], a[240:247], v172
g_49L10_3:
    s_waitcnt vmcnt(1)
    v_max3_u32 v19, v36, v37, v38
    v_max_u32 v19, v19, v39
    v_cmp_eq_u32 vcc, -1, v19
    s_nop 0
    s_cbranch_vccnz g_49F10_3
    v_smfmac_f32_16x16x64_bf16 v[64:67], v[36:39], a[216:223], v172
    v_smfmac_f32_16x16x64_bf16 v[68:71], v[36:39], a[248:255], v172
    s_branch g_49L2_1
g_49L14_3:
    s_waitcnt vmcnt(2)
    v_max3_u32 v19, v36, v37, v38
    v_max_u32 v19, v19, v39
    v_cmp_eq_u32 vcc, -1, v19
    s_nop 0
    s_cbranch_vccnz g_49F14_3
    v_smfmac_f32_16x16x64_bf16 v[64:67], v[36:39], a[216:223], v172
    v_smfmac_f32_16x16x64_bf16 v[68:71], v[36:39], a[248:255], v172
    s_branch g_49L6_1
g_49L3_1:
    s_waitcnt vmcnt(1)
    v_max3_u32 v19, v28, v29, v30
    v_max_u32 v19, v19, v31
    v_cmp_eq_u32 vcc, -1, v19
    s_nop 0
    s_cbranch_vccnz g_49F3_1
    v_smfmac_f32_16x16x64_bf16 v[64:67], v[28:31], a[200:207], v172
    v_smfmac_f32_16x16x64_bf16 v[68:71], v[28:31], a[232:239], v172
    s_branch g_49L1_0
g_49L6_2:
    s_waitcnt vmcnt(1)
    v_max3_u32 v19, v32, v33, v34
    v_max_u32 v19, v19, v35
    v_cmp_eq_u32 vcc, -1, v19
    s_nop 0
    s_cbranch_vccnz g_49F6_2
    v_smfmac_f32_16x16x64_bf16 v[64:67], v[32:35], a[208:215], v172
    v_smfmac_f32_16x16x64_bf16 v[68:71], v[32:35], a[240:247], v172
    s_branch g_49L2_1
g_49L9_0:
    s_waitcnt vmcnt(1)
    v_max3_u32 v19, v24, v25, v26
    v_max_u32 v19, v19, v27
    v_cmp_eq_u32 vcc, -1, v19
    s_nop 0
    s_cbranch_vccnz g_49F9_0
    v_smfmac_f32_16x16x64_bf16 v[64:67], v[24:27], a[192:199], v172
    v_smfmac_f32_16x16x64_bf16 v[68:71], v[24:27], a[224:231], v172
    s_branch g_49L8_3
g_49L12_3:
    s_waitcnt vmcnt(1)
    v_max3_u32 v19, v36, v37, v38
    v_max_u32 v19, v19, v39
    v_cmp_eq_u32 vcc, -1, v19
    s_nop 0
    s_cbranch_vccnz g_49F12_3
    v_smfmac_f32_16x16x64_bf16 v[64:67], v[36:39], a[216:223], v172
    v_smfmac_f32_16x16x64_bf16 v[68:71], v[36:39], a[248:255], v172
    s_branch g_49L4_2
g_49F15_0:
    s_mov_b64 exec, vcc
    buffer_load_dwordx4 v[24:27], v8, s[4:7], s16 offen offset:0 sc1
    s_mov_b64 exec, -1
    s_add_u32 s23, s23, 1
    s_cmp_lt_u32 s23, 200000
    s_cbranch_scc1 g_49L15_1
    s_mov_b32 s25, 200000
    s_branch gc_50
g_49F15_1:
    s_mov_b64 exec, vcc
    buffer_load_dwordx4 v[28:31], v8, s[4:7], s16 offen offset:1024 sc1
    s_mov_b64 exec, -1
    s_add_u32 s23, s23, 1
    s_cmp_lt_u32 s23, 200000
    s_cbranch_scc1 g_49L15_2
    s_mov_b32 s25, 200000
    s_branch gc_50
g_49F15_2:
    s_mov_b64 exec, vcc
    buffer_load_dwordx4 v[32:35], v8, s[4:7], s16 offen offset:2048 sc1
    s_mov_b64 exec, -1
    s_add_u32 s23, s23, 1
    s_cmp_lt_u32 s23, 200000
    s_cbranch_scc1 g_49L15_3
    s_mov_b32 s25, 200000
    s_branch gc_50
g_49F15_3:
    s_mov_b64 exec, vcc
    buffer_load_dwordx4 v[36:39], v8, s[4:7], s16 offen offset:3072 sc1
    s_mov_b64 exec, -1
    s_add_u32 s23, s23, 1
    s_cmp_lt_u32 s23, 200000
    s_cbranch_scc1 g_49L15_0
    s_mov_b32 s25, 200000
    s_branch gc_50
g_49F7_0:
    s_mov_b64 exec, vcc
    buffer_load_dwordx4 v[24:27], v8, s[4:7], s16 offen offset:0 sc1
    s_mov_b64 exec, -1
    s_add_u32 s23, s23, 1
    s_cmp_lt_u32 s23, 200000
    s_cbranch_scc1 g_49L7_1
    s_mov_b32 s25, 200000
    s_branch gc_50
g_49F7_1:
    s_mov_b64 exec, vcc
    buffer_load_dwordx4 v[28:31], v8, s[4:7], s16 offen offset:1024 sc1
    s_mov_b64 exec, -1
    s_add_u32 s23, s23, 1
    s_cmp_lt_u32 s23, 200000
    s_cbranch_scc1 g_49L7_2
    s_mov_b32 s25, 200000
    s_branch gc_50
g_49F7_2:
    s_mov_b64 exec, vcc
    buffer_load_dwordx4 v[32:35], v8, s[4:7], s16 offen offset:2048 sc1
    s_mov_b64 exec, -1
    s_add_u32 s23, s23, 1
    s_cmp_lt_u32 s23, 200000
    s_cbranch_scc1 g_49L7_0
    s_mov_b32 s25, 200000
    s_branch gc_50
g_49F11_0:
    s_mov_b64 exec, vcc
    buffer_load_dwordx4 v[24:27], v8, s[4:7], s16 offen offset:0 sc1
    s_mov_b64 exec, -1
    s_add_u32 s23, s23, 1
    s_cmp_lt_u32 s23, 200000
    s_cbranch_scc1 g_49L11_1
    s_mov_b32 s25, 200000
    s_branch gc_50
g_49F11_1:
    s_mov_b64 exec, vcc
    buffer_load_dwordx4 v[28:31], v8, s[4:7], s16 offen offset:1024 sc1
    s_mov_b64 exec, -1
    s_add_u32 s23, s23, 1
    s_cmp_lt_u32 s23, 200000
    s_cbranch_scc1 g_49L11_3
    s_mov_b32 s25, 200000
    s_branch gc_50
g_49F11_3:
    s_mov_b64 exec, vcc
    buffer_load_dwordx4 v[36:39], v8, s[4:7], s16 offen offset:3072 sc1
    s_mov_b64 exec, -1
    s_add_u32 s23, s23, 1
    s_cmp_lt_u32 s23, 200000
    s_cbranch_scc1 g_49L11_0
    s_mov_b32 s25, 200000
    s_branch gc_50
g_49F13_0:
    s_mov_b64 exec, vcc
    buffer_load_dwordx4 v[24:27], v8, s[4:7], s16 offen offset:0 sc1
    s_mov_b64 exec, -1
    s_add_u32 s23, s23, 1
    s_cmp_lt_u32 s23, 200000
    s_cbranch_scc1 g_49L13_2
    s_mov_b32 s25, 200000
    s_branch gc_50
g_49F13_2:
    s_mov_b64 exec, vcc
    buffer_load_dwordx4 v[32:35], v8, s[4:7], s16 offen offset:2048 sc1
    s_mov_b64 exec, -1
    s_add_u32 s23, s23, 1
    s_cmp_lt_u32 s23, 200000
    s_cbranch_scc1 g_49L13_3
    s_mov_b32 s25, 200000
    s_branch gc_50
g_49F13_3:
    s_mov_b64 exec, vcc
    buffer_load_dwordx4 v[36:39], v8, s[4:7], s16 offen offset:3072 sc1
    s_mov_b64 exec, -1
    s_add_u32 s23, s23, 1
    s_cmp_lt_u32 s23, 200000
    s_cbranch_scc1 g_49L13_0
    s_mov_b32 s25, 200000
    s_branch gc_50
g_49F14_1:
    s_mov_b64 exec, vcc
    buffer_load_dwordx4 v[28:31], v8, s[4:7], s16 offen offset:1024 sc1
    s_mov_b64 exec, -1
    s_add_u32 s23, s23, 1
    s_cmp_lt_u32 s23, 200000
    s_cbranch_scc1 g_49L14_2
    s_mov_b32 s25, 200000
    s_branch gc_50
g_49F14_2:
    s_mov_b64 exec, vcc
    buffer_load_dwordx4 v[32:35], v8, s[4:7], s16 offen offset:2048 sc1
    s_mov_b64 exec, -1
    s_add_u32 s23, s23, 1
    s_cmp_lt_u32 s23, 200000
    s_cbranch_scc1 g_49L14_3
    s_mov_b32 s25, 200000
    s_branch gc_50
g_49F14_3:
    s_mov_b64 exec, vcc
    buffer_load_dwordx4 v[36:39], v8, s[4:7], s16 offen offset:3072 sc1
    s_mov_b64 exec, -1
    s_add_u32 s23, s23, 1
    s_cmp_lt_u32 s23, 200000
    s_cbranch_scc1 g_49L14_1
    s_mov_b32 s25, 200000
    s_branch gc_50
g_49F3_0:
    s_mov_b64 exec, vcc
    buffer_load_dwordx4 v[24:27], v8, s[4:7], s16 offen offset:0 sc1
    s_mov_b64 exec, -1
    s_add_u32 s23, s23, 1
    s_cmp_lt_u32 s23, 200000
    s_cbranch_scc1 g_49L3_1
    s_mov_b32 s25, 200000
    s_branch gc_50
g_49F3_1:
    s_mov_b64 exec, vcc
    buffer_load_dwordx4 v[28:31], v8, s[4:7], s16 offen offset:1024 sc1
    s_mov_b64 exec, -1
    s_add_u32 s23, s23, 1
    s_cmp_lt_u32 s23, 200000
    s_cbranch_scc1 g_49L3_0
    s_mov_b32 s25, 200000
    s_branch gc_50
g_49F5_0:
    s_mov_b64 exec, vcc
    buffer_load_dwordx4 v[24:27], v8, s[4:7], s16 offen offset:0 sc1
    s_mov_b64 exec, -1
    s_add_u32 s23, s23, 1
    s_cmp_lt_u32 s23, 200000
    s_cbranch_scc1 g_49L5_2
    s_mov_b32 s25, 200000
    s_branch gc_50
g_49F5_2:
    s_mov_b64 exec, vcc
    buffer_load_dwordx4 v[32:35], v8, s[4:7], s16 offen offset:2048 sc1
    s_mov_b64 exec, -1
    s_add_u32 s23, s23, 1
    s_cmp_lt_u32 s23, 200000
    s_cbranch_scc1 g_49L5_0
    s_mov_b32 s25, 200000
    s_branch gc_50
g_49F6_1:
    s_mov_b64 exec, vcc
    buffer_load_dwordx4 v[28:31], v8, s[4:7], s16 offen offset:1024 sc1
    s_mov_b64 exec, -1
    s_add_u32 s23, s23, 1
    s_cmp_lt_u32 s23, 200000
    s_cbranch_scc1 g_49L6_2
    s_mov_b32 s25, 200000
    s_branch gc_50
g_49F6_2:
    s_mov_b64 exec, vcc
    buffer_load_dwordx4 v[32:35], v8, s[4:7], s16 offen offset:2048 sc1
    s_mov_b64 exec, -1
    s_add_u32 s23, s23, 1
    s_cmp_lt_u32 s23, 200000
    s_cbranch_scc1 g_49L6_1
    s_mov_b32 s25, 200000
    s_branch gc_50
g_49F9_0:
    s_mov_b64 exec, vcc
    buffer_load_dwordx4 v[24:27], v8, s[4:7], s16 offen offset:0 sc1
    s_mov_b64 exec, -1
    s_add_u32 s23, s23, 1
    s_cmp_lt_u32 s23, 200000
    s_cbranch_scc1 g_49L9_3
    s_mov_b32 s25, 200000
    s_branch gc_50
g_49F9_3:
    s_mov_b64 exec, vcc
    buffer_load_dwordx4 v[36:39], v8, s[4:7], s16 offen offset:3072 sc1
    s_mov_b64 exec, -1
    s_add_u32 s23, s23, 1
    s_cmp_lt_u32 s23, 200000
    s_cbranch_scc1 g_49L9_0
    s_mov_b32 s25, 200000
    s_branch gc_50
g_49F10_1:
    s_mov_b64 exec, vcc
    buffer_load_dwordx4 v[28:31], v8, s[4:7], s16 offen offset:1024 sc1
    s_mov_b64 exec, -1
    s_add_u32 s23, s23, 1
    s_cmp_lt_u32 s23, 200000
    s_cbranch_scc1 g_49L10_3
    s_mov_b32 s25, 200000
    s_branch gc_50
g_49F10_3:
    s_mov_b64 exec, vcc
    buffer_load_dwordx4 v[36:39], v8, s[4:7], s16 offen offset:3072 sc1
    s_mov_b64 exec, -1
    s_add_u32 s23, s23, 1
    s_cmp_lt_u32 s23, 200000
    s_cbranch_scc1 g_49L10_1
    s_mov_b32 s25, 200000
    s_branch gc_50
g_49F12_2:
    s_mov_b64 exec, vcc
    buffer_load_dwordx4 v[32:35], v8, s[4:7], s16 offen offset:2048 sc1
    s_mov_b64 exec, -1
    s_add_u32 s23, s23, 1
    s_cmp_lt_u32 s23, 200000
    s_cbranch_scc1 g_49L12_3
    s_mov_b32 s25, 200000
    s_branch gc_50
g_49F12_3:
    s_mov_b64 exec, vcc
    buffer_load_dwordx4 v[36:39], v8, s[4:7], s16 offen offset:3072 sc1
    s_mov_b64 exec, -1
    s_add_u32 s23, s23, 1
    s_cmp_lt_u32 s23, 200000
    s_cbranch_scc1 g_49L12_2
    s_mov_b32 s25, 200000
    s_branch gc_50
g_49F1_0:
    s_mov_b64 exec, vcc
    buffer_load_dwordx4 v[24:27], v8, s[4:7], s16 offen offset:0 sc1
    s_mov_b64 exec, -1
    s_add_u32 s23, s23, 1
    s_cmp_lt_u32 s23, 200000
    s_cbranch_scc1 g_49L1_0
    s_mov_b32 s25, 200000
    s_branch gc_50
g_49F2_1:
    s_mov_b64 exec, vcc
    buffer_load_dwordx4 v[28:31], v8, s[4:7], s16 offen offset:1024 sc1
    s_mov_b64 exec, -1
    s_add_u32 s23, s23, 1
    s_cmp_lt_u32 s23, 200000
    s_cbranch_scc1 g_49L2_1
    s_mov_b32 s25, 200000
    s_branch gc_50
g_49F4_2:
    s_mov_b64 exec, vcc
    buffer_load_dwordx4 v[32:35], v8, s[4:7], s16 offen offset:2048 sc1
    s_mov_b64 exec, -1
    s_add_u32 s23, s23, 1
    s_cmp_lt_u32 s23, 200000
    s_cbranch_scc1 g_49L4_2
    s_mov_b32 s25, 200000
    s_branch gc_50
g_49F8_3:
    s_mov_b64 exec, vcc
    buffer_load_dwordx4 v[36:39], v8, s[4:7], s16 offen offset:3072 sc1
    s_mov_b64 exec, -1
    s_add_u32 s23, s23, 1
    s_cmp_lt_u32 s23, 200000
    s_cbranch_scc1 g_49L8_3
    s_mov_b32 s25, 200000
    s_branch gc_50
pr_51:
    v_max3_u32 v19, v96, v97, v98
    v_max3_u32 v19, v19, v99, v100
    v_max3_u32 v19, v19, v101, v102
    v_max3_u32 v19, v19, v103, v104
    v_max3_u32 v19, v19, v105, v106
    v_max_u32 v19, v19, v107
    v_cmp_eq_u32 vcc, -1, v19
    s_nop 0
    s_cbranch_vccz pf_55
    buffer_load_dwordx4 v[96:99], v10, s[4:7], s84 offen sc1
    buffer_load_dwordx4 v[100:103], v23, s[4:7], s84 offen sc1
    buffer_load_dwordx4 v[104:107], v244, s[4:7], s84 offen sc1
    s_add_u32 s23, s23, 1
    s_cmp_lt_u32 s23, 200000
    s_cbranch_scc1 pb_53
    s_mov_b32 s25, 200000
pf_55:
    buffer_store_dwordx2 v[180:181], v11, s[4:7], s42 offen
    s_branch pg_52
.p2align 6
recur_slow_w0:
    s_nop 15
    s_mov_b32 s23, s25
g_56:
    buffer_load_dwordx4 v[24:27], v2, s[4:7], s16 offen offset:0 sc1
    buffer_load_dwordx4 v[28:31], v2, s[4:7], s16 offen offset:1024 sc1
    buffer_load_dwordx4 v[32:35], v2, s[4:7], s16 offen offset:2048 sc1
    buffer_load_dwordx4 v[36:39], v2, s[4:7], s16 offen offset:3072 sc1
    s_waitcnt vmcnt(0)
    v_max3_u32 v19, v24, v25, v26
    v_max3_u32 v19, v19, v27, v28
    v_max3_u32 v19, v19, v29, v30
    v_max3_u32 v19, v19, v31, v32
    v_max3_u32 v19, v19, v33, v34
    v_max3_u32 v19, v19, v35, v36
    v_max3_u32 v19, v19, v37, v38
    v_max_u32 v19, v19, v39
    v_cmp_eq_u32 vcc, -1, v19
    s_nop 0
    s_cbranch_vccz g_56k
    s_add_u32 s23, s23, 1
    s_cmp_lt_u32 s23, 200000
    s_cbranch_scc1 g_56
    s_mov_b32 s25, 200000
g_56k:
    v_smfmac_f32_16x16x64_bf16 v[40:43], v[24:27], a[0:7], v172
    v_smfmac_f32_16x16x64_bf16 v[44:47], v[24:27], a[64:71], v172
    v_smfmac_f32_16x16x64_bf16 v[48:51], v[24:27], a[32:39], v172
    v_smfmac_f32_16x16x64_bf16 v[52:55], v[24:27], a[96:103], v172
    v_smfmac_f32_16x16x64_bf16 v[40:43], v[28:31], a[8:15], v172
    v_smfmac_f32_16x16x64_bf16 v[44:47], v[28:31], a[72:79], v172
    v_smfmac_f32_16x16x64_bf16 v[48:51], v[28:31], a[40:47], v172
    v_smfmac_f32_16x16x64_bf16 v[52:55], v[28:31], a[104:111], v172
    v_smfmac_f32_16x16x64_bf16 v[40:43], v[32:35], a[16:23], v172
    v_smfmac_f32_16x16x64_bf16 v[44:47], v[32:35], a[80:87], v172
    v_smfmac_f32_16x16x64_bf16 v[48:51], v[32:35], a[48:55], v172
    v_smfmac_f32_16x16x64_bf16 v[52:55], v[32:35], a[112:119], v172
    v_smfmac_f32_16x16x64_bf16 v[40:43], v[36:39], a[24:31], v172
    v_smfmac_f32_16x16x64_bf16 v[44:47], v[36:39], a[88:95], v172
    v_smfmac_f32_16x16x64_bf16 v[48:51], v[36:39], a[56:63], v172
    v_smfmac_f32_16x16x64_bf16 v[52:55], v[36:39], a[120:127], v172
    v_cvt_pk_bf16_f32 v72, v40, v41
    v_cvt_pk_bf16_f32 v73, v42, v43
    v_cvt_pk_bf16_f32 v74, v44, v45
    v_cvt_pk_bf16_f32 v75, v46, v47
    v_smfmac_f32_16x16x64_bf16 v[56:59], v[24:27], a[128:135], v172
    v_cvt_pk_bf16_f32 v76, v48, v49
    v_cvt_pk_bf16_f32 v77, v50, v51
    s_nop 0
    v_cvt_pk_bf16_f32 v78, v52, v53
    v_cvt_pk_bf16_f32 v79, v54, v55
    v_smfmac_f32_16x16x64_bf16 v[60:63], v[24:27], a[160:167], v172
    v_mfma_f32_16x16x32_bf16 v[88:91], v[72:75], v[84:87], 0
    v_mfma_f32_16x16x32_bf16 v[92:95], v[76:79], v[84:87], 0
    v_smfmac_f32_16x16x64_bf16 v[56:59], v[28:31], a[136:143], v172
    v_smfmac_f32_16x16x64_bf16 v[60:63], v[28:31], a[168:175], v172
    s_barrier
    ds_read_b128 v[104:107], v16 offset:2048
    ds_read_b128 v[108:111], v16 offset:3072
    ds_read_b128 v[112:115], v16 offset:4096
    ds_read_b128 v[116:119], v16 offset:5120
    ds_read_b128 v[120:123], v16 offset:6144
    ds_read_b128 v[124:127], v16 offset:7168
    v_smfmac_f32_16x16x64_bf16 v[56:59], v[32:35], a[144:151], v172
    v_smfmac_f32_16x16x64_bf16 v[60:63], v[32:35], a[176:183], v172
    v_smfmac_f32_16x16x64_bf16 v[56:59], v[36:39], a[152:159], v172
    v_smfmac_f32_16x16x64_bf16 v[60:63], v[36:39], a[184:191], v172
    s_waitcnt lgkmcnt(5)
    v_mfma_f32_16x16x32_bf16 v[88:91], v[104:107], v[84:87], v[88:91]
    s_waitcnt lgkmcnt(4)
    v_mfma_f32_16x16x32_bf16 v[92:95], v[108:111], v[84:87], v[92:95]
    s_waitcnt lgkmcnt(3)
    v_mfma_f32_16x16x32_bf16 v[88:91], v[112:115], v[84:87], v[88:91]
    s_waitcnt lgkmcnt(2)
    v_mfma_f32_16x16x32_bf16 v[92:95], v[116:119], v[84:87], v[92:95]
    s_waitcnt lgkmcnt(1)
    v_mfma_f32_16x16x32_bf16 v[88:91], v[120:123], v[84:87], v[88:91]
    s_waitcnt lgkmcnt(0)
    v_mfma_f32_16x16x32_bf16 v[92:95], v[124:127], v[84:87], v[92:95]
    v_cvt_pk_bf16_f32 v80, v56, v57
    v_cvt_pk_bf16_f32 v81, v58, v59
    v_cvt_pk_bf16_f32 v82, v60, v61
    v_cvt_pk_bf16_f32 v83, v62, v63
    ds_write_b128 v17, v[80:83] offset:8192
    s_nop 0
    v_cvt_pk_bf16_f32 v128, v88, v89
    v_cvt_pk_bf16_f32 v129, v90, v91
    v_cvt_pk_bf16_f32 v130, v92, v93
    v_cvt_pk_bf16_f32 v131, v94, v95
    s_nop 1
    v_mfma_f32_16x16x32_bf16 v[144:147], v[132:135], v[128:131], 0
    v_mfma_f32_16x16x32_bf16 v[148:151], v[136:139], v[128:131], 0
    v_mfma_f32_16x16x32_bf16 v[140:143], v[128:131], v[128:131], 0
    s_nop 1
    buffer_store_dwordx4 v[144:147], v3, s[4:7], s16 offen sc1
    s_nop 1
    buffer_store_dwordx4 v[148:151], v3, s[4:7], s16 offen offset:128 sc1
    s_nop 1
    buffer_store_dwordx4 v[140:143], v4, s[4:7], s16 offen sc1
    s_cmp_eq_u32 s15, 63
    s_waitcnt lgkmcnt(0)
    s_barrier
    s_cbranch_scc1 recur_slow_last0
    v_readfirstlane_b32 s85, v247
    s_add_u32 s94, s15, 2
    s_barrier
    s_nop 15
    s_mov_b32 s23, s25
g_57:
    buffer_load_dwordx4 v[24:27], v8, s[4:7], s16 offen offset:0 sc1
    buffer_load_dwordx4 v[28:31], v8, s[4:7], s16 offen offset:1024 sc1
    buffer_load_dwordx4 v[32:35], v8, s[4:7], s16 offen offset:2048 sc1
    buffer_load_dwordx4 v[36:39], v8, s[4:7], s16 offen offset:3072 sc1
    s_waitcnt vmcnt(0)
    v_max3_u32 v19, v24, v25, v26
    v_max3_u32 v19, v19, v27, v28
    v_max3_u32 v19, v19, v29, v30
    v_max3_u32 v19, v19, v31, v32
    v_max3_u32 v19, v19, v33, v34
    v_max3_u32 v19, v19, v35, v36
    v_max3_u32 v19, v19, v37, v38
    v_max_u32 v19, v19, v39
    v_cmp_eq_u32 vcc, -1, v19
    s_nop 0
    s_cbranch_vccz g_57k
    s_add_u32 s23, s23, 1
    s_cmp_lt_u32 s23, 200000
    s_cbranch_scc1 g_57
    s_mov_b32 s25, 200000
g_57k:
    v_smfmac_f32_16x16x64_bf16 v[64:67], v[24:27], a[192:199], v172
    v_smfmac_f32_16x16x64_bf16 v[68:71], v[24:27], a[224:231], v172
    v_smfmac_f32_16x16x64_bf16 v[64:67], v[28:31], a[200:207], v172
    v_smfmac_f32_16x16x64_bf16 v[68:71], v[28:31], a[232:239], v172
    v_smfmac_f32_16x16x64_bf16 v[64:67], v[32:35], a[208:215], v172
    v_smfmac_f32_16x16x64_bf16 v[68:71], v[32:35], a[240:247], v172
    v_smfmac_f32_16x16x64_bf16 v[64:67], v[36:39], a[216:223], v172
    v_smfmac_f32_16x16x64_bf16 v[68:71], v[36:39], a[248:255], v172
    s_nop 4
    v_cvt_pk_bf16_f32 v80, v64, v65
    v_cvt_pk_bf16_f32 v81, v66, v67
    s_nop 0
    v_cvt_pk_bf16_f32 v82, v68, v69
    v_cvt_pk_bf16_f32 v83, v70, v71
    ds_write_b128 v17, v[80:83] offset:9216
    s_waitcnt lgkmcnt(0)
    s_barrier
    s_mov_b32 s23, s25
fw_58:
    s_cmp_ge_u32 s85, s94
    s_cbranch_scc1 fo_59
    buffer_load_dword v247, v245, s[4:7], 0 offen sc1
    s_add_u32 s23, s23, 1
    s_waitcnt vmcnt(0)
    v_readfirstlane_b32 s85, v247
    s_cmp_lt_u32 s23, 200000
    s_cbranch_scc1 fw_58
    s_mov_b32 s25, 200000
fo_59:
    buffer_load_dwordx4 v[132:135], v12, s[4:7], s17 offen sc1
    buffer_load_dwordx4 v[136:139], v12, s[4:7], s17 offen offset:256 sc1
    s_add_u32 s17, s17, 2048
    s_min_u32 s17, s17, 17954816
    s_nop 15
    s_nop 15
    s_nop 15
    s_nop 15
    buffer_store_dwordx4 v[128:131], v14, s[4:7], s19 offen sc1
    s_add_u32 s19, s19, 512
    s_add_u32 s21, s15, 3
    s_min_u32 s21, s21, 64
    s_cmp_lt_u32 s85, s21
    s_cselect_b64 exec, 1, 0
    buffer_load_dword v247, v245, s[4:7], 0 offen sc1
    s_mov_b64 exec, -1
    v_mov_b32 v40, 0
    v_mov_b32 v41, 0
    v_mov_b32 v42, 0
    v_mov_b32 v43, 0
    v_mov_b32 v44, 0
    v_mov_b32 v45, 0
    v_mov_b32 v46, 0
    v_mov_b32 v47, 0
    v_mov_b32 v48, 0
    v_mov_b32 v49, 0
    v_mov_b32 v50, 0
    v_mov_b32 v51, 0
    v_mov_b32 v52, 0
    v_mov_b32 v53, 0
    v_mov_b32 v54, 0
    v_mov_b32 v55, 0
    v_mov_b32 v56, 0
    v_mov_b32 v57, 0
    v_mov_b32 v58, 0
    v_mov_b32 v59, 0
    v_mov_b32 v60, 0
    v_mov_b32 v61, 0
    v_mov_b32 v62, 0
    v_mov_b32 v63, 0
    v_mov_b32 v64, 0
    v_mov_b32 v65, 0
    v_mov_b32 v66, 0
    v_mov_b32 v67, 0
    v_mov_b32 v68, 0
    v_mov_b32 v69, 0
    v_mov_b32 v70, 0
    v_mov_b32 v71, 0
    s_mov_b32 s21, s16
    s_mov_b32 s16, s42
    s_mov_b32 s42, s43
    s_mov_b32 s43, s44
    s_mov_b32 s44, s21
    s_add_u32 s95, s95, 524288
    s_lshr_b32 s84, s95, 8
    s_and_b32 s84, s84, 8192
    s_xor_b32 s84, s84, s46
    s_add_u32 s84, s84, s95
    s_add_u32 s15, s15, 1
    s_barrier
    s_branch recur_slow_w0
recur_slow_last0:
    buffer_store_dwordx4 v[128:131], v14, s[4:7], s19 offen sc1
    s_waitcnt vmcnt(0)
    s_branch recur_end
.p2align 6
recur_slow_w1:
    s_nop 15
    s_mov_b32 s23, s25
g_60:
    buffer_load_dwordx4 v[24:27], v2, s[4:7], s16 offen offset:0 sc1
    buffer_load_dwordx4 v[28:31], v2, s[4:7], s16 offen offset:1024 sc1
    buffer_load_dwordx4 v[32:35], v2, s[4:7], s16 offen offset:2048 sc1
    buffer_load_dwordx4 v[36:39], v2, s[4:7], s16 offen offset:3072 sc1
    s_waitcnt vmcnt(0)
    v_max3_u32 v19, v24, v25, v26
    v_max3_u32 v19, v19, v27, v28
    v_max3_u32 v19, v19, v29, v30
    v_max3_u32 v19, v19, v31, v32
    v_max3_u32 v19, v19, v33, v34
    v_max3_u32 v19, v19, v35, v36
    v_max3_u32 v19, v19, v37, v38
    v_max_u32 v19, v19, v39
    v_cmp_eq_u32 vcc, -1, v19
    s_nop 0
    s_cbranch_vccz g_60k
    s_add_u32 s23, s23, 1
    s_cmp_lt_u32 s23, 200000
    s_cbranch_scc1 g_60
    s_mov_b32 s25, 200000
g_60k:
    v_smfmac_f32_16x16x64_bf16 v[40:43], v[24:27], a[0:7], v172
    v_smfmac_f32_16x16x64_bf16 v[44:47], v[24:27], a[64:71], v172
    v_smfmac_f32_16x16x64_bf16 v[48:51], v[24:27], a[32:39], v172
    v_smfmac_f32_16x16x64_bf16 v[52:55], v[24:27], a[96:103], v172
    v_smfmac_f32_16x16x64_bf16 v[40:43], v[28:31], a[8:15], v172
    v_smfmac_f32_16x16x64_bf16 v[44:47], v[28:31], a[72:79], v172
    v_smfmac_f32_16x16x64_bf16 v[48:51], v[28:31], a[40:47], v172
    v_smfmac_f32_16x16x64_bf16 v[52:55], v[28:31], a[104:111], v172
    v_smfmac_f32_16x16x64_bf16 v[40:43], v[32:35], a[16:23], v172
    v_smfmac_f32_16x16x64_bf16 v[44:47], v[32:35], a[80:87], v172
    v_smfmac_f32_16x16x64_bf16 v[48:51], v[32:35], a[48:55], v172
    v_smfmac_f32_16x16x64_bf16 v[52:55], v[32:35], a[112:119], v172
    v_smfmac_f32_16x16x64_bf16 v[40:43], v[36:39], a[24:31], v172
    v_smfmac_f32_16x16x64_bf16 v[44:47], v[36:39], a[88:95], v172
    v_smfmac_f32_16x16x64_bf16 v[48:51], v[36:39], a[56:63], v172
    v_smfmac_f32_16x16x64_bf16 v[52:55], v[36:39], a[120:127], v172
    v_cvt_pk_bf16_f32 v72, v40, v41
    v_cvt_pk_bf16_f32 v73, v42, v43
    v_cvt_pk_bf16_f32 v74, v44, v45
    v_cvt_pk_bf16_f32 v75, v46, v47
    ds_write_b128 v17, v[72:75] offset:0
    v_cvt_pk_bf16_f32 v76, v48, v49
    v_cvt_pk_bf16_f32 v77, v50, v51
    s_nop 0
    v_cvt_pk_bf16_f32 v78, v52, v53
    v_cvt_pk_bf16_f32 v79, v54, v55
    ds_write_b128 v17, v[76:79] offset:1024
    v_smfmac_f32_16x16x64_bf16 v[56:59], v[24:27], a[128:135], v172
    v_smfmac_f32_16x16x64_bf16 v[60:63], v[24:27], a[160:167], v172
    v_smfmac_f32_16x16x64_bf16 v[56:59], v[28:31], a[136:143], v172
    s_waitcnt lgkmcnt(0)
    s_barrier
    v_smfmac_f32_16x16x64_bf16 v[60:63], v[28:31], a[168:175], v172
    v_smfmac_f32_16x16x64_bf16 v[56:59], v[32:35], a[144:151], v172
    v_smfmac_f32_16x16x64_bf16 v[60:63], v[32:35], a[176:183], v172
    v_smfmac_f32_16x16x64_bf16 v[56:59], v[36:39], a[152:159], v172
    v_smfmac_f32_16x16x64_bf16 v[60:63], v[36:39], a[184:191], v172
    s_nop 4
    v_cvt_pk_bf16_f32 v80, v56, v57
    v_cvt_pk_bf16_f32 v81, v58, v59
    s_nop 0
    v_cvt_pk_bf16_f32 v82, v60, v61
    v_cvt_pk_bf16_f32 v83, v62, v63
    ds_write_b128 v17, v[80:83] offset:8192
    v_mov_b32 v152, v228
    v_mov_b32 v153, v229
    v_mov_b32 v156, v230
    v_mov_b32 v157, v231
    v_mov_b32 v160, v232
    v_mov_b32 v161, v233
    v_mov_b32 v164, v234
    v_mov_b32 v165, v235
    s_cmp_eq_u32 s15, 63
    s_waitcnt lgkmcnt(0)
    s_barrier
    s_cbranch_scc1 recur_end
    s_nop 15
    s_nop 15
    s_nop 7
    buffer_load_dwordx4 v[208:211], v5, s[4:7], s16 offen offset:0 sc1
    buffer_load_dwordx4 v[212:215], v5, s[4:7], s16 offen offset:1024 sc1
    buffer_load_dwordx4 v[216:219], v5, s[4:7], s16 offen offset:2048 sc1
    buffer_load_dwordx4 v[220:223], v5, s[4:7], s16 offen offset:3072 sc1
    buffer_load_dword v224, v6, s[4:7], s16 offen offset:0 sc1
    buffer_load_dword v225, v6, s[4:7], s16 offen offset:256 sc1
    buffer_load_dword v226, v6, s[4:7], s16 offen offset:512 sc1
    buffer_load_dword v227, v6, s[4:7], s16 offen offset:768 sc1
    s_mov_b32 s23, s25
    ds_read_b128 v[96:99], v16 offset:8192
    ds_read_b128 v[104:107], v16 offset:12288
    ds_read_b128 v[108:111], v16 offset:14336
    v_mfma_f32_16x16x32_bf16 v[140:143], v[84:87], v[80:83], 0
    s_waitcnt lgkmcnt(2)
    v_mfma_f32_16x16x32_bf16 v[140:143], v[84:87], v[96:99], v[140:143]
    s_waitcnt lgkmcnt(1)
    v_mfma_f32_16x16x32_bf16 v[140:143], v[84:87], v[104:107], v[140:143]
    s_waitcnt lgkmcnt(0)
    v_mfma_f32_16x16x32_bf16 v[140:143], v[84:87], v[108:111], v[140:143]
    buffer_load_dwordx4 v[24:27], v5, s[4:7], s16 offen offset:0 sc1
    buffer_load_dwordx4 v[28:31], v5, s[4:7], s16 offen offset:1024 sc1
    buffer_load_dwordx4 v[32:35], v5, s[4:7], s16 offen offset:2048 sc1
    buffer_load_dwordx4 v[36:39], v5, s[4:7], s16 offen offset:3072 sc1
    buffer_load_dword v40, v6, s[4:7], s16 offen offset:0 sc1
    buffer_load_dword v41, v6, s[4:7], s16 offen offset:256 sc1
    buffer_load_dword v42, v6, s[4:7], s16 offen offset:512 sc1
    buffer_load_dword v43, v6, s[4:7], s16 offen offset:768 sc1
    v_cvt_pk_bf16_f32 v154, v140, v179
    v_cvt_pk_bf16_f32 v158, v141, v179
    v_cvt_pk_bf16_f32 v162, v142, v179
    v_cvt_pk_bf16_f32 v166, v143, v179
    s_waitcnt vmcnt(14)
    v_pk_add_f32 v[180:181], v[208:209], v[212:213]
    v_pk_add_f32 v[182:183], v[210:211], v[214:215]
    s_waitcnt vmcnt(12)
    v_pk_add_f32 v[188:189], v[216:217], v[220:221]
    v_pk_add_f32 v[190:191], v[218:219], v[222:223]
    v_pk_add_f32 v[180:181], v[180:181], v[188:189]
    v_pk_add_f32 v[182:183], v[182:183], v[190:191]
    v_pk_add_f32 v[188:189], v[180:181], v[182:183]
    v_max3_f32 v185, v180, v181, v182
    s_waitcnt vmcnt(8)
    v_pk_add_f32 v[192:193], v[224:225], v[226:227]
    v_add_f32 v188, v188, v189
    v_add_f32 v184, v192, v193
    v_max3_f32 v185, v185, v183, v184
    v_cmp_u_f32 vcc, v188, v184
    s_nop 0
    v_max_f32_dpp v185, v185, v185 row_ror:8 row_mask:0xf bank_mask:0xf
    v_mov_b32 v186, v185
    s_nop 1
    v_permlane16_swap_b32 v185, v186
    v_max_f32 v185, v185, v186
    v_mov_b32 v186, v185
    s_cbranch_vccnz ss_61
sg_63:
    s_nop 0
    v_permlane32_swap_b32 v185, v186
    v_max_f32 v185, v185, v186
    v_mul_f32 v185, s24, v185
    v_fma_f32 v180, v180, s24, -v185
    v_fma_f32 v181, v181, s24, -v185
    v_fma_f32 v182, v182, s24, -v185
    v_fma_f32 v183, v183, s24, -v185
    v_fma_f32 v184, v184, s24, -v185
    v_exp_f32 v180, v180
    v_exp_f32 v181, v181
    v_exp_f32 v182, v182
    v_exp_f32 v183, v183
    v_exp_f32 v184, v184
    v_cvt_pk_bf16_f32 v176, v180, v181
    v_cvt_pk_bf16_f32 v177, v182, v183
    v_cvt_pk_bf16_f32 v178, v184, v179
    s_nop 1
    v_mfma_f32_16x16x32_bf16 v[240:243], v[236:239], v[176:179], 0
    v_mfma_f32_16x16x32_bf16 v[188:191], v[152:155], v[176:179], 0
    v_mfma_f32_16x16x32_bf16 v[192:195], v[156:159], v[176:179], 0
    v_mfma_f32_16x16x32_bf16 v[196:199], v[160:163], v[176:179], 0
    v_mfma_f32_16x16x32_bf16 v[200:203], v[164:167], v[176:179], 0
    v_add_f32_dpp v185, v240, v240 row_ror:8 row_mask:0xf bank_mask:0xf
    v_rcp_f32 v185, v185
    v_add_f32_dpp v88, v192, v188 row_ror:8 row_mask:0xf bank_mask:0x3
    v_add_f32_dpp v89, v193, v189 row_ror:8 row_mask:0xf bank_mask:0x3
    v_add_f32_dpp v90, v194, v190 row_ror:8 row_mask:0xf bank_mask:0x3
    v_add_f32_dpp v91, v195, v191 row_ror:8 row_mask:0xf bank_mask:0x3
    s_nop 1
    v_add_f32_dpp v88, v196, v200 row_ror:8 row_mask:0xf bank_mask:0xc
    v_add_f32_dpp v89, v197, v201 row_ror:8 row_mask:0xf bank_mask:0xc
    v_add_f32_dpp v90, v198, v202 row_ror:8 row_mask:0xf bank_mask:0xc
    v_add_f32_dpp v91, v199, v203 row_ror:8 row_mask:0xf bank_mask:0xc
    v_mul_f32 v88, v88, v185
    v_mul_f32 v89, v89, v185
    v_mul_f32 v90, v90, v185
    v_mul_f32 v91, v91, v185
    v_cvt_pk_bf16_f32 v88, v88, v89
    v_cvt_pk_bf16_f32 v89, v90, v91
    buffer_store_dwordx2 v[88:89], v7, s[4:7], s16 offen sc1
    v_readfirstlane_b32 s85, v247
    s_add_u32 s94, s15, 2
    s_barrier
    s_nop 15
    s_mov_b32 s23, s25
g_64:
    buffer_load_dwordx4 v[24:27], v8, s[4:7], s16 offen offset:0 sc1
    buffer_load_dwordx4 v[28:31], v8, s[4:7], s16 offen offset:1024 sc1
    buffer_load_dwordx4 v[32:35], v8, s[4:7], s16 offen offset:2048 sc1
    buffer_load_dwordx4 v[36:39], v8, s[4:7], s16 offen offset:3072 sc1
    s_waitcnt vmcnt(0)
    v_max3_u32 v19, v24, v25, v26
    v_max3_u32 v19, v19, v27, v28
    v_max3_u32 v19, v19, v29, v30
    v_max3_u32 v19, v19, v31, v32
    v_max3_u32 v19, v19, v33, v34
    v_max3_u32 v19, v19, v35, v36
    v_max3_u32 v19, v19, v37, v38
    v_max_u32 v19, v19, v39
    v_cmp_eq_u32 vcc, -1, v19
    s_nop 0
    s_cbranch_vccz g_64k
    s_add_u32 s23, s23, 1
    s_cmp_lt_u32 s23, 200000
    s_cbranch_scc1 g_64
    s_mov_b32 s25, 200000
g_64k:
    v_smfmac_f32_16x16x64_bf16 v[64:67], v[24:27], a[192:199], v172
    v_smfmac_f32_16x16x64_bf16 v[68:71], v[24:27], a[224:231], v172
    v_smfmac_f32_16x16x64_bf16 v[64:67], v[28:31], a[200:207], v172
    v_smfmac_f32_16x16x64_bf16 v[68:71], v[28:31], a[232:239], v172
    v_smfmac_f32_16x16x64_bf16 v[64:67], v[32:35], a[208:215], v172
    v_smfmac_f32_16x16x64_bf16 v[68:71], v[32:35], a[240:247], v172
    v_smfmac_f32_16x16x64_bf16 v[64:67], v[36:39], a[216:223], v172
    v_smfmac_f32_16x16x64_bf16 v[68:71], v[36:39], a[248:255], v172
    s_nop 4
    v_cvt_pk_bf16_f32 v80, v64, v65
    v_cvt_pk_bf16_f32 v81, v66, v67
    s_nop 0
    v_cvt_pk_bf16_f32 v82, v68, v69
    v_cvt_pk_bf16_f32 v83, v70, v71
    ds_write_b128 v17, v[80:83] offset:9216
    s_waitcnt lgkmcnt(0)
    s_barrier
    s_mov_b32 s23, s25
fw_65:
    s_cmp_ge_u32 s85, s94
    s_cbranch_scc1 fo_66
    buffer_load_dword v247, v245, s[4:7], 0 offen sc1
    s_add_u32 s23, s23, 1
    s_waitcnt vmcnt(0)
    v_readfirstlane_b32 s85, v247
    s_cmp_lt_u32 s23, 200000
    s_cbranch_scc1 fw_65
    s_mov_b32 s25, 200000
fo_66:
    buffer_load_dwordx4 v[228:231], v13, s[4:7], s18 offen offset:0 sc1
    buffer_load_dwordx4 v[232:235], v13, s[4:7], s18 offen offset:256 sc1
    s_add_u32 s18, s18, 2048
    s_min_u32 s18, s18, 35780608
    s_nop 15
    s_nop 15
    s_nop 15
    s_nop 15
    s_add_u32 s21, s15, 3
    s_min_u32 s21, s21, 64
    s_cmp_lt_u32 s85, s21
    s_cselect_b64 exec, 1, 0
    buffer_load_dword v247, v245, s[4:7], 0 offen sc1
    s_mov_b64 exec, -1
    v_mov_b32 v40, 0
    v_mov_b32 v41, 0
    v_mov_b32 v42, 0
    v_mov_b32 v43, 0
    v_mov_b32 v44, 0
    v_mov_b32 v45, 0
    v_mov_b32 v46, 0
    v_mov_b32 v47, 0
    v_mov_b32 v48, 0
    v_mov_b32 v49, 0
    v_mov_b32 v50, 0
    v_mov_b32 v51, 0
    v_mov_b32 v52, 0
    v_mov_b32 v53, 0
    v_mov_b32 v54, 0
    v_mov_b32 v55, 0
    v_mov_b32 v56, 0
    v_mov_b32 v57, 0
    v_mov_b32 v58, 0
    v_mov_b32 v59, 0
    v_mov_b32 v60, 0
    v_mov_b32 v61, 0
    v_mov_b32 v62, 0
    v_mov_b32 v63, 0
    v_mov_b32 v64, 0
    v_mov_b32 v65, 0
    v_mov_b32 v66, 0
    v_mov_b32 v67, 0
    v_mov_b32 v68, 0
    v_mov_b32 v69, 0
    v_mov_b32 v70, 0
    v_mov_b32 v71, 0
    s_mov_b32 s21, s16
    s_mov_b32 s16, s42
    s_mov_b32 s42, s43
    s_mov_b32 s43, s44
    s_mov_b32 s44, s21
    s_add_u32 s95, s95, 524288
    s_lshr_b32 s84, s95, 8
    s_and_b32 s84, s84, 8192
    s_xor_b32 s84, s84, s46
    s_add_u32 s84, s84, s95
    s_add_u32 s15, s15, 1
    s_barrier
    s_branch recur_slow_w1
sb_62:
    v_max3_u32 v19, v24, v25, v26
    v_max3_u32 v19, v19, v27, v28
    v_max3_u32 v19, v19, v29, v30
    v_max3_u32 v19, v19, v31, v32
    v_max3_u32 v19, v19, v33, v34
    v_max3_u32 v19, v19, v35, v36
    v_max3_u32 v19, v19, v37, v38
    v_max3_u32 v19, v19, v39, v40
    v_max3_u32 v19, v19, v41, v42
    v_max_u32 v19, v19, v43
    v_cmp_eq_u32 vcc, -1, v19
    s_nop 0
    s_cbranch_vccz sg_63
    buffer_load_dwordx4 v[24:27], v5, s[4:7], s16 offen offset:0 sc1
    buffer_load_dwordx4 v[28:31], v5, s[4:7], s16 offen offset:1024 sc1
    buffer_load_dwordx4 v[32:35], v5, s[4:7], s16 offen offset:2048 sc1
    buffer_load_dwordx4 v[36:39], v5, s[4:7], s16 offen offset:3072 sc1
    buffer_load_dword v40, v6, s[4:7], s16 offen offset:0 sc1
    buffer_load_dword v41, v6, s[4:7], s16 offen offset:256 sc1
    buffer_load_dword v42, v6, s[4:7], s16 offen offset:512 sc1
    buffer_load_dword v43, v6, s[4:7], s16 offen offset:768 sc1
    s_add_u32 s23, s23, 1
    s_cmp_lt_u32 s23, 200000
    s_cbranch_scc1 ss_61
    s_mov_b32 s25, 200000
    s_branch sg_63
ss_61:
    s_waitcnt vmcnt(6)
    v_pk_add_f32 v[180:181], v[24:25], v[28:29]
    v_pk_add_f32 v[182:183], v[26:27], v[30:31]
    s_waitcnt vmcnt(4)
    v_pk_add_f32 v[188:189], v[32:33], v[36:37]
    v_pk_add_f32 v[190:191], v[34:35], v[38:39]
    v_pk_add_f32 v[180:181], v[180:181], v[188:189]
    v_pk_add_f32 v[182:183], v[182:183], v[190:191]
    v_pk_add_f32 v[188:189], v[180:181], v[182:183]
    v_max3_f32 v185, v180, v181, v182
    s_waitcnt vmcnt(0)
    v_pk_add_f32 v[192:193], v[40:41], v[42:43]
    v_add_f32 v188, v188, v189
    v_add_f32 v184, v192, v193
    v_max3_f32 v185, v185, v183, v184
    v_cmp_u_f32 vcc, v188, v184
    s_nop 0
    v_max_f32_dpp v185, v185, v185 row_ror:8 row_mask:0xf bank_mask:0xf
    v_mov_b32 v186, v185
    s_nop 1
    v_permlane16_swap_b32 v185, v186
    v_max_f32 v185, v185, v186
    v_mov_b32 v186, v185
    s_cbranch_vccnz sb_62
    s_branch sg_63
.p2align 6
recur_slow_w2:
    s_nop 15
    s_mov_b32 s23, s25
g_67:
    buffer_load_dwordx4 v[24:27], v2, s[4:7], s16 offen offset:0 sc1
    buffer_load_dwordx4 v[28:31], v2, s[4:7], s16 offen offset:1024 sc1
    buffer_load_dwordx4 v[32:35], v2, s[4:7], s16 offen offset:2048 sc1
    buffer_load_dwordx4 v[36:39], v2, s[4:7], s16 offen offset:3072 sc1
    s_waitcnt vmcnt(0)
    v_max3_u32 v19, v24, v25, v26
    v_max3_u32 v19, v19, v27, v28
    v_max3_u32 v19, v19, v29, v30
    v_max3_u32 v19, v19, v31, v32
    v_max3_u32 v19, v19, v33, v34
    v_max3_u32 v19, v19, v35, v36
    v_max3_u32 v19, v19, v37, v38
    v_max_u32 v19, v19, v39
    v_cmp_eq_u32 vcc, -1, v19
    s_nop 0
    s_cbranch_vccz g_67k
    s_add_u32 s23, s23, 1
    s_cmp_lt_u32 s23, 200000
    s_cbranch_scc1 g_67
    s_mov_b32 s25, 200000
g_67k:
    v_smfmac_f32_16x16x64_bf16 v[40:43], v[24:27], a[0:7], v172
    v_smfmac_f32_16x16x64_bf16 v[44:47], v[24:27], a[64:71], v172
    v_smfmac_f32_16x16x64_bf16 v[48:51], v[24:27], a[32:39], v172
    v_smfmac_f32_16x16x64_bf16 v[52:55], v[24:27], a[96:103], v172
    v_smfmac_f32_16x16x64_bf16 v[40:43], v[28:31], a[8:15], v172
    v_smfmac_f32_16x16x64_bf16 v[44:47], v[28:31], a[72:79], v172
    v_smfmac_f32_16x16x64_bf16 v[48:51], v[28:31], a[40:47], v172
    v_smfmac_f32_16x16x64_bf16 v[52:55], v[28:31], a[104:111], v172
    v_smfmac_f32_16x16x64_bf16 v[40:43], v[32:35], a[16:23], v172
    v_smfmac_f32_16x16x64_bf16 v[44:47], v[32:35], a[80:87], v172
    v_smfmac_f32_16x16x64_bf16 v[48:51], v[32:35], a[48:55], v172
    v_smfmac_f32_16x16x64_bf16 v[52:55], v[32:35], a[112:119], v172
    v_smfmac_f32_16x16x64_bf16 v[40:43], v[36:39], a[24:31], v172
    v_smfmac_f32_16x16x64_bf16 v[44:47], v[36:39], a[88:95], v172
    v_smfmac_f32_16x16x64_bf16 v[48:51], v[36:39], a[56:63], v172
    v_smfmac_f32_16x16x64_bf16 v[52:55], v[36:39], a[120:127], v172
    v_cvt_pk_bf16_f32 v72, v40, v41
    v_cvt_pk_bf16_f32 v73, v42, v43
    v_cvt_pk_bf16_f32 v74, v44, v45
    v_cvt_pk_bf16_f32 v75, v46, v47
    ds_write_b128 v17, v[72:75] offset:0
    v_cvt_pk_bf16_f32 v76, v48, v49
    v_cvt_pk_bf16_f32 v77, v50, v51
    s_nop 0
    v_cvt_pk_bf16_f32 v78, v52, v53
    v_cvt_pk_bf16_f32 v79, v54, v55
    ds_write_b128 v17, v[76:79] offset:1024
    v_smfmac_f32_16x16x64_bf16 v[56:59], v[24:27], a[128:135], v172
    v_smfmac_f32_16x16x64_bf16 v[60:63], v[24:27], a[160:167], v172
    v_smfmac_f32_16x16x64_bf16 v[56:59], v[28:31], a[136:143], v172
    s_waitcnt lgkmcnt(0)
    s_barrier
    v_smfmac_f32_16x16x64_bf16 v[60:63], v[28:31], a[168:175], v172
    v_smfmac_f32_16x16x64_bf16 v[56:59], v[32:35], a[144:151], v172
    v_smfmac_f32_16x16x64_bf16 v[60:63], v[32:35], a[176:183], v172
    v_smfmac_f32_16x16x64_bf16 v[56:59], v[36:39], a[152:159], v172
    v_smfmac_f32_16x16x64_bf16 v[60:63], v[36:39], a[184:191], v172
    s_nop 4
    v_cvt_pk_bf16_f32 v80, v56, v57
    v_cvt_pk_bf16_f32 v81, v58, v59
    s_nop 0
    v_cvt_pk_bf16_f32 v82, v60, v61
    v_cvt_pk_bf16_f32 v83, v62, v63
    ds_write_b128 v17, v[80:83] offset:8192
    s_cmp_eq_u32 s15, 63
    s_waitcnt lgkmcnt(0)
    s_barrier
    ds_read_b128 v[96:99], v16 offset:8192
    ds_read_b128 v[100:103], v16 offset:10240
    ds_read_b128 v[108:111], v16 offset:14336
    v_mfma_f32_16x16x32_bf16 v[140:143], v[84:87], v[80:83], 0
    s_waitcnt lgkmcnt(2)
    v_mfma_f32_16x16x32_bf16 v[140:143], v[84:87], v[96:99], v[140:143]
    s_waitcnt lgkmcnt(1)
    v_mfma_f32_16x16x32_bf16 v[140:143], v[84:87], v[100:103], v[140:143]
    s_waitcnt lgkmcnt(0)
    v_mfma_f32_16x16x32_bf16 v[140:143], v[84:87], v[108:111], v[140:143]
    s_nop 7
    v_cvt_pk_bf16_f32 v168, v140, v141
    v_cvt_pk_bf16_f32 v169, v142, v143
    v_mov_b32 v170, v168
    v_mov_b32 v171, v169
    s_nop 0
    v_permlane16_swap_b32 v168, v170
    v_permlane16_swap_b32 v169, v171
    v_mov_b32 v247, s15
    s_cbranch_scc1 recur_slow_last2
    s_barrier
    s_nop 15
    s_mov_b32 s23, s25
g_68:
    buffer_load_dwordx4 v[24:27], v8, s[4:7], s16 offen offset:0 sc1
    buffer_load_dwordx4 v[28:31], v8, s[4:7], s16 offen offset:1024 sc1
    buffer_load_dwordx4 v[32:35], v8, s[4:7], s16 offen offset:2048 sc1
    buffer_load_dwordx4 v[36:39], v8, s[4:7], s16 offen offset:3072 sc1
    s_waitcnt vmcnt(0)
    v_max3_u32 v19, v24, v25, v26
    v_max3_u32 v19, v19, v27, v28
    v_max3_u32 v19, v19, v29, v30
    v_max3_u32 v19, v19, v31, v32
    v_max3_u32 v19, v19, v33, v34
    v_max3_u32 v19, v19, v35, v36
    v_max3_u32 v19, v19, v37, v38
    v_max_u32 v19, v19, v39
    v_cmp_eq_u32 vcc, -1, v19
    s_nop 0
    s_cbranch_vccz g_68k
    s_add_u32 s23, s23, 1
    s_cmp_lt_u32 s23, 200000
    s_cbranch_scc1 g_68
    s_mov_b32 s25, 200000
g_68k:
    v_smfmac_f32_16x16x64_bf16 v[64:67], v[24:27], a[192:199], v172
    v_smfmac_f32_16x16x64_bf16 v[68:71], v[24:27], a[224:231], v172
    v_smfmac_f32_16x16x64_bf16 v[64:67], v[28:31], a[200:207], v172
    v_smfmac_f32_16x16x64_bf16 v[68:71], v[28:31], a[232:239], v172
    v_smfmac_f32_16x16x64_bf16 v[64:67], v[32:35], a[208:215], v172
    v_smfmac_f32_16x16x64_bf16 v[68:71], v[32:35], a[240:247], v172
    v_smfmac_f32_16x16x64_bf16 v[64:67], v[36:39], a[216:223], v172
    v_smfmac_f32_16x16x64_bf16 v[68:71], v[36:39], a[248:255], v172
    s_nop 4
    v_cvt_pk_bf16_f32 v80, v64, v65
    v_cvt_pk_bf16_f32 v81, v66, v67
    s_nop 0
    v_cvt_pk_bf16_f32 v82, v68, v69
    v_cvt_pk_bf16_f32 v83, v70, v71
    ds_write_b128 v17, v[80:83] offset:9216
    s_waitcnt lgkmcnt(0)
    s_barrier
    s_nop 15
    s_nop 15
    s_nop 15
    s_nop 15
    buffer_store_dwordx4 v[168:171], v15, s[4:7], s20 offen sc1
    s_add_u32 s20, s20, 512
    s_add_u32 s21, s95, 1048576
    s_lshr_b32 s22, s21, 8
    s_and_b32 s22, s22, 8192
    s_xor_b32 s22, s22, s46
    s_add_u32 s21, s21, s22
    buffer_store_dwordx4 v[204:207], v9, s[4:7], s21 offen sc1
    s_add_u32 s21, s21, 262144
    buffer_store_dword v247, v246, s[4:7], 0 offen sc1
    v_mov_b32 v40, 0
    v_mov_b32 v41, 0
    v_mov_b32 v42, 0
    v_mov_b32 v43, 0
    v_mov_b32 v44, 0
    v_mov_b32 v45, 0
    v_mov_b32 v46, 0
    v_mov_b32 v47, 0
    v_mov_b32 v48, 0
    v_mov_b32 v49, 0
    v_mov_b32 v50, 0
    v_mov_b32 v51, 0
    v_mov_b32 v52, 0
    v_mov_b32 v53, 0
    v_mov_b32 v54, 0
    v_mov_b32 v55, 0
    v_mov_b32 v56, 0
    v_mov_b32 v57, 0
    v_mov_b32 v58, 0
    v_mov_b32 v59, 0
    v_mov_b32 v60, 0
    v_mov_b32 v61, 0
    v_mov_b32 v62, 0
    v_mov_b32 v63, 0
    v_mov_b32 v64, 0
    v_mov_b32 v65, 0
    v_mov_b32 v66, 0
    v_mov_b32 v67, 0
    v_mov_b32 v68, 0
    v_mov_b32 v69, 0
    v_mov_b32 v70, 0
    v_mov_b32 v71, 0
    s_mov_b32 s21, s16
    s_mov_b32 s16, s42
    s_mov_b32 s42, s43
    s_mov_b32 s43, s44
    s_mov_b32 s44, s21
    s_add_u32 s95, s95, 524288
    s_lshr_b32 s84, s95, 8
    s_and_b32 s84, s84, 8192
    s_xor_b32 s84, s84, s46
    s_add_u32 s84, s84, s95
    s_add_u32 s15, s15, 1
    s_barrier
    s_branch recur_slow_w2
recur_slow_last2:
    buffer_store_dwordx4 v[168:171], v15, s[4:7], s20 offen sc1
    s_waitcnt vmcnt(0)
    s_branch recur_end
.p2align 6
recur_slow_w3:
    s_nop 15
    s_mov_b32 s23, s25
g_69:
    buffer_load_dwordx4 v[24:27], v2, s[4:7], s16 offen offset:0 sc1
    buffer_load_dwordx4 v[28:31], v2, s[4:7], s16 offen offset:1024 sc1
    buffer_load_dwordx4 v[32:35], v2, s[4:7], s16 offen offset:2048 sc1
    buffer_load_dwordx4 v[36:39], v2, s[4:7], s16 offen offset:3072 sc1
    s_waitcnt vmcnt(0)
    v_max3_u32 v19, v24, v25, v26
    v_max3_u32 v19, v19, v27, v28
    v_max3_u32 v19, v19, v29, v30
    v_max3_u32 v19, v19, v31, v32
    v_max3_u32 v19, v19, v33, v34
    v_max3_u32 v19, v19, v35, v36
    v_max3_u32 v19, v19, v37, v38
    v_max_u32 v19, v19, v39
    v_cmp_eq_u32 vcc, -1, v19
    s_nop 0
    s_cbranch_vccz g_69k
    s_add_u32 s23, s23, 1
    s_cmp_lt_u32 s23, 200000
    s_cbranch_scc1 g_69
    s_mov_b32 s25, 200000
g_69k:
    v_smfmac_f32_16x16x64_bf16 v[40:43], v[24:27], a[0:7], v172
    v_smfmac_f32_16x16x64_bf16 v[44:47], v[24:27], a[64:71], v172
    v_smfmac_f32_16x16x64_bf16 v[48:51], v[24:27], a[32:39], v172
    v_smfmac_f32_16x16x64_bf16 v[52:55], v[24:27], a[96:103], v172
    v_smfmac_f32_16x16x64_bf16 v[40:43], v[28:31], a[8:15], v172
    v_smfmac_f32_16x16x64_bf16 v[44:47], v[28:31], a[72:79], v172
    v_smfmac_f32_16x16x64_bf16 v[48:51], v[28:31], a[40:47], v172
    v_smfmac_f32_16x16x64_bf16 v[52:55], v[28:31], a[104:111], v172
    v_smfmac_f32_16x16x64_bf16 v[40:43], v[32:35], a[16:23], v172
    v_smfmac_f32_16x16x64_bf16 v[44:47], v[32:35], a[80:87], v172
    v_smfmac_f32_16x16x64_bf16 v[48:51], v[32:35], a[48:55], v172
    v_smfmac_f32_16x16x64_bf16 v[52:55], v[32:35], a[112:119], v172
    v_smfmac_f32_16x16x64_bf16 v[40:43], v[36:39], a[24:31], v172
    v_smfmac_f32_16x16x64_bf16 v[44:47], v[36:39], a[88:95], v172
    v_smfmac_f32_16x16x64_bf16 v[48:51], v[36:39], a[56:63], v172
    v_smfmac_f32_16x16x64_bf16 v[52:55], v[36:39], a[120:127], v172
    v_cvt_pk_bf16_f32 v72, v40, v41
    v_cvt_pk_bf16_f32 v73, v42, v43
    v_cvt_pk_bf16_f32 v74, v44, v45
    v_cvt_pk_bf16_f32 v75, v46, v47
    ds_write_b128 v17, v[72:75] offset:0
    v_cvt_pk_bf16_f32 v76, v48, v49
    v_cvt_pk_bf16_f32 v77, v50, v51
    s_nop 0
    v_cvt_pk_bf16_f32 v78, v52, v53
    v_cvt_pk_bf16_f32 v79, v54, v55
    ds_write_b128 v17, v[76:79] offset:1024
    v_smfmac_f32_16x16x64_bf16 v[56:59], v[24:27], a[128:135], v172
    v_smfmac_f32_16x16x64_bf16 v[60:63], v[24:27], a[160:167], v172
    v_smfmac_f32_16x16x64_bf16 v[56:59], v[28:31], a[136:143], v172
    s_waitcnt lgkmcnt(0)
    s_barrier
    v_smfmac_f32_16x16x64_bf16 v[60:63], v[28:31], a[168:175], v172
    v_smfmac_f32_16x16x64_bf16 v[56:59], v[32:35], a[144:151], v172
    v_smfmac_f32_16x16x64_bf16 v[60:63], v[32:35], a[176:183], v172
    v_smfmac_f32_16x16x64_bf16 v[56:59], v[36:39], a[152:159], v172
    v_smfmac_f32_16x16x64_bf16 v[60:63], v[36:39], a[184:191], v172
    s_nop 4
    v_cvt_pk_bf16_f32 v80, v56, v57
    v_cvt_pk_bf16_f32 v81, v58, v59
    s_nop 0
    v_cvt_pk_bf16_f32 v82, v60, v61
    v_cvt_pk_bf16_f32 v83, v62, v63
    ds_write_b128 v17, v[80:83] offset:8192
    buffer_store_dwordx4 v[204:207], v3, s[4:7], s43 offen sc1
    buffer_store_dwordx4 v[204:207], v3, s[4:7], s43 offen offset:128 sc1
    buffer_store_dwordx4 v[204:207], v4, s[4:7], s43 offen sc1
    buffer_store_dwordx2 v[204:205], v7, s[4:7], s43 offen sc1
    buffer_store_dwordx2 v[204:205], v11, s[4:7], s43 offen sc1
    s_cmp_eq_u32 s15, 63
    s_waitcnt lgkmcnt(0)
    s_barrier
    s_cbranch_scc1 recur_end
    s_barrier
    s_nop 15
    s_mov_b32 s23, s25
g_70:
    buffer_load_dwordx4 v[24:27], v8, s[4:7], s16 offen offset:0 sc1
    buffer_load_dwordx4 v[28:31], v8, s[4:7], s16 offen offset:1024 sc1
    buffer_load_dwordx4 v[32:35], v8, s[4:7], s16 offen offset:2048 sc1
    buffer_load_dwordx4 v[36:39], v8, s[4:7], s16 offen offset:3072 sc1
    s_waitcnt vmcnt(0)
    v_max3_u32 v19, v24, v25, v26
    v_max3_u32 v19, v19, v27, v28
    v_max3_u32 v19, v19, v29, v30
    v_max3_u32 v19, v19, v31, v32
    v_max3_u32 v19, v19, v33, v34
    v_max3_u32 v19, v19, v35, v36
    v_max3_u32 v19, v19, v37, v38
    v_max_u32 v19, v19, v39
    v_cmp_eq_u32 vcc, -1, v19
    s_nop 0
    s_cbranch_vccz g_70k
    s_add_u32 s23, s23, 1
    s_cmp_lt_u32 s23, 200000
    s_cbranch_scc1 g_70
    s_mov_b32 s25, 200000
g_70k:
    v_smfmac_f32_16x16x64_bf16 v[64:67], v[24:27], a[192:199], v172
    v_smfmac_f32_16x16x64_bf16 v[68:71], v[24:27], a[224:231], v172
    v_smfmac_f32_16x16x64_bf16 v[64:67], v[28:31], a[200:207], v172
    v_smfmac_f32_16x16x64_bf16 v[68:71], v[28:31], a[232:239], v172
    v_smfmac_f32_16x16x64_bf16 v[64:67], v[32:35], a[208:215], v172
    v_smfmac_f32_16x16x64_bf16 v[68:71], v[32:35], a[240:247], v172
    v_smfmac_f32_16x16x64_bf16 v[64:67], v[36:39], a[216:223], v172
    v_smfmac_f32_16x16x64_bf16 v[68:71], v[36:39], a[248:255], v172
    s_nop 4
    v_cvt_pk_bf16_f32 v80, v64, v65
    v_cvt_pk_bf16_f32 v81, v66, v67
    s_nop 0
    v_cvt_pk_bf16_f32 v82, v68, v69
    v_cvt_pk_bf16_f32 v83, v70, v71
    s_nop 1
    v_mfma_f32_16x16x32_bf16 v[88:91], v[80:83], v[84:87], 0
    s_barrier
    ds_read_b128 v[96:99], v16 offset:9216
    ds_read_b128 v[100:103], v16 offset:11264
    ds_read_b128 v[104:107], v16 offset:13312
    s_waitcnt lgkmcnt(2)
    v_mfma_f32_16x16x32_bf16 v[88:91], v[96:99], v[84:87], v[88:91]
    s_waitcnt lgkmcnt(1)
    v_mfma_f32_16x16x32_bf16 v[88:91], v[100:103], v[84:87], v[88:91]
    s_waitcnt lgkmcnt(0)
    v_mfma_f32_16x16x32_bf16 v[88:91], v[104:107], v[84:87], v[88:91]
    s_nop 7
    buffer_store_dwordx4 v[88:91], v9, s[4:7], s84 offen sc1
    s_add_u32 s22, s84, 262144
    s_nop 15
    s_nop 15
    s_nop 15
    s_nop 15
    s_nop 15
    s_nop 15
    s_nop 15
    s_nop 15
    s_mov_b32 s23, s25
    buffer_load_dwordx4 v[96:99], v10, s[4:7], s84 offen sc1
    buffer_load_dwordx4 v[100:103], v23, s[4:7], s84 offen sc1
    buffer_load_dwordx4 v[104:107], v244, s[4:7], s84 offen sc1
    v_mov_b32 v40, 0
    v_mov_b32 v41, 0
    v_mov_b32 v42, 0
    v_mov_b32 v43, 0
    v_mov_b32 v44, 0
    v_mov_b32 v45, 0
    v_mov_b32 v46, 0
    v_mov_b32 v47, 0
    v_mov_b32 v48, 0
    v_mov_b32 v49, 0
    v_mov_b32 v50, 0
    v_mov_b32 v51, 0
    v_mov_b32 v52, 0
    v_mov_b32 v53, 0
    v_mov_b32 v54, 0
    v_mov_b32 v55, 0
    v_mov_b32 v56, 0
    v_mov_b32 v57, 0
    v_mov_b32 v58, 0
    v_mov_b32 v59, 0
    v_mov_b32 v60, 0
    v_mov_b32 v61, 0
    v_mov_b32 v62, 0
    v_mov_b32 v63, 0
    v_mov_b32 v64, 0
    v_mov_b32 v65, 0
    v_mov_b32 v66, 0
    v_mov_b32 v67, 0
    v_mov_b32 v68, 0
    v_mov_b32 v69, 0
    v_mov_b32 v70, 0
    v_mov_b32 v71, 0
pb_73:
    s_waitcnt vmcnt(2)
    v_pk_add_f32 v[120:121], v[88:89], v[96:97]
    v_pk_add_f32 v[122:123], v[90:91], v[98:99]
    s_waitcnt vmcnt(1)
    v_pk_add_f32 v[120:121], v[120:121], v[100:101]
    v_pk_add_f32 v[122:123], v[122:123], v[102:103]
    s_waitcnt vmcnt(0)
    v_pk_add_f32 v[120:121], v[120:121], v[104:105]
    v_pk_add_f32 v[122:123], v[122:123], v[106:107]
    v_cvt_pk_bf16_f32 v180, v120, v121
    v_pk_add_f32 v[124:125], v[120:121], v[122:123]
    v_cvt_pk_bf16_f32 v181, v122, v123
    v_cmpx_o_f32 vcc, v124, v125
    buffer_store_dwordx2 v[180:181], v11, s[4:7], s42 offen sc1
    s_cmp_eq_u64 vcc, -1
    s_mov_b64 exec, -1
    s_cbranch_scc0 pr_71
pg_72:
    s_barrier
    s_mov_b32 s21, s16
    s_mov_b32 s16, s42
    s_mov_b32 s42, s43
    s_mov_b32 s43, s44
    s_mov_b32 s44, s21
    s_add_u32 s95, s95, 524288
    s_lshr_b32 s84, s95, 8
    s_and_b32 s84, s84, 8192
    s_xor_b32 s84, s84, s46
    s_add_u32 s84, s84, s95
    s_add_u32 s15, s15, 1
    s_branch recur_slow_w3
pr_71:
    v_max3_u32 v19, v96, v97, v98
    v_max3_u32 v19, v19, v99, v100
    v_max3_u32 v19, v19, v101, v102
    v_max3_u32 v19, v19, v103, v104
    v_max3_u32 v19, v19, v105, v106
    v_max_u32 v19, v19, v107
    v_cmp_eq_u32 vcc, -1, v19
    s_nop 0
    s_cbranch_vccz pf_75
    buffer_load_dwordx4 v[96:99], v10, s[4:7], s84 offen sc1
    buffer_load_dwordx4 v[100:103], v23, s[4:7], s84 offen sc1
    buffer_load_dwordx4 v[104:107], v244, s[4:7], s84 offen sc1
    s_add_u32 s23, s23, 1
    s_cmp_lt_u32 s23, 200000
    s_cbranch_scc1 pb_73
    s_mov_b32 s25, 200000
pf_75:
    buffer_store_dwordx2 v[180:181], v11, s[4:7], s42 offen sc1
    s_branch pg_72
recur_end:
    s_barrier
    v_mov_b32 v247, 64
    buffer_store_dword v247, v246, s[4:7], 0 offen sc1
    s_endpgm
.section .rodata,"a"
.p2align 6
.amdhsa_kernel concat_heads__spectral_gfnet__memory_aug_recurrent_mem_tr__prompt_kernel
  .amdhsa_next_free_vgpr 512
  .amdhsa_next_free_sgpr 102
  .amdhsa_accum_offset 256
  .amdhsa_group_segment_fixed_size 0
  .amdhsa_kernarg_size 104
  .amdhsa_user_sgpr_count 2
  .amdhsa_user_sgpr_kernarg_segment_ptr 1
  .amdhsa_system_sgpr_workgroup_id_x 1
  .amdhsa_float_denorm_mode_32 3
.end_amdhsa_kernel
```

```asm
; @launch kernel=concat_heads__spectral_gfnet__memory_aug_recurrent_mem_tr__prompt_kernel grid=(256,1,1) block=(256,1,1) lds=163840
.amdgcn_target "amdgcn-amd-amdhsa--gfx950"
.text
.globl concat_heads__spectral_gfnet__memory_aug_recurrent_mem_tr__prompt_kernel
.p2align 8
.type concat_heads__spectral_gfnet__memory_aug_recurrent_mem_tr__prompt_kernel,@function
concat_heads__spectral_gfnet__memory_aug_recurrent_mem_tr__prompt_kernel:
    s_cmp_ge_u32 s2, 256
    s_cbranch_scc1 W_end
    s_load_dwordx2 s[100:101], s[0:1], 88
    s_mov_b32 s97, s2
    s_mov_b32 s98, 0
    s_getreg_b32 s3, hwreg(HW_REG_XCC_ID, 0, 3)
role_start:
    s_andn2_b32 s2, s97, 7
    s_or_b32 s2, s2, s3
    s_bitcmp1_b32 s3, 2
    s_cbranch_scc0 R_entry
    s_cmp_ge_u32 s2, 256
    s_cbranch_scc1 W_end
    s_load_dwordx2 s[4:5], s[0:1], 96
    v_lshrrev_b32 v5, 6, v0
    v_and_b32 v1, 63, v0
    v_readfirstlane_b32 s16, v5
    s_mov_b32 s6, 268435456
    s_mov_b32 s7, 0x20000
    s_waitcnt lgkmcnt(0)
    s_lshr_b32 s90, s2, 6
    s_bfe_u32 s91, s2, 0x30003
    s_lshl_b32 s91, s91, 2
    s_and_b32 s17, s3, 3
    s_add_u32 s91, s91, s17
    s_lshl_b32 s93, s17, 3
    s_lshr_b32 s17, s91, 2
    s_add_u32 s93, s93, s17
    s_mov_b32 s92, 0
    s_lshl_b32 s17, s93, 2
    s_add_u32 s17, s17, s16
    s_lshl_b32 s18, s90, 7
    s_add_u32 s18, s18, s17
    s_lshl_b32 s18, s18, 7
    s_add_u32 s18, s18, 100663296
    s_lshl_b32 s20, s17, 7
    s_add_u32 s20, s20, 100728832
    s_cmp_eq_u32 s90, 3
    s_cselect_b32 s18, s20, s18
    s_cselect_b64 exec, 7, 1
    v_mov_b32 v5, s18
    s_and_b32 s18, s17, 31
    s_lshl_b32 s18, s18, 2
    s_lshr_b32 s20, s93, 3
    s_add_u32 s18, s18, s20
    s_lshl_b32 s18, s18, 7
    s_add_u32 s18, s18, 100745216
    v_writelane_b32 v5, s18, 1
    s_lshl_b32 s18, s17, 7
    s_add_u32 s18, s18, 100761600
    v_writelane_b32 v5, s18, 2
    v_mov_b32 v6, 0
    buffer_store_dword v6, v5, s[4:7], 0 offen sc1
    s_mov_b64 exec, -1
    s_cmp_eq_u32 s90, 3
    s_cbranch_scc1 W_F
    s_load_dwordx2 s[8:9], s[0:1], 24
    s_mov_b32 s10, 4194304
    s_mov_b32 s11, 0x20000
    s_lshr_b32 s17, s2, 3
    s_lshl_b32 s17, s17, 15
    v_lshlrev_b32 v5, 7, v0
    s_waitcnt lgkmcnt(0)
    buffer_load_dword v254, v5, s[8:11], s17 offen
    s_cmp_lg_u32 s90, 0
    s_cbranch_scc1 W_P
    s_waitcnt vmcnt(0)
    s_barrier
    s_or_b32 s17, s16, s98
    s_cmp_lg_u32 s17, 0
    s_cbranch_scc1 vote_1
    s_lshl_b32 s17, s91, 14
    s_add_u32 s17, s17, 239075328
    v_lshlrev_b32 v5, 2, v1
    v_add_u32 v5, s17, v5
    v_add_u32 v6, 8192, v5
    s_mov_b32 s20, -1
    s_mov_b32 s21, -1
    s_mov_b64 exec, 1
    buffer_store_dword v1, v5, s[4:7], 0 offen sc1
    s_mov_b32 s22, 0
vp_2:
    s_add_u32 s22, s22, 1
    s_getreg_b32 s18, hwreg(HW_REG_IB_STS, 0, 4)
    s_cmp_lt_u32 s22, 2048
    s_cselect_b32 s18, s18, 0
    s_cmp_lg_u32 s18, 0
    s_cbranch_scc1 vp_2
    s_min_u32 s20, s20, s22
    buffer_store_dword v1, v6, s[4:7], 0 offen sc1
    s_mov_b32 s22, 0
vp_3:
    s_add_u32 s22, s22, 1
    s_getreg_b32 s18, hwreg(HW_REG_IB_STS, 0, 4)
    s_cmp_lt_u32 s22, 2048
    s_cselect_b32 s18, s18, 0
    s_cmp_lg_u32 s18, 0
    s_cbranch_scc1 vp_3
    s_min_u32 s21, s21, s22
    buffer_store_dword v1, v5, s[4:7], 0 offen sc1
    s_mov_b32 s22, 0
vp_4:
    s_add_u32 s22, s22, 1
    s_getreg_b32 s18, hwreg(HW_REG_IB_STS, 0, 4)
    s_cmp_lt_u32 s22, 2048
    s_cselect_b32 s18, s18, 0
    s_cmp_lg_u32 s18, 0
    s_cbranch_scc1 vp_4
    s_min_u32 s20, s20, s22
    buffer_store_dword v1, v6, s[4:7], 0 offen sc1
    s_mov_b32 s22, 0
vp_5:
    s_add_u32 s22, s22, 1
    s_getreg_b32 s18, hwreg(HW_REG_IB_STS, 0, 4)
    s_cmp_lt_u32 s22, 2048
    s_cselect_b32 s18, s18, 0
    s_cmp_lg_u32 s18, 0
    s_cbranch_scc1 vp_5
    s_min_u32 s21, s21, s22
    buffer_store_dword v1, v5, s[4:7], 0 offen sc1
    s_mov_b32 s22, 0
vp_6:
    s_add_u32 s22, s22, 1
    s_getreg_b32 s18, hwreg(HW_REG_IB_STS, 0, 4)
    s_cmp_lt_u32 s22, 2048
    s_cselect_b32 s18, s18, 0
    s_cmp_lg_u32 s18, 0
    s_cbranch_scc1 vp_6
    s_min_u32 s20, s20, s22
    buffer_store_dword v1, v6, s[4:7], 0 offen sc1
    s_mov_b32 s22, 0
vp_7:
    s_add_u32 s22, s22, 1
    s_getreg_b32 s18, hwreg(HW_REG_IB_STS, 0, 4)
    s_cmp_lt_u32 s22, 2048
    s_cselect_b32 s18, s18, 0
    s_cmp_lg_u32 s18, 0
    s_cbranch_scc1 vp_7
    s_min_u32 s21, s21, s22
    buffer_store_dword v1, v5, s[4:7], 0 offen sc1
    s_mov_b32 s22, 0
vp_8:
    s_add_u32 s22, s22, 1
    s_getreg_b32 s18, hwreg(HW_REG_IB_STS, 0, 4)
    s_cmp_lt_u32 s22, 2048
    s_cselect_b32 s18, s18, 0
    s_cmp_lg_u32 s18, 0
    s_cbranch_scc1 vp_8
    s_min_u32 s20, s20, s22
    buffer_store_dword v1, v6, s[4:7], 0 offen sc1
    s_mov_b32 s22, 0
vp_9:
    s_add_u32 s22, s22, 1
    s_getreg_b32 s18, hwreg(HW_REG_IB_STS, 0, 4)
    s_cmp_lt_u32 s22, 2048
    s_cselect_b32 s18, s18, 0
    s_cmp_lg_u32 s18, 0
    s_cbranch_scc1 vp_9
    s_min_u32 s21, s21, s22
    s_and_b32 s17, s97, 3
    s_lshl_b32 s17, s17, 3
    s_lshl_b32 s17, 0x40, s17
    s_cmp_lt_u32 s20, s21
    s_cselect_b32 s17, s17, 0
    s_andn2_b32 s18, s97, 3
    v_mov_b32 v5, s18
    v_mov_b32 v6, s17
    global_atomic_add v5, v6, s[100:101] sc1
    s_mov_b64 exec, -1
    s_waitcnt vmcnt(0)
vote_1:
    s_waitcnt vmcnt(0)
    s_barrier
    s_cmp_lg_u32 s16, 0
    s_cbranch_scc1 reg_10
    s_and_b32 s17, s2, 3
    s_lshl_b32 s17, s17, 3
    s_lshl_b32 s18, s98, 2
    s_add_u32 s17, s17, s18
    s_lshl_b32 s17, 1, s17
    s_andn2_b32 s18, s2, 3
    v_mov_b32 v5, s18
    v_mov_b32 v6, s17
    s_mov_b64 exec, 1
    global_atomic_add v5, v6, s[100:101] sc1
    s_mov_b64 exec, -1
reg_10:
W_P:
    s_load_dwordx2 s[12:13], s[0:1], 40
    s_load_dwordx2 s[28:29], s[0:1], 48
    s_load_dwordx2 s[30:31], s[0:1], 56
    s_load_dwordx2 s[8:9], s[0:1], 24
    s_mov_b32 s10, 4194304
    s_mov_b32 s11, 0x20000
    s_mov_b32 s14, 8388608
    s_mov_b32 s15, 0x20000
    s_waitcnt lgkmcnt(0)
    s_cmp_eq_u32 s90, 1
    s_cselect_b64 s[12:13], s[28:29], s[12:13]
    s_cmp_eq_u32 s90, 2
    s_cselect_b64 s[12:13], s[30:31], s[12:13]
    s_lshl_b32 s28, s93, 2
    s_add_u32 s28, s28, s16
    s_lshl_b32 s20, s28, 6
    v_lshrrev_b32 v5, 2, v1
    v_and_b32 v6, 3, v1
    v_lshlrev_b32 v8, 4, v6
    v_lshl_add_u32 v7, v5, 13, v8
    s_mul_i32 s19, s16, 40960
    s_and_b32 s17, s93, 3
    s_lshl_b32 s17, s17, 8
    v_add_lshl_u32 v2, v0, s17, 13
    s_andn2_b32 s17, s93, 3
    s_lshl_b32 s17, s17, 8
    buffer_load_dword v253, v2, s[12:15], s17 offen offset:384
    s_add_u32 m0, s19, 0
    s_nop 0
    buffer_load_dwordx4 v7, s[12:15], s20 offen lds
    s_add_u32 s20, s20, 131072
    s_add_u32 m0, s19, 1024
    s_nop 0
    buffer_load_dwordx4 v7, s[12:15], s20 offen lds
    s_add_u32 s20, s20, 131072
    s_add_u32 m0, s19, 2048
    s_nop 0
    buffer_load_dwordx4 v7, s[12:15], s20 offen lds
    s_add_u32 s20, s20, 131072
    s_add_u32 m0, s19, 3072
    s_nop 0
    buffer_load_dwordx4 v7, s[12:15], s20 offen lds
    s_add_u32 s20, s20, 131072
    v_bfe_u32 v5, v1, 2, 2
    v_lshrrev_b32 v6, 4, v1
    v_lshl_add_u32 v5, v6, 3, v5
    v_lshl_add_u32 v8, v5, 6, v8
    v_add_u32 v8, s19, v8
    s_cmp_eq_u32 s90, 0
    s_cbranch_scc1 nq_11
    s_waitcnt vmcnt(6)
    s_barrier
    s_cmp_lg_u32 s16, 0
    s_cbranch_scc1 reg_12
    s_and_b32 s17, s2, 3
    s_lshl_b32 s17, s17, 3
    s_lshl_b32 s18, s98, 2
    s_add_u32 s17, s17, s18
    s_lshl_b32 s17, 1, s17
    s_andn2_b32 s18, s2, 3
    v_mov_b32 v5, s18
    v_mov_b32 v6, s17
    s_mov_b64 exec, 1
    global_atomic_add v5, v6, s[100:101] sc1
    s_mov_b64 exec, -1
reg_12:
    s_barrier
nq_11:
    s_add_u32 m0, s19, 4096
    s_nop 0
    buffer_load_dwordx4 v7, s[12:15], s20 offen lds
    s_add_u32 s20, s20, 131072
    s_add_u32 m0, s19, 5120
    s_nop 0
    buffer_load_dwordx4 v7, s[12:15], s20 offen lds
    s_add_u32 s20, s20, 131072
    s_add_u32 m0, s19, 6144
    s_nop 0
    buffer_load_dwordx4 v7, s[12:15], s20 offen lds
    s_add_u32 s20, s20, 131072
    s_add_u32 m0, s19, 7168
    s_nop 0
    buffer_load_dwordx4 v7, s[12:15], s20 offen lds
    s_add_u32 s20, s20, 131072
    s_add_u32 m0, s19, 8192
    s_nop 0
    buffer_load_dwordx4 v7, s[12:15], s20 offen lds
    s_add_u32 s20, s20, 131072
    s_add_u32 m0, s19, 9216
    s_nop 0
    buffer_load_dwordx4 v7, s[12:15], s20 offen lds
    s_add_u32 s20, s20, 131072
    s_add_u32 m0, s19, 10240
    s_nop 0
    buffer_load_dwordx4 v7, s[12:15], s20 offen lds
    s_add_u32 s20, s20, 131072
    s_add_u32 m0, s19, 11264
    s_nop 0
    buffer_load_dwordx4 v7, s[12:15], s20 offen lds
    s_add_u32 s20, s20, 131072
    s_add_u32 m0, s19, 12288
    s_nop 0
    buffer_load_dwordx4 v7, s[12:15], s20 offen lds
    s_add_u32 s20, s20, 131072
    s_add_u32 m0, s19, 13312
    s_nop 0
    buffer_load_dwordx4 v7, s[12:15], s20 offen lds
    s_add_u32 s20, s20, 131072
    s_add_u32 m0, s19, 14336
    s_nop 0
    buffer_load_dwordx4 v7, s[12:15], s20 offen lds
    s_add_u32 s20, s20, 131072
    s_add_u32 m0, s19, 15360
    s_nop 0
    buffer_load_dwordx4 v7, s[12:15], s20 offen lds
    s_add_u32 s20, s20, 131072
    s_add_u32 m0, s19, 16384
    s_nop 0
    buffer_load_dwordx4 v7, s[12:15], s20 offen lds
    s_add_u32 s20, s20, 131072
    s_add_u32 m0, s19, 17408
    s_nop 0
    buffer_load_dwordx4 v7, s[12:15], s20 offen lds
    s_add_u32 s20, s20, 131072
    s_add_u32 m0, s19, 18432
    s_nop 0
    buffer_load_dwordx4 v7, s[12:15], s20 offen lds
    s_add_u32 s20, s20, 131072
    s_add_u32 m0, s19, 19456
    s_nop 0
    buffer_load_dwordx4 v7, s[12:15], s20 offen lds
    s_add_u32 s20, s20, 131072
    s_add_u32 m0, s19, 20480
    s_nop 0
    buffer_load_dwordx4 v7, s[12:15], s20 offen lds
    s_add_u32 s20, s20, 131072
    s_add_u32 m0, s19, 21504
    s_nop 0
    buffer_load_dwordx4 v7, s[12:15], s20 offen lds
    s_add_u32 s20, s20, 131072
    s_add_u32 m0, s19, 22528
    s_nop 0
    buffer_load_dwordx4 v7, s[12:15], s20 offen lds
    s_add_u32 s20, s20, 131072
    s_add_u32 m0, s19, 23552
    s_nop 0
    buffer_load_dwordx4 v7, s[12:15], s20 offen lds
    s_add_u32 s20, s20, 131072
    s_add_u32 m0, s19, 24576
    s_nop 0
    buffer_load_dwordx4 v7, s[12:15], s20 offen lds
    s_add_u32 s20, s20, 131072
    s_add_u32 m0, s19, 25600
    s_nop 0
    buffer_load_dwordx4 v7, s[12:15], s20 offen lds
    s_add_u32 s20, s20, 131072
    s_add_u32 m0, s19, 26624
    s_nop 0
    buffer_load_dwordx4 v7, s[12:15], s20 offen lds
    s_add_u32 s20, s20, 131072
    s_add_u32 m0, s19, 27648
    s_nop 0
    buffer_load_dwordx4 v7, s[12:15], s20 offen lds
    s_add_u32 s20, s20, 131072
    s_add_u32 m0, s19, 28672
    s_nop 0
    buffer_load_dwordx4 v7, s[12:15], s20 offen lds
    s_add_u32 s20, s20, 131072
    s_add_u32 m0, s19, 29696
    s_nop 0
    buffer_load_dwordx4 v7, s[12:15], s20 offen lds
    s_add_u32 s20, s20, 131072
    s_add_u32 m0, s19, 30720
    s_nop 0
    buffer_load_dwordx4 v7, s[12:15], s20 offen lds
    s_add_u32 s20, s20, 131072
    s_add_u32 m0, s19, 31744
    s_nop 0
    buffer_load_dwordx4 v7, s[12:15], s20 offen lds
    s_add_u32 s20, s20, 131072
    s_add_u32 m0, s19, 32768
    s_nop 0
    buffer_load_dwordx4 v7, s[12:15], s20 offen lds
    s_add_u32 s20, s20, 131072
    s_add_u32 m0, s19, 33792
    s_nop 0
    buffer_load_dwordx4 v7, s[12:15], s20 offen lds
    s_add_u32 s20, s20, 131072
    s_add_u32 m0, s19, 34816
    s_nop 0
    buffer_load_dwordx4 v7, s[12:15], s20 offen lds
    s_add_u32 s20, s20, 131072
    s_add_u32 m0, s19, 35840
    s_nop 0
    buffer_load_dwordx4 v7, s[12:15], s20 offen lds
    s_add_u32 s20, s20, 131072
    s_add_u32 m0, s19, 36864
    s_nop 0
    buffer_load_dwordx4 v7, s[12:15], s20 offen lds
    s_add_u32 s20, s20, 131072
    s_add_u32 m0, s19, 37888
    s_nop 0
    buffer_load_dwordx4 v7, s[12:15], s20 offen lds
    s_add_u32 s20, s20, 131072
    s_add_u32 m0, s19, 38912
    s_nop 0
    buffer_load_dwordx4 v7, s[12:15], s20 offen lds
    s_add_u32 s20, s20, 131072
    s_add_u32 m0, s19, 39936
    s_nop 0
    buffer_load_dwordx4 v7, s[12:15], s20 offen lds
    s_add_u32 s20, s20, 131072
    s_waitcnt vmcnt(38)
    ds_read_b64_tr_b16 a[0:1], v8 offset:0
    ds_read_b64_tr_b16 a[2:3], v8 offset:256
    ds_read_b64_tr_b16 a[4:5], v8 offset:8
    ds_read_b64_tr_b16 a[6:7], v8 offset:264
    s_waitcnt vmcnt(36)
    ds_read_b64_tr_b16 a[8:9], v8 offset:2048
    ds_read_b64_tr_b16 a[10:11], v8 offset:2304
    ds_read_b64_tr_b16 a[12:13], v8 offset:2056
    ds_read_b64_tr_b16 a[14:15], v8 offset:2312
    s_waitcnt lgkmcnt(4)
    s_add_u32 m0, s19, 0
    s_nop 0
    buffer_load_dwordx4 v7, s[12:15], s20 offen lds
    s_add_u32 s20, s20, 131072
    s_add_u32 m0, s19, 1024
    s_nop 0
    buffer_load_dwordx4 v7, s[12:15], s20 offen lds
    s_add_u32 s20, s20, 131072
    s_waitcnt vmcnt(36)
    ds_read_b64_tr_b16 a[16:17], v8 offset:4096
    ds_read_b64_tr_b16 a[18:19], v8 offset:4352
    ds_read_b64_tr_b16 a[20:21], v8 offset:4104
    ds_read_b64_tr_b16 a[22:23], v8 offset:4360
    s_waitcnt lgkmcnt(4)
    s_add_u32 m0, s19, 2048
    s_nop 0
    buffer_load_dwordx4 v7, s[12:15], s20 offen lds
    s_add_u32 s20, s20, 131072
    s_add_u32 m0, s19, 3072
    s_nop 0
    buffer_load_dwordx4 v7, s[12:15], s20 offen lds
    s_add_u32 s20, s20, 131072
    s_waitcnt vmcnt(36)
    ds_read_b64_tr_b16 a[24:25], v8 offset:6144
    ds_read_b64_tr_b16 a[26:27], v8 offset:6400
    ds_read_b64_tr_b16 a[28:29], v8 offset:6152
    ds_read_b64_tr_b16 a[30:31], v8 offset:6408
    s_waitcnt lgkmcnt(4)
    s_add_u32 m0, s19, 4096
    s_nop 0
    buffer_load_dwordx4 v7, s[12:15], s20 offen lds
    s_add_u32 s20, s20, 131072
    s_add_u32 m0, s19, 5120
    s_nop 0
    buffer_load_dwordx4 v7, s[12:15], s20 offen lds
    s_add_u32 s20, s20, 131072
    s_waitcnt vmcnt(36)
    ds_read_b64_tr_b16 a[32:33], v8 offset:8192
    ds_read_b64_tr_b16 a[34:35], v8 offset:8448
    ds_read_b64_tr_b16 a[36:37], v8 offset:8200
    ds_read_b64_tr_b16 a[38:39], v8 offset:8456
    s_waitcnt lgkmcnt(4)
    s_add_u32 m0, s19, 6144
    s_nop 0
    buffer_load_dwordx4 v7, s[12:15], s20 offen lds
    s_add_u32 s20, s20, 131072
    s_add_u32 m0, s19, 7168
    s_nop 0
    buffer_load_dwordx4 v7, s[12:15], s20 offen lds
    s_add_u32 s20, s20, 131072
    s_waitcnt vmcnt(36)
    ds_read_b64_tr_b16 a[40:41], v8 offset:10240
    ds_read_b64_tr_b16 a[42:43], v8 offset:10496
    ds_read_b64_tr_b16 a[44:45], v8 offset:10248
    ds_read_b64_tr_b16 a[46:47], v8 offset:10504
    s_waitcnt lgkmcnt(4)
    s_add_u32 m0, s19, 8192
    s_nop 0
    buffer_load_dwordx4 v7, s[12:15], s20 offen lds
    s_add_u32 s20, s20, 131072
    s_add_u32 m0, s19, 9216
    s_nop 0
    buffer_load_dwordx4 v7, s[12:15], s20 offen lds
    s_add_u32 s20, s20, 131072
    s_waitcnt vmcnt(36)
    ds_read_b64_tr_b16 a[48:49], v8 offset:12288
    ds_read_b64_tr_b16 a[50:51], v8 offset:12544
    ds_read_b64_tr_b16 a[52:53], v8 offset:12296
    ds_read_b64_tr_b16 a[54:55], v8 offset:12552
    s_waitcnt lgkmcnt(4)
    s_add_u32 m0, s19, 10240
    s_nop 0
    buffer_load_dwordx4 v7, s[12:15], s20 offen lds
    s_add_u32 s20, s20, 131072
    s_add_u32 m0, s19, 11264
    s_nop 0
    buffer_load_dwordx4 v7, s[12:15], s20 offen lds
    s_add_u32 s20, s20, 131072
    s_waitcnt vmcnt(36)
    ds_read_b64_tr_b16 a[56:57], v8 offset:14336
    ds_read_b64_tr_b16 a[58:59], v8 offset:14592
    ds_read_b64_tr_b16 a[60:61], v8 offset:14344
    ds_read_b64_tr_b16 a[62:63], v8 offset:14600
    s_waitcnt lgkmcnt(4)
    s_add_u32 m0, s19, 12288
    s_nop 0
    buffer_load_dwordx4 v7, s[12:15], s20 offen lds
    s_add_u32 s20, s20, 131072
    s_add_u32 m0, s19, 13312
    s_nop 0
    buffer_load_dwordx4 v7, s[12:15], s20 offen lds
    s_add_u32 s20, s20, 131072
    s_waitcnt vmcnt(36)
    ds_read_b64_tr_b16 a[64:65], v8 offset:16384
    ds_read_b64_tr_b16 a[66:67], v8 offset:16640
    ds_read_b64_tr_b16 a[68:69], v8 offset:16392
    ds_read_b64_tr_b16 a[70:71], v8 offset:16648
    s_waitcnt lgkmcnt(4)
    s_add_u32 m0, s19, 14336
    s_nop 0
    buffer_load_dwordx4 v7, s[12:15], s20 offen lds
    s_add_u32 s20, s20, 131072
    s_add_u32 m0, s19, 15360
    s_nop 0
    buffer_load_dwordx4 v7, s[12:15], s20 offen lds
    s_add_u32 s20, s20, 131072
    s_waitcnt vmcnt(36)
    ds_read_b64_tr_b16 a[72:73], v8 offset:18432
    ds_read_b64_tr_b16 a[74:75], v8 offset:18688
    ds_read_b64_tr_b16 a[76:77], v8 offset:18440
    ds_read_b64_tr_b16 a[78:79], v8 offset:18696
    s_waitcnt lgkmcnt(4)
    s_add_u32 m0, s19, 16384
    s_nop 0
    buffer_load_dwordx4 v7, s[12:15], s20 offen lds
    s_add_u32 s20, s20, 131072
    s_add_u32 m0, s19, 17408
    s_nop 0
    buffer_load_dwordx4 v7, s[12:15], s20 offen lds
    s_add_u32 s20, s20, 131072
    s_waitcnt vmcnt(36)
    ds_read_b64_tr_b16 a[80:81], v8 offset:20480
    ds_read_b64_tr_b16 a[82:83], v8 offset:20736
    ds_read_b64_tr_b16 a[84:85], v8 offset:20488
    ds_read_b64_tr_b16 a[86:87], v8 offset:20744
    s_waitcnt lgkmcnt(4)
    s_add_u32 m0, s19, 18432
    s_nop 0
    buffer_load_dwordx4 v7, s[12:15], s20 offen lds
    s_add_u32 s20, s20, 131072
    s_add_u32 m0, s19, 19456
    s_nop 0
    buffer_load_dwordx4 v7, s[12:15], s20 offen lds
    s_add_u32 s20, s20, 131072
    s_waitcnt vmcnt(36)
    ds_read_b64_tr_b16 a[88:89], v8 offset:22528
    ds_read_b64_tr_b16 a[90:91], v8 offset:22784
    ds_read_b64_tr_b16 a[92:93], v8 offset:22536
    ds_read_b64_tr_b16 a[94:95], v8 offset:22792
    s_waitcnt lgkmcnt(4)
    s_add_u32 m0, s19, 20480
    s_nop 0
    buffer_load_dwordx4 v7, s[12:15], s20 offen lds
    s_add_u32 s20, s20, 131072
    s_add_u32 m0, s19, 21504
    s_nop 0
    buffer_load_dwordx4 v7, s[12:15], s20 offen lds
    s_add_u32 s20, s20, 131072
    s_waitcnt vmcnt(36)
    ds_read_b64_tr_b16 a[96:97], v8 offset:24576
    ds_read_b64_tr_b16 a[98:99], v8 offset:24832
    ds_read_b64_tr_b16 a[100:101], v8 offset:24584
    ds_read_b64_tr_b16 a[102:103], v8 offset:24840
    s_waitcnt lgkmcnt(4)
    s_add_u32 m0, s19, 22528
    s_nop 0
    buffer_load_dwordx4 v7, s[12:15], s20 offen lds
    s_add_u32 s20, s20, 131072
    s_add_u32 m0, s19, 23552
    s_nop 0
    buffer_load_dwordx4 v7, s[12:15], s20 offen lds
    s_add_u32 s20, s20, 131072
    s_waitcnt vmcnt(36)
    ds_read_b64_tr_b16 a[104:105], v8 offset:26624
    ds_read_b64_tr_b16 a[106:107], v8 offset:26880
    ds_read_b64_tr_b16 a[108:109], v8 offset:26632
    ds_read_b64_tr_b16 a[110:111], v8 offset:26888
    s_waitcnt lgkmcnt(7)
    s_waitcnt vmcnt(34)
    ds_read_b64_tr_b16 a[112:113], v8 offset:28672
    ds_read_b64_tr_b16 a[114:115], v8 offset:28928
    ds_read_b64_tr_b16 a[116:117], v8 offset:28680
    ds_read_b64_tr_b16 a[118:119], v8 offset:28936
    s_waitcnt vmcnt(32)
    ds_read_b64_tr_b16 a[120:121], v8 offset:30720
    ds_read_b64_tr_b16 a[122:123], v8 offset:30976
    ds_read_b64_tr_b16 a[124:125], v8 offset:30728
    ds_read_b64_tr_b16 a[126:127], v8 offset:30984
    s_waitcnt lgkmcnt(7)
    s_waitcnt vmcnt(30)
    ds_read_b64_tr_b16 a[128:129], v8 offset:32768
    ds_read_b64_tr_b16 a[130:131], v8 offset:33024
    ds_read_b64_tr_b16 a[132:133], v8 offset:32776
    ds_read_b64_tr_b16 a[134:135], v8 offset:33032
    s_waitcnt vmcnt(28)
    ds_read_b64_tr_b16 a[136:137], v8 offset:34816
    ds_read_b64_tr_b16 a[138:139], v8 offset:35072
    ds_read_b64_tr_b16 a[140:141], v8 offset:34824
    ds_read_b64_tr_b16 a[142:143], v8 offset:35080
    s_waitcnt lgkmcnt(7)
    s_waitcnt vmcnt(26)
    ds_read_b64_tr_b16 a[144:145], v8 offset:36864
    ds_read_b64_tr_b16 a[146:147], v8 offset:37120
    ds_read_b64_tr_b16 a[148:149], v8 offset:36872
    ds_read_b64_tr_b16 a[150:151], v8 offset:37128
    s_waitcnt vmcnt(24)
    ds_read_b64_tr_b16 a[152:153], v8 offset:38912
    ds_read_b64_tr_b16 a[154:155], v8 offset:39168
    ds_read_b64_tr_b16 a[156:157], v8 offset:38920
    ds_read_b64_tr_b16 a[158:159], v8 offset:39176
    s_waitcnt lgkmcnt(7)
    s_waitcnt vmcnt(22)
    ds_read_b64_tr_b16 a[160:161], v8 offset:0
    ds_read_b64_tr_b16 a[162:163], v8 offset:256
    ds_read_b64_tr_b16 a[164:165], v8 offset:8
    ds_read_b64_tr_b16 a[166:167], v8 offset:264
    s_waitcnt vmcnt(20)
    ds_read_b64_tr_b16 a[168:169], v8 offset:2048
    ds_read_b64_tr_b16 a[170:171], v8 offset:2304
    ds_read_b64_tr_b16 a[172:173], v8 offset:2056
    ds_read_b64_tr_b16 a[174:175], v8 offset:2312
    s_waitcnt lgkmcnt(7)
    s_waitcnt vmcnt(18)
    ds_read_b64_tr_b16 a[176:177], v8 offset:4096
    ds_read_b64_tr_b16 a[178:179], v8 offset:4352
    ds_read_b64_tr_b16 a[180:181], v8 offset:4104
    ds_read_b64_tr_b16 a[182:183], v8 offset:4360
    s_waitcnt vmcnt(16)
    ds_read_b64_tr_b16 a[184:185], v8 offset:6144
    ds_read_b64_tr_b16 a[186:187], v8 offset:6400
    ds_read_b64_tr_b16 a[188:189], v8 offset:6152
    ds_read_b64_tr_b16 a[190:191], v8 offset:6408
    s_waitcnt lgkmcnt(7)
    s_waitcnt vmcnt(14)
    ds_read_b64_tr_b16 a[192:193], v8 offset:8192
    ds_read_b64_tr_b16 a[194:195], v8 offset:8448
    ds_read_b64_tr_b16 a[196:197], v8 offset:8200
    ds_read_b64_tr_b16 a[198:199], v8 offset:8456
    s_waitcnt vmcnt(12)
    ds_read_b64_tr_b16 a[200:201], v8 offset:10240
    ds_read_b64_tr_b16 a[202:203], v8 offset:10496
    ds_read_b64_tr_b16 a[204:205], v8 offset:10248
    ds_read_b64_tr_b16 a[206:207], v8 offset:10504
    s_waitcnt lgkmcnt(7)
    s_waitcnt vmcnt(10)
    ds_read_b64_tr_b16 a[208:209], v8 offset:12288
    ds_read_b64_tr_b16 a[210:211], v8 offset:12544
    ds_read_b64_tr_b16 a[212:213], v8 offset:12296
    ds_read_b64_tr_b16 a[214:215], v8 offset:12552
    s_waitcnt vmcnt(8)
    ds_read_b64_tr_b16 a[216:217], v8 offset:14336
    ds_read_b64_tr_b16 a[218:219], v8 offset:14592
    ds_read_b64_tr_b16 a[220:221], v8 offset:14344
    ds_read_b64_tr_b16 a[222:223], v8 offset:14600
    s_waitcnt lgkmcnt(7)
    s_waitcnt vmcnt(6)
    ds_read_b64_tr_b16 a[224:225], v8 offset:16384
    ds_read_b64_tr_b16 a[226:227], v8 offset:16640
    ds_read_b64_tr_b16 a[228:229], v8 offset:16392
    ds_read_b64_tr_b16 a[230:231], v8 offset:16648
    s_waitcnt vmcnt(4)
    ds_read_b64_tr_b16 a[232:233], v8 offset:18432
    ds_read_b64_tr_b16 a[234:235], v8 offset:18688
    ds_read_b64_tr_b16 a[236:237], v8 offset:18440
    ds_read_b64_tr_b16 a[238:239], v8 offset:18696
    s_waitcnt lgkmcnt(7)
    s_waitcnt vmcnt(2)
    ds_read_b64_tr_b16 a[240:241], v8 offset:20480
    ds_read_b64_tr_b16 a[242:243], v8 offset:20736
    ds_read_b64_tr_b16 a[244:245], v8 offset:20488
    ds_read_b64_tr_b16 a[246:247], v8 offset:20744
    s_waitcnt vmcnt(0)
    ds_read_b64_tr_b16 a[248:249], v8 offset:22528
    ds_read_b64_tr_b16 a[250:251], v8 offset:22784
    ds_read_b64_tr_b16 a[252:253], v8 offset:22536
    ds_read_b64_tr_b16 a[254:255], v8 offset:22792
    s_waitcnt lgkmcnt(7)
    s_waitcnt lgkmcnt(0)
    v_and_b32 v5, 15, v1
    v_bfe_u32 v6, v1, 1, 3
    v_lshrrev_b32 v7, 4, v1
    v_xor_b32 v6, v6, v7
    v_lshlrev_b32 v6, 4, v6
    v_lshl_add_u32 v10, v5, 7, v6
    s_lshl_b32 s19, s16, 10
    v_xor_b32 v11, 64, v10
    v_add_u32 v12, 0x10000, v10
    v_add_u32 v13, 0x10000, v11
    v_lshrrev_b32 v7, 3, v1
    s_lshl_b32 s17, s16, 3
    v_add_u32 v7, s17, v7
    v_bfe_u32 v8, v7, 1, 3
    v_xor_b32 v8, v8, v1
    v_and_b32 v8, 7, v8
    v_bfe_u32 v5, v7, 2, 2
    v_and_b32 v2, 3, v7
    v_lshl_add_u32 v2, v5, 3, v2
    v_bfe_u32 v5, v7, 4, 1
    v_lshl_add_u32 v2, v5, 2, v2
    v_bfe_u32 v5, v1, 2, 2
    v_and_b32 v3, 3, v1
    v_lshl_add_u32 v3, v5, 3, v3
    v_lshlrev_b32 v2, 11, v2
    v_lshl_add_u32 v2, v8, 4, v2
    v_and_b32 v5, 16, v1
    v_lshl_add_u32 v3, v3, 5, v5
    v_and_b32 v5, 32, v1
    v_lshl_add_u32 v3, v5, 5, v3
    s_mul_i32 s21, s28, 133120
    s_mul_i32 s18, s90, 17825792
    s_add_u32 s21, s21, s18
    s_lshl_b32 s18, s90, 7
    s_add_u32 s17, s28, s18
    s_lshl_b32 s17, s17, 7
    s_add_u32 s17, s17, 100663296
    v_mov_b32 v4, s17
    v_mov_b32 v5, 1073741824
    v_cmp_eq_u32 vcc, 0, v1
    s_nop 1
    v_cndmask_b32 v4, v5, v4, vcc
    v_lshlrev_b32 v252, 7, v1
    s_cmp_eq_u32 s90, 0
    s_cselect_b32 s20, 0, 32
    v_cmp_gt_u32 vcc, s20, v1
    s_nop 1
    v_cndmask_b32 v252, v5, v252, vcc
    s_mov_b32 s20, 0
    s_mov_b32 s24, 65536
    s_mov_b32 s25, 2048
    s_barrier
    s_cmp_eq_u32 s90, 2
    s_cbranch_scc1 P_v
    s_mov_b32 s26, s25
    s_sub_u32 s25, s21, 1073741824
    s_mov_b32 s21, 1073741824
    s_mov_b32 s23, 0
    s_mov_b32 s22, 0
    s_add_u32 m0, s19, 0
    s_nop 0
    buffer_load_dwordx4 v2, s[8:11], s20 offen offset:0 lds
    s_add_u32 m0, s19, 3968
    s_nop 0
    buffer_load_dwordx4 v2, s[8:11], s20 offen offset:128 lds
    s_add_u32 m0, s19, 7936
    s_nop 0
    buffer_load_dwordx4 v2, s[8:11], s20 offen offset:256 lds
    s_add_u32 m0, s19, 11904
    s_nop 0
    buffer_load_dwordx4 v2, s[8:11], s20 offen offset:384 lds
    s_add_u32 m0, s19, 15872
    s_nop 0
    buffer_load_dwordx4 v2, s[8:11], s20 offen offset:512 lds
    s_add_u32 m0, s19, 19840
    s_nop 0
    buffer_load_dwordx4 v2, s[8:11], s20 offen offset:640 lds
    s_add_u32 m0, s19, 23808
    s_nop 0
    buffer_load_dwordx4 v2, s[8:11], s20 offen offset:768 lds
    s_add_u32 m0, s19, 27776
    s_nop 0
    buffer_load_dwordx4 v2, s[8:11], s20 offen offset:896 lds
    s_add_u32 m0, s19, 31744
    s_nop 0
    buffer_load_dwordx4 v2, s[8:11], s20 offen offset:1024 lds
    s_add_u32 m0, s19, 35712
    s_nop 0
    buffer_load_dwordx4 v2, s[8:11], s20 offen offset:1152 lds
    s_add_u32 m0, s19, 39680
    s_nop 0
    buffer_load_dwordx4 v2, s[8:11], s20 offen offset:1280 lds
    s_add_u32 m0, s19, 43648
    s_nop 0
    buffer_load_dwordx4 v2, s[8:11], s20 offen offset:1408 lds
    s_add_u32 m0, s19, 47616
    s_nop 0
    buffer_load_dwordx4 v2, s[8:11], s20 offen offset:1536 lds
    s_add_u32 m0, s19, 51584
    s_nop 0
    buffer_load_dwordx4 v2, s[8:11], s20 offen offset:1664 lds
    s_add_u32 m0, s19, 55552
    s_nop 0
    buffer_load_dwordx4 v2, s[8:11], s20 offen offset:1792 lds
    s_add_u32 m0, s19, 59520
    s_nop 0
    buffer_load_dwordx4 v2, s[8:11], s20 offen offset:1920 lds
    s_add_u32 s20, s20, s24
    s_add_u32 m0, s19, 65536
    s_nop 0
    buffer_load_dwordx4 v2, s[8:11], s20 offen offset:0 lds
    s_add_u32 m0, s19, 69504
    s_nop 0
    buffer_load_dwordx4 v2, s[8:11], s20 offen offset:128 lds
    s_add_u32 m0, s19, 73472
    s_nop 0
    buffer_load_dwordx4 v2, s[8:11], s20 offen offset:256 lds
    v_mov_b32 v9, s23
    s_add_u32 s23, s23, 1
    buffer_store_dword v9, v4, s[4:7], 0 offen sc1
    s_mov_b32 s23, 0
    s_waitcnt vmcnt(12)
    s_barrier
    ds_read_b128 v[20:23], v10 offset:0
    ds_read_b128 v[24:27], v10 offset:2048
    ds_read_b128 v[28:31], v11 offset:0
    ds_read_b128 v[32:35], v11 offset:2048
    ds_read_b128 v[36:39], v10 offset:4096
    ds_read_b128 v[40:43], v10 offset:6144
    ds_read_b128 v[44:47], v11 offset:4096
.p2align 6
P_qk_top:
    s_waitcnt lgkmcnt(6)
    v_mfma_f32_16x16x32_bf16 v[52:55], a[0:3], v[20:23], 0
    ds_read_b128 v[48:51], v11 offset:6144
    v_mfma_f32_16x16x32_bf16 v[56:59], a[4:7], v[20:23], 0
    s_waitcnt lgkmcnt(6)
    v_mfma_f32_16x16x32_bf16 v[60:63], a[0:3], v[24:27], 0
    ds_read_b128 v[20:23], v10 offset:8192
    s_add_u32 m0, s19, 77440
    v_mfma_f32_16x16x32_bf16 v[64:67], a[4:7], v[24:27], 0
    buffer_load_dwordx4 v2, s[8:11], s20 offen offset:384 lds
    s_waitcnt lgkmcnt(6)
    v_mfma_f32_16x16x32_bf16 v[52:55], a[8:11], v[28:31], v[52:55]
    ds_read_b128 v[24:27], v10 offset:10240
    v_mfma_f32_16x16x32_bf16 v[56:59], a[12:15], v[28:31], v[56:59]
    s_waitcnt lgkmcnt(6)
    v_mfma_f32_16x16x32_bf16 v[60:63], a[8:11], v[32:35], v[60:63]
    ds_read_b128 v[28:31], v11 offset:8192
    s_add_u32 m0, s19, 81408
    v_mfma_f32_16x16x32_bf16 v[64:67], a[12:15], v[32:35], v[64:67]
    buffer_load_dwordx4 v2, s[8:11], s20 offen offset:512 lds
    s_waitcnt lgkmcnt(6)
    v_mfma_f32_16x16x32_bf16 v[52:55], a[16:19], v[36:39], v[52:55]
    ds_read_b128 v[32:35], v11 offset:10240
    v_mfma_f32_16x16x32_bf16 v[56:59], a[20:23], v[36:39], v[56:59]
    s_waitcnt lgkmcnt(6)
    v_mfma_f32_16x16x32_bf16 v[60:63], a[16:19], v[40:43], v[60:63]
    ds_read_b128 v[36:39], v10 offset:12288
    s_add_u32 m0, s19, 85376
    v_mfma_f32_16x16x32_bf16 v[64:67], a[20:23], v[40:43], v[64:67]
    buffer_load_dwordx4 v2, s[8:11], s20 offen offset:640 lds
    s_waitcnt lgkmcnt(6)
    v_mfma_f32_16x16x32_bf16 v[52:55], a[24:27], v[44:47], v[52:55]
    ds_read_b128 v[40:43], v10 offset:14336
    v_mfma_f32_16x16x32_bf16 v[56:59], a[28:31], v[44:47], v[56:59]
    s_waitcnt lgkmcnt(6)
    v_mfma_f32_16x16x32_bf16 v[60:63], a[24:27], v[48:51], v[60:63]
    ds_read_b128 v[44:47], v11 offset:12288
    s_add_u32 m0, s19, 89344
    v_mfma_f32_16x16x32_bf16 v[64:67], a[28:31], v[48:51], v[64:67]
    buffer_load_dwordx4 v2, s[8:11], s20 offen offset:768 lds
    s_waitcnt lgkmcnt(6)
    v_mfma_f32_16x16x32_bf16 v[52:55], a[32:35], v[20:23], v[52:55]
    ds_read_b128 v[48:51], v11 offset:14336
    v_mfma_f32_16x16x32_bf16 v[56:59], a[36:39], v[20:23], v[56:59]
    s_waitcnt lgkmcnt(6)
    v_mfma_f32_16x16x32_bf16 v[60:63], a[32:35], v[24:27], v[60:63]
    ds_read_b128 v[20:23], v10 offset:16384
    s_add_u32 m0, s19, 93312
    v_mfma_f32_16x16x32_bf16 v[64:67], a[36:39], v[24:27], v[64:67]
    buffer_load_dwordx4 v2, s[8:11], s20 offen offset:896 lds
    s_waitcnt lgkmcnt(6)
    v_mfma_f32_16x16x32_bf16 v[52:55], a[40:43], v[28:31], v[52:55]
    ds_read_b128 v[24:27], v10 offset:18432
    v_mfma_f32_16x16x32_bf16 v[56:59], a[44:47], v[28:31], v[56:59]
    v_cvt_pk_bf16_f32 v84, v68, v69
    s_waitcnt lgkmcnt(6)
    v_mfma_f32_16x16x32_bf16 v[60:63], a[40:43], v[32:35], v[60:63]
    ds_read_b128 v[28:31], v11 offset:16384
    v_mfma_f32_16x16x32_bf16 v[64:67], a[44:47], v[32:35], v[64:67]
    v_cvt_pk_bf16_f32 v85, v70, v71
    s_waitcnt lgkmcnt(6)
    v_mfma_f32_16x16x32_bf16 v[52:55], a[48:51], v[36:39], v[52:55]
    ds_read_b128 v[32:35], v11 offset:18432
    v_mfma_f32_16x16x32_bf16 v[56:59], a[52:55], v[36:39], v[56:59]
    v_cvt_pk_bf16_f32 v86, v72, v73
    s_waitcnt lgkmcnt(6)
    v_mfma_f32_16x16x32_bf16 v[60:63], a[48:51], v[40:43], v[60:63]
    ds_read_b128 v[36:39], v10 offset:20480
    v_mfma_f32_16x16x32_bf16 v[64:67], a[52:55], v[40:43], v[64:67]
    v_cvt_pk_bf16_f32 v87, v74, v75
    s_waitcnt lgkmcnt(6)
    v_mfma_f32_16x16x32_bf16 v[52:55], a[56:59], v[44:47], v[52:55]
    ds_read_b128 v[40:43], v10 offset:22528
    v_mfma_f32_16x16x32_bf16 v[56:59], a[60:63], v[44:47], v[56:59]
    v_cvt_pk_bf16_f32 v88, v76, v77
    s_waitcnt lgkmcnt(6)
    v_mfma_f32_16x16x32_bf16 v[60:63], a[56:59], v[48:51], v[60:63]
    ds_read_b128 v[44:47], v11 offset:20480
    v_mfma_f32_16x16x32_bf16 v[64:67], a[60:63], v[48:51], v[64:67]
    v_cvt_pk_bf16_f32 v89, v78, v79
    buffer_store_dwordx4 v[84:87], v3, s[4:7], s21 offen offset:0 sc1
    s_waitcnt lgkmcnt(6)
    v_mfma_f32_16x16x32_bf16 v[52:55], a[64:67], v[20:23], v[52:55]
    ds_read_b128 v[48:51], v11 offset:22528
    v_mfma_f32_16x16x32_bf16 v[56:59], a[68:71], v[20:23], v[56:59]
    v_cvt_pk_bf16_f32 v90, v80, v81
    s_waitcnt lgkmcnt(6)
    v_mfma_f32_16x16x32_bf16 v[60:63], a[64:67], v[24:27], v[60:63]
    ds_read_b128 v[20:23], v10 offset:24576
    v_mfma_f32_16x16x32_bf16 v[64:67], a[68:71], v[24:27], v[64:67]
    v_cvt_pk_bf16_f32 v91, v82, v83
    s_waitcnt lgkmcnt(6)
    v_mfma_f32_16x16x32_bf16 v[52:55], a[72:75], v[28:31], v[52:55]
    ds_read_b128 v[24:27], v10 offset:26624
    v_mfma_f32_16x16x32_bf16 v[56:59], a[76:79], v[28:31], v[56:59]
    s_waitcnt lgkmcnt(6)
    v_mfma_f32_16x16x32_bf16 v[60:63], a[72:75], v[32:35], v[60:63]
    ds_read_b128 v[28:31], v11 offset:24576
    v_mfma_f32_16x16x32_bf16 v[64:67], a[76:79], v[32:35], v[64:67]
    buffer_store_dwordx4 v[88:91], v3, s[4:7], s21 offen offset:128 sc1
    s_waitcnt lgkmcnt(6)
    v_mfma_f32_16x16x32_bf16 v[52:55], a[80:83], v[36:39], v[52:55]
    ds_read_b128 v[32:35], v11 offset:26624
    v_mfma_f32_16x16x32_bf16 v[56:59], a[84:87], v[36:39], v[56:59]
    s_add_u32 s21, s21, s25
    s_mov_b32 s25, s26
    s_waitcnt lgkmcnt(6)
    v_mfma_f32_16x16x32_bf16 v[60:63], a[80:83], v[40:43], v[60:63]
    ds_read_b128 v[36:39], v10 offset:28672
    v_mfma_f32_16x16x32_bf16 v[64:67], a[84:87], v[40:43], v[64:67]
    s_waitcnt lgkmcnt(6)
    v_mfma_f32_16x16x32_bf16 v[52:55], a[88:91], v[44:47], v[52:55]
    ds_read_b128 v[40:43], v10 offset:30720
    v_mfma_f32_16x16x32_bf16 v[56:59], a[92:95], v[44:47], v[56:59]
    s_waitcnt lgkmcnt(6)
    v_mfma_f32_16x16x32_bf16 v[60:63], a[88:91], v[48:51], v[60:63]
    ds_read_b128 v[44:47], v11 offset:28672
    v_mfma_f32_16x16x32_bf16 v[64:67], a[92:95], v[48:51], v[64:67]
    s_waitcnt lgkmcnt(6)
    v_mfma_f32_16x16x32_bf16 v[52:55], a[96:99], v[20:23], v[52:55]
    ds_read_b128 v[48:51], v11 offset:30720
    v_mfma_f32_16x16x32_bf16 v[56:59], a[100:103], v[20:23], v[56:59]
    s_waitcnt lgkmcnt(6)
    v_mfma_f32_16x16x32_bf16 v[60:63], a[96:99], v[24:27], v[60:63]
    s_waitcnt vmcnt(11)
    s_barrier
    ds_read_b128 v[20:23], v10 offset:32768
    v_mfma_f32_16x16x32_bf16 v[64:67], a[100:103], v[24:27], v[64:67]
    s_waitcnt lgkmcnt(6)
    v_mfma_f32_16x16x32_bf16 v[52:55], a[104:107], v[28:31], v[52:55]
    ds_read_b128 v[24:27], v10 offset:34816
    s_add_u32 m0, s19, 97280
    v_mfma_f32_16x16x32_bf16 v[56:59], a[108:111], v[28:31], v[56:59]
    buffer_load_dwordx4 v2, s[8:11], s20 offen offset:1024 lds
    s_waitcnt lgkmcnt(6)
    v_mfma_f32_16x16x32_bf16 v[60:63], a[104:107], v[32:35], v[60:63]
    ds_read_b128 v[28:31], v11 offset:32768
    v_mfma_f32_16x16x32_bf16 v[64:67], a[108:111], v[32:35], v[64:67]
    s_waitcnt lgkmcnt(6)
    v_mfma_f32_16x16x32_bf16 v[52:55], a[112:115], v[36:39], v[52:55]
    ds_read_b128 v[32:35], v11 offset:34816
    s_add_u32 m0, s19, 101248
    v_mfma_f32_16x16x32_bf16 v[56:59], a[116:119], v[36:39], v[56:59]
    buffer_load_dwordx4 v2, s[8:11], s20 offen offset:1152 lds
    s_waitcnt lgkmcnt(6)
    v_mfma_f32_16x16x32_bf16 v[60:63], a[112:115], v[40:43], v[60:63]
    ds_read_b128 v[36:39], v10 offset:36864
    v_mfma_f32_16x16x32_bf16 v[64:67], a[116:119], v[40:43], v[64:67]
    s_waitcnt lgkmcnt(6)
    v_mfma_f32_16x16x32_bf16 v[52:55], a[120:123], v[44:47], v[52:55]
    ds_read_b128 v[40:43], v10 offset:38912
    s_add_u32 m0, s19, 105216
    v_mfma_f32_16x16x32_bf16 v[56:59], a[124:127], v[44:47], v[56:59]
    buffer_load_dwordx4 v2, s[8:11], s20 offen offset:1280 lds
    s_waitcnt lgkmcnt(6)
    v_mfma_f32_16x16x32_bf16 v[60:63], a[120:123], v[48:51], v[60:63]
    ds_read_b128 v[44:47], v11 offset:36864
    v_mfma_f32_16x16x32_bf16 v[64:67], a[124:127], v[48:51], v[64:67]
    s_waitcnt lgkmcnt(6)
    v_mfma_f32_16x16x32_bf16 v[52:55], a[128:131], v[20:23], v[52:55]
    ds_read_b128 v[48:51], v11 offset:38912
    v_mfma_f32_16x16x32_bf16 v[56:59], a[132:135], v[20:23], v[56:59]
    s_waitcnt lgkmcnt(6)
    v_mfma_f32_16x16x32_bf16 v[60:63], a[128:131], v[24:27], v[60:63]
    ds_read_b128 v[20:23], v10 offset:40960
    s_add_u32 m0, s19, 109184
    v_mfma_f32_16x16x32_bf16 v[64:67], a[132:135], v[24:27], v[64:67]
    buffer_load_dwordx4 v2, s[8:11], s20 offen offset:1408 lds
    s_waitcnt lgkmcnt(6)
    v_mfma_f32_16x16x32_bf16 v[52:55], a[136:139], v[28:31], v[52:55]
    ds_read_b128 v[24:27], v10 offset:43008
    v_mfma_f32_16x16x32_bf16 v[56:59], a[140:143], v[28:31], v[56:59]
    s_waitcnt lgkmcnt(6)
    v_mfma_f32_16x16x32_bf16 v[60:63], a[136:139], v[32:35], v[60:63]
    ds_read_b128 v[28:31], v11 offset:40960
    s_add_u32 m0, s19, 113152
    v_mfma_f32_16x16x32_bf16 v[64:67], a[140:143], v[32:35], v[64:67]
    buffer_load_dwordx4 v2, s[8:11], s20 offen offset:1536 lds
    s_waitcnt lgkmcnt(6)
    v_mfma_f32_16x16x32_bf16 v[52:55], a[144:147], v[36:39], v[52:55]
    ds_read_b128 v[32:35], v11 offset:43008
    v_mfma_f32_16x16x32_bf16 v[56:59], a[148:151], v[36:39], v[56:59]
    s_waitcnt lgkmcnt(6)
    v_mfma_f32_16x16x32_bf16 v[60:63], a[144:147], v[40:43], v[60:63]
    ds_read_b128 v[36:39], v10 offset:45056
    s_add_u32 m0, s19, 117120
    v_mfma_f32_16x16x32_bf16 v[64:67], a[148:151], v[40:43], v[64:67]
    buffer_load_dwordx4 v2, s[8:11], s20 offen offset:1664 lds
    s_waitcnt lgkmcnt(6)
    v_mfma_f32_16x16x32_bf16 v[52:55], a[152:155], v[44:47], v[52:55]
    ds_read_b128 v[40:43], v10 offset:47104
    v_mfma_f32_16x16x32_bf16 v[56:59], a[156:159], v[44:47], v[56:59]
    s_waitcnt lgkmcnt(6)
    v_mfma_f32_16x16x32_bf16 v[60:63], a[152:155], v[48:51], v[60:63]
    ds_read_b128 v[44:47], v11 offset:45056
    s_add_u32 m0, s19, 121088
    v_mfma_f32_16x16x32_bf16 v[64:67], a[156:159], v[48:51], v[64:67]
    buffer_load_dwordx4 v2, s[8:11], s20 offen offset:1792 lds
    s_waitcnt lgkmcnt(6)
    v_mfma_f32_16x16x32_bf16 v[52:55], a[160:163], v[20:23], v[52:55]
    ds_read_b128 v[48:51], v11 offset:47104
    v_mfma_f32_16x16x32_bf16 v[56:59], a[164:167], v[20:23], v[56:59]
    s_waitcnt lgkmcnt(6)
    v_mfma_f32_16x16x32_bf16 v[60:63], a[160:163], v[24:27], v[60:63]
    ds_read_b128 v[20:23], v10 offset:49152
    s_add_u32 m0, s19, 125056
    v_mfma_f32_16x16x32_bf16 v[64:67], a[164:167], v[24:27], v[64:67]
    buffer_load_dwordx4 v2, s[8:11], s20 offen offset:1920 lds
    s_waitcnt lgkmcnt(6)
    v_mfma_f32_16x16x32_bf16 v[52:55], a[168:171], v[28:31], v[52:55]
    ds_read_b128 v[24:27], v10 offset:51200
    v_mfma_f32_16x16x32_bf16 v[56:59], a[172:175], v[28:31], v[56:59]
    s_add_u32 s20, s20, s24
    s_waitcnt lgkmcnt(6)
    v_mfma_f32_16x16x32_bf16 v[60:63], a[168:171], v[32:35], v[60:63]
    ds_read_b128 v[28:31], v11 offset:49152
    v_mfma_f32_16x16x32_bf16 v[64:67], a[172:175], v[32:35], v[64:67]
    s_waitcnt lgkmcnt(6)
    v_mfma_f32_16x16x32_bf16 v[52:55], a[176:179], v[36:39], v[52:55]
    ds_read_b128 v[32:35], v11 offset:51200
    v_mfma_f32_16x16x32_bf16 v[56:59], a[180:183], v[36:39], v[56:59]
    s_waitcnt lgkmcnt(6)
    v_mfma_f32_16x16x32_bf16 v[60:63], a[176:179], v[40:43], v[60:63]
    ds_read_b128 v[36:39], v10 offset:53248
    v_mfma_f32_16x16x32_bf16 v[64:67], a[180:183], v[40:43], v[64:67]
    s_waitcnt lgkmcnt(6)
    v_mfma_f32_16x16x32_bf16 v[52:55], a[184:187], v[44:47], v[52:55]
    ds_read_b128 v[40:43], v10 offset:55296
    v_mfma_f32_16x16x32_bf16 v[56:59], a[188:191], v[44:47], v[56:59]
    s_waitcnt lgkmcnt(6)
    v_mfma_f32_16x16x32_bf16 v[60:63], a[184:187], v[48:51], v[60:63]
    ds_read_b128 v[44:47], v11 offset:53248
    v_mfma_f32_16x16x32_bf16 v[64:67], a[188:191], v[48:51], v[64:67]
    s_waitcnt lgkmcnt(6)
    v_mfma_f32_16x16x32_bf16 v[52:55], a[192:195], v[20:23], v[52:55]
    ds_read_b128 v[48:51], v11 offset:55296
    v_mfma_f32_16x16x32_bf16 v[56:59], a[196:199], v[20:23], v[56:59]
    s_waitcnt lgkmcnt(6)
    v_mfma_f32_16x16x32_bf16 v[60:63], a[192:195], v[24:27], v[60:63]
    ds_read_b128 v[20:23], v10 offset:57344
    v_mfma_f32_16x16x32_bf16 v[64:67], a[196:199], v[24:27], v[64:67]
    s_waitcnt lgkmcnt(6)
    v_mfma_f32_16x16x32_bf16 v[52:55], a[200:203], v[28:31], v[52:55]
    ds_read_b128 v[24:27], v10 offset:59392
    v_mfma_f32_16x16x32_bf16 v[56:59], a[204:207], v[28:31], v[56:59]
    s_waitcnt lgkmcnt(6)
    v_mfma_f32_16x16x32_bf16 v[60:63], a[200:203], v[32:35], v[60:63]
    ds_read_b128 v[28:31], v11 offset:57344
    v_mfma_f32_16x16x32_bf16 v[64:67], a[204:207], v[32:35], v[64:67]
    s_waitcnt lgkmcnt(6)
    v_mfma_f32_16x16x32_bf16 v[52:55], a[208:211], v[36:39], v[52:55]
    ds_read_b128 v[32:35], v11 offset:59392
    v_mfma_f32_16x16x32_bf16 v[56:59], a[212:215], v[36:39], v[56:59]
    s_waitcnt lgkmcnt(6)
    v_mfma_f32_16x16x32_bf16 v[60:63], a[208:211], v[40:43], v[60:63]
    ds_read_b128 v[36:39], v10 offset:61440
    v_mfma_f32_16x16x32_bf16 v[64:67], a[212:215], v[40:43], v[64:67]
    s_waitcnt lgkmcnt(6)
    v_mfma_f32_16x16x32_bf16 v[52:55], a[216:219], v[44:47], v[52:55]
    ds_read_b128 v[40:43], v10 offset:63488
    v_mfma_f32_16x16x32_bf16 v[56:59], a[220:223], v[44:47], v[56:59]
    s_waitcnt lgkmcnt(6)
    v_mfma_f32_16x16x32_bf16 v[60:63], a[216:219], v[48:51], v[60:63]
    ds_read_b128 v[44:47], v11 offset:61440
    v_mfma_f32_16x16x32_bf16 v[64:67], a[220:223], v[48:51], v[64:67]
    s_waitcnt lgkmcnt(6)
    v_mfma_f32_16x16x32_bf16 v[52:55], a[224:227], v[20:23], v[52:55]
    ds_read_b128 v[48:51], v11 offset:63488
    v_mfma_f32_16x16x32_bf16 v[56:59], a[228:231], v[20:23], v[56:59]
    s_waitcnt lgkmcnt(6)
    v_mfma_f32_16x16x32_bf16 v[60:63], a[224:227], v[24:27], v[60:63]
    s_waitcnt vmcnt(8)
    s_barrier
    ds_read_b128 v[20:23], v12 offset:0
    v_mfma_f32_16x16x32_bf16 v[64:67], a[228:231], v[24:27], v[64:67]
    s_waitcnt lgkmcnt(6)
    v_mfma_f32_16x16x32_bf16 v[52:55], a[232:235], v[28:31], v[52:55]
    ds_read_b128 v[24:27], v12 offset:2048
    s_add_u32 m0, s19, 0
    v_mfma_f32_16x16x32_bf16 v[56:59], a[236:239], v[28:31], v[56:59]
    buffer_load_dwordx4 v2, s[8:11], s20 offen offset:0 lds
    s_waitcnt lgkmcnt(6)
    v_mfma_f32_16x16x32_bf16 v[60:63], a[232:235], v[32:35], v[60:63]
    ds_read_b128 v[28:31], v13 offset:0
    v_mfma_f32_16x16x32_bf16 v[64:67], a[236:239], v[32:35], v[64:67]
    v_mov_b32 v9, s23
    s_add_u32 s23, s23, 1
    buffer_store_dword v9, v4, s[4:7], 0 offen sc1
    s_waitcnt lgkmcnt(6)
    v_mfma_f32_16x16x32_bf16 v[52:55], a[240:243], v[36:39], v[52:55]
    ds_read_b128 v[32:35], v13 offset:2048
    s_add_u32 m0, s19, 3968
    v_mfma_f32_16x16x32_bf16 v[56:59], a[244:247], v[36:39], v[56:59]
    buffer_load_dwordx4 v2, s[8:11], s20 offen offset:128 lds
    s_waitcnt lgkmcnt(6)
    v_mfma_f32_16x16x32_bf16 v[60:63], a[240:243], v[40:43], v[60:63]
    ds_read_b128 v[36:39], v12 offset:4096
    v_mfma_f32_16x16x32_bf16 v[64:67], a[244:247], v[40:43], v[64:67]
    s_waitcnt lgkmcnt(6)
    v_mfma_f32_16x16x32_bf16 v[52:55], a[248:251], v[44:47], v[52:55]
    ds_read_b128 v[40:43], v12 offset:6144
    s_add_u32 m0, s19, 7936
    v_mfma_f32_16x16x32_bf16 v[56:59], a[252:255], v[44:47], v[56:59]
    buffer_load_dwordx4 v2, s[8:11], s20 offen offset:256 lds
    s_waitcnt lgkmcnt(6)
    v_mfma_f32_16x16x32_bf16 v[60:63], a[248:251], v[48:51], v[60:63]
    ds_read_b128 v[44:47], v13 offset:4096
    v_mfma_f32_16x16x32_bf16 v[64:67], a[252:255], v[48:51], v[64:67]
    s_waitcnt lgkmcnt(6)
    v_mfma_f32_16x16x32_bf16 v[68:71], a[0:3], v[20:23], 0
    ds_read_b128 v[48:51], v13 offset:6144
    v_mfma_f32_16x16x32_bf16 v[72:75], a[4:7], v[20:23], 0
    s_waitcnt lgkmcnt(6)
    v_mfma_f32_16x16x32_bf16 v[76:79], a[0:3], v[24:27], 0
    ds_read_b128 v[20:23], v12 offset:8192
    s_add_u32 m0, s19, 11904
    v_mfma_f32_16x16x32_bf16 v[80:83], a[4:7], v[24:27], 0
    buffer_load_dwordx4 v2, s[8:11], s20 offen offset:384 lds
    s_waitcnt lgkmcnt(6)
    v_mfma_f32_16x16x32_bf16 v[68:71], a[8:11], v[28:31], v[68:71]
    ds_read_b128 v[24:27], v12 offset:10240
    v_mfma_f32_16x16x32_bf16 v[72:75], a[12:15], v[28:31], v[72:75]
    s_waitcnt lgkmcnt(6)
    v_mfma_f32_16x16x32_bf16 v[76:79], a[8:11], v[32:35], v[76:79]
    ds_read_b128 v[28:31], v13 offset:8192
    s_add_u32 m0, s19, 15872
    v_mfma_f32_16x16x32_bf16 v[80:83], a[12:15], v[32:35], v[80:83]
    buffer_load_dwordx4 v2, s[8:11], s20 offen offset:512 lds
    s_waitcnt lgkmcnt(6)
    v_mfma_f32_16x16x32_bf16 v[68:71], a[16:19], v[36:39], v[68:71]
    ds_read_b128 v[32:35], v13 offset:10240
    v_mfma_f32_16x16x32_bf16 v[72:75], a[20:23], v[36:39], v[72:75]
    s_waitcnt lgkmcnt(6)
    v_mfma_f32_16x16x32_bf16 v[76:79], a[16:19], v[40:43], v[76:79]
    ds_read_b128 v[36:39], v12 offset:12288
    s_add_u32 m0, s19, 19840
    v_mfma_f32_16x16x32_bf16 v[80:83], a[20:23], v[40:43], v[80:83]
    buffer_load_dwordx4 v2, s[8:11], s20 offen offset:640 lds
    s_waitcnt lgkmcnt(6)
    v_mfma_f32_16x16x32_bf16 v[68:71], a[24:27], v[44:47], v[68:71]
    ds_read_b128 v[40:43], v12 offset:14336
    v_mfma_f32_16x16x32_bf16 v[72:75], a[28:31], v[44:47], v[72:75]
    s_waitcnt lgkmcnt(6)
    v_mfma_f32_16x16x32_bf16 v[76:79], a[24:27], v[48:51], v[76:79]
    ds_read_b128 v[44:47], v13 offset:12288
    s_add_u32 m0, s19, 23808
    v_mfma_f32_16x16x32_bf16 v[80:83], a[28:31], v[48:51], v[80:83]
    buffer_load_dwordx4 v2, s[8:11], s20 offen offset:768 lds
    s_waitcnt lgkmcnt(6)
    v_mfma_f32_16x16x32_bf16 v[68:71], a[32:35], v[20:23], v[68:71]
    ds_read_b128 v[48:51], v13 offset:14336
    v_mfma_f32_16x16x32_bf16 v[72:75], a[36:39], v[20:23], v[72:75]
    s_waitcnt lgkmcnt(6)
    v_mfma_f32_16x16x32_bf16 v[76:79], a[32:35], v[24:27], v[76:79]
    ds_read_b128 v[20:23], v12 offset:16384
    s_add_u32 m0, s19, 27776
    v_mfma_f32_16x16x32_bf16 v[80:83], a[36:39], v[24:27], v[80:83]
    buffer_load_dwordx4 v2, s[8:11], s20 offen offset:896 lds
    s_waitcnt lgkmcnt(6)
    v_mfma_f32_16x16x32_bf16 v[68:71], a[40:43], v[28:31], v[68:71]
    ds_read_b128 v[24:27], v12 offset:18432
    v_mfma_f32_16x16x32_bf16 v[72:75], a[44:47], v[28:31], v[72:75]
    v_cvt_pk_bf16_f32 v84, v52, v53
    s_waitcnt lgkmcnt(6)
    v_mfma_f32_16x16x32_bf16 v[76:79], a[40:43], v[32:35], v[76:79]
    ds_read_b128 v[28:31], v13 offset:16384
    v_mfma_f32_16x16x32_bf16 v[80:83], a[44:47], v[32:35], v[80:83]
    v_cvt_pk_bf16_f32 v85, v54, v55
    s_waitcnt lgkmcnt(6)
    v_mfma_f32_16x16x32_bf16 v[68:71], a[48:51], v[36:39], v[68:71]
    ds_read_b128 v[32:35], v13 offset:18432
    v_mfma_f32_16x16x32_bf16 v[72:75], a[52:55], v[36:39], v[72:75]
    v_cvt_pk_bf16_f32 v86, v56, v57
    s_waitcnt lgkmcnt(6)
    v_mfma_f32_16x16x32_bf16 v[76:79], a[48:51], v[40:43], v[76:79]
    ds_read_b128 v[36:39], v12 offset:20480
    v_mfma_f32_16x16x32_bf16 v[80:83], a[52:55], v[40:43], v[80:83]
    v_cvt_pk_bf16_f32 v87, v58, v59
    s_waitcnt lgkmcnt(6)
    v_mfma_f32_16x16x32_bf16 v[68:71], a[56:59], v[44:47], v[68:71]
    ds_read_b128 v[40:43], v12 offset:22528
    v_mfma_f32_16x16x32_bf16 v[72:75], a[60:63], v[44:47], v[72:75]
    v_cvt_pk_bf16_f32 v88, v60, v61
    s_waitcnt lgkmcnt(6)
    v_mfma_f32_16x16x32_bf16 v[76:79], a[56:59], v[48:51], v[76:79]
    ds_read_b128 v[44:47], v13 offset:20480
    v_mfma_f32_16x16x32_bf16 v[80:83], a[60:63], v[48:51], v[80:83]
    v_cvt_pk_bf16_f32 v89, v62, v63
    buffer_store_dwordx4 v[84:87], v3, s[4:7], s21 offen offset:0 sc1
    s_waitcnt lgkmcnt(6)
    v_mfma_f32_16x16x32_bf16 v[68:71], a[64:67], v[20:23], v[68:71]
    ds_read_b128 v[48:51], v13 offset:22528
    v_mfma_f32_16x16x32_bf16 v[72:75], a[68:71], v[20:23], v[72:75]
    v_cvt_pk_bf16_f32 v90, v64, v65
    s_waitcnt lgkmcnt(6)
    v_mfma_f32_16x16x32_bf16 v[76:79], a[64:67], v[24:27], v[76:79]
    ds_read_b128 v[20:23], v12 offset:24576
    v_mfma_f32_16x16x32_bf16 v[80:83], a[68:71], v[24:27], v[80:83]
    v_cvt_pk_bf16_f32 v91, v66, v67
    s_waitcnt lgkmcnt(6)
    v_mfma_f32_16x16x32_bf16 v[68:71], a[72:75], v[28:31], v[68:71]
    ds_read_b128 v[24:27], v12 offset:26624
    v_mfma_f32_16x16x32_bf16 v[72:75], a[76:79], v[28:31], v[72:75]
    s_waitcnt lgkmcnt(6)
    v_mfma_f32_16x16x32_bf16 v[76:79], a[72:75], v[32:35], v[76:79]
    ds_read_b128 v[28:31], v13 offset:24576
    v_mfma_f32_16x16x32_bf16 v[80:83], a[76:79], v[32:35], v[80:83]
    buffer_store_dwordx4 v[88:91], v3, s[4:7], s21 offen offset:128 sc1
    s_waitcnt lgkmcnt(6)
    v_mfma_f32_16x16x32_bf16 v[68:71], a[80:83], v[36:39], v[68:71]
    ds_read_b128 v[32:35], v13 offset:26624
    v_mfma_f32_16x16x32_bf16 v[72:75], a[84:87], v[36:39], v[72:75]
    s_add_u32 s21, s21, s25
    s_mov_b32 s25, s26
    s_waitcnt lgkmcnt(6)
    v_mfma_f32_16x16x32_bf16 v[76:79], a[80:83], v[40:43], v[76:79]
    ds_read_b128 v[36:39], v12 offset:28672
    v_mfma_f32_16x16x32_bf16 v[80:83], a[84:87], v[40:43], v[80:83]
    s_waitcnt lgkmcnt(6)
    v_mfma_f32_16x16x32_bf16 v[68:71], a[88:91], v[44:47], v[68:71]
    ds_read_b128 v[40:43], v12 offset:30720
    v_mfma_f32_16x16x32_bf16 v[72:75], a[92:95], v[44:47], v[72:75]
    s_waitcnt lgkmcnt(6)
    v_mfma_f32_16x16x32_bf16 v[76:79], a[88:91], v[48:51], v[76:79]
    ds_read_b128 v[44:47], v13 offset:28672
    v_mfma_f32_16x16x32_bf16 v[80:83], a[92:95], v[48:51], v[80:83]
    s_waitcnt lgkmcnt(6)
    v_mfma_f32_16x16x32_bf16 v[68:71], a[96:99], v[20:23], v[68:71]
    ds_read_b128 v[48:51], v13 offset:30720
    v_mfma_f32_16x16x32_bf16 v[72:75], a[100:103], v[20:23], v[72:75]
    s_waitcnt lgkmcnt(6)
    v_mfma_f32_16x16x32_bf16 v[76:79], a[96:99], v[24:27], v[76:79]
    s_waitcnt vmcnt(11)
    s_barrier
    ds_read_b128 v[20:23], v12 offset:32768
    v_mfma_f32_16x16x32_bf16 v[80:83], a[100:103], v[24:27], v[80:83]
    s_waitcnt lgkmcnt(6)
    v_mfma_f32_16x16x32_bf16 v[68:71], a[104:107], v[28:31], v[68:71]
    ds_read_b128 v[24:27], v12 offset:34816
    s_add_u32 m0, s19, 31744
    v_mfma_f32_16x16x32_bf16 v[72:75], a[108:111], v[28:31], v[72:75]
    buffer_load_dwordx4 v2, s[8:11], s20 offen offset:1024 lds
    s_waitcnt lgkmcnt(6)
    v_mfma_f32_16x16x32_bf16 v[76:79], a[104:107], v[32:35], v[76:79]
    ds_read_b128 v[28:31], v13 offset:32768
    v_mfma_f32_16x16x32_bf16 v[80:83], a[108:111], v[32:35], v[80:83]
    s_waitcnt lgkmcnt(6)
    v_mfma_f32_16x16x32_bf16 v[68:71], a[112:115], v[36:39], v[68:71]
    ds_read_b128 v[32:35], v13 offset:34816
    s_add_u32 m0, s19, 35712
    v_mfma_f32_16x16x32_bf16 v[72:75], a[116:119], v[36:39], v[72:75]
    buffer_load_dwordx4 v2, s[8:11], s20 offen offset:1152 lds
    s_waitcnt lgkmcnt(6)
    v_mfma_f32_16x16x32_bf16 v[76:79], a[112:115], v[40:43], v[76:79]
    ds_read_b128 v[36:39], v12 offset:36864
    v_mfma_f32_16x16x32_bf16 v[80:83], a[116:119], v[40:43], v[80:83]
    s_waitcnt lgkmcnt(6)
    v_mfma_f32_16x16x32_bf16 v[68:71], a[120:123], v[44:47], v[68:71]
    ds_read_b128 v[40:43], v12 offset:38912
    s_add_u32 m0, s19, 39680
    v_mfma_f32_16x16x32_bf16 v[72:75], a[124:127], v[44:47], v[72:75]
    buffer_load_dwordx4 v2, s[8:11], s20 offen offset:1280 lds
    s_waitcnt lgkmcnt(6)
    v_mfma_f32_16x16x32_bf16 v[76:79], a[120:123], v[48:51], v[76:79]
    ds_read_b128 v[44:47], v13 offset:36864
    v_mfma_f32_16x16x32_bf16 v[80:83], a[124:127], v[48:51], v[80:83]
    s_waitcnt lgkmcnt(6)
    v_mfma_f32_16x16x32_bf16 v[68:71], a[128:131], v[20:23], v[68:71]
    ds_read_b128 v[48:51], v13 offset:38912
    v_mfma_f32_16x16x32_bf16 v[72:75], a[132:135], v[20:23], v[72:75]
    s_waitcnt lgkmcnt(6)
    v_mfma_f32_16x16x32_bf16 v[76:79], a[128:131], v[24:27], v[76:79]
    ds_read_b128 v[20:23], v12 offset:40960
    s_add_u32 m0, s19, 43648
    v_mfma_f32_16x16x32_bf16 v[80:83], a[132:135], v[24:27], v[80:83]
    buffer_load_dwordx4 v2, s[8:11], s20 offen offset:1408 lds
    s_waitcnt lgkmcnt(6)
    v_mfma_f32_16x16x32_bf16 v[68:71], a[136:139], v[28:31], v[68:71]
    ds_read_b128 v[24:27], v12 offset:43008
    v_mfma_f32_16x16x32_bf16 v[72:75], a[140:143], v[28:31], v[72:75]
    s_waitcnt lgkmcnt(6)
    v_mfma_f32_16x16x32_bf16 v[76:79], a[136:139], v[32:35], v[76:79]
    ds_read_b128 v[28:31], v13 offset:40960
    s_add_u32 m0, s19, 47616
    v_mfma_f32_16x16x32_bf16 v[80:83], a[140:143], v[32:35], v[80:83]
    buffer_load_dwordx4 v2, s[8:11], s20 offen offset:1536 lds
    s_waitcnt lgkmcnt(6)
    v_mfma_f32_16x16x32_bf16 v[68:71], a[144:147], v[36:39], v[68:71]
    ds_read_b128 v[32:35], v13 offset:43008
    v_mfma_f32_16x16x32_bf16 v[72:75], a[148:151], v[36:39], v[72:75]
    s_waitcnt lgkmcnt(6)
    v_mfma_f32_16x16x32_bf16 v[76:79], a[144:147], v[40:43], v[76:79]
    ds_read_b128 v[36:39], v12 offset:45056
    s_add_u32 m0, s19, 51584
    v_mfma_f32_16x16x32_bf16 v[80:83], a[148:151], v[40:43], v[80:83]
    buffer_load_dwordx4 v2, s[8:11], s20 offen offset:1664 lds
    s_waitcnt lgkmcnt(6)
    v_mfma_f32_16x16x32_bf16 v[68:71], a[152:155], v[44:47], v[68:71]
    ds_read_b128 v[40:43], v12 offset:47104
    v_mfma_f32_16x16x32_bf16 v[72:75], a[156:159], v[44:47], v[72:75]
    s_waitcnt lgkmcnt(6)
    v_mfma_f32_16x16x32_bf16 v[76:79], a[152:155], v[48:51], v[76:79]
    ds_read_b128 v[44:47], v13 offset:45056
    s_add_u32 m0, s19, 55552
    v_mfma_f32_16x16x32_bf16 v[80:83], a[156:159], v[48:51], v[80:83]
    buffer_load_dwordx4 v2, s[8:11], s20 offen offset:1792 lds
    s_waitcnt lgkmcnt(6)
    v_mfma_f32_16x16x32_bf16 v[68:71], a[160:163], v[20:23], v[68:71]
    ds_read_b128 v[48:51], v13 offset:47104
    v_mfma_f32_16x16x32_bf16 v[72:75], a[164:167], v[20:23], v[72:75]
    s_waitcnt lgkmcnt(6)
    v_mfma_f32_16x16x32_bf16 v[76:79], a[160:163], v[24:27], v[76:79]
    ds_read_b128 v[20:23], v12 offset:49152
    s_add_u32 m0, s19, 59520
    v_mfma_f32_16x16x32_bf16 v[80:83], a[164:167], v[24:27], v[80:83]
    buffer_load_dwordx4 v2, s[8:11], s20 offen offset:1920 lds
    s_waitcnt lgkmcnt(6)
    v_mfma_f32_16x16x32_bf16 v[68:71], a[168:171], v[28:31], v[68:71]
    ds_read_b128 v[24:27], v12 offset:51200
    v_mfma_f32_16x16x32_bf16 v[72:75], a[172:175], v[28:31], v[72:75]
    s_add_u32 s20, s20, s24
    s_waitcnt lgkmcnt(6)
    v_mfma_f32_16x16x32_bf16 v[76:79], a[168:171], v[32:35], v[76:79]
    ds_read_b128 v[28:31], v13 offset:49152
    v_mfma_f32_16x16x32_bf16 v[80:83], a[172:175], v[32:35], v[80:83]
    s_waitcnt lgkmcnt(6)
    v_mfma_f32_16x16x32_bf16 v[68:71], a[176:179], v[36:39], v[68:71]
    ds_read_b128 v[32:35], v13 offset:51200
    v_mfma_f32_16x16x32_bf16 v[72:75], a[180:183], v[36:39], v[72:75]
    s_waitcnt lgkmcnt(6)
    v_mfma_f32_16x16x32_bf16 v[76:79], a[176:179], v[40:43], v[76:79]
    ds_read_b128 v[36:39], v12 offset:53248
    v_mfma_f32_16x16x32_bf16 v[80:83], a[180:183], v[40:43], v[80:83]
    s_waitcnt lgkmcnt(6)
    v_mfma_f32_16x16x32_bf16 v[68:71], a[184:187], v[44:47], v[68:71]
    ds_read_b128 v[40:43], v12 offset:55296
    v_mfma_f32_16x16x32_bf16 v[72:75], a[188:191], v[44:47], v[72:75]
    s_waitcnt lgkmcnt(6)
    v_mfma_f32_16x16x32_bf16 v[76:79], a[184:187], v[48:51], v[76:79]
    ds_read_b128 v[44:47], v13 offset:53248
    v_mfma_f32_16x16x32_bf16 v[80:83], a[188:191], v[48:51], v[80:83]
    s_waitcnt lgkmcnt(6)
    v_mfma_f32_16x16x32_bf16 v[68:71], a[192:195], v[20:23], v[68:71]
    ds_read_b128 v[48:51], v13 offset:55296
    v_mfma_f32_16x16x32_bf16 v[72:75], a[196:199], v[20:23], v[72:75]
    s_waitcnt lgkmcnt(6)
    v_mfma_f32_16x16x32_bf16 v[76:79], a[192:195], v[24:27], v[76:79]
    ds_read_b128 v[20:23], v12 offset:57344
    v_mfma_f32_16x16x32_bf16 v[80:83], a[196:199], v[24:27], v[80:83]
    s_waitcnt lgkmcnt(6)
    v_mfma_f32_16x16x32_bf16 v[68:71], a[200:203], v[28:31], v[68:71]
    ds_read_b128 v[24:27], v12 offset:59392
    v_mfma_f32_16x16x32_bf16 v[72:75], a[204:207], v[28:31], v[72:75]
    s_waitcnt lgkmcnt(6)
    v_mfma_f32_16x16x32_bf16 v[76:79], a[200:203], v[32:35], v[76:79]
    ds_read_b128 v[28:31], v13 offset:57344
    v_mfma_f32_16x16x32_bf16 v[80:83], a[204:207], v[32:35], v[80:83]
    s_waitcnt lgkmcnt(6)
    v_mfma_f32_16x16x32_bf16 v[68:71], a[208:211], v[36:39], v[68:71]
    ds_read_b128 v[32:35], v13 offset:59392
    v_mfma_f32_16x16x32_bf16 v[72:75], a[212:215], v[36:39], v[72:75]
    s_waitcnt lgkmcnt(6)
    v_mfma_f32_16x16x32_bf16 v[76:79], a[208:211], v[40:43], v[76:79]
    ds_read_b128 v[36:39], v12 offset:61440
    v_mfma_f32_16x16x32_bf16 v[80:83], a[212:215], v[40:43], v[80:83]
    s_waitcnt lgkmcnt(6)
    v_mfma_f32_16x16x32_bf16 v[68:71], a[216:219], v[44:47], v[68:71]
    ds_read_b128 v[40:43], v12 offset:63488
    v_mfma_f32_16x16x32_bf16 v[72:75], a[220:223], v[44:47], v[72:75]
    s_waitcnt lgkmcnt(6)
    v_mfma_f32_16x16x32_bf16 v[76:79], a[216:219], v[48:51], v[76:79]
    ds_read_b128 v[44:47], v13 offset:61440
    v_mfma_f32_16x16x32_bf16 v[80:83], a[220:223], v[48:51], v[80:83]
    s_waitcnt lgkmcnt(6)
    v_mfma_f32_16x16x32_bf16 v[68:71], a[224:227], v[20:23], v[68:71]
    ds_read_b128 v[48:51], v13 offset:63488
    v_mfma_f32_16x16x32_bf16 v[72:75], a[228:231], v[20:23], v[72:75]
    s_waitcnt lgkmcnt(6)
    v_mfma_f32_16x16x32_bf16 v[76:79], a[224:227], v[24:27], v[76:79]
    s_waitcnt vmcnt(8)
    s_barrier
    ds_read_b128 v[20:23], v10 offset:0
    v_mfma_f32_16x16x32_bf16 v[80:83], a[228:231], v[24:27], v[80:83]
    s_waitcnt lgkmcnt(6)
    v_mfma_f32_16x16x32_bf16 v[68:71], a[232:235], v[28:31], v[68:71]
    ds_read_b128 v[24:27], v10 offset:2048
    s_add_u32 m0, s19, 65536
    v_mfma_f32_16x16x32_bf16 v[72:75], a[236:239], v[28:31], v[72:75]
    buffer_load_dwordx4 v2, s[8:11], s20 offen offset:0 lds
    s_waitcnt lgkmcnt(6)
    v_mfma_f32_16x16x32_bf16 v[76:79], a[232:235], v[32:35], v[76:79]
    ds_read_b128 v[28:31], v11 offset:0
    v_mfma_f32_16x16x32_bf16 v[80:83], a[236:239], v[32:35], v[80:83]
    v_mov_b32 v9, s23
    s_add_u32 s23, s23, 1
    buffer_store_dword v9, v4, s[4:7], 0 offen sc1
    s_waitcnt lgkmcnt(6)
    v_mfma_f32_16x16x32_bf16 v[68:71], a[240:243], v[36:39], v[68:71]
    ds_read_b128 v[32:35], v11 offset:2048
    s_add_u32 m0, s19, 69504
    v_mfma_f32_16x16x32_bf16 v[72:75], a[244:247], v[36:39], v[72:75]
    buffer_load_dwordx4 v2, s[8:11], s20 offen offset:128 lds
    s_waitcnt lgkmcnt(6)
    v_mfma_f32_16x16x32_bf16 v[76:79], a[240:243], v[40:43], v[76:79]
    ds_read_b128 v[36:39], v10 offset:4096
    v_mfma_f32_16x16x32_bf16 v[80:83], a[244:247], v[40:43], v[80:83]
    s_waitcnt lgkmcnt(6)
    v_mfma_f32_16x16x32_bf16 v[68:71], a[248:251], v[44:47], v[68:71]
    ds_read_b128 v[40:43], v10 offset:6144
    s_add_u32 m0, s19, 73472
    v_mfma_f32_16x16x32_bf16 v[72:75], a[252:255], v[44:47], v[72:75]
    buffer_load_dwordx4 v2, s[8:11], s20 offen offset:256 lds
    s_waitcnt lgkmcnt(6)
    v_mfma_f32_16x16x32_bf16 v[76:79], a[248:251], v[48:51], v[76:79]
    ds_read_b128 v[44:47], v11 offset:4096
    v_mfma_f32_16x16x32_bf16 v[80:83], a[252:255], v[48:51], v[80:83]
    s_add_u32 s22, s22, 2
    s_cmp_lt_u32 s22, 64
    s_cbranch_scc1 P_qk_top
    v_cvt_pk_bf16_f32 v84, v68, v69
    v_cvt_pk_bf16_f32 v85, v70, v71
    v_cvt_pk_bf16_f32 v86, v72, v73
    v_cvt_pk_bf16_f32 v87, v74, v75
    v_cvt_pk_bf16_f32 v88, v76, v77
    v_cvt_pk_bf16_f32 v89, v78, v79
    v_cvt_pk_bf16_f32 v90, v80, v81
    v_cvt_pk_bf16_f32 v91, v82, v83
    buffer_store_dwordx4 v[84:87], v3, s[4:7], s21 offen offset:0 sc1
    buffer_store_dwordx4 v[88:91], v3, s[4:7], s21 offen offset:128 sc1
    s_waitcnt vmcnt(0) lgkmcnt(0)
    v_mov_b32 v9, s23
    s_add_u32 s23, s23, 1
    buffer_store_dword v9, v4, s[4:7], 0 offen sc1
    s_branch W_U
P_v:
    s_mov_b32 s26, s25
    s_sub_u32 s25, s21, 1073741824
    s_mov_b32 s21, 1073741824
    s_mov_b32 s23, 0
    s_mov_b32 s22, 0
    s_add_u32 m0, s19, 0
    s_nop 0
    buffer_load_dwordx4 v2, s[8:11], s20 offen offset:0 lds
    s_add_u32 m0, s19, 3968
    s_nop 0
    buffer_load_dwordx4 v2, s[8:11], s20 offen offset:128 lds
    s_add_u32 m0, s19, 7936
    s_nop 0
    buffer_load_dwordx4 v2, s[8:11], s20 offen offset:256 lds
    s_add_u32 m0, s19, 11904
    s_nop 0
    buffer_load_dwordx4 v2, s[8:11], s20 offen offset:384 lds
    s_add_u32 m0, s19, 15872
    s_nop 0
    buffer_load_dwordx4 v2, s[8:11], s20 offen offset:512 lds
    s_add_u32 m0, s19, 19840
    s_nop 0
    buffer_load_dwordx4 v2, s[8:11], s20 offen offset:640 lds
    s_add_u32 m0, s19, 23808
    s_nop 0
    buffer_load_dwordx4 v2, s[8:11], s20 offen offset:768 lds
    s_add_u32 m0, s19, 27776
    s_nop 0
    buffer_load_dwordx4 v2, s[8:11], s20 offen offset:896 lds
    s_add_u32 m0, s19, 31744
    s_nop 0
    buffer_load_dwordx4 v2, s[8:11], s20 offen offset:1024 lds
    s_add_u32 m0, s19, 35712
    s_nop 0
    buffer_load_dwordx4 v2, s[8:11], s20 offen offset:1152 lds
    s_add_u32 m0, s19, 39680
    s_nop 0
    buffer_load_dwordx4 v2, s[8:11], s20 offen offset:1280 lds
    s_add_u32 m0, s19, 43648
    s_nop 0
    buffer_load_dwordx4 v2, s[8:11], s20 offen offset:1408 lds
    s_add_u32 m0, s19, 47616
    s_nop 0
    buffer_load_dwordx4 v2, s[8:11], s20 offen offset:1536 lds
    s_add_u32 m0, s19, 51584
    s_nop 0
    buffer_load_dwordx4 v2, s[8:11], s20 offen offset:1664 lds
    s_add_u32 m0, s19, 55552
    s_nop 0
    buffer_load_dwordx4 v2, s[8:11], s20 offen offset:1792 lds
    s_add_u32 m0, s19, 59520
    s_nop 0
    buffer_load_dwordx4 v2, s[8:11], s20 offen offset:1920 lds
    s_add_u32 s20, s20, s24
    s_add_u32 m0, s19, 65536
    s_nop 0
    buffer_load_dwordx4 v2, s[8:11], s20 offen offset:0 lds
    s_add_u32 m0, s19, 69504
    s_nop 0
    buffer_load_dwordx4 v2, s[8:11], s20 offen offset:128 lds
    s_add_u32 m0, s19, 73472
    s_nop 0
    buffer_load_dwordx4 v2, s[8:11], s20 offen offset:256 lds
    v_mov_b32 v9, s23
    s_add_u32 s23, s23, 1
    buffer_store_dword v9, v4, s[4:7], 0 offen sc1
    s_mov_b32 s23, 0
    s_waitcnt vmcnt(12)
    s_barrier
    ds_read_b128 v[20:23], v10 offset:0
    ds_read_b128 v[24:27], v10 offset:2048
    ds_read_b128 v[28:31], v11 offset:0
    ds_read_b128 v[32:35], v11 offset:2048
    ds_read_b128 v[36:39], v10 offset:4096
    ds_read_b128 v[40:43], v10 offset:6144
    ds_read_b128 v[44:47], v11 offset:4096
.p2align 6
P_v_top:
    s_waitcnt lgkmcnt(6)
    v_mfma_f32_16x16x32_bf16 v[52:55], v[20:23], a[0:3], 0
    ds_read_b128 v[48:51], v11 offset:6144
    v_mfma_f32_16x16x32_bf16 v[60:63], v[20:23], a[4:7], 0
    s_waitcnt lgkmcnt(6)
    v_mfma_f32_16x16x32_bf16 v[56:59], v[24:27], a[0:3], 0
    ds_read_b128 v[20:23], v10 offset:8192
    s_add_u32 m0, s19, 77440
    v_mfma_f32_16x16x32_bf16 v[64:67], v[24:27], a[4:7], 0
    buffer_load_dwordx4 v2, s[8:11], s20 offen offset:384 lds
    s_waitcnt lgkmcnt(6)
    v_mfma_f32_16x16x32_bf16 v[52:55], v[28:31], a[8:11], v[52:55]
    ds_read_b128 v[24:27], v10 offset:10240
    v_mfma_f32_16x16x32_bf16 v[60:63], v[28:31], a[12:15], v[60:63]
    s_waitcnt lgkmcnt(6)
    v_mfma_f32_16x16x32_bf16 v[56:59], v[32:35], a[8:11], v[56:59]
    ds_read_b128 v[28:31], v11 offset:8192
    s_add_u32 m0, s19, 81408
    v_mfma_f32_16x16x32_bf16 v[64:67], v[32:35], a[12:15], v[64:67]
    buffer_load_dwordx4 v2, s[8:11], s20 offen offset:512 lds
    s_waitcnt lgkmcnt(6)
    v_mfma_f32_16x16x32_bf16 v[52:55], v[36:39], a[16:19], v[52:55]
    ds_read_b128 v[32:35], v11 offset:10240
    v_mfma_f32_16x16x32_bf16 v[60:63], v[36:39], a[20:23], v[60:63]
    s_waitcnt lgkmcnt(6)
    v_mfma_f32_16x16x32_bf16 v[56:59], v[40:43], a[16:19], v[56:59]
    ds_read_b128 v[36:39], v10 offset:12288
    s_add_u32 m0, s19, 85376
    v_mfma_f32_16x16x32_bf16 v[64:67], v[40:43], a[20:23], v[64:67]
    buffer_load_dwordx4 v2, s[8:11], s20 offen offset:640 lds
    s_waitcnt lgkmcnt(6)
    v_mfma_f32_16x16x32_bf16 v[52:55], v[44:47], a[24:27], v[52:55]
    ds_read_b128 v[40:43], v10 offset:14336
    v_mfma_f32_16x16x32_bf16 v[60:63], v[44:47], a[28:31], v[60:63]
    s_waitcnt lgkmcnt(6)
    v_mfma_f32_16x16x32_bf16 v[56:59], v[48:51], a[24:27], v[56:59]
    ds_read_b128 v[44:47], v11 offset:12288
    s_add_u32 m0, s19, 89344
    v_mfma_f32_16x16x32_bf16 v[64:67], v[48:51], a[28:31], v[64:67]
    buffer_load_dwordx4 v2, s[8:11], s20 offen offset:768 lds
    s_waitcnt lgkmcnt(6)
    v_mfma_f32_16x16x32_bf16 v[52:55], v[20:23], a[32:35], v[52:55]
    ds_read_b128 v[48:51], v11 offset:14336
    v_mfma_f32_16x16x32_bf16 v[60:63], v[20:23], a[36:39], v[60:63]
    s_waitcnt lgkmcnt(6)
    v_mfma_f32_16x16x32_bf16 v[56:59], v[24:27], a[32:35], v[56:59]
    ds_read_b128 v[20:23], v10 offset:16384
    s_add_u32 m0, s19, 93312
    v_mfma_f32_16x16x32_bf16 v[64:67], v[24:27], a[36:39], v[64:67]
    buffer_load_dwordx4 v2, s[8:11], s20 offen offset:896 lds
    s_waitcnt lgkmcnt(6)
    v_mfma_f32_16x16x32_bf16 v[52:55], v[28:31], a[40:43], v[52:55]
    ds_read_b128 v[24:27], v10 offset:18432
    v_mfma_f32_16x16x32_bf16 v[60:63], v[28:31], a[44:47], v[60:63]
    v_cvt_pk_bf16_f32 v84, v68, v69
    s_waitcnt lgkmcnt(6)
    v_mfma_f32_16x16x32_bf16 v[56:59], v[32:35], a[40:43], v[56:59]
    ds_read_b128 v[28:31], v11 offset:16384
    v_mfma_f32_16x16x32_bf16 v[64:67], v[32:35], a[44:47], v[64:67]
    v_cvt_pk_bf16_f32 v85, v70, v71
    s_waitcnt lgkmcnt(6)
    v_mfma_f32_16x16x32_bf16 v[52:55], v[36:39], a[48:51], v[52:55]
    ds_read_b128 v[32:35], v11 offset:18432
    v_mfma_f32_16x16x32_bf16 v[60:63], v[36:39], a[52:55], v[60:63]
    v_cvt_pk_bf16_f32 v86, v72, v73
    s_waitcnt lgkmcnt(6)
    v_mfma_f32_16x16x32_bf16 v[56:59], v[40:43], a[48:51], v[56:59]
    ds_read_b128 v[36:39], v10 offset:20480
    v_mfma_f32_16x16x32_bf16 v[64:67], v[40:43], a[52:55], v[64:67]
    v_cvt_pk_bf16_f32 v87, v74, v75
    s_waitcnt lgkmcnt(6)
    v_mfma_f32_16x16x32_bf16 v[52:55], v[44:47], a[56:59], v[52:55]
    ds_read_b128 v[40:43], v10 offset:22528
    v_mfma_f32_16x16x32_bf16 v[60:63], v[44:47], a[60:63], v[60:63]
    v_cvt_pk_bf16_f32 v88, v76, v77
    s_waitcnt lgkmcnt(6)
    v_mfma_f32_16x16x32_bf16 v[56:59], v[48:51], a[56:59], v[56:59]
    ds_read_b128 v[44:47], v11 offset:20480
    v_mfma_f32_16x16x32_bf16 v[64:67], v[48:51], a[60:63], v[64:67]
    v_cvt_pk_bf16_f32 v89, v78, v79
    buffer_store_dwordx4 v[84:87], v3, s[4:7], s21 offen offset:0 sc1
    s_waitcnt lgkmcnt(6)
    v_mfma_f32_16x16x32_bf16 v[52:55], v[20:23], a[64:67], v[52:55]
    ds_read_b128 v[48:51], v11 offset:22528
    v_mfma_f32_16x16x32_bf16 v[60:63], v[20:23], a[68:71], v[60:63]
    v_cvt_pk_bf16_f32 v90, v80, v81
    s_waitcnt lgkmcnt(6)
    v_mfma_f32_16x16x32_bf16 v[56:59], v[24:27], a[64:67], v[56:59]
    ds_read_b128 v[20:23], v10 offset:24576
    v_mfma_f32_16x16x32_bf16 v[64:67], v[24:27], a[68:71], v[64:67]
    v_cvt_pk_bf16_f32 v91, v82, v83
    s_waitcnt lgkmcnt(6)
    v_mfma_f32_16x16x32_bf16 v[52:55], v[28:31], a[72:75], v[52:55]
    ds_read_b128 v[24:27], v10 offset:26624
    v_mfma_f32_16x16x32_bf16 v[60:63], v[28:31], a[76:79], v[60:63]
    s_waitcnt lgkmcnt(6)
    v_mfma_f32_16x16x32_bf16 v[56:59], v[32:35], a[72:75], v[56:59]
    ds_read_b128 v[28:31], v11 offset:24576
    v_mfma_f32_16x16x32_bf16 v[64:67], v[32:35], a[76:79], v[64:67]
    buffer_store_dwordx4 v[88:91], v3, s[4:7], s21 offen offset:128 sc1
    s_waitcnt lgkmcnt(6)
    v_mfma_f32_16x16x32_bf16 v[52:55], v[36:39], a[80:83], v[52:55]
    ds_read_b128 v[32:35], v11 offset:26624
    v_mfma_f32_16x16x32_bf16 v[60:63], v[36:39], a[84:87], v[60:63]
    s_add_u32 s21, s21, s25
    s_mov_b32 s25, s26
    s_waitcnt lgkmcnt(6)
    v_mfma_f32_16x16x32_bf16 v[56:59], v[40:43], a[80:83], v[56:59]
    ds_read_b128 v[36:39], v10 offset:28672
    v_mfma_f32_16x16x32_bf16 v[64:67], v[40:43], a[84:87], v[64:67]
    s_waitcnt lgkmcnt(6)
    v_mfma_f32_16x16x32_bf16 v[52:55], v[44:47], a[88:91], v[52:55]
    ds_read_b128 v[40:43], v10 offset:30720
    v_mfma_f32_16x16x32_bf16 v[60:63], v[44:47], a[92:95], v[60:63]
    s_waitcnt lgkmcnt(6)
    v_mfma_f32_16x16x32_bf16 v[56:59], v[48:51], a[88:91], v[56:59]
    ds_read_b128 v[44:47], v11 offset:28672
    v_mfma_f32_16x16x32_bf16 v[64:67], v[48:51], a[92:95], v[64:67]
    s_waitcnt lgkmcnt(6)
    v_mfma_f32_16x16x32_bf16 v[52:55], v[20:23], a[96:99], v[52:55]
    ds_read_b128 v[48:51], v11 offset:30720
    v_mfma_f32_16x16x32_bf16 v[60:63], v[20:23], a[100:103], v[60:63]
    s_waitcnt lgkmcnt(6)
    v_mfma_f32_16x16x32_bf16 v[56:59], v[24:27], a[96:99], v[56:59]
    s_waitcnt vmcnt(11)
    s_barrier
    ds_read_b128 v[20:23], v10 offset:32768
    v_mfma_f32_16x16x32_bf16 v[64:67], v[24:27], a[100:103], v[64:67]
    s_waitcnt lgkmcnt(6)
    v_mfma_f32_16x16x32_bf16 v[52:55], v[28:31], a[104:107], v[52:55]
    ds_read_b128 v[24:27], v10 offset:34816
    s_add_u32 m0, s19, 97280
    v_mfma_f32_16x16x32_bf16 v[60:63], v[28:31], a[108:111], v[60:63]
    buffer_load_dwordx4 v2, s[8:11], s20 offen offset:1024 lds
    s_waitcnt lgkmcnt(6)
    v_mfma_f32_16x16x32_bf16 v[56:59], v[32:35], a[104:107], v[56:59]
    ds_read_b128 v[28:31], v11 offset:32768
    v_mfma_f32_16x16x32_bf16 v[64:67], v[32:35], a[108:111], v[64:67]
    s_waitcnt lgkmcnt(6)
    v_mfma_f32_16x16x32_bf16 v[52:55], v[36:39], a[112:115], v[52:55]
    ds_read_b128 v[32:35], v11 offset:34816
    s_add_u32 m0, s19, 101248
    v_mfma_f32_16x16x32_bf16 v[60:63], v[36:39], a[116:119], v[60:63]
    buffer_load_dwordx4 v2, s[8:11], s20 offen offset:1152 lds
    s_waitcnt lgkmcnt(6)
    v_mfma_f32_16x16x32_bf16 v[56:59], v[40:43], a[112:115], v[56:59]
    ds_read_b128 v[36:39], v10 offset:36864
    v_mfma_f32_16x16x32_bf16 v[64:67], v[40:43], a[116:119], v[64:67]
    s_waitcnt lgkmcnt(6)
    v_mfma_f32_16x16x32_bf16 v[52:55], v[44:47], a[120:123], v[52:55]
    ds_read_b128 v[40:43], v10 offset:38912
    s_add_u32 m0, s19, 105216
    v_mfma_f32_16x16x32_bf16 v[60:63], v[44:47], a[124:127], v[60:63]
    buffer_load_dwordx4 v2, s[8:11], s20 offen offset:1280 lds
    s_waitcnt lgkmcnt(6)
    v_mfma_f32_16x16x32_bf16 v[56:59], v[48:51], a[120:123], v[56:59]
    ds_read_b128 v[44:47], v11 offset:36864
    v_mfma_f32_16x16x32_bf16 v[64:67], v[48:51], a[124:127], v[64:67]
    s_waitcnt lgkmcnt(6)
    v_mfma_f32_16x16x32_bf16 v[52:55], v[20:23], a[128:131], v[52:55]
    ds_read_b128 v[48:51], v11 offset:38912
    v_mfma_f32_16x16x32_bf16 v[60:63], v[20:23], a[132:135], v[60:63]
    s_waitcnt lgkmcnt(6)
    v_mfma_f32_16x16x32_bf16 v[56:59], v[24:27], a[128:131], v[56:59]
    ds_read_b128 v[20:23], v10 offset:40960
    s_add_u32 m0, s19, 109184
    v_mfma_f32_16x16x32_bf16 v[64:67], v[24:27], a[132:135], v[64:67]
    buffer_load_dwordx4 v2, s[8:11], s20 offen offset:1408 lds
    s_waitcnt lgkmcnt(6)
    v_mfma_f32_16x16x32_bf16 v[52:55], v[28:31], a[136:139], v[52:55]
    ds_read_b128 v[24:27], v10 offset:43008
    v_mfma_f32_16x16x32_bf16 v[60:63], v[28:31], a[140:143], v[60:63]
    s_waitcnt lgkmcnt(6)
    v_mfma_f32_16x16x32_bf16 v[56:59], v[32:35], a[136:139], v[56:59]
    ds_read_b128 v[28:31], v11 offset:40960
    s_add_u32 m0, s19, 113152
    v_mfma_f32_16x16x32_bf16 v[64:67], v[32:35], a[140:143], v[64:67]
    buffer_load_dwordx4 v2, s[8:11], s20 offen offset:1536 lds
    s_waitcnt lgkmcnt(6)
    v_mfma_f32_16x16x32_bf16 v[52:55], v[36:39], a[144:147], v[52:55]
    ds_read_b128 v[32:35], v11 offset:43008
    v_mfma_f32_16x16x32_bf16 v[60:63], v[36:39], a[148:151], v[60:63]
    s_waitcnt lgkmcnt(6)
    v_mfma_f32_16x16x32_bf16 v[56:59], v[40:43], a[144:147], v[56:59]
    ds_read_b128 v[36:39], v10 offset:45056
    s_add_u32 m0, s19, 117120
    v_mfma_f32_16x16x32_bf16 v[64:67], v[40:43], a[148:151], v[64:67]
    buffer_load_dwordx4 v2, s[8:11], s20 offen offset:1664 lds
    s_waitcnt lgkmcnt(6)
    v_mfma_f32_16x16x32_bf16 v[52:55], v[44:47], a[152:155], v[52:55]
    ds_read_b128 v[40:43], v10 offset:47104
    v_mfma_f32_16x16x32_bf16 v[60:63], v[44:47], a[156:159], v[60:63]
    s_waitcnt lgkmcnt(6)
    v_mfma_f32_16x16x32_bf16 v[56:59], v[48:51], a[152:155], v[56:59]
    ds_read_b128 v[44:47], v11 offset:45056
    s_add_u32 m0, s19, 121088
    v_mfma_f32_16x16x32_bf16 v[64:67], v[48:51], a[156:159], v[64:67]
    buffer_load_dwordx4 v2, s[8:11], s20 offen offset:1792 lds
    s_waitcnt lgkmcnt(6)
    v_mfma_f32_16x16x32_bf16 v[52:55], v[20:23], a[160:163], v[52:55]
    ds_read_b128 v[48:51], v11 offset:47104
    v_mfma_f32_16x16x32_bf16 v[60:63], v[20:23], a[164:167], v[60:63]
    s_waitcnt lgkmcnt(6)
    v_mfma_f32_16x16x32_bf16 v[56:59], v[24:27], a[160:163], v[56:59]
    ds_read_b128 v[20:23], v10 offset:49152
    s_add_u32 m0, s19, 125056
    v_mfma_f32_16x16x32_bf16 v[64:67], v[24:27], a[164:167], v[64:67]
    buffer_load_dwordx4 v2, s[8:11], s20 offen offset:1920 lds
    s_waitcnt lgkmcnt(6)
    v_mfma_f32_16x16x32_bf16 v[52:55], v[28:31], a[168:171], v[52:55]
    ds_read_b128 v[24:27], v10 offset:51200
    v_mfma_f32_16x16x32_bf16 v[60:63], v[28:31], a[172:175], v[60:63]
    s_add_u32 s20, s20, s24
    s_waitcnt lgkmcnt(6)
    v_mfma_f32_16x16x32_bf16 v[56:59], v[32:35], a[168:171], v[56:59]
    ds_read_b128 v[28:31], v11 offset:49152
    v_mfma_f32_16x16x32_bf16 v[64:67], v[32:35], a[172:175], v[64:67]
    s_waitcnt lgkmcnt(6)
    v_mfma_f32_16x16x32_bf16 v[52:55], v[36:39], a[176:179], v[52:55]
    ds_read_b128 v[32:35], v11 offset:51200
    v_mfma_f32_16x16x32_bf16 v[60:63], v[36:39], a[180:183], v[60:63]
    s_waitcnt lgkmcnt(6)
    v_mfma_f32_16x16x32_bf16 v[56:59], v[40:43], a[176:179], v[56:59]
    ds_read_b128 v[36:39], v10 offset:53248
    v_mfma_f32_16x16x32_bf16 v[64:67], v[40:43], a[180:183], v[64:67]
    s_waitcnt lgkmcnt(6)
    v_mfma_f32_16x16x32_bf16 v[52:55], v[44:47], a[184:187], v[52:55]
    ds_read_b128 v[40:43], v10 offset:55296
    v_mfma_f32_16x16x32_bf16 v[60:63], v[44:47], a[188:191], v[60:63]
    s_waitcnt lgkmcnt(6)
    v_mfma_f32_16x16x32_bf16 v[56:59], v[48:51], a[184:187], v[56:59]
    ds_read_b128 v[44:47], v11 offset:53248
    v_mfma_f32_16x16x32_bf16 v[64:67], v[48:51], a[188:191], v[64:67]
    s_waitcnt lgkmcnt(6)
    v_mfma_f32_16x16x32_bf16 v[52:55], v[20:23], a[192:195], v[52:55]
    ds_read_b128 v[48:51], v11 offset:55296
    v_mfma_f32_16x16x32_bf16 v[60:63], v[20:23], a[196:199], v[60:63]
    s_waitcnt lgkmcnt(6)
    v_mfma_f32_16x16x32_bf16 v[56:59], v[24:27], a[192:195], v[56:59]
    ds_read_b128 v[20:23], v10 offset:57344
    v_mfma_f32_16x16x32_bf16 v[64:67], v[24:27], a[196:199], v[64:67]
    s_waitcnt lgkmcnt(6)
    v_mfma_f32_16x16x32_bf16 v[52:55], v[28:31], a[200:203], v[52:55]
    ds_read_b128 v[24:27], v10 offset:59392
    v_mfma_f32_16x16x32_bf16 v[60:63], v[28:31], a[204:207], v[60:63]
    s_waitcnt lgkmcnt(6)
    v_mfma_f32_16x16x32_bf16 v[56:59], v[32:35], a[200:203], v[56:59]
    ds_read_b128 v[28:31], v11 offset:57344
    v_mfma_f32_16x16x32_bf16 v[64:67], v[32:35], a[204:207], v[64:67]
    s_waitcnt lgkmcnt(6)
    v_mfma_f32_16x16x32_bf16 v[52:55], v[36:39], a[208:211], v[52:55]
    ds_read_b128 v[32:35], v11 offset:59392
    v_mfma_f32_16x16x32_bf16 v[60:63], v[36:39], a[212:215], v[60:63]
    s_waitcnt lgkmcnt(6)
    v_mfma_f32_16x16x32_bf16 v[56:59], v[40:43], a[208:211], v[56:59]
    ds_read_b128 v[36:39], v10 offset:61440
    v_mfma_f32_16x16x32_bf16 v[64:67], v[40:43], a[212:215], v[64:67]
    s_waitcnt lgkmcnt(6)
    v_mfma_f32_16x16x32_bf16 v[52:55], v[44:47], a[216:219], v[52:55]
    ds_read_b128 v[40:43], v10 offset:63488
    v_mfma_f32_16x16x32_bf16 v[60:63], v[44:47], a[220:223], v[60:63]
    s_waitcnt lgkmcnt(6)
    v_mfma_f32_16x16x32_bf16 v[56:59], v[48:51], a[216:219], v[56:59]
    ds_read_b128 v[44:47], v11 offset:61440
    v_mfma_f32_16x16x32_bf16 v[64:67], v[48:51], a[220:223], v[64:67]
    s_waitcnt lgkmcnt(6)
    v_mfma_f32_16x16x32_bf16 v[52:55], v[20:23], a[224:227], v[52:55]
    ds_read_b128 v[48:51], v11 offset:63488
    v_mfma_f32_16x16x32_bf16 v[60:63], v[20:23], a[228:231], v[60:63]
    s_waitcnt lgkmcnt(6)
    v_mfma_f32_16x16x32_bf16 v[56:59], v[24:27], a[224:227], v[56:59]
    s_waitcnt vmcnt(8)
    s_barrier
    ds_read_b128 v[20:23], v12 offset:0
    v_mfma_f32_16x16x32_bf16 v[64:67], v[24:27], a[228:231], v[64:67]
    s_waitcnt lgkmcnt(6)
    v_mfma_f32_16x16x32_bf16 v[52:55], v[28:31], a[232:235], v[52:55]
    ds_read_b128 v[24:27], v12 offset:2048
    s_add_u32 m0, s19, 0
    v_mfma_f32_16x16x32_bf16 v[60:63], v[28:31], a[236:239], v[60:63]
    buffer_load_dwordx4 v2, s[8:11], s20 offen offset:0 lds
    s_waitcnt lgkmcnt(6)
    v_mfma_f32_16x16x32_bf16 v[56:59], v[32:35], a[232:235], v[56:59]
    ds_read_b128 v[28:31], v13 offset:0
    v_mfma_f32_16x16x32_bf16 v[64:67], v[32:35], a[236:239], v[64:67]
    v_mov_b32 v9, s23
    s_add_u32 s23, s23, 1
    buffer_store_dword v9, v4, s[4:7], 0 offen sc1
    s_waitcnt lgkmcnt(6)
    v_mfma_f32_16x16x32_bf16 v[52:55], v[36:39], a[240:243], v[52:55]
    ds_read_b128 v[32:35], v13 offset:2048
    s_add_u32 m0, s19, 3968
    v_mfma_f32_16x16x32_bf16 v[60:63], v[36:39], a[244:247], v[60:63]
    buffer_load_dwordx4 v2, s[8:11], s20 offen offset:128 lds
    s_waitcnt lgkmcnt(6)
    v_mfma_f32_16x16x32_bf16 v[56:59], v[40:43], a[240:243], v[56:59]
    ds_read_b128 v[36:39], v12 offset:4096
    v_mfma_f32_16x16x32_bf16 v[64:67], v[40:43], a[244:247], v[64:67]
    s_waitcnt lgkmcnt(6)
    v_mfma_f32_16x16x32_bf16 v[52:55], v[44:47], a[248:251], v[52:55]
    ds_read_b128 v[40:43], v12 offset:6144
    s_add_u32 m0, s19, 7936
    v_mfma_f32_16x16x32_bf16 v[60:63], v[44:47], a[252:255], v[60:63]
    buffer_load_dwordx4 v2, s[8:11], s20 offen offset:256 lds
    s_waitcnt lgkmcnt(6)
    v_mfma_f32_16x16x32_bf16 v[56:59], v[48:51], a[248:251], v[56:59]
    ds_read_b128 v[44:47], v13 offset:4096
    v_mfma_f32_16x16x32_bf16 v[64:67], v[48:51], a[252:255], v[64:67]
    s_waitcnt lgkmcnt(6)
    v_mfma_f32_16x16x32_bf16 v[68:71], v[20:23], a[0:3], 0
    ds_read_b128 v[48:51], v13 offset:6144
    v_mfma_f32_16x16x32_bf16 v[76:79], v[20:23], a[4:7], 0
    s_waitcnt lgkmcnt(6)
    v_mfma_f32_16x16x32_bf16 v[72:75], v[24:27], a[0:3], 0
    ds_read_b128 v[20:23], v12 offset:8192
    s_add_u32 m0, s19, 11904
    v_mfma_f32_16x16x32_bf16 v[80:83], v[24:27], a[4:7], 0
    buffer_load_dwordx4 v2, s[8:11], s20 offen offset:384 lds
    s_waitcnt lgkmcnt(6)
    v_mfma_f32_16x16x32_bf16 v[68:71], v[28:31], a[8:11], v[68:71]
    ds_read_b128 v[24:27], v12 offset:10240
    v_mfma_f32_16x16x32_bf16 v[76:79], v[28:31], a[12:15], v[76:79]
    s_waitcnt lgkmcnt(6)
    v_mfma_f32_16x16x32_bf16 v[72:75], v[32:35], a[8:11], v[72:75]
    ds_read_b128 v[28:31], v13 offset:8192
    s_add_u32 m0, s19, 15872
    v_mfma_f32_16x16x32_bf16 v[80:83], v[32:35], a[12:15], v[80:83]
    buffer_load_dwordx4 v2, s[8:11], s20 offen offset:512 lds
    s_waitcnt lgkmcnt(6)
    v_mfma_f32_16x16x32_bf16 v[68:71], v[36:39], a[16:19], v[68:71]
    ds_read_b128 v[32:35], v13 offset:10240
    v_mfma_f32_16x16x32_bf16 v[76:79], v[36:39], a[20:23], v[76:79]
    s_waitcnt lgkmcnt(6)
    v_mfma_f32_16x16x32_bf16 v[72:75], v[40:43], a[16:19], v[72:75]
    ds_read_b128 v[36:39], v12 offset:12288
    s_add_u32 m0, s19, 19840
    v_mfma_f32_16x16x32_bf16 v[80:83], v[40:43], a[20:23], v[80:83]
    buffer_load_dwordx4 v2, s[8:11], s20 offen offset:640 lds
    s_waitcnt lgkmcnt(6)
    v_mfma_f32_16x16x32_bf16 v[68:71], v[44:47], a[24:27], v[68:71]
    ds_read_b128 v[40:43], v12 offset:14336
    v_mfma_f32_16x16x32_bf16 v[76:79], v[44:47], a[28:31], v[76:79]
    s_waitcnt lgkmcnt(6)
    v_mfma_f32_16x16x32_bf16 v[72:75], v[48:51], a[24:27], v[72:75]
    ds_read_b128 v[44:47], v13 offset:12288
    s_add_u32 m0, s19, 23808
    v_mfma_f32_16x16x32_bf16 v[80:83], v[48:51], a[28:31], v[80:83]
    buffer_load_dwordx4 v2, s[8:11], s20 offen offset:768 lds
    s_waitcnt lgkmcnt(6)
    v_mfma_f32_16x16x32_bf16 v[68:71], v[20:23], a[32:35], v[68:71]
    ds_read_b128 v[48:51], v13 offset:14336
    v_mfma_f32_16x16x32_bf16 v[76:79], v[20:23], a[36:39], v[76:79]
    s_waitcnt lgkmcnt(6)
    v_mfma_f32_16x16x32_bf16 v[72:75], v[24:27], a[32:35], v[72:75]
    ds_read_b128 v[20:23], v12 offset:16384
    s_add_u32 m0, s19, 27776
    v_mfma_f32_16x16x32_bf16 v[80:83], v[24:27], a[36:39], v[80:83]
    buffer_load_dwordx4 v2, s[8:11], s20 offen offset:896 lds
    s_waitcnt lgkmcnt(6)
    v_mfma_f32_16x16x32_bf16 v[68:71], v[28:31], a[40:43], v[68:71]
    ds_read_b128 v[24:27], v12 offset:18432
    v_mfma_f32_16x16x32_bf16 v[76:79], v[28:31], a[44:47], v[76:79]
    v_cvt_pk_bf16_f32 v84, v52, v53
    s_waitcnt lgkmcnt(6)
    v_mfma_f32_16x16x32_bf16 v[72:75], v[32:35], a[40:43], v[72:75]
    ds_read_b128 v[28:31], v13 offset:16384
    v_mfma_f32_16x16x32_bf16 v[80:83], v[32:35], a[44:47], v[80:83]
    v_cvt_pk_bf16_f32 v85, v54, v55
    s_waitcnt lgkmcnt(6)
    v_mfma_f32_16x16x32_bf16 v[68:71], v[36:39], a[48:51], v[68:71]
    ds_read_b128 v[32:35], v13 offset:18432
    v_mfma_f32_16x16x32_bf16 v[76:79], v[36:39], a[52:55], v[76:79]
    v_cvt_pk_bf16_f32 v86, v56, v57
    s_waitcnt lgkmcnt(6)
    v_mfma_f32_16x16x32_bf16 v[72:75], v[40:43], a[48:51], v[72:75]
    ds_read_b128 v[36:39], v12 offset:20480
    v_mfma_f32_16x16x32_bf16 v[80:83], v[40:43], a[52:55], v[80:83]
    v_cvt_pk_bf16_f32 v87, v58, v59
    s_waitcnt lgkmcnt(6)
    v_mfma_f32_16x16x32_bf16 v[68:71], v[44:47], a[56:59], v[68:71]
    ds_read_b128 v[40:43], v12 offset:22528
    v_mfma_f32_16x16x32_bf16 v[76:79], v[44:47], a[60:63], v[76:79]
    v_cvt_pk_bf16_f32 v88, v60, v61
    s_waitcnt lgkmcnt(6)
    v_mfma_f32_16x16x32_bf16 v[72:75], v[48:51], a[56:59], v[72:75]
    ds_read_b128 v[44:47], v13 offset:20480
    v_mfma_f32_16x16x32_bf16 v[80:83], v[48:51], a[60:63], v[80:83]
    v_cvt_pk_bf16_f32 v89, v62, v63
    buffer_store_dwordx4 v[84:87], v3, s[4:7], s21 offen offset:0 sc1
    s_waitcnt lgkmcnt(6)
    v_mfma_f32_16x16x32_bf16 v[68:71], v[20:23], a[64:67], v[68:71]
    ds_read_b128 v[48:51], v13 offset:22528
    v_mfma_f32_16x16x32_bf16 v[76:79], v[20:23], a[68:71], v[76:79]
    v_cvt_pk_bf16_f32 v90, v64, v65
    s_waitcnt lgkmcnt(6)
    v_mfma_f32_16x16x32_bf16 v[72:75], v[24:27], a[64:67], v[72:75]
    ds_read_b128 v[20:23], v12 offset:24576
    v_mfma_f32_16x16x32_bf16 v[80:83], v[24:27], a[68:71], v[80:83]
    v_cvt_pk_bf16_f32 v91, v66, v67
    s_waitcnt lgkmcnt(6)
    v_mfma_f32_16x16x32_bf16 v[68:71], v[28:31], a[72:75], v[68:71]
    ds_read_b128 v[24:27], v12 offset:26624
    v_mfma_f32_16x16x32_bf16 v[76:79], v[28:31], a[76:79], v[76:79]
    s_waitcnt lgkmcnt(6)
    v_mfma_f32_16x16x32_bf16 v[72:75], v[32:35], a[72:75], v[72:75]
    ds_read_b128 v[28:31], v13 offset:24576
    v_mfma_f32_16x16x32_bf16 v[80:83], v[32:35], a[76:79], v[80:83]
    buffer_store_dwordx4 v[88:91], v3, s[4:7], s21 offen offset:128 sc1
    s_waitcnt lgkmcnt(6)
    v_mfma_f32_16x16x32_bf16 v[68:71], v[36:39], a[80:83], v[68:71]
    ds_read_b128 v[32:35], v13 offset:26624
    v_mfma_f32_16x16x32_bf16 v[76:79], v[36:39], a[84:87], v[76:79]
    s_add_u32 s21, s21, s25
    s_mov_b32 s25, s26
    s_waitcnt lgkmcnt(6)
    v_mfma_f32_16x16x32_bf16 v[72:75], v[40:43], a[80:83], v[72:75]
    ds_read_b128 v[36:39], v12 offset:28672
    v_mfma_f32_16x16x32_bf16 v[80:83], v[40:43], a[84:87], v[80:83]
    s_waitcnt lgkmcnt(6)
    v_mfma_f32_16x16x32_bf16 v[68:71], v[44:47], a[88:91], v[68:71]
    ds_read_b128 v[40:43], v12 offset:30720
    v_mfma_f32_16x16x32_bf16 v[76:79], v[44:47], a[92:95], v[76:79]
    s_waitcnt lgkmcnt(6)
    v_mfma_f32_16x16x32_bf16 v[72:75], v[48:51], a[88:91], v[72:75]
    ds_read_b128 v[44:47], v13 offset:28672
    v_mfma_f32_16x16x32_bf16 v[80:83], v[48:51], a[92:95], v[80:83]
    s_waitcnt lgkmcnt(6)
    v_mfma_f32_16x16x32_bf16 v[68:71], v[20:23], a[96:99], v[68:71]
    ds_read_b128 v[48:51], v13 offset:30720
    v_mfma_f32_16x16x32_bf16 v[76:79], v[20:23], a[100:103], v[76:79]
    s_waitcnt lgkmcnt(6)
    v_mfma_f32_16x16x32_bf16 v[72:75], v[24:27], a[96:99], v[72:75]
    s_waitcnt vmcnt(11)
    s_barrier
    ds_read_b128 v[20:23], v12 offset:32768
    v_mfma_f32_16x16x32_bf16 v[80:83], v[24:27], a[100:103], v[80:83]
    s_waitcnt lgkmcnt(6)
    v_mfma_f32_16x16x32_bf16 v[68:71], v[28:31], a[104:107], v[68:71]
    ds_read_b128 v[24:27], v12 offset:34816
    s_add_u32 m0, s19, 31744
    v_mfma_f32_16x16x32_bf16 v[76:79], v[28:31], a[108:111], v[76:79]
    buffer_load_dwordx4 v2, s[8:11], s20 offen offset:1024 lds
    s_waitcnt lgkmcnt(6)
    v_mfma_f32_16x16x32_bf16 v[72:75], v[32:35], a[104:107], v[72:75]
    ds_read_b128 v[28:31], v13 offset:32768
    v_mfma_f32_16x16x32_bf16 v[80:83], v[32:35], a[108:111], v[80:83]
    s_waitcnt lgkmcnt(6)
    v_mfma_f32_16x16x32_bf16 v[68:71], v[36:39], a[112:115], v[68:71]
    ds_read_b128 v[32:35], v13 offset:34816
    s_add_u32 m0, s19, 35712
    v_mfma_f32_16x16x32_bf16 v[76:79], v[36:39], a[116:119], v[76:79]
    buffer_load_dwordx4 v2, s[8:11], s20 offen offset:1152 lds
    s_waitcnt lgkmcnt(6)
    v_mfma_f32_16x16x32_bf16 v[72:75], v[40:43], a[112:115], v[72:75]
    ds_read_b128 v[36:39], v12 offset:36864
    v_mfma_f32_16x16x32_bf16 v[80:83], v[40:43], a[116:119], v[80:83]
    s_waitcnt lgkmcnt(6)
    v_mfma_f32_16x16x32_bf16 v[68:71], v[44:47], a[120:123], v[68:71]
    ds_read_b128 v[40:43], v12 offset:38912
    s_add_u32 m0, s19, 39680
    v_mfma_f32_16x16x32_bf16 v[76:79], v[44:47], a[124:127], v[76:79]
    buffer_load_dwordx4 v2, s[8:11], s20 offen offset:1280 lds
    s_waitcnt lgkmcnt(6)
    v_mfma_f32_16x16x32_bf16 v[72:75], v[48:51], a[120:123], v[72:75]
    ds_read_b128 v[44:47], v13 offset:36864
    v_mfma_f32_16x16x32_bf16 v[80:83], v[48:51], a[124:127], v[80:83]
    s_waitcnt lgkmcnt(6)
    v_mfma_f32_16x16x32_bf16 v[68:71], v[20:23], a[128:131], v[68:71]
    ds_read_b128 v[48:51], v13 offset:38912
    v_mfma_f32_16x16x32_bf16 v[76:79], v[20:23], a[132:135], v[76:79]
    s_waitcnt lgkmcnt(6)
    v_mfma_f32_16x16x32_bf16 v[72:75], v[24:27], a[128:131], v[72:75]
    ds_read_b128 v[20:23], v12 offset:40960
    s_add_u32 m0, s19, 43648
    v_mfma_f32_16x16x32_bf16 v[80:83], v[24:27], a[132:135], v[80:83]
    buffer_load_dwordx4 v2, s[8:11], s20 offen offset:1408 lds
    s_waitcnt lgkmcnt(6)
    v_mfma_f32_16x16x32_bf16 v[68:71], v[28:31], a[136:139], v[68:71]
    ds_read_b128 v[24:27], v12 offset:43008
    v_mfma_f32_16x16x32_bf16 v[76:79], v[28:31], a[140:143], v[76:79]
    s_waitcnt lgkmcnt(6)
    v_mfma_f32_16x16x32_bf16 v[72:75], v[32:35], a[136:139], v[72:75]
    ds_read_b128 v[28:31], v13 offset:40960
    s_add_u32 m0, s19, 47616
    v_mfma_f32_16x16x32_bf16 v[80:83], v[32:35], a[140:143], v[80:83]
    buffer_load_dwordx4 v2, s[8:11], s20 offen offset:1536 lds
    s_waitcnt lgkmcnt(6)
    v_mfma_f32_16x16x32_bf16 v[68:71], v[36:39], a[144:147], v[68:71]
    ds_read_b128 v[32:35], v13 offset:43008
    v_mfma_f32_16x16x32_bf16 v[76:79], v[36:39], a[148:151], v[76:79]
    s_waitcnt lgkmcnt(6)
    v_mfma_f32_16x16x32_bf16 v[72:75], v[40:43], a[144:147], v[72:75]
    ds_read_b128 v[36:39], v12 offset:45056
    s_add_u32 m0, s19, 51584
    v_mfma_f32_16x16x32_bf16 v[80:83], v[40:43], a[148:151], v[80:83]
    buffer_load_dwordx4 v2, s[8:11], s20 offen offset:1664 lds
    s_waitcnt lgkmcnt(6)
    v_mfma_f32_16x16x32_bf16 v[68:71], v[44:47], a[152:155], v[68:71]
    ds_read_b128 v[40:43], v12 offset:47104
    v_mfma_f32_16x16x32_bf16 v[76:79], v[44:47], a[156:159], v[76:79]
    s_waitcnt lgkmcnt(6)
    v_mfma_f32_16x16x32_bf16 v[72:75], v[48:51], a[152:155], v[72:75]
    ds_read_b128 v[44:47], v13 offset:45056
    s_add_u32 m0, s19, 55552
    v_mfma_f32_16x16x32_bf16 v[80:83], v[48:51], a[156:159], v[80:83]
    buffer_load_dwordx4 v2, s[8:11], s20 offen offset:1792 lds
    s_waitcnt lgkmcnt(6)
    v_mfma_f32_16x16x32_bf16 v[68:71], v[20:23], a[160:163], v[68:71]
    ds_read_b128 v[48:51], v13 offset:47104
    v_mfma_f32_16x16x32_bf16 v[76:79], v[20:23], a[164:167], v[76:79]
    s_waitcnt lgkmcnt(6)
    v_mfma_f32_16x16x32_bf16 v[72:75], v[24:27], a[160:163], v[72:75]
    ds_read_b128 v[20:23], v12 offset:49152
    s_add_u32 m0, s19, 59520
    v_mfma_f32_16x16x32_bf16 v[80:83], v[24:27], a[164:167], v[80:83]
    buffer_load_dwordx4 v2, s[8:11], s20 offen offset:1920 lds
    s_waitcnt lgkmcnt(6)
    v_mfma_f32_16x16x32_bf16 v[68:71], v[28:31], a[168:171], v[68:71]
    ds_read_b128 v[24:27], v12 offset:51200
    v_mfma_f32_16x16x32_bf16 v[76:79], v[28:31], a[172:175], v[76:79]
    s_add_u32 s20, s20, s24
    s_waitcnt lgkmcnt(6)
    v_mfma_f32_16x16x32_bf16 v[72:75], v[32:35], a[168:171], v[72:75]
    ds_read_b128 v[28:31], v13 offset:49152
    v_mfma_f32_16x16x32_bf16 v[80:83], v[32:35], a[172:175], v[80:83]
    s_waitcnt lgkmcnt(6)
    v_mfma_f32_16x16x32_bf16 v[68:71], v[36:39], a[176:179], v[68:71]
    ds_read_b128 v[32:35], v13 offset:51200
    v_mfma_f32_16x16x32_bf16 v[76:79], v[36:39], a[180:183], v[76:79]
    s_waitcnt lgkmcnt(6)
    v_mfma_f32_16x16x32_bf16 v[72:75], v[40:43], a[176:179], v[72:75]
    ds_read_b128 v[36:39], v12 offset:53248
    v_mfma_f32_16x16x32_bf16 v[80:83], v[40:43], a[180:183], v[80:83]
    s_waitcnt lgkmcnt(6)
    v_mfma_f32_16x16x32_bf16 v[68:71], v[44:47], a[184:187], v[68:71]
    ds_read_b128 v[40:43], v12 offset:55296
    v_mfma_f32_16x16x32_bf16 v[76:79], v[44:47], a[188:191], v[76:79]
    s_waitcnt lgkmcnt(6)
    v_mfma_f32_16x16x32_bf16 v[72:75], v[48:51], a[184:187], v[72:75]
    ds_read_b128 v[44:47], v13 offset:53248
    v_mfma_f32_16x16x32_bf16 v[80:83], v[48:51], a[188:191], v[80:83]
    s_waitcnt lgkmcnt(6)
    v_mfma_f32_16x16x32_bf16 v[68:71], v[20:23], a[192:195], v[68:71]
    ds_read_b128 v[48:51], v13 offset:55296
    v_mfma_f32_16x16x32_bf16 v[76:79], v[20:23], a[196:199], v[76:79]
    s_waitcnt lgkmcnt(6)
    v_mfma_f32_16x16x32_bf16 v[72:75], v[24:27], a[192:195], v[72:75]
    ds_read_b128 v[20:23], v12 offset:57344
    v_mfma_f32_16x16x32_bf16 v[80:83], v[24:27], a[196:199], v[80:83]
    s_waitcnt lgkmcnt(6)
    v_mfma_f32_16x16x32_bf16 v[68:71], v[28:31], a[200:203], v[68:71]
    ds_read_b128 v[24:27], v12 offset:59392
    v_mfma_f32_16x16x32_bf16 v[76:79], v[28:31], a[204:207], v[76:79]
    s_waitcnt lgkmcnt(6)
    v_mfma_f32_16x16x32_bf16 v[72:75], v[32:35], a[200:203], v[72:75]
    ds_read_b128 v[28:31], v13 offset:57344
    v_mfma_f32_16x16x32_bf16 v[80:83], v[32:35], a[204:207], v[80:83]
    s_waitcnt lgkmcnt(6)
    v_mfma_f32_16x16x32_bf16 v[68:71], v[36:39], a[208:211], v[68:71]
    ds_read_b128 v[32:35], v13 offset:59392
    v_mfma_f32_16x16x32_bf16 v[76:79], v[36:39], a[212:215], v[76:79]
    s_waitcnt lgkmcnt(6)
    v_mfma_f32_16x16x32_bf16 v[72:75], v[40:43], a[208:211], v[72:75]
    ds_read_b128 v[36:39], v12 offset:61440
    v_mfma_f32_16x16x32_bf16 v[80:83], v[40:43], a[212:215], v[80:83]
    s_waitcnt lgkmcnt(6)
    v_mfma_f32_16x16x32_bf16 v[68:71], v[44:47], a[216:219], v[68:71]
    ds_read_b128 v[40:43], v12 offset:63488
    v_mfma_f32_16x16x32_bf16 v[76:79], v[44:47], a[220:223], v[76:79]
    s_waitcnt lgkmcnt(6)
    v_mfma_f32_16x16x32_bf16 v[72:75], v[48:51], a[216:219], v[72:75]
    ds_read_b128 v[44:47], v13 offset:61440
    v_mfma_f32_16x16x32_bf16 v[80:83], v[48:51], a[220:223], v[80:83]
    s_waitcnt lgkmcnt(6)
    v_mfma_f32_16x16x32_bf16 v[68:71], v[20:23], a[224:227], v[68:71]
    ds_read_b128 v[48:51], v13 offset:63488
    v_mfma_f32_16x16x32_bf16 v[76:79], v[20:23], a[228:231], v[76:79]
    s_waitcnt lgkmcnt(6)
    v_mfma_f32_16x16x32_bf16 v[72:75], v[24:27], a[224:227], v[72:75]
    s_waitcnt vmcnt(8)
    s_barrier
    ds_read_b128 v[20:23], v10 offset:0
    v_mfma_f32_16x16x32_bf16 v[80:83], v[24:27], a[228:231], v[80:83]
    s_waitcnt lgkmcnt(6)
    v_mfma_f32_16x16x32_bf16 v[68:71], v[28:31], a[232:235], v[68:71]
    ds_read_b128 v[24:27], v10 offset:2048
    s_add_u32 m0, s19, 65536
    v_mfma_f32_16x16x32_bf16 v[76:79], v[28:31], a[236:239], v[76:79]
    buffer_load_dwordx4 v2, s[8:11], s20 offen offset:0 lds
    s_waitcnt lgkmcnt(6)
    v_mfma_f32_16x16x32_bf16 v[72:75], v[32:35], a[232:235], v[72:75]
    ds_read_b128 v[28:31], v11 offset:0
    v_mfma_f32_16x16x32_bf16 v[80:83], v[32:35], a[236:239], v[80:83]
    v_mov_b32 v9, s23
    s_add_u32 s23, s23, 1
    buffer_store_dword v9, v4, s[4:7], 0 offen sc1
    s_waitcnt lgkmcnt(6)
    v_mfma_f32_16x16x32_bf16 v[68:71], v[36:39], a[240:243], v[68:71]
    ds_read_b128 v[32:35], v11 offset:2048
    s_add_u32 m0, s19, 69504
    v_mfma_f32_16x16x32_bf16 v[76:79], v[36:39], a[244:247], v[76:79]
    buffer_load_dwordx4 v2, s[8:11], s20 offen offset:128 lds
    s_waitcnt lgkmcnt(6)
    v_mfma_f32_16x16x32_bf16 v[72:75], v[40:43], a[240:243], v[72:75]
    ds_read_b128 v[36:39], v10 offset:4096
    v_mfma_f32_16x16x32_bf16 v[80:83], v[40:43], a[244:247], v[80:83]
    s_waitcnt lgkmcnt(6)
    v_mfma_f32_16x16x32_bf16 v[68:71], v[44:47], a[248:251], v[68:71]
    ds_read_b128 v[40:43], v10 offset:6144
    s_add_u32 m0, s19, 73472
    v_mfma_f32_16x16x32_bf16 v[76:79], v[44:47], a[252:255], v[76:79]
    buffer_load_dwordx4 v2, s[8:11], s20 offen offset:256 lds
    s_waitcnt lgkmcnt(6)
    v_mfma_f32_16x16x32_bf16 v[72:75], v[48:51], a[248:251], v[72:75]
    ds_read_b128 v[44:47], v11 offset:4096
    v_mfma_f32_16x16x32_bf16 v[80:83], v[48:51], a[252:255], v[80:83]
    s_add_u32 s22, s22, 2
    s_cmp_lt_u32 s22, 64
    s_cbranch_scc1 P_v_top
    v_cvt_pk_bf16_f32 v84, v68, v69
    v_cvt_pk_bf16_f32 v85, v70, v71
    s_nop 0
    v_cvt_pk_bf16_f32 v86, v72, v73
    v_cvt_pk_bf16_f32 v87, v74, v75
    v_cvt_pk_bf16_f32 v88, v76, v77
    v_cvt_pk_bf16_f32 v89, v78, v79
    v_cvt_pk_bf16_f32 v90, v80, v81
    v_cvt_pk_bf16_f32 v91, v82, v83
    buffer_store_dwordx4 v[84:87], v3, s[4:7], s21 offen offset:0 sc1
    buffer_store_dwordx4 v[88:91], v3, s[4:7], s21 offen offset:128 sc1
    s_waitcnt vmcnt(0) lgkmcnt(0)
    v_mov_b32 v9, s23
    s_add_u32 s23, s23, 1
    buffer_store_dword v9, v4, s[4:7], 0 offen sc1
    s_branch W_U
W_U:
    v_lshlrev_b32 v5, 2, v1
    s_mov_b32 s18, 0
rdv_13:
    global_load_dword v6, v5, s[100:101] sc1
    s_waitcnt vmcnt(0)
rdv_13p:
    s_lshl_b32 s17, s98, 2
    v_lshrrev_b32 v9, s17, v6
    s_cmp_eq_u32 s98, 0
    s_cselect_b32 s17, 0x0f0f0f0f, s17
    s_cselect_b32 s17, s17, 0x01010101
    v_and_b32 v9, s17, v9
    v_cmp_ne_u32 vcc, 0x01010101, v9
    s_nop 0
    s_cbranch_vccz rdvok_14
    v_sad_u8 v9, v9, 0, 0
    s_nop 1
    v_add_u32_dpp v9, v9, v9 quad_perm:[1,0,3,2] row_mask:0xf bank_mask:0xf
    v_cmp_ne_u32 vcc, 8, v9
    s_nop 0
    s_cbranch_vccnz rdvw_15
    s_mov_b32 s98, 1
    s_and_b32 s3, s97, 7
    s_waitcnt vmcnt(0) lgkmcnt(0)
    s_barrier
    s_branch role_start
rdvw_15:
    s_sleep 4
    s_add_u32 s18, s18, 1
    s_cmp_lt_u32 s18, 262144
    s_cbranch_scc1 rdv_13
    s_mov_b32 s92, 1048576
rdvok_14:
    v_and_b32 v9, 0x40404040, v6
    v_bcnt_u32_b32 v9, v9, 0
    s_mov_b32 s89, 0
    v_cmp_le_u32 vcc, 1, v9
    s_nop 0
    s_bcnt1_i32_b64 s17, vcc
    s_add_u32 s89, s89, s17
    v_cmp_le_u32 vcc, 2, v9
    s_nop 0
    s_bcnt1_i32_b64 s17, vcc
    s_add_u32 s89, s89, s17
    v_cmp_le_u32 vcc, 3, v9
    s_nop 0
    s_bcnt1_i32_b64 s17, vcc
    s_add_u32 s89, s89, s17
    v_cmp_le_u32 vcc, 4, v9
    s_nop 0
    s_bcnt1_i32_b64 s17, vcc
    s_add_u32 s89, s89, s17
    s_cmp_gt_u32 s89, 16
    s_cselect_b32 s89, 8192, 0
    s_load_dwordx2 s[8:9], s[0:1], 64
    s_load_dwordx2 s[12:13], s[0:1], 80
    s_mov_b32 s10, 8388608
    s_mov_b32 s11, 0x20000
    s_mov_b32 s14, 8388608
    s_mov_b32 s15, 0x20000
    s_lshl_b32 s17, s90, 2
    s_lshr_b32 s17, 0, s17
    s_add_u32 s35, s93, s17
    s_and_b32 s35, s35, 15
    s_lshr_b32 s28, s93, 4
    s_lshl_b32 s17, s90, 2
    s_lshr_b32 s17, 516, s17
    s_and_b32 s17, s17, 15
    s_add_u32 s28, s28, s17
    s_lshl_b32 s20, s16, 21
    s_lshl_b32 s17, s35, 7
    s_add_u32 s20, s20, s17
    v_lshrrev_b32 v5, 2, v1
    v_and_b32 v6, 3, v1
    v_lshlrev_b32 v7, 4, v6
    v_lshl_add_u32 v7, v5, 11, v7
    v_lshlrev_b32 v8, 3, v6
    v_bfe_u32 v5, v1, 2, 2
    v_lshrrev_b32 v6, 4, v1
    v_lshl_add_u32 v5, v6, 3, v5
    v_lshl_add_u32 v8, v5, 6, v8
    s_lshl_b32 s19, s16, 15
    v_add_u32 v8, s19, v8
    s_and_b32 s37, s93, 0
    s_lshl_b32 s37, s37, 18
    s_waitcnt lgkmcnt(0)
    s_barrier
    v_lshrrev_b32 v5, 3, v1
    v_and_b32 v6, 3, v5
    v_lshlrev_b32 v6, 1, v6
    v_xor_b32 v6, v6, v1
    v_and_b32 v6, 7, v6
    v_lshlrev_b32 v6, 4, v6
    v_lshl_add_u32 v7, v5, 11, v6
    v_xor_b32 v49, 32, v7
    v_bfe_u32 v5, v1, 2, 2
    v_lshrrev_b32 v6, 4, v1
    v_lshl_add_u32 v8, v6, 3, v5
    v_lshl_add_u32 v8, v8, 7, s19
    v_and_b32 v6, 1, v6
    v_xor_b32 v5, v5, v6
    v_lshl_add_u32 v8, v5, 5, v8
    v_and_b32 v6, 3, v1
    v_lshl_add_u32 v8, v6, 3, v8
    v_xor_b32 v2, 32, v8
    v_xor_b32 v3, 64, v8
    v_xor_b32 v4, 96, v8
    s_sub_u32 s17, s90, 1
    s_and_b32 s17, s17, 3
    s_lshl_b32 s17, s17, 3
    s_and_b32 s18, s93, 7
    s_add_u32 s17, s17, s18
    s_lshl_b32 s17, s17, 8
    v_add_lshl_u32 v5, v0, s17, 11
    s_and_b32 s17, s93, 8
    s_lshl_b32 s17, s17, 7
    buffer_load_dword v48, v5, s[8:11], s17 offen offset:384
    s_add_u32 m0, s19, 0
    s_add_u32 s17, s20, 0
    buffer_load_dwordx4 v7, s[8:11], s17 offen lds
    s_add_u32 m0, s19, 1024
    s_add_u32 s17, s20, 16384
    buffer_load_dwordx4 v49, s[8:11], s17 offen lds
    s_add_u32 m0, s19, 2048
    s_add_u32 s17, s20, 32768
    buffer_load_dwordx4 v7, s[8:11], s17 offen lds
    s_add_u32 m0, s19, 3072
    s_add_u32 s17, s20, 49152
    buffer_load_dwordx4 v49, s[8:11], s17 offen lds
    s_add_u32 m0, s19, 4096
    s_add_u32 s17, s20, 65536
    buffer_load_dwordx4 v7, s[8:11], s17 offen lds
    s_add_u32 m0, s19, 5120
    s_add_u32 s17, s20, 81920
    buffer_load_dwordx4 v49, s[8:11], s17 offen lds
    s_add_u32 m0, s19, 6144
    s_add_u32 s17, s20, 98304
    buffer_load_dwordx4 v7, s[8:11], s17 offen lds
    s_add_u32 m0, s19, 7168
    s_add_u32 s17, s20, 114688
    buffer_load_dwordx4 v49, s[8:11], s17 offen lds
    s_add_u32 m0, s19, 8192
    s_add_u32 s17, s20, 131072
    buffer_load_dwordx4 v7, s[8:11], s17 offen lds
    s_add_u32 m0, s19, 9216
    s_add_u32 s17, s20, 147456
    buffer_load_dwordx4 v49, s[8:11], s17 offen lds
    s_add_u32 m0, s19, 10240
    s_add_u32 s17, s20, 163840
    buffer_load_dwordx4 v7, s[8:11], s17 offen lds
    s_add_u32 m0, s19, 11264
    s_add_u32 s17, s20, 180224
    buffer_load_dwordx4 v49, s[8:11], s17 offen lds
    s_add_u32 m0, s19, 12288
    s_add_u32 s17, s20, 262144
    buffer_load_dwordx4 v7, s[8:11], s17 offen lds
    s_add_u32 m0, s19, 13312
    s_add_u32 s17, s20, 278528
    buffer_load_dwordx4 v49, s[8:11], s17 offen lds
    s_add_u32 m0, s19, 14336
    s_add_u32 s17, s20, 294912
    buffer_load_dwordx4 v7, s[8:11], s17 offen lds
    s_add_u32 m0, s19, 15360
    s_add_u32 s17, s20, 311296
    buffer_load_dwordx4 v49, s[8:11], s17 offen lds
    s_add_u32 m0, s19, 16384
    s_add_u32 s17, s20, 327680
    buffer_load_dwordx4 v7, s[8:11], s17 offen lds
    s_add_u32 m0, s19, 17408
    s_add_u32 s17, s20, 344064
    buffer_load_dwordx4 v49, s[8:11], s17 offen lds
    s_add_u32 m0, s19, 18432
    s_add_u32 s17, s20, 360448
    buffer_load_dwordx4 v7, s[8:11], s17 offen lds
    s_add_u32 m0, s19, 19456
    s_add_u32 s17, s20, 376832
    buffer_load_dwordx4 v49, s[8:11], s17 offen lds
    s_add_u32 m0, s19, 20480
    s_add_u32 s17, s20, 393216
    buffer_load_dwordx4 v7, s[8:11], s17 offen lds
    s_add_u32 m0, s19, 21504
    s_add_u32 s17, s20, 409600
    buffer_load_dwordx4 v49, s[8:11], s17 offen lds
    s_add_u32 m0, s19, 22528
    s_add_u32 s17, s20, 425984
    buffer_load_dwordx4 v7, s[8:11], s17 offen lds
    s_add_u32 m0, s19, 23552
    s_add_u32 s17, s20, 442368
    buffer_load_dwordx4 v49, s[8:11], s17 offen lds
    s_add_u32 m0, s19, 24576
    s_add_u32 s17, s20, 524288
    buffer_load_dwordx4 v7, s[8:11], s17 offen lds
    s_add_u32 m0, s19, 25600
    s_add_u32 s17, s20, 540672
    buffer_load_dwordx4 v49, s[8:11], s17 offen lds
    s_add_u32 m0, s19, 26624
    s_add_u32 s17, s20, 557056
    buffer_load_dwordx4 v7, s[8:11], s17 offen lds
    s_add_u32 m0, s19, 27648
    s_add_u32 s17, s20, 573440
    buffer_load_dwordx4 v49, s[8:11], s17 offen lds
    s_add_u32 m0, s19, 28672
    s_add_u32 s17, s20, 589824
    buffer_load_dwordx4 v7, s[8:11], s17 offen lds
    s_add_u32 m0, s19, 29696
    s_add_u32 s17, s20, 606208
    buffer_load_dwordx4 v49, s[8:11], s17 offen lds
    s_add_u32 m0, s19, 30720
    s_add_u32 s17, s20, 622592
    buffer_load_dwordx4 v7, s[8:11], s17 offen lds
    s_add_u32 m0, s19, 31744
    s_add_u32 s17, s20, 638976
    buffer_load_dwordx4 v49, s[8:11], s17 offen lds
    s_waitcnt vmcnt(28)
    ds_read_b64_tr_b16 a[0:1], v8 offset:0
    ds_read_b64_tr_b16 a[2:3], v8 offset:512
    ds_read_b64_tr_b16 a[4:5], v2 offset:0
    ds_read_b64_tr_b16 a[6:7], v2 offset:512
    ds_read_b64_tr_b16 a[8:9], v3 offset:0
    ds_read_b64_tr_b16 a[10:11], v3 offset:512
    ds_read_b64_tr_b16 a[12:13], v4 offset:0
    ds_read_b64_tr_b16 a[14:15], v4 offset:512
    s_waitcnt vmcnt(24)
    ds_read_b64_tr_b16 a[16:17], v8 offset:4096
    ds_read_b64_tr_b16 a[18:19], v8 offset:4608
    ds_read_b64_tr_b16 a[20:21], v2 offset:4096
    ds_read_b64_tr_b16 a[22:23], v2 offset:4608
    s_waitcnt lgkmcnt(4)
    s_add_u32 m0, s19, 0
    s_add_u32 s17, s20, 655360
    buffer_load_dwordx4 v7, s[8:11], s17 offen lds
    s_add_u32 m0, s19, 1024
    s_add_u32 s17, s20, 671744
    buffer_load_dwordx4 v49, s[8:11], s17 offen lds
    s_add_u32 m0, s19, 2048
    s_add_u32 s17, s20, 688128
    buffer_load_dwordx4 v7, s[8:11], s17 offen lds
    s_add_u32 m0, s19, 3072
    s_add_u32 s17, s20, 704512
    buffer_load_dwordx4 v49, s[8:11], s17 offen lds
    ds_read_b64_tr_b16 a[24:25], v3 offset:4096
    ds_read_b64_tr_b16 a[26:27], v3 offset:4608
    ds_read_b64_tr_b16 a[28:29], v4 offset:4096
    ds_read_b64_tr_b16 a[30:31], v4 offset:4608
    s_waitcnt vmcnt(24)
    ds_read_b64_tr_b16 a[32:33], v8 offset:8192
    ds_read_b64_tr_b16 a[34:35], v8 offset:8704
    ds_read_b64_tr_b16 a[36:37], v2 offset:8192
    ds_read_b64_tr_b16 a[38:39], v2 offset:8704
    s_waitcnt lgkmcnt(4)
    s_add_u32 m0, s19, 4096
    s_add_u32 s17, s20, 786432
    buffer_load_dwordx4 v7, s[8:11], s17 offen lds
    s_add_u32 m0, s19, 5120
    s_add_u32 s17, s20, 802816
    buffer_load_dwordx4 v49, s[8:11], s17 offen lds
    s_add_u32 m0, s19, 6144
    s_add_u32 s17, s20, 819200
    buffer_load_dwordx4 v7, s[8:11], s17 offen lds
    s_add_u32 m0, s19, 7168
    s_add_u32 s17, s20, 835584
    buffer_load_dwordx4 v49, s[8:11], s17 offen lds
    ds_read_b64_tr_b16 a[40:41], v3 offset:8192
    ds_read_b64_tr_b16 a[42:43], v3 offset:8704
    ds_read_b64_tr_b16 a[44:45], v4 offset:8192
    ds_read_b64_tr_b16 a[46:47], v4 offset:8704
    s_waitcnt vmcnt(24)
    ds_read_b64_tr_b16 a[48:49], v8 offset:12288
    ds_read_b64_tr_b16 a[50:51], v8 offset:12800
    ds_read_b64_tr_b16 a[52:53], v2 offset:12288
    ds_read_b64_tr_b16 a[54:55], v2 offset:12800
    s_waitcnt lgkmcnt(4)
    s_add_u32 m0, s19, 8192
    s_add_u32 s17, s20, 851968
    buffer_load_dwordx4 v7, s[8:11], s17 offen lds
    s_add_u32 m0, s19, 9216
    s_add_u32 s17, s20, 868352
    buffer_load_dwordx4 v49, s[8:11], s17 offen lds
    s_add_u32 m0, s19, 10240
    s_add_u32 s17, s20, 884736
    buffer_load_dwordx4 v7, s[8:11], s17 offen lds
    s_add_u32 m0, s19, 11264
    s_add_u32 s17, s20, 901120
    buffer_load_dwordx4 v49, s[8:11], s17 offen lds
    ds_read_b64_tr_b16 a[56:57], v3 offset:12288
    ds_read_b64_tr_b16 a[58:59], v3 offset:12800
    ds_read_b64_tr_b16 a[60:61], v4 offset:12288
    ds_read_b64_tr_b16 a[62:63], v4 offset:12800
    s_waitcnt vmcnt(24)
    ds_read_b64_tr_b16 a[64:65], v8 offset:16384
    ds_read_b64_tr_b16 a[66:67], v8 offset:16896
    ds_read_b64_tr_b16 a[68:69], v2 offset:16384
    ds_read_b64_tr_b16 a[70:71], v2 offset:16896
    s_waitcnt lgkmcnt(4)
    s_add_u32 m0, s19, 12288
    s_add_u32 s17, s20, 917504
    buffer_load_dwordx4 v7, s[8:11], s17 offen lds
    s_add_u32 m0, s19, 13312
    s_add_u32 s17, s20, 933888
    buffer_load_dwordx4 v49, s[8:11], s17 offen lds
    s_add_u32 m0, s19, 14336
    s_add_u32 s17, s20, 950272
    buffer_load_dwordx4 v7, s[8:11], s17 offen lds
    s_add_u32 m0, s19, 15360
    s_add_u32 s17, s20, 966656
    buffer_load_dwordx4 v49, s[8:11], s17 offen lds
    ds_read_b64_tr_b16 a[72:73], v3 offset:16384
    ds_read_b64_tr_b16 a[74:75], v3 offset:16896
    ds_read_b64_tr_b16 a[76:77], v4 offset:16384
    ds_read_b64_tr_b16 a[78:79], v4 offset:16896
    s_waitcnt vmcnt(24)
    ds_read_b64_tr_b16 a[80:81], v8 offset:20480
    ds_read_b64_tr_b16 a[82:83], v8 offset:20992
    ds_read_b64_tr_b16 a[84:85], v2 offset:20480
    ds_read_b64_tr_b16 a[86:87], v2 offset:20992
    s_waitcnt lgkmcnt(4)
    s_add_u32 m0, s19, 16384
    s_add_u32 s17, s20, 1048576
    buffer_load_dwordx4 v7, s[8:11], s17 offen lds
    s_add_u32 m0, s19, 17408
    s_add_u32 s17, s20, 1064960
    buffer_load_dwordx4 v49, s[8:11], s17 offen lds
    s_add_u32 m0, s19, 18432
    s_add_u32 s17, s20, 1081344
    buffer_load_dwordx4 v7, s[8:11], s17 offen lds
    s_add_u32 m0, s19, 19456
    s_add_u32 s17, s20, 1097728
    buffer_load_dwordx4 v49, s[8:11], s17 offen lds
    ds_read_b64_tr_b16 a[88:89], v3 offset:20480
    ds_read_b64_tr_b16 a[90:91], v3 offset:20992
    ds_read_b64_tr_b16 a[92:93], v4 offset:20480
    ds_read_b64_tr_b16 a[94:95], v4 offset:20992
    s_waitcnt vmcnt(24)
    ds_read_b64_tr_b16 a[96:97], v8 offset:24576
    ds_read_b64_tr_b16 a[98:99], v8 offset:25088
    ds_read_b64_tr_b16 a[100:101], v2 offset:24576
    ds_read_b64_tr_b16 a[102:103], v2 offset:25088
    s_waitcnt lgkmcnt(4)
    s_add_u32 m0, s19, 20480
    s_add_u32 s17, s20, 1114112
    buffer_load_dwordx4 v7, s[8:11], s17 offen lds
    s_add_u32 m0, s19, 21504
    s_add_u32 s17, s20, 1130496
    buffer_load_dwordx4 v49, s[8:11], s17 offen lds
    s_add_u32 m0, s19, 22528
    s_add_u32 s17, s20, 1146880
    buffer_load_dwordx4 v7, s[8:11], s17 offen lds
    s_add_u32 m0, s19, 23552
    s_add_u32 s17, s20, 1163264
    buffer_load_dwordx4 v49, s[8:11], s17 offen lds
    ds_read_b64_tr_b16 a[104:105], v3 offset:24576
    ds_read_b64_tr_b16 a[106:107], v3 offset:25088
    ds_read_b64_tr_b16 a[108:109], v4 offset:24576
    ds_read_b64_tr_b16 a[110:111], v4 offset:25088
    s_waitcnt vmcnt(24)
    ds_read_b64_tr_b16 a[112:113], v8 offset:28672
    ds_read_b64_tr_b16 a[114:115], v8 offset:29184
    ds_read_b64_tr_b16 a[116:117], v2 offset:28672
    ds_read_b64_tr_b16 a[118:119], v2 offset:29184
    s_waitcnt lgkmcnt(4)
    s_add_u32 m0, s19, 24576
    s_add_u32 s17, s20, 1179648
    buffer_load_dwordx4 v7, s[8:11], s17 offen lds
    s_add_u32 m0, s19, 25600
    s_add_u32 s17, s20, 1196032
    buffer_load_dwordx4 v49, s[8:11], s17 offen lds
    s_add_u32 m0, s19, 26624
    s_add_u32 s17, s20, 1212416
    buffer_load_dwordx4 v7, s[8:11], s17 offen lds
    s_add_u32 m0, s19, 27648
    s_add_u32 s17, s20, 1228800
    buffer_load_dwordx4 v49, s[8:11], s17 offen lds
    ds_read_b64_tr_b16 a[120:121], v3 offset:28672
    ds_read_b64_tr_b16 a[122:123], v3 offset:29184
    ds_read_b64_tr_b16 a[124:125], v4 offset:28672
    ds_read_b64_tr_b16 a[126:127], v4 offset:29184
    s_waitcnt vmcnt(24)
    ds_read_b64_tr_b16 a[128:129], v8 offset:0
    ds_read_b64_tr_b16 a[130:131], v8 offset:512
    ds_read_b64_tr_b16 a[132:133], v2 offset:0
    ds_read_b64_tr_b16 a[134:135], v2 offset:512
    s_waitcnt lgkmcnt(4)
    s_add_u32 m0, s19, 28672
    s_add_u32 s17, s20, 1310720
    buffer_load_dwordx4 v7, s[8:11], s17 offen lds
    s_add_u32 m0, s19, 29696
    s_add_u32 s17, s20, 1327104
    buffer_load_dwordx4 v49, s[8:11], s17 offen lds
    s_add_u32 m0, s19, 30720
    s_add_u32 s17, s20, 1343488
    buffer_load_dwordx4 v7, s[8:11], s17 offen lds
    s_add_u32 m0, s19, 31744
    s_add_u32 s17, s20, 1359872
    buffer_load_dwordx4 v49, s[8:11], s17 offen lds
    ds_read_b64_tr_b16 a[136:137], v3 offset:0
    ds_read_b64_tr_b16 a[138:139], v3 offset:512
    ds_read_b64_tr_b16 a[140:141], v4 offset:0
    ds_read_b64_tr_b16 a[142:143], v4 offset:512
    s_waitcnt vmcnt(24)
    ds_read_b64_tr_b16 a[144:145], v8 offset:4096
    ds_read_b64_tr_b16 a[146:147], v8 offset:4608
    ds_read_b64_tr_b16 a[148:149], v2 offset:4096
    ds_read_b64_tr_b16 a[150:151], v2 offset:4608
    s_waitcnt lgkmcnt(4)
    s_add_u32 m0, s19, 0
    s_add_u32 s17, s20, 1376256
    buffer_load_dwordx4 v7, s[8:11], s17 offen lds
    s_add_u32 m0, s19, 1024
    s_add_u32 s17, s20, 1392640
    buffer_load_dwordx4 v49, s[8:11], s17 offen lds
    s_add_u32 m0, s19, 2048
    s_add_u32 s17, s20, 1409024
    buffer_load_dwordx4 v7, s[8:11], s17 offen lds
    s_add_u32 m0, s19, 3072
    s_add_u32 s17, s20, 1425408
    buffer_load_dwordx4 v49, s[8:11], s17 offen lds
    ds_read_b64_tr_b16 a[152:153], v3 offset:4096
    ds_read_b64_tr_b16 a[154:155], v3 offset:4608
    ds_read_b64_tr_b16 a[156:157], v4 offset:4096
    ds_read_b64_tr_b16 a[158:159], v4 offset:4608
    s_waitcnt vmcnt(24)
    ds_read_b64_tr_b16 a[160:161], v8 offset:8192
    ds_read_b64_tr_b16 a[162:163], v8 offset:8704
    ds_read_b64_tr_b16 a[164:165], v2 offset:8192
    ds_read_b64_tr_b16 a[166:167], v2 offset:8704
    s_waitcnt lgkmcnt(4)
    s_add_u32 m0, s19, 4096
    s_add_u32 s17, s20, 1441792
    buffer_load_dwordx4 v7, s[8:11], s17 offen lds
    s_add_u32 m0, s19, 5120
    s_add_u32 s17, s20, 1458176
    buffer_load_dwordx4 v49, s[8:11], s17 offen lds
    s_add_u32 m0, s19, 6144
    s_add_u32 s17, s20, 1474560
    buffer_load_dwordx4 v7, s[8:11], s17 offen lds
    s_add_u32 m0, s19, 7168
    s_add_u32 s17, s20, 1490944
    buffer_load_dwordx4 v49, s[8:11], s17 offen lds
    ds_read_b64_tr_b16 a[168:169], v3 offset:8192
    ds_read_b64_tr_b16 a[170:171], v3 offset:8704
    ds_read_b64_tr_b16 a[172:173], v4 offset:8192
    ds_read_b64_tr_b16 a[174:175], v4 offset:8704
    s_waitcnt vmcnt(24)
    ds_read_b64_tr_b16 a[176:177], v8 offset:12288
    ds_read_b64_tr_b16 a[178:179], v8 offset:12800
    ds_read_b64_tr_b16 a[180:181], v2 offset:12288
    ds_read_b64_tr_b16 a[182:183], v2 offset:12800
    s_waitcnt lgkmcnt(4)
    s_add_u32 m0, s19, 8192
    s_add_u32 s17, s20, 1572864
    buffer_load_dwordx4 v7, s[8:11], s17 offen lds
    s_add_u32 m0, s19, 9216
    s_add_u32 s17, s20, 1589248
    buffer_load_dwordx4 v49, s[8:11], s17 offen lds
    s_add_u32 m0, s19, 10240
    s_add_u32 s17, s20, 1605632
    buffer_load_dwordx4 v7, s[8:11], s17 offen lds
    s_add_u32 m0, s19, 11264
    s_add_u32 s17, s20, 1622016
    buffer_load_dwordx4 v49, s[8:11], s17 offen lds
    ds_read_b64_tr_b16 a[184:185], v3 offset:12288
    ds_read_b64_tr_b16 a[186:187], v3 offset:12800
    ds_read_b64_tr_b16 a[188:189], v4 offset:12288
    ds_read_b64_tr_b16 a[190:191], v4 offset:12800
    s_waitcnt vmcnt(24)
    ds_read_b64_tr_b16 a[192:193], v8 offset:16384
    ds_read_b64_tr_b16 a[194:195], v8 offset:16896
    ds_read_b64_tr_b16 a[196:197], v2 offset:16384
    ds_read_b64_tr_b16 a[198:199], v2 offset:16896
    s_waitcnt lgkmcnt(4)
    s_add_u32 m0, s19, 12288
    s_add_u32 s17, s20, 1638400
    buffer_load_dwordx4 v7, s[8:11], s17 offen lds
    s_add_u32 m0, s19, 13312
    s_add_u32 s17, s20, 1654784
    buffer_load_dwordx4 v49, s[8:11], s17 offen lds
    s_add_u32 m0, s19, 14336
    s_add_u32 s17, s20, 1671168
    buffer_load_dwordx4 v7, s[8:11], s17 offen lds
    s_add_u32 m0, s19, 15360
    s_add_u32 s17, s20, 1687552
    buffer_load_dwordx4 v49, s[8:11], s17 offen lds
    ds_read_b64_tr_b16 a[200:201], v3 offset:16384
    ds_read_b64_tr_b16 a[202:203], v3 offset:16896
    ds_read_b64_tr_b16 a[204:205], v4 offset:16384
    ds_read_b64_tr_b16 a[206:207], v4 offset:16896
    s_waitcnt vmcnt(24)
    ds_read_b64_tr_b16 a[208:209], v8 offset:20480
    ds_read_b64_tr_b16 a[210:211], v8 offset:20992
    ds_read_b64_tr_b16 a[212:213], v2 offset:20480
    ds_read_b64_tr_b16 a[214:215], v2 offset:20992
    s_waitcnt lgkmcnt(4)
    s_add_u32 m0, s19, 16384
    s_add_u32 s17, s20, 1703936
    buffer_load_dwordx4 v7, s[8:11], s17 offen lds
    s_add_u32 m0, s19, 17408
    s_add_u32 s17, s20, 1720320
    buffer_load_dwordx4 v49, s[8:11], s17 offen lds
    s_add_u32 m0, s19, 18432
    s_add_u32 s17, s20, 1736704
    buffer_load_dwordx4 v7, s[8:11], s17 offen lds
    s_add_u32 m0, s19, 19456
    s_add_u32 s17, s20, 1753088
    buffer_load_dwordx4 v49, s[8:11], s17 offen lds
    ds_read_b64_tr_b16 a[216:217], v3 offset:20480
    ds_read_b64_tr_b16 a[218:219], v3 offset:20992
    ds_read_b64_tr_b16 a[220:221], v4 offset:20480
    ds_read_b64_tr_b16 a[222:223], v4 offset:20992
    s_waitcnt vmcnt(24)
    ds_read_b64_tr_b16 a[224:225], v8 offset:24576
    ds_read_b64_tr_b16 a[226:227], v8 offset:25088
    ds_read_b64_tr_b16 a[228:229], v2 offset:24576
    ds_read_b64_tr_b16 a[230:231], v2 offset:25088
    s_waitcnt lgkmcnt(4)
    s_add_u32 m0, s19, 20480
    s_add_u32 s17, s20, 1835008
    buffer_load_dwordx4 v7, s[8:11], s17 offen lds
    s_add_u32 m0, s19, 21504
    s_add_u32 s17, s20, 1851392
    buffer_load_dwordx4 v49, s[8:11], s17 offen lds
    s_add_u32 m0, s19, 22528
    s_add_u32 s17, s20, 1867776
    buffer_load_dwordx4 v7, s[8:11], s17 offen lds
    s_add_u32 m0, s19, 23552
    s_add_u32 s17, s20, 1884160
    buffer_load_dwordx4 v49, s[8:11], s17 offen lds
    ds_read_b64_tr_b16 a[232:233], v3 offset:24576
    ds_read_b64_tr_b16 a[234:235], v3 offset:25088
    ds_read_b64_tr_b16 a[236:237], v4 offset:24576
    ds_read_b64_tr_b16 a[238:239], v4 offset:25088
    s_waitcnt vmcnt(24)
    ds_read_b64_tr_b16 a[240:241], v8 offset:28672
    ds_read_b64_tr_b16 a[242:243], v8 offset:29184
    ds_read_b64_tr_b16 a[244:245], v2 offset:28672
    ds_read_b64_tr_b16 a[246:247], v2 offset:29184
    s_waitcnt lgkmcnt(4)
    s_add_u32 m0, s19, 24576
    s_add_u32 s17, s20, 1900544
    buffer_load_dwordx4 v7, s[8:11], s17 offen lds
    s_add_u32 m0, s19, 25600
    s_add_u32 s17, s20, 1916928
    buffer_load_dwordx4 v49, s[8:11], s17 offen lds
    s_add_u32 m0, s19, 26624
    s_add_u32 s17, s20, 1933312
    buffer_load_dwordx4 v7, s[8:11], s17 offen lds
    s_add_u32 m0, s19, 27648
    s_add_u32 s17, s20, 1949696
    buffer_load_dwordx4 v49, s[8:11], s17 offen lds
    ds_read_b64_tr_b16 a[248:249], v3 offset:28672
    ds_read_b64_tr_b16 a[250:251], v3 offset:29184
    ds_read_b64_tr_b16 a[252:253], v4 offset:28672
    ds_read_b64_tr_b16 a[254:255], v4 offset:29184
    s_waitcnt vmcnt(24)
    ds_read_b64_tr_b16 v[128:129], v8 offset:0
    ds_read_b64_tr_b16 v[130:131], v8 offset:512
    ds_read_b64_tr_b16 v[132:133], v2 offset:0
    ds_read_b64_tr_b16 v[134:135], v2 offset:512
    s_waitcnt lgkmcnt(4)
    s_add_u32 m0, s19, 28672
    s_add_u32 s17, s20, 1966080
    buffer_load_dwordx4 v7, s[8:11], s17 offen lds
    s_add_u32 m0, s19, 29696
    s_add_u32 s17, s20, 1982464
    buffer_load_dwordx4 v49, s[8:11], s17 offen lds
    s_add_u32 m0, s19, 30720
    s_add_u32 s17, s20, 1998848
    buffer_load_dwordx4 v7, s[8:11], s17 offen lds
    s_add_u32 m0, s19, 31744
    s_add_u32 s17, s20, 2015232
    buffer_load_dwordx4 v49, s[8:11], s17 offen lds
    ds_read_b64_tr_b16 v[136:137], v3 offset:0
    ds_read_b64_tr_b16 v[138:139], v3 offset:512
    ds_read_b64_tr_b16 v[140:141], v4 offset:0
    ds_read_b64_tr_b16 v[142:143], v4 offset:512
    s_waitcnt vmcnt(24)
    ds_read_b64_tr_b16 v[144:145], v8 offset:4096
    ds_read_b64_tr_b16 v[146:147], v8 offset:4608
    ds_read_b64_tr_b16 v[148:149], v2 offset:4096
    ds_read_b64_tr_b16 v[150:151], v2 offset:4608
    s_waitcnt lgkmcnt(4)
    s_add_u32 m0, s19, 0
    s_add_u32 s17, s20, 196608
    buffer_load_dwordx4 v7, s[8:11], s17 offen lds
    s_add_u32 m0, s19, 1024
    s_add_u32 s17, s20, 212992
    buffer_load_dwordx4 v49, s[8:11], s17 offen lds
    s_add_u32 m0, s19, 2048
    s_add_u32 s17, s20, 229376
    buffer_load_dwordx4 v7, s[8:11], s17 offen lds
    s_add_u32 m0, s19, 3072
    s_add_u32 s17, s20, 245760
    buffer_load_dwordx4 v49, s[8:11], s17 offen lds
    ds_read_b64_tr_b16 v[152:153], v3 offset:4096
    ds_read_b64_tr_b16 v[154:155], v3 offset:4608
    ds_read_b64_tr_b16 v[156:157], v4 offset:4096
    ds_read_b64_tr_b16 v[158:159], v4 offset:4608
    s_waitcnt vmcnt(24)
    ds_read_b64_tr_b16 v[160:161], v8 offset:8192
    ds_read_b64_tr_b16 v[162:163], v8 offset:8704
    ds_read_b64_tr_b16 v[164:165], v2 offset:8192
    ds_read_b64_tr_b16 v[166:167], v2 offset:8704
    s_waitcnt lgkmcnt(4)
    s_add_u32 m0, s19, 4096
    s_add_u32 s17, s20, 458752
    buffer_load_dwordx4 v7, s[8:11], s17 offen lds
    s_add_u32 m0, s19, 5120
    s_add_u32 s17, s20, 475136
    buffer_load_dwordx4 v49, s[8:11], s17 offen lds
    s_add_u32 m0, s19, 6144
    s_add_u32 s17, s20, 491520
    buffer_load_dwordx4 v7, s[8:11], s17 offen lds
    s_add_u32 m0, s19, 7168
    s_add_u32 s17, s20, 507904
    buffer_load_dwordx4 v49, s[8:11], s17 offen lds
    ds_read_b64_tr_b16 v[168:169], v3 offset:8192
    ds_read_b64_tr_b16 v[170:171], v3 offset:8704
    ds_read_b64_tr_b16 v[172:173], v4 offset:8192
    ds_read_b64_tr_b16 v[174:175], v4 offset:8704
    s_waitcnt vmcnt(24)
    ds_read_b64_tr_b16 v[176:177], v8 offset:12288
    ds_read_b64_tr_b16 v[178:179], v8 offset:12800
    ds_read_b64_tr_b16 v[180:181], v2 offset:12288
    ds_read_b64_tr_b16 v[182:183], v2 offset:12800
    s_waitcnt lgkmcnt(4)
    s_add_u32 m0, s19, 8192
    s_add_u32 s17, s20, 720896
    buffer_load_dwordx4 v7, s[8:11], s17 offen lds
    s_add_u32 m0, s19, 9216
    s_add_u32 s17, s20, 737280
    buffer_load_dwordx4 v49, s[8:11], s17 offen lds
    s_add_u32 m0, s19, 10240
    s_add_u32 s17, s20, 753664
    buffer_load_dwordx4 v7, s[8:11], s17 offen lds
    s_add_u32 m0, s19, 11264
    s_add_u32 s17, s20, 770048
    buffer_load_dwordx4 v49, s[8:11], s17 offen lds
    ds_read_b64_tr_b16 v[184:185], v3 offset:12288
    ds_read_b64_tr_b16 v[186:187], v3 offset:12800
    ds_read_b64_tr_b16 v[188:189], v4 offset:12288
    ds_read_b64_tr_b16 v[190:191], v4 offset:12800
    s_waitcnt vmcnt(24)
    ds_read_b64_tr_b16 v[192:193], v8 offset:16384
    ds_read_b64_tr_b16 v[194:195], v8 offset:16896
    ds_read_b64_tr_b16 v[196:197], v2 offset:16384
    ds_read_b64_tr_b16 v[198:199], v2 offset:16896
    s_waitcnt lgkmcnt(4)
    s_add_u32 m0, s19, 12288
    s_add_u32 s17, s20, 983040
    buffer_load_dwordx4 v7, s[8:11], s17 offen lds
    s_add_u32 m0, s19, 13312
    s_add_u32 s17, s20, 999424
    buffer_load_dwordx4 v49, s[8:11], s17 offen lds
    s_add_u32 m0, s19, 14336
    s_add_u32 s17, s20, 1015808
    buffer_load_dwordx4 v7, s[8:11], s17 offen lds
    s_add_u32 m0, s19, 15360
    s_add_u32 s17, s20, 1032192
    buffer_load_dwordx4 v49, s[8:11], s17 offen lds
    ds_read_b64_tr_b16 v[200:201], v3 offset:16384
    ds_read_b64_tr_b16 v[202:203], v3 offset:16896
    ds_read_b64_tr_b16 v[204:205], v4 offset:16384
    ds_read_b64_tr_b16 v[206:207], v4 offset:16896
    s_waitcnt vmcnt(24)
    ds_read_b64_tr_b16 v[208:209], v8 offset:20480
    ds_read_b64_tr_b16 v[210:211], v8 offset:20992
    ds_read_b64_tr_b16 v[212:213], v2 offset:20480
    ds_read_b64_tr_b16 v[214:215], v2 offset:20992
    s_waitcnt lgkmcnt(4)
    s_add_u32 m0, s19, 16384
    s_add_u32 s17, s20, 1245184
    buffer_load_dwordx4 v7, s[8:11], s17 offen lds
    s_add_u32 m0, s19, 17408
    s_add_u32 s17, s20, 1261568
    buffer_load_dwordx4 v49, s[8:11], s17 offen lds
    s_add_u32 m0, s19, 18432
    s_add_u32 s17, s20, 1277952
    buffer_load_dwordx4 v7, s[8:11], s17 offen lds
    s_add_u32 m0, s19, 19456
    s_add_u32 s17, s20, 1294336
    buffer_load_dwordx4 v49, s[8:11], s17 offen lds
    ds_read_b64_tr_b16 v[216:217], v3 offset:20480
    ds_read_b64_tr_b16 v[218:219], v3 offset:20992
    ds_read_b64_tr_b16 v[220:221], v4 offset:20480
    ds_read_b64_tr_b16 v[222:223], v4 offset:20992
    s_waitcnt vmcnt(24)
    ds_read_b64_tr_b16 v[224:225], v8 offset:24576
    ds_read_b64_tr_b16 v[226:227], v8 offset:25088
    ds_read_b64_tr_b16 v[228:229], v2 offset:24576
    ds_read_b64_tr_b16 v[230:231], v2 offset:25088
    s_waitcnt lgkmcnt(4)
    s_add_u32 m0, s19, 20480
    s_add_u32 s17, s20, 1507328
    buffer_load_dwordx4 v7, s[8:11], s17 offen lds
    s_add_u32 m0, s19, 21504
    s_add_u32 s17, s20, 1523712
    buffer_load_dwordx4 v49, s[8:11], s17 offen lds
    s_add_u32 m0, s19, 22528
    s_add_u32 s17, s20, 1540096
    buffer_load_dwordx4 v7, s[8:11], s17 offen lds
    s_add_u32 m0, s19, 23552
    s_add_u32 s17, s20, 1556480
    buffer_load_dwordx4 v49, s[8:11], s17 offen lds
    ds_read_b64_tr_b16 v[232:233], v3 offset:24576
    ds_read_b64_tr_b16 v[234:235], v3 offset:25088
    ds_read_b64_tr_b16 v[236:237], v4 offset:24576
    ds_read_b64_tr_b16 v[238:239], v4 offset:25088
    s_waitcnt vmcnt(24)
    ds_read_b64_tr_b16 v[240:241], v8 offset:28672
    ds_read_b64_tr_b16 v[242:243], v8 offset:29184
    ds_read_b64_tr_b16 v[244:245], v2 offset:28672
    ds_read_b64_tr_b16 v[246:247], v2 offset:29184
    s_waitcnt lgkmcnt(4)
    s_add_u32 m0, s19, 24576
    s_add_u32 s17, s20, 1769472
    buffer_load_dwordx4 v7, s[8:11], s17 offen lds
    s_add_u32 m0, s19, 25600
    s_add_u32 s17, s20, 1785856
    buffer_load_dwordx4 v49, s[8:11], s17 offen lds
    s_add_u32 m0, s19, 26624
    s_add_u32 s17, s20, 1802240
    buffer_load_dwordx4 v7, s[8:11], s17 offen lds
    s_add_u32 m0, s19, 27648
    s_add_u32 s17, s20, 1818624
    buffer_load_dwordx4 v49, s[8:11], s17 offen lds
    ds_read_b64_tr_b16 v[248:249], v3 offset:28672
    ds_read_b64_tr_b16 v[250:251], v3 offset:29184
    ds_read_b64_tr_b16 v[252:253], v4 offset:28672
    ds_read_b64_tr_b16 v[254:255], v4 offset:29184
    s_waitcnt lgkmcnt(0)
    s_add_u32 m0, s19, 28672
    s_add_u32 s17, s20, 2031616
    buffer_load_dwordx4 v7, s[8:11], s17 offen lds
    s_add_u32 m0, s19, 29696
    s_add_u32 s17, s20, 2048000
    buffer_load_dwordx4 v49, s[8:11], s17 offen lds
    s_add_u32 m0, s19, 30720
    s_add_u32 s17, s20, 2064384
    buffer_load_dwordx4 v7, s[8:11], s17 offen lds
    s_add_u32 m0, s19, 31744
    s_add_u32 s17, s20, 2080768
    buffer_load_dwordx4 v49, s[8:11], s17 offen lds
    s_lshr_b32 s37, s37, 6
    s_add_u32 s37, s37, 54525952
    v_lshlrev_b32 v15, 4, v1
    v_add_u32 v10, s19, v15
    s_lshl_b32 s17, s16, 10
    s_add_u32 s17, s17, 131072
    v_add_u32 v14, s17, v15
    s_lshl_b32 s17, s16, 12
    s_add_u32 s18, s17, 147456
    v_add_u32 v15, s18, v15
    v_bfe_u32 v11, v1, 3, 2
    v_and_b32 v5, 7, v1
    v_lshlrev_b32 v5, 9, v5
    v_lshl_add_u32 v11, v11, 7, v5
    s_add_u32 s17, s17, 100728832
    v_add_u32 v11, s17, v11
    v_mov_b32 v12, 0
    v_and_b32 v13, 15, v1
    v_lshrrev_b32 v5, 4, v1
    v_lshlrev_b32 v5, 3, v5
    v_lshl_add_u32 v13, v13, 12, v5
    s_lshl_b32 s17, s35, 7
    s_lshl_b32 s18, s16, 5
    s_add_u32 s17, s17, s18
    s_add_u32 s17, s17, 2048
    v_add_u32 v13, s17, v13
    s_waitcnt vmcnt(0)
    v_add_u32 v10, s19, v10
    s_xor_b32 s37, s89, 201334784
    s_mov_b32 s36, 0
U_wait:
    s_mov_b32 s29, s92
U_fl:
    s_lshr_b32 s17, s28, 3
    v_cmp_ge_u32 vcc, s17, v12
    s_lshl_b32 s18, s28, 2
    s_and_b32 s18, s18, 24
    s_lshr_b32 s17, vcc_lo, s18
    s_and_b32 s17, s17, 0xff
    s_cbranch_scc0 U_go
    s_cmp_ge_u32 s29, 1048576
    s_cselect_b32 s92, 1048576, s92
    s_cbranch_scc1 U_go
    s_lshl_b32 s17, s17, s18
    s_cmp_eq_u32 s29, 0
    s_cselect_b32 exec_lo, -1, s17
    s_mov_b32 exec_hi, 0
    s_add_u32 s29, s29, 1
    buffer_load_dword v12, v11, s[4:7], 0 offen sc1
    s_mov_b64 exec, -1
    s_sleep 2
    s_waitcnt vmcnt(0)
    s_branch U_fl
U_go:
    s_mul_i32 s30, s28, 263168
    s_and_b32 s30, s30, 33300480
    s_xor_b32 s30, s30, s37
    buffer_load_dwordx4 v[64:67], v10, s[4:7], s30 offen offset:0
    buffer_load_dwordx4 v[68:71], v10, s[4:7], s30 offen offset:1024
    buffer_load_dwordx4 v[72:75], v10, s[4:7], s30 offen offset:2048
    buffer_load_dwordx4 v[76:79], v10, s[4:7], s30 offen offset:3072
    s_add_u32 s30, s30, 4096
    buffer_load_dwordx4 v[80:83], v10, s[4:7], s30 offen offset:0
    buffer_load_dwordx4 v[84:87], v10, s[4:7], s30 offen offset:1024
    buffer_load_dwordx4 v[88:91], v10, s[4:7], s30 offen offset:2048
    buffer_load_dwordx4 v[92:95], v10, s[4:7], s30 offen offset:3072
    s_add_u32 s30, s30, 12288
    buffer_load_dwordx4 v[96:99], v10, s[4:7], s30 offen offset:0
    buffer_load_dwordx4 v[100:103], v10, s[4:7], s30 offen offset:1024
    buffer_load_dwordx4 v[104:107], v10, s[4:7], s30 offen offset:2048
    buffer_load_dwordx4 v[108:111], v10, s[4:7], s30 offen offset:3072
    s_add_u32 s30, s30, 4096
    buffer_load_dwordx4 v[112:115], v10, s[4:7], s30 offen offset:0
    buffer_load_dwordx4 v[116:119], v10, s[4:7], s30 offen offset:1024
    buffer_load_dwordx4 v[120:123], v10, s[4:7], s30 offen offset:2048
    s_mov_b32 s34, 0
    s_mov_b32 s31, 1073741824
    ds_read_b128 v[48:51], v15 offset:0
    ds_read_b128 v[52:55], v15 offset:1024
    ds_read_b128 v[56:59], v15 offset:2048
    ds_read_b128 v[60:63], v15 offset:3072
.p2align 6
U_item:
    s_waitcnt vmcnt(14)
    v_mfma_f32_16x16x32_bf16 v[16:19], a[0:3], v[64:67], 0
    buffer_load_dwordx4 v[124:127], v10, s[4:7], s30 offen offset:3072
    v_mfma_f32_16x16x32_bf16 v[20:23], a[4:7], v[64:67], 0
    s_add_u32 s33, s28, 6
    s_lshr_b32 s17, s33, 3
    v_cmp_ge_u32 vcc, s17, v12
    s_lshl_b32 s18, s33, 2
    s_and_b32 s18, s18, 24
    ds_read_b64_tr_b16 v[32:33], v8 offset:0
    v_mfma_f32_16x16x32_bf16 v[24:27], a[8:11], v[64:67], 0
    s_lshr_b32 s17, vcc_lo, s18
    s_and_b32 s17, s17, 0xff
    s_lshl_b32 exec_lo, s17, s18
    s_mov_b32 exec_hi, 0
    buffer_load_dword v12, v11, s[4:7], 0 offen sc1
    s_mov_b64 exec, -1
    ds_read_b64_tr_b16 v[34:35], v8 offset:512
    v_mfma_f32_16x16x32_bf16 v[28:31], a[12:15], v[64:67], 0
    ds_read_b64_tr_b16 v[36:37], v2 offset:0
    ds_read_b64_tr_b16 v[38:39], v2 offset:512
    s_waitcnt vmcnt(15)
    v_mfma_f32_16x16x32_bf16 v[16:19], a[16:19], v[68:71], v[16:19]
    s_add_u32 s30, s30, 12288
    buffer_load_dwordx4 v[64:67], v10, s[4:7], s30 offen offset:0
    v_mfma_f32_16x16x32_bf16 v[20:23], a[20:23], v[68:71], v[20:23]
    ds_read_b64_tr_b16 v[40:41], v3 offset:0
    v_mfma_f32_16x16x32_bf16 v[24:27], a[24:27], v[68:71], v[24:27]
    ds_read_b64_tr_b16 v[42:43], v3 offset:512
    v_mfma_f32_16x16x32_bf16 v[28:31], a[28:31], v[68:71], v[28:31]
    ds_read_b64_tr_b16 v[44:45], v4 offset:0
    ds_read_b64_tr_b16 v[46:47], v4 offset:512
    s_waitcnt vmcnt(15)
    v_mfma_f32_16x16x32_bf16 v[16:19], a[32:35], v[72:75], v[16:19]
    buffer_load_dwordx4 v[68:71], v10, s[4:7], s30 offen offset:1024
    v_mfma_f32_16x16x32_bf16 v[20:23], a[36:39], v[72:75], v[20:23]
    s_waitcnt lgkmcnt(8)
    s_cmp_eq_u32 s34, 0
    s_cbranch_scc1 U_nb
    s_barrier
U_nb:
    v_mfma_f32_16x16x32_bf16 v[24:27], a[40:43], v[72:75], v[24:27]
    ds_read_b128 v[48:51], v15 offset:0
    ds_read_b128 v[52:55], v15 offset:1024
    v_mfma_f32_16x16x32_bf16 v[28:31], a[44:47], v[72:75], v[28:31]
    ds_read_b128 v[56:59], v15 offset:2048
    ds_read_b128 v[60:63], v15 offset:3072
    s_waitcnt vmcnt(15)
    s_waitcnt lgkmcnt(4)
    v_mfma_f32_16x16x32_bf16 v[16:19], v[32:35], v[76:79], v[16:19]
    buffer_load_dwordx4 v[72:75], v10, s[4:7], s30 offen offset:2048
    v_mfma_f32_16x16x32_bf16 v[20:23], v[36:39], v[76:79], v[20:23]
    v_mfma_f32_16x16x32_bf16 v[24:27], v[40:43], v[76:79], v[24:27]
    v_mfma_f32_16x16x32_bf16 v[28:31], v[44:47], v[76:79], v[28:31]
    s_waitcnt vmcnt(15)
    v_mfma_f32_16x16x32_bf16 v[16:19], a[48:51], v[80:83], v[16:19]
    buffer_load_dwordx4 v[76:79], v10, s[4:7], s30 offen offset:3072
    s_waitcnt lgkmcnt(0)
    v_mfma_f32_16x16x32_bf16 v[20:23], a[52:55], v[80:83], v[20:23]
    v_add_f32 v48, v48, v52
    v_add_f32 v49, v49, v53
    ds_read_b64_tr_b16 v[32:33], v8 offset:4096
    v_mfma_f32_16x16x32_bf16 v[24:27], a[56:59], v[80:83], v[24:27]
    v_add_f32 v50, v50, v54
    v_add_f32 v51, v51, v55
    ds_read_b64_tr_b16 v[34:35], v8 offset:4608
    v_mfma_f32_16x16x32_bf16 v[28:31], a[60:63], v[80:83], v[28:31]
    ds_read_b64_tr_b16 v[36:37], v2 offset:4096
    ds_read_b64_tr_b16 v[38:39], v2 offset:4608
    s_waitcnt vmcnt(15)
    v_mfma_f32_16x16x32_bf16 v[16:19], a[64:67], v[84:87], v[16:19]
    s_add_u32 s30, s30, 4096
    buffer_load_dwordx4 v[80:83], v10, s[4:7], s30 offen offset:0
    v_mfma_f32_16x16x32_bf16 v[20:23], a[68:71], v[84:87], v[20:23]
    v_add_f32 v56, v56, v60
    v_add_f32 v57, v57, v61
    ds_read_b64_tr_b16 v[40:41], v3 offset:4096
    v_mfma_f32_16x16x32_bf16 v[24:27], a[72:75], v[84:87], v[24:27]
    v_add_f32 v58, v58, v62
    v_add_f32 v59, v59, v63
    ds_read_b64_tr_b16 v[42:43], v3 offset:4608
    v_mfma_f32_16x16x32_bf16 v[28:31], a[76:79], v[84:87], v[28:31]
    ds_read_b64_tr_b16 v[44:45], v4 offset:4096
    ds_read_b64_tr_b16 v[46:47], v4 offset:4608
    s_waitcnt vmcnt(15)
    v_mfma_f32_16x16x32_bf16 v[16:19], a[80:83], v[88:91], v[16:19]
    buffer_load_dwordx4 v[84:87], v10, s[4:7], s30 offen offset:1024
    v_mfma_f32_16x16x32_bf16 v[20:23], a[84:87], v[88:91], v[20:23]
    v_add_f32 v48, v48, v56
    v_add_f32 v49, v49, v57
    v_mfma_f32_16x16x32_bf16 v[24:27], a[88:91], v[88:91], v[24:27]
    v_add_f32 v50, v50, v58
    v_add_f32 v51, v51, v59
    v_mfma_f32_16x16x32_bf16 v[28:31], a[92:95], v[88:91], v[28:31]
    s_waitcnt vmcnt(15)
    s_waitcnt lgkmcnt(0)
    v_mfma_f32_16x16x32_bf16 v[16:19], v[32:35], v[92:95], v[16:19]
    buffer_load_dwordx4 v[88:91], v10, s[4:7], s30 offen offset:2048
    v_mfma_f32_16x16x32_bf16 v[20:23], v[36:39], v[92:95], v[20:23]
    v_cvt_pk_bf16_f32 v52, v48, v49
    v_cvt_pk_bf16_f32 v53, v50, v51
    v_mfma_f32_16x16x32_bf16 v[24:27], v[40:43], v[92:95], v[24:27]
    v_mfma_f32_16x16x32_bf16 v[28:31], v[44:47], v[92:95], v[28:31]
    s_waitcnt vmcnt(15)
    v_mfma_f32_16x16x32_bf16 v[16:19], a[96:99], v[96:99], v[16:19]
    buffer_load_dwordx4 v[92:95], v10, s[4:7], s30 offen offset:3072
    v_mfma_f32_16x16x32_bf16 v[20:23], a[100:103], v[96:99], v[20:23]
    buffer_store_dwordx2 v[52:53], v13, s[12:15], s31 offen
    v_xor_b32 v15, 0x4000, v15
    ds_read_b64_tr_b16 v[32:33], v8 offset:8192
    v_mfma_f32_16x16x32_bf16 v[24:27], a[104:107], v[96:99], v[24:27]
    ds_read_b64_tr_b16 v[34:35], v8 offset:8704
    v_mfma_f32_16x16x32_bf16 v[28:31], a[108:111], v[96:99], v[28:31]
    ds_read_b64_tr_b16 v[36:37], v2 offset:8192
    ds_read_b64_tr_b16 v[38:39], v2 offset:8704
    s_waitcnt vmcnt(16)
    v_mfma_f32_16x16x32_bf16 v[16:19], a[112:115], v[100:103], v[16:19]
    s_add_u32 s30, s30, 12288
    buffer_load_dwordx4 v[96:99], v10, s[4:7], s30 offen offset:0
    v_mfma_f32_16x16x32_bf16 v[20:23], a[116:119], v[100:103], v[20:23]
    ds_read_b64_tr_b16 v[40:41], v3 offset:8192
    v_mfma_f32_16x16x32_bf16 v[24:27], a[120:123], v[100:103], v[24:27]
    ds_read_b64_tr_b16 v[42:43], v3 offset:8704
    v_mfma_f32_16x16x32_bf16 v[28:31], a[124:127], v[100:103], v[28:31]
    ds_read_b64_tr_b16 v[44:45], v4 offset:8192
    ds_read_b64_tr_b16 v[46:47], v4 offset:8704
    s_waitcnt vmcnt(16)
    v_mfma_f32_16x16x32_bf16 v[16:19], a[128:131], v[104:107], v[16:19]
    buffer_load_dwordx4 v[100:103], v10, s[4:7], s30 offen offset:1024
    v_mfma_f32_16x16x32_bf16 v[20:23], a[132:135], v[104:107], v[20:23]
    v_mfma_f32_16x16x32_bf16 v[24:27], a[136:139], v[104:107], v[24:27]
    v_mfma_f32_16x16x32_bf16 v[28:31], a[140:143], v[104:107], v[28:31]
    s_waitcnt vmcnt(16)
    s_waitcnt lgkmcnt(0)
    v_mfma_f32_16x16x32_bf16 v[16:19], v[32:35], v[108:111], v[16:19]
    buffer_load_dwordx4 v[104:107], v10, s[4:7], s30 offen offset:2048
    v_mfma_f32_16x16x32_bf16 v[20:23], v[36:39], v[108:111], v[20:23]
    v_mfma_f32_16x16x32_bf16 v[24:27], v[40:43], v[108:111], v[24:27]
    v_mfma_f32_16x16x32_bf16 v[28:31], v[44:47], v[108:111], v[28:31]
    s_waitcnt vmcnt(16)
    v_mfma_f32_16x16x32_bf16 v[16:19], a[144:147], v[112:115], v[16:19]
    buffer_load_dwordx4 v[108:111], v10, s[4:7], s30 offen offset:3072
    v_mfma_f32_16x16x32_bf16 v[20:23], a[148:151], v[112:115], v[20:23]
    ds_read_b64_tr_b16 v[32:33], v8 offset:12288
    v_mfma_f32_16x16x32_bf16 v[24:27], a[152:155], v[112:115], v[24:27]
    ds_read_b64_tr_b16 v[34:35], v8 offset:12800
    v_mfma_f32_16x16x32_bf16 v[28:31], a[156:159], v[112:115], v[28:31]
    ds_read_b64_tr_b16 v[36:37], v2 offset:12288
    ds_read_b64_tr_b16 v[38:39], v2 offset:12800
    s_waitcnt vmcnt(16)
    v_mfma_f32_16x16x32_bf16 v[16:19], a[160:163], v[116:119], v[16:19]
    s_add_u32 s30, s30, 4096
    buffer_load_dwordx4 v[112:115], v10, s[4:7], s30 offen offset:0
    v_mfma_f32_16x16x32_bf16 v[20:23], a[164:167], v[116:119], v[20:23]
    ds_read_b64_tr_b16 v[40:41], v3 offset:12288
    v_mfma_f32_16x16x32_bf16 v[24:27], a[168:171], v[116:119], v[24:27]
    ds_read_b64_tr_b16 v[42:43], v3 offset:12800
    v_mfma_f32_16x16x32_bf16 v[28:31], a[172:175], v[116:119], v[28:31]
    ds_read_b64_tr_b16 v[44:45], v4 offset:12288
    ds_read_b64_tr_b16 v[46:47], v4 offset:12800
    s_waitcnt vmcnt(16)
    v_mfma_f32_16x16x32_bf16 v[16:19], a[176:179], v[120:123], v[16:19]
    buffer_load_dwordx4 v[116:119], v10, s[4:7], s30 offen offset:1024
    v_mfma_f32_16x16x32_bf16 v[20:23], a[180:183], v[120:123], v[20:23]
    v_mfma_f32_16x16x32_bf16 v[24:27], a[184:187], v[120:123], v[24:27]
    v_mfma_f32_16x16x32_bf16 v[28:31], a[188:191], v[120:123], v[28:31]
    s_waitcnt vmcnt(16)
    s_waitcnt lgkmcnt(0)
    v_mfma_f32_16x16x32_bf16 v[16:19], v[32:35], v[124:127], v[16:19]
    buffer_load_dwordx4 v[120:123], v10, s[4:7], s30 offen offset:2048
    v_mfma_f32_16x16x32_bf16 v[20:23], v[36:39], v[124:127], v[20:23]
    v_mfma_f32_16x16x32_bf16 v[24:27], v[40:43], v[124:127], v[24:27]
    v_mfma_f32_16x16x32_bf16 v[28:31], v[44:47], v[124:127], v[28:31]
    s_waitcnt vmcnt(15)
    v_mfma_f32_16x16x32_bf16 v[16:19], a[192:195], v[64:67], v[16:19]
    buffer_load_dwordx4 v[124:127], v10, s[4:7], s30 offen offset:3072
    v_mfma_f32_16x16x32_bf16 v[20:23], a[196:199], v[64:67], v[20:23]
    s_lshr_b32 s17, s33, 3
    v_cmp_ge_u32 vcc, s17, v12
    s_lshl_b32 s18, s33, 2
    s_and_b32 s18, s18, 24
    ds_read_b64_tr_b16 v[32:33], v8 offset:16384
    v_mfma_f32_16x16x32_bf16 v[24:27], a[200:203], v[64:67], v[24:27]
    s_mul_i32 s30, s33, 263168
    s_and_b32 s30, s30, 33300480
    s_xor_b32 s30, s30, s37
    s_lshr_b32 s17, vcc_lo, s18
    s_and_b32 s17, s17, 0xff
    s_cselect_b32 s34, 0, 1
    s_cselect_b32 s30, 1073741824, s30
    ds_read_b64_tr_b16 v[34:35], v8 offset:16896
    v_mfma_f32_16x16x32_bf16 v[28:31], a[204:207], v[64:67], v[28:31]
    ds_read_b64_tr_b16 v[36:37], v2 offset:16384
    ds_read_b64_tr_b16 v[38:39], v2 offset:16896
    s_waitcnt vmcnt(15)
    v_mfma_f32_16x16x32_bf16 v[16:19], a[208:211], v[68:71], v[16:19]
    buffer_load_dwordx4 v[64:67], v10, s[4:7], s30 offen offset:0
    v_mfma_f32_16x16x32_bf16 v[20:23], a[212:215], v[68:71], v[20:23]
    ds_read_b64_tr_b16 v[40:41], v3 offset:16384
    v_mfma_f32_16x16x32_bf16 v[24:27], a[216:219], v[68:71], v[24:27]
    ds_read_b64_tr_b16 v[42:43], v3 offset:16896
    v_mfma_f32_16x16x32_bf16 v[28:31], a[220:223], v[68:71], v[28:31]
    ds_read_b64_tr_b16 v[44:45], v4 offset:16384
    ds_read_b64_tr_b16 v[46:47], v4 offset:16896
    s_waitcnt vmcnt(15)
    v_mfma_f32_16x16x32_bf16 v[16:19], a[224:227], v[72:75], v[16:19]
    buffer_load_dwordx4 v[68:71], v10, s[4:7], s30 offen offset:1024
    v_mfma_f32_16x16x32_bf16 v[20:23], a[228:231], v[72:75], v[20:23]
    v_mfma_f32_16x16x32_bf16 v[24:27], a[232:235], v[72:75], v[24:27]
    v_mfma_f32_16x16x32_bf16 v[28:31], a[236:239], v[72:75], v[28:31]
    s_waitcnt vmcnt(15)
    s_waitcnt lgkmcnt(0)
    v_mfma_f32_16x16x32_bf16 v[16:19], v[32:35], v[76:79], v[16:19]
    buffer_load_dwordx4 v[72:75], v10, s[4:7], s30 offen offset:2048
    v_mfma_f32_16x16x32_bf16 v[20:23], v[36:39], v[76:79], v[20:23]
    v_mfma_f32_16x16x32_bf16 v[24:27], v[40:43], v[76:79], v[24:27]
    v_mfma_f32_16x16x32_bf16 v[28:31], v[44:47], v[76:79], v[28:31]
    s_waitcnt vmcnt(15)
    v_mfma_f32_16x16x32_bf16 v[16:19], a[240:243], v[80:83], v[16:19]
    buffer_load_dwordx4 v[76:79], v10, s[4:7], s30 offen offset:3072
    v_mfma_f32_16x16x32_bf16 v[20:23], a[244:247], v[80:83], v[20:23]
    ds_read_b64_tr_b16 v[32:33], v8 offset:20480
    v_mfma_f32_16x16x32_bf16 v[24:27], a[248:251], v[80:83], v[24:27]
    ds_read_b64_tr_b16 v[34:35], v8 offset:20992
    v_mfma_f32_16x16x32_bf16 v[28:31], a[252:255], v[80:83], v[28:31]
    ds_read_b64_tr_b16 v[36:37], v2 offset:20480
    ds_read_b64_tr_b16 v[38:39], v2 offset:20992
    s_waitcnt vmcnt(15)
    v_mfma_f32_16x16x32_bf16 v[16:19], v[128:131], v[84:87], v[16:19]
    s_add_u32 s30, s30, 4096
    buffer_load_dwordx4 v[80:83], v10, s[4:7], s30 offen offset:0
    v_mfma_f32_16x16x32_bf16 v[20:23], v[132:135], v[84:87], v[20:23]
    ds_read_b64_tr_b16 v[40:41], v3 offset:20480
    v_mfma_f32_16x16x32_bf16 v[24:27], v[136:139], v[84:87], v[24:27]
    ds_read_b64_tr_b16 v[42:43], v3 offset:20992
    v_mfma_f32_16x16x32_bf16 v[28:31], v[140:143], v[84:87], v[28:31]
    ds_read_b64_tr_b16 v[44:45], v4 offset:20480
    ds_read_b64_tr_b16 v[46:47], v4 offset:20992
    s_waitcnt vmcnt(15)
    v_mfma_f32_16x16x32_bf16 v[16:19], v[144:147], v[88:91], v[16:19]
    buffer_load_dwordx4 v[84:87], v10, s[4:7], s30 offen offset:1024
    v_mfma_f32_16x16x32_bf16 v[20:23], v[148:151], v[88:91], v[20:23]
    v_mfma_f32_16x16x32_bf16 v[24:27], v[152:155], v[88:91], v[24:27]
    v_mfma_f32_16x16x32_bf16 v[28:31], v[156:159], v[88:91], v[28:31]
    s_waitcnt vmcnt(15)
    s_waitcnt lgkmcnt(0)
    v_mfma_f32_16x16x32_bf16 v[16:19], v[32:35], v[92:95], v[16:19]
    buffer_load_dwordx4 v[88:91], v10, s[4:7], s30 offen offset:2048
    v_mfma_f32_16x16x32_bf16 v[20:23], v[36:39], v[92:95], v[20:23]
    v_mfma_f32_16x16x32_bf16 v[24:27], v[40:43], v[92:95], v[24:27]
    v_mfma_f32_16x16x32_bf16 v[28:31], v[44:47], v[92:95], v[28:31]
    s_waitcnt vmcnt(14)
    v_mfma_f32_16x16x32_bf16 v[16:19], v[160:163], v[96:99], v[16:19]
    buffer_load_dwordx4 v[92:95], v10, s[4:7], s30 offen offset:3072
    v_mfma_f32_16x16x32_bf16 v[20:23], v[164:167], v[96:99], v[20:23]
    ds_read_b64_tr_b16 v[32:33], v8 offset:24576
    v_mfma_f32_16x16x32_bf16 v[24:27], v[168:171], v[96:99], v[24:27]
    ds_read_b64_tr_b16 v[34:35], v8 offset:25088
    v_mfma_f32_16x16x32_bf16 v[28:31], v[172:175], v[96:99], v[28:31]
    ds_read_b64_tr_b16 v[36:37], v2 offset:24576
    ds_read_b64_tr_b16 v[38:39], v2 offset:25088
    s_waitcnt vmcnt(14)
    v_mfma_f32_16x16x32_bf16 v[16:19], v[176:179], v[100:103], v[16:19]
    s_add_u32 s30, s30, 12288
    buffer_load_dwordx4 v[96:99], v10, s[4:7], s30 offen offset:0
    v_mfma_f32_16x16x32_bf16 v[20:23], v[180:183], v[100:103], v[20:23]
    ds_read_b64_tr_b16 v[40:41], v3 offset:24576
    v_mfma_f32_16x16x32_bf16 v[24:27], v[184:187], v[100:103], v[24:27]
    ds_read_b64_tr_b16 v[42:43], v3 offset:25088
    v_mfma_f32_16x16x32_bf16 v[28:31], v[188:191], v[100:103], v[28:31]
    ds_read_b64_tr_b16 v[44:45], v4 offset:24576
    ds_read_b64_tr_b16 v[46:47], v4 offset:25088
    s_waitcnt vmcnt(14)
    v_mfma_f32_16x16x32_bf16 v[16:19], v[192:195], v[104:107], v[16:19]
    buffer_load_dwordx4 v[100:103], v10, s[4:7], s30 offen offset:1024
    v_mfma_f32_16x16x32_bf16 v[20:23], v[196:199], v[104:107], v[20:23]
    v_mfma_f32_16x16x32_bf16 v[24:27], v[200:203], v[104:107], v[24:27]
    v_mfma_f32_16x16x32_bf16 v[28:31], v[204:207], v[104:107], v[28:31]
    s_waitcnt vmcnt(14)
    s_waitcnt lgkmcnt(0)
    v_mfma_f32_16x16x32_bf16 v[16:19], v[32:35], v[108:111], v[16:19]
    buffer_load_dwordx4 v[104:107], v10, s[4:7], s30 offen offset:2048
    v_mfma_f32_16x16x32_bf16 v[20:23], v[36:39], v[108:111], v[20:23]
    v_mfma_f32_16x16x32_bf16 v[24:27], v[40:43], v[108:111], v[24:27]
    v_mfma_f32_16x16x32_bf16 v[28:31], v[44:47], v[108:111], v[28:31]
    s_waitcnt vmcnt(14)
    v_mfma_f32_16x16x32_bf16 v[16:19], v[208:211], v[112:115], v[16:19]
    buffer_load_dwordx4 v[108:111], v10, s[4:7], s30 offen offset:3072
    v_mfma_f32_16x16x32_bf16 v[20:23], v[212:215], v[112:115], v[20:23]
    ds_read_b64_tr_b16 v[32:33], v8 offset:28672
    v_mfma_f32_16x16x32_bf16 v[24:27], v[216:219], v[112:115], v[24:27]
    ds_read_b64_tr_b16 v[34:35], v8 offset:29184
    v_mfma_f32_16x16x32_bf16 v[28:31], v[220:223], v[112:115], v[28:31]
    ds_read_b64_tr_b16 v[36:37], v2 offset:28672
    ds_read_b64_tr_b16 v[38:39], v2 offset:29184
    s_waitcnt vmcnt(14)
    v_mfma_f32_16x16x32_bf16 v[16:19], v[224:227], v[116:119], v[16:19]
    s_add_u32 s30, s30, 4096
    buffer_load_dwordx4 v[112:115], v10, s[4:7], s30 offen offset:0
    v_mfma_f32_16x16x32_bf16 v[20:23], v[228:231], v[116:119], v[20:23]
    ds_read_b64_tr_b16 v[40:41], v3 offset:28672
    v_mfma_f32_16x16x32_bf16 v[24:27], v[232:235], v[116:119], v[24:27]
    ds_read_b64_tr_b16 v[42:43], v3 offset:29184
    v_mfma_f32_16x16x32_bf16 v[28:31], v[236:239], v[116:119], v[28:31]
    ds_read_b64_tr_b16 v[44:45], v4 offset:28672
    ds_read_b64_tr_b16 v[46:47], v4 offset:29184
    s_waitcnt vmcnt(14)
    v_mfma_f32_16x16x32_bf16 v[16:19], v[240:243], v[120:123], v[16:19]
    buffer_load_dwordx4 v[116:119], v10, s[4:7], s30 offen offset:1024
    v_mfma_f32_16x16x32_bf16 v[20:23], v[244:247], v[120:123], v[20:23]
    v_mfma_f32_16x16x32_bf16 v[24:27], v[248:251], v[120:123], v[24:27]
    v_mfma_f32_16x16x32_bf16 v[28:31], v[252:255], v[120:123], v[28:31]
    s_waitcnt vmcnt(14)
    s_waitcnt lgkmcnt(0)
    v_mfma_f32_16x16x32_bf16 v[16:19], v[32:35], v[124:127], v[16:19]
    buffer_load_dwordx4 v[120:123], v10, s[4:7], s30 offen offset:2048
    v_mfma_f32_16x16x32_bf16 v[20:23], v[36:39], v[124:127], v[20:23]
    v_mfma_f32_16x16x32_bf16 v[24:27], v[40:43], v[124:127], v[24:27]
    v_mfma_f32_16x16x32_bf16 v[28:31], v[44:47], v[124:127], v[28:31]
    s_lshl_b32 s31, s28, 16
    s_mov_b32 s28, s33
    s_cmp_eq_u32 s34, 1
    ds_write_b128 v14, v[16:19] offset:0
    ds_write_b128 v14, v[20:23] offset:4096
    ds_write_b128 v14, v[24:27] offset:8192
    s_nop 1
    ds_write_b128 v14, v[28:31] offset:12288
    v_xor_b32 v14, 0x4000, v14
    s_cbranch_scc1 U_item
    s_waitcnt lgkmcnt(0)
    s_barrier
    ds_read_b128 v[48:51], v15 offset:0
    ds_read_b128 v[52:55], v15 offset:1024
    ds_read_b128 v[56:59], v15 offset:2048
    ds_read_b128 v[60:63], v15 offset:3072
    s_waitcnt lgkmcnt(0)
    v_add_f32 v48, v48, v52
    v_add_f32 v49, v49, v53
    v_add_f32 v50, v50, v54
    v_add_f32 v51, v51, v55
    v_add_f32 v56, v56, v60
    v_add_f32 v57, v57, v61
    v_add_f32 v58, v58, v62
    v_add_f32 v59, v59, v63
    v_add_f32 v48, v48, v56
    v_add_f32 v49, v49, v57
    v_add_f32 v50, v50, v58
    v_add_f32 v51, v51, v59
    v_cvt_pk_bf16_f32 v52, v48, v49
    v_cvt_pk_bf16_f32 v53, v50, v51
    buffer_store_dwordx2 v[52:53], v13, s[12:15], s31 offen
    s_cmp_lt_u32 s28, 128
    s_cbranch_scc1 U_wait
    s_branch W_fin
W_F:
    s_waitcnt vmcnt(0)
    s_barrier
    s_cmp_lg_u32 s16, 0
    s_cbranch_scc1 reg_16
    s_and_b32 s17, s2, 3
    s_lshl_b32 s17, s17, 3
    s_lshl_b32 s18, s98, 2
    s_add_u32 s17, s17, s18
    s_lshl_b32 s17, 1, s17
    s_andn2_b32 s18, s2, 3
    v_mov_b32 v5, s18
    v_mov_b32 v6, s17
    s_mov_b64 exec, 1
    global_atomic_add v5, v6, s[100:101] sc1
    s_mov_b64 exec, -1
reg_16:
    s_load_dwordx2 s[48:49], s[0:1], 8
    s_load_dwordx2 s[52:53], s[0:1], 16
    s_mov_b32 s50, 2101248
    s_mov_b32 s51, 0x20000
    s_mov_b32 s54, 2101248
    s_mov_b32 s55, 0x20000
    s_load_dwordx2 s[40:41], s[0:1], 0
    s_load_dwordx2 s[44:45], s[0:1], 24
    s_mov_b32 s42, 4194304
    s_mov_b32 s43, 0x20000
    s_mov_b32 s46, 4194304
    s_mov_b32 s47, 0x20000
    s_lshr_b32 s28, s93, 3
    s_and_b32 s29, s93, 7
    s_lshl_b32 s29, s29, 2
    s_add_u32 s29, s29, s16
    v_bfe_u32 v5, v1, 2, 2
    v_and_b32 v7, 3, v1
    v_lshl_add_u32 v7, v5, 3, v7
    s_lshl_b32 s17, s29, 5
    v_add_u32 v7, s17, v7
    v_lshrrev_b32 v8, 4, v1
    v_cvt_f32_u32 v8, v8
    s_mov_b32 s31, 981467136
    v_add_u32 v5, 0, v7
    v_lshrrev_b32 v6, 1, v5
    v_and_b32 v30, 1, v5
    v_cmp_eq_u32 vcc, 1, v5
    v_mov_b32 v5, 512
    s_nop 0
    v_cndmask_b32 v6, v6, v5, vcc
    v_cndmask_b32 v30, v30, 0, vcc
    v_add_u32 v5, v6, v30
    v_bfe_i32 v40, v5, 1, 1
    v_add_u32 v5, v6, v5
    v_bfe_i32 v42, v5, 1, 1
    v_add_u32 v5, v6, v5
    v_bfe_i32 v44, v5, 1, 1
    v_and_b32 v40, 0x80008000, v40
    v_and_b32 v42, 0x80008000, v42
    v_and_b32 v44, 0x80008000, v44
    v_cvt_f32_u32 v6, v6
    v_cvt_f32_u32 v30, v30
    v_mul_f32 v32, s31, v6
    v_mul_f32 v30, 0x3e800000, v30
    v_mov_b32 v34, v32
    v_mul_f32 v36, 0x42000000, v32
    v_mul_f32 v5, 0x41000000, v32
    v_fma_f32 v30, v5, v8, v30
    v_add_u32 v5, 4, v7
    v_lshrrev_b32 v6, 1, v5
    v_and_b32 v31, 1, v5
    v_cmp_eq_u32 vcc, 1, v5
    v_mov_b32 v5, 512
    s_nop 0
    v_cndmask_b32 v6, v6, v5, vcc
    v_cndmask_b32 v31, v31, 0, vcc
    v_add_u32 v5, v6, v31
    v_bfe_i32 v41, v5, 1, 1
    v_add_u32 v5, v6, v5
    v_bfe_i32 v43, v5, 1, 1
    v_add_u32 v5, v6, v5
    v_bfe_i32 v45, v5, 1, 1
    v_and_b32 v41, 0x80008000, v41
    v_and_b32 v43, 0x80008000, v43
    v_and_b32 v45, 0x80008000, v45
    v_cvt_f32_u32 v6, v6
    v_cvt_f32_u32 v31, v31
    v_mul_f32 v33, s31, v6
    v_mul_f32 v31, 0x3e800000, v31
    v_mov_b32 v35, v33
    v_mul_f32 v37, 0x42000000, v33
    v_mul_f32 v5, 0x41000000, v33
    v_fma_f32 v31, v5, v8, v31
    v_fract_f32 v48, v30
    v_add_f32 v49, v48, v32
    v_cos_f32 v56, v48
    v_add_f32 v50, v49, v34
    v_cos_f32 v57, v49
    v_add_f32 v51, v50, v32
    v_cos_f32 v58, v50
    v_add_f32 v52, v51, v34
    v_cos_f32 v59, v51
    v_add_f32 v53, v52, v32
    v_cos_f32 v60, v52
    v_add_f32 v54, v53, v34
    v_cos_f32 v61, v53
    v_add_f32 v55, v54, v32
    v_cos_f32 v62, v54
    v_cos_f32 v63, v55
    v_add_f32 v30, v48, v36
    v_cvt_pk_bf16_f32 v64, v56, v57
    v_cvt_pk_bf16_f32 v65, v58, v59
    v_cvt_pk_bf16_f32 v66, v60, v61
    v_cvt_pk_bf16_f32 v67, v62, v63
    v_accvgpr_write_b32 a0, v64
    v_accvgpr_write_b32 a1, v65
    v_accvgpr_write_b32 a2, v66
    v_accvgpr_write_b32 a3, v67
    v_xor_b32_dpp v68, v64, v40 quad_perm:[0,1,3,2] row_mask:0xf bank_mask:0xf
    v_xor_b32_dpp v69, v65, v40 quad_perm:[0,1,3,2] row_mask:0xf bank_mask:0xf
    v_xor_b32_dpp v70, v66, v40 quad_perm:[0,1,3,2] row_mask:0xf bank_mask:0xf
    v_xor_b32_dpp v71, v67, v40 quad_perm:[0,1,3,2] row_mask:0xf bank_mask:0xf
    v_accvgpr_write_b32 a64, v68
    v_accvgpr_write_b32 a65, v69
    v_accvgpr_write_b32 a66, v70
    v_accvgpr_write_b32 a67, v71
    v_xor_b32 v68, v64, v42
    v_xor_b32 v69, v65, v42
    v_xor_b32 v70, v66, v42
    v_xor_b32 v71, v67, v42
    v_accvgpr_write_b32 a128, v68
    v_accvgpr_write_b32 a129, v69
    v_accvgpr_write_b32 a130, v70
    v_accvgpr_write_b32 a131, v71
    v_xor_b32_dpp v68, v64, v44 quad_perm:[0,1,3,2] row_mask:0xf bank_mask:0xf
    v_xor_b32_dpp v69, v65, v44 quad_perm:[0,1,3,2] row_mask:0xf bank_mask:0xf
    v_xor_b32_dpp v70, v66, v44 quad_perm:[0,1,3,2] row_mask:0xf bank_mask:0xf
    v_xor_b32_dpp v71, v67, v44 quad_perm:[0,1,3,2] row_mask:0xf bank_mask:0xf
    v_accvgpr_write_b32 a192, v68
    v_accvgpr_write_b32 a193, v69
    v_accvgpr_write_b32 a194, v70
    v_accvgpr_write_b32 a195, v71
    v_fract_f32 v48, v31
    v_add_f32 v49, v48, v33
    v_cos_f32 v56, v48
    v_add_f32 v50, v49, v35
    v_cos_f32 v57, v49
    v_add_f32 v51, v50, v33
    v_cos_f32 v58, v50
    v_add_f32 v52, v51, v35
    v_cos_f32 v59, v51
    v_add_f32 v53, v52, v33
    v_cos_f32 v60, v52
    v_add_f32 v54, v53, v35
    v_cos_f32 v61, v53
    v_add_f32 v55, v54, v33
    v_cos_f32 v62, v54
    v_cos_f32 v63, v55
    v_add_f32 v31, v48, v37
    v_cvt_pk_bf16_f32 v64, v56, v57
    v_cvt_pk_bf16_f32 v65, v58, v59
    v_cvt_pk_bf16_f32 v66, v60, v61
    v_cvt_pk_bf16_f32 v67, v62, v63
    v_accvgpr_write_b32 a4, v64
    v_accvgpr_write_b32 a5, v65
    v_accvgpr_write_b32 a6, v66
    v_accvgpr_write_b32 a7, v67
    v_xor_b32_dpp v68, v64, v41 quad_perm:[0,1,3,2] row_mask:0xf bank_mask:0xf
    v_xor_b32_dpp v69, v65, v41 quad_perm:[0,1,3,2] row_mask:0xf bank_mask:0xf
    v_xor_b32_dpp v70, v66, v41 quad_perm:[0,1,3,2] row_mask:0xf bank_mask:0xf
    v_xor_b32_dpp v71, v67, v41 quad_perm:[0,1,3,2] row_mask:0xf bank_mask:0xf
    v_accvgpr_write_b32 a68, v68
    v_accvgpr_write_b32 a69, v69
    v_accvgpr_write_b32 a70, v70
    v_accvgpr_write_b32 a71, v71
    v_xor_b32 v68, v64, v43
    v_xor_b32 v69, v65, v43
    v_xor_b32 v70, v66, v43
    v_xor_b32 v71, v67, v43
    v_accvgpr_write_b32 a132, v68
    v_accvgpr_write_b32 a133, v69
    v_accvgpr_write_b32 a134, v70
    v_accvgpr_write_b32 a135, v71
    v_xor_b32_dpp v68, v64, v45 quad_perm:[0,1,3,2] row_mask:0xf bank_mask:0xf
    v_xor_b32_dpp v69, v65, v45 quad_perm:[0,1,3,2] row_mask:0xf bank_mask:0xf
    v_xor_b32_dpp v70, v66, v45 quad_perm:[0,1,3,2] row_mask:0xf bank_mask:0xf
    v_xor_b32_dpp v71, v67, v45 quad_perm:[0,1,3,2] row_mask:0xf bank_mask:0xf
    v_accvgpr_write_b32 a196, v68
    v_accvgpr_write_b32 a197, v69
    v_accvgpr_write_b32 a198, v70
    v_accvgpr_write_b32 a199, v71
    v_fract_f32 v48, v30
    v_add_f32 v49, v48, v32
    v_cos_f32 v56, v48
    v_add_f32 v50, v49, v34
    v_cos_f32 v57, v49
    v_add_f32 v51, v50, v32
    v_cos_f32 v58, v50
    v_add_f32 v52, v51, v34
    v_cos_f32 v59, v51
    v_add_f32 v53, v52, v32
    v_cos_f32 v60, v52
    v_add_f32 v54, v53, v34
    v_cos_f32 v61, v53
    v_add_f32 v55, v54, v32
    v_cos_f32 v62, v54
    v_cos_f32 v63, v55
    v_add_f32 v30, v48, v36
    v_cvt_pk_bf16_f32 v64, v56, v57
    v_cvt_pk_bf16_f32 v65, v58, v59
    v_cvt_pk_bf16_f32 v66, v60, v61
    v_cvt_pk_bf16_f32 v67, v62, v63
    v_accvgpr_write_b32 a8, v64
    v_accvgpr_write_b32 a9, v65
    v_accvgpr_write_b32 a10, v66
    v_accvgpr_write_b32 a11, v67
    v_xor_b32_dpp v68, v64, v40 quad_perm:[0,1,3,2] row_mask:0xf bank_mask:0xf
    v_xor_b32_dpp v69, v65, v40 quad_perm:[0,1,3,2] row_mask:0xf bank_mask:0xf
    v_xor_b32_dpp v70, v66, v40 quad_perm:[0,1,3,2] row_mask:0xf bank_mask:0xf
    v_xor_b32_dpp v71, v67, v40 quad_perm:[0,1,3,2] row_mask:0xf bank_mask:0xf
    v_accvgpr_write_b32 a72, v68
    v_accvgpr_write_b32 a73, v69
    v_accvgpr_write_b32 a74, v70
    v_accvgpr_write_b32 a75, v71
    v_xor_b32 v68, v64, v42
    v_xor_b32 v69, v65, v42
    v_xor_b32 v70, v66, v42
    v_xor_b32 v71, v67, v42
    v_accvgpr_write_b32 a136, v68
    v_accvgpr_write_b32 a137, v69
    v_accvgpr_write_b32 a138, v70
    v_accvgpr_write_b32 a139, v71
    v_xor_b32_dpp v68, v64, v44 quad_perm:[0,1,3,2] row_mask:0xf bank_mask:0xf
    v_xor_b32_dpp v69, v65, v44 quad_perm:[0,1,3,2] row_mask:0xf bank_mask:0xf
    v_xor_b32_dpp v70, v66, v44 quad_perm:[0,1,3,2] row_mask:0xf bank_mask:0xf
    v_xor_b32_dpp v71, v67, v44 quad_perm:[0,1,3,2] row_mask:0xf bank_mask:0xf
    v_accvgpr_write_b32 a200, v68
    v_accvgpr_write_b32 a201, v69
    v_accvgpr_write_b32 a202, v70
    v_accvgpr_write_b32 a203, v71
    v_fract_f32 v48, v31
    v_add_f32 v49, v48, v33
    v_cos_f32 v56, v48
    v_add_f32 v50, v49, v35
    v_cos_f32 v57, v49
    v_add_f32 v51, v50, v33
    v_cos_f32 v58, v50
    v_add_f32 v52, v51, v35
    v_cos_f32 v59, v51
    v_add_f32 v53, v52, v33
    v_cos_f32 v60, v52
    v_add_f32 v54, v53, v35
    v_cos_f32 v61, v53
    v_add_f32 v55, v54, v33
    v_cos_f32 v62, v54
    v_cos_f32 v63, v55
    v_add_f32 v31, v48, v37
    v_cvt_pk_bf16_f32 v64, v56, v57
    v_cvt_pk_bf16_f32 v65, v58, v59
    v_cvt_pk_bf16_f32 v66, v60, v61
    v_cvt_pk_bf16_f32 v67, v62, v63
    v_accvgpr_write_b32 a12, v64
    v_accvgpr_write_b32 a13, v65
    v_accvgpr_write_b32 a14, v66
    v_accvgpr_write_b32 a15, v67
    v_xor_b32_dpp v68, v64, v41 quad_perm:[0,1,3,2] row_mask:0xf bank_mask:0xf
    v_xor_b32_dpp v69, v65, v41 quad_perm:[0,1,3,2] row_mask:0xf bank_mask:0xf
    v_xor_b32_dpp v70, v66, v41 quad_perm:[0,1,3,2] row_mask:0xf bank_mask:0xf
    v_xor_b32_dpp v71, v67, v41 quad_perm:[0,1,3,2] row_mask:0xf bank_mask:0xf
    v_accvgpr_write_b32 a76, v68
    v_accvgpr_write_b32 a77, v69
    v_accvgpr_write_b32 a78, v70
    v_accvgpr_write_b32 a79, v71
    v_xor_b32 v68, v64, v43
    v_xor_b32 v69, v65, v43
    v_xor_b32 v70, v66, v43
    v_xor_b32 v71, v67, v43
    v_accvgpr_write_b32 a140, v68
    v_accvgpr_write_b32 a141, v69
    v_accvgpr_write_b32 a142, v70
    v_accvgpr_write_b32 a143, v71
    v_xor_b32_dpp v68, v64, v45 quad_perm:[0,1,3,2] row_mask:0xf bank_mask:0xf
    v_xor_b32_dpp v69, v65, v45 quad_perm:[0,1,3,2] row_mask:0xf bank_mask:0xf
    v_xor_b32_dpp v70, v66, v45 quad_perm:[0,1,3,2] row_mask:0xf bank_mask:0xf
    v_xor_b32_dpp v71, v67, v45 quad_perm:[0,1,3,2] row_mask:0xf bank_mask:0xf
    v_accvgpr_write_b32 a204, v68
    v_accvgpr_write_b32 a205, v69
    v_accvgpr_write_b32 a206, v70
    v_accvgpr_write_b32 a207, v71
    v_fract_f32 v48, v30
    v_add_f32 v49, v48, v32
    v_cos_f32 v56, v48
    v_add_f32 v50, v49, v34
    v_cos_f32 v57, v49
    v_add_f32 v51, v50, v32
    v_cos_f32 v58, v50
    v_add_f32 v52, v51, v34
    v_cos_f32 v59, v51
    v_add_f32 v53, v52, v32
    v_cos_f32 v60, v52
    v_add_f32 v54, v53, v34
    v_cos_f32 v61, v53
    v_add_f32 v55, v54, v32
    v_cos_f32 v62, v54
    v_cos_f32 v63, v55
    v_add_f32 v30, v48, v36
    v_cvt_pk_bf16_f32 v64, v56, v57
    v_cvt_pk_bf16_f32 v65, v58, v59
    v_cvt_pk_bf16_f32 v66, v60, v61
    v_cvt_pk_bf16_f32 v67, v62, v63
    v_accvgpr_write_b32 a16, v64
    v_accvgpr_write_b32 a17, v65
    v_accvgpr_write_b32 a18, v66
    v_accvgpr_write_b32 a19, v67
    v_xor_b32_dpp v68, v64, v40 quad_perm:[0,1,3,2] row_mask:0xf bank_mask:0xf
    v_xor_b32_dpp v69, v65, v40 quad_perm:[0,1,3,2] row_mask:0xf bank_mask:0xf
    v_xor_b32_dpp v70, v66, v40 quad_perm:[0,1,3,2] row_mask:0xf bank_mask:0xf
    v_xor_b32_dpp v71, v67, v40 quad_perm:[0,1,3,2] row_mask:0xf bank_mask:0xf
    v_accvgpr_write_b32 a80, v68
    v_accvgpr_write_b32 a81, v69
    v_accvgpr_write_b32 a82, v70
    v_accvgpr_write_b32 a83, v71
    v_xor_b32 v68, v64, v42
    v_xor_b32 v69, v65, v42
    v_xor_b32 v70, v66, v42
    v_xor_b32 v71, v67, v42
    v_accvgpr_write_b32 a144, v68
    v_accvgpr_write_b32 a145, v69
    v_accvgpr_write_b32 a146, v70
    v_accvgpr_write_b32 a147, v71
    v_xor_b32_dpp v68, v64, v44 quad_perm:[0,1,3,2] row_mask:0xf bank_mask:0xf
    v_xor_b32_dpp v69, v65, v44 quad_perm:[0,1,3,2] row_mask:0xf bank_mask:0xf
    v_xor_b32_dpp v70, v66, v44 quad_perm:[0,1,3,2] row_mask:0xf bank_mask:0xf
    v_xor_b32_dpp v71, v67, v44 quad_perm:[0,1,3,2] row_mask:0xf bank_mask:0xf
    v_accvgpr_write_b32 a208, v68
    v_accvgpr_write_b32 a209, v69
    v_accvgpr_write_b32 a210, v70
    v_accvgpr_write_b32 a211, v71
    v_fract_f32 v48, v31
    v_add_f32 v49, v48, v33
    v_cos_f32 v56, v48
    v_add_f32 v50, v49, v35
    v_cos_f32 v57, v49
    v_add_f32 v51, v50, v33
    v_cos_f32 v58, v50
    v_add_f32 v52, v51, v35
    v_cos_f32 v59, v51
    v_add_f32 v53, v52, v33
    v_cos_f32 v60, v52
    v_add_f32 v54, v53, v35
    v_cos_f32 v61, v53
    v_add_f32 v55, v54, v33
    v_cos_f32 v62, v54
    v_cos_f32 v63, v55
    v_add_f32 v31, v48, v37
    v_cvt_pk_bf16_f32 v64, v56, v57
    v_cvt_pk_bf16_f32 v65, v58, v59
    v_cvt_pk_bf16_f32 v66, v60, v61
    v_cvt_pk_bf16_f32 v67, v62, v63
    v_accvgpr_write_b32 a20, v64
    v_accvgpr_write_b32 a21, v65
    v_accvgpr_write_b32 a22, v66
    v_accvgpr_write_b32 a23, v67
    v_xor_b32_dpp v68, v64, v41 quad_perm:[0,1,3,2] row_mask:0xf bank_mask:0xf
    v_xor_b32_dpp v69, v65, v41 quad_perm:[0,1,3,2] row_mask:0xf bank_mask:0xf
    v_xor_b32_dpp v70, v66, v41 quad_perm:[0,1,3,2] row_mask:0xf bank_mask:0xf
    v_xor_b32_dpp v71, v67, v41 quad_perm:[0,1,3,2] row_mask:0xf bank_mask:0xf
    v_accvgpr_write_b32 a84, v68
    v_accvgpr_write_b32 a85, v69
    v_accvgpr_write_b32 a86, v70
    v_accvgpr_write_b32 a87, v71
    v_xor_b32 v68, v64, v43
    v_xor_b32 v69, v65, v43
    v_xor_b32 v70, v66, v43
    v_xor_b32 v71, v67, v43
    v_accvgpr_write_b32 a148, v68
    v_accvgpr_write_b32 a149, v69
    v_accvgpr_write_b32 a150, v70
    v_accvgpr_write_b32 a151, v71
    v_xor_b32_dpp v68, v64, v45 quad_perm:[0,1,3,2] row_mask:0xf bank_mask:0xf
    v_xor_b32_dpp v69, v65, v45 quad_perm:[0,1,3,2] row_mask:0xf bank_mask:0xf
    v_xor_b32_dpp v70, v66, v45 quad_perm:[0,1,3,2] row_mask:0xf bank_mask:0xf
    v_xor_b32_dpp v71, v67, v45 quad_perm:[0,1,3,2] row_mask:0xf bank_mask:0xf
    v_accvgpr_write_b32 a212, v68
    v_accvgpr_write_b32 a213, v69
    v_accvgpr_write_b32 a214, v70
    v_accvgpr_write_b32 a215, v71
    v_fract_f32 v48, v30
    v_add_f32 v49, v48, v32
    v_cos_f32 v56, v48
    v_add_f32 v50, v49, v34
    v_cos_f32 v57, v49
    v_add_f32 v51, v50, v32
    v_cos_f32 v58, v50
    v_add_f32 v52, v51, v34
    v_cos_f32 v59, v51
    v_add_f32 v53, v52, v32
    v_cos_f32 v60, v52
    v_add_f32 v54, v53, v34
    v_cos_f32 v61, v53
    v_add_f32 v55, v54, v32
    v_cos_f32 v62, v54
    v_cos_f32 v63, v55
    v_add_f32 v30, v48, v36
    v_cvt_pk_bf16_f32 v64, v56, v57
    v_cvt_pk_bf16_f32 v65, v58, v59
    v_cvt_pk_bf16_f32 v66, v60, v61
    v_cvt_pk_bf16_f32 v67, v62, v63
    v_accvgpr_write_b32 a24, v64
    v_accvgpr_write_b32 a25, v65
    v_accvgpr_write_b32 a26, v66
    v_accvgpr_write_b32 a27, v67
    v_xor_b32_dpp v68, v64, v40 quad_perm:[0,1,3,2] row_mask:0xf bank_mask:0xf
    v_xor_b32_dpp v69, v65, v40 quad_perm:[0,1,3,2] row_mask:0xf bank_mask:0xf
    v_xor_b32_dpp v70, v66, v40 quad_perm:[0,1,3,2] row_mask:0xf bank_mask:0xf
    v_xor_b32_dpp v71, v67, v40 quad_perm:[0,1,3,2] row_mask:0xf bank_mask:0xf
    v_accvgpr_write_b32 a88, v68
    v_accvgpr_write_b32 a89, v69
    v_accvgpr_write_b32 a90, v70
    v_accvgpr_write_b32 a91, v71
    v_xor_b32 v68, v64, v42
    v_xor_b32 v69, v65, v42
    v_xor_b32 v70, v66, v42
    v_xor_b32 v71, v67, v42
    v_accvgpr_write_b32 a152, v68
    v_accvgpr_write_b32 a153, v69
    v_accvgpr_write_b32 a154, v70
    v_accvgpr_write_b32 a155, v71
    v_xor_b32_dpp v68, v64, v44 quad_perm:[0,1,3,2] row_mask:0xf bank_mask:0xf
    v_xor_b32_dpp v69, v65, v44 quad_perm:[0,1,3,2] row_mask:0xf bank_mask:0xf
    v_xor_b32_dpp v70, v66, v44 quad_perm:[0,1,3,2] row_mask:0xf bank_mask:0xf
    v_xor_b32_dpp v71, v67, v44 quad_perm:[0,1,3,2] row_mask:0xf bank_mask:0xf
    v_accvgpr_write_b32 a216, v68
    v_accvgpr_write_b32 a217, v69
    v_accvgpr_write_b32 a218, v70
    v_accvgpr_write_b32 a219, v71
    v_fract_f32 v48, v31
    v_add_f32 v49, v48, v33
    v_cos_f32 v56, v48
    v_add_f32 v50, v49, v35
    v_cos_f32 v57, v49
    v_add_f32 v51, v50, v33
    v_cos_f32 v58, v50
    v_add_f32 v52, v51, v35
    v_cos_f32 v59, v51
    v_add_f32 v53, v52, v33
    v_cos_f32 v60, v52
    v_add_f32 v54, v53, v35
    v_cos_f32 v61, v53
    v_add_f32 v55, v54, v33
    v_cos_f32 v62, v54
    v_cos_f32 v63, v55
    v_add_f32 v31, v48, v37
    v_cvt_pk_bf16_f32 v64, v56, v57
    v_cvt_pk_bf16_f32 v65, v58, v59
    v_cvt_pk_bf16_f32 v66, v60, v61
    v_cvt_pk_bf16_f32 v67, v62, v63
    v_accvgpr_write_b32 a28, v64
    v_accvgpr_write_b32 a29, v65
    v_accvgpr_write_b32 a30, v66
    v_accvgpr_write_b32 a31, v67
    v_xor_b32_dpp v68, v64, v41 quad_perm:[0,1,3,2] row_mask:0xf bank_mask:0xf
    v_xor_b32_dpp v69, v65, v41 quad_perm:[0,1,3,2] row_mask:0xf bank_mask:0xf
    v_xor_b32_dpp v70, v66, v41 quad_perm:[0,1,3,2] row_mask:0xf bank_mask:0xf
    v_xor_b32_dpp v71, v67, v41 quad_perm:[0,1,3,2] row_mask:0xf bank_mask:0xf
    v_accvgpr_write_b32 a92, v68
    v_accvgpr_write_b32 a93, v69
    v_accvgpr_write_b32 a94, v70
    v_accvgpr_write_b32 a95, v71
    v_xor_b32 v68, v64, v43
    v_xor_b32 v69, v65, v43
    v_xor_b32 v70, v66, v43
    v_xor_b32 v71, v67, v43
    v_accvgpr_write_b32 a156, v68
    v_accvgpr_write_b32 a157, v69
    v_accvgpr_write_b32 a158, v70
    v_accvgpr_write_b32 a159, v71
    v_xor_b32_dpp v68, v64, v45 quad_perm:[0,1,3,2] row_mask:0xf bank_mask:0xf
    v_xor_b32_dpp v69, v65, v45 quad_perm:[0,1,3,2] row_mask:0xf bank_mask:0xf
    v_xor_b32_dpp v70, v66, v45 quad_perm:[0,1,3,2] row_mask:0xf bank_mask:0xf
    v_xor_b32_dpp v71, v67, v45 quad_perm:[0,1,3,2] row_mask:0xf bank_mask:0xf
    v_accvgpr_write_b32 a220, v68
    v_accvgpr_write_b32 a221, v69
    v_accvgpr_write_b32 a222, v70
    v_accvgpr_write_b32 a223, v71
    v_fract_f32 v48, v30
    v_add_f32 v49, v48, v32
    v_cos_f32 v56, v48
    v_add_f32 v50, v49, v34
    v_cos_f32 v57, v49
    v_add_f32 v51, v50, v32
    v_cos_f32 v58, v50
    v_add_f32 v52, v51, v34
    v_cos_f32 v59, v51
    v_add_f32 v53, v52, v32
    v_cos_f32 v60, v52
    v_add_f32 v54, v53, v34
    v_cos_f32 v61, v53
    v_add_f32 v55, v54, v32
    v_cos_f32 v62, v54
    v_cos_f32 v63, v55
    v_add_f32 v30, v48, v36
    v_cvt_pk_bf16_f32 v64, v56, v57
    v_cvt_pk_bf16_f32 v65, v58, v59
    v_cvt_pk_bf16_f32 v66, v60, v61
    v_cvt_pk_bf16_f32 v67, v62, v63
    v_accvgpr_write_b32 a32, v64
    v_accvgpr_write_b32 a33, v65
    v_accvgpr_write_b32 a34, v66
    v_accvgpr_write_b32 a35, v67
    v_xor_b32_dpp v68, v64, v40 quad_perm:[0,1,3,2] row_mask:0xf bank_mask:0xf
    v_xor_b32_dpp v69, v65, v40 quad_perm:[0,1,3,2] row_mask:0xf bank_mask:0xf
    v_xor_b32_dpp v70, v66, v40 quad_perm:[0,1,3,2] row_mask:0xf bank_mask:0xf
    v_xor_b32_dpp v71, v67, v40 quad_perm:[0,1,3,2] row_mask:0xf bank_mask:0xf
    v_accvgpr_write_b32 a96, v68
    v_accvgpr_write_b32 a97, v69
    v_accvgpr_write_b32 a98, v70
    v_accvgpr_write_b32 a99, v71
    v_xor_b32 v68, v64, v42
    v_xor_b32 v69, v65, v42
    v_xor_b32 v70, v66, v42
    v_xor_b32 v71, v67, v42
    v_accvgpr_write_b32 a160, v68
    v_accvgpr_write_b32 a161, v69
    v_accvgpr_write_b32 a162, v70
    v_accvgpr_write_b32 a163, v71
    v_xor_b32_dpp v68, v64, v44 quad_perm:[0,1,3,2] row_mask:0xf bank_mask:0xf
    v_xor_b32_dpp v69, v65, v44 quad_perm:[0,1,3,2] row_mask:0xf bank_mask:0xf
    v_xor_b32_dpp v70, v66, v44 quad_perm:[0,1,3,2] row_mask:0xf bank_mask:0xf
    v_xor_b32_dpp v71, v67, v44 quad_perm:[0,1,3,2] row_mask:0xf bank_mask:0xf
    v_accvgpr_write_b32 a224, v68
    v_accvgpr_write_b32 a225, v69
    v_accvgpr_write_b32 a226, v70
    v_accvgpr_write_b32 a227, v71
    v_fract_f32 v48, v31
    v_add_f32 v49, v48, v33
    v_cos_f32 v56, v48
    v_add_f32 v50, v49, v35
    v_cos_f32 v57, v49
    v_add_f32 v51, v50, v33
    v_cos_f32 v58, v50
    v_add_f32 v52, v51, v35
    v_cos_f32 v59, v51
    v_add_f32 v53, v52, v33
    v_cos_f32 v60, v52
    v_add_f32 v54, v53, v35
    v_cos_f32 v61, v53
    v_add_f32 v55, v54, v33
    v_cos_f32 v62, v54
    v_cos_f32 v63, v55
    v_add_f32 v31, v48, v37
    v_cvt_pk_bf16_f32 v64, v56, v57
    v_cvt_pk_bf16_f32 v65, v58, v59
    v_cvt_pk_bf16_f32 v66, v60, v61
    v_cvt_pk_bf16_f32 v67, v62, v63
    v_accvgpr_write_b32 a36, v64
    v_accvgpr_write_b32 a37, v65
    v_accvgpr_write_b32 a38, v66
    v_accvgpr_write_b32 a39, v67
    v_xor_b32_dpp v68, v64, v41 quad_perm:[0,1,3,2] row_mask:0xf bank_mask:0xf
    v_xor_b32_dpp v69, v65, v41 quad_perm:[0,1,3,2] row_mask:0xf bank_mask:0xf
    v_xor_b32_dpp v70, v66, v41 quad_perm:[0,1,3,2] row_mask:0xf bank_mask:0xf
    v_xor_b32_dpp v71, v67, v41 quad_perm:[0,1,3,2] row_mask:0xf bank_mask:0xf
    v_accvgpr_write_b32 a100, v68
    v_accvgpr_write_b32 a101, v69
    v_accvgpr_write_b32 a102, v70
    v_accvgpr_write_b32 a103, v71
    v_xor_b32 v68, v64, v43
    v_xor_b32 v69, v65, v43
    v_xor_b32 v70, v66, v43
    v_xor_b32 v71, v67, v43
    v_accvgpr_write_b32 a164, v68
    v_accvgpr_write_b32 a165, v69
    v_accvgpr_write_b32 a166, v70
    v_accvgpr_write_b32 a167, v71
    v_xor_b32_dpp v68, v64, v45 quad_perm:[0,1,3,2] row_mask:0xf bank_mask:0xf
    v_xor_b32_dpp v69, v65, v45 quad_perm:[0,1,3,2] row_mask:0xf bank_mask:0xf
    v_xor_b32_dpp v70, v66, v45 quad_perm:[0,1,3,2] row_mask:0xf bank_mask:0xf
    v_xor_b32_dpp v71, v67, v45 quad_perm:[0,1,3,2] row_mask:0xf bank_mask:0xf
    v_accvgpr_write_b32 a228, v68
    v_accvgpr_write_b32 a229, v69
    v_accvgpr_write_b32 a230, v70
    v_accvgpr_write_b32 a231, v71
    v_fract_f32 v48, v30
    v_add_f32 v49, v48, v32
    v_cos_f32 v56, v48
    v_add_f32 v50, v49, v34
    v_cos_f32 v57, v49
    v_add_f32 v51, v50, v32
    v_cos_f32 v58, v50
    v_add_f32 v52, v51, v34
    v_cos_f32 v59, v51
    v_add_f32 v53, v52, v32
    v_cos_f32 v60, v52
    v_add_f32 v54, v53, v34
    v_cos_f32 v61, v53
    v_add_f32 v55, v54, v32
    v_cos_f32 v62, v54
    v_cos_f32 v63, v55
    v_add_f32 v30, v48, v36
    v_cvt_pk_bf16_f32 v64, v56, v57
    v_cvt_pk_bf16_f32 v65, v58, v59
    v_cvt_pk_bf16_f32 v66, v60, v61
    v_cvt_pk_bf16_f32 v67, v62, v63
    v_accvgpr_write_b32 a40, v64
    v_accvgpr_write_b32 a41, v65
    v_accvgpr_write_b32 a42, v66
    v_accvgpr_write_b32 a43, v67
    v_xor_b32_dpp v68, v64, v40 quad_perm:[0,1,3,2] row_mask:0xf bank_mask:0xf
    v_xor_b32_dpp v69, v65, v40 quad_perm:[0,1,3,2] row_mask:0xf bank_mask:0xf
    v_xor_b32_dpp v70, v66, v40 quad_perm:[0,1,3,2] row_mask:0xf bank_mask:0xf
    v_xor_b32_dpp v71, v67, v40 quad_perm:[0,1,3,2] row_mask:0xf bank_mask:0xf
    v_accvgpr_write_b32 a104, v68
    v_accvgpr_write_b32 a105, v69
    v_accvgpr_write_b32 a106, v70
    v_accvgpr_write_b32 a107, v71
    v_xor_b32 v68, v64, v42
    v_xor_b32 v69, v65, v42
    v_xor_b32 v70, v66, v42
    v_xor_b32 v71, v67, v42
    v_accvgpr_write_b32 a168, v68
    v_accvgpr_write_b32 a169, v69
    v_accvgpr_write_b32 a170, v70
    v_accvgpr_write_b32 a171, v71
    v_xor_b32_dpp v68, v64, v44 quad_perm:[0,1,3,2] row_mask:0xf bank_mask:0xf
    v_xor_b32_dpp v69, v65, v44 quad_perm:[0,1,3,2] row_mask:0xf bank_mask:0xf
    v_xor_b32_dpp v70, v66, v44 quad_perm:[0,1,3,2] row_mask:0xf bank_mask:0xf
    v_xor_b32_dpp v71, v67, v44 quad_perm:[0,1,3,2] row_mask:0xf bank_mask:0xf
    v_accvgpr_write_b32 a232, v68
    v_accvgpr_write_b32 a233, v69
    v_accvgpr_write_b32 a234, v70
    v_accvgpr_write_b32 a235, v71
    v_fract_f32 v48, v31
    v_add_f32 v49, v48, v33
    v_cos_f32 v56, v48
    v_add_f32 v50, v49, v35
    v_cos_f32 v57, v49
    v_add_f32 v51, v50, v33
    v_cos_f32 v58, v50
    v_add_f32 v52, v51, v35
    v_cos_f32 v59, v51
    v_add_f32 v53, v52, v33
    v_cos_f32 v60, v52
    v_add_f32 v54, v53, v35
    v_cos_f32 v61, v53
    v_add_f32 v55, v54, v33
    v_cos_f32 v62, v54
    v_cos_f32 v63, v55
    v_add_f32 v31, v48, v37
    v_cvt_pk_bf16_f32 v64, v56, v57
    v_cvt_pk_bf16_f32 v65, v58, v59
    v_cvt_pk_bf16_f32 v66, v60, v61
    v_cvt_pk_bf16_f32 v67, v62, v63
    v_accvgpr_write_b32 a44, v64
    v_accvgpr_write_b32 a45, v65
    v_accvgpr_write_b32 a46, v66
    v_accvgpr_write_b32 a47, v67
    v_xor_b32_dpp v68, v64, v41 quad_perm:[0,1,3,2] row_mask:0xf bank_mask:0xf
    v_xor_b32_dpp v69, v65, v41 quad_perm:[0,1,3,2] row_mask:0xf bank_mask:0xf
    v_xor_b32_dpp v70, v66, v41 quad_perm:[0,1,3,2] row_mask:0xf bank_mask:0xf
    v_xor_b32_dpp v71, v67, v41 quad_perm:[0,1,3,2] row_mask:0xf bank_mask:0xf
    v_accvgpr_write_b32 a108, v68
    v_accvgpr_write_b32 a109, v69
    v_accvgpr_write_b32 a110, v70
    v_accvgpr_write_b32 a111, v71
    v_xor_b32 v68, v64, v43
    v_xor_b32 v69, v65, v43
    v_xor_b32 v70, v66, v43
    v_xor_b32 v71, v67, v43
    v_accvgpr_write_b32 a172, v68
    v_accvgpr_write_b32 a173, v69
    v_accvgpr_write_b32 a174, v70
    v_accvgpr_write_b32 a175, v71
    v_xor_b32_dpp v68, v64, v45 quad_perm:[0,1,3,2] row_mask:0xf bank_mask:0xf
    v_xor_b32_dpp v69, v65, v45 quad_perm:[0,1,3,2] row_mask:0xf bank_mask:0xf
    v_xor_b32_dpp v70, v66, v45 quad_perm:[0,1,3,2] row_mask:0xf bank_mask:0xf
    v_xor_b32_dpp v71, v67, v45 quad_perm:[0,1,3,2] row_mask:0xf bank_mask:0xf
    v_accvgpr_write_b32 a236, v68
    v_accvgpr_write_b32 a237, v69
    v_accvgpr_write_b32 a238, v70
    v_accvgpr_write_b32 a239, v71
    v_fract_f32 v48, v30
    v_add_f32 v49, v48, v32
    v_cos_f32 v56, v48
    v_add_f32 v50, v49, v34
    v_cos_f32 v57, v49
    v_add_f32 v51, v50, v32
    v_cos_f32 v58, v50
    v_add_f32 v52, v51, v34
    v_cos_f32 v59, v51
    v_add_f32 v53, v52, v32
    v_cos_f32 v60, v52
    v_add_f32 v54, v53, v34
    v_cos_f32 v61, v53
    v_add_f32 v55, v54, v32
    v_cos_f32 v62, v54
    v_cos_f32 v63, v55
    v_add_f32 v30, v48, v36
    v_cvt_pk_bf16_f32 v64, v56, v57
    v_cvt_pk_bf16_f32 v65, v58, v59
    v_cvt_pk_bf16_f32 v66, v60, v61
    v_cvt_pk_bf16_f32 v67, v62, v63
    v_accvgpr_write_b32 a48, v64
    v_accvgpr_write_b32 a49, v65
    v_accvgpr_write_b32 a50, v66
    v_accvgpr_write_b32 a51, v67
    v_xor_b32_dpp v68, v64, v40 quad_perm:[0,1,3,2] row_mask:0xf bank_mask:0xf
    v_xor_b32_dpp v69, v65, v40 quad_perm:[0,1,3,2] row_mask:0xf bank_mask:0xf
    v_xor_b32_dpp v70, v66, v40 quad_perm:[0,1,3,2] row_mask:0xf bank_mask:0xf
    v_xor_b32_dpp v71, v67, v40 quad_perm:[0,1,3,2] row_mask:0xf bank_mask:0xf
    v_accvgpr_write_b32 a112, v68
    v_accvgpr_write_b32 a113, v69
    v_accvgpr_write_b32 a114, v70
    v_accvgpr_write_b32 a115, v71
    v_xor_b32 v68, v64, v42
    v_xor_b32 v69, v65, v42
    v_xor_b32 v70, v66, v42
    v_xor_b32 v71, v67, v42
    v_accvgpr_write_b32 a176, v68
    v_accvgpr_write_b32 a177, v69
    v_accvgpr_write_b32 a178, v70
    v_accvgpr_write_b32 a179, v71
    v_xor_b32_dpp v68, v64, v44 quad_perm:[0,1,3,2] row_mask:0xf bank_mask:0xf
    v_xor_b32_dpp v69, v65, v44 quad_perm:[0,1,3,2] row_mask:0xf bank_mask:0xf
    v_xor_b32_dpp v70, v66, v44 quad_perm:[0,1,3,2] row_mask:0xf bank_mask:0xf
    v_xor_b32_dpp v71, v67, v44 quad_perm:[0,1,3,2] row_mask:0xf bank_mask:0xf
    v_accvgpr_write_b32 a240, v68
    v_accvgpr_write_b32 a241, v69
    v_accvgpr_write_b32 a242, v70
    v_accvgpr_write_b32 a243, v71
    v_fract_f32 v48, v31
    v_add_f32 v49, v48, v33
    v_cos_f32 v56, v48
    v_add_f32 v50, v49, v35
    v_cos_f32 v57, v49
    v_add_f32 v51, v50, v33
    v_cos_f32 v58, v50
    v_add_f32 v52, v51, v35
    v_cos_f32 v59, v51
    v_add_f32 v53, v52, v33
    v_cos_f32 v60, v52
    v_add_f32 v54, v53, v35
    v_cos_f32 v61, v53
    v_add_f32 v55, v54, v33
    v_cos_f32 v62, v54
    v_cos_f32 v63, v55
    v_add_f32 v31, v48, v37
    v_cvt_pk_bf16_f32 v64, v56, v57
    v_cvt_pk_bf16_f32 v65, v58, v59
    v_cvt_pk_bf16_f32 v66, v60, v61
    v_cvt_pk_bf16_f32 v67, v62, v63
    v_accvgpr_write_b32 a52, v64
    v_accvgpr_write_b32 a53, v65
    v_accvgpr_write_b32 a54, v66
    v_accvgpr_write_b32 a55, v67
    v_xor_b32_dpp v68, v64, v41 quad_perm:[0,1,3,2] row_mask:0xf bank_mask:0xf
    v_xor_b32_dpp v69, v65, v41 quad_perm:[0,1,3,2] row_mask:0xf bank_mask:0xf
    v_xor_b32_dpp v70, v66, v41 quad_perm:[0,1,3,2] row_mask:0xf bank_mask:0xf
    v_xor_b32_dpp v71, v67, v41 quad_perm:[0,1,3,2] row_mask:0xf bank_mask:0xf
    v_accvgpr_write_b32 a116, v68
    v_accvgpr_write_b32 a117, v69
    v_accvgpr_write_b32 a118, v70
    v_accvgpr_write_b32 a119, v71
    v_xor_b32 v68, v64, v43
    v_xor_b32 v69, v65, v43
    v_xor_b32 v70, v66, v43
    v_xor_b32 v71, v67, v43
    v_accvgpr_write_b32 a180, v68
    v_accvgpr_write_b32 a181, v69
    v_accvgpr_write_b32 a182, v70
    v_accvgpr_write_b32 a183, v71
    v_xor_b32_dpp v68, v64, v45 quad_perm:[0,1,3,2] row_mask:0xf bank_mask:0xf
    v_xor_b32_dpp v69, v65, v45 quad_perm:[0,1,3,2] row_mask:0xf bank_mask:0xf
    v_xor_b32_dpp v70, v66, v45 quad_perm:[0,1,3,2] row_mask:0xf bank_mask:0xf
    v_xor_b32_dpp v71, v67, v45 quad_perm:[0,1,3,2] row_mask:0xf bank_mask:0xf
    v_accvgpr_write_b32 a244, v68
    v_accvgpr_write_b32 a245, v69
    v_accvgpr_write_b32 a246, v70
    v_accvgpr_write_b32 a247, v71
    v_fract_f32 v48, v30
    v_add_f32 v49, v48, v32
    v_cos_f32 v56, v48
    v_add_f32 v50, v49, v34
    v_cos_f32 v57, v49
    v_add_f32 v51, v50, v32
    v_cos_f32 v58, v50
    v_add_f32 v52, v51, v34
    v_cos_f32 v59, v51
    v_add_f32 v53, v52, v32
    v_cos_f32 v60, v52
    v_add_f32 v54, v53, v34
    v_cos_f32 v61, v53
    v_add_f32 v55, v54, v32
    v_cos_f32 v62, v54
    v_cos_f32 v63, v55
    v_add_f32 v30, v48, v36
    v_cvt_pk_bf16_f32 v64, v56, v57
    v_cvt_pk_bf16_f32 v65, v58, v59
    v_cvt_pk_bf16_f32 v66, v60, v61
    v_cvt_pk_bf16_f32 v67, v62, v63
    v_accvgpr_write_b32 a56, v64
    v_accvgpr_write_b32 a57, v65
    v_accvgpr_write_b32 a58, v66
    v_accvgpr_write_b32 a59, v67
    v_xor_b32_dpp v68, v64, v40 quad_perm:[0,1,3,2] row_mask:0xf bank_mask:0xf
    v_xor_b32_dpp v69, v65, v40 quad_perm:[0,1,3,2] row_mask:0xf bank_mask:0xf
    v_xor_b32_dpp v70, v66, v40 quad_perm:[0,1,3,2] row_mask:0xf bank_mask:0xf
    v_xor_b32_dpp v71, v67, v40 quad_perm:[0,1,3,2] row_mask:0xf bank_mask:0xf
    v_accvgpr_write_b32 a120, v68
    v_accvgpr_write_b32 a121, v69
    v_accvgpr_write_b32 a122, v70
    v_accvgpr_write_b32 a123, v71
    v_xor_b32 v68, v64, v42
    v_xor_b32 v69, v65, v42
    v_xor_b32 v70, v66, v42
    v_xor_b32 v71, v67, v42
    v_accvgpr_write_b32 a184, v68
    v_accvgpr_write_b32 a185, v69
    v_accvgpr_write_b32 a186, v70
    v_accvgpr_write_b32 a187, v71
    v_xor_b32_dpp v68, v64, v44 quad_perm:[0,1,3,2] row_mask:0xf bank_mask:0xf
    v_xor_b32_dpp v69, v65, v44 quad_perm:[0,1,3,2] row_mask:0xf bank_mask:0xf
    v_xor_b32_dpp v70, v66, v44 quad_perm:[0,1,3,2] row_mask:0xf bank_mask:0xf
    v_xor_b32_dpp v71, v67, v44 quad_perm:[0,1,3,2] row_mask:0xf bank_mask:0xf
    v_accvgpr_write_b32 a248, v68
    v_accvgpr_write_b32 a249, v69
    v_accvgpr_write_b32 a250, v70
    v_accvgpr_write_b32 a251, v71
    v_fract_f32 v48, v31
    v_add_f32 v49, v48, v33
    v_cos_f32 v56, v48
    v_add_f32 v50, v49, v35
    v_cos_f32 v57, v49
    v_add_f32 v51, v50, v33
    v_cos_f32 v58, v50
    v_add_f32 v52, v51, v35
    v_cos_f32 v59, v51
    v_add_f32 v53, v52, v33
    v_cos_f32 v60, v52
    v_add_f32 v54, v53, v35
    v_cos_f32 v61, v53
    v_add_f32 v55, v54, v33
    v_cos_f32 v62, v54
    v_cos_f32 v63, v55
    v_add_f32 v31, v48, v37
    v_cvt_pk_bf16_f32 v64, v56, v57
    v_cvt_pk_bf16_f32 v65, v58, v59
    v_cvt_pk_bf16_f32 v66, v60, v61
    v_cvt_pk_bf16_f32 v67, v62, v63
    v_accvgpr_write_b32 a60, v64
    v_accvgpr_write_b32 a61, v65
    v_accvgpr_write_b32 a62, v66
    v_accvgpr_write_b32 a63, v67
    v_xor_b32_dpp v68, v64, v41 quad_perm:[0,1,3,2] row_mask:0xf bank_mask:0xf
    v_xor_b32_dpp v69, v65, v41 quad_perm:[0,1,3,2] row_mask:0xf bank_mask:0xf
    v_xor_b32_dpp v70, v66, v41 quad_perm:[0,1,3,2] row_mask:0xf bank_mask:0xf
    v_xor_b32_dpp v71, v67, v41 quad_perm:[0,1,3,2] row_mask:0xf bank_mask:0xf
    v_accvgpr_write_b32 a124, v68
    v_accvgpr_write_b32 a125, v69
    v_accvgpr_write_b32 a126, v70
    v_accvgpr_write_b32 a127, v71
    v_xor_b32 v68, v64, v43
    v_xor_b32 v69, v65, v43
    v_xor_b32 v70, v66, v43
    v_xor_b32 v71, v67, v43
    v_accvgpr_write_b32 a188, v68
    v_accvgpr_write_b32 a189, v69
    v_accvgpr_write_b32 a190, v70
    v_accvgpr_write_b32 a191, v71
    v_xor_b32_dpp v68, v64, v45 quad_perm:[0,1,3,2] row_mask:0xf bank_mask:0xf
    v_xor_b32_dpp v69, v65, v45 quad_perm:[0,1,3,2] row_mask:0xf bank_mask:0xf
    v_xor_b32_dpp v70, v66, v45 quad_perm:[0,1,3,2] row_mask:0xf bank_mask:0xf
    v_xor_b32_dpp v71, v67, v45 quad_perm:[0,1,3,2] row_mask:0xf bank_mask:0xf
    v_accvgpr_write_b32 a252, v68
    v_accvgpr_write_b32 a253, v69
    v_accvgpr_write_b32 a254, v70
    v_accvgpr_write_b32 a255, v71
    s_and_b32 s17, s28, 1
    s_lshl_b32 s17, s17, 15
    s_lshr_b32 s18, s28, 1
    s_lshl_b32 s18, s18, 21
    s_add_u32 s17, s17, s18
    s_lshl_b32 s18, s29, 16
    s_add_u32 s17, s17, s18
    v_lshlrev_b32 v15, 7, v1
    s_waitcnt lgkmcnt(0)
    s_mov_b32 s35, s17
    s_lshl_b32 s34, s93, 2
    s_add_u32 s34, s34, s16
    s_lshl_b32 s34, s34, 13
    s_sub_u32 s34, s34, 262144
    v_mov_b32 v247, v15
    s_lshl_b32 s17, s29, 6
    v_add_u32 v246, s17, v1
    v_mul_u32_u24 v246, 1026, v246
    s_lshl_b32 s17, s28, 8
    v_add_u32 v246, s17, v246
    v_and_b32 v246, -4, v246
    s_load_dwordx2 s[8:9], s[0:1], 0
    s_mov_b32 s10, 4194304
    s_mov_b32 s11, 0x20000
    s_waitcnt lgkmcnt(0)
    v_and_b32 v5, 15, v1
    v_bfe_u32 v6, v1, 1, 3
    v_lshrrev_b32 v7, 4, v1
    v_xor_b32 v6, v6, v7
    v_lshlrev_b32 v6, 4, v6
    v_lshl_add_u32 v10, v5, 7, v6
    s_lshl_b32 s19, s16, 10
    v_xor_b32 v11, 64, v10
    v_add_u32 v12, 0x10000, v10
    v_add_u32 v13, 0x10000, v11
    v_lshrrev_b32 v7, 3, v1
    s_lshl_b32 s17, s16, 3
    v_add_u32 v7, s17, v7
    v_bfe_u32 v8, v7, 1, 3
    v_xor_b32 v8, v8, v1
    v_and_b32 v8, 7, v8
    v_bfe_u32 v5, v7, 2, 2
    v_and_b32 v2, 3, v7
    v_lshl_add_u32 v2, v5, 3, v2
    v_bfe_u32 v5, v7, 4, 1
    v_lshl_add_u32 v2, v5, 2, v2
    v_bfe_u32 v5, v1, 2, 2
    v_and_b32 v3, 3, v1
    v_lshl_add_u32 v3, v5, 3, v3
    v_lshlrev_b32 v2, 16, v2
    v_lshl_add_u32 v2, v8, 4, v2
    v_and_b32 v5, 48, v1
    v_lshl_add_u32 v3, v3, 6, v5
    s_mul_i32 s21, s29, 139776
    s_mul_i32 s17, s28, 34816
    s_add_u32 s21, s21, s17
    s_add_u32 s21, s21, 104857600
    s_and_b32 s20, s28, 1
    s_lshl_b32 s20, s20, 15
    s_lshr_b32 s17, s28, 1
    s_lshl_b32 s17, s17, 21
    s_add_u32 s20, s20, s17
    s_mov_b32 s24, 2048
    s_mov_b32 s25, 2176
    s_barrier
    s_mov_b32 s26, s25
    s_sub_u32 s25, s21, 1073741824
    s_mov_b32 s21, 1073741824
    s_mov_b32 s23, 0
    s_mov_b32 s22, 0
    s_add_u32 m0, s19, 0
    s_nop 0
    buffer_load_dwordx4 v2, s[8:11], s20 offen offset:0 lds
    s_add_u32 m0, s19, 3968
    s_nop 0
    buffer_load_dwordx4 v2, s[8:11], s20 offen offset:128 lds
    s_add_u32 m0, s19, 7936
    s_nop 0
    buffer_load_dwordx4 v2, s[8:11], s20 offen offset:256 lds
    s_add_u32 m0, s19, 11904
    s_nop 0
    buffer_load_dwordx4 v2, s[8:11], s20 offen offset:384 lds
    s_add_u32 m0, s19, 15872
    s_nop 0
    buffer_load_dwordx4 v2, s[8:11], s20 offen offset:512 lds
    s_add_u32 m0, s19, 19840
    s_nop 0
    buffer_load_dwordx4 v2, s[8:11], s20 offen offset:640 lds
    s_add_u32 m0, s19, 23808
    s_nop 0
    buffer_load_dwordx4 v2, s[8:11], s20 offen offset:768 lds
    s_add_u32 m0, s19, 27776
    s_nop 0
    buffer_load_dwordx4 v2, s[8:11], s20 offen offset:896 lds
    s_add_u32 m0, s19, 31744
    s_nop 0
    buffer_load_dwordx4 v2, s[8:11], s20 offen offset:1024 lds
    s_add_u32 m0, s19, 35712
    s_nop 0
    buffer_load_dwordx4 v2, s[8:11], s20 offen offset:1152 lds
    s_add_u32 m0, s19, 39680
    s_nop 0
    buffer_load_dwordx4 v2, s[8:11], s20 offen offset:1280 lds
    s_add_u32 m0, s19, 43648
    s_nop 0
    buffer_load_dwordx4 v2, s[8:11], s20 offen offset:1408 lds
    s_add_u32 m0, s19, 47616
    s_nop 0
    buffer_load_dwordx4 v2, s[8:11], s20 offen offset:1536 lds
    s_add_u32 m0, s19, 51584
    s_nop 0
    buffer_load_dwordx4 v2, s[8:11], s20 offen offset:1664 lds
    s_add_u32 m0, s19, 55552
    s_nop 0
    buffer_load_dwordx4 v2, s[8:11], s20 offen offset:1792 lds
    s_add_u32 m0, s19, 59520
    s_nop 0
    buffer_load_dwordx4 v2, s[8:11], s20 offen offset:1920 lds
    s_add_u32 s20, s20, s24
    s_add_u32 m0, s19, 65536
    s_nop 0
    buffer_load_dwordx4 v2, s[8:11], s20 offen offset:0 lds
    s_add_u32 m0, s19, 69504
    s_nop 0
    buffer_load_dwordx4 v2, s[8:11], s20 offen offset:128 lds
    s_add_u32 m0, s19, 73472
    s_nop 0
    buffer_load_dwordx4 v2, s[8:11], s20 offen offset:256 lds
    s_waitcnt vmcnt(11)
    s_barrier
    ds_read_b128 v[20:23], v10 offset:0
    ds_read_b128 v[24:27], v10 offset:2048
    ds_read_b128 v[28:31], v11 offset:0
    ds_read_b128 v[32:35], v11 offset:2048
    ds_read_b128 v[36:39], v10 offset:4096
    ds_read_b128 v[40:43], v10 offset:6144
    ds_read_b128 v[44:47], v11 offset:4096
.p2align 6
F1_top:
    s_waitcnt lgkmcnt(6)
    v_mfma_f32_16x16x32_bf16 v[52:55], v[20:23], a[0:3], 0
    ds_read_b128 v[48:51], v11 offset:6144
    v_mfma_f32_16x16x32_bf16 v[60:63], v[20:23], a[4:7], 0
    s_waitcnt lgkmcnt(6)
    v_mfma_f32_16x16x32_bf16 v[56:59], v[24:27], a[0:3], 0
    ds_read_b128 v[20:23], v10 offset:8192
    s_add_u32 m0, s19, 77440
    v_mfma_f32_16x16x32_bf16 v[64:67], v[24:27], a[4:7], 0
    buffer_load_dwordx4 v2, s[8:11], s20 offen offset:384 lds
    s_waitcnt lgkmcnt(6)
    v_mfma_f32_16x16x32_bf16 v[52:55], v[28:31], a[8:11], v[52:55]
    ds_read_b128 v[24:27], v10 offset:10240
    v_mfma_f32_16x16x32_bf16 v[60:63], v[28:31], a[12:15], v[60:63]
    s_waitcnt lgkmcnt(6)
    v_mfma_f32_16x16x32_bf16 v[56:59], v[32:35], a[8:11], v[56:59]
    ds_read_b128 v[28:31], v11 offset:8192
    s_add_u32 m0, s19, 81408
    v_mfma_f32_16x16x32_bf16 v[64:67], v[32:35], a[12:15], v[64:67]
    buffer_load_dwordx4 v2, s[8:11], s20 offen offset:512 lds
    s_waitcnt lgkmcnt(6)
    v_mfma_f32_16x16x32_bf16 v[52:55], v[36:39], a[16:19], v[52:55]
    ds_read_b128 v[32:35], v11 offset:10240
    v_mfma_f32_16x16x32_bf16 v[60:63], v[36:39], a[20:23], v[60:63]
    s_waitcnt lgkmcnt(6)
    v_mfma_f32_16x16x32_bf16 v[56:59], v[40:43], a[16:19], v[56:59]
    ds_read_b128 v[36:39], v10 offset:12288
    s_add_u32 m0, s19, 85376
    v_mfma_f32_16x16x32_bf16 v[64:67], v[40:43], a[20:23], v[64:67]
    buffer_load_dwordx4 v2, s[8:11], s20 offen offset:640 lds
    s_waitcnt lgkmcnt(6)
    v_mfma_f32_16x16x32_bf16 v[52:55], v[44:47], a[24:27], v[52:55]
    ds_read_b128 v[40:43], v10 offset:14336
    v_mfma_f32_16x16x32_bf16 v[60:63], v[44:47], a[28:31], v[60:63]
    s_waitcnt lgkmcnt(6)
    v_mfma_f32_16x16x32_bf16 v[56:59], v[48:51], a[24:27], v[56:59]
    ds_read_b128 v[44:47], v11 offset:12288
    s_add_u32 m0, s19, 89344
    v_mfma_f32_16x16x32_bf16 v[64:67], v[48:51], a[28:31], v[64:67]
    buffer_load_dwordx4 v2, s[8:11], s20 offen offset:768 lds
    s_waitcnt lgkmcnt(6)
    v_mfma_f32_16x16x32_bf16 v[52:55], v[20:23], a[32:35], v[52:55]
    ds_read_b128 v[48:51], v11 offset:14336
    v_mfma_f32_16x16x32_bf16 v[60:63], v[20:23], a[36:39], v[60:63]
    s_waitcnt lgkmcnt(6)
    v_mfma_f32_16x16x32_bf16 v[56:59], v[24:27], a[32:35], v[56:59]
    ds_read_b128 v[20:23], v10 offset:16384
    s_add_u32 m0, s19, 93312
    v_mfma_f32_16x16x32_bf16 v[64:67], v[24:27], a[36:39], v[64:67]
    buffer_load_dwordx4 v2, s[8:11], s20 offen offset:896 lds
    s_waitcnt lgkmcnt(6)
    v_mfma_f32_16x16x32_bf16 v[52:55], v[28:31], a[40:43], v[52:55]
    ds_read_b128 v[24:27], v10 offset:18432
    v_mfma_f32_16x16x32_bf16 v[60:63], v[28:31], a[44:47], v[60:63]
    v_cvt_pk_bf16_f32 v84, v68, v69
    s_waitcnt lgkmcnt(6)
    v_mfma_f32_16x16x32_bf16 v[56:59], v[32:35], a[40:43], v[56:59]
    ds_read_b128 v[28:31], v11 offset:16384
    v_mfma_f32_16x16x32_bf16 v[64:67], v[32:35], a[44:47], v[64:67]
    v_cvt_pk_bf16_f32 v85, v70, v71
    s_waitcnt lgkmcnt(6)
    v_mfma_f32_16x16x32_bf16 v[52:55], v[36:39], a[48:51], v[52:55]
    ds_read_b128 v[32:35], v11 offset:18432
    v_mfma_f32_16x16x32_bf16 v[60:63], v[36:39], a[52:55], v[60:63]
    v_cvt_pk_bf16_f32 v86, v72, v73
    s_waitcnt lgkmcnt(6)
    v_mfma_f32_16x16x32_bf16 v[56:59], v[40:43], a[48:51], v[56:59]
    ds_read_b128 v[36:39], v10 offset:20480
    v_mfma_f32_16x16x32_bf16 v[64:67], v[40:43], a[52:55], v[64:67]
    v_cvt_pk_bf16_f32 v87, v74, v75
    s_waitcnt lgkmcnt(6)
    v_mfma_f32_16x16x32_bf16 v[52:55], v[44:47], a[56:59], v[52:55]
    ds_read_b128 v[40:43], v10 offset:22528
    v_mfma_f32_16x16x32_bf16 v[60:63], v[44:47], a[60:63], v[60:63]
    v_cvt_pk_bf16_f32 v88, v76, v77
    s_waitcnt lgkmcnt(6)
    v_mfma_f32_16x16x32_bf16 v[56:59], v[48:51], a[56:59], v[56:59]
    ds_read_b128 v[44:47], v11 offset:20480
    v_mfma_f32_16x16x32_bf16 v[64:67], v[48:51], a[60:63], v[64:67]
    v_cvt_pk_bf16_f32 v89, v78, v79
    buffer_store_dwordx4 v[84:87], v3, s[4:7], s21 offen offset:0 sc1
    s_waitcnt lgkmcnt(6)
    v_mfma_f32_16x16x32_bf16 v[52:55], v[20:23], a[64:67], v[52:55]
    ds_read_b128 v[48:51], v11 offset:22528
    v_mfma_f32_16x16x32_bf16 v[60:63], v[20:23], a[68:71], v[60:63]
    v_cvt_pk_bf16_f32 v90, v80, v81
    s_waitcnt lgkmcnt(6)
    v_mfma_f32_16x16x32_bf16 v[56:59], v[24:27], a[64:67], v[56:59]
    ds_read_b128 v[20:23], v10 offset:24576
    v_mfma_f32_16x16x32_bf16 v[64:67], v[24:27], a[68:71], v[64:67]
    v_cvt_pk_bf16_f32 v91, v82, v83
    s_waitcnt lgkmcnt(6)
    v_mfma_f32_16x16x32_bf16 v[52:55], v[28:31], a[72:75], v[52:55]
    ds_read_b128 v[24:27], v10 offset:26624
    v_mfma_f32_16x16x32_bf16 v[60:63], v[28:31], a[76:79], v[60:63]
    s_waitcnt lgkmcnt(6)
    v_mfma_f32_16x16x32_bf16 v[56:59], v[32:35], a[72:75], v[56:59]
    ds_read_b128 v[28:31], v11 offset:24576
    v_mfma_f32_16x16x32_bf16 v[64:67], v[32:35], a[76:79], v[64:67]
    buffer_store_dwordx4 v[88:91], v3, s[4:7], s21 offen offset:256 sc1
    s_waitcnt lgkmcnt(6)
    v_mfma_f32_16x16x32_bf16 v[52:55], v[36:39], a[80:83], v[52:55]
    ds_read_b128 v[32:35], v11 offset:26624
    v_mfma_f32_16x16x32_bf16 v[60:63], v[36:39], a[84:87], v[60:63]
    s_add_u32 s21, s21, s25
    s_mov_b32 s25, s26
    s_waitcnt lgkmcnt(6)
    v_mfma_f32_16x16x32_bf16 v[56:59], v[40:43], a[80:83], v[56:59]
    ds_read_b128 v[36:39], v10 offset:28672
    v_mfma_f32_16x16x32_bf16 v[64:67], v[40:43], a[84:87], v[64:67]
    s_waitcnt lgkmcnt(6)
    v_mfma_f32_16x16x32_bf16 v[52:55], v[44:47], a[88:91], v[52:55]
    ds_read_b128 v[40:43], v10 offset:30720
    v_mfma_f32_16x16x32_bf16 v[60:63], v[44:47], a[92:95], v[60:63]
    buffer_load_dword v248, v247, s[44:47], s34 offen
    s_add_u32 s34, s34, 1048576
    s_sub_u32 s31, s22, 10
    s_lshl_b32 s31, s31, 6
    s_cmp_lt_u32 s31, 384
    s_cselect_b32 s31, s31, 1073741824
    buffer_load_dword v249, v246, s[48:51], s31 offen
    buffer_load_dword v250, v246, s[52:55], s31 offen
    s_cmp_eq_u32 s22, 2
    s_cselect_b32 s31, s35, 1073741824
    buffer_load_dword v251, v247, s[40:43], s31 offen
    s_add_u32 s31, s31, 8192
    buffer_load_dword v251, v247, s[40:43], s31 offen
    s_add_u32 s31, s31, 8192
    buffer_load_dword v251, v247, s[40:43], s31 offen
    s_add_u32 s31, s31, 8192
    buffer_load_dword v251, v247, s[40:43], s31 offen
    s_add_u32 s31, s31, 8192
    s_waitcnt lgkmcnt(6)
    v_mfma_f32_16x16x32_bf16 v[56:59], v[48:51], a[88:91], v[56:59]
    ds_read_b128 v[44:47], v11 offset:28672
    v_mfma_f32_16x16x32_bf16 v[64:67], v[48:51], a[92:95], v[64:67]
    s_waitcnt lgkmcnt(6)
    v_mfma_f32_16x16x32_bf16 v[52:55], v[20:23], a[96:99], v[52:55]
    ds_read_b128 v[48:51], v11 offset:30720
    v_mfma_f32_16x16x32_bf16 v[60:63], v[20:23], a[100:103], v[60:63]
    s_waitcnt lgkmcnt(6)
    v_mfma_f32_16x16x32_bf16 v[56:59], v[24:27], a[96:99], v[56:59]
    s_waitcnt vmcnt(17)
    s_barrier
    ds_read_b128 v[20:23], v10 offset:32768
    v_mfma_f32_16x16x32_bf16 v[64:67], v[24:27], a[100:103], v[64:67]
    s_waitcnt lgkmcnt(6)
    v_mfma_f32_16x16x32_bf16 v[52:55], v[28:31], a[104:107], v[52:55]
    ds_read_b128 v[24:27], v10 offset:34816
    s_add_u32 m0, s19, 97280
    v_mfma_f32_16x16x32_bf16 v[60:63], v[28:31], a[108:111], v[60:63]
    buffer_load_dwordx4 v2, s[8:11], s20 offen offset:1024 lds
    s_waitcnt lgkmcnt(6)
    v_mfma_f32_16x16x32_bf16 v[56:59], v[32:35], a[104:107], v[56:59]
    ds_read_b128 v[28:31], v11 offset:32768
    v_mfma_f32_16x16x32_bf16 v[64:67], v[32:35], a[108:111], v[64:67]
    s_waitcnt lgkmcnt(6)
    v_mfma_f32_16x16x32_bf16 v[52:55], v[36:39], a[112:115], v[52:55]
    ds_read_b128 v[32:35], v11 offset:34816
    s_add_u32 m0, s19, 101248
    v_mfma_f32_16x16x32_bf16 v[60:63], v[36:39], a[116:119], v[60:63]
    buffer_load_dwordx4 v2, s[8:11], s20 offen offset:1152 lds
    s_waitcnt lgkmcnt(6)
    v_mfma_f32_16x16x32_bf16 v[56:59], v[40:43], a[112:115], v[56:59]
    ds_read_b128 v[36:39], v10 offset:36864
    v_mfma_f32_16x16x32_bf16 v[64:67], v[40:43], a[116:119], v[64:67]
    s_waitcnt lgkmcnt(6)
    v_mfma_f32_16x16x32_bf16 v[52:55], v[44:47], a[120:123], v[52:55]
    ds_read_b128 v[40:43], v10 offset:38912
    s_add_u32 m0, s19, 105216
    v_mfma_f32_16x16x32_bf16 v[60:63], v[44:47], a[124:127], v[60:63]
    buffer_load_dwordx4 v2, s[8:11], s20 offen offset:1280 lds
    s_waitcnt lgkmcnt(6)
    v_mfma_f32_16x16x32_bf16 v[56:59], v[48:51], a[120:123], v[56:59]
    ds_read_b128 v[44:47], v11 offset:36864
    v_mfma_f32_16x16x32_bf16 v[64:67], v[48:51], a[124:127], v[64:67]
    s_waitcnt lgkmcnt(6)
    v_mfma_f32_16x16x32_bf16 v[52:55], v[20:23], a[128:131], v[52:55]
    ds_read_b128 v[48:51], v11 offset:38912
    v_mfma_f32_16x16x32_bf16 v[60:63], v[20:23], a[132:135], v[60:63]
    s_waitcnt lgkmcnt(6)
    v_mfma_f32_16x16x32_bf16 v[56:59], v[24:27], a[128:131], v[56:59]
    ds_read_b128 v[20:23], v10 offset:40960
    s_add_u32 m0, s19, 109184
    v_mfma_f32_16x16x32_bf16 v[64:67], v[24:27], a[132:135], v[64:67]
    buffer_load_dwordx4 v2, s[8:11], s20 offen offset:1408 lds
    s_waitcnt lgkmcnt(6)
    v_mfma_f32_16x16x32_bf16 v[52:55], v[28:31], a[136:139], v[52:55]
    ds_read_b128 v[24:27], v10 offset:43008
    v_mfma_f32_16x16x32_bf16 v[60:63], v[28:31], a[140:143], v[60:63]
    s_waitcnt lgkmcnt(6)
    v_mfma_f32_16x16x32_bf16 v[56:59], v[32:35], a[136:139], v[56:59]
    ds_read_b128 v[28:31], v11 offset:40960
    s_add_u32 m0, s19, 113152
    v_mfma_f32_16x16x32_bf16 v[64:67], v[32:35], a[140:143], v[64:67]
    buffer_load_dwordx4 v2, s[8:11], s20 offen offset:1536 lds
    s_waitcnt lgkmcnt(6)
    v_mfma_f32_16x16x32_bf16 v[52:55], v[36:39], a[144:147], v[52:55]
    ds_read_b128 v[32:35], v11 offset:43008
    v_mfma_f32_16x16x32_bf16 v[60:63], v[36:39], a[148:151], v[60:63]
    s_waitcnt lgkmcnt(6)
    v_mfma_f32_16x16x32_bf16 v[56:59], v[40:43], a[144:147], v[56:59]
    ds_read_b128 v[36:39], v10 offset:45056
    s_add_u32 m0, s19, 117120
    v_mfma_f32_16x16x32_bf16 v[64:67], v[40:43], a[148:151], v[64:67]
    buffer_load_dwordx4 v2, s[8:11], s20 offen offset:1664 lds
    s_waitcnt lgkmcnt(6)
    v_mfma_f32_16x16x32_bf16 v[52:55], v[44:47], a[152:155], v[52:55]
    ds_read_b128 v[40:43], v10 offset:47104
    v_mfma_f32_16x16x32_bf16 v[60:63], v[44:47], a[156:159], v[60:63]
    s_waitcnt lgkmcnt(6)
    v_mfma_f32_16x16x32_bf16 v[56:59], v[48:51], a[152:155], v[56:59]
    ds_read_b128 v[44:47], v11 offset:45056
    s_add_u32 m0, s19, 121088
    v_mfma_f32_16x16x32_bf16 v[64:67], v[48:51], a[156:159], v[64:67]
    buffer_load_dwordx4 v2, s[8:11], s20 offen offset:1792 lds
    s_waitcnt lgkmcnt(6)
    v_mfma_f32_16x16x32_bf16 v[52:55], v[20:23], a[160:163], v[52:55]
    ds_read_b128 v[48:51], v11 offset:47104
    v_mfma_f32_16x16x32_bf16 v[60:63], v[20:23], a[164:167], v[60:63]
    s_waitcnt lgkmcnt(6)
    v_mfma_f32_16x16x32_bf16 v[56:59], v[24:27], a[160:163], v[56:59]
    ds_read_b128 v[20:23], v10 offset:49152
    s_add_u32 m0, s19, 125056
    v_mfma_f32_16x16x32_bf16 v[64:67], v[24:27], a[164:167], v[64:67]
    buffer_load_dwordx4 v2, s[8:11], s20 offen offset:1920 lds
    s_waitcnt lgkmcnt(6)
    v_mfma_f32_16x16x32_bf16 v[52:55], v[28:31], a[168:171], v[52:55]
    ds_read_b128 v[24:27], v10 offset:51200
    v_mfma_f32_16x16x32_bf16 v[60:63], v[28:31], a[172:175], v[60:63]
    s_add_u32 s20, s20, s24
    s_waitcnt lgkmcnt(6)
    v_mfma_f32_16x16x32_bf16 v[56:59], v[32:35], a[168:171], v[56:59]
    ds_read_b128 v[28:31], v11 offset:49152
    v_mfma_f32_16x16x32_bf16 v[64:67], v[32:35], a[172:175], v[64:67]
    s_waitcnt lgkmcnt(6)
    v_mfma_f32_16x16x32_bf16 v[52:55], v[36:39], a[176:179], v[52:55]
    ds_read_b128 v[32:35], v11 offset:51200
    v_mfma_f32_16x16x32_bf16 v[60:63], v[36:39], a[180:183], v[60:63]
    s_waitcnt lgkmcnt(6)
    v_mfma_f32_16x16x32_bf16 v[56:59], v[40:43], a[176:179], v[56:59]
    ds_read_b128 v[36:39], v10 offset:53248
    v_mfma_f32_16x16x32_bf16 v[64:67], v[40:43], a[180:183], v[64:67]
    s_waitcnt lgkmcnt(6)
    v_mfma_f32_16x16x32_bf16 v[52:55], v[44:47], a[184:187], v[52:55]
    ds_read_b128 v[40:43], v10 offset:55296
    v_mfma_f32_16x16x32_bf16 v[60:63], v[44:47], a[188:191], v[60:63]
    s_waitcnt lgkmcnt(6)
    v_mfma_f32_16x16x32_bf16 v[56:59], v[48:51], a[184:187], v[56:59]
    ds_read_b128 v[44:47], v11 offset:53248
    v_mfma_f32_16x16x32_bf16 v[64:67], v[48:51], a[188:191], v[64:67]
    s_waitcnt lgkmcnt(6)
    v_mfma_f32_16x16x32_bf16 v[52:55], v[20:23], a[192:195], v[52:55]
    ds_read_b128 v[48:51], v11 offset:55296
    v_mfma_f32_16x16x32_bf16 v[60:63], v[20:23], a[196:199], v[60:63]
    s_waitcnt lgkmcnt(6)
    v_mfma_f32_16x16x32_bf16 v[56:59], v[24:27], a[192:195], v[56:59]
    ds_read_b128 v[20:23], v10 offset:57344
    v_mfma_f32_16x16x32_bf16 v[64:67], v[24:27], a[196:199], v[64:67]
    s_waitcnt lgkmcnt(6)
    v_mfma_f32_16x16x32_bf16 v[52:55], v[28:31], a[200:203], v[52:55]
    ds_read_b128 v[24:27], v10 offset:59392
    v_mfma_f32_16x16x32_bf16 v[60:63], v[28:31], a[204:207], v[60:63]
    s_waitcnt lgkmcnt(6)
    v_mfma_f32_16x16x32_bf16 v[56:59], v[32:35], a[200:203], v[56:59]
    ds_read_b128 v[28:31], v11 offset:57344
    v_mfma_f32_16x16x32_bf16 v[64:67], v[32:35], a[204:207], v[64:67]
    s_waitcnt lgkmcnt(6)
    v_mfma_f32_16x16x32_bf16 v[52:55], v[36:39], a[208:211], v[52:55]
    ds_read_b128 v[32:35], v11 offset:59392
    v_mfma_f32_16x16x32_bf16 v[60:63], v[36:39], a[212:215], v[60:63]
    s_waitcnt lgkmcnt(6)
    v_mfma_f32_16x16x32_bf16 v[56:59], v[40:43], a[208:211], v[56:59]
    ds_read_b128 v[36:39], v10 offset:61440
    v_mfma_f32_16x16x32_bf16 v[64:67], v[40:43], a[212:215], v[64:67]
    s_waitcnt lgkmcnt(6)
    v_mfma_f32_16x16x32_bf16 v[52:55], v[44:47], a[216:219], v[52:55]
    ds_read_b128 v[40:43], v10 offset:63488
    v_mfma_f32_16x16x32_bf16 v[60:63], v[44:47], a[220:223], v[60:63]
    s_waitcnt lgkmcnt(6)
    v_mfma_f32_16x16x32_bf16 v[56:59], v[48:51], a[216:219], v[56:59]
    ds_read_b128 v[44:47], v11 offset:61440
    v_mfma_f32_16x16x32_bf16 v[64:67], v[48:51], a[220:223], v[64:67]
    s_waitcnt lgkmcnt(6)
    v_mfma_f32_16x16x32_bf16 v[52:55], v[20:23], a[224:227], v[52:55]
    ds_read_b128 v[48:51], v11 offset:63488
    v_mfma_f32_16x16x32_bf16 v[60:63], v[20:23], a[228:231], v[60:63]
    s_waitcnt lgkmcnt(6)
    v_mfma_f32_16x16x32_bf16 v[56:59], v[24:27], a[224:227], v[56:59]
    s_waitcnt vmcnt(8)
    s_barrier
    ds_read_b128 v[20:23], v12 offset:0
    v_mfma_f32_16x16x32_bf16 v[64:67], v[24:27], a[228:231], v[64:67]
    s_waitcnt lgkmcnt(6)
    v_mfma_f32_16x16x32_bf16 v[52:55], v[28:31], a[232:235], v[52:55]
    ds_read_b128 v[24:27], v12 offset:2048
    s_add_u32 m0, s19, 0
    v_mfma_f32_16x16x32_bf16 v[60:63], v[28:31], a[236:239], v[60:63]
    buffer_load_dwordx4 v2, s[8:11], s20 offen offset:0 lds
    s_waitcnt lgkmcnt(6)
    v_mfma_f32_16x16x32_bf16 v[56:59], v[32:35], a[232:235], v[56:59]
    ds_read_b128 v[28:31], v13 offset:0
    v_mfma_f32_16x16x32_bf16 v[64:67], v[32:35], a[236:239], v[64:67]
    s_waitcnt lgkmcnt(6)
    v_mfma_f32_16x16x32_bf16 v[52:55], v[36:39], a[240:243], v[52:55]
    ds_read_b128 v[32:35], v13 offset:2048
    s_add_u32 m0, s19, 3968
    v_mfma_f32_16x16x32_bf16 v[60:63], v[36:39], a[244:247], v[60:63]
    buffer_load_dwordx4 v2, s[8:11], s20 offen offset:128 lds
    s_waitcnt lgkmcnt(6)
    v_mfma_f32_16x16x32_bf16 v[56:59], v[40:43], a[240:243], v[56:59]
    ds_read_b128 v[36:39], v12 offset:4096
    v_mfma_f32_16x16x32_bf16 v[64:67], v[40:43], a[244:247], v[64:67]
    s_waitcnt lgkmcnt(6)
    v_mfma_f32_16x16x32_bf16 v[52:55], v[44:47], a[248:251], v[52:55]
    ds_read_b128 v[40:43], v12 offset:6144
    s_add_u32 m0, s19, 7936
    v_mfma_f32_16x16x32_bf16 v[60:63], v[44:47], a[252:255], v[60:63]
    buffer_load_dwordx4 v2, s[8:11], s20 offen offset:256 lds
    s_waitcnt lgkmcnt(6)
    v_mfma_f32_16x16x32_bf16 v[56:59], v[48:51], a[248:251], v[56:59]
    ds_read_b128 v[44:47], v13 offset:4096
    v_mfma_f32_16x16x32_bf16 v[64:67], v[48:51], a[252:255], v[64:67]
    s_waitcnt lgkmcnt(6)
    v_mfma_f32_16x16x32_bf16 v[68:71], v[20:23], a[0:3], 0
    ds_read_b128 v[48:51], v13 offset:6144
    v_mfma_f32_16x16x32_bf16 v[76:79], v[20:23], a[4:7], 0
    s_waitcnt lgkmcnt(6)
    v_mfma_f32_16x16x32_bf16 v[72:75], v[24:27], a[0:3], 0
    ds_read_b128 v[20:23], v12 offset:8192
    s_add_u32 m0, s19, 11904
    v_mfma_f32_16x16x32_bf16 v[80:83], v[24:27], a[4:7], 0
    buffer_load_dwordx4 v2, s[8:11], s20 offen offset:384 lds
    s_waitcnt lgkmcnt(6)
    v_mfma_f32_16x16x32_bf16 v[68:71], v[28:31], a[8:11], v[68:71]
    ds_read_b128 v[24:27], v12 offset:10240
    v_mfma_f32_16x16x32_bf16 v[76:79], v[28:31], a[12:15], v[76:79]
    s_waitcnt lgkmcnt(6)
    v_mfma_f32_16x16x32_bf16 v[72:75], v[32:35], a[8:11], v[72:75]
    ds_read_b128 v[28:31], v13 offset:8192
    s_add_u32 m0, s19, 15872
    v_mfma_f32_16x16x32_bf16 v[80:83], v[32:35], a[12:15], v[80:83]
    buffer_load_dwordx4 v2, s[8:11], s20 offen offset:512 lds
    s_waitcnt lgkmcnt(6)
    v_mfma_f32_16x16x32_bf16 v[68:71], v[36:39], a[16:19], v[68:71]
    ds_read_b128 v[32:35], v13 offset:10240
    v_mfma_f32_16x16x32_bf16 v[76:79], v[36:39], a[20:23], v[76:79]
    s_waitcnt lgkmcnt(6)
    v_mfma_f32_16x16x32_bf16 v[72:75], v[40:43], a[16:19], v[72:75]
    ds_read_b128 v[36:39], v12 offset:12288
    s_add_u32 m0, s19, 19840
    v_mfma_f32_16x16x32_bf16 v[80:83], v[40:43], a[20:23], v[80:83]
    buffer_load_dwordx4 v2, s[8:11], s20 offen offset:640 lds
    s_waitcnt lgkmcnt(6)
    v_mfma_f32_16x16x32_bf16 v[68:71], v[44:47], a[24:27], v[68:71]
    ds_read_b128 v[40:43], v12 offset:14336
    v_mfma_f32_16x16x32_bf16 v[76:79], v[44:47], a[28:31], v[76:79]
    s_waitcnt lgkmcnt(6)
    v_mfma_f32_16x16x32_bf16 v[72:75], v[48:51], a[24:27], v[72:75]
    ds_read_b128 v[44:47], v13 offset:12288
    s_add_u32 m0, s19, 23808
    v_mfma_f32_16x16x32_bf16 v[80:83], v[48:51], a[28:31], v[80:83]
    buffer_load_dwordx4 v2, s[8:11], s20 offen offset:768 lds
    s_waitcnt lgkmcnt(6)
    v_mfma_f32_16x16x32_bf16 v[68:71], v[20:23], a[32:35], v[68:71]
    ds_read_b128 v[48:51], v13 offset:14336
    v_mfma_f32_16x16x32_bf16 v[76:79], v[20:23], a[36:39], v[76:79]
    s_waitcnt lgkmcnt(6)
    v_mfma_f32_16x16x32_bf16 v[72:75], v[24:27], a[32:35], v[72:75]
    ds_read_b128 v[20:23], v12 offset:16384
    s_add_u32 m0, s19, 27776
    v_mfma_f32_16x16x32_bf16 v[80:83], v[24:27], a[36:39], v[80:83]
    buffer_load_dwordx4 v2, s[8:11], s20 offen offset:896 lds
    s_waitcnt lgkmcnt(6)
    v_mfma_f32_16x16x32_bf16 v[68:71], v[28:31], a[40:43], v[68:71]
    ds_read_b128 v[24:27], v12 offset:18432
    v_mfma_f32_16x16x32_bf16 v[76:79], v[28:31], a[44:47], v[76:79]
    v_cvt_pk_bf16_f32 v84, v52, v53
    s_waitcnt lgkmcnt(6)
    v_mfma_f32_16x16x32_bf16 v[72:75], v[32:35], a[40:43], v[72:75]
    ds_read_b128 v[28:31], v13 offset:16384
    v_mfma_f32_16x16x32_bf16 v[80:83], v[32:35], a[44:47], v[80:83]
    v_cvt_pk_bf16_f32 v85, v54, v55
    s_waitcnt lgkmcnt(6)
    v_mfma_f32_16x16x32_bf16 v[68:71], v[36:39], a[48:51], v[68:71]
    ds_read_b128 v[32:35], v13 offset:18432
    v_mfma_f32_16x16x32_bf16 v[76:79], v[36:39], a[52:55], v[76:79]
    v_cvt_pk_bf16_f32 v86, v56, v57
    s_waitcnt lgkmcnt(6)
    v_mfma_f32_16x16x32_bf16 v[72:75], v[40:43], a[48:51], v[72:75]
    ds_read_b128 v[36:39], v12 offset:20480
    v_mfma_f32_16x16x32_bf16 v[80:83], v[40:43], a[52:55], v[80:83]
    v_cvt_pk_bf16_f32 v87, v58, v59
    s_waitcnt lgkmcnt(6)
    v_mfma_f32_16x16x32_bf16 v[68:71], v[44:47], a[56:59], v[68:71]
    ds_read_b128 v[40:43], v12 offset:22528
    v_mfma_f32_16x16x32_bf16 v[76:79], v[44:47], a[60:63], v[76:79]
    v_cvt_pk_bf16_f32 v88, v60, v61
    s_waitcnt lgkmcnt(6)
    v_mfma_f32_16x16x32_bf16 v[72:75], v[48:51], a[56:59], v[72:75]
    ds_read_b128 v[44:47], v13 offset:20480
    v_mfma_f32_16x16x32_bf16 v[80:83], v[48:51], a[60:63], v[80:83]
    v_cvt_pk_bf16_f32 v89, v62, v63
    buffer_store_dwordx4 v[84:87], v3, s[4:7], s21 offen offset:0 sc1
    s_waitcnt lgkmcnt(6)
    v_mfma_f32_16x16x32_bf16 v[68:71], v[20:23], a[64:67], v[68:71]
    ds_read_b128 v[48:51], v13 offset:22528
    v_mfma_f32_16x16x32_bf16 v[76:79], v[20:23], a[68:71], v[76:79]
    v_cvt_pk_bf16_f32 v90, v64, v65
    s_waitcnt lgkmcnt(6)
    v_mfma_f32_16x16x32_bf16 v[72:75], v[24:27], a[64:67], v[72:75]
    ds_read_b128 v[20:23], v12 offset:24576
    v_mfma_f32_16x16x32_bf16 v[80:83], v[24:27], a[68:71], v[80:83]
    v_cvt_pk_bf16_f32 v91, v66, v67
    s_waitcnt lgkmcnt(6)
    v_mfma_f32_16x16x32_bf16 v[68:71], v[28:31], a[72:75], v[68:71]
    ds_read_b128 v[24:27], v12 offset:26624
    v_mfma_f32_16x16x32_bf16 v[76:79], v[28:31], a[76:79], v[76:79]
    s_waitcnt lgkmcnt(6)
    v_mfma_f32_16x16x32_bf16 v[72:75], v[32:35], a[72:75], v[72:75]
    ds_read_b128 v[28:31], v13 offset:24576
    v_mfma_f32_16x16x32_bf16 v[80:83], v[32:35], a[76:79], v[80:83]
    buffer_store_dwordx4 v[88:91], v3, s[4:7], s21 offen offset:256 sc1
    s_waitcnt lgkmcnt(6)
    v_mfma_f32_16x16x32_bf16 v[68:71], v[36:39], a[80:83], v[68:71]
    ds_read_b128 v[32:35], v13 offset:26624
    v_mfma_f32_16x16x32_bf16 v[76:79], v[36:39], a[84:87], v[76:79]
    s_add_u32 s21, s21, s25
    s_mov_b32 s25, s26
    s_waitcnt lgkmcnt(6)
    v_mfma_f32_16x16x32_bf16 v[72:75], v[40:43], a[80:83], v[72:75]
    ds_read_b128 v[36:39], v12 offset:28672
    v_mfma_f32_16x16x32_bf16 v[80:83], v[40:43], a[84:87], v[80:83]
    s_waitcnt lgkmcnt(6)
    v_mfma_f32_16x16x32_bf16 v[68:71], v[44:47], a[88:91], v[68:71]
    ds_read_b128 v[40:43], v12 offset:30720
    v_mfma_f32_16x16x32_bf16 v[76:79], v[44:47], a[92:95], v[76:79]
    s_waitcnt lgkmcnt(6)
    v_mfma_f32_16x16x32_bf16 v[72:75], v[48:51], a[88:91], v[72:75]
    ds_read_b128 v[44:47], v13 offset:28672
    v_mfma_f32_16x16x32_bf16 v[80:83], v[48:51], a[92:95], v[80:83]
    s_waitcnt lgkmcnt(6)
    v_mfma_f32_16x16x32_bf16 v[68:71], v[20:23], a[96:99], v[68:71]
    ds_read_b128 v[48:51], v13 offset:30720
    v_mfma_f32_16x16x32_bf16 v[76:79], v[20:23], a[100:103], v[76:79]
    s_waitcnt lgkmcnt(6)
    v_mfma_f32_16x16x32_bf16 v[72:75], v[24:27], a[96:99], v[72:75]
    s_waitcnt vmcnt(10)
    s_barrier
    ds_read_b128 v[20:23], v12 offset:32768
    v_mfma_f32_16x16x32_bf16 v[80:83], v[24:27], a[100:103], v[80:83]
    s_waitcnt lgkmcnt(6)
    v_mfma_f32_16x16x32_bf16 v[68:71], v[28:31], a[104:107], v[68:71]
    ds_read_b128 v[24:27], v12 offset:34816
    s_add_u32 m0, s19, 31744
    v_mfma_f32_16x16x32_bf16 v[76:79], v[28:31], a[108:111], v[76:79]
    buffer_load_dwordx4 v2, s[8:11], s20 offen offset:1024 lds
    s_waitcnt lgkmcnt(6)
    v_mfma_f32_16x16x32_bf16 v[72:75], v[32:35], a[104:107], v[72:75]
    ds_read_b128 v[28:31], v13 offset:32768
    v_mfma_f32_16x16x32_bf16 v[80:83], v[32:35], a[108:111], v[80:83]
    s_waitcnt lgkmcnt(6)
    v_mfma_f32_16x16x32_bf16 v[68:71], v[36:39], a[112:115], v[68:71]
    ds_read_b128 v[32:35], v13 offset:34816
    s_add_u32 m0, s19, 35712
    v_mfma_f32_16x16x32_bf16 v[76:79], v[36:39], a[116:119], v[76:79]
    buffer_load_dwordx4 v2, s[8:11], s20 offen offset:1152 lds
    s_waitcnt lgkmcnt(6)
    v_mfma_f32_16x16x32_bf16 v[72:75], v[40:43], a[112:115], v[72:75]
    ds_read_b128 v[36:39], v12 offset:36864
    v_mfma_f32_16x16x32_bf16 v[80:83], v[40:43], a[116:119], v[80:83]
    s_waitcnt lgkmcnt(6)
    v_mfma_f32_16x16x32_bf16 v[68:71], v[44:47], a[120:123], v[68:71]
    ds_read_b128 v[40:43], v12 offset:38912
    s_add_u32 m0, s19, 39680
    v_mfma_f32_16x16x32_bf16 v[76:79], v[44:47], a[124:127], v[76:79]
    buffer_load_dwordx4 v2, s[8:11], s20 offen offset:1280 lds
    s_waitcnt lgkmcnt(6)
    v_mfma_f32_16x16x32_bf16 v[72:75], v[48:51], a[120:123], v[72:75]
    ds_read_b128 v[44:47], v13 offset:36864
    v_mfma_f32_16x16x32_bf16 v[80:83], v[48:51], a[124:127], v[80:83]
    s_waitcnt lgkmcnt(6)
    v_mfma_f32_16x16x32_bf16 v[68:71], v[20:23], a[128:131], v[68:71]
    ds_read_b128 v[48:51], v13 offset:38912
    v_mfma_f32_16x16x32_bf16 v[76:79], v[20:23], a[132:135], v[76:79]
    s_waitcnt lgkmcnt(6)
    v_mfma_f32_16x16x32_bf16 v[72:75], v[24:27], a[128:131], v[72:75]
    ds_read_b128 v[20:23], v12 offset:40960
    s_add_u32 m0, s19, 43648
    v_mfma_f32_16x16x32_bf16 v[80:83], v[24:27], a[132:135], v[80:83]
    buffer_load_dwordx4 v2, s[8:11], s20 offen offset:1408 lds
    s_waitcnt lgkmcnt(6)
    v_mfma_f32_16x16x32_bf16 v[68:71], v[28:31], a[136:139], v[68:71]
    ds_read_b128 v[24:27], v12 offset:43008
    v_mfma_f32_16x16x32_bf16 v[76:79], v[28:31], a[140:143], v[76:79]
    s_waitcnt lgkmcnt(6)
    v_mfma_f32_16x16x32_bf16 v[72:75], v[32:35], a[136:139], v[72:75]
    ds_read_b128 v[28:31], v13 offset:40960
    s_add_u32 m0, s19, 47616
    v_mfma_f32_16x16x32_bf16 v[80:83], v[32:35], a[140:143], v[80:83]
    buffer_load_dwordx4 v2, s[8:11], s20 offen offset:1536 lds
    s_waitcnt lgkmcnt(6)
    v_mfma_f32_16x16x32_bf16 v[68:71], v[36:39], a[144:147], v[68:71]
    ds_read_b128 v[32:35], v13 offset:43008
    v_mfma_f32_16x16x32_bf16 v[76:79], v[36:39], a[148:151], v[76:79]
    s_waitcnt lgkmcnt(6)
    v_mfma_f32_16x16x32_bf16 v[72:75], v[40:43], a[144:147], v[72:75]
    ds_read_b128 v[36:39], v12 offset:45056
    s_add_u32 m0, s19, 51584
    v_mfma_f32_16x16x32_bf16 v[80:83], v[40:43], a[148:151], v[80:83]
    buffer_load_dwordx4 v2, s[8:11], s20 offen offset:1664 lds
    s_waitcnt lgkmcnt(6)
    v_mfma_f32_16x16x32_bf16 v[68:71], v[44:47], a[152:155], v[68:71]
    ds_read_b128 v[40:43], v12 offset:47104
    v_mfma_f32_16x16x32_bf16 v[76:79], v[44:47], a[156:159], v[76:79]
    s_waitcnt lgkmcnt(6)
    v_mfma_f32_16x16x32_bf16 v[72:75], v[48:51], a[152:155], v[72:75]
    ds_read_b128 v[44:47], v13 offset:45056
    s_add_u32 m0, s19, 55552
    v_mfma_f32_16x16x32_bf16 v[80:83], v[48:51], a[156:159], v[80:83]
    buffer_load_dwordx4 v2, s[8:11], s20 offen offset:1792 lds
    s_waitcnt lgkmcnt(6)
    v_mfma_f32_16x16x32_bf16 v[68:71], v[20:23], a[160:163], v[68:71]
    ds_read_b128 v[48:51], v13 offset:47104
    v_mfma_f32_16x16x32_bf16 v[76:79], v[20:23], a[164:167], v[76:79]
    s_waitcnt lgkmcnt(6)
    v_mfma_f32_16x16x32_bf16 v[72:75], v[24:27], a[160:163], v[72:75]
    ds_read_b128 v[20:23], v12 offset:49152
    s_add_u32 m0, s19, 59520
    v_mfma_f32_16x16x32_bf16 v[80:83], v[24:27], a[164:167], v[80:83]
    buffer_load_dwordx4 v2, s[8:11], s20 offen offset:1920 lds
    s_waitcnt lgkmcnt(6)
    v_mfma_f32_16x16x32_bf16 v[68:71], v[28:31], a[168:171], v[68:71]
    ds_read_b128 v[24:27], v12 offset:51200
    v_mfma_f32_16x16x32_bf16 v[76:79], v[28:31], a[172:175], v[76:79]
    s_add_u32 s20, s20, s24
    s_waitcnt lgkmcnt(6)
    v_mfma_f32_16x16x32_bf16 v[72:75], v[32:35], a[168:171], v[72:75]
    ds_read_b128 v[28:31], v13 offset:49152
    v_mfma_f32_16x16x32_bf16 v[80:83], v[32:35], a[172:175], v[80:83]
    s_waitcnt lgkmcnt(6)
    v_mfma_f32_16x16x32_bf16 v[68:71], v[36:39], a[176:179], v[68:71]
    ds_read_b128 v[32:35], v13 offset:51200
    v_mfma_f32_16x16x32_bf16 v[76:79], v[36:39], a[180:183], v[76:79]
    s_waitcnt lgkmcnt(6)
    v_mfma_f32_16x16x32_bf16 v[72:75], v[40:43], a[176:179], v[72:75]
    ds_read_b128 v[36:39], v12 offset:53248
    v_mfma_f32_16x16x32_bf16 v[80:83], v[40:43], a[180:183], v[80:83]
    s_waitcnt lgkmcnt(6)
    v_mfma_f32_16x16x32_bf16 v[68:71], v[44:47], a[184:187], v[68:71]
    ds_read_b128 v[40:43], v12 offset:55296
    v_mfma_f32_16x16x32_bf16 v[76:79], v[44:47], a[188:191], v[76:79]
    s_waitcnt lgkmcnt(6)
    v_mfma_f32_16x16x32_bf16 v[72:75], v[48:51], a[184:187], v[72:75]
    ds_read_b128 v[44:47], v13 offset:53248
    v_mfma_f32_16x16x32_bf16 v[80:83], v[48:51], a[188:191], v[80:83]
    s_waitcnt lgkmcnt(6)
    v_mfma_f32_16x16x32_bf16 v[68:71], v[20:23], a[192:195], v[68:71]
    ds_read_b128 v[48:51], v13 offset:55296
    v_mfma_f32_16x16x32_bf16 v[76:79], v[20:23], a[196:199], v[76:79]
    s_waitcnt lgkmcnt(6)
    v_mfma_f32_16x16x32_bf16 v[72:75], v[24:27], a[192:195], v[72:75]
    ds_read_b128 v[20:23], v12 offset:57344
    v_mfma_f32_16x16x32_bf16 v[80:83], v[24:27], a[196:199], v[80:83]
    s_waitcnt lgkmcnt(6)
    v_mfma_f32_16x16x32_bf16 v[68:71], v[28:31], a[200:203], v[68:71]
    ds_read_b128 v[24:27], v12 offset:59392
    v_mfma_f32_16x16x32_bf16 v[76:79], v[28:31], a[204:207], v[76:79]
    s_waitcnt lgkmcnt(6)
    v_mfma_f32_16x16x32_bf16 v[72:75], v[32:35], a[200:203], v[72:75]
    ds_read_b128 v[28:31], v13 offset:57344
    v_mfma_f32_16x16x32_bf16 v[80:83], v[32:35], a[204:207], v[80:83]
    s_waitcnt lgkmcnt(6)
    v_mfma_f32_16x16x32_bf16 v[68:71], v[36:39], a[208:211], v[68:71]
    ds_read_b128 v[32:35], v13 offset:59392
    v_mfma_f32_16x16x32_bf16 v[76:79], v[36:39], a[212:215], v[76:79]
    s_waitcnt lgkmcnt(6)
    v_mfma_f32_16x16x32_bf16 v[72:75], v[40:43], a[208:211], v[72:75]
    ds_read_b128 v[36:39], v12 offset:61440
    v_mfma_f32_16x16x32_bf16 v[80:83], v[40:43], a[212:215], v[80:83]
    s_waitcnt lgkmcnt(6)
    v_mfma_f32_16x16x32_bf16 v[68:71], v[44:47], a[216:219], v[68:71]
    ds_read_b128 v[40:43], v12 offset:63488
    v_mfma_f32_16x16x32_bf16 v[76:79], v[44:47], a[220:223], v[76:79]
    s_waitcnt lgkmcnt(6)
    v_mfma_f32_16x16x32_bf16 v[72:75], v[48:51], a[216:219], v[72:75]
    ds_read_b128 v[44:47], v13 offset:61440
    v_mfma_f32_16x16x32_bf16 v[80:83], v[48:51], a[220:223], v[80:83]
    s_waitcnt lgkmcnt(6)
    v_mfma_f32_16x16x32_bf16 v[68:71], v[20:23], a[224:227], v[68:71]
    ds_read_b128 v[48:51], v13 offset:63488
    v_mfma_f32_16x16x32_bf16 v[76:79], v[20:23], a[228:231], v[76:79]
    s_waitcnt lgkmcnt(6)
    v_mfma_f32_16x16x32_bf16 v[72:75], v[24:27], a[224:227], v[72:75]
    s_waitcnt vmcnt(8)
    s_barrier
    ds_read_b128 v[20:23], v10 offset:0
    v_mfma_f32_16x16x32_bf16 v[80:83], v[24:27], a[228:231], v[80:83]
    s_waitcnt lgkmcnt(6)
    v_mfma_f32_16x16x32_bf16 v[68:71], v[28:31], a[232:235], v[68:71]
    ds_read_b128 v[24:27], v10 offset:2048
    s_add_u32 m0, s19, 65536
    v_mfma_f32_16x16x32_bf16 v[76:79], v[28:31], a[236:239], v[76:79]
    buffer_load_dwordx4 v2, s[8:11], s20 offen offset:0 lds
    s_waitcnt lgkmcnt(6)
    v_mfma_f32_16x16x32_bf16 v[72:75], v[32:35], a[232:235], v[72:75]
    ds_read_b128 v[28:31], v11 offset:0
    v_mfma_f32_16x16x32_bf16 v[80:83], v[32:35], a[236:239], v[80:83]
    s_waitcnt lgkmcnt(6)
    v_mfma_f32_16x16x32_bf16 v[68:71], v[36:39], a[240:243], v[68:71]
    ds_read_b128 v[32:35], v11 offset:2048
    s_add_u32 m0, s19, 69504
    v_mfma_f32_16x16x32_bf16 v[76:79], v[36:39], a[244:247], v[76:79]
    buffer_load_dwordx4 v2, s[8:11], s20 offen offset:128 lds
    s_waitcnt lgkmcnt(6)
    v_mfma_f32_16x16x32_bf16 v[72:75], v[40:43], a[240:243], v[72:75]
    ds_read_b128 v[36:39], v10 offset:4096
    v_mfma_f32_16x16x32_bf16 v[80:83], v[40:43], a[244:247], v[80:83]
    s_waitcnt lgkmcnt(6)
    v_mfma_f32_16x16x32_bf16 v[68:71], v[44:47], a[248:251], v[68:71]
    ds_read_b128 v[40:43], v10 offset:6144
    s_add_u32 m0, s19, 73472
    v_mfma_f32_16x16x32_bf16 v[76:79], v[44:47], a[252:255], v[76:79]
    buffer_load_dwordx4 v2, s[8:11], s20 offen offset:256 lds
    s_waitcnt lgkmcnt(6)
    v_mfma_f32_16x16x32_bf16 v[72:75], v[48:51], a[248:251], v[72:75]
    ds_read_b128 v[44:47], v11 offset:4096
    v_mfma_f32_16x16x32_bf16 v[80:83], v[48:51], a[252:255], v[80:83]
    s_add_u32 s22, s22, 2
    s_cmp_lt_u32 s22, 16
    s_cbranch_scc1 F1_top
    v_cvt_pk_bf16_f32 v84, v68, v69
    v_cvt_pk_bf16_f32 v85, v70, v71
    s_nop 0
    v_cvt_pk_bf16_f32 v86, v72, v73
    v_cvt_pk_bf16_f32 v87, v74, v75
    v_cvt_pk_bf16_f32 v88, v76, v77
    v_cvt_pk_bf16_f32 v89, v78, v79
    v_cvt_pk_bf16_f32 v90, v80, v81
    v_cvt_pk_bf16_f32 v91, v82, v83
    buffer_store_dwordx4 v[84:87], v3, s[4:7], s21 offen offset:0 sc1
    buffer_store_dwordx4 v[88:91], v3, s[4:7], s21 offen offset:256 sc1
    s_waitcnt vmcnt(0) lgkmcnt(0)
    v_lshlrev_b32 v5, 2, v1
    s_mov_b32 s18, 0
rdv_17:
    global_load_dword v6, v5, s[100:101] sc1
    s_waitcnt vmcnt(0)
rdv_17p:
    s_lshl_b32 s17, s98, 2
    v_lshrrev_b32 v9, s17, v6
    s_cmp_eq_u32 s98, 0
    s_cselect_b32 s17, 0x0f0f0f0f, s17
    s_cselect_b32 s17, s17, 0x01010101
    v_and_b32 v9, s17, v9
    v_cmp_ne_u32 vcc, 0x01010101, v9
    s_nop 0
    s_cbranch_vccz rdvok_18
    v_sad_u8 v9, v9, 0, 0
    s_nop 1
    v_add_u32_dpp v9, v9, v9 quad_perm:[1,0,3,2] row_mask:0xf bank_mask:0xf
    v_cmp_ne_u32 vcc, 8, v9
    s_nop 0
    s_cbranch_vccnz rdvw_19
    s_mov_b32 s98, 1
    s_and_b32 s3, s97, 7
    s_waitcnt vmcnt(0) lgkmcnt(0)
    s_barrier
    s_branch role_start
rdvw_19:
    s_sleep 4
    s_add_u32 s18, s18, 1
    s_cmp_lt_u32 s18, 262144
    s_cbranch_scc1 rdv_17
    s_mov_b32 s92, 1048576
rdvok_18:
    v_and_b32 v9, 0x40404040, v6
    v_bcnt_u32_b32 v9, v9, 0
    s_mov_b32 s89, 0
    v_cmp_le_u32 vcc, 1, v9
    s_nop 0
    s_bcnt1_i32_b64 s17, vcc
    s_add_u32 s89, s89, s17
    v_cmp_le_u32 vcc, 2, v9
    s_nop 0
    s_bcnt1_i32_b64 s17, vcc
    s_add_u32 s89, s89, s17
    v_cmp_le_u32 vcc, 3, v9
    s_nop 0
    s_bcnt1_i32_b64 s17, vcc
    s_add_u32 s89, s89, s17
    v_cmp_le_u32 vcc, 4, v9
    s_nop 0
    s_bcnt1_i32_b64 s17, vcc
    s_add_u32 s89, s89, s17
    s_cmp_gt_u32 s89, 16
    s_cselect_b32 s89, 8192, 0
    s_barrier
    s_lshl_b32 s31, s29, 2
    s_add_u32 s31, s31, s28
    s_lshl_b32 s17, s31, 7
    s_add_u32 s17, s17, 100745216
    v_lshl_add_u32 v5, v1, 2, s17
    v_mov_b32 v6, 1
    s_mov_b64 exec, 0xffffffff
    buffer_store_dword v6, v5, s[4:7], 0 offen sc1
    s_mov_b64 exec, -1
    v_and_b32 v10, 19, v1
    v_bfe_u32 v5, v1, 2, 1
    v_bfe_u32 v6, v1, 3, 1
    v_lshl_add_u32 v10, v5, 3, v10
    v_lshl_add_u32 v10, v6, 2, v10
    v_lshrrev_b32 v8, 1, v1
    v_and_b32 v19, 19, v8
    v_bfe_u32 v5, v8, 2, 1
    v_bfe_u32 v6, v8, 3, 1
    v_lshl_add_u32 v19, v5, 3, v19
    v_lshl_add_u32 v19, v6, 2, v19
    s_load_dwordx2 s[12:13], s[0:1], 80
    s_mov_b32 s14, 8388608
    s_mov_b32 s15, 0x20000
    v_lshrrev_b32 v11, 5, v1
    v_lshl_add_u32 v12, v11, 9, v10
    v_mul_u32_u24 v12, 1026, v12
    v_and_b32 v13, 1, v1
    v_lshlrev_b32 v13, 4, v13
    v_lshlrev_b32 v14, 4, v1
    s_lshr_b32 s17, s16, 1
    s_and_b32 s18, s16, 1
    s_lshl_b32 s17, s17, 5
    s_lshl_b32 s18, s18, 10
    s_add_u32 s17, s17, s18
    s_mul_i32 s20, s17, 1026
    s_lshl_b32 s17, s93, 5
    s_add_u32 s20, s20, s17
    v_mul_u32_u24 v19, 1026, v19
    v_add_u32 v19, v19, v13
    s_mov_b32 s32, 0x05040100
    s_mov_b32 s33, 0x07060302
    v_cvt_f32_u32 v16, v10
    v_lshlrev_b32 v17, 3, v11
    v_cvt_f32_u32 v17, v17
    s_add_u32 s17, s20, 0
    buffer_load_dwordx4 v[60:63], v19, s[48:51], s17 offen
    v_add_f32 v5, 0, v16
    v_mul_f32 v5, 1015021568, v5
    v_mul_f32 v6, v5, v17
    v_mul_f32 v7, 0x41800000, v5
    v_fract_f32 v32, v6
    v_add_f32 v33, v32, v5
    v_add_f32 v34, v33, v5
    v_add_f32 v35, v34, v5
    v_add_f32 v36, v35, v5
    v_add_f32 v37, v36, v5
    v_add_f32 v38, v37, v5
    v_add_f32 v39, v38, v5
    v_add_f32 v6, v32, v7
    v_cos_f32 v40, v32
    v_sin_f32 v48, v32
    v_cos_f32 v41, v33
    buffer_load_dwordx4 v[64:67], v19, s[52:55], s17 offen
    v_sin_f32 v49, v33
    v_cos_f32 v42, v34
    v_sin_f32 v50, v34
    v_cos_f32 v43, v35
    v_sin_f32 v51, v35
    v_cos_f32 v44, v36
    v_sin_f32 v52, v36
    v_cos_f32 v45, v37
    v_sin_f32 v53, v37
    v_cos_f32 v46, v38
    v_sin_f32 v54, v38
    v_cos_f32 v47, v39
    v_sin_f32 v55, v39
    v_cvt_pk_bf16_f32 v56, v40, v41
    v_cvt_pk_bf16_f32 v57, v48, v49
    v_accvgpr_write_b32 a0, v56
    v_xor_b32 v58, 0x80008000, v57
    s_add_u32 s17, s20, 131328
    buffer_load_dwordx4 v[68:71], v19, s[48:51], s17 offen
    v_accvgpr_write_b32 a32, v57
    v_accvgpr_write_b32 a64, v58
    v_cvt_pk_bf16_f32 v56, v42, v43
    v_cvt_pk_bf16_f32 v57, v50, v51
    v_accvgpr_write_b32 a1, v56
    v_xor_b32 v58, 0x80008000, v57
    v_accvgpr_write_b32 a33, v57
    v_accvgpr_write_b32 a65, v58
    v_cvt_pk_bf16_f32 v56, v44, v45
    v_cvt_pk_bf16_f32 v57, v52, v53
    v_accvgpr_write_b32 a2, v56
    v_xor_b32 v58, 0x80008000, v57
    v_accvgpr_write_b32 a34, v57
    v_accvgpr_write_b32 a66, v58
    v_cvt_pk_bf16_f32 v56, v46, v47
    v_cvt_pk_bf16_f32 v57, v54, v55
    v_accvgpr_write_b32 a3, v56
    buffer_load_dwordx4 v[72:75], v19, s[52:55], s17 offen
    v_xor_b32 v58, 0x80008000, v57
    v_accvgpr_write_b32 a35, v57
    v_accvgpr_write_b32 a67, v58
    v_fract_f32 v32, v6
    v_add_f32 v33, v32, v5
    v_add_f32 v34, v33, v5
    v_add_f32 v35, v34, v5
    v_add_f32 v36, v35, v5
    v_add_f32 v37, v36, v5
    v_add_f32 v38, v37, v5
    v_add_f32 v39, v38, v5
    v_add_f32 v6, v32, v7
    v_cos_f32 v40, v32
    v_sin_f32 v48, v32
    v_cos_f32 v41, v33
    v_sin_f32 v49, v33
    s_add_u32 s17, s20, 262656
    buffer_load_dwordx4 v[76:79], v19, s[48:51], s17 offen
    v_cos_f32 v42, v34
    v_sin_f32 v50, v34
    v_cos_f32 v43, v35
    v_sin_f32 v51, v35
    v_cos_f32 v44, v36
    v_sin_f32 v52, v36
    v_cos_f32 v45, v37
    v_sin_f32 v53, v37
    v_cos_f32 v46, v38
    v_sin_f32 v54, v38
    v_cos_f32 v47, v39
    v_sin_f32 v55, v39
    v_cvt_pk_bf16_f32 v56, v40, v41
    v_cvt_pk_bf16_f32 v57, v48, v49
    v_accvgpr_write_b32 a4, v56
    v_xor_b32 v58, 0x80008000, v57
    v_accvgpr_write_b32 a36, v57
    buffer_load_dwordx4 v[80:83], v19, s[52:55], s17 offen
    v_accvgpr_write_b32 a68, v58
    v_cvt_pk_bf16_f32 v56, v42, v43
    v_cvt_pk_bf16_f32 v57, v50, v51
    v_accvgpr_write_b32 a5, v56
    v_xor_b32 v58, 0x80008000, v57
    v_accvgpr_write_b32 a37, v57
    v_accvgpr_write_b32 a69, v58
    v_cvt_pk_bf16_f32 v56, v44, v45
    v_cvt_pk_bf16_f32 v57, v52, v53
    v_accvgpr_write_b32 a6, v56
    v_xor_b32 v58, 0x80008000, v57
    v_accvgpr_write_b32 a38, v57
    v_accvgpr_write_b32 a70, v58
    v_cvt_pk_bf16_f32 v56, v46, v47
    v_cvt_pk_bf16_f32 v57, v54, v55
    v_accvgpr_write_b32 a7, v56
    v_xor_b32 v58, 0x80008000, v57
    s_add_u32 s17, s20, 393984
    buffer_load_dwordx4 v[84:87], v19, s[48:51], s17 offen
    v_accvgpr_write_b32 a39, v57
    v_accvgpr_write_b32 a71, v58
    v_fract_f32 v32, v6
    v_add_f32 v33, v32, v5
    v_add_f32 v34, v33, v5
    v_add_f32 v35, v34, v5
    v_add_f32 v36, v35, v5
    v_add_f32 v37, v36, v5
    v_add_f32 v38, v37, v5
    v_add_f32 v39, v38, v5
    v_add_f32 v6, v32, v7
    v_cos_f32 v40, v32
    v_sin_f32 v48, v32
    v_cos_f32 v41, v33
    v_sin_f32 v49, v33
    v_cos_f32 v42, v34
    buffer_load_dwordx4 v[88:91], v19, s[52:55], s17 offen
    v_sin_f32 v50, v34
    v_cos_f32 v43, v35
    v_sin_f32 v51, v35
    v_cos_f32 v44, v36
    v_sin_f32 v52, v36
    v_cos_f32 v45, v37
    v_sin_f32 v53, v37
    v_cos_f32 v46, v38
    v_sin_f32 v54, v38
    v_cos_f32 v47, v39
    v_sin_f32 v55, v39
    v_cvt_pk_bf16_f32 v56, v40, v41
    v_cvt_pk_bf16_f32 v57, v48, v49
    v_accvgpr_write_b32 a8, v56
    v_xor_b32 v58, 0x80008000, v57
    v_accvgpr_write_b32 a40, v57
    v_accvgpr_write_b32 a72, v58
    s_add_u32 s17, s20, 525312
    buffer_load_dwordx4 v[92:95], v19, s[48:51], s17 offen
    v_cvt_pk_bf16_f32 v56, v42, v43
    v_cvt_pk_bf16_f32 v57, v50, v51
    v_accvgpr_write_b32 a9, v56
    v_xor_b32 v58, 0x80008000, v57
    v_accvgpr_write_b32 a41, v57
    v_accvgpr_write_b32 a73, v58
    v_cvt_pk_bf16_f32 v56, v44, v45
    v_cvt_pk_bf16_f32 v57, v52, v53
    v_accvgpr_write_b32 a10, v56
    v_xor_b32 v58, 0x80008000, v57
    v_accvgpr_write_b32 a42, v57
    v_accvgpr_write_b32 a74, v58
    v_cvt_pk_bf16_f32 v56, v46, v47
    v_cvt_pk_bf16_f32 v57, v54, v55
    v_accvgpr_write_b32 a11, v56
    v_xor_b32 v58, 0x80008000, v57
    v_accvgpr_write_b32 a43, v57
    buffer_load_dwordx4 v[96:99], v19, s[52:55], s17 offen
    v_accvgpr_write_b32 a75, v58
    v_fract_f32 v32, v6
    v_add_f32 v33, v32, v5
    v_add_f32 v34, v33, v5
    v_add_f32 v35, v34, v5
    v_add_f32 v36, v35, v5
    v_add_f32 v37, v36, v5
    v_add_f32 v38, v37, v5
    v_add_f32 v39, v38, v5
    v_add_f32 v6, v32, v7
    v_cos_f32 v40, v32
    v_sin_f32 v48, v32
    v_cos_f32 v41, v33
    v_sin_f32 v49, v33
    v_cos_f32 v42, v34
    v_sin_f32 v50, v34
    s_add_u32 s17, s20, 656640
    buffer_load_dwordx4 v[100:103], v19, s[48:51], s17 offen
    v_cos_f32 v43, v35
    v_sin_f32 v51, v35
    v_cos_f32 v44, v36
    v_sin_f32 v52, v36
    v_cos_f32 v45, v37
    v_sin_f32 v53, v37
    v_cos_f32 v46, v38
    v_sin_f32 v54, v38
    v_cos_f32 v47, v39
    v_sin_f32 v55, v39
    v_cvt_pk_bf16_f32 v56, v40, v41
    v_cvt_pk_bf16_f32 v57, v48, v49
    v_accvgpr_write_b32 a12, v56
    v_xor_b32 v58, 0x80008000, v57
    v_accvgpr_write_b32 a44, v57
    v_accvgpr_write_b32 a76, v58
    v_cvt_pk_bf16_f32 v56, v42, v43
    buffer_load_dwordx4 v[104:107], v19, s[52:55], s17 offen
    v_cvt_pk_bf16_f32 v57, v50, v51
    v_accvgpr_write_b32 a13, v56
    v_xor_b32 v58, 0x80008000, v57
    v_accvgpr_write_b32 a45, v57
    v_accvgpr_write_b32 a77, v58
    v_cvt_pk_bf16_f32 v56, v44, v45
    v_cvt_pk_bf16_f32 v57, v52, v53
    v_accvgpr_write_b32 a14, v56
    v_xor_b32 v58, 0x80008000, v57
    v_accvgpr_write_b32 a46, v57
    v_accvgpr_write_b32 a78, v58
    v_cvt_pk_bf16_f32 v56, v46, v47
    v_cvt_pk_bf16_f32 v57, v54, v55
    v_accvgpr_write_b32 a15, v56
    v_xor_b32 v58, 0x80008000, v57
    v_accvgpr_write_b32 a47, v57
    v_accvgpr_write_b32 a79, v58
    s_add_u32 s17, s20, 787968
    buffer_load_dwordx4 v[108:111], v19, s[48:51], s17 offen
    v_add_f32 v5, 1107296256, v16
    v_mul_f32 v5, 1015021568, v5
    v_mul_f32 v6, v5, v17
    v_mul_f32 v7, 0x41800000, v5
    v_fract_f32 v32, v6
    v_add_f32 v33, v32, v5
    v_add_f32 v34, v33, v5
    v_add_f32 v35, v34, v5
    v_add_f32 v36, v35, v5
    v_add_f32 v37, v36, v5
    v_add_f32 v38, v37, v5
    v_add_f32 v39, v38, v5
    v_add_f32 v6, v32, v7
    v_cos_f32 v40, v32
    v_sin_f32 v48, v32
    v_cos_f32 v41, v33
    buffer_load_dwordx4 v[112:115], v19, s[52:55], s17 offen
    v_sin_f32 v49, v33
    v_cos_f32 v42, v34
    v_sin_f32 v50, v34
    v_cos_f32 v43, v35
    v_sin_f32 v51, v35
    v_cos_f32 v44, v36
    v_sin_f32 v52, v36
    v_cos_f32 v45, v37
    v_sin_f32 v53, v37
    v_cos_f32 v46, v38
    v_sin_f32 v54, v38
    v_cos_f32 v47, v39
    v_sin_f32 v55, v39
    v_cvt_pk_bf16_f32 v56, v40, v41
    v_cvt_pk_bf16_f32 v57, v48, v49
    v_accvgpr_write_b32 a16, v56
    v_xor_b32 v58, 0x80008000, v57
    s_add_u32 s17, s20, 919296
    buffer_load_dwordx4 v[116:119], v19, s[48:51], s17 offen
    v_accvgpr_write_b32 a48, v57
    v_accvgpr_write_b32 a80, v58
    v_cvt_pk_bf16_f32 v56, v42, v43
    v_cvt_pk_bf16_f32 v57, v50, v51
    v_accvgpr_write_b32 a17, v56
    v_xor_b32 v58, 0x80008000, v57
    v_accvgpr_write_b32 a49, v57
    v_accvgpr_write_b32 a81, v58
    v_cvt_pk_bf16_f32 v56, v44, v45
    v_cvt_pk_bf16_f32 v57, v52, v53
    v_accvgpr_write_b32 a18, v56
    v_xor_b32 v58, 0x80008000, v57
    v_accvgpr_write_b32 a50, v57
    v_accvgpr_write_b32 a82, v58
    v_cvt_pk_bf16_f32 v56, v46, v47
    v_cvt_pk_bf16_f32 v57, v54, v55
    v_accvgpr_write_b32 a19, v56
    buffer_load_dwordx4 v[120:123], v19, s[52:55], s17 offen
    v_xor_b32 v58, 0x80008000, v57
    v_accvgpr_write_b32 a51, v57
    v_accvgpr_write_b32 a83, v58
    v_fract_f32 v32, v6
    v_add_f32 v33, v32, v5
    v_add_f32 v34, v33, v5
    v_add_f32 v35, v34, v5
    v_add_f32 v36, v35, v5
    v_add_f32 v37, v36, v5
    v_add_f32 v38, v37, v5
    v_add_f32 v39, v38, v5
    v_add_f32 v6, v32, v7
    v_cos_f32 v40, v32
    v_sin_f32 v48, v32
    v_cos_f32 v41, v33
    v_sin_f32 v49, v33
    v_cos_f32 v42, v34
    s_add_u32 s17, s20, 65664
    buffer_load_dwordx4 v[124:127], v19, s[48:51], s17 offen
    v_sin_f32 v50, v34
    v_cos_f32 v43, v35
    v_sin_f32 v51, v35
    v_cos_f32 v44, v36
    v_sin_f32 v52, v36
    v_cos_f32 v45, v37
    v_sin_f32 v53, v37
    v_cos_f32 v46, v38
    v_sin_f32 v54, v38
    v_cos_f32 v47, v39
    v_sin_f32 v55, v39
    v_cvt_pk_bf16_f32 v56, v40, v41
    v_cvt_pk_bf16_f32 v57, v48, v49
    v_accvgpr_write_b32 a20, v56
    v_xor_b32 v58, 0x80008000, v57
    v_accvgpr_write_b32 a52, v57
    buffer_load_dwordx4 v[128:131], v19, s[52:55], s17 offen
    v_accvgpr_write_b32 a84, v58
    v_cvt_pk_bf16_f32 v56, v42, v43
    v_cvt_pk_bf16_f32 v57, v50, v51
    v_accvgpr_write_b32 a21, v56
    v_xor_b32 v58, 0x80008000, v57
    v_accvgpr_write_b32 a53, v57
    v_accvgpr_write_b32 a85, v58
    v_cvt_pk_bf16_f32 v56, v44, v45
    v_cvt_pk_bf16_f32 v57, v52, v53
    v_accvgpr_write_b32 a22, v56
    v_xor_b32 v58, 0x80008000, v57
    v_accvgpr_write_b32 a54, v57
    v_accvgpr_write_b32 a86, v58
    v_cvt_pk_bf16_f32 v56, v46, v47
    v_cvt_pk_bf16_f32 v57, v54, v55
    v_accvgpr_write_b32 a23, v56
    v_xor_b32 v58, 0x80008000, v57
    s_add_u32 s17, s20, 196992
    buffer_load_dwordx4 v[132:135], v19, s[48:51], s17 offen
    v_accvgpr_write_b32 a55, v57
    v_accvgpr_write_b32 a87, v58
    v_fract_f32 v32, v6
    v_add_f32 v33, v32, v5
    v_add_f32 v34, v33, v5
    v_add_f32 v35, v34, v5
    v_add_f32 v36, v35, v5
    v_add_f32 v37, v36, v5
    v_add_f32 v38, v37, v5
    v_add_f32 v39, v38, v5
    v_add_f32 v6, v32, v7
    v_cos_f32 v40, v32
    v_sin_f32 v48, v32
    v_cos_f32 v41, v33
    v_sin_f32 v49, v33
    v_cos_f32 v42, v34
    v_sin_f32 v50, v34
    buffer_load_dwordx4 v[136:139], v19, s[52:55], s17 offen
    v_cos_f32 v43, v35
    v_sin_f32 v51, v35
    v_cos_f32 v44, v36
    v_sin_f32 v52, v36
    v_cos_f32 v45, v37
    v_sin_f32 v53, v37
    v_cos_f32 v46, v38
    v_sin_f32 v54, v38
    v_cos_f32 v47, v39
    v_sin_f32 v55, v39
    v_cvt_pk_bf16_f32 v56, v40, v41
    v_cvt_pk_bf16_f32 v57, v48, v49
    v_accvgpr_write_b32 a24, v56
    v_xor_b32 v58, 0x80008000, v57
    v_accvgpr_write_b32 a56, v57
    v_accvgpr_write_b32 a88, v58
    s_add_u32 s17, s20, 328320
    buffer_load_dwordx4 v[140:143], v19, s[48:51], s17 offen
    v_cvt_pk_bf16_f32 v56, v42, v43
    v_cvt_pk_bf16_f32 v57, v50, v51
    v_accvgpr_write_b32 a25, v56
    v_xor_b32 v58, 0x80008000, v57
    v_accvgpr_write_b32 a57, v57
    v_accvgpr_write_b32 a89, v58
    v_cvt_pk_bf16_f32 v56, v44, v45
    v_cvt_pk_bf16_f32 v57, v52, v53
    v_accvgpr_write_b32 a26, v56
    v_xor_b32 v58, 0x80008000, v57
    v_accvgpr_write_b32 a58, v57
    v_accvgpr_write_b32 a90, v58
    v_cvt_pk_bf16_f32 v56, v46, v47
    v_cvt_pk_bf16_f32 v57, v54, v55
    v_accvgpr_write_b32 a27, v56
    v_xor_b32 v58, 0x80008000, v57
    v_accvgpr_write_b32 a59, v57
    buffer_load_dwordx4 v[144:147], v19, s[52:55], s17 offen
    v_accvgpr_write_b32 a91, v58
    v_fract_f32 v32, v6
    v_add_f32 v33, v32, v5
    v_add_f32 v34, v33, v5
    v_add_f32 v35, v34, v5
    v_add_f32 v36, v35, v5
    v_add_f32 v37, v36, v5
    v_add_f32 v38, v37, v5
    v_add_f32 v39, v38, v5
    v_add_f32 v6, v32, v7
    v_cos_f32 v40, v32
    v_sin_f32 v48, v32
    v_cos_f32 v41, v33
    v_sin_f32 v49, v33
    v_cos_f32 v42, v34
    v_sin_f32 v50, v34
    v_cos_f32 v43, v35
    s_add_u32 s17, s20, 459648
    buffer_load_dwordx4 v[148:151], v19, s[48:51], s17 offen
    v_sin_f32 v51, v35
    v_cos_f32 v44, v36
    v_sin_f32 v52, v36
    v_cos_f32 v45, v37
    v_sin_f32 v53, v37
    v_cos_f32 v46, v38
    v_sin_f32 v54, v38
    v_cos_f32 v47, v39
    v_sin_f32 v55, v39
    v_cvt_pk_bf16_f32 v56, v40, v41
    v_cvt_pk_bf16_f32 v57, v48, v49
    v_accvgpr_write_b32 a28, v56
    v_xor_b32 v58, 0x80008000, v57
    v_accvgpr_write_b32 a60, v57
    v_accvgpr_write_b32 a92, v58
    v_cvt_pk_bf16_f32 v56, v42, v43
    buffer_load_dwordx4 v[152:155], v19, s[52:55], s17 offen
    v_cvt_pk_bf16_f32 v57, v50, v51
    v_accvgpr_write_b32 a29, v56
    v_xor_b32 v58, 0x80008000, v57
    v_accvgpr_write_b32 a61, v57
    v_accvgpr_write_b32 a93, v58
    v_cvt_pk_bf16_f32 v56, v44, v45
    v_cvt_pk_bf16_f32 v57, v52, v53
    v_accvgpr_write_b32 a30, v56
    v_xor_b32 v58, 0x80008000, v57
    v_accvgpr_write_b32 a62, v57
    v_accvgpr_write_b32 a94, v58
    v_cvt_pk_bf16_f32 v56, v46, v47
    v_cvt_pk_bf16_f32 v57, v54, v55
    v_accvgpr_write_b32 a31, v56
    v_xor_b32 v58, 0x80008000, v57
    v_accvgpr_write_b32 a63, v57
    v_accvgpr_write_b32 a95, v58
    s_add_u32 s17, s20, 590976
    buffer_load_dwordx4 v[156:159], v19, s[48:51], s17 offen
    v_add_f32 v5, 0, v16
    v_mul_f32 v5, 1023410176, v5
    v_mul_f32 v6, v5, v17
    v_mul_f32 v7, 0x41800000, v5
    v_fract_f32 v32, v6
    v_add_f32 v33, v32, v5
    v_add_f32 v34, v33, v5
    v_add_f32 v35, v34, v5
    v_add_f32 v36, v35, v5
    v_add_f32 v37, v36, v5
    v_add_f32 v38, v37, v5
    v_add_f32 v39, v38, v5
    v_add_f32 v6, v32, v7
    v_cos_f32 v40, v32
    v_sin_f32 v48, v32
    v_cos_f32 v41, v33
    v_sin_f32 v49, v33
    buffer_load_dwordx4 v[160:163], v19, s[52:55], s17 offen
    v_cos_f32 v42, v34
    v_sin_f32 v50, v34
    v_cos_f32 v43, v35
    v_sin_f32 v51, v35
    v_cos_f32 v44, v36
    v_sin_f32 v52, v36
    v_cos_f32 v45, v37
    v_sin_f32 v53, v37
    v_cos_f32 v46, v38
    v_sin_f32 v54, v38
    v_cos_f32 v47, v39
    v_sin_f32 v55, v39
    v_mul_f32 v40, 981467136, v40
    v_mul_f32 v41, 981467136, v41
    v_mul_f32 v42, 981467136, v42
    v_mul_f32 v43, 981467136, v43
    s_add_u32 s17, s20, 722304
    buffer_load_dwordx4 v[164:167], v19, s[48:51], s17 offen
    v_mul_f32 v44, 981467136, v44
    v_mul_f32 v45, 981467136, v45
    v_mul_f32 v46, 981467136, v46
    v_mul_f32 v47, 981467136, v47
    v_mul_f32 v48, 981467136, v48
    v_mul_f32 v49, 981467136, v49
    v_mul_f32 v50, 981467136, v50
    v_mul_f32 v51, 981467136, v51
    v_mul_f32 v52, 981467136, v52
    v_mul_f32 v53, 981467136, v53
    v_mul_f32 v54, 981467136, v54
    v_mul_f32 v55, 981467136, v55
    v_cvt_pk_bf16_f32 v56, v40, v41
    v_cvt_pk_bf16_f32 v57, v48, v49
    v_accvgpr_write_b32 a96, v56
    v_xor_b32 v58, 0x80008000, v57
    v_accvgpr_write_b32 a104, v57
    buffer_load_dwordx4 v[168:171], v19, s[52:55], s17 offen
    v_accvgpr_write_b32 a112, v58
    v_cvt_pk_bf16_f32 v56, v42, v43
    v_cvt_pk_bf16_f32 v57, v50, v51
    v_accvgpr_write_b32 a97, v56
    v_xor_b32 v58, 0x80008000, v57
    v_accvgpr_write_b32 a105, v57
    v_accvgpr_write_b32 a113, v58
    v_cvt_pk_bf16_f32 v56, v44, v45
    v_cvt_pk_bf16_f32 v57, v52, v53
    v_accvgpr_write_b32 a98, v56
    v_xor_b32 v58, 0x80008000, v57
    v_accvgpr_write_b32 a106, v57
    v_accvgpr_write_b32 a114, v58
    v_cvt_pk_bf16_f32 v56, v46, v47
    v_cvt_pk_bf16_f32 v57, v54, v55
    v_accvgpr_write_b32 a99, v56
    v_xor_b32 v58, 0x80008000, v57
    s_add_u32 s17, s20, 853632
    buffer_load_dwordx4 v[172:175], v19, s[48:51], s17 offen
    v_accvgpr_write_b32 a107, v57
    v_accvgpr_write_b32 a115, v58
    v_fract_f32 v32, v6
    v_add_f32 v33, v32, v5
    v_add_f32 v34, v33, v5
    v_add_f32 v35, v34, v5
    v_add_f32 v36, v35, v5
    v_add_f32 v37, v36, v5
    v_add_f32 v38, v37, v5
    v_add_f32 v39, v38, v5
    v_add_f32 v6, v32, v7
    v_cos_f32 v40, v32
    v_sin_f32 v48, v32
    v_cos_f32 v41, v33
    v_sin_f32 v49, v33
    v_cos_f32 v42, v34
    buffer_load_dwordx4 v[176:179], v19, s[52:55], s17 offen
    v_sin_f32 v50, v34
    v_cos_f32 v43, v35
    v_sin_f32 v51, v35
    v_cos_f32 v44, v36
    v_sin_f32 v52, v36
    v_cos_f32 v45, v37
    v_sin_f32 v53, v37
    v_cos_f32 v46, v38
    v_sin_f32 v54, v38
    v_cos_f32 v47, v39
    v_sin_f32 v55, v39
    v_mul_f32 v40, 981467136, v40
    v_mul_f32 v41, 981467136, v41
    v_mul_f32 v42, 981467136, v42
    v_mul_f32 v43, 981467136, v43
    v_mul_f32 v44, 981467136, v44
    v_mul_f32 v45, 981467136, v45
    s_add_u32 s17, s20, 984960
    buffer_load_dwordx4 v[180:183], v19, s[48:51], s17 offen
    v_mul_f32 v46, 981467136, v46
    v_mul_f32 v47, 981467136, v47
    v_mul_f32 v48, 981467136, v48
    v_mul_f32 v49, 981467136, v49
    v_mul_f32 v50, 981467136, v50
    v_mul_f32 v51, 981467136, v51
    v_mul_f32 v52, 981467136, v52
    v_mul_f32 v53, 981467136, v53
    v_mul_f32 v54, 981467136, v54
    v_mul_f32 v55, 981467136, v55
    v_cvt_pk_bf16_f32 v56, v40, v41
    v_cvt_pk_bf16_f32 v57, v48, v49
    v_accvgpr_write_b32 a100, v56
    v_xor_b32 v58, 0x80008000, v57
    v_accvgpr_write_b32 a108, v57
    v_accvgpr_write_b32 a116, v58
    v_cvt_pk_bf16_f32 v56, v42, v43
    buffer_load_dwordx4 v[184:187], v19, s[52:55], s17 offen
    v_cvt_pk_bf16_f32 v57, v50, v51
    v_accvgpr_write_b32 a101, v56
    v_xor_b32 v58, 0x80008000, v57
    v_accvgpr_write_b32 a109, v57
    v_accvgpr_write_b32 a117, v58
    v_cvt_pk_bf16_f32 v56, v44, v45
    v_cvt_pk_bf16_f32 v57, v52, v53
    v_accvgpr_write_b32 a102, v56
    v_xor_b32 v58, 0x80008000, v57
    v_accvgpr_write_b32 a110, v57
    v_accvgpr_write_b32 a118, v58
    v_cvt_pk_bf16_f32 v56, v46, v47
    v_cvt_pk_bf16_f32 v57, v54, v55
    v_accvgpr_write_b32 a103, v56
    v_xor_b32 v58, 0x80008000, v57
    v_accvgpr_write_b32 a111, v57
    v_accvgpr_write_b32 a119, v58
    s_lshl_b32 s17, s16, 11
    v_lshlrev_b32 v5, 12, v13
    v_lshl_add_u32 v5, v8, 4, v5
    v_add_u32 v5, s17, v5
    s_cmp_eq_u32 s16, 0
    s_cselect_b32 s17, 0, 10240
    s_add_u32 s17, s17, 0x20000
    v_add_u32 v13, s17, v14
    s_waitcnt vmcnt(24)
    v_perm_b32 v236, v64, v60, s32
    v_perm_b32 v237, v72, v68, s32
    v_perm_b32 v238, v80, v76, s32
    v_perm_b32 v239, v88, v84, s32
    ds_write_b128 v5, v[236:239] offset:0
    v_perm_b32 v240, v64, v60, s33
    v_perm_b32 v241, v72, v68, s33
    v_perm_b32 v242, v80, v76, s33
    v_perm_b32 v243, v88, v84, s33
    ds_write_b128 v5, v[240:243] offset:8192
    v_perm_b32 v244, v65, v61, s32
    v_perm_b32 v245, v73, v69, s32
    v_perm_b32 v246, v81, v77, s32
    v_perm_b32 v247, v89, v85, s32
    ds_write_b128 v5, v[244:247] offset:16384
    v_perm_b32 v248, v65, v61, s33
    v_perm_b32 v249, v73, v69, s33
    v_perm_b32 v250, v81, v77, s33
    v_perm_b32 v251, v89, v85, s33
    ds_write_b128 v5, v[248:251] offset:24576
    v_perm_b32 v236, v66, v62, s32
    v_perm_b32 v237, v74, v70, s32
    v_perm_b32 v238, v82, v78, s32
    v_perm_b32 v239, v90, v86, s32
    ds_write_b128 v5, v[236:239] offset:32768
    v_perm_b32 v240, v66, v62, s33
    v_perm_b32 v241, v74, v70, s33
    v_perm_b32 v242, v82, v78, s33
    v_perm_b32 v243, v90, v86, s33
    ds_write_b128 v5, v[240:243] offset:40960
    v_perm_b32 v244, v67, v63, s32
    v_perm_b32 v245, v75, v71, s32
    v_perm_b32 v246, v83, v79, s32
    v_perm_b32 v247, v91, v87, s32
    ds_write_b128 v5, v[244:247] offset:49152
    v_perm_b32 v248, v67, v63, s33
    v_perm_b32 v249, v75, v71, s33
    v_perm_b32 v250, v83, v79, s33
    v_perm_b32 v251, v91, v87, s33
    ds_write_b128 v5, v[248:251] offset:57344
    s_waitcnt vmcnt(16)
    v_perm_b32 v236, v96, v92, s32
    v_perm_b32 v237, v104, v100, s32
    v_perm_b32 v238, v112, v108, s32
    v_perm_b32 v239, v120, v116, s32
    ds_write_b128 v5, v[236:239] offset:512
    v_perm_b32 v240, v96, v92, s33
    v_perm_b32 v241, v104, v100, s33
    v_perm_b32 v242, v112, v108, s33
    v_perm_b32 v243, v120, v116, s33
    ds_write_b128 v5, v[240:243] offset:8704
    v_perm_b32 v244, v97, v93, s32
    v_perm_b32 v245, v105, v101, s32
    v_perm_b32 v246, v113, v109, s32
    v_perm_b32 v247, v121, v117, s32
    ds_write_b128 v5, v[244:247] offset:16896
    v_perm_b32 v248, v97, v93, s33
    v_perm_b32 v249, v105, v101, s33
    v_perm_b32 v250, v113, v109, s33
    v_perm_b32 v251, v121, v117, s33
    ds_write_b128 v5, v[248:251] offset:25088
    v_perm_b32 v236, v98, v94, s32
    v_perm_b32 v237, v106, v102, s32
    v_perm_b32 v238, v114, v110, s32
    v_perm_b32 v239, v122, v118, s32
    ds_write_b128 v5, v[236:239] offset:33280
    v_perm_b32 v240, v98, v94, s33
    v_perm_b32 v241, v106, v102, s33
    v_perm_b32 v242, v114, v110, s33
    v_perm_b32 v243, v122, v118, s33
    ds_write_b128 v5, v[240:243] offset:41472
    v_perm_b32 v244, v99, v95, s32
    v_perm_b32 v245, v107, v103, s32
    v_perm_b32 v246, v115, v111, s32
    v_perm_b32 v247, v123, v119, s32
    ds_write_b128 v5, v[244:247] offset:49664
    v_perm_b32 v248, v99, v95, s33
    v_perm_b32 v249, v107, v103, s33
    v_perm_b32 v250, v115, v111, s33
    v_perm_b32 v251, v123, v119, s33
    ds_write_b128 v5, v[248:251] offset:57856
    s_waitcnt vmcnt(8)
    v_perm_b32 v236, v128, v124, s32
    v_perm_b32 v237, v136, v132, s32
    v_perm_b32 v238, v144, v140, s32
    v_perm_b32 v239, v152, v148, s32
    ds_write_b128 v5, v[236:239] offset:1024
    v_perm_b32 v240, v128, v124, s33
    v_perm_b32 v241, v136, v132, s33
    v_perm_b32 v242, v144, v140, s33
    v_perm_b32 v243, v152, v148, s33
    ds_write_b128 v5, v[240:243] offset:9216
    v_perm_b32 v244, v129, v125, s32
    v_perm_b32 v245, v137, v133, s32
    v_perm_b32 v246, v145, v141, s32
    v_perm_b32 v247, v153, v149, s32
    ds_write_b128 v5, v[244:247] offset:17408
    v_perm_b32 v248, v129, v125, s33
    v_perm_b32 v249, v137, v133, s33
    v_perm_b32 v250, v145, v141, s33
    v_perm_b32 v251, v153, v149, s33
    ds_write_b128 v5, v[248:251] offset:25600
    v_perm_b32 v236, v130, v126, s32
    v_perm_b32 v237, v138, v134, s32
    v_perm_b32 v238, v146, v142, s32
    v_perm_b32 v239, v154, v150, s32
    ds_write_b128 v5, v[236:239] offset:33792
    v_perm_b32 v240, v130, v126, s33
    v_perm_b32 v241, v138, v134, s33
    v_perm_b32 v242, v146, v142, s33
    v_perm_b32 v243, v154, v150, s33
    ds_write_b128 v5, v[240:243] offset:41984
    v_perm_b32 v244, v131, v127, s32
    v_perm_b32 v245, v139, v135, s32
    v_perm_b32 v246, v147, v143, s32
    v_perm_b32 v247, v155, v151, s32
    ds_write_b128 v5, v[244:247] offset:50176
    v_perm_b32 v248, v131, v127, s33
    v_perm_b32 v249, v139, v135, s33
    v_perm_b32 v250, v147, v143, s33
    v_perm_b32 v251, v155, v151, s33
    ds_write_b128 v5, v[248:251] offset:58368
    s_waitcnt vmcnt(0)
    v_perm_b32 v236, v160, v156, s32
    v_perm_b32 v237, v168, v164, s32
    v_perm_b32 v238, v176, v172, s32
    v_perm_b32 v239, v184, v180, s32
    ds_write_b128 v5, v[236:239] offset:1536
    v_perm_b32 v240, v160, v156, s33
    v_perm_b32 v241, v168, v164, s33
    v_perm_b32 v242, v176, v172, s33
    v_perm_b32 v243, v184, v180, s33
    ds_write_b128 v5, v[240:243] offset:9728
    v_perm_b32 v244, v161, v157, s32
    v_perm_b32 v245, v169, v165, s32
    v_perm_b32 v246, v177, v173, s32
    v_perm_b32 v247, v185, v181, s32
    ds_write_b128 v5, v[244:247] offset:17920
    v_perm_b32 v248, v161, v157, s33
    v_perm_b32 v249, v169, v165, s33
    v_perm_b32 v250, v177, v173, s33
    v_perm_b32 v251, v185, v181, s33
    ds_write_b128 v5, v[248:251] offset:26112
    v_perm_b32 v236, v162, v158, s32
    v_perm_b32 v237, v170, v166, s32
    v_perm_b32 v238, v178, v174, s32
    v_perm_b32 v239, v186, v182, s32
    ds_write_b128 v5, v[236:239] offset:34304
    v_perm_b32 v240, v162, v158, s33
    v_perm_b32 v241, v170, v166, s33
    v_perm_b32 v242, v178, v174, s33
    v_perm_b32 v243, v186, v182, s33
    ds_write_b128 v5, v[240:243] offset:42496
    v_perm_b32 v244, v163, v159, s32
    v_perm_b32 v245, v171, v167, s32
    v_perm_b32 v246, v179, v175, s32
    v_perm_b32 v247, v187, v183, s32
    ds_write_b128 v5, v[244:247] offset:50688
    v_perm_b32 v248, v163, v159, s33
    v_perm_b32 v249, v171, v167, s33
    v_perm_b32 v250, v179, v175, s33
    v_perm_b32 v251, v187, v183, s33
    ds_write_b128 v5, v[248:251] offset:58880
    v_mul_u32_u24 v15, 2176, v10
    v_lshl_add_u32 v15, v11, 4, v15
    v_lshlrev_b32 v18, 12, v11
    v_lshl_add_u32 v18, v10, 4, v18
    s_mul_i32 s32, s93, 139776
    s_lshl_b32 s17, s16, 9
    s_add_u32 s32, s32, s17
    s_add_u32 s32, s32, 104857600
    s_add_u32 s33, s32, 64
    s_lshl_b32 s31, s93, 2
    s_add_u32 s31, s31, s16
    s_lshl_b32 s35, s16, 15
    s_mov_b32 s38, 0xffff0000
    s_mov_b32 s36, 0
    s_cmp_eq_u32 s31, 0
    s_cselect_b32 s37, 5, 4
    s_cselect_b32 s33, 1073741824, s33
    s_cselect_b32 s34, 1024, 1073741824
    v_and_b32 v8, 3, v1
    v_lshlrev_b32 v8, 7, v8
    s_lshl_b32 s17, s93, 9
    s_add_u32 s17, s17, 100745216
    v_add_u32 v8, s17, v8
    s_waitcnt lgkmcnt(0)
    s_mov_b32 s30, s92
F2_w:
    buffer_load_dword v5, v8, s[4:7], 0 offen sc1
    s_waitcnt vmcnt(0)
    v_cmp_gt_u32 vcc, 1, v5
    s_nop 0
    s_and_b32 s17, vcc_lo, 15
    s_cbranch_scc0 F2_w_ok
    s_cmp_ge_u32 s30, 1048576
    s_cselect_b32 s92, 1048576, s92
    s_cbranch_scc1 F2_w_ok
    s_add_u32 s30, s30, 1
    s_sleep 8
    s_branch F2_w
F2_w_ok:
    buffer_load_dwordx4 v[128:131], v15, s[4:7], s32 offen offset:0
    buffer_load_dwordx4 v[132:135], v15, s[4:7], s32 offen offset:32
    s_add_u32 s17, s32, 69632
    buffer_load_dwordx4 v[136:139], v15, s[4:7], s17 offen offset:0
    buffer_load_dwordx4 v[140:143], v15, s[4:7], s17 offen offset:32
    buffer_load_dwordx4 v[144:147], v15, s[4:7], s33 offen offset:0
    buffer_load_dwordx4 v[148:151], v15, s[4:7], s33 offen offset:32
    s_add_u32 s17, s33, 69632
    buffer_load_dwordx4 v[152:155], v15, s[4:7], s17 offen offset:0
    buffer_load_dwordx4 v[156:159], v15, s[4:7], s17 offen offset:32
    v_add_f32 v5, 0, v16
    v_mul_f32 v5, 973078528, v5
    v_add_f32 v6, 0, v17
    v_mul_f32 v6, v6, v5
    v_cos_f32 v160, v6
    v_sin_f32 v176, v6
    v_add_f32 v6, 1065353216, v17
    v_mul_f32 v6, v6, v5
    v_cos_f32 v161, v6
    v_sin_f32 v177, v6
    v_add_f32 v6, 1073741824, v17
    v_mul_f32 v6, v6, v5
    v_cos_f32 v162, v6
    v_sin_f32 v178, v6
    v_add_f32 v6, 1077936128, v17
    v_mul_f32 v6, v6, v5
    v_cos_f32 v163, v6
    v_sin_f32 v179, v6
    v_add_f32 v6, 1082130432, v17
    v_mul_f32 v6, v6, v5
    v_cos_f32 v164, v6
    v_sin_f32 v180, v6
    v_add_f32 v6, 1084227584, v17
    v_mul_f32 v6, v6, v5
    v_cos_f32 v165, v6
    v_sin_f32 v181, v6
    v_add_f32 v6, 1086324736, v17
    v_mul_f32 v6, v6, v5
    v_cos_f32 v166, v6
    v_sin_f32 v182, v6
    v_add_f32 v6, 1088421888, v17
    v_mul_f32 v6, v6, v5
    v_cos_f32 v167, v6
    v_sin_f32 v183, v6
    v_add_f32 v6, 1098907648, v17
    v_mul_f32 v6, v6, v5
    v_cos_f32 v168, v6
    v_sin_f32 v184, v6
    v_add_f32 v6, 1099431936, v17
    v_mul_f32 v6, v6, v5
    v_cos_f32 v169, v6
    v_sin_f32 v185, v6
    v_add_f32 v6, 1099956224, v17
    v_mul_f32 v6, v6, v5
    v_cos_f32 v170, v6
    v_sin_f32 v186, v6
    v_add_f32 v6, 1100480512, v17
    v_mul_f32 v6, v6, v5
    v_cos_f32 v171, v6
    v_sin_f32 v187, v6
    v_add_f32 v6, 1101004800, v17
    v_mul_f32 v6, v6, v5
    v_cos_f32 v172, v6
    v_sin_f32 v188, v6
    v_add_f32 v6, 1101529088, v17
    v_mul_f32 v6, v6, v5
    v_cos_f32 v173, v6
    v_sin_f32 v189, v6
    v_add_f32 v6, 1102053376, v17
    v_mul_f32 v6, v6, v5
    v_cos_f32 v174, v6
    v_sin_f32 v190, v6
    v_add_f32 v6, 1102577664, v17
    v_mul_f32 v6, v6, v5
    v_cos_f32 v175, v6
    v_sin_f32 v191, v6
    v_add_f32 v5, 1107296256, v16
    v_mul_f32 v5, 973078528, v5
    v_add_f32 v6, 0, v17
    v_mul_f32 v6, v6, v5
    v_cos_f32 v192, v6
    v_sin_f32 v208, v6
    v_add_f32 v6, 1065353216, v17
    v_mul_f32 v6, v6, v5
    v_cos_f32 v193, v6
    v_sin_f32 v209, v6
    v_add_f32 v6, 1073741824, v17
    v_mul_f32 v6, v6, v5
    v_cos_f32 v194, v6
    v_sin_f32 v210, v6
    v_add_f32 v6, 1077936128, v17
    v_mul_f32 v6, v6, v5
    v_cos_f32 v195, v6
    v_sin_f32 v211, v6
    v_add_f32 v6, 1082130432, v17
    v_mul_f32 v6, v6, v5
    v_cos_f32 v196, v6
    v_sin_f32 v212, v6
    v_add_f32 v6, 1084227584, v17
    v_mul_f32 v6, v6, v5
    v_cos_f32 v197, v6
    v_sin_f32 v213, v6
    v_add_f32 v6, 1086324736, v17
    v_mul_f32 v6, v6, v5
    v_cos_f32 v198, v6
    v_sin_f32 v214, v6
    v_add_f32 v6, 1088421888, v17
    v_mul_f32 v6, v6, v5
    v_cos_f32 v199, v6
    v_sin_f32 v215, v6
    v_add_f32 v6, 1098907648, v17
    v_mul_f32 v6, v6, v5
    v_cos_f32 v200, v6
    v_sin_f32 v216, v6
    v_add_f32 v6, 1099431936, v17
    v_mul_f32 v6, v6, v5
    v_cos_f32 v201, v6
    v_sin_f32 v217, v6
    v_add_f32 v6, 1099956224, v17
    v_mul_f32 v6, v6, v5
    v_cos_f32 v202, v6
    v_sin_f32 v218, v6
    v_add_f32 v6, 1100480512, v17
    v_mul_f32 v6, v6, v5
    v_cos_f32 v203, v6
    v_sin_f32 v219, v6
    v_add_f32 v6, 1101004800, v17
    v_mul_f32 v6, v6, v5
    v_cos_f32 v204, v6
    v_sin_f32 v220, v6
    v_add_f32 v6, 1101529088, v17
    v_mul_f32 v6, v6, v5
    v_cos_f32 v205, v6
    v_sin_f32 v221, v6
    v_add_f32 v6, 1102053376, v17
    v_mul_f32 v6, v6, v5
    v_cos_f32 v206, v6
    v_sin_f32 v222, v6
    v_add_f32 v6, 1102577664, v17
    v_mul_f32 v6, v6, v5
    v_cos_f32 v207, v6
    v_sin_f32 v223, v6
    v_add_f32 v5, 0, v16
    v_mul_f32 v5, 973078528, v5
    v_add_f32 v6, 1107296256, v17
    v_mul_f32 v6, v6, v5
    v_cos_f32 v224, v6
    v_sin_f32 v240, v6
    v_add_f32 v6, 1107558400, v17
    v_mul_f32 v6, v6, v5
    v_cos_f32 v225, v6
    v_sin_f32 v241, v6
    v_add_f32 v6, 1107820544, v17
    v_mul_f32 v6, v6, v5
    v_cos_f32 v226, v6
    v_sin_f32 v242, v6
    v_add_f32 v6, 1108082688, v17
    v_mul_f32 v6, v6, v5
    v_cos_f32 v227, v6
    v_sin_f32 v243, v6
    v_add_f32 v6, 1108344832, v17
    v_mul_f32 v6, v6, v5
    v_cos_f32 v228, v6
    v_sin_f32 v244, v6
    v_add_f32 v6, 1108606976, v17
    v_mul_f32 v6, v6, v5
    v_cos_f32 v229, v6
    v_sin_f32 v245, v6
    v_add_f32 v6, 1108869120, v17
    v_mul_f32 v6, v6, v5
    v_cos_f32 v230, v6
    v_sin_f32 v246, v6
    v_add_f32 v6, 1109131264, v17
    v_mul_f32 v6, v6, v5
    v_cos_f32 v231, v6
    v_sin_f32 v247, v6
    v_add_f32 v6, 1111490560, v17
    v_mul_f32 v6, v6, v5
    v_cos_f32 v232, v6
    v_sin_f32 v248, v6
    v_add_f32 v6, 1111752704, v17
    v_mul_f32 v6, v6, v5
    v_cos_f32 v233, v6
    v_sin_f32 v249, v6
    v_add_f32 v6, 1112014848, v17
    v_mul_f32 v6, v6, v5
    v_cos_f32 v234, v6
    v_sin_f32 v250, v6
    v_add_f32 v6, 1112276992, v17
    v_mul_f32 v6, v6, v5
    v_cos_f32 v235, v6
    v_sin_f32 v251, v6
    v_add_f32 v6, 1112539136, v17
    v_mul_f32 v6, v6, v5
    v_cos_f32 v236, v6
    v_sin_f32 v252, v6
    v_add_f32 v6, 1112801280, v17
    v_mul_f32 v6, v6, v5
    v_cos_f32 v237, v6
    v_sin_f32 v253, v6
    v_add_f32 v6, 1113063424, v17
    v_mul_f32 v6, v6, v5
    v_cos_f32 v238, v6
    v_sin_f32 v254, v6
    v_add_f32 v6, 1113325568, v17
    v_mul_f32 v6, v6, v5
    v_cos_f32 v239, v6
    v_sin_f32 v255, v6
    s_barrier
.p2align 6
F2_top:
    s_waitcnt vmcnt(0)
    v_mfma_f32_32x32x16_bf16 v[32:47], v[128:131], a[0:3], 0
    v_mfma_f32_32x32x16_bf16 v[48:63], v[144:147], a[0:3], 0
    v_mfma_f32_32x32x16_bf16 v[32:47], v[144:147], a[32:35], v[32:47]
    ds_write_b128 v13, a[248:251]
    v_mfma_f32_32x32x16_bf16 v[48:63], v[128:131], a[64:67], v[48:63]
    ds_write_b128 v13, a[252:255] offset:1024
    ds_write_b16 v13, v2 offset:2
    v_mfma_f32_32x32x16_bf16 v[32:47], v[132:135], a[4:7], v[32:47]
    ds_write_b16 v13, v3 offset:1026
    v_mfma_f32_32x32x16_bf16 v[48:63], v[148:151], a[4:7], v[48:63]
    ds_write_b16 v13, v4 offset:6
    ds_write_b16 v13, v7 offset:1030
    v_mfma_f32_32x32x16_bf16 v[32:47], v[148:151], a[36:39], v[32:47]
    ds_write_b16 v13, v8 offset:10
    v_mfma_f32_32x32x16_bf16 v[48:63], v[132:135], a[68:71], v[48:63]
    ds_write_b16 v13, v10 offset:1034
    ds_write_b16 v13, v11 offset:14
    v_mfma_f32_32x32x16_bf16 v[32:47], v[136:139], a[8:11], v[32:47]
    ds_write_b16 v13, v16 offset:1038
    v_mfma_f32_32x32x16_bf16 v[48:63], v[152:155], a[8:11], v[48:63]
    v_add_u32 v13, 2048, v13
    s_add_u32 s36, s36, 1
    v_mfma_f32_32x32x16_bf16 v[32:47], v[152:155], a[40:43], v[32:47]
    s_add_u32 s32, s32, 128
    v_mfma_f32_32x32x16_bf16 v[48:63], v[136:139], a[72:75], v[48:63]
    s_add_u32 s33, s32, 64
    s_cmp_eq_u32 s36, 4
    v_mfma_f32_32x32x16_bf16 v[32:47], v[140:143], a[12:15], v[32:47]
    s_cselect_b32 s32, 104857664, s32
    v_mfma_f32_32x32x16_bf16 v[48:63], v[156:159], a[12:15], v[48:63]
    s_cselect_b32 s33, 1073741824, s33
    s_cmp_lt_u32 s36, s37
    v_mfma_f32_32x32x16_bf16 v[32:47], v[156:159], a[44:47], v[32:47]
    s_cselect_b32 s32, s32, 1073741824
    v_mfma_f32_32x32x16_bf16 v[48:63], v[140:143], a[76:79], v[48:63]
    s_cselect_b32 s33, s33, 1073741824
    v_add_u32 v19, s35, v14
    v_mfma_f32_32x32x16_bf16 v[64:79], v[128:131], a[16:19], 0
    v_mfma_f32_32x32x16_bf16 v[80:95], v[144:147], a[16:19], 0
    s_add_u32 s18, s34, 0
    buffer_load_ushort a248, v12, s[48:51], s18 offen
    buffer_load_ushort v2, v12, s[52:55], s18 offen
    v_mfma_f32_32x32x16_bf16 v[64:79], v[144:147], a[48:51], v[64:79]
    v_mul_f32 v20, v32, v160
    s_nop 0
    v_mul_f32 v22, v48, v160
    v_mul_f32 v21, v33, v161
    v_mul_f32 v23, v49, v161
    v_fma_f32 v20, v48, v176, v20
    v_mfma_f32_32x32x16_bf16 v[80:95], v[128:131], a[80:83], v[80:95]
    v_fma_f32 v22, -v32, v176, v22
    v_fma_f32 v21, v49, v177, v21
    v_fma_f32 v23, -v33, v177, v23
    v_cvt_pk_bf16_f32 v96, v20, v21
    v_cvt_pk_bf16_f32 v112, v22, v23
    v_mul_f32 v24, v34, v162
    v_mfma_f32_32x32x16_bf16 v[64:79], v[132:135], a[20:23], v[64:79]
    v_mul_f32 v26, v50, v162
    v_mul_f32 v25, v35, v163
    v_mul_f32 v27, v51, v163
    v_fma_f32 v24, v50, v178, v24
    v_fma_f32 v26, -v34, v178, v26
    v_fma_f32 v25, v51, v179, v25
    v_mfma_f32_32x32x16_bf16 v[80:95], v[148:151], a[20:23], v[80:95]
    v_fma_f32 v27, -v35, v179, v27
    v_cvt_pk_bf16_f32 v97, v24, v25
    v_cvt_pk_bf16_f32 v113, v26, v27
    v_mul_f32 v20, v36, v164
    v_mul_f32 v22, v52, v164
    v_mfma_f32_32x32x16_bf16 v[64:79], v[148:151], a[52:55], v[64:79]
    v_mul_f32 v21, v37, v165
    v_mul_f32 v23, v53, v165
    v_fma_f32 v20, v52, v180, v20
    v_fma_f32 v22, -v36, v180, v22
    v_fma_f32 v21, v53, v181, v21
    v_fma_f32 v23, -v37, v181, v23
    v_mfma_f32_32x32x16_bf16 v[80:95], v[132:135], a[84:87], v[80:95]
    v_cvt_pk_bf16_f32 v98, v20, v21
    v_cvt_pk_bf16_f32 v114, v22, v23
    v_mul_f32 v24, v38, v166
    v_mul_f32 v26, v54, v166
    v_mul_f32 v25, v39, v167
    v_mul_f32 v27, v55, v167
    v_mfma_f32_32x32x16_bf16 v[64:79], v[136:139], a[24:27], v[64:79]
    v_fma_f32 v24, v54, v182, v24
    v_fma_f32 v26, -v38, v182, v26
    v_fma_f32 v25, v55, v183, v25
    v_fma_f32 v27, -v39, v183, v27
    v_cvt_pk_bf16_f32 v99, v24, v25
    v_cvt_pk_bf16_f32 v115, v26, v27
    v_mfma_f32_32x32x16_bf16 v[80:95], v[152:155], a[24:27], v[80:95]
    v_mul_f32 v20, v40, v168
    v_mul_f32 v22, v56, v168
    v_mul_f32 v21, v41, v169
    v_mul_f32 v23, v57, v169
    v_fma_f32 v20, v56, v184, v20
    v_mfma_f32_32x32x16_bf16 v[64:79], v[152:155], a[56:59], v[64:79]
    v_fma_f32 v22, -v40, v184, v22
    v_fma_f32 v21, v57, v185, v21
    v_fma_f32 v23, -v41, v185, v23
    v_cvt_pk_bf16_f32 v100, v20, v21
    v_cvt_pk_bf16_f32 v116, v22, v23
    v_mul_f32 v24, v42, v170
    v_mfma_f32_32x32x16_bf16 v[80:95], v[136:139], a[88:91], v[80:95]
    v_mul_f32 v26, v58, v170
    v_mul_f32 v25, v43, v171
    v_mul_f32 v27, v59, v171
    v_fma_f32 v24, v58, v186, v24
    v_fma_f32 v26, -v42, v186, v26
    v_fma_f32 v25, v59, v187, v25
    v_mfma_f32_32x32x16_bf16 v[64:79], v[140:143], a[28:31], v[64:79]
    v_fma_f32 v27, -v43, v187, v27
    v_cvt_pk_bf16_f32 v101, v24, v25
    v_cvt_pk_bf16_f32 v117, v26, v27
    v_mul_f32 v20, v44, v172
    v_mul_f32 v22, v60, v172
    v_mfma_f32_32x32x16_bf16 v[80:95], v[156:159], a[28:31], v[80:95]
    v_mul_f32 v21, v45, v173
    v_mul_f32 v23, v61, v173
    v_fma_f32 v20, v60, v188, v20
    v_fma_f32 v22, -v44, v188, v22
    v_fma_f32 v21, v61, v189, v21
    v_fma_f32 v23, -v45, v189, v23
    v_mfma_f32_32x32x16_bf16 v[64:79], v[156:159], a[60:63], v[64:79]
    v_cvt_pk_bf16_f32 v102, v20, v21
    v_cvt_pk_bf16_f32 v118, v22, v23
    v_mul_f32 v24, v46, v174
    v_mul_f32 v26, v62, v174
    v_mul_f32 v25, v47, v175
    v_mul_f32 v27, v63, v175
    v_mfma_f32_32x32x16_bf16 v[80:95], v[140:143], a[92:95], v[80:95]
    v_fma_f32 v24, v62, v190, v24
    v_fma_f32 v26, -v46, v190, v26
    v_fma_f32 v25, v63, v191, v25
    v_fma_f32 v27, -v47, v191, v27
    v_cvt_pk_bf16_f32 v103, v24, v25
    v_cvt_pk_bf16_f32 v119, v26, v27
    v_mfma_f32_32x32x16_bf16 v[32:47], a[96:99], v[96:99], 0
    buffer_load_dwordx4 v[128:131], v15, s[4:7], s32 offen offset:0
    v_mfma_f32_32x32x16_bf16 v[48:63], a[96:99], v[112:115], 0
    buffer_load_dwordx4 v[132:135], v15, s[4:7], s32 offen offset:32
    v_mfma_f32_32x32x16_bf16 v[32:47], a[104:107], v[112:115], v[32:47]
    s_add_u32 s17, s32, 69632
    buffer_load_dwordx4 v[136:139], v15, s[4:7], s17 offen offset:0
    v_mul_f32 v20, v64, v192
    v_mul_f32 v22, v80, v192
    v_mul_f32 v21, v65, v193
    v_mul_f32 v23, v81, v193
    v_fma_f32 v20, v80, v208, v20
    v_fma_f32 v22, -v64, v208, v22
    v_fma_f32 v21, v81, v209, v21
    v_fma_f32 v23, -v65, v209, v23
    v_cvt_pk_bf16_f32 v104, v20, v21
    v_cvt_pk_bf16_f32 v120, v22, v23
    v_mul_f32 v24, v66, v194
    v_mul_f32 v26, v82, v194
    v_mul_f32 v25, v67, v195
    v_mfma_f32_32x32x16_bf16 v[48:63], a[112:115], v[96:99], v[48:63]
    buffer_load_dwordx4 v[140:143], v15, s[4:7], s17 offen offset:32
    v_mul_f32 v27, v83, v195
    v_fma_f32 v24, v82, v210, v24
    v_fma_f32 v26, -v66, v210, v26
    v_fma_f32 v25, v83, v211, v25
    v_fma_f32 v27, -v67, v211, v27
    v_cvt_pk_bf16_f32 v105, v24, v25
    v_cvt_pk_bf16_f32 v121, v26, v27
    v_mul_f32 v20, v68, v196
    v_mul_f32 v22, v84, v196
    v_mul_f32 v21, v69, v197
    v_mul_f32 v23, v85, v197
    v_fma_f32 v20, v84, v212, v20
    v_fma_f32 v22, -v68, v212, v22
    v_mfma_f32_32x32x16_bf16 v[32:47], a[100:103], v[100:103], v[32:47]
    buffer_load_dwordx4 v[144:147], v15, s[4:7], s33 offen offset:0
    v_fma_f32 v21, v85, v213, v21
    v_fma_f32 v23, -v69, v213, v23
    v_cvt_pk_bf16_f32 v106, v20, v21
    v_cvt_pk_bf16_f32 v122, v22, v23
    v_mul_f32 v24, v70, v198
    v_mul_f32 v26, v86, v198
    v_mul_f32 v25, v71, v199
    v_mul_f32 v27, v87, v199
    v_fma_f32 v24, v86, v214, v24
    v_fma_f32 v26, -v70, v214, v26
    v_fma_f32 v25, v87, v215, v25
    v_fma_f32 v27, -v71, v215, v27
    v_cvt_pk_bf16_f32 v107, v24, v25
    v_cvt_pk_bf16_f32 v123, v26, v27
    v_mfma_f32_32x32x16_bf16 v[48:63], a[100:103], v[116:119], v[48:63]
    buffer_load_dwordx4 v[148:151], v15, s[4:7], s33 offen offset:32
    v_mul_f32 v20, v72, v200
    v_mul_f32 v22, v88, v200
    v_mul_f32 v21, v73, v201
    v_mul_f32 v23, v89, v201
    v_fma_f32 v20, v88, v216, v20
    v_fma_f32 v22, -v72, v216, v22
    v_fma_f32 v21, v89, v217, v21
    v_fma_f32 v23, -v73, v217, v23
    v_cvt_pk_bf16_f32 v108, v20, v21
    v_cvt_pk_bf16_f32 v124, v22, v23
    v_mul_f32 v24, v74, v202
    v_mul_f32 v26, v90, v202
    v_mul_f32 v25, v75, v203
    v_mfma_f32_32x32x16_bf16 v[32:47], a[108:111], v[116:119], v[32:47]
    s_add_u32 s17, s33, 69632
    buffer_load_dwordx4 v[152:155], v15, s[4:7], s17 offen offset:0
    v_mul_f32 v27, v91, v203
    v_fma_f32 v24, v90, v218, v24
    v_fma_f32 v26, -v74, v218, v26
    v_fma_f32 v25, v91, v219, v25
    v_fma_f32 v27, -v75, v219, v27
    v_cvt_pk_bf16_f32 v109, v24, v25
    v_cvt_pk_bf16_f32 v125, v26, v27
    v_mul_f32 v20, v76, v204
    v_mul_f32 v22, v92, v204
    v_mul_f32 v21, v77, v205
    v_mul_f32 v23, v93, v205
    v_fma_f32 v20, v92, v220, v20
    v_fma_f32 v22, -v76, v220, v22
    v_mfma_f32_32x32x16_bf16 v[48:63], a[116:119], v[100:103], v[48:63]
    buffer_load_dwordx4 v[156:159], v15, s[4:7], s17 offen offset:32
    s_nop 1
    ds_read_b128 v[96:99], v19 offset:0
    ds_read_b128 v[112:115], v19 offset:1024
    ds_read_b128 v[100:103], v19 offset:2048
    ds_read_b128 v[116:119], v19 offset:3072
    v_fma_f32 v21, v93, v221, v21
    v_fma_f32 v23, -v77, v221, v23
    v_cvt_pk_bf16_f32 v110, v20, v21
    v_cvt_pk_bf16_f32 v126, v22, v23
    v_mul_f32 v24, v78, v206
    v_mul_f32 v26, v94, v206
    v_mul_f32 v25, v79, v207
    v_mul_f32 v27, v95, v207
    v_fma_f32 v24, v94, v222, v24
    v_fma_f32 v26, -v78, v222, v26
    v_fma_f32 v25, v95, v223, v25
    v_fma_f32 v27, -v79, v223, v27
    v_cvt_pk_bf16_f32 v111, v24, v25
    v_cvt_pk_bf16_f32 v127, v26, v27
    v_mfma_f32_32x32x16_bf16 v[64:79], a[96:99], v[104:107], 0
    v_mfma_f32_32x32x16_bf16 v[80:95], a[96:99], v[120:123], 0
    s_add_u32 s18, s34, 65664
    buffer_load_ushort a252, v12, s[48:51], s18 offen
    buffer_load_ushort v3, v12, s[52:55], s18 offen
    v_mfma_f32_32x32x16_bf16 v[64:79], a[104:107], v[120:123], v[64:79]
    s_waitcnt lgkmcnt(0)
    v_lshlrev_b32 v28, 16, v96
    v_and_b32 v30, s38, v96
    v_lshlrev_b32 v29, 16, v112
    v_and_b32 v31, s38, v112
    v_mul_f32 v20, v32, v28
    v_mul_f32 v22, v48, v28
    v_mul_f32 v21, v33, v29
    v_mul_f32 v23, v49, v29
    v_fma_f32 v20, -v48, v30, v20
    v_fma_f32 v22, v32, v30, v22
    v_fma_f32 v21, -v49, v31, v21
    v_fma_f32 v23, v33, v31, v23
    v_cvt_pk_bf16_f32 v96, v20, v21
    v_cvt_pk_bf16_f32 v112, v22, v23
    v_lshlrev_b32 v28, 16, v97
    v_and_b32 v30, s38, v97
    v_lshlrev_b32 v29, 16, v113
    v_mfma_f32_32x32x16_bf16 v[80:95], a[112:115], v[104:107], v[80:95]
    v_and_b32 v31, s38, v113
    v_mul_f32 v24, v34, v28
    v_mul_f32 v26, v50, v28
    v_mul_f32 v25, v35, v29
    v_mul_f32 v27, v51, v29
    v_fma_f32 v24, -v50, v30, v24
    v_fma_f32 v26, v34, v30, v26
    v_fma_f32 v25, -v51, v31, v25
    v_fma_f32 v27, v35, v31, v27
    v_cvt_pk_bf16_f32 v97, v24, v25
    v_cvt_pk_bf16_f32 v113, v26, v27
    v_lshlrev_b32 v28, 16, v98
    v_and_b32 v30, s38, v98
    v_lshlrev_b32 v29, 16, v114
    v_and_b32 v31, s38, v114
    v_mul_f32 v20, v36, v28
    v_mul_f32 v22, v52, v28
    v_mul_f32 v21, v37, v29
    v_mul_f32 v23, v53, v29
    v_mfma_f32_32x32x16_bf16 v[64:79], a[100:103], v[108:111], v[64:79]
    v_fma_f32 v20, -v52, v30, v20
    v_fma_f32 v22, v36, v30, v22
    v_fma_f32 v21, -v53, v31, v21
    v_fma_f32 v23, v37, v31, v23
    v_cvt_pk_bf16_f32 v98, v20, v21
    v_cvt_pk_bf16_f32 v114, v22, v23
    v_lshlrev_b32 v28, 16, v99
    v_and_b32 v30, s38, v99
    v_lshlrev_b32 v29, 16, v115
    v_and_b32 v31, s38, v115
    v_mul_f32 v24, v38, v28
    v_mul_f32 v26, v54, v28
    v_mul_f32 v25, v39, v29
    v_mul_f32 v27, v55, v29
    v_fma_f32 v24, -v54, v30, v24
    v_fma_f32 v26, v38, v30, v26
    v_fma_f32 v25, -v55, v31, v25
    v_fma_f32 v27, v39, v31, v27
    v_cvt_pk_bf16_f32 v99, v24, v25
    v_mfma_f32_32x32x16_bf16 v[80:95], a[100:103], v[124:127], v[80:95]
    v_cvt_pk_bf16_f32 v115, v26, v27
    v_lshlrev_b32 v28, 16, v100
    v_and_b32 v30, s38, v100
    v_lshlrev_b32 v29, 16, v116
    v_and_b32 v31, s38, v116
    v_mul_f32 v20, v40, v28
    v_mul_f32 v22, v56, v28
    v_mul_f32 v21, v41, v29
    v_mul_f32 v23, v57, v29
    v_fma_f32 v20, -v56, v30, v20
    v_fma_f32 v22, v40, v30, v22
    v_fma_f32 v21, -v57, v31, v21
    v_fma_f32 v23, v41, v31, v23
    v_cvt_pk_bf16_f32 v100, v20, v21
    v_cvt_pk_bf16_f32 v116, v22, v23
    v_lshlrev_b32 v28, 16, v101
    v_and_b32 v30, s38, v101
    v_lshlrev_b32 v29, 16, v117
    v_and_b32 v31, s38, v117
    v_mfma_f32_32x32x16_bf16 v[64:79], a[108:111], v[124:127], v[64:79]
    v_mul_f32 v24, v42, v28
    v_mul_f32 v26, v58, v28
    v_mul_f32 v25, v43, v29
    v_mul_f32 v27, v59, v29
    v_fma_f32 v24, -v58, v30, v24
    v_fma_f32 v26, v42, v30, v26
    v_fma_f32 v25, -v59, v31, v25
    v_fma_f32 v27, v43, v31, v27
    v_cvt_pk_bf16_f32 v101, v24, v25
    v_cvt_pk_bf16_f32 v117, v26, v27
    v_lshlrev_b32 v28, 16, v102
    v_and_b32 v30, s38, v102
    v_lshlrev_b32 v29, 16, v118
    v_and_b32 v31, s38, v118
    v_mul_f32 v20, v44, v28
    v_mul_f32 v22, v60, v28
    v_mul_f32 v21, v45, v29
    v_mul_f32 v23, v61, v29
    v_fma_f32 v20, -v60, v30, v20
    v_mfma_f32_32x32x16_bf16 v[80:95], a[116:119], v[108:111], v[80:95]
    s_nop 1
    ds_read_b128 v[104:107], v19 offset:4096
    ds_read_b128 v[120:123], v19 offset:5120
    ds_read_b128 v[108:111], v19 offset:6144
    ds_read_b128 v[124:127], v19 offset:7168
    v_fma_f32 v22, v44, v30, v22
    v_fma_f32 v21, -v61, v31, v21
    v_fma_f32 v23, v45, v31, v23
    v_cvt_pk_bf16_f32 v102, v20, v21
    v_cvt_pk_bf16_f32 v118, v22, v23
    v_lshlrev_b32 v28, 16, v103
    v_and_b32 v30, s38, v103
    v_lshlrev_b32 v29, 16, v119
    v_and_b32 v31, s38, v119
    v_mul_f32 v24, v46, v28
    v_mul_f32 v26, v62, v28
    v_mul_f32 v25, v47, v29
    v_mul_f32 v27, v63, v29
    v_fma_f32 v24, -v62, v30, v24
    v_fma_f32 v26, v46, v30, v26
    v_fma_f32 v25, -v63, v31, v25
    v_fma_f32 v27, v47, v31, v27
    v_cvt_pk_bf16_f32 v103, v24, v25
    v_cvt_pk_bf16_f32 v119, v26, v27
    v_mfma_f32_32x32x16_bf16 v[32:47], v[96:99], a[96:99], 0
    v_mfma_f32_32x32x16_bf16 v[48:63], v[112:115], a[96:99], 0
    s_add_u32 s18, s34, 131328
    buffer_load_ushort a249, v12, s[48:51], s18 offen
    buffer_load_ushort v4, v12, s[52:55], s18 offen
    v_mfma_f32_32x32x16_bf16 v[32:47], v[112:115], a[112:115], v[32:47]
    s_waitcnt lgkmcnt(0)
    v_lshlrev_b32 v28, 16, v104
    v_and_b32 v30, s38, v104
    v_lshlrev_b32 v29, 16, v120
    v_and_b32 v31, s38, v120
    v_mul_f32 v20, v64, v28
    v_mul_f32 v22, v80, v28
    v_mul_f32 v21, v65, v29
    v_mul_f32 v23, v81, v29
    v_fma_f32 v20, -v80, v30, v20
    v_fma_f32 v22, v64, v30, v22
    v_fma_f32 v21, -v81, v31, v21
    v_fma_f32 v23, v65, v31, v23
    v_cvt_pk_bf16_f32 v104, v20, v21
    v_cvt_pk_bf16_f32 v120, v22, v23
    v_lshlrev_b32 v28, 16, v105
    v_and_b32 v30, s38, v105
    v_lshlrev_b32 v29, 16, v121
    v_mfma_f32_32x32x16_bf16 v[48:63], v[96:99], a[104:107], v[48:63]
    v_and_b32 v31, s38, v121
    v_mul_f32 v24, v66, v28
    v_mul_f32 v26, v82, v28
    v_mul_f32 v25, v67, v29
    v_mul_f32 v27, v83, v29
    v_fma_f32 v24, -v82, v30, v24
    v_fma_f32 v26, v66, v30, v26
    v_fma_f32 v25, -v83, v31, v25
    v_fma_f32 v27, v67, v31, v27
    v_cvt_pk_bf16_f32 v105, v24, v25
    v_cvt_pk_bf16_f32 v121, v26, v27
    v_lshlrev_b32 v28, 16, v106
    v_and_b32 v30, s38, v106
    v_lshlrev_b32 v29, 16, v122
    v_and_b32 v31, s38, v122
    v_mul_f32 v20, v68, v28
    v_mul_f32 v22, v84, v28
    v_mul_f32 v21, v69, v29
    v_mul_f32 v23, v85, v29
    v_mfma_f32_32x32x16_bf16 v[32:47], v[100:103], a[100:103], v[32:47]
    v_fma_f32 v20, -v84, v30, v20
    v_fma_f32 v22, v68, v30, v22
    v_fma_f32 v21, -v85, v31, v21
    v_fma_f32 v23, v69, v31, v23
    v_cvt_pk_bf16_f32 v106, v20, v21
    v_cvt_pk_bf16_f32 v122, v22, v23
    v_lshlrev_b32 v28, 16, v107
    v_and_b32 v30, s38, v107
    v_lshlrev_b32 v29, 16, v123
    v_and_b32 v31, s38, v123
    v_mul_f32 v24, v70, v28
    v_mul_f32 v26, v86, v28
    v_mul_f32 v25, v71, v29
    v_mul_f32 v27, v87, v29
    v_fma_f32 v24, -v86, v30, v24
    v_fma_f32 v26, v70, v30, v26
    v_fma_f32 v25, -v87, v31, v25
    v_fma_f32 v27, v71, v31, v27
    v_cvt_pk_bf16_f32 v107, v24, v25
    v_mfma_f32_32x32x16_bf16 v[48:63], v[116:119], a[100:103], v[48:63]
    v_cvt_pk_bf16_f32 v123, v26, v27
    v_lshlrev_b32 v28, 16, v108
    v_and_b32 v30, s38, v108
    v_lshlrev_b32 v29, 16, v124
    v_and_b32 v31, s38, v124
    v_mul_f32 v20, v72, v28
    v_mul_f32 v22, v88, v28
    v_mul_f32 v21, v73, v29
    v_mul_f32 v23, v89, v29
    v_fma_f32 v20, -v88, v30, v20
    v_fma_f32 v22, v72, v30, v22
    v_fma_f32 v21, -v89, v31, v21
    v_fma_f32 v23, v73, v31, v23
    v_cvt_pk_bf16_f32 v108, v20, v21
    v_cvt_pk_bf16_f32 v124, v22, v23
    v_lshlrev_b32 v28, 16, v109
    v_and_b32 v30, s38, v109
    v_lshlrev_b32 v29, 16, v125
    v_and_b32 v31, s38, v125
    v_mfma_f32_32x32x16_bf16 v[32:47], v[116:119], a[116:119], v[32:47]
    v_mul_f32 v24, v74, v28
    v_mul_f32 v26, v90, v28
    v_mul_f32 v25, v75, v29
    v_mul_f32 v27, v91, v29
    v_fma_f32 v24, -v90, v30, v24
    v_fma_f32 v26, v74, v30, v26
    v_fma_f32 v25, -v91, v31, v25
    v_fma_f32 v27, v75, v31, v27
    v_cvt_pk_bf16_f32 v109, v24, v25
    v_cvt_pk_bf16_f32 v125, v26, v27
    v_lshlrev_b32 v28, 16, v110
    v_and_b32 v30, s38, v110
    v_lshlrev_b32 v29, 16, v126
    v_and_b32 v31, s38, v126
    v_mul_f32 v20, v76, v28
    v_mul_f32 v22, v92, v28
    v_mul_f32 v21, v77, v29
    v_mul_f32 v23, v93, v29
    v_fma_f32 v20, -v92, v30, v20
    v_mfma_f32_32x32x16_bf16 v[48:63], v[100:103], a[108:111], v[48:63]
    v_fma_f32 v22, v76, v30, v22
    v_fma_f32 v21, -v93, v31, v21
    v_fma_f32 v23, v77, v31, v23
    v_cvt_pk_bf16_f32 v110, v20, v21
    v_cvt_pk_bf16_f32 v126, v22, v23
    v_lshlrev_b32 v28, 16, v111
    v_and_b32 v30, s38, v111
    v_lshlrev_b32 v29, 16, v127
    v_and_b32 v31, s38, v127
    v_mul_f32 v24, v78, v28
    v_mul_f32 v26, v94, v28
    v_mul_f32 v25, v79, v29
    v_mul_f32 v27, v95, v29
    v_fma_f32 v24, -v94, v30, v24
    v_fma_f32 v26, v78, v30, v26
    v_fma_f32 v25, -v95, v31, v25
    v_fma_f32 v27, v79, v31, v27
    v_cvt_pk_bf16_f32 v111, v24, v25
    v_cvt_pk_bf16_f32 v127, v26, v27
    v_mfma_f32_32x32x16_bf16 v[64:79], v[104:107], a[96:99], 0
    v_mfma_f32_32x32x16_bf16 v[80:95], v[120:123], a[96:99], 0
    s_add_u32 s18, s34, 196992
    buffer_load_ushort a253, v12, s[48:51], s18 offen
    buffer_load_ushort v7, v12, s[52:55], s18 offen
    v_mfma_f32_32x32x16_bf16 v[64:79], v[120:123], a[112:115], v[64:79]
    v_mul_f32 v20, v32, v160
    v_mul_f32 v22, v48, v160
    v_mul_f32 v21, v33, v161
    v_mul_f32 v23, v49, v161
    v_fma_f32 v20, -v48, v176, v20
    v_fma_f32 v22, v32, v176, v22
    v_fma_f32 v21, -v49, v177, v21
    v_fma_f32 v23, v33, v177, v23
    v_cvt_pk_bf16_f32 v96, v20, v21
    v_cvt_pk_bf16_f32 v112, v22, v23
    v_mul_f32 v24, v34, v162
    v_mul_f32 v26, v50, v162
    v_mul_f32 v25, v35, v163
    v_mfma_f32_32x32x16_bf16 v[80:95], v[104:107], a[104:107], v[80:95]
    v_mul_f32 v27, v51, v163
    v_fma_f32 v24, -v50, v178, v24
    v_fma_f32 v26, v34, v178, v26
    v_fma_f32 v25, -v51, v179, v25
    v_fma_f32 v27, v35, v179, v27
    v_cvt_pk_bf16_f32 v97, v24, v25
    v_cvt_pk_bf16_f32 v113, v26, v27
    v_mul_f32 v20, v36, v164
    v_mul_f32 v22, v52, v164
    v_mul_f32 v21, v37, v165
    v_mul_f32 v23, v53, v165
    v_fma_f32 v20, -v52, v180, v20
    v_fma_f32 v22, v36, v180, v22
    v_mfma_f32_32x32x16_bf16 v[64:79], v[108:111], a[100:103], v[64:79]
    v_fma_f32 v21, -v53, v181, v21
    v_fma_f32 v23, v37, v181, v23
    v_cvt_pk_bf16_f32 v98, v20, v21
    v_cvt_pk_bf16_f32 v114, v22, v23
    v_mul_f32 v24, v38, v166
    v_mul_f32 v26, v54, v166
    v_mul_f32 v25, v39, v167
    v_mul_f32 v27, v55, v167
    v_fma_f32 v24, -v54, v182, v24
    v_fma_f32 v26, v38, v182, v26
    v_fma_f32 v25, -v55, v183, v25
    v_fma_f32 v27, v39, v183, v27
    v_cvt_pk_bf16_f32 v99, v24, v25
    v_cvt_pk_bf16_f32 v115, v26, v27
    v_mfma_f32_32x32x16_bf16 v[80:95], v[124:127], a[100:103], v[80:95]
    v_mul_f32 v20, v40, v168
    v_mul_f32 v22, v56, v168
    v_mul_f32 v21, v41, v169
    v_mul_f32 v23, v57, v169
    v_fma_f32 v20, -v56, v184, v20
    v_fma_f32 v22, v40, v184, v22
    v_fma_f32 v21, -v57, v185, v21
    v_fma_f32 v23, v41, v185, v23
    v_cvt_pk_bf16_f32 v100, v20, v21
    v_cvt_pk_bf16_f32 v116, v22, v23
    v_mul_f32 v24, v42, v170
    v_mul_f32 v26, v58, v170
    v_mul_f32 v25, v43, v171
    v_mfma_f32_32x32x16_bf16 v[64:79], v[124:127], a[116:119], v[64:79]
    v_mul_f32 v27, v59, v171
    v_fma_f32 v24, -v58, v186, v24
    v_fma_f32 v26, v42, v186, v26
    v_fma_f32 v25, -v59, v187, v25
    v_fma_f32 v27, v43, v187, v27
    v_cvt_pk_bf16_f32 v101, v24, v25
    v_cvt_pk_bf16_f32 v117, v26, v27
    v_mul_f32 v20, v44, v172
    v_mul_f32 v22, v60, v172
    v_mul_f32 v21, v45, v173
    v_mul_f32 v23, v61, v173
    v_fma_f32 v20, -v60, v188, v20
    v_fma_f32 v22, v44, v188, v22
    v_mfma_f32_32x32x16_bf16 v[80:95], v[108:111], a[108:111], v[80:95]
    v_fma_f32 v21, -v61, v189, v21
    v_fma_f32 v23, v45, v189, v23
    v_cvt_pk_bf16_f32 v102, v20, v21
    v_cvt_pk_bf16_f32 v118, v22, v23
    v_mul_f32 v24, v46, v174
    v_mul_f32 v26, v62, v174
    v_mul_f32 v25, v47, v175
    v_mul_f32 v27, v63, v175
    v_fma_f32 v24, -v62, v190, v24
    v_fma_f32 v26, v46, v190, v26
    v_fma_f32 v25, -v63, v191, v25
    v_fma_f32 v27, v47, v191, v27
    v_cvt_pk_bf16_f32 v103, v24, v25
    v_cvt_pk_bf16_f32 v119, v26, v27
    v_mfma_f32_32x32x16_bf16 v[32:47], a[0:3], v[96:99], 0
    v_mfma_f32_32x32x16_bf16 v[48:63], a[0:3], v[112:115], 0
    s_add_u32 s18, s34, 262656
    buffer_load_ushort a250, v12, s[48:51], s18 offen
    buffer_load_ushort v8, v12, s[52:55], s18 offen
    v_mfma_f32_32x32x16_bf16 v[32:47], a[64:67], v[112:115], v[32:47]
    v_mul_f32 v20, v64, v224
    v_mul_f32 v22, v80, v224
    v_mul_f32 v21, v65, v225
    v_mul_f32 v23, v81, v225
    v_fma_f32 v20, -v80, v240, v20
    v_fma_f32 v22, v64, v240, v22
    v_fma_f32 v21, -v81, v241, v21
    v_fma_f32 v23, v65, v241, v23
    v_cvt_pk_bf16_f32 v104, v20, v21
    v_cvt_pk_bf16_f32 v120, v22, v23
    v_mul_f32 v24, v66, v226
    v_mul_f32 v26, v82, v226
    v_mul_f32 v25, v67, v227
    v_mfma_f32_32x32x16_bf16 v[48:63], a[32:35], v[96:99], v[48:63]
    v_mul_f32 v27, v83, v227
    v_fma_f32 v24, -v82, v242, v24
    v_fma_f32 v26, v66, v242, v26
    v_fma_f32 v25, -v83, v243, v25
    v_fma_f32 v27, v67, v243, v27
    v_cvt_pk_bf16_f32 v105, v24, v25
    v_cvt_pk_bf16_f32 v121, v26, v27
    v_mul_f32 v20, v68, v228
    v_mul_f32 v22, v84, v228
    v_mul_f32 v21, v69, v229
    v_mul_f32 v23, v85, v229
    v_fma_f32 v20, -v84, v244, v20
    v_fma_f32 v22, v68, v244, v22
    v_mfma_f32_32x32x16_bf16 v[32:47], a[4:7], v[100:103], v[32:47]
    v_fma_f32 v21, -v85, v245, v21
    v_fma_f32 v23, v69, v245, v23
    v_cvt_pk_bf16_f32 v106, v20, v21
    v_cvt_pk_bf16_f32 v122, v22, v23
    v_mul_f32 v24, v70, v230
    v_mul_f32 v26, v86, v230
    v_mul_f32 v25, v71, v231
    v_mul_f32 v27, v87, v231
    v_fma_f32 v24, -v86, v246, v24
    v_fma_f32 v26, v70, v246, v26
    v_fma_f32 v25, -v87, v247, v25
    v_fma_f32 v27, v71, v247, v27
    v_cvt_pk_bf16_f32 v107, v24, v25
    v_cvt_pk_bf16_f32 v123, v26, v27
    v_mfma_f32_32x32x16_bf16 v[48:63], a[4:7], v[116:119], v[48:63]
    v_mul_f32 v20, v72, v232
    v_mul_f32 v22, v88, v232
    v_mul_f32 v21, v73, v233
    v_mul_f32 v23, v89, v233
    v_fma_f32 v20, -v88, v248, v20
    v_fma_f32 v22, v72, v248, v22
    v_fma_f32 v21, -v89, v249, v21
    v_fma_f32 v23, v73, v249, v23
    v_cvt_pk_bf16_f32 v108, v20, v21
    v_cvt_pk_bf16_f32 v124, v22, v23
    v_mul_f32 v24, v74, v234
    v_mul_f32 v26, v90, v234
    v_mul_f32 v25, v75, v235
    v_mfma_f32_32x32x16_bf16 v[32:47], a[68:71], v[116:119], v[32:47]
    v_mul_f32 v27, v91, v235
    v_fma_f32 v24, -v90, v250, v24
    v_fma_f32 v26, v74, v250, v26
    v_fma_f32 v25, -v91, v251, v25
    v_fma_f32 v27, v75, v251, v27
    v_cvt_pk_bf16_f32 v109, v24, v25
    v_cvt_pk_bf16_f32 v125, v26, v27
    v_mul_f32 v20, v76, v236
    v_mul_f32 v22, v92, v236
    v_mul_f32 v21, v77, v237
    v_mul_f32 v23, v93, v237
    v_fma_f32 v20, -v92, v252, v20
    v_fma_f32 v22, v76, v252, v22
    v_mfma_f32_32x32x16_bf16 v[48:63], a[36:39], v[100:103], v[48:63]
    v_fma_f32 v21, -v93, v253, v21
    v_fma_f32 v23, v77, v253, v23
    v_cvt_pk_bf16_f32 v110, v20, v21
    v_cvt_pk_bf16_f32 v126, v22, v23
    v_mul_f32 v24, v78, v238
    v_mul_f32 v26, v94, v238
    v_mul_f32 v25, v79, v239
    v_mul_f32 v27, v95, v239
    v_fma_f32 v24, -v94, v254, v24
    v_fma_f32 v26, v78, v254, v26
    v_fma_f32 v25, -v95, v255, v25
    v_fma_f32 v27, v79, v255, v27
    v_cvt_pk_bf16_f32 v111, v24, v25
    v_cvt_pk_bf16_f32 v127, v26, v27
    v_mfma_f32_32x32x16_bf16 v[32:47], a[8:11], v[104:107], v[32:47]
    s_add_u32 s18, s34, 328320
    buffer_load_ushort a254, v12, s[48:51], s18 offen
    buffer_load_ushort v10, v12, s[52:55], s18 offen
    v_mfma_f32_32x32x16_bf16 v[48:63], a[8:11], v[120:123], v[48:63]
    v_mfma_f32_32x32x16_bf16 v[32:47], a[72:75], v[120:123], v[32:47]
    v_mfma_f32_32x32x16_bf16 v[48:63], a[40:43], v[104:107], v[48:63]
    v_mfma_f32_32x32x16_bf16 v[32:47], a[12:15], v[108:111], v[32:47]
    s_add_u32 s18, s34, 393984
    buffer_load_ushort a251, v12, s[48:51], s18 offen
    buffer_load_ushort v11, v12, s[52:55], s18 offen
    v_mfma_f32_32x32x16_bf16 v[48:63], a[12:15], v[124:127], v[48:63]
    v_mfma_f32_32x32x16_bf16 v[32:47], a[76:79], v[124:127], v[32:47]
    v_mfma_f32_32x32x16_bf16 v[48:63], a[44:47], v[108:111], v[48:63]
    v_mfma_f32_32x32x16_bf16 v[64:79], a[16:19], v[96:99], 0
    s_add_u32 s18, s34, 459648
    buffer_load_ushort a255, v12, s[48:51], s18 offen
    buffer_load_ushort v16, v12, s[52:55], s18 offen
    v_mfma_f32_32x32x16_bf16 v[80:95], a[16:19], v[112:115], 0
    v_mfma_f32_32x32x16_bf16 v[64:79], a[80:83], v[112:115], v[64:79]
    s_nop 1
    v_cvt_pk_bf16_f32 v32, v32, v48
    v_mfma_f32_32x32x16_bf16 v[80:95], a[48:51], v[96:99], v[80:95]
    v_cvt_pk_bf16_f32 v33, v33, v49
    v_mfma_f32_32x32x16_bf16 v[64:79], a[20:23], v[100:103], v[64:79]
    v_cvt_pk_bf16_f32 v34, v34, v50
    v_mfma_f32_32x32x16_bf16 v[80:95], a[20:23], v[116:119], v[80:95]
    v_cvt_pk_bf16_f32 v35, v35, v51
    v_mfma_f32_32x32x16_bf16 v[64:79], a[84:87], v[116:119], v[64:79]
    v_cvt_pk_bf16_f32 v36, v36, v52
    v_mfma_f32_32x32x16_bf16 v[80:95], a[52:55], v[100:103], v[80:95]
    v_cvt_pk_bf16_f32 v37, v37, v53
    v_mfma_f32_32x32x16_bf16 v[64:79], a[24:27], v[104:107], v[64:79]
    v_cvt_pk_bf16_f32 v38, v38, v54
    v_cvt_pk_bf16_f32 v39, v39, v55
    v_mfma_f32_32x32x16_bf16 v[80:95], a[24:27], v[120:123], v[80:95]
    v_cvt_pk_bf16_f32 v40, v40, v56
    v_mfma_f32_32x32x16_bf16 v[64:79], a[88:91], v[120:123], v[64:79]
    v_cvt_pk_bf16_f32 v41, v41, v57
    v_mfma_f32_32x32x16_bf16 v[80:95], a[56:59], v[104:107], v[80:95]
    v_cvt_pk_bf16_f32 v42, v42, v58
    v_mfma_f32_32x32x16_bf16 v[64:79], a[28:31], v[108:111], v[64:79]
    v_cvt_pk_bf16_f32 v43, v43, v59
    v_mfma_f32_32x32x16_bf16 v[80:95], a[28:31], v[124:127], v[80:95]
    v_cvt_pk_bf16_f32 v44, v44, v60
    v_mfma_f32_32x32x16_bf16 v[64:79], a[92:95], v[124:127], v[64:79]
    v_cvt_pk_bf16_f32 v45, v45, v61
    v_mfma_f32_32x32x16_bf16 v[80:95], a[60:63], v[108:111], v[80:95]
    v_cvt_pk_bf16_f32 v46, v46, v62
    v_cvt_pk_bf16_f32 v47, v47, v63
    s_nop 9
    v_cvt_pk_bf16_f32 v64, v64, v80
    v_cvt_pk_bf16_f32 v65, v65, v81
    v_cvt_pk_bf16_f32 v66, v66, v82
    v_cvt_pk_bf16_f32 v67, v67, v83
    v_cvt_pk_bf16_f32 v68, v68, v84
    v_cvt_pk_bf16_f32 v69, v69, v85
    v_cvt_pk_bf16_f32 v70, v70, v86
    v_cvt_pk_bf16_f32 v71, v71, v87
    v_cvt_pk_bf16_f32 v72, v72, v88
    v_cvt_pk_bf16_f32 v73, v73, v89
    v_cvt_pk_bf16_f32 v74, v74, v90
    v_cvt_pk_bf16_f32 v75, v75, v91
    v_cvt_pk_bf16_f32 v76, v76, v92
    v_cvt_pk_bf16_f32 v77, v77, v93
    v_cvt_pk_bf16_f32 v78, v78, v94
    v_cvt_pk_bf16_f32 v79, v79, v95
    s_cmp_eq_u32 s36, 2
    s_cbranch_scc1 F2_o1
    s_cmp_eq_u32 s36, 3
    s_cbranch_scc1 F2_o2
    s_cmp_eq_u32 s36, 4
    s_cbranch_scc1 F2_o3
    s_cmp_eq_u32 s36, 5
    s_cbranch_scc1 F2_o4
    v_accvgpr_write_b32 a120, v32
    v_accvgpr_write_b32 a124, v33
    v_accvgpr_write_b32 a128, v34
    v_accvgpr_write_b32 a132, v35
    v_accvgpr_write_b32 a136, v36
    v_accvgpr_write_b32 a140, v37
    v_accvgpr_write_b32 a144, v38
    v_accvgpr_write_b32 a148, v39
    v_accvgpr_write_b32 a152, v40
    v_accvgpr_write_b32 a156, v41
    v_accvgpr_write_b32 a160, v42
    v_accvgpr_write_b32 a164, v43
    v_accvgpr_write_b32 a168, v44
    v_accvgpr_write_b32 a172, v45
    v_accvgpr_write_b32 a176, v46
    v_accvgpr_write_b32 a180, v47
    v_accvgpr_write_b32 a184, v64
    v_accvgpr_write_b32 a188, v65
    v_accvgpr_write_b32 a192, v66
    v_accvgpr_write_b32 a196, v67
    v_accvgpr_write_b32 a200, v68
    v_accvgpr_write_b32 a204, v69
    v_accvgpr_write_b32 a208, v70
    v_accvgpr_write_b32 a212, v71
    v_accvgpr_write_b32 a216, v72
    v_accvgpr_write_b32 a220, v73
    v_accvgpr_write_b32 a224, v74
    v_accvgpr_write_b32 a228, v75
    v_accvgpr_write_b32 a232, v76
    v_accvgpr_write_b32 a236, v77
    v_accvgpr_write_b32 a240, v78
    v_accvgpr_write_b32 a244, v79
    s_branch F2_nx
F2_o1:
    v_accvgpr_write_b32 a121, v32
    v_accvgpr_write_b32 a125, v33
    v_accvgpr_write_b32 a129, v34
    v_accvgpr_write_b32 a133, v35
    v_accvgpr_write_b32 a137, v36
    v_accvgpr_write_b32 a141, v37
    v_accvgpr_write_b32 a145, v38
    v_accvgpr_write_b32 a149, v39
    v_accvgpr_write_b32 a153, v40
    v_accvgpr_write_b32 a157, v41
    v_accvgpr_write_b32 a161, v42
    v_accvgpr_write_b32 a165, v43
    v_accvgpr_write_b32 a169, v44
    v_accvgpr_write_b32 a173, v45
    v_accvgpr_write_b32 a177, v46
    v_accvgpr_write_b32 a181, v47
    v_accvgpr_write_b32 a185, v64
    v_accvgpr_write_b32 a189, v65
    v_accvgpr_write_b32 a193, v66
    v_accvgpr_write_b32 a197, v67
    v_accvgpr_write_b32 a201, v68
    v_accvgpr_write_b32 a205, v69
    v_accvgpr_write_b32 a209, v70
    v_accvgpr_write_b32 a213, v71
    v_accvgpr_write_b32 a217, v72
    v_accvgpr_write_b32 a221, v73
    v_accvgpr_write_b32 a225, v74
    v_accvgpr_write_b32 a229, v75
    v_accvgpr_write_b32 a233, v76
    v_accvgpr_write_b32 a237, v77
    v_accvgpr_write_b32 a241, v78
    v_accvgpr_write_b32 a245, v79
    s_branch F2_nx
F2_o2:
    v_accvgpr_write_b32 a122, v32
    v_accvgpr_write_b32 a126, v33
    v_accvgpr_write_b32 a130, v34
    v_accvgpr_write_b32 a134, v35
    v_accvgpr_write_b32 a138, v36
    v_accvgpr_write_b32 a142, v37
    v_accvgpr_write_b32 a146, v38
    v_accvgpr_write_b32 a150, v39
    v_accvgpr_write_b32 a154, v40
    v_accvgpr_write_b32 a158, v41
    v_accvgpr_write_b32 a162, v42
    v_accvgpr_write_b32 a166, v43
    v_accvgpr_write_b32 a170, v44
    v_accvgpr_write_b32 a174, v45
    v_accvgpr_write_b32 a178, v46
    v_accvgpr_write_b32 a182, v47
    v_accvgpr_write_b32 a186, v64
    v_accvgpr_write_b32 a190, v65
    v_accvgpr_write_b32 a194, v66
    v_accvgpr_write_b32 a198, v67
    v_accvgpr_write_b32 a202, v68
    v_accvgpr_write_b32 a206, v69
    v_accvgpr_write_b32 a210, v70
    v_accvgpr_write_b32 a214, v71
    v_accvgpr_write_b32 a218, v72
    v_accvgpr_write_b32 a222, v73
    v_accvgpr_write_b32 a226, v74
    v_accvgpr_write_b32 a230, v75
    v_accvgpr_write_b32 a234, v76
    v_accvgpr_write_b32 a238, v77
    v_accvgpr_write_b32 a242, v78
    v_accvgpr_write_b32 a246, v79
    s_branch F2_nx
F2_o3:
    v_accvgpr_write_b32 a123, v32
    v_accvgpr_write_b32 a127, v33
    v_accvgpr_write_b32 a131, v34
    v_accvgpr_write_b32 a135, v35
    v_accvgpr_write_b32 a139, v36
    v_accvgpr_write_b32 a143, v37
    v_accvgpr_write_b32 a147, v38
    v_accvgpr_write_b32 a151, v39
    v_accvgpr_write_b32 a155, v40
    v_accvgpr_write_b32 a159, v41
    v_accvgpr_write_b32 a163, v42
    v_accvgpr_write_b32 a167, v43
    v_accvgpr_write_b32 a171, v44
    v_accvgpr_write_b32 a175, v45
    v_accvgpr_write_b32 a179, v46
    v_accvgpr_write_b32 a183, v47
    v_accvgpr_write_b32 a187, v64
    v_accvgpr_write_b32 a191, v65
    v_accvgpr_write_b32 a195, v66
    v_accvgpr_write_b32 a199, v67
    v_accvgpr_write_b32 a203, v68
    v_accvgpr_write_b32 a207, v69
    v_accvgpr_write_b32 a211, v70
    v_accvgpr_write_b32 a215, v71
    v_accvgpr_write_b32 a219, v72
    v_accvgpr_write_b32 a223, v73
    v_accvgpr_write_b32 a227, v74
    v_accvgpr_write_b32 a231, v75
    v_accvgpr_write_b32 a235, v76
    v_accvgpr_write_b32 a239, v77
    v_accvgpr_write_b32 a243, v78
    v_accvgpr_write_b32 a247, v79
    s_branch F2_nx
F2_o4:
    v_accvgpr_read_b32 v5, a120
    v_lshlrev_b32 v6, 16, v32
    v_bfi_b32 v5, s38, v6, v5
    v_accvgpr_write_b32 a120, v5
    v_accvgpr_read_b32 v5, a124
    v_lshlrev_b32 v6, 16, v33
    v_bfi_b32 v5, s38, v6, v5
    v_accvgpr_write_b32 a124, v5
    v_accvgpr_read_b32 v5, a128
    v_lshlrev_b32 v6, 16, v34
    v_bfi_b32 v5, s38, v6, v5
    v_accvgpr_write_b32 a128, v5
    v_accvgpr_read_b32 v5, a132
    v_lshlrev_b32 v6, 16, v35
    v_bfi_b32 v5, s38, v6, v5
    v_accvgpr_write_b32 a132, v5
    v_accvgpr_read_b32 v5, a136
    v_lshlrev_b32 v6, 16, v36
    v_bfi_b32 v5, s38, v6, v5
    v_accvgpr_write_b32 a136, v5
    v_accvgpr_read_b32 v5, a140
    v_lshlrev_b32 v6, 16, v37
    v_bfi_b32 v5, s38, v6, v5
    v_accvgpr_write_b32 a140, v5
    v_accvgpr_read_b32 v5, a144
    v_lshlrev_b32 v6, 16, v38
    v_bfi_b32 v5, s38, v6, v5
    v_accvgpr_write_b32 a144, v5
    v_accvgpr_read_b32 v5, a148
    v_lshlrev_b32 v6, 16, v39
    v_bfi_b32 v5, s38, v6, v5
    v_accvgpr_write_b32 a148, v5
    v_accvgpr_read_b32 v5, a152
    v_lshlrev_b32 v6, 16, v40
    v_bfi_b32 v5, s38, v6, v5
    v_accvgpr_write_b32 a152, v5
    v_accvgpr_read_b32 v5, a156
    v_lshlrev_b32 v6, 16, v41
    v_bfi_b32 v5, s38, v6, v5
    v_accvgpr_write_b32 a156, v5
    v_accvgpr_read_b32 v5, a160
    v_lshlrev_b32 v6, 16, v42
    v_bfi_b32 v5, s38, v6, v5
    v_accvgpr_write_b32 a160, v5
    v_accvgpr_read_b32 v5, a164
    v_lshlrev_b32 v6, 16, v43
    v_bfi_b32 v5, s38, v6, v5
    v_accvgpr_write_b32 a164, v5
    v_accvgpr_read_b32 v5, a168
    v_lshlrev_b32 v6, 16, v44
    v_bfi_b32 v5, s38, v6, v5
    v_accvgpr_write_b32 a168, v5
    v_accvgpr_read_b32 v5, a172
    v_lshlrev_b32 v6, 16, v45
    v_bfi_b32 v5, s38, v6, v5
    v_accvgpr_write_b32 a172, v5
    v_accvgpr_read_b32 v5, a176
    v_lshlrev_b32 v6, 16, v46
    v_bfi_b32 v5, s38, v6, v5
    v_accvgpr_write_b32 a176, v5
    v_accvgpr_read_b32 v5, a180
    v_lshlrev_b32 v6, 16, v47
    v_bfi_b32 v5, s38, v6, v5
    v_accvgpr_write_b32 a180, v5
    v_accvgpr_read_b32 v5, a184
    v_lshlrev_b32 v6, 16, v64
    v_bfi_b32 v5, s38, v6, v5
    v_accvgpr_write_b32 a184, v5
    v_accvgpr_read_b32 v5, a188
    v_lshlrev_b32 v6, 16, v65
    v_bfi_b32 v5, s38, v6, v5
    v_accvgpr_write_b32 a188, v5
    v_accvgpr_read_b32 v5, a192
    v_lshlrev_b32 v6, 16, v66
    v_bfi_b32 v5, s38, v6, v5
    v_accvgpr_write_b32 a192, v5
    v_accvgpr_read_b32 v5, a196
    v_lshlrev_b32 v6, 16, v67
    v_bfi_b32 v5, s38, v6, v5
    v_accvgpr_write_b32 a196, v5
    v_accvgpr_read_b32 v5, a200
    v_lshlrev_b32 v6, 16, v68
    v_bfi_b32 v5, s38, v6, v5
    v_accvgpr_write_b32 a200, v5
    v_accvgpr_read_b32 v5, a204
    v_lshlrev_b32 v6, 16, v69
    v_bfi_b32 v5, s38, v6, v5
    v_accvgpr_write_b32 a204, v5
    v_accvgpr_read_b32 v5, a208
    v_lshlrev_b32 v6, 16, v70
    v_bfi_b32 v5, s38, v6, v5
    v_accvgpr_write_b32 a208, v5
    v_accvgpr_read_b32 v5, a212
    v_lshlrev_b32 v6, 16, v71
    v_bfi_b32 v5, s38, v6, v5
    v_accvgpr_write_b32 a212, v5
    v_accvgpr_read_b32 v5, a216
    v_lshlrev_b32 v6, 16, v72
    v_bfi_b32 v5, s38, v6, v5
    v_accvgpr_write_b32 a216, v5
    v_accvgpr_read_b32 v5, a220
    v_lshlrev_b32 v6, 16, v73
    v_bfi_b32 v5, s38, v6, v5
    v_accvgpr_write_b32 a220, v5
    v_accvgpr_read_b32 v5, a224
    v_lshlrev_b32 v6, 16, v74
    v_bfi_b32 v5, s38, v6, v5
    v_accvgpr_write_b32 a224, v5
    v_accvgpr_read_b32 v5, a228
    v_lshlrev_b32 v6, 16, v75
    v_bfi_b32 v5, s38, v6, v5
    v_accvgpr_write_b32 a228, v5
    v_accvgpr_read_b32 v5, a232
    v_lshlrev_b32 v6, 16, v76
    v_bfi_b32 v5, s38, v6, v5
    v_accvgpr_write_b32 a232, v5
    v_accvgpr_read_b32 v5, a236
    v_lshlrev_b32 v6, 16, v77
    v_bfi_b32 v5, s38, v6, v5
    v_accvgpr_write_b32 a236, v5
    v_accvgpr_read_b32 v5, a240
    v_lshlrev_b32 v6, 16, v78
    v_bfi_b32 v5, s38, v6, v5
    v_accvgpr_write_b32 a240, v5
    v_accvgpr_read_b32 v5, a244
    v_lshlrev_b32 v6, 16, v79
    v_bfi_b32 v5, s38, v6, v5
    v_accvgpr_write_b32 a244, v5
F2_nx:
    s_add_u32 s35, s35, 8192
    s_bitcmp1_b32 s36, 0
    s_cselect_b32 s17, 0, 2068416
    s_add_u32 s34, s34, 1050624
    s_sub_u32 s34, s34, s17
    s_cmp_eq_u32 s36, 4
    s_cselect_b32 s35, 133120, s35
    s_cselect_b32 s34, 1073741824, s34
    s_cmp_lt_u32 s36, s37
    s_cbranch_scc1 F2_top
    s_mul_i32 s21, s31, 33024
    s_add_u32 s21, s21, 111149056
    s_add_u32 s17, s21, 0
    buffer_store_dwordx4 a[120:123], v18, s[4:7], s17 offen offset:0 sc1
    buffer_store_dwordx4 a[124:127], v18, s[4:7], s17 offen offset:512 sc1
    buffer_store_dwordx4 a[128:131], v18, s[4:7], s17 offen offset:1024 sc1
    buffer_store_dwordx4 a[132:135], v18, s[4:7], s17 offen offset:1536 sc1
    buffer_store_dwordx4 a[136:139], v18, s[4:7], s17 offen offset:2048 sc1
    buffer_store_dwordx4 a[140:143], v18, s[4:7], s17 offen offset:2560 sc1
    buffer_store_dwordx4 a[144:147], v18, s[4:7], s17 offen offset:3072 sc1
    buffer_store_dwordx4 a[148:151], v18, s[4:7], s17 offen offset:3584 sc1
    s_add_u32 s17, s21, 8192
    buffer_store_dwordx4 a[152:155], v18, s[4:7], s17 offen offset:0 sc1
    buffer_store_dwordx4 a[156:159], v18, s[4:7], s17 offen offset:512 sc1
    buffer_store_dwordx4 a[160:163], v18, s[4:7], s17 offen offset:1024 sc1
    buffer_store_dwordx4 a[164:167], v18, s[4:7], s17 offen offset:1536 sc1
    buffer_store_dwordx4 a[168:171], v18, s[4:7], s17 offen offset:2048 sc1
    buffer_store_dwordx4 a[172:175], v18, s[4:7], s17 offen offset:2560 sc1
    buffer_store_dwordx4 a[176:179], v18, s[4:7], s17 offen offset:3072 sc1
    buffer_store_dwordx4 a[180:183], v18, s[4:7], s17 offen offset:3584 sc1
    s_add_u32 s17, s21, 16384
    buffer_store_dwordx4 a[184:187], v18, s[4:7], s17 offen offset:0 sc1
    buffer_store_dwordx4 a[188:191], v18, s[4:7], s17 offen offset:512 sc1
    buffer_store_dwordx4 a[192:195], v18, s[4:7], s17 offen offset:1024 sc1
    buffer_store_dwordx4 a[196:199], v18, s[4:7], s17 offen offset:1536 sc1
    buffer_store_dwordx4 a[200:203], v18, s[4:7], s17 offen offset:2048 sc1
    buffer_store_dwordx4 a[204:207], v18, s[4:7], s17 offen offset:2560 sc1
    buffer_store_dwordx4 a[208:211], v18, s[4:7], s17 offen offset:3072 sc1
    buffer_store_dwordx4 a[212:215], v18, s[4:7], s17 offen offset:3584 sc1
    s_add_u32 s17, s21, 24576
    buffer_store_dwordx4 a[216:219], v18, s[4:7], s17 offen offset:0 sc1
    buffer_store_dwordx4 a[220:223], v18, s[4:7], s17 offen offset:512 sc1
    buffer_store_dwordx4 a[224:227], v18, s[4:7], s17 offen offset:1024 sc1
    buffer_store_dwordx4 a[228:231], v18, s[4:7], s17 offen offset:1536 sc1
    buffer_store_dwordx4 a[232:235], v18, s[4:7], s17 offen offset:2048 sc1
    buffer_store_dwordx4 a[236:239], v18, s[4:7], s17 offen offset:2560 sc1
    buffer_store_dwordx4 a[240:243], v18, s[4:7], s17 offen offset:3072 sc1
    buffer_store_dwordx4 a[244:247], v18, s[4:7], s17 offen offset:3584 sc1
    s_waitcnt vmcnt(0)
    s_lshl_b32 s17, s31, 7
    s_add_u32 s17, s17, 100761600
    v_lshl_add_u32 v5, v1, 2, s17
    v_mov_b32 v6, 1
    s_mov_b64 exec, 0xffffffff
    buffer_store_dword v6, v5, s[4:7], 0 offen sc1
    s_mov_b64 exec, -1
    v_bfe_u32 v5, v1, 2, 2
    v_and_b32 v7, 3, v1
    v_lshl_add_u32 v7, v5, 3, v7
    s_lshl_b32 s17, s29, 5
    v_add_u32 v7, s17, v7
    v_lshrrev_b32 v8, 4, v1
    v_cvt_f32_u32 v8, v8
    s_mov_b32 s31, 981467136
    v_and_b32 v38, 1, v7
    v_add_u32 v5, 0, v7
    v_cvt_f32_u32 v6, v5
    v_mul_f32 v6, s31, v6
    v_mov_b32 v32, 0x3e800000
    v_sub_f32 v34, v6, v32
    v_mul_f32 v36, 0x41800000, v6
    v_mul_f32 v5, 4.0, v6
    v_mul_f32 v30, v5, v8
    v_add_u32 v5, 4, v7
    v_cvt_f32_u32 v6, v5
    v_mul_f32 v6, s31, v6
    v_mov_b32 v33, 0x3e800000
    v_sub_f32 v35, v6, v33
    v_mul_f32 v37, 0x41800000, v6
    v_mul_f32 v5, 4.0, v6
    v_mul_f32 v31, v5, v8
    v_lshlrev_b32 v40, 4, v38
    v_bfe_u32 v5, v7, 1, 1
    v_add_u32 v6, 1, v7
    v_bfe_u32 v6, v6, 1, 1
    v_lshlrev_b32 v5, 15, v5
    v_lshl_or_b32 v41, v6, 31, v5
    v_fract_f32 v48, v30
    v_add_f32 v49, v48, v32
    v_cos_f32 v56, v48
    v_add_f32 v50, v49, v34
    v_cos_f32 v57, v49
    v_add_f32 v51, v50, v32
    v_cos_f32 v58, v50
    v_add_f32 v52, v51, v34
    v_cos_f32 v59, v51
    v_add_f32 v53, v52, v32
    v_cos_f32 v60, v52
    v_add_f32 v54, v53, v34
    v_cos_f32 v61, v53
    v_add_f32 v55, v54, v32
    v_cos_f32 v62, v54
    v_cos_f32 v63, v55
    v_add_f32 v30, v48, v36
    v_cvt_pk_bf16_f32 v64, v56, v57
    v_cvt_pk_bf16_f32 v65, v58, v59
    v_cvt_pk_bf16_f32 v66, v60, v61
    v_cvt_pk_bf16_f32 v67, v62, v63
    v_accvgpr_write_b32 a0, v64
    v_accvgpr_write_b32 a1, v65
    v_accvgpr_write_b32 a2, v66
    v_accvgpr_write_b32 a3, v67
    v_alignbit_b32 v68, v64, v64, v40
    v_xor_b32 v68, v68, v41
    v_alignbit_b32 v69, v65, v65, v40
    v_xor_b32 v69, v69, v41
    v_alignbit_b32 v70, v66, v66, v40
    v_xor_b32 v70, v70, v41
    v_alignbit_b32 v71, v67, v67, v40
    v_xor_b32 v71, v71, v41
    v_accvgpr_write_b32 a128, v68
    v_accvgpr_write_b32 a129, v69
    v_accvgpr_write_b32 a130, v70
    v_accvgpr_write_b32 a131, v71
    v_fract_f32 v48, v31
    v_add_f32 v49, v48, v33
    v_cos_f32 v56, v48
    v_add_f32 v50, v49, v35
    v_cos_f32 v57, v49
    v_add_f32 v51, v50, v33
    v_cos_f32 v58, v50
    v_add_f32 v52, v51, v35
    v_cos_f32 v59, v51
    v_add_f32 v53, v52, v33
    v_cos_f32 v60, v52
    v_add_f32 v54, v53, v35
    v_cos_f32 v61, v53
    v_add_f32 v55, v54, v33
    v_cos_f32 v62, v54
    v_cos_f32 v63, v55
    v_add_f32 v31, v48, v37
    v_cvt_pk_bf16_f32 v64, v56, v57
    v_cvt_pk_bf16_f32 v65, v58, v59
    v_cvt_pk_bf16_f32 v66, v60, v61
    v_cvt_pk_bf16_f32 v67, v62, v63
    v_accvgpr_write_b32 a4, v64
    v_accvgpr_write_b32 a5, v65
    v_accvgpr_write_b32 a6, v66
    v_accvgpr_write_b32 a7, v67
    v_alignbit_b32 v68, v64, v64, v40
    v_xor_b32 v68, v68, v41
    v_alignbit_b32 v69, v65, v65, v40
    v_xor_b32 v69, v69, v41
    v_alignbit_b32 v70, v66, v66, v40
    v_xor_b32 v70, v70, v41
    v_alignbit_b32 v71, v67, v67, v40
    v_xor_b32 v71, v71, v41
    v_accvgpr_write_b32 a132, v68
    v_accvgpr_write_b32 a133, v69
    v_accvgpr_write_b32 a134, v70
    v_accvgpr_write_b32 a135, v71
    v_fract_f32 v48, v30
    v_add_f32 v49, v48, v32
    v_cos_f32 v56, v48
    v_add_f32 v50, v49, v34
    v_cos_f32 v57, v49
    v_add_f32 v51, v50, v32
    v_cos_f32 v58, v50
    v_add_f32 v52, v51, v34
    v_cos_f32 v59, v51
    v_add_f32 v53, v52, v32
    v_cos_f32 v60, v52
    v_add_f32 v54, v53, v34
    v_cos_f32 v61, v53
    v_add_f32 v55, v54, v32
    v_cos_f32 v62, v54
    v_cos_f32 v63, v55
    v_add_f32 v30, v48, v36
    v_cvt_pk_bf16_f32 v64, v56, v57
    v_cvt_pk_bf16_f32 v65, v58, v59
    v_cvt_pk_bf16_f32 v66, v60, v61
    v_cvt_pk_bf16_f32 v67, v62, v63
    v_accvgpr_write_b32 a8, v64
    v_accvgpr_write_b32 a9, v65
    v_accvgpr_write_b32 a10, v66
    v_accvgpr_write_b32 a11, v67
    v_alignbit_b32 v68, v64, v64, v40
    v_xor_b32 v68, v68, v41
    v_alignbit_b32 v69, v65, v65, v40
    v_xor_b32 v69, v69, v41
    v_alignbit_b32 v70, v66, v66, v40
    v_xor_b32 v70, v70, v41
    v_alignbit_b32 v71, v67, v67, v40
    v_xor_b32 v71, v71, v41
    v_accvgpr_write_b32 a136, v68
    v_accvgpr_write_b32 a137, v69
    v_accvgpr_write_b32 a138, v70
    v_accvgpr_write_b32 a139, v71
    v_fract_f32 v48, v31
    v_add_f32 v49, v48, v33
    v_cos_f32 v56, v48
    v_add_f32 v50, v49, v35
    v_cos_f32 v57, v49
    v_add_f32 v51, v50, v33
    v_cos_f32 v58, v50
    v_add_f32 v52, v51, v35
    v_cos_f32 v59, v51
    v_add_f32 v53, v52, v33
    v_cos_f32 v60, v52
    v_add_f32 v54, v53, v35
    v_cos_f32 v61, v53
    v_add_f32 v55, v54, v33
    v_cos_f32 v62, v54
    v_cos_f32 v63, v55
    v_add_f32 v31, v48, v37
    v_cvt_pk_bf16_f32 v64, v56, v57
    v_cvt_pk_bf16_f32 v65, v58, v59
    v_cvt_pk_bf16_f32 v66, v60, v61
    v_cvt_pk_bf16_f32 v67, v62, v63
    v_accvgpr_write_b32 a12, v64
    v_accvgpr_write_b32 a13, v65
    v_accvgpr_write_b32 a14, v66
    v_accvgpr_write_b32 a15, v67
    v_alignbit_b32 v68, v64, v64, v40
    v_xor_b32 v68, v68, v41
    v_alignbit_b32 v69, v65, v65, v40
    v_xor_b32 v69, v69, v41
    v_alignbit_b32 v70, v66, v66, v40
    v_xor_b32 v70, v70, v41
    v_alignbit_b32 v71, v67, v67, v40
    v_xor_b32 v71, v71, v41
    v_accvgpr_write_b32 a140, v68
    v_accvgpr_write_b32 a141, v69
    v_accvgpr_write_b32 a142, v70
    v_accvgpr_write_b32 a143, v71
    v_fract_f32 v48, v30
    v_add_f32 v49, v48, v32
    v_cos_f32 v56, v48
    v_add_f32 v50, v49, v34
    v_cos_f32 v57, v49
    v_add_f32 v51, v50, v32
    v_cos_f32 v58, v50
    v_add_f32 v52, v51, v34
    v_cos_f32 v59, v51
    v_add_f32 v53, v52, v32
    v_cos_f32 v60, v52
    v_add_f32 v54, v53, v34
    v_cos_f32 v61, v53
    v_add_f32 v55, v54, v32
    v_cos_f32 v62, v54
    v_cos_f32 v63, v55
    v_add_f32 v30, v48, v36
    v_cvt_pk_bf16_f32 v64, v56, v57
    v_cvt_pk_bf16_f32 v65, v58, v59
    v_cvt_pk_bf16_f32 v66, v60, v61
    v_cvt_pk_bf16_f32 v67, v62, v63
    v_accvgpr_write_b32 a16, v64
    v_accvgpr_write_b32 a17, v65
    v_accvgpr_write_b32 a18, v66
    v_accvgpr_write_b32 a19, v67
    v_alignbit_b32 v68, v64, v64, v40
    v_xor_b32 v68, v68, v41
    v_alignbit_b32 v69, v65, v65, v40
    v_xor_b32 v69, v69, v41
    v_alignbit_b32 v70, v66, v66, v40
    v_xor_b32 v70, v70, v41
    v_alignbit_b32 v71, v67, v67, v40
    v_xor_b32 v71, v71, v41
    v_accvgpr_write_b32 a144, v68
    v_accvgpr_write_b32 a145, v69
    v_accvgpr_write_b32 a146, v70
    v_accvgpr_write_b32 a147, v71
    v_fract_f32 v48, v31
    v_add_f32 v49, v48, v33
    v_cos_f32 v56, v48
    v_add_f32 v50, v49, v35
    v_cos_f32 v57, v49
    v_add_f32 v51, v50, v33
    v_cos_f32 v58, v50
    v_add_f32 v52, v51, v35
    v_cos_f32 v59, v51
    v_add_f32 v53, v52, v33
    v_cos_f32 v60, v52
    v_add_f32 v54, v53, v35
    v_cos_f32 v61, v53
    v_add_f32 v55, v54, v33
    v_cos_f32 v62, v54
    v_cos_f32 v63, v55
    v_add_f32 v31, v48, v37
    v_cvt_pk_bf16_f32 v64, v56, v57
    v_cvt_pk_bf16_f32 v65, v58, v59
    v_cvt_pk_bf16_f32 v66, v60, v61
    v_cvt_pk_bf16_f32 v67, v62, v63
    v_accvgpr_write_b32 a20, v64
    v_accvgpr_write_b32 a21, v65
    v_accvgpr_write_b32 a22, v66
    v_accvgpr_write_b32 a23, v67
    v_alignbit_b32 v68, v64, v64, v40
    v_xor_b32 v68, v68, v41
    v_alignbit_b32 v69, v65, v65, v40
    v_xor_b32 v69, v69, v41
    v_alignbit_b32 v70, v66, v66, v40
    v_xor_b32 v70, v70, v41
    v_alignbit_b32 v71, v67, v67, v40
    v_xor_b32 v71, v71, v41
    v_accvgpr_write_b32 a148, v68
    v_accvgpr_write_b32 a149, v69
    v_accvgpr_write_b32 a150, v70
    v_accvgpr_write_b32 a151, v71
    v_fract_f32 v48, v30
    v_add_f32 v49, v48, v32
    v_cos_f32 v56, v48
    v_add_f32 v50, v49, v34
    v_cos_f32 v57, v49
    v_add_f32 v51, v50, v32
    v_cos_f32 v58, v50
    v_add_f32 v52, v51, v34
    v_cos_f32 v59, v51
    v_add_f32 v53, v52, v32
    v_cos_f32 v60, v52
    v_add_f32 v54, v53, v34
    v_cos_f32 v61, v53
    v_add_f32 v55, v54, v32
    v_cos_f32 v62, v54
    v_cos_f32 v63, v55
    v_add_f32 v30, v48, v36
    v_cvt_pk_bf16_f32 v64, v56, v57
    v_cvt_pk_bf16_f32 v65, v58, v59
    v_cvt_pk_bf16_f32 v66, v60, v61
    v_cvt_pk_bf16_f32 v67, v62, v63
    v_accvgpr_write_b32 a24, v64
    v_accvgpr_write_b32 a25, v65
    v_accvgpr_write_b32 a26, v66
    v_accvgpr_write_b32 a27, v67
    v_alignbit_b32 v68, v64, v64, v40
    v_xor_b32 v68, v68, v41
    v_alignbit_b32 v69, v65, v65, v40
    v_xor_b32 v69, v69, v41
    v_alignbit_b32 v70, v66, v66, v40
    v_xor_b32 v70, v70, v41
    v_alignbit_b32 v71, v67, v67, v40
    v_xor_b32 v71, v71, v41
    v_accvgpr_write_b32 a152, v68
    v_accvgpr_write_b32 a153, v69
    v_accvgpr_write_b32 a154, v70
    v_accvgpr_write_b32 a155, v71
    v_fract_f32 v48, v31
    v_add_f32 v49, v48, v33
    v_cos_f32 v56, v48
    v_add_f32 v50, v49, v35
    v_cos_f32 v57, v49
    v_add_f32 v51, v50, v33
    v_cos_f32 v58, v50
    v_add_f32 v52, v51, v35
    v_cos_f32 v59, v51
    v_add_f32 v53, v52, v33
    v_cos_f32 v60, v52
    v_add_f32 v54, v53, v35
    v_cos_f32 v61, v53
    v_add_f32 v55, v54, v33
    v_cos_f32 v62, v54
    v_cos_f32 v63, v55
    v_add_f32 v31, v48, v37
    v_cvt_pk_bf16_f32 v64, v56, v57
    v_cvt_pk_bf16_f32 v65, v58, v59
    v_cvt_pk_bf16_f32 v66, v60, v61
    v_cvt_pk_bf16_f32 v67, v62, v63
    v_accvgpr_write_b32 a28, v64
    v_accvgpr_write_b32 a29, v65
    v_accvgpr_write_b32 a30, v66
    v_accvgpr_write_b32 a31, v67
    v_alignbit_b32 v68, v64, v64, v40
    v_xor_b32 v68, v68, v41
    v_alignbit_b32 v69, v65, v65, v40
    v_xor_b32 v69, v69, v41
    v_alignbit_b32 v70, v66, v66, v40
    v_xor_b32 v70, v70, v41
    v_alignbit_b32 v71, v67, v67, v40
    v_xor_b32 v71, v71, v41
    v_accvgpr_write_b32 a156, v68
    v_accvgpr_write_b32 a157, v69
    v_accvgpr_write_b32 a158, v70
    v_accvgpr_write_b32 a159, v71
    v_fract_f32 v48, v30
    v_add_f32 v49, v48, v32
    v_cos_f32 v56, v48
    v_add_f32 v50, v49, v34
    v_cos_f32 v57, v49
    v_add_f32 v51, v50, v32
    v_cos_f32 v58, v50
    v_add_f32 v52, v51, v34
    v_cos_f32 v59, v51
    v_add_f32 v53, v52, v32
    v_cos_f32 v60, v52
    v_add_f32 v54, v53, v34
    v_cos_f32 v61, v53
    v_add_f32 v55, v54, v32
    v_cos_f32 v62, v54
    v_cos_f32 v63, v55
    v_add_f32 v30, v48, v36
    v_cvt_pk_bf16_f32 v64, v56, v57
    v_cvt_pk_bf16_f32 v65, v58, v59
    v_cvt_pk_bf16_f32 v66, v60, v61
    v_cvt_pk_bf16_f32 v67, v62, v63
    v_accvgpr_write_b32 a32, v64
    v_accvgpr_write_b32 a33, v65
    v_accvgpr_write_b32 a34, v66
    v_accvgpr_write_b32 a35, v67
    v_alignbit_b32 v68, v64, v64, v40
    v_xor_b32 v68, v68, v41
    v_alignbit_b32 v69, v65, v65, v40
    v_xor_b32 v69, v69, v41
    v_alignbit_b32 v70, v66, v66, v40
    v_xor_b32 v70, v70, v41
    v_alignbit_b32 v71, v67, v67, v40
    v_xor_b32 v71, v71, v41
    v_accvgpr_write_b32 a160, v68
    v_accvgpr_write_b32 a161, v69
    v_accvgpr_write_b32 a162, v70
    v_accvgpr_write_b32 a163, v71
    v_fract_f32 v48, v31
    v_add_f32 v49, v48, v33
    v_cos_f32 v56, v48
    v_add_f32 v50, v49, v35
    v_cos_f32 v57, v49
    v_add_f32 v51, v50, v33
    v_cos_f32 v58, v50
    v_add_f32 v52, v51, v35
    v_cos_f32 v59, v51
    v_add_f32 v53, v52, v33
    v_cos_f32 v60, v52
    v_add_f32 v54, v53, v35
    v_cos_f32 v61, v53
    v_add_f32 v55, v54, v33
    v_cos_f32 v62, v54
    v_cos_f32 v63, v55
    v_add_f32 v31, v48, v37
    v_cvt_pk_bf16_f32 v64, v56, v57
    v_cvt_pk_bf16_f32 v65, v58, v59
    v_cvt_pk_bf16_f32 v66, v60, v61
    v_cvt_pk_bf16_f32 v67, v62, v63
    v_accvgpr_write_b32 a36, v64
    v_accvgpr_write_b32 a37, v65
    v_accvgpr_write_b32 a38, v66
    v_accvgpr_write_b32 a39, v67
    v_alignbit_b32 v68, v64, v64, v40
    v_xor_b32 v68, v68, v41
    v_alignbit_b32 v69, v65, v65, v40
    v_xor_b32 v69, v69, v41
    v_alignbit_b32 v70, v66, v66, v40
    v_xor_b32 v70, v70, v41
    v_alignbit_b32 v71, v67, v67, v40
    v_xor_b32 v71, v71, v41
    v_accvgpr_write_b32 a164, v68
    v_accvgpr_write_b32 a165, v69
    v_accvgpr_write_b32 a166, v70
    v_accvgpr_write_b32 a167, v71
    v_fract_f32 v48, v30
    v_add_f32 v49, v48, v32
    v_cos_f32 v56, v48
    v_add_f32 v50, v49, v34
    v_cos_f32 v57, v49
    v_add_f32 v51, v50, v32
    v_cos_f32 v58, v50
    v_add_f32 v52, v51, v34
    v_cos_f32 v59, v51
    v_add_f32 v53, v52, v32
    v_cos_f32 v60, v52
    v_add_f32 v54, v53, v34
    v_cos_f32 v61, v53
    v_add_f32 v55, v54, v32
    v_cos_f32 v62, v54
    v_cos_f32 v63, v55
    v_add_f32 v30, v48, v36
    v_cvt_pk_bf16_f32 v64, v56, v57
    v_cvt_pk_bf16_f32 v65, v58, v59
    v_cvt_pk_bf16_f32 v66, v60, v61
    v_cvt_pk_bf16_f32 v67, v62, v63
    v_accvgpr_write_b32 a40, v64
    v_accvgpr_write_b32 a41, v65
    v_accvgpr_write_b32 a42, v66
    v_accvgpr_write_b32 a43, v67
    v_alignbit_b32 v68, v64, v64, v40
    v_xor_b32 v68, v68, v41
    v_alignbit_b32 v69, v65, v65, v40
    v_xor_b32 v69, v69, v41
    v_alignbit_b32 v70, v66, v66, v40
    v_xor_b32 v70, v70, v41
    v_alignbit_b32 v71, v67, v67, v40
    v_xor_b32 v71, v71, v41
    v_accvgpr_write_b32 a168, v68
    v_accvgpr_write_b32 a169, v69
    v_accvgpr_write_b32 a170, v70
    v_accvgpr_write_b32 a171, v71
    v_fract_f32 v48, v31
    v_add_f32 v49, v48, v33
    v_cos_f32 v56, v48
    v_add_f32 v50, v49, v35
    v_cos_f32 v57, v49
    v_add_f32 v51, v50, v33
    v_cos_f32 v58, v50
    v_add_f32 v52, v51, v35
    v_cos_f32 v59, v51
    v_add_f32 v53, v52, v33
    v_cos_f32 v60, v52
    v_add_f32 v54, v53, v35
    v_cos_f32 v61, v53
    v_add_f32 v55, v54, v33
    v_cos_f32 v62, v54
    v_cos_f32 v63, v55
    v_add_f32 v31, v48, v37
    v_cvt_pk_bf16_f32 v64, v56, v57
    v_cvt_pk_bf16_f32 v65, v58, v59
    v_cvt_pk_bf16_f32 v66, v60, v61
    v_cvt_pk_bf16_f32 v67, v62, v63
    v_accvgpr_write_b32 a44, v64
    v_accvgpr_write_b32 a45, v65
    v_accvgpr_write_b32 a46, v66
    v_accvgpr_write_b32 a47, v67
    v_alignbit_b32 v68, v64, v64, v40
    v_xor_b32 v68, v68, v41
    v_alignbit_b32 v69, v65, v65, v40
    v_xor_b32 v69, v69, v41
    v_alignbit_b32 v70, v66, v66, v40
    v_xor_b32 v70, v70, v41
    v_alignbit_b32 v71, v67, v67, v40
    v_xor_b32 v71, v71, v41
    v_accvgpr_write_b32 a172, v68
    v_accvgpr_write_b32 a173, v69
    v_accvgpr_write_b32 a174, v70
    v_accvgpr_write_b32 a175, v71
    v_fract_f32 v48, v30
    v_add_f32 v49, v48, v32
    v_cos_f32 v56, v48
    v_add_f32 v50, v49, v34
    v_cos_f32 v57, v49
    v_add_f32 v51, v50, v32
    v_cos_f32 v58, v50
    v_add_f32 v52, v51, v34
    v_cos_f32 v59, v51
    v_add_f32 v53, v52, v32
    v_cos_f32 v60, v52
    v_add_f32 v54, v53, v34
    v_cos_f32 v61, v53
    v_add_f32 v55, v54, v32
    v_cos_f32 v62, v54
    v_cos_f32 v63, v55
    v_add_f32 v30, v48, v36
    v_cvt_pk_bf16_f32 v64, v56, v57
    v_cvt_pk_bf16_f32 v65, v58, v59
    v_cvt_pk_bf16_f32 v66, v60, v61
    v_cvt_pk_bf16_f32 v67, v62, v63
    v_accvgpr_write_b32 a48, v64
    v_accvgpr_write_b32 a49, v65
    v_accvgpr_write_b32 a50, v66
    v_accvgpr_write_b32 a51, v67
    v_alignbit_b32 v68, v64, v64, v40
    v_xor_b32 v68, v68, v41
    v_alignbit_b32 v69, v65, v65, v40
    v_xor_b32 v69, v69, v41
    v_alignbit_b32 v70, v66, v66, v40
    v_xor_b32 v70, v70, v41
    v_alignbit_b32 v71, v67, v67, v40
    v_xor_b32 v71, v71, v41
    v_accvgpr_write_b32 a176, v68
    v_accvgpr_write_b32 a177, v69
    v_accvgpr_write_b32 a178, v70
    v_accvgpr_write_b32 a179, v71
    v_fract_f32 v48, v31
    v_add_f32 v49, v48, v33
    v_cos_f32 v56, v48
    v_add_f32 v50, v49, v35
    v_cos_f32 v57, v49
    v_add_f32 v51, v50, v33
    v_cos_f32 v58, v50
    v_add_f32 v52, v51, v35
    v_cos_f32 v59, v51
    v_add_f32 v53, v52, v33
    v_cos_f32 v60, v52
    v_add_f32 v54, v53, v35
    v_cos_f32 v61, v53
    v_add_f32 v55, v54, v33
    v_cos_f32 v62, v54
    v_cos_f32 v63, v55
    v_add_f32 v31, v48, v37
    v_cvt_pk_bf16_f32 v64, v56, v57
    v_cvt_pk_bf16_f32 v65, v58, v59
    v_cvt_pk_bf16_f32 v66, v60, v61
    v_cvt_pk_bf16_f32 v67, v62, v63
    v_accvgpr_write_b32 a52, v64
    v_accvgpr_write_b32 a53, v65
    v_accvgpr_write_b32 a54, v66
    v_accvgpr_write_b32 a55, v67
    v_alignbit_b32 v68, v64, v64, v40
    v_xor_b32 v68, v68, v41
    v_alignbit_b32 v69, v65, v65, v40
    v_xor_b32 v69, v69, v41
    v_alignbit_b32 v70, v66, v66, v40
    v_xor_b32 v70, v70, v41
    v_alignbit_b32 v71, v67, v67, v40
    v_xor_b32 v71, v71, v41
    v_accvgpr_write_b32 a180, v68
    v_accvgpr_write_b32 a181, v69
    v_accvgpr_write_b32 a182, v70
    v_accvgpr_write_b32 a183, v71
    v_fract_f32 v48, v30
    v_add_f32 v49, v48, v32
    v_cos_f32 v56, v48
    v_add_f32 v50, v49, v34
    v_cos_f32 v57, v49
    v_add_f32 v51, v50, v32
    v_cos_f32 v58, v50
    v_add_f32 v52, v51, v34
    v_cos_f32 v59, v51
    v_add_f32 v53, v52, v32
    v_cos_f32 v60, v52
    v_add_f32 v54, v53, v34
    v_cos_f32 v61, v53
    v_add_f32 v55, v54, v32
    v_cos_f32 v62, v54
    v_cos_f32 v63, v55
    v_add_f32 v30, v48, v36
    v_cvt_pk_bf16_f32 v64, v56, v57
    v_cvt_pk_bf16_f32 v65, v58, v59
    v_cvt_pk_bf16_f32 v66, v60, v61
    v_cvt_pk_bf16_f32 v67, v62, v63
    v_accvgpr_write_b32 a56, v64
    v_accvgpr_write_b32 a57, v65
    v_accvgpr_write_b32 a58, v66
    v_accvgpr_write_b32 a59, v67
    v_alignbit_b32 v68, v64, v64, v40
    v_xor_b32 v68, v68, v41
    v_alignbit_b32 v69, v65, v65, v40
    v_xor_b32 v69, v69, v41
    v_alignbit_b32 v70, v66, v66, v40
    v_xor_b32 v70, v70, v41
    v_alignbit_b32 v71, v67, v67, v40
    v_xor_b32 v71, v71, v41
    v_accvgpr_write_b32 a184, v68
    v_accvgpr_write_b32 a185, v69
    v_accvgpr_write_b32 a186, v70
    v_accvgpr_write_b32 a187, v71
    v_fract_f32 v48, v31
    v_add_f32 v49, v48, v33
    v_cos_f32 v56, v48
    v_add_f32 v50, v49, v35
    v_cos_f32 v57, v49
    v_add_f32 v51, v50, v33
    v_cos_f32 v58, v50
    v_add_f32 v52, v51, v35
    v_cos_f32 v59, v51
    v_add_f32 v53, v52, v33
    v_cos_f32 v60, v52
    v_add_f32 v54, v53, v35
    v_cos_f32 v61, v53
    v_add_f32 v55, v54, v33
    v_cos_f32 v62, v54
    v_cos_f32 v63, v55
    v_add_f32 v31, v48, v37
    v_cvt_pk_bf16_f32 v64, v56, v57
    v_cvt_pk_bf16_f32 v65, v58, v59
    v_cvt_pk_bf16_f32 v66, v60, v61
    v_cvt_pk_bf16_f32 v67, v62, v63
    v_accvgpr_write_b32 a60, v64
    v_accvgpr_write_b32 a61, v65
    v_accvgpr_write_b32 a62, v66
    v_accvgpr_write_b32 a63, v67
    v_alignbit_b32 v68, v64, v64, v40
    v_xor_b32 v68, v68, v41
    v_alignbit_b32 v69, v65, v65, v40
    v_xor_b32 v69, v69, v41
    v_alignbit_b32 v70, v66, v66, v40
    v_xor_b32 v70, v70, v41
    v_alignbit_b32 v71, v67, v67, v40
    v_xor_b32 v71, v71, v41
    v_accvgpr_write_b32 a188, v68
    v_accvgpr_write_b32 a189, v69
    v_accvgpr_write_b32 a190, v70
    v_accvgpr_write_b32 a191, v71
    v_fract_f32 v48, v30
    v_add_f32 v49, v48, v32
    v_cos_f32 v56, v48
    v_add_f32 v50, v49, v34
    v_cos_f32 v57, v49
    v_add_f32 v51, v50, v32
    v_cos_f32 v58, v50
    v_add_f32 v52, v51, v34
    v_cos_f32 v59, v51
    v_add_f32 v53, v52, v32
    v_cos_f32 v60, v52
    v_add_f32 v54, v53, v34
    v_cos_f32 v61, v53
    v_add_f32 v55, v54, v32
    v_cos_f32 v62, v54
    v_cos_f32 v63, v55
    v_add_f32 v30, v48, v36
    v_cvt_pk_bf16_f32 v64, v56, v57
    v_cvt_pk_bf16_f32 v65, v58, v59
    v_cvt_pk_bf16_f32 v66, v60, v61
    v_cvt_pk_bf16_f32 v67, v62, v63
    v_accvgpr_write_b32 a64, v64
    v_accvgpr_write_b32 a65, v65
    v_accvgpr_write_b32 a66, v66
    v_accvgpr_write_b32 a67, v67
    v_alignbit_b32 v68, v64, v64, v40
    v_xor_b32 v68, v68, v41
    v_alignbit_b32 v69, v65, v65, v40
    v_xor_b32 v69, v69, v41
    v_alignbit_b32 v70, v66, v66, v40
    v_xor_b32 v70, v70, v41
    v_alignbit_b32 v71, v67, v67, v40
    v_xor_b32 v71, v71, v41
    v_accvgpr_write_b32 a192, v68
    v_accvgpr_write_b32 a193, v69
    v_accvgpr_write_b32 a194, v70
    v_accvgpr_write_b32 a195, v71
    v_fract_f32 v48, v31
    v_add_f32 v49, v48, v33
    v_cos_f32 v56, v48
    v_add_f32 v50, v49, v35
    v_cos_f32 v57, v49
    v_add_f32 v51, v50, v33
    v_cos_f32 v58, v50
    v_add_f32 v52, v51, v35
    v_cos_f32 v59, v51
    v_add_f32 v53, v52, v33
    v_cos_f32 v60, v52
    v_add_f32 v54, v53, v35
    v_cos_f32 v61, v53
    v_add_f32 v55, v54, v33
    v_cos_f32 v62, v54
    v_cos_f32 v63, v55
    v_add_f32 v31, v48, v37
    v_cvt_pk_bf16_f32 v64, v56, v57
    v_cvt_pk_bf16_f32 v65, v58, v59
    v_cvt_pk_bf16_f32 v66, v60, v61
    v_cvt_pk_bf16_f32 v67, v62, v63
    v_accvgpr_write_b32 a68, v64
    v_accvgpr_write_b32 a69, v65
    v_accvgpr_write_b32 a70, v66
    v_accvgpr_write_b32 a71, v67
    v_alignbit_b32 v68, v64, v64, v40
    v_xor_b32 v68, v68, v41
    v_alignbit_b32 v69, v65, v65, v40
    v_xor_b32 v69, v69, v41
    v_alignbit_b32 v70, v66, v66, v40
    v_xor_b32 v70, v70, v41
    v_alignbit_b32 v71, v67, v67, v40
    v_xor_b32 v71, v71, v41
    v_accvgpr_write_b32 a196, v68
    v_accvgpr_write_b32 a197, v69
    v_accvgpr_write_b32 a198, v70
    v_accvgpr_write_b32 a199, v71
    v_fract_f32 v48, v30
    v_add_f32 v49, v48, v32
    v_cos_f32 v56, v48
    v_add_f32 v50, v49, v34
    v_cos_f32 v57, v49
    v_add_f32 v51, v50, v32
    v_cos_f32 v58, v50
    v_add_f32 v52, v51, v34
    v_cos_f32 v59, v51
    v_add_f32 v53, v52, v32
    v_cos_f32 v60, v52
    v_add_f32 v54, v53, v34
    v_cos_f32 v61, v53
    v_add_f32 v55, v54, v32
    v_cos_f32 v62, v54
    v_cos_f32 v63, v55
    v_add_f32 v30, v48, v36
    v_cvt_pk_bf16_f32 v64, v56, v57
    v_cvt_pk_bf16_f32 v65, v58, v59
    v_cvt_pk_bf16_f32 v66, v60, v61
    v_cvt_pk_bf16_f32 v67, v62, v63
    v_accvgpr_write_b32 a72, v64
    v_accvgpr_write_b32 a73, v65
    v_accvgpr_write_b32 a74, v66
    v_accvgpr_write_b32 a75, v67
    v_alignbit_b32 v68, v64, v64, v40
    v_xor_b32 v68, v68, v41
    v_alignbit_b32 v69, v65, v65, v40
    v_xor_b32 v69, v69, v41
    v_alignbit_b32 v70, v66, v66, v40
    v_xor_b32 v70, v70, v41
    v_alignbit_b32 v71, v67, v67, v40
    v_xor_b32 v71, v71, v41
    v_accvgpr_write_b32 a200, v68
    v_accvgpr_write_b32 a201, v69
    v_accvgpr_write_b32 a202, v70
    v_accvgpr_write_b32 a203, v71
    v_fract_f32 v48, v31
    v_add_f32 v49, v48, v33
    v_cos_f32 v56, v48
    v_add_f32 v50, v49, v35
    v_cos_f32 v57, v49
    v_add_f32 v51, v50, v33
    v_cos_f32 v58, v50
    v_add_f32 v52, v51, v35
    v_cos_f32 v59, v51
    v_add_f32 v53, v52, v33
    v_cos_f32 v60, v52
    v_add_f32 v54, v53, v35
    v_cos_f32 v61, v53
    v_add_f32 v55, v54, v33
    v_cos_f32 v62, v54
    v_cos_f32 v63, v55
    v_add_f32 v31, v48, v37
    v_cvt_pk_bf16_f32 v64, v56, v57
    v_cvt_pk_bf16_f32 v65, v58, v59
    v_cvt_pk_bf16_f32 v66, v60, v61
    v_cvt_pk_bf16_f32 v67, v62, v63
    v_accvgpr_write_b32 a76, v64
    v_accvgpr_write_b32 a77, v65
    v_accvgpr_write_b32 a78, v66
    v_accvgpr_write_b32 a79, v67
    v_alignbit_b32 v68, v64, v64, v40
    v_xor_b32 v68, v68, v41
    v_alignbit_b32 v69, v65, v65, v40
    v_xor_b32 v69, v69, v41
    v_alignbit_b32 v70, v66, v66, v40
    v_xor_b32 v70, v70, v41
    v_alignbit_b32 v71, v67, v67, v40
    v_xor_b32 v71, v71, v41
    v_accvgpr_write_b32 a204, v68
    v_accvgpr_write_b32 a205, v69
    v_accvgpr_write_b32 a206, v70
    v_accvgpr_write_b32 a207, v71
    v_fract_f32 v48, v30
    v_add_f32 v49, v48, v32
    v_cos_f32 v56, v48
    v_add_f32 v50, v49, v34
    v_cos_f32 v57, v49
    v_add_f32 v51, v50, v32
    v_cos_f32 v58, v50
    v_add_f32 v52, v51, v34
    v_cos_f32 v59, v51
    v_add_f32 v53, v52, v32
    v_cos_f32 v60, v52
    v_add_f32 v54, v53, v34
    v_cos_f32 v61, v53
    v_add_f32 v55, v54, v32
    v_cos_f32 v62, v54
    v_cos_f32 v63, v55
    v_add_f32 v30, v48, v36
    v_cvt_pk_bf16_f32 v64, v56, v57
    v_cvt_pk_bf16_f32 v65, v58, v59
    v_cvt_pk_bf16_f32 v66, v60, v61
    v_cvt_pk_bf16_f32 v67, v62, v63
    v_accvgpr_write_b32 a80, v64
    v_accvgpr_write_b32 a81, v65
    v_accvgpr_write_b32 a82, v66
    v_accvgpr_write_b32 a83, v67
    v_alignbit_b32 v68, v64, v64, v40
    v_xor_b32 v68, v68, v41
    v_alignbit_b32 v69, v65, v65, v40
    v_xor_b32 v69, v69, v41
    v_alignbit_b32 v70, v66, v66, v40
    v_xor_b32 v70, v70, v41
    v_alignbit_b32 v71, v67, v67, v40
    v_xor_b32 v71, v71, v41
    v_accvgpr_write_b32 a208, v68
    v_accvgpr_write_b32 a209, v69
    v_accvgpr_write_b32 a210, v70
    v_accvgpr_write_b32 a211, v71
    v_fract_f32 v48, v31
    v_add_f32 v49, v48, v33
    v_cos_f32 v56, v48
    v_add_f32 v50, v49, v35
    v_cos_f32 v57, v49
    v_add_f32 v51, v50, v33
    v_cos_f32 v58, v50
    v_add_f32 v52, v51, v35
    v_cos_f32 v59, v51
    v_add_f32 v53, v52, v33
    v_cos_f32 v60, v52
    v_add_f32 v54, v53, v35
    v_cos_f32 v61, v53
    v_add_f32 v55, v54, v33
    v_cos_f32 v62, v54
    v_cos_f32 v63, v55
    v_add_f32 v31, v48, v37
    v_cvt_pk_bf16_f32 v64, v56, v57
    v_cvt_pk_bf16_f32 v65, v58, v59
    v_cvt_pk_bf16_f32 v66, v60, v61
    v_cvt_pk_bf16_f32 v67, v62, v63
    v_accvgpr_write_b32 a84, v64
    v_accvgpr_write_b32 a85, v65
    v_accvgpr_write_b32 a86, v66
    v_accvgpr_write_b32 a87, v67
    v_alignbit_b32 v68, v64, v64, v40
    v_xor_b32 v68, v68, v41
    v_alignbit_b32 v69, v65, v65, v40
    v_xor_b32 v69, v69, v41
    v_alignbit_b32 v70, v66, v66, v40
    v_xor_b32 v70, v70, v41
    v_alignbit_b32 v71, v67, v67, v40
    v_xor_b32 v71, v71, v41
    v_accvgpr_write_b32 a212, v68
    v_accvgpr_write_b32 a213, v69
    v_accvgpr_write_b32 a214, v70
    v_accvgpr_write_b32 a215, v71
    v_fract_f32 v48, v30
    v_add_f32 v49, v48, v32
    v_cos_f32 v56, v48
    v_add_f32 v50, v49, v34
    v_cos_f32 v57, v49
    v_add_f32 v51, v50, v32
    v_cos_f32 v58, v50
    v_add_f32 v52, v51, v34
    v_cos_f32 v59, v51
    v_add_f32 v53, v52, v32
    v_cos_f32 v60, v52
    v_add_f32 v54, v53, v34
    v_cos_f32 v61, v53
    v_add_f32 v55, v54, v32
    v_cos_f32 v62, v54
    v_cos_f32 v63, v55
    v_add_f32 v30, v48, v36
    v_cvt_pk_bf16_f32 v64, v56, v57
    v_cvt_pk_bf16_f32 v65, v58, v59
    v_cvt_pk_bf16_f32 v66, v60, v61
    v_cvt_pk_bf16_f32 v67, v62, v63
    v_accvgpr_write_b32 a88, v64
    v_accvgpr_write_b32 a89, v65
    v_accvgpr_write_b32 a90, v66
    v_accvgpr_write_b32 a91, v67
    v_alignbit_b32 v68, v64, v64, v40
    v_xor_b32 v68, v68, v41
    v_alignbit_b32 v69, v65, v65, v40
    v_xor_b32 v69, v69, v41
    v_alignbit_b32 v70, v66, v66, v40
    v_xor_b32 v70, v70, v41
    v_alignbit_b32 v71, v67, v67, v40
    v_xor_b32 v71, v71, v41
    v_accvgpr_write_b32 a216, v68
    v_accvgpr_write_b32 a217, v69
    v_accvgpr_write_b32 a218, v70
    v_accvgpr_write_b32 a219, v71
    v_fract_f32 v48, v31
    v_add_f32 v49, v48, v33
    v_cos_f32 v56, v48
    v_add_f32 v50, v49, v35
    v_cos_f32 v57, v49
    v_add_f32 v51, v50, v33
    v_cos_f32 v58, v50
    v_add_f32 v52, v51, v35
    v_cos_f32 v59, v51
    v_add_f32 v53, v52, v33
    v_cos_f32 v60, v52
    v_add_f32 v54, v53, v35
    v_cos_f32 v61, v53
    v_add_f32 v55, v54, v33
    v_cos_f32 v62, v54
    v_cos_f32 v63, v55
    v_add_f32 v31, v48, v37
    v_cvt_pk_bf16_f32 v64, v56, v57
    v_cvt_pk_bf16_f32 v65, v58, v59
    v_cvt_pk_bf16_f32 v66, v60, v61
    v_cvt_pk_bf16_f32 v67, v62, v63
    v_accvgpr_write_b32 a92, v64
    v_accvgpr_write_b32 a93, v65
    v_accvgpr_write_b32 a94, v66
    v_accvgpr_write_b32 a95, v67
    v_alignbit_b32 v68, v64, v64, v40
    v_xor_b32 v68, v68, v41
    v_alignbit_b32 v69, v65, v65, v40
    v_xor_b32 v69, v69, v41
    v_alignbit_b32 v70, v66, v66, v40
    v_xor_b32 v70, v70, v41
    v_alignbit_b32 v71, v67, v67, v40
    v_xor_b32 v71, v71, v41
    v_accvgpr_write_b32 a220, v68
    v_accvgpr_write_b32 a221, v69
    v_accvgpr_write_b32 a222, v70
    v_accvgpr_write_b32 a223, v71
    v_fract_f32 v48, v30
    v_add_f32 v49, v48, v32
    v_cos_f32 v56, v48
    v_add_f32 v50, v49, v34
    v_cos_f32 v57, v49
    v_add_f32 v51, v50, v32
    v_cos_f32 v58, v50
    v_add_f32 v52, v51, v34
    v_cos_f32 v59, v51
    v_add_f32 v53, v52, v32
    v_cos_f32 v60, v52
    v_add_f32 v54, v53, v34
    v_cos_f32 v61, v53
    v_add_f32 v55, v54, v32
    v_cos_f32 v62, v54
    v_cos_f32 v63, v55
    v_add_f32 v30, v48, v36
    v_cvt_pk_bf16_f32 v64, v56, v57
    v_cvt_pk_bf16_f32 v65, v58, v59
    v_cvt_pk_bf16_f32 v66, v60, v61
    v_cvt_pk_bf16_f32 v67, v62, v63
    v_accvgpr_write_b32 a96, v64
    v_accvgpr_write_b32 a97, v65
    v_accvgpr_write_b32 a98, v66
    v_accvgpr_write_b32 a99, v67
    v_alignbit_b32 v68, v64, v64, v40
    v_xor_b32 v68, v68, v41
    v_alignbit_b32 v69, v65, v65, v40
    v_xor_b32 v69, v69, v41
    v_alignbit_b32 v70, v66, v66, v40
    v_xor_b32 v70, v70, v41
    v_alignbit_b32 v71, v67, v67, v40
    v_xor_b32 v71, v71, v41
    v_accvgpr_write_b32 a224, v68
    v_accvgpr_write_b32 a225, v69
    v_accvgpr_write_b32 a226, v70
    v_accvgpr_write_b32 a227, v71
    v_fract_f32 v48, v31
    v_add_f32 v49, v48, v33
    v_cos_f32 v56, v48
    v_add_f32 v50, v49, v35
    v_cos_f32 v57, v49
    v_add_f32 v51, v50, v33
    v_cos_f32 v58, v50
    v_add_f32 v52, v51, v35
    v_cos_f32 v59, v51
    v_add_f32 v53, v52, v33
    v_cos_f32 v60, v52
    v_add_f32 v54, v53, v35
    v_cos_f32 v61, v53
    v_add_f32 v55, v54, v33
    v_cos_f32 v62, v54
    v_cos_f32 v63, v55
    v_add_f32 v31, v48, v37
    v_cvt_pk_bf16_f32 v64, v56, v57
    v_cvt_pk_bf16_f32 v65, v58, v59
    v_cvt_pk_bf16_f32 v66, v60, v61
    v_cvt_pk_bf16_f32 v67, v62, v63
    v_accvgpr_write_b32 a100, v64
    v_accvgpr_write_b32 a101, v65
    v_accvgpr_write_b32 a102, v66
    v_accvgpr_write_b32 a103, v67
    v_alignbit_b32 v68, v64, v64, v40
    v_xor_b32 v68, v68, v41
    v_alignbit_b32 v69, v65, v65, v40
    v_xor_b32 v69, v69, v41
    v_alignbit_b32 v70, v66, v66, v40
    v_xor_b32 v70, v70, v41
    v_alignbit_b32 v71, v67, v67, v40
    v_xor_b32 v71, v71, v41
    v_accvgpr_write_b32 a228, v68
    v_accvgpr_write_b32 a229, v69
    v_accvgpr_write_b32 a230, v70
    v_accvgpr_write_b32 a231, v71
    v_fract_f32 v48, v30
    v_add_f32 v49, v48, v32
    v_cos_f32 v56, v48
    v_add_f32 v50, v49, v34
    v_cos_f32 v57, v49
    v_add_f32 v51, v50, v32
    v_cos_f32 v58, v50
    v_add_f32 v52, v51, v34
    v_cos_f32 v59, v51
    v_add_f32 v53, v52, v32
    v_cos_f32 v60, v52
    v_add_f32 v54, v53, v34
    v_cos_f32 v61, v53
    v_add_f32 v55, v54, v32
    v_cos_f32 v62, v54
    v_cos_f32 v63, v55
    v_add_f32 v30, v48, v36
    v_cvt_pk_bf16_f32 v64, v56, v57
    v_cvt_pk_bf16_f32 v65, v58, v59
    v_cvt_pk_bf16_f32 v66, v60, v61
    v_cvt_pk_bf16_f32 v67, v62, v63
    v_accvgpr_write_b32 a104, v64
    v_accvgpr_write_b32 a105, v65
    v_accvgpr_write_b32 a106, v66
    v_accvgpr_write_b32 a107, v67
    v_alignbit_b32 v68, v64, v64, v40
    v_xor_b32 v68, v68, v41
    v_alignbit_b32 v69, v65, v65, v40
    v_xor_b32 v69, v69, v41
    v_alignbit_b32 v70, v66, v66, v40
    v_xor_b32 v70, v70, v41
    v_alignbit_b32 v71, v67, v67, v40
    v_xor_b32 v71, v71, v41
    v_accvgpr_write_b32 a232, v68
    v_accvgpr_write_b32 a233, v69
    v_accvgpr_write_b32 a234, v70
    v_accvgpr_write_b32 a235, v71
    v_fract_f32 v48, v31
    v_add_f32 v49, v48, v33
    v_cos_f32 v56, v48
    v_add_f32 v50, v49, v35
    v_cos_f32 v57, v49
    v_add_f32 v51, v50, v33
    v_cos_f32 v58, v50
    v_add_f32 v52, v51, v35
    v_cos_f32 v59, v51
    v_add_f32 v53, v52, v33
    v_cos_f32 v60, v52
    v_add_f32 v54, v53, v35
    v_cos_f32 v61, v53
    v_add_f32 v55, v54, v33
    v_cos_f32 v62, v54
    v_cos_f32 v63, v55
    v_add_f32 v31, v48, v37
    v_cvt_pk_bf16_f32 v64, v56, v57
    v_cvt_pk_bf16_f32 v65, v58, v59
    v_cvt_pk_bf16_f32 v66, v60, v61
    v_cvt_pk_bf16_f32 v67, v62, v63
    v_accvgpr_write_b32 a108, v64
    v_accvgpr_write_b32 a109, v65
    v_accvgpr_write_b32 a110, v66
    v_accvgpr_write_b32 a111, v67
    v_alignbit_b32 v68, v64, v64, v40
    v_xor_b32 v68, v68, v41
    v_alignbit_b32 v69, v65, v65, v40
    v_xor_b32 v69, v69, v41
    v_alignbit_b32 v70, v66, v66, v40
    v_xor_b32 v70, v70, v41
    v_alignbit_b32 v71, v67, v67, v40
    v_xor_b32 v71, v71, v41
    v_accvgpr_write_b32 a236, v68
    v_accvgpr_write_b32 a237, v69
    v_accvgpr_write_b32 a238, v70
    v_accvgpr_write_b32 a239, v71
    v_fract_f32 v48, v30
    v_add_f32 v49, v48, v32
    v_cos_f32 v56, v48
    v_add_f32 v50, v49, v34
    v_cos_f32 v57, v49
    v_add_f32 v51, v50, v32
    v_cos_f32 v58, v50
    v_add_f32 v52, v51, v34
    v_cos_f32 v59, v51
    v_add_f32 v53, v52, v32
    v_cos_f32 v60, v52
    v_add_f32 v54, v53, v34
    v_cos_f32 v61, v53
    v_add_f32 v55, v54, v32
    v_cos_f32 v62, v54
    v_cos_f32 v63, v55
    v_add_f32 v30, v48, v36
    v_cvt_pk_bf16_f32 v64, v56, v57
    v_cvt_pk_bf16_f32 v65, v58, v59
    v_cvt_pk_bf16_f32 v66, v60, v61
    v_cvt_pk_bf16_f32 v67, v62, v63
    v_accvgpr_write_b32 a112, v64
    v_accvgpr_write_b32 a113, v65
    v_accvgpr_write_b32 a114, v66
    v_accvgpr_write_b32 a115, v67
    v_alignbit_b32 v68, v64, v64, v40
    v_xor_b32 v68, v68, v41
    v_alignbit_b32 v69, v65, v65, v40
    v_xor_b32 v69, v69, v41
    v_alignbit_b32 v70, v66, v66, v40
    v_xor_b32 v70, v70, v41
    v_alignbit_b32 v71, v67, v67, v40
    v_xor_b32 v71, v71, v41
    v_accvgpr_write_b32 a240, v68
    v_accvgpr_write_b32 a241, v69
    v_accvgpr_write_b32 a242, v70
    v_accvgpr_write_b32 a243, v71
    v_fract_f32 v48, v31
    v_add_f32 v49, v48, v33
    v_cos_f32 v56, v48
    v_add_f32 v50, v49, v35
    v_cos_f32 v57, v49
    v_add_f32 v51, v50, v33
    v_cos_f32 v58, v50
    v_add_f32 v52, v51, v35
    v_cos_f32 v59, v51
    v_add_f32 v53, v52, v33
    v_cos_f32 v60, v52
    v_add_f32 v54, v53, v35
    v_cos_f32 v61, v53
    v_add_f32 v55, v54, v33
    v_cos_f32 v62, v54
    v_cos_f32 v63, v55
    v_add_f32 v31, v48, v37
    v_cvt_pk_bf16_f32 v64, v56, v57
    v_cvt_pk_bf16_f32 v65, v58, v59
    v_cvt_pk_bf16_f32 v66, v60, v61
    v_cvt_pk_bf16_f32 v67, v62, v63
    v_accvgpr_write_b32 a116, v64
    v_accvgpr_write_b32 a117, v65
    v_accvgpr_write_b32 a118, v66
    v_accvgpr_write_b32 a119, v67
    v_alignbit_b32 v68, v64, v64, v40
    v_xor_b32 v68, v68, v41
    v_alignbit_b32 v69, v65, v65, v40
    v_xor_b32 v69, v69, v41
    v_alignbit_b32 v70, v66, v66, v40
    v_xor_b32 v70, v70, v41
    v_alignbit_b32 v71, v67, v67, v40
    v_xor_b32 v71, v71, v41
    v_accvgpr_write_b32 a244, v68
    v_accvgpr_write_b32 a245, v69
    v_accvgpr_write_b32 a246, v70
    v_accvgpr_write_b32 a247, v71
    v_fract_f32 v48, v30
    v_add_f32 v49, v48, v32
    v_cos_f32 v56, v48
    v_add_f32 v50, v49, v34
    v_cos_f32 v57, v49
    v_add_f32 v51, v50, v32
    v_cos_f32 v58, v50
    v_add_f32 v52, v51, v34
    v_cos_f32 v59, v51
    v_add_f32 v53, v52, v32
    v_cos_f32 v60, v52
    v_add_f32 v54, v53, v34
    v_cos_f32 v61, v53
    v_add_f32 v55, v54, v32
    v_cos_f32 v62, v54
    v_cos_f32 v63, v55
    v_add_f32 v30, v48, v36
    v_cvt_pk_bf16_f32 v64, v56, v57
    v_cvt_pk_bf16_f32 v65, v58, v59
    v_cvt_pk_bf16_f32 v66, v60, v61
    v_cvt_pk_bf16_f32 v67, v62, v63
    v_accvgpr_write_b32 a120, v64
    v_accvgpr_write_b32 a121, v65
    v_accvgpr_write_b32 a122, v66
    v_accvgpr_write_b32 a123, v67
    v_alignbit_b32 v68, v64, v64, v40
    v_xor_b32 v68, v68, v41
    v_alignbit_b32 v69, v65, v65, v40
    v_xor_b32 v69, v69, v41
    v_alignbit_b32 v70, v66, v66, v40
    v_xor_b32 v70, v70, v41
    v_alignbit_b32 v71, v67, v67, v40
    v_xor_b32 v71, v71, v41
    v_accvgpr_write_b32 a248, v68
    v_accvgpr_write_b32 a249, v69
    v_accvgpr_write_b32 a250, v70
    v_accvgpr_write_b32 a251, v71
    v_fract_f32 v48, v31
    v_add_f32 v49, v48, v33
    v_cos_f32 v56, v48
    v_add_f32 v50, v49, v35
    v_cos_f32 v57, v49
    v_add_f32 v51, v50, v33
    v_cos_f32 v58, v50
    v_add_f32 v52, v51, v35
    v_cos_f32 v59, v51
    v_add_f32 v53, v52, v33
    v_cos_f32 v60, v52
    v_add_f32 v54, v53, v35
    v_cos_f32 v61, v53
    v_add_f32 v55, v54, v33
    v_cos_f32 v62, v54
    v_cos_f32 v63, v55
    v_add_f32 v31, v48, v37
    v_cvt_pk_bf16_f32 v64, v56, v57
    v_cvt_pk_bf16_f32 v65, v58, v59
    v_cvt_pk_bf16_f32 v66, v60, v61
    v_cvt_pk_bf16_f32 v67, v62, v63
    v_accvgpr_write_b32 a124, v64
    v_accvgpr_write_b32 a125, v65
    v_accvgpr_write_b32 a126, v66
    v_accvgpr_write_b32 a127, v67
    v_alignbit_b32 v68, v64, v64, v40
    v_xor_b32 v68, v68, v41
    v_alignbit_b32 v69, v65, v65, v40
    v_xor_b32 v69, v69, v41
    v_alignbit_b32 v70, v66, v66, v40
    v_xor_b32 v70, v70, v41
    v_alignbit_b32 v71, v67, v67, v40
    v_xor_b32 v71, v71, v41
    v_accvgpr_write_b32 a252, v68
    v_accvgpr_write_b32 a253, v69
    v_accvgpr_write_b32 a254, v70
    v_accvgpr_write_b32 a255, v71
    v_lshlrev_b32 v6, 31, v38
    v_or_b32 v6, 0x3f003f00, v6
    v_cmp_gt_u32 vcc, 16, v1
    v_accvgpr_read_b32 v5, a0
    s_nop 0
    v_cndmask_b32 v5, v5, v6, vcc
    v_accvgpr_write_b32 a0, v5
    v_accvgpr_read_b32 v5, a4
    v_cndmask_b32 v5, v5, v6, vcc
    v_accvgpr_write_b32 a4, v5
    v_and_b32 v5, 15, v1
    v_lshrrev_b32 v6, 4, v1
    v_lshlrev_b32 v5, 4, v5
    v_lshl_add_u32 v10, v6, 9, v5
    v_add_u32 v11, 2048, v10
    v_add_u32 v12, 0x10000, v10
    v_add_u32 v13, 0x10000, v11
    s_lshl_b32 s19, s16, 10
    s_lshl_b32 s17, s16, 1
    v_lshrrev_b32 v8, 5, v1
    v_add_u32 v8, s17, v8
    v_and_b32 v7, 31, v1
    v_mul_u32_u24 v2, 33024, v8
    v_lshl_add_u32 v2, v7, 4, v2
    v_and_b32 v3, 15, v1
    v_and_b32 v5, 48, v1
    v_lshl_add_u32 v3, v3, 12, v5
    v_add_u32 v4, 0x10000, v3
    s_lshl_b32 s21, s28, 21
    s_lshl_b32 s17, s29, 6
    s_add_u32 s21, s21, s17
    s_lshl_b32 s20, s28, 13
    s_add_u32 s20, s20, 111149056
    s_mov_b32 s24, 512
    s_mov_b32 s25, 131072
    v_and_b32 v7, 31, v1
    v_lshlrev_b32 v7, 7, v7
    s_lshl_b32 s17, s16, 12
    s_add_u32 s17, s17, 100761600
    v_add_u32 v7, s17, v7
    s_mov_b32 s30, s92
F3_w0:
    buffer_load_dword v5, v7, s[4:7], 0 offen sc1
    s_waitcnt vmcnt(0)
    v_cmp_gt_u32 vcc, 1, v5
    s_nop 0
    s_cmp_lg_u64 vcc, 0
    s_cbranch_scc0 F3_w0_ok
    s_cmp_ge_u32 s30, 1048576
    s_cselect_b32 s92, 1048576, s92
    s_cbranch_scc1 F3_w0_ok
    s_add_u32 s30, s30, 1
    s_sleep 8
    s_branch F3_w0
F3_w0_ok:
    s_barrier
    s_mov_b32 s26, s25
    s_sub_u32 s25, s21, 1073741824
    s_mov_b32 s21, 1073741824
    s_mov_b32 s23, 0
    s_mov_b32 s22, 0
    s_add_u32 m0, s19, 0
    s_add_u32 s17, s20, 0
    buffer_load_dwordx4 v2, s[4:7], s17 offen lds
    s_add_u32 m0, s19, 4096
    s_add_u32 s17, s20, 264192
    buffer_load_dwordx4 v2, s[4:7], s17 offen lds
    s_add_u32 m0, s19, 8192
    s_add_u32 s17, s20, 528384
    buffer_load_dwordx4 v2, s[4:7], s17 offen lds
    s_add_u32 m0, s19, 12288
    s_add_u32 s17, s20, 792576
    buffer_load_dwordx4 v2, s[4:7], s17 offen lds
    s_add_u32 m0, s19, 16384
    s_add_u32 s17, s20, 1056768
    buffer_load_dwordx4 v2, s[4:7], s17 offen lds
    s_add_u32 m0, s19, 20480
    s_add_u32 s17, s20, 1320960
    buffer_load_dwordx4 v2, s[4:7], s17 offen lds
    s_add_u32 m0, s19, 24576
    s_add_u32 s17, s20, 1585152
    buffer_load_dwordx4 v2, s[4:7], s17 offen lds
    s_add_u32 m0, s19, 28672
    s_add_u32 s17, s20, 1849344
    buffer_load_dwordx4 v2, s[4:7], s17 offen lds
    s_add_u32 m0, s19, 32768
    s_add_u32 s17, s20, 2113536
    buffer_load_dwordx4 v2, s[4:7], s17 offen lds
    s_add_u32 m0, s19, 36864
    s_add_u32 s17, s20, 2377728
    buffer_load_dwordx4 v2, s[4:7], s17 offen lds
    s_add_u32 m0, s19, 40960
    s_add_u32 s17, s20, 2641920
    buffer_load_dwordx4 v2, s[4:7], s17 offen lds
    s_add_u32 m0, s19, 45056
    s_add_u32 s17, s20, 2906112
    buffer_load_dwordx4 v2, s[4:7], s17 offen lds
    s_add_u32 m0, s19, 49152
    s_add_u32 s17, s20, 3170304
    buffer_load_dwordx4 v2, s[4:7], s17 offen lds
    s_add_u32 m0, s19, 53248
    s_add_u32 s17, s20, 3434496
    buffer_load_dwordx4 v2, s[4:7], s17 offen lds
    s_add_u32 m0, s19, 57344
    s_add_u32 s17, s20, 3698688
    buffer_load_dwordx4 v2, s[4:7], s17 offen lds
    s_add_u32 m0, s19, 61440
    s_add_u32 s17, s20, 3962880
    buffer_load_dwordx4 v2, s[4:7], s17 offen lds
    s_add_u32 s20, s20, s24
    s_add_u32 m0, s19, 65536
    s_add_u32 s17, s20, 0
    buffer_load_dwordx4 v2, s[4:7], s17 offen lds
    s_add_u32 m0, s19, 69632
    s_add_u32 s17, s20, 264192
    buffer_load_dwordx4 v2, s[4:7], s17 offen lds
    s_add_u32 m0, s19, 73728
    s_add_u32 s17, s20, 528384
    buffer_load_dwordx4 v2, s[4:7], s17 offen lds
    s_waitcnt vmcnt(11)
    s_barrier
    ds_read_b128 v[20:23], v10 offset:0
    ds_read_b128 v[24:27], v10 offset:256
    ds_read_b128 v[28:31], v11 offset:0
    ds_read_b128 v[32:35], v11 offset:256
    ds_read_b128 v[36:39], v10 offset:4096
    ds_read_b128 v[40:43], v10 offset:4352
    ds_read_b128 v[44:47], v11 offset:4096
.p2align 6
F3_top:
    s_waitcnt lgkmcnt(6)
    v_mfma_f32_16x16x32_bf16 v[52:55], a[0:3], v[20:23], 0
    ds_read_b128 v[48:51], v11 offset:4352
    v_mfma_f32_16x16x32_bf16 v[56:59], a[4:7], v[20:23], 0
    s_waitcnt lgkmcnt(6)
    v_mfma_f32_16x16x32_bf16 v[60:63], a[0:3], v[24:27], 0
    ds_read_b128 v[20:23], v10 offset:8192
    s_add_u32 m0, s19, 77824
    v_mfma_f32_16x16x32_bf16 v[64:67], a[4:7], v[24:27], 0
    s_add_u32 s17, s20, 792576
    buffer_load_dwordx4 v2, s[4:7], s17 offen lds
    s_waitcnt lgkmcnt(6)
    v_mfma_f32_16x16x32_bf16 v[52:55], a[8:11], v[28:31], v[52:55]
    ds_read_b128 v[24:27], v10 offset:8448
    v_mfma_f32_16x16x32_bf16 v[56:59], a[12:15], v[28:31], v[56:59]
    s_waitcnt lgkmcnt(6)
    v_mfma_f32_16x16x32_bf16 v[60:63], a[8:11], v[32:35], v[60:63]
    ds_read_b128 v[28:31], v11 offset:8192
    s_add_u32 m0, s19, 81920
    v_mfma_f32_16x16x32_bf16 v[64:67], a[12:15], v[32:35], v[64:67]
    s_add_u32 s17, s20, 1056768
    buffer_load_dwordx4 v2, s[4:7], s17 offen lds
    s_waitcnt lgkmcnt(6)
    v_mfma_f32_16x16x32_bf16 v[52:55], a[16:19], v[36:39], v[52:55]
    ds_read_b128 v[32:35], v11 offset:8448
    v_mfma_f32_16x16x32_bf16 v[56:59], a[20:23], v[36:39], v[56:59]
    s_waitcnt lgkmcnt(6)
    v_mfma_f32_16x16x32_bf16 v[60:63], a[16:19], v[40:43], v[60:63]
    ds_read_b128 v[36:39], v10 offset:12288
    s_add_u32 m0, s19, 86016
    v_mfma_f32_16x16x32_bf16 v[64:67], a[20:23], v[40:43], v[64:67]
    s_add_u32 s17, s20, 1320960
    buffer_load_dwordx4 v2, s[4:7], s17 offen lds
    s_waitcnt lgkmcnt(6)
    v_mfma_f32_16x16x32_bf16 v[52:55], a[24:27], v[44:47], v[52:55]
    ds_read_b128 v[40:43], v10 offset:12544
    v_mfma_f32_16x16x32_bf16 v[56:59], a[28:31], v[44:47], v[56:59]
    s_waitcnt lgkmcnt(6)
    v_mfma_f32_16x16x32_bf16 v[60:63], a[24:27], v[48:51], v[60:63]
    ds_read_b128 v[44:47], v11 offset:12288
    s_add_u32 m0, s19, 90112
    v_mfma_f32_16x16x32_bf16 v[64:67], a[28:31], v[48:51], v[64:67]
    s_add_u32 s17, s20, 1585152
    buffer_load_dwordx4 v2, s[4:7], s17 offen lds
    s_waitcnt lgkmcnt(6)
    v_mfma_f32_16x16x32_bf16 v[52:55], a[32:35], v[20:23], v[52:55]
    ds_read_b128 v[48:51], v11 offset:12544
    v_mfma_f32_16x16x32_bf16 v[56:59], a[36:39], v[20:23], v[56:59]
    s_waitcnt lgkmcnt(6)
    v_mfma_f32_16x16x32_bf16 v[60:63], a[32:35], v[24:27], v[60:63]
    ds_read_b128 v[20:23], v10 offset:16384
    s_add_u32 m0, s19, 94208
    v_mfma_f32_16x16x32_bf16 v[64:67], a[36:39], v[24:27], v[64:67]
    s_add_u32 s17, s20, 1849344
    buffer_load_dwordx4 v2, s[4:7], s17 offen lds
    s_waitcnt lgkmcnt(6)
    v_mfma_f32_16x16x32_bf16 v[52:55], a[40:43], v[28:31], v[52:55]
    ds_read_b128 v[24:27], v10 offset:16640
    v_mfma_f32_16x16x32_bf16 v[56:59], a[44:47], v[28:31], v[56:59]
    v_cvt_pk_bf16_f32 v84, v68, v69
    s_waitcnt lgkmcnt(6)
    v_mfma_f32_16x16x32_bf16 v[60:63], a[40:43], v[32:35], v[60:63]
    ds_read_b128 v[28:31], v11 offset:16384
    v_mfma_f32_16x16x32_bf16 v[64:67], a[44:47], v[32:35], v[64:67]
    v_cvt_pk_bf16_f32 v85, v70, v71
    s_waitcnt lgkmcnt(6)
    v_mfma_f32_16x16x32_bf16 v[52:55], a[48:51], v[36:39], v[52:55]
    ds_read_b128 v[32:35], v11 offset:16640
    v_mfma_f32_16x16x32_bf16 v[56:59], a[52:55], v[36:39], v[56:59]
    v_cvt_pk_bf16_f32 v86, v72, v73
    s_waitcnt lgkmcnt(6)
    v_mfma_f32_16x16x32_bf16 v[60:63], a[48:51], v[40:43], v[60:63]
    ds_read_b128 v[36:39], v10 offset:20480
    v_mfma_f32_16x16x32_bf16 v[64:67], a[52:55], v[40:43], v[64:67]
    v_cvt_pk_bf16_f32 v87, v74, v75
    s_waitcnt lgkmcnt(6)
    v_mfma_f32_16x16x32_bf16 v[52:55], a[56:59], v[44:47], v[52:55]
    ds_read_b128 v[40:43], v10 offset:20736
    v_mfma_f32_16x16x32_bf16 v[56:59], a[60:63], v[44:47], v[56:59]
    v_cvt_pk_bf16_f32 v88, v76, v77
    s_waitcnt lgkmcnt(6)
    v_mfma_f32_16x16x32_bf16 v[60:63], a[56:59], v[48:51], v[60:63]
    ds_read_b128 v[44:47], v11 offset:20480
    v_mfma_f32_16x16x32_bf16 v[64:67], a[60:63], v[48:51], v[64:67]
    v_cvt_pk_bf16_f32 v89, v78, v79
    buffer_store_dwordx4 v[84:87], v3, s[12:15], s21 offen
    s_waitcnt lgkmcnt(6)
    v_mfma_f32_16x16x32_bf16 v[52:55], a[64:67], v[20:23], v[52:55]
    ds_read_b128 v[48:51], v11 offset:20736
    v_mfma_f32_16x16x32_bf16 v[56:59], a[68:71], v[20:23], v[56:59]
    v_cvt_pk_bf16_f32 v90, v80, v81
    s_waitcnt lgkmcnt(6)
    v_mfma_f32_16x16x32_bf16 v[60:63], a[64:67], v[24:27], v[60:63]
    ds_read_b128 v[20:23], v10 offset:24576
    v_mfma_f32_16x16x32_bf16 v[64:67], a[68:71], v[24:27], v[64:67]
    v_cvt_pk_bf16_f32 v91, v82, v83
    s_waitcnt lgkmcnt(6)
    v_mfma_f32_16x16x32_bf16 v[52:55], a[72:75], v[28:31], v[52:55]
    ds_read_b128 v[24:27], v10 offset:24832
    v_mfma_f32_16x16x32_bf16 v[56:59], a[76:79], v[28:31], v[56:59]
    s_waitcnt lgkmcnt(6)
    v_mfma_f32_16x16x32_bf16 v[60:63], a[72:75], v[32:35], v[60:63]
    ds_read_b128 v[28:31], v11 offset:24576
    v_mfma_f32_16x16x32_bf16 v[64:67], a[76:79], v[32:35], v[64:67]
    buffer_store_dwordx4 v[88:91], v4, s[12:15], s21 offen
    s_waitcnt lgkmcnt(6)
    v_mfma_f32_16x16x32_bf16 v[52:55], a[80:83], v[36:39], v[52:55]
    ds_read_b128 v[32:35], v11 offset:24832
    v_mfma_f32_16x16x32_bf16 v[56:59], a[84:87], v[36:39], v[56:59]
    s_add_u32 s21, s21, s25
    s_mov_b32 s25, s26
    s_waitcnt lgkmcnt(6)
    v_mfma_f32_16x16x32_bf16 v[60:63], a[80:83], v[40:43], v[60:63]
    ds_read_b128 v[36:39], v10 offset:28672
    v_mfma_f32_16x16x32_bf16 v[64:67], a[84:87], v[40:43], v[64:67]
    s_waitcnt lgkmcnt(6)
    v_mfma_f32_16x16x32_bf16 v[52:55], a[88:91], v[44:47], v[52:55]
    ds_read_b128 v[40:43], v10 offset:28928
    v_mfma_f32_16x16x32_bf16 v[56:59], a[92:95], v[44:47], v[56:59]
    s_waitcnt lgkmcnt(6)
    v_mfma_f32_16x16x32_bf16 v[60:63], a[88:91], v[48:51], v[60:63]
    ds_read_b128 v[44:47], v11 offset:28672
    v_mfma_f32_16x16x32_bf16 v[64:67], a[92:95], v[48:51], v[64:67]
    s_waitcnt lgkmcnt(6)
    v_mfma_f32_16x16x32_bf16 v[52:55], a[96:99], v[20:23], v[52:55]
    ds_read_b128 v[48:51], v11 offset:28928
    v_mfma_f32_16x16x32_bf16 v[56:59], a[100:103], v[20:23], v[56:59]
    s_waitcnt lgkmcnt(6)
    v_mfma_f32_16x16x32_bf16 v[60:63], a[96:99], v[24:27], v[60:63]
    s_waitcnt vmcnt(10)
    s_barrier
    ds_read_b128 v[20:23], v10 offset:32768
    v_mfma_f32_16x16x32_bf16 v[64:67], a[100:103], v[24:27], v[64:67]
    s_waitcnt lgkmcnt(6)
    v_mfma_f32_16x16x32_bf16 v[52:55], a[104:107], v[28:31], v[52:55]
    ds_read_b128 v[24:27], v10 offset:33024
    s_add_u32 m0, s19, 98304
    v_mfma_f32_16x16x32_bf16 v[56:59], a[108:111], v[28:31], v[56:59]
    s_add_u32 s17, s20, 2113536
    buffer_load_dwordx4 v2, s[4:7], s17 offen lds
    s_waitcnt lgkmcnt(6)
    v_mfma_f32_16x16x32_bf16 v[60:63], a[104:107], v[32:35], v[60:63]
    ds_read_b128 v[28:31], v11 offset:32768
    v_mfma_f32_16x16x32_bf16 v[64:67], a[108:111], v[32:35], v[64:67]
    s_waitcnt lgkmcnt(6)
    v_mfma_f32_16x16x32_bf16 v[52:55], a[112:115], v[36:39], v[52:55]
    ds_read_b128 v[32:35], v11 offset:33024
    s_add_u32 m0, s19, 102400
    v_mfma_f32_16x16x32_bf16 v[56:59], a[116:119], v[36:39], v[56:59]
    s_add_u32 s17, s20, 2377728
    buffer_load_dwordx4 v2, s[4:7], s17 offen lds
    s_waitcnt lgkmcnt(6)
    v_mfma_f32_16x16x32_bf16 v[60:63], a[112:115], v[40:43], v[60:63]
    ds_read_b128 v[36:39], v10 offset:36864
    v_mfma_f32_16x16x32_bf16 v[64:67], a[116:119], v[40:43], v[64:67]
    s_waitcnt lgkmcnt(6)
    v_mfma_f32_16x16x32_bf16 v[52:55], a[120:123], v[44:47], v[52:55]
    ds_read_b128 v[40:43], v10 offset:37120
    s_add_u32 m0, s19, 106496
    v_mfma_f32_16x16x32_bf16 v[56:59], a[124:127], v[44:47], v[56:59]
    s_add_u32 s17, s20, 2641920
    buffer_load_dwordx4 v2, s[4:7], s17 offen lds
    s_waitcnt lgkmcnt(6)
    v_mfma_f32_16x16x32_bf16 v[60:63], a[120:123], v[48:51], v[60:63]
    ds_read_b128 v[44:47], v11 offset:36864
    v_mfma_f32_16x16x32_bf16 v[64:67], a[124:127], v[48:51], v[64:67]
    s_waitcnt lgkmcnt(6)
    v_mfma_f32_16x16x32_bf16 v[52:55], a[128:131], v[20:23], v[52:55]
    ds_read_b128 v[48:51], v11 offset:37120
    v_mfma_f32_16x16x32_bf16 v[56:59], a[132:135], v[20:23], v[56:59]
    s_waitcnt lgkmcnt(6)
    v_mfma_f32_16x16x32_bf16 v[60:63], a[128:131], v[24:27], v[60:63]
    ds_read_b128 v[20:23], v10 offset:40960
    s_add_u32 m0, s19, 110592
    v_mfma_f32_16x16x32_bf16 v[64:67], a[132:135], v[24:27], v[64:67]
    s_add_u32 s17, s20, 2906112
    buffer_load_dwordx4 v2, s[4:7], s17 offen lds
    s_waitcnt lgkmcnt(6)
    v_mfma_f32_16x16x32_bf16 v[52:55], a[136:139], v[28:31], v[52:55]
    ds_read_b128 v[24:27], v10 offset:41216
    v_mfma_f32_16x16x32_bf16 v[56:59], a[140:143], v[28:31], v[56:59]
    s_waitcnt lgkmcnt(6)
    v_mfma_f32_16x16x32_bf16 v[60:63], a[136:139], v[32:35], v[60:63]
    ds_read_b128 v[28:31], v11 offset:40960
    s_add_u32 m0, s19, 114688
    v_mfma_f32_16x16x32_bf16 v[64:67], a[140:143], v[32:35], v[64:67]
    s_add_u32 s17, s20, 3170304
    buffer_load_dwordx4 v2, s[4:7], s17 offen lds
    s_waitcnt lgkmcnt(6)
    v_mfma_f32_16x16x32_bf16 v[52:55], a[144:147], v[36:39], v[52:55]
    ds_read_b128 v[32:35], v11 offset:41216
    v_mfma_f32_16x16x32_bf16 v[56:59], a[148:151], v[36:39], v[56:59]
    s_waitcnt lgkmcnt(6)
    v_mfma_f32_16x16x32_bf16 v[60:63], a[144:147], v[40:43], v[60:63]
    ds_read_b128 v[36:39], v10 offset:45056
    s_add_u32 m0, s19, 118784
    v_mfma_f32_16x16x32_bf16 v[64:67], a[148:151], v[40:43], v[64:67]
    s_add_u32 s17, s20, 3434496
    buffer_load_dwordx4 v2, s[4:7], s17 offen lds
    s_waitcnt lgkmcnt(6)
    v_mfma_f32_16x16x32_bf16 v[52:55], a[152:155], v[44:47], v[52:55]
    ds_read_b128 v[40:43], v10 offset:45312
    v_mfma_f32_16x16x32_bf16 v[56:59], a[156:159], v[44:47], v[56:59]
    s_waitcnt lgkmcnt(6)
    v_mfma_f32_16x16x32_bf16 v[60:63], a[152:155], v[48:51], v[60:63]
    ds_read_b128 v[44:47], v11 offset:45056
    s_add_u32 m0, s19, 122880
    v_mfma_f32_16x16x32_bf16 v[64:67], a[156:159], v[48:51], v[64:67]
    s_add_u32 s17, s20, 3698688
    buffer_load_dwordx4 v2, s[4:7], s17 offen lds
    s_waitcnt lgkmcnt(6)
    v_mfma_f32_16x16x32_bf16 v[52:55], a[160:163], v[20:23], v[52:55]
    ds_read_b128 v[48:51], v11 offset:45312
    v_mfma_f32_16x16x32_bf16 v[56:59], a[164:167], v[20:23], v[56:59]
    s_waitcnt lgkmcnt(6)
    v_mfma_f32_16x16x32_bf16 v[60:63], a[160:163], v[24:27], v[60:63]
    ds_read_b128 v[20:23], v10 offset:49152
    s_add_u32 m0, s19, 126976
    v_mfma_f32_16x16x32_bf16 v[64:67], a[164:167], v[24:27], v[64:67]
    s_add_u32 s17, s20, 3962880
    buffer_load_dwordx4 v2, s[4:7], s17 offen lds
    s_waitcnt lgkmcnt(6)
    v_mfma_f32_16x16x32_bf16 v[52:55], a[168:171], v[28:31], v[52:55]
    ds_read_b128 v[24:27], v10 offset:49408
    v_mfma_f32_16x16x32_bf16 v[56:59], a[172:175], v[28:31], v[56:59]
    s_add_u32 s20, s20, s24
    s_waitcnt lgkmcnt(6)
    v_mfma_f32_16x16x32_bf16 v[60:63], a[168:171], v[32:35], v[60:63]
    ds_read_b128 v[28:31], v11 offset:49152
    v_mfma_f32_16x16x32_bf16 v[64:67], a[172:175], v[32:35], v[64:67]
    s_waitcnt lgkmcnt(6)
    v_mfma_f32_16x16x32_bf16 v[52:55], a[176:179], v[36:39], v[52:55]
    ds_read_b128 v[32:35], v11 offset:49408
    v_mfma_f32_16x16x32_bf16 v[56:59], a[180:183], v[36:39], v[56:59]
    s_waitcnt lgkmcnt(6)
    v_mfma_f32_16x16x32_bf16 v[60:63], a[176:179], v[40:43], v[60:63]
    ds_read_b128 v[36:39], v10 offset:53248
    v_mfma_f32_16x16x32_bf16 v[64:67], a[180:183], v[40:43], v[64:67]
    s_waitcnt lgkmcnt(6)
    v_mfma_f32_16x16x32_bf16 v[52:55], a[184:187], v[44:47], v[52:55]
    ds_read_b128 v[40:43], v10 offset:53504
    v_mfma_f32_16x16x32_bf16 v[56:59], a[188:191], v[44:47], v[56:59]
    s_waitcnt lgkmcnt(6)
    v_mfma_f32_16x16x32_bf16 v[60:63], a[184:187], v[48:51], v[60:63]
    ds_read_b128 v[44:47], v11 offset:53248
    v_mfma_f32_16x16x32_bf16 v[64:67], a[188:191], v[48:51], v[64:67]
    s_waitcnt lgkmcnt(6)
    v_mfma_f32_16x16x32_bf16 v[52:55], a[192:195], v[20:23], v[52:55]
    ds_read_b128 v[48:51], v11 offset:53504
    v_mfma_f32_16x16x32_bf16 v[56:59], a[196:199], v[20:23], v[56:59]
    s_waitcnt lgkmcnt(6)
    v_mfma_f32_16x16x32_bf16 v[60:63], a[192:195], v[24:27], v[60:63]
    ds_read_b128 v[20:23], v10 offset:57344
    v_mfma_f32_16x16x32_bf16 v[64:67], a[196:199], v[24:27], v[64:67]
    s_waitcnt lgkmcnt(6)
    v_mfma_f32_16x16x32_bf16 v[52:55], a[200:203], v[28:31], v[52:55]
    ds_read_b128 v[24:27], v10 offset:57600
    v_mfma_f32_16x16x32_bf16 v[56:59], a[204:207], v[28:31], v[56:59]
    s_waitcnt lgkmcnt(6)
    v_mfma_f32_16x16x32_bf16 v[60:63], a[200:203], v[32:35], v[60:63]
    ds_read_b128 v[28:31], v11 offset:57344
    v_mfma_f32_16x16x32_bf16 v[64:67], a[204:207], v[32:35], v[64:67]
    s_waitcnt lgkmcnt(6)
    v_mfma_f32_16x16x32_bf16 v[52:55], a[208:211], v[36:39], v[52:55]
    ds_read_b128 v[32:35], v11 offset:57600
    v_mfma_f32_16x16x32_bf16 v[56:59], a[212:215], v[36:39], v[56:59]
    s_waitcnt lgkmcnt(6)
    v_mfma_f32_16x16x32_bf16 v[60:63], a[208:211], v[40:43], v[60:63]
    ds_read_b128 v[36:39], v10 offset:61440
    v_mfma_f32_16x16x32_bf16 v[64:67], a[212:215], v[40:43], v[64:67]
    s_waitcnt lgkmcnt(6)
    v_mfma_f32_16x16x32_bf16 v[52:55], a[216:219], v[44:47], v[52:55]
    ds_read_b128 v[40:43], v10 offset:61696
    v_mfma_f32_16x16x32_bf16 v[56:59], a[220:223], v[44:47], v[56:59]
    s_waitcnt lgkmcnt(6)
    v_mfma_f32_16x16x32_bf16 v[60:63], a[216:219], v[48:51], v[60:63]
    ds_read_b128 v[44:47], v11 offset:61440
    v_mfma_f32_16x16x32_bf16 v[64:67], a[220:223], v[48:51], v[64:67]
    s_waitcnt lgkmcnt(6)
    v_mfma_f32_16x16x32_bf16 v[52:55], a[224:227], v[20:23], v[52:55]
    ds_read_b128 v[48:51], v11 offset:61696
    v_mfma_f32_16x16x32_bf16 v[56:59], a[228:231], v[20:23], v[56:59]
    s_waitcnt lgkmcnt(6)
    v_mfma_f32_16x16x32_bf16 v[60:63], a[224:227], v[24:27], v[60:63]
    s_waitcnt vmcnt(8)
    s_barrier
    ds_read_b128 v[20:23], v12 offset:0
    v_mfma_f32_16x16x32_bf16 v[64:67], a[228:231], v[24:27], v[64:67]
    s_waitcnt lgkmcnt(6)
    v_mfma_f32_16x16x32_bf16 v[52:55], a[232:235], v[28:31], v[52:55]
    ds_read_b128 v[24:27], v12 offset:256
    s_add_u32 m0, s19, 0
    v_mfma_f32_16x16x32_bf16 v[56:59], a[236:239], v[28:31], v[56:59]
    s_add_u32 s17, s20, 0
    buffer_load_dwordx4 v2, s[4:7], s17 offen lds
    s_waitcnt lgkmcnt(6)
    v_mfma_f32_16x16x32_bf16 v[60:63], a[232:235], v[32:35], v[60:63]
    ds_read_b128 v[28:31], v13 offset:0
    v_mfma_f32_16x16x32_bf16 v[64:67], a[236:239], v[32:35], v[64:67]
    s_waitcnt lgkmcnt(6)
    v_mfma_f32_16x16x32_bf16 v[52:55], a[240:243], v[36:39], v[52:55]
    ds_read_b128 v[32:35], v13 offset:256
    s_add_u32 m0, s19, 4096
    v_mfma_f32_16x16x32_bf16 v[56:59], a[244:247], v[36:39], v[56:59]
    s_add_u32 s17, s20, 264192
    buffer_load_dwordx4 v2, s[4:7], s17 offen lds
    s_waitcnt lgkmcnt(6)
    v_mfma_f32_16x16x32_bf16 v[60:63], a[240:243], v[40:43], v[60:63]
    ds_read_b128 v[36:39], v12 offset:4096
    v_mfma_f32_16x16x32_bf16 v[64:67], a[244:247], v[40:43], v[64:67]
    s_waitcnt lgkmcnt(6)
    v_mfma_f32_16x16x32_bf16 v[52:55], a[248:251], v[44:47], v[52:55]
    ds_read_b128 v[40:43], v12 offset:4352
    s_add_u32 m0, s19, 8192
    v_mfma_f32_16x16x32_bf16 v[56:59], a[252:255], v[44:47], v[56:59]
    s_add_u32 s17, s20, 528384
    buffer_load_dwordx4 v2, s[4:7], s17 offen lds
    s_waitcnt lgkmcnt(6)
    v_mfma_f32_16x16x32_bf16 v[60:63], a[248:251], v[48:51], v[60:63]
    ds_read_b128 v[44:47], v13 offset:4096
    v_mfma_f32_16x16x32_bf16 v[64:67], a[252:255], v[48:51], v[64:67]
    s_waitcnt lgkmcnt(6)
    v_mfma_f32_16x16x32_bf16 v[68:71], a[0:3], v[20:23], 0
    ds_read_b128 v[48:51], v13 offset:4352
    v_mfma_f32_16x16x32_bf16 v[72:75], a[4:7], v[20:23], 0
    s_waitcnt lgkmcnt(6)
    v_mfma_f32_16x16x32_bf16 v[76:79], a[0:3], v[24:27], 0
    ds_read_b128 v[20:23], v12 offset:8192
    s_add_u32 m0, s19, 12288
    v_mfma_f32_16x16x32_bf16 v[80:83], a[4:7], v[24:27], 0
    s_add_u32 s17, s20, 792576
    buffer_load_dwordx4 v2, s[4:7], s17 offen lds
    s_waitcnt lgkmcnt(6)
    v_mfma_f32_16x16x32_bf16 v[68:71], a[8:11], v[28:31], v[68:71]
    ds_read_b128 v[24:27], v12 offset:8448
    v_mfma_f32_16x16x32_bf16 v[72:75], a[12:15], v[28:31], v[72:75]
    s_waitcnt lgkmcnt(6)
    v_mfma_f32_16x16x32_bf16 v[76:79], a[8:11], v[32:35], v[76:79]
    ds_read_b128 v[28:31], v13 offset:8192
    s_add_u32 m0, s19, 16384
    v_mfma_f32_16x16x32_bf16 v[80:83], a[12:15], v[32:35], v[80:83]
    s_add_u32 s17, s20, 1056768
    buffer_load_dwordx4 v2, s[4:7], s17 offen lds
    s_waitcnt lgkmcnt(6)
    v_mfma_f32_16x16x32_bf16 v[68:71], a[16:19], v[36:39], v[68:71]
    ds_read_b128 v[32:35], v13 offset:8448
    v_mfma_f32_16x16x32_bf16 v[72:75], a[20:23], v[36:39], v[72:75]
    s_waitcnt lgkmcnt(6)
    v_mfma_f32_16x16x32_bf16 v[76:79], a[16:19], v[40:43], v[76:79]
    ds_read_b128 v[36:39], v12 offset:12288
    s_add_u32 m0, s19, 20480
    v_mfma_f32_16x16x32_bf16 v[80:83], a[20:23], v[40:43], v[80:83]
    s_add_u32 s17, s20, 1320960
    buffer_load_dwordx4 v2, s[4:7], s17 offen lds
    s_waitcnt lgkmcnt(6)
    v_mfma_f32_16x16x32_bf16 v[68:71], a[24:27], v[44:47], v[68:71]
    ds_read_b128 v[40:43], v12 offset:12544
    v_mfma_f32_16x16x32_bf16 v[72:75], a[28:31], v[44:47], v[72:75]
    s_waitcnt lgkmcnt(6)
    v_mfma_f32_16x16x32_bf16 v[76:79], a[24:27], v[48:51], v[76:79]
    ds_read_b128 v[44:47], v13 offset:12288
    s_add_u32 m0, s19, 24576
    v_mfma_f32_16x16x32_bf16 v[80:83], a[28:31], v[48:51], v[80:83]
    s_add_u32 s17, s20, 1585152
    buffer_load_dwordx4 v2, s[4:7], s17 offen lds
    s_waitcnt lgkmcnt(6)
    v_mfma_f32_16x16x32_bf16 v[68:71], a[32:35], v[20:23], v[68:71]
    ds_read_b128 v[48:51], v13 offset:12544
    v_mfma_f32_16x16x32_bf16 v[72:75], a[36:39], v[20:23], v[72:75]
    s_waitcnt lgkmcnt(6)
    v_mfma_f32_16x16x32_bf16 v[76:79], a[32:35], v[24:27], v[76:79]
    ds_read_b128 v[20:23], v12 offset:16384
    s_add_u32 m0, s19, 28672
    v_mfma_f32_16x16x32_bf16 v[80:83], a[36:39], v[24:27], v[80:83]
    s_add_u32 s17, s20, 1849344
    buffer_load_dwordx4 v2, s[4:7], s17 offen lds
    s_waitcnt lgkmcnt(6)
    v_mfma_f32_16x16x32_bf16 v[68:71], a[40:43], v[28:31], v[68:71]
    ds_read_b128 v[24:27], v12 offset:16640
    v_mfma_f32_16x16x32_bf16 v[72:75], a[44:47], v[28:31], v[72:75]
    v_cvt_pk_bf16_f32 v84, v52, v53
    s_waitcnt lgkmcnt(6)
    v_mfma_f32_16x16x32_bf16 v[76:79], a[40:43], v[32:35], v[76:79]
    ds_read_b128 v[28:31], v13 offset:16384
    v_mfma_f32_16x16x32_bf16 v[80:83], a[44:47], v[32:35], v[80:83]
    v_cvt_pk_bf16_f32 v85, v54, v55
    s_waitcnt lgkmcnt(6)
    v_mfma_f32_16x16x32_bf16 v[68:71], a[48:51], v[36:39], v[68:71]
    ds_read_b128 v[32:35], v13 offset:16640
    v_mfma_f32_16x16x32_bf16 v[72:75], a[52:55], v[36:39], v[72:75]
    v_cvt_pk_bf16_f32 v86, v56, v57
    s_waitcnt lgkmcnt(6)
    v_mfma_f32_16x16x32_bf16 v[76:79], a[48:51], v[40:43], v[76:79]
    ds_read_b128 v[36:39], v12 offset:20480
    v_mfma_f32_16x16x32_bf16 v[80:83], a[52:55], v[40:43], v[80:83]
    v_cvt_pk_bf16_f32 v87, v58, v59
    s_waitcnt lgkmcnt(6)
    v_mfma_f32_16x16x32_bf16 v[68:71], a[56:59], v[44:47], v[68:71]
    ds_read_b128 v[40:43], v12 offset:20736
    v_mfma_f32_16x16x32_bf16 v[72:75], a[60:63], v[44:47], v[72:75]
    v_cvt_pk_bf16_f32 v88, v60, v61
    s_waitcnt lgkmcnt(6)
    v_mfma_f32_16x16x32_bf16 v[76:79], a[56:59], v[48:51], v[76:79]
    ds_read_b128 v[44:47], v13 offset:20480
    v_mfma_f32_16x16x32_bf16 v[80:83], a[60:63], v[48:51], v[80:83]
    v_cvt_pk_bf16_f32 v89, v62, v63
    buffer_store_dwordx4 v[84:87], v3, s[12:15], s21 offen
    s_waitcnt lgkmcnt(6)
    v_mfma_f32_16x16x32_bf16 v[68:71], a[64:67], v[20:23], v[68:71]
    ds_read_b128 v[48:51], v13 offset:20736
    v_mfma_f32_16x16x32_bf16 v[72:75], a[68:71], v[20:23], v[72:75]
    v_cvt_pk_bf16_f32 v90, v64, v65
    s_waitcnt lgkmcnt(6)
    v_mfma_f32_16x16x32_bf16 v[76:79], a[64:67], v[24:27], v[76:79]
    ds_read_b128 v[20:23], v12 offset:24576
    v_mfma_f32_16x16x32_bf16 v[80:83], a[68:71], v[24:27], v[80:83]
    v_cvt_pk_bf16_f32 v91, v66, v67
    s_waitcnt lgkmcnt(6)
    v_mfma_f32_16x16x32_bf16 v[68:71], a[72:75], v[28:31], v[68:71]
    ds_read_b128 v[24:27], v12 offset:24832
    v_mfma_f32_16x16x32_bf16 v[72:75], a[76:79], v[28:31], v[72:75]
    s_waitcnt lgkmcnt(6)
    v_mfma_f32_16x16x32_bf16 v[76:79], a[72:75], v[32:35], v[76:79]
    ds_read_b128 v[28:31], v13 offset:24576
    v_mfma_f32_16x16x32_bf16 v[80:83], a[76:79], v[32:35], v[80:83]
    buffer_store_dwordx4 v[88:91], v4, s[12:15], s21 offen
    s_waitcnt lgkmcnt(6)
    v_mfma_f32_16x16x32_bf16 v[68:71], a[80:83], v[36:39], v[68:71]
    ds_read_b128 v[32:35], v13 offset:24832
    v_mfma_f32_16x16x32_bf16 v[72:75], a[84:87], v[36:39], v[72:75]
    s_add_u32 s21, s21, s25
    s_mov_b32 s25, s26
    s_waitcnt lgkmcnt(6)
    v_mfma_f32_16x16x32_bf16 v[76:79], a[80:83], v[40:43], v[76:79]
    ds_read_b128 v[36:39], v12 offset:28672
    v_mfma_f32_16x16x32_bf16 v[80:83], a[84:87], v[40:43], v[80:83]
    s_waitcnt lgkmcnt(6)
    v_mfma_f32_16x16x32_bf16 v[68:71], a[88:91], v[44:47], v[68:71]
    ds_read_b128 v[40:43], v12 offset:28928
    v_mfma_f32_16x16x32_bf16 v[72:75], a[92:95], v[44:47], v[72:75]
    s_waitcnt lgkmcnt(6)
    v_mfma_f32_16x16x32_bf16 v[76:79], a[88:91], v[48:51], v[76:79]
    ds_read_b128 v[44:47], v13 offset:28672
    v_mfma_f32_16x16x32_bf16 v[80:83], a[92:95], v[48:51], v[80:83]
    s_waitcnt lgkmcnt(6)
    v_mfma_f32_16x16x32_bf16 v[68:71], a[96:99], v[20:23], v[68:71]
    ds_read_b128 v[48:51], v13 offset:28928
    v_mfma_f32_16x16x32_bf16 v[72:75], a[100:103], v[20:23], v[72:75]
    s_waitcnt lgkmcnt(6)
    v_mfma_f32_16x16x32_bf16 v[76:79], a[96:99], v[24:27], v[76:79]
    s_waitcnt vmcnt(10)
    s_barrier
    ds_read_b128 v[20:23], v12 offset:32768
    v_mfma_f32_16x16x32_bf16 v[80:83], a[100:103], v[24:27], v[80:83]
    s_waitcnt lgkmcnt(6)
    v_mfma_f32_16x16x32_bf16 v[68:71], a[104:107], v[28:31], v[68:71]
    ds_read_b128 v[24:27], v12 offset:33024
    s_add_u32 m0, s19, 32768
    v_mfma_f32_16x16x32_bf16 v[72:75], a[108:111], v[28:31], v[72:75]
    s_add_u32 s17, s20, 2113536
    buffer_load_dwordx4 v2, s[4:7], s17 offen lds
    s_waitcnt lgkmcnt(6)
    v_mfma_f32_16x16x32_bf16 v[76:79], a[104:107], v[32:35], v[76:79]
    ds_read_b128 v[28:31], v13 offset:32768
    v_mfma_f32_16x16x32_bf16 v[80:83], a[108:111], v[32:35], v[80:83]
    s_waitcnt lgkmcnt(6)
    v_mfma_f32_16x16x32_bf16 v[68:71], a[112:115], v[36:39], v[68:71]
    ds_read_b128 v[32:35], v13 offset:33024
    s_add_u32 m0, s19, 36864
    v_mfma_f32_16x16x32_bf16 v[72:75], a[116:119], v[36:39], v[72:75]
    s_add_u32 s17, s20, 2377728
    buffer_load_dwordx4 v2, s[4:7], s17 offen lds
    s_waitcnt lgkmcnt(6)
    v_mfma_f32_16x16x32_bf16 v[76:79], a[112:115], v[40:43], v[76:79]
    ds_read_b128 v[36:39], v12 offset:36864
    v_mfma_f32_16x16x32_bf16 v[80:83], a[116:119], v[40:43], v[80:83]
    s_waitcnt lgkmcnt(6)
    v_mfma_f32_16x16x32_bf16 v[68:71], a[120:123], v[44:47], v[68:71]
    ds_read_b128 v[40:43], v12 offset:37120
    s_add_u32 m0, s19, 40960
    v_mfma_f32_16x16x32_bf16 v[72:75], a[124:127], v[44:47], v[72:75]
    s_add_u32 s17, s20, 2641920
    buffer_load_dwordx4 v2, s[4:7], s17 offen lds
    s_waitcnt lgkmcnt(6)
    v_mfma_f32_16x16x32_bf16 v[76:79], a[120:123], v[48:51], v[76:79]
    ds_read_b128 v[44:47], v13 offset:36864
    v_mfma_f32_16x16x32_bf16 v[80:83], a[124:127], v[48:51], v[80:83]
    s_waitcnt lgkmcnt(6)
    v_mfma_f32_16x16x32_bf16 v[68:71], a[128:131], v[20:23], v[68:71]
    ds_read_b128 v[48:51], v13 offset:37120
    v_mfma_f32_16x16x32_bf16 v[72:75], a[132:135], v[20:23], v[72:75]
    s_waitcnt lgkmcnt(6)
    v_mfma_f32_16x16x32_bf16 v[76:79], a[128:131], v[24:27], v[76:79]
    ds_read_b128 v[20:23], v12 offset:40960
    s_add_u32 m0, s19, 45056
    v_mfma_f32_16x16x32_bf16 v[80:83], a[132:135], v[24:27], v[80:83]
    s_add_u32 s17, s20, 2906112
    buffer_load_dwordx4 v2, s[4:7], s17 offen lds
    s_waitcnt lgkmcnt(6)
    v_mfma_f32_16x16x32_bf16 v[68:71], a[136:139], v[28:31], v[68:71]
    ds_read_b128 v[24:27], v12 offset:41216
    v_mfma_f32_16x16x32_bf16 v[72:75], a[140:143], v[28:31], v[72:75]
    s_waitcnt lgkmcnt(6)
    v_mfma_f32_16x16x32_bf16 v[76:79], a[136:139], v[32:35], v[76:79]
    ds_read_b128 v[28:31], v13 offset:40960
    s_add_u32 m0, s19, 49152
    v_mfma_f32_16x16x32_bf16 v[80:83], a[140:143], v[32:35], v[80:83]
    s_add_u32 s17, s20, 3170304
    buffer_load_dwordx4 v2, s[4:7], s17 offen lds
    s_waitcnt lgkmcnt(6)
    v_mfma_f32_16x16x32_bf16 v[68:71], a[144:147], v[36:39], v[68:71]
    ds_read_b128 v[32:35], v13 offset:41216
    v_mfma_f32_16x16x32_bf16 v[72:75], a[148:151], v[36:39], v[72:75]
    s_waitcnt lgkmcnt(6)
    v_mfma_f32_16x16x32_bf16 v[76:79], a[144:147], v[40:43], v[76:79]
    ds_read_b128 v[36:39], v12 offset:45056
    s_add_u32 m0, s19, 53248
    v_mfma_f32_16x16x32_bf16 v[80:83], a[148:151], v[40:43], v[80:83]
    s_add_u32 s17, s20, 3434496
    buffer_load_dwordx4 v2, s[4:7], s17 offen lds
    s_waitcnt lgkmcnt(6)
    v_mfma_f32_16x16x32_bf16 v[68:71], a[152:155], v[44:47], v[68:71]
    ds_read_b128 v[40:43], v12 offset:45312
    v_mfma_f32_16x16x32_bf16 v[72:75], a[156:159], v[44:47], v[72:75]
    s_waitcnt lgkmcnt(6)
    v_mfma_f32_16x16x32_bf16 v[76:79], a[152:155], v[48:51], v[76:79]
    ds_read_b128 v[44:47], v13 offset:45056
    s_add_u32 m0, s19, 57344
    v_mfma_f32_16x16x32_bf16 v[80:83], a[156:159], v[48:51], v[80:83]
    s_add_u32 s17, s20, 3698688
    buffer_load_dwordx4 v2, s[4:7], s17 offen lds
    s_waitcnt lgkmcnt(6)
    v_mfma_f32_16x16x32_bf16 v[68:71], a[160:163], v[20:23], v[68:71]
    ds_read_b128 v[48:51], v13 offset:45312
    v_mfma_f32_16x16x32_bf16 v[72:75], a[164:167], v[20:23], v[72:75]
    s_waitcnt lgkmcnt(6)
    v_mfma_f32_16x16x32_bf16 v[76:79], a[160:163], v[24:27], v[76:79]
    ds_read_b128 v[20:23], v12 offset:49152
    s_add_u32 m0, s19, 61440
    v_mfma_f32_16x16x32_bf16 v[80:83], a[164:167], v[24:27], v[80:83]
    s_add_u32 s17, s20, 3962880
    buffer_load_dwordx4 v2, s[4:7], s17 offen lds
    s_waitcnt lgkmcnt(6)
    v_mfma_f32_16x16x32_bf16 v[68:71], a[168:171], v[28:31], v[68:71]
    ds_read_b128 v[24:27], v12 offset:49408
    v_mfma_f32_16x16x32_bf16 v[72:75], a[172:175], v[28:31], v[72:75]
    s_add_u32 s20, s20, s24
    s_waitcnt lgkmcnt(6)
    v_mfma_f32_16x16x32_bf16 v[76:79], a[168:171], v[32:35], v[76:79]
    ds_read_b128 v[28:31], v13 offset:49152
    v_mfma_f32_16x16x32_bf16 v[80:83], a[172:175], v[32:35], v[80:83]
    s_waitcnt lgkmcnt(6)
    v_mfma_f32_16x16x32_bf16 v[68:71], a[176:179], v[36:39], v[68:71]
    ds_read_b128 v[32:35], v13 offset:49408
    v_mfma_f32_16x16x32_bf16 v[72:75], a[180:183], v[36:39], v[72:75]
    s_waitcnt lgkmcnt(6)
    v_mfma_f32_16x16x32_bf16 v[76:79], a[176:179], v[40:43], v[76:79]
    ds_read_b128 v[36:39], v12 offset:53248
    v_mfma_f32_16x16x32_bf16 v[80:83], a[180:183], v[40:43], v[80:83]
    s_waitcnt lgkmcnt(6)
    v_mfma_f32_16x16x32_bf16 v[68:71], a[184:187], v[44:47], v[68:71]
    ds_read_b128 v[40:43], v12 offset:53504
    v_mfma_f32_16x16x32_bf16 v[72:75], a[188:191], v[44:47], v[72:75]
    s_waitcnt lgkmcnt(6)
    v_mfma_f32_16x16x32_bf16 v[76:79], a[184:187], v[48:51], v[76:79]
    ds_read_b128 v[44:47], v13 offset:53248
    v_mfma_f32_16x16x32_bf16 v[80:83], a[188:191], v[48:51], v[80:83]
    s_waitcnt lgkmcnt(6)
    v_mfma_f32_16x16x32_bf16 v[68:71], a[192:195], v[20:23], v[68:71]
    ds_read_b128 v[48:51], v13 offset:53504
    v_mfma_f32_16x16x32_bf16 v[72:75], a[196:199], v[20:23], v[72:75]
    s_waitcnt lgkmcnt(6)
    v_mfma_f32_16x16x32_bf16 v[76:79], a[192:195], v[24:27], v[76:79]
    ds_read_b128 v[20:23], v12 offset:57344
    v_mfma_f32_16x16x32_bf16 v[80:83], a[196:199], v[24:27], v[80:83]
    s_waitcnt lgkmcnt(6)
    v_mfma_f32_16x16x32_bf16 v[68:71], a[200:203], v[28:31], v[68:71]
    ds_read_b128 v[24:27], v12 offset:57600
    v_mfma_f32_16x16x32_bf16 v[72:75], a[204:207], v[28:31], v[72:75]
    s_waitcnt lgkmcnt(6)
    v_mfma_f32_16x16x32_bf16 v[76:79], a[200:203], v[32:35], v[76:79]
    ds_read_b128 v[28:31], v13 offset:57344
    v_mfma_f32_16x16x32_bf16 v[80:83], a[204:207], v[32:35], v[80:83]
    s_waitcnt lgkmcnt(6)
    v_mfma_f32_16x16x32_bf16 v[68:71], a[208:211], v[36:39], v[68:71]
    ds_read_b128 v[32:35], v13 offset:57600
    v_mfma_f32_16x16x32_bf16 v[72:75], a[212:215], v[36:39], v[72:75]
    s_waitcnt lgkmcnt(6)
    v_mfma_f32_16x16x32_bf16 v[76:79], a[208:211], v[40:43], v[76:79]
    ds_read_b128 v[36:39], v12 offset:61440
    v_mfma_f32_16x16x32_bf16 v[80:83], a[212:215], v[40:43], v[80:83]
    s_waitcnt lgkmcnt(6)
    v_mfma_f32_16x16x32_bf16 v[68:71], a[216:219], v[44:47], v[68:71]
    ds_read_b128 v[40:43], v12 offset:61696
    v_mfma_f32_16x16x32_bf16 v[72:75], a[220:223], v[44:47], v[72:75]
    s_waitcnt lgkmcnt(6)
    v_mfma_f32_16x16x32_bf16 v[76:79], a[216:219], v[48:51], v[76:79]
    ds_read_b128 v[44:47], v13 offset:61440
    v_mfma_f32_16x16x32_bf16 v[80:83], a[220:223], v[48:51], v[80:83]
    s_waitcnt lgkmcnt(6)
    v_mfma_f32_16x16x32_bf16 v[68:71], a[224:227], v[20:23], v[68:71]
    ds_read_b128 v[48:51], v13 offset:61696
    v_mfma_f32_16x16x32_bf16 v[72:75], a[228:231], v[20:23], v[72:75]
    s_waitcnt lgkmcnt(6)
    v_mfma_f32_16x16x32_bf16 v[76:79], a[224:227], v[24:27], v[76:79]
    s_waitcnt vmcnt(8)
    s_barrier
    ds_read_b128 v[20:23], v10 offset:0
    v_mfma_f32_16x16x32_bf16 v[80:83], a[228:231], v[24:27], v[80:83]
    s_waitcnt lgkmcnt(6)
    v_mfma_f32_16x16x32_bf16 v[68:71], a[232:235], v[28:31], v[68:71]
    ds_read_b128 v[24:27], v10 offset:256
    s_add_u32 m0, s19, 65536
    v_mfma_f32_16x16x32_bf16 v[72:75], a[236:239], v[28:31], v[72:75]
    s_add_u32 s17, s20, 0
    buffer_load_dwordx4 v2, s[4:7], s17 offen lds
    s_waitcnt lgkmcnt(6)
    v_mfma_f32_16x16x32_bf16 v[76:79], a[232:235], v[32:35], v[76:79]
    ds_read_b128 v[28:31], v11 offset:0
    v_mfma_f32_16x16x32_bf16 v[80:83], a[236:239], v[32:35], v[80:83]
    s_waitcnt lgkmcnt(6)
    v_mfma_f32_16x16x32_bf16 v[68:71], a[240:243], v[36:39], v[68:71]
    ds_read_b128 v[32:35], v11 offset:256
    s_add_u32 m0, s19, 69632
    v_mfma_f32_16x16x32_bf16 v[72:75], a[244:247], v[36:39], v[72:75]
    s_add_u32 s17, s20, 264192
    buffer_load_dwordx4 v2, s[4:7], s17 offen lds
    s_waitcnt lgkmcnt(6)
    v_mfma_f32_16x16x32_bf16 v[76:79], a[240:243], v[40:43], v[76:79]
    ds_read_b128 v[36:39], v10 offset:4096
    v_mfma_f32_16x16x32_bf16 v[80:83], a[244:247], v[40:43], v[80:83]
    s_waitcnt lgkmcnt(6)
    v_mfma_f32_16x16x32_bf16 v[68:71], a[248:251], v[44:47], v[68:71]
    ds_read_b128 v[40:43], v10 offset:4352
    s_add_u32 m0, s19, 73728
    v_mfma_f32_16x16x32_bf16 v[72:75], a[252:255], v[44:47], v[72:75]
    s_add_u32 s17, s20, 528384
    buffer_load_dwordx4 v2, s[4:7], s17 offen lds
    s_waitcnt lgkmcnt(6)
    v_mfma_f32_16x16x32_bf16 v[76:79], a[248:251], v[48:51], v[76:79]
    ds_read_b128 v[44:47], v11 offset:4096
    v_mfma_f32_16x16x32_bf16 v[80:83], a[252:255], v[48:51], v[80:83]
    s_add_u32 s22, s22, 2
    s_cmp_lt_u32 s22, 16
    s_cbranch_scc1 F3_top
    v_cvt_pk_bf16_f32 v84, v68, v69
    v_cvt_pk_bf16_f32 v85, v70, v71
    v_cvt_pk_bf16_f32 v86, v72, v73
    v_cvt_pk_bf16_f32 v87, v74, v75
    v_cvt_pk_bf16_f32 v88, v76, v77
    v_cvt_pk_bf16_f32 v89, v78, v79
    v_cvt_pk_bf16_f32 v90, v80, v81
    v_cvt_pk_bf16_f32 v91, v82, v83
    buffer_store_dwordx4 v[84:87], v3, s[12:15], s21 offen
    buffer_store_dwordx4 v[88:91], v4, s[12:15], s21 offen
    s_waitcnt vmcnt(0) lgkmcnt(0)
    s_branch W_T
W_T:
    v_and_b32 v7, 19, v1
    v_bfe_u32 v5, v1, 2, 1
    v_bfe_u32 v6, v1, 3, 1
    v_lshl_add_u32 v7, v5, 3, v7
    v_lshl_add_u32 v7, v6, 2, v7
    v_lshrrev_b32 v5, 5, v1
    v_and_b32 v6, 31, v1
    v_lshlrev_b32 v8, 4, v5
    v_lshl_add_u32 v10, v6, 6, v8
    v_lshl_add_u32 v11, v7, 6, v8
    v_mov_b32 v17, 1073741824
    v_cmp_gt_u32 vcc, 8, v6
    s_nop 1
    v_cndmask_b32 v12, v17, v10, vcc
    v_lshlrev_b32 v13, 3, v5
    v_lshl_add_u32 v13, v7, 4, v13
    v_and_b32 v14, 15, v1
    v_lshlrev_b32 v14, 4, v14
    v_lshl_add_u32 v14, v5, 8, v14
    v_bfe_u32 v8, v1, 4, 1
    v_lshl_add_u32 v14, v8, 18, v14
    v_lshrrev_b32 v15, 2, v1
    v_and_b32 v8, 3, v1
    v_lshl_add_u32 v15, v15, 7, v8
    s_lshl_b32 s17, s93, 2
    v_add_u32 v15, s17, v15
    v_lshlrev_b32 v15, 7, v15
    v_add_u32 v15, 100663296, v15
    v_cmp_gt_u32 vcc, 16, v1
    s_nop 1
    v_cndmask_b32 v15, v17, v15, vcc
    v_mov_b32 v16, 0
    s_add_u32 s18, s16, s17
    s_lshl_b32 s18, s18, 7
    s_add_u32 s18, s18, 100728832
    v_lshl_add_u32 v4, v1, 2, s18
    v_cmp_gt_u32 vcc, 32, v1
    s_nop 1
    v_cndmask_b32 v4, v17, v4, vcc
    v_lshlrev_b32 v5, 3, v5
    v_sub_u32 v6, v6, v5
    s_mov_b32 s29, 1040356334
    s_mov_b32 s28, s16
    s_mul_i32 s31, s17, 133120
    s_lshl_b32 s18, s28, 11
    s_add_u32 s31, s31, s18
    s_mul_i32 s32, s17, 33280
    s_lshl_b32 s18, s28, 9
    s_add_u32 s32, s32, s18
    s_add_u32 s32, s32, 71303168
    s_lshl_b32 s33, s28, 18
    s_lshl_b32 s18, s93, 12
    s_add_u32 s33, s33, s18
    s_add_u32 s33, s33, 54525952
    v_mov_b32 v17, 0xff800000
    s_mov_b32 s35, 0
    v_mov_b32 v9, 0
    s_lshl_b32 s33, s28, 19
    s_lshr_b32 s18, s93, 1
    s_lshl_b32 s18, s18, 14
    s_add_u32 s33, s33, s18
    s_and_b32 s18, s93, 1
    s_lshl_b32 s18, s18, 12
    s_add_u32 s33, s33, s18
    s_add_u32 s33, s33, 201334784
    s_xor_b32 s33, s33, s89
    v_and_b32 v10, 31, v1
    v_lshlrev_b32 v10, 5, v10
    v_lshl_add_u32 v10, v5, 1, v10
    v_lshlrev_b32 v11, 5, v7
    v_lshl_add_u32 v11, v5, 1, v11
    v_cmp_le_i32 s[36:37], 0, v6
    v_cmp_le_i32 s[38:39], 1, v6
    v_cmp_le_i32 s[40:41], 2, v6
    v_cmp_le_i32 s[42:43], 3, v6
    v_cmp_le_i32 s[44:45], 4, v6
    v_cmp_le_i32 s[46:47], 5, v6
    v_cmp_le_i32 s[48:49], 6, v6
    v_cmp_le_i32 s[50:51], 7, v6
    v_cmp_le_i32 s[52:53], 16, v6
    v_cmp_le_i32 s[54:55], 17, v6
    v_cmp_le_i32 s[56:57], 18, v6
    v_cmp_le_i32 s[58:59], 19, v6
    v_cmp_le_i32 s[60:61], 20, v6
    v_cmp_le_i32 s[62:63], 21, v6
    v_cmp_le_i32 s[64:65], 22, v6
    v_cmp_le_i32 s[66:67], 23, v6
    v_mov_b32 v54, 0
    v_mov_b32 v55, 0
    v_mov_b32 v58, 0
    v_mov_b32 v59, 0
    v_mov_b32 v62, 0
    v_mov_b32 v63, 0
    v_mov_b32 v66, 0
    v_mov_b32 v67, 0
    v_mov_b32 v102, 0
    v_mov_b32 v103, 0
    v_mov_b32 v106, 0
    v_mov_b32 v107, 0
    v_mov_b32 v110, 0
    v_mov_b32 v111, 0
    v_mov_b32 v114, 0
    v_mov_b32 v115, 0
    v_mov_b32 v158, 0
    v_mov_b32 v159, 0
    s_mov_b32 s30, s92
T_p:
    v_cmp_ge_u32 vcc, s28, v16
    s_nop 0
    s_and_b32 s17, vcc_lo, 4095
    s_cbranch_scc0 T_pk
    s_cmp_ge_u32 s30, 1048576
    s_cselect_b32 s92, 1048576, s92
    s_cbranch_scc1 T_pk
    s_add_u32 s30, s30, 1
    buffer_load_dword v16, v15, s[4:7], 0 offen sc1
    s_sleep 8
    s_waitcnt vmcnt(0)
    s_branch T_p
T_pk:
    s_add_u32 s17, s31, 0
    buffer_load_dwordx4 a[0:3], v10, s[4:7], s17 offen offset:0
    buffer_load_dwordx4 a[4:7], v10, s[4:7], s17 offen offset:1024
    s_add_u32 s17, s31, 133120
    buffer_load_dwordx4 a[8:11], v10, s[4:7], s17 offen offset:0
    buffer_load_dwordx4 a[12:15], v10, s[4:7], s17 offen offset:1024
    s_add_u32 s17, s31, 266240
    buffer_load_dwordx4 a[16:19], v10, s[4:7], s17 offen offset:0
    buffer_load_dwordx4 a[20:23], v10, s[4:7], s17 offen offset:1024
    s_add_u32 s17, s31, 399360
    buffer_load_dwordx4 a[24:27], v10, s[4:7], s17 offen offset:0
    buffer_load_dwordx4 a[28:31], v10, s[4:7], s17 offen offset:1024
    s_add_u32 s17, s31, 17825792
    buffer_load_dwordx4 a[32:35], v11, s[4:7], s17 offen offset:0
    buffer_load_dwordx4 a[36:39], v11, s[4:7], s17 offen offset:1024
    s_add_u32 s17, s31, 17958912
    buffer_load_dwordx4 a[40:43], v11, s[4:7], s17 offen offset:0
    buffer_load_dwordx4 a[44:47], v11, s[4:7], s17 offen offset:1024
    s_add_u32 s17, s31, 18092032
    buffer_load_dwordx4 a[48:51], v11, s[4:7], s17 offen offset:0
    buffer_load_dwordx4 a[52:55], v11, s[4:7], s17 offen offset:1024
    s_add_u32 s17, s31, 18225152
    buffer_load_dwordx4 a[56:59], v11, s[4:7], s17 offen offset:0
    buffer_load_dwordx4 a[60:63], v11, s[4:7], s17 offen offset:1024
    s_add_u32 s17, s31, 35651584
    buffer_load_dwordx4 a[64:67], v11, s[4:7], s17 offen offset:0
    buffer_load_dwordx4 a[68:71], v11, s[4:7], s17 offen offset:1024
    s_add_u32 s17, s31, 35784704
    buffer_load_dwordx4 a[72:75], v11, s[4:7], s17 offen offset:0
    buffer_load_dwordx4 a[76:79], v11, s[4:7], s17 offen offset:1024
    s_add_u32 s17, s31, 35917824
    buffer_load_dwordx4 a[80:83], v11, s[4:7], s17 offen offset:0
    buffer_load_dwordx4 a[84:87], v11, s[4:7], s17 offen offset:1024
    s_add_u32 s17, s31, 36050944
    buffer_load_dwordx4 a[88:91], v11, s[4:7], s17 offen offset:0
    buffer_load_dwordx4 a[92:95], v11, s[4:7], s17 offen offset:1024
T_top0:
    s_cmp_eq_u32 s35, 0
    s_cbranch_scc1 T_slow0
T_go0:
    s_add_u32 s34, s28, 4
    s_min_u32 s68, s34, 63
    s_waitcnt vmcnt(8)
    v_cmp_ge_u32 vcc, s68, v16
    s_nop 0
    s_and_b32 s17, vcc_lo, 0xfff
    s_cbranch_scc1 T_pw0
T_pok0:
    s_add_u32 s31, s31, 8192
    s_add_u32 s32, s32, 2048
    s_and_b32 s17, vcc_lo, 61440
    s_cselect_b32 s35, 0, 1
    s_cselect_b32 s69, 1073741824, s32
    s_cmp_lt_u32 s34, 64
    s_cselect_b32 s68, s31, 1073741824
    s_cselect_b32 s69, s69, 1073741824
    buffer_load_dword v16, v15, s[4:7], 0 offen sc1
    v_mfma_f32_32x32x16_bf16 v[116:131], a[32:35], a[0:3], 0
    s_add_u32 s17, s68, 0
    buffer_load_dwordx4 a[96:99], v10, s[4:7], s17 offen offset:0
    buffer_load_dwordx4 a[100:103], v10, s[4:7], s17 offen offset:1024
    v_mfma_f32_32x32x16_bf16 v[116:131], a[36:39], a[4:7], v[116:131]
    s_add_u32 s17, s68, 133120
    buffer_load_dwordx4 a[104:107], v10, s[4:7], s17 offen offset:0
    buffer_load_dwordx4 a[108:111], v10, s[4:7], s17 offen offset:1024
    v_mfma_f32_32x32x16_bf16 v[116:131], a[40:43], a[8:11], v[116:131]
    s_add_u32 s17, s68, 266240
    buffer_load_dwordx4 a[112:115], v10, s[4:7], s17 offen offset:0
    buffer_load_dwordx4 a[116:119], v10, s[4:7], s17 offen offset:1024
    v_mfma_f32_32x32x16_bf16 v[116:131], a[44:47], a[12:15], v[116:131]
    s_add_u32 s17, s68, 399360
    buffer_load_dwordx4 a[120:123], v10, s[4:7], s17 offen offset:0
    buffer_load_dwordx4 a[124:127], v10, s[4:7], s17 offen offset:1024
    v_mfma_f32_32x32x16_bf16 v[116:131], a[48:51], a[16:19], v[116:131]
    s_add_u32 s17, s68, 17825792
    buffer_load_dwordx4 a[128:131], v11, s[4:7], s17 offen offset:0
    buffer_load_dwordx4 a[132:135], v11, s[4:7], s17 offen offset:1024
    v_mfma_f32_32x32x16_bf16 v[116:131], a[52:55], a[20:23], v[116:131]
    s_add_u32 s17, s68, 17958912
    buffer_load_dwordx4 a[136:139], v11, s[4:7], s17 offen offset:0
    buffer_load_dwordx4 a[140:143], v11, s[4:7], s17 offen offset:1024
    v_mfma_f32_32x32x16_bf16 v[116:131], a[56:59], a[24:27], v[116:131]
    s_add_u32 s17, s68, 18092032
    buffer_load_dwordx4 a[144:147], v11, s[4:7], s17 offen offset:0
    buffer_load_dwordx4 a[148:151], v11, s[4:7], s17 offen offset:1024
    v_mfma_f32_32x32x16_bf16 v[116:131], a[60:63], a[28:31], v[116:131]
    s_add_u32 s17, s68, 18225152
    buffer_load_dwordx4 a[152:155], v11, s[4:7], s17 offen offset:0
    buffer_load_dwordx4 a[156:159], v11, s[4:7], s17 offen offset:1024
    v_mfma_f32_32x32x16_bf16 v[132:147], v[20:23], a[0:3], 0
    s_add_u32 s17, s68, 35651584
    buffer_load_dwordx4 a[160:163], v11, s[4:7], s17 offen offset:0
    buffer_load_dwordx4 a[164:167], v11, s[4:7], s17 offen offset:1024
    v_mfma_f32_32x32x16_bf16 v[132:147], v[24:27], a[4:7], v[132:147]
    s_add_u32 s17, s68, 35784704
    buffer_load_dwordx4 a[168:171], v11, s[4:7], s17 offen offset:0
    buffer_load_dwordx4 a[172:175], v11, s[4:7], s17 offen offset:1024
    v_mfma_f32_32x32x16_bf16 v[132:147], v[28:31], a[8:11], v[132:147]
    s_add_u32 s17, s68, 35917824
    buffer_load_dwordx4 a[176:179], v11, s[4:7], s17 offen offset:0
    buffer_load_dwordx4 a[180:183], v11, s[4:7], s17 offen offset:1024
    v_mfma_f32_32x32x16_bf16 v[132:147], v[32:35], a[12:15], v[132:147]
    s_add_u32 s17, s68, 36050944
    buffer_load_dwordx4 a[184:187], v11, s[4:7], s17 offen offset:0
    buffer_load_dwordx4 a[188:191], v11, s[4:7], s17 offen offset:1024
    v_mfma_f32_32x32x16_bf16 v[132:147], v[36:39], a[16:19], v[132:147]
    s_add_u32 s17, s69, 0
    s_add_u32 s18, s69, 5242880
    buffer_load_dwordx4 v[68:71], v12, s[4:7], s17 offen offset:0
    buffer_load_dwordx4 v[72:75], v12, s[4:7], s17 offen offset:32
    buffer_load_dwordx2 v[100:101], v13, s[4:7], s18 offen
    v_mfma_f32_32x32x16_bf16 v[132:147], v[40:43], a[20:23], v[132:147]
    s_add_u32 s17, s69, 33280
    s_add_u32 s18, s69, 5276160
    buffer_load_dwordx4 v[76:79], v12, s[4:7], s17 offen offset:0
    buffer_load_dwordx4 v[80:83], v12, s[4:7], s17 offen offset:32
    buffer_load_dwordx2 v[104:105], v13, s[4:7], s18 offen
    v_mfma_f32_32x32x16_bf16 v[132:147], v[44:47], a[24:27], v[132:147]
    s_add_u32 s17, s69, 66560
    s_add_u32 s18, s69, 5309440
    buffer_load_dwordx4 v[84:87], v12, s[4:7], s17 offen offset:0
    buffer_load_dwordx4 v[88:91], v12, s[4:7], s17 offen offset:32
    buffer_load_dwordx2 v[108:109], v13, s[4:7], s18 offen
    v_mfma_f32_32x32x16_bf16 v[132:147], v[48:51], a[28:31], v[132:147]
    s_add_u32 s17, s69, 99840
    s_add_u32 s18, s69, 5342720
    buffer_load_dwordx4 v[92:95], v12, s[4:7], s17 offen offset:0
    buffer_load_dwordx4 v[96:99], v12, s[4:7], s17 offen offset:32
    buffer_load_dwordx2 v[112:113], v13, s[4:7], s18 offen
    v_cndmask_b32 v116, v17, v116, s[36:37]
    v_cndmask_b32 v117, v17, v117, s[38:39]
    v_cndmask_b32 v118, v17, v118, s[40:41]
    v_cndmask_b32 v119, v17, v119, s[42:43]
    v_cndmask_b32 v120, v17, v120, s[44:45]
    v_cndmask_b32 v121, v17, v121, s[46:47]
    v_cndmask_b32 v122, v17, v122, s[48:49]
    v_cndmask_b32 v123, v17, v123, s[50:51]
    v_cndmask_b32 v124, v17, v124, s[52:53]
    v_cndmask_b32 v125, v17, v125, s[54:55]
    v_cndmask_b32 v126, v17, v126, s[56:57]
    v_cndmask_b32 v127, v17, v127, s[58:59]
    v_cndmask_b32 v128, v17, v128, s[60:61]
    v_cndmask_b32 v129, v17, v129, s[62:63]
    v_cndmask_b32 v130, v17, v130, s[64:65]
    v_cndmask_b32 v131, v17, v131, s[66:67]
    v_max3_f32 v18, v116, v117, v118
    v_max3_f32 v18, v18, v119, v120
    v_max3_f32 v18, v18, v121, v122
    v_max3_f32 v18, v18, v123, v124
    v_max3_f32 v18, v18, v125, v126
    v_max3_f32 v18, v18, v127, v128
    v_max3_f32 v18, v18, v129, v130
    v_max3_f32 v18, v18, v131, v132
    v_max3_f32 v18, v18, v133, v134
    v_max_f32 v18, v18, v135
    v_mov_b32 v5, v18
    s_nop 1
    v_permlane32_swap_b32 v18, v5
    v_max_f32 v18, v18, v5
    v_mul_f32 v18, s29, v18
    v_fma_f32 v116, v116, s29, -v18
    v_fma_f32 v117, v117, s29, -v18
    v_fma_f32 v118, v118, s29, -v18
    v_fma_f32 v119, v119, s29, -v18
    v_fma_f32 v120, v120, s29, -v18
    v_fma_f32 v121, v121, s29, -v18
    v_fma_f32 v122, v122, s29, -v18
    v_fma_f32 v123, v123, s29, -v18
    v_fma_f32 v124, v124, s29, -v18
    v_fma_f32 v125, v125, s29, -v18
    v_fma_f32 v126, v126, s29, -v18
    v_fma_f32 v127, v127, s29, -v18
    v_fma_f32 v128, v128, s29, -v18
    v_fma_f32 v129, v129, s29, -v18
    v_fma_f32 v130, v130, s29, -v18
    v_fma_f32 v131, v131, s29, -v18
    v_fma_f32 v132, v132, s29, -v18
    v_fma_f32 v133, v133, s29, -v18
    v_fma_f32 v134, v134, s29, -v18
    v_fma_f32 v135, v135, s29, -v18
    v_exp_f32 v116, v116
    v_exp_f32 v117, v117
    v_exp_f32 v118, v118
    v_exp_f32 v119, v119
    v_exp_f32 v120, v120
    v_exp_f32 v121, v121
    v_exp_f32 v122, v122
    v_exp_f32 v123, v123
    v_exp_f32 v124, v124
    v_exp_f32 v125, v125
    v_exp_f32 v126, v126
    v_exp_f32 v127, v127
    v_exp_f32 v128, v128
    v_exp_f32 v129, v129
    v_exp_f32 v130, v130
    v_exp_f32 v131, v131
    v_exp_f32 v132, v132
    v_exp_f32 v133, v133
    v_exp_f32 v134, v134
    v_exp_f32 v135, v135
    s_waitcnt vmcnt(37)
    buffer_store_dword v9, v4, s[4:7], 0 offen sc1
    v_add_f32 v19, v116, v117
    v_add_f32 v6, v118, v119
    v_add_f32 v19, v19, v120
    v_add_f32 v6, v6, v121
    v_add_f32 v19, v19, v122
    v_add_f32 v6, v6, v123
    v_add_f32 v19, v19, v124
    v_add_f32 v6, v6, v125
    v_add_f32 v19, v19, v126
    v_add_f32 v6, v6, v127
    v_add_f32 v19, v19, v128
    v_add_f32 v6, v6, v129
    v_add_f32 v19, v19, v130
    v_add_f32 v6, v6, v131
    v_add_f32 v19, v19, v132
    v_add_f32 v6, v6, v133
    v_add_f32 v19, v19, v134
    v_add_f32 v6, v6, v135
    v_add_f32 v19, v19, v6
    v_mov_b32 v5, v19
    s_nop 1
    v_permlane32_swap_b32 v19, v5
    v_add_f32 v19, v19, v5
    v_rcp_f32 v19, v19
    s_nop 0
    v_mul_f32 v116, v116, v19
    v_mul_f32 v117, v117, v19
    v_mul_f32 v118, v118, v19
    v_mul_f32 v119, v119, v19
    v_mul_f32 v120, v120, v19
    v_mul_f32 v121, v121, v19
    v_mul_f32 v122, v122, v19
    v_mul_f32 v123, v123, v19
    v_mul_f32 v124, v124, v19
    v_mul_f32 v125, v125, v19
    v_mul_f32 v126, v126, v19
    v_mul_f32 v127, v127, v19
    v_mul_f32 v128, v128, v19
    v_mul_f32 v129, v129, v19
    v_mul_f32 v130, v130, v19
    v_mul_f32 v131, v131, v19
    v_mul_f32 v132, v132, v19
    v_mul_f32 v133, v133, v19
    v_mul_f32 v134, v134, v19
    v_mul_f32 v135, v135, v19
    v_cvt_pk_bf16_f32 v148, v116, v117
    v_cvt_pk_bf16_f32 v149, v118, v119
    v_cvt_pk_bf16_f32 v150, v120, v121
    v_cvt_pk_bf16_f32 v151, v122, v123
    v_cvt_pk_bf16_f32 v152, v124, v125
    v_cvt_pk_bf16_f32 v153, v126, v127
    v_cvt_pk_bf16_f32 v154, v128, v129
    v_cvt_pk_bf16_f32 v155, v130, v131
    v_cvt_pk_bf16_f32 v156, v132, v133
    v_cvt_pk_bf16_f32 v157, v134, v135
    v_mfma_f32_32x32x16_bf16 v[160:175], a[64:67], v[148:151], 0
    v_mfma_f32_32x32x16_bf16 v[160:175], a[68:71], v[152:155], v[160:175]
    v_mfma_f32_32x32x16_bf16 v[160:175], v[52:55], v[156:159], v[160:175]
    v_mfma_f32_32x32x16_bf16 v[176:191], a[72:75], v[148:151], 0
    v_mfma_f32_32x32x16_bf16 v[176:191], a[76:79], v[152:155], v[176:191]
    v_mfma_f32_32x32x16_bf16 v[176:191], v[56:59], v[156:159], v[176:191]
    s_nop 2
    v_cvt_pk_bf16_f32 v224, v160, v161
    v_cvt_pk_bf16_f32 v225, v162, v163
    v_cvt_pk_bf16_f32 v226, v164, v165
    v_cvt_pk_bf16_f32 v227, v166, v167
    v_cvt_pk_bf16_f32 v228, v168, v169
    v_cvt_pk_bf16_f32 v229, v170, v171
    v_cvt_pk_bf16_f32 v230, v172, v173
    v_cvt_pk_bf16_f32 v231, v174, v175
    buffer_store_dwordx4 v[224:227], v14, s[4:7], s33 offen offset:0 sc1
    buffer_store_dwordx4 v[228:231], v14, s[4:7], s33 offen offset:512 sc1
    v_mfma_f32_32x32x16_bf16 v[192:207], a[80:83], v[148:151], 0
    v_mfma_f32_32x32x16_bf16 v[192:207], a[84:87], v[152:155], v[192:207]
    v_mfma_f32_32x32x16_bf16 v[192:207], v[60:63], v[156:159], v[192:207]
    v_cvt_pk_bf16_f32 v232, v176, v177
    v_cvt_pk_bf16_f32 v233, v178, v179
    v_cvt_pk_bf16_f32 v234, v180, v181
    v_cvt_pk_bf16_f32 v235, v182, v183
    v_cvt_pk_bf16_f32 v236, v184, v185
    v_cvt_pk_bf16_f32 v237, v186, v187
    v_cvt_pk_bf16_f32 v238, v188, v189
    v_cvt_pk_bf16_f32 v239, v190, v191
    buffer_store_dwordx4 v[232:235], v14, s[4:7], s33 offen offset:1024 sc1
    buffer_store_dwordx4 v[236:239], v14, s[4:7], s33 offen offset:1536 sc1
    v_mfma_f32_32x32x16_bf16 v[208:223], a[88:91], v[148:151], 0
    v_mfma_f32_32x32x16_bf16 v[208:223], a[92:95], v[152:155], v[208:223]
    v_mfma_f32_32x32x16_bf16 v[208:223], v[64:67], v[156:159], v[208:223]
    v_cvt_pk_bf16_f32 v240, v192, v193
    v_cvt_pk_bf16_f32 v241, v194, v195
    v_cvt_pk_bf16_f32 v242, v196, v197
    v_cvt_pk_bf16_f32 v243, v198, v199
    v_cvt_pk_bf16_f32 v244, v200, v201
    v_cvt_pk_bf16_f32 v245, v202, v203
    v_cvt_pk_bf16_f32 v246, v204, v205
    v_cvt_pk_bf16_f32 v247, v206, v207
    buffer_store_dwordx4 v[240:243], v14, s[4:7], s33 offen offset:2048 sc1
    buffer_store_dwordx4 v[244:247], v14, s[4:7], s33 offen offset:2560 sc1
    v_add_u32 v9, 1, v9
    s_nop 0
    v_cvt_pk_bf16_f32 v248, v208, v209
    v_cvt_pk_bf16_f32 v249, v210, v211
    v_cvt_pk_bf16_f32 v250, v212, v213
    v_cvt_pk_bf16_f32 v251, v214, v215
    v_cvt_pk_bf16_f32 v252, v216, v217
    v_cvt_pk_bf16_f32 v253, v218, v219
    v_cvt_pk_bf16_f32 v254, v220, v221
    v_cvt_pk_bf16_f32 v255, v222, v223
    buffer_store_dwordx4 v[248:251], v14, s[4:7], s33 offen offset:3072 sc1
    buffer_store_dwordx4 v[252:255], v14, s[4:7], s33 offen offset:3584 sc1
    s_mov_b32 s28, s34
    s_add_u32 s33, s33, 2097152
    s_xor_b32 s33, s33, 8192
T_top1:
    s_cmp_eq_u32 s35, 0
    s_cbranch_scc1 T_slow1
T_go1:
    s_add_u32 s34, s28, 4
    s_min_u32 s68, s34, 63
    s_waitcnt vmcnt(8)
    v_cmp_ge_u32 vcc, s68, v16
    s_nop 0
    s_and_b32 s17, vcc_lo, 0xfff
    s_cbranch_scc1 T_pw1
T_pok1:
    s_add_u32 s31, s31, 8192
    s_add_u32 s32, s32, 2048
    s_and_b32 s17, vcc_lo, 61440
    s_cselect_b32 s35, 0, 1
    s_cselect_b32 s69, 1073741824, s32
    s_cmp_lt_u32 s34, 64
    s_cselect_b32 s68, s31, 1073741824
    s_cselect_b32 s69, s69, 1073741824
    buffer_load_dword v16, v15, s[4:7], 0 offen sc1
    v_mfma_f32_32x32x16_bf16 v[116:131], a[128:131], a[96:99], 0
    s_add_u32 s17, s68, 0
    buffer_load_dwordx4 a[0:3], v10, s[4:7], s17 offen offset:0
    buffer_load_dwordx4 a[4:7], v10, s[4:7], s17 offen offset:1024
    v_mfma_f32_32x32x16_bf16 v[116:131], a[132:135], a[100:103], v[116:131]
    s_add_u32 s17, s68, 133120
    buffer_load_dwordx4 a[8:11], v10, s[4:7], s17 offen offset:0
    buffer_load_dwordx4 a[12:15], v10, s[4:7], s17 offen offset:1024
    v_mfma_f32_32x32x16_bf16 v[116:131], a[136:139], a[104:107], v[116:131]
    s_add_u32 s17, s68, 266240
    buffer_load_dwordx4 a[16:19], v10, s[4:7], s17 offen offset:0
    buffer_load_dwordx4 a[20:23], v10, s[4:7], s17 offen offset:1024
    v_mfma_f32_32x32x16_bf16 v[116:131], a[140:143], a[108:111], v[116:131]
    s_add_u32 s17, s68, 399360
    buffer_load_dwordx4 a[24:27], v10, s[4:7], s17 offen offset:0
    buffer_load_dwordx4 a[28:31], v10, s[4:7], s17 offen offset:1024
    v_mfma_f32_32x32x16_bf16 v[116:131], a[144:147], a[112:115], v[116:131]
    s_add_u32 s17, s68, 17825792
    buffer_load_dwordx4 a[32:35], v11, s[4:7], s17 offen offset:0
    buffer_load_dwordx4 a[36:39], v11, s[4:7], s17 offen offset:1024
    v_mfma_f32_32x32x16_bf16 v[116:131], a[148:151], a[116:119], v[116:131]
    s_add_u32 s17, s68, 17958912
    buffer_load_dwordx4 a[40:43], v11, s[4:7], s17 offen offset:0
    buffer_load_dwordx4 a[44:47], v11, s[4:7], s17 offen offset:1024
    v_mfma_f32_32x32x16_bf16 v[116:131], a[152:155], a[120:123], v[116:131]
    s_add_u32 s17, s68, 18092032
    buffer_load_dwordx4 a[48:51], v11, s[4:7], s17 offen offset:0
    buffer_load_dwordx4 a[52:55], v11, s[4:7], s17 offen offset:1024
    v_mfma_f32_32x32x16_bf16 v[116:131], a[156:159], a[124:127], v[116:131]
    s_add_u32 s17, s68, 18225152
    buffer_load_dwordx4 a[56:59], v11, s[4:7], s17 offen offset:0
    buffer_load_dwordx4 a[60:63], v11, s[4:7], s17 offen offset:1024
    v_mfma_f32_32x32x16_bf16 v[132:147], v[68:71], a[96:99], 0
    s_add_u32 s17, s68, 35651584
    buffer_load_dwordx4 a[64:67], v11, s[4:7], s17 offen offset:0
    buffer_load_dwordx4 a[68:71], v11, s[4:7], s17 offen offset:1024
    v_mfma_f32_32x32x16_bf16 v[132:147], v[72:75], a[100:103], v[132:147]
    s_add_u32 s17, s68, 35784704
    buffer_load_dwordx4 a[72:75], v11, s[4:7], s17 offen offset:0
    buffer_load_dwordx4 a[76:79], v11, s[4:7], s17 offen offset:1024
    v_mfma_f32_32x32x16_bf16 v[132:147], v[76:79], a[104:107], v[132:147]
    s_add_u32 s17, s68, 35917824
    buffer_load_dwordx4 a[80:83], v11, s[4:7], s17 offen offset:0
    buffer_load_dwordx4 a[84:87], v11, s[4:7], s17 offen offset:1024
    v_mfma_f32_32x32x16_bf16 v[132:147], v[80:83], a[108:111], v[132:147]
    s_add_u32 s17, s68, 36050944
    buffer_load_dwordx4 a[88:91], v11, s[4:7], s17 offen offset:0
    buffer_load_dwordx4 a[92:95], v11, s[4:7], s17 offen offset:1024
    v_mfma_f32_32x32x16_bf16 v[132:147], v[84:87], a[112:115], v[132:147]
    s_add_u32 s17, s69, 0
    s_add_u32 s18, s69, 5242880
    buffer_load_dwordx4 v[20:23], v12, s[4:7], s17 offen offset:0
    buffer_load_dwordx4 v[24:27], v12, s[4:7], s17 offen offset:32
    buffer_load_dwordx2 v[52:53], v13, s[4:7], s18 offen
    v_mfma_f32_32x32x16_bf16 v[132:147], v[88:91], a[116:119], v[132:147]
    s_add_u32 s17, s69, 33280
    s_add_u32 s18, s69, 5276160
    buffer_load_dwordx4 v[28:31], v12, s[4:7], s17 offen offset:0
    buffer_load_dwordx4 v[32:35], v12, s[4:7], s17 offen offset:32
    buffer_load_dwordx2 v[56:57], v13, s[4:7], s18 offen
    v_mfma_f32_32x32x16_bf16 v[132:147], v[92:95], a[120:123], v[132:147]
    s_add_u32 s17, s69, 66560
    s_add_u32 s18, s69, 5309440
    buffer_load_dwordx4 v[36:39], v12, s[4:7], s17 offen offset:0
    buffer_load_dwordx4 v[40:43], v12, s[4:7], s17 offen offset:32
    buffer_load_dwordx2 v[60:61], v13, s[4:7], s18 offen
    v_mfma_f32_32x32x16_bf16 v[132:147], v[96:99], a[124:127], v[132:147]
    s_add_u32 s17, s69, 99840
    s_add_u32 s18, s69, 5342720
    buffer_load_dwordx4 v[44:47], v12, s[4:7], s17 offen offset:0
    buffer_load_dwordx4 v[48:51], v12, s[4:7], s17 offen offset:32
    buffer_load_dwordx2 v[64:65], v13, s[4:7], s18 offen
    v_cndmask_b32 v116, v17, v116, s[36:37]
    v_cndmask_b32 v117, v17, v117, s[38:39]
    v_cndmask_b32 v118, v17, v118, s[40:41]
    v_cndmask_b32 v119, v17, v119, s[42:43]
    v_cndmask_b32 v120, v17, v120, s[44:45]
    v_cndmask_b32 v121, v17, v121, s[46:47]
    v_cndmask_b32 v122, v17, v122, s[48:49]
    v_cndmask_b32 v123, v17, v123, s[50:51]
    v_cndmask_b32 v124, v17, v124, s[52:53]
    v_cndmask_b32 v125, v17, v125, s[54:55]
    v_cndmask_b32 v126, v17, v126, s[56:57]
    v_cndmask_b32 v127, v17, v127, s[58:59]
    v_cndmask_b32 v128, v17, v128, s[60:61]
    v_cndmask_b32 v129, v17, v129, s[62:63]
    v_cndmask_b32 v130, v17, v130, s[64:65]
    v_cndmask_b32 v131, v17, v131, s[66:67]
    v_max3_f32 v18, v116, v117, v118
    v_max3_f32 v18, v18, v119, v120
    v_max3_f32 v18, v18, v121, v122
    v_max3_f32 v18, v18, v123, v124
    v_max3_f32 v18, v18, v125, v126
    v_max3_f32 v18, v18, v127, v128
    v_max3_f32 v18, v18, v129, v130
    v_max3_f32 v18, v18, v131, v132
    v_max3_f32 v18, v18, v133, v134
    v_max_f32 v18, v18, v135
    v_mov_b32 v5, v18
    s_nop 1
    v_permlane32_swap_b32 v18, v5
    v_max_f32 v18, v18, v5
    v_mul_f32 v18, s29, v18
    v_fma_f32 v116, v116, s29, -v18
    v_fma_f32 v117, v117, s29, -v18
    v_fma_f32 v118, v118, s29, -v18
    v_fma_f32 v119, v119, s29, -v18
    v_fma_f32 v120, v120, s29, -v18
    v_fma_f32 v121, v121, s29, -v18
    v_fma_f32 v122, v122, s29, -v18
    v_fma_f32 v123, v123, s29, -v18
    v_fma_f32 v124, v124, s29, -v18
    v_fma_f32 v125, v125, s29, -v18
    v_fma_f32 v126, v126, s29, -v18
    v_fma_f32 v127, v127, s29, -v18
    v_fma_f32 v128, v128, s29, -v18
    v_fma_f32 v129, v129, s29, -v18
    v_fma_f32 v130, v130, s29, -v18
    v_fma_f32 v131, v131, s29, -v18
    v_fma_f32 v132, v132, s29, -v18
    v_fma_f32 v133, v133, s29, -v18
    v_fma_f32 v134, v134, s29, -v18
    v_fma_f32 v135, v135, s29, -v18
    v_exp_f32 v116, v116
    v_exp_f32 v117, v117
    v_exp_f32 v118, v118
    v_exp_f32 v119, v119
    v_exp_f32 v120, v120
    v_exp_f32 v121, v121
    v_exp_f32 v122, v122
    v_exp_f32 v123, v123
    v_exp_f32 v124, v124
    v_exp_f32 v125, v125
    v_exp_f32 v126, v126
    v_exp_f32 v127, v127
    v_exp_f32 v128, v128
    v_exp_f32 v129, v129
    v_exp_f32 v130, v130
    v_exp_f32 v131, v131
    v_exp_f32 v132, v132
    v_exp_f32 v133, v133
    v_exp_f32 v134, v134
    v_exp_f32 v135, v135
    s_waitcnt vmcnt(37)
    buffer_store_dword v9, v4, s[4:7], 0 offen sc1
    v_add_f32 v19, v116, v117
    v_add_f32 v6, v118, v119
    v_add_f32 v19, v19, v120
    v_add_f32 v6, v6, v121
    v_add_f32 v19, v19, v122
    v_add_f32 v6, v6, v123
    v_add_f32 v19, v19, v124
    v_add_f32 v6, v6, v125
    v_add_f32 v19, v19, v126
    v_add_f32 v6, v6, v127
    v_add_f32 v19, v19, v128
    v_add_f32 v6, v6, v129
    v_add_f32 v19, v19, v130
    v_add_f32 v6, v6, v131
    v_add_f32 v19, v19, v132
    v_add_f32 v6, v6, v133
    v_add_f32 v19, v19, v134
    v_add_f32 v6, v6, v135
    v_add_f32 v19, v19, v6
    v_mov_b32 v5, v19
    s_nop 1
    v_permlane32_swap_b32 v19, v5
    v_add_f32 v19, v19, v5
    v_rcp_f32 v19, v19
    s_nop 0
    v_mul_f32 v116, v116, v19
    v_mul_f32 v117, v117, v19
    v_mul_f32 v118, v118, v19
    v_mul_f32 v119, v119, v19
    v_mul_f32 v120, v120, v19
    v_mul_f32 v121, v121, v19
    v_mul_f32 v122, v122, v19
    v_mul_f32 v123, v123, v19
    v_mul_f32 v124, v124, v19
    v_mul_f32 v125, v125, v19
    v_mul_f32 v126, v126, v19
    v_mul_f32 v127, v127, v19
    v_mul_f32 v128, v128, v19
    v_mul_f32 v129, v129, v19
    v_mul_f32 v130, v130, v19
    v_mul_f32 v131, v131, v19
    v_mul_f32 v132, v132, v19
    v_mul_f32 v133, v133, v19
    v_mul_f32 v134, v134, v19
    v_mul_f32 v135, v135, v19
    v_cvt_pk_bf16_f32 v148, v116, v117
    v_cvt_pk_bf16_f32 v149, v118, v119
    v_cvt_pk_bf16_f32 v150, v120, v121
    v_cvt_pk_bf16_f32 v151, v122, v123
    v_cvt_pk_bf16_f32 v152, v124, v125
    v_cvt_pk_bf16_f32 v153, v126, v127
    v_cvt_pk_bf16_f32 v154, v128, v129
    v_cvt_pk_bf16_f32 v155, v130, v131
    v_cvt_pk_bf16_f32 v156, v132, v133
    v_cvt_pk_bf16_f32 v157, v134, v135
    v_mfma_f32_32x32x16_bf16 v[160:175], a[160:163], v[148:151], 0
    v_mfma_f32_32x32x16_bf16 v[160:175], a[164:167], v[152:155], v[160:175]
    v_mfma_f32_32x32x16_bf16 v[160:175], v[100:103], v[156:159], v[160:175]
    v_mfma_f32_32x32x16_bf16 v[176:191], a[168:171], v[148:151], 0
    v_mfma_f32_32x32x16_bf16 v[176:191], a[172:175], v[152:155], v[176:191]
    v_mfma_f32_32x32x16_bf16 v[176:191], v[104:107], v[156:159], v[176:191]
    s_nop 2
    v_cvt_pk_bf16_f32 v224, v160, v161
    v_cvt_pk_bf16_f32 v225, v162, v163
    v_cvt_pk_bf16_f32 v226, v164, v165
    v_cvt_pk_bf16_f32 v227, v166, v167
    v_cvt_pk_bf16_f32 v228, v168, v169
    v_cvt_pk_bf16_f32 v229, v170, v171
    v_cvt_pk_bf16_f32 v230, v172, v173
    v_cvt_pk_bf16_f32 v231, v174, v175
    buffer_store_dwordx4 v[224:227], v14, s[4:7], s33 offen offset:0 sc1
    buffer_store_dwordx4 v[228:231], v14, s[4:7], s33 offen offset:512 sc1
    v_mfma_f32_32x32x16_bf16 v[192:207], a[176:179], v[148:151], 0
    v_mfma_f32_32x32x16_bf16 v[192:207], a[180:183], v[152:155], v[192:207]
    v_mfma_f32_32x32x16_bf16 v[192:207], v[108:111], v[156:159], v[192:207]
    v_cvt_pk_bf16_f32 v232, v176, v177
    v_cvt_pk_bf16_f32 v233, v178, v179
    v_cvt_pk_bf16_f32 v234, v180, v181
    v_cvt_pk_bf16_f32 v235, v182, v183
    v_cvt_pk_bf16_f32 v236, v184, v185
    v_cvt_pk_bf16_f32 v237, v186, v187
    v_cvt_pk_bf16_f32 v238, v188, v189
    v_cvt_pk_bf16_f32 v239, v190, v191
    buffer_store_dwordx4 v[232:235], v14, s[4:7], s33 offen offset:1024 sc1
    buffer_store_dwordx4 v[236:239], v14, s[4:7], s33 offen offset:1536 sc1
    v_mfma_f32_32x32x16_bf16 v[208:223], a[184:187], v[148:151], 0
    v_mfma_f32_32x32x16_bf16 v[208:223], a[188:191], v[152:155], v[208:223]
    v_mfma_f32_32x32x16_bf16 v[208:223], v[112:115], v[156:159], v[208:223]
    v_cvt_pk_bf16_f32 v240, v192, v193
    v_cvt_pk_bf16_f32 v241, v194, v195
    v_cvt_pk_bf16_f32 v242, v196, v197
    v_cvt_pk_bf16_f32 v243, v198, v199
    v_cvt_pk_bf16_f32 v244, v200, v201
    v_cvt_pk_bf16_f32 v245, v202, v203
    v_cvt_pk_bf16_f32 v246, v204, v205
    v_cvt_pk_bf16_f32 v247, v206, v207
    buffer_store_dwordx4 v[240:243], v14, s[4:7], s33 offen offset:2048 sc1
    buffer_store_dwordx4 v[244:247], v14, s[4:7], s33 offen offset:2560 sc1
    v_add_u32 v9, 1, v9
    s_nop 0
    v_cvt_pk_bf16_f32 v248, v208, v209
    v_cvt_pk_bf16_f32 v249, v210, v211
    v_cvt_pk_bf16_f32 v250, v212, v213
    v_cvt_pk_bf16_f32 v251, v214, v215
    v_cvt_pk_bf16_f32 v252, v216, v217
    v_cvt_pk_bf16_f32 v253, v218, v219
    v_cvt_pk_bf16_f32 v254, v220, v221
    v_cvt_pk_bf16_f32 v255, v222, v223
    buffer_store_dwordx4 v[248:251], v14, s[4:7], s33 offen offset:3072 sc1
    buffer_store_dwordx4 v[252:255], v14, s[4:7], s33 offen offset:3584 sc1
    s_mov_b32 s28, s34
    s_add_u32 s33, s33, 2097152
    s_xor_b32 s33, s33, 8192
    s_cmp_lt_u32 s28, 64
    s_cbranch_scc1 T_top0
T_fin:
    s_waitcnt vmcnt(0)
    buffer_store_dword v9, v4, s[4:7], 0 offen sc1
    s_branch W_fin
T_slow0:
    s_waitcnt vmcnt(0)
    buffer_store_dword v9, v4, s[4:7], 0 offen sc1
    s_mov_b32 s30, s92
T_s0:
    v_cmp_ge_u32 vcc, s28, v16
    s_nop 0
    s_and_b32 s17, vcc_lo, 61440
    s_cbranch_scc0 T_sk0
    s_cmp_ge_u32 s30, 1048576
    s_cselect_b32 s92, 1048576, s92
    s_cbranch_scc1 T_sk0
    s_add_u32 s30, s30, 1
    buffer_load_dword v16, v15, s[4:7], 0 offen sc1
    s_sleep 2
    s_waitcnt vmcnt(0)
    s_branch T_s0
T_sk0:
    s_add_u32 s17, s32, 0
    s_add_u32 s18, s32, 5242880
    buffer_load_dwordx4 v[20:23], v12, s[4:7], s17 offen offset:0
    buffer_load_dwordx4 v[24:27], v12, s[4:7], s17 offen offset:32
    buffer_load_dwordx2 v[52:53], v13, s[4:7], s18 offen
    s_add_u32 s17, s32, 33280
    s_add_u32 s18, s32, 5276160
    buffer_load_dwordx4 v[28:31], v12, s[4:7], s17 offen offset:0
    buffer_load_dwordx4 v[32:35], v12, s[4:7], s17 offen offset:32
    buffer_load_dwordx2 v[56:57], v13, s[4:7], s18 offen
    s_add_u32 s17, s32, 66560
    s_add_u32 s18, s32, 5309440
    buffer_load_dwordx4 v[36:39], v12, s[4:7], s17 offen offset:0
    buffer_load_dwordx4 v[40:43], v12, s[4:7], s17 offen offset:32
    buffer_load_dwordx2 v[60:61], v13, s[4:7], s18 offen
    s_add_u32 s17, s32, 99840
    s_add_u32 s18, s32, 5342720
    buffer_load_dwordx4 v[44:47], v12, s[4:7], s17 offen offset:0
    buffer_load_dwordx4 v[48:51], v12, s[4:7], s17 offen offset:32
    buffer_load_dwordx2 v[64:65], v13, s[4:7], s18 offen
    s_waitcnt vmcnt(0)
    s_branch T_go0
T_pw0:
    s_mov_b32 s30, s92
T_q0:
    v_cmp_ge_u32 vcc, s68, v16
    s_nop 0
    s_and_b32 s17, vcc_lo, 4095
    s_cbranch_scc0 T_pok0
    s_cmp_ge_u32 s30, 1048576
    s_cselect_b32 s92, 1048576, s92
    s_cbranch_scc1 T_pok0
    s_add_u32 s30, s30, 1
    buffer_load_dword v16, v15, s[4:7], 0 offen sc1
    s_sleep 8
    s_waitcnt vmcnt(0)
    s_branch T_q0
T_slow1:
    s_waitcnt vmcnt(0)
    buffer_store_dword v9, v4, s[4:7], 0 offen sc1
    s_cmp_ge_u32 s28, 60
    s_cbranch_scc1 T_last
    s_mov_b32 s30, s92
T_s1:
    v_cmp_ge_u32 vcc, s28, v16
    s_nop 0
    s_and_b32 s17, vcc_lo, 61440
    s_cbranch_scc0 T_sk1
    s_cmp_ge_u32 s30, 1048576
    s_cselect_b32 s92, 1048576, s92
    s_cbranch_scc1 T_sk1
    s_add_u32 s30, s30, 1
    buffer_load_dword v16, v15, s[4:7], 0 offen sc1
    s_sleep 2
    s_waitcnt vmcnt(0)
    s_branch T_s1
T_sk1:
    s_add_u32 s17, s32, 0
    s_add_u32 s18, s32, 5242880
    buffer_load_dwordx4 v[68:71], v12, s[4:7], s17 offen offset:0
    buffer_load_dwordx4 v[72:75], v12, s[4:7], s17 offen offset:32
    buffer_load_dwordx2 v[100:101], v13, s[4:7], s18 offen
    s_add_u32 s17, s32, 33280
    s_add_u32 s18, s32, 5276160
    buffer_load_dwordx4 v[76:79], v12, s[4:7], s17 offen offset:0
    buffer_load_dwordx4 v[80:83], v12, s[4:7], s17 offen offset:32
    buffer_load_dwordx2 v[104:105], v13, s[4:7], s18 offen
    s_add_u32 s17, s32, 66560
    s_add_u32 s18, s32, 5309440
    buffer_load_dwordx4 v[84:87], v12, s[4:7], s17 offen offset:0
    buffer_load_dwordx4 v[88:91], v12, s[4:7], s17 offen offset:32
    buffer_load_dwordx2 v[108:109], v13, s[4:7], s18 offen
    s_add_u32 s17, s32, 99840
    s_add_u32 s18, s32, 5342720
    buffer_load_dwordx4 v[92:95], v12, s[4:7], s17 offen offset:0
    buffer_load_dwordx4 v[96:99], v12, s[4:7], s17 offen offset:32
    buffer_load_dwordx2 v[112:113], v13, s[4:7], s18 offen
    s_waitcnt vmcnt(0)
    s_branch T_go1
T_pw1:
    s_mov_b32 s30, s92
T_q1:
    v_cmp_ge_u32 vcc, s68, v16
    s_nop 0
    s_and_b32 s17, vcc_lo, 4095
    s_cbranch_scc0 T_pok1
    s_cmp_ge_u32 s30, 1048576
    s_cselect_b32 s92, 1048576, s92
    s_cbranch_scc1 T_pok1
    s_add_u32 s30, s30, 1
    buffer_load_dword v16, v15, s[4:7], 0 offen sc1
    s_sleep 8
    s_waitcnt vmcnt(0)
    s_branch T_q1
T_last:
    v_mfma_f32_32x32x16_bf16 v[116:131], a[128:131], a[96:99], 0
    v_mfma_f32_32x32x16_bf16 v[116:131], a[132:135], a[100:103], v[116:131]
    v_mfma_f32_32x32x16_bf16 v[116:131], a[136:139], a[104:107], v[116:131]
    v_mfma_f32_32x32x16_bf16 v[116:131], a[140:143], a[108:111], v[116:131]
    v_mfma_f32_32x32x16_bf16 v[116:131], a[144:147], a[112:115], v[116:131]
    v_mfma_f32_32x32x16_bf16 v[116:131], a[148:151], a[116:119], v[116:131]
    v_mfma_f32_32x32x16_bf16 v[116:131], a[152:155], a[120:123], v[116:131]
    v_mfma_f32_32x32x16_bf16 v[116:131], a[156:159], a[124:127], v[116:131]
    s_nop 11
    v_cndmask_b32 v116, v17, v116, s[36:37]
    v_cndmask_b32 v117, v17, v117, s[38:39]
    v_cndmask_b32 v118, v17, v118, s[40:41]
    v_cndmask_b32 v119, v17, v119, s[42:43]
    v_cndmask_b32 v120, v17, v120, s[44:45]
    v_cndmask_b32 v121, v17, v121, s[46:47]
    v_cndmask_b32 v122, v17, v122, s[48:49]
    v_cndmask_b32 v123, v17, v123, s[50:51]
    v_cndmask_b32 v124, v17, v124, s[52:53]
    v_cndmask_b32 v125, v17, v125, s[54:55]
    v_cndmask_b32 v126, v17, v126, s[56:57]
    v_cndmask_b32 v127, v17, v127, s[58:59]
    v_cndmask_b32 v128, v17, v128, s[60:61]
    v_cndmask_b32 v129, v17, v129, s[62:63]
    v_cndmask_b32 v130, v17, v130, s[64:65]
    v_cndmask_b32 v131, v17, v131, s[66:67]
    v_max3_f32 v20, v116, v117, v118
    v_max3_f32 v20, v20, v119, v120
    v_max3_f32 v20, v20, v121, v122
    v_max3_f32 v20, v20, v123, v124
    v_max3_f32 v20, v20, v125, v126
    v_max3_f32 v20, v20, v127, v128
    v_max3_f32 v20, v20, v129, v130
    v_max_f32 v20, v20, v131
    v_mov_b32 v5, v20
    s_nop 1
    v_permlane32_swap_b32 v20, v5
    v_max_f32 v20, v20, v5
    v_mul_f32 v18, s29, v20
    v_fma_f32 v116, v116, s29, -v18
    v_fma_f32 v117, v117, s29, -v18
    v_fma_f32 v118, v118, s29, -v18
    v_fma_f32 v119, v119, s29, -v18
    v_fma_f32 v120, v120, s29, -v18
    v_fma_f32 v121, v121, s29, -v18
    v_fma_f32 v122, v122, s29, -v18
    v_fma_f32 v123, v123, s29, -v18
    v_fma_f32 v124, v124, s29, -v18
    v_fma_f32 v125, v125, s29, -v18
    v_fma_f32 v126, v126, s29, -v18
    v_fma_f32 v127, v127, s29, -v18
    v_fma_f32 v128, v128, s29, -v18
    v_fma_f32 v129, v129, s29, -v18
    v_fma_f32 v130, v130, s29, -v18
    v_fma_f32 v131, v131, s29, -v18
    v_exp_f32 v116, v116
    v_exp_f32 v117, v117
    v_exp_f32 v118, v118
    v_exp_f32 v119, v119
    v_exp_f32 v120, v120
    v_exp_f32 v121, v121
    v_exp_f32 v122, v122
    v_exp_f32 v123, v123
    v_exp_f32 v124, v124
    v_exp_f32 v125, v125
    v_exp_f32 v126, v126
    v_exp_f32 v127, v127
    v_exp_f32 v128, v128
    v_exp_f32 v129, v129
    v_exp_f32 v130, v130
    v_exp_f32 v131, v131
    v_add_f32 v19, v116, v117
    v_add_f32 v19, v19, v118
    v_add_f32 v19, v19, v119
    v_add_f32 v19, v19, v120
    v_add_f32 v19, v19, v121
    v_add_f32 v19, v19, v122
    v_add_f32 v19, v19, v123
    v_add_f32 v19, v19, v124
    v_add_f32 v19, v19, v125
    v_add_f32 v19, v19, v126
    v_add_f32 v19, v19, v127
    v_add_f32 v19, v19, v128
    v_add_f32 v19, v19, v129
    v_add_f32 v19, v19, v130
    v_add_f32 v19, v19, v131
    v_cvt_pk_bf16_f32 v148, v116, v117
    v_cvt_pk_bf16_f32 v149, v118, v119
    v_cvt_pk_bf16_f32 v150, v120, v121
    v_cvt_pk_bf16_f32 v151, v122, v123
    v_cvt_pk_bf16_f32 v152, v124, v125
    v_cvt_pk_bf16_f32 v153, v126, v127
    v_cvt_pk_bf16_f32 v154, v128, v129
    v_cvt_pk_bf16_f32 v155, v130, v131
    v_mfma_f32_32x32x16_bf16 v[160:175], a[160:163], v[148:151], 0
    s_nop 0
    v_mfma_f32_32x32x16_bf16 v[160:175], a[164:167], v[152:155], v[160:175]
    v_mfma_f32_32x32x16_bf16 v[176:191], a[168:171], v[148:151], 0
    v_mfma_f32_32x32x16_bf16 v[176:191], a[172:175], v[152:155], v[176:191]
    v_mfma_f32_32x32x16_bf16 v[192:207], a[176:179], v[148:151], 0
    v_mfma_f32_32x32x16_bf16 v[192:207], a[180:183], v[152:155], v[192:207]
    v_mfma_f32_32x32x16_bf16 v[208:223], a[184:187], v[148:151], 0
    v_mfma_f32_32x32x16_bf16 v[208:223], a[188:191], v[152:155], v[208:223]
    s_cmp_ge_u32 s28, 61
    s_cselect_b64 s[48:49], 0xffff, 0
    s_sub_u32 s34, s28, 2
    s_add_u32 s36, s32, 0
    s_add_u32 s40, s32, 5242880
    s_add_u32 s37, s32, 33280
    s_add_u32 s41, s32, 5276160
    s_add_u32 s38, s32, 66560
    s_add_u32 s42, s32, 5309440
    s_add_u32 s39, s32, 99840
    s_add_u32 s43, s32, 5342720
    v_add_u32 v9, 1, v9
    s_mov_b32 s30, s92
T_l0:
    v_cmp_ge_u32 vcc, s34, v16
    s_nop 0
    s_and_b32 s17, vcc_lo, 61440
    s_cbranch_scc0 T_l1
    s_cmp_ge_u32 s30, 1048576
    s_cselect_b32 s92, 1048576, s92
    s_cbranch_scc1 T_l1
    s_add_u32 s30, s30, 1
    buffer_load_dword v16, v15, s[4:7], 0 offen sc1
    s_sleep 2
    s_waitcnt vmcnt(0)
    s_branch T_l0
T_l2:
    v_max3_u32 v5, v68, v69, v70
    v_max3_u32 v5, v5, v71, v72
    v_max3_u32 v5, v5, v73, v74
    v_max3_u32 v5, v5, v75, v76
    v_max3_u32 v5, v5, v77, v78
    v_max3_u32 v5, v5, v79, v80
    v_max3_u32 v5, v5, v81, v82
    v_max3_u32 v5, v5, v83, v84
    v_max3_u32 v5, v5, v85, v86
    v_max3_u32 v5, v5, v87, v88
    v_max3_u32 v5, v5, v89, v90
    v_max3_u32 v5, v5, v91, v92
    v_max3_u32 v5, v5, v93, v94
    v_max3_u32 v5, v5, v95, v96
    v_max3_u32 v5, v5, v97, v98
    v_max3_u32 v5, v5, v99, v6
    v_cmp_eq_u32 vcc, -1, v5
    s_nop 0
    s_cbranch_vccz T_l3
    s_add_u32 s30, s30, 1
    s_cmp_ge_u32 s30, 1048576
    s_cbranch_scc1 T_l3
T_l1:
    buffer_load_dwordx4 v[68:71], v12, s[4:7], s36 offen offset:0 sc1
    buffer_load_dwordx4 v[72:75], v12, s[4:7], s36 offen offset:32 sc1
    buffer_load_dwordx4 v[76:79], v12, s[4:7], s37 offen offset:0 sc1
    buffer_load_dwordx4 v[80:83], v12, s[4:7], s37 offen offset:32 sc1
    buffer_load_dwordx4 v[84:87], v12, s[4:7], s38 offen offset:0 sc1
    buffer_load_dwordx4 v[88:91], v12, s[4:7], s38 offen offset:32 sc1
    buffer_load_dwordx4 v[92:95], v12, s[4:7], s39 offen offset:0 sc1
    buffer_load_dwordx4 v[96:99], v12, s[4:7], s39 offen offset:32 sc1
    buffer_load_dwordx2 v[100:101], v13, s[4:7], s40 offen sc1
    buffer_load_dwordx2 v[104:105], v13, s[4:7], s41 offen sc1
    buffer_load_dwordx2 v[108:109], v13, s[4:7], s42 offen sc1
    buffer_load_dwordx2 v[112:113], v13, s[4:7], s43 offen sc1
    s_waitcnt vmcnt(11)
    v_mfma_f32_32x32x16_bf16 v[132:147], v[68:71], a[96:99], 0
    s_waitcnt vmcnt(10)
    v_mfma_f32_32x32x16_bf16 v[132:147], v[72:75], a[100:103], v[132:147]
    s_waitcnt vmcnt(9)
    v_mfma_f32_32x32x16_bf16 v[132:147], v[76:79], a[104:107], v[132:147]
    s_waitcnt vmcnt(8)
    v_mfma_f32_32x32x16_bf16 v[132:147], v[80:83], a[108:111], v[132:147]
    s_waitcnt vmcnt(7)
    v_mfma_f32_32x32x16_bf16 v[132:147], v[84:87], a[112:115], v[132:147]
    s_waitcnt vmcnt(6)
    v_mfma_f32_32x32x16_bf16 v[132:147], v[88:91], a[116:119], v[132:147]
    s_waitcnt vmcnt(5)
    v_mfma_f32_32x32x16_bf16 v[132:147], v[92:95], a[120:123], v[132:147]
    s_waitcnt vmcnt(4)
    v_mfma_f32_32x32x16_bf16 v[132:147], v[96:99], a[124:127], v[132:147]
    s_waitcnt vmcnt(0)
    v_max3_u32 v6, v100, v101, v104
    v_max3_u32 v6, v6, v105, v108
    v_max3_u32 v6, v6, v109, v112
    v_max_u32 v6, v6, v113
    v_cmp_eq_u32 s[44:45], -1, v6
    s_nop 5
    v_cmp_u_f32 s[46:47], v132, v133
    v_cmp_u_f32 vcc, v134, v135
    v_max3_f32 v18, v132, v133, v20
    s_or_b64 s[44:45], s[44:45], s[46:47]
    v_max3_f32 v18, v134, v135, v18
    s_or_b64 vcc, vcc, s[44:45]
    s_cbranch_vccnz T_l2
T_l3:
    v_mov_b32 v5, v18
    s_nop 1
    v_permlane32_swap_b32 v18, v5
    v_max_f32 v18, v18, v5
    v_mul_f32 v18, s29, v18
    v_fma_f32 v21, v20, s29, -v18
    v_fma_f32 v132, v132, s29, -v18
    v_fma_f32 v133, v133, s29, -v18
    v_fma_f32 v134, v134, s29, -v18
    v_fma_f32 v135, v135, s29, -v18
    v_exp_f32 v21, v21
    v_exp_f32 v132, v132
    v_exp_f32 v133, v133
    v_exp_f32 v134, v134
    v_exp_f32 v135, v135
    v_fma_f32 v19, v19, v21, v132
    v_add_f32 v6, v133, v134
    v_add_f32 v19, v19, v135
    v_add_f32 v19, v19, v6
    v_mov_b32 v5, v19
    s_nop 1
    v_permlane32_swap_b32 v19, v5
    v_add_f32 v19, v19, v5
    v_rcp_f32 v19, v19
    s_nop 0
    v_mul_f32 v21, v21, v19
    v_mul_f32 v132, v132, v19
    v_mul_f32 v133, v133, v19
    v_mul_f32 v134, v134, v19
    v_mul_f32 v135, v135, v19
    v_cvt_pk_bf16_f32 v156, v132, v133
    v_cvt_pk_bf16_f32 v157, v134, v135
    v_mul_f32 v160, v160, v21
    v_mul_f32 v161, v161, v21
    v_mul_f32 v162, v162, v21
    v_mul_f32 v163, v163, v21
    v_mul_f32 v164, v164, v21
    v_mul_f32 v165, v165, v21
    v_mul_f32 v166, v166, v21
    v_mul_f32 v167, v167, v21
    v_mul_f32 v168, v168, v21
    v_mul_f32 v169, v169, v21
    v_mul_f32 v170, v170, v21
    v_mul_f32 v171, v171, v21
    v_mul_f32 v172, v172, v21
    v_mul_f32 v173, v173, v21
    v_mul_f32 v174, v174, v21
    v_mul_f32 v175, v175, v21
    s_nop 1
    v_mfma_f32_32x32x16_bf16 v[160:175], v[100:103], v[156:159], v[160:175]
    v_mul_f32 v176, v176, v21
    v_mul_f32 v177, v177, v21
    v_mul_f32 v178, v178, v21
    v_mul_f32 v179, v179, v21
    v_mul_f32 v180, v180, v21
    v_mul_f32 v181, v181, v21
    v_mul_f32 v182, v182, v21
    v_mul_f32 v183, v183, v21
    v_mul_f32 v184, v184, v21
    v_mul_f32 v185, v185, v21
    v_mul_f32 v186, v186, v21
    v_mul_f32 v187, v187, v21
    v_mul_f32 v188, v188, v21
    v_mul_f32 v189, v189, v21
    v_mul_f32 v190, v190, v21
    v_mul_f32 v191, v191, v21
    s_nop 1
    v_mfma_f32_32x32x16_bf16 v[176:191], v[104:107], v[156:159], v[176:191]
    v_cvt_pk_bf16_f32 v224, v160, v161
    v_cvt_pk_bf16_f32 v225, v162, v163
    v_cvt_pk_bf16_f32 v226, v164, v165
    v_cvt_pk_bf16_f32 v227, v166, v167
    v_cvt_pk_bf16_f32 v228, v168, v169
    v_cvt_pk_bf16_f32 v229, v170, v171
    v_cvt_pk_bf16_f32 v230, v172, v173
    v_cvt_pk_bf16_f32 v231, v174, v175
    buffer_store_dwordx4 v[224:227], v14, s[4:7], s33 offen offset:0 sc1
    buffer_store_dwordx4 v[228:231], v14, s[4:7], s33 offen offset:512 sc1
    v_mul_f32 v192, v192, v21
    v_mul_f32 v193, v193, v21
    v_mul_f32 v194, v194, v21
    v_mul_f32 v195, v195, v21
    v_mul_f32 v196, v196, v21
    v_mul_f32 v197, v197, v21
    v_mul_f32 v198, v198, v21
    v_mul_f32 v199, v199, v21
    v_mul_f32 v200, v200, v21
    v_mul_f32 v201, v201, v21
    v_mul_f32 v202, v202, v21
    v_mul_f32 v203, v203, v21
    v_mul_f32 v204, v204, v21
    v_mul_f32 v205, v205, v21
    v_mul_f32 v206, v206, v21
    v_mul_f32 v207, v207, v21
    s_nop 1
    v_mfma_f32_32x32x16_bf16 v[192:207], v[108:111], v[156:159], v[192:207]
    v_cvt_pk_bf16_f32 v232, v176, v177
    v_cvt_pk_bf16_f32 v233, v178, v179
    v_cvt_pk_bf16_f32 v234, v180, v181
    v_cvt_pk_bf16_f32 v235, v182, v183
    v_cvt_pk_bf16_f32 v236, v184, v185
    v_cvt_pk_bf16_f32 v237, v186, v187
    v_cvt_pk_bf16_f32 v238, v188, v189
    v_cvt_pk_bf16_f32 v239, v190, v191
    buffer_store_dwordx4 v[232:235], v14, s[4:7], s33 offen offset:1024 sc1
    buffer_store_dwordx4 v[236:239], v14, s[4:7], s33 offen offset:1536 sc1
    v_mul_f32 v208, v208, v21
    v_mul_f32 v209, v209, v21
    v_mul_f32 v210, v210, v21
    v_mul_f32 v211, v211, v21
    v_mul_f32 v212, v212, v21
    v_mul_f32 v213, v213, v21
    v_mul_f32 v214, v214, v21
    v_mul_f32 v215, v215, v21
    v_mul_f32 v216, v216, v21
    v_mul_f32 v217, v217, v21
    v_mul_f32 v218, v218, v21
    v_mul_f32 v219, v219, v21
    v_mul_f32 v220, v220, v21
    v_mul_f32 v221, v221, v21
    v_mul_f32 v222, v222, v21
    v_mul_f32 v223, v223, v21
    s_nop 1
    v_mfma_f32_32x32x16_bf16 v[208:223], v[112:115], v[156:159], v[208:223]
    v_cvt_pk_bf16_f32 v240, v192, v193
    v_cvt_pk_bf16_f32 v241, v194, v195
    v_cvt_pk_bf16_f32 v242, v196, v197
    v_cvt_pk_bf16_f32 v243, v198, v199
    v_cvt_pk_bf16_f32 v244, v200, v201
    v_cvt_pk_bf16_f32 v245, v202, v203
    v_cvt_pk_bf16_f32 v246, v204, v205
    v_cvt_pk_bf16_f32 v247, v206, v207
    buffer_store_dwordx4 v[240:243], v14, s[4:7], s33 offen offset:2048 sc1
    buffer_store_dwordx4 v[244:247], v14, s[4:7], s33 offen offset:2560 sc1
    s_nop 1
    v_cvt_pk_bf16_f32 v248, v208, v209
    v_cvt_pk_bf16_f32 v249, v210, v211
    v_cvt_pk_bf16_f32 v250, v212, v213
    v_cvt_pk_bf16_f32 v251, v214, v215
    v_cvt_pk_bf16_f32 v252, v216, v217
    v_cvt_pk_bf16_f32 v253, v218, v219
    v_cvt_pk_bf16_f32 v254, v220, v221
    v_cvt_pk_bf16_f32 v255, v222, v223
    buffer_store_dwordx4 v[248:251], v14, s[4:7], s33 offen offset:3072 sc1
    buffer_store_dwordx4 v[252:255], v14, s[4:7], s33 offen offset:3584 sc1
    s_branch T_fin
W_fin:
W_end:
    s_endpgm
R_entry:
    s_mov_b32 s12, s3
    s_lshr_b32 s13, s2, 3
    s_load_dwordx2 s[4:5], s[0:1], 96
    s_load_dwordx2 s[28:29], s[0:1], 32
    s_load_dwordx2 s[30:31], s[0:1], 40
    s_load_dwordx2 s[32:33], s[0:1], 48
    s_load_dwordx2 s[34:35], s[0:1], 56
    s_load_dwordx2 s[36:37], s[0:1], 64
    v_lshrrev_b32 v19, 6, v0
    v_and_b32 v1, 63, v0
    v_readfirstlane_b32 s14, v19
    s_mov_b32 s6, 268435456
    s_mov_b32 s7, 0x20000
    s_mov_b32 s10, 8388608
    s_mov_b32 s11, 0x20000
    s_mov_b32 s25, 0
    s_mov_b32 s24, 1040356334
    s_waitcnt lgkmcnt(0)
    v_and_b32 v96, 7, v1
    v_bfe_u32 v97, v1, 3, 1
    v_lshrrev_b32 v98, 4, v1
    v_lshlrev_b32 v19, 4, v1
    s_lshl_b32 s21, s12, 14
    s_lshl_b32 s22, s14, 12
    s_add_u32 s21, s21, s22
    s_add_u32 s22, s21, 0
    v_add_u32 v2, s22, v19
    s_add_u32 s22, s21, 229376
    v_add_u32 v8, s22, v19
    s_lshr_b32 s21, s13, 1
    s_lshl_b32 s21, s21, 10
    s_and_b32 s22, s13, 1
    s_lshl_b32 s22, s22, 7
    s_add_u32 s21, s21, s22
    s_lshl_b32 s22, s12, 14
    s_add_u32 s21, s21, s22
    v_lshlrev_b32 v20, 8, v98
    v_lshl_add_u32 v20, v96, 4, v20
    v_lshl_add_u32 v20, v97, 3, v20
    s_add_u32 s22, s21, 229376
    v_add_u32 v7, s22, v20
    s_add_u32 s22, s21, 0
    v_add_u32 v11, s22, v20
    s_lshr_b32 s21, s13, 1
    s_lshl_b32 s21, s21, 14
    s_and_b32 s22, s13, 1
    s_lshl_b32 s22, s22, 12
    s_add_u32 s21, s21, s22
    s_lshl_b32 s22, s12, 10
    s_add_u32 s22, s21, s22
    v_add_u32 v9, s22, v19
    v_xor_b32 v10, 1024, v9
    v_xor_b32 v23, 2048, v9
    v_xor_b32 v244, 3072, v9
    s_mov_b32 s95, 167772160
    s_lshr_b32 s40, s13, 2
    s_lshl_b32 s21, s12, 3
    s_add_u32 s40, s40, s21
    s_and_b32 s41, s13, 3
    s_mul_i32 s21, s40, 5120
    s_add_u32 s21, s21, 65536
    v_add_u32 v5, s21, v19
    v_lshlrev_b32 v20, 2, v1
    s_add_u32 s22, s21, 4096
    v_add_u32 v6, s22, v20
    s_lshl_b32 s22, s41, 10
    s_add_u32 s22, s22, s21
    v_add_u32 v3, s22, v19
    v_mov_b32 v21, 1073741824
    v_cmp_eq_u32 vcc, 0, v97
    s_nop 1
    v_cndmask_b32 v3, v21, v3, vcc
    s_lshl_b32 s22, s41, 8
    s_add_u32 s22, s22, s21
    s_add_u32 s22, s22, 4096
    v_lshlrev_b32 v20, 4, v98
    v_lshl_add_u32 v20, v96, 5, v20
    v_add_u32 v4, s22, v20
    v_cndmask_b32 v4, v4, v21, vcc
    v_cmp_gt_u32 vcc, 2, v98
    s_nop 1
    v_cndmask_b32 v4, v21, v4, vcc
    s_lshl_b32 s27, s40, 7
    s_lshl_b32 s21, s41, 5
    s_add_u32 s27, s27, s21
    v_bfe_u32 v20, v1, 2, 2
    v_and_b32 v22, 3, v1
    v_lshl_add_u32 v20, v20, 3, v22
    v_and_b32 v12, 16, v1
    v_lshl_add_u32 v12, v20, 5, v12
    v_and_b32 v13, 32, v1
    v_lshl_add_u32 v12, v13, 5, v12
    s_and_b32 s21, s14, 1
    s_lshl_b32 s21, s21, 14
    s_lshl_b32 s22, s27, 2
    s_add_u32 s21, s21, s22
    s_add_u32 s21, s21, 100679680
    v_mov_b32 v245, s21
    s_mov_b32 s47, s21
    s_mov_b32 s85, 0
    s_mul_i32 s21, s27, 4160
    v_add_u32 v12, s21, v12
    v_mov_b32 v13, v12
    v_and_b32 v173, 15, v1
    v_lshl_add_u32 v173, v173, 7, s21
    v_mul_u32_u24 v175, 69632, v98
    v_lshl_add_u32 v173, v175, 8, v173
    s_add_u32 s22, s22, 100679680
    v_lshl_add_u32 v174, v98, 14, s22
    v_mov_b32 v175, 0
    v_lshlrev_b32 v15, 4, v20
    v_lshl_add_u32 v15, v98, 5, v15
    s_mul_i32 s21, s27, 1040
    v_add_u32 v15, s21, v15
    v_and_b32 v22, 1, v98
    v_cmp_eq_u32 vcc, 0, v22
    s_nop 1
    v_cndmask_b32 v15, v21, v15, vcc
    v_lshlrev_b32 v14, 6, v96
    v_lshl_add_u32 v14, v98, 4, v14
    v_add_u32 v14, s21, v14
    v_cmp_eq_u32 vcc, 1, v97
    s_nop 1
    v_cndmask_b32 v14, v21, v14, vcc
    v_mov_b32 v16, v19
    s_lshl_b32 s21, s14, 11
    v_add_u32 v17, s21, v19
    v_and_b32 v20, 15, v1
    v_bfe_u32 v22, v1, 2, 2
    v_and_b32 v18, 1, v1
    v_lshl_add_u32 v18, v22, 1, v18
    v_bfe_u32 v22, v1, 1, 1
    v_lshl_add_u32 v18, v22, 3, v18
    s_cmp_eq_u32 s14, 1
    s_cselect_b64 vcc, -1, 0
    v_cndmask_b32 v20, v20, v18, vcc
    v_and_b32 v22, 1, v98
    v_lshlrev_b32 v22, 2, v22
    v_sub_u32 v20, v20, v22
    v_mov_b32 v22, 0x3f80
    v_mov_b32 v18, 0x3f800000
    v_mov_b32 v172, 0x4444
    v_mov_b32 v84, 0xeeee
    v_cmp_eq_u32 vcc, 1, v97
    s_nop 1
    v_cndmask_b32 v172, v172, v84, vcc
    v_cmp_eq_u32 vcc, 0, v20
    s_nop 1
    v_cndmask_b32 v84, 0, v22, vcc
    v_cmp_eq_u32 vcc, 1, v20
    s_nop 1
    v_cndmask_b32 v84, v84, v18, vcc
    v_cmp_eq_u32 vcc, 2, v20
    s_nop 1
    v_cndmask_b32 v85, 0, v22, vcc
    v_cmp_eq_u32 vcc, 3, v20
    s_nop 1
    v_cndmask_b32 v85, v85, v18, vcc
    v_cmp_eq_u32 vcc, 8, v20
    s_nop 1
    v_cndmask_b32 v86, 0, v22, vcc
    v_cmp_eq_u32 vcc, 9, v20
    s_nop 1
    v_cndmask_b32 v86, v86, v18, vcc
    v_cmp_eq_u32 vcc, 10, v20
    s_nop 1
    v_cndmask_b32 v87, 0, v22, vcc
    v_cmp_eq_u32 vcc, 11, v20
    s_nop 1
    v_cndmask_b32 v87, v87, v18, vcc
    s_mov_b32 s16, 81788928
    s_mov_b32 s42, 82083840
    s_mov_b32 s43, 82378752
    s_mov_b32 s44, 82673664
    s_mov_b32 s17, 17825792
    s_mov_b32 s18, 35651584
    s_mov_b32 s19, 71303168
    s_mov_b32 s20, 76546048
    s_mov_b32 s15, 0
    v_mov_b32 v204, -1
    v_mov_b32 v205, -1
    v_mov_b32 v206, -1
    v_mov_b32 v207, -1
    v_mov_b32 v236, 0x3f803f80
    v_mov_b32 v237, 0x3f803f80
    v_mov_b32 v238, 0x3f803f80
    v_mov_b32 v239, 0x3f803f80
    s_mul_i32 s22, s14, 294912
    s_add_u32 s22, s22, 81788928
    buffer_store_dwordx4 v[204:207], v3, s[4:7], s22 offen sc1
    buffer_store_dwordx4 v[204:207], v3, s[4:7], s22 offen offset:128 sc1
    buffer_store_dwordx4 v[204:207], v4, s[4:7], s22 offen sc1
    buffer_store_dwordx2 v[204:205], v7, s[4:7], s22 offen sc1
    buffer_store_dwordx2 v[204:205], v11, s[4:7], s22 offen sc1
    s_lshl_b32 s22, s14, 18
    s_add_u32 s22, s22, 167772160
    buffer_store_dwordx4 v[204:207], v9, s[4:7], s22 offen sc1
    s_add_u32 s22, s22, 8192
    buffer_store_dwordx4 v[204:207], v9, s[4:7], s22 offen sc1
    s_lshl_b32 s22, s14, 9
    s_add_u32 s22, s22, 71333888
    buffer_store_dwordx4 v[204:207], v14, s[4:7], s22 offen sc1
    s_add_u32 s22, s22, 5242880
    buffer_store_dwordx4 v[204:207], v15, s[4:7], s22 offen sc1
    s_lshl_b32 s22, s27, 2
    s_add_u32 s22, s22, 100712448
    v_lshlrev_b32 v246, 2, v1
    v_add_u32 v246, s22, v246
    v_cmp_gt_u32 vcc, 32, v1
    s_nop 1
    v_cndmask_b32 v246, v21, v246, vcc
    v_mov_b32 v247, 0
    buffer_store_dword v247, v246, s[4:7], 0 offen sc1
    v_lshrrev_b32 v19, 2, v1
    v_and_b32 v22, 3, v1
    v_lshlrev_b32 v22, 4, v22
    v_lshl_add_u32 v140, v19, 13, v22
    v_lshl_add_u32 v141, v19, 11, v22
    s_mul_i32 s86, s14, 40960
    s_lshr_b32 s21, s13, 3
    s_cmp_eq_u32 s21, 1
    s_cselect_b64 s[88:89], s[32:33], s[30:31]
    s_cmp_eq_u32 s21, 2
    s_cselect_b64 s[88:89], s[34:35], s[88:89]
    s_cmp_eq_u32 s21, 3
    s_cselect_b64 s[88:89], s[36:37], s[88:89]
    s_mov_b32 s90, 8388608
    s_mov_b32 s91, 0x20000
    s_cselect_b32 s21, 11, 13
    s_cselect_b32 s92, 21, 11
    s_lshl_b32 s92, s12, s92
    s_and_b32 s22, s13, 3
    s_lshl_b32 s22, s22, 8
    v_add_u32 v142, s22, v0
    v_lshlrev_b32 v142, s21, v142
    s_and_b32 s22, s13, 4
    s_lshl_b32 s22, s22, 8
    s_add_u32 s92, s92, s22
    s_lshr_b32 s22, s13, 3
    s_lshl2_add_u32 s22, s12, s22
    s_bitcmp1_b32 26214, s22
    s_cselect_b32 s21, s92, 1073741824
    buffer_load_dword v143, v142, s[88:91], s21 offen offset:384
    s_cmp_eq_u32 s92, 7168
    s_cselect_b32 s92, s92, 1073741824
    s_bitcmp1_b32 26214, s22
    s_cselect_b32 s21, s92, 1073741824
    buffer_load_dword v143, v142, s[88:91], s21 offen offset:896
    s_mov_b32 s8, s32
    s_mov_b32 s9, s33
    s_lshl_b32 s87, s14, 21
    s_lshl_b32 s22, s27, 1
    s_add_u32 s87, s87, s22
    s_add_u32 m0, s86, 0
    s_nop 0
    buffer_load_dwordx4 v140, s[8:11], s87 offen lds
    s_add_u32 s87, s87, 131072
    s_add_u32 m0, s86, 1024
    s_nop 0
    buffer_load_dwordx4 v140, s[8:11], s87 offen lds
    s_add_u32 s87, s87, 131072
    s_add_u32 m0, s86, 2048
    s_nop 0
    buffer_load_dwordx4 v140, s[8:11], s87 offen lds
    s_add_u32 s87, s87, 131072
    s_add_u32 m0, s86, 3072
    s_nop 0
    buffer_load_dwordx4 v140, s[8:11], s87 offen lds
    s_add_u32 s87, s87, 131072
    v_bfe_u32 v19, v1, 2, 1
    v_lshl_add_u32 v19, v98, 2, v19
    v_lshl_add_u32 v19, v97, 5, v19
    v_lshl_add_u32 v22, v19, 6, v22
    v_add_u32 v22, s86, v22
    s_waitcnt vmcnt(6)
    s_barrier
    s_cmp_lg_u32 s14, 0
    s_cbranch_scc1 reg_20
    s_and_b32 s21, s2, 3
    s_lshl_b32 s21, s21, 3
    s_lshl_b32 s22, s98, 2
    s_add_u32 s21, s21, s22
    s_lshl_b32 s21, 1, s21
    s_andn2_b32 s22, s2, 3
    v_mov_b32 v20, s22
    v_mov_b32 v21, s21
    s_mov_b64 exec, 1
    global_atomic_add v20, v21, s[100:101] sc1
    s_mov_b64 exec, -1
reg_20:
    s_barrier
    s_add_u32 m0, s86, 4096
    s_nop 0
    buffer_load_dwordx4 v140, s[8:11], s87 offen lds
    s_add_u32 s87, s87, 131072
    s_add_u32 m0, s86, 5120
    s_nop 0
    buffer_load_dwordx4 v140, s[8:11], s87 offen lds
    s_add_u32 s87, s87, 131072
    s_add_u32 m0, s86, 6144
    s_nop 0
    buffer_load_dwordx4 v140, s[8:11], s87 offen lds
    s_add_u32 s87, s87, 131072
    s_add_u32 m0, s86, 7168
    s_nop 0
    buffer_load_dwordx4 v140, s[8:11], s87 offen lds
    s_add_u32 s87, s87, 131072
    s_add_u32 m0, s86, 8192
    s_nop 0
    buffer_load_dwordx4 v140, s[8:11], s87 offen lds
    s_add_u32 s87, s87, 131072
    s_add_u32 m0, s86, 9216
    s_nop 0
    buffer_load_dwordx4 v140, s[8:11], s87 offen lds
    s_add_u32 s87, s87, 131072
    s_add_u32 m0, s86, 10240
    s_nop 0
    buffer_load_dwordx4 v140, s[8:11], s87 offen lds
    s_add_u32 s87, s87, 131072
    s_add_u32 m0, s86, 11264
    s_nop 0
    buffer_load_dwordx4 v140, s[8:11], s87 offen lds
    s_add_u32 s87, s87, 131072
    s_add_u32 m0, s86, 12288
    s_nop 0
    buffer_load_dwordx4 v140, s[8:11], s87 offen lds
    s_add_u32 s87, s87, 131072
    s_add_u32 m0, s86, 13312
    s_nop 0
    buffer_load_dwordx4 v140, s[8:11], s87 offen lds
    s_add_u32 s87, s87, 131072
    s_add_u32 m0, s86, 14336
    s_nop 0
    buffer_load_dwordx4 v140, s[8:11], s87 offen lds
    s_add_u32 s87, s87, 131072
    s_add_u32 m0, s86, 15360
    s_nop 0
    buffer_load_dwordx4 v140, s[8:11], s87 offen lds
    s_add_u32 s87, s87, 131072
    s_mov_b32 s8, s34
    s_mov_b32 s9, s35
    s_lshl_b32 s87, s14, 21
    s_lshl_b32 s22, s27, 1
    s_add_u32 s87, s87, s22
    s_add_u32 m0, s86, 16384
    s_nop 0
    buffer_load_dwordx4 v140, s[8:11], s87 offen lds
    s_add_u32 s87, s87, 131072
    s_add_u32 m0, s86, 17408
    s_nop 0
    buffer_load_dwordx4 v140, s[8:11], s87 offen lds
    s_add_u32 s87, s87, 131072
    s_add_u32 m0, s86, 18432
    s_nop 0
    buffer_load_dwordx4 v140, s[8:11], s87 offen lds
    s_add_u32 s87, s87, 131072
    s_add_u32 m0, s86, 19456
    s_nop 0
    buffer_load_dwordx4 v140, s[8:11], s87 offen lds
    s_add_u32 s87, s87, 131072
    s_add_u32 m0, s86, 20480
    s_nop 0
    buffer_load_dwordx4 v140, s[8:11], s87 offen lds
    s_add_u32 s87, s87, 131072
    s_add_u32 m0, s86, 21504
    s_nop 0
    buffer_load_dwordx4 v140, s[8:11], s87 offen lds
    s_add_u32 s87, s87, 131072
    s_add_u32 m0, s86, 22528
    s_nop 0
    buffer_load_dwordx4 v140, s[8:11], s87 offen lds
    s_add_u32 s87, s87, 131072
    s_add_u32 m0, s86, 23552
    s_nop 0
    buffer_load_dwordx4 v140, s[8:11], s87 offen lds
    s_add_u32 s87, s87, 131072
    s_add_u32 m0, s86, 24576
    s_nop 0
    buffer_load_dwordx4 v140, s[8:11], s87 offen lds
    s_add_u32 s87, s87, 131072
    s_add_u32 m0, s86, 25600
    s_nop 0
    buffer_load_dwordx4 v140, s[8:11], s87 offen lds
    s_add_u32 s87, s87, 131072
    s_add_u32 m0, s86, 26624
    s_nop 0
    buffer_load_dwordx4 v140, s[8:11], s87 offen lds
    s_add_u32 s87, s87, 131072
    s_add_u32 m0, s86, 27648
    s_nop 0
    buffer_load_dwordx4 v140, s[8:11], s87 offen lds
    s_add_u32 s87, s87, 131072
    s_add_u32 m0, s86, 28672
    s_nop 0
    buffer_load_dwordx4 v140, s[8:11], s87 offen lds
    s_add_u32 s87, s87, 131072
    s_add_u32 m0, s86, 29696
    s_nop 0
    buffer_load_dwordx4 v140, s[8:11], s87 offen lds
    s_add_u32 s87, s87, 131072
    s_add_u32 m0, s86, 30720
    s_nop 0
    buffer_load_dwordx4 v140, s[8:11], s87 offen lds
    s_add_u32 s87, s87, 131072
    s_add_u32 m0, s86, 31744
    s_nop 0
    buffer_load_dwordx4 v140, s[8:11], s87 offen lds
    s_add_u32 s87, s87, 131072
    s_mov_b32 s8, s30
    s_mov_b32 s9, s31
    s_lshl_b32 s87, s14, 21
    s_lshl_b32 s22, s27, 1
    s_add_u32 s87, s87, s22
    s_add_u32 m0, s86, 32768
    s_nop 0
    buffer_load_dwordx4 v140, s[8:11], s87 offen lds
    s_add_u32 s87, s87, 131072
    s_add_u32 m0, s86, 33792
    s_nop 0
    buffer_load_dwordx4 v140, s[8:11], s87 offen lds
    s_add_u32 s87, s87, 131072
    s_add_u32 m0, s86, 34816
    s_nop 0
    buffer_load_dwordx4 v140, s[8:11], s87 offen lds
    s_add_u32 s87, s87, 131072
    s_add_u32 m0, s86, 35840
    s_nop 0
    buffer_load_dwordx4 v140, s[8:11], s87 offen lds
    s_add_u32 s87, s87, 131072
    s_lshr_b32 s21, s13, 3
    s_cmp_eq_u32 s21, 1
    s_cselect_b64 s[88:89], s[32:33], s[30:31]
    s_cmp_eq_u32 s21, 2
    s_cselect_b64 s[88:89], s[34:35], s[88:89]
    s_cmp_eq_u32 s21, 3
    s_cselect_b64 s[88:89], s[36:37], s[88:89]
    s_mov_b32 s90, 8388608
    s_mov_b32 s91, 0x20000
    s_cselect_b32 s21, 11, 13
    s_cselect_b32 s92, 21, 11
    s_lshl_b32 s92, s12, s92
    s_and_b32 s22, s13, 3
    s_lshl_b32 s22, s22, 8
    v_add_u32 v142, s22, v0
    v_lshlrev_b32 v142, s21, v142
    s_and_b32 s22, s13, 4
    s_lshl_b32 s22, s22, 8
    s_add_u32 s92, s92, s22
    s_lshr_b32 s22, s13, 3
    s_lshl2_add_u32 s22, s12, s22
    s_bitcmp1_b32 39321, s22
    s_cselect_b32 s21, s92, 1073741824
    buffer_load_dword v143, v142, s[88:91], s21 offen offset:384
    s_cmp_eq_u32 s92, 7168
    s_cselect_b32 s92, s92, 1073741824
    s_bitcmp1_b32 39321, s22
    s_cselect_b32 s21, s92, 1073741824
    buffer_load_dword v143, v142, s[88:91], s21 offen offset:896
    s_add_u32 m0, s86, 36864
    s_nop 0
    buffer_load_dwordx4 v140, s[8:11], s87 offen lds
    s_add_u32 s87, s87, 131072
    s_add_u32 m0, s86, 37888
    s_nop 0
    buffer_load_dwordx4 v140, s[8:11], s87 offen lds
    s_add_u32 s87, s87, 131072
    s_add_u32 m0, s86, 38912
    s_nop 0
    buffer_load_dwordx4 v140, s[8:11], s87 offen lds
    s_add_u32 s87, s87, 131072
    s_add_u32 m0, s86, 39936
    s_nop 0
    buffer_load_dwordx4 v140, s[8:11], s87 offen lds
    s_add_u32 s87, s87, 131072
    s_waitcnt vmcnt(38)
    ds_read_b64_tr_b16 a[64:65], v22 offset:0
    ds_read_b64_tr_b16 a[66:67], v22 offset:128
    ds_read_b64_tr_b16 a[68:69], v22 offset:1024
    ds_read_b64_tr_b16 a[70:71], v22 offset:1152
    s_waitcnt lgkmcnt(4)
    ds_read_b64_tr_b16 a[96:97], v22 offset:8
    ds_read_b64_tr_b16 a[98:99], v22 offset:136
    ds_read_b64_tr_b16 a[100:101], v22 offset:1032
    ds_read_b64_tr_b16 a[102:103], v22 offset:1160
    s_waitcnt vmcnt(34)
    ds_read_b64_tr_b16 a[72:73], v22 offset:4096
    ds_read_b64_tr_b16 a[74:75], v22 offset:4224
    ds_read_b64_tr_b16 a[76:77], v22 offset:5120
    ds_read_b64_tr_b16 a[78:79], v22 offset:5248
    s_waitcnt lgkmcnt(4)
    ds_read_b64_tr_b16 a[104:105], v22 offset:4104
    ds_read_b64_tr_b16 a[106:107], v22 offset:4232
    ds_read_b64_tr_b16 a[108:109], v22 offset:5128
    ds_read_b64_tr_b16 a[110:111], v22 offset:5256
    s_add_u32 m0, s86, 0
    s_nop 0
    buffer_load_dwordx4 v140, s[8:11], s87 offen lds
    s_add_u32 s87, s87, 131072
    s_add_u32 m0, s86, 1024
    s_nop 0
    buffer_load_dwordx4 v140, s[8:11], s87 offen lds
    s_add_u32 s87, s87, 131072
    s_add_u32 m0, s86, 2048
    s_nop 0
    buffer_load_dwordx4 v140, s[8:11], s87 offen lds
    s_add_u32 s87, s87, 131072
    s_add_u32 m0, s86, 3072
    s_nop 0
    buffer_load_dwordx4 v140, s[8:11], s87 offen lds
    s_add_u32 s87, s87, 131072
    s_waitcnt vmcnt(34)
    ds_read_b64_tr_b16 a[80:81], v22 offset:8192
    ds_read_b64_tr_b16 a[82:83], v22 offset:8320
    ds_read_b64_tr_b16 a[84:85], v22 offset:9216
    ds_read_b64_tr_b16 a[86:87], v22 offset:9344
    s_waitcnt lgkmcnt(4)
    ds_read_b64_tr_b16 a[112:113], v22 offset:8200
    ds_read_b64_tr_b16 a[114:115], v22 offset:8328
    ds_read_b64_tr_b16 a[116:117], v22 offset:9224
    ds_read_b64_tr_b16 a[118:119], v22 offset:9352
    s_add_u32 m0, s86, 4096
    s_nop 0
    buffer_load_dwordx4 v140, s[8:11], s87 offen lds
    s_add_u32 s87, s87, 131072
    s_add_u32 m0, s86, 5120
    s_nop 0
    buffer_load_dwordx4 v140, s[8:11], s87 offen lds
    s_add_u32 s87, s87, 131072
    s_add_u32 m0, s86, 6144
    s_nop 0
    buffer_load_dwordx4 v140, s[8:11], s87 offen lds
    s_add_u32 s87, s87, 131072
    s_add_u32 m0, s86, 7168
    s_nop 0
    buffer_load_dwordx4 v140, s[8:11], s87 offen lds
    s_add_u32 s87, s87, 131072
    s_waitcnt vmcnt(34)
    ds_read_b64_tr_b16 a[88:89], v22 offset:12288
    ds_read_b64_tr_b16 a[90:91], v22 offset:12416
    ds_read_b64_tr_b16 a[92:93], v22 offset:13312
    ds_read_b64_tr_b16 a[94:95], v22 offset:13440
    s_waitcnt lgkmcnt(4)
    ds_read_b64_tr_b16 a[120:121], v22 offset:12296
    ds_read_b64_tr_b16 a[122:123], v22 offset:12424
    ds_read_b64_tr_b16 a[124:125], v22 offset:13320
    ds_read_b64_tr_b16 a[126:127], v22 offset:13448
    s_mov_b32 s8, s36
    s_mov_b32 s9, s37
    s_lshl_b32 s87, s12, 21
    s_lshl_b32 s22, s14, 19
    s_add_u32 s87, s87, s22
    s_lshl_b32 s22, s13, 6
    s_add_u32 s87, s87, s22
    s_add_u32 m0, s86, 8192
    s_nop 0
    buffer_load_dwordx4 v141, s[8:11], s87 offen lds
    s_add_u32 s87, s87, 32768
    s_add_u32 m0, s86, 9216
    s_nop 0
    buffer_load_dwordx4 v141, s[8:11], s87 offen lds
    s_add_u32 s87, s87, 32768
    s_add_u32 m0, s86, 10240
    s_nop 0
    buffer_load_dwordx4 v141, s[8:11], s87 offen lds
    s_add_u32 s87, s87, 32768
    s_add_u32 m0, s86, 11264
    s_nop 0
    buffer_load_dwordx4 v141, s[8:11], s87 offen lds
    s_add_u32 s87, s87, 32768
    s_mov_b32 s88, s28
    s_mov_b32 s89, s29
    s_mov_b32 s90, 16384
    s_mov_b32 s91, 0x20000
    v_lshlrev_b32 v20, 11, v96
    v_lshl_add_u32 v20, v98, 4, v20
    v_lshl_add_u32 v20, v97, 3, v20
    s_lshl_b32 s21, s13, 6
    buffer_load_dwordx2 v[88:89], v20, s[88:91], s21 offen
    v_lshlrev_b32 v90, 2, v1
    global_load_dword v91, v90, s[100:101] sc1
    s_waitcnt vmcnt(36)
    ds_read_b64_tr_b16 a[128:129], v22 offset:16384
    ds_read_b64_tr_b16 a[130:131], v22 offset:16512
    ds_read_b64_tr_b16 a[132:133], v22 offset:17408
    ds_read_b64_tr_b16 a[134:135], v22 offset:17536
    s_waitcnt lgkmcnt(4)
    ds_read_b64_tr_b16 a[160:161], v22 offset:16392
    ds_read_b64_tr_b16 a[162:163], v22 offset:16520
    ds_read_b64_tr_b16 a[164:165], v22 offset:17416
    ds_read_b64_tr_b16 a[166:167], v22 offset:17544
    s_add_u32 m0, s86, 12288
    s_nop 0
    buffer_load_dwordx4 v141, s[8:11], s87 offen lds
    s_add_u32 s87, s87, 32768
    s_add_u32 m0, s86, 13312
    s_nop 0
    buffer_load_dwordx4 v141, s[8:11], s87 offen lds
    s_add_u32 s87, s87, 32768
    s_add_u32 m0, s86, 14336
    s_nop 0
    buffer_load_dwordx4 v141, s[8:11], s87 offen lds
    s_add_u32 s87, s87, 32768
    s_add_u32 m0, s86, 15360
    s_nop 0
    buffer_load_dwordx4 v141, s[8:11], s87 offen lds
    s_add_u32 s87, s87, 32768
    s_waitcnt vmcnt(36)
    ds_read_b64_tr_b16 a[136:137], v22 offset:20480
    ds_read_b64_tr_b16 a[138:139], v22 offset:20608
    ds_read_b64_tr_b16 a[140:141], v22 offset:21504
    ds_read_b64_tr_b16 a[142:143], v22 offset:21632
    s_waitcnt lgkmcnt(4)
    ds_read_b64_tr_b16 a[168:169], v22 offset:20488
    ds_read_b64_tr_b16 a[170:171], v22 offset:20616
    ds_read_b64_tr_b16 a[172:173], v22 offset:21512
    ds_read_b64_tr_b16 a[174:175], v22 offset:21640
    s_add_u32 m0, s86, 16384
    s_nop 0
    buffer_load_dwordx4 v141, s[8:11], s87 offen lds
    s_add_u32 s87, s87, 32768
    s_add_u32 m0, s86, 17408
    s_nop 0
    buffer_load_dwordx4 v141, s[8:11], s87 offen lds
    s_add_u32 s87, s87, 32768
    s_add_u32 m0, s86, 18432
    s_nop 0
    buffer_load_dwordx4 v141, s[8:11], s87 offen lds
    s_add_u32 s87, s87, 32768
    s_add_u32 m0, s86, 19456
    s_nop 0
    buffer_load_dwordx4 v141, s[8:11], s87 offen lds
    s_add_u32 s87, s87, 32768
    s_mul_i32 s22, s14, 294912
    s_add_u32 s22, s22, 81788928
    buffer_load_dword v145, v3, s[4:7], s22 offen offset:0 sc1
    buffer_load_dword v146, v3, s[4:7], s22 offen offset:128 sc1
    buffer_load_dword v147, v4, s[4:7], s22 offen offset:0 sc1
    buffer_load_dword v148, v7, s[4:7], s22 offen offset:0 sc1
    buffer_load_dword v149, v11, s[4:7], s22 offen offset:0 sc1
    s_waitcnt vmcnt(41)
    ds_read_b64_tr_b16 a[144:145], v22 offset:24576
    ds_read_b64_tr_b16 a[146:147], v22 offset:24704
    ds_read_b64_tr_b16 a[148:149], v22 offset:25600
    ds_read_b64_tr_b16 a[150:151], v22 offset:25728
    s_waitcnt lgkmcnt(4)
    ds_read_b64_tr_b16 a[176:177], v22 offset:24584
    ds_read_b64_tr_b16 a[178:179], v22 offset:24712
    ds_read_b64_tr_b16 a[180:181], v22 offset:25608
    ds_read_b64_tr_b16 a[182:183], v22 offset:25736
    s_add_u32 m0, s86, 20480
    s_nop 0
    buffer_load_dwordx4 v141, s[8:11], s87 offen lds
    s_add_u32 s87, s87, 32768
    s_add_u32 m0, s86, 21504
    s_nop 0
    buffer_load_dwordx4 v141, s[8:11], s87 offen lds
    s_add_u32 s87, s87, 32768
    s_add_u32 m0, s86, 22528
    s_nop 0
    buffer_load_dwordx4 v141, s[8:11], s87 offen lds
    s_add_u32 s87, s87, 32768
    s_add_u32 m0, s86, 23552
    s_nop 0
    buffer_load_dwordx4 v141, s[8:11], s87 offen lds
    s_add_u32 s87, s87, 32768
    s_waitcnt vmcnt(41)
    ds_read_b64_tr_b16 a[152:153], v22 offset:28672
    ds_read_b64_tr_b16 a[154:155], v22 offset:28800
    ds_read_b64_tr_b16 a[156:157], v22 offset:29696
    ds_read_b64_tr_b16 a[158:159], v22 offset:29824
    s_waitcnt lgkmcnt(4)
    ds_read_b64_tr_b16 a[184:185], v22 offset:28680
    ds_read_b64_tr_b16 a[186:187], v22 offset:28808
    ds_read_b64_tr_b16 a[188:189], v22 offset:29704
    ds_read_b64_tr_b16 a[190:191], v22 offset:29832
    s_waitcnt vmcnt(37)
    ds_read_b64_tr_b16 a[0:1], v22 offset:32768
    ds_read_b64_tr_b16 a[2:3], v22 offset:32896
    ds_read_b64_tr_b16 a[4:5], v22 offset:33792
    ds_read_b64_tr_b16 a[6:7], v22 offset:33920
    s_waitcnt lgkmcnt(4)
    ds_read_b64_tr_b16 a[32:33], v22 offset:32776
    ds_read_b64_tr_b16 a[34:35], v22 offset:32904
    ds_read_b64_tr_b16 a[36:37], v22 offset:33800
    ds_read_b64_tr_b16 a[38:39], v22 offset:33928
    s_waitcnt vmcnt(31)
    ds_read_b64_tr_b16 a[8:9], v22 offset:36864
    ds_read_b64_tr_b16 a[10:11], v22 offset:36992
    ds_read_b64_tr_b16 a[12:13], v22 offset:37888
    ds_read_b64_tr_b16 a[14:15], v22 offset:38016
    s_waitcnt lgkmcnt(4)
    ds_read_b64_tr_b16 a[40:41], v22 offset:36872
    ds_read_b64_tr_b16 a[42:43], v22 offset:37000
    ds_read_b64_tr_b16 a[44:45], v22 offset:37896
    ds_read_b64_tr_b16 a[46:47], v22 offset:38024
    s_waitcnt vmcnt(27)
    ds_read_b64_tr_b16 a[16:17], v22 offset:0
    ds_read_b64_tr_b16 a[18:19], v22 offset:128
    ds_read_b64_tr_b16 a[20:21], v22 offset:1024
    ds_read_b64_tr_b16 a[22:23], v22 offset:1152
    s_waitcnt lgkmcnt(4)
    ds_read_b64_tr_b16 a[48:49], v22 offset:8
    ds_read_b64_tr_b16 a[50:51], v22 offset:136
    ds_read_b64_tr_b16 a[52:53], v22 offset:1032
    ds_read_b64_tr_b16 a[54:55], v22 offset:1160
    s_waitcnt vmcnt(23)
    ds_read_b64_tr_b16 a[24:25], v22 offset:4096
    ds_read_b64_tr_b16 a[26:27], v22 offset:4224
    ds_read_b64_tr_b16 a[28:29], v22 offset:5120
    ds_read_b64_tr_b16 a[30:31], v22 offset:5248
    s_waitcnt lgkmcnt(4)
    ds_read_b64_tr_b16 a[56:57], v22 offset:4104
    ds_read_b64_tr_b16 a[58:59], v22 offset:4232
    ds_read_b64_tr_b16 a[60:61], v22 offset:5128
    ds_read_b64_tr_b16 a[62:63], v22 offset:5256
    s_waitcnt vmcnt(19)
    ds_read_b64_tr_b16 a[192:193], v22 offset:8192
    ds_read_b64_tr_b16 a[194:195], v22 offset:8320
    ds_read_b64_tr_b16 a[196:197], v22 offset:9216
    ds_read_b64_tr_b16 a[198:199], v22 offset:9344
    s_waitcnt lgkmcnt(4)
    ds_read_b64_tr_b16 a[224:225], v22 offset:8200
    ds_read_b64_tr_b16 a[226:227], v22 offset:8328
    ds_read_b64_tr_b16 a[228:229], v22 offset:9224
    ds_read_b64_tr_b16 a[230:231], v22 offset:9352
    s_waitcnt vmcnt(13)
    ds_read_b64_tr_b16 a[200:201], v22 offset:12288
    ds_read_b64_tr_b16 a[202:203], v22 offset:12416
    ds_read_b64_tr_b16 a[204:205], v22 offset:13312
    ds_read_b64_tr_b16 a[206:207], v22 offset:13440
    s_waitcnt lgkmcnt(4)
    ds_read_b64_tr_b16 a[232:233], v22 offset:12296
    ds_read_b64_tr_b16 a[234:235], v22 offset:12424
    ds_read_b64_tr_b16 a[236:237], v22 offset:13320
    ds_read_b64_tr_b16 a[238:239], v22 offset:13448
    v_lshlrev_b32 v90, 2, v1
    s_mov_b32 s22, 0
    s_branch rdv_21p
rdv_21:
    global_load_dword v91, v90, s[100:101] sc1
    s_waitcnt vmcnt(0)
rdv_21p:
    s_lshl_b32 s21, s98, 2
    v_lshrrev_b32 v92, s21, v91
    s_cmp_eq_u32 s98, 0
    s_cselect_b32 s21, 0x0f0f0f0f, s21
    s_cselect_b32 s21, s21, 0x01010101
    v_and_b32 v92, s21, v92
    v_cmp_ne_u32 vcc, 0x01010101, v92
    s_nop 0
    s_cbranch_vccz rdvok_22
    v_sad_u8 v92, v92, 0, 0
    s_nop 1
    v_add_u32_dpp v92, v92, v92 quad_perm:[1,0,3,2] row_mask:0xf bank_mask:0xf
    v_cmp_ne_u32 vcc, 8, v92
    s_nop 0
    s_cbranch_vccnz rdvw_23
    s_mov_b32 s98, 1
    s_and_b32 s3, s97, 7
    s_waitcnt vmcnt(0) lgkmcnt(0)
    s_barrier
    s_branch role_start
rdvw_23:
    s_sleep 4
    s_add_u32 s22, s22, 1
    s_cmp_lt_u32 s22, 262144
    s_cbranch_scc1 rdv_21
    s_mov_b32 s25, 200000
rdvok_22:
    v_and_b32 v92, 0x40404040, v91
    v_bcnt_u32_b32 v92, v92, 0
    s_mov_b32 s46, 0
    v_cmp_le_u32 vcc, 1, v92
    s_nop 0
    s_bcnt1_i32_b64 s21, vcc
    s_add_u32 s46, s46, s21
    v_cmp_le_u32 vcc, 2, v92
    s_nop 0
    s_bcnt1_i32_b64 s21, vcc
    s_add_u32 s46, s46, s21
    v_cmp_le_u32 vcc, 3, v92
    s_nop 0
    s_bcnt1_i32_b64 s21, vcc
    s_add_u32 s46, s46, s21
    v_cmp_le_u32 vcc, 4, v92
    s_nop 0
    s_bcnt1_i32_b64 s21, vcc
    s_add_u32 s46, s46, s21
    s_cmp_gt_u32 s46, 16
    s_cselect_b32 s46, 8192, 0
    s_add_u32 s84, s95, s46
    s_xor_b32 s45, s98, 1
    v_min_u32 v88, -2, v88
    v_min_u32 v89, -2, v89
    buffer_store_dwordx2 v[88:89], v11, s[4:7], s16 offen sc1
    s_waitcnt vmcnt(10)
    ds_read_b64_tr_b16 a[208:209], v22 offset:16384
    ds_read_b64_tr_b16 a[210:211], v22 offset:16512
    ds_read_b64_tr_b16 a[212:213], v22 offset:17408
    ds_read_b64_tr_b16 a[214:215], v22 offset:17536
    s_waitcnt lgkmcnt(4)
    ds_read_b64_tr_b16 a[240:241], v22 offset:16392
    ds_read_b64_tr_b16 a[242:243], v22 offset:16520
    ds_read_b64_tr_b16 a[244:245], v22 offset:17416
    ds_read_b64_tr_b16 a[246:247], v22 offset:17544
    buffer_load_dword v247, v245, s[4:7], 0 offen sc1
    s_waitcnt vmcnt(2)
    ds_read_b64_tr_b16 a[216:217], v22 offset:20480
    ds_read_b64_tr_b16 a[218:219], v22 offset:20608
    ds_read_b64_tr_b16 a[220:221], v22 offset:21504
    ds_read_b64_tr_b16 a[222:223], v22 offset:21632
    s_waitcnt lgkmcnt(4)
    ds_read_b64_tr_b16 a[248:249], v22 offset:20488
    ds_read_b64_tr_b16 a[250:251], v22 offset:20616
    ds_read_b64_tr_b16 a[252:253], v22 offset:21512
    ds_read_b64_tr_b16 a[254:255], v22 offset:21640
    s_waitcnt lgkmcnt(0)
    v_mov_b32 v155, 0
    v_mov_b32 v159, 0
    v_mov_b32 v163, 0
    v_mov_b32 v167, 0
    v_mov_b32 v179, 0
    s_waitcnt vmcnt(0)
    v_readfirstlane_b32 s85, v247
    v_mov_b32 v40, 0
    v_mov_b32 v41, 0
    v_mov_b32 v42, 0
    v_mov_b32 v43, 0
    v_mov_b32 v44, 0
    v_mov_b32 v45, 0
    v_mov_b32 v46, 0
    v_mov_b32 v47, 0
    v_mov_b32 v48, 0
    v_mov_b32 v49, 0
    v_mov_b32 v50, 0
    v_mov_b32 v51, 0
    v_mov_b32 v52, 0
    v_mov_b32 v53, 0
    v_mov_b32 v54, 0
    v_mov_b32 v55, 0
    v_mov_b32 v56, 0
    v_mov_b32 v57, 0
    v_mov_b32 v58, 0
    v_mov_b32 v59, 0
    v_mov_b32 v60, 0
    v_mov_b32 v61, 0
    v_mov_b32 v62, 0
    v_mov_b32 v63, 0
    v_mov_b32 v64, 0
    v_mov_b32 v65, 0
    v_mov_b32 v66, 0
    v_mov_b32 v67, 0
    v_mov_b32 v68, 0
    v_mov_b32 v69, 0
    v_mov_b32 v70, 0
    v_mov_b32 v71, 0
    s_cmp_ge_u32 s14, 2
    s_cbranch_scc1 kv_24
    s_mov_b32 s94, 1
    s_mov_b32 s23, s25
fw_26:
    s_cmp_ge_u32 s85, s94
    s_cbranch_scc1 fo_27
    buffer_load_dword v247, v245, s[4:7], 0 offen sc1
    s_add_u32 s23, s23, 1
    s_waitcnt vmcnt(0)
    v_readfirstlane_b32 s85, v247
    s_cmp_lt_u32 s23, 200000
    s_cbranch_scc1 fw_26
    s_mov_b32 s25, 200000
fo_27:
    s_cmp_eq_u32 s14, 1
    s_cbranch_scc1 kv_25
    buffer_load_dwordx4 v[132:135], v12, s[4:7], s17 offen sc1
    buffer_load_dwordx4 v[136:139], v12, s[4:7], s17 offen offset:128 sc1
    s_add_u32 s17, s17, 2048
    s_min_u32 s17, s17, 17954816
    s_branch kv_24
kv_25:
    buffer_load_dwordx4 v[228:231], v13, s[4:7], s18 offen offset:0 sc1
    buffer_load_dwordx4 v[232:235], v13, s[4:7], s18 offen offset:128 sc1
    s_add_u32 s18, s18, 2048
    s_min_u32 s18, s18, 35780608
kv_24:
    s_mul_i32 s86, s27, 4160
    s_add_u32 s86, s86, 17825792
    s_mov_b32 s23, s25
    s_barrier
    s_cmp_eq_u32 s45, 0
    s_cbranch_scc1 recur_slow_disp
    s_cmp_eq_u32 s14, 1
    s_cbranch_scc1 recur_fast_w1
    s_cmp_eq_u32 s14, 2
    s_cbranch_scc1 recur_fast_w2
    s_cmp_eq_u32 s14, 3
    s_cbranch_scc1 recur_fast_w3
    s_branch recur_fast_w0
recur_slow_disp:
    s_cmp_eq_u32 s14, 1
    s_cbranch_scc1 recur_slow_w1
    s_cmp_eq_u32 s14, 2
    s_cbranch_scc1 recur_slow_w2
    s_cmp_eq_u32 s14, 3
    s_cbranch_scc1 recur_slow_w3
    s_branch recur_slow_w0
.p2align 6
recur_fast_w0:
    s_nop 15
    s_mov_b32 s23, s25
    buffer_load_dwordx4 v[24:27], v2, s[4:7], s16 offen offset:0 sc1
    s_nop 11
    buffer_load_dwordx4 v[28:31], v2, s[4:7], s16 offen offset:1024 sc1
    s_nop 11
    buffer_load_dwordx4 v[32:35], v2, s[4:7], s16 offen offset:2048 sc1
    s_nop 11
    buffer_load_dwordx4 v[36:39], v2, s[4:7], s16 offen offset:3072 sc1
    s_waitcnt vmcnt(3)
    v_max3_u32 v19, v24, v25, v26
    v_max_u32 v19, v19, v27
    v_cmp_eq_u32 vcc, -1, v19
    s_nop 0
    s_cbranch_vccnz g_28F15_0
    v_smfmac_f32_16x16x64_bf16 v[40:43], v[24:27], a[0:7], v172
    s_waitcnt vmcnt(2)
    v_max3_u32 v19, v28, v29, v30
    v_max_u32 v19, v19, v31
    v_smfmac_f32_16x16x64_bf16 v[44:47], v[24:27], a[64:71], v172
    v_cmp_eq_u32 vcc, -1, v19
    v_smfmac_f32_16x16x64_bf16 v[48:51], v[24:27], a[32:39], v172
    v_smfmac_f32_16x16x64_bf16 v[52:55], v[24:27], a[96:103], v172
    s_cbranch_vccnz g_28F14_1
    v_smfmac_f32_16x16x64_bf16 v[40:43], v[28:31], a[8:15], v172
    s_waitcnt vmcnt(1)
    v_max3_u32 v19, v32, v33, v34
    v_max_u32 v19, v19, v35
    v_smfmac_f32_16x16x64_bf16 v[44:47], v[28:31], a[72:79], v172
    v_cmp_eq_u32 vcc, -1, v19
    v_smfmac_f32_16x16x64_bf16 v[48:51], v[28:31], a[40:47], v172
    v_smfmac_f32_16x16x64_bf16 v[52:55], v[28:31], a[104:111], v172
    s_cbranch_vccnz g_28F12_2
    v_smfmac_f32_16x16x64_bf16 v[40:43], v[32:35], a[16:23], v172
    s_waitcnt vmcnt(0)
    v_max3_u32 v19, v36, v37, v38
    v_max_u32 v19, v19, v39
    v_smfmac_f32_16x16x64_bf16 v[44:47], v[32:35], a[80:87], v172
    v_cmp_eq_u32 vcc, -1, v19
    v_smfmac_f32_16x16x64_bf16 v[48:51], v[32:35], a[48:55], v172
    v_smfmac_f32_16x16x64_bf16 v[52:55], v[32:35], a[112:119], v172
    s_cbranch_vccnz g_28F8_3
    v_smfmac_f32_16x16x64_bf16 v[40:43], v[36:39], a[24:31], v172
    v_smfmac_f32_16x16x64_bf16 v[44:47], v[36:39], a[88:95], v172
    v_smfmac_f32_16x16x64_bf16 v[48:51], v[36:39], a[56:63], v172
    v_smfmac_f32_16x16x64_bf16 v[52:55], v[36:39], a[120:127], v172
gc_29:
    v_cvt_pk_bf16_f32 v72, v40, v41
    v_cvt_pk_bf16_f32 v73, v42, v43
    v_cvt_pk_bf16_f32 v74, v44, v45
    v_cvt_pk_bf16_f32 v75, v46, v47
    v_smfmac_f32_16x16x64_bf16 v[56:59], v[24:27], a[128:135], v172
    v_cvt_pk_bf16_f32 v76, v48, v49
    v_cvt_pk_bf16_f32 v77, v50, v51
    s_nop 0
    v_cvt_pk_bf16_f32 v78, v52, v53
    v_cvt_pk_bf16_f32 v79, v54, v55
    v_smfmac_f32_16x16x64_bf16 v[60:63], v[24:27], a[160:167], v172
    v_mfma_f32_16x16x32_bf16 v[88:91], v[72:75], v[84:87], 0
    v_mfma_f32_16x16x32_bf16 v[92:95], v[76:79], v[84:87], 0
    v_smfmac_f32_16x16x64_bf16 v[56:59], v[28:31], a[136:143], v172
    v_smfmac_f32_16x16x64_bf16 v[60:63], v[28:31], a[168:175], v172
    s_barrier
    ds_read_b128 v[104:107], v16 offset:2048
    ds_read_b128 v[108:111], v16 offset:3072
    ds_read_b128 v[112:115], v16 offset:4096
    ds_read_b128 v[116:119], v16 offset:5120
    ds_read_b128 v[120:123], v16 offset:6144
    ds_read_b128 v[124:127], v16 offset:7168
    v_smfmac_f32_16x16x64_bf16 v[56:59], v[32:35], a[144:151], v172
    v_smfmac_f32_16x16x64_bf16 v[60:63], v[32:35], a[176:183], v172
    v_smfmac_f32_16x16x64_bf16 v[56:59], v[36:39], a[152:159], v172
    v_smfmac_f32_16x16x64_bf16 v[60:63], v[36:39], a[184:191], v172
    s_waitcnt lgkmcnt(5)
    v_mfma_f32_16x16x32_bf16 v[88:91], v[104:107], v[84:87], v[88:91]
    s_waitcnt lgkmcnt(4)
    v_mfma_f32_16x16x32_bf16 v[92:95], v[108:111], v[84:87], v[92:95]
    s_waitcnt lgkmcnt(3)
    v_mfma_f32_16x16x32_bf16 v[88:91], v[112:115], v[84:87], v[88:91]
    s_waitcnt lgkmcnt(2)
    v_mfma_f32_16x16x32_bf16 v[92:95], v[116:119], v[84:87], v[92:95]
    s_waitcnt lgkmcnt(1)
    v_mfma_f32_16x16x32_bf16 v[88:91], v[120:123], v[84:87], v[88:91]
    s_waitcnt lgkmcnt(0)
    v_mfma_f32_16x16x32_bf16 v[92:95], v[124:127], v[84:87], v[92:95]
    v_cvt_pk_bf16_f32 v80, v56, v57
    v_cvt_pk_bf16_f32 v81, v58, v59
    v_cvt_pk_bf16_f32 v82, v60, v61
    v_cvt_pk_bf16_f32 v83, v62, v63
    ds_write_b128 v17, v[80:83] offset:8192
    s_nop 0
    v_cvt_pk_bf16_f32 v128, v88, v89
    v_cvt_pk_bf16_f32 v129, v90, v91
    v_cvt_pk_bf16_f32 v130, v92, v93
    v_cvt_pk_bf16_f32 v131, v94, v95
    s_nop 1
    v_mfma_f32_16x16x32_bf16 v[144:147], v[132:135], v[128:131], 0
    v_mfma_f32_16x16x32_bf16 v[148:151], v[136:139], v[128:131], 0
    v_mfma_f32_16x16x32_bf16 v[140:143], v[128:131], v[128:131], 0
    s_nop 1
    buffer_store_dwordx4 v[144:147], v3, s[4:7], s16 offen
    s_nop 1
    buffer_store_dwordx4 v[148:151], v3, s[4:7], s16 offen offset:128
    s_nop 1
    buffer_store_dwordx4 v[140:143], v4, s[4:7], s16 offen
    s_cmp_eq_u32 s15, 63
    s_waitcnt lgkmcnt(0)
    s_barrier
    s_cbranch_scc1 recur_fast_last0
    v_readfirstlane_b32 s85, v247
    s_add_u32 s94, s15, 2
    s_barrier
    s_nop 15
    s_mov_b32 s23, s25
    buffer_load_dwordx4 v[24:27], v8, s[4:7], s16 offen offset:0 sc1
    s_nop 11
    buffer_load_dwordx4 v[28:31], v8, s[4:7], s16 offen offset:1024 sc1
    s_nop 11
    buffer_load_dwordx4 v[32:35], v8, s[4:7], s16 offen offset:2048 sc1
    s_nop 11
    buffer_load_dwordx4 v[36:39], v8, s[4:7], s16 offen offset:3072 sc1
    s_waitcnt vmcnt(3)
    v_max3_u32 v19, v24, v25, v26
    v_max_u32 v19, v19, v27
    v_cmp_eq_u32 vcc, -1, v19
    s_nop 0
    s_cbranch_vccnz g_30F15_0
    v_smfmac_f32_16x16x64_bf16 v[64:67], v[24:27], a[192:199], v172
    v_smfmac_f32_16x16x64_bf16 v[68:71], v[24:27], a[224:231], v172
    s_waitcnt vmcnt(2)
    v_max3_u32 v19, v28, v29, v30
    v_max_u32 v19, v19, v31
    v_cmp_eq_u32 vcc, -1, v19
    s_nop 0
    s_cbranch_vccnz g_30F14_1
    v_smfmac_f32_16x16x64_bf16 v[64:67], v[28:31], a[200:207], v172
    v_smfmac_f32_16x16x64_bf16 v[68:71], v[28:31], a[232:239], v172
    s_waitcnt vmcnt(1)
    v_max3_u32 v19, v32, v33, v34
    v_max_u32 v19, v19, v35
    v_cmp_eq_u32 vcc, -1, v19
    s_nop 0
    s_cbranch_vccnz g_30F12_2
    v_smfmac_f32_16x16x64_bf16 v[64:67], v[32:35], a[208:215], v172
    v_smfmac_f32_16x16x64_bf16 v[68:71], v[32:35], a[240:247], v172
    s_waitcnt vmcnt(0)
    v_max3_u32 v19, v36, v37, v38
    v_max_u32 v19, v19, v39
    v_cmp_eq_u32 vcc, -1, v19
    s_nop 0
    s_cbranch_vccnz g_30F8_3
    v_smfmac_f32_16x16x64_bf16 v[64:67], v[36:39], a[216:223], v172
    v_smfmac_f32_16x16x64_bf16 v[68:71], v[36:39], a[248:255], v172
    s_nop 4
    v_cvt_pk_bf16_f32 v80, v64, v65
    v_cvt_pk_bf16_f32 v81, v66, v67
    s_nop 0
    v_cvt_pk_bf16_f32 v82, v68, v69
    v_cvt_pk_bf16_f32 v83, v70, v71
    ds_write_b128 v17, v[80:83] offset:9216
gc_31:
    s_waitcnt lgkmcnt(0)
    s_barrier
    s_mov_b32 s23, s25
fw_32:
    s_cmp_ge_u32 s85, s94
    s_cbranch_scc1 fo_33
    buffer_load_dword v247, v245, s[4:7], 0 offen sc1
    s_add_u32 s23, s23, 1
    s_waitcnt vmcnt(0)
    v_readfirstlane_b32 s85, v247
    s_cmp_lt_u32 s23, 200000
    s_cbranch_scc1 fw_32
    s_mov_b32 s25, 200000
fo_33:
    buffer_load_dwordx4 v[132:135], v12, s[4:7], s17 offen sc1
    buffer_load_dwordx4 v[136:139], v12, s[4:7], s17 offen offset:128 sc1
    s_add_u32 s17, s17, 2048
    s_min_u32 s17, s17, 17954816
    s_nop 15
    s_nop 15
    s_nop 15
    s_nop 15
    buffer_store_dwordx4 v[128:131], v14, s[4:7], s19 offen sc1
    s_add_u32 s19, s19, 512
    s_add_u32 s21, s15, 3
    s_min_u32 s21, s21, 64
    s_cmp_lt_u32 s85, s21
    s_cselect_b64 exec, 1, 0
    buffer_load_dword v247, v245, s[4:7], 0 offen sc1
    s_mov_b64 exec, -1
    v_mov_b32 v40, 0
    v_mov_b32 v41, 0
    v_mov_b32 v42, 0
    v_mov_b32 v43, 0
    v_mov_b32 v44, 0
    v_mov_b32 v45, 0
    v_mov_b32 v46, 0
    v_mov_b32 v47, 0
    v_mov_b32 v48, 0
    v_mov_b32 v49, 0
    v_mov_b32 v50, 0
    v_mov_b32 v51, 0
    v_mov_b32 v52, 0
    v_mov_b32 v53, 0
    v_mov_b32 v54, 0
    v_mov_b32 v55, 0
    v_mov_b32 v56, 0
    v_mov_b32 v57, 0
    v_mov_b32 v58, 0
    v_mov_b32 v59, 0
    v_mov_b32 v60, 0
    v_mov_b32 v61, 0
    v_mov_b32 v62, 0
    v_mov_b32 v63, 0
    v_mov_b32 v64, 0
    v_mov_b32 v65, 0
    v_mov_b32 v66, 0
    v_mov_b32 v67, 0
    v_mov_b32 v68, 0
    v_mov_b32 v69, 0
    v_mov_b32 v70, 0
    v_mov_b32 v71, 0
    s_mov_b32 s21, s16
    s_mov_b32 s16, s42
    s_mov_b32 s42, s43
    s_mov_b32 s43, s44
    s_mov_b32 s44, s21
    s_add_u32 s95, s95, 524288
    s_lshr_b32 s84, s95, 8
    s_and_b32 s84, s84, 8192
    s_xor_b32 s84, s84, s46
    s_add_u32 s84, s84, s95
    s_add_u32 s15, s15, 1
    s_barrier
    s_branch recur_fast_w0
g_28L15_0:
    s_waitcnt vmcnt(3)
    v_max3_u32 v19, v24, v25, v26
    v_max_u32 v19, v19, v27
    v_cmp_eq_u32 vcc, -1, v19
    s_nop 0
    s_cbranch_vccnz g_28F15_0
    v_smfmac_f32_16x16x64_bf16 v[40:43], v[24:27], a[0:7], v172
    v_smfmac_f32_16x16x64_bf16 v[44:47], v[24:27], a[64:71], v172
    v_smfmac_f32_16x16x64_bf16 v[48:51], v[24:27], a[32:39], v172
    v_smfmac_f32_16x16x64_bf16 v[52:55], v[24:27], a[96:103], v172
g_28L14_1:
    s_waitcnt vmcnt(2)
    v_max3_u32 v19, v28, v29, v30
    v_max_u32 v19, v19, v31
    v_cmp_eq_u32 vcc, -1, v19
    s_nop 0
    s_cbranch_vccnz g_28F14_1
    v_smfmac_f32_16x16x64_bf16 v[40:43], v[28:31], a[8:15], v172
    v_smfmac_f32_16x16x64_bf16 v[44:47], v[28:31], a[72:79], v172
    v_smfmac_f32_16x16x64_bf16 v[48:51], v[28:31], a[40:47], v172
    v_smfmac_f32_16x16x64_bf16 v[52:55], v[28:31], a[104:111], v172
g_28L12_2:
    s_waitcnt vmcnt(1)
    v_max3_u32 v19, v32, v33, v34
    v_max_u32 v19, v19, v35
    v_cmp_eq_u32 vcc, -1, v19
    s_nop 0
    s_cbranch_vccnz g_28F12_2
    v_smfmac_f32_16x16x64_bf16 v[40:43], v[32:35], a[16:23], v172
    v_smfmac_f32_16x16x64_bf16 v[44:47], v[32:35], a[80:87], v172
    v_smfmac_f32_16x16x64_bf16 v[48:51], v[32:35], a[48:55], v172
    v_smfmac_f32_16x16x64_bf16 v[52:55], v[32:35], a[112:119], v172
g_28L8_3:
    s_waitcnt vmcnt(0)
    v_max3_u32 v19, v36, v37, v38
    v_max_u32 v19, v19, v39
    v_cmp_eq_u32 vcc, -1, v19
    s_nop 0
    s_cbranch_vccnz g_28F8_3
    v_smfmac_f32_16x16x64_bf16 v[40:43], v[36:39], a[24:31], v172
    v_smfmac_f32_16x16x64_bf16 v[44:47], v[36:39], a[88:95], v172
    v_smfmac_f32_16x16x64_bf16 v[48:51], v[36:39], a[56:63], v172
    v_smfmac_f32_16x16x64_bf16 v[52:55], v[36:39], a[120:127], v172
    s_branch gc_29
g_28L15_1:
    s_waitcnt vmcnt(3)
    v_max3_u32 v19, v28, v29, v30
    v_max_u32 v19, v19, v31
    v_cmp_eq_u32 vcc, -1, v19
    s_nop 0
    s_cbranch_vccnz g_28F15_1
    v_smfmac_f32_16x16x64_bf16 v[40:43], v[28:31], a[8:15], v172
    v_smfmac_f32_16x16x64_bf16 v[44:47], v[28:31], a[72:79], v172
    v_smfmac_f32_16x16x64_bf16 v[48:51], v[28:31], a[40:47], v172
    v_smfmac_f32_16x16x64_bf16 v[52:55], v[28:31], a[104:111], v172
g_28L13_2:
    s_waitcnt vmcnt(2)
    v_max3_u32 v19, v32, v33, v34
    v_max_u32 v19, v19, v35
    v_cmp_eq_u32 vcc, -1, v19
    s_nop 0
    s_cbranch_vccnz g_28F13_2
    v_smfmac_f32_16x16x64_bf16 v[40:43], v[32:35], a[16:23], v172
    v_smfmac_f32_16x16x64_bf16 v[44:47], v[32:35], a[80:87], v172
    v_smfmac_f32_16x16x64_bf16 v[48:51], v[32:35], a[48:55], v172
    v_smfmac_f32_16x16x64_bf16 v[52:55], v[32:35], a[112:119], v172
g_28L9_3:
    s_waitcnt vmcnt(1)
    v_max3_u32 v19, v36, v37, v38
    v_max_u32 v19, v19, v39
    v_cmp_eq_u32 vcc, -1, v19
    s_nop 0
    s_cbranch_vccnz g_28F9_3
    v_smfmac_f32_16x16x64_bf16 v[40:43], v[36:39], a[24:31], v172
    v_smfmac_f32_16x16x64_bf16 v[44:47], v[36:39], a[88:95], v172
    v_smfmac_f32_16x16x64_bf16 v[48:51], v[36:39], a[56:63], v172
    v_smfmac_f32_16x16x64_bf16 v[52:55], v[36:39], a[120:127], v172
g_28L1_0:
    s_waitcnt vmcnt(0)
    v_max3_u32 v19, v24, v25, v26
    v_max_u32 v19, v19, v27
    v_cmp_eq_u32 vcc, -1, v19
    s_nop 0
    s_cbranch_vccnz g_28F1_0
    v_smfmac_f32_16x16x64_bf16 v[40:43], v[24:27], a[0:7], v172
    v_smfmac_f32_16x16x64_bf16 v[44:47], v[24:27], a[64:71], v172
    v_smfmac_f32_16x16x64_bf16 v[48:51], v[24:27], a[32:39], v172
    v_smfmac_f32_16x16x64_bf16 v[52:55], v[24:27], a[96:103], v172
    s_branch gc_29
g_28L15_2:
    s_waitcnt vmcnt(3)
    v_max3_u32 v19, v32, v33, v34
    v_max_u32 v19, v19, v35
    v_cmp_eq_u32 vcc, -1, v19
    s_nop 0
    s_cbranch_vccnz g_28F15_2
    v_smfmac_f32_16x16x64_bf16 v[40:43], v[32:35], a[16:23], v172
    v_smfmac_f32_16x16x64_bf16 v[44:47], v[32:35], a[80:87], v172
    v_smfmac_f32_16x16x64_bf16 v[48:51], v[32:35], a[48:55], v172
    v_smfmac_f32_16x16x64_bf16 v[52:55], v[32:35], a[112:119], v172
g_28L11_3:
    s_waitcnt vmcnt(2)
    v_max3_u32 v19, v36, v37, v38
    v_max_u32 v19, v19, v39
    v_cmp_eq_u32 vcc, -1, v19
    s_nop 0
    s_cbranch_vccnz g_28F11_3
    v_smfmac_f32_16x16x64_bf16 v[40:43], v[36:39], a[24:31], v172
    v_smfmac_f32_16x16x64_bf16 v[44:47], v[36:39], a[88:95], v172
    v_smfmac_f32_16x16x64_bf16 v[48:51], v[36:39], a[56:63], v172
    v_smfmac_f32_16x16x64_bf16 v[52:55], v[36:39], a[120:127], v172
g_28L3_0:
    s_waitcnt vmcnt(1)
    v_max3_u32 v19, v24, v25, v26
    v_max_u32 v19, v19, v27
    v_cmp_eq_u32 vcc, -1, v19
    s_nop 0
    s_cbranch_vccnz g_28F3_0
    v_smfmac_f32_16x16x64_bf16 v[40:43], v[24:27], a[0:7], v172
    v_smfmac_f32_16x16x64_bf16 v[44:47], v[24:27], a[64:71], v172
    v_smfmac_f32_16x16x64_bf16 v[48:51], v[24:27], a[32:39], v172
    v_smfmac_f32_16x16x64_bf16 v[52:55], v[24:27], a[96:103], v172
g_28L2_1:
    s_waitcnt vmcnt(0)
    v_max3_u32 v19, v28, v29, v30
    v_max_u32 v19, v19, v31
    v_cmp_eq_u32 vcc, -1, v19
    s_nop 0
    s_cbranch_vccnz g_28F2_1
    v_smfmac_f32_16x16x64_bf16 v[40:43], v[28:31], a[8:15], v172
    v_smfmac_f32_16x16x64_bf16 v[44:47], v[28:31], a[72:79], v172
    v_smfmac_f32_16x16x64_bf16 v[48:51], v[28:31], a[40:47], v172
    v_smfmac_f32_16x16x64_bf16 v[52:55], v[28:31], a[104:111], v172
    s_branch gc_29
g_28L15_3:
    s_waitcnt vmcnt(3)
    v_max3_u32 v19, v36, v37, v38
    v_max_u32 v19, v19, v39
    v_cmp_eq_u32 vcc, -1, v19
    s_nop 0
    s_cbranch_vccnz g_28F15_3
    v_smfmac_f32_16x16x64_bf16 v[40:43], v[36:39], a[24:31], v172
    v_smfmac_f32_16x16x64_bf16 v[44:47], v[36:39], a[88:95], v172
    v_smfmac_f32_16x16x64_bf16 v[48:51], v[36:39], a[56:63], v172
    v_smfmac_f32_16x16x64_bf16 v[52:55], v[36:39], a[120:127], v172
g_28L7_0:
    s_waitcnt vmcnt(2)
    v_max3_u32 v19, v24, v25, v26
    v_max_u32 v19, v19, v27
    v_cmp_eq_u32 vcc, -1, v19
    s_nop 0
    s_cbranch_vccnz g_28F7_0
    v_smfmac_f32_16x16x64_bf16 v[40:43], v[24:27], a[0:7], v172
    v_smfmac_f32_16x16x64_bf16 v[44:47], v[24:27], a[64:71], v172
    v_smfmac_f32_16x16x64_bf16 v[48:51], v[24:27], a[32:39], v172
    v_smfmac_f32_16x16x64_bf16 v[52:55], v[24:27], a[96:103], v172
g_28L6_1:
    s_waitcnt vmcnt(1)
    v_max3_u32 v19, v28, v29, v30
    v_max_u32 v19, v19, v31
    v_cmp_eq_u32 vcc, -1, v19
    s_nop 0
    s_cbranch_vccnz g_28F6_1
    v_smfmac_f32_16x16x64_bf16 v[40:43], v[28:31], a[8:15], v172
    v_smfmac_f32_16x16x64_bf16 v[44:47], v[28:31], a[72:79], v172
    v_smfmac_f32_16x16x64_bf16 v[48:51], v[28:31], a[40:47], v172
    v_smfmac_f32_16x16x64_bf16 v[52:55], v[28:31], a[104:111], v172
g_28L4_2:
    s_waitcnt vmcnt(0)
    v_max3_u32 v19, v32, v33, v34
    v_max_u32 v19, v19, v35
    v_cmp_eq_u32 vcc, -1, v19
    s_nop 0
    s_cbranch_vccnz g_28F4_2
    v_smfmac_f32_16x16x64_bf16 v[40:43], v[32:35], a[16:23], v172
    v_smfmac_f32_16x16x64_bf16 v[44:47], v[32:35], a[80:87], v172
    v_smfmac_f32_16x16x64_bf16 v[48:51], v[32:35], a[48:55], v172
    v_smfmac_f32_16x16x64_bf16 v[52:55], v[32:35], a[112:119], v172
    s_branch gc_29
g_28L7_1:
    s_waitcnt vmcnt(2)
    v_max3_u32 v19, v28, v29, v30
    v_max_u32 v19, v19, v31
    v_cmp_eq_u32 vcc, -1, v19
    s_nop 0
    s_cbranch_vccnz g_28F7_1
    v_smfmac_f32_16x16x64_bf16 v[40:43], v[28:31], a[8:15], v172
    v_smfmac_f32_16x16x64_bf16 v[44:47], v[28:31], a[72:79], v172
    v_smfmac_f32_16x16x64_bf16 v[48:51], v[28:31], a[40:47], v172
    v_smfmac_f32_16x16x64_bf16 v[52:55], v[28:31], a[104:111], v172
g_28L5_2:
    s_waitcnt vmcnt(1)
    v_max3_u32 v19, v32, v33, v34
    v_max_u32 v19, v19, v35
    v_cmp_eq_u32 vcc, -1, v19
    s_nop 0
    s_cbranch_vccnz g_28F5_2
    v_smfmac_f32_16x16x64_bf16 v[40:43], v[32:35], a[16:23], v172
    v_smfmac_f32_16x16x64_bf16 v[44:47], v[32:35], a[80:87], v172
    v_smfmac_f32_16x16x64_bf16 v[48:51], v[32:35], a[48:55], v172
    v_smfmac_f32_16x16x64_bf16 v[52:55], v[32:35], a[112:119], v172
    s_branch g_28L1_0
g_28L7_2:
    s_waitcnt vmcnt(2)
    v_max3_u32 v19, v32, v33, v34
    v_max_u32 v19, v19, v35
    v_cmp_eq_u32 vcc, -1, v19
    s_nop 0
    s_cbranch_vccnz g_28F7_2
    v_smfmac_f32_16x16x64_bf16 v[40:43], v[32:35], a[16:23], v172
    v_smfmac_f32_16x16x64_bf16 v[44:47], v[32:35], a[80:87], v172
    v_smfmac_f32_16x16x64_bf16 v[48:51], v[32:35], a[48:55], v172
    v_smfmac_f32_16x16x64_bf16 v[52:55], v[32:35], a[112:119], v172
    s_branch g_28L3_0
g_28L11_0:
    s_waitcnt vmcnt(2)
    v_max3_u32 v19, v24, v25, v26
    v_max_u32 v19, v19, v27
    v_cmp_eq_u32 vcc, -1, v19
    s_nop 0
    s_cbranch_vccnz g_28F11_0
    v_smfmac_f32_16x16x64_bf16 v[40:43], v[24:27], a[0:7], v172
    v_smfmac_f32_16x16x64_bf16 v[44:47], v[24:27], a[64:71], v172
    v_smfmac_f32_16x16x64_bf16 v[48:51], v[24:27], a[32:39], v172
    v_smfmac_f32_16x16x64_bf16 v[52:55], v[24:27], a[96:103], v172
g_28L10_1:
    s_waitcnt vmcnt(1)
    v_max3_u32 v19, v28, v29, v30
    v_max_u32 v19, v19, v31
    v_cmp_eq_u32 vcc, -1, v19
    s_nop 0
    s_cbranch_vccnz g_28F10_1
    v_smfmac_f32_16x16x64_bf16 v[40:43], v[28:31], a[8:15], v172
    v_smfmac_f32_16x16x64_bf16 v[44:47], v[28:31], a[72:79], v172
    v_smfmac_f32_16x16x64_bf16 v[48:51], v[28:31], a[40:47], v172
    v_smfmac_f32_16x16x64_bf16 v[52:55], v[28:31], a[104:111], v172
    s_branch g_28L8_3
g_28L11_1:
    s_waitcnt vmcnt(2)
    v_max3_u32 v19, v28, v29, v30
    v_max_u32 v19, v19, v31
    v_cmp_eq_u32 vcc, -1, v19
    s_nop 0
    s_cbranch_vccnz g_28F11_1
    v_smfmac_f32_16x16x64_bf16 v[40:43], v[28:31], a[8:15], v172
    v_smfmac_f32_16x16x64_bf16 v[44:47], v[28:31], a[72:79], v172
    v_smfmac_f32_16x16x64_bf16 v[48:51], v[28:31], a[40:47], v172
    v_smfmac_f32_16x16x64_bf16 v[52:55], v[28:31], a[104:111], v172
    s_branch g_28L9_3
g_28L13_0:
    s_waitcnt vmcnt(2)
    v_max3_u32 v19, v24, v25, v26
    v_max_u32 v19, v19, v27
    v_cmp_eq_u32 vcc, -1, v19
    s_nop 0
    s_cbranch_vccnz g_28F13_0
    v_smfmac_f32_16x16x64_bf16 v[40:43], v[24:27], a[0:7], v172
    v_smfmac_f32_16x16x64_bf16 v[44:47], v[24:27], a[64:71], v172
    v_smfmac_f32_16x16x64_bf16 v[48:51], v[24:27], a[32:39], v172
    v_smfmac_f32_16x16x64_bf16 v[52:55], v[24:27], a[96:103], v172
    s_branch g_28L12_2
g_28L13_3:
    s_waitcnt vmcnt(2)
    v_max3_u32 v19, v36, v37, v38
    v_max_u32 v19, v19, v39
    v_cmp_eq_u32 vcc, -1, v19
    s_nop 0
    s_cbranch_vccnz g_28F13_3
    v_smfmac_f32_16x16x64_bf16 v[40:43], v[36:39], a[24:31], v172
    v_smfmac_f32_16x16x64_bf16 v[44:47], v[36:39], a[88:95], v172
    v_smfmac_f32_16x16x64_bf16 v[48:51], v[36:39], a[56:63], v172
    v_smfmac_f32_16x16x64_bf16 v[52:55], v[36:39], a[120:127], v172
g_28L5_0:
    s_waitcnt vmcnt(1)
    v_max3_u32 v19, v24, v25, v26
    v_max_u32 v19, v19, v27
    v_cmp_eq_u32 vcc, -1, v19
    s_nop 0
    s_cbranch_vccnz g_28F5_0
    v_smfmac_f32_16x16x64_bf16 v[40:43], v[24:27], a[0:7], v172
    v_smfmac_f32_16x16x64_bf16 v[44:47], v[24:27], a[64:71], v172
    v_smfmac_f32_16x16x64_bf16 v[48:51], v[24:27], a[32:39], v172
    v_smfmac_f32_16x16x64_bf16 v[52:55], v[24:27], a[96:103], v172
    s_branch g_28L4_2
g_28L14_2:
    s_waitcnt vmcnt(2)
    v_max3_u32 v19, v32, v33, v34
    v_max_u32 v19, v19, v35
    v_cmp_eq_u32 vcc, -1, v19
    s_nop 0
    s_cbranch_vccnz g_28F14_2
    v_smfmac_f32_16x16x64_bf16 v[40:43], v[32:35], a[16:23], v172
    v_smfmac_f32_16x16x64_bf16 v[44:47], v[32:35], a[80:87], v172
    v_smfmac_f32_16x16x64_bf16 v[48:51], v[32:35], a[48:55], v172
    v_smfmac_f32_16x16x64_bf16 v[52:55], v[32:35], a[112:119], v172
g_28L10_3:
    s_waitcnt vmcnt(1)
    v_max3_u32 v19, v36, v37, v38
    v_max_u32 v19, v19, v39
    v_cmp_eq_u32 vcc, -1, v19
    s_nop 0
    s_cbranch_vccnz g_28F10_3
    v_smfmac_f32_16x16x64_bf16 v[40:43], v[36:39], a[24:31], v172
    v_smfmac_f32_16x16x64_bf16 v[44:47], v[36:39], a[88:95], v172
    v_smfmac_f32_16x16x64_bf16 v[48:51], v[36:39], a[56:63], v172
    v_smfmac_f32_16x16x64_bf16 v[52:55], v[36:39], a[120:127], v172
    s_branch g_28L2_1
g_28L14_3:
    s_waitcnt vmcnt(2)
    v_max3_u32 v19, v36, v37, v38
    v_max_u32 v19, v19, v39
    v_cmp_eq_u32 vcc, -1, v19
    s_nop 0
    s_cbranch_vccnz g_28F14_3
    v_smfmac_f32_16x16x64_bf16 v[40:43], v[36:39], a[24:31], v172
    v_smfmac_f32_16x16x64_bf16 v[44:47], v[36:39], a[88:95], v172
    v_smfmac_f32_16x16x64_bf16 v[48:51], v[36:39], a[56:63], v172
    v_smfmac_f32_16x16x64_bf16 v[52:55], v[36:39], a[120:127], v172
    s_branch g_28L6_1
g_28L3_1:
    s_waitcnt vmcnt(1)
    v_max3_u32 v19, v28, v29, v30
    v_max_u32 v19, v19, v31
    v_cmp_eq_u32 vcc, -1, v19
    s_nop 0
    s_cbranch_vccnz g_28F3_1
    v_smfmac_f32_16x16x64_bf16 v[40:43], v[28:31], a[8:15], v172
    v_smfmac_f32_16x16x64_bf16 v[44:47], v[28:31], a[72:79], v172
    v_smfmac_f32_16x16x64_bf16 v[48:51], v[28:31], a[40:47], v172
    v_smfmac_f32_16x16x64_bf16 v[52:55], v[28:31], a[104:111], v172
    s_branch g_28L1_0
g_28L6_2:
    s_waitcnt vmcnt(1)
    v_max3_u32 v19, v32, v33, v34
    v_max_u32 v19, v19, v35
    v_cmp_eq_u32 vcc, -1, v19
    s_nop 0
    s_cbranch_vccnz g_28F6_2
    v_smfmac_f32_16x16x64_bf16 v[40:43], v[32:35], a[16:23], v172
    v_smfmac_f32_16x16x64_bf16 v[44:47], v[32:35], a[80:87], v172
    v_smfmac_f32_16x16x64_bf16 v[48:51], v[32:35], a[48:55], v172
    v_smfmac_f32_16x16x64_bf16 v[52:55], v[32:35], a[112:119], v172
    s_branch g_28L2_1
g_28L9_0:
    s_waitcnt vmcnt(1)
    v_max3_u32 v19, v24, v25, v26
    v_max_u32 v19, v19, v27
    v_cmp_eq_u32 vcc, -1, v19
    s_nop 0
    s_cbranch_vccnz g_28F9_0
    v_smfmac_f32_16x16x64_bf16 v[40:43], v[24:27], a[0:7], v172
    v_smfmac_f32_16x16x64_bf16 v[44:47], v[24:27], a[64:71], v172
    v_smfmac_f32_16x16x64_bf16 v[48:51], v[24:27], a[32:39], v172
    v_smfmac_f32_16x16x64_bf16 v[52:55], v[24:27], a[96:103], v172
    s_branch g_28L8_3
g_28L12_3:
    s_waitcnt vmcnt(1)
    v_max3_u32 v19, v36, v37, v38
    v_max_u32 v19, v19, v39
    v_cmp_eq_u32 vcc, -1, v19
    s_nop 0
    s_cbranch_vccnz g_28F12_3
    v_smfmac_f32_16x16x64_bf16 v[40:43], v[36:39], a[24:31], v172
    v_smfmac_f32_16x16x64_bf16 v[44:47], v[36:39], a[88:95], v172
    v_smfmac_f32_16x16x64_bf16 v[48:51], v[36:39], a[56:63], v172
    v_smfmac_f32_16x16x64_bf16 v[52:55], v[36:39], a[120:127], v172
    s_branch g_28L4_2
g_28F15_0:
    s_mov_b64 exec, vcc
    buffer_load_dwordx4 v[24:27], v2, s[4:7], s16 offen offset:0 sc1
    s_mov_b64 exec, -1
    s_add_u32 s23, s23, 1
    s_cmp_lt_u32 s23, 200000
    s_cbranch_scc1 g_28L15_1
    s_mov_b32 s25, 200000
    s_branch gc_29
g_28F15_1:
    s_mov_b64 exec, vcc
    buffer_load_dwordx4 v[28:31], v2, s[4:7], s16 offen offset:1024 sc1
    s_mov_b64 exec, -1
    s_add_u32 s23, s23, 1
    s_cmp_lt_u32 s23, 200000
    s_cbranch_scc1 g_28L15_2
    s_mov_b32 s25, 200000
    s_branch gc_29
g_28F15_2:
    s_mov_b64 exec, vcc
    buffer_load_dwordx4 v[32:35], v2, s[4:7], s16 offen offset:2048 sc1
    s_mov_b64 exec, -1
    s_add_u32 s23, s23, 1
    s_cmp_lt_u32 s23, 200000
    s_cbranch_scc1 g_28L15_3
    s_mov_b32 s25, 200000
    s_branch gc_29
g_28F15_3:
    s_mov_b64 exec, vcc
    buffer_load_dwordx4 v[36:39], v2, s[4:7], s16 offen offset:3072 sc1
    s_mov_b64 exec, -1
    s_add_u32 s23, s23, 1
    s_cmp_lt_u32 s23, 200000
    s_cbranch_scc1 g_28L15_0
    s_mov_b32 s25, 200000
    s_branch gc_29
g_28F7_0:
    s_mov_b64 exec, vcc
    buffer_load_dwordx4 v[24:27], v2, s[4:7], s16 offen offset:0 sc1
    s_mov_b64 exec, -1
    s_add_u32 s23, s23, 1
    s_cmp_lt_u32 s23, 200000
    s_cbranch_scc1 g_28L7_1
    s_mov_b32 s25, 200000
    s_branch gc_29
g_28F7_1:
    s_mov_b64 exec, vcc
    buffer_load_dwordx4 v[28:31], v2, s[4:7], s16 offen offset:1024 sc1
    s_mov_b64 exec, -1
    s_add_u32 s23, s23, 1
    s_cmp_lt_u32 s23, 200000
    s_cbranch_scc1 g_28L7_2
    s_mov_b32 s25, 200000
    s_branch gc_29
g_28F7_2:
    s_mov_b64 exec, vcc
    buffer_load_dwordx4 v[32:35], v2, s[4:7], s16 offen offset:2048 sc1
    s_mov_b64 exec, -1
    s_add_u32 s23, s23, 1
    s_cmp_lt_u32 s23, 200000
    s_cbranch_scc1 g_28L7_0
    s_mov_b32 s25, 200000
    s_branch gc_29
g_28F11_0:
    s_mov_b64 exec, vcc
    buffer_load_dwordx4 v[24:27], v2, s[4:7], s16 offen offset:0 sc1
    s_mov_b64 exec, -1
    s_add_u32 s23, s23, 1
    s_cmp_lt_u32 s23, 200000
    s_cbranch_scc1 g_28L11_1
    s_mov_b32 s25, 200000
    s_branch gc_29
g_28F11_1:
    s_mov_b64 exec, vcc
    buffer_load_dwordx4 v[28:31], v2, s[4:7], s16 offen offset:1024 sc1
    s_mov_b64 exec, -1
    s_add_u32 s23, s23, 1
    s_cmp_lt_u32 s23, 200000
    s_cbranch_scc1 g_28L11_3
    s_mov_b32 s25, 200000
    s_branch gc_29
g_28F11_3:
    s_mov_b64 exec, vcc
    buffer_load_dwordx4 v[36:39], v2, s[4:7], s16 offen offset:3072 sc1
    s_mov_b64 exec, -1
    s_add_u32 s23, s23, 1
    s_cmp_lt_u32 s23, 200000
    s_cbranch_scc1 g_28L11_0
    s_mov_b32 s25, 200000
    s_branch gc_29
g_28F13_0:
    s_mov_b64 exec, vcc
    buffer_load_dwordx4 v[24:27], v2, s[4:7], s16 offen offset:0 sc1
    s_mov_b64 exec, -1
    s_add_u32 s23, s23, 1
    s_cmp_lt_u32 s23, 200000
    s_cbranch_scc1 g_28L13_2
    s_mov_b32 s25, 200000
    s_branch gc_29
g_28F13_2:
    s_mov_b64 exec, vcc
    buffer_load_dwordx4 v[32:35], v2, s[4:7], s16 offen offset:2048 sc1
    s_mov_b64 exec, -1
    s_add_u32 s23, s23, 1
    s_cmp_lt_u32 s23, 200000
    s_cbranch_scc1 g_28L13_3
    s_mov_b32 s25, 200000
    s_branch gc_29
g_28F13_3:
    s_mov_b64 exec, vcc
    buffer_load_dwordx4 v[36:39], v2, s[4:7], s16 offen offset:3072 sc1
    s_mov_b64 exec, -1
    s_add_u32 s23, s23, 1
    s_cmp_lt_u32 s23, 200000
    s_cbranch_scc1 g_28L13_0
    s_mov_b32 s25, 200000
    s_branch gc_29
g_28F14_1:
    s_mov_b64 exec, vcc
    buffer_load_dwordx4 v[28:31], v2, s[4:7], s16 offen offset:1024 sc1
    s_mov_b64 exec, -1
    s_add_u32 s23, s23, 1
    s_cmp_lt_u32 s23, 200000
    s_cbranch_scc1 g_28L14_2
    s_mov_b32 s25, 200000
    s_branch gc_29
g_28F14_2:
    s_mov_b64 exec, vcc
    buffer_load_dwordx4 v[32:35], v2, s[4:7], s16 offen offset:2048 sc1
    s_mov_b64 exec, -1
    s_add_u32 s23, s23, 1
    s_cmp_lt_u32 s23, 200000
    s_cbranch_scc1 g_28L14_3
    s_mov_b32 s25, 200000
    s_branch gc_29
g_28F14_3:
    s_mov_b64 exec, vcc
    buffer_load_dwordx4 v[36:39], v2, s[4:7], s16 offen offset:3072 sc1
    s_mov_b64 exec, -1
    s_add_u32 s23, s23, 1
    s_cmp_lt_u32 s23, 200000
    s_cbranch_scc1 g_28L14_1
    s_mov_b32 s25, 200000
    s_branch gc_29
g_28F3_0:
    s_mov_b64 exec, vcc
    buffer_load_dwordx4 v[24:27], v2, s[4:7], s16 offen offset:0 sc1
    s_mov_b64 exec, -1
    s_add_u32 s23, s23, 1
    s_cmp_lt_u32 s23, 200000
    s_cbranch_scc1 g_28L3_1
    s_mov_b32 s25, 200000
    s_branch gc_29
g_28F3_1:
    s_mov_b64 exec, vcc
    buffer_load_dwordx4 v[28:31], v2, s[4:7], s16 offen offset:1024 sc1
    s_mov_b64 exec, -1
    s_add_u32 s23, s23, 1
    s_cmp_lt_u32 s23, 200000
    s_cbranch_scc1 g_28L3_0
    s_mov_b32 s25, 200000
    s_branch gc_29
g_28F5_0:
    s_mov_b64 exec, vcc
    buffer_load_dwordx4 v[24:27], v2, s[4:7], s16 offen offset:0 sc1
    s_mov_b64 exec, -1
    s_add_u32 s23, s23, 1
    s_cmp_lt_u32 s23, 200000
    s_cbranch_scc1 g_28L5_2
    s_mov_b32 s25, 200000
    s_branch gc_29
g_28F5_2:
    s_mov_b64 exec, vcc
    buffer_load_dwordx4 v[32:35], v2, s[4:7], s16 offen offset:2048 sc1
    s_mov_b64 exec, -1
    s_add_u32 s23, s23, 1
    s_cmp_lt_u32 s23, 200000
    s_cbranch_scc1 g_28L5_0
    s_mov_b32 s25, 200000
    s_branch gc_29
g_28F6_1:
    s_mov_b64 exec, vcc
    buffer_load_dwordx4 v[28:31], v2, s[4:7], s16 offen offset:1024 sc1
    s_mov_b64 exec, -1
    s_add_u32 s23, s23, 1
    s_cmp_lt_u32 s23, 200000
    s_cbranch_scc1 g_28L6_2
    s_mov_b32 s25, 200000
    s_branch gc_29
g_28F6_2:
    s_mov_b64 exec, vcc
    buffer_load_dwordx4 v[32:35], v2, s[4:7], s16 offen offset:2048 sc1
    s_mov_b64 exec, -1
    s_add_u32 s23, s23, 1
    s_cmp_lt_u32 s23, 200000
    s_cbranch_scc1 g_28L6_1
    s_mov_b32 s25, 200000
    s_branch gc_29
g_28F9_0:
    s_mov_b64 exec, vcc
    buffer_load_dwordx4 v[24:27], v2, s[4:7], s16 offen offset:0 sc1
    s_mov_b64 exec, -1
    s_add_u32 s23, s23, 1
    s_cmp_lt_u32 s23, 200000
    s_cbranch_scc1 g_28L9_3
    s_mov_b32 s25, 200000
    s_branch gc_29
g_28F9_3:
    s_mov_b64 exec, vcc
    buffer_load_dwordx4 v[36:39], v2, s[4:7], s16 offen offset:3072 sc1
    s_mov_b64 exec, -1
    s_add_u32 s23, s23, 1
    s_cmp_lt_u32 s23, 200000
    s_cbranch_scc1 g_28L9_0
    s_mov_b32 s25, 200000
    s_branch gc_29
g_28F10_1:
    s_mov_b64 exec, vcc
    buffer_load_dwordx4 v[28:31], v2, s[4:7], s16 offen offset:1024 sc1
    s_mov_b64 exec, -1
    s_add_u32 s23, s23, 1
    s_cmp_lt_u32 s23, 200000
    s_cbranch_scc1 g_28L10_3
    s_mov_b32 s25, 200000
    s_branch gc_29
g_28F10_3:
    s_mov_b64 exec, vcc
    buffer_load_dwordx4 v[36:39], v2, s[4:7], s16 offen offset:3072 sc1
    s_mov_b64 exec, -1
    s_add_u32 s23, s23, 1
    s_cmp_lt_u32 s23, 200000
    s_cbranch_scc1 g_28L10_1
    s_mov_b32 s25, 200000
    s_branch gc_29
g_28F12_2:
    s_mov_b64 exec, vcc
    buffer_load_dwordx4 v[32:35], v2, s[4:7], s16 offen offset:2048 sc1
    s_mov_b64 exec, -1
    s_add_u32 s23, s23, 1
    s_cmp_lt_u32 s23, 200000
    s_cbranch_scc1 g_28L12_3
    s_mov_b32 s25, 200000
    s_branch gc_29
g_28F12_3:
    s_mov_b64 exec, vcc
    buffer_load_dwordx4 v[36:39], v2, s[4:7], s16 offen offset:3072 sc1
    s_mov_b64 exec, -1
    s_add_u32 s23, s23, 1
    s_cmp_lt_u32 s23, 200000
    s_cbranch_scc1 g_28L12_2
    s_mov_b32 s25, 200000
    s_branch gc_29
g_28F1_0:
    s_mov_b64 exec, vcc
    buffer_load_dwordx4 v[24:27], v2, s[4:7], s16 offen offset:0 sc1
    s_mov_b64 exec, -1
    s_add_u32 s23, s23, 1
    s_cmp_lt_u32 s23, 200000
    s_cbranch_scc1 g_28L1_0
    s_mov_b32 s25, 200000
    s_branch gc_29
g_28F2_1:
    s_mov_b64 exec, vcc
    buffer_load_dwordx4 v[28:31], v2, s[4:7], s16 offen offset:1024 sc1
    s_mov_b64 exec, -1
    s_add_u32 s23, s23, 1
    s_cmp_lt_u32 s23, 200000
    s_cbranch_scc1 g_28L2_1
    s_mov_b32 s25, 200000
    s_branch gc_29
g_28F4_2:
    s_mov_b64 exec, vcc
    buffer_load_dwordx4 v[32:35], v2, s[4:7], s16 offen offset:2048 sc1
    s_mov_b64 exec, -1
    s_add_u32 s23, s23, 1
    s_cmp_lt_u32 s23, 200000
    s_cbranch_scc1 g_28L4_2
    s_mov_b32 s25, 200000
    s_branch gc_29
g_28F8_3:
    s_mov_b64 exec, vcc
    buffer_load_dwordx4 v[36:39], v2, s[4:7], s16 offen offset:3072 sc1
    s_mov_b64 exec, -1
    s_add_u32 s23, s23, 1
    s_cmp_lt_u32 s23, 200000
    s_cbranch_scc1 g_28L8_3
    s_mov_b32 s25, 200000
    s_branch gc_29
recur_fast_last0:
    buffer_store_dwordx4 v[128:131], v14, s[4:7], s19 offen sc1
    s_waitcnt vmcnt(0)
    s_branch recur_end
g_30L15_0:
    s_waitcnt vmcnt(3)
    v_max3_u32 v19, v24, v25, v26
    v_max_u32 v19, v19, v27
    v_cmp_eq_u32 vcc, -1, v19
    s_nop 0
    s_cbranch_vccnz g_30F15_0
    v_smfmac_f32_16x16x64_bf16 v[64:67], v[24:27], a[192:199], v172
    v_smfmac_f32_16x16x64_bf16 v[68:71], v[24:27], a[224:231], v172
g_30L14_1:
    s_waitcnt vmcnt(2)
    v_max3_u32 v19, v28, v29, v30
    v_max_u32 v19, v19, v31
    v_cmp_eq_u32 vcc, -1, v19
    s_nop 0
    s_cbranch_vccnz g_30F14_1
    v_smfmac_f32_16x16x64_bf16 v[64:67], v[28:31], a[200:207], v172
    v_smfmac_f32_16x16x64_bf16 v[68:71], v[28:31], a[232:239], v172
g_30L12_2:
    s_waitcnt vmcnt(1)
    v_max3_u32 v19, v32, v33, v34
    v_max_u32 v19, v19, v35
    v_cmp_eq_u32 vcc, -1, v19
    s_nop 0
    s_cbranch_vccnz g_30F12_2
    v_smfmac_f32_16x16x64_bf16 v[64:67], v[32:35], a[208:215], v172
    v_smfmac_f32_16x16x64_bf16 v[68:71], v[32:35], a[240:247], v172
g_30L8_3:
    s_waitcnt vmcnt(0)
    v_max3_u32 v19, v36, v37, v38
    v_max_u32 v19, v19, v39
    v_cmp_eq_u32 vcc, -1, v19
    s_nop 0
    s_cbranch_vccnz g_30F8_3
    v_smfmac_f32_16x16x64_bf16 v[64:67], v[36:39], a[216:223], v172
    v_smfmac_f32_16x16x64_bf16 v[68:71], v[36:39], a[248:255], v172
    s_nop 4
    v_cvt_pk_bf16_f32 v80, v64, v65
    v_cvt_pk_bf16_f32 v81, v66, v67
    s_nop 0
    v_cvt_pk_bf16_f32 v82, v68, v69
    v_cvt_pk_bf16_f32 v83, v70, v71
    ds_write_b128 v17, v[80:83] offset:9216
    s_branch gc_31
g_30L15_1:
    s_waitcnt vmcnt(3)
    v_max3_u32 v19, v28, v29, v30
    v_max_u32 v19, v19, v31
    v_cmp_eq_u32 vcc, -1, v19
    s_nop 0
    s_cbranch_vccnz g_30F15_1
    v_smfmac_f32_16x16x64_bf16 v[64:67], v[28:31], a[200:207], v172
    v_smfmac_f32_16x16x64_bf16 v[68:71], v[28:31], a[232:239], v172
g_30L13_2:
    s_waitcnt vmcnt(2)
    v_max3_u32 v19, v32, v33, v34
    v_max_u32 v19, v19, v35
    v_cmp_eq_u32 vcc, -1, v19
    s_nop 0
    s_cbranch_vccnz g_30F13_2
    v_smfmac_f32_16x16x64_bf16 v[64:67], v[32:35], a[208:215], v172
    v_smfmac_f32_16x16x64_bf16 v[68:71], v[32:35], a[240:247], v172
g_30L9_3:
    s_waitcnt vmcnt(1)
    v_max3_u32 v19, v36, v37, v38
    v_max_u32 v19, v19, v39
    v_cmp_eq_u32 vcc, -1, v19
    s_nop 0
    s_cbranch_vccnz g_30F9_3
    v_smfmac_f32_16x16x64_bf16 v[64:67], v[36:39], a[216:223], v172
    v_smfmac_f32_16x16x64_bf16 v[68:71], v[36:39], a[248:255], v172
g_30L1_0:
    s_waitcnt vmcnt(0)
    v_max3_u32 v19, v24, v25, v26
    v_max_u32 v19, v19, v27
    v_cmp_eq_u32 vcc, -1, v19
    s_nop 0
    s_cbranch_vccnz g_30F1_0
    v_smfmac_f32_16x16x64_bf16 v[64:67], v[24:27], a[192:199], v172
    v_smfmac_f32_16x16x64_bf16 v[68:71], v[24:27], a[224:231], v172
    s_nop 4
    v_cvt_pk_bf16_f32 v80, v64, v65
    v_cvt_pk_bf16_f32 v81, v66, v67
    s_nop 0
    v_cvt_pk_bf16_f32 v82, v68, v69
    v_cvt_pk_bf16_f32 v83, v70, v71
    ds_write_b128 v17, v[80:83] offset:9216
    s_branch gc_31
g_30L15_2:
    s_waitcnt vmcnt(3)
    v_max3_u32 v19, v32, v33, v34
    v_max_u32 v19, v19, v35
    v_cmp_eq_u32 vcc, -1, v19
    s_nop 0
    s_cbranch_vccnz g_30F15_2
    v_smfmac_f32_16x16x64_bf16 v[64:67], v[32:35], a[208:215], v172
    v_smfmac_f32_16x16x64_bf16 v[68:71], v[32:35], a[240:247], v172
g_30L11_3:
    s_waitcnt vmcnt(2)
    v_max3_u32 v19, v36, v37, v38
    v_max_u32 v19, v19, v39
    v_cmp_eq_u32 vcc, -1, v19
    s_nop 0
    s_cbranch_vccnz g_30F11_3
    v_smfmac_f32_16x16x64_bf16 v[64:67], v[36:39], a[216:223], v172
    v_smfmac_f32_16x16x64_bf16 v[68:71], v[36:39], a[248:255], v172
g_30L3_0:
    s_waitcnt vmcnt(1)
    v_max3_u32 v19, v24, v25, v26
    v_max_u32 v19, v19, v27
    v_cmp_eq_u32 vcc, -1, v19
    s_nop 0
    s_cbranch_vccnz g_30F3_0
    v_smfmac_f32_16x16x64_bf16 v[64:67], v[24:27], a[192:199], v172
    v_smfmac_f32_16x16x64_bf16 v[68:71], v[24:27], a[224:231], v172
g_30L2_1:
    s_waitcnt vmcnt(0)
    v_max3_u32 v19, v28, v29, v30
    v_max_u32 v19, v19, v31
    v_cmp_eq_u32 vcc, -1, v19
    s_nop 0
    s_cbranch_vccnz g_30F2_1
    v_smfmac_f32_16x16x64_bf16 v[64:67], v[28:31], a[200:207], v172
    v_smfmac_f32_16x16x64_bf16 v[68:71], v[28:31], a[232:239], v172
    s_nop 4
    v_cvt_pk_bf16_f32 v80, v64, v65
    v_cvt_pk_bf16_f32 v81, v66, v67
    s_nop 0
    v_cvt_pk_bf16_f32 v82, v68, v69
    v_cvt_pk_bf16_f32 v83, v70, v71
    ds_write_b128 v17, v[80:83] offset:9216
    s_branch gc_31
g_30L15_3:
    s_waitcnt vmcnt(3)
    v_max3_u32 v19, v36, v37, v38
    v_max_u32 v19, v19, v39
    v_cmp_eq_u32 vcc, -1, v19
    s_nop 0
    s_cbranch_vccnz g_30F15_3
    v_smfmac_f32_16x16x64_bf16 v[64:67], v[36:39], a[216:223], v172
    v_smfmac_f32_16x16x64_bf16 v[68:71], v[36:39], a[248:255], v172
g_30L7_0:
    s_waitcnt vmcnt(2)
    v_max3_u32 v19, v24, v25, v26
    v_max_u32 v19, v19, v27
    v_cmp_eq_u32 vcc, -1, v19
    s_nop 0
    s_cbranch_vccnz g_30F7_0
    v_smfmac_f32_16x16x64_bf16 v[64:67], v[24:27], a[192:199], v172
    v_smfmac_f32_16x16x64_bf16 v[68:71], v[24:27], a[224:231], v172
g_30L6_1:
    s_waitcnt vmcnt(1)
    v_max3_u32 v19, v28, v29, v30
    v_max_u32 v19, v19, v31
    v_cmp_eq_u32 vcc, -1, v19
    s_nop 0
    s_cbranch_vccnz g_30F6_1
    v_smfmac_f32_16x16x64_bf16 v[64:67], v[28:31], a[200:207], v172
    v_smfmac_f32_16x16x64_bf16 v[68:71], v[28:31], a[232:239], v172
g_30L4_2:
    s_waitcnt vmcnt(0)
    v_max3_u32 v19, v32, v33, v34
    v_max_u32 v19, v19, v35
    v_cmp_eq_u32 vcc, -1, v19
    s_nop 0
    s_cbranch_vccnz g_30F4_2
    v_smfmac_f32_16x16x64_bf16 v[64:67], v[32:35], a[208:215], v172
    v_smfmac_f32_16x16x64_bf16 v[68:71], v[32:35], a[240:247], v172
    s_nop 4
    v_cvt_pk_bf16_f32 v80, v64, v65
    v_cvt_pk_bf16_f32 v81, v66, v67
    s_nop 0
    v_cvt_pk_bf16_f32 v82, v68, v69
    v_cvt_pk_bf16_f32 v83, v70, v71
    ds_write_b128 v17, v[80:83] offset:9216
    s_branch gc_31
g_30L7_1:
    s_waitcnt vmcnt(2)
    v_max3_u32 v19, v28, v29, v30
    v_max_u32 v19, v19, v31
    v_cmp_eq_u32 vcc, -1, v19
    s_nop 0
    s_cbranch_vccnz g_30F7_1
    v_smfmac_f32_16x16x64_bf16 v[64:67], v[28:31], a[200:207], v172
    v_smfmac_f32_16x16x64_bf16 v[68:71], v[28:31], a[232:239], v172
g_30L5_2:
    s_waitcnt vmcnt(1)
    v_max3_u32 v19, v32, v33, v34
    v_max_u32 v19, v19, v35
    v_cmp_eq_u32 vcc, -1, v19
    s_nop 0
    s_cbranch_vccnz g_30F5_2
    v_smfmac_f32_16x16x64_bf16 v[64:67], v[32:35], a[208:215], v172
    v_smfmac_f32_16x16x64_bf16 v[68:71], v[32:35], a[240:247], v172
    s_branch g_30L1_0
g_30L7_2:
    s_waitcnt vmcnt(2)
    v_max3_u32 v19, v32, v33, v34
    v_max_u32 v19, v19, v35
    v_cmp_eq_u32 vcc, -1, v19
    s_nop 0
    s_cbranch_vccnz g_30F7_2
    v_smfmac_f32_16x16x64_bf16 v[64:67], v[32:35], a[208:215], v172
    v_smfmac_f32_16x16x64_bf16 v[68:71], v[32:35], a[240:247], v172
    s_branch g_30L3_0
g_30L11_0:
    s_waitcnt vmcnt(2)
    v_max3_u32 v19, v24, v25, v26
    v_max_u32 v19, v19, v27
    v_cmp_eq_u32 vcc, -1, v19
    s_nop 0
    s_cbranch_vccnz g_30F11_0
    v_smfmac_f32_16x16x64_bf16 v[64:67], v[24:27], a[192:199], v172
    v_smfmac_f32_16x16x64_bf16 v[68:71], v[24:27], a[224:231], v172
g_30L10_1:
    s_waitcnt vmcnt(1)
    v_max3_u32 v19, v28, v29, v30
    v_max_u32 v19, v19, v31
    v_cmp_eq_u32 vcc, -1, v19
    s_nop 0
    s_cbranch_vccnz g_30F10_1
    v_smfmac_f32_16x16x64_bf16 v[64:67], v[28:31], a[200:207], v172
    v_smfmac_f32_16x16x64_bf16 v[68:71], v[28:31], a[232:239], v172
    s_branch g_30L8_3
g_30L11_1:
    s_waitcnt vmcnt(2)
    v_max3_u32 v19, v28, v29, v30
    v_max_u32 v19, v19, v31
    v_cmp_eq_u32 vcc, -1, v19
    s_nop 0
    s_cbranch_vccnz g_30F11_1
    v_smfmac_f32_16x16x64_bf16 v[64:67], v[28:31], a[200:207], v172
    v_smfmac_f32_16x16x64_bf16 v[68:71], v[28:31], a[232:239], v172
    s_branch g_30L9_3
g_30L13_0:
    s_waitcnt vmcnt(2)
    v_max3_u32 v19, v24, v25, v26
    v_max_u32 v19, v19, v27
    v_cmp_eq_u32 vcc, -1, v19
    s_nop 0
    s_cbranch_vccnz g_30F13_0
    v_smfmac_f32_16x16x64_bf16 v[64:67], v[24:27], a[192:199], v172
    v_smfmac_f32_16x16x64_bf16 v[68:71], v[24:27], a[224:231], v172
    s_branch g_30L12_2
g_30L13_3:
    s_waitcnt vmcnt(2)
    v_max3_u32 v19, v36, v37, v38
    v_max_u32 v19, v19, v39
    v_cmp_eq_u32 vcc, -1, v19
    s_nop 0
    s_cbranch_vccnz g_30F13_3
    v_smfmac_f32_16x16x64_bf16 v[64:67], v[36:39], a[216:223], v172
    v_smfmac_f32_16x16x64_bf16 v[68:71], v[36:39], a[248:255], v172
g_30L5_0:
    s_waitcnt vmcnt(1)
    v_max3_u32 v19, v24, v25, v26
    v_max_u32 v19, v19, v27
    v_cmp_eq_u32 vcc, -1, v19
    s_nop 0
    s_cbranch_vccnz g_30F5_0
    v_smfmac_f32_16x16x64_bf16 v[64:67], v[24:27], a[192:199], v172
    v_smfmac_f32_16x16x64_bf16 v[68:71], v[24:27], a[224:231], v172
    s_branch g_30L4_2
g_30L14_2:
    s_waitcnt vmcnt(2)
    v_max3_u32 v19, v32, v33, v34
    v_max_u32 v19, v19, v35
    v_cmp_eq_u32 vcc, -1, v19
    s_nop 0
    s_cbranch_vccnz g_30F14_2
    v_smfmac_f32_16x16x64_bf16 v[64:67], v[32:35], a[208:215], v172
    v_smfmac_f32_16x16x64_bf16 v[68:71], v[32:35], a[240:247], v172
g_30L10_3:
    s_waitcnt vmcnt(1)
    v_max3_u32 v19, v36, v37, v38
    v_max_u32 v19, v19, v39
    v_cmp_eq_u32 vcc, -1, v19
    s_nop 0
    s_cbranch_vccnz g_30F10_3
    v_smfmac_f32_16x16x64_bf16 v[64:67], v[36:39], a[216:223], v172
    v_smfmac_f32_16x16x64_bf16 v[68:71], v[36:39], a[248:255], v172
    s_branch g_30L2_1
g_30L14_3:
    s_waitcnt vmcnt(2)
    v_max3_u32 v19, v36, v37, v38
    v_max_u32 v19, v19, v39
    v_cmp_eq_u32 vcc, -1, v19
    s_nop 0
    s_cbranch_vccnz g_30F14_3
    v_smfmac_f32_16x16x64_bf16 v[64:67], v[36:39], a[216:223], v172
    v_smfmac_f32_16x16x64_bf16 v[68:71], v[36:39], a[248:255], v172
    s_branch g_30L6_1
g_30L3_1:
    s_waitcnt vmcnt(1)
    v_max3_u32 v19, v28, v29, v30
    v_max_u32 v19, v19, v31
    v_cmp_eq_u32 vcc, -1, v19
    s_nop 0
    s_cbranch_vccnz g_30F3_1
    v_smfmac_f32_16x16x64_bf16 v[64:67], v[28:31], a[200:207], v172
    v_smfmac_f32_16x16x64_bf16 v[68:71], v[28:31], a[232:239], v172
    s_branch g_30L1_0
g_30L6_2:
    s_waitcnt vmcnt(1)
    v_max3_u32 v19, v32, v33, v34
    v_max_u32 v19, v19, v35
    v_cmp_eq_u32 vcc, -1, v19
    s_nop 0
    s_cbranch_vccnz g_30F6_2
    v_smfmac_f32_16x16x64_bf16 v[64:67], v[32:35], a[208:215], v172
    v_smfmac_f32_16x16x64_bf16 v[68:71], v[32:35], a[240:247], v172
    s_branch g_30L2_1
g_30L9_0:
    s_waitcnt vmcnt(1)
    v_max3_u32 v19, v24, v25, v26
    v_max_u32 v19, v19, v27
    v_cmp_eq_u32 vcc, -1, v19
    s_nop 0
    s_cbranch_vccnz g_30F9_0
    v_smfmac_f32_16x16x64_bf16 v[64:67], v[24:27], a[192:199], v172
    v_smfmac_f32_16x16x64_bf16 v[68:71], v[24:27], a[224:231], v172
    s_branch g_30L8_3
g_30L12_3:
    s_waitcnt vmcnt(1)
    v_max3_u32 v19, v36, v37, v38
    v_max_u32 v19, v19, v39
    v_cmp_eq_u32 vcc, -1, v19
    s_nop 0
    s_cbranch_vccnz g_30F12_3
    v_smfmac_f32_16x16x64_bf16 v[64:67], v[36:39], a[216:223], v172
    v_smfmac_f32_16x16x64_bf16 v[68:71], v[36:39], a[248:255], v172
    s_branch g_30L4_2
g_30F15_0:
    s_mov_b64 exec, vcc
    buffer_load_dwordx4 v[24:27], v8, s[4:7], s16 offen offset:0 sc1
    s_mov_b64 exec, -1
    s_add_u32 s23, s23, 1
    s_cmp_lt_u32 s23, 200000
    s_cbranch_scc1 g_30L15_1
    s_mov_b32 s25, 200000
    s_branch gc_31
g_30F15_1:
    s_mov_b64 exec, vcc
    buffer_load_dwordx4 v[28:31], v8, s[4:7], s16 offen offset:1024 sc1
    s_mov_b64 exec, -1
    s_add_u32 s23, s23, 1
    s_cmp_lt_u32 s23, 200000
    s_cbranch_scc1 g_30L15_2
    s_mov_b32 s25, 200000
    s_branch gc_31
g_30F15_2:
    s_mov_b64 exec, vcc
    buffer_load_dwordx4 v[32:35], v8, s[4:7], s16 offen offset:2048 sc1
    s_mov_b64 exec, -1
    s_add_u32 s23, s23, 1
    s_cmp_lt_u32 s23, 200000
    s_cbranch_scc1 g_30L15_3
    s_mov_b32 s25, 200000
    s_branch gc_31
g_30F15_3:
    s_mov_b64 exec, vcc
    buffer_load_dwordx4 v[36:39], v8, s[4:7], s16 offen offset:3072 sc1
    s_mov_b64 exec, -1
    s_add_u32 s23, s23, 1
    s_cmp_lt_u32 s23, 200000
    s_cbranch_scc1 g_30L15_0
    s_mov_b32 s25, 200000
    s_branch gc_31
g_30F7_0:
    s_mov_b64 exec, vcc
    buffer_load_dwordx4 v[24:27], v8, s[4:7], s16 offen offset:0 sc1
    s_mov_b64 exec, -1
    s_add_u32 s23, s23, 1
    s_cmp_lt_u32 s23, 200000
    s_cbranch_scc1 g_30L7_1
    s_mov_b32 s25, 200000
    s_branch gc_31
g_30F7_1:
    s_mov_b64 exec, vcc
    buffer_load_dwordx4 v[28:31], v8, s[4:7], s16 offen offset:1024 sc1
    s_mov_b64 exec, -1
    s_add_u32 s23, s23, 1
    s_cmp_lt_u32 s23, 200000
    s_cbranch_scc1 g_30L7_2
    s_mov_b32 s25, 200000
    s_branch gc_31
g_30F7_2:
    s_mov_b64 exec, vcc
    buffer_load_dwordx4 v[32:35], v8, s[4:7], s16 offen offset:2048 sc1
    s_mov_b64 exec, -1
    s_add_u32 s23, s23, 1
    s_cmp_lt_u32 s23, 200000
    s_cbranch_scc1 g_30L7_0
    s_mov_b32 s25, 200000
    s_branch gc_31
g_30F11_0:
    s_mov_b64 exec, vcc
    buffer_load_dwordx4 v[24:27], v8, s[4:7], s16 offen offset:0 sc1
    s_mov_b64 exec, -1
    s_add_u32 s23, s23, 1
    s_cmp_lt_u32 s23, 200000
    s_cbranch_scc1 g_30L11_1
    s_mov_b32 s25, 200000
    s_branch gc_31
g_30F11_1:
    s_mov_b64 exec, vcc
    buffer_load_dwordx4 v[28:31], v8, s[4:7], s16 offen offset:1024 sc1
    s_mov_b64 exec, -1
    s_add_u32 s23, s23, 1
    s_cmp_lt_u32 s23, 200000
    s_cbranch_scc1 g_30L11_3
    s_mov_b32 s25, 200000
    s_branch gc_31
g_30F11_3:
    s_mov_b64 exec, vcc
    buffer_load_dwordx4 v[36:39], v8, s[4:7], s16 offen offset:3072 sc1
    s_mov_b64 exec, -1
    s_add_u32 s23, s23, 1
    s_cmp_lt_u32 s23, 200000
    s_cbranch_scc1 g_30L11_0
    s_mov_b32 s25, 200000
    s_branch gc_31
g_30F13_0:
    s_mov_b64 exec, vcc
    buffer_load_dwordx4 v[24:27], v8, s[4:7], s16 offen offset:0 sc1
    s_mov_b64 exec, -1
    s_add_u32 s23, s23, 1
    s_cmp_lt_u32 s23, 200000
    s_cbranch_scc1 g_30L13_2
    s_mov_b32 s25, 200000
    s_branch gc_31
g_30F13_2:
    s_mov_b64 exec, vcc
    buffer_load_dwordx4 v[32:35], v8, s[4:7], s16 offen offset:2048 sc1
    s_mov_b64 exec, -1
    s_add_u32 s23, s23, 1
    s_cmp_lt_u32 s23, 200000
    s_cbranch_scc1 g_30L13_3
    s_mov_b32 s25, 200000
    s_branch gc_31
g_30F13_3:
    s_mov_b64 exec, vcc
    buffer_load_dwordx4 v[36:39], v8, s[4:7], s16 offen offset:3072 sc1
    s_mov_b64 exec, -1
    s_add_u32 s23, s23, 1
    s_cmp_lt_u32 s23, 200000
    s_cbranch_scc1 g_30L13_0
    s_mov_b32 s25, 200000
    s_branch gc_31
g_30F14_1:
    s_mov_b64 exec, vcc
    buffer_load_dwordx4 v[28:31], v8, s[4:7], s16 offen offset:1024 sc1
    s_mov_b64 exec, -1
    s_add_u32 s23, s23, 1
    s_cmp_lt_u32 s23, 200000
    s_cbranch_scc1 g_30L14_2
    s_mov_b32 s25, 200000
    s_branch gc_31
g_30F14_2:
    s_mov_b64 exec, vcc
    buffer_load_dwordx4 v[32:35], v8, s[4:7], s16 offen offset:2048 sc1
    s_mov_b64 exec, -1
    s_add_u32 s23, s23, 1
    s_cmp_lt_u32 s23, 200000
    s_cbranch_scc1 g_30L14_3
    s_mov_b32 s25, 200000
    s_branch gc_31
g_30F14_3:
    s_mov_b64 exec, vcc
    buffer_load_dwordx4 v[36:39], v8, s[4:7], s16 offen offset:3072 sc1
    s_mov_b64 exec, -1
    s_add_u32 s23, s23, 1
    s_cmp_lt_u32 s23, 200000
    s_cbranch_scc1 g_30L14_1
    s_mov_b32 s25, 200000
    s_branch gc_31
g_30F3_0:
    s_mov_b64 exec, vcc
    buffer_load_dwordx4 v[24:27], v8, s[4:7], s16 offen offset:0 sc1
    s_mov_b64 exec, -1
    s_add_u32 s23, s23, 1
    s_cmp_lt_u32 s23, 200000
    s_cbranch_scc1 g_30L3_1
    s_mov_b32 s25, 200000
    s_branch gc_31
g_30F3_1:
    s_mov_b64 exec, vcc
    buffer_load_dwordx4 v[28:31], v8, s[4:7], s16 offen offset:1024 sc1
    s_mov_b64 exec, -1
    s_add_u32 s23, s23, 1
    s_cmp_lt_u32 s23, 200000
    s_cbranch_scc1 g_30L3_0
    s_mov_b32 s25, 200000
    s_branch gc_31
g_30F5_0:
    s_mov_b64 exec, vcc
    buffer_load_dwordx4 v[24:27], v8, s[4:7], s16 offen offset:0 sc1
    s_mov_b64 exec, -1
    s_add_u32 s23, s23, 1
    s_cmp_lt_u32 s23, 200000
    s_cbranch_scc1 g_30L5_2
    s_mov_b32 s25, 200000
    s_branch gc_31
g_30F5_2:
    s_mov_b64 exec, vcc
    buffer_load_dwordx4 v[32:35], v8, s[4:7], s16 offen offset:2048 sc1
    s_mov_b64 exec, -1
    s_add_u32 s23, s23, 1
    s_cmp_lt_u32 s23, 200000
    s_cbranch_scc1 g_30L5_0
    s_mov_b32 s25, 200000
    s_branch gc_31
g_30F6_1:
    s_mov_b64 exec, vcc
    buffer_load_dwordx4 v[28:31], v8, s[4:7], s16 offen offset:1024 sc1
    s_mov_b64 exec, -1
    s_add_u32 s23, s23, 1
    s_cmp_lt_u32 s23, 200000
    s_cbranch_scc1 g_30L6_2
    s_mov_b32 s25, 200000
    s_branch gc_31
g_30F6_2:
    s_mov_b64 exec, vcc
    buffer_load_dwordx4 v[32:35], v8, s[4:7], s16 offen offset:2048 sc1
    s_mov_b64 exec, -1
    s_add_u32 s23, s23, 1
    s_cmp_lt_u32 s23, 200000
    s_cbranch_scc1 g_30L6_1
    s_mov_b32 s25, 200000
    s_branch gc_31
g_30F9_0:
    s_mov_b64 exec, vcc
    buffer_load_dwordx4 v[24:27], v8, s[4:7], s16 offen offset:0 sc1
    s_mov_b64 exec, -1
    s_add_u32 s23, s23, 1
    s_cmp_lt_u32 s23, 200000
    s_cbranch_scc1 g_30L9_3
    s_mov_b32 s25, 200000
    s_branch gc_31
g_30F9_3:
    s_mov_b64 exec, vcc
    buffer_load_dwordx4 v[36:39], v8, s[4:7], s16 offen offset:3072 sc1
    s_mov_b64 exec, -1
    s_add_u32 s23, s23, 1
    s_cmp_lt_u32 s23, 200000
    s_cbranch_scc1 g_30L9_0
    s_mov_b32 s25, 200000
    s_branch gc_31
g_30F10_1:
    s_mov_b64 exec, vcc
    buffer_load_dwordx4 v[28:31], v8, s[4:7], s16 offen offset:1024 sc1
    s_mov_b64 exec, -1
    s_add_u32 s23, s23, 1
    s_cmp_lt_u32 s23, 200000
    s_cbranch_scc1 g_30L10_3
    s_mov_b32 s25, 200000
    s_branch gc_31
g_30F10_3:
    s_mov_b64 exec, vcc
    buffer_load_dwordx4 v[36:39], v8, s[4:7], s16 offen offset:3072 sc1
    s_mov_b64 exec, -1
    s_add_u32 s23, s23, 1
    s_cmp_lt_u32 s23, 200000
    s_cbranch_scc1 g_30L10_1
    s_mov_b32 s25, 200000
    s_branch gc_31
g_30F12_2:
    s_mov_b64 exec, vcc
    buffer_load_dwordx4 v[32:35], v8, s[4:7], s16 offen offset:2048 sc1
    s_mov_b64 exec, -1
    s_add_u32 s23, s23, 1
    s_cmp_lt_u32 s23, 200000
    s_cbranch_scc1 g_30L12_3
    s_mov_b32 s25, 200000
    s_branch gc_31
g_30F12_3:
    s_mov_b64 exec, vcc
    buffer_load_dwordx4 v[36:39], v8, s[4:7], s16 offen offset:3072 sc1
    s_mov_b64 exec, -1
    s_add_u32 s23, s23, 1
    s_cmp_lt_u32 s23, 200000
    s_cbranch_scc1 g_30L12_2
    s_mov_b32 s25, 200000
    s_branch gc_31
g_30F1_0:
    s_mov_b64 exec, vcc
    buffer_load_dwordx4 v[24:27], v8, s[4:7], s16 offen offset:0 sc1
    s_mov_b64 exec, -1
    s_add_u32 s23, s23, 1
    s_cmp_lt_u32 s23, 200000
    s_cbranch_scc1 g_30L1_0
    s_mov_b32 s25, 200000
    s_branch gc_31
g_30F2_1:
    s_mov_b64 exec, vcc
    buffer_load_dwordx4 v[28:31], v8, s[4:7], s16 offen offset:1024 sc1
    s_mov_b64 exec, -1
    s_add_u32 s23, s23, 1
    s_cmp_lt_u32 s23, 200000
    s_cbranch_scc1 g_30L2_1
    s_mov_b32 s25, 200000
    s_branch gc_31
g_30F4_2:
    s_mov_b64 exec, vcc
    buffer_load_dwordx4 v[32:35], v8, s[4:7], s16 offen offset:2048 sc1
    s_mov_b64 exec, -1
    s_add_u32 s23, s23, 1
    s_cmp_lt_u32 s23, 200000
    s_cbranch_scc1 g_30L4_2
    s_mov_b32 s25, 200000
    s_branch gc_31
g_30F8_3:
    s_mov_b64 exec, vcc
    buffer_load_dwordx4 v[36:39], v8, s[4:7], s16 offen offset:3072 sc1
    s_mov_b64 exec, -1
    s_add_u32 s23, s23, 1
    s_cmp_lt_u32 s23, 200000
    s_cbranch_scc1 g_30L8_3
    s_mov_b32 s25, 200000
    s_branch gc_31
.p2align 6
recur_fast_w1:
    s_nop 15
    s_mov_b32 s23, s25
    buffer_load_dwordx4 v[24:27], v2, s[4:7], s16 offen offset:0 sc1
    s_nop 11
    buffer_load_dwordx4 v[28:31], v2, s[4:7], s16 offen offset:1024 sc1
    s_nop 11
    buffer_load_dwordx4 v[32:35], v2, s[4:7], s16 offen offset:2048 sc1
    s_nop 11
    buffer_load_dwordx4 v[36:39], v2, s[4:7], s16 offen offset:3072 sc1
    s_waitcnt vmcnt(3)
    v_max3_u32 v19, v24, v25, v26
    v_max_u32 v19, v19, v27
    v_cmp_eq_u32 vcc, -1, v19
    s_nop 0
    s_cbranch_vccnz g_34F15_0
    v_smfmac_f32_16x16x64_bf16 v[40:43], v[24:27], a[0:7], v172
    s_waitcnt vmcnt(2)
    v_max3_u32 v19, v28, v29, v30
    v_max_u32 v19, v19, v31
    v_smfmac_f32_16x16x64_bf16 v[44:47], v[24:27], a[64:71], v172
    v_cmp_eq_u32 vcc, -1, v19
    v_smfmac_f32_16x16x64_bf16 v[48:51], v[24:27], a[32:39], v172
    v_smfmac_f32_16x16x64_bf16 v[52:55], v[24:27], a[96:103], v172
    s_cbranch_vccnz g_34F14_1
    v_smfmac_f32_16x16x64_bf16 v[40:43], v[28:31], a[8:15], v172
    s_waitcnt vmcnt(1)
    v_max3_u32 v19, v32, v33, v34
    v_max_u32 v19, v19, v35
    v_smfmac_f32_16x16x64_bf16 v[44:47], v[28:31], a[72:79], v172
    v_cmp_eq_u32 vcc, -1, v19
    v_smfmac_f32_16x16x64_bf16 v[48:51], v[28:31], a[40:47], v172
    v_smfmac_f32_16x16x64_bf16 v[52:55], v[28:31], a[104:111], v172
    s_cbranch_vccnz g_34F12_2
    v_smfmac_f32_16x16x64_bf16 v[40:43], v[32:35], a[16:23], v172
    s_waitcnt vmcnt(0)
    v_max3_u32 v19, v36, v37, v38
    v_max_u32 v19, v19, v39
    v_smfmac_f32_16x16x64_bf16 v[44:47], v[32:35], a[80:87], v172
    v_cmp_eq_u32 vcc, -1, v19
    v_smfmac_f32_16x16x64_bf16 v[48:51], v[32:35], a[48:55], v172
    v_smfmac_f32_16x16x64_bf16 v[52:55], v[32:35], a[112:119], v172
    s_cbranch_vccnz g_34F8_3
    v_smfmac_f32_16x16x64_bf16 v[40:43], v[36:39], a[24:31], v172
    v_smfmac_f32_16x16x64_bf16 v[44:47], v[36:39], a[88:95], v172
    v_smfmac_f32_16x16x64_bf16 v[48:51], v[36:39], a[56:63], v172
    v_smfmac_f32_16x16x64_bf16 v[52:55], v[36:39], a[120:127], v172
gc_35:
    v_cvt_pk_bf16_f32 v72, v40, v41
    v_cvt_pk_bf16_f32 v73, v42, v43
    v_cvt_pk_bf16_f32 v74, v44, v45
    v_cvt_pk_bf16_f32 v75, v46, v47
    ds_write_b128 v17, v[72:75] offset:0
    v_cvt_pk_bf16_f32 v76, v48, v49
    v_cvt_pk_bf16_f32 v77, v50, v51
    s_nop 0
    v_cvt_pk_bf16_f32 v78, v52, v53
    v_cvt_pk_bf16_f32 v79, v54, v55
    ds_write_b128 v17, v[76:79] offset:1024
    v_smfmac_f32_16x16x64_bf16 v[56:59], v[24:27], a[128:135], v172
    v_smfmac_f32_16x16x64_bf16 v[60:63], v[24:27], a[160:167], v172
    v_smfmac_f32_16x16x64_bf16 v[56:59], v[28:31], a[136:143], v172
    s_waitcnt lgkmcnt(0)
    s_barrier
    v_smfmac_f32_16x16x64_bf16 v[60:63], v[28:31], a[168:175], v172
    v_smfmac_f32_16x16x64_bf16 v[56:59], v[32:35], a[144:151], v172
    v_smfmac_f32_16x16x64_bf16 v[60:63], v[32:35], a[176:183], v172
    v_smfmac_f32_16x16x64_bf16 v[56:59], v[36:39], a[152:159], v172
    v_smfmac_f32_16x16x64_bf16 v[60:63], v[36:39], a[184:191], v172
    s_nop 4
    v_cvt_pk_bf16_f32 v80, v56, v57
    v_cvt_pk_bf16_f32 v81, v58, v59
    s_nop 0
    v_cvt_pk_bf16_f32 v82, v60, v61
    v_cvt_pk_bf16_f32 v83, v62, v63
    ds_write_b128 v17, v[80:83] offset:8192
    v_mov_b32 v152, v228
    v_mov_b32 v153, v229
    v_mov_b32 v156, v230
    v_mov_b32 v157, v231
    v_mov_b32 v160, v232
    v_mov_b32 v161, v233
    v_mov_b32 v164, v234
    v_mov_b32 v165, v235
    s_cmp_eq_u32 s15, 63
    s_waitcnt lgkmcnt(0)
    s_barrier
    s_cbranch_scc1 recur_end
    s_nop 15
    s_nop 15
    s_nop 7
    buffer_load_dwordx4 v[208:211], v5, s[4:7], s16 offen offset:0 sc1
    buffer_load_dwordx4 v[212:215], v5, s[4:7], s16 offen offset:1024 sc1
    buffer_load_dwordx4 v[216:219], v5, s[4:7], s16 offen offset:2048 sc1
    buffer_load_dwordx4 v[220:223], v5, s[4:7], s16 offen offset:3072 sc1
    buffer_load_dword v224, v6, s[4:7], s16 offen offset:0 sc1
    buffer_load_dword v225, v6, s[4:7], s16 offen offset:256 sc1
    buffer_load_dword v226, v6, s[4:7], s16 offen offset:512 sc1
    buffer_load_dword v227, v6, s[4:7], s16 offen offset:768 sc1
    s_mov_b32 s23, s25
    ds_read_b128 v[96:99], v16 offset:8192
    ds_read_b128 v[104:107], v16 offset:12288
    ds_read_b128 v[108:111], v16 offset:14336
    v_mfma_f32_16x16x32_bf16 v[140:143], v[84:87], v[80:83], 0
    s_waitcnt lgkmcnt(2)
    v_mfma_f32_16x16x32_bf16 v[140:143], v[84:87], v[96:99], v[140:143]
    s_waitcnt lgkmcnt(1)
    v_mfma_f32_16x16x32_bf16 v[140:143], v[84:87], v[104:107], v[140:143]
    s_waitcnt lgkmcnt(0)
    v_mfma_f32_16x16x32_bf16 v[140:143], v[84:87], v[108:111], v[140:143]
    buffer_load_dwordx4 v[24:27], v5, s[4:7], s16 offen offset:0 sc1
    buffer_load_dwordx4 v[28:31], v5, s[4:7], s16 offen offset:1024 sc1
    buffer_load_dwordx4 v[32:35], v5, s[4:7], s16 offen offset:2048 sc1
    buffer_load_dwordx4 v[36:39], v5, s[4:7], s16 offen offset:3072 sc1
    buffer_load_dword v40, v6, s[4:7], s16 offen offset:0 sc1
    buffer_load_dword v41, v6, s[4:7], s16 offen offset:256 sc1
    buffer_load_dword v42, v6, s[4:7], s16 offen offset:512 sc1
    buffer_load_dword v43, v6, s[4:7], s16 offen offset:768 sc1
    v_cvt_pk_bf16_f32 v154, v140, v179
    v_cvt_pk_bf16_f32 v158, v141, v179
    v_cvt_pk_bf16_f32 v162, v142, v179
    v_cvt_pk_bf16_f32 v166, v143, v179
    s_waitcnt vmcnt(14)
    v_pk_add_f32 v[180:181], v[208:209], v[212:213]
    v_pk_add_f32 v[182:183], v[210:211], v[214:215]
    s_waitcnt vmcnt(12)
    v_pk_add_f32 v[188:189], v[216:217], v[220:221]
    v_pk_add_f32 v[190:191], v[218:219], v[222:223]
    v_pk_add_f32 v[180:181], v[180:181], v[188:189]
    v_pk_add_f32 v[182:183], v[182:183], v[190:191]
    v_pk_add_f32 v[188:189], v[180:181], v[182:183]
    v_max3_f32 v185, v180, v181, v182
    s_waitcnt vmcnt(8)
    v_pk_add_f32 v[192:193], v[224:225], v[226:227]
    v_add_f32 v188, v188, v189
    v_add_f32 v184, v192, v193
    v_max3_f32 v185, v185, v183, v184
    v_cmp_u_f32 vcc, v188, v184
    s_nop 0
    v_max_f32_dpp v185, v185, v185 row_ror:8 row_mask:0xf bank_mask:0xf
    v_mov_b32 v186, v185
    s_nop 1
    v_permlane16_swap_b32 v185, v186
    v_max_f32 v185, v185, v186
    v_mov_b32 v186, v185
    s_cbranch_vccnz ss_36
sg_38:
    s_nop 0
    v_permlane32_swap_b32 v185, v186
    v_max_f32 v185, v185, v186
    v_mul_f32 v185, s24, v185
    v_fma_f32 v180, v180, s24, -v185
    v_fma_f32 v181, v181, s24, -v185
    v_fma_f32 v182, v182, s24, -v185
    v_fma_f32 v183, v183, s24, -v185
    v_fma_f32 v184, v184, s24, -v185
    v_exp_f32 v180, v180
    v_exp_f32 v181, v181
    v_exp_f32 v182, v182
    v_exp_f32 v183, v183
    v_exp_f32 v184, v184
    v_cvt_pk_bf16_f32 v176, v180, v181
    v_cvt_pk_bf16_f32 v177, v182, v183
    v_cvt_pk_bf16_f32 v178, v184, v179
    s_nop 1
    v_mfma_f32_16x16x32_bf16 v[240:243], v[236:239], v[176:179], 0
    v_mfma_f32_16x16x32_bf16 v[188:191], v[152:155], v[176:179], 0
    v_mfma_f32_16x16x32_bf16 v[192:195], v[156:159], v[176:179], 0
    v_mfma_f32_16x16x32_bf16 v[196:199], v[160:163], v[176:179], 0
    v_mfma_f32_16x16x32_bf16 v[200:203], v[164:167], v[176:179], 0
    v_add_f32_dpp v185, v240, v240 row_ror:8 row_mask:0xf bank_mask:0xf
    v_rcp_f32 v185, v185
    v_add_f32_dpp v88, v192, v188 row_ror:8 row_mask:0xf bank_mask:0x3
    v_add_f32_dpp v89, v193, v189 row_ror:8 row_mask:0xf bank_mask:0x3
    v_add_f32_dpp v90, v194, v190 row_ror:8 row_mask:0xf bank_mask:0x3
    v_add_f32_dpp v91, v195, v191 row_ror:8 row_mask:0xf bank_mask:0x3
    s_nop 1
    v_add_f32_dpp v88, v196, v200 row_ror:8 row_mask:0xf bank_mask:0xc
    v_add_f32_dpp v89, v197, v201 row_ror:8 row_mask:0xf bank_mask:0xc
    v_add_f32_dpp v90, v198, v202 row_ror:8 row_mask:0xf bank_mask:0xc
    v_add_f32_dpp v91, v199, v203 row_ror:8 row_mask:0xf bank_mask:0xc
    v_mul_f32 v88, v88, v185
    v_mul_f32 v89, v89, v185
    v_mul_f32 v90, v90, v185
    v_mul_f32 v91, v91, v185
    v_cvt_pk_bf16_f32 v88, v88, v89
    v_cvt_pk_bf16_f32 v89, v90, v91
    buffer_store_dwordx2 v[88:89], v7, s[4:7], s16 offen
    v_readfirstlane_b32 s85, v247
    s_add_u32 s94, s15, 2
    s_barrier
    s_nop 15
    s_mov_b32 s23, s25
    buffer_load_dwordx4 v[24:27], v8, s[4:7], s16 offen offset:0 sc1
    s_nop 11
    buffer_load_dwordx4 v[28:31], v8, s[4:7], s16 offen offset:1024 sc1
    s_nop 11
    buffer_load_dwordx4 v[32:35], v8, s[4:7], s16 offen offset:2048 sc1
    s_nop 11
    buffer_load_dwordx4 v[36:39], v8, s[4:7], s16 offen offset:3072 sc1
    s_waitcnt vmcnt(3)
    v_max3_u32 v19, v24, v25, v26
    v_max_u32 v19, v19, v27
    v_cmp_eq_u32 vcc, -1, v19
    s_nop 0
    s_cbranch_vccnz g_39F15_0
    v_smfmac_f32_16x16x64_bf16 v[64:67], v[24:27], a[192:199], v172
    v_smfmac_f32_16x16x64_bf16 v[68:71], v[24:27], a[224:231], v172
    s_waitcnt vmcnt(2)
    v_max3_u32 v19, v28, v29, v30
    v_max_u32 v19, v19, v31
    v_cmp_eq_u32 vcc, -1, v19
    s_nop 0
    s_cbranch_vccnz g_39F14_1
    v_smfmac_f32_16x16x64_bf16 v[64:67], v[28:31], a[200:207], v172
    v_smfmac_f32_16x16x64_bf16 v[68:71], v[28:31], a[232:239], v172
    s_waitcnt vmcnt(1)
    v_max3_u32 v19, v32, v33, v34
    v_max_u32 v19, v19, v35
    v_cmp_eq_u32 vcc, -1, v19
    s_nop 0
    s_cbranch_vccnz g_39F12_2
    v_smfmac_f32_16x16x64_bf16 v[64:67], v[32:35], a[208:215], v172
    v_smfmac_f32_16x16x64_bf16 v[68:71], v[32:35], a[240:247], v172
    s_waitcnt vmcnt(0)
    v_max3_u32 v19, v36, v37, v38
    v_max_u32 v19, v19, v39
    v_cmp_eq_u32 vcc, -1, v19
    s_nop 0
    s_cbranch_vccnz g_39F8_3
    v_smfmac_f32_16x16x64_bf16 v[64:67], v[36:39], a[216:223], v172
    v_smfmac_f32_16x16x64_bf16 v[68:71], v[36:39], a[248:255], v172
    s_nop 4
    v_cvt_pk_bf16_f32 v80, v64, v65
    v_cvt_pk_bf16_f32 v81, v66, v67
    s_nop 0
    v_cvt_pk_bf16_f32 v82, v68, v69
    v_cvt_pk_bf16_f32 v83, v70, v71
    ds_write_b128 v17, v[80:83] offset:9216
gc_40:
    s_waitcnt lgkmcnt(0)
    s_barrier
    s_mov_b32 s23, s25
fw_41:
    s_cmp_ge_u32 s85, s94
    s_cbranch_scc1 fo_42
    buffer_load_dword v247, v245, s[4:7], 0 offen sc1
    s_add_u32 s23, s23, 1
    s_waitcnt vmcnt(0)
    v_readfirstlane_b32 s85, v247
    s_cmp_lt_u32 s23, 200000
    s_cbranch_scc1 fw_41
    s_mov_b32 s25, 200000
fo_42:
    buffer_load_dwordx4 v[228:231], v13, s[4:7], s18 offen offset:0 sc1
    buffer_load_dwordx4 v[232:235], v13, s[4:7], s18 offen offset:128 sc1
    s_add_u32 s18, s18, 2048
    s_min_u32 s18, s18, 35780608
    s_nop 15
    s_nop 15
    s_nop 15
    s_nop 15
    s_add_u32 s21, s15, 3
    s_min_u32 s21, s21, 64
    s_cmp_lt_u32 s85, s21
    s_cselect_b64 exec, 1, 0
    buffer_load_dword v247, v245, s[4:7], 0 offen sc1
    s_mov_b64 exec, -1
    v_mov_b32 v40, 0
    v_mov_b32 v41, 0
    v_mov_b32 v42, 0
    v_mov_b32 v43, 0
    v_mov_b32 v44, 0
    v_mov_b32 v45, 0
    v_mov_b32 v46, 0
    v_mov_b32 v47, 0
    v_mov_b32 v48, 0
    v_mov_b32 v49, 0
    v_mov_b32 v50, 0
    v_mov_b32 v51, 0
    v_mov_b32 v52, 0
    v_mov_b32 v53, 0
    v_mov_b32 v54, 0
    v_mov_b32 v55, 0
    v_mov_b32 v56, 0
    v_mov_b32 v57, 0
    v_mov_b32 v58, 0
    v_mov_b32 v59, 0
    v_mov_b32 v60, 0
    v_mov_b32 v61, 0
    v_mov_b32 v62, 0
    v_mov_b32 v63, 0
    v_mov_b32 v64, 0
    v_mov_b32 v65, 0
    v_mov_b32 v66, 0
    v_mov_b32 v67, 0
    v_mov_b32 v68, 0
    v_mov_b32 v69, 0
    v_mov_b32 v70, 0
    v_mov_b32 v71, 0
    s_mov_b32 s21, s16
    s_mov_b32 s16, s42
    s_mov_b32 s42, s43
    s_mov_b32 s43, s44
    s_mov_b32 s44, s21
    s_add_u32 s95, s95, 524288
    s_lshr_b32 s84, s95, 8
    s_and_b32 s84, s84, 8192
    s_xor_b32 s84, s84, s46
    s_add_u32 s84, s84, s95
    s_add_u32 s15, s15, 1
    s_barrier
    s_branch recur_fast_w1
g_34L15_0:
    s_waitcnt vmcnt(3)
    v_max3_u32 v19, v24, v25, v26
    v_max_u32 v19, v19, v27
    v_cmp_eq_u32 vcc, -1, v19
    s_nop 0
    s_cbranch_vccnz g_34F15_0
    v_smfmac_f32_16x16x64_bf16 v[40:43], v[24:27], a[0:7], v172
    v_smfmac_f32_16x16x64_bf16 v[44:47], v[24:27], a[64:71], v172
    v_smfmac_f32_16x16x64_bf16 v[48:51], v[24:27], a[32:39], v172
    v_smfmac_f32_16x16x64_bf16 v[52:55], v[24:27], a[96:103], v172
g_34L14_1:
    s_waitcnt vmcnt(2)
    v_max3_u32 v19, v28, v29, v30
    v_max_u32 v19, v19, v31
    v_cmp_eq_u32 vcc, -1, v19
    s_nop 0
    s_cbranch_vccnz g_34F14_1
    v_smfmac_f32_16x16x64_bf16 v[40:43], v[28:31], a[8:15], v172
    v_smfmac_f32_16x16x64_bf16 v[44:47], v[28:31], a[72:79], v172
    v_smfmac_f32_16x16x64_bf16 v[48:51], v[28:31], a[40:47], v172
    v_smfmac_f32_16x16x64_bf16 v[52:55], v[28:31], a[104:111], v172
g_34L12_2:
    s_waitcnt vmcnt(1)
    v_max3_u32 v19, v32, v33, v34
    v_max_u32 v19, v19, v35
    v_cmp_eq_u32 vcc, -1, v19
    s_nop 0
    s_cbranch_vccnz g_34F12_2
    v_smfmac_f32_16x16x64_bf16 v[40:43], v[32:35], a[16:23], v172
    v_smfmac_f32_16x16x64_bf16 v[44:47], v[32:35], a[80:87], v172
    v_smfmac_f32_16x16x64_bf16 v[48:51], v[32:35], a[48:55], v172
    v_smfmac_f32_16x16x64_bf16 v[52:55], v[32:35], a[112:119], v172
g_34L8_3:
    s_waitcnt vmcnt(0)
    v_max3_u32 v19, v36, v37, v38
    v_max_u32 v19, v19, v39
    v_cmp_eq_u32 vcc, -1, v19
    s_nop 0
    s_cbranch_vccnz g_34F8_3
    v_smfmac_f32_16x16x64_bf16 v[40:43], v[36:39], a[24:31], v172
    v_smfmac_f32_16x16x64_bf16 v[44:47], v[36:39], a[88:95], v172
    v_smfmac_f32_16x16x64_bf16 v[48:51], v[36:39], a[56:63], v172
    v_smfmac_f32_16x16x64_bf16 v[52:55], v[36:39], a[120:127], v172
    s_branch gc_35
g_34L15_1:
    s_waitcnt vmcnt(3)
    v_max3_u32 v19, v28, v29, v30
    v_max_u32 v19, v19, v31
    v_cmp_eq_u32 vcc, -1, v19
    s_nop 0
    s_cbranch_vccnz g_34F15_1
    v_smfmac_f32_16x16x64_bf16 v[40:43], v[28:31], a[8:15], v172
    v_smfmac_f32_16x16x64_bf16 v[44:47], v[28:31], a[72:79], v172
    v_smfmac_f32_16x16x64_bf16 v[48:51], v[28:31], a[40:47], v172
    v_smfmac_f32_16x16x64_bf16 v[52:55], v[28:31], a[104:111], v172
g_34L13_2:
    s_waitcnt vmcnt(2)
    v_max3_u32 v19, v32, v33, v34
    v_max_u32 v19, v19, v35
    v_cmp_eq_u32 vcc, -1, v19
    s_nop 0
    s_cbranch_vccnz g_34F13_2
    v_smfmac_f32_16x16x64_bf16 v[40:43], v[32:35], a[16:23], v172
    v_smfmac_f32_16x16x64_bf16 v[44:47], v[32:35], a[80:87], v172
    v_smfmac_f32_16x16x64_bf16 v[48:51], v[32:35], a[48:55], v172
    v_smfmac_f32_16x16x64_bf16 v[52:55], v[32:35], a[112:119], v172
g_34L9_3:
    s_waitcnt vmcnt(1)
    v_max3_u32 v19, v36, v37, v38
    v_max_u32 v19, v19, v39
    v_cmp_eq_u32 vcc, -1, v19
    s_nop 0
    s_cbranch_vccnz g_34F9_3
    v_smfmac_f32_16x16x64_bf16 v[40:43], v[36:39], a[24:31], v172
    v_smfmac_f32_16x16x64_bf16 v[44:47], v[36:39], a[88:95], v172
    v_smfmac_f32_16x16x64_bf16 v[48:51], v[36:39], a[56:63], v172
    v_smfmac_f32_16x16x64_bf16 v[52:55], v[36:39], a[120:127], v172
g_34L1_0:
    s_waitcnt vmcnt(0)
    v_max3_u32 v19, v24, v25, v26
    v_max_u32 v19, v19, v27
    v_cmp_eq_u32 vcc, -1, v19
    s_nop 0
    s_cbranch_vccnz g_34F1_0
    v_smfmac_f32_16x16x64_bf16 v[40:43], v[24:27], a[0:7], v172
    v_smfmac_f32_16x16x64_bf16 v[44:47], v[24:27], a[64:71], v172
    v_smfmac_f32_16x16x64_bf16 v[48:51], v[24:27], a[32:39], v172
    v_smfmac_f32_16x16x64_bf16 v[52:55], v[24:27], a[96:103], v172
    s_branch gc_35
g_34L15_2:
    s_waitcnt vmcnt(3)
    v_max3_u32 v19, v32, v33, v34
    v_max_u32 v19, v19, v35
    v_cmp_eq_u32 vcc, -1, v19
    s_nop 0
    s_cbranch_vccnz g_34F15_2
    v_smfmac_f32_16x16x64_bf16 v[40:43], v[32:35], a[16:23], v172
    v_smfmac_f32_16x16x64_bf16 v[44:47], v[32:35], a[80:87], v172
    v_smfmac_f32_16x16x64_bf16 v[48:51], v[32:35], a[48:55], v172
    v_smfmac_f32_16x16x64_bf16 v[52:55], v[32:35], a[112:119], v172
g_34L11_3:
    s_waitcnt vmcnt(2)
    v_max3_u32 v19, v36, v37, v38
    v_max_u32 v19, v19, v39
    v_cmp_eq_u32 vcc, -1, v19
    s_nop 0
    s_cbranch_vccnz g_34F11_3
    v_smfmac_f32_16x16x64_bf16 v[40:43], v[36:39], a[24:31], v172
    v_smfmac_f32_16x16x64_bf16 v[44:47], v[36:39], a[88:95], v172
    v_smfmac_f32_16x16x64_bf16 v[48:51], v[36:39], a[56:63], v172
    v_smfmac_f32_16x16x64_bf16 v[52:55], v[36:39], a[120:127], v172
g_34L3_0:
    s_waitcnt vmcnt(1)
    v_max3_u32 v19, v24, v25, v26
    v_max_u32 v19, v19, v27
    v_cmp_eq_u32 vcc, -1, v19
    s_nop 0
    s_cbranch_vccnz g_34F3_0
    v_smfmac_f32_16x16x64_bf16 v[40:43], v[24:27], a[0:7], v172
    v_smfmac_f32_16x16x64_bf16 v[44:47], v[24:27], a[64:71], v172
    v_smfmac_f32_16x16x64_bf16 v[48:51], v[24:27], a[32:39], v172
    v_smfmac_f32_16x16x64_bf16 v[52:55], v[24:27], a[96:103], v172
g_34L2_1:
    s_waitcnt vmcnt(0)
    v_max3_u32 v19, v28, v29, v30
    v_max_u32 v19, v19, v31
    v_cmp_eq_u32 vcc, -1, v19
    s_nop 0
    s_cbranch_vccnz g_34F2_1
    v_smfmac_f32_16x16x64_bf16 v[40:43], v[28:31], a[8:15], v172
    v_smfmac_f32_16x16x64_bf16 v[44:47], v[28:31], a[72:79], v172
    v_smfmac_f32_16x16x64_bf16 v[48:51], v[28:31], a[40:47], v172
    v_smfmac_f32_16x16x64_bf16 v[52:55], v[28:31], a[104:111], v172
    s_branch gc_35
g_34L15_3:
    s_waitcnt vmcnt(3)
    v_max3_u32 v19, v36, v37, v38
    v_max_u32 v19, v19, v39
    v_cmp_eq_u32 vcc, -1, v19
    s_nop 0
    s_cbranch_vccnz g_34F15_3
    v_smfmac_f32_16x16x64_bf16 v[40:43], v[36:39], a[24:31], v172
    v_smfmac_f32_16x16x64_bf16 v[44:47], v[36:39], a[88:95], v172
    v_smfmac_f32_16x16x64_bf16 v[48:51], v[36:39], a[56:63], v172
    v_smfmac_f32_16x16x64_bf16 v[52:55], v[36:39], a[120:127], v172
g_34L7_0:
    s_waitcnt vmcnt(2)
    v_max3_u32 v19, v24, v25, v26
    v_max_u32 v19, v19, v27
    v_cmp_eq_u32 vcc, -1, v19
    s_nop 0
    s_cbranch_vccnz g_34F7_0
    v_smfmac_f32_16x16x64_bf16 v[40:43], v[24:27], a[0:7], v172
    v_smfmac_f32_16x16x64_bf16 v[44:47], v[24:27], a[64:71], v172
    v_smfmac_f32_16x16x64_bf16 v[48:51], v[24:27], a[32:39], v172
    v_smfmac_f32_16x16x64_bf16 v[52:55], v[24:27], a[96:103], v172
g_34L6_1:
    s_waitcnt vmcnt(1)
    v_max3_u32 v19, v28, v29, v30
    v_max_u32 v19, v19, v31
    v_cmp_eq_u32 vcc, -1, v19
    s_nop 0
    s_cbranch_vccnz g_34F6_1
    v_smfmac_f32_16x16x64_bf16 v[40:43], v[28:31], a[8:15], v172
    v_smfmac_f32_16x16x64_bf16 v[44:47], v[28:31], a[72:79], v172
    v_smfmac_f32_16x16x64_bf16 v[48:51], v[28:31], a[40:47], v172
    v_smfmac_f32_16x16x64_bf16 v[52:55], v[28:31], a[104:111], v172
g_34L4_2:
    s_waitcnt vmcnt(0)
    v_max3_u32 v19, v32, v33, v34
    v_max_u32 v19, v19, v35
    v_cmp_eq_u32 vcc, -1, v19
    s_nop 0
    s_cbranch_vccnz g_34F4_2
    v_smfmac_f32_16x16x64_bf16 v[40:43], v[32:35], a[16:23], v172
    v_smfmac_f32_16x16x64_bf16 v[44:47], v[32:35], a[80:87], v172
    v_smfmac_f32_16x16x64_bf16 v[48:51], v[32:35], a[48:55], v172
    v_smfmac_f32_16x16x64_bf16 v[52:55], v[32:35], a[112:119], v172
    s_branch gc_35
g_34L7_1:
    s_waitcnt vmcnt(2)
    v_max3_u32 v19, v28, v29, v30
    v_max_u32 v19, v19, v31
    v_cmp_eq_u32 vcc, -1, v19
    s_nop 0
    s_cbranch_vccnz g_34F7_1
    v_smfmac_f32_16x16x64_bf16 v[40:43], v[28:31], a[8:15], v172
    v_smfmac_f32_16x16x64_bf16 v[44:47], v[28:31], a[72:79], v172
    v_smfmac_f32_16x16x64_bf16 v[48:51], v[28:31], a[40:47], v172
    v_smfmac_f32_16x16x64_bf16 v[52:55], v[28:31], a[104:111], v172
g_34L5_2:
    s_waitcnt vmcnt(1)
    v_max3_u32 v19, v32, v33, v34
    v_max_u32 v19, v19, v35
    v_cmp_eq_u32 vcc, -1, v19
    s_nop 0
    s_cbranch_vccnz g_34F5_2
    v_smfmac_f32_16x16x64_bf16 v[40:43], v[32:35], a[16:23], v172
    v_smfmac_f32_16x16x64_bf16 v[44:47], v[32:35], a[80:87], v172
    v_smfmac_f32_16x16x64_bf16 v[48:51], v[32:35], a[48:55], v172
    v_smfmac_f32_16x16x64_bf16 v[52:55], v[32:35], a[112:119], v172
    s_branch g_34L1_0
g_34L7_2:
    s_waitcnt vmcnt(2)
    v_max3_u32 v19, v32, v33, v34
    v_max_u32 v19, v19, v35
    v_cmp_eq_u32 vcc, -1, v19
    s_nop 0
    s_cbranch_vccnz g_34F7_2
    v_smfmac_f32_16x16x64_bf16 v[40:43], v[32:35], a[16:23], v172
    v_smfmac_f32_16x16x64_bf16 v[44:47], v[32:35], a[80:87], v172
    v_smfmac_f32_16x16x64_bf16 v[48:51], v[32:35], a[48:55], v172
    v_smfmac_f32_16x16x64_bf16 v[52:55], v[32:35], a[112:119], v172
    s_branch g_34L3_0
g_34L11_0:
    s_waitcnt vmcnt(2)
    v_max3_u32 v19, v24, v25, v26
    v_max_u32 v19, v19, v27
    v_cmp_eq_u32 vcc, -1, v19
    s_nop 0
    s_cbranch_vccnz g_34F11_0
    v_smfmac_f32_16x16x64_bf16 v[40:43], v[24:27], a[0:7], v172
    v_smfmac_f32_16x16x64_bf16 v[44:47], v[24:27], a[64:71], v172
    v_smfmac_f32_16x16x64_bf16 v[48:51], v[24:27], a[32:39], v172
    v_smfmac_f32_16x16x64_bf16 v[52:55], v[24:27], a[96:103], v172
g_34L10_1:
    s_waitcnt vmcnt(1)
    v_max3_u32 v19, v28, v29, v30
    v_max_u32 v19, v19, v31
    v_cmp_eq_u32 vcc, -1, v19
    s_nop 0
    s_cbranch_vccnz g_34F10_1
    v_smfmac_f32_16x16x64_bf16 v[40:43], v[28:31], a[8:15], v172
    v_smfmac_f32_16x16x64_bf16 v[44:47], v[28:31], a[72:79], v172
    v_smfmac_f32_16x16x64_bf16 v[48:51], v[28:31], a[40:47], v172
    v_smfmac_f32_16x16x64_bf16 v[52:55], v[28:31], a[104:111], v172
    s_branch g_34L8_3
g_34L11_1:
    s_waitcnt vmcnt(2)
    v_max3_u32 v19, v28, v29, v30
    v_max_u32 v19, v19, v31
    v_cmp_eq_u32 vcc, -1, v19
    s_nop 0
    s_cbranch_vccnz g_34F11_1
    v_smfmac_f32_16x16x64_bf16 v[40:43], v[28:31], a[8:15], v172
    v_smfmac_f32_16x16x64_bf16 v[44:47], v[28:31], a[72:79], v172
    v_smfmac_f32_16x16x64_bf16 v[48:51], v[28:31], a[40:47], v172
    v_smfmac_f32_16x16x64_bf16 v[52:55], v[28:31], a[104:111], v172
    s_branch g_34L9_3
g_34L13_0:
    s_waitcnt vmcnt(2)
    v_max3_u32 v19, v24, v25, v26
    v_max_u32 v19, v19, v27
    v_cmp_eq_u32 vcc, -1, v19
    s_nop 0
    s_cbranch_vccnz g_34F13_0
    v_smfmac_f32_16x16x64_bf16 v[40:43], v[24:27], a[0:7], v172
    v_smfmac_f32_16x16x64_bf16 v[44:47], v[24:27], a[64:71], v172
    v_smfmac_f32_16x16x64_bf16 v[48:51], v[24:27], a[32:39], v172
    v_smfmac_f32_16x16x64_bf16 v[52:55], v[24:27], a[96:103], v172
    s_branch g_34L12_2
g_34L13_3:
    s_waitcnt vmcnt(2)
    v_max3_u32 v19, v36, v37, v38
    v_max_u32 v19, v19, v39
    v_cmp_eq_u32 vcc, -1, v19
    s_nop 0
    s_cbranch_vccnz g_34F13_3
    v_smfmac_f32_16x16x64_bf16 v[40:43], v[36:39], a[24:31], v172
    v_smfmac_f32_16x16x64_bf16 v[44:47], v[36:39], a[88:95], v172
    v_smfmac_f32_16x16x64_bf16 v[48:51], v[36:39], a[56:63], v172
    v_smfmac_f32_16x16x64_bf16 v[52:55], v[36:39], a[120:127], v172
g_34L5_0:
    s_waitcnt vmcnt(1)
    v_max3_u32 v19, v24, v25, v26
    v_max_u32 v19, v19, v27
    v_cmp_eq_u32 vcc, -1, v19
    s_nop 0
    s_cbranch_vccnz g_34F5_0
    v_smfmac_f32_16x16x64_bf16 v[40:43], v[24:27], a[0:7], v172
    v_smfmac_f32_16x16x64_bf16 v[44:47], v[24:27], a[64:71], v172
    v_smfmac_f32_16x16x64_bf16 v[48:51], v[24:27], a[32:39], v172
    v_smfmac_f32_16x16x64_bf16 v[52:55], v[24:27], a[96:103], v172
    s_branch g_34L4_2
g_34L14_2:
    s_waitcnt vmcnt(2)
    v_max3_u32 v19, v32, v33, v34
    v_max_u32 v19, v19, v35
    v_cmp_eq_u32 vcc, -1, v19
    s_nop 0
    s_cbranch_vccnz g_34F14_2
    v_smfmac_f32_16x16x64_bf16 v[40:43], v[32:35], a[16:23], v172
    v_smfmac_f32_16x16x64_bf16 v[44:47], v[32:35], a[80:87], v172
    v_smfmac_f32_16x16x64_bf16 v[48:51], v[32:35], a[48:55], v172
    v_smfmac_f32_16x16x64_bf16 v[52:55], v[32:35], a[112:119], v172
g_34L10_3:
    s_waitcnt vmcnt(1)
    v_max3_u32 v19, v36, v37, v38
    v_max_u32 v19, v19, v39
    v_cmp_eq_u32 vcc, -1, v19
    s_nop 0
    s_cbranch_vccnz g_34F10_3
    v_smfmac_f32_16x16x64_bf16 v[40:43], v[36:39], a[24:31], v172
    v_smfmac_f32_16x16x64_bf16 v[44:47], v[36:39], a[88:95], v172
    v_smfmac_f32_16x16x64_bf16 v[48:51], v[36:39], a[56:63], v172
    v_smfmac_f32_16x16x64_bf16 v[52:55], v[36:39], a[120:127], v172
    s_branch g_34L2_1
g_34L14_3:
    s_waitcnt vmcnt(2)
    v_max3_u32 v19, v36, v37, v38
    v_max_u32 v19, v19, v39
    v_cmp_eq_u32 vcc, -1, v19
    s_nop 0
    s_cbranch_vccnz g_34F14_3
    v_smfmac_f32_16x16x64_bf16 v[40:43], v[36:39], a[24:31], v172
    v_smfmac_f32_16x16x64_bf16 v[44:47], v[36:39], a[88:95], v172
    v_smfmac_f32_16x16x64_bf16 v[48:51], v[36:39], a[56:63], v172
    v_smfmac_f32_16x16x64_bf16 v[52:55], v[36:39], a[120:127], v172
    s_branch g_34L6_1
g_34L3_1:
    s_waitcnt vmcnt(1)
    v_max3_u32 v19, v28, v29, v30
    v_max_u32 v19, v19, v31
    v_cmp_eq_u32 vcc, -1, v19
    s_nop 0
    s_cbranch_vccnz g_34F3_1
    v_smfmac_f32_16x16x64_bf16 v[40:43], v[28:31], a[8:15], v172
    v_smfmac_f32_16x16x64_bf16 v[44:47], v[28:31], a[72:79], v172
    v_smfmac_f32_16x16x64_bf16 v[48:51], v[28:31], a[40:47], v172
    v_smfmac_f32_16x16x64_bf16 v[52:55], v[28:31], a[104:111], v172
    s_branch g_34L1_0
g_34L6_2:
    s_waitcnt vmcnt(1)
    v_max3_u32 v19, v32, v33, v34
    v_max_u32 v19, v19, v35
    v_cmp_eq_u32 vcc, -1, v19
    s_nop 0
    s_cbranch_vccnz g_34F6_2
    v_smfmac_f32_16x16x64_bf16 v[40:43], v[32:35], a[16:23], v172
    v_smfmac_f32_16x16x64_bf16 v[44:47], v[32:35], a[80:87], v172
    v_smfmac_f32_16x16x64_bf16 v[48:51], v[32:35], a[48:55], v172
    v_smfmac_f32_16x16x64_bf16 v[52:55], v[32:35], a[112:119], v172
    s_branch g_34L2_1
g_34L9_0:
    s_waitcnt vmcnt(1)
    v_max3_u32 v19, v24, v25, v26
    v_max_u32 v19, v19, v27
    v_cmp_eq_u32 vcc, -1, v19
    s_nop 0
    s_cbranch_vccnz g_34F9_0
    v_smfmac_f32_16x16x64_bf16 v[40:43], v[24:27], a[0:7], v172
    v_smfmac_f32_16x16x64_bf16 v[44:47], v[24:27], a[64:71], v172
    v_smfmac_f32_16x16x64_bf16 v[48:51], v[24:27], a[32:39], v172
    v_smfmac_f32_16x16x64_bf16 v[52:55], v[24:27], a[96:103], v172
    s_branch g_34L8_3
g_34L12_3:
    s_waitcnt vmcnt(1)
    v_max3_u32 v19, v36, v37, v38
    v_max_u32 v19, v19, v39
    v_cmp_eq_u32 vcc, -1, v19
    s_nop 0
    s_cbranch_vccnz g_34F12_3
    v_smfmac_f32_16x16x64_bf16 v[40:43], v[36:39], a[24:31], v172
    v_smfmac_f32_16x16x64_bf16 v[44:47], v[36:39], a[88:95], v172
    v_smfmac_f32_16x16x64_bf16 v[48:51], v[36:39], a[56:63], v172
    v_smfmac_f32_16x16x64_bf16 v[52:55], v[36:39], a[120:127], v172
    s_branch g_34L4_2
g_34F15_0:
    s_mov_b64 exec, vcc
    buffer_load_dwordx4 v[24:27], v2, s[4:7], s16 offen offset:0 sc1
    s_mov_b64 exec, -1
    s_add_u32 s23, s23, 1
    s_cmp_lt_u32 s23, 200000
    s_cbranch_scc1 g_34L15_1
    s_mov_b32 s25, 200000
    s_branch gc_35
g_34F15_1:
    s_mov_b64 exec, vcc
    buffer_load_dwordx4 v[28:31], v2, s[4:7], s16 offen offset:1024 sc1
    s_mov_b64 exec, -1
    s_add_u32 s23, s23, 1
    s_cmp_lt_u32 s23, 200000
    s_cbranch_scc1 g_34L15_2
    s_mov_b32 s25, 200000
    s_branch gc_35
g_34F15_2:
    s_mov_b64 exec, vcc
    buffer_load_dwordx4 v[32:35], v2, s[4:7], s16 offen offset:2048 sc1
    s_mov_b64 exec, -1
    s_add_u32 s23, s23, 1
    s_cmp_lt_u32 s23, 200000
    s_cbranch_scc1 g_34L15_3
    s_mov_b32 s25, 200000
    s_branch gc_35
g_34F15_3:
    s_mov_b64 exec, vcc
    buffer_load_dwordx4 v[36:39], v2, s[4:7], s16 offen offset:3072 sc1
    s_mov_b64 exec, -1
    s_add_u32 s23, s23, 1
    s_cmp_lt_u32 s23, 200000
    s_cbranch_scc1 g_34L15_0
    s_mov_b32 s25, 200000
    s_branch gc_35
g_34F7_0:
    s_mov_b64 exec, vcc
    buffer_load_dwordx4 v[24:27], v2, s[4:7], s16 offen offset:0 sc1
    s_mov_b64 exec, -1
    s_add_u32 s23, s23, 1
    s_cmp_lt_u32 s23, 200000
    s_cbranch_scc1 g_34L7_1
    s_mov_b32 s25, 200000
    s_branch gc_35
g_34F7_1:
    s_mov_b64 exec, vcc
    buffer_load_dwordx4 v[28:31], v2, s[4:7], s16 offen offset:1024 sc1
    s_mov_b64 exec, -1
    s_add_u32 s23, s23, 1
    s_cmp_lt_u32 s23, 200000
    s_cbranch_scc1 g_34L7_2
    s_mov_b32 s25, 200000
    s_branch gc_35
g_34F7_2:
    s_mov_b64 exec, vcc
    buffer_load_dwordx4 v[32:35], v2, s[4:7], s16 offen offset:2048 sc1
    s_mov_b64 exec, -1
    s_add_u32 s23, s23, 1
    s_cmp_lt_u32 s23, 200000
    s_cbranch_scc1 g_34L7_0
    s_mov_b32 s25, 200000
    s_branch gc_35
g_34F11_0:
    s_mov_b64 exec, vcc
    buffer_load_dwordx4 v[24:27], v2, s[4:7], s16 offen offset:0 sc1
    s_mov_b64 exec, -1
    s_add_u32 s23, s23, 1
    s_cmp_lt_u32 s23, 200000
    s_cbranch_scc1 g_34L11_1
    s_mov_b32 s25, 200000
    s_branch gc_35
g_34F11_1:
    s_mov_b64 exec, vcc
    buffer_load_dwordx4 v[28:31], v2, s[4:7], s16 offen offset:1024 sc1
    s_mov_b64 exec, -1
    s_add_u32 s23, s23, 1
    s_cmp_lt_u32 s23, 200000
    s_cbranch_scc1 g_34L11_3
    s_mov_b32 s25, 200000
    s_branch gc_35
g_34F11_3:
    s_mov_b64 exec, vcc
    buffer_load_dwordx4 v[36:39], v2, s[4:7], s16 offen offset:3072 sc1
    s_mov_b64 exec, -1
    s_add_u32 s23, s23, 1
    s_cmp_lt_u32 s23, 200000
    s_cbranch_scc1 g_34L11_0
    s_mov_b32 s25, 200000
    s_branch gc_35
g_34F13_0:
    s_mov_b64 exec, vcc
    buffer_load_dwordx4 v[24:27], v2, s[4:7], s16 offen offset:0 sc1
    s_mov_b64 exec, -1
    s_add_u32 s23, s23, 1
    s_cmp_lt_u32 s23, 200000
    s_cbranch_scc1 g_34L13_2
    s_mov_b32 s25, 200000
    s_branch gc_35
g_34F13_2:
    s_mov_b64 exec, vcc
    buffer_load_dwordx4 v[32:35], v2, s[4:7], s16 offen offset:2048 sc1
    s_mov_b64 exec, -1
    s_add_u32 s23, s23, 1
    s_cmp_lt_u32 s23, 200000
    s_cbranch_scc1 g_34L13_3
    s_mov_b32 s25, 200000
    s_branch gc_35
g_34F13_3:
    s_mov_b64 exec, vcc
    buffer_load_dwordx4 v[36:39], v2, s[4:7], s16 offen offset:3072 sc1
    s_mov_b64 exec, -1
    s_add_u32 s23, s23, 1
    s_cmp_lt_u32 s23, 200000
    s_cbranch_scc1 g_34L13_0
    s_mov_b32 s25, 200000
    s_branch gc_35
g_34F14_1:
    s_mov_b64 exec, vcc
    buffer_load_dwordx4 v[28:31], v2, s[4:7], s16 offen offset:1024 sc1
    s_mov_b64 exec, -1
    s_add_u32 s23, s23, 1
    s_cmp_lt_u32 s23, 200000
    s_cbranch_scc1 g_34L14_2
    s_mov_b32 s25, 200000
    s_branch gc_35
g_34F14_2:
    s_mov_b64 exec, vcc
    buffer_load_dwordx4 v[32:35], v2, s[4:7], s16 offen offset:2048 sc1
    s_mov_b64 exec, -1
    s_add_u32 s23, s23, 1
    s_cmp_lt_u32 s23, 200000
    s_cbranch_scc1 g_34L14_3
    s_mov_b32 s25, 200000
    s_branch gc_35
g_34F14_3:
    s_mov_b64 exec, vcc
    buffer_load_dwordx4 v[36:39], v2, s[4:7], s16 offen offset:3072 sc1
    s_mov_b64 exec, -1
    s_add_u32 s23, s23, 1
    s_cmp_lt_u32 s23, 200000
    s_cbranch_scc1 g_34L14_1
    s_mov_b32 s25, 200000
    s_branch gc_35
g_34F3_0:
    s_mov_b64 exec, vcc
    buffer_load_dwordx4 v[24:27], v2, s[4:7], s16 offen offset:0 sc1
    s_mov_b64 exec, -1
    s_add_u32 s23, s23, 1
    s_cmp_lt_u32 s23, 200000
    s_cbranch_scc1 g_34L3_1
    s_mov_b32 s25, 200000
    s_branch gc_35
g_34F3_1:
    s_mov_b64 exec, vcc
    buffer_load_dwordx4 v[28:31], v2, s[4:7], s16 offen offset:1024 sc1
    s_mov_b64 exec, -1
    s_add_u32 s23, s23, 1
    s_cmp_lt_u32 s23, 200000
    s_cbranch_scc1 g_34L3_0
    s_mov_b32 s25, 200000
    s_branch gc_35
g_34F5_0:
    s_mov_b64 exec, vcc
    buffer_load_dwordx4 v[24:27], v2, s[4:7], s16 offen offset:0 sc1
    s_mov_b64 exec, -1
    s_add_u32 s23, s23, 1
    s_cmp_lt_u32 s23, 200000
    s_cbranch_scc1 g_34L5_2
    s_mov_b32 s25, 200000
    s_branch gc_35
g_34F5_2:
    s_mov_b64 exec, vcc
    buffer_load_dwordx4 v[32:35], v2, s[4:7], s16 offen offset:2048 sc1
    s_mov_b64 exec, -1
    s_add_u32 s23, s23, 1
    s_cmp_lt_u32 s23, 200000
    s_cbranch_scc1 g_34L5_0
    s_mov_b32 s25, 200000
    s_branch gc_35
g_34F6_1:
    s_mov_b64 exec, vcc
    buffer_load_dwordx4 v[28:31], v2, s[4:7], s16 offen offset:1024 sc1
    s_mov_b64 exec, -1
    s_add_u32 s23, s23, 1
    s_cmp_lt_u32 s23, 200000
    s_cbranch_scc1 g_34L6_2
    s_mov_b32 s25, 200000
    s_branch gc_35
g_34F6_2:
    s_mov_b64 exec, vcc
    buffer_load_dwordx4 v[32:35], v2, s[4:7], s16 offen offset:2048 sc1
    s_mov_b64 exec, -1
    s_add_u32 s23, s23, 1
    s_cmp_lt_u32 s23, 200000
    s_cbranch_scc1 g_34L6_1
    s_mov_b32 s25, 200000
    s_branch gc_35
g_34F9_0:
    s_mov_b64 exec, vcc
    buffer_load_dwordx4 v[24:27], v2, s[4:7], s16 offen offset:0 sc1
    s_mov_b64 exec, -1
    s_add_u32 s23, s23, 1
    s_cmp_lt_u32 s23, 200000
    s_cbranch_scc1 g_34L9_3
    s_mov_b32 s25, 200000
    s_branch gc_35
g_34F9_3:
    s_mov_b64 exec, vcc
    buffer_load_dwordx4 v[36:39], v2, s[4:7], s16 offen offset:3072 sc1
    s_mov_b64 exec, -1
    s_add_u32 s23, s23, 1
    s_cmp_lt_u32 s23, 200000
    s_cbranch_scc1 g_34L9_0
    s_mov_b32 s25, 200000
    s_branch gc_35
g_34F10_1:
    s_mov_b64 exec, vcc
    buffer_load_dwordx4 v[28:31], v2, s[4:7], s16 offen offset:1024 sc1
    s_mov_b64 exec, -1
    s_add_u32 s23, s23, 1
    s_cmp_lt_u32 s23, 200000
    s_cbranch_scc1 g_34L10_3
    s_mov_b32 s25, 200000
    s_branch gc_35
g_34F10_3:
    s_mov_b64 exec, vcc
    buffer_load_dwordx4 v[36:39], v2, s[4:7], s16 offen offset:3072 sc1
    s_mov_b64 exec, -1
    s_add_u32 s23, s23, 1
    s_cmp_lt_u32 s23, 200000
    s_cbranch_scc1 g_34L10_1
    s_mov_b32 s25, 200000
    s_branch gc_35
g_34F12_2:
    s_mov_b64 exec, vcc
    buffer_load_dwordx4 v[32:35], v2, s[4:7], s16 offen offset:2048 sc1
    s_mov_b64 exec, -1
    s_add_u32 s23, s23, 1
    s_cmp_lt_u32 s23, 200000
    s_cbranch_scc1 g_34L12_3
    s_mov_b32 s25, 200000
    s_branch gc_35
g_34F12_3:
    s_mov_b64 exec, vcc
    buffer_load_dwordx4 v[36:39], v2, s[4:7], s16 offen offset:3072 sc1
    s_mov_b64 exec, -1
    s_add_u32 s23, s23, 1
    s_cmp_lt_u32 s23, 200000
    s_cbranch_scc1 g_34L12_2
    s_mov_b32 s25, 200000
    s_branch gc_35
g_34F1_0:
    s_mov_b64 exec, vcc
    buffer_load_dwordx4 v[24:27], v2, s[4:7], s16 offen offset:0 sc1
    s_mov_b64 exec, -1
    s_add_u32 s23, s23, 1
    s_cmp_lt_u32 s23, 200000
    s_cbranch_scc1 g_34L1_0
    s_mov_b32 s25, 200000
    s_branch gc_35
g_34F2_1:
    s_mov_b64 exec, vcc
    buffer_load_dwordx4 v[28:31], v2, s[4:7], s16 offen offset:1024 sc1
    s_mov_b64 exec, -1
    s_add_u32 s23, s23, 1
    s_cmp_lt_u32 s23, 200000
    s_cbranch_scc1 g_34L2_1
    s_mov_b32 s25, 200000
    s_branch gc_35
g_34F4_2:
    s_mov_b64 exec, vcc
    buffer_load_dwordx4 v[32:35], v2, s[4:7], s16 offen offset:2048 sc1
    s_mov_b64 exec, -1
    s_add_u32 s23, s23, 1
    s_cmp_lt_u32 s23, 200000
    s_cbranch_scc1 g_34L4_2
    s_mov_b32 s25, 200000
    s_branch gc_35
g_34F8_3:
    s_mov_b64 exec, vcc
    buffer_load_dwordx4 v[36:39], v2, s[4:7], s16 offen offset:3072 sc1
    s_mov_b64 exec, -1
    s_add_u32 s23, s23, 1
    s_cmp_lt_u32 s23, 200000
    s_cbranch_scc1 g_34L8_3
    s_mov_b32 s25, 200000
    s_branch gc_35
sb_37:
    v_max3_u32 v19, v24, v25, v26
    v_max3_u32 v19, v19, v27, v28
    v_max3_u32 v19, v19, v29, v30
    v_max3_u32 v19, v19, v31, v32
    v_max3_u32 v19, v19, v33, v34
    v_max3_u32 v19, v19, v35, v36
    v_max3_u32 v19, v19, v37, v38
    v_max3_u32 v19, v19, v39, v40
    v_max3_u32 v19, v19, v41, v42
    v_max_u32 v19, v19, v43
    v_cmp_eq_u32 vcc, -1, v19
    s_nop 0
    s_cbranch_vccz sg_38
    buffer_load_dwordx4 v[24:27], v5, s[4:7], s16 offen offset:0 sc1
    buffer_load_dwordx4 v[28:31], v5, s[4:7], s16 offen offset:1024 sc1
    buffer_load_dwordx4 v[32:35], v5, s[4:7], s16 offen offset:2048 sc1
    buffer_load_dwordx4 v[36:39], v5, s[4:7], s16 offen offset:3072 sc1
    buffer_load_dword v40, v6, s[4:7], s16 offen offset:0 sc1
    buffer_load_dword v41, v6, s[4:7], s16 offen offset:256 sc1
    buffer_load_dword v42, v6, s[4:7], s16 offen offset:512 sc1
    buffer_load_dword v43, v6, s[4:7], s16 offen offset:768 sc1
    s_add_u32 s23, s23, 1
    s_cmp_lt_u32 s23, 200000
    s_cbranch_scc1 ss_36
    s_mov_b32 s25, 200000
    s_branch sg_38
ss_36:
    s_waitcnt vmcnt(6)
    v_pk_add_f32 v[180:181], v[24:25], v[28:29]
    v_pk_add_f32 v[182:183], v[26:27], v[30:31]
    s_waitcnt vmcnt(4)
    v_pk_add_f32 v[188:189], v[32:33], v[36:37]
    v_pk_add_f32 v[190:191], v[34:35], v[38:39]
    v_pk_add_f32 v[180:181], v[180:181], v[188:189]
    v_pk_add_f32 v[182:183], v[182:183], v[190:191]
    v_pk_add_f32 v[188:189], v[180:181], v[182:183]
    v_max3_f32 v185, v180, v181, v182
    s_waitcnt vmcnt(0)
    v_pk_add_f32 v[192:193], v[40:41], v[42:43]
    v_add_f32 v188, v188, v189
    v_add_f32 v184, v192, v193
    v_max3_f32 v185, v185, v183, v184
    v_cmp_u_f32 vcc, v188, v184
    s_nop 0
    v_max_f32_dpp v185, v185, v185 row_ror:8 row_mask:0xf bank_mask:0xf
    v_mov_b32 v186, v185
    s_nop 1
    v_permlane16_swap_b32 v185, v186
    v_max_f32 v185, v185, v186
    v_mov_b32 v186, v185
    s_cbranch_vccnz sb_37
    s_branch sg_38
g_39L15_0:
    s_waitcnt vmcnt(3)
    v_max3_u32 v19, v24, v25, v26
    v_max_u32 v19, v19, v27
    v_cmp_eq_u32 vcc, -1, v19
    s_nop 0
    s_cbranch_vccnz g_39F15_0
    v_smfmac_f32_16x16x64_bf16 v[64:67], v[24:27], a[192:199], v172
    v_smfmac_f32_16x16x64_bf16 v[68:71], v[24:27], a[224:231], v172
g_39L14_1:
    s_waitcnt vmcnt(2)
    v_max3_u32 v19, v28, v29, v30
    v_max_u32 v19, v19, v31
    v_cmp_eq_u32 vcc, -1, v19
    s_nop 0
    s_cbranch_vccnz g_39F14_1
    v_smfmac_f32_16x16x64_bf16 v[64:67], v[28:31], a[200:207], v172
    v_smfmac_f32_16x16x64_bf16 v[68:71], v[28:31], a[232:239], v172
g_39L12_2:
    s_waitcnt vmcnt(1)
    v_max3_u32 v19, v32, v33, v34
    v_max_u32 v19, v19, v35
    v_cmp_eq_u32 vcc, -1, v19
    s_nop 0
    s_cbranch_vccnz g_39F12_2
    v_smfmac_f32_16x16x64_bf16 v[64:67], v[32:35], a[208:215], v172
    v_smfmac_f32_16x16x64_bf16 v[68:71], v[32:35], a[240:247], v172
g_39L8_3:
    s_waitcnt vmcnt(0)
    v_max3_u32 v19, v36, v37, v38
    v_max_u32 v19, v19, v39
    v_cmp_eq_u32 vcc, -1, v19
    s_nop 0
    s_cbranch_vccnz g_39F8_3
    v_smfmac_f32_16x16x64_bf16 v[64:67], v[36:39], a[216:223], v172
    v_smfmac_f32_16x16x64_bf16 v[68:71], v[36:39], a[248:255], v172
    s_nop 4
    v_cvt_pk_bf16_f32 v80, v64, v65
    v_cvt_pk_bf16_f32 v81, v66, v67
    s_nop 0
    v_cvt_pk_bf16_f32 v82, v68, v69
    v_cvt_pk_bf16_f32 v83, v70, v71
    ds_write_b128 v17, v[80:83] offset:9216
    s_branch gc_40
g_39L15_1:
    s_waitcnt vmcnt(3)
    v_max3_u32 v19, v28, v29, v30
    v_max_u32 v19, v19, v31
    v_cmp_eq_u32 vcc, -1, v19
    s_nop 0
    s_cbranch_vccnz g_39F15_1
    v_smfmac_f32_16x16x64_bf16 v[64:67], v[28:31], a[200:207], v172
    v_smfmac_f32_16x16x64_bf16 v[68:71], v[28:31], a[232:239], v172
g_39L13_2:
    s_waitcnt vmcnt(2)
    v_max3_u32 v19, v32, v33, v34
    v_max_u32 v19, v19, v35
    v_cmp_eq_u32 vcc, -1, v19
    s_nop 0
    s_cbranch_vccnz g_39F13_2
    v_smfmac_f32_16x16x64_bf16 v[64:67], v[32:35], a[208:215], v172
    v_smfmac_f32_16x16x64_bf16 v[68:71], v[32:35], a[240:247], v172
g_39L9_3:
    s_waitcnt vmcnt(1)
    v_max3_u32 v19, v36, v37, v38
    v_max_u32 v19, v19, v39
    v_cmp_eq_u32 vcc, -1, v19
    s_nop 0
    s_cbranch_vccnz g_39F9_3
    v_smfmac_f32_16x16x64_bf16 v[64:67], v[36:39], a[216:223], v172
    v_smfmac_f32_16x16x64_bf16 v[68:71], v[36:39], a[248:255], v172
g_39L1_0:
    s_waitcnt vmcnt(0)
    v_max3_u32 v19, v24, v25, v26
    v_max_u32 v19, v19, v27
    v_cmp_eq_u32 vcc, -1, v19
    s_nop 0
    s_cbranch_vccnz g_39F1_0
    v_smfmac_f32_16x16x64_bf16 v[64:67], v[24:27], a[192:199], v172
    v_smfmac_f32_16x16x64_bf16 v[68:71], v[24:27], a[224:231], v172
    s_nop 4
    v_cvt_pk_bf16_f32 v80, v64, v65
    v_cvt_pk_bf16_f32 v81, v66, v67
    s_nop 0
    v_cvt_pk_bf16_f32 v82, v68, v69
    v_cvt_pk_bf16_f32 v83, v70, v71
    ds_write_b128 v17, v[80:83] offset:9216
    s_branch gc_40
g_39L15_2:
    s_waitcnt vmcnt(3)
    v_max3_u32 v19, v32, v33, v34
    v_max_u32 v19, v19, v35
    v_cmp_eq_u32 vcc, -1, v19
    s_nop 0
    s_cbranch_vccnz g_39F15_2
    v_smfmac_f32_16x16x64_bf16 v[64:67], v[32:35], a[208:215], v172
    v_smfmac_f32_16x16x64_bf16 v[68:71], v[32:35], a[240:247], v172
g_39L11_3:
    s_waitcnt vmcnt(2)
    v_max3_u32 v19, v36, v37, v38
    v_max_u32 v19, v19, v39
    v_cmp_eq_u32 vcc, -1, v19
    s_nop 0
    s_cbranch_vccnz g_39F11_3
    v_smfmac_f32_16x16x64_bf16 v[64:67], v[36:39], a[216:223], v172
    v_smfmac_f32_16x16x64_bf16 v[68:71], v[36:39], a[248:255], v172
g_39L3_0:
    s_waitcnt vmcnt(1)
    v_max3_u32 v19, v24, v25, v26
    v_max_u32 v19, v19, v27
    v_cmp_eq_u32 vcc, -1, v19
    s_nop 0
    s_cbranch_vccnz g_39F3_0
    v_smfmac_f32_16x16x64_bf16 v[64:67], v[24:27], a[192:199], v172
    v_smfmac_f32_16x16x64_bf16 v[68:71], v[24:27], a[224:231], v172
g_39L2_1:
    s_waitcnt vmcnt(0)
    v_max3_u32 v19, v28, v29, v30
    v_max_u32 v19, v19, v31
    v_cmp_eq_u32 vcc, -1, v19
    s_nop 0
    s_cbranch_vccnz g_39F2_1
    v_smfmac_f32_16x16x64_bf16 v[64:67], v[28:31], a[200:207], v172
    v_smfmac_f32_16x16x64_bf16 v[68:71], v[28:31], a[232:239], v172
    s_nop 4
    v_cvt_pk_bf16_f32 v80, v64, v65
    v_cvt_pk_bf16_f32 v81, v66, v67
    s_nop 0
    v_cvt_pk_bf16_f32 v82, v68, v69
    v_cvt_pk_bf16_f32 v83, v70, v71
    ds_write_b128 v17, v[80:83] offset:9216
    s_branch gc_40
g_39L15_3:
    s_waitcnt vmcnt(3)
    v_max3_u32 v19, v36, v37, v38
    v_max_u32 v19, v19, v39
    v_cmp_eq_u32 vcc, -1, v19
    s_nop 0
    s_cbranch_vccnz g_39F15_3
    v_smfmac_f32_16x16x64_bf16 v[64:67], v[36:39], a[216:223], v172
    v_smfmac_f32_16x16x64_bf16 v[68:71], v[36:39], a[248:255], v172
g_39L7_0:
    s_waitcnt vmcnt(2)
    v_max3_u32 v19, v24, v25, v26
    v_max_u32 v19, v19, v27
    v_cmp_eq_u32 vcc, -1, v19
    s_nop 0
    s_cbranch_vccnz g_39F7_0
    v_smfmac_f32_16x16x64_bf16 v[64:67], v[24:27], a[192:199], v172
    v_smfmac_f32_16x16x64_bf16 v[68:71], v[24:27], a[224:231], v172
g_39L6_1:
    s_waitcnt vmcnt(1)
    v_max3_u32 v19, v28, v29, v30
    v_max_u32 v19, v19, v31
    v_cmp_eq_u32 vcc, -1, v19
    s_nop 0
    s_cbranch_vccnz g_39F6_1
    v_smfmac_f32_16x16x64_bf16 v[64:67], v[28:31], a[200:207], v172
    v_smfmac_f32_16x16x64_bf16 v[68:71], v[28:31], a[232:239], v172
g_39L4_2:
    s_waitcnt vmcnt(0)
    v_max3_u32 v19, v32, v33, v34
    v_max_u32 v19, v19, v35
    v_cmp_eq_u32 vcc, -1, v19
    s_nop 0
    s_cbranch_vccnz g_39F4_2
    v_smfmac_f32_16x16x64_bf16 v[64:67], v[32:35], a[208:215], v172
    v_smfmac_f32_16x16x64_bf16 v[68:71], v[32:35], a[240:247], v172
    s_nop 4
    v_cvt_pk_bf16_f32 v80, v64, v65
    v_cvt_pk_bf16_f32 v81, v66, v67
    s_nop 0
    v_cvt_pk_bf16_f32 v82, v68, v69
    v_cvt_pk_bf16_f32 v83, v70, v71
    ds_write_b128 v17, v[80:83] offset:9216
    s_branch gc_40
g_39L7_1:
    s_waitcnt vmcnt(2)
    v_max3_u32 v19, v28, v29, v30
    v_max_u32 v19, v19, v31
    v_cmp_eq_u32 vcc, -1, v19
    s_nop 0
    s_cbranch_vccnz g_39F7_1
    v_smfmac_f32_16x16x64_bf16 v[64:67], v[28:31], a[200:207], v172
    v_smfmac_f32_16x16x64_bf16 v[68:71], v[28:31], a[232:239], v172
g_39L5_2:
    s_waitcnt vmcnt(1)
    v_max3_u32 v19, v32, v33, v34
    v_max_u32 v19, v19, v35
    v_cmp_eq_u32 vcc, -1, v19
    s_nop 0
    s_cbranch_vccnz g_39F5_2
    v_smfmac_f32_16x16x64_bf16 v[64:67], v[32:35], a[208:215], v172
    v_smfmac_f32_16x16x64_bf16 v[68:71], v[32:35], a[240:247], v172
    s_branch g_39L1_0
g_39L7_2:
    s_waitcnt vmcnt(2)
    v_max3_u32 v19, v32, v33, v34
    v_max_u32 v19, v19, v35
    v_cmp_eq_u32 vcc, -1, v19
    s_nop 0
    s_cbranch_vccnz g_39F7_2
    v_smfmac_f32_16x16x64_bf16 v[64:67], v[32:35], a[208:215], v172
    v_smfmac_f32_16x16x64_bf16 v[68:71], v[32:35], a[240:247], v172
    s_branch g_39L3_0
g_39L11_0:
    s_waitcnt vmcnt(2)
    v_max3_u32 v19, v24, v25, v26
    v_max_u32 v19, v19, v27
    v_cmp_eq_u32 vcc, -1, v19
    s_nop 0
    s_cbranch_vccnz g_39F11_0
    v_smfmac_f32_16x16x64_bf16 v[64:67], v[24:27], a[192:199], v172
    v_smfmac_f32_16x16x64_bf16 v[68:71], v[24:27], a[224:231], v172
g_39L10_1:
    s_waitcnt vmcnt(1)
    v_max3_u32 v19, v28, v29, v30
    v_max_u32 v19, v19, v31
    v_cmp_eq_u32 vcc, -1, v19
    s_nop 0
    s_cbranch_vccnz g_39F10_1
    v_smfmac_f32_16x16x64_bf16 v[64:67], v[28:31], a[200:207], v172
    v_smfmac_f32_16x16x64_bf16 v[68:71], v[28:31], a[232:239], v172
    s_branch g_39L8_3
g_39L11_1:
    s_waitcnt vmcnt(2)
    v_max3_u32 v19, v28, v29, v30
    v_max_u32 v19, v19, v31
    v_cmp_eq_u32 vcc, -1, v19
    s_nop 0
    s_cbranch_vccnz g_39F11_1
    v_smfmac_f32_16x16x64_bf16 v[64:67], v[28:31], a[200:207], v172
    v_smfmac_f32_16x16x64_bf16 v[68:71], v[28:31], a[232:239], v172
    s_branch g_39L9_3
g_39L13_0:
    s_waitcnt vmcnt(2)
    v_max3_u32 v19, v24, v25, v26
    v_max_u32 v19, v19, v27
    v_cmp_eq_u32 vcc, -1, v19
    s_nop 0
    s_cbranch_vccnz g_39F13_0
    v_smfmac_f32_16x16x64_bf16 v[64:67], v[24:27], a[192:199], v172
    v_smfmac_f32_16x16x64_bf16 v[68:71], v[24:27], a[224:231], v172
    s_branch g_39L12_2
g_39L13_3:
    s_waitcnt vmcnt(2)
    v_max3_u32 v19, v36, v37, v38
    v_max_u32 v19, v19, v39
    v_cmp_eq_u32 vcc, -1, v19
    s_nop 0
    s_cbranch_vccnz g_39F13_3
    v_smfmac_f32_16x16x64_bf16 v[64:67], v[36:39], a[216:223], v172
    v_smfmac_f32_16x16x64_bf16 v[68:71], v[36:39], a[248:255], v172
g_39L5_0:
    s_waitcnt vmcnt(1)
    v_max3_u32 v19, v24, v25, v26
    v_max_u32 v19, v19, v27
    v_cmp_eq_u32 vcc, -1, v19
    s_nop 0
    s_cbranch_vccnz g_39F5_0
    v_smfmac_f32_16x16x64_bf16 v[64:67], v[24:27], a[192:199], v172
    v_smfmac_f32_16x16x64_bf16 v[68:71], v[24:27], a[224:231], v172
    s_branch g_39L4_2
g_39L14_2:
    s_waitcnt vmcnt(2)
    v_max3_u32 v19, v32, v33, v34
    v_max_u32 v19, v19, v35
    v_cmp_eq_u32 vcc, -1, v19
    s_nop 0
    s_cbranch_vccnz g_39F14_2
    v_smfmac_f32_16x16x64_bf16 v[64:67], v[32:35], a[208:215], v172
    v_smfmac_f32_16x16x64_bf16 v[68:71], v[32:35], a[240:247], v172
g_39L10_3:
    s_waitcnt vmcnt(1)
    v_max3_u32 v19, v36, v37, v38
    v_max_u32 v19, v19, v39
    v_cmp_eq_u32 vcc, -1, v19
    s_nop 0
    s_cbranch_vccnz g_39F10_3
    v_smfmac_f32_16x16x64_bf16 v[64:67], v[36:39], a[216:223], v172
    v_smfmac_f32_16x16x64_bf16 v[68:71], v[36:39], a[248:255], v172
    s_branch g_39L2_1
g_39L14_3:
    s_waitcnt vmcnt(2)
    v_max3_u32 v19, v36, v37, v38
    v_max_u32 v19, v19, v39
    v_cmp_eq_u32 vcc, -1, v19
    s_nop 0
    s_cbranch_vccnz g_39F14_3
    v_smfmac_f32_16x16x64_bf16 v[64:67], v[36:39], a[216:223], v172
    v_smfmac_f32_16x16x64_bf16 v[68:71], v[36:39], a[248:255], v172
    s_branch g_39L6_1
g_39L3_1:
    s_waitcnt vmcnt(1)
    v_max3_u32 v19, v28, v29, v30
    v_max_u32 v19, v19, v31
    v_cmp_eq_u32 vcc, -1, v19
    s_nop 0
    s_cbranch_vccnz g_39F3_1
    v_smfmac_f32_16x16x64_bf16 v[64:67], v[28:31], a[200:207], v172
    v_smfmac_f32_16x16x64_bf16 v[68:71], v[28:31], a[232:239], v172
    s_branch g_39L1_0
g_39L6_2:
    s_waitcnt vmcnt(1)
    v_max3_u32 v19, v32, v33, v34
    v_max_u32 v19, v19, v35
    v_cmp_eq_u32 vcc, -1, v19
    s_nop 0
    s_cbranch_vccnz g_39F6_2
    v_smfmac_f32_16x16x64_bf16 v[64:67], v[32:35], a[208:215], v172
    v_smfmac_f32_16x16x64_bf16 v[68:71], v[32:35], a[240:247], v172
    s_branch g_39L2_1
g_39L9_0:
    s_waitcnt vmcnt(1)
    v_max3_u32 v19, v24, v25, v26
    v_max_u32 v19, v19, v27
    v_cmp_eq_u32 vcc, -1, v19
    s_nop 0
    s_cbranch_vccnz g_39F9_0
    v_smfmac_f32_16x16x64_bf16 v[64:67], v[24:27], a[192:199], v172
    v_smfmac_f32_16x16x64_bf16 v[68:71], v[24:27], a[224:231], v172
    s_branch g_39L8_3
g_39L12_3:
    s_waitcnt vmcnt(1)
    v_max3_u32 v19, v36, v37, v38
    v_max_u32 v19, v19, v39
    v_cmp_eq_u32 vcc, -1, v19
    s_nop 0
    s_cbranch_vccnz g_39F12_3
    v_smfmac_f32_16x16x64_bf16 v[64:67], v[36:39], a[216:223], v172
    v_smfmac_f32_16x16x64_bf16 v[68:71], v[36:39], a[248:255], v172
    s_branch g_39L4_2
g_39F15_0:
    s_mov_b64 exec, vcc
    buffer_load_dwordx4 v[24:27], v8, s[4:7], s16 offen offset:0 sc1
    s_mov_b64 exec, -1
    s_add_u32 s23, s23, 1
    s_cmp_lt_u32 s23, 200000
    s_cbranch_scc1 g_39L15_1
    s_mov_b32 s25, 200000
    s_branch gc_40
g_39F15_1:
    s_mov_b64 exec, vcc
    buffer_load_dwordx4 v[28:31], v8, s[4:7], s16 offen offset:1024 sc1
    s_mov_b64 exec, -1
    s_add_u32 s23, s23, 1
    s_cmp_lt_u32 s23, 200000
    s_cbranch_scc1 g_39L15_2
    s_mov_b32 s25, 200000
    s_branch gc_40
g_39F15_2:
    s_mov_b64 exec, vcc
    buffer_load_dwordx4 v[32:35], v8, s[4:7], s16 offen offset:2048 sc1
    s_mov_b64 exec, -1
    s_add_u32 s23, s23, 1
    s_cmp_lt_u32 s23, 200000
    s_cbranch_scc1 g_39L15_3
    s_mov_b32 s25, 200000
    s_branch gc_40
g_39F15_3:
    s_mov_b64 exec, vcc
    buffer_load_dwordx4 v[36:39], v8, s[4:7], s16 offen offset:3072 sc1
    s_mov_b64 exec, -1
    s_add_u32 s23, s23, 1
    s_cmp_lt_u32 s23, 200000
    s_cbranch_scc1 g_39L15_0
    s_mov_b32 s25, 200000
    s_branch gc_40
g_39F7_0:
    s_mov_b64 exec, vcc
    buffer_load_dwordx4 v[24:27], v8, s[4:7], s16 offen offset:0 sc1
    s_mov_b64 exec, -1
    s_add_u32 s23, s23, 1
    s_cmp_lt_u32 s23, 200000
    s_cbranch_scc1 g_39L7_1
    s_mov_b32 s25, 200000
    s_branch gc_40
g_39F7_1:
    s_mov_b64 exec, vcc
    buffer_load_dwordx4 v[28:31], v8, s[4:7], s16 offen offset:1024 sc1
    s_mov_b64 exec, -1
    s_add_u32 s23, s23, 1
    s_cmp_lt_u32 s23, 200000
    s_cbranch_scc1 g_39L7_2
    s_mov_b32 s25, 200000
    s_branch gc_40
g_39F7_2:
    s_mov_b64 exec, vcc
    buffer_load_dwordx4 v[32:35], v8, s[4:7], s16 offen offset:2048 sc1
    s_mov_b64 exec, -1
    s_add_u32 s23, s23, 1
    s_cmp_lt_u32 s23, 200000
    s_cbranch_scc1 g_39L7_0
    s_mov_b32 s25, 200000
    s_branch gc_40
g_39F11_0:
    s_mov_b64 exec, vcc
    buffer_load_dwordx4 v[24:27], v8, s[4:7], s16 offen offset:0 sc1
    s_mov_b64 exec, -1
    s_add_u32 s23, s23, 1
    s_cmp_lt_u32 s23, 200000
    s_cbranch_scc1 g_39L11_1
    s_mov_b32 s25, 200000
    s_branch gc_40
g_39F11_1:
    s_mov_b64 exec, vcc
    buffer_load_dwordx4 v[28:31], v8, s[4:7], s16 offen offset:1024 sc1
    s_mov_b64 exec, -1
    s_add_u32 s23, s23, 1
    s_cmp_lt_u32 s23, 200000
    s_cbranch_scc1 g_39L11_3
    s_mov_b32 s25, 200000
    s_branch gc_40
g_39F11_3:
    s_mov_b64 exec, vcc
    buffer_load_dwordx4 v[36:39], v8, s[4:7], s16 offen offset:3072 sc1
    s_mov_b64 exec, -1
    s_add_u32 s23, s23, 1
    s_cmp_lt_u32 s23, 200000
    s_cbranch_scc1 g_39L11_0
    s_mov_b32 s25, 200000
    s_branch gc_40
g_39F13_0:
    s_mov_b64 exec, vcc
    buffer_load_dwordx4 v[24:27], v8, s[4:7], s16 offen offset:0 sc1
    s_mov_b64 exec, -1
    s_add_u32 s23, s23, 1
    s_cmp_lt_u32 s23, 200000
    s_cbranch_scc1 g_39L13_2
    s_mov_b32 s25, 200000
    s_branch gc_40
g_39F13_2:
    s_mov_b64 exec, vcc
    buffer_load_dwordx4 v[32:35], v8, s[4:7], s16 offen offset:2048 sc1
    s_mov_b64 exec, -1
    s_add_u32 s23, s23, 1
    s_cmp_lt_u32 s23, 200000
    s_cbranch_scc1 g_39L13_3
    s_mov_b32 s25, 200000
    s_branch gc_40
g_39F13_3:
    s_mov_b64 exec, vcc
    buffer_load_dwordx4 v[36:39], v8, s[4:7], s16 offen offset:3072 sc1
    s_mov_b64 exec, -1
    s_add_u32 s23, s23, 1
    s_cmp_lt_u32 s23, 200000
    s_cbranch_scc1 g_39L13_0
    s_mov_b32 s25, 200000
    s_branch gc_40
g_39F14_1:
    s_mov_b64 exec, vcc
    buffer_load_dwordx4 v[28:31], v8, s[4:7], s16 offen offset:1024 sc1
    s_mov_b64 exec, -1
    s_add_u32 s23, s23, 1
    s_cmp_lt_u32 s23, 200000
    s_cbranch_scc1 g_39L14_2
    s_mov_b32 s25, 200000
    s_branch gc_40
g_39F14_2:
    s_mov_b64 exec, vcc
    buffer_load_dwordx4 v[32:35], v8, s[4:7], s16 offen offset:2048 sc1
    s_mov_b64 exec, -1
    s_add_u32 s23, s23, 1
    s_cmp_lt_u32 s23, 200000
    s_cbranch_scc1 g_39L14_3
    s_mov_b32 s25, 200000
    s_branch gc_40
g_39F14_3:
    s_mov_b64 exec, vcc
    buffer_load_dwordx4 v[36:39], v8, s[4:7], s16 offen offset:3072 sc1
    s_mov_b64 exec, -1
    s_add_u32 s23, s23, 1
    s_cmp_lt_u32 s23, 200000
    s_cbranch_scc1 g_39L14_1
    s_mov_b32 s25, 200000
    s_branch gc_40
g_39F3_0:
    s_mov_b64 exec, vcc
    buffer_load_dwordx4 v[24:27], v8, s[4:7], s16 offen offset:0 sc1
    s_mov_b64 exec, -1
    s_add_u32 s23, s23, 1
    s_cmp_lt_u32 s23, 200000
    s_cbranch_scc1 g_39L3_1
    s_mov_b32 s25, 200000
    s_branch gc_40
g_39F3_1:
    s_mov_b64 exec, vcc
    buffer_load_dwordx4 v[28:31], v8, s[4:7], s16 offen offset:1024 sc1
    s_mov_b64 exec, -1
    s_add_u32 s23, s23, 1
    s_cmp_lt_u32 s23, 200000
    s_cbranch_scc1 g_39L3_0
    s_mov_b32 s25, 200000
    s_branch gc_40
g_39F5_0:
    s_mov_b64 exec, vcc
    buffer_load_dwordx4 v[24:27], v8, s[4:7], s16 offen offset:0 sc1
    s_mov_b64 exec, -1
    s_add_u32 s23, s23, 1
    s_cmp_lt_u32 s23, 200000
    s_cbranch_scc1 g_39L5_2
    s_mov_b32 s25, 200000
    s_branch gc_40
g_39F5_2:
    s_mov_b64 exec, vcc
    buffer_load_dwordx4 v[32:35], v8, s[4:7], s16 offen offset:2048 sc1
    s_mov_b64 exec, -1
    s_add_u32 s23, s23, 1
    s_cmp_lt_u32 s23, 200000
    s_cbranch_scc1 g_39L5_0
    s_mov_b32 s25, 200000
    s_branch gc_40
g_39F6_1:
    s_mov_b64 exec, vcc
    buffer_load_dwordx4 v[28:31], v8, s[4:7], s16 offen offset:1024 sc1
    s_mov_b64 exec, -1
    s_add_u32 s23, s23, 1
    s_cmp_lt_u32 s23, 200000
    s_cbranch_scc1 g_39L6_2
    s_mov_b32 s25, 200000
    s_branch gc_40
g_39F6_2:
    s_mov_b64 exec, vcc
    buffer_load_dwordx4 v[32:35], v8, s[4:7], s16 offen offset:2048 sc1
    s_mov_b64 exec, -1
    s_add_u32 s23, s23, 1
    s_cmp_lt_u32 s23, 200000
    s_cbranch_scc1 g_39L6_1
    s_mov_b32 s25, 200000
    s_branch gc_40
g_39F9_0:
    s_mov_b64 exec, vcc
    buffer_load_dwordx4 v[24:27], v8, s[4:7], s16 offen offset:0 sc1
    s_mov_b64 exec, -1
    s_add_u32 s23, s23, 1
    s_cmp_lt_u32 s23, 200000
    s_cbranch_scc1 g_39L9_3
    s_mov_b32 s25, 200000
    s_branch gc_40
g_39F9_3:
    s_mov_b64 exec, vcc
    buffer_load_dwordx4 v[36:39], v8, s[4:7], s16 offen offset:3072 sc1
    s_mov_b64 exec, -1
    s_add_u32 s23, s23, 1
    s_cmp_lt_u32 s23, 200000
    s_cbranch_scc1 g_39L9_0
    s_mov_b32 s25, 200000
    s_branch gc_40
g_39F10_1:
    s_mov_b64 exec, vcc
    buffer_load_dwordx4 v[28:31], v8, s[4:7], s16 offen offset:1024 sc1
    s_mov_b64 exec, -1
    s_add_u32 s23, s23, 1
    s_cmp_lt_u32 s23, 200000
    s_cbranch_scc1 g_39L10_3
    s_mov_b32 s25, 200000
    s_branch gc_40
g_39F10_3:
    s_mov_b64 exec, vcc
    buffer_load_dwordx4 v[36:39], v8, s[4:7], s16 offen offset:3072 sc1
    s_mov_b64 exec, -1
    s_add_u32 s23, s23, 1
    s_cmp_lt_u32 s23, 200000
    s_cbranch_scc1 g_39L10_1
    s_mov_b32 s25, 200000
    s_branch gc_40
g_39F12_2:
    s_mov_b64 exec, vcc
    buffer_load_dwordx4 v[32:35], v8, s[4:7], s16 offen offset:2048 sc1
    s_mov_b64 exec, -1
    s_add_u32 s23, s23, 1
    s_cmp_lt_u32 s23, 200000
    s_cbranch_scc1 g_39L12_3
    s_mov_b32 s25, 200000
    s_branch gc_40
g_39F12_3:
    s_mov_b64 exec, vcc
    buffer_load_dwordx4 v[36:39], v8, s[4:7], s16 offen offset:3072 sc1
    s_mov_b64 exec, -1
    s_add_u32 s23, s23, 1
    s_cmp_lt_u32 s23, 200000
    s_cbranch_scc1 g_39L12_2
    s_mov_b32 s25, 200000
    s_branch gc_40
g_39F1_0:
    s_mov_b64 exec, vcc
    buffer_load_dwordx4 v[24:27], v8, s[4:7], s16 offen offset:0 sc1
    s_mov_b64 exec, -1
    s_add_u32 s23, s23, 1
    s_cmp_lt_u32 s23, 200000
    s_cbranch_scc1 g_39L1_0
    s_mov_b32 s25, 200000
    s_branch gc_40
g_39F2_1:
    s_mov_b64 exec, vcc
    buffer_load_dwordx4 v[28:31], v8, s[4:7], s16 offen offset:1024 sc1
    s_mov_b64 exec, -1
    s_add_u32 s23, s23, 1
    s_cmp_lt_u32 s23, 200000
    s_cbranch_scc1 g_39L2_1
    s_mov_b32 s25, 200000
    s_branch gc_40
g_39F4_2:
    s_mov_b64 exec, vcc
    buffer_load_dwordx4 v[32:35], v8, s[4:7], s16 offen offset:2048 sc1
    s_mov_b64 exec, -1
    s_add_u32 s23, s23, 1
    s_cmp_lt_u32 s23, 200000
    s_cbranch_scc1 g_39L4_2
    s_mov_b32 s25, 200000
    s_branch gc_40
g_39F8_3:
    s_mov_b64 exec, vcc
    buffer_load_dwordx4 v[36:39], v8, s[4:7], s16 offen offset:3072 sc1
    s_mov_b64 exec, -1
    s_add_u32 s23, s23, 1
    s_cmp_lt_u32 s23, 200000
    s_cbranch_scc1 g_39L8_3
    s_mov_b32 s25, 200000
    s_branch gc_40
.p2align 6
recur_fast_w2:
    s_nop 15
    s_mov_b32 s23, s25
    buffer_load_dwordx4 v[24:27], v2, s[4:7], s16 offen offset:0 sc1
    s_nop 11
    buffer_load_dwordx4 v[28:31], v2, s[4:7], s16 offen offset:1024 sc1
    s_nop 11
    buffer_load_dwordx4 v[32:35], v2, s[4:7], s16 offen offset:2048 sc1
    s_nop 11
    buffer_load_dwordx4 v[36:39], v2, s[4:7], s16 offen offset:3072 sc1
    s_waitcnt vmcnt(3)
    v_max3_u32 v19, v24, v25, v26
    v_max_u32 v19, v19, v27
    v_cmp_eq_u32 vcc, -1, v19
    s_nop 0
    s_cbranch_vccnz g_43F15_0
    v_smfmac_f32_16x16x64_bf16 v[40:43], v[24:27], a[0:7], v172
    s_waitcnt vmcnt(2)
    v_max3_u32 v19, v28, v29, v30
    v_max_u32 v19, v19, v31
    v_smfmac_f32_16x16x64_bf16 v[44:47], v[24:27], a[64:71], v172
    v_cmp_eq_u32 vcc, -1, v19
    v_smfmac_f32_16x16x64_bf16 v[48:51], v[24:27], a[32:39], v172
    v_smfmac_f32_16x16x64_bf16 v[52:55], v[24:27], a[96:103], v172
    s_cbranch_vccnz g_43F14_1
    v_smfmac_f32_16x16x64_bf16 v[40:43], v[28:31], a[8:15], v172
    s_waitcnt vmcnt(1)
    v_max3_u32 v19, v32, v33, v34
    v_max_u32 v19, v19, v35
    v_smfmac_f32_16x16x64_bf16 v[44:47], v[28:31], a[72:79], v172
    v_cmp_eq_u32 vcc, -1, v19
    v_smfmac_f32_16x16x64_bf16 v[48:51], v[28:31], a[40:47], v172
    v_smfmac_f32_16x16x64_bf16 v[52:55], v[28:31], a[104:111], v172
    s_cbranch_vccnz g_43F12_2
    v_smfmac_f32_16x16x64_bf16 v[40:43], v[32:35], a[16:23], v172
    s_waitcnt vmcnt(0)
    v_max3_u32 v19, v36, v37, v38
    v_max_u32 v19, v19, v39
    v_smfmac_f32_16x16x64_bf16 v[44:47], v[32:35], a[80:87], v172
    v_cmp_eq_u32 vcc, -1, v19
    v_smfmac_f32_16x16x64_bf16 v[48:51], v[32:35], a[48:55], v172
    v_smfmac_f32_16x16x64_bf16 v[52:55], v[32:35], a[112:119], v172
    s_cbranch_vccnz g_43F8_3
    v_smfmac_f32_16x16x64_bf16 v[40:43], v[36:39], a[24:31], v172
    v_smfmac_f32_16x16x64_bf16 v[44:47], v[36:39], a[88:95], v172
    v_smfmac_f32_16x16x64_bf16 v[48:51], v[36:39], a[56:63], v172
    v_smfmac_f32_16x16x64_bf16 v[52:55], v[36:39], a[120:127], v172
gc_44:
    v_cvt_pk_bf16_f32 v72, v40, v41
    v_cvt_pk_bf16_f32 v73, v42, v43
    v_cvt_pk_bf16_f32 v74, v44, v45
    v_cvt_pk_bf16_f32 v75, v46, v47
    ds_write_b128 v17, v[72:75] offset:0
    v_cvt_pk_bf16_f32 v76, v48, v49
    v_cvt_pk_bf16_f32 v77, v50, v51
    s_nop 0
    v_cvt_pk_bf16_f32 v78, v52, v53
    v_cvt_pk_bf16_f32 v79, v54, v55
    ds_write_b128 v17, v[76:79] offset:1024
    v_smfmac_f32_16x16x64_bf16 v[56:59], v[24:27], a[128:135], v172
    v_smfmac_f32_16x16x64_bf16 v[60:63], v[24:27], a[160:167], v172
    v_smfmac_f32_16x16x64_bf16 v[56:59], v[28:31], a[136:143], v172
    s_waitcnt lgkmcnt(0)
    s_barrier
    v_smfmac_f32_16x16x64_bf16 v[60:63], v[28:31], a[168:175], v172
    v_smfmac_f32_16x16x64_bf16 v[56:59], v[32:35], a[144:151], v172
    v_smfmac_f32_16x16x64_bf16 v[60:63], v[32:35], a[176:183], v172
    v_smfmac_f32_16x16x64_bf16 v[56:59], v[36:39], a[152:159], v172
    v_smfmac_f32_16x16x64_bf16 v[60:63], v[36:39], a[184:191], v172
    s_nop 4
    v_cvt_pk_bf16_f32 v80, v56, v57
    v_cvt_pk_bf16_f32 v81, v58, v59
    s_nop 0
    v_cvt_pk_bf16_f32 v82, v60, v61
    v_cvt_pk_bf16_f32 v83, v62, v63
    ds_write_b128 v17, v[80:83] offset:8192
    s_cmp_eq_u32 s15, 63
    s_waitcnt lgkmcnt(0)
    s_barrier
    ds_read_b128 v[96:99], v16 offset:8192
    ds_read_b128 v[100:103], v16 offset:10240
    ds_read_b128 v[108:111], v16 offset:14336
    v_mfma_f32_16x16x32_bf16 v[140:143], v[84:87], v[80:83], 0
    s_waitcnt lgkmcnt(2)
    v_mfma_f32_16x16x32_bf16 v[140:143], v[84:87], v[96:99], v[140:143]
    s_waitcnt lgkmcnt(1)
    v_mfma_f32_16x16x32_bf16 v[140:143], v[84:87], v[100:103], v[140:143]
    s_waitcnt lgkmcnt(0)
    v_mfma_f32_16x16x32_bf16 v[140:143], v[84:87], v[108:111], v[140:143]
    s_nop 7
    v_cvt_pk_bf16_f32 v168, v140, v141
    v_cvt_pk_bf16_f32 v169, v142, v143
    v_mov_b32 v170, v168
    v_mov_b32 v171, v169
    s_nop 0
    v_permlane16_swap_b32 v168, v170
    v_permlane16_swap_b32 v169, v171
    v_mov_b32 v247, s15
    s_cbranch_scc1 recur_fast_last2
    s_barrier
    s_nop 15
    s_mov_b32 s23, s25
    buffer_load_dwordx4 v[24:27], v8, s[4:7], s16 offen offset:0 sc1
    s_nop 11
    buffer_load_dwordx4 v[28:31], v8, s[4:7], s16 offen offset:1024 sc1
    s_nop 11
    buffer_load_dwordx4 v[32:35], v8, s[4:7], s16 offen offset:2048 sc1
    s_nop 11
    buffer_load_dwordx4 v[36:39], v8, s[4:7], s16 offen offset:3072 sc1
    s_waitcnt vmcnt(3)
    v_max3_u32 v19, v24, v25, v26
    v_max_u32 v19, v19, v27
    v_cmp_eq_u32 vcc, -1, v19
    s_nop 0
    s_cbranch_vccnz g_45F15_0
    v_smfmac_f32_16x16x64_bf16 v[64:67], v[24:27], a[192:199], v172
    v_smfmac_f32_16x16x64_bf16 v[68:71], v[24:27], a[224:231], v172
    s_waitcnt vmcnt(2)
    v_max3_u32 v19, v28, v29, v30
    v_max_u32 v19, v19, v31
    v_cmp_eq_u32 vcc, -1, v19
    s_nop 0
    s_cbranch_vccnz g_45F14_1
    v_smfmac_f32_16x16x64_bf16 v[64:67], v[28:31], a[200:207], v172
    v_smfmac_f32_16x16x64_bf16 v[68:71], v[28:31], a[232:239], v172
    s_waitcnt vmcnt(1)
    v_max3_u32 v19, v32, v33, v34
    v_max_u32 v19, v19, v35
    v_cmp_eq_u32 vcc, -1, v19
    s_nop 0
    s_cbranch_vccnz g_45F12_2
    v_smfmac_f32_16x16x64_bf16 v[64:67], v[32:35], a[208:215], v172
    v_smfmac_f32_16x16x64_bf16 v[68:71], v[32:35], a[240:247], v172
    s_waitcnt vmcnt(0)
    v_max3_u32 v19, v36, v37, v38
    v_max_u32 v19, v19, v39
    v_cmp_eq_u32 vcc, -1, v19
    s_nop 0
    s_cbranch_vccnz g_45F8_3
    v_smfmac_f32_16x16x64_bf16 v[64:67], v[36:39], a[216:223], v172
    v_smfmac_f32_16x16x64_bf16 v[68:71], v[36:39], a[248:255], v172
    s_nop 4
    v_cvt_pk_bf16_f32 v80, v64, v65
    v_cvt_pk_bf16_f32 v81, v66, v67
    s_nop 0
    v_cvt_pk_bf16_f32 v82, v68, v69
    v_cvt_pk_bf16_f32 v83, v70, v71
    ds_write_b128 v17, v[80:83] offset:9216
gc_46:
    s_waitcnt lgkmcnt(0)
    s_barrier
    s_nop 15
    s_nop 15
    s_nop 15
    s_nop 15
    buffer_store_dwordx4 v[168:171], v15, s[4:7], s20 offen sc1
    s_add_u32 s20, s20, 512
    s_add_u32 s21, s95, 1048576
    s_lshr_b32 s22, s21, 8
    s_and_b32 s22, s22, 8192
    s_xor_b32 s22, s22, s46
    s_add_u32 s21, s21, s22
    buffer_store_dwordx4 v[204:207], v9, s[4:7], s21 offen sc1
    s_add_u32 s21, s21, 262144
    buffer_store_dword v247, v246, s[4:7], 0 offen sc1
    v_mov_b32 v40, 0
    v_mov_b32 v41, 0
    v_mov_b32 v42, 0
    v_mov_b32 v43, 0
    v_mov_b32 v44, 0
    v_mov_b32 v45, 0
    v_mov_b32 v46, 0
    v_mov_b32 v47, 0
    v_mov_b32 v48, 0
    v_mov_b32 v49, 0
    v_mov_b32 v50, 0
    v_mov_b32 v51, 0
    v_mov_b32 v52, 0
    v_mov_b32 v53, 0
    v_mov_b32 v54, 0
    v_mov_b32 v55, 0
    v_mov_b32 v56, 0
    v_mov_b32 v57, 0
    v_mov_b32 v58, 0
    v_mov_b32 v59, 0
    v_mov_b32 v60, 0
    v_mov_b32 v61, 0
    v_mov_b32 v62, 0
    v_mov_b32 v63, 0
    v_mov_b32 v64, 0
    v_mov_b32 v65, 0
    v_mov_b32 v66, 0
    v_mov_b32 v67, 0
    v_mov_b32 v68, 0
    v_mov_b32 v69, 0
    v_mov_b32 v70, 0
    v_mov_b32 v71, 0
    s_mov_b32 s21, s16
    s_mov_b32 s16, s42
    s_mov_b32 s42, s43
    s_mov_b32 s43, s44
    s_mov_b32 s44, s21
    s_add_u32 s95, s95, 524288
    s_lshr_b32 s84, s95, 8
    s_and_b32 s84, s84, 8192
    s_xor_b32 s84, s84, s46
    s_add_u32 s84, s84, s95
    s_add_u32 s15, s15, 1
    s_barrier
    s_branch recur_fast_w2
g_43L15_0:
    s_waitcnt vmcnt(3)
    v_max3_u32 v19, v24, v25, v26
    v_max_u32 v19, v19, v27
    v_cmp_eq_u32 vcc, -1, v19
    s_nop 0
    s_cbranch_vccnz g_43F15_0
    v_smfmac_f32_16x16x64_bf16 v[40:43], v[24:27], a[0:7], v172
    v_smfmac_f32_16x16x64_bf16 v[44:47], v[24:27], a[64:71], v172
    v_smfmac_f32_16x16x64_bf16 v[48:51], v[24:27], a[32:39], v172
    v_smfmac_f32_16x16x64_bf16 v[52:55], v[24:27], a[96:103], v172
g_43L14_1:
    s_waitcnt vmcnt(2)
    v_max3_u32 v19, v28, v29, v30
    v_max_u32 v19, v19, v31
    v_cmp_eq_u32 vcc, -1, v19
    s_nop 0
    s_cbranch_vccnz g_43F14_1
    v_smfmac_f32_16x16x64_bf16 v[40:43], v[28:31], a[8:15], v172
    v_smfmac_f32_16x16x64_bf16 v[44:47], v[28:31], a[72:79], v172
    v_smfmac_f32_16x16x64_bf16 v[48:51], v[28:31], a[40:47], v172
    v_smfmac_f32_16x16x64_bf16 v[52:55], v[28:31], a[104:111], v172
g_43L12_2:
    s_waitcnt vmcnt(1)
    v_max3_u32 v19, v32, v33, v34
    v_max_u32 v19, v19, v35
    v_cmp_eq_u32 vcc, -1, v19
    s_nop 0
    s_cbranch_vccnz g_43F12_2
    v_smfmac_f32_16x16x64_bf16 v[40:43], v[32:35], a[16:23], v172
    v_smfmac_f32_16x16x64_bf16 v[44:47], v[32:35], a[80:87], v172
    v_smfmac_f32_16x16x64_bf16 v[48:51], v[32:35], a[48:55], v172
    v_smfmac_f32_16x16x64_bf16 v[52:55], v[32:35], a[112:119], v172
g_43L8_3:
    s_waitcnt vmcnt(0)
    v_max3_u32 v19, v36, v37, v38
    v_max_u32 v19, v19, v39
    v_cmp_eq_u32 vcc, -1, v19
    s_nop 0
    s_cbranch_vccnz g_43F8_3
    v_smfmac_f32_16x16x64_bf16 v[40:43], v[36:39], a[24:31], v172
    v_smfmac_f32_16x16x64_bf16 v[44:47], v[36:39], a[88:95], v172
    v_smfmac_f32_16x16x64_bf16 v[48:51], v[36:39], a[56:63], v172
    v_smfmac_f32_16x16x64_bf16 v[52:55], v[36:39], a[120:127], v172
    s_branch gc_44
g_43L15_1:
    s_waitcnt vmcnt(3)
    v_max3_u32 v19, v28, v29, v30
    v_max_u32 v19, v19, v31
    v_cmp_eq_u32 vcc, -1, v19
    s_nop 0
    s_cbranch_vccnz g_43F15_1
    v_smfmac_f32_16x16x64_bf16 v[40:43], v[28:31], a[8:15], v172
    v_smfmac_f32_16x16x64_bf16 v[44:47], v[28:31], a[72:79], v172
    v_smfmac_f32_16x16x64_bf16 v[48:51], v[28:31], a[40:47], v172
    v_smfmac_f32_16x16x64_bf16 v[52:55], v[28:31], a[104:111], v172
g_43L13_2:
    s_waitcnt vmcnt(2)
    v_max3_u32 v19, v32, v33, v34
    v_max_u32 v19, v19, v35
    v_cmp_eq_u32 vcc, -1, v19
    s_nop 0
    s_cbranch_vccnz g_43F13_2
    v_smfmac_f32_16x16x64_bf16 v[40:43], v[32:35], a[16:23], v172
    v_smfmac_f32_16x16x64_bf16 v[44:47], v[32:35], a[80:87], v172
    v_smfmac_f32_16x16x64_bf16 v[48:51], v[32:35], a[48:55], v172
    v_smfmac_f32_16x16x64_bf16 v[52:55], v[32:35], a[112:119], v172
g_43L9_3:
    s_waitcnt vmcnt(1)
    v_max3_u32 v19, v36, v37, v38
    v_max_u32 v19, v19, v39
    v_cmp_eq_u32 vcc, -1, v19
    s_nop 0
    s_cbranch_vccnz g_43F9_3
    v_smfmac_f32_16x16x64_bf16 v[40:43], v[36:39], a[24:31], v172
    v_smfmac_f32_16x16x64_bf16 v[44:47], v[36:39], a[88:95], v172
    v_smfmac_f32_16x16x64_bf16 v[48:51], v[36:39], a[56:63], v172
    v_smfmac_f32_16x16x64_bf16 v[52:55], v[36:39], a[120:127], v172
g_43L1_0:
    s_waitcnt vmcnt(0)
    v_max3_u32 v19, v24, v25, v26
    v_max_u32 v19, v19, v27
    v_cmp_eq_u32 vcc, -1, v19
    s_nop 0
    s_cbranch_vccnz g_43F1_0
    v_smfmac_f32_16x16x64_bf16 v[40:43], v[24:27], a[0:7], v172
    v_smfmac_f32_16x16x64_bf16 v[44:47], v[24:27], a[64:71], v172
    v_smfmac_f32_16x16x64_bf16 v[48:51], v[24:27], a[32:39], v172
    v_smfmac_f32_16x16x64_bf16 v[52:55], v[24:27], a[96:103], v172
    s_branch gc_44
g_43L15_2:
    s_waitcnt vmcnt(3)
    v_max3_u32 v19, v32, v33, v34
    v_max_u32 v19, v19, v35
    v_cmp_eq_u32 vcc, -1, v19
    s_nop 0
    s_cbranch_vccnz g_43F15_2
    v_smfmac_f32_16x16x64_bf16 v[40:43], v[32:35], a[16:23], v172
    v_smfmac_f32_16x16x64_bf16 v[44:47], v[32:35], a[80:87], v172
    v_smfmac_f32_16x16x64_bf16 v[48:51], v[32:35], a[48:55], v172
    v_smfmac_f32_16x16x64_bf16 v[52:55], v[32:35], a[112:119], v172
g_43L11_3:
    s_waitcnt vmcnt(2)
    v_max3_u32 v19, v36, v37, v38
    v_max_u32 v19, v19, v39
    v_cmp_eq_u32 vcc, -1, v19
    s_nop 0
    s_cbranch_vccnz g_43F11_3
    v_smfmac_f32_16x16x64_bf16 v[40:43], v[36:39], a[24:31], v172
    v_smfmac_f32_16x16x64_bf16 v[44:47], v[36:39], a[88:95], v172
    v_smfmac_f32_16x16x64_bf16 v[48:51], v[36:39], a[56:63], v172
    v_smfmac_f32_16x16x64_bf16 v[52:55], v[36:39], a[120:127], v172
g_43L3_0:
    s_waitcnt vmcnt(1)
    v_max3_u32 v19, v24, v25, v26
    v_max_u32 v19, v19, v27
    v_cmp_eq_u32 vcc, -1, v19
    s_nop 0
    s_cbranch_vccnz g_43F3_0
    v_smfmac_f32_16x16x64_bf16 v[40:43], v[24:27], a[0:7], v172
    v_smfmac_f32_16x16x64_bf16 v[44:47], v[24:27], a[64:71], v172
    v_smfmac_f32_16x16x64_bf16 v[48:51], v[24:27], a[32:39], v172
    v_smfmac_f32_16x16x64_bf16 v[52:55], v[24:27], a[96:103], v172
g_43L2_1:
    s_waitcnt vmcnt(0)
    v_max3_u32 v19, v28, v29, v30
    v_max_u32 v19, v19, v31
    v_cmp_eq_u32 vcc, -1, v19
    s_nop 0
    s_cbranch_vccnz g_43F2_1
    v_smfmac_f32_16x16x64_bf16 v[40:43], v[28:31], a[8:15], v172
    v_smfmac_f32_16x16x64_bf16 v[44:47], v[28:31], a[72:79], v172
    v_smfmac_f32_16x16x64_bf16 v[48:51], v[28:31], a[40:47], v172
    v_smfmac_f32_16x16x64_bf16 v[52:55], v[28:31], a[104:111], v172
    s_branch gc_44
g_43L15_3:
    s_waitcnt vmcnt(3)
    v_max3_u32 v19, v36, v37, v38
    v_max_u32 v19, v19, v39
    v_cmp_eq_u32 vcc, -1, v19
    s_nop 0
    s_cbranch_vccnz g_43F15_3
    v_smfmac_f32_16x16x64_bf16 v[40:43], v[36:39], a[24:31], v172
    v_smfmac_f32_16x16x64_bf16 v[44:47], v[36:39], a[88:95], v172
    v_smfmac_f32_16x16x64_bf16 v[48:51], v[36:39], a[56:63], v172
    v_smfmac_f32_16x16x64_bf16 v[52:55], v[36:39], a[120:127], v172
g_43L7_0:
    s_waitcnt vmcnt(2)
    v_max3_u32 v19, v24, v25, v26
    v_max_u32 v19, v19, v27
    v_cmp_eq_u32 vcc, -1, v19
    s_nop 0
    s_cbranch_vccnz g_43F7_0
    v_smfmac_f32_16x16x64_bf16 v[40:43], v[24:27], a[0:7], v172
    v_smfmac_f32_16x16x64_bf16 v[44:47], v[24:27], a[64:71], v172
    v_smfmac_f32_16x16x64_bf16 v[48:51], v[24:27], a[32:39], v172
    v_smfmac_f32_16x16x64_bf16 v[52:55], v[24:27], a[96:103], v172
g_43L6_1:
    s_waitcnt vmcnt(1)
    v_max3_u32 v19, v28, v29, v30
    v_max_u32 v19, v19, v31
    v_cmp_eq_u32 vcc, -1, v19
    s_nop 0
    s_cbranch_vccnz g_43F6_1
    v_smfmac_f32_16x16x64_bf16 v[40:43], v[28:31], a[8:15], v172
    v_smfmac_f32_16x16x64_bf16 v[44:47], v[28:31], a[72:79], v172
    v_smfmac_f32_16x16x64_bf16 v[48:51], v[28:31], a[40:47], v172
    v_smfmac_f32_16x16x64_bf16 v[52:55], v[28:31], a[104:111], v172
g_43L4_2:
    s_waitcnt vmcnt(0)
    v_max3_u32 v19, v32, v33, v34
    v_max_u32 v19, v19, v35
    v_cmp_eq_u32 vcc, -1, v19
    s_nop 0
    s_cbranch_vccnz g_43F4_2
    v_smfmac_f32_16x16x64_bf16 v[40:43], v[32:35], a[16:23], v172
    v_smfmac_f32_16x16x64_bf16 v[44:47], v[32:35], a[80:87], v172
    v_smfmac_f32_16x16x64_bf16 v[48:51], v[32:35], a[48:55], v172
    v_smfmac_f32_16x16x64_bf16 v[52:55], v[32:35], a[112:119], v172
    s_branch gc_44
g_43L7_1:
    s_waitcnt vmcnt(2)
    v_max3_u32 v19, v28, v29, v30
    v_max_u32 v19, v19, v31
    v_cmp_eq_u32 vcc, -1, v19
    s_nop 0
    s_cbranch_vccnz g_43F7_1
    v_smfmac_f32_16x16x64_bf16 v[40:43], v[28:31], a[8:15], v172
    v_smfmac_f32_16x16x64_bf16 v[44:47], v[28:31], a[72:79], v172
    v_smfmac_f32_16x16x64_bf16 v[48:51], v[28:31], a[40:47], v172
    v_smfmac_f32_16x16x64_bf16 v[52:55], v[28:31], a[104:111], v172
g_43L5_2:
    s_waitcnt vmcnt(1)
    v_max3_u32 v19, v32, v33, v34
    v_max_u32 v19, v19, v35
    v_cmp_eq_u32 vcc, -1, v19
    s_nop 0
    s_cbranch_vccnz g_43F5_2
    v_smfmac_f32_16x16x64_bf16 v[40:43], v[32:35], a[16:23], v172
    v_smfmac_f32_16x16x64_bf16 v[44:47], v[32:35], a[80:87], v172
    v_smfmac_f32_16x16x64_bf16 v[48:51], v[32:35], a[48:55], v172
    v_smfmac_f32_16x16x64_bf16 v[52:55], v[32:35], a[112:119], v172
    s_branch g_43L1_0
g_43L7_2:
    s_waitcnt vmcnt(2)
    v_max3_u32 v19, v32, v33, v34
    v_max_u32 v19, v19, v35
    v_cmp_eq_u32 vcc, -1, v19
    s_nop 0
    s_cbranch_vccnz g_43F7_2
    v_smfmac_f32_16x16x64_bf16 v[40:43], v[32:35], a[16:23], v172
    v_smfmac_f32_16x16x64_bf16 v[44:47], v[32:35], a[80:87], v172
    v_smfmac_f32_16x16x64_bf16 v[48:51], v[32:35], a[48:55], v172
    v_smfmac_f32_16x16x64_bf16 v[52:55], v[32:35], a[112:119], v172
    s_branch g_43L3_0
g_43L11_0:
    s_waitcnt vmcnt(2)
    v_max3_u32 v19, v24, v25, v26
    v_max_u32 v19, v19, v27
    v_cmp_eq_u32 vcc, -1, v19
    s_nop 0
    s_cbranch_vccnz g_43F11_0
    v_smfmac_f32_16x16x64_bf16 v[40:43], v[24:27], a[0:7], v172
    v_smfmac_f32_16x16x64_bf16 v[44:47], v[24:27], a[64:71], v172
    v_smfmac_f32_16x16x64_bf16 v[48:51], v[24:27], a[32:39], v172
    v_smfmac_f32_16x16x64_bf16 v[52:55], v[24:27], a[96:103], v172
g_43L10_1:
    s_waitcnt vmcnt(1)
    v_max3_u32 v19, v28, v29, v30
    v_max_u32 v19, v19, v31
    v_cmp_eq_u32 vcc, -1, v19
    s_nop 0
    s_cbranch_vccnz g_43F10_1
    v_smfmac_f32_16x16x64_bf16 v[40:43], v[28:31], a[8:15], v172
    v_smfmac_f32_16x16x64_bf16 v[44:47], v[28:31], a[72:79], v172
    v_smfmac_f32_16x16x64_bf16 v[48:51], v[28:31], a[40:47], v172
    v_smfmac_f32_16x16x64_bf16 v[52:55], v[28:31], a[104:111], v172
    s_branch g_43L8_3
g_43L11_1:
    s_waitcnt vmcnt(2)
    v_max3_u32 v19, v28, v29, v30
    v_max_u32 v19, v19, v31
    v_cmp_eq_u32 vcc, -1, v19
    s_nop 0
    s_cbranch_vccnz g_43F11_1
    v_smfmac_f32_16x16x64_bf16 v[40:43], v[28:31], a[8:15], v172
    v_smfmac_f32_16x16x64_bf16 v[44:47], v[28:31], a[72:79], v172
    v_smfmac_f32_16x16x64_bf16 v[48:51], v[28:31], a[40:47], v172
    v_smfmac_f32_16x16x64_bf16 v[52:55], v[28:31], a[104:111], v172
    s_branch g_43L9_3
g_43L13_0:
    s_waitcnt vmcnt(2)
    v_max3_u32 v19, v24, v25, v26
    v_max_u32 v19, v19, v27
    v_cmp_eq_u32 vcc, -1, v19
    s_nop 0
    s_cbranch_vccnz g_43F13_0
    v_smfmac_f32_16x16x64_bf16 v[40:43], v[24:27], a[0:7], v172
    v_smfmac_f32_16x16x64_bf16 v[44:47], v[24:27], a[64:71], v172
    v_smfmac_f32_16x16x64_bf16 v[48:51], v[24:27], a[32:39], v172
    v_smfmac_f32_16x16x64_bf16 v[52:55], v[24:27], a[96:103], v172
    s_branch g_43L12_2
g_43L13_3:
    s_waitcnt vmcnt(2)
    v_max3_u32 v19, v36, v37, v38
    v_max_u32 v19, v19, v39
    v_cmp_eq_u32 vcc, -1, v19
    s_nop 0
    s_cbranch_vccnz g_43F13_3
    v_smfmac_f32_16x16x64_bf16 v[40:43], v[36:39], a[24:31], v172
    v_smfmac_f32_16x16x64_bf16 v[44:47], v[36:39], a[88:95], v172
    v_smfmac_f32_16x16x64_bf16 v[48:51], v[36:39], a[56:63], v172
    v_smfmac_f32_16x16x64_bf16 v[52:55], v[36:39], a[120:127], v172
g_43L5_0:
    s_waitcnt vmcnt(1)
    v_max3_u32 v19, v24, v25, v26
    v_max_u32 v19, v19, v27
    v_cmp_eq_u32 vcc, -1, v19
    s_nop 0
    s_cbranch_vccnz g_43F5_0
    v_smfmac_f32_16x16x64_bf16 v[40:43], v[24:27], a[0:7], v172
    v_smfmac_f32_16x16x64_bf16 v[44:47], v[24:27], a[64:71], v172
    v_smfmac_f32_16x16x64_bf16 v[48:51], v[24:27], a[32:39], v172
    v_smfmac_f32_16x16x64_bf16 v[52:55], v[24:27], a[96:103], v172
    s_branch g_43L4_2
g_43L14_2:
    s_waitcnt vmcnt(2)
    v_max3_u32 v19, v32, v33, v34
    v_max_u32 v19, v19, v35
    v_cmp_eq_u32 vcc, -1, v19
    s_nop 0
    s_cbranch_vccnz g_43F14_2
    v_smfmac_f32_16x16x64_bf16 v[40:43], v[32:35], a[16:23], v172
    v_smfmac_f32_16x16x64_bf16 v[44:47], v[32:35], a[80:87], v172
    v_smfmac_f32_16x16x64_bf16 v[48:51], v[32:35], a[48:55], v172
    v_smfmac_f32_16x16x64_bf16 v[52:55], v[32:35], a[112:119], v172
g_43L10_3:
    s_waitcnt vmcnt(1)
    v_max3_u32 v19, v36, v37, v38
    v_max_u32 v19, v19, v39
    v_cmp_eq_u32 vcc, -1, v19
    s_nop 0
    s_cbranch_vccnz g_43F10_3
    v_smfmac_f32_16x16x64_bf16 v[40:43], v[36:39], a[24:31], v172
    v_smfmac_f32_16x16x64_bf16 v[44:47], v[36:39], a[88:95], v172
    v_smfmac_f32_16x16x64_bf16 v[48:51], v[36:39], a[56:63], v172
    v_smfmac_f32_16x16x64_bf16 v[52:55], v[36:39], a[120:127], v172
    s_branch g_43L2_1
g_43L14_3:
    s_waitcnt vmcnt(2)
    v_max3_u32 v19, v36, v37, v38
    v_max_u32 v19, v19, v39
    v_cmp_eq_u32 vcc, -1, v19
    s_nop 0
    s_cbranch_vccnz g_43F14_3
    v_smfmac_f32_16x16x64_bf16 v[40:43], v[36:39], a[24:31], v172
    v_smfmac_f32_16x16x64_bf16 v[44:47], v[36:39], a[88:95], v172
    v_smfmac_f32_16x16x64_bf16 v[48:51], v[36:39], a[56:63], v172
    v_smfmac_f32_16x16x64_bf16 v[52:55], v[36:39], a[120:127], v172
    s_branch g_43L6_1
g_43L3_1:
    s_waitcnt vmcnt(1)
    v_max3_u32 v19, v28, v29, v30
    v_max_u32 v19, v19, v31
    v_cmp_eq_u32 vcc, -1, v19
    s_nop 0
    s_cbranch_vccnz g_43F3_1
    v_smfmac_f32_16x16x64_bf16 v[40:43], v[28:31], a[8:15], v172
    v_smfmac_f32_16x16x64_bf16 v[44:47], v[28:31], a[72:79], v172
    v_smfmac_f32_16x16x64_bf16 v[48:51], v[28:31], a[40:47], v172
    v_smfmac_f32_16x16x64_bf16 v[52:55], v[28:31], a[104:111], v172
    s_branch g_43L1_0
g_43L6_2:
    s_waitcnt vmcnt(1)
    v_max3_u32 v19, v32, v33, v34
    v_max_u32 v19, v19, v35
    v_cmp_eq_u32 vcc, -1, v19
    s_nop 0
    s_cbranch_vccnz g_43F6_2
    v_smfmac_f32_16x16x64_bf16 v[40:43], v[32:35], a[16:23], v172
    v_smfmac_f32_16x16x64_bf16 v[44:47], v[32:35], a[80:87], v172
    v_smfmac_f32_16x16x64_bf16 v[48:51], v[32:35], a[48:55], v172
    v_smfmac_f32_16x16x64_bf16 v[52:55], v[32:35], a[112:119], v172
    s_branch g_43L2_1
g_43L9_0:
    s_waitcnt vmcnt(1)
    v_max3_u32 v19, v24, v25, v26
    v_max_u32 v19, v19, v27
    v_cmp_eq_u32 vcc, -1, v19
    s_nop 0
    s_cbranch_vccnz g_43F9_0
    v_smfmac_f32_16x16x64_bf16 v[40:43], v[24:27], a[0:7], v172
    v_smfmac_f32_16x16x64_bf16 v[44:47], v[24:27], a[64:71], v172
    v_smfmac_f32_16x16x64_bf16 v[48:51], v[24:27], a[32:39], v172
    v_smfmac_f32_16x16x64_bf16 v[52:55], v[24:27], a[96:103], v172
    s_branch g_43L8_3
g_43L12_3:
    s_waitcnt vmcnt(1)
    v_max3_u32 v19, v36, v37, v38
    v_max_u32 v19, v19, v39
    v_cmp_eq_u32 vcc, -1, v19
    s_nop 0
    s_cbranch_vccnz g_43F12_3
    v_smfmac_f32_16x16x64_bf16 v[40:43], v[36:39], a[24:31], v172
    v_smfmac_f32_16x16x64_bf16 v[44:47], v[36:39], a[88:95], v172
    v_smfmac_f32_16x16x64_bf16 v[48:51], v[36:39], a[56:63], v172
    v_smfmac_f32_16x16x64_bf16 v[52:55], v[36:39], a[120:127], v172
    s_branch g_43L4_2
g_43F15_0:
    s_mov_b64 exec, vcc
    buffer_load_dwordx4 v[24:27], v2, s[4:7], s16 offen offset:0 sc1
    s_mov_b64 exec, -1
    s_add_u32 s23, s23, 1
    s_cmp_lt_u32 s23, 200000
    s_cbranch_scc1 g_43L15_1
    s_mov_b32 s25, 200000
    s_branch gc_44
g_43F15_1:
    s_mov_b64 exec, vcc
    buffer_load_dwordx4 v[28:31], v2, s[4:7], s16 offen offset:1024 sc1
    s_mov_b64 exec, -1
    s_add_u32 s23, s23, 1
    s_cmp_lt_u32 s23, 200000
    s_cbranch_scc1 g_43L15_2
    s_mov_b32 s25, 200000
    s_branch gc_44
g_43F15_2:
    s_mov_b64 exec, vcc
    buffer_load_dwordx4 v[32:35], v2, s[4:7], s16 offen offset:2048 sc1
    s_mov_b64 exec, -1
    s_add_u32 s23, s23, 1
    s_cmp_lt_u32 s23, 200000
    s_cbranch_scc1 g_43L15_3
    s_mov_b32 s25, 200000
    s_branch gc_44
g_43F15_3:
    s_mov_b64 exec, vcc
    buffer_load_dwordx4 v[36:39], v2, s[4:7], s16 offen offset:3072 sc1
    s_mov_b64 exec, -1
    s_add_u32 s23, s23, 1
    s_cmp_lt_u32 s23, 200000
    s_cbranch_scc1 g_43L15_0
    s_mov_b32 s25, 200000
    s_branch gc_44
g_43F7_0:
    s_mov_b64 exec, vcc
    buffer_load_dwordx4 v[24:27], v2, s[4:7], s16 offen offset:0 sc1
    s_mov_b64 exec, -1
    s_add_u32 s23, s23, 1
    s_cmp_lt_u32 s23, 200000
    s_cbranch_scc1 g_43L7_1
    s_mov_b32 s25, 200000
    s_branch gc_44
g_43F7_1:
    s_mov_b64 exec, vcc
    buffer_load_dwordx4 v[28:31], v2, s[4:7], s16 offen offset:1024 sc1
    s_mov_b64 exec, -1
    s_add_u32 s23, s23, 1
    s_cmp_lt_u32 s23, 200000
    s_cbranch_scc1 g_43L7_2
    s_mov_b32 s25, 200000
    s_branch gc_44
g_43F7_2:
    s_mov_b64 exec, vcc
    buffer_load_dwordx4 v[32:35], v2, s[4:7], s16 offen offset:2048 sc1
    s_mov_b64 exec, -1
    s_add_u32 s23, s23, 1
    s_cmp_lt_u32 s23, 200000
    s_cbranch_scc1 g_43L7_0
    s_mov_b32 s25, 200000
    s_branch gc_44
g_43F11_0:
    s_mov_b64 exec, vcc
    buffer_load_dwordx4 v[24:27], v2, s[4:7], s16 offen offset:0 sc1
    s_mov_b64 exec, -1
    s_add_u32 s23, s23, 1
    s_cmp_lt_u32 s23, 200000
    s_cbranch_scc1 g_43L11_1
    s_mov_b32 s25, 200000
    s_branch gc_44
g_43F11_1:
    s_mov_b64 exec, vcc
    buffer_load_dwordx4 v[28:31], v2, s[4:7], s16 offen offset:1024 sc1
    s_mov_b64 exec, -1
    s_add_u32 s23, s23, 1
    s_cmp_lt_u32 s23, 200000
    s_cbranch_scc1 g_43L11_3
    s_mov_b32 s25, 200000
    s_branch gc_44
g_43F11_3:
    s_mov_b64 exec, vcc
    buffer_load_dwordx4 v[36:39], v2, s[4:7], s16 offen offset:3072 sc1
    s_mov_b64 exec, -1
    s_add_u32 s23, s23, 1
    s_cmp_lt_u32 s23, 200000
    s_cbranch_scc1 g_43L11_0
    s_mov_b32 s25, 200000
    s_branch gc_44
g_43F13_0:
    s_mov_b64 exec, vcc
    buffer_load_dwordx4 v[24:27], v2, s[4:7], s16 offen offset:0 sc1
    s_mov_b64 exec, -1
    s_add_u32 s23, s23, 1
    s_cmp_lt_u32 s23, 200000
    s_cbranch_scc1 g_43L13_2
    s_mov_b32 s25, 200000
    s_branch gc_44
g_43F13_2:
    s_mov_b64 exec, vcc
    buffer_load_dwordx4 v[32:35], v2, s[4:7], s16 offen offset:2048 sc1
    s_mov_b64 exec, -1
    s_add_u32 s23, s23, 1
    s_cmp_lt_u32 s23, 200000
    s_cbranch_scc1 g_43L13_3
    s_mov_b32 s25, 200000
    s_branch gc_44
g_43F13_3:
    s_mov_b64 exec, vcc
    buffer_load_dwordx4 v[36:39], v2, s[4:7], s16 offen offset:3072 sc1
    s_mov_b64 exec, -1
    s_add_u32 s23, s23, 1
    s_cmp_lt_u32 s23, 200000
    s_cbranch_scc1 g_43L13_0
    s_mov_b32 s25, 200000
    s_branch gc_44
g_43F14_1:
    s_mov_b64 exec, vcc
    buffer_load_dwordx4 v[28:31], v2, s[4:7], s16 offen offset:1024 sc1
    s_mov_b64 exec, -1
    s_add_u32 s23, s23, 1
    s_cmp_lt_u32 s23, 200000
    s_cbranch_scc1 g_43L14_2
    s_mov_b32 s25, 200000
    s_branch gc_44
g_43F14_2:
    s_mov_b64 exec, vcc
    buffer_load_dwordx4 v[32:35], v2, s[4:7], s16 offen offset:2048 sc1
    s_mov_b64 exec, -1
    s_add_u32 s23, s23, 1
    s_cmp_lt_u32 s23, 200000
    s_cbranch_scc1 g_43L14_3
    s_mov_b32 s25, 200000
    s_branch gc_44
g_43F14_3:
    s_mov_b64 exec, vcc
    buffer_load_dwordx4 v[36:39], v2, s[4:7], s16 offen offset:3072 sc1
    s_mov_b64 exec, -1
    s_add_u32 s23, s23, 1
    s_cmp_lt_u32 s23, 200000
    s_cbranch_scc1 g_43L14_1
    s_mov_b32 s25, 200000
    s_branch gc_44
g_43F3_0:
    s_mov_b64 exec, vcc
    buffer_load_dwordx4 v[24:27], v2, s[4:7], s16 offen offset:0 sc1
    s_mov_b64 exec, -1
    s_add_u32 s23, s23, 1
    s_cmp_lt_u32 s23, 200000
    s_cbranch_scc1 g_43L3_1
    s_mov_b32 s25, 200000
    s_branch gc_44
g_43F3_1:
    s_mov_b64 exec, vcc
    buffer_load_dwordx4 v[28:31], v2, s[4:7], s16 offen offset:1024 sc1
    s_mov_b64 exec, -1
    s_add_u32 s23, s23, 1
    s_cmp_lt_u32 s23, 200000
    s_cbranch_scc1 g_43L3_0
    s_mov_b32 s25, 200000
    s_branch gc_44
g_43F5_0:
    s_mov_b64 exec, vcc
    buffer_load_dwordx4 v[24:27], v2, s[4:7], s16 offen offset:0 sc1
    s_mov_b64 exec, -1
    s_add_u32 s23, s23, 1
    s_cmp_lt_u32 s23, 200000
    s_cbranch_scc1 g_43L5_2
    s_mov_b32 s25, 200000
    s_branch gc_44
g_43F5_2:
    s_mov_b64 exec, vcc
    buffer_load_dwordx4 v[32:35], v2, s[4:7], s16 offen offset:2048 sc1
    s_mov_b64 exec, -1
    s_add_u32 s23, s23, 1
    s_cmp_lt_u32 s23, 200000
    s_cbranch_scc1 g_43L5_0
    s_mov_b32 s25, 200000
    s_branch gc_44
g_43F6_1:
    s_mov_b64 exec, vcc
    buffer_load_dwordx4 v[28:31], v2, s[4:7], s16 offen offset:1024 sc1
    s_mov_b64 exec, -1
    s_add_u32 s23, s23, 1
    s_cmp_lt_u32 s23, 200000
    s_cbranch_scc1 g_43L6_2
    s_mov_b32 s25, 200000
    s_branch gc_44
g_43F6_2:
    s_mov_b64 exec, vcc
    buffer_load_dwordx4 v[32:35], v2, s[4:7], s16 offen offset:2048 sc1
    s_mov_b64 exec, -1
    s_add_u32 s23, s23, 1
    s_cmp_lt_u32 s23, 200000
    s_cbranch_scc1 g_43L6_1
    s_mov_b32 s25, 200000
    s_branch gc_44
g_43F9_0:
    s_mov_b64 exec, vcc
    buffer_load_dwordx4 v[24:27], v2, s[4:7], s16 offen offset:0 sc1
    s_mov_b64 exec, -1
    s_add_u32 s23, s23, 1
    s_cmp_lt_u32 s23, 200000
    s_cbranch_scc1 g_43L9_3
    s_mov_b32 s25, 200000
    s_branch gc_44
g_43F9_3:
    s_mov_b64 exec, vcc
    buffer_load_dwordx4 v[36:39], v2, s[4:7], s16 offen offset:3072 sc1
    s_mov_b64 exec, -1
    s_add_u32 s23, s23, 1
    s_cmp_lt_u32 s23, 200000
    s_cbranch_scc1 g_43L9_0
    s_mov_b32 s25, 200000
    s_branch gc_44
g_43F10_1:
    s_mov_b64 exec, vcc
    buffer_load_dwordx4 v[28:31], v2, s[4:7], s16 offen offset:1024 sc1
    s_mov_b64 exec, -1
    s_add_u32 s23, s23, 1
    s_cmp_lt_u32 s23, 200000
    s_cbranch_scc1 g_43L10_3
    s_mov_b32 s25, 200000
    s_branch gc_44
g_43F10_3:
    s_mov_b64 exec, vcc
    buffer_load_dwordx4 v[36:39], v2, s[4:7], s16 offen offset:3072 sc1
    s_mov_b64 exec, -1
    s_add_u32 s23, s23, 1
    s_cmp_lt_u32 s23, 200000
    s_cbranch_scc1 g_43L10_1
    s_mov_b32 s25, 200000
    s_branch gc_44
g_43F12_2:
    s_mov_b64 exec, vcc
    buffer_load_dwordx4 v[32:35], v2, s[4:7], s16 offen offset:2048 sc1
    s_mov_b64 exec, -1
    s_add_u32 s23, s23, 1
    s_cmp_lt_u32 s23, 200000
    s_cbranch_scc1 g_43L12_3
    s_mov_b32 s25, 200000
    s_branch gc_44
g_43F12_3:
    s_mov_b64 exec, vcc
    buffer_load_dwordx4 v[36:39], v2, s[4:7], s16 offen offset:3072 sc1
    s_mov_b64 exec, -1
    s_add_u32 s23, s23, 1
    s_cmp_lt_u32 s23, 200000
    s_cbranch_scc1 g_43L12_2
    s_mov_b32 s25, 200000
    s_branch gc_44
g_43F1_0:
    s_mov_b64 exec, vcc
    buffer_load_dwordx4 v[24:27], v2, s[4:7], s16 offen offset:0 sc1
    s_mov_b64 exec, -1
    s_add_u32 s23, s23, 1
    s_cmp_lt_u32 s23, 200000
    s_cbranch_scc1 g_43L1_0
    s_mov_b32 s25, 200000
    s_branch gc_44
g_43F2_1:
    s_mov_b64 exec, vcc
    buffer_load_dwordx4 v[28:31], v2, s[4:7], s16 offen offset:1024 sc1
    s_mov_b64 exec, -1
    s_add_u32 s23, s23, 1
    s_cmp_lt_u32 s23, 200000
    s_cbranch_scc1 g_43L2_1
    s_mov_b32 s25, 200000
    s_branch gc_44
g_43F4_2:
    s_mov_b64 exec, vcc
    buffer_load_dwordx4 v[32:35], v2, s[4:7], s16 offen offset:2048 sc1
    s_mov_b64 exec, -1
    s_add_u32 s23, s23, 1
    s_cmp_lt_u32 s23, 200000
    s_cbranch_scc1 g_43L4_2
    s_mov_b32 s25, 200000
    s_branch gc_44
g_43F8_3:
    s_mov_b64 exec, vcc
    buffer_load_dwordx4 v[36:39], v2, s[4:7], s16 offen offset:3072 sc1
    s_mov_b64 exec, -1
    s_add_u32 s23, s23, 1
    s_cmp_lt_u32 s23, 200000
    s_cbranch_scc1 g_43L8_3
    s_mov_b32 s25, 200000
    s_branch gc_44
recur_fast_last2:
    buffer_store_dwordx4 v[168:171], v15, s[4:7], s20 offen sc1
    s_waitcnt vmcnt(0)
    s_branch recur_end
g_45L15_0:
    s_waitcnt vmcnt(3)
    v_max3_u32 v19, v24, v25, v26
    v_max_u32 v19, v19, v27
    v_cmp_eq_u32 vcc, -1, v19
    s_nop 0
    s_cbranch_vccnz g_45F15_0
    v_smfmac_f32_16x16x64_bf16 v[64:67], v[24:27], a[192:199], v172
    v_smfmac_f32_16x16x64_bf16 v[68:71], v[24:27], a[224:231], v172
g_45L14_1:
    s_waitcnt vmcnt(2)
    v_max3_u32 v19, v28, v29, v30
    v_max_u32 v19, v19, v31
    v_cmp_eq_u32 vcc, -1, v19
    s_nop 0
    s_cbranch_vccnz g_45F14_1
    v_smfmac_f32_16x16x64_bf16 v[64:67], v[28:31], a[200:207], v172
    v_smfmac_f32_16x16x64_bf16 v[68:71], v[28:31], a[232:239], v172
g_45L12_2:
    s_waitcnt vmcnt(1)
    v_max3_u32 v19, v32, v33, v34
    v_max_u32 v19, v19, v35
    v_cmp_eq_u32 vcc, -1, v19
    s_nop 0
    s_cbranch_vccnz g_45F12_2
    v_smfmac_f32_16x16x64_bf16 v[64:67], v[32:35], a[208:215], v172
    v_smfmac_f32_16x16x64_bf16 v[68:71], v[32:35], a[240:247], v172
g_45L8_3:
    s_waitcnt vmcnt(0)
    v_max3_u32 v19, v36, v37, v38
    v_max_u32 v19, v19, v39
    v_cmp_eq_u32 vcc, -1, v19
    s_nop 0
    s_cbranch_vccnz g_45F8_3
    v_smfmac_f32_16x16x64_bf16 v[64:67], v[36:39], a[216:223], v172
    v_smfmac_f32_16x16x64_bf16 v[68:71], v[36:39], a[248:255], v172
    s_nop 4
    v_cvt_pk_bf16_f32 v80, v64, v65
    v_cvt_pk_bf16_f32 v81, v66, v67
    s_nop 0
    v_cvt_pk_bf16_f32 v82, v68, v69
    v_cvt_pk_bf16_f32 v83, v70, v71
    ds_write_b128 v17, v[80:83] offset:9216
    s_branch gc_46
g_45L15_1:
    s_waitcnt vmcnt(3)
    v_max3_u32 v19, v28, v29, v30
    v_max_u32 v19, v19, v31
    v_cmp_eq_u32 vcc, -1, v19
    s_nop 0
    s_cbranch_vccnz g_45F15_1
    v_smfmac_f32_16x16x64_bf16 v[64:67], v[28:31], a[200:207], v172
    v_smfmac_f32_16x16x64_bf16 v[68:71], v[28:31], a[232:239], v172
g_45L13_2:
    s_waitcnt vmcnt(2)
    v_max3_u32 v19, v32, v33, v34
    v_max_u32 v19, v19, v35
    v_cmp_eq_u32 vcc, -1, v19
    s_nop 0
    s_cbranch_vccnz g_45F13_2
    v_smfmac_f32_16x16x64_bf16 v[64:67], v[32:35], a[208:215], v172
    v_smfmac_f32_16x16x64_bf16 v[68:71], v[32:35], a[240:247], v172
g_45L9_3:
    s_waitcnt vmcnt(1)
    v_max3_u32 v19, v36, v37, v38
    v_max_u32 v19, v19, v39
    v_cmp_eq_u32 vcc, -1, v19
    s_nop 0
    s_cbranch_vccnz g_45F9_3
    v_smfmac_f32_16x16x64_bf16 v[64:67], v[36:39], a[216:223], v172
    v_smfmac_f32_16x16x64_bf16 v[68:71], v[36:39], a[248:255], v172
g_45L1_0:
    s_waitcnt vmcnt(0)
    v_max3_u32 v19, v24, v25, v26
    v_max_u32 v19, v19, v27
    v_cmp_eq_u32 vcc, -1, v19
    s_nop 0
    s_cbranch_vccnz g_45F1_0
    v_smfmac_f32_16x16x64_bf16 v[64:67], v[24:27], a[192:199], v172
    v_smfmac_f32_16x16x64_bf16 v[68:71], v[24:27], a[224:231], v172
    s_nop 4
    v_cvt_pk_bf16_f32 v80, v64, v65
    v_cvt_pk_bf16_f32 v81, v66, v67
    s_nop 0
    v_cvt_pk_bf16_f32 v82, v68, v69
    v_cvt_pk_bf16_f32 v83, v70, v71
    ds_write_b128 v17, v[80:83] offset:9216
    s_branch gc_46
g_45L15_2:
    s_waitcnt vmcnt(3)
    v_max3_u32 v19, v32, v33, v34
    v_max_u32 v19, v19, v35
    v_cmp_eq_u32 vcc, -1, v19
    s_nop 0
    s_cbranch_vccnz g_45F15_2
    v_smfmac_f32_16x16x64_bf16 v[64:67], v[32:35], a[208:215], v172
    v_smfmac_f32_16x16x64_bf16 v[68:71], v[32:35], a[240:247], v172
g_45L11_3:
    s_waitcnt vmcnt(2)
    v_max3_u32 v19, v36, v37, v38
    v_max_u32 v19, v19, v39
    v_cmp_eq_u32 vcc, -1, v19
    s_nop 0
    s_cbranch_vccnz g_45F11_3
    v_smfmac_f32_16x16x64_bf16 v[64:67], v[36:39], a[216:223], v172
    v_smfmac_f32_16x16x64_bf16 v[68:71], v[36:39], a[248:255], v172
g_45L3_0:
    s_waitcnt vmcnt(1)
    v_max3_u32 v19, v24, v25, v26
    v_max_u32 v19, v19, v27
    v_cmp_eq_u32 vcc, -1, v19
    s_nop 0
    s_cbranch_vccnz g_45F3_0
    v_smfmac_f32_16x16x64_bf16 v[64:67], v[24:27], a[192:199], v172
    v_smfmac_f32_16x16x64_bf16 v[68:71], v[24:27], a[224:231], v172
g_45L2_1:
    s_waitcnt vmcnt(0)
    v_max3_u32 v19, v28, v29, v30
    v_max_u32 v19, v19, v31
    v_cmp_eq_u32 vcc, -1, v19
    s_nop 0
    s_cbranch_vccnz g_45F2_1
    v_smfmac_f32_16x16x64_bf16 v[64:67], v[28:31], a[200:207], v172
    v_smfmac_f32_16x16x64_bf16 v[68:71], v[28:31], a[232:239], v172
    s_nop 4
    v_cvt_pk_bf16_f32 v80, v64, v65
    v_cvt_pk_bf16_f32 v81, v66, v67
    s_nop 0
    v_cvt_pk_bf16_f32 v82, v68, v69
    v_cvt_pk_bf16_f32 v83, v70, v71
    ds_write_b128 v17, v[80:83] offset:9216
    s_branch gc_46
g_45L15_3:
    s_waitcnt vmcnt(3)
    v_max3_u32 v19, v36, v37, v38
    v_max_u32 v19, v19, v39
    v_cmp_eq_u32 vcc, -1, v19
    s_nop 0
    s_cbranch_vccnz g_45F15_3
    v_smfmac_f32_16x16x64_bf16 v[64:67], v[36:39], a[216:223], v172
    v_smfmac_f32_16x16x64_bf16 v[68:71], v[36:39], a[248:255], v172
g_45L7_0:
    s_waitcnt vmcnt(2)
    v_max3_u32 v19, v24, v25, v26
    v_max_u32 v19, v19, v27
    v_cmp_eq_u32 vcc, -1, v19
    s_nop 0
    s_cbranch_vccnz g_45F7_0
    v_smfmac_f32_16x16x64_bf16 v[64:67], v[24:27], a[192:199], v172
    v_smfmac_f32_16x16x64_bf16 v[68:71], v[24:27], a[224:231], v172
g_45L6_1:
    s_waitcnt vmcnt(1)
    v_max3_u32 v19, v28, v29, v30
    v_max_u32 v19, v19, v31
    v_cmp_eq_u32 vcc, -1, v19
    s_nop 0
    s_cbranch_vccnz g_45F6_1
    v_smfmac_f32_16x16x64_bf16 v[64:67], v[28:31], a[200:207], v172
    v_smfmac_f32_16x16x64_bf16 v[68:71], v[28:31], a[232:239], v172
g_45L4_2:
    s_waitcnt vmcnt(0)
    v_max3_u32 v19, v32, v33, v34
    v_max_u32 v19, v19, v35
    v_cmp_eq_u32 vcc, -1, v19
    s_nop 0
    s_cbranch_vccnz g_45F4_2
    v_smfmac_f32_16x16x64_bf16 v[64:67], v[32:35], a[208:215], v172
    v_smfmac_f32_16x16x64_bf16 v[68:71], v[32:35], a[240:247], v172
    s_nop 4
    v_cvt_pk_bf16_f32 v80, v64, v65
    v_cvt_pk_bf16_f32 v81, v66, v67
    s_nop 0
    v_cvt_pk_bf16_f32 v82, v68, v69
    v_cvt_pk_bf16_f32 v83, v70, v71
    ds_write_b128 v17, v[80:83] offset:9216
    s_branch gc_46
g_45L7_1:
    s_waitcnt vmcnt(2)
    v_max3_u32 v19, v28, v29, v30
    v_max_u32 v19, v19, v31
    v_cmp_eq_u32 vcc, -1, v19
    s_nop 0
    s_cbranch_vccnz g_45F7_1
    v_smfmac_f32_16x16x64_bf16 v[64:67], v[28:31], a[200:207], v172
    v_smfmac_f32_16x16x64_bf16 v[68:71], v[28:31], a[232:239], v172
g_45L5_2:
    s_waitcnt vmcnt(1)
    v_max3_u32 v19, v32, v33, v34
    v_max_u32 v19, v19, v35
    v_cmp_eq_u32 vcc, -1, v19
    s_nop 0
    s_cbranch_vccnz g_45F5_2
    v_smfmac_f32_16x16x64_bf16 v[64:67], v[32:35], a[208:215], v172
    v_smfmac_f32_16x16x64_bf16 v[68:71], v[32:35], a[240:247], v172
    s_branch g_45L1_0
g_45L7_2:
    s_waitcnt vmcnt(2)
    v_max3_u32 v19, v32, v33, v34
    v_max_u32 v19, v19, v35
    v_cmp_eq_u32 vcc, -1, v19
    s_nop 0
    s_cbranch_vccnz g_45F7_2
    v_smfmac_f32_16x16x64_bf16 v[64:67], v[32:35], a[208:215], v172
    v_smfmac_f32_16x16x64_bf16 v[68:71], v[32:35], a[240:247], v172
    s_branch g_45L3_0
g_45L11_0:
    s_waitcnt vmcnt(2)
    v_max3_u32 v19, v24, v25, v26
    v_max_u32 v19, v19, v27
    v_cmp_eq_u32 vcc, -1, v19
    s_nop 0
    s_cbranch_vccnz g_45F11_0
    v_smfmac_f32_16x16x64_bf16 v[64:67], v[24:27], a[192:199], v172
    v_smfmac_f32_16x16x64_bf16 v[68:71], v[24:27], a[224:231], v172
g_45L10_1:
    s_waitcnt vmcnt(1)
    v_max3_u32 v19, v28, v29, v30
    v_max_u32 v19, v19, v31
    v_cmp_eq_u32 vcc, -1, v19
    s_nop 0
    s_cbranch_vccnz g_45F10_1
    v_smfmac_f32_16x16x64_bf16 v[64:67], v[28:31], a[200:207], v172
    v_smfmac_f32_16x16x64_bf16 v[68:71], v[28:31], a[232:239], v172
    s_branch g_45L8_3
g_45L11_1:
    s_waitcnt vmcnt(2)
    v_max3_u32 v19, v28, v29, v30
    v_max_u32 v19, v19, v31
    v_cmp_eq_u32 vcc, -1, v19
    s_nop 0
    s_cbranch_vccnz g_45F11_1
    v_smfmac_f32_16x16x64_bf16 v[64:67], v[28:31], a[200:207], v172
    v_smfmac_f32_16x16x64_bf16 v[68:71], v[28:31], a[232:239], v172
    s_branch g_45L9_3
g_45L13_0:
    s_waitcnt vmcnt(2)
    v_max3_u32 v19, v24, v25, v26
    v_max_u32 v19, v19, v27
    v_cmp_eq_u32 vcc, -1, v19
    s_nop 0
    s_cbranch_vccnz g_45F13_0
    v_smfmac_f32_16x16x64_bf16 v[64:67], v[24:27], a[192:199], v172
    v_smfmac_f32_16x16x64_bf16 v[68:71], v[24:27], a[224:231], v172
    s_branch g_45L12_2
g_45L13_3:
    s_waitcnt vmcnt(2)
    v_max3_u32 v19, v36, v37, v38
    v_max_u32 v19, v19, v39
    v_cmp_eq_u32 vcc, -1, v19
    s_nop 0
    s_cbranch_vccnz g_45F13_3
    v_smfmac_f32_16x16x64_bf16 v[64:67], v[36:39], a[216:223], v172
    v_smfmac_f32_16x16x64_bf16 v[68:71], v[36:39], a[248:255], v172
g_45L5_0:
    s_waitcnt vmcnt(1)
    v_max3_u32 v19, v24, v25, v26
    v_max_u32 v19, v19, v27
    v_cmp_eq_u32 vcc, -1, v19
    s_nop 0
    s_cbranch_vccnz g_45F5_0
    v_smfmac_f32_16x16x64_bf16 v[64:67], v[24:27], a[192:199], v172
    v_smfmac_f32_16x16x64_bf16 v[68:71], v[24:27], a[224:231], v172
    s_branch g_45L4_2
g_45L14_2:
    s_waitcnt vmcnt(2)
    v_max3_u32 v19, v32, v33, v34
    v_max_u32 v19, v19, v35
    v_cmp_eq_u32 vcc, -1, v19
    s_nop 0
    s_cbranch_vccnz g_45F14_2
    v_smfmac_f32_16x16x64_bf16 v[64:67], v[32:35], a[208:215], v172
    v_smfmac_f32_16x16x64_bf16 v[68:71], v[32:35], a[240:247], v172
g_45L10_3:
    s_waitcnt vmcnt(1)
    v_max3_u32 v19, v36, v37, v38
    v_max_u32 v19, v19, v39
    v_cmp_eq_u32 vcc, -1, v19
    s_nop 0
    s_cbranch_vccnz g_45F10_3
    v_smfmac_f32_16x16x64_bf16 v[64:67], v[36:39], a[216:223], v172
    v_smfmac_f32_16x16x64_bf16 v[68:71], v[36:39], a[248:255], v172
    s_branch g_45L2_1
g_45L14_3:
    s_waitcnt vmcnt(2)
    v_max3_u32 v19, v36, v37, v38
    v_max_u32 v19, v19, v39
    v_cmp_eq_u32 vcc, -1, v19
    s_nop 0
    s_cbranch_vccnz g_45F14_3
    v_smfmac_f32_16x16x64_bf16 v[64:67], v[36:39], a[216:223], v172
    v_smfmac_f32_16x16x64_bf16 v[68:71], v[36:39], a[248:255], v172
    s_branch g_45L6_1
g_45L3_1:
    s_waitcnt vmcnt(1)
    v_max3_u32 v19, v28, v29, v30
    v_max_u32 v19, v19, v31
    v_cmp_eq_u32 vcc, -1, v19
    s_nop 0
    s_cbranch_vccnz g_45F3_1
    v_smfmac_f32_16x16x64_bf16 v[64:67], v[28:31], a[200:207], v172
    v_smfmac_f32_16x16x64_bf16 v[68:71], v[28:31], a[232:239], v172
    s_branch g_45L1_0
g_45L6_2:
    s_waitcnt vmcnt(1)
    v_max3_u32 v19, v32, v33, v34
    v_max_u32 v19, v19, v35
    v_cmp_eq_u32 vcc, -1, v19
    s_nop 0
    s_cbranch_vccnz g_45F6_2
    v_smfmac_f32_16x16x64_bf16 v[64:67], v[32:35], a[208:215], v172
    v_smfmac_f32_16x16x64_bf16 v[68:71], v[32:35], a[240:247], v172
    s_branch g_45L2_1
g_45L9_0:
    s_waitcnt vmcnt(1)
    v_max3_u32 v19, v24, v25, v26
    v_max_u32 v19, v19, v27
    v_cmp_eq_u32 vcc, -1, v19
    s_nop 0
    s_cbranch_vccnz g_45F9_0
    v_smfmac_f32_16x16x64_bf16 v[64:67], v[24:27], a[192:199], v172
    v_smfmac_f32_16x16x64_bf16 v[68:71], v[24:27], a[224:231], v172
    s_branch g_45L8_3
g_45L12_3:
    s_waitcnt vmcnt(1)
    v_max3_u32 v19, v36, v37, v38
    v_max_u32 v19, v19, v39
    v_cmp_eq_u32 vcc, -1, v19
    s_nop 0
    s_cbranch_vccnz g_45F12_3
    v_smfmac_f32_16x16x64_bf16 v[64:67], v[36:39], a[216:223], v172
    v_smfmac_f32_16x16x64_bf16 v[68:71], v[36:39], a[248:255], v172
    s_branch g_45L4_2
g_45F15_0:
    s_mov_b64 exec, vcc
    buffer_load_dwordx4 v[24:27], v8, s[4:7], s16 offen offset:0 sc1
    s_mov_b64 exec, -1
    s_add_u32 s23, s23, 1
    s_cmp_lt_u32 s23, 200000
    s_cbranch_scc1 g_45L15_1
    s_mov_b32 s25, 200000
    s_branch gc_46
g_45F15_1:
    s_mov_b64 exec, vcc
    buffer_load_dwordx4 v[28:31], v8, s[4:7], s16 offen offset:1024 sc1
    s_mov_b64 exec, -1
    s_add_u32 s23, s23, 1
    s_cmp_lt_u32 s23, 200000
    s_cbranch_scc1 g_45L15_2
    s_mov_b32 s25, 200000
    s_branch gc_46
g_45F15_2:
    s_mov_b64 exec, vcc
    buffer_load_dwordx4 v[32:35], v8, s[4:7], s16 offen offset:2048 sc1
    s_mov_b64 exec, -1
    s_add_u32 s23, s23, 1
    s_cmp_lt_u32 s23, 200000
    s_cbranch_scc1 g_45L15_3
    s_mov_b32 s25, 200000
    s_branch gc_46
g_45F15_3:
    s_mov_b64 exec, vcc
    buffer_load_dwordx4 v[36:39], v8, s[4:7], s16 offen offset:3072 sc1
    s_mov_b64 exec, -1
    s_add_u32 s23, s23, 1
    s_cmp_lt_u32 s23, 200000
    s_cbranch_scc1 g_45L15_0
    s_mov_b32 s25, 200000
    s_branch gc_46
g_45F7_0:
    s_mov_b64 exec, vcc
    buffer_load_dwordx4 v[24:27], v8, s[4:7], s16 offen offset:0 sc1
    s_mov_b64 exec, -1
    s_add_u32 s23, s23, 1
    s_cmp_lt_u32 s23, 200000
    s_cbranch_scc1 g_45L7_1
    s_mov_b32 s25, 200000
    s_branch gc_46
g_45F7_1:
    s_mov_b64 exec, vcc
    buffer_load_dwordx4 v[28:31], v8, s[4:7], s16 offen offset:1024 sc1
    s_mov_b64 exec, -1
    s_add_u32 s23, s23, 1
    s_cmp_lt_u32 s23, 200000
    s_cbranch_scc1 g_45L7_2
    s_mov_b32 s25, 200000
    s_branch gc_46
g_45F7_2:
    s_mov_b64 exec, vcc
    buffer_load_dwordx4 v[32:35], v8, s[4:7], s16 offen offset:2048 sc1
    s_mov_b64 exec, -1
    s_add_u32 s23, s23, 1
    s_cmp_lt_u32 s23, 200000
    s_cbranch_scc1 g_45L7_0
    s_mov_b32 s25, 200000
    s_branch gc_46
g_45F11_0:
    s_mov_b64 exec, vcc
    buffer_load_dwordx4 v[24:27], v8, s[4:7], s16 offen offset:0 sc1
    s_mov_b64 exec, -1
    s_add_u32 s23, s23, 1
    s_cmp_lt_u32 s23, 200000
    s_cbranch_scc1 g_45L11_1
    s_mov_b32 s25, 200000
    s_branch gc_46
g_45F11_1:
    s_mov_b64 exec, vcc
    buffer_load_dwordx4 v[28:31], v8, s[4:7], s16 offen offset:1024 sc1
    s_mov_b64 exec, -1
    s_add_u32 s23, s23, 1
    s_cmp_lt_u32 s23, 200000
    s_cbranch_scc1 g_45L11_3
    s_mov_b32 s25, 200000
    s_branch gc_46
g_45F11_3:
    s_mov_b64 exec, vcc
    buffer_load_dwordx4 v[36:39], v8, s[4:7], s16 offen offset:3072 sc1
    s_mov_b64 exec, -1
    s_add_u32 s23, s23, 1
    s_cmp_lt_u32 s23, 200000
    s_cbranch_scc1 g_45L11_0
    s_mov_b32 s25, 200000
    s_branch gc_46
g_45F13_0:
    s_mov_b64 exec, vcc
    buffer_load_dwordx4 v[24:27], v8, s[4:7], s16 offen offset:0 sc1
    s_mov_b64 exec, -1
    s_add_u32 s23, s23, 1
    s_cmp_lt_u32 s23, 200000
    s_cbranch_scc1 g_45L13_2
    s_mov_b32 s25, 200000
    s_branch gc_46
g_45F13_2:
    s_mov_b64 exec, vcc
    buffer_load_dwordx4 v[32:35], v8, s[4:7], s16 offen offset:2048 sc1
    s_mov_b64 exec, -1
    s_add_u32 s23, s23, 1
    s_cmp_lt_u32 s23, 200000
    s_cbranch_scc1 g_45L13_3
    s_mov_b32 s25, 200000
    s_branch gc_46
g_45F13_3:
    s_mov_b64 exec, vcc
    buffer_load_dwordx4 v[36:39], v8, s[4:7], s16 offen offset:3072 sc1
    s_mov_b64 exec, -1
    s_add_u32 s23, s23, 1
    s_cmp_lt_u32 s23, 200000
    s_cbranch_scc1 g_45L13_0
    s_mov_b32 s25, 200000
    s_branch gc_46
g_45F14_1:
    s_mov_b64 exec, vcc
    buffer_load_dwordx4 v[28:31], v8, s[4:7], s16 offen offset:1024 sc1
    s_mov_b64 exec, -1
    s_add_u32 s23, s23, 1
    s_cmp_lt_u32 s23, 200000
    s_cbranch_scc1 g_45L14_2
    s_mov_b32 s25, 200000
    s_branch gc_46
g_45F14_2:
    s_mov_b64 exec, vcc
    buffer_load_dwordx4 v[32:35], v8, s[4:7], s16 offen offset:2048 sc1
    s_mov_b64 exec, -1
    s_add_u32 s23, s23, 1
    s_cmp_lt_u32 s23, 200000
    s_cbranch_scc1 g_45L14_3
    s_mov_b32 s25, 200000
    s_branch gc_46
g_45F14_3:
    s_mov_b64 exec, vcc
    buffer_load_dwordx4 v[36:39], v8, s[4:7], s16 offen offset:3072 sc1
    s_mov_b64 exec, -1
    s_add_u32 s23, s23, 1
    s_cmp_lt_u32 s23, 200000
    s_cbranch_scc1 g_45L14_1
    s_mov_b32 s25, 200000
    s_branch gc_46
g_45F3_0:
    s_mov_b64 exec, vcc
    buffer_load_dwordx4 v[24:27], v8, s[4:7], s16 offen offset:0 sc1
    s_mov_b64 exec, -1
    s_add_u32 s23, s23, 1
    s_cmp_lt_u32 s23, 200000
    s_cbranch_scc1 g_45L3_1
    s_mov_b32 s25, 200000
    s_branch gc_46
g_45F3_1:
    s_mov_b64 exec, vcc
    buffer_load_dwordx4 v[28:31], v8, s[4:7], s16 offen offset:1024 sc1
    s_mov_b64 exec, -1
    s_add_u32 s23, s23, 1
    s_cmp_lt_u32 s23, 200000
    s_cbranch_scc1 g_45L3_0
    s_mov_b32 s25, 200000
    s_branch gc_46
g_45F5_0:
    s_mov_b64 exec, vcc
    buffer_load_dwordx4 v[24:27], v8, s[4:7], s16 offen offset:0 sc1
    s_mov_b64 exec, -1
    s_add_u32 s23, s23, 1
    s_cmp_lt_u32 s23, 200000
    s_cbranch_scc1 g_45L5_2
    s_mov_b32 s25, 200000
    s_branch gc_46
g_45F5_2:
    s_mov_b64 exec, vcc
    buffer_load_dwordx4 v[32:35], v8, s[4:7], s16 offen offset:2048 sc1
    s_mov_b64 exec, -1
    s_add_u32 s23, s23, 1
    s_cmp_lt_u32 s23, 200000
    s_cbranch_scc1 g_45L5_0
    s_mov_b32 s25, 200000
    s_branch gc_46
g_45F6_1:
    s_mov_b64 exec, vcc
    buffer_load_dwordx4 v[28:31], v8, s[4:7], s16 offen offset:1024 sc1
    s_mov_b64 exec, -1
    s_add_u32 s23, s23, 1
    s_cmp_lt_u32 s23, 200000
    s_cbranch_scc1 g_45L6_2
    s_mov_b32 s25, 200000
    s_branch gc_46
g_45F6_2:
    s_mov_b64 exec, vcc
    buffer_load_dwordx4 v[32:35], v8, s[4:7], s16 offen offset:2048 sc1
    s_mov_b64 exec, -1
    s_add_u32 s23, s23, 1
    s_cmp_lt_u32 s23, 200000
    s_cbranch_scc1 g_45L6_1
    s_mov_b32 s25, 200000
    s_branch gc_46
g_45F9_0:
    s_mov_b64 exec, vcc
    buffer_load_dwordx4 v[24:27], v8, s[4:7], s16 offen offset:0 sc1
    s_mov_b64 exec, -1
    s_add_u32 s23, s23, 1
    s_cmp_lt_u32 s23, 200000
    s_cbranch_scc1 g_45L9_3
    s_mov_b32 s25, 200000
    s_branch gc_46
g_45F9_3:
    s_mov_b64 exec, vcc
    buffer_load_dwordx4 v[36:39], v8, s[4:7], s16 offen offset:3072 sc1
    s_mov_b64 exec, -1
    s_add_u32 s23, s23, 1
    s_cmp_lt_u32 s23, 200000
    s_cbranch_scc1 g_45L9_0
    s_mov_b32 s25, 200000
    s_branch gc_46
g_45F10_1:
    s_mov_b64 exec, vcc
    buffer_load_dwordx4 v[28:31], v8, s[4:7], s16 offen offset:1024 sc1
    s_mov_b64 exec, -1
    s_add_u32 s23, s23, 1
    s_cmp_lt_u32 s23, 200000
    s_cbranch_scc1 g_45L10_3
    s_mov_b32 s25, 200000
    s_branch gc_46
g_45F10_3:
    s_mov_b64 exec, vcc
    buffer_load_dwordx4 v[36:39], v8, s[4:7], s16 offen offset:3072 sc1
    s_mov_b64 exec, -1
    s_add_u32 s23, s23, 1
    s_cmp_lt_u32 s23, 200000
    s_cbranch_scc1 g_45L10_1
    s_mov_b32 s25, 200000
    s_branch gc_46
g_45F12_2:
    s_mov_b64 exec, vcc
    buffer_load_dwordx4 v[32:35], v8, s[4:7], s16 offen offset:2048 sc1
    s_mov_b64 exec, -1
    s_add_u32 s23, s23, 1
    s_cmp_lt_u32 s23, 200000
    s_cbranch_scc1 g_45L12_3
    s_mov_b32 s25, 200000
    s_branch gc_46
g_45F12_3:
    s_mov_b64 exec, vcc
    buffer_load_dwordx4 v[36:39], v8, s[4:7], s16 offen offset:3072 sc1
    s_mov_b64 exec, -1
    s_add_u32 s23, s23, 1
    s_cmp_lt_u32 s23, 200000
    s_cbranch_scc1 g_45L12_2
    s_mov_b32 s25, 200000
    s_branch gc_46
g_45F1_0:
    s_mov_b64 exec, vcc
    buffer_load_dwordx4 v[24:27], v8, s[4:7], s16 offen offset:0 sc1
    s_mov_b64 exec, -1
    s_add_u32 s23, s23, 1
    s_cmp_lt_u32 s23, 200000
    s_cbranch_scc1 g_45L1_0
    s_mov_b32 s25, 200000
    s_branch gc_46
g_45F2_1:
    s_mov_b64 exec, vcc
    buffer_load_dwordx4 v[28:31], v8, s[4:7], s16 offen offset:1024 sc1
    s_mov_b64 exec, -1
    s_add_u32 s23, s23, 1
    s_cmp_lt_u32 s23, 200000
    s_cbranch_scc1 g_45L2_1
    s_mov_b32 s25, 200000
    s_branch gc_46
g_45F4_2:
    s_mov_b64 exec, vcc
    buffer_load_dwordx4 v[32:35], v8, s[4:7], s16 offen offset:2048 sc1
    s_mov_b64 exec, -1
    s_add_u32 s23, s23, 1
    s_cmp_lt_u32 s23, 200000
    s_cbranch_scc1 g_45L4_2
    s_mov_b32 s25, 200000
    s_branch gc_46
g_45F8_3:
    s_mov_b64 exec, vcc
    buffer_load_dwordx4 v[36:39], v8, s[4:7], s16 offen offset:3072 sc1
    s_mov_b64 exec, -1
    s_add_u32 s23, s23, 1
    s_cmp_lt_u32 s23, 200000
    s_cbranch_scc1 g_45L8_3
    s_mov_b32 s25, 200000
    s_branch gc_46
.p2align 6
recur_fast_w3:
    s_nop 15
    s_mov_b32 s23, s25
    buffer_load_dwordx4 v[24:27], v2, s[4:7], s16 offen offset:0 sc1
    s_nop 11
    buffer_load_dwordx4 v[28:31], v2, s[4:7], s16 offen offset:1024 sc1
    s_nop 11
    buffer_load_dwordx4 v[32:35], v2, s[4:7], s16 offen offset:2048 sc1
    s_nop 11
    buffer_load_dwordx4 v[36:39], v2, s[4:7], s16 offen offset:3072 sc1
    s_waitcnt vmcnt(3)
    v_max3_u32 v19, v24, v25, v26
    v_max_u32 v19, v19, v27
    v_cmp_eq_u32 vcc, -1, v19
    s_nop 0
    s_cbranch_vccnz g_47F15_0
    v_smfmac_f32_16x16x64_bf16 v[40:43], v[24:27], a[0:7], v172
    s_waitcnt vmcnt(2)
    v_max3_u32 v19, v28, v29, v30
    v_max_u32 v19, v19, v31
    v_smfmac_f32_16x16x64_bf16 v[44:47], v[24:27], a[64:71], v172
    v_cmp_eq_u32 vcc, -1, v19
    v_smfmac_f32_16x16x64_bf16 v[48:51], v[24:27], a[32:39], v172
    v_smfmac_f32_16x16x64_bf16 v[52:55], v[24:27], a[96:103], v172
    s_cbranch_vccnz g_47F14_1
    v_smfmac_f32_16x16x64_bf16 v[40:43], v[28:31], a[8:15], v172
    s_waitcnt vmcnt(1)
    v_max3_u32 v19, v32, v33, v34
    v_max_u32 v19, v19, v35
    v_smfmac_f32_16x16x64_bf16 v[44:47], v[28:31], a[72:79], v172
    v_cmp_eq_u32 vcc, -1, v19
    v_smfmac_f32_16x16x64_bf16 v[48:51], v[28:31], a[40:47], v172
    v_smfmac_f32_16x16x64_bf16 v[52:55], v[28:31], a[104:111], v172
    s_cbranch_vccnz g_47F12_2
    v_smfmac_f32_16x16x64_bf16 v[40:43], v[32:35], a[16:23], v172
    s_waitcnt vmcnt(0)
    v_max3_u32 v19, v36, v37, v38
    v_max_u32 v19, v19, v39
    v_smfmac_f32_16x16x64_bf16 v[44:47], v[32:35], a[80:87], v172
    v_cmp_eq_u32 vcc, -1, v19
    v_smfmac_f32_16x16x64_bf16 v[48:51], v[32:35], a[48:55], v172
    v_smfmac_f32_16x16x64_bf16 v[52:55], v[32:35], a[112:119], v172
    s_cbranch_vccnz g_47F8_3
    v_smfmac_f32_16x16x64_bf16 v[40:43], v[36:39], a[24:31], v172
    v_smfmac_f32_16x16x64_bf16 v[44:47], v[36:39], a[88:95], v172
    v_smfmac_f32_16x16x64_bf16 v[48:51], v[36:39], a[56:63], v172
    v_smfmac_f32_16x16x64_bf16 v[52:55], v[36:39], a[120:127], v172
gc_48:
    v_cvt_pk_bf16_f32 v72, v40, v41
    v_cvt_pk_bf16_f32 v73, v42, v43
    v_cvt_pk_bf16_f32 v74, v44, v45
    v_cvt_pk_bf16_f32 v75, v46, v47
    ds_write_b128 v17, v[72:75] offset:0
    v_cvt_pk_bf16_f32 v76, v48, v49
    v_cvt_pk_bf16_f32 v77, v50, v51
    s_nop 0
    v_cvt_pk_bf16_f32 v78, v52, v53
    v_cvt_pk_bf16_f32 v79, v54, v55
    ds_write_b128 v17, v[76:79] offset:1024
    v_smfmac_f32_16x16x64_bf16 v[56:59], v[24:27], a[128:135], v172
    v_smfmac_f32_16x16x64_bf16 v[60:63], v[24:27], a[160:167], v172
    v_smfmac_f32_16x16x64_bf16 v[56:59], v[28:31], a[136:143], v172
    s_waitcnt lgkmcnt(0)
    s_barrier
    v_smfmac_f32_16x16x64_bf16 v[60:63], v[28:31], a[168:175], v172
    v_smfmac_f32_16x16x64_bf16 v[56:59], v[32:35], a[144:151], v172
    v_smfmac_f32_16x16x64_bf16 v[60:63], v[32:35], a[176:183], v172
    v_smfmac_f32_16x16x64_bf16 v[56:59], v[36:39], a[152:159], v172
    v_smfmac_f32_16x16x64_bf16 v[60:63], v[36:39], a[184:191], v172
    s_nop 4
    v_cvt_pk_bf16_f32 v80, v56, v57
    v_cvt_pk_bf16_f32 v81, v58, v59
    s_nop 0
    v_cvt_pk_bf16_f32 v82, v60, v61
    v_cvt_pk_bf16_f32 v83, v62, v63
    ds_write_b128 v17, v[80:83] offset:8192
    buffer_store_dwordx4 v[204:207], v3, s[4:7], s43 offen
    buffer_store_dwordx4 v[204:207], v3, s[4:7], s43 offen offset:128
    buffer_store_dwordx4 v[204:207], v4, s[4:7], s43 offen
    buffer_store_dwordx2 v[204:205], v7, s[4:7], s43 offen
    buffer_store_dwordx2 v[204:205], v11, s[4:7], s43 offen
    s_cmp_eq_u32 s15, 63
    s_waitcnt lgkmcnt(0)
    s_barrier
    s_cbranch_scc1 recur_end
    s_barrier
    s_nop 15
    s_mov_b32 s23, s25
    buffer_load_dwordx4 v[24:27], v8, s[4:7], s16 offen offset:0 sc1
    s_nop 11
    buffer_load_dwordx4 v[28:31], v8, s[4:7], s16 offen offset:1024 sc1
    s_nop 11
    buffer_load_dwordx4 v[32:35], v8, s[4:7], s16 offen offset:2048 sc1
    s_nop 11
    buffer_load_dwordx4 v[36:39], v8, s[4:7], s16 offen offset:3072 sc1
    s_waitcnt vmcnt(3)
    v_max3_u32 v19, v24, v25, v26
    v_max_u32 v19, v19, v27
    v_cmp_eq_u32 vcc, -1, v19
    s_nop 0
    s_cbranch_vccnz g_49F15_0
    v_smfmac_f32_16x16x64_bf16 v[64:67], v[24:27], a[192:199], v172
    v_smfmac_f32_16x16x64_bf16 v[68:71], v[24:27], a[224:231], v172
    s_waitcnt vmcnt(2)
    v_max3_u32 v19, v28, v29, v30
    v_max_u32 v19, v19, v31
    v_cmp_eq_u32 vcc, -1, v19
    s_nop 0
    s_cbranch_vccnz g_49F14_1
    v_smfmac_f32_16x16x64_bf16 v[64:67], v[28:31], a[200:207], v172
    v_smfmac_f32_16x16x64_bf16 v[68:71], v[28:31], a[232:239], v172
    s_waitcnt vmcnt(1)
    v_max3_u32 v19, v32, v33, v34
    v_max_u32 v19, v19, v35
    v_cmp_eq_u32 vcc, -1, v19
    s_nop 0
    s_cbranch_vccnz g_49F12_2
    v_smfmac_f32_16x16x64_bf16 v[64:67], v[32:35], a[208:215], v172
    v_smfmac_f32_16x16x64_bf16 v[68:71], v[32:35], a[240:247], v172
    s_waitcnt vmcnt(0)
    v_max3_u32 v19, v36, v37, v38
    v_max_u32 v19, v19, v39
    v_cmp_eq_u32 vcc, -1, v19
    s_nop 0
    s_cbranch_vccnz g_49F8_3
    v_smfmac_f32_16x16x64_bf16 v[64:67], v[36:39], a[216:223], v172
    v_smfmac_f32_16x16x64_bf16 v[68:71], v[36:39], a[248:255], v172
    s_nop 4
    v_cvt_pk_bf16_f32 v80, v64, v65
    v_cvt_pk_bf16_f32 v81, v66, v67
    s_nop 0
    v_cvt_pk_bf16_f32 v82, v68, v69
    v_cvt_pk_bf16_f32 v83, v70, v71
    s_nop 1
    v_mfma_f32_16x16x32_bf16 v[88:91], v[80:83], v[84:87], 0
gc_50:
    s_barrier
    ds_read_b128 v[96:99], v16 offset:9216
    ds_read_b128 v[100:103], v16 offset:11264
    ds_read_b128 v[104:107], v16 offset:13312
    s_waitcnt lgkmcnt(2)
    v_mfma_f32_16x16x32_bf16 v[88:91], v[96:99], v[84:87], v[88:91]
    s_waitcnt lgkmcnt(1)
    v_mfma_f32_16x16x32_bf16 v[88:91], v[100:103], v[84:87], v[88:91]
    s_waitcnt lgkmcnt(0)
    v_mfma_f32_16x16x32_bf16 v[88:91], v[104:107], v[84:87], v[88:91]
    s_nop 7
    buffer_store_dwordx4 v[88:91], v9, s[4:7], s84 offen sc1
    s_add_u32 s22, s84, 262144
    s_nop 15
    s_nop 15
    s_nop 15
    s_nop 15
    s_nop 15
    s_nop 15
    s_nop 15
    s_nop 15
    s_nop 15
    s_mov_b32 s23, s25
    buffer_load_dwordx4 v[96:99], v10, s[4:7], s84 offen sc1
    buffer_load_dwordx4 v[100:103], v23, s[4:7], s84 offen sc1
    buffer_load_dwordx4 v[104:107], v244, s[4:7], s84 offen sc1
    v_mov_b32 v40, 0
    v_mov_b32 v41, 0
    v_mov_b32 v42, 0
    v_mov_b32 v43, 0
    v_mov_b32 v44, 0
    v_mov_b32 v45, 0
    v_mov_b32 v46, 0
    v_mov_b32 v47, 0
    v_mov_b32 v48, 0
    v_mov_b32 v49, 0
    v_mov_b32 v50, 0
    v_mov_b32 v51, 0
    v_mov_b32 v52, 0
    v_mov_b32 v53, 0
    v_mov_b32 v54, 0
    v_mov_b32 v55, 0
    v_mov_b32 v56, 0
    v_mov_b32 v57, 0
    v_mov_b32 v58, 0
    v_mov_b32 v59, 0
    v_mov_b32 v60, 0
    v_mov_b32 v61, 0
    v_mov_b32 v62, 0
    v_mov_b32 v63, 0
    v_mov_b32 v64, 0
    v_mov_b32 v65, 0
    v_mov_b32 v66, 0
    v_mov_b32 v67, 0
    v_mov_b32 v68, 0
    v_mov_b32 v69, 0
    v_mov_b32 v70, 0
    v_mov_b32 v71, 0
pb_53:
    s_waitcnt vmcnt(2)
    v_pk_add_f32 v[120:121], v[88:89], v[96:97]
    v_pk_add_f32 v[122:123], v[90:91], v[98:99]
    s_waitcnt vmcnt(1)
    v_pk_add_f32 v[120:121], v[120:121], v[100:101]
    v_pk_add_f32 v[122:123], v[122:123], v[102:103]
    s_waitcnt vmcnt(0)
    v_pk_add_f32 v[120:121], v[120:121], v[104:105]
    v_pk_add_f32 v[122:123], v[122:123], v[106:107]
    v_cvt_pk_bf16_f32 v180, v120, v121
    v_pk_add_f32 v[124:125], v[120:121], v[122:123]
    v_cvt_pk_bf16_f32 v181, v122, v123
    v_cmpx_o_f32 vcc, v124, v125
    buffer_store_dwordx2 v[180:181], v11, s[4:7], s42 offen
    s_cmp_eq_u64 vcc, -1
    s_mov_b64 exec, -1
    s_cbranch_scc0 pr_51
pg_52:
    s_barrier
    s_mov_b32 s21, s16
    s_mov_b32 s16, s42
    s_mov_b32 s42, s43
    s_mov_b32 s43, s44
    s_mov_b32 s44, s21
    s_add_u32 s95, s95, 524288
    s_lshr_b32 s84, s95, 8
    s_and_b32 s84, s84, 8192
    s_xor_b32 s84, s84, s46
    s_add_u32 s84, s84, s95
    s_add_u32 s15, s15, 1
    s_branch recur_fast_w3
g_47L15_0:
    s_waitcnt vmcnt(3)
    v_max3_u32 v19, v24, v25, v26
    v_max_u32 v19, v19, v27
    v_cmp_eq_u32 vcc, -1, v19
    s_nop 0
    s_cbranch_vccnz g_47F15_0
    v_smfmac_f32_16x16x64_bf16 v[40:43], v[24:27], a[0:7], v172
    v_smfmac_f32_16x16x64_bf16 v[44:47], v[24:27], a[64:71], v172
    v_smfmac_f32_16x16x64_bf16 v[48:51], v[24:27], a[32:39], v172
    v_smfmac_f32_16x16x64_bf16 v[52:55], v[24:27], a[96:103], v172
g_47L14_1:
    s_waitcnt vmcnt(2)
    v_max3_u32 v19, v28, v29, v30
    v_max_u32 v19, v19, v31
    v_cmp_eq_u32 vcc, -1, v19
    s_nop 0
    s_cbranch_vccnz g_47F14_1
    v_smfmac_f32_16x16x64_bf16 v[40:43], v[28:31], a[8:15], v172
    v_smfmac_f32_16x16x64_bf16 v[44:47], v[28:31], a[72:79], v172
    v_smfmac_f32_16x16x64_bf16 v[48:51], v[28:31], a[40:47], v172
    v_smfmac_f32_16x16x64_bf16 v[52:55], v[28:31], a[104:111], v172
g_47L12_2:
    s_waitcnt vmcnt(1)
    v_max3_u32 v19, v32, v33, v34
    v_max_u32 v19, v19, v35
    v_cmp_eq_u32 vcc, -1, v19
    s_nop 0
    s_cbranch_vccnz g_47F12_2
    v_smfmac_f32_16x16x64_bf16 v[40:43], v[32:35], a[16:23], v172
    v_smfmac_f32_16x16x64_bf16 v[44:47], v[32:35], a[80:87], v172
    v_smfmac_f32_16x16x64_bf16 v[48:51], v[32:35], a[48:55], v172
    v_smfmac_f32_16x16x64_bf16 v[52:55], v[32:35], a[112:119], v172
g_47L8_3:
    s_waitcnt vmcnt(0)
    v_max3_u32 v19, v36, v37, v38
    v_max_u32 v19, v19, v39
    v_cmp_eq_u32 vcc, -1, v19
    s_nop 0
    s_cbranch_vccnz g_47F8_3
    v_smfmac_f32_16x16x64_bf16 v[40:43], v[36:39], a[24:31], v172
    v_smfmac_f32_16x16x64_bf16 v[44:47], v[36:39], a[88:95], v172
    v_smfmac_f32_16x16x64_bf16 v[48:51], v[36:39], a[56:63], v172
    v_smfmac_f32_16x16x64_bf16 v[52:55], v[36:39], a[120:127], v172
    s_branch gc_48
g_47L15_1:
    s_waitcnt vmcnt(3)
    v_max3_u32 v19, v28, v29, v30
    v_max_u32 v19, v19, v31
    v_cmp_eq_u32 vcc, -1, v19
    s_nop 0
    s_cbranch_vccnz g_47F15_1
    v_smfmac_f32_16x16x64_bf16 v[40:43], v[28:31], a[8:15], v172
    v_smfmac_f32_16x16x64_bf16 v[44:47], v[28:31], a[72:79], v172
    v_smfmac_f32_16x16x64_bf16 v[48:51], v[28:31], a[40:47], v172
    v_smfmac_f32_16x16x64_bf16 v[52:55], v[28:31], a[104:111], v172
g_47L13_2:
    s_waitcnt vmcnt(2)
    v_max3_u32 v19, v32, v33, v34
    v_max_u32 v19, v19, v35
    v_cmp_eq_u32 vcc, -1, v19
    s_nop 0
    s_cbranch_vccnz g_47F13_2
    v_smfmac_f32_16x16x64_bf16 v[40:43], v[32:35], a[16:23], v172
    v_smfmac_f32_16x16x64_bf16 v[44:47], v[32:35], a[80:87], v172
    v_smfmac_f32_16x16x64_bf16 v[48:51], v[32:35], a[48:55], v172
    v_smfmac_f32_16x16x64_bf16 v[52:55], v[32:35], a[112:119], v172
g_47L9_3:
    s_waitcnt vmcnt(1)
    v_max3_u32 v19, v36, v37, v38
    v_max_u32 v19, v19, v39
    v_cmp_eq_u32 vcc, -1, v19
    s_nop 0
    s_cbranch_vccnz g_47F9_3
    v_smfmac_f32_16x16x64_bf16 v[40:43], v[36:39], a[24:31], v172
    v_smfmac_f32_16x16x64_bf16 v[44:47], v[36:39], a[88:95], v172
    v_smfmac_f32_16x16x64_bf16 v[48:51], v[36:39], a[56:63], v172
    v_smfmac_f32_16x16x64_bf16 v[52:55], v[36:39], a[120:127], v172
g_47L1_0:
    s_waitcnt vmcnt(0)
    v_max3_u32 v19, v24, v25, v26
    v_max_u32 v19, v19, v27
    v_cmp_eq_u32 vcc, -1, v19
    s_nop 0
    s_cbranch_vccnz g_47F1_0
    v_smfmac_f32_16x16x64_bf16 v[40:43], v[24:27], a[0:7], v172
    v_smfmac_f32_16x16x64_bf16 v[44:47], v[24:27], a[64:71], v172
    v_smfmac_f32_16x16x64_bf16 v[48:51], v[24:27], a[32:39], v172
    v_smfmac_f32_16x16x64_bf16 v[52:55], v[24:27], a[96:103], v172
    s_branch gc_48
g_47L15_2:
    s_waitcnt vmcnt(3)
    v_max3_u32 v19, v32, v33, v34
    v_max_u32 v19, v19, v35
    v_cmp_eq_u32 vcc, -1, v19
    s_nop 0
    s_cbranch_vccnz g_47F15_2
    v_smfmac_f32_16x16x64_bf16 v[40:43], v[32:35], a[16:23], v172
    v_smfmac_f32_16x16x64_bf16 v[44:47], v[32:35], a[80:87], v172
    v_smfmac_f32_16x16x64_bf16 v[48:51], v[32:35], a[48:55], v172
    v_smfmac_f32_16x16x64_bf16 v[52:55], v[32:35], a[112:119], v172
g_47L11_3:
    s_waitcnt vmcnt(2)
    v_max3_u32 v19, v36, v37, v38
    v_max_u32 v19, v19, v39
    v_cmp_eq_u32 vcc, -1, v19
    s_nop 0
    s_cbranch_vccnz g_47F11_3
    v_smfmac_f32_16x16x64_bf16 v[40:43], v[36:39], a[24:31], v172
    v_smfmac_f32_16x16x64_bf16 v[44:47], v[36:39], a[88:95], v172
    v_smfmac_f32_16x16x64_bf16 v[48:51], v[36:39], a[56:63], v172
    v_smfmac_f32_16x16x64_bf16 v[52:55], v[36:39], a[120:127], v172
g_47L3_0:
    s_waitcnt vmcnt(1)
    v_max3_u32 v19, v24, v25, v26
    v_max_u32 v19, v19, v27
    v_cmp_eq_u32 vcc, -1, v19
    s_nop 0
    s_cbranch_vccnz g_47F3_0
    v_smfmac_f32_16x16x64_bf16 v[40:43], v[24:27], a[0:7], v172
    v_smfmac_f32_16x16x64_bf16 v[44:47], v[24:27], a[64:71], v172
    v_smfmac_f32_16x16x64_bf16 v[48:51], v[24:27], a[32:39], v172
    v_smfmac_f32_16x16x64_bf16 v[52:55], v[24:27], a[96:103], v172
g_47L2_1:
    s_waitcnt vmcnt(0)
    v_max3_u32 v19, v28, v29, v30
    v_max_u32 v19, v19, v31
    v_cmp_eq_u32 vcc, -1, v19
    s_nop 0
    s_cbranch_vccnz g_47F2_1
    v_smfmac_f32_16x16x64_bf16 v[40:43], v[28:31], a[8:15], v172
    v_smfmac_f32_16x16x64_bf16 v[44:47], v[28:31], a[72:79], v172
    v_smfmac_f32_16x16x64_bf16 v[48:51], v[28:31], a[40:47], v172
    v_smfmac_f32_16x16x64_bf16 v[52:55], v[28:31], a[104:111], v172
    s_branch gc_48
g_47L15_3:
    s_waitcnt vmcnt(3)
    v_max3_u32 v19, v36, v37, v38
    v_max_u32 v19, v19, v39
    v_cmp_eq_u32 vcc, -1, v19
    s_nop 0
    s_cbranch_vccnz g_47F15_3
    v_smfmac_f32_16x16x64_bf16 v[40:43], v[36:39], a[24:31], v172
    v_smfmac_f32_16x16x64_bf16 v[44:47], v[36:39], a[88:95], v172
    v_smfmac_f32_16x16x64_bf16 v[48:51], v[36:39], a[56:63], v172
    v_smfmac_f32_16x16x64_bf16 v[52:55], v[36:39], a[120:127], v172
g_47L7_0:
    s_waitcnt vmcnt(2)
    v_max3_u32 v19, v24, v25, v26
    v_max_u32 v19, v19, v27
    v_cmp_eq_u32 vcc, -1, v19
    s_nop 0
    s_cbranch_vccnz g_47F7_0
    v_smfmac_f32_16x16x64_bf16 v[40:43], v[24:27], a[0:7], v172
    v_smfmac_f32_16x16x64_bf16 v[44:47], v[24:27], a[64:71], v172
    v_smfmac_f32_16x16x64_bf16 v[48:51], v[24:27], a[32:39], v172
    v_smfmac_f32_16x16x64_bf16 v[52:55], v[24:27], a[96:103], v172
g_47L6_1:
    s_waitcnt vmcnt(1)
    v_max3_u32 v19, v28, v29, v30
    v_max_u32 v19, v19, v31
    v_cmp_eq_u32 vcc, -1, v19
    s_nop 0
    s_cbranch_vccnz g_47F6_1
    v_smfmac_f32_16x16x64_bf16 v[40:43], v[28:31], a[8:15], v172
    v_smfmac_f32_16x16x64_bf16 v[44:47], v[28:31], a[72:79], v172
    v_smfmac_f32_16x16x64_bf16 v[48:51], v[28:31], a[40:47], v172
    v_smfmac_f32_16x16x64_bf16 v[52:55], v[28:31], a[104:111], v172
g_47L4_2:
    s_waitcnt vmcnt(0)
    v_max3_u32 v19, v32, v33, v34
    v_max_u32 v19, v19, v35
    v_cmp_eq_u32 vcc, -1, v19
    s_nop 0
    s_cbranch_vccnz g_47F4_2
    v_smfmac_f32_16x16x64_bf16 v[40:43], v[32:35], a[16:23], v172
    v_smfmac_f32_16x16x64_bf16 v[44:47], v[32:35], a[80:87], v172
    v_smfmac_f32_16x16x64_bf16 v[48:51], v[32:35], a[48:55], v172
    v_smfmac_f32_16x16x64_bf16 v[52:55], v[32:35], a[112:119], v172
    s_branch gc_48
g_47L7_1:
    s_waitcnt vmcnt(2)
    v_max3_u32 v19, v28, v29, v30
    v_max_u32 v19, v19, v31
    v_cmp_eq_u32 vcc, -1, v19
    s_nop 0
    s_cbranch_vccnz g_47F7_1
    v_smfmac_f32_16x16x64_bf16 v[40:43], v[28:31], a[8:15], v172
    v_smfmac_f32_16x16x64_bf16 v[44:47], v[28:31], a[72:79], v172
    v_smfmac_f32_16x16x64_bf16 v[48:51], v[28:31], a[40:47], v172
    v_smfmac_f32_16x16x64_bf16 v[52:55], v[28:31], a[104:111], v172
g_47L5_2:
    s_waitcnt vmcnt(1)
    v_max3_u32 v19, v32, v33, v34
    v_max_u32 v19, v19, v35
    v_cmp_eq_u32 vcc, -1, v19
    s_nop 0
    s_cbranch_vccnz g_47F5_2
    v_smfmac_f32_16x16x64_bf16 v[40:43], v[32:35], a[16:23], v172
    v_smfmac_f32_16x16x64_bf16 v[44:47], v[32:35], a[80:87], v172
    v_smfmac_f32_16x16x64_bf16 v[48:51], v[32:35], a[48:55], v172
    v_smfmac_f32_16x16x64_bf16 v[52:55], v[32:35], a[112:119], v172
    s_branch g_47L1_0
g_47L7_2:
    s_waitcnt vmcnt(2)
    v_max3_u32 v19, v32, v33, v34
    v_max_u32 v19, v19, v35
    v_cmp_eq_u32 vcc, -1, v19
    s_nop 0
    s_cbranch_vccnz g_47F7_2
    v_smfmac_f32_16x16x64_bf16 v[40:43], v[32:35], a[16:23], v172
    v_smfmac_f32_16x16x64_bf16 v[44:47], v[32:35], a[80:87], v172
    v_smfmac_f32_16x16x64_bf16 v[48:51], v[32:35], a[48:55], v172
    v_smfmac_f32_16x16x64_bf16 v[52:55], v[32:35], a[112:119], v172
    s_branch g_47L3_0
g_47L11_0:
    s_waitcnt vmcnt(2)
    v_max3_u32 v19, v24, v25, v26
    v_max_u32 v19, v19, v27
    v_cmp_eq_u32 vcc, -1, v19
    s_nop 0
    s_cbranch_vccnz g_47F11_0
    v_smfmac_f32_16x16x64_bf16 v[40:43], v[24:27], a[0:7], v172
    v_smfmac_f32_16x16x64_bf16 v[44:47], v[24:27], a[64:71], v172
    v_smfmac_f32_16x16x64_bf16 v[48:51], v[24:27], a[32:39], v172
    v_smfmac_f32_16x16x64_bf16 v[52:55], v[24:27], a[96:103], v172
g_47L10_1:
    s_waitcnt vmcnt(1)
    v_max3_u32 v19, v28, v29, v30
    v_max_u32 v19, v19, v31
    v_cmp_eq_u32 vcc, -1, v19
    s_nop 0
    s_cbranch_vccnz g_47F10_1
    v_smfmac_f32_16x16x64_bf16 v[40:43], v[28:31], a[8:15], v172
    v_smfmac_f32_16x16x64_bf16 v[44:47], v[28:31], a[72:79], v172
    v_smfmac_f32_16x16x64_bf16 v[48:51], v[28:31], a[40:47], v172
    v_smfmac_f32_16x16x64_bf16 v[52:55], v[28:31], a[104:111], v172
    s_branch g_47L8_3
g_47L11_1:
    s_waitcnt vmcnt(2)
    v_max3_u32 v19, v28, v29, v30
    v_max_u32 v19, v19, v31
    v_cmp_eq_u32 vcc, -1, v19
    s_nop 0
    s_cbranch_vccnz g_47F11_1
    v_smfmac_f32_16x16x64_bf16 v[40:43], v[28:31], a[8:15], v172
    v_smfmac_f32_16x16x64_bf16 v[44:47], v[28:31], a[72:79], v172
    v_smfmac_f32_16x16x64_bf16 v[48:51], v[28:31], a[40:47], v172
    v_smfmac_f32_16x16x64_bf16 v[52:55], v[28:31], a[104:111], v172
    s_branch g_47L9_3
g_47L13_0:
    s_waitcnt vmcnt(2)
    v_max3_u32 v19, v24, v25, v26
    v_max_u32 v19, v19, v27
    v_cmp_eq_u32 vcc, -1, v19
    s_nop 0
    s_cbranch_vccnz g_47F13_0
    v_smfmac_f32_16x16x64_bf16 v[40:43], v[24:27], a[0:7], v172
    v_smfmac_f32_16x16x64_bf16 v[44:47], v[24:27], a[64:71], v172
    v_smfmac_f32_16x16x64_bf16 v[48:51], v[24:27], a[32:39], v172
    v_smfmac_f32_16x16x64_bf16 v[52:55], v[24:27], a[96:103], v172
    s_branch g_47L12_2
g_47L13_3:
    s_waitcnt vmcnt(2)
    v_max3_u32 v19, v36, v37, v38
    v_max_u32 v19, v19, v39
    v_cmp_eq_u32 vcc, -1, v19
    s_nop 0
    s_cbranch_vccnz g_47F13_3
    v_smfmac_f32_16x16x64_bf16 v[40:43], v[36:39], a[24:31], v172
    v_smfmac_f32_16x16x64_bf16 v[44:47], v[36:39], a[88:95], v172
    v_smfmac_f32_16x16x64_bf16 v[48:51], v[36:39], a[56:63], v172
    v_smfmac_f32_16x16x64_bf16 v[52:55], v[36:39], a[120:127], v172
g_47L5_0:
    s_waitcnt vmcnt(1)
    v_max3_u32 v19, v24, v25, v26
    v_max_u32 v19, v19, v27
    v_cmp_eq_u32 vcc, -1, v19
    s_nop 0
    s_cbranch_vccnz g_47F5_0
    v_smfmac_f32_16x16x64_bf16 v[40:43], v[24:27], a[0:7], v172
    v_smfmac_f32_16x16x64_bf16 v[44:47], v[24:27], a[64:71], v172
    v_smfmac_f32_16x16x64_bf16 v[48:51], v[24:27], a[32:39], v172
    v_smfmac_f32_16x16x64_bf16 v[52:55], v[24:27], a[96:103], v172
    s_branch g_47L4_2
g_47L14_2:
    s_waitcnt vmcnt(2)
    v_max3_u32 v19, v32, v33, v34
    v_max_u32 v19, v19, v35
    v_cmp_eq_u32 vcc, -1, v19
    s_nop 0
    s_cbranch_vccnz g_47F14_2
    v_smfmac_f32_16x16x64_bf16 v[40:43], v[32:35], a[16:23], v172
    v_smfmac_f32_16x16x64_bf16 v[44:47], v[32:35], a[80:87], v172
    v_smfmac_f32_16x16x64_bf16 v[48:51], v[32:35], a[48:55], v172
    v_smfmac_f32_16x16x64_bf16 v[52:55], v[32:35], a[112:119], v172
g_47L10_3:
    s_waitcnt vmcnt(1)
    v_max3_u32 v19, v36, v37, v38
    v_max_u32 v19, v19, v39
    v_cmp_eq_u32 vcc, -1, v19
    s_nop 0
    s_cbranch_vccnz g_47F10_3
    v_smfmac_f32_16x16x64_bf16 v[40:43], v[36:39], a[24:31], v172
    v_smfmac_f32_16x16x64_bf16 v[44:47], v[36:39], a[88:95], v172
    v_smfmac_f32_16x16x64_bf16 v[48:51], v[36:39], a[56:63], v172
    v_smfmac_f32_16x16x64_bf16 v[52:55], v[36:39], a[120:127], v172
    s_branch g_47L2_1
g_47L14_3:
    s_waitcnt vmcnt(2)
    v_max3_u32 v19, v36, v37, v38
    v_max_u32 v19, v19, v39
    v_cmp_eq_u32 vcc, -1, v19
    s_nop 0
    s_cbranch_vccnz g_47F14_3
    v_smfmac_f32_16x16x64_bf16 v[40:43], v[36:39], a[24:31], v172
    v_smfmac_f32_16x16x64_bf16 v[44:47], v[36:39], a[88:95], v172
    v_smfmac_f32_16x16x64_bf16 v[48:51], v[36:39], a[56:63], v172
    v_smfmac_f32_16x16x64_bf16 v[52:55], v[36:39], a[120:127], v172
    s_branch g_47L6_1
g_47L3_1:
    s_waitcnt vmcnt(1)
    v_max3_u32 v19, v28, v29, v30
    v_max_u32 v19, v19, v31
    v_cmp_eq_u32 vcc, -1, v19
    s_nop 0
    s_cbranch_vccnz g_47F3_1
    v_smfmac_f32_16x16x64_bf16 v[40:43], v[28:31], a[8:15], v172
    v_smfmac_f32_16x16x64_bf16 v[44:47], v[28:31], a[72:79], v172
    v_smfmac_f32_16x16x64_bf16 v[48:51], v[28:31], a[40:47], v172
    v_smfmac_f32_16x16x64_bf16 v[52:55], v[28:31], a[104:111], v172
    s_branch g_47L1_0
g_47L6_2:
    s_waitcnt vmcnt(1)
    v_max3_u32 v19, v32, v33, v34
    v_max_u32 v19, v19, v35
    v_cmp_eq_u32 vcc, -1, v19
    s_nop 0
    s_cbranch_vccnz g_47F6_2
    v_smfmac_f32_16x16x64_bf16 v[40:43], v[32:35], a[16:23], v172
    v_smfmac_f32_16x16x64_bf16 v[44:47], v[32:35], a[80:87], v172
    v_smfmac_f32_16x16x64_bf16 v[48:51], v[32:35], a[48:55], v172
    v_smfmac_f32_16x16x64_bf16 v[52:55], v[32:35], a[112:119], v172
    s_branch g_47L2_1
g_47L9_0:
    s_waitcnt vmcnt(1)
    v_max3_u32 v19, v24, v25, v26
    v_max_u32 v19, v19, v27
    v_cmp_eq_u32 vcc, -1, v19
    s_nop 0
    s_cbranch_vccnz g_47F9_0
    v_smfmac_f32_16x16x64_bf16 v[40:43], v[24:27], a[0:7], v172
    v_smfmac_f32_16x16x64_bf16 v[44:47], v[24:27], a[64:71], v172
    v_smfmac_f32_16x16x64_bf16 v[48:51], v[24:27], a[32:39], v172
    v_smfmac_f32_16x16x64_bf16 v[52:55], v[24:27], a[96:103], v172
    s_branch g_47L8_3
g_47L12_3:
    s_waitcnt vmcnt(1)
    v_max3_u32 v19, v36, v37, v38
    v_max_u32 v19, v19, v39
    v_cmp_eq_u32 vcc, -1, v19
    s_nop 0
    s_cbranch_vccnz g_47F12_3
    v_smfmac_f32_16x16x64_bf16 v[40:43], v[36:39], a[24:31], v172
    v_smfmac_f32_16x16x64_bf16 v[44:47], v[36:39], a[88:95], v172
    v_smfmac_f32_16x16x64_bf16 v[48:51], v[36:39], a[56:63], v172
    v_smfmac_f32_16x16x64_bf16 v[52:55], v[36:39], a[120:127], v172
    s_branch g_47L4_2
g_47F15_0:
    s_mov_b64 exec, vcc
    buffer_load_dwordx4 v[24:27], v2, s[4:7], s16 offen offset:0 sc1
    s_mov_b64 exec, -1
    s_add_u32 s23, s23, 1
    s_cmp_lt_u32 s23, 200000
    s_cbranch_scc1 g_47L15_1
    s_mov_b32 s25, 200000
    s_branch gc_48
g_47F15_1:
    s_mov_b64 exec, vcc
    buffer_load_dwordx4 v[28:31], v2, s[4:7], s16 offen offset:1024 sc1
    s_mov_b64 exec, -1
    s_add_u32 s23, s23, 1
    s_cmp_lt_u32 s23, 200000
    s_cbranch_scc1 g_47L15_2
    s_mov_b32 s25, 200000
    s_branch gc_48
g_47F15_2:
    s_mov_b64 exec, vcc
    buffer_load_dwordx4 v[32:35], v2, s[4:7], s16 offen offset:2048 sc1
    s_mov_b64 exec, -1
    s_add_u32 s23, s23, 1
    s_cmp_lt_u32 s23, 200000
    s_cbranch_scc1 g_47L15_3
    s_mov_b32 s25, 200000
    s_branch gc_48
g_47F15_3:
    s_mov_b64 exec, vcc
    buffer_load_dwordx4 v[36:39], v2, s[4:7], s16 offen offset:3072 sc1
    s_mov_b64 exec, -1
    s_add_u32 s23, s23, 1
    s_cmp_lt_u32 s23, 200000
    s_cbranch_scc1 g_47L15_0
    s_mov_b32 s25, 200000
    s_branch gc_48
g_47F7_0:
    s_mov_b64 exec, vcc
    buffer_load_dwordx4 v[24:27], v2, s[4:7], s16 offen offset:0 sc1
    s_mov_b64 exec, -1
    s_add_u32 s23, s23, 1
    s_cmp_lt_u32 s23, 200000
    s_cbranch_scc1 g_47L7_1
    s_mov_b32 s25, 200000
    s_branch gc_48
g_47F7_1:
    s_mov_b64 exec, vcc
    buffer_load_dwordx4 v[28:31], v2, s[4:7], s16 offen offset:1024 sc1
    s_mov_b64 exec, -1
    s_add_u32 s23, s23, 1
    s_cmp_lt_u32 s23, 200000
    s_cbranch_scc1 g_47L7_2
    s_mov_b32 s25, 200000
    s_branch gc_48
g_47F7_2:
    s_mov_b64 exec, vcc
    buffer_load_dwordx4 v[32:35], v2, s[4:7], s16 offen offset:2048 sc1
    s_mov_b64 exec, -1
    s_add_u32 s23, s23, 1
    s_cmp_lt_u32 s23, 200000
    s_cbranch_scc1 g_47L7_0
    s_mov_b32 s25, 200000
    s_branch gc_48
g_47F11_0:
    s_mov_b64 exec, vcc
    buffer_load_dwordx4 v[24:27], v2, s[4:7], s16 offen offset:0 sc1
    s_mov_b64 exec, -1
    s_add_u32 s23, s23, 1
    s_cmp_lt_u32 s23, 200000
    s_cbranch_scc1 g_47L11_1
    s_mov_b32 s25, 200000
    s_branch gc_48
g_47F11_1:
    s_mov_b64 exec, vcc
    buffer_load_dwordx4 v[28:31], v2, s[4:7], s16 offen offset:1024 sc1
    s_mov_b64 exec, -1
    s_add_u32 s23, s23, 1
    s_cmp_lt_u32 s23, 200000
    s_cbranch_scc1 g_47L11_3
    s_mov_b32 s25, 200000
    s_branch gc_48
g_47F11_3:
    s_mov_b64 exec, vcc
    buffer_load_dwordx4 v[36:39], v2, s[4:7], s16 offen offset:3072 sc1
    s_mov_b64 exec, -1
    s_add_u32 s23, s23, 1
    s_cmp_lt_u32 s23, 200000
    s_cbranch_scc1 g_47L11_0
    s_mov_b32 s25, 200000
    s_branch gc_48
g_47F13_0:
    s_mov_b64 exec, vcc
    buffer_load_dwordx4 v[24:27], v2, s[4:7], s16 offen offset:0 sc1
    s_mov_b64 exec, -1
    s_add_u32 s23, s23, 1
    s_cmp_lt_u32 s23, 200000
    s_cbranch_scc1 g_47L13_2
    s_mov_b32 s25, 200000
    s_branch gc_48
g_47F13_2:
    s_mov_b64 exec, vcc
    buffer_load_dwordx4 v[32:35], v2, s[4:7], s16 offen offset:2048 sc1
    s_mov_b64 exec, -1
    s_add_u32 s23, s23, 1
    s_cmp_lt_u32 s23, 200000
    s_cbranch_scc1 g_47L13_3
    s_mov_b32 s25, 200000
    s_branch gc_48
g_47F13_3:
    s_mov_b64 exec, vcc
    buffer_load_dwordx4 v[36:39], v2, s[4:7], s16 offen offset:3072 sc1
    s_mov_b64 exec, -1
    s_add_u32 s23, s23, 1
    s_cmp_lt_u32 s23, 200000
    s_cbranch_scc1 g_47L13_0
    s_mov_b32 s25, 200000
    s_branch gc_48
g_47F14_1:
    s_mov_b64 exec, vcc
    buffer_load_dwordx4 v[28:31], v2, s[4:7], s16 offen offset:1024 sc1
    s_mov_b64 exec, -1
    s_add_u32 s23, s23, 1
    s_cmp_lt_u32 s23, 200000
    s_cbranch_scc1 g_47L14_2
    s_mov_b32 s25, 200000
    s_branch gc_48
g_47F14_2:
    s_mov_b64 exec, vcc
    buffer_load_dwordx4 v[32:35], v2, s[4:7], s16 offen offset:2048 sc1
    s_mov_b64 exec, -1
    s_add_u32 s23, s23, 1
    s_cmp_lt_u32 s23, 200000
    s_cbranch_scc1 g_47L14_3
    s_mov_b32 s25, 200000
    s_branch gc_48
g_47F14_3:
    s_mov_b64 exec, vcc
    buffer_load_dwordx4 v[36:39], v2, s[4:7], s16 offen offset:3072 sc1
    s_mov_b64 exec, -1
    s_add_u32 s23, s23, 1
    s_cmp_lt_u32 s23, 200000
    s_cbranch_scc1 g_47L14_1
    s_mov_b32 s25, 200000
    s_branch gc_48
g_47F3_0:
    s_mov_b64 exec, vcc
    buffer_load_dwordx4 v[24:27], v2, s[4:7], s16 offen offset:0 sc1
    s_mov_b64 exec, -1
    s_add_u32 s23, s23, 1
    s_cmp_lt_u32 s23, 200000
    s_cbranch_scc1 g_47L3_1
    s_mov_b32 s25, 200000
    s_branch gc_48
g_47F3_1:
    s_mov_b64 exec, vcc
    buffer_load_dwordx4 v[28:31], v2, s[4:7], s16 offen offset:1024 sc1
    s_mov_b64 exec, -1
    s_add_u32 s23, s23, 1
    s_cmp_lt_u32 s23, 200000
    s_cbranch_scc1 g_47L3_0
    s_mov_b32 s25, 200000
    s_branch gc_48
g_47F5_0:
    s_mov_b64 exec, vcc
    buffer_load_dwordx4 v[24:27], v2, s[4:7], s16 offen offset:0 sc1
    s_mov_b64 exec, -1
    s_add_u32 s23, s23, 1
    s_cmp_lt_u32 s23, 200000
    s_cbranch_scc1 g_47L5_2
    s_mov_b32 s25, 200000
    s_branch gc_48
g_47F5_2:
    s_mov_b64 exec, vcc
    buffer_load_dwordx4 v[32:35], v2, s[4:7], s16 offen offset:2048 sc1
    s_mov_b64 exec, -1
    s_add_u32 s23, s23, 1
    s_cmp_lt_u32 s23, 200000
    s_cbranch_scc1 g_47L5_0
    s_mov_b32 s25, 200000
    s_branch gc_48
g_47F6_1:
    s_mov_b64 exec, vcc
    buffer_load_dwordx4 v[28:31], v2, s[4:7], s16 offen offset:1024 sc1
    s_mov_b64 exec, -1
    s_add_u32 s23, s23, 1
    s_cmp_lt_u32 s23, 200000
    s_cbranch_scc1 g_47L6_2
    s_mov_b32 s25, 200000
    s_branch gc_48
g_47F6_2:
    s_mov_b64 exec, vcc
    buffer_load_dwordx4 v[32:35], v2, s[4:7], s16 offen offset:2048 sc1
    s_mov_b64 exec, -1
    s_add_u32 s23, s23, 1
    s_cmp_lt_u32 s23, 200000
    s_cbranch_scc1 g_47L6_1
    s_mov_b32 s25, 200000
    s_branch gc_48
g_47F9_0:
    s_mov_b64 exec, vcc
    buffer_load_dwordx4 v[24:27], v2, s[4:7], s16 offen offset:0 sc1
    s_mov_b64 exec, -1
    s_add_u32 s23, s23, 1
    s_cmp_lt_u32 s23, 200000
    s_cbranch_scc1 g_47L9_3
    s_mov_b32 s25, 200000
    s_branch gc_48
g_47F9_3:
    s_mov_b64 exec, vcc
    buffer_load_dwordx4 v[36:39], v2, s[4:7], s16 offen offset:3072 sc1
    s_mov_b64 exec, -1
    s_add_u32 s23, s23, 1
    s_cmp_lt_u32 s23, 200000
    s_cbranch_scc1 g_47L9_0
    s_mov_b32 s25, 200000
    s_branch gc_48
g_47F10_1:
    s_mov_b64 exec, vcc
    buffer_load_dwordx4 v[28:31], v2, s[4:7], s16 offen offset:1024 sc1
    s_mov_b64 exec, -1
    s_add_u32 s23, s23, 1
    s_cmp_lt_u32 s23, 200000
    s_cbranch_scc1 g_47L10_3
    s_mov_b32 s25, 200000
    s_branch gc_48
g_47F10_3:
    s_mov_b64 exec, vcc
    buffer_load_dwordx4 v[36:39], v2, s[4:7], s16 offen offset:3072 sc1
    s_mov_b64 exec, -1
    s_add_u32 s23, s23, 1
    s_cmp_lt_u32 s23, 200000
    s_cbranch_scc1 g_47L10_1
    s_mov_b32 s25, 200000
    s_branch gc_48
g_47F12_2:
    s_mov_b64 exec, vcc
    buffer_load_dwordx4 v[32:35], v2, s[4:7], s16 offen offset:2048 sc1
    s_mov_b64 exec, -1
    s_add_u32 s23, s23, 1
    s_cmp_lt_u32 s23, 200000
    s_cbranch_scc1 g_47L12_3
    s_mov_b32 s25, 200000
    s_branch gc_48
g_47F12_3:
    s_mov_b64 exec, vcc
    buffer_load_dwordx4 v[36:39], v2, s[4:7], s16 offen offset:3072 sc1
    s_mov_b64 exec, -1
    s_add_u32 s23, s23, 1
    s_cmp_lt_u32 s23, 200000
    s_cbranch_scc1 g_47L12_2
    s_mov_b32 s25, 200000
    s_branch gc_48
g_47F1_0:
    s_mov_b64 exec, vcc
    buffer_load_dwordx4 v[24:27], v2, s[4:7], s16 offen offset:0 sc1
    s_mov_b64 exec, -1
    s_add_u32 s23, s23, 1
    s_cmp_lt_u32 s23, 200000
    s_cbranch_scc1 g_47L1_0
    s_mov_b32 s25, 200000
    s_branch gc_48
g_47F2_1:
    s_mov_b64 exec, vcc
    buffer_load_dwordx4 v[28:31], v2, s[4:7], s16 offen offset:1024 sc1
    s_mov_b64 exec, -1
    s_add_u32 s23, s23, 1
    s_cmp_lt_u32 s23, 200000
    s_cbranch_scc1 g_47L2_1
    s_mov_b32 s25, 200000
    s_branch gc_48
g_47F4_2:
    s_mov_b64 exec, vcc
    buffer_load_dwordx4 v[32:35], v2, s[4:7], s16 offen offset:2048 sc1
    s_mov_b64 exec, -1
    s_add_u32 s23, s23, 1
    s_cmp_lt_u32 s23, 200000
    s_cbranch_scc1 g_47L4_2
    s_mov_b32 s25, 200000
    s_branch gc_48
g_47F8_3:
    s_mov_b64 exec, vcc
    buffer_load_dwordx4 v[36:39], v2, s[4:7], s16 offen offset:3072 sc1
    s_mov_b64 exec, -1
    s_add_u32 s23, s23, 1
    s_cmp_lt_u32 s23, 200000
    s_cbranch_scc1 g_47L8_3
    s_mov_b32 s25, 200000
    s_branch gc_48
g_49L15_0:
    s_waitcnt vmcnt(3)
    v_max3_u32 v19, v24, v25, v26
    v_max_u32 v19, v19, v27
    v_cmp_eq_u32 vcc, -1, v19
    s_nop 0
    s_cbranch_vccnz g_49F15_0
    v_smfmac_f32_16x16x64_bf16 v[64:67], v[24:27], a[192:199], v172
    v_smfmac_f32_16x16x64_bf16 v[68:71], v[24:27], a[224:231], v172
g_49L14_1:
    s_waitcnt vmcnt(2)
    v_max3_u32 v19, v28, v29, v30
    v_max_u32 v19, v19, v31
    v_cmp_eq_u32 vcc, -1, v19
    s_nop 0
    s_cbranch_vccnz g_49F14_1
    v_smfmac_f32_16x16x64_bf16 v[64:67], v[28:31], a[200:207], v172
    v_smfmac_f32_16x16x64_bf16 v[68:71], v[28:31], a[232:239], v172
g_49L12_2:
    s_waitcnt vmcnt(1)
    v_max3_u32 v19, v32, v33, v34
    v_max_u32 v19, v19, v35
    v_cmp_eq_u32 vcc, -1, v19
    s_nop 0
    s_cbranch_vccnz g_49F12_2
    v_smfmac_f32_16x16x64_bf16 v[64:67], v[32:35], a[208:215], v172
    v_smfmac_f32_16x16x64_bf16 v[68:71], v[32:35], a[240:247], v172
g_49L8_3:
    s_waitcnt vmcnt(0)
    v_max3_u32 v19, v36, v37, v38
    v_max_u32 v19, v19, v39
    v_cmp_eq_u32 vcc, -1, v19
    s_nop 0
    s_cbranch_vccnz g_49F8_3
    v_smfmac_f32_16x16x64_bf16 v[64:67], v[36:39], a[216:223], v172
    v_smfmac_f32_16x16x64_bf16 v[68:71], v[36:39], a[248:255], v172
    s_nop 4
    v_cvt_pk_bf16_f32 v80, v64, v65
    v_cvt_pk_bf16_f32 v81, v66, v67
    s_nop 0
    v_cvt_pk_bf16_f32 v82, v68, v69
    v_cvt_pk_bf16_f32 v83, v70, v71
    s_nop 1
    v_mfma_f32_16x16x32_bf16 v[88:91], v[80:83], v[84:87], 0
    s_branch gc_50
g_49L15_1:
    s_waitcnt vmcnt(3)
    v_max3_u32 v19, v28, v29, v30
    v_max_u32 v19, v19, v31
    v_cmp_eq_u32 vcc, -1, v19
    s_nop 0
    s_cbranch_vccnz g_49F15_1
    v_smfmac_f32_16x16x64_bf16 v[64:67], v[28:31], a[200:207], v172
    v_smfmac_f32_16x16x64_bf16 v[68:71], v[28:31], a[232:239], v172
g_49L13_2:
    s_waitcnt vmcnt(2)
    v_max3_u32 v19, v32, v33, v34
    v_max_u32 v19, v19, v35
    v_cmp_eq_u32 vcc, -1, v19
    s_nop 0
    s_cbranch_vccnz g_49F13_2
    v_smfmac_f32_16x16x64_bf16 v[64:67], v[32:35], a[208:215], v172
    v_smfmac_f32_16x16x64_bf16 v[68:71], v[32:35], a[240:247], v172
g_49L9_3:
    s_waitcnt vmcnt(1)
    v_max3_u32 v19, v36, v37, v38
    v_max_u32 v19, v19, v39
    v_cmp_eq_u32 vcc, -1, v19
    s_nop 0
    s_cbranch_vccnz g_49F9_3
    v_smfmac_f32_16x16x64_bf16 v[64:67], v[36:39], a[216:223], v172
    v_smfmac_f32_16x16x64_bf16 v[68:71], v[36:39], a[248:255], v172
g_49L1_0:
    s_waitcnt vmcnt(0)
    v_max3_u32 v19, v24, v25, v26
    v_max_u32 v19, v19, v27
    v_cmp_eq_u32 vcc, -1, v19
    s_nop 0
    s_cbranch_vccnz g_49F1_0
    v_smfmac_f32_16x16x64_bf16 v[64:67], v[24:27], a[192:199], v172
    v_smfmac_f32_16x16x64_bf16 v[68:71], v[24:27], a[224:231], v172
    s_nop 4
    v_cvt_pk_bf16_f32 v80, v64, v65
    v_cvt_pk_bf16_f32 v81, v66, v67
    s_nop 0
    v_cvt_pk_bf16_f32 v82, v68, v69
    v_cvt_pk_bf16_f32 v83, v70, v71
    s_nop 1
    v_mfma_f32_16x16x32_bf16 v[88:91], v[80:83], v[84:87], 0
    s_branch gc_50
g_49L15_2:
    s_waitcnt vmcnt(3)
    v_max3_u32 v19, v32, v33, v34
    v_max_u32 v19, v19, v35
    v_cmp_eq_u32 vcc, -1, v19
    s_nop 0
    s_cbranch_vccnz g_49F15_2
    v_smfmac_f32_16x16x64_bf16 v[64:67], v[32:35], a[208:215], v172
    v_smfmac_f32_16x16x64_bf16 v[68:71], v[32:35], a[240:247], v172
g_49L11_3:
    s_waitcnt vmcnt(2)
    v_max3_u32 v19, v36, v37, v38
    v_max_u32 v19, v19, v39
    v_cmp_eq_u32 vcc, -1, v19
    s_nop 0
    s_cbranch_vccnz g_49F11_3
    v_smfmac_f32_16x16x64_bf16 v[64:67], v[36:39], a[216:223], v172
    v_smfmac_f32_16x16x64_bf16 v[68:71], v[36:39], a[248:255], v172
g_49L3_0:
    s_waitcnt vmcnt(1)
    v_max3_u32 v19, v24, v25, v26
    v_max_u32 v19, v19, v27
    v_cmp_eq_u32 vcc, -1, v19
    s_nop 0
    s_cbranch_vccnz g_49F3_0
    v_smfmac_f32_16x16x64_bf16 v[64:67], v[24:27], a[192:199], v172
    v_smfmac_f32_16x16x64_bf16 v[68:71], v[24:27], a[224:231], v172
g_49L2_1:
    s_waitcnt vmcnt(0)
    v_max3_u32 v19, v28, v29, v30
    v_max_u32 v19, v19, v31
    v_cmp_eq_u32 vcc, -1, v19
    s_nop 0
    s_cbranch_vccnz g_49F2_1
    v_smfmac_f32_16x16x64_bf16 v[64:67], v[28:31], a[200:207], v172
    v_smfmac_f32_16x16x64_bf16 v[68:71], v[28:31], a[232:239], v172
    s_nop 4
    v_cvt_pk_bf16_f32 v80, v64, v65
    v_cvt_pk_bf16_f32 v81, v66, v67
    s_nop 0
    v_cvt_pk_bf16_f32 v82, v68, v69
    v_cvt_pk_bf16_f32 v83, v70, v71
    s_nop 1
    v_mfma_f32_16x16x32_bf16 v[88:91], v[80:83], v[84:87], 0
    s_branch gc_50
g_49L15_3:
    s_waitcnt vmcnt(3)
    v_max3_u32 v19, v36, v37, v38
    v_max_u32 v19, v19, v39
    v_cmp_eq_u32 vcc, -1, v19
    s_nop 0
    s_cbranch_vccnz g_49F15_3
    v_smfmac_f32_16x16x64_bf16 v[64:67], v[36:39], a[216:223], v172
    v_smfmac_f32_16x16x64_bf16 v[68:71], v[36:39], a[248:255], v172
g_49L7_0:
    s_waitcnt vmcnt(2)
    v_max3_u32 v19, v24, v25, v26
    v_max_u32 v19, v19, v27
    v_cmp_eq_u32 vcc, -1, v19
    s_nop 0
    s_cbranch_vccnz g_49F7_0
    v_smfmac_f32_16x16x64_bf16 v[64:67], v[24:27], a[192:199], v172
    v_smfmac_f32_16x16x64_bf16 v[68:71], v[24:27], a[224:231], v172
g_49L6_1:
    s_waitcnt vmcnt(1)
    v_max3_u32 v19, v28, v29, v30
    v_max_u32 v19, v19, v31
    v_cmp_eq_u32 vcc, -1, v19
    s_nop 0
    s_cbranch_vccnz g_49F6_1
    v_smfmac_f32_16x16x64_bf16 v[64:67], v[28:31], a[200:207], v172
    v_smfmac_f32_16x16x64_bf16 v[68:71], v[28:31], a[232:239], v172
g_49L4_2:
    s_waitcnt vmcnt(0)
    v_max3_u32 v19, v32, v33, v34
    v_max_u32 v19, v19, v35
    v_cmp_eq_u32 vcc, -1, v19
    s_nop 0
    s_cbranch_vccnz g_49F4_2
    v_smfmac_f32_16x16x64_bf16 v[64:67], v[32:35], a[208:215], v172
    v_smfmac_f32_16x16x64_bf16 v[68:71], v[32:35], a[240:247], v172
    s_nop 4
    v_cvt_pk_bf16_f32 v80, v64, v65
    v_cvt_pk_bf16_f32 v81, v66, v67
    s_nop 0
    v_cvt_pk_bf16_f32 v82, v68, v69
    v_cvt_pk_bf16_f32 v83, v70, v71
    s_nop 1
    v_mfma_f32_16x16x32_bf16 v[88:91], v[80:83], v[84:87], 0
    s_branch gc_50
g_49L7_1:
    s_waitcnt vmcnt(2)
    v_max3_u32 v19, v28, v29, v30
    v_max_u32 v19, v19, v31
    v_cmp_eq_u32 vcc, -1, v19
    s_nop 0
    s_cbranch_vccnz g_49F7_1
    v_smfmac_f32_16x16x64_bf16 v[64:67], v[28:31], a[200:207], v172
    v_smfmac_f32_16x16x64_bf16 v[68:71], v[28:31], a[232:239], v172
g_49L5_2:
    s_waitcnt vmcnt(1)
    v_max3_u32 v19, v32, v33, v34
    v_max_u32 v19, v19, v35
    v_cmp_eq_u32 vcc, -1, v19
    s_nop 0
    s_cbranch_vccnz g_49F5_2
    v_smfmac_f32_16x16x64_bf16 v[64:67], v[32:35], a[208:215], v172
    v_smfmac_f32_16x16x64_bf16 v[68:71], v[32:35], a[240:247], v172
    s_branch g_49L1_0
g_49L7_2:
    s_waitcnt vmcnt(2)
    v_max3_u32 v19, v32, v33, v34
    v_max_u32 v19, v19, v35
    v_cmp_eq_u32 vcc, -1, v19
    s_nop 0
    s_cbranch_vccnz g_49F7_2
    v_smfmac_f32_16x16x64_bf16 v[64:67], v[32:35], a[208:215], v172
    v_smfmac_f32_16x16x64_bf16 v[68:71], v[32:35], a[240:247], v172
    s_branch g_49L3_0
g_49L11_0:
    s_waitcnt vmcnt(2)
    v_max3_u32 v19, v24, v25, v26
    v_max_u32 v19, v19, v27
    v_cmp_eq_u32 vcc, -1, v19
    s_nop 0
    s_cbranch_vccnz g_49F11_0
    v_smfmac_f32_16x16x64_bf16 v[64:67], v[24:27], a[192:199], v172
    v_smfmac_f32_16x16x64_bf16 v[68:71], v[24:27], a[224:231], v172
g_49L10_1:
    s_waitcnt vmcnt(1)
    v_max3_u32 v19, v28, v29, v30
    v_max_u32 v19, v19, v31
    v_cmp_eq_u32 vcc, -1, v19
    s_nop 0
    s_cbranch_vccnz g_49F10_1
    v_smfmac_f32_16x16x64_bf16 v[64:67], v[28:31], a[200:207], v172
    v_smfmac_f32_16x16x64_bf16 v[68:71], v[28:31], a[232:239], v172
    s_branch g_49L8_3
g_49L11_1:
    s_waitcnt vmcnt(2)
    v_max3_u32 v19, v28, v29, v30
    v_max_u32 v19, v19, v31
    v_cmp_eq_u32 vcc, -1, v19
    s_nop 0
    s_cbranch_vccnz g_49F11_1
    v_smfmac_f32_16x16x64_bf16 v[64:67], v[28:31], a[200:207], v172
    v_smfmac_f32_16x16x64_bf16 v[68:71], v[28:31], a[232:239], v172
    s_branch g_49L9_3
g_49L13_0:
    s_waitcnt vmcnt(2)
    v_max3_u32 v19, v24, v25, v26
    v_max_u32 v19, v19, v27
    v_cmp_eq_u32 vcc, -1, v19
    s_nop 0
    s_cbranch_vccnz g_49F13_0
    v_smfmac_f32_16x16x64_bf16 v[64:67], v[24:27], a[192:199], v172
    v_smfmac_f32_16x16x64_bf16 v[68:71], v[24:27], a[224:231], v172
    s_branch g_49L12_2
g_49L13_3:
    s_waitcnt vmcnt(2)
    v_max3_u32 v19, v36, v37, v38
    v_max_u32 v19, v19, v39
    v_cmp_eq_u32 vcc, -1, v19
    s_nop 0
    s_cbranch_vccnz g_49F13_3
    v_smfmac_f32_16x16x64_bf16 v[64:67], v[36:39], a[216:223], v172
    v_smfmac_f32_16x16x64_bf16 v[68:71], v[36:39], a[248:255], v172
g_49L5_0:
    s_waitcnt vmcnt(1)
    v_max3_u32 v19, v24, v25, v26
    v_max_u32 v19, v19, v27
    v_cmp_eq_u32 vcc, -1, v19
    s_nop 0
    s_cbranch_vccnz g_49F5_0
    v_smfmac_f32_16x16x64_bf16 v[64:67], v[24:27], a[192:199], v172
    v_smfmac_f32_16x16x64_bf16 v[68:71], v[24:27], a[224:231], v172
    s_branch g_49L4_2
g_49L14_2:
    s_waitcnt vmcnt(2)
    v_max3_u32 v19, v32, v33, v34
    v_max_u32 v19, v19, v35
    v_cmp_eq_u32 vcc, -1, v19
    s_nop 0
    s_cbranch_vccnz g_49F14_2
    v_smfmac_f32_16x16x64_bf16 v[64:67], v[32:35], a[208:215], v172
    v_smfmac_f32_16x16x64_bf16 v[68:71], v[32:35], a[240:247], v172
g_49L10_3:
    s_waitcnt vmcnt(1)
    v_max3_u32 v19, v36, v37, v38
    v_max_u32 v19, v19, v39
    v_cmp_eq_u32 vcc, -1, v19
    s_nop 0
    s_cbranch_vccnz g_49F10_3
    v_smfmac_f32_16x16x64_bf16 v[64:67], v[36:39], a[216:223], v172
    v_smfmac_f32_16x16x64_bf16 v[68:71], v[36:39], a[248:255], v172
    s_branch g_49L2_1
g_49L14_3:
    s_waitcnt vmcnt(2)
    v_max3_u32 v19, v36, v37, v38
    v_max_u32 v19, v19, v39
    v_cmp_eq_u32 vcc, -1, v19
    s_nop 0
    s_cbranch_vccnz g_49F14_3
    v_smfmac_f32_16x16x64_bf16 v[64:67], v[36:39], a[216:223], v172
    v_smfmac_f32_16x16x64_bf16 v[68:71], v[36:39], a[248:255], v172
    s_branch g_49L6_1
g_49L3_1:
    s_waitcnt vmcnt(1)
    v_max3_u32 v19, v28, v29, v30
    v_max_u32 v19, v19, v31
    v_cmp_eq_u32 vcc, -1, v19
    s_nop 0
    s_cbranch_vccnz g_49F3_1
    v_smfmac_f32_16x16x64_bf16 v[64:67], v[28:31], a[200:207], v172
    v_smfmac_f32_16x16x64_bf16 v[68:71], v[28:31], a[232:239], v172
    s_branch g_49L1_0
g_49L6_2:
    s_waitcnt vmcnt(1)
    v_max3_u32 v19, v32, v33, v34
    v_max_u32 v19, v19, v35
    v_cmp_eq_u32 vcc, -1, v19
    s_nop 0
    s_cbranch_vccnz g_49F6_2
    v_smfmac_f32_16x16x64_bf16 v[64:67], v[32:35], a[208:215], v172
    v_smfmac_f32_16x16x64_bf16 v[68:71], v[32:35], a[240:247], v172
    s_branch g_49L2_1
g_49L9_0:
    s_waitcnt vmcnt(1)
    v_max3_u32 v19, v24, v25, v26
    v_max_u32 v19, v19, v27
    v_cmp_eq_u32 vcc, -1, v19
    s_nop 0
    s_cbranch_vccnz g_49F9_0
    v_smfmac_f32_16x16x64_bf16 v[64:67], v[24:27], a[192:199], v172
    v_smfmac_f32_16x16x64_bf16 v[68:71], v[24:27], a[224:231], v172
    s_branch g_49L8_3
g_49L12_3:
    s_waitcnt vmcnt(1)
    v_max3_u32 v19, v36, v37, v38
    v_max_u32 v19, v19, v39
    v_cmp_eq_u32 vcc, -1, v19
    s_nop 0
    s_cbranch_vccnz g_49F12_3
    v_smfmac_f32_16x16x64_bf16 v[64:67], v[36:39], a[216:223], v172
    v_smfmac_f32_16x16x64_bf16 v[68:71], v[36:39], a[248:255], v172
    s_branch g_49L4_2
g_49F15_0:
    s_mov_b64 exec, vcc
    buffer_load_dwordx4 v[24:27], v8, s[4:7], s16 offen offset:0 sc1
    s_mov_b64 exec, -1
    s_add_u32 s23, s23, 1
    s_cmp_lt_u32 s23, 200000
    s_cbranch_scc1 g_49L15_1
    s_mov_b32 s25, 200000
    s_branch gc_50
g_49F15_1:
    s_mov_b64 exec, vcc
    buffer_load_dwordx4 v[28:31], v8, s[4:7], s16 offen offset:1024 sc1
    s_mov_b64 exec, -1
    s_add_u32 s23, s23, 1
    s_cmp_lt_u32 s23, 200000
    s_cbranch_scc1 g_49L15_2
    s_mov_b32 s25, 200000
    s_branch gc_50
g_49F15_2:
    s_mov_b64 exec, vcc
    buffer_load_dwordx4 v[32:35], v8, s[4:7], s16 offen offset:2048 sc1
    s_mov_b64 exec, -1
    s_add_u32 s23, s23, 1
    s_cmp_lt_u32 s23, 200000
    s_cbranch_scc1 g_49L15_3
    s_mov_b32 s25, 200000
    s_branch gc_50
g_49F15_3:
    s_mov_b64 exec, vcc
    buffer_load_dwordx4 v[36:39], v8, s[4:7], s16 offen offset:3072 sc1
    s_mov_b64 exec, -1
    s_add_u32 s23, s23, 1
    s_cmp_lt_u32 s23, 200000
    s_cbranch_scc1 g_49L15_0
    s_mov_b32 s25, 200000
    s_branch gc_50
g_49F7_0:
    s_mov_b64 exec, vcc
    buffer_load_dwordx4 v[24:27], v8, s[4:7], s16 offen offset:0 sc1
    s_mov_b64 exec, -1
    s_add_u32 s23, s23, 1
    s_cmp_lt_u32 s23, 200000
    s_cbranch_scc1 g_49L7_1
    s_mov_b32 s25, 200000
    s_branch gc_50
g_49F7_1:
    s_mov_b64 exec, vcc
    buffer_load_dwordx4 v[28:31], v8, s[4:7], s16 offen offset:1024 sc1
    s_mov_b64 exec, -1
    s_add_u32 s23, s23, 1
    s_cmp_lt_u32 s23, 200000
    s_cbranch_scc1 g_49L7_2
    s_mov_b32 s25, 200000
    s_branch gc_50
g_49F7_2:
    s_mov_b64 exec, vcc
    buffer_load_dwordx4 v[32:35], v8, s[4:7], s16 offen offset:2048 sc1
    s_mov_b64 exec, -1
    s_add_u32 s23, s23, 1
    s_cmp_lt_u32 s23, 200000
    s_cbranch_scc1 g_49L7_0
    s_mov_b32 s25, 200000
    s_branch gc_50
g_49F11_0:
    s_mov_b64 exec, vcc
    buffer_load_dwordx4 v[24:27], v8, s[4:7], s16 offen offset:0 sc1
    s_mov_b64 exec, -1
    s_add_u32 s23, s23, 1
    s_cmp_lt_u32 s23, 200000
    s_cbranch_scc1 g_49L11_1
    s_mov_b32 s25, 200000
    s_branch gc_50
g_49F11_1:
    s_mov_b64 exec, vcc
    buffer_load_dwordx4 v[28:31], v8, s[4:7], s16 offen offset:1024 sc1
    s_mov_b64 exec, -1
    s_add_u32 s23, s23, 1
    s_cmp_lt_u32 s23, 200000
    s_cbranch_scc1 g_49L11_3
    s_mov_b32 s25, 200000
    s_branch gc_50
g_49F11_3:
    s_mov_b64 exec, vcc
    buffer_load_dwordx4 v[36:39], v8, s[4:7], s16 offen offset:3072 sc1
    s_mov_b64 exec, -1
    s_add_u32 s23, s23, 1
    s_cmp_lt_u32 s23, 200000
    s_cbranch_scc1 g_49L11_0
    s_mov_b32 s25, 200000
    s_branch gc_50
g_49F13_0:
    s_mov_b64 exec, vcc
    buffer_load_dwordx4 v[24:27], v8, s[4:7], s16 offen offset:0 sc1
    s_mov_b64 exec, -1
    s_add_u32 s23, s23, 1
    s_cmp_lt_u32 s23, 200000
    s_cbranch_scc1 g_49L13_2
    s_mov_b32 s25, 200000
    s_branch gc_50
g_49F13_2:
    s_mov_b64 exec, vcc
    buffer_load_dwordx4 v[32:35], v8, s[4:7], s16 offen offset:2048 sc1
    s_mov_b64 exec, -1
    s_add_u32 s23, s23, 1
    s_cmp_lt_u32 s23, 200000
    s_cbranch_scc1 g_49L13_3
    s_mov_b32 s25, 200000
    s_branch gc_50
g_49F13_3:
    s_mov_b64 exec, vcc
    buffer_load_dwordx4 v[36:39], v8, s[4:7], s16 offen offset:3072 sc1
    s_mov_b64 exec, -1
    s_add_u32 s23, s23, 1
    s_cmp_lt_u32 s23, 200000
    s_cbranch_scc1 g_49L13_0
    s_mov_b32 s25, 200000
    s_branch gc_50
g_49F14_1:
    s_mov_b64 exec, vcc
    buffer_load_dwordx4 v[28:31], v8, s[4:7], s16 offen offset:1024 sc1
    s_mov_b64 exec, -1
    s_add_u32 s23, s23, 1
    s_cmp_lt_u32 s23, 200000
    s_cbranch_scc1 g_49L14_2
    s_mov_b32 s25, 200000
    s_branch gc_50
g_49F14_2:
    s_mov_b64 exec, vcc
    buffer_load_dwordx4 v[32:35], v8, s[4:7], s16 offen offset:2048 sc1
    s_mov_b64 exec, -1
    s_add_u32 s23, s23, 1
    s_cmp_lt_u32 s23, 200000
    s_cbranch_scc1 g_49L14_3
    s_mov_b32 s25, 200000
    s_branch gc_50
g_49F14_3:
    s_mov_b64 exec, vcc
    buffer_load_dwordx4 v[36:39], v8, s[4:7], s16 offen offset:3072 sc1
    s_mov_b64 exec, -1
    s_add_u32 s23, s23, 1
    s_cmp_lt_u32 s23, 200000
    s_cbranch_scc1 g_49L14_1
    s_mov_b32 s25, 200000
    s_branch gc_50
g_49F3_0:
    s_mov_b64 exec, vcc
    buffer_load_dwordx4 v[24:27], v8, s[4:7], s16 offen offset:0 sc1
    s_mov_b64 exec, -1
    s_add_u32 s23, s23, 1
    s_cmp_lt_u32 s23, 200000
    s_cbranch_scc1 g_49L3_1
    s_mov_b32 s25, 200000
    s_branch gc_50
g_49F3_1:
    s_mov_b64 exec, vcc
    buffer_load_dwordx4 v[28:31], v8, s[4:7], s16 offen offset:1024 sc1
    s_mov_b64 exec, -1
    s_add_u32 s23, s23, 1
    s_cmp_lt_u32 s23, 200000
    s_cbranch_scc1 g_49L3_0
    s_mov_b32 s25, 200000
    s_branch gc_50
g_49F5_0:
    s_mov_b64 exec, vcc
    buffer_load_dwordx4 v[24:27], v8, s[4:7], s16 offen offset:0 sc1
    s_mov_b64 exec, -1
    s_add_u32 s23, s23, 1
    s_cmp_lt_u32 s23, 200000
    s_cbranch_scc1 g_49L5_2
    s_mov_b32 s25, 200000
    s_branch gc_50
g_49F5_2:
    s_mov_b64 exec, vcc
    buffer_load_dwordx4 v[32:35], v8, s[4:7], s16 offen offset:2048 sc1
    s_mov_b64 exec, -1
    s_add_u32 s23, s23, 1
    s_cmp_lt_u32 s23, 200000
    s_cbranch_scc1 g_49L5_0
    s_mov_b32 s25, 200000
    s_branch gc_50
g_49F6_1:
    s_mov_b64 exec, vcc
    buffer_load_dwordx4 v[28:31], v8, s[4:7], s16 offen offset:1024 sc1
    s_mov_b64 exec, -1
    s_add_u32 s23, s23, 1
    s_cmp_lt_u32 s23, 200000
    s_cbranch_scc1 g_49L6_2
    s_mov_b32 s25, 200000
    s_branch gc_50
g_49F6_2:
    s_mov_b64 exec, vcc
    buffer_load_dwordx4 v[32:35], v8, s[4:7], s16 offen offset:2048 sc1
    s_mov_b64 exec, -1
    s_add_u32 s23, s23, 1
    s_cmp_lt_u32 s23, 200000
    s_cbranch_scc1 g_49L6_1
    s_mov_b32 s25, 200000
    s_branch gc_50
g_49F9_0:
    s_mov_b64 exec, vcc
    buffer_load_dwordx4 v[24:27], v8, s[4:7], s16 offen offset:0 sc1
    s_mov_b64 exec, -1
    s_add_u32 s23, s23, 1
    s_cmp_lt_u32 s23, 200000
    s_cbranch_scc1 g_49L9_3
    s_mov_b32 s25, 200000
    s_branch gc_50
g_49F9_3:
    s_mov_b64 exec, vcc
    buffer_load_dwordx4 v[36:39], v8, s[4:7], s16 offen offset:3072 sc1
    s_mov_b64 exec, -1
    s_add_u32 s23, s23, 1
    s_cmp_lt_u32 s23, 200000
    s_cbranch_scc1 g_49L9_0
    s_mov_b32 s25, 200000
    s_branch gc_50
g_49F10_1:
    s_mov_b64 exec, vcc
    buffer_load_dwordx4 v[28:31], v8, s[4:7], s16 offen offset:1024 sc1
    s_mov_b64 exec, -1
    s_add_u32 s23, s23, 1
    s_cmp_lt_u32 s23, 200000
    s_cbranch_scc1 g_49L10_3
    s_mov_b32 s25, 200000
    s_branch gc_50
g_49F10_3:
    s_mov_b64 exec, vcc
    buffer_load_dwordx4 v[36:39], v8, s[4:7], s16 offen offset:3072 sc1
    s_mov_b64 exec, -1
    s_add_u32 s23, s23, 1
    s_cmp_lt_u32 s23, 200000
    s_cbranch_scc1 g_49L10_1
    s_mov_b32 s25, 200000
    s_branch gc_50
g_49F12_2:
    s_mov_b64 exec, vcc
    buffer_load_dwordx4 v[32:35], v8, s[4:7], s16 offen offset:2048 sc1
    s_mov_b64 exec, -1
    s_add_u32 s23, s23, 1
    s_cmp_lt_u32 s23, 200000
    s_cbranch_scc1 g_49L12_3
    s_mov_b32 s25, 200000
    s_branch gc_50
g_49F12_3:
    s_mov_b64 exec, vcc
    buffer_load_dwordx4 v[36:39], v8, s[4:7], s16 offen offset:3072 sc1
    s_mov_b64 exec, -1
    s_add_u32 s23, s23, 1
    s_cmp_lt_u32 s23, 200000
    s_cbranch_scc1 g_49L12_2
    s_mov_b32 s25, 200000
    s_branch gc_50
g_49F1_0:
    s_mov_b64 exec, vcc
    buffer_load_dwordx4 v[24:27], v8, s[4:7], s16 offen offset:0 sc1
    s_mov_b64 exec, -1
    s_add_u32 s23, s23, 1
    s_cmp_lt_u32 s23, 200000
    s_cbranch_scc1 g_49L1_0
    s_mov_b32 s25, 200000
    s_branch gc_50
g_49F2_1:
    s_mov_b64 exec, vcc
    buffer_load_dwordx4 v[28:31], v8, s[4:7], s16 offen offset:1024 sc1
    s_mov_b64 exec, -1
    s_add_u32 s23, s23, 1
    s_cmp_lt_u32 s23, 200000
    s_cbranch_scc1 g_49L2_1
    s_mov_b32 s25, 200000
    s_branch gc_50
g_49F4_2:
    s_mov_b64 exec, vcc
    buffer_load_dwordx4 v[32:35], v8, s[4:7], s16 offen offset:2048 sc1
    s_mov_b64 exec, -1
    s_add_u32 s23, s23, 1
    s_cmp_lt_u32 s23, 200000
    s_cbranch_scc1 g_49L4_2
    s_mov_b32 s25, 200000
    s_branch gc_50
g_49F8_3:
    s_mov_b64 exec, vcc
    buffer_load_dwordx4 v[36:39], v8, s[4:7], s16 offen offset:3072 sc1
    s_mov_b64 exec, -1
    s_add_u32 s23, s23, 1
    s_cmp_lt_u32 s23, 200000
    s_cbranch_scc1 g_49L8_3
    s_mov_b32 s25, 200000
    s_branch gc_50
pr_51:
    v_max3_u32 v19, v96, v97, v98
    v_max3_u32 v19, v19, v99, v100
    v_max3_u32 v19, v19, v101, v102
    v_max3_u32 v19, v19, v103, v104
    v_max3_u32 v19, v19, v105, v106
    v_max_u32 v19, v19, v107
    v_cmp_eq_u32 vcc, -1, v19
    s_nop 0
    s_cbranch_vccz pf_55
    buffer_load_dwordx4 v[96:99], v10, s[4:7], s84 offen sc1
    buffer_load_dwordx4 v[100:103], v23, s[4:7], s84 offen sc1
    buffer_load_dwordx4 v[104:107], v244, s[4:7], s84 offen sc1
    s_add_u32 s23, s23, 1
    s_cmp_lt_u32 s23, 200000
    s_cbranch_scc1 pb_53
    s_mov_b32 s25, 200000
pf_55:
    buffer_store_dwordx2 v[180:181], v11, s[4:7], s42 offen
    s_branch pg_52
.p2align 6
recur_slow_w0:
    s_nop 15
    s_mov_b32 s23, s25
g_56:
    buffer_load_dwordx4 v[24:27], v2, s[4:7], s16 offen offset:0 sc1
    buffer_load_dwordx4 v[28:31], v2, s[4:7], s16 offen offset:1024 sc1
    buffer_load_dwordx4 v[32:35], v2, s[4:7], s16 offen offset:2048 sc1
    buffer_load_dwordx4 v[36:39], v2, s[4:7], s16 offen offset:3072 sc1
    s_waitcnt vmcnt(0)
    v_max3_u32 v19, v24, v25, v26
    v_max3_u32 v19, v19, v27, v28
    v_max3_u32 v19, v19, v29, v30
    v_max3_u32 v19, v19, v31, v32
    v_max3_u32 v19, v19, v33, v34
    v_max3_u32 v19, v19, v35, v36
    v_max3_u32 v19, v19, v37, v38
    v_max_u32 v19, v19, v39
    v_cmp_eq_u32 vcc, -1, v19
    s_nop 0
    s_cbranch_vccz g_56k
    s_add_u32 s23, s23, 1
    s_cmp_lt_u32 s23, 200000
    s_cbranch_scc1 g_56
    s_mov_b32 s25, 200000
g_56k:
    v_smfmac_f32_16x16x64_bf16 v[40:43], v[24:27], a[0:7], v172
    v_smfmac_f32_16x16x64_bf16 v[44:47], v[24:27], a[64:71], v172
    v_smfmac_f32_16x16x64_bf16 v[48:51], v[24:27], a[32:39], v172
    v_smfmac_f32_16x16x64_bf16 v[52:55], v[24:27], a[96:103], v172
    v_smfmac_f32_16x16x64_bf16 v[40:43], v[28:31], a[8:15], v172
    v_smfmac_f32_16x16x64_bf16 v[44:47], v[28:31], a[72:79], v172
    v_smfmac_f32_16x16x64_bf16 v[48:51], v[28:31], a[40:47], v172
    v_smfmac_f32_16x16x64_bf16 v[52:55], v[28:31], a[104:111], v172
    v_smfmac_f32_16x16x64_bf16 v[40:43], v[32:35], a[16:23], v172
    v_smfmac_f32_16x16x64_bf16 v[44:47], v[32:35], a[80:87], v172
    v_smfmac_f32_16x16x64_bf16 v[48:51], v[32:35], a[48:55], v172
    v_smfmac_f32_16x16x64_bf16 v[52:55], v[32:35], a[112:119], v172
    v_smfmac_f32_16x16x64_bf16 v[40:43], v[36:39], a[24:31], v172
    v_smfmac_f32_16x16x64_bf16 v[44:47], v[36:39], a[88:95], v172
    v_smfmac_f32_16x16x64_bf16 v[48:51], v[36:39], a[56:63], v172
    v_smfmac_f32_16x16x64_bf16 v[52:55], v[36:39], a[120:127], v172
    v_cvt_pk_bf16_f32 v72, v40, v41
    v_cvt_pk_bf16_f32 v73, v42, v43
    v_cvt_pk_bf16_f32 v74, v44, v45
    v_cvt_pk_bf16_f32 v75, v46, v47
    v_smfmac_f32_16x16x64_bf16 v[56:59], v[24:27], a[128:135], v172
    v_cvt_pk_bf16_f32 v76, v48, v49
    v_cvt_pk_bf16_f32 v77, v50, v51
    s_nop 0
    v_cvt_pk_bf16_f32 v78, v52, v53
    v_cvt_pk_bf16_f32 v79, v54, v55
    v_smfmac_f32_16x16x64_bf16 v[60:63], v[24:27], a[160:167], v172
    v_mfma_f32_16x16x32_bf16 v[88:91], v[72:75], v[84:87], 0
    v_mfma_f32_16x16x32_bf16 v[92:95], v[76:79], v[84:87], 0
    v_smfmac_f32_16x16x64_bf16 v[56:59], v[28:31], a[136:143], v172
    v_smfmac_f32_16x16x64_bf16 v[60:63], v[28:31], a[168:175], v172
    s_barrier
    ds_read_b128 v[104:107], v16 offset:2048
    ds_read_b128 v[108:111], v16 offset:3072
    ds_read_b128 v[112:115], v16 offset:4096
    ds_read_b128 v[116:119], v16 offset:5120
    ds_read_b128 v[120:123], v16 offset:6144
    ds_read_b128 v[124:127], v16 offset:7168
    v_smfmac_f32_16x16x64_bf16 v[56:59], v[32:35], a[144:151], v172
    v_smfmac_f32_16x16x64_bf16 v[60:63], v[32:35], a[176:183], v172
    v_smfmac_f32_16x16x64_bf16 v[56:59], v[36:39], a[152:159], v172
    v_smfmac_f32_16x16x64_bf16 v[60:63], v[36:39], a[184:191], v172
    s_waitcnt lgkmcnt(5)
    v_mfma_f32_16x16x32_bf16 v[88:91], v[104:107], v[84:87], v[88:91]
    s_waitcnt lgkmcnt(4)
    v_mfma_f32_16x16x32_bf16 v[92:95], v[108:111], v[84:87], v[92:95]
    s_waitcnt lgkmcnt(3)
    v_mfma_f32_16x16x32_bf16 v[88:91], v[112:115], v[84:87], v[88:91]
    s_waitcnt lgkmcnt(2)
    v_mfma_f32_16x16x32_bf16 v[92:95], v[116:119], v[84:87], v[92:95]
    s_waitcnt lgkmcnt(1)
    v_mfma_f32_16x16x32_bf16 v[88:91], v[120:123], v[84:87], v[88:91]
    s_waitcnt lgkmcnt(0)
    v_mfma_f32_16x16x32_bf16 v[92:95], v[124:127], v[84:87], v[92:95]
    v_cvt_pk_bf16_f32 v80, v56, v57
    v_cvt_pk_bf16_f32 v81, v58, v59
    v_cvt_pk_bf16_f32 v82, v60, v61
    v_cvt_pk_bf16_f32 v83, v62, v63
    ds_write_b128 v17, v[80:83] offset:8192
    s_nop 0
    v_cvt_pk_bf16_f32 v128, v88, v89
    v_cvt_pk_bf16_f32 v129, v90, v91
    v_cvt_pk_bf16_f32 v130, v92, v93
    v_cvt_pk_bf16_f32 v131, v94, v95
    s_nop 1
    v_mfma_f32_16x16x32_bf16 v[144:147], v[132:135], v[128:131], 0
    v_mfma_f32_16x16x32_bf16 v[148:151], v[136:139], v[128:131], 0
    v_mfma_f32_16x16x32_bf16 v[140:143], v[128:131], v[128:131], 0
    s_nop 1
    buffer_store_dwordx4 v[144:147], v3, s[4:7], s16 offen sc1
    s_nop 1
    buffer_store_dwordx4 v[148:151], v3, s[4:7], s16 offen offset:128 sc1
    s_nop 1
    buffer_store_dwordx4 v[140:143], v4, s[4:7], s16 offen sc1
    s_cmp_eq_u32 s15, 63
    s_waitcnt lgkmcnt(0)
    s_barrier
    s_cbranch_scc1 recur_slow_last0
    v_readfirstlane_b32 s85, v247
    s_add_u32 s94, s15, 2
    s_barrier
    s_nop 15
    s_mov_b32 s23, s25
g_57:
    buffer_load_dwordx4 v[24:27], v8, s[4:7], s16 offen offset:0 sc1
    buffer_load_dwordx4 v[28:31], v8, s[4:7], s16 offen offset:1024 sc1
    buffer_load_dwordx4 v[32:35], v8, s[4:7], s16 offen offset:2048 sc1
    buffer_load_dwordx4 v[36:39], v8, s[4:7], s16 offen offset:3072 sc1
    s_waitcnt vmcnt(0)
    v_max3_u32 v19, v24, v25, v26
    v_max3_u32 v19, v19, v27, v28
    v_max3_u32 v19, v19, v29, v30
    v_max3_u32 v19, v19, v31, v32
    v_max3_u32 v19, v19, v33, v34
    v_max3_u32 v19, v19, v35, v36
    v_max3_u32 v19, v19, v37, v38
    v_max_u32 v19, v19, v39
    v_cmp_eq_u32 vcc, -1, v19
    s_nop 0
    s_cbranch_vccz g_57k
    s_add_u32 s23, s23, 1
    s_cmp_lt_u32 s23, 200000
    s_cbranch_scc1 g_57
    s_mov_b32 s25, 200000
g_57k:
    v_smfmac_f32_16x16x64_bf16 v[64:67], v[24:27], a[192:199], v172
    v_smfmac_f32_16x16x64_bf16 v[68:71], v[24:27], a[224:231], v172
    v_smfmac_f32_16x16x64_bf16 v[64:67], v[28:31], a[200:207], v172
    v_smfmac_f32_16x16x64_bf16 v[68:71], v[28:31], a[232:239], v172
    v_smfmac_f32_16x16x64_bf16 v[64:67], v[32:35], a[208:215], v172
    v_smfmac_f32_16x16x64_bf16 v[68:71], v[32:35], a[240:247], v172
    v_smfmac_f32_16x16x64_bf16 v[64:67], v[36:39], a[216:223], v172
    v_smfmac_f32_16x16x64_bf16 v[68:71], v[36:39], a[248:255], v172
    s_nop 4
    v_cvt_pk_bf16_f32 v80, v64, v65
    v_cvt_pk_bf16_f32 v81, v66, v67
    s_nop 0
    v_cvt_pk_bf16_f32 v82, v68, v69
    v_cvt_pk_bf16_f32 v83, v70, v71
    ds_write_b128 v17, v[80:83] offset:9216
    s_waitcnt lgkmcnt(0)
    s_barrier
    s_mov_b32 s23, s25
fw_58:
    s_cmp_ge_u32 s85, s94
    s_cbranch_scc1 fo_59
    buffer_load_dword v247, v245, s[4:7], 0 offen sc1
    s_add_u32 s23, s23, 1
    s_waitcnt vmcnt(0)
    v_readfirstlane_b32 s85, v247
    s_cmp_lt_u32 s23, 200000
    s_cbranch_scc1 fw_58
    s_mov_b32 s25, 200000
fo_59:
    buffer_load_dwordx4 v[132:135], v12, s[4:7], s17 offen sc1
    buffer_load_dwordx4 v[136:139], v12, s[4:7], s17 offen offset:128 sc1
    s_add_u32 s17, s17, 2048
    s_min_u32 s17, s17, 17954816
    s_nop 15
    s_nop 15
    s_nop 15
    s_nop 15
    buffer_store_dwordx4 v[128:131], v14, s[4:7], s19 offen sc1
    s_add_u32 s19, s19, 512
    s_add_u32 s21, s15, 3
    s_min_u32 s21, s21, 64
    s_cmp_lt_u32 s85, s21
    s_cselect_b64 exec, 1, 0
    buffer_load_dword v247, v245, s[4:7], 0 offen sc1
    s_mov_b64 exec, -1
    v_mov_b32 v40, 0
    v_mov_b32 v41, 0
    v_mov_b32 v42, 0
    v_mov_b32 v43, 0
    v_mov_b32 v44, 0
    v_mov_b32 v45, 0
    v_mov_b32 v46, 0
    v_mov_b32 v47, 0
    v_mov_b32 v48, 0
    v_mov_b32 v49, 0
    v_mov_b32 v50, 0
    v_mov_b32 v51, 0
    v_mov_b32 v52, 0
    v_mov_b32 v53, 0
    v_mov_b32 v54, 0
    v_mov_b32 v55, 0
    v_mov_b32 v56, 0
    v_mov_b32 v57, 0
    v_mov_b32 v58, 0
    v_mov_b32 v59, 0
    v_mov_b32 v60, 0
    v_mov_b32 v61, 0
    v_mov_b32 v62, 0
    v_mov_b32 v63, 0
    v_mov_b32 v64, 0
    v_mov_b32 v65, 0
    v_mov_b32 v66, 0
    v_mov_b32 v67, 0
    v_mov_b32 v68, 0
    v_mov_b32 v69, 0
    v_mov_b32 v70, 0
    v_mov_b32 v71, 0
    s_mov_b32 s21, s16
    s_mov_b32 s16, s42
    s_mov_b32 s42, s43
    s_mov_b32 s43, s44
    s_mov_b32 s44, s21
    s_add_u32 s95, s95, 524288
    s_lshr_b32 s84, s95, 8
    s_and_b32 s84, s84, 8192
    s_xor_b32 s84, s84, s46
    s_add_u32 s84, s84, s95
    s_add_u32 s15, s15, 1
    s_barrier
    s_branch recur_slow_w0
recur_slow_last0:
    buffer_store_dwordx4 v[128:131], v14, s[4:7], s19 offen sc1
    s_waitcnt vmcnt(0)
    s_branch recur_end
.p2align 6
recur_slow_w1:
    s_nop 15
    s_mov_b32 s23, s25
g_60:
    buffer_load_dwordx4 v[24:27], v2, s[4:7], s16 offen offset:0 sc1
    buffer_load_dwordx4 v[28:31], v2, s[4:7], s16 offen offset:1024 sc1
    buffer_load_dwordx4 v[32:35], v2, s[4:7], s16 offen offset:2048 sc1
    buffer_load_dwordx4 v[36:39], v2, s[4:7], s16 offen offset:3072 sc1
    s_waitcnt vmcnt(0)
    v_max3_u32 v19, v24, v25, v26
    v_max3_u32 v19, v19, v27, v28
    v_max3_u32 v19, v19, v29, v30
    v_max3_u32 v19, v19, v31, v32
    v_max3_u32 v19, v19, v33, v34
    v_max3_u32 v19, v19, v35, v36
    v_max3_u32 v19, v19, v37, v38
    v_max_u32 v19, v19, v39
    v_cmp_eq_u32 vcc, -1, v19
    s_nop 0
    s_cbranch_vccz g_60k
    s_add_u32 s23, s23, 1
    s_cmp_lt_u32 s23, 200000
    s_cbranch_scc1 g_60
    s_mov_b32 s25, 200000
g_60k:
    v_smfmac_f32_16x16x64_bf16 v[40:43], v[24:27], a[0:7], v172
    v_smfmac_f32_16x16x64_bf16 v[44:47], v[24:27], a[64:71], v172
    v_smfmac_f32_16x16x64_bf16 v[48:51], v[24:27], a[32:39], v172
    v_smfmac_f32_16x16x64_bf16 v[52:55], v[24:27], a[96:103], v172
    v_smfmac_f32_16x16x64_bf16 v[40:43], v[28:31], a[8:15], v172
    v_smfmac_f32_16x16x64_bf16 v[44:47], v[28:31], a[72:79], v172
    v_smfmac_f32_16x16x64_bf16 v[48:51], v[28:31], a[40:47], v172
    v_smfmac_f32_16x16x64_bf16 v[52:55], v[28:31], a[104:111], v172
    v_smfmac_f32_16x16x64_bf16 v[40:43], v[32:35], a[16:23], v172
    v_smfmac_f32_16x16x64_bf16 v[44:47], v[32:35], a[80:87], v172
    v_smfmac_f32_16x16x64_bf16 v[48:51], v[32:35], a[48:55], v172
    v_smfmac_f32_16x16x64_bf16 v[52:55], v[32:35], a[112:119], v172
    v_smfmac_f32_16x16x64_bf16 v[40:43], v[36:39], a[24:31], v172
    v_smfmac_f32_16x16x64_bf16 v[44:47], v[36:39], a[88:95], v172
    v_smfmac_f32_16x16x64_bf16 v[48:51], v[36:39], a[56:63], v172
    v_smfmac_f32_16x16x64_bf16 v[52:55], v[36:39], a[120:127], v172
    v_cvt_pk_bf16_f32 v72, v40, v41
    v_cvt_pk_bf16_f32 v73, v42, v43
    v_cvt_pk_bf16_f32 v74, v44, v45
    v_cvt_pk_bf16_f32 v75, v46, v47
    ds_write_b128 v17, v[72:75] offset:0
    v_cvt_pk_bf16_f32 v76, v48, v49
    v_cvt_pk_bf16_f32 v77, v50, v51
    s_nop 0
    v_cvt_pk_bf16_f32 v78, v52, v53
    v_cvt_pk_bf16_f32 v79, v54, v55
    ds_write_b128 v17, v[76:79] offset:1024
    v_smfmac_f32_16x16x64_bf16 v[56:59], v[24:27], a[128:135], v172
    v_smfmac_f32_16x16x64_bf16 v[60:63], v[24:27], a[160:167], v172
    v_smfmac_f32_16x16x64_bf16 v[56:59], v[28:31], a[136:143], v172
    s_waitcnt lgkmcnt(0)
    s_barrier
    v_smfmac_f32_16x16x64_bf16 v[60:63], v[28:31], a[168:175], v172
    v_smfmac_f32_16x16x64_bf16 v[56:59], v[32:35], a[144:151], v172
    v_smfmac_f32_16x16x64_bf16 v[60:63], v[32:35], a[176:183], v172
    v_smfmac_f32_16x16x64_bf16 v[56:59], v[36:39], a[152:159], v172
    v_smfmac_f32_16x16x64_bf16 v[60:63], v[36:39], a[184:191], v172
    s_nop 4
    v_cvt_pk_bf16_f32 v80, v56, v57
    v_cvt_pk_bf16_f32 v81, v58, v59
    s_nop 0
    v_cvt_pk_bf16_f32 v82, v60, v61
    v_cvt_pk_bf16_f32 v83, v62, v63
    ds_write_b128 v17, v[80:83] offset:8192
    v_mov_b32 v152, v228
    v_mov_b32 v153, v229
    v_mov_b32 v156, v230
    v_mov_b32 v157, v231
    v_mov_b32 v160, v232
    v_mov_b32 v161, v233
    v_mov_b32 v164, v234
    v_mov_b32 v165, v235
    s_cmp_eq_u32 s15, 63
    s_waitcnt lgkmcnt(0)
    s_barrier
    s_cbranch_scc1 recur_end
    s_nop 15
    s_nop 15
    s_nop 7
    buffer_load_dwordx4 v[208:211], v5, s[4:7], s16 offen offset:0 sc1
    buffer_load_dwordx4 v[212:215], v5, s[4:7], s16 offen offset:1024 sc1
    buffer_load_dwordx4 v[216:219], v5, s[4:7], s16 offen offset:2048 sc1
    buffer_load_dwordx4 v[220:223], v5, s[4:7], s16 offen offset:3072 sc1
    buffer_load_dword v224, v6, s[4:7], s16 offen offset:0 sc1
    buffer_load_dword v225, v6, s[4:7], s16 offen offset:256 sc1
    buffer_load_dword v226, v6, s[4:7], s16 offen offset:512 sc1
    buffer_load_dword v227, v6, s[4:7], s16 offen offset:768 sc1
    s_mov_b32 s23, s25
    ds_read_b128 v[96:99], v16 offset:8192
    ds_read_b128 v[104:107], v16 offset:12288
    ds_read_b128 v[108:111], v16 offset:14336
    v_mfma_f32_16x16x32_bf16 v[140:143], v[84:87], v[80:83], 0
    s_waitcnt lgkmcnt(2)
    v_mfma_f32_16x16x32_bf16 v[140:143], v[84:87], v[96:99], v[140:143]
    s_waitcnt lgkmcnt(1)
    v_mfma_f32_16x16x32_bf16 v[140:143], v[84:87], v[104:107], v[140:143]
    s_waitcnt lgkmcnt(0)
    v_mfma_f32_16x16x32_bf16 v[140:143], v[84:87], v[108:111], v[140:143]
    buffer_load_dwordx4 v[24:27], v5, s[4:7], s16 offen offset:0 sc1
    buffer_load_dwordx4 v[28:31], v5, s[4:7], s16 offen offset:1024 sc1
    buffer_load_dwordx4 v[32:35], v5, s[4:7], s16 offen offset:2048 sc1
    buffer_load_dwordx4 v[36:39], v5, s[4:7], s16 offen offset:3072 sc1
    buffer_load_dword v40, v6, s[4:7], s16 offen offset:0 sc1
    buffer_load_dword v41, v6, s[4:7], s16 offen offset:256 sc1
    buffer_load_dword v42, v6, s[4:7], s16 offen offset:512 sc1
    buffer_load_dword v43, v6, s[4:7], s16 offen offset:768 sc1
    v_cvt_pk_bf16_f32 v154, v140, v179
    v_cvt_pk_bf16_f32 v158, v141, v179
    v_cvt_pk_bf16_f32 v162, v142, v179
    v_cvt_pk_bf16_f32 v166, v143, v179
    s_waitcnt vmcnt(14)
    v_pk_add_f32 v[180:181], v[208:209], v[212:213]
    v_pk_add_f32 v[182:183], v[210:211], v[214:215]
    s_waitcnt vmcnt(12)
    v_pk_add_f32 v[188:189], v[216:217], v[220:221]
    v_pk_add_f32 v[190:191], v[218:219], v[222:223]
    v_pk_add_f32 v[180:181], v[180:181], v[188:189]
    v_pk_add_f32 v[182:183], v[182:183], v[190:191]
    v_pk_add_f32 v[188:189], v[180:181], v[182:183]
    v_max3_f32 v185, v180, v181, v182
    s_waitcnt vmcnt(8)
    v_pk_add_f32 v[192:193], v[224:225], v[226:227]
    v_add_f32 v188, v188, v189
    v_add_f32 v184, v192, v193
    v_max3_f32 v185, v185, v183, v184
    v_cmp_u_f32 vcc, v188, v184
    s_nop 0
    v_max_f32_dpp v185, v185, v185 row_ror:8 row_mask:0xf bank_mask:0xf
    v_mov_b32 v186, v185
    s_nop 1
    v_permlane16_swap_b32 v185, v186
    v_max_f32 v185, v185, v186
    v_mov_b32 v186, v185
    s_cbranch_vccnz ss_61
sg_63:
    s_nop 0
    v_permlane32_swap_b32 v185, v186
    v_max_f32 v185, v185, v186
    v_mul_f32 v185, s24, v185
    v_fma_f32 v180, v180, s24, -v185
    v_fma_f32 v181, v181, s24, -v185
    v_fma_f32 v182, v182, s24, -v185
    v_fma_f32 v183, v183, s24, -v185
    v_fma_f32 v184, v184, s24, -v185
    v_exp_f32 v180, v180
    v_exp_f32 v181, v181
    v_exp_f32 v182, v182
    v_exp_f32 v183, v183
    v_exp_f32 v184, v184
    v_cvt_pk_bf16_f32 v176, v180, v181
    v_cvt_pk_bf16_f32 v177, v182, v183
    v_cvt_pk_bf16_f32 v178, v184, v179
    s_nop 1
    v_mfma_f32_16x16x32_bf16 v[240:243], v[236:239], v[176:179], 0
    v_mfma_f32_16x16x32_bf16 v[188:191], v[152:155], v[176:179], 0
    v_mfma_f32_16x16x32_bf16 v[192:195], v[156:159], v[176:179], 0
    v_mfma_f32_16x16x32_bf16 v[196:199], v[160:163], v[176:179], 0
    v_mfma_f32_16x16x32_bf16 v[200:203], v[164:167], v[176:179], 0
    v_add_f32_dpp v185, v240, v240 row_ror:8 row_mask:0xf bank_mask:0xf
    v_rcp_f32 v185, v185
    v_add_f32_dpp v88, v192, v188 row_ror:8 row_mask:0xf bank_mask:0x3
    v_add_f32_dpp v89, v193, v189 row_ror:8 row_mask:0xf bank_mask:0x3
    v_add_f32_dpp v90, v194, v190 row_ror:8 row_mask:0xf bank_mask:0x3
    v_add_f32_dpp v91, v195, v191 row_ror:8 row_mask:0xf bank_mask:0x3
    s_nop 1
    v_add_f32_dpp v88, v196, v200 row_ror:8 row_mask:0xf bank_mask:0xc
    v_add_f32_dpp v89, v197, v201 row_ror:8 row_mask:0xf bank_mask:0xc
    v_add_f32_dpp v90, v198, v202 row_ror:8 row_mask:0xf bank_mask:0xc
    v_add_f32_dpp v91, v199, v203 row_ror:8 row_mask:0xf bank_mask:0xc
    v_mul_f32 v88, v88, v185
    v_mul_f32 v89, v89, v185
    v_mul_f32 v90, v90, v185
    v_mul_f32 v91, v91, v185
    v_cvt_pk_bf16_f32 v88, v88, v89
    v_cvt_pk_bf16_f32 v89, v90, v91
    buffer_store_dwordx2 v[88:89], v7, s[4:7], s16 offen sc1
    v_readfirstlane_b32 s85, v247
    s_add_u32 s94, s15, 2
    s_barrier
    s_nop 15
    s_mov_b32 s23, s25
g_64:
    buffer_load_dwordx4 v[24:27], v8, s[4:7], s16 offen offset:0 sc1
    buffer_load_dwordx4 v[28:31], v8, s[4:7], s16 offen offset:1024 sc1
    buffer_load_dwordx4 v[32:35], v8, s[4:7], s16 offen offset:2048 sc1
    buffer_load_dwordx4 v[36:39], v8, s[4:7], s16 offen offset:3072 sc1
    s_waitcnt vmcnt(0)
    v_max3_u32 v19, v24, v25, v26
    v_max3_u32 v19, v19, v27, v28
    v_max3_u32 v19, v19, v29, v30
    v_max3_u32 v19, v19, v31, v32
    v_max3_u32 v19, v19, v33, v34
    v_max3_u32 v19, v19, v35, v36
    v_max3_u32 v19, v19, v37, v38
    v_max_u32 v19, v19, v39
    v_cmp_eq_u32 vcc, -1, v19
    s_nop 0
    s_cbranch_vccz g_64k
    s_add_u32 s23, s23, 1
    s_cmp_lt_u32 s23, 200000
    s_cbranch_scc1 g_64
    s_mov_b32 s25, 200000
g_64k:
    v_smfmac_f32_16x16x64_bf16 v[64:67], v[24:27], a[192:199], v172
    v_smfmac_f32_16x16x64_bf16 v[68:71], v[24:27], a[224:231], v172
    v_smfmac_f32_16x16x64_bf16 v[64:67], v[28:31], a[200:207], v172
    v_smfmac_f32_16x16x64_bf16 v[68:71], v[28:31], a[232:239], v172
    v_smfmac_f32_16x16x64_bf16 v[64:67], v[32:35], a[208:215], v172
    v_smfmac_f32_16x16x64_bf16 v[68:71], v[32:35], a[240:247], v172
    v_smfmac_f32_16x16x64_bf16 v[64:67], v[36:39], a[216:223], v172
    v_smfmac_f32_16x16x64_bf16 v[68:71], v[36:39], a[248:255], v172
    s_nop 4
    v_cvt_pk_bf16_f32 v80, v64, v65
    v_cvt_pk_bf16_f32 v81, v66, v67
    s_nop 0
    v_cvt_pk_bf16_f32 v82, v68, v69
    v_cvt_pk_bf16_f32 v83, v70, v71
    ds_write_b128 v17, v[80:83] offset:9216
    s_waitcnt lgkmcnt(0)
    s_barrier
    s_mov_b32 s23, s25
fw_65:
    s_cmp_ge_u32 s85, s94
    s_cbranch_scc1 fo_66
    buffer_load_dword v247, v245, s[4:7], 0 offen sc1
    s_add_u32 s23, s23, 1
    s_waitcnt vmcnt(0)
    v_readfirstlane_b32 s85, v247
    s_cmp_lt_u32 s23, 200000
    s_cbranch_scc1 fw_65
    s_mov_b32 s25, 200000
fo_66:
    buffer_load_dwordx4 v[228:231], v13, s[4:7], s18 offen offset:0 sc1
    buffer_load_dwordx4 v[232:235], v13, s[4:7], s18 offen offset:128 sc1
    s_add_u32 s18, s18, 2048
    s_min_u32 s18, s18, 35780608
    s_nop 15
    s_nop 15
    s_nop 15
    s_nop 15
    s_add_u32 s21, s15, 3
    s_min_u32 s21, s21, 64
    s_cmp_lt_u32 s85, s21
    s_cselect_b64 exec, 1, 0
    buffer_load_dword v247, v245, s[4:7], 0 offen sc1
    s_mov_b64 exec, -1
    v_mov_b32 v40, 0
    v_mov_b32 v41, 0
    v_mov_b32 v42, 0
    v_mov_b32 v43, 0
    v_mov_b32 v44, 0
    v_mov_b32 v45, 0
    v_mov_b32 v46, 0
    v_mov_b32 v47, 0
    v_mov_b32 v48, 0
    v_mov_b32 v49, 0
    v_mov_b32 v50, 0
    v_mov_b32 v51, 0
    v_mov_b32 v52, 0
    v_mov_b32 v53, 0
    v_mov_b32 v54, 0
    v_mov_b32 v55, 0
    v_mov_b32 v56, 0
    v_mov_b32 v57, 0
    v_mov_b32 v58, 0
    v_mov_b32 v59, 0
    v_mov_b32 v60, 0
    v_mov_b32 v61, 0
    v_mov_b32 v62, 0
    v_mov_b32 v63, 0
    v_mov_b32 v64, 0
    v_mov_b32 v65, 0
    v_mov_b32 v66, 0
    v_mov_b32 v67, 0
    v_mov_b32 v68, 0
    v_mov_b32 v69, 0
    v_mov_b32 v70, 0
    v_mov_b32 v71, 0
    s_mov_b32 s21, s16
    s_mov_b32 s16, s42
    s_mov_b32 s42, s43
    s_mov_b32 s43, s44
    s_mov_b32 s44, s21
    s_add_u32 s95, s95, 524288
    s_lshr_b32 s84, s95, 8
    s_and_b32 s84, s84, 8192
    s_xor_b32 s84, s84, s46
    s_add_u32 s84, s84, s95
    s_add_u32 s15, s15, 1
    s_barrier
    s_branch recur_slow_w1
sb_62:
    v_max3_u32 v19, v24, v25, v26
    v_max3_u32 v19, v19, v27, v28
    v_max3_u32 v19, v19, v29, v30
    v_max3_u32 v19, v19, v31, v32
    v_max3_u32 v19, v19, v33, v34
    v_max3_u32 v19, v19, v35, v36
    v_max3_u32 v19, v19, v37, v38
    v_max3_u32 v19, v19, v39, v40
    v_max3_u32 v19, v19, v41, v42
    v_max_u32 v19, v19, v43
    v_cmp_eq_u32 vcc, -1, v19
    s_nop 0
    s_cbranch_vccz sg_63
    buffer_load_dwordx4 v[24:27], v5, s[4:7], s16 offen offset:0 sc1
    buffer_load_dwordx4 v[28:31], v5, s[4:7], s16 offen offset:1024 sc1
    buffer_load_dwordx4 v[32:35], v5, s[4:7], s16 offen offset:2048 sc1
    buffer_load_dwordx4 v[36:39], v5, s[4:7], s16 offen offset:3072 sc1
    buffer_load_dword v40, v6, s[4:7], s16 offen offset:0 sc1
    buffer_load_dword v41, v6, s[4:7], s16 offen offset:256 sc1
    buffer_load_dword v42, v6, s[4:7], s16 offen offset:512 sc1
    buffer_load_dword v43, v6, s[4:7], s16 offen offset:768 sc1
    s_add_u32 s23, s23, 1
    s_cmp_lt_u32 s23, 200000
    s_cbranch_scc1 ss_61
    s_mov_b32 s25, 200000
    s_branch sg_63
ss_61:
    s_waitcnt vmcnt(6)
    v_pk_add_f32 v[180:181], v[24:25], v[28:29]
    v_pk_add_f32 v[182:183], v[26:27], v[30:31]
    s_waitcnt vmcnt(4)
    v_pk_add_f32 v[188:189], v[32:33], v[36:37]
    v_pk_add_f32 v[190:191], v[34:35], v[38:39]
    v_pk_add_f32 v[180:181], v[180:181], v[188:189]
    v_pk_add_f32 v[182:183], v[182:183], v[190:191]
    v_pk_add_f32 v[188:189], v[180:181], v[182:183]
    v_max3_f32 v185, v180, v181, v182
    s_waitcnt vmcnt(0)
    v_pk_add_f32 v[192:193], v[40:41], v[42:43]
    v_add_f32 v188, v188, v189
    v_add_f32 v184, v192, v193
    v_max3_f32 v185, v185, v183, v184
    v_cmp_u_f32 vcc, v188, v184
    s_nop 0
    v_max_f32_dpp v185, v185, v185 row_ror:8 row_mask:0xf bank_mask:0xf
    v_mov_b32 v186, v185
    s_nop 1
    v_permlane16_swap_b32 v185, v186
    v_max_f32 v185, v185, v186
    v_mov_b32 v186, v185
    s_cbranch_vccnz sb_62
    s_branch sg_63
.p2align 6
recur_slow_w2:
    s_nop 15
    s_mov_b32 s23, s25
g_67:
    buffer_load_dwordx4 v[24:27], v2, s[4:7], s16 offen offset:0 sc1
    buffer_load_dwordx4 v[28:31], v2, s[4:7], s16 offen offset:1024 sc1
    buffer_load_dwordx4 v[32:35], v2, s[4:7], s16 offen offset:2048 sc1
    buffer_load_dwordx4 v[36:39], v2, s[4:7], s16 offen offset:3072 sc1
    s_waitcnt vmcnt(0)
    v_max3_u32 v19, v24, v25, v26
    v_max3_u32 v19, v19, v27, v28
    v_max3_u32 v19, v19, v29, v30
    v_max3_u32 v19, v19, v31, v32
    v_max3_u32 v19, v19, v33, v34
    v_max3_u32 v19, v19, v35, v36
    v_max3_u32 v19, v19, v37, v38
    v_max_u32 v19, v19, v39
    v_cmp_eq_u32 vcc, -1, v19
    s_nop 0
    s_cbranch_vccz g_67k
    s_add_u32 s23, s23, 1
    s_cmp_lt_u32 s23, 200000
    s_cbranch_scc1 g_67
    s_mov_b32 s25, 200000
g_67k:
    v_smfmac_f32_16x16x64_bf16 v[40:43], v[24:27], a[0:7], v172
    v_smfmac_f32_16x16x64_bf16 v[44:47], v[24:27], a[64:71], v172
    v_smfmac_f32_16x16x64_bf16 v[48:51], v[24:27], a[32:39], v172
    v_smfmac_f32_16x16x64_bf16 v[52:55], v[24:27], a[96:103], v172
    v_smfmac_f32_16x16x64_bf16 v[40:43], v[28:31], a[8:15], v172
    v_smfmac_f32_16x16x64_bf16 v[44:47], v[28:31], a[72:79], v172
    v_smfmac_f32_16x16x64_bf16 v[48:51], v[28:31], a[40:47], v172
    v_smfmac_f32_16x16x64_bf16 v[52:55], v[28:31], a[104:111], v172
    v_smfmac_f32_16x16x64_bf16 v[40:43], v[32:35], a[16:23], v172
    v_smfmac_f32_16x16x64_bf16 v[44:47], v[32:35], a[80:87], v172
    v_smfmac_f32_16x16x64_bf16 v[48:51], v[32:35], a[48:55], v172
    v_smfmac_f32_16x16x64_bf16 v[52:55], v[32:35], a[112:119], v172
    v_smfmac_f32_16x16x64_bf16 v[40:43], v[36:39], a[24:31], v172
    v_smfmac_f32_16x16x64_bf16 v[44:47], v[36:39], a[88:95], v172
    v_smfmac_f32_16x16x64_bf16 v[48:51], v[36:39], a[56:63], v172
    v_smfmac_f32_16x16x64_bf16 v[52:55], v[36:39], a[120:127], v172
    v_cvt_pk_bf16_f32 v72, v40, v41
    v_cvt_pk_bf16_f32 v73, v42, v43
    v_cvt_pk_bf16_f32 v74, v44, v45
    v_cvt_pk_bf16_f32 v75, v46, v47
    ds_write_b128 v17, v[72:75] offset:0
    v_cvt_pk_bf16_f32 v76, v48, v49
    v_cvt_pk_bf16_f32 v77, v50, v51
    s_nop 0
    v_cvt_pk_bf16_f32 v78, v52, v53
    v_cvt_pk_bf16_f32 v79, v54, v55
    ds_write_b128 v17, v[76:79] offset:1024
    v_smfmac_f32_16x16x64_bf16 v[56:59], v[24:27], a[128:135], v172
    v_smfmac_f32_16x16x64_bf16 v[60:63], v[24:27], a[160:167], v172
    v_smfmac_f32_16x16x64_bf16 v[56:59], v[28:31], a[136:143], v172
    s_waitcnt lgkmcnt(0)
    s_barrier
    v_smfmac_f32_16x16x64_bf16 v[60:63], v[28:31], a[168:175], v172
    v_smfmac_f32_16x16x64_bf16 v[56:59], v[32:35], a[144:151], v172
    v_smfmac_f32_16x16x64_bf16 v[60:63], v[32:35], a[176:183], v172
    v_smfmac_f32_16x16x64_bf16 v[56:59], v[36:39], a[152:159], v172
    v_smfmac_f32_16x16x64_bf16 v[60:63], v[36:39], a[184:191], v172
    s_nop 4
    v_cvt_pk_bf16_f32 v80, v56, v57
    v_cvt_pk_bf16_f32 v81, v58, v59
    s_nop 0
    v_cvt_pk_bf16_f32 v82, v60, v61
    v_cvt_pk_bf16_f32 v83, v62, v63
    ds_write_b128 v17, v[80:83] offset:8192
    s_cmp_eq_u32 s15, 63
    s_waitcnt lgkmcnt(0)
    s_barrier
    ds_read_b128 v[96:99], v16 offset:8192
    ds_read_b128 v[100:103], v16 offset:10240
    ds_read_b128 v[108:111], v16 offset:14336
    v_mfma_f32_16x16x32_bf16 v[140:143], v[84:87], v[80:83], 0
    s_waitcnt lgkmcnt(2)
    v_mfma_f32_16x16x32_bf16 v[140:143], v[84:87], v[96:99], v[140:143]
    s_waitcnt lgkmcnt(1)
    v_mfma_f32_16x16x32_bf16 v[140:143], v[84:87], v[100:103], v[140:143]
    s_waitcnt lgkmcnt(0)
    v_mfma_f32_16x16x32_bf16 v[140:143], v[84:87], v[108:111], v[140:143]
    s_nop 7
    v_cvt_pk_bf16_f32 v168, v140, v141
    v_cvt_pk_bf16_f32 v169, v142, v143
    v_mov_b32 v170, v168
    v_mov_b32 v171, v169
    s_nop 0
    v_permlane16_swap_b32 v168, v170
    v_permlane16_swap_b32 v169, v171
    v_mov_b32 v247, s15
    s_cbranch_scc1 recur_slow_last2
    s_barrier
    s_nop 15
    s_mov_b32 s23, s25
g_68:
    buffer_load_dwordx4 v[24:27], v8, s[4:7], s16 offen offset:0 sc1
    buffer_load_dwordx4 v[28:31], v8, s[4:7], s16 offen offset:1024 sc1
    buffer_load_dwordx4 v[32:35], v8, s[4:7], s16 offen offset:2048 sc1
    buffer_load_dwordx4 v[36:39], v8, s[4:7], s16 offen offset:3072 sc1
    s_waitcnt vmcnt(0)
    v_max3_u32 v19, v24, v25, v26
    v_max3_u32 v19, v19, v27, v28
    v_max3_u32 v19, v19, v29, v30
    v_max3_u32 v19, v19, v31, v32
    v_max3_u32 v19, v19, v33, v34
    v_max3_u32 v19, v19, v35, v36
    v_max3_u32 v19, v19, v37, v38
    v_max_u32 v19, v19, v39
    v_cmp_eq_u32 vcc, -1, v19
    s_nop 0
    s_cbranch_vccz g_68k
    s_add_u32 s23, s23, 1
    s_cmp_lt_u32 s23, 200000
    s_cbranch_scc1 g_68
    s_mov_b32 s25, 200000
g_68k:
    v_smfmac_f32_16x16x64_bf16 v[64:67], v[24:27], a[192:199], v172
    v_smfmac_f32_16x16x64_bf16 v[68:71], v[24:27], a[224:231], v172
    v_smfmac_f32_16x16x64_bf16 v[64:67], v[28:31], a[200:207], v172
    v_smfmac_f32_16x16x64_bf16 v[68:71], v[28:31], a[232:239], v172
    v_smfmac_f32_16x16x64_bf16 v[64:67], v[32:35], a[208:215], v172
    v_smfmac_f32_16x16x64_bf16 v[68:71], v[32:35], a[240:247], v172
    v_smfmac_f32_16x16x64_bf16 v[64:67], v[36:39], a[216:223], v172
    v_smfmac_f32_16x16x64_bf16 v[68:71], v[36:39], a[248:255], v172
    s_nop 4
    v_cvt_pk_bf16_f32 v80, v64, v65
    v_cvt_pk_bf16_f32 v81, v66, v67
    s_nop 0
    v_cvt_pk_bf16_f32 v82, v68, v69
    v_cvt_pk_bf16_f32 v83, v70, v71
    ds_write_b128 v17, v[80:83] offset:9216
    s_waitcnt lgkmcnt(0)
    s_barrier
    s_nop 15
    s_nop 15
    s_nop 15
    s_nop 15
    buffer_store_dwordx4 v[168:171], v15, s[4:7], s20 offen sc1
    s_add_u32 s20, s20, 512
    s_add_u32 s21, s95, 1048576
    s_lshr_b32 s22, s21, 8
    s_and_b32 s22, s22, 8192
    s_xor_b32 s22, s22, s46
    s_add_u32 s21, s21, s22
    buffer_store_dwordx4 v[204:207], v9, s[4:7], s21 offen sc1
    s_add_u32 s21, s21, 262144
    buffer_store_dword v247, v246, s[4:7], 0 offen sc1
    v_mov_b32 v40, 0
    v_mov_b32 v41, 0
    v_mov_b32 v42, 0
    v_mov_b32 v43, 0
    v_mov_b32 v44, 0
    v_mov_b32 v45, 0
    v_mov_b32 v46, 0
    v_mov_b32 v47, 0
    v_mov_b32 v48, 0
    v_mov_b32 v49, 0
    v_mov_b32 v50, 0
    v_mov_b32 v51, 0
    v_mov_b32 v52, 0
    v_mov_b32 v53, 0
    v_mov_b32 v54, 0
    v_mov_b32 v55, 0
    v_mov_b32 v56, 0
    v_mov_b32 v57, 0
    v_mov_b32 v58, 0
    v_mov_b32 v59, 0
    v_mov_b32 v60, 0
    v_mov_b32 v61, 0
    v_mov_b32 v62, 0
    v_mov_b32 v63, 0
    v_mov_b32 v64, 0
    v_mov_b32 v65, 0
    v_mov_b32 v66, 0
    v_mov_b32 v67, 0
    v_mov_b32 v68, 0
    v_mov_b32 v69, 0
    v_mov_b32 v70, 0
    v_mov_b32 v71, 0
    s_mov_b32 s21, s16
    s_mov_b32 s16, s42
    s_mov_b32 s42, s43
    s_mov_b32 s43, s44
    s_mov_b32 s44, s21
    s_add_u32 s95, s95, 524288
    s_lshr_b32 s84, s95, 8
    s_and_b32 s84, s84, 8192
    s_xor_b32 s84, s84, s46
    s_add_u32 s84, s84, s95
    s_add_u32 s15, s15, 1
    s_barrier
    s_branch recur_slow_w2
recur_slow_last2:
    buffer_store_dwordx4 v[168:171], v15, s[4:7], s20 offen sc1
    s_waitcnt vmcnt(0)
    s_branch recur_end
.p2align 6
recur_slow_w3:
    s_nop 15
    s_mov_b32 s23, s25
g_69:
    buffer_load_dwordx4 v[24:27], v2, s[4:7], s16 offen offset:0 sc1
    buffer_load_dwordx4 v[28:31], v2, s[4:7], s16 offen offset:1024 sc1
    buffer_load_dwordx4 v[32:35], v2, s[4:7], s16 offen offset:2048 sc1
    buffer_load_dwordx4 v[36:39], v2, s[4:7], s16 offen offset:3072 sc1
    s_waitcnt vmcnt(0)
    v_max3_u32 v19, v24, v25, v26
    v_max3_u32 v19, v19, v27, v28
    v_max3_u32 v19, v19, v29, v30
    v_max3_u32 v19, v19, v31, v32
    v_max3_u32 v19, v19, v33, v34
    v_max3_u32 v19, v19, v35, v36
    v_max3_u32 v19, v19, v37, v38
    v_max_u32 v19, v19, v39
    v_cmp_eq_u32 vcc, -1, v19
    s_nop 0
    s_cbranch_vccz g_69k
    s_add_u32 s23, s23, 1
    s_cmp_lt_u32 s23, 200000
    s_cbranch_scc1 g_69
    s_mov_b32 s25, 200000
g_69k:
    v_smfmac_f32_16x16x64_bf16 v[40:43], v[24:27], a[0:7], v172
    v_smfmac_f32_16x16x64_bf16 v[44:47], v[24:27], a[64:71], v172
    v_smfmac_f32_16x16x64_bf16 v[48:51], v[24:27], a[32:39], v172
    v_smfmac_f32_16x16x64_bf16 v[52:55], v[24:27], a[96:103], v172
    v_smfmac_f32_16x16x64_bf16 v[40:43], v[28:31], a[8:15], v172
    v_smfmac_f32_16x16x64_bf16 v[44:47], v[28:31], a[72:79], v172
    v_smfmac_f32_16x16x64_bf16 v[48:51], v[28:31], a[40:47], v172
    v_smfmac_f32_16x16x64_bf16 v[52:55], v[28:31], a[104:111], v172
    v_smfmac_f32_16x16x64_bf16 v[40:43], v[32:35], a[16:23], v172
    v_smfmac_f32_16x16x64_bf16 v[44:47], v[32:35], a[80:87], v172
    v_smfmac_f32_16x16x64_bf16 v[48:51], v[32:35], a[48:55], v172
    v_smfmac_f32_16x16x64_bf16 v[52:55], v[32:35], a[112:119], v172
    v_smfmac_f32_16x16x64_bf16 v[40:43], v[36:39], a[24:31], v172
    v_smfmac_f32_16x16x64_bf16 v[44:47], v[36:39], a[88:95], v172
    v_smfmac_f32_16x16x64_bf16 v[48:51], v[36:39], a[56:63], v172
    v_smfmac_f32_16x16x64_bf16 v[52:55], v[36:39], a[120:127], v172
    v_cvt_pk_bf16_f32 v72, v40, v41
    v_cvt_pk_bf16_f32 v73, v42, v43
    v_cvt_pk_bf16_f32 v74, v44, v45
    v_cvt_pk_bf16_f32 v75, v46, v47
    ds_write_b128 v17, v[72:75] offset:0
    v_cvt_pk_bf16_f32 v76, v48, v49
    v_cvt_pk_bf16_f32 v77, v50, v51
    s_nop 0
    v_cvt_pk_bf16_f32 v78, v52, v53
    v_cvt_pk_bf16_f32 v79, v54, v55
    ds_write_b128 v17, v[76:79] offset:1024
    v_smfmac_f32_16x16x64_bf16 v[56:59], v[24:27], a[128:135], v172
    v_smfmac_f32_16x16x64_bf16 v[60:63], v[24:27], a[160:167], v172
    v_smfmac_f32_16x16x64_bf16 v[56:59], v[28:31], a[136:143], v172
    s_waitcnt lgkmcnt(0)
    s_barrier
    v_smfmac_f32_16x16x64_bf16 v[60:63], v[28:31], a[168:175], v172
    v_smfmac_f32_16x16x64_bf16 v[56:59], v[32:35], a[144:151], v172
    v_smfmac_f32_16x16x64_bf16 v[60:63], v[32:35], a[176:183], v172
    v_smfmac_f32_16x16x64_bf16 v[56:59], v[36:39], a[152:159], v172
    v_smfmac_f32_16x16x64_bf16 v[60:63], v[36:39], a[184:191], v172
    s_nop 4
    v_cvt_pk_bf16_f32 v80, v56, v57
    v_cvt_pk_bf16_f32 v81, v58, v59
    s_nop 0
    v_cvt_pk_bf16_f32 v82, v60, v61
    v_cvt_pk_bf16_f32 v83, v62, v63
    ds_write_b128 v17, v[80:83] offset:8192
    buffer_store_dwordx4 v[204:207], v3, s[4:7], s43 offen sc1
    buffer_store_dwordx4 v[204:207], v3, s[4:7], s43 offen offset:128 sc1
    buffer_store_dwordx4 v[204:207], v4, s[4:7], s43 offen sc1
    buffer_store_dwordx2 v[204:205], v7, s[4:7], s43 offen sc1
    buffer_store_dwordx2 v[204:205], v11, s[4:7], s43 offen sc1
    s_cmp_eq_u32 s15, 63
    s_waitcnt lgkmcnt(0)
    s_barrier
    s_cbranch_scc1 recur_end
    s_barrier
    s_nop 15
    s_mov_b32 s23, s25
g_70:
    buffer_load_dwordx4 v[24:27], v8, s[4:7], s16 offen offset:0 sc1
    buffer_load_dwordx4 v[28:31], v8, s[4:7], s16 offen offset:1024 sc1
    buffer_load_dwordx4 v[32:35], v8, s[4:7], s16 offen offset:2048 sc1
    buffer_load_dwordx4 v[36:39], v8, s[4:7], s16 offen offset:3072 sc1
    s_waitcnt vmcnt(0)
    v_max3_u32 v19, v24, v25, v26
    v_max3_u32 v19, v19, v27, v28
    v_max3_u32 v19, v19, v29, v30
    v_max3_u32 v19, v19, v31, v32
    v_max3_u32 v19, v19, v33, v34
    v_max3_u32 v19, v19, v35, v36
    v_max3_u32 v19, v19, v37, v38
    v_max_u32 v19, v19, v39
    v_cmp_eq_u32 vcc, -1, v19
    s_nop 0
    s_cbranch_vccz g_70k
    s_add_u32 s23, s23, 1
    s_cmp_lt_u32 s23, 200000
    s_cbranch_scc1 g_70
    s_mov_b32 s25, 200000
g_70k:
    v_smfmac_f32_16x16x64_bf16 v[64:67], v[24:27], a[192:199], v172
    v_smfmac_f32_16x16x64_bf16 v[68:71], v[24:27], a[224:231], v172
    v_smfmac_f32_16x16x64_bf16 v[64:67], v[28:31], a[200:207], v172
    v_smfmac_f32_16x16x64_bf16 v[68:71], v[28:31], a[232:239], v172
    v_smfmac_f32_16x16x64_bf16 v[64:67], v[32:35], a[208:215], v172
    v_smfmac_f32_16x16x64_bf16 v[68:71], v[32:35], a[240:247], v172
    v_smfmac_f32_16x16x64_bf16 v[64:67], v[36:39], a[216:223], v172
    v_smfmac_f32_16x16x64_bf16 v[68:71], v[36:39], a[248:255], v172
    s_nop 4
    v_cvt_pk_bf16_f32 v80, v64, v65
    v_cvt_pk_bf16_f32 v81, v66, v67
    s_nop 0
    v_cvt_pk_bf16_f32 v82, v68, v69
    v_cvt_pk_bf16_f32 v83, v70, v71
    s_nop 1
    v_mfma_f32_16x16x32_bf16 v[88:91], v[80:83], v[84:87], 0
    s_barrier
    ds_read_b128 v[96:99], v16 offset:9216
    ds_read_b128 v[100:103], v16 offset:11264
    ds_read_b128 v[104:107], v16 offset:13312
    s_waitcnt lgkmcnt(2)
    v_mfma_f32_16x16x32_bf16 v[88:91], v[96:99], v[84:87], v[88:91]
    s_waitcnt lgkmcnt(1)
    v_mfma_f32_16x16x32_bf16 v[88:91], v[100:103], v[84:87], v[88:91]
    s_waitcnt lgkmcnt(0)
    v_mfma_f32_16x16x32_bf16 v[88:91], v[104:107], v[84:87], v[88:91]
    s_nop 7
    buffer_store_dwordx4 v[88:91], v9, s[4:7], s84 offen sc1
    s_add_u32 s22, s84, 262144
    s_nop 15
    s_nop 15
    s_nop 15
    s_nop 15
    s_nop 15
    s_nop 15
    s_nop 15
    s_nop 15
    s_nop 15
    s_mov_b32 s23, s25
    buffer_load_dwordx4 v[96:99], v10, s[4:7], s84 offen sc1
    buffer_load_dwordx4 v[100:103], v23, s[4:7], s84 offen sc1
    buffer_load_dwordx4 v[104:107], v244, s[4:7], s84 offen sc1
    v_mov_b32 v40, 0
    v_mov_b32 v41, 0
    v_mov_b32 v42, 0
    v_mov_b32 v43, 0
    v_mov_b32 v44, 0
    v_mov_b32 v45, 0
    v_mov_b32 v46, 0
    v_mov_b32 v47, 0
    v_mov_b32 v48, 0
    v_mov_b32 v49, 0
    v_mov_b32 v50, 0
    v_mov_b32 v51, 0
    v_mov_b32 v52, 0
    v_mov_b32 v53, 0
    v_mov_b32 v54, 0
    v_mov_b32 v55, 0
    v_mov_b32 v56, 0
    v_mov_b32 v57, 0
    v_mov_b32 v58, 0
    v_mov_b32 v59, 0
    v_mov_b32 v60, 0
    v_mov_b32 v61, 0
    v_mov_b32 v62, 0
    v_mov_b32 v63, 0
    v_mov_b32 v64, 0
    v_mov_b32 v65, 0
    v_mov_b32 v66, 0
    v_mov_b32 v67, 0
    v_mov_b32 v68, 0
    v_mov_b32 v69, 0
    v_mov_b32 v70, 0
    v_mov_b32 v71, 0
pb_73:
    s_waitcnt vmcnt(2)
    v_pk_add_f32 v[120:121], v[88:89], v[96:97]
    v_pk_add_f32 v[122:123], v[90:91], v[98:99]
    s_waitcnt vmcnt(1)
    v_pk_add_f32 v[120:121], v[120:121], v[100:101]
    v_pk_add_f32 v[122:123], v[122:123], v[102:103]
    s_waitcnt vmcnt(0)
    v_pk_add_f32 v[120:121], v[120:121], v[104:105]
    v_pk_add_f32 v[122:123], v[122:123], v[106:107]
    v_cvt_pk_bf16_f32 v180, v120, v121
    v_pk_add_f32 v[124:125], v[120:121], v[122:123]
    v_cvt_pk_bf16_f32 v181, v122, v123
    v_cmpx_o_f32 vcc, v124, v125
    buffer_store_dwordx2 v[180:181], v11, s[4:7], s42 offen sc1
    s_cmp_eq_u64 vcc, -1
    s_mov_b64 exec, -1
    s_cbranch_scc0 pr_71
pg_72:
    s_barrier
    s_mov_b32 s21, s16
    s_mov_b32 s16, s42
    s_mov_b32 s42, s43
    s_mov_b32 s43, s44
    s_mov_b32 s44, s21
    s_add_u32 s95, s95, 524288
    s_lshr_b32 s84, s95, 8
    s_and_b32 s84, s84, 8192
    s_xor_b32 s84, s84, s46
    s_add_u32 s84, s84, s95
    s_add_u32 s15, s15, 1
    s_branch recur_slow_w3
pr_71:
    v_max3_u32 v19, v96, v97, v98
    v_max3_u32 v19, v19, v99, v100
    v_max3_u32 v19, v19, v101, v102
    v_max3_u32 v19, v19, v103, v104
    v_max3_u32 v19, v19, v105, v106
    v_max_u32 v19, v19, v107
    v_cmp_eq_u32 vcc, -1, v19
    s_nop 0
    s_cbranch_vccz pf_75
    buffer_load_dwordx4 v[96:99], v10, s[4:7], s84 offen sc1
    buffer_load_dwordx4 v[100:103], v23, s[4:7], s84 offen sc1
    buffer_load_dwordx4 v[104:107], v244, s[4:7], s84 offen sc1
    s_add_u32 s23, s23, 1
    s_cmp_lt_u32 s23, 200000
    s_cbranch_scc1 pb_73
    s_mov_b32 s25, 200000
pf_75:
    buffer_store_dwordx2 v[180:181], v11, s[4:7], s42 offen sc1
    s_branch pg_72
recur_end:
    s_barrier
    v_mov_b32 v247, 64
    buffer_store_dword v247, v246, s[4:7], 0 offen sc1
    s_endpgm
.section .rodata,"a"
.p2align 6
.amdhsa_kernel concat_heads__spectral_gfnet__memory_aug_recurrent_mem_tr__prompt_kernel
  .amdhsa_next_free_vgpr 512
  .amdhsa_next_free_sgpr 102
  .amdhsa_accum_offset 256
  .amdhsa_group_segment_fixed_size 0
  .amdhsa_kernarg_size 104
  .amdhsa_user_sgpr_count 2
  .amdhsa_user_sgpr_kernarg_segment_ptr 1
  .amdhsa_system_sgpr_workgroup_id_x 1
  .amdhsa_float_denorm_mode_32 3
.end_amdhsa_kernel
```

```asm
; @launch kernel=concat_heads__spectral_gfnet__memory_aug_recurrent_mem_tr__prompt_kernel grid=(256,1,1) block=(256,1,1) lds=163840
.amdgcn_target "amdgcn-amd-amdhsa--gfx950"
.text
.globl concat_heads__spectral_gfnet__memory_aug_recurrent_mem_tr__prompt_kernel
.p2align 8
.type concat_heads__spectral_gfnet__memory_aug_recurrent_mem_tr__prompt_kernel,@function
concat_heads__spectral_gfnet__memory_aug_recurrent_mem_tr__prompt_kernel:
    s_cmp_ge_u32 s2, 256
    s_cbranch_scc1 W_end
    s_load_dwordx2 s[100:101], s[0:1], 88
    s_mov_b32 s97, s2
    s_mov_b32 s98, 0
    s_getreg_b32 s3, hwreg(HW_REG_XCC_ID, 0, 3)
role_start:
    s_andn2_b32 s2, s97, 7
    s_or_b32 s2, s2, s3
    s_bitcmp1_b32 s3, 2
    s_cbranch_scc0 R_entry
    s_cmp_ge_u32 s2, 256
    s_cbranch_scc1 W_end
    s_load_dwordx2 s[4:5], s[0:1], 96
    v_lshrrev_b32 v5, 6, v0
    v_and_b32 v1, 63, v0
    v_readfirstlane_b32 s16, v5
    s_mov_b32 s6, 268435456
    s_mov_b32 s7, 0x20000
    s_waitcnt lgkmcnt(0)
    s_lshr_b32 s90, s2, 6
    s_bfe_u32 s91, s2, 0x30003
    s_lshl_b32 s91, s91, 2
    s_and_b32 s17, s3, 3
    s_add_u32 s91, s91, s17
    s_lshl_b32 s93, s17, 3
    s_lshr_b32 s17, s91, 2
    s_add_u32 s93, s93, s17
    s_mov_b32 s92, 0
    s_lshl_b32 s17, s93, 2
    s_add_u32 s17, s17, s16
    s_lshl_b32 s18, s90, 7
    s_add_u32 s18, s18, s17
    s_lshl_b32 s18, s18, 7
    s_add_u32 s18, s18, 100663296
    s_lshl_b32 s20, s17, 7
    s_add_u32 s20, s20, 100728832
    s_cmp_eq_u32 s90, 3
    s_cselect_b32 s18, s20, s18
    s_cselect_b64 exec, 7, 1
    v_mov_b32 v5, s18
    s_and_b32 s18, s17, 31
    s_lshl_b32 s18, s18, 2
    s_lshr_b32 s20, s93, 3
    s_add_u32 s18, s18, s20
    s_lshl_b32 s18, s18, 7
    s_add_u32 s18, s18, 100745216
    v_writelane_b32 v5, s18, 1
    s_lshl_b32 s18, s17, 7
    s_add_u32 s18, s18, 100761600
    v_writelane_b32 v5, s18, 2
    v_mov_b32 v6, 0
    buffer_store_dword v6, v5, s[4:7], 0 offen sc1
    s_mov_b64 exec, -1
    s_cmp_eq_u32 s90, 3
    s_cbranch_scc1 W_F
    s_load_dwordx2 s[8:9], s[0:1], 24
    s_mov_b32 s10, 4194304
    s_mov_b32 s11, 0x20000
    s_lshr_b32 s17, s2, 3
    s_lshl_b32 s17, s17, 15
    v_lshlrev_b32 v5, 7, v0
    s_waitcnt lgkmcnt(0)
    buffer_load_dword v254, v5, s[8:11], s17 offen
    s_cmp_lg_u32 s90, 0
    s_cbranch_scc1 W_P
    s_waitcnt vmcnt(0)
    s_barrier
    s_or_b32 s17, s16, s98
    s_cmp_lg_u32 s17, 0
    s_cbranch_scc1 vote_1
    s_lshl_b32 s17, s91, 14
    s_add_u32 s17, s17, 239075328
    v_lshlrev_b32 v5, 2, v1
    v_add_u32 v5, s17, v5
    v_add_u32 v6, 8192, v5
    s_mov_b32 s20, -1
    s_mov_b32 s21, -1
    s_mov_b64 exec, 1
    buffer_store_dword v1, v5, s[4:7], 0 offen sc1
    s_mov_b32 s22, 0
vp_2:
    s_add_u32 s22, s22, 1
    s_getreg_b32 s18, hwreg(HW_REG_IB_STS, 0, 4)
    s_cmp_lt_u32 s22, 2048
    s_cselect_b32 s18, s18, 0
    s_cmp_lg_u32 s18, 0
    s_cbranch_scc1 vp_2
    s_min_u32 s20, s20, s22
    buffer_store_dword v1, v6, s[4:7], 0 offen sc1
    s_mov_b32 s22, 0
vp_3:
    s_add_u32 s22, s22, 1
    s_getreg_b32 s18, hwreg(HW_REG_IB_STS, 0, 4)
    s_cmp_lt_u32 s22, 2048
    s_cselect_b32 s18, s18, 0
    s_cmp_lg_u32 s18, 0
    s_cbranch_scc1 vp_3
    s_min_u32 s21, s21, s22
    buffer_store_dword v1, v5, s[4:7], 0 offen sc1
    s_mov_b32 s22, 0
vp_4:
    s_add_u32 s22, s22, 1
    s_getreg_b32 s18, hwreg(HW_REG_IB_STS, 0, 4)
    s_cmp_lt_u32 s22, 2048
    s_cselect_b32 s18, s18, 0
    s_cmp_lg_u32 s18, 0
    s_cbranch_scc1 vp_4
    s_min_u32 s20, s20, s22
    buffer_store_dword v1, v6, s[4:7], 0 offen sc1
    s_mov_b32 s22, 0
vp_5:
    s_add_u32 s22, s22, 1
    s_getreg_b32 s18, hwreg(HW_REG_IB_STS, 0, 4)
    s_cmp_lt_u32 s22, 2048
    s_cselect_b32 s18, s18, 0
    s_cmp_lg_u32 s18, 0
    s_cbranch_scc1 vp_5
    s_min_u32 s21, s21, s22
    buffer_store_dword v1, v5, s[4:7], 0 offen sc1
    s_mov_b32 s22, 0
vp_6:
    s_add_u32 s22, s22, 1
    s_getreg_b32 s18, hwreg(HW_REG_IB_STS, 0, 4)
    s_cmp_lt_u32 s22, 2048
    s_cselect_b32 s18, s18, 0
    s_cmp_lg_u32 s18, 0
    s_cbranch_scc1 vp_6
    s_min_u32 s20, s20, s22
    buffer_store_dword v1, v6, s[4:7], 0 offen sc1
    s_mov_b32 s22, 0
vp_7:
    s_add_u32 s22, s22, 1
    s_getreg_b32 s18, hwreg(HW_REG_IB_STS, 0, 4)
    s_cmp_lt_u32 s22, 2048
    s_cselect_b32 s18, s18, 0
    s_cmp_lg_u32 s18, 0
    s_cbranch_scc1 vp_7
    s_min_u32 s21, s21, s22
    buffer_store_dword v1, v5, s[4:7], 0 offen sc1
    s_mov_b32 s22, 0
vp_8:
    s_add_u32 s22, s22, 1
    s_getreg_b32 s18, hwreg(HW_REG_IB_STS, 0, 4)
    s_cmp_lt_u32 s22, 2048
    s_cselect_b32 s18, s18, 0
    s_cmp_lg_u32 s18, 0
    s_cbranch_scc1 vp_8
    s_min_u32 s20, s20, s22
    buffer_store_dword v1, v6, s[4:7], 0 offen sc1
    s_mov_b32 s22, 0
vp_9:
    s_add_u32 s22, s22, 1
    s_getreg_b32 s18, hwreg(HW_REG_IB_STS, 0, 4)
    s_cmp_lt_u32 s22, 2048
    s_cselect_b32 s18, s18, 0
    s_cmp_lg_u32 s18, 0
    s_cbranch_scc1 vp_9
    s_min_u32 s21, s21, s22
    s_and_b32 s17, s97, 3
    s_lshl_b32 s17, s17, 3
    s_lshl_b32 s17, 0x40, s17
    s_cmp_lt_u32 s20, s21
    s_cselect_b32 s17, s17, 0
    s_andn2_b32 s18, s97, 3
    v_mov_b32 v5, s18
    v_mov_b32 v6, s17
    global_atomic_add v5, v6, s[100:101] sc1
    s_mov_b64 exec, -1
    s_waitcnt vmcnt(0)
vote_1:
    s_waitcnt vmcnt(0)
    s_barrier
    s_cmp_lg_u32 s16, 0
    s_cbranch_scc1 reg_10
    s_and_b32 s17, s2, 3
    s_lshl_b32 s17, s17, 3
    s_lshl_b32 s18, s98, 2
    s_add_u32 s17, s17, s18
    s_lshl_b32 s17, 1, s17
    s_andn2_b32 s18, s2, 3
    v_mov_b32 v5, s18
    v_mov_b32 v6, s17
    s_mov_b64 exec, 1
    global_atomic_add v5, v6, s[100:101] sc1
    s_mov_b64 exec, -1
reg_10:
W_P:
    s_load_dwordx2 s[12:13], s[0:1], 40
    s_load_dwordx2 s[28:29], s[0:1], 48
    s_load_dwordx2 s[30:31], s[0:1], 56
    s_load_dwordx2 s[8:9], s[0:1], 24
    s_mov_b32 s10, 4194304
    s_mov_b32 s11, 0x20000
    s_mov_b32 s14, 8388608
    s_mov_b32 s15, 0x20000
    s_waitcnt lgkmcnt(0)
    s_cmp_eq_u32 s90, 1
    s_cselect_b64 s[12:13], s[28:29], s[12:13]
    s_cmp_eq_u32 s90, 2
    s_cselect_b64 s[12:13], s[30:31], s[12:13]
    s_lshl_b32 s28, s93, 2
    s_add_u32 s28, s28, s16
    s_lshl_b32 s20, s28, 6
    v_lshrrev_b32 v5, 2, v1
    v_and_b32 v6, 3, v1
    v_lshlrev_b32 v8, 4, v6
    v_lshl_add_u32 v7, v5, 13, v8
    s_mul_i32 s19, s16, 40960
    s_and_b32 s17, s93, 3
    s_lshl_b32 s17, s17, 8
    v_add_lshl_u32 v2, v0, s17, 13
    s_andn2_b32 s17, s93, 3
    s_lshl_b32 s17, s17, 8
    buffer_load_dword v253, v2, s[12:15], s17 offen offset:384
    s_add_u32 m0, s19, 0
    s_nop 0
    buffer_load_dwordx4 v7, s[12:15], s20 offen lds
    s_add_u32 s20, s20, 131072
    s_add_u32 m0, s19, 1024
    s_nop 0
    buffer_load_dwordx4 v7, s[12:15], s20 offen lds
    s_add_u32 s20, s20, 131072
    s_add_u32 m0, s19, 2048
    s_nop 0
    buffer_load_dwordx4 v7, s[12:15], s20 offen lds
    s_add_u32 s20, s20, 131072
    s_add_u32 m0, s19, 3072
    s_nop 0
    buffer_load_dwordx4 v7, s[12:15], s20 offen lds
    s_add_u32 s20, s20, 131072
    v_bfe_u32 v5, v1, 2, 2
    v_lshrrev_b32 v6, 4, v1
    v_lshl_add_u32 v5, v6, 3, v5
    v_lshl_add_u32 v8, v5, 6, v8
    v_add_u32 v8, s19, v8
    s_cmp_eq_u32 s90, 0
    s_cbranch_scc1 nq_13
    s_waitcnt vmcnt(6)
    s_barrier
    s_cmp_lg_u32 s16, 0
    s_cbranch_scc1 reg_14
    s_and_b32 s17, s2, 3
    s_lshl_b32 s17, s17, 3
    s_lshl_b32 s18, s98, 2
    s_add_u32 s17, s17, s18
    s_lshl_b32 s17, 1, s17
    s_andn2_b32 s18, s2, 3
    v_mov_b32 v5, s18
    v_mov_b32 v6, s17
    s_mov_b64 exec, 1
    global_atomic_add v5, v6, s[100:101] sc1
    s_mov_b64 exec, -1
reg_14:
    s_barrier
nq_13:
    s_add_u32 m0, s19, 4096
    s_nop 0
    buffer_load_dwordx4 v7, s[12:15], s20 offen lds
    s_add_u32 s20, s20, 131072
    s_add_u32 m0, s19, 5120
    s_nop 0
    buffer_load_dwordx4 v7, s[12:15], s20 offen lds
    s_add_u32 s20, s20, 131072
    s_add_u32 m0, s19, 6144
    s_nop 0
    buffer_load_dwordx4 v7, s[12:15], s20 offen lds
    s_add_u32 s20, s20, 131072
    s_add_u32 m0, s19, 7168
    s_nop 0
    buffer_load_dwordx4 v7, s[12:15], s20 offen lds
    s_add_u32 s20, s20, 131072
    s_add_u32 m0, s19, 8192
    s_nop 0
    buffer_load_dwordx4 v7, s[12:15], s20 offen lds
    s_add_u32 s20, s20, 131072
    s_add_u32 m0, s19, 9216
    s_nop 0
    buffer_load_dwordx4 v7, s[12:15], s20 offen lds
    s_add_u32 s20, s20, 131072
    s_add_u32 m0, s19, 10240
    s_nop 0
    buffer_load_dwordx4 v7, s[12:15], s20 offen lds
    s_add_u32 s20, s20, 131072
    s_add_u32 m0, s19, 11264
    s_nop 0
    buffer_load_dwordx4 v7, s[12:15], s20 offen lds
    s_add_u32 s20, s20, 131072
    s_add_u32 m0, s19, 12288
    s_nop 0
    buffer_load_dwordx4 v7, s[12:15], s20 offen lds
    s_add_u32 s20, s20, 131072
    s_add_u32 m0, s19, 13312
    s_nop 0
    buffer_load_dwordx4 v7, s[12:15], s20 offen lds
    s_add_u32 s20, s20, 131072
    s_add_u32 m0, s19, 14336
    s_nop 0
    buffer_load_dwordx4 v7, s[12:15], s20 offen lds
    s_add_u32 s20, s20, 131072
    s_add_u32 m0, s19, 15360
    s_nop 0
    buffer_load_dwordx4 v7, s[12:15], s20 offen lds
    s_add_u32 s20, s20, 131072
    s_add_u32 m0, s19, 16384
    s_nop 0
    buffer_load_dwordx4 v7, s[12:15], s20 offen lds
    s_add_u32 s20, s20, 131072
    s_add_u32 m0, s19, 17408
    s_nop 0
    buffer_load_dwordx4 v7, s[12:15], s20 offen lds
    s_add_u32 s20, s20, 131072
    s_add_u32 m0, s19, 18432
    s_nop 0
    buffer_load_dwordx4 v7, s[12:15], s20 offen lds
    s_add_u32 s20, s20, 131072
    s_add_u32 m0, s19, 19456
    s_nop 0
    buffer_load_dwordx4 v7, s[12:15], s20 offen lds
    s_add_u32 s20, s20, 131072
    s_add_u32 m0, s19, 20480
    s_nop 0
    buffer_load_dwordx4 v7, s[12:15], s20 offen lds
    s_add_u32 s20, s20, 131072
    s_add_u32 m0, s19, 21504
    s_nop 0
    buffer_load_dwordx4 v7, s[12:15], s20 offen lds
    s_add_u32 s20, s20, 131072
    s_add_u32 m0, s19, 22528
    s_nop 0
    buffer_load_dwordx4 v7, s[12:15], s20 offen lds
    s_add_u32 s20, s20, 131072
    s_add_u32 m0, s19, 23552
    s_nop 0
    buffer_load_dwordx4 v7, s[12:15], s20 offen lds
    s_add_u32 s20, s20, 131072
    s_add_u32 m0, s19, 24576
    s_nop 0
    buffer_load_dwordx4 v7, s[12:15], s20 offen lds
    s_add_u32 s20, s20, 131072
    s_add_u32 m0, s19, 25600
    s_nop 0
    buffer_load_dwordx4 v7, s[12:15], s20 offen lds
    s_add_u32 s20, s20, 131072
    s_add_u32 m0, s19, 26624
    s_nop 0
    buffer_load_dwordx4 v7, s[12:15], s20 offen lds
    s_add_u32 s20, s20, 131072
    s_add_u32 m0, s19, 27648
    s_nop 0
    buffer_load_dwordx4 v7, s[12:15], s20 offen lds
    s_add_u32 s20, s20, 131072
    s_add_u32 m0, s19, 28672
    s_nop 0
    buffer_load_dwordx4 v7, s[12:15], s20 offen lds
    s_add_u32 s20, s20, 131072
    s_add_u32 m0, s19, 29696
    s_nop 0
    buffer_load_dwordx4 v7, s[12:15], s20 offen lds
    s_add_u32 s20, s20, 131072
    s_add_u32 m0, s19, 30720
    s_nop 0
    buffer_load_dwordx4 v7, s[12:15], s20 offen lds
    s_add_u32 s20, s20, 131072
    s_add_u32 m0, s19, 31744
    s_nop 0
    buffer_load_dwordx4 v7, s[12:15], s20 offen lds
    s_add_u32 s20, s20, 131072
    s_add_u32 m0, s19, 32768
    s_nop 0
    buffer_load_dwordx4 v7, s[12:15], s20 offen lds
    s_add_u32 s20, s20, 131072
    s_add_u32 m0, s19, 33792
    s_nop 0
    buffer_load_dwordx4 v7, s[12:15], s20 offen lds
    s_add_u32 s20, s20, 131072
    s_add_u32 m0, s19, 34816
    s_nop 0
    buffer_load_dwordx4 v7, s[12:15], s20 offen lds
    s_add_u32 s20, s20, 131072
    s_add_u32 m0, s19, 35840
    s_nop 0
    buffer_load_dwordx4 v7, s[12:15], s20 offen lds
    s_add_u32 s20, s20, 131072
    s_add_u32 m0, s19, 36864
    s_nop 0
    buffer_load_dwordx4 v7, s[12:15], s20 offen lds
    s_add_u32 s20, s20, 131072
    s_add_u32 m0, s19, 37888
    s_nop 0
    buffer_load_dwordx4 v7, s[12:15], s20 offen lds
    s_add_u32 s20, s20, 131072
    s_add_u32 m0, s19, 38912
    s_nop 0
    buffer_load_dwordx4 v7, s[12:15], s20 offen lds
    s_add_u32 s20, s20, 131072
    s_add_u32 m0, s19, 39936
    s_nop 0
    buffer_load_dwordx4 v7, s[12:15], s20 offen lds
    s_add_u32 s20, s20, 131072
    s_waitcnt vmcnt(38)
    ds_read_b64_tr_b16 a[0:1], v8 offset:0
    ds_read_b64_tr_b16 a[2:3], v8 offset:256
    ds_read_b64_tr_b16 a[4:5], v8 offset:8
    ds_read_b64_tr_b16 a[6:7], v8 offset:264
    s_waitcnt vmcnt(36)
    ds_read_b64_tr_b16 a[8:9], v8 offset:2048
    ds_read_b64_tr_b16 a[10:11], v8 offset:2304
    ds_read_b64_tr_b16 a[12:13], v8 offset:2056
    ds_read_b64_tr_b16 a[14:15], v8 offset:2312
    s_waitcnt lgkmcnt(4)
    s_add_u32 m0, s19, 0
    s_nop 0
    buffer_load_dwordx4 v7, s[12:15], s20 offen lds
    s_add_u32 s20, s20, 131072
    s_add_u32 m0, s19, 1024
    s_nop 0
    buffer_load_dwordx4 v7, s[12:15], s20 offen lds
    s_add_u32 s20, s20, 131072
    s_waitcnt vmcnt(36)
    ds_read_b64_tr_b16 a[16:17], v8 offset:4096
    ds_read_b64_tr_b16 a[18:19], v8 offset:4352
    ds_read_b64_tr_b16 a[20:21], v8 offset:4104
    ds_read_b64_tr_b16 a[22:23], v8 offset:4360
    s_waitcnt lgkmcnt(4)
    s_add_u32 m0, s19, 2048
    s_nop 0
    buffer_load_dwordx4 v7, s[12:15], s20 offen lds
    s_add_u32 s20, s20, 131072
    s_add_u32 m0, s19, 3072
    s_nop 0
    buffer_load_dwordx4 v7, s[12:15], s20 offen lds
    s_add_u32 s20, s20, 131072
    s_waitcnt vmcnt(36)
    ds_read_b64_tr_b16 a[24:25], v8 offset:6144
    ds_read_b64_tr_b16 a[26:27], v8 offset:6400
    ds_read_b64_tr_b16 a[28:29], v8 offset:6152
    ds_read_b64_tr_b16 a[30:31], v8 offset:6408
    s_waitcnt lgkmcnt(4)
    s_add_u32 m0, s19, 4096
    s_nop 0
    buffer_load_dwordx4 v7, s[12:15], s20 offen lds
    s_add_u32 s20, s20, 131072
    s_add_u32 m0, s19, 5120
    s_nop 0
    buffer_load_dwordx4 v7, s[12:15], s20 offen lds
    s_add_u32 s20, s20, 131072
    s_waitcnt vmcnt(36)
    ds_read_b64_tr_b16 a[32:33], v8 offset:8192
    ds_read_b64_tr_b16 a[34:35], v8 offset:8448
    ds_read_b64_tr_b16 a[36:37], v8 offset:8200
    ds_read_b64_tr_b16 a[38:39], v8 offset:8456
    s_waitcnt lgkmcnt(4)
    s_add_u32 m0, s19, 6144
    s_nop 0
    buffer_load_dwordx4 v7, s[12:15], s20 offen lds
    s_add_u32 s20, s20, 131072
    s_add_u32 m0, s19, 7168
    s_nop 0
    buffer_load_dwordx4 v7, s[12:15], s20 offen lds
    s_add_u32 s20, s20, 131072
    s_waitcnt vmcnt(36)
    ds_read_b64_tr_b16 a[40:41], v8 offset:10240
    ds_read_b64_tr_b16 a[42:43], v8 offset:10496
    ds_read_b64_tr_b16 a[44:45], v8 offset:10248
    ds_read_b64_tr_b16 a[46:47], v8 offset:10504
    s_waitcnt lgkmcnt(4)
    s_add_u32 m0, s19, 8192
    s_nop 0
    buffer_load_dwordx4 v7, s[12:15], s20 offen lds
    s_add_u32 s20, s20, 131072
    s_add_u32 m0, s19, 9216
    s_nop 0
    buffer_load_dwordx4 v7, s[12:15], s20 offen lds
    s_add_u32 s20, s20, 131072
    s_waitcnt vmcnt(36)
    ds_read_b64_tr_b16 a[48:49], v8 offset:12288
    ds_read_b64_tr_b16 a[50:51], v8 offset:12544
    ds_read_b64_tr_b16 a[52:53], v8 offset:12296
    ds_read_b64_tr_b16 a[54:55], v8 offset:12552
    s_waitcnt lgkmcnt(4)
    s_add_u32 m0, s19, 10240
    s_nop 0
    buffer_load_dwordx4 v7, s[12:15], s20 offen lds
    s_add_u32 s20, s20, 131072
    s_add_u32 m0, s19, 11264
    s_nop 0
    buffer_load_dwordx4 v7, s[12:15], s20 offen lds
    s_add_u32 s20, s20, 131072
    s_waitcnt vmcnt(36)
    ds_read_b64_tr_b16 a[56:57], v8 offset:14336
    ds_read_b64_tr_b16 a[58:59], v8 offset:14592
    ds_read_b64_tr_b16 a[60:61], v8 offset:14344
    ds_read_b64_tr_b16 a[62:63], v8 offset:14600
    s_waitcnt lgkmcnt(4)
    s_add_u32 m0, s19, 12288
    s_nop 0
    buffer_load_dwordx4 v7, s[12:15], s20 offen lds
    s_add_u32 s20, s20, 131072
    s_add_u32 m0, s19, 13312
    s_nop 0
    buffer_load_dwordx4 v7, s[12:15], s20 offen lds
    s_add_u32 s20, s20, 131072
    s_waitcnt vmcnt(36)
    ds_read_b64_tr_b16 a[64:65], v8 offset:16384
    ds_read_b64_tr_b16 a[66:67], v8 offset:16640
    ds_read_b64_tr_b16 a[68:69], v8 offset:16392
    ds_read_b64_tr_b16 a[70:71], v8 offset:16648
    s_waitcnt lgkmcnt(4)
    s_add_u32 m0, s19, 14336
    s_nop 0
    buffer_load_dwordx4 v7, s[12:15], s20 offen lds
    s_add_u32 s20, s20, 131072
    s_add_u32 m0, s19, 15360
    s_nop 0
    buffer_load_dwordx4 v7, s[12:15], s20 offen lds
    s_add_u32 s20, s20, 131072
    s_waitcnt vmcnt(36)
    ds_read_b64_tr_b16 a[72:73], v8 offset:18432
    ds_read_b64_tr_b16 a[74:75], v8 offset:18688
    ds_read_b64_tr_b16 a[76:77], v8 offset:18440
    ds_read_b64_tr_b16 a[78:79], v8 offset:18696
    s_waitcnt lgkmcnt(4)
    s_add_u32 m0, s19, 16384
    s_nop 0
    buffer_load_dwordx4 v7, s[12:15], s20 offen lds
    s_add_u32 s20, s20, 131072
    s_add_u32 m0, s19, 17408
    s_nop 0
    buffer_load_dwordx4 v7, s[12:15], s20 offen lds
    s_add_u32 s20, s20, 131072
    s_waitcnt vmcnt(36)
    ds_read_b64_tr_b16 a[80:81], v8 offset:20480
    ds_read_b64_tr_b16 a[82:83], v8 offset:20736
    ds_read_b64_tr_b16 a[84:85], v8 offset:20488
    ds_read_b64_tr_b16 a[86:87], v8 offset:20744
    s_waitcnt lgkmcnt(4)
    s_add_u32 m0, s19, 18432
    s_nop 0
    buffer_load_dwordx4 v7, s[12:15], s20 offen lds
    s_add_u32 s20, s20, 131072
    s_add_u32 m0, s19, 19456
    s_nop 0
    buffer_load_dwordx4 v7, s[12:15], s20 offen lds
    s_add_u32 s20, s20, 131072
    s_waitcnt vmcnt(36)
    ds_read_b64_tr_b16 a[88:89], v8 offset:22528
    ds_read_b64_tr_b16 a[90:91], v8 offset:22784
    ds_read_b64_tr_b16 a[92:93], v8 offset:22536
    ds_read_b64_tr_b16 a[94:95], v8 offset:22792
    s_waitcnt lgkmcnt(4)
    s_add_u32 m0, s19, 20480
    s_nop 0
    buffer_load_dwordx4 v7, s[12:15], s20 offen lds
    s_add_u32 s20, s20, 131072
    s_add_u32 m0, s19, 21504
    s_nop 0
    buffer_load_dwordx4 v7, s[12:15], s20 offen lds
    s_add_u32 s20, s20, 131072
    s_waitcnt vmcnt(36)
    ds_read_b64_tr_b16 a[96:97], v8 offset:24576
    ds_read_b64_tr_b16 a[98:99], v8 offset:24832
    ds_read_b64_tr_b16 a[100:101], v8 offset:24584
    ds_read_b64_tr_b16 a[102:103], v8 offset:24840
    s_waitcnt lgkmcnt(4)
    s_add_u32 m0, s19, 22528
    s_nop 0
    buffer_load_dwordx4 v7, s[12:15], s20 offen lds
    s_add_u32 s20, s20, 131072
    s_add_u32 m0, s19, 23552
    s_nop 0
    buffer_load_dwordx4 v7, s[12:15], s20 offen lds
    s_add_u32 s20, s20, 131072
    s_waitcnt vmcnt(36)
    ds_read_b64_tr_b16 a[104:105], v8 offset:26624
    ds_read_b64_tr_b16 a[106:107], v8 offset:26880
    ds_read_b64_tr_b16 a[108:109], v8 offset:26632
    ds_read_b64_tr_b16 a[110:111], v8 offset:26888
    s_waitcnt lgkmcnt(7)
    s_waitcnt vmcnt(34)
    ds_read_b64_tr_b16 a[112:113], v8 offset:28672
    ds_read_b64_tr_b16 a[114:115], v8 offset:28928
    ds_read_b64_tr_b16 a[116:117], v8 offset:28680
    ds_read_b64_tr_b16 a[118:119], v8 offset:28936
    s_waitcnt vmcnt(32)
    ds_read_b64_tr_b16 a[120:121], v8 offset:30720
    ds_read_b64_tr_b16 a[122:123], v8 offset:30976
    ds_read_b64_tr_b16 a[124:125], v8 offset:30728
    ds_read_b64_tr_b16 a[126:127], v8 offset:30984
    s_waitcnt lgkmcnt(7)
    s_waitcnt vmcnt(30)
    ds_read_b64_tr_b16 a[128:129], v8 offset:32768
    ds_read_b64_tr_b16 a[130:131], v8 offset:33024
    ds_read_b64_tr_b16 a[132:133], v8 offset:32776
    ds_read_b64_tr_b16 a[134:135], v8 offset:33032
    s_waitcnt vmcnt(28)
    ds_read_b64_tr_b16 a[136:137], v8 offset:34816
    ds_read_b64_tr_b16 a[138:139], v8 offset:35072
    ds_read_b64_tr_b16 a[140:141], v8 offset:34824
    ds_read_b64_tr_b16 a[142:143], v8 offset:35080
    s_waitcnt lgkmcnt(7)
    s_waitcnt vmcnt(26)
    ds_read_b64_tr_b16 a[144:145], v8 offset:36864
    ds_read_b64_tr_b16 a[146:147], v8 offset:37120
    ds_read_b64_tr_b16 a[148:149], v8 offset:36872
    ds_read_b64_tr_b16 a[150:151], v8 offset:37128
    s_waitcnt vmcnt(24)
    ds_read_b64_tr_b16 a[152:153], v8 offset:38912
    ds_read_b64_tr_b16 a[154:155], v8 offset:39168
    ds_read_b64_tr_b16 a[156:157], v8 offset:38920
    ds_read_b64_tr_b16 a[158:159], v8 offset:39176
    s_waitcnt lgkmcnt(7)
    s_waitcnt vmcnt(22)
    ds_read_b64_tr_b16 a[160:161], v8 offset:0
    ds_read_b64_tr_b16 a[162:163], v8 offset:256
    ds_read_b64_tr_b16 a[164:165], v8 offset:8
    ds_read_b64_tr_b16 a[166:167], v8 offset:264
    s_waitcnt vmcnt(20)
    ds_read_b64_tr_b16 a[168:169], v8 offset:2048
    ds_read_b64_tr_b16 a[170:171], v8 offset:2304
    ds_read_b64_tr_b16 a[172:173], v8 offset:2056
    ds_read_b64_tr_b16 a[174:175], v8 offset:2312
    s_waitcnt lgkmcnt(7)
    s_waitcnt vmcnt(18)
    ds_read_b64_tr_b16 a[176:177], v8 offset:4096
    ds_read_b64_tr_b16 a[178:179], v8 offset:4352
    ds_read_b64_tr_b16 a[180:181], v8 offset:4104
    ds_read_b64_tr_b16 a[182:183], v8 offset:4360
    s_waitcnt vmcnt(16)
    ds_read_b64_tr_b16 a[184:185], v8 offset:6144
    ds_read_b64_tr_b16 a[186:187], v8 offset:6400
    ds_read_b64_tr_b16 a[188:189], v8 offset:6152
    ds_read_b64_tr_b16 a[190:191], v8 offset:6408
    s_waitcnt lgkmcnt(7)
    s_waitcnt vmcnt(14)
    ds_read_b64_tr_b16 a[192:193], v8 offset:8192
    ds_read_b64_tr_b16 a[194:195], v8 offset:8448
    ds_read_b64_tr_b16 a[196:197], v8 offset:8200
    ds_read_b64_tr_b16 a[198:199], v8 offset:8456
    s_waitcnt vmcnt(12)
    ds_read_b64_tr_b16 a[200:201], v8 offset:10240
    ds_read_b64_tr_b16 a[202:203], v8 offset:10496
    ds_read_b64_tr_b16 a[204:205], v8 offset:10248
    ds_read_b64_tr_b16 a[206:207], v8 offset:10504
    s_waitcnt lgkmcnt(7)
    s_waitcnt vmcnt(10)
    ds_read_b64_tr_b16 a[208:209], v8 offset:12288
    ds_read_b64_tr_b16 a[210:211], v8 offset:12544
    ds_read_b64_tr_b16 a[212:213], v8 offset:12296
    ds_read_b64_tr_b16 a[214:215], v8 offset:12552
    s_waitcnt vmcnt(8)
    ds_read_b64_tr_b16 a[216:217], v8 offset:14336
    ds_read_b64_tr_b16 a[218:219], v8 offset:14592
    ds_read_b64_tr_b16 a[220:221], v8 offset:14344
    ds_read_b64_tr_b16 a[222:223], v8 offset:14600
    s_waitcnt lgkmcnt(7)
    s_waitcnt vmcnt(6)
    ds_read_b64_tr_b16 a[224:225], v8 offset:16384
    ds_read_b64_tr_b16 a[226:227], v8 offset:16640
    ds_read_b64_tr_b16 a[228:229], v8 offset:16392
    ds_read_b64_tr_b16 a[230:231], v8 offset:16648
    s_waitcnt vmcnt(4)
    ds_read_b64_tr_b16 a[232:233], v8 offset:18432
    ds_read_b64_tr_b16 a[234:235], v8 offset:18688
    ds_read_b64_tr_b16 a[236:237], v8 offset:18440
    ds_read_b64_tr_b16 a[238:239], v8 offset:18696
    s_waitcnt lgkmcnt(7)
    s_waitcnt vmcnt(2)
    ds_read_b64_tr_b16 a[240:241], v8 offset:20480
    ds_read_b64_tr_b16 a[242:243], v8 offset:20736
    ds_read_b64_tr_b16 a[244:245], v8 offset:20488
    ds_read_b64_tr_b16 a[246:247], v8 offset:20744
    s_waitcnt vmcnt(0)
    ds_read_b64_tr_b16 a[248:249], v8 offset:22528
    ds_read_b64_tr_b16 a[250:251], v8 offset:22784
    ds_read_b64_tr_b16 a[252:253], v8 offset:22536
    ds_read_b64_tr_b16 a[254:255], v8 offset:22792
    s_waitcnt lgkmcnt(7)
    s_waitcnt lgkmcnt(0)
weven_12:
    v_and_b32 v5, 15, v1
    v_bfe_u32 v6, v1, 1, 3
    v_lshrrev_b32 v7, 4, v1
    v_xor_b32 v6, v6, v7
    v_lshlrev_b32 v6, 4, v6
    v_lshl_add_u32 v10, v5, 7, v6
    s_lshl_b32 s19, s16, 10
    v_xor_b32 v11, 64, v10
    v_add_u32 v12, 0x10000, v10
    v_add_u32 v13, 0x10000, v11
    v_lshrrev_b32 v7, 3, v1
    s_lshl_b32 s17, s16, 3
    v_add_u32 v7, s17, v7
    v_bfe_u32 v8, v7, 1, 3
    v_xor_b32 v8, v8, v1
    v_and_b32 v8, 7, v8
    v_bfe_u32 v5, v7, 2, 2
    v_and_b32 v2, 3, v7
    v_lshl_add_u32 v2, v5, 3, v2
    v_bfe_u32 v5, v7, 4, 1
    v_lshl_add_u32 v2, v5, 2, v2
    v_bfe_u32 v5, v1, 2, 2
    v_and_b32 v3, 3, v1
    v_lshl_add_u32 v3, v5, 3, v3
    v_lshlrev_b32 v2, 11, v2
    v_lshl_add_u32 v2, v8, 4, v2
    v_and_b32 v5, 16, v1
    v_lshl_add_u32 v3, v3, 5, v5
    v_and_b32 v5, 32, v1
    v_lshl_add_u32 v3, v5, 5, v3
    s_mul_i32 s21, s28, 133120
    s_mul_i32 s18, s90, 17825792
    s_add_u32 s21, s21, s18
    s_lshl_b32 s18, s90, 7
    s_add_u32 s17, s28, s18
    s_lshl_b32 s17, s17, 7
    s_add_u32 s17, s17, 100663296
    v_mov_b32 v4, s17
    v_mov_b32 v5, 1073741824
    v_cmp_eq_u32 vcc, 0, v1
    s_nop 1
    v_cndmask_b32 v4, v5, v4, vcc
    v_lshlrev_b32 v252, 7, v1
    s_cmp_eq_u32 s90, 0
    s_cselect_b32 s20, 0, 32
    v_cmp_gt_u32 vcc, s20, v1
    s_nop 1
    v_cndmask_b32 v252, v5, v252, vcc
    s_mov_b32 s20, 0
    s_mov_b32 s24, 65536
    s_mov_b32 s25, 2048
    s_barrier
    s_cmp_eq_u32 s90, 2
    s_cbranch_scc1 P_v
    s_mov_b32 s26, s25
    s_sub_u32 s25, s21, 1073741824
    s_mov_b32 s21, 1073741824
    s_mov_b32 s23, 0
    s_mov_b32 s22, 0
    s_add_u32 m0, s19, 0
    s_nop 0
    buffer_load_dwordx4 v2, s[8:11], s20 offen offset:0 lds
    s_add_u32 m0, s19, 3968
    s_nop 0
    buffer_load_dwordx4 v2, s[8:11], s20 offen offset:128 lds
    s_add_u32 m0, s19, 7936
    s_nop 0
    buffer_load_dwordx4 v2, s[8:11], s20 offen offset:256 lds
    s_add_u32 m0, s19, 11904
    s_nop 0
    buffer_load_dwordx4 v2, s[8:11], s20 offen offset:384 lds
    s_add_u32 m0, s19, 15872
    s_nop 0
    buffer_load_dwordx4 v2, s[8:11], s20 offen offset:512 lds
    s_add_u32 m0, s19, 19840
    s_nop 0
    buffer_load_dwordx4 v2, s[8:11], s20 offen offset:640 lds
    s_add_u32 m0, s19, 23808
    s_nop 0
    buffer_load_dwordx4 v2, s[8:11], s20 offen offset:768 lds
    s_add_u32 m0, s19, 27776
    s_nop 0
    buffer_load_dwordx4 v2, s[8:11], s20 offen offset:896 lds
    s_add_u32 m0, s19, 31744
    s_nop 0
    buffer_load_dwordx4 v2, s[8:11], s20 offen offset:1024 lds
    s_add_u32 m0, s19, 35712
    s_nop 0
    buffer_load_dwordx4 v2, s[8:11], s20 offen offset:1152 lds
    s_add_u32 m0, s19, 39680
    s_nop 0
    buffer_load_dwordx4 v2, s[8:11], s20 offen offset:1280 lds
    s_add_u32 m0, s19, 43648
    s_nop 0
    buffer_load_dwordx4 v2, s[8:11], s20 offen offset:1408 lds
    s_add_u32 m0, s19, 47616
    s_nop 0
    buffer_load_dwordx4 v2, s[8:11], s20 offen offset:1536 lds
    s_add_u32 m0, s19, 51584
    s_nop 0
    buffer_load_dwordx4 v2, s[8:11], s20 offen offset:1664 lds
    s_add_u32 m0, s19, 55552
    s_nop 0
    buffer_load_dwordx4 v2, s[8:11], s20 offen offset:1792 lds
    s_add_u32 m0, s19, 59520
    s_nop 0
    buffer_load_dwordx4 v2, s[8:11], s20 offen offset:1920 lds
    s_add_u32 s20, s20, s24
    s_add_u32 m0, s19, 65536
    s_nop 0
    buffer_load_dwordx4 v2, s[8:11], s20 offen offset:0 lds
    s_add_u32 m0, s19, 69504
    s_nop 0
    buffer_load_dwordx4 v2, s[8:11], s20 offen offset:128 lds
    s_add_u32 m0, s19, 73472
    s_nop 0
    buffer_load_dwordx4 v2, s[8:11], s20 offen offset:256 lds
    v_mov_b32 v9, s23
    s_add_u32 s23, s23, 1
    buffer_store_dword v9, v4, s[4:7], 0 offen sc1
    s_mov_b32 s23, 0
    s_waitcnt vmcnt(12)
    s_barrier
    ds_read_b128 v[20:23], v10 offset:0
    ds_read_b128 v[24:27], v10 offset:2048
    ds_read_b128 v[28:31], v11 offset:0
    ds_read_b128 v[32:35], v11 offset:2048
    ds_read_b128 v[36:39], v10 offset:4096
    ds_read_b128 v[40:43], v10 offset:6144
    ds_read_b128 v[44:47], v11 offset:4096
.p2align 6
P_qk_top:
    s_waitcnt lgkmcnt(6)
    v_mfma_f32_16x16x32_bf16 v[52:55], a[0:3], v[20:23], 0
    ds_read_b128 v[48:51], v11 offset:6144
    v_mfma_f32_16x16x32_bf16 v[56:59], a[4:7], v[20:23], 0
    s_waitcnt lgkmcnt(6)
    v_mfma_f32_16x16x32_bf16 v[60:63], a[0:3], v[24:27], 0
    ds_read_b128 v[20:23], v10 offset:8192
    s_add_u32 m0, s19, 77440
    v_mfma_f32_16x16x32_bf16 v[64:67], a[4:7], v[24:27], 0
    buffer_load_dwordx4 v2, s[8:11], s20 offen offset:384 lds
    s_waitcnt lgkmcnt(6)
    v_mfma_f32_16x16x32_bf16 v[52:55], a[8:11], v[28:31], v[52:55]
    ds_read_b128 v[24:27], v10 offset:10240
    v_mfma_f32_16x16x32_bf16 v[56:59], a[12:15], v[28:31], v[56:59]
    s_waitcnt lgkmcnt(6)
    v_mfma_f32_16x16x32_bf16 v[60:63], a[8:11], v[32:35], v[60:63]
    ds_read_b128 v[28:31], v11 offset:8192
    s_add_u32 m0, s19, 81408
    v_mfma_f32_16x16x32_bf16 v[64:67], a[12:15], v[32:35], v[64:67]
    buffer_load_dwordx4 v2, s[8:11], s20 offen offset:512 lds
    s_waitcnt lgkmcnt(6)
    v_mfma_f32_16x16x32_bf16 v[52:55], a[16:19], v[36:39], v[52:55]
    ds_read_b128 v[32:35], v11 offset:10240
    v_mfma_f32_16x16x32_bf16 v[56:59], a[20:23], v[36:39], v[56:59]
    s_waitcnt lgkmcnt(6)
    v_mfma_f32_16x16x32_bf16 v[60:63], a[16:19], v[40:43], v[60:63]
    ds_read_b128 v[36:39], v10 offset:12288
    s_add_u32 m0, s19, 85376
    v_mfma_f32_16x16x32_bf16 v[64:67], a[20:23], v[40:43], v[64:67]
    buffer_load_dwordx4 v2, s[8:11], s20 offen offset:640 lds
    s_waitcnt lgkmcnt(6)
    v_mfma_f32_16x16x32_bf16 v[52:55], a[24:27], v[44:47], v[52:55]
    ds_read_b128 v[40:43], v10 offset:14336
    v_mfma_f32_16x16x32_bf16 v[56:59], a[28:31], v[44:47], v[56:59]
    s_waitcnt lgkmcnt(6)
    v_mfma_f32_16x16x32_bf16 v[60:63], a[24:27], v[48:51], v[60:63]
    ds_read_b128 v[44:47], v11 offset:12288
    s_add_u32 m0, s19, 89344
    v_mfma_f32_16x16x32_bf16 v[64:67], a[28:31], v[48:51], v[64:67]
    buffer_load_dwordx4 v2, s[8:11], s20 offen offset:768 lds
    s_waitcnt lgkmcnt(6)
    v_mfma_f32_16x16x32_bf16 v[52:55], a[32:35], v[20:23], v[52:55]
    ds_read_b128 v[48:51], v11 offset:14336
    v_mfma_f32_16x16x32_bf16 v[56:59], a[36:39], v[20:23], v[56:59]
    s_waitcnt lgkmcnt(6)
    v_mfma_f32_16x16x32_bf16 v[60:63], a[32:35], v[24:27], v[60:63]
    ds_read_b128 v[20:23], v10 offset:16384
    s_add_u32 m0, s19, 93312
    v_mfma_f32_16x16x32_bf16 v[64:67], a[36:39], v[24:27], v[64:67]
    buffer_load_dwordx4 v2, s[8:11], s20 offen offset:896 lds
    s_waitcnt lgkmcnt(6)
    v_mfma_f32_16x16x32_bf16 v[52:55], a[40:43], v[28:31], v[52:55]
    ds_read_b128 v[24:27], v10 offset:18432
    v_mfma_f32_16x16x32_bf16 v[56:59], a[44:47], v[28:31], v[56:59]
    v_cvt_pk_bf16_f32 v84, v68, v69
    s_waitcnt lgkmcnt(6)
    v_mfma_f32_16x16x32_bf16 v[60:63], a[40:43], v[32:35], v[60:63]
    ds_read_b128 v[28:31], v11 offset:16384
    v_mfma_f32_16x16x32_bf16 v[64:67], a[44:47], v[32:35], v[64:67]
    v_cvt_pk_bf16_f32 v85, v70, v71
    s_waitcnt lgkmcnt(6)
    v_mfma_f32_16x16x32_bf16 v[52:55], a[48:51], v[36:39], v[52:55]
    ds_read_b128 v[32:35], v11 offset:18432
    v_mfma_f32_16x16x32_bf16 v[56:59], a[52:55], v[36:39], v[56:59]
    v_cvt_pk_bf16_f32 v86, v72, v73
    s_waitcnt lgkmcnt(6)
    v_mfma_f32_16x16x32_bf16 v[60:63], a[48:51], v[40:43], v[60:63]
    ds_read_b128 v[36:39], v10 offset:20480
    v_mfma_f32_16x16x32_bf16 v[64:67], a[52:55], v[40:43], v[64:67]
    v_cvt_pk_bf16_f32 v87, v74, v75
    s_waitcnt lgkmcnt(6)
    v_mfma_f32_16x16x32_bf16 v[52:55], a[56:59], v[44:47], v[52:55]
    ds_read_b128 v[40:43], v10 offset:22528
    v_mfma_f32_16x16x32_bf16 v[56:59], a[60:63], v[44:47], v[56:59]
    v_cvt_pk_bf16_f32 v88, v76, v77
    s_waitcnt lgkmcnt(6)
    v_mfma_f32_16x16x32_bf16 v[60:63], a[56:59], v[48:51], v[60:63]
    ds_read_b128 v[44:47], v11 offset:20480
    v_mfma_f32_16x16x32_bf16 v[64:67], a[60:63], v[48:51], v[64:67]
    v_cvt_pk_bf16_f32 v89, v78, v79
    buffer_store_dwordx4 v[84:87], v3, s[4:7], s21 offen offset:0 sc1
    s_waitcnt lgkmcnt(6)
    v_mfma_f32_16x16x32_bf16 v[52:55], a[64:67], v[20:23], v[52:55]
    ds_read_b128 v[48:51], v11 offset:22528
    v_mfma_f32_16x16x32_bf16 v[56:59], a[68:71], v[20:23], v[56:59]
    v_cvt_pk_bf16_f32 v90, v80, v81
    s_waitcnt lgkmcnt(6)
    v_mfma_f32_16x16x32_bf16 v[60:63], a[64:67], v[24:27], v[60:63]
    ds_read_b128 v[20:23], v10 offset:24576
    v_mfma_f32_16x16x32_bf16 v[64:67], a[68:71], v[24:27], v[64:67]
    v_cvt_pk_bf16_f32 v91, v82, v83
    s_waitcnt lgkmcnt(6)
    v_mfma_f32_16x16x32_bf16 v[52:55], a[72:75], v[28:31], v[52:55]
    ds_read_b128 v[24:27], v10 offset:26624
    v_mfma_f32_16x16x32_bf16 v[56:59], a[76:79], v[28:31], v[56:59]
    s_waitcnt lgkmcnt(6)
    v_mfma_f32_16x16x32_bf16 v[60:63], a[72:75], v[32:35], v[60:63]
    ds_read_b128 v[28:31], v11 offset:24576
    v_mfma_f32_16x16x32_bf16 v[64:67], a[76:79], v[32:35], v[64:67]
    buffer_store_dwordx4 v[88:91], v3, s[4:7], s21 offen offset:128 sc1
    s_waitcnt lgkmcnt(6)
    v_mfma_f32_16x16x32_bf16 v[52:55], a[80:83], v[36:39], v[52:55]
    ds_read_b128 v[32:35], v11 offset:26624
    v_mfma_f32_16x16x32_bf16 v[56:59], a[84:87], v[36:39], v[56:59]
    s_add_u32 s21, s21, s25
    s_mov_b32 s25, s26
    s_waitcnt lgkmcnt(6)
    v_mfma_f32_16x16x32_bf16 v[60:63], a[80:83], v[40:43], v[60:63]
    ds_read_b128 v[36:39], v10 offset:28672
    v_mfma_f32_16x16x32_bf16 v[64:67], a[84:87], v[40:43], v[64:67]
    s_waitcnt lgkmcnt(6)
    v_mfma_f32_16x16x32_bf16 v[52:55], a[88:91], v[44:47], v[52:55]
    ds_read_b128 v[40:43], v10 offset:30720
    v_mfma_f32_16x16x32_bf16 v[56:59], a[92:95], v[44:47], v[56:59]
    s_waitcnt lgkmcnt(6)
    v_mfma_f32_16x16x32_bf16 v[60:63], a[88:91], v[48:51], v[60:63]
    ds_read_b128 v[44:47], v11 offset:28672
    v_mfma_f32_16x16x32_bf16 v[64:67], a[92:95], v[48:51], v[64:67]
    s_waitcnt lgkmcnt(6)
    v_mfma_f32_16x16x32_bf16 v[52:55], a[96:99], v[20:23], v[52:55]
    ds_read_b128 v[48:51], v11 offset:30720
    v_mfma_f32_16x16x32_bf16 v[56:59], a[100:103], v[20:23], v[56:59]
    s_waitcnt lgkmcnt(6)
    v_mfma_f32_16x16x32_bf16 v[60:63], a[96:99], v[24:27], v[60:63]
    s_waitcnt vmcnt(11)
    s_barrier
    ds_read_b128 v[20:23], v10 offset:32768
    v_mfma_f32_16x16x32_bf16 v[64:67], a[100:103], v[24:27], v[64:67]
    s_waitcnt lgkmcnt(6)
    v_mfma_f32_16x16x32_bf16 v[52:55], a[104:107], v[28:31], v[52:55]
    ds_read_b128 v[24:27], v10 offset:34816
    s_add_u32 m0, s19, 97280
    v_mfma_f32_16x16x32_bf16 v[56:59], a[108:111], v[28:31], v[56:59]
    buffer_load_dwordx4 v2, s[8:11], s20 offen offset:1024 lds
    s_waitcnt lgkmcnt(6)
    v_mfma_f32_16x16x32_bf16 v[60:63], a[104:107], v[32:35], v[60:63]
    ds_read_b128 v[28:31], v11 offset:32768
    v_mfma_f32_16x16x32_bf16 v[64:67], a[108:111], v[32:35], v[64:67]
    s_waitcnt lgkmcnt(6)
    v_mfma_f32_16x16x32_bf16 v[52:55], a[112:115], v[36:39], v[52:55]
    ds_read_b128 v[32:35], v11 offset:34816
    s_add_u32 m0, s19, 101248
    v_mfma_f32_16x16x32_bf16 v[56:59], a[116:119], v[36:39], v[56:59]
    buffer_load_dwordx4 v2, s[8:11], s20 offen offset:1152 lds
    s_waitcnt lgkmcnt(6)
    v_mfma_f32_16x16x32_bf16 v[60:63], a[112:115], v[40:43], v[60:63]
    ds_read_b128 v[36:39], v10 offset:36864
    v_mfma_f32_16x16x32_bf16 v[64:67], a[116:119], v[40:43], v[64:67]
    s_waitcnt lgkmcnt(6)
    v_mfma_f32_16x16x32_bf16 v[52:55], a[120:123], v[44:47], v[52:55]
    ds_read_b128 v[40:43], v10 offset:38912
    s_add_u32 m0, s19, 105216
    v_mfma_f32_16x16x32_bf16 v[56:59], a[124:127], v[44:47], v[56:59]
    buffer_load_dwordx4 v2, s[8:11], s20 offen offset:1280 lds
    s_waitcnt lgkmcnt(6)
    v_mfma_f32_16x16x32_bf16 v[60:63], a[120:123], v[48:51], v[60:63]
    ds_read_b128 v[44:47], v11 offset:36864
    v_mfma_f32_16x16x32_bf16 v[64:67], a[124:127], v[48:51], v[64:67]
    s_waitcnt lgkmcnt(6)
    v_mfma_f32_16x16x32_bf16 v[52:55], a[128:131], v[20:23], v[52:55]
    ds_read_b128 v[48:51], v11 offset:38912
    v_mfma_f32_16x16x32_bf16 v[56:59], a[132:135], v[20:23], v[56:59]
    s_waitcnt lgkmcnt(6)
    v_mfma_f32_16x16x32_bf16 v[60:63], a[128:131], v[24:27], v[60:63]
    ds_read_b128 v[20:23], v10 offset:40960
    s_add_u32 m0, s19, 109184
    v_mfma_f32_16x16x32_bf16 v[64:67], a[132:135], v[24:27], v[64:67]
    buffer_load_dwordx4 v2, s[8:11], s20 offen offset:1408 lds
    s_waitcnt lgkmcnt(6)
    v_mfma_f32_16x16x32_bf16 v[52:55], a[136:139], v[28:31], v[52:55]
    ds_read_b128 v[24:27], v10 offset:43008
    v_mfma_f32_16x16x32_bf16 v[56:59], a[140:143], v[28:31], v[56:59]
    s_waitcnt lgkmcnt(6)
    v_mfma_f32_16x16x32_bf16 v[60:63], a[136:139], v[32:35], v[60:63]
    ds_read_b128 v[28:31], v11 offset:40960
    s_add_u32 m0, s19, 113152
    v_mfma_f32_16x16x32_bf16 v[64:67], a[140:143], v[32:35], v[64:67]
    buffer_load_dwordx4 v2, s[8:11], s20 offen offset:1536 lds
    s_waitcnt lgkmcnt(6)
    v_mfma_f32_16x16x32_bf16 v[52:55], a[144:147], v[36:39], v[52:55]
    ds_read_b128 v[32:35], v11 offset:43008
    v_mfma_f32_16x16x32_bf16 v[56:59], a[148:151], v[36:39], v[56:59]
    s_waitcnt lgkmcnt(6)
    v_mfma_f32_16x16x32_bf16 v[60:63], a[144:147], v[40:43], v[60:63]
    ds_read_b128 v[36:39], v10 offset:45056
    s_add_u32 m0, s19, 117120
    v_mfma_f32_16x16x32_bf16 v[64:67], a[148:151], v[40:43], v[64:67]
    buffer_load_dwordx4 v2, s[8:11], s20 offen offset:1664 lds
    s_waitcnt lgkmcnt(6)
    v_mfma_f32_16x16x32_bf16 v[52:55], a[152:155], v[44:47], v[52:55]
    ds_read_b128 v[40:43], v10 offset:47104
    v_mfma_f32_16x16x32_bf16 v[56:59], a[156:159], v[44:47], v[56:59]
    s_waitcnt lgkmcnt(6)
    v_mfma_f32_16x16x32_bf16 v[60:63], a[152:155], v[48:51], v[60:63]
    ds_read_b128 v[44:47], v11 offset:45056
    s_add_u32 m0, s19, 121088
    v_mfma_f32_16x16x32_bf16 v[64:67], a[156:159], v[48:51], v[64:67]
    buffer_load_dwordx4 v2, s[8:11], s20 offen offset:1792 lds
    s_waitcnt lgkmcnt(6)
    v_mfma_f32_16x16x32_bf16 v[52:55], a[160:163], v[20:23], v[52:55]
    ds_read_b128 v[48:51], v11 offset:47104
    v_mfma_f32_16x16x32_bf16 v[56:59], a[164:167], v[20:23], v[56:59]
    s_waitcnt lgkmcnt(6)
    v_mfma_f32_16x16x32_bf16 v[60:63], a[160:163], v[24:27], v[60:63]
    ds_read_b128 v[20:23], v10 offset:49152
    s_add_u32 m0, s19, 125056
    v_mfma_f32_16x16x32_bf16 v[64:67], a[164:167], v[24:27], v[64:67]
    buffer_load_dwordx4 v2, s[8:11], s20 offen offset:1920 lds
    s_waitcnt lgkmcnt(6)
    v_mfma_f32_16x16x32_bf16 v[52:55], a[168:171], v[28:31], v[52:55]
    ds_read_b128 v[24:27], v10 offset:51200
    v_mfma_f32_16x16x32_bf16 v[56:59], a[172:175], v[28:31], v[56:59]
    s_add_u32 s20, s20, s24
    s_waitcnt lgkmcnt(6)
    v_mfma_f32_16x16x32_bf16 v[60:63], a[168:171], v[32:35], v[60:63]
    ds_read_b128 v[28:31], v11 offset:49152
    v_mfma_f32_16x16x32_bf16 v[64:67], a[172:175], v[32:35], v[64:67]
    s_waitcnt lgkmcnt(6)
    v_mfma_f32_16x16x32_bf16 v[52:55], a[176:179], v[36:39], v[52:55]
    ds_read_b128 v[32:35], v11 offset:51200
    v_mfma_f32_16x16x32_bf16 v[56:59], a[180:183], v[36:39], v[56:59]
    s_waitcnt lgkmcnt(6)
    v_mfma_f32_16x16x32_bf16 v[60:63], a[176:179], v[40:43], v[60:63]
    ds_read_b128 v[36:39], v10 offset:53248
    v_mfma_f32_16x16x32_bf16 v[64:67], a[180:183], v[40:43], v[64:67]
    s_waitcnt lgkmcnt(6)
    v_mfma_f32_16x16x32_bf16 v[52:55], a[184:187], v[44:47], v[52:55]
    ds_read_b128 v[40:43], v10 offset:55296
    v_mfma_f32_16x16x32_bf16 v[56:59], a[188:191], v[44:47], v[56:59]
    s_waitcnt lgkmcnt(6)
    v_mfma_f32_16x16x32_bf16 v[60:63], a[184:187], v[48:51], v[60:63]
    ds_read_b128 v[44:47], v11 offset:53248
    v_mfma_f32_16x16x32_bf16 v[64:67], a[188:191], v[48:51], v[64:67]
    s_waitcnt lgkmcnt(6)
    v_mfma_f32_16x16x32_bf16 v[52:55], a[192:195], v[20:23], v[52:55]
    ds_read_b128 v[48:51], v11 offset:55296
    v_mfma_f32_16x16x32_bf16 v[56:59], a[196:199], v[20:23], v[56:59]
    s_waitcnt lgkmcnt(6)
    v_mfma_f32_16x16x32_bf16 v[60:63], a[192:195], v[24:27], v[60:63]
    ds_read_b128 v[20:23], v10 offset:57344
    v_mfma_f32_16x16x32_bf16 v[64:67], a[196:199], v[24:27], v[64:67]
    s_waitcnt lgkmcnt(6)
    v_mfma_f32_16x16x32_bf16 v[52:55], a[200:203], v[28:31], v[52:55]
    ds_read_b128 v[24:27], v10 offset:59392
    v_mfma_f32_16x16x32_bf16 v[56:59], a[204:207], v[28:31], v[56:59]
    s_waitcnt lgkmcnt(6)
    v_mfma_f32_16x16x32_bf16 v[60:63], a[200:203], v[32:35], v[60:63]
    ds_read_b128 v[28:31], v11 offset:57344
    v_mfma_f32_16x16x32_bf16 v[64:67], a[204:207], v[32:35], v[64:67]
    s_waitcnt lgkmcnt(6)
    v_mfma_f32_16x16x32_bf16 v[52:55], a[208:211], v[36:39], v[52:55]
    ds_read_b128 v[32:35], v11 offset:59392
    v_mfma_f32_16x16x32_bf16 v[56:59], a[212:215], v[36:39], v[56:59]
    s_waitcnt lgkmcnt(6)
    v_mfma_f32_16x16x32_bf16 v[60:63], a[208:211], v[40:43], v[60:63]
    ds_read_b128 v[36:39], v10 offset:61440
    v_mfma_f32_16x16x32_bf16 v[64:67], a[212:215], v[40:43], v[64:67]
    s_waitcnt lgkmcnt(6)
    v_mfma_f32_16x16x32_bf16 v[52:55], a[216:219], v[44:47], v[52:55]
    ds_read_b128 v[40:43], v10 offset:63488
    v_mfma_f32_16x16x32_bf16 v[56:59], a[220:223], v[44:47], v[56:59]
    s_waitcnt lgkmcnt(6)
    v_mfma_f32_16x16x32_bf16 v[60:63], a[216:219], v[48:51], v[60:63]
    ds_read_b128 v[44:47], v11 offset:61440
    v_mfma_f32_16x16x32_bf16 v[64:67], a[220:223], v[48:51], v[64:67]
    s_waitcnt lgkmcnt(6)
    v_mfma_f32_16x16x32_bf16 v[52:55], a[224:227], v[20:23], v[52:55]
    ds_read_b128 v[48:51], v11 offset:63488
    v_mfma_f32_16x16x32_bf16 v[56:59], a[228:231], v[20:23], v[56:59]
    s_waitcnt lgkmcnt(6)
    v_mfma_f32_16x16x32_bf16 v[60:63], a[224:227], v[24:27], v[60:63]
    s_waitcnt vmcnt(8)
    s_barrier
    ds_read_b128 v[20:23], v12 offset:0
    v_mfma_f32_16x16x32_bf16 v[64:67], a[228:231], v[24:27], v[64:67]
    s_waitcnt lgkmcnt(6)
    v_mfma_f32_16x16x32_bf16 v[52:55], a[232:235], v[28:31], v[52:55]
    ds_read_b128 v[24:27], v12 offset:2048
    s_add_u32 m0, s19, 0
    v_mfma_f32_16x16x32_bf16 v[56:59], a[236:239], v[28:31], v[56:59]
    buffer_load_dwordx4 v2, s[8:11], s20 offen offset:0 lds
    s_waitcnt lgkmcnt(6)
    v_mfma_f32_16x16x32_bf16 v[60:63], a[232:235], v[32:35], v[60:63]
    ds_read_b128 v[28:31], v13 offset:0
    v_mfma_f32_16x16x32_bf16 v[64:67], a[236:239], v[32:35], v[64:67]
    v_mov_b32 v9, s23
    s_add_u32 s23, s23, 1
    buffer_store_dword v9, v4, s[4:7], 0 offen sc1
    s_waitcnt lgkmcnt(6)
    v_mfma_f32_16x16x32_bf16 v[52:55], a[240:243], v[36:39], v[52:55]
    ds_read_b128 v[32:35], v13 offset:2048
    s_add_u32 m0, s19, 3968
    v_mfma_f32_16x16x32_bf16 v[56:59], a[244:247], v[36:39], v[56:59]
    buffer_load_dwordx4 v2, s[8:11], s20 offen offset:128 lds
    s_waitcnt lgkmcnt(6)
    v_mfma_f32_16x16x32_bf16 v[60:63], a[240:243], v[40:43], v[60:63]
    ds_read_b128 v[36:39], v12 offset:4096
    v_mfma_f32_16x16x32_bf16 v[64:67], a[244:247], v[40:43], v[64:67]
    s_waitcnt lgkmcnt(6)
    v_mfma_f32_16x16x32_bf16 v[52:55], a[248:251], v[44:47], v[52:55]
    ds_read_b128 v[40:43], v12 offset:6144
    s_add_u32 m0, s19, 7936
    v_mfma_f32_16x16x32_bf16 v[56:59], a[252:255], v[44:47], v[56:59]
    buffer_load_dwordx4 v2, s[8:11], s20 offen offset:256 lds
    s_waitcnt lgkmcnt(6)
    v_mfma_f32_16x16x32_bf16 v[60:63], a[248:251], v[48:51], v[60:63]
    ds_read_b128 v[44:47], v13 offset:4096
    v_mfma_f32_16x16x32_bf16 v[64:67], a[252:255], v[48:51], v[64:67]
    s_waitcnt lgkmcnt(6)
    v_mfma_f32_16x16x32_bf16 v[68:71], a[0:3], v[20:23], 0
    ds_read_b128 v[48:51], v13 offset:6144
    v_mfma_f32_16x16x32_bf16 v[72:75], a[4:7], v[20:23], 0
    s_waitcnt lgkmcnt(6)
    v_mfma_f32_16x16x32_bf16 v[76:79], a[0:3], v[24:27], 0
    ds_read_b128 v[20:23], v12 offset:8192
    s_add_u32 m0, s19, 11904
    v_mfma_f32_16x16x32_bf16 v[80:83], a[4:7], v[24:27], 0
    buffer_load_dwordx4 v2, s[8:11], s20 offen offset:384 lds
    s_waitcnt lgkmcnt(6)
    v_mfma_f32_16x16x32_bf16 v[68:71], a[8:11], v[28:31], v[68:71]
    ds_read_b128 v[24:27], v12 offset:10240
    v_mfma_f32_16x16x32_bf16 v[72:75], a[12:15], v[28:31], v[72:75]
    s_waitcnt lgkmcnt(6)
    v_mfma_f32_16x16x32_bf16 v[76:79], a[8:11], v[32:35], v[76:79]
    ds_read_b128 v[28:31], v13 offset:8192
    s_add_u32 m0, s19, 15872
    v_mfma_f32_16x16x32_bf16 v[80:83], a[12:15], v[32:35], v[80:83]
    buffer_load_dwordx4 v2, s[8:11], s20 offen offset:512 lds
    s_waitcnt lgkmcnt(6)
    v_mfma_f32_16x16x32_bf16 v[68:71], a[16:19], v[36:39], v[68:71]
    ds_read_b128 v[32:35], v13 offset:10240
    v_mfma_f32_16x16x32_bf16 v[72:75], a[20:23], v[36:39], v[72:75]
    s_waitcnt lgkmcnt(6)
    v_mfma_f32_16x16x32_bf16 v[76:79], a[16:19], v[40:43], v[76:79]
    ds_read_b128 v[36:39], v12 offset:12288
    s_add_u32 m0, s19, 19840
    v_mfma_f32_16x16x32_bf16 v[80:83], a[20:23], v[40:43], v[80:83]
    buffer_load_dwordx4 v2, s[8:11], s20 offen offset:640 lds
    s_waitcnt lgkmcnt(6)
    v_mfma_f32_16x16x32_bf16 v[68:71], a[24:27], v[44:47], v[68:71]
    ds_read_b128 v[40:43], v12 offset:14336
    v_mfma_f32_16x16x32_bf16 v[72:75], a[28:31], v[44:47], v[72:75]
    s_waitcnt lgkmcnt(6)
    v_mfma_f32_16x16x32_bf16 v[76:79], a[24:27], v[48:51], v[76:79]
    ds_read_b128 v[44:47], v13 offset:12288
    s_add_u32 m0, s19, 23808
    v_mfma_f32_16x16x32_bf16 v[80:83], a[28:31], v[48:51], v[80:83]
    buffer_load_dwordx4 v2, s[8:11], s20 offen offset:768 lds
    s_waitcnt lgkmcnt(6)
    v_mfma_f32_16x16x32_bf16 v[68:71], a[32:35], v[20:23], v[68:71]
    ds_read_b128 v[48:51], v13 offset:14336
    v_mfma_f32_16x16x32_bf16 v[72:75], a[36:39], v[20:23], v[72:75]
    s_waitcnt lgkmcnt(6)
    v_mfma_f32_16x16x32_bf16 v[76:79], a[32:35], v[24:27], v[76:79]
    ds_read_b128 v[20:23], v12 offset:16384
    s_add_u32 m0, s19, 27776
    v_mfma_f32_16x16x32_bf16 v[80:83], a[36:39], v[24:27], v[80:83]
    buffer_load_dwordx4 v2, s[8:11], s20 offen offset:896 lds
    s_waitcnt lgkmcnt(6)
    v_mfma_f32_16x16x32_bf16 v[68:71], a[40:43], v[28:31], v[68:71]
    ds_read_b128 v[24:27], v12 offset:18432
    v_mfma_f32_16x16x32_bf16 v[72:75], a[44:47], v[28:31], v[72:75]
    v_cvt_pk_bf16_f32 v84, v52, v53
    s_waitcnt lgkmcnt(6)
    v_mfma_f32_16x16x32_bf16 v[76:79], a[40:43], v[32:35], v[76:79]
    ds_read_b128 v[28:31], v13 offset:16384
    v_mfma_f32_16x16x32_bf16 v[80:83], a[44:47], v[32:35], v[80:83]
    v_cvt_pk_bf16_f32 v85, v54, v55
    s_waitcnt lgkmcnt(6)
    v_mfma_f32_16x16x32_bf16 v[68:71], a[48:51], v[36:39], v[68:71]
    ds_read_b128 v[32:35], v13 offset:18432
    v_mfma_f32_16x16x32_bf16 v[72:75], a[52:55], v[36:39], v[72:75]
    v_cvt_pk_bf16_f32 v86, v56, v57
    s_waitcnt lgkmcnt(6)
    v_mfma_f32_16x16x32_bf16 v[76:79], a[48:51], v[40:43], v[76:79]
    ds_read_b128 v[36:39], v12 offset:20480
    v_mfma_f32_16x16x32_bf16 v[80:83], a[52:55], v[40:43], v[80:83]
    v_cvt_pk_bf16_f32 v87, v58, v59
    s_waitcnt lgkmcnt(6)
    v_mfma_f32_16x16x32_bf16 v[68:71], a[56:59], v[44:47], v[68:71]
    ds_read_b128 v[40:43], v12 offset:22528
    v_mfma_f32_16x16x32_bf16 v[72:75], a[60:63], v[44:47], v[72:75]
    v_cvt_pk_bf16_f32 v88, v60, v61
    s_waitcnt lgkmcnt(6)
    v_mfma_f32_16x16x32_bf16 v[76:79], a[56:59], v[48:51], v[76:79]
    ds_read_b128 v[44:47], v13 offset:20480
    v_mfma_f32_16x16x32_bf16 v[80:83], a[60:63], v[48:51], v[80:83]
    v_cvt_pk_bf16_f32 v89, v62, v63
    buffer_store_dwordx4 v[84:87], v3, s[4:7], s21 offen offset:0 sc1
    s_waitcnt lgkmcnt(6)
    v_mfma_f32_16x16x32_bf16 v[68:71], a[64:67], v[20:23], v[68:71]
    ds_read_b128 v[48:51], v13 offset:22528
    v_mfma_f32_16x16x32_bf16 v[72:75], a[68:71], v[20:23], v[72:75]
    v_cvt_pk_bf16_f32 v90, v64, v65
    s_waitcnt lgkmcnt(6)
    v_mfma_f32_16x16x32_bf16 v[76:79], a[64:67], v[24:27], v[76:79]
    ds_read_b128 v[20:23], v12 offset:24576
    v_mfma_f32_16x16x32_bf16 v[80:83], a[68:71], v[24:27], v[80:83]
    v_cvt_pk_bf16_f32 v91, v66, v67
    s_waitcnt lgkmcnt(6)
    v_mfma_f32_16x16x32_bf16 v[68:71], a[72:75], v[28:31], v[68:71]
    ds_read_b128 v[24:27], v12 offset:26624
    v_mfma_f32_16x16x32_bf16 v[72:75], a[76:79], v[28:31], v[72:75]
    s_waitcnt lgkmcnt(6)
    v_mfma_f32_16x16x32_bf16 v[76:79], a[72:75], v[32:35], v[76:79]
    ds_read_b128 v[28:31], v13 offset:24576
    v_mfma_f32_16x16x32_bf16 v[80:83], a[76:79], v[32:35], v[80:83]
    buffer_store_dwordx4 v[88:91], v3, s[4:7], s21 offen offset:128 sc1
    s_waitcnt lgkmcnt(6)
    v_mfma_f32_16x16x32_bf16 v[68:71], a[80:83], v[36:39], v[68:71]
    ds_read_b128 v[32:35], v13 offset:26624
    v_mfma_f32_16x16x32_bf16 v[72:75], a[84:87], v[36:39], v[72:75]
    s_add_u32 s21, s21, s25
    s_mov_b32 s25, s26
    s_waitcnt lgkmcnt(6)
    v_mfma_f32_16x16x32_bf16 v[76:79], a[80:83], v[40:43], v[76:79]
    ds_read_b128 v[36:39], v12 offset:28672
    v_mfma_f32_16x16x32_bf16 v[80:83], a[84:87], v[40:43], v[80:83]
    s_waitcnt lgkmcnt(6)
    v_mfma_f32_16x16x32_bf16 v[68:71], a[88:91], v[44:47], v[68:71]
    ds_read_b128 v[40:43], v12 offset:30720
    v_mfma_f32_16x16x32_bf16 v[72:75], a[92:95], v[44:47], v[72:75]
    s_waitcnt lgkmcnt(6)
    v_mfma_f32_16x16x32_bf16 v[76:79], a[88:91], v[48:51], v[76:79]
    ds_read_b128 v[44:47], v13 offset:28672
    v_mfma_f32_16x16x32_bf16 v[80:83], a[92:95], v[48:51], v[80:83]
    s_waitcnt lgkmcnt(6)
    v_mfma_f32_16x16x32_bf16 v[68:71], a[96:99], v[20:23], v[68:71]
    ds_read_b128 v[48:51], v13 offset:30720
    v_mfma_f32_16x16x32_bf16 v[72:75], a[100:103], v[20:23], v[72:75]
    s_waitcnt lgkmcnt(6)
    v_mfma_f32_16x16x32_bf16 v[76:79], a[96:99], v[24:27], v[76:79]
    s_waitcnt vmcnt(11)
    s_barrier
    ds_read_b128 v[20:23], v12 offset:32768
    v_mfma_f32_16x16x32_bf16 v[80:83], a[100:103], v[24:27], v[80:83]
    s_waitcnt lgkmcnt(6)
    v_mfma_f32_16x16x32_bf16 v[68:71], a[104:107], v[28:31], v[68:71]
    ds_read_b128 v[24:27], v12 offset:34816
    s_add_u32 m0, s19, 31744
    v_mfma_f32_16x16x32_bf16 v[72:75], a[108:111], v[28:31], v[72:75]
    buffer_load_dwordx4 v2, s[8:11], s20 offen offset:1024 lds
    s_waitcnt lgkmcnt(6)
    v_mfma_f32_16x16x32_bf16 v[76:79], a[104:107], v[32:35], v[76:79]
    ds_read_b128 v[28:31], v13 offset:32768
    v_mfma_f32_16x16x32_bf16 v[80:83], a[108:111], v[32:35], v[80:83]
    s_waitcnt lgkmcnt(6)
    v_mfma_f32_16x16x32_bf16 v[68:71], a[112:115], v[36:39], v[68:71]
    ds_read_b128 v[32:35], v13 offset:34816
    s_add_u32 m0, s19, 35712
    v_mfma_f32_16x16x32_bf16 v[72:75], a[116:119], v[36:39], v[72:75]
    buffer_load_dwordx4 v2, s[8:11], s20 offen offset:1152 lds
    s_waitcnt lgkmcnt(6)
    v_mfma_f32_16x16x32_bf16 v[76:79], a[112:115], v[40:43], v[76:79]
    ds_read_b128 v[36:39], v12 offset:36864
    v_mfma_f32_16x16x32_bf16 v[80:83], a[116:119], v[40:43], v[80:83]
    s_waitcnt lgkmcnt(6)
    v_mfma_f32_16x16x32_bf16 v[68:71], a[120:123], v[44:47], v[68:71]
    ds_read_b128 v[40:43], v12 offset:38912
    s_add_u32 m0, s19, 39680
    v_mfma_f32_16x16x32_bf16 v[72:75], a[124:127], v[44:47], v[72:75]
    buffer_load_dwordx4 v2, s[8:11], s20 offen offset:1280 lds
    s_waitcnt lgkmcnt(6)
    v_mfma_f32_16x16x32_bf16 v[76:79], a[120:123], v[48:51], v[76:79]
    ds_read_b128 v[44:47], v13 offset:36864
    v_mfma_f32_16x16x32_bf16 v[80:83], a[124:127], v[48:51], v[80:83]
    s_waitcnt lgkmcnt(6)
    v_mfma_f32_16x16x32_bf16 v[68:71], a[128:131], v[20:23], v[68:71]
    ds_read_b128 v[48:51], v13 offset:38912
    v_mfma_f32_16x16x32_bf16 v[72:75], a[132:135], v[20:23], v[72:75]
    s_waitcnt lgkmcnt(6)
    v_mfma_f32_16x16x32_bf16 v[76:79], a[128:131], v[24:27], v[76:79]
    ds_read_b128 v[20:23], v12 offset:40960
    s_add_u32 m0, s19, 43648
    v_mfma_f32_16x16x32_bf16 v[80:83], a[132:135], v[24:27], v[80:83]
    buffer_load_dwordx4 v2, s[8:11], s20 offen offset:1408 lds
    s_waitcnt lgkmcnt(6)
    v_mfma_f32_16x16x32_bf16 v[68:71], a[136:139], v[28:31], v[68:71]
    ds_read_b128 v[24:27], v12 offset:43008
    v_mfma_f32_16x16x32_bf16 v[72:75], a[140:143], v[28:31], v[72:75]
    s_waitcnt lgkmcnt(6)
    v_mfma_f32_16x16x32_bf16 v[76:79], a[136:139], v[32:35], v[76:79]
    ds_read_b128 v[28:31], v13 offset:40960
    s_add_u32 m0, s19, 47616
    v_mfma_f32_16x16x32_bf16 v[80:83], a[140:143], v[32:35], v[80:83]
    buffer_load_dwordx4 v2, s[8:11], s20 offen offset:1536 lds
    s_waitcnt lgkmcnt(6)
    v_mfma_f32_16x16x32_bf16 v[68:71], a[144:147], v[36:39], v[68:71]
    ds_read_b128 v[32:35], v13 offset:43008
    v_mfma_f32_16x16x32_bf16 v[72:75], a[148:151], v[36:39], v[72:75]
    s_waitcnt lgkmcnt(6)
    v_mfma_f32_16x16x32_bf16 v[76:79], a[144:147], v[40:43], v[76:79]
    ds_read_b128 v[36:39], v12 offset:45056
    s_add_u32 m0, s19, 51584
    v_mfma_f32_16x16x32_bf16 v[80:83], a[148:151], v[40:43], v[80:83]
    buffer_load_dwordx4 v2, s[8:11], s20 offen offset:1664 lds
    s_waitcnt lgkmcnt(6)
    v_mfma_f32_16x16x32_bf16 v[68:71], a[152:155], v[44:47], v[68:71]
    ds_read_b128 v[40:43], v12 offset:47104
    v_mfma_f32_16x16x32_bf16 v[72:75], a[156:159], v[44:47], v[72:75]
    s_waitcnt lgkmcnt(6)
    v_mfma_f32_16x16x32_bf16 v[76:79], a[152:155], v[48:51], v[76:79]
    ds_read_b128 v[44:47], v13 offset:45056
    s_add_u32 m0, s19, 55552
    v_mfma_f32_16x16x32_bf16 v[80:83], a[156:159], v[48:51], v[80:83]
    buffer_load_dwordx4 v2, s[8:11], s20 offen offset:1792 lds
    s_waitcnt lgkmcnt(6)
    v_mfma_f32_16x16x32_bf16 v[68:71], a[160:163], v[20:23], v[68:71]
    ds_read_b128 v[48:51], v13 offset:47104
    v_mfma_f32_16x16x32_bf16 v[72:75], a[164:167], v[20:23], v[72:75]
    s_waitcnt lgkmcnt(6)
    v_mfma_f32_16x16x32_bf16 v[76:79], a[160:163], v[24:27], v[76:79]
    ds_read_b128 v[20:23], v12 offset:49152
    s_add_u32 m0, s19, 59520
    v_mfma_f32_16x16x32_bf16 v[80:83], a[164:167], v[24:27], v[80:83]
    buffer_load_dwordx4 v2, s[8:11], s20 offen offset:1920 lds
    s_waitcnt lgkmcnt(6)
    v_mfma_f32_16x16x32_bf16 v[68:71], a[168:171], v[28:31], v[68:71]
    ds_read_b128 v[24:27], v12 offset:51200
    v_mfma_f32_16x16x32_bf16 v[72:75], a[172:175], v[28:31], v[72:75]
    s_add_u32 s20, s20, s24
    s_waitcnt lgkmcnt(6)
    v_mfma_f32_16x16x32_bf16 v[76:79], a[168:171], v[32:35], v[76:79]
    ds_read_b128 v[28:31], v13 offset:49152
    v_mfma_f32_16x16x32_bf16 v[80:83], a[172:175], v[32:35], v[80:83]
    s_waitcnt lgkmcnt(6)
    v_mfma_f32_16x16x32_bf16 v[68:71], a[176:179], v[36:39], v[68:71]
    ds_read_b128 v[32:35], v13 offset:51200
    v_mfma_f32_16x16x32_bf16 v[72:75], a[180:183], v[36:39], v[72:75]
    s_waitcnt lgkmcnt(6)
    v_mfma_f32_16x16x32_bf16 v[76:79], a[176:179], v[40:43], v[76:79]
    ds_read_b128 v[36:39], v12 offset:53248
    v_mfma_f32_16x16x32_bf16 v[80:83], a[180:183], v[40:43], v[80:83]
    s_waitcnt lgkmcnt(6)
    v_mfma_f32_16x16x32_bf16 v[68:71], a[184:187], v[44:47], v[68:71]
    ds_read_b128 v[40:43], v12 offset:55296
    v_mfma_f32_16x16x32_bf16 v[72:75], a[188:191], v[44:47], v[72:75]
    s_waitcnt lgkmcnt(6)
    v_mfma_f32_16x16x32_bf16 v[76:79], a[184:187], v[48:51], v[76:79]
    ds_read_b128 v[44:47], v13 offset:53248
    v_mfma_f32_16x16x32_bf16 v[80:83], a[188:191], v[48:51], v[80:83]
    s_waitcnt lgkmcnt(6)
    v_mfma_f32_16x16x32_bf16 v[68:71], a[192:195], v[20:23], v[68:71]
    ds_read_b128 v[48:51], v13 offset:55296
    v_mfma_f32_16x16x32_bf16 v[72:75], a[196:199], v[20:23], v[72:75]
    s_waitcnt lgkmcnt(6)
    v_mfma_f32_16x16x32_bf16 v[76:79], a[192:195], v[24:27], v[76:79]
    ds_read_b128 v[20:23], v12 offset:57344
    v_mfma_f32_16x16x32_bf16 v[80:83], a[196:199], v[24:27], v[80:83]
    s_waitcnt lgkmcnt(6)
    v_mfma_f32_16x16x32_bf16 v[68:71], a[200:203], v[28:31], v[68:71]
    ds_read_b128 v[24:27], v12 offset:59392
    v_mfma_f32_16x16x32_bf16 v[72:75], a[204:207], v[28:31], v[72:75]
    s_waitcnt lgkmcnt(6)
    v_mfma_f32_16x16x32_bf16 v[76:79], a[200:203], v[32:35], v[76:79]
    ds_read_b128 v[28:31], v13 offset:57344
    v_mfma_f32_16x16x32_bf16 v[80:83], a[204:207], v[32:35], v[80:83]
    s_waitcnt lgkmcnt(6)
    v_mfma_f32_16x16x32_bf16 v[68:71], a[208:211], v[36:39], v[68:71]
    ds_read_b128 v[32:35], v13 offset:59392
    v_mfma_f32_16x16x32_bf16 v[72:75], a[212:215], v[36:39], v[72:75]
    s_waitcnt lgkmcnt(6)
    v_mfma_f32_16x16x32_bf16 v[76:79], a[208:211], v[40:43], v[76:79]
    ds_read_b128 v[36:39], v12 offset:61440
    v_mfma_f32_16x16x32_bf16 v[80:83], a[212:215], v[40:43], v[80:83]
    s_waitcnt lgkmcnt(6)
    v_mfma_f32_16x16x32_bf16 v[68:71], a[216:219], v[44:47], v[68:71]
    ds_read_b128 v[40:43], v12 offset:63488
    v_mfma_f32_16x16x32_bf16 v[72:75], a[220:223], v[44:47], v[72:75]
    s_waitcnt lgkmcnt(6)
    v_mfma_f32_16x16x32_bf16 v[76:79], a[216:219], v[48:51], v[76:79]
    ds_read_b128 v[44:47], v13 offset:61440
    v_mfma_f32_16x16x32_bf16 v[80:83], a[220:223], v[48:51], v[80:83]
    s_waitcnt lgkmcnt(6)
    v_mfma_f32_16x16x32_bf16 v[68:71], a[224:227], v[20:23], v[68:71]
    ds_read_b128 v[48:51], v13 offset:63488
    v_mfma_f32_16x16x32_bf16 v[72:75], a[228:231], v[20:23], v[72:75]
    s_waitcnt lgkmcnt(6)
    v_mfma_f32_16x16x32_bf16 v[76:79], a[224:227], v[24:27], v[76:79]
    s_waitcnt vmcnt(8)
    s_barrier
    ds_read_b128 v[20:23], v10 offset:0
    v_mfma_f32_16x16x32_bf16 v[80:83], a[228:231], v[24:27], v[80:83]
    s_waitcnt lgkmcnt(6)
    v_mfma_f32_16x16x32_bf16 v[68:71], a[232:235], v[28:31], v[68:71]
    ds_read_b128 v[24:27], v10 offset:2048
    s_add_u32 m0, s19, 65536
    v_mfma_f32_16x16x32_bf16 v[72:75], a[236:239], v[28:31], v[72:75]
    buffer_load_dwordx4 v2, s[8:11], s20 offen offset:0 lds
    s_waitcnt lgkmcnt(6)
    v_mfma_f32_16x16x32_bf16 v[76:79], a[232:235], v[32:35], v[76:79]
    ds_read_b128 v[28:31], v11 offset:0
    v_mfma_f32_16x16x32_bf16 v[80:83], a[236:239], v[32:35], v[80:83]
    v_mov_b32 v9, s23
    s_add_u32 s23, s23, 1
    buffer_store_dword v9, v4, s[4:7], 0 offen sc1
    s_waitcnt lgkmcnt(6)
    v_mfma_f32_16x16x32_bf16 v[68:71], a[240:243], v[36:39], v[68:71]
    ds_read_b128 v[32:35], v11 offset:2048
    s_add_u32 m0, s19, 69504
    v_mfma_f32_16x16x32_bf16 v[72:75], a[244:247], v[36:39], v[72:75]
    buffer_load_dwordx4 v2, s[8:11], s20 offen offset:128 lds
    s_waitcnt lgkmcnt(6)
    v_mfma_f32_16x16x32_bf16 v[76:79], a[240:243], v[40:43], v[76:79]
    ds_read_b128 v[36:39], v10 offset:4096
    v_mfma_f32_16x16x32_bf16 v[80:83], a[244:247], v[40:43], v[80:83]
    s_waitcnt lgkmcnt(6)
    v_mfma_f32_16x16x32_bf16 v[68:71], a[248:251], v[44:47], v[68:71]
    ds_read_b128 v[40:43], v10 offset:6144
    s_add_u32 m0, s19, 73472
    v_mfma_f32_16x16x32_bf16 v[72:75], a[252:255], v[44:47], v[72:75]
    buffer_load_dwordx4 v2, s[8:11], s20 offen offset:256 lds
    s_waitcnt lgkmcnt(6)
    v_mfma_f32_16x16x32_bf16 v[76:79], a[248:251], v[48:51], v[76:79]
    ds_read_b128 v[44:47], v11 offset:4096
    v_mfma_f32_16x16x32_bf16 v[80:83], a[252:255], v[48:51], v[80:83]
    s_add_u32 s22, s22, 2
    s_cmp_lt_u32 s22, 64
    s_cbranch_scc1 P_qk_top
    v_cvt_pk_bf16_f32 v84, v68, v69
    v_cvt_pk_bf16_f32 v85, v70, v71
    v_cvt_pk_bf16_f32 v86, v72, v73
    v_cvt_pk_bf16_f32 v87, v74, v75
    v_cvt_pk_bf16_f32 v88, v76, v77
    v_cvt_pk_bf16_f32 v89, v78, v79
    v_cvt_pk_bf16_f32 v90, v80, v81
    v_cvt_pk_bf16_f32 v91, v82, v83
    buffer_store_dwordx4 v[84:87], v3, s[4:7], s21 offen offset:0 sc1
    buffer_store_dwordx4 v[88:91], v3, s[4:7], s21 offen offset:128 sc1
    s_waitcnt vmcnt(0) lgkmcnt(0)
    v_mov_b32 v9, s23
    s_add_u32 s23, s23, 1
    buffer_store_dword v9, v4, s[4:7], 0 offen sc1
    s_branch W_U
P_v:
    s_mov_b32 s26, s25
    s_sub_u32 s25, s21, 1073741824
    s_mov_b32 s21, 1073741824
    s_mov_b32 s23, 0
    s_mov_b32 s22, 0
    s_add_u32 m0, s19, 0
    s_nop 0
    buffer_load_dwordx4 v2, s[8:11], s20 offen offset:0 lds
    s_add_u32 m0, s19, 3968
    s_nop 0
    buffer_load_dwordx4 v2, s[8:11], s20 offen offset:128 lds
    s_add_u32 m0, s19, 7936
    s_nop 0
    buffer_load_dwordx4 v2, s[8:11], s20 offen offset:256 lds
    s_add_u32 m0, s19, 11904
    s_nop 0
    buffer_load_dwordx4 v2, s[8:11], s20 offen offset:384 lds
    s_add_u32 m0, s19, 15872
    s_nop 0
    buffer_load_dwordx4 v2, s[8:11], s20 offen offset:512 lds
    s_add_u32 m0, s19, 19840
    s_nop 0
    buffer_load_dwordx4 v2, s[8:11], s20 offen offset:640 lds
    s_add_u32 m0, s19, 23808
    s_nop 0
    buffer_load_dwordx4 v2, s[8:11], s20 offen offset:768 lds
    s_add_u32 m0, s19, 27776
    s_nop 0
    buffer_load_dwordx4 v2, s[8:11], s20 offen offset:896 lds
    s_add_u32 m0, s19, 31744
    s_nop 0
    buffer_load_dwordx4 v2, s[8:11], s20 offen offset:1024 lds
    s_add_u32 m0, s19, 35712
    s_nop 0
    buffer_load_dwordx4 v2, s[8:11], s20 offen offset:1152 lds
    s_add_u32 m0, s19, 39680
    s_nop 0
    buffer_load_dwordx4 v2, s[8:11], s20 offen offset:1280 lds
    s_add_u32 m0, s19, 43648
    s_nop 0
    buffer_load_dwordx4 v2, s[8:11], s20 offen offset:1408 lds
    s_add_u32 m0, s19, 47616
    s_nop 0
    buffer_load_dwordx4 v2, s[8:11], s20 offen offset:1536 lds
    s_add_u32 m0, s19, 51584
    s_nop 0
    buffer_load_dwordx4 v2, s[8:11], s20 offen offset:1664 lds
    s_add_u32 m0, s19, 55552
    s_nop 0
    buffer_load_dwordx4 v2, s[8:11], s20 offen offset:1792 lds
    s_add_u32 m0, s19, 59520
    s_nop 0
    buffer_load_dwordx4 v2, s[8:11], s20 offen offset:1920 lds
    s_add_u32 s20, s20, s24
    s_add_u32 m0, s19, 65536
    s_nop 0
    buffer_load_dwordx4 v2, s[8:11], s20 offen offset:0 lds
    s_add_u32 m0, s19, 69504
    s_nop 0
    buffer_load_dwordx4 v2, s[8:11], s20 offen offset:128 lds
    s_add_u32 m0, s19, 73472
    s_nop 0
    buffer_load_dwordx4 v2, s[8:11], s20 offen offset:256 lds
    v_mov_b32 v9, s23
    s_add_u32 s23, s23, 1
    buffer_store_dword v9, v4, s[4:7], 0 offen sc1
    s_mov_b32 s23, 0
    s_waitcnt vmcnt(12)
    s_barrier
    ds_read_b128 v[20:23], v10 offset:0
    ds_read_b128 v[24:27], v10 offset:2048
    ds_read_b128 v[28:31], v11 offset:0
    ds_read_b128 v[32:35], v11 offset:2048
    ds_read_b128 v[36:39], v10 offset:4096
    ds_read_b128 v[40:43], v10 offset:6144
    ds_read_b128 v[44:47], v11 offset:4096
.p2align 6
P_v_top:
    s_waitcnt lgkmcnt(6)
    v_mfma_f32_16x16x32_bf16 v[52:55], v[20:23], a[0:3], 0
    ds_read_b128 v[48:51], v11 offset:6144
    v_mfma_f32_16x16x32_bf16 v[60:63], v[20:23], a[4:7], 0
    s_waitcnt lgkmcnt(6)
    v_mfma_f32_16x16x32_bf16 v[56:59], v[24:27], a[0:3], 0
    ds_read_b128 v[20:23], v10 offset:8192
    s_add_u32 m0, s19, 77440
    v_mfma_f32_16x16x32_bf16 v[64:67], v[24:27], a[4:7], 0
    buffer_load_dwordx4 v2, s[8:11], s20 offen offset:384 lds
    s_waitcnt lgkmcnt(6)
    v_mfma_f32_16x16x32_bf16 v[52:55], v[28:31], a[8:11], v[52:55]
    ds_read_b128 v[24:27], v10 offset:10240
    v_mfma_f32_16x16x32_bf16 v[60:63], v[28:31], a[12:15], v[60:63]
    s_waitcnt lgkmcnt(6)
    v_mfma_f32_16x16x32_bf16 v[56:59], v[32:35], a[8:11], v[56:59]
    ds_read_b128 v[28:31], v11 offset:8192
    s_add_u32 m0, s19, 81408
    v_mfma_f32_16x16x32_bf16 v[64:67], v[32:35], a[12:15], v[64:67]
    buffer_load_dwordx4 v2, s[8:11], s20 offen offset:512 lds
    s_waitcnt lgkmcnt(6)
    v_mfma_f32_16x16x32_bf16 v[52:55], v[36:39], a[16:19], v[52:55]
    ds_read_b128 v[32:35], v11 offset:10240
    v_mfma_f32_16x16x32_bf16 v[60:63], v[36:39], a[20:23], v[60:63]
    s_waitcnt lgkmcnt(6)
    v_mfma_f32_16x16x32_bf16 v[56:59], v[40:43], a[16:19], v[56:59]
    ds_read_b128 v[36:39], v10 offset:12288
    s_add_u32 m0, s19, 85376
    v_mfma_f32_16x16x32_bf16 v[64:67], v[40:43], a[20:23], v[64:67]
    buffer_load_dwordx4 v2, s[8:11], s20 offen offset:640 lds
    s_waitcnt lgkmcnt(6)
    v_mfma_f32_16x16x32_bf16 v[52:55], v[44:47], a[24:27], v[52:55]
    ds_read_b128 v[40:43], v10 offset:14336
    v_mfma_f32_16x16x32_bf16 v[60:63], v[44:47], a[28:31], v[60:63]
    s_waitcnt lgkmcnt(6)
    v_mfma_f32_16x16x32_bf16 v[56:59], v[48:51], a[24:27], v[56:59]
    ds_read_b128 v[44:47], v11 offset:12288
    s_add_u32 m0, s19, 89344
    v_mfma_f32_16x16x32_bf16 v[64:67], v[48:51], a[28:31], v[64:67]
    buffer_load_dwordx4 v2, s[8:11], s20 offen offset:768 lds
    s_waitcnt lgkmcnt(6)
    v_mfma_f32_16x16x32_bf16 v[52:55], v[20:23], a[32:35], v[52:55]
    ds_read_b128 v[48:51], v11 offset:14336
    v_mfma_f32_16x16x32_bf16 v[60:63], v[20:23], a[36:39], v[60:63]
    s_waitcnt lgkmcnt(6)
    v_mfma_f32_16x16x32_bf16 v[56:59], v[24:27], a[32:35], v[56:59]
    ds_read_b128 v[20:23], v10 offset:16384
    s_add_u32 m0, s19, 93312
    v_mfma_f32_16x16x32_bf16 v[64:67], v[24:27], a[36:39], v[64:67]
    buffer_load_dwordx4 v2, s[8:11], s20 offen offset:896 lds
    s_waitcnt lgkmcnt(6)
    v_mfma_f32_16x16x32_bf16 v[52:55], v[28:31], a[40:43], v[52:55]
    ds_read_b128 v[24:27], v10 offset:18432
    v_mfma_f32_16x16x32_bf16 v[60:63], v[28:31], a[44:47], v[60:63]
    v_cvt_pk_bf16_f32 v84, v68, v69
    s_waitcnt lgkmcnt(6)
    v_mfma_f32_16x16x32_bf16 v[56:59], v[32:35], a[40:43], v[56:59]
    ds_read_b128 v[28:31], v11 offset:16384
    v_mfma_f32_16x16x32_bf16 v[64:67], v[32:35], a[44:47], v[64:67]
    v_cvt_pk_bf16_f32 v85, v70, v71
    s_waitcnt lgkmcnt(6)
    v_mfma_f32_16x16x32_bf16 v[52:55], v[36:39], a[48:51], v[52:55]
    ds_read_b128 v[32:35], v11 offset:18432
    v_mfma_f32_16x16x32_bf16 v[60:63], v[36:39], a[52:55], v[60:63]
    v_cvt_pk_bf16_f32 v86, v72, v73
    s_waitcnt lgkmcnt(6)
    v_mfma_f32_16x16x32_bf16 v[56:59], v[40:43], a[48:51], v[56:59]
    ds_read_b128 v[36:39], v10 offset:20480
    v_mfma_f32_16x16x32_bf16 v[64:67], v[40:43], a[52:55], v[64:67]
    v_cvt_pk_bf16_f32 v87, v74, v75
    s_waitcnt lgkmcnt(6)
    v_mfma_f32_16x16x32_bf16 v[52:55], v[44:47], a[56:59], v[52:55]
    ds_read_b128 v[40:43], v10 offset:22528
    v_mfma_f32_16x16x32_bf16 v[60:63], v[44:47], a[60:63], v[60:63]
    v_cvt_pk_bf16_f32 v88, v76, v77
    s_waitcnt lgkmcnt(6)
    v_mfma_f32_16x16x32_bf16 v[56:59], v[48:51], a[56:59], v[56:59]
    ds_read_b128 v[44:47], v11 offset:20480
    v_mfma_f32_16x16x32_bf16 v[64:67], v[48:51], a[60:63], v[64:67]
    v_cvt_pk_bf16_f32 v89, v78, v79
    buffer_store_dwordx4 v[84:87], v3, s[4:7], s21 offen offset:0 sc1
    s_waitcnt lgkmcnt(6)
    v_mfma_f32_16x16x32_bf16 v[52:55], v[20:23], a[64:67], v[52:55]
    ds_read_b128 v[48:51], v11 offset:22528
    v_mfma_f32_16x16x32_bf16 v[60:63], v[20:23], a[68:71], v[60:63]
    v_cvt_pk_bf16_f32 v90, v80, v81
    s_waitcnt lgkmcnt(6)
    v_mfma_f32_16x16x32_bf16 v[56:59], v[24:27], a[64:67], v[56:59]
    ds_read_b128 v[20:23], v10 offset:24576
    v_mfma_f32_16x16x32_bf16 v[64:67], v[24:27], a[68:71], v[64:67]
    v_cvt_pk_bf16_f32 v91, v82, v83
    s_waitcnt lgkmcnt(6)
    v_mfma_f32_16x16x32_bf16 v[52:55], v[28:31], a[72:75], v[52:55]
    ds_read_b128 v[24:27], v10 offset:26624
    v_mfma_f32_16x16x32_bf16 v[60:63], v[28:31], a[76:79], v[60:63]
    s_waitcnt lgkmcnt(6)
    v_mfma_f32_16x16x32_bf16 v[56:59], v[32:35], a[72:75], v[56:59]
    ds_read_b128 v[28:31], v11 offset:24576
    v_mfma_f32_16x16x32_bf16 v[64:67], v[32:35], a[76:79], v[64:67]
    buffer_store_dwordx4 v[88:91], v3, s[4:7], s21 offen offset:128 sc1
    s_waitcnt lgkmcnt(6)
    v_mfma_f32_16x16x32_bf16 v[52:55], v[36:39], a[80:83], v[52:55]
    ds_read_b128 v[32:35], v11 offset:26624
    v_mfma_f32_16x16x32_bf16 v[60:63], v[36:39], a[84:87], v[60:63]
    s_add_u32 s21, s21, s25
    s_mov_b32 s25, s26
    s_waitcnt lgkmcnt(6)
    v_mfma_f32_16x16x32_bf16 v[56:59], v[40:43], a[80:83], v[56:59]
    ds_read_b128 v[36:39], v10 offset:28672
    v_mfma_f32_16x16x32_bf16 v[64:67], v[40:43], a[84:87], v[64:67]
    s_waitcnt lgkmcnt(6)
    v_mfma_f32_16x16x32_bf16 v[52:55], v[44:47], a[88:91], v[52:55]
    ds_read_b128 v[40:43], v10 offset:30720
    v_mfma_f32_16x16x32_bf16 v[60:63], v[44:47], a[92:95], v[60:63]
    s_waitcnt lgkmcnt(6)
    v_mfma_f32_16x16x32_bf16 v[56:59], v[48:51], a[88:91], v[56:59]
    ds_read_b128 v[44:47], v11 offset:28672
    v_mfma_f32_16x16x32_bf16 v[64:67], v[48:51], a[92:95], v[64:67]
    s_waitcnt lgkmcnt(6)
    v_mfma_f32_16x16x32_bf16 v[52:55], v[20:23], a[96:99], v[52:55]
    ds_read_b128 v[48:51], v11 offset:30720
    v_mfma_f32_16x16x32_bf16 v[60:63], v[20:23], a[100:103], v[60:63]
    s_waitcnt lgkmcnt(6)
    v_mfma_f32_16x16x32_bf16 v[56:59], v[24:27], a[96:99], v[56:59]
    s_waitcnt vmcnt(11)
    s_barrier
    ds_read_b128 v[20:23], v10 offset:32768
    v_mfma_f32_16x16x32_bf16 v[64:67], v[24:27], a[100:103], v[64:67]
    s_waitcnt lgkmcnt(6)
    v_mfma_f32_16x16x32_bf16 v[52:55], v[28:31], a[104:107], v[52:55]
    ds_read_b128 v[24:27], v10 offset:34816
    s_add_u32 m0, s19, 97280
    v_mfma_f32_16x16x32_bf16 v[60:63], v[28:31], a[108:111], v[60:63]
    buffer_load_dwordx4 v2, s[8:11], s20 offen offset:1024 lds
    s_waitcnt lgkmcnt(6)
    v_mfma_f32_16x16x32_bf16 v[56:59], v[32:35], a[104:107], v[56:59]
    ds_read_b128 v[28:31], v11 offset:32768
    v_mfma_f32_16x16x32_bf16 v[64:67], v[32:35], a[108:111], v[64:67]
    s_waitcnt lgkmcnt(6)
    v_mfma_f32_16x16x32_bf16 v[52:55], v[36:39], a[112:115], v[52:55]
    ds_read_b128 v[32:35], v11 offset:34816
    s_add_u32 m0, s19, 101248
    v_mfma_f32_16x16x32_bf16 v[60:63], v[36:39], a[116:119], v[60:63]
    buffer_load_dwordx4 v2, s[8:11], s20 offen offset:1152 lds
    s_waitcnt lgkmcnt(6)
    v_mfma_f32_16x16x32_bf16 v[56:59], v[40:43], a[112:115], v[56:59]
    ds_read_b128 v[36:39], v10 offset:36864
    v_mfma_f32_16x16x32_bf16 v[64:67], v[40:43], a[116:119], v[64:67]
    s_waitcnt lgkmcnt(6)
    v_mfma_f32_16x16x32_bf16 v[52:55], v[44:47], a[120:123], v[52:55]
    ds_read_b128 v[40:43], v10 offset:38912
    s_add_u32 m0, s19, 105216
    v_mfma_f32_16x16x32_bf16 v[60:63], v[44:47], a[124:127], v[60:63]
    buffer_load_dwordx4 v2, s[8:11], s20 offen offset:1280 lds
    s_waitcnt lgkmcnt(6)
    v_mfma_f32_16x16x32_bf16 v[56:59], v[48:51], a[120:123], v[56:59]
    ds_read_b128 v[44:47], v11 offset:36864
    v_mfma_f32_16x16x32_bf16 v[64:67], v[48:51], a[124:127], v[64:67]
    s_waitcnt lgkmcnt(6)
    v_mfma_f32_16x16x32_bf16 v[52:55], v[20:23], a[128:131], v[52:55]
    ds_read_b128 v[48:51], v11 offset:38912
    v_mfma_f32_16x16x32_bf16 v[60:63], v[20:23], a[132:135], v[60:63]
    s_waitcnt lgkmcnt(6)
    v_mfma_f32_16x16x32_bf16 v[56:59], v[24:27], a[128:131], v[56:59]
    ds_read_b128 v[20:23], v10 offset:40960
    s_add_u32 m0, s19, 109184
    v_mfma_f32_16x16x32_bf16 v[64:67], v[24:27], a[132:135], v[64:67]
    buffer_load_dwordx4 v2, s[8:11], s20 offen offset:1408 lds
    s_waitcnt lgkmcnt(6)
    v_mfma_f32_16x16x32_bf16 v[52:55], v[28:31], a[136:139], v[52:55]
    ds_read_b128 v[24:27], v10 offset:43008
    v_mfma_f32_16x16x32_bf16 v[60:63], v[28:31], a[140:143], v[60:63]
    s_waitcnt lgkmcnt(6)
    v_mfma_f32_16x16x32_bf16 v[56:59], v[32:35], a[136:139], v[56:59]
    ds_read_b128 v[28:31], v11 offset:40960
    s_add_u32 m0, s19, 113152
    v_mfma_f32_16x16x32_bf16 v[64:67], v[32:35], a[140:143], v[64:67]
    buffer_load_dwordx4 v2, s[8:11], s20 offen offset:1536 lds
    s_waitcnt lgkmcnt(6)
    v_mfma_f32_16x16x32_bf16 v[52:55], v[36:39], a[144:147], v[52:55]
    ds_read_b128 v[32:35], v11 offset:43008
    v_mfma_f32_16x16x32_bf16 v[60:63], v[36:39], a[148:151], v[60:63]
    s_waitcnt lgkmcnt(6)
    v_mfma_f32_16x16x32_bf16 v[56:59], v[40:43], a[144:147], v[56:59]
    ds_read_b128 v[36:39], v10 offset:45056
    s_add_u32 m0, s19, 117120
    v_mfma_f32_16x16x32_bf16 v[64:67], v[40:43], a[148:151], v[64:67]
    buffer_load_dwordx4 v2, s[8:11], s20 offen offset:1664 lds
    s_waitcnt lgkmcnt(6)
    v_mfma_f32_16x16x32_bf16 v[52:55], v[44:47], a[152:155], v[52:55]
    ds_read_b128 v[40:43], v10 offset:47104
    v_mfma_f32_16x16x32_bf16 v[60:63], v[44:47], a[156:159], v[60:63]
    s_waitcnt lgkmcnt(6)
    v_mfma_f32_16x16x32_bf16 v[56:59], v[48:51], a[152:155], v[56:59]
    ds_read_b128 v[44:47], v11 offset:45056
    s_add_u32 m0, s19, 121088
    v_mfma_f32_16x16x32_bf16 v[64:67], v[48:51], a[156:159], v[64:67]
    buffer_load_dwordx4 v2, s[8:11], s20 offen offset:1792 lds
    s_waitcnt lgkmcnt(6)
    v_mfma_f32_16x16x32_bf16 v[52:55], v[20:23], a[160:163], v[52:55]
    ds_read_b128 v[48:51], v11 offset:47104
    v_mfma_f32_16x16x32_bf16 v[60:63], v[20:23], a[164:167], v[60:63]
    s_waitcnt lgkmcnt(6)
    v_mfma_f32_16x16x32_bf16 v[56:59], v[24:27], a[160:163], v[56:59]
    ds_read_b128 v[20:23], v10 offset:49152
    s_add_u32 m0, s19, 125056
    v_mfma_f32_16x16x32_bf16 v[64:67], v[24:27], a[164:167], v[64:67]
    buffer_load_dwordx4 v2, s[8:11], s20 offen offset:1920 lds
    s_waitcnt lgkmcnt(6)
    v_mfma_f32_16x16x32_bf16 v[52:55], v[28:31], a[168:171], v[52:55]
    ds_read_b128 v[24:27], v10 offset:51200
    v_mfma_f32_16x16x32_bf16 v[60:63], v[28:31], a[172:175], v[60:63]
    s_add_u32 s20, s20, s24
    s_waitcnt lgkmcnt(6)
    v_mfma_f32_16x16x32_bf16 v[56:59], v[32:35], a[168:171], v[56:59]
    ds_read_b128 v[28:31], v11 offset:49152
    v_mfma_f32_16x16x32_bf16 v[64:67], v[32:35], a[172:175], v[64:67]
    s_waitcnt lgkmcnt(6)
    v_mfma_f32_16x16x32_bf16 v[52:55], v[36:39], a[176:179], v[52:55]
    ds_read_b128 v[32:35], v11 offset:51200
    v_mfma_f32_16x16x32_bf16 v[60:63], v[36:39], a[180:183], v[60:63]
    s_waitcnt lgkmcnt(6)
    v_mfma_f32_16x16x32_bf16 v[56:59], v[40:43], a[176:179], v[56:59]
    ds_read_b128 v[36:39], v10 offset:53248
    v_mfma_f32_16x16x32_bf16 v[64:67], v[40:43], a[180:183], v[64:67]
    s_waitcnt lgkmcnt(6)
    v_mfma_f32_16x16x32_bf16 v[52:55], v[44:47], a[184:187], v[52:55]
    ds_read_b128 v[40:43], v10 offset:55296
    v_mfma_f32_16x16x32_bf16 v[60:63], v[44:47], a[188:191], v[60:63]
    s_waitcnt lgkmcnt(6)
    v_mfma_f32_16x16x32_bf16 v[56:59], v[48:51], a[184:187], v[56:59]
    ds_read_b128 v[44:47], v11 offset:53248
    v_mfma_f32_16x16x32_bf16 v[64:67], v[48:51], a[188:191], v[64:67]
    s_waitcnt lgkmcnt(6)
    v_mfma_f32_16x16x32_bf16 v[52:55], v[20:23], a[192:195], v[52:55]
    ds_read_b128 v[48:51], v11 offset:55296
    v_mfma_f32_16x16x32_bf16 v[60:63], v[20:23], a[196:199], v[60:63]
    s_waitcnt lgkmcnt(6)
    v_mfma_f32_16x16x32_bf16 v[56:59], v[24:27], a[192:195], v[56:59]
    ds_read_b128 v[20:23], v10 offset:57344
    v_mfma_f32_16x16x32_bf16 v[64:67], v[24:27], a[196:199], v[64:67]
    s_waitcnt lgkmcnt(6)
    v_mfma_f32_16x16x32_bf16 v[52:55], v[28:31], a[200:203], v[52:55]
    ds_read_b128 v[24:27], v10 offset:59392
    v_mfma_f32_16x16x32_bf16 v[60:63], v[28:31], a[204:207], v[60:63]
    s_waitcnt lgkmcnt(6)
    v_mfma_f32_16x16x32_bf16 v[56:59], v[32:35], a[200:203], v[56:59]
    ds_read_b128 v[28:31], v11 offset:57344
    v_mfma_f32_16x16x32_bf16 v[64:67], v[32:35], a[204:207], v[64:67]
    s_waitcnt lgkmcnt(6)
    v_mfma_f32_16x16x32_bf16 v[52:55], v[36:39], a[208:211], v[52:55]
    ds_read_b128 v[32:35], v11 offset:59392
    v_mfma_f32_16x16x32_bf16 v[60:63], v[36:39], a[212:215], v[60:63]
    s_waitcnt lgkmcnt(6)
    v_mfma_f32_16x16x32_bf16 v[56:59], v[40:43], a[208:211], v[56:59]
    ds_read_b128 v[36:39], v10 offset:61440
    v_mfma_f32_16x16x32_bf16 v[64:67], v[40:43], a[212:215], v[64:67]
    s_waitcnt lgkmcnt(6)
    v_mfma_f32_16x16x32_bf16 v[52:55], v[44:47], a[216:219], v[52:55]
    ds_read_b128 v[40:43], v10 offset:63488
    v_mfma_f32_16x16x32_bf16 v[60:63], v[44:47], a[220:223], v[60:63]
    s_waitcnt lgkmcnt(6)
    v_mfma_f32_16x16x32_bf16 v[56:59], v[48:51], a[216:219], v[56:59]
    ds_read_b128 v[44:47], v11 offset:61440
    v_mfma_f32_16x16x32_bf16 v[64:67], v[48:51], a[220:223], v[64:67]
    s_waitcnt lgkmcnt(6)
    v_mfma_f32_16x16x32_bf16 v[52:55], v[20:23], a[224:227], v[52:55]
    ds_read_b128 v[48:51], v11 offset:63488
    v_mfma_f32_16x16x32_bf16 v[60:63], v[20:23], a[228:231], v[60:63]
    s_waitcnt lgkmcnt(6)
    v_mfma_f32_16x16x32_bf16 v[56:59], v[24:27], a[224:227], v[56:59]
    s_waitcnt vmcnt(8)
    s_barrier
    ds_read_b128 v[20:23], v12 offset:0
    v_mfma_f32_16x16x32_bf16 v[64:67], v[24:27], a[228:231], v[64:67]
    s_waitcnt lgkmcnt(6)
    v_mfma_f32_16x16x32_bf16 v[52:55], v[28:31], a[232:235], v[52:55]
    ds_read_b128 v[24:27], v12 offset:2048
    s_add_u32 m0, s19, 0
    v_mfma_f32_16x16x32_bf16 v[60:63], v[28:31], a[236:239], v[60:63]
    buffer_load_dwordx4 v2, s[8:11], s20 offen offset:0 lds
    s_waitcnt lgkmcnt(6)
    v_mfma_f32_16x16x32_bf16 v[56:59], v[32:35], a[232:235], v[56:59]
    ds_read_b128 v[28:31], v13 offset:0
    v_mfma_f32_16x16x32_bf16 v[64:67], v[32:35], a[236:239], v[64:67]
    v_mov_b32 v9, s23
    s_add_u32 s23, s23, 1
    buffer_store_dword v9, v4, s[4:7], 0 offen sc1
    s_waitcnt lgkmcnt(6)
    v_mfma_f32_16x16x32_bf16 v[52:55], v[36:39], a[240:243], v[52:55]
    ds_read_b128 v[32:35], v13 offset:2048
    s_add_u32 m0, s19, 3968
    v_mfma_f32_16x16x32_bf16 v[60:63], v[36:39], a[244:247], v[60:63]
    buffer_load_dwordx4 v2, s[8:11], s20 offen offset:128 lds
    s_waitcnt lgkmcnt(6)
    v_mfma_f32_16x16x32_bf16 v[56:59], v[40:43], a[240:243], v[56:59]
    ds_read_b128 v[36:39], v12 offset:4096
    v_mfma_f32_16x16x32_bf16 v[64:67], v[40:43], a[244:247], v[64:67]
    s_waitcnt lgkmcnt(6)
    v_mfma_f32_16x16x32_bf16 v[52:55], v[44:47], a[248:251], v[52:55]
    ds_read_b128 v[40:43], v12 offset:6144
    s_add_u32 m0, s19, 7936
    v_mfma_f32_16x16x32_bf16 v[60:63], v[44:47], a[252:255], v[60:63]
    buffer_load_dwordx4 v2, s[8:11], s20 offen offset:256 lds
    s_waitcnt lgkmcnt(6)
    v_mfma_f32_16x16x32_bf16 v[56:59], v[48:51], a[248:251], v[56:59]
    ds_read_b128 v[44:47], v13 offset:4096
    v_mfma_f32_16x16x32_bf16 v[64:67], v[48:51], a[252:255], v[64:67]
    s_waitcnt lgkmcnt(6)
    v_mfma_f32_16x16x32_bf16 v[68:71], v[20:23], a[0:3], 0
    ds_read_b128 v[48:51], v13 offset:6144
    v_mfma_f32_16x16x32_bf16 v[76:79], v[20:23], a[4:7], 0
    s_waitcnt lgkmcnt(6)
    v_mfma_f32_16x16x32_bf16 v[72:75], v[24:27], a[0:3], 0
    ds_read_b128 v[20:23], v12 offset:8192
    s_add_u32 m0, s19, 11904
    v_mfma_f32_16x16x32_bf16 v[80:83], v[24:27], a[4:7], 0
    buffer_load_dwordx4 v2, s[8:11], s20 offen offset:384 lds
    s_waitcnt lgkmcnt(6)
    v_mfma_f32_16x16x32_bf16 v[68:71], v[28:31], a[8:11], v[68:71]
    ds_read_b128 v[24:27], v12 offset:10240
    v_mfma_f32_16x16x32_bf16 v[76:79], v[28:31], a[12:15], v[76:79]
    s_waitcnt lgkmcnt(6)
    v_mfma_f32_16x16x32_bf16 v[72:75], v[32:35], a[8:11], v[72:75]
    ds_read_b128 v[28:31], v13 offset:8192
    s_add_u32 m0, s19, 15872
    v_mfma_f32_16x16x32_bf16 v[80:83], v[32:35], a[12:15], v[80:83]
    buffer_load_dwordx4 v2, s[8:11], s20 offen offset:512 lds
    s_waitcnt lgkmcnt(6)
    v_mfma_f32_16x16x32_bf16 v[68:71], v[36:39], a[16:19], v[68:71]
    ds_read_b128 v[32:35], v13 offset:10240
    v_mfma_f32_16x16x32_bf16 v[76:79], v[36:39], a[20:23], v[76:79]
    s_waitcnt lgkmcnt(6)
    v_mfma_f32_16x16x32_bf16 v[72:75], v[40:43], a[16:19], v[72:75]
    ds_read_b128 v[36:39], v12 offset:12288
    s_add_u32 m0, s19, 19840
    v_mfma_f32_16x16x32_bf16 v[80:83], v[40:43], a[20:23], v[80:83]
    buffer_load_dwordx4 v2, s[8:11], s20 offen offset:640 lds
    s_waitcnt lgkmcnt(6)
    v_mfma_f32_16x16x32_bf16 v[68:71], v[44:47], a[24:27], v[68:71]
    ds_read_b128 v[40:43], v12 offset:14336
    v_mfma_f32_16x16x32_bf16 v[76:79], v[44:47], a[28:31], v[76:79]
    s_waitcnt lgkmcnt(6)
    v_mfma_f32_16x16x32_bf16 v[72:75], v[48:51], a[24:27], v[72:75]
    ds_read_b128 v[44:47], v13 offset:12288
    s_add_u32 m0, s19, 23808
    v_mfma_f32_16x16x32_bf16 v[80:83], v[48:51], a[28:31], v[80:83]
    buffer_load_dwordx4 v2, s[8:11], s20 offen offset:768 lds
    s_waitcnt lgkmcnt(6)
    v_mfma_f32_16x16x32_bf16 v[68:71], v[20:23], a[32:35], v[68:71]
    ds_read_b128 v[48:51], v13 offset:14336
    v_mfma_f32_16x16x32_bf16 v[76:79], v[20:23], a[36:39], v[76:79]
    s_waitcnt lgkmcnt(6)
    v_mfma_f32_16x16x32_bf16 v[72:75], v[24:27], a[32:35], v[72:75]
    ds_read_b128 v[20:23], v12 offset:16384
    s_add_u32 m0, s19, 27776
    v_mfma_f32_16x16x32_bf16 v[80:83], v[24:27], a[36:39], v[80:83]
    buffer_load_dwordx4 v2, s[8:11], s20 offen offset:896 lds
    s_waitcnt lgkmcnt(6)
    v_mfma_f32_16x16x32_bf16 v[68:71], v[28:31], a[40:43], v[68:71]
    ds_read_b128 v[24:27], v12 offset:18432
    v_mfma_f32_16x16x32_bf16 v[76:79], v[28:31], a[44:47], v[76:79]
    v_cvt_pk_bf16_f32 v84, v52, v53
    s_waitcnt lgkmcnt(6)
    v_mfma_f32_16x16x32_bf16 v[72:75], v[32:35], a[40:43], v[72:75]
    ds_read_b128 v[28:31], v13 offset:16384
    v_mfma_f32_16x16x32_bf16 v[80:83], v[32:35], a[44:47], v[80:83]
    v_cvt_pk_bf16_f32 v85, v54, v55
    s_waitcnt lgkmcnt(6)
    v_mfma_f32_16x16x32_bf16 v[68:71], v[36:39], a[48:51], v[68:71]
    ds_read_b128 v[32:35], v13 offset:18432
    v_mfma_f32_16x16x32_bf16 v[76:79], v[36:39], a[52:55], v[76:79]
    v_cvt_pk_bf16_f32 v86, v56, v57
    s_waitcnt lgkmcnt(6)
    v_mfma_f32_16x16x32_bf16 v[72:75], v[40:43], a[48:51], v[72:75]
    ds_read_b128 v[36:39], v12 offset:20480
    v_mfma_f32_16x16x32_bf16 v[80:83], v[40:43], a[52:55], v[80:83]
    v_cvt_pk_bf16_f32 v87, v58, v59
    s_waitcnt lgkmcnt(6)
    v_mfma_f32_16x16x32_bf16 v[68:71], v[44:47], a[56:59], v[68:71]
    ds_read_b128 v[40:43], v12 offset:22528
    v_mfma_f32_16x16x32_bf16 v[76:79], v[44:47], a[60:63], v[76:79]
    v_cvt_pk_bf16_f32 v88, v60, v61
    s_waitcnt lgkmcnt(6)
    v_mfma_f32_16x16x32_bf16 v[72:75], v[48:51], a[56:59], v[72:75]
    ds_read_b128 v[44:47], v13 offset:20480
    v_mfma_f32_16x16x32_bf16 v[80:83], v[48:51], a[60:63], v[80:83]
    v_cvt_pk_bf16_f32 v89, v62, v63
    buffer_store_dwordx4 v[84:87], v3, s[4:7], s21 offen offset:0 sc1
    s_waitcnt lgkmcnt(6)
    v_mfma_f32_16x16x32_bf16 v[68:71], v[20:23], a[64:67], v[68:71]
    ds_read_b128 v[48:51], v13 offset:22528
    v_mfma_f32_16x16x32_bf16 v[76:79], v[20:23], a[68:71], v[76:79]
    v_cvt_pk_bf16_f32 v90, v64, v65
    s_waitcnt lgkmcnt(6)
    v_mfma_f32_16x16x32_bf16 v[72:75], v[24:27], a[64:67], v[72:75]
    ds_read_b128 v[20:23], v12 offset:24576
    v_mfma_f32_16x16x32_bf16 v[80:83], v[24:27], a[68:71], v[80:83]
    v_cvt_pk_bf16_f32 v91, v66, v67
    s_waitcnt lgkmcnt(6)
    v_mfma_f32_16x16x32_bf16 v[68:71], v[28:31], a[72:75], v[68:71]
    ds_read_b128 v[24:27], v12 offset:26624
    v_mfma_f32_16x16x32_bf16 v[76:79], v[28:31], a[76:79], v[76:79]
    s_waitcnt lgkmcnt(6)
    v_mfma_f32_16x16x32_bf16 v[72:75], v[32:35], a[72:75], v[72:75]
    ds_read_b128 v[28:31], v13 offset:24576
    v_mfma_f32_16x16x32_bf16 v[80:83], v[32:35], a[76:79], v[80:83]
    buffer_store_dwordx4 v[88:91], v3, s[4:7], s21 offen offset:128 sc1
    s_waitcnt lgkmcnt(6)
    v_mfma_f32_16x16x32_bf16 v[68:71], v[36:39], a[80:83], v[68:71]
    ds_read_b128 v[32:35], v13 offset:26624
    v_mfma_f32_16x16x32_bf16 v[76:79], v[36:39], a[84:87], v[76:79]
    s_add_u32 s21, s21, s25
    s_mov_b32 s25, s26
    s_waitcnt lgkmcnt(6)
    v_mfma_f32_16x16x32_bf16 v[72:75], v[40:43], a[80:83], v[72:75]
    ds_read_b128 v[36:39], v12 offset:28672
    v_mfma_f32_16x16x32_bf16 v[80:83], v[40:43], a[84:87], v[80:83]
    s_waitcnt lgkmcnt(6)
    v_mfma_f32_16x16x32_bf16 v[68:71], v[44:47], a[88:91], v[68:71]
    ds_read_b128 v[40:43], v12 offset:30720
    v_mfma_f32_16x16x32_bf16 v[76:79], v[44:47], a[92:95], v[76:79]
    s_waitcnt lgkmcnt(6)
    v_mfma_f32_16x16x32_bf16 v[72:75], v[48:51], a[88:91], v[72:75]
    ds_read_b128 v[44:47], v13 offset:28672
    v_mfma_f32_16x16x32_bf16 v[80:83], v[48:51], a[92:95], v[80:83]
    s_waitcnt lgkmcnt(6)
    v_mfma_f32_16x16x32_bf16 v[68:71], v[20:23], a[96:99], v[68:71]
    ds_read_b128 v[48:51], v13 offset:30720
    v_mfma_f32_16x16x32_bf16 v[76:79], v[20:23], a[100:103], v[76:79]
    s_waitcnt lgkmcnt(6)
    v_mfma_f32_16x16x32_bf16 v[72:75], v[24:27], a[96:99], v[72:75]
    s_waitcnt vmcnt(11)
    s_barrier
    ds_read_b128 v[20:23], v12 offset:32768
    v_mfma_f32_16x16x32_bf16 v[80:83], v[24:27], a[100:103], v[80:83]
    s_waitcnt lgkmcnt(6)
    v_mfma_f32_16x16x32_bf16 v[68:71], v[28:31], a[104:107], v[68:71]
    ds_read_b128 v[24:27], v12 offset:34816
    s_add_u32 m0, s19, 31744
    v_mfma_f32_16x16x32_bf16 v[76:79], v[28:31], a[108:111], v[76:79]
    buffer_load_dwordx4 v2, s[8:11], s20 offen offset:1024 lds
    s_waitcnt lgkmcnt(6)
    v_mfma_f32_16x16x32_bf16 v[72:75], v[32:35], a[104:107], v[72:75]
    ds_read_b128 v[28:31], v13 offset:32768
    v_mfma_f32_16x16x32_bf16 v[80:83], v[32:35], a[108:111], v[80:83]
    s_waitcnt lgkmcnt(6)
    v_mfma_f32_16x16x32_bf16 v[68:71], v[36:39], a[112:115], v[68:71]
    ds_read_b128 v[32:35], v13 offset:34816
    s_add_u32 m0, s19, 35712
    v_mfma_f32_16x16x32_bf16 v[76:79], v[36:39], a[116:119], v[76:79]
    buffer_load_dwordx4 v2, s[8:11], s20 offen offset:1152 lds
    s_waitcnt lgkmcnt(6)
    v_mfma_f32_16x16x32_bf16 v[72:75], v[40:43], a[112:115], v[72:75]
    ds_read_b128 v[36:39], v12 offset:36864
    v_mfma_f32_16x16x32_bf16 v[80:83], v[40:43], a[116:119], v[80:83]
    s_waitcnt lgkmcnt(6)
    v_mfma_f32_16x16x32_bf16 v[68:71], v[44:47], a[120:123], v[68:71]
    ds_read_b128 v[40:43], v12 offset:38912
    s_add_u32 m0, s19, 39680
    v_mfma_f32_16x16x32_bf16 v[76:79], v[44:47], a[124:127], v[76:79]
    buffer_load_dwordx4 v2, s[8:11], s20 offen offset:1280 lds
    s_waitcnt lgkmcnt(6)
    v_mfma_f32_16x16x32_bf16 v[72:75], v[48:51], a[120:123], v[72:75]
    ds_read_b128 v[44:47], v13 offset:36864
    v_mfma_f32_16x16x32_bf16 v[80:83], v[48:51], a[124:127], v[80:83]
    s_waitcnt lgkmcnt(6)
    v_mfma_f32_16x16x32_bf16 v[68:71], v[20:23], a[128:131], v[68:71]
    ds_read_b128 v[48:51], v13 offset:38912
    v_mfma_f32_16x16x32_bf16 v[76:79], v[20:23], a[132:135], v[76:79]
    s_waitcnt lgkmcnt(6)
    v_mfma_f32_16x16x32_bf16 v[72:75], v[24:27], a[128:131], v[72:75]
    ds_read_b128 v[20:23], v12 offset:40960
    s_add_u32 m0, s19, 43648
    v_mfma_f32_16x16x32_bf16 v[80:83], v[24:27], a[132:135], v[80:83]
    buffer_load_dwordx4 v2, s[8:11], s20 offen offset:1408 lds
    s_waitcnt lgkmcnt(6)
    v_mfma_f32_16x16x32_bf16 v[68:71], v[28:31], a[136:139], v[68:71]
    ds_read_b128 v[24:27], v12 offset:43008
    v_mfma_f32_16x16x32_bf16 v[76:79], v[28:31], a[140:143], v[76:79]
    s_waitcnt lgkmcnt(6)
    v_mfma_f32_16x16x32_bf16 v[72:75], v[32:35], a[136:139], v[72:75]
    ds_read_b128 v[28:31], v13 offset:40960
    s_add_u32 m0, s19, 47616
    v_mfma_f32_16x16x32_bf16 v[80:83], v[32:35], a[140:143], v[80:83]
    buffer_load_dwordx4 v2, s[8:11], s20 offen offset:1536 lds
    s_waitcnt lgkmcnt(6)
    v_mfma_f32_16x16x32_bf16 v[68:71], v[36:39], a[144:147], v[68:71]
    ds_read_b128 v[32:35], v13 offset:43008
    v_mfma_f32_16x16x32_bf16 v[76:79], v[36:39], a[148:151], v[76:79]
    s_waitcnt lgkmcnt(6)
    v_mfma_f32_16x16x32_bf16 v[72:75], v[40:43], a[144:147], v[72:75]
    ds_read_b128 v[36:39], v12 offset:45056
    s_add_u32 m0, s19, 51584
    v_mfma_f32_16x16x32_bf16 v[80:83], v[40:43], a[148:151], v[80:83]
    buffer_load_dwordx4 v2, s[8:11], s20 offen offset:1664 lds
    s_waitcnt lgkmcnt(6)
    v_mfma_f32_16x16x32_bf16 v[68:71], v[44:47], a[152:155], v[68:71]
    ds_read_b128 v[40:43], v12 offset:47104
    v_mfma_f32_16x16x32_bf16 v[76:79], v[44:47], a[156:159], v[76:79]
    s_waitcnt lgkmcnt(6)
    v_mfma_f32_16x16x32_bf16 v[72:75], v[48:51], a[152:155], v[72:75]
    ds_read_b128 v[44:47], v13 offset:45056
    s_add_u32 m0, s19, 55552
    v_mfma_f32_16x16x32_bf16 v[80:83], v[48:51], a[156:159], v[80:83]
    buffer_load_dwordx4 v2, s[8:11], s20 offen offset:1792 lds
    s_waitcnt lgkmcnt(6)
    v_mfma_f32_16x16x32_bf16 v[68:71], v[20:23], a[160:163], v[68:71]
    ds_read_b128 v[48:51], v13 offset:47104
    v_mfma_f32_16x16x32_bf16 v[76:79], v[20:23], a[164:167], v[76:79]
    s_waitcnt lgkmcnt(6)
    v_mfma_f32_16x16x32_bf16 v[72:75], v[24:27], a[160:163], v[72:75]
    ds_read_b128 v[20:23], v12 offset:49152
    s_add_u32 m0, s19, 59520
    v_mfma_f32_16x16x32_bf16 v[80:83], v[24:27], a[164:167], v[80:83]
    buffer_load_dwordx4 v2, s[8:11], s20 offen offset:1920 lds
    s_waitcnt lgkmcnt(6)
    v_mfma_f32_16x16x32_bf16 v[68:71], v[28:31], a[168:171], v[68:71]
    ds_read_b128 v[24:27], v12 offset:51200
    v_mfma_f32_16x16x32_bf16 v[76:79], v[28:31], a[172:175], v[76:79]
    s_add_u32 s20, s20, s24
    s_waitcnt lgkmcnt(6)
    v_mfma_f32_16x16x32_bf16 v[72:75], v[32:35], a[168:171], v[72:75]
    ds_read_b128 v[28:31], v13 offset:49152
    v_mfma_f32_16x16x32_bf16 v[80:83], v[32:35], a[172:175], v[80:83]
    s_waitcnt lgkmcnt(6)
    v_mfma_f32_16x16x32_bf16 v[68:71], v[36:39], a[176:179], v[68:71]
    ds_read_b128 v[32:35], v13 offset:51200
    v_mfma_f32_16x16x32_bf16 v[76:79], v[36:39], a[180:183], v[76:79]
    s_waitcnt lgkmcnt(6)
    v_mfma_f32_16x16x32_bf16 v[72:75], v[40:43], a[176:179], v[72:75]
    ds_read_b128 v[36:39], v12 offset:53248
    v_mfma_f32_16x16x32_bf16 v[80:83], v[40:43], a[180:183], v[80:83]
    s_waitcnt lgkmcnt(6)
    v_mfma_f32_16x16x32_bf16 v[68:71], v[44:47], a[184:187], v[68:71]
    ds_read_b128 v[40:43], v12 offset:55296
    v_mfma_f32_16x16x32_bf16 v[76:79], v[44:47], a[188:191], v[76:79]
    s_waitcnt lgkmcnt(6)
    v_mfma_f32_16x16x32_bf16 v[72:75], v[48:51], a[184:187], v[72:75]
    ds_read_b128 v[44:47], v13 offset:53248
    v_mfma_f32_16x16x32_bf16 v[80:83], v[48:51], a[188:191], v[80:83]
    s_waitcnt lgkmcnt(6)
    v_mfma_f32_16x16x32_bf16 v[68:71], v[20:23], a[192:195], v[68:71]
    ds_read_b128 v[48:51], v13 offset:55296
    v_mfma_f32_16x16x32_bf16 v[76:79], v[20:23], a[196:199], v[76:79]
    s_waitcnt lgkmcnt(6)
    v_mfma_f32_16x16x32_bf16 v[72:75], v[24:27], a[192:195], v[72:75]
    ds_read_b128 v[20:23], v12 offset:57344
    v_mfma_f32_16x16x32_bf16 v[80:83], v[24:27], a[196:199], v[80:83]
    s_waitcnt lgkmcnt(6)
    v_mfma_f32_16x16x32_bf16 v[68:71], v[28:31], a[200:203], v[68:71]
    ds_read_b128 v[24:27], v12 offset:59392
    v_mfma_f32_16x16x32_bf16 v[76:79], v[28:31], a[204:207], v[76:79]
    s_waitcnt lgkmcnt(6)
    v_mfma_f32_16x16x32_bf16 v[72:75], v[32:35], a[200:203], v[72:75]
    ds_read_b128 v[28:31], v13 offset:57344
    v_mfma_f32_16x16x32_bf16 v[80:83], v[32:35], a[204:207], v[80:83]
    s_waitcnt lgkmcnt(6)
    v_mfma_f32_16x16x32_bf16 v[68:71], v[36:39], a[208:211], v[68:71]
    ds_read_b128 v[32:35], v13 offset:59392
    v_mfma_f32_16x16x32_bf16 v[76:79], v[36:39], a[212:215], v[76:79]
    s_waitcnt lgkmcnt(6)
    v_mfma_f32_16x16x32_bf16 v[72:75], v[40:43], a[208:211], v[72:75]
    ds_read_b128 v[36:39], v12 offset:61440
    v_mfma_f32_16x16x32_bf16 v[80:83], v[40:43], a[212:215], v[80:83]
    s_waitcnt lgkmcnt(6)
    v_mfma_f32_16x16x32_bf16 v[68:71], v[44:47], a[216:219], v[68:71]
    ds_read_b128 v[40:43], v12 offset:63488
    v_mfma_f32_16x16x32_bf16 v[76:79], v[44:47], a[220:223], v[76:79]
    s_waitcnt lgkmcnt(6)
    v_mfma_f32_16x16x32_bf16 v[72:75], v[48:51], a[216:219], v[72:75]
    ds_read_b128 v[44:47], v13 offset:61440
    v_mfma_f32_16x16x32_bf16 v[80:83], v[48:51], a[220:223], v[80:83]
    s_waitcnt lgkmcnt(6)
    v_mfma_f32_16x16x32_bf16 v[68:71], v[20:23], a[224:227], v[68:71]
    ds_read_b128 v[48:51], v13 offset:63488
    v_mfma_f32_16x16x32_bf16 v[76:79], v[20:23], a[228:231], v[76:79]
    s_waitcnt lgkmcnt(6)
    v_mfma_f32_16x16x32_bf16 v[72:75], v[24:27], a[224:227], v[72:75]
    s_waitcnt vmcnt(8)
    s_barrier
    ds_read_b128 v[20:23], v10 offset:0
    v_mfma_f32_16x16x32_bf16 v[80:83], v[24:27], a[228:231], v[80:83]
    s_waitcnt lgkmcnt(6)
    v_mfma_f32_16x16x32_bf16 v[68:71], v[28:31], a[232:235], v[68:71]
    ds_read_b128 v[24:27], v10 offset:2048
    s_add_u32 m0, s19, 65536
    v_mfma_f32_16x16x32_bf16 v[76:79], v[28:31], a[236:239], v[76:79]
    buffer_load_dwordx4 v2, s[8:11], s20 offen offset:0 lds
    s_waitcnt lgkmcnt(6)
    v_mfma_f32_16x16x32_bf16 v[72:75], v[32:35], a[232:235], v[72:75]
    ds_read_b128 v[28:31], v11 offset:0
    v_mfma_f32_16x16x32_bf16 v[80:83], v[32:35], a[236:239], v[80:83]
    v_mov_b32 v9, s23
    s_add_u32 s23, s23, 1
    buffer_store_dword v9, v4, s[4:7], 0 offen sc1
    s_waitcnt lgkmcnt(6)
    v_mfma_f32_16x16x32_bf16 v[68:71], v[36:39], a[240:243], v[68:71]
    ds_read_b128 v[32:35], v11 offset:2048
    s_add_u32 m0, s19, 69504
    v_mfma_f32_16x16x32_bf16 v[76:79], v[36:39], a[244:247], v[76:79]
    buffer_load_dwordx4 v2, s[8:11], s20 offen offset:128 lds
    s_waitcnt lgkmcnt(6)
    v_mfma_f32_16x16x32_bf16 v[72:75], v[40:43], a[240:243], v[72:75]
    ds_read_b128 v[36:39], v10 offset:4096
    v_mfma_f32_16x16x32_bf16 v[80:83], v[40:43], a[244:247], v[80:83]
    s_waitcnt lgkmcnt(6)
    v_mfma_f32_16x16x32_bf16 v[68:71], v[44:47], a[248:251], v[68:71]
    ds_read_b128 v[40:43], v10 offset:6144
    s_add_u32 m0, s19, 73472
    v_mfma_f32_16x16x32_bf16 v[76:79], v[44:47], a[252:255], v[76:79]
    buffer_load_dwordx4 v2, s[8:11], s20 offen offset:256 lds
    s_waitcnt lgkmcnt(6)
    v_mfma_f32_16x16x32_bf16 v[72:75], v[48:51], a[248:251], v[72:75]
    ds_read_b128 v[44:47], v11 offset:4096
    v_mfma_f32_16x16x32_bf16 v[80:83], v[48:51], a[252:255], v[80:83]
    s_add_u32 s22, s22, 2
    s_cmp_lt_u32 s22, 64
    s_cbranch_scc1 P_v_top
    v_cvt_pk_bf16_f32 v84, v68, v69
    v_cvt_pk_bf16_f32 v85, v70, v71
    s_nop 0
    v_cvt_pk_bf16_f32 v86, v72, v73
    v_cvt_pk_bf16_f32 v87, v74, v75
    v_cvt_pk_bf16_f32 v88, v76, v77
    v_cvt_pk_bf16_f32 v89, v78, v79
    v_cvt_pk_bf16_f32 v90, v80, v81
    v_cvt_pk_bf16_f32 v91, v82, v83
    buffer_store_dwordx4 v[84:87], v3, s[4:7], s21 offen offset:0 sc1
    buffer_store_dwordx4 v[88:91], v3, s[4:7], s21 offen offset:128 sc1
    s_waitcnt vmcnt(0) lgkmcnt(0)
    v_mov_b32 v9, s23
    s_add_u32 s23, s23, 1
    buffer_store_dword v9, v4, s[4:7], 0 offen sc1
    s_branch W_U
W_U:
    v_lshlrev_b32 v5, 2, v1
    s_mov_b32 s18, 0
rdv_15:
    global_load_dword v6, v5, s[100:101] sc1
    s_waitcnt vmcnt(0)
rdv_15p:
    s_lshl_b32 s17, s98, 2
    v_lshrrev_b32 v9, s17, v6
    s_cmp_eq_u32 s98, 0
    s_cselect_b32 s17, 0x0f0f0f0f, s17
    s_cselect_b32 s17, s17, 0x01010101
    v_and_b32 v9, s17, v9
    v_cmp_ne_u32 vcc, 0x01010101, v9
    s_nop 0
    s_cbranch_vccz rdvok_16
    v_sad_u8 v9, v9, 0, 0
    s_nop 1
    v_add_u32_dpp v9, v9, v9 quad_perm:[1,0,3,2] row_mask:0xf bank_mask:0xf
    v_cmp_ne_u32 vcc, 8, v9
    s_nop 0
    s_cbranch_vccnz rdvw_17
    s_mov_b32 s98, 1
    s_and_b32 s3, s97, 7
    s_waitcnt vmcnt(0) lgkmcnt(0)
    s_barrier
    s_branch role_start
rdvw_17:
    s_sleep 4
    s_add_u32 s18, s18, 1
    s_cmp_lt_u32 s18, 262144
    s_cbranch_scc1 rdv_15
    s_mov_b32 s92, 1048576
rdvok_16:
    v_and_b32 v9, 0x40404040, v6
    v_bcnt_u32_b32 v9, v9, 0
    s_mov_b32 s89, 0
    v_cmp_le_u32 vcc, 1, v9
    s_nop 0
    s_bcnt1_i32_b64 s17, vcc
    s_add_u32 s89, s89, s17
    v_cmp_le_u32 vcc, 2, v9
    s_nop 0
    s_bcnt1_i32_b64 s17, vcc
    s_add_u32 s89, s89, s17
    v_cmp_le_u32 vcc, 3, v9
    s_nop 0
    s_bcnt1_i32_b64 s17, vcc
    s_add_u32 s89, s89, s17
    v_cmp_le_u32 vcc, 4, v9
    s_nop 0
    s_bcnt1_i32_b64 s17, vcc
    s_add_u32 s89, s89, s17
    s_cmp_gt_u32 s89, 16
    s_cselect_b32 s89, 8192, 0
    s_load_dwordx2 s[8:9], s[0:1], 64
    s_load_dwordx2 s[12:13], s[0:1], 80
    s_mov_b32 s10, 8388608
    s_mov_b32 s11, 0x20000
    s_mov_b32 s14, 8388608
    s_mov_b32 s15, 0x20000
    s_lshl_b32 s17, s90, 2
    s_lshr_b32 s17, 0, s17
    s_add_u32 s35, s93, s17
    s_and_b32 s35, s35, 15
    s_lshr_b32 s28, s93, 4
    s_lshl_b32 s17, s90, 2
    s_lshr_b32 s17, 516, s17
    s_and_b32 s17, s17, 15
    s_add_u32 s28, s28, s17
    s_cmp_ge_u32 s28, 4
    s_cselect_b32 s17, 16, 0
    s_add_u32 s28, s28, s17
    s_lshl_b32 s20, s16, 21
    s_lshl_b32 s17, s35, 7
    s_add_u32 s20, s20, s17
    v_lshrrev_b32 v5, 2, v1
    v_and_b32 v6, 3, v1
    v_lshlrev_b32 v7, 4, v6
    v_lshl_add_u32 v7, v5, 11, v7
    v_lshlrev_b32 v8, 3, v6
    v_bfe_u32 v5, v1, 2, 2
    v_lshrrev_b32 v6, 4, v1
    v_lshl_add_u32 v5, v6, 3, v5
    v_lshl_add_u32 v8, v5, 6, v8
    s_lshl_b32 s19, s16, 15
    v_add_u32 v8, s19, v8
    s_and_b32 s37, s93, 0
    s_lshl_b32 s37, s37, 18
    s_waitcnt lgkmcnt(0)
    s_barrier
    v_lshrrev_b32 v5, 3, v1
    v_and_b32 v6, 3, v5
    v_lshlrev_b32 v6, 1, v6
    v_xor_b32 v6, v6, v1
    v_and_b32 v6, 7, v6
    v_lshlrev_b32 v6, 4, v6
    v_lshl_add_u32 v7, v5, 11, v6
    v_xor_b32 v49, 32, v7
    v_bfe_u32 v5, v1, 2, 2
    v_lshrrev_b32 v6, 4, v1
    v_lshl_add_u32 v8, v6, 3, v5
    v_lshl_add_u32 v8, v8, 7, s19
    v_and_b32 v6, 1, v6
    v_xor_b32 v5, v5, v6
    v_lshl_add_u32 v8, v5, 5, v8
    v_and_b32 v6, 3, v1
    v_lshl_add_u32 v8, v6, 3, v8
    v_xor_b32 v2, 32, v8
    v_xor_b32 v3, 64, v8
    v_xor_b32 v4, 96, v8
    s_sub_u32 s17, s90, 1
    s_and_b32 s17, s17, 3
    s_lshl_b32 s17, s17, 3
    s_and_b32 s18, s93, 7
    s_add_u32 s17, s17, s18
    s_lshl_b32 s17, s17, 8
    v_add_lshl_u32 v5, v0, s17, 11
    s_and_b32 s17, s93, 8
    s_lshl_b32 s17, s17, 7
    buffer_load_dword v48, v5, s[8:11], s17 offen offset:384
    s_add_u32 m0, s19, 0
    s_add_u32 s17, s20, 0
    buffer_load_dwordx4 v7, s[8:11], s17 offen lds
    s_add_u32 m0, s19, 1024
    s_add_u32 s17, s20, 16384
    buffer_load_dwordx4 v49, s[8:11], s17 offen lds
    s_add_u32 m0, s19, 2048
    s_add_u32 s17, s20, 32768
    buffer_load_dwordx4 v7, s[8:11], s17 offen lds
    s_add_u32 m0, s19, 3072
    s_add_u32 s17, s20, 49152
    buffer_load_dwordx4 v49, s[8:11], s17 offen lds
    s_add_u32 m0, s19, 4096
    s_add_u32 s17, s20, 65536
    buffer_load_dwordx4 v7, s[8:11], s17 offen lds
    s_add_u32 m0, s19, 5120
    s_add_u32 s17, s20, 81920
    buffer_load_dwordx4 v49, s[8:11], s17 offen lds
    s_add_u32 m0, s19, 6144
    s_add_u32 s17, s20, 98304
    buffer_load_dwordx4 v7, s[8:11], s17 offen lds
    s_add_u32 m0, s19, 7168
    s_add_u32 s17, s20, 114688
    buffer_load_dwordx4 v49, s[8:11], s17 offen lds
    s_add_u32 m0, s19, 8192
    s_add_u32 s17, s20, 131072
    buffer_load_dwordx4 v7, s[8:11], s17 offen lds
    s_add_u32 m0, s19, 9216
    s_add_u32 s17, s20, 147456
    buffer_load_dwordx4 v49, s[8:11], s17 offen lds
    s_add_u32 m0, s19, 10240
    s_add_u32 s17, s20, 163840
    buffer_load_dwordx4 v7, s[8:11], s17 offen lds
    s_add_u32 m0, s19, 11264
    s_add_u32 s17, s20, 180224
    buffer_load_dwordx4 v49, s[8:11], s17 offen lds
    s_add_u32 m0, s19, 12288
    s_add_u32 s17, s20, 262144
    buffer_load_dwordx4 v7, s[8:11], s17 offen lds
    s_add_u32 m0, s19, 13312
    s_add_u32 s17, s20, 278528
    buffer_load_dwordx4 v49, s[8:11], s17 offen lds
    s_add_u32 m0, s19, 14336
    s_add_u32 s17, s20, 294912
    buffer_load_dwordx4 v7, s[8:11], s17 offen lds
    s_add_u32 m0, s19, 15360
    s_add_u32 s17, s20, 311296
    buffer_load_dwordx4 v49, s[8:11], s17 offen lds
    s_add_u32 m0, s19, 16384
    s_add_u32 s17, s20, 327680
    buffer_load_dwordx4 v7, s[8:11], s17 offen lds
    s_add_u32 m0, s19, 17408
    s_add_u32 s17, s20, 344064
    buffer_load_dwordx4 v49, s[8:11], s17 offen lds
    s_add_u32 m0, s19, 18432
    s_add_u32 s17, s20, 360448
    buffer_load_dwordx4 v7, s[8:11], s17 offen lds
    s_add_u32 m0, s19, 19456
    s_add_u32 s17, s20, 376832
    buffer_load_dwordx4 v49, s[8:11], s17 offen lds
    s_add_u32 m0, s19, 20480
    s_add_u32 s17, s20, 393216
    buffer_load_dwordx4 v7, s[8:11], s17 offen lds
    s_add_u32 m0, s19, 21504
    s_add_u32 s17, s20, 409600
    buffer_load_dwordx4 v49, s[8:11], s17 offen lds
    s_add_u32 m0, s19, 22528
    s_add_u32 s17, s20, 425984
    buffer_load_dwordx4 v7, s[8:11], s17 offen lds
    s_add_u32 m0, s19, 23552
    s_add_u32 s17, s20, 442368
    buffer_load_dwordx4 v49, s[8:11], s17 offen lds
    s_add_u32 m0, s19, 24576
    s_add_u32 s17, s20, 524288
    buffer_load_dwordx4 v7, s[8:11], s17 offen lds
    s_add_u32 m0, s19, 25600
    s_add_u32 s17, s20, 540672
    buffer_load_dwordx4 v49, s[8:11], s17 offen lds
    s_add_u32 m0, s19, 26624
    s_add_u32 s17, s20, 557056
    buffer_load_dwordx4 v7, s[8:11], s17 offen lds
    s_add_u32 m0, s19, 27648
    s_add_u32 s17, s20, 573440
    buffer_load_dwordx4 v49, s[8:11], s17 offen lds
    s_add_u32 m0, s19, 28672
    s_add_u32 s17, s20, 589824
    buffer_load_dwordx4 v7, s[8:11], s17 offen lds
    s_add_u32 m0, s19, 29696
    s_add_u32 s17, s20, 606208
    buffer_load_dwordx4 v49, s[8:11], s17 offen lds
    s_add_u32 m0, s19, 30720
    s_add_u32 s17, s20, 622592
    buffer_load_dwordx4 v7, s[8:11], s17 offen lds
    s_add_u32 m0, s19, 31744
    s_add_u32 s17, s20, 638976
    buffer_load_dwordx4 v49, s[8:11], s17 offen lds
    s_waitcnt vmcnt(28)
    ds_read_b64_tr_b16 a[0:1], v8 offset:0
    ds_read_b64_tr_b16 a[2:3], v8 offset:512
    ds_read_b64_tr_b16 a[4:5], v2 offset:0
    ds_read_b64_tr_b16 a[6:7], v2 offset:512
    ds_read_b64_tr_b16 a[8:9], v3 offset:0
    ds_read_b64_tr_b16 a[10:11], v3 offset:512
    ds_read_b64_tr_b16 a[12:13], v4 offset:0
    ds_read_b64_tr_b16 a[14:15], v4 offset:512
    s_waitcnt vmcnt(24)
    ds_read_b64_tr_b16 a[16:17], v8 offset:4096
    ds_read_b64_tr_b16 a[18:19], v8 offset:4608
    ds_read_b64_tr_b16 a[20:21], v2 offset:4096
    ds_read_b64_tr_b16 a[22:23], v2 offset:4608
    s_waitcnt lgkmcnt(4)
    s_add_u32 m0, s19, 0
    s_add_u32 s17, s20, 655360
    buffer_load_dwordx4 v7, s[8:11], s17 offen lds
    s_add_u32 m0, s19, 1024
    s_add_u32 s17, s20, 671744
    buffer_load_dwordx4 v49, s[8:11], s17 offen lds
    s_add_u32 m0, s19, 2048
    s_add_u32 s17, s20, 688128
    buffer_load_dwordx4 v7, s[8:11], s17 offen lds
    s_add_u32 m0, s19, 3072
    s_add_u32 s17, s20, 704512
    buffer_load_dwordx4 v49, s[8:11], s17 offen lds
    ds_read_b64_tr_b16 a[24:25], v3 offset:4096
    ds_read_b64_tr_b16 a[26:27], v3 offset:4608
    ds_read_b64_tr_b16 a[28:29], v4 offset:4096
    ds_read_b64_tr_b16 a[30:31], v4 offset:4608
    s_waitcnt vmcnt(24)
    ds_read_b64_tr_b16 a[32:33], v8 offset:8192
    ds_read_b64_tr_b16 a[34:35], v8 offset:8704
    ds_read_b64_tr_b16 a[36:37], v2 offset:8192
    ds_read_b64_tr_b16 a[38:39], v2 offset:8704
    s_waitcnt lgkmcnt(4)
    s_add_u32 m0, s19, 4096
    s_add_u32 s17, s20, 786432
    buffer_load_dwordx4 v7, s[8:11], s17 offen lds
    s_add_u32 m0, s19, 5120
    s_add_u32 s17, s20, 802816
    buffer_load_dwordx4 v49, s[8:11], s17 offen lds
    s_add_u32 m0, s19, 6144
    s_add_u32 s17, s20, 819200
    buffer_load_dwordx4 v7, s[8:11], s17 offen lds
    s_add_u32 m0, s19, 7168
    s_add_u32 s17, s20, 835584
    buffer_load_dwordx4 v49, s[8:11], s17 offen lds
    ds_read_b64_tr_b16 a[40:41], v3 offset:8192
    ds_read_b64_tr_b16 a[42:43], v3 offset:8704
    ds_read_b64_tr_b16 a[44:45], v4 offset:8192
    ds_read_b64_tr_b16 a[46:47], v4 offset:8704
    s_waitcnt vmcnt(24)
    ds_read_b64_tr_b16 a[48:49], v8 offset:12288
    ds_read_b64_tr_b16 a[50:51], v8 offset:12800
    ds_read_b64_tr_b16 a[52:53], v2 offset:12288
    ds_read_b64_tr_b16 a[54:55], v2 offset:12800
    s_waitcnt lgkmcnt(4)
    s_add_u32 m0, s19, 8192
    s_add_u32 s17, s20, 851968
    buffer_load_dwordx4 v7, s[8:11], s17 offen lds
    s_add_u32 m0, s19, 9216
    s_add_u32 s17, s20, 868352
    buffer_load_dwordx4 v49, s[8:11], s17 offen lds
    s_add_u32 m0, s19, 10240
    s_add_u32 s17, s20, 884736
    buffer_load_dwordx4 v7, s[8:11], s17 offen lds
    s_add_u32 m0, s19, 11264
    s_add_u32 s17, s20, 901120
    buffer_load_dwordx4 v49, s[8:11], s17 offen lds
    ds_read_b64_tr_b16 a[56:57], v3 offset:12288
    ds_read_b64_tr_b16 a[58:59], v3 offset:12800
    ds_read_b64_tr_b16 a[60:61], v4 offset:12288
    ds_read_b64_tr_b16 a[62:63], v4 offset:12800
    s_waitcnt vmcnt(24)
    ds_read_b64_tr_b16 a[64:65], v8 offset:16384
    ds_read_b64_tr_b16 a[66:67], v8 offset:16896
    ds_read_b64_tr_b16 a[68:69], v2 offset:16384
    ds_read_b64_tr_b16 a[70:71], v2 offset:16896
    s_waitcnt lgkmcnt(4)
    s_add_u32 m0, s19, 12288
    s_add_u32 s17, s20, 917504
    buffer_load_dwordx4 v7, s[8:11], s17 offen lds
    s_add_u32 m0, s19, 13312
    s_add_u32 s17, s20, 933888
    buffer_load_dwordx4 v49, s[8:11], s17 offen lds
    s_add_u32 m0, s19, 14336
    s_add_u32 s17, s20, 950272
    buffer_load_dwordx4 v7, s[8:11], s17 offen lds
    s_add_u32 m0, s19, 15360
    s_add_u32 s17, s20, 966656
    buffer_load_dwordx4 v49, s[8:11], s17 offen lds
    ds_read_b64_tr_b16 a[72:73], v3 offset:16384
    ds_read_b64_tr_b16 a[74:75], v3 offset:16896
    ds_read_b64_tr_b16 a[76:77], v4 offset:16384
    ds_read_b64_tr_b16 a[78:79], v4 offset:16896
    s_waitcnt vmcnt(24)
    ds_read_b64_tr_b16 a[80:81], v8 offset:20480
    ds_read_b64_tr_b16 a[82:83], v8 offset:20992
    ds_read_b64_tr_b16 a[84:85], v2 offset:20480
    ds_read_b64_tr_b16 a[86:87], v2 offset:20992
    s_waitcnt lgkmcnt(4)
    s_add_u32 m0, s19, 16384
    s_add_u32 s17, s20, 1048576
    buffer_load_dwordx4 v7, s[8:11], s17 offen lds
    s_add_u32 m0, s19, 17408
    s_add_u32 s17, s20, 1064960
    buffer_load_dwordx4 v49, s[8:11], s17 offen lds
    s_add_u32 m0, s19, 18432
    s_add_u32 s17, s20, 1081344
    buffer_load_dwordx4 v7, s[8:11], s17 offen lds
    s_add_u32 m0, s19, 19456
    s_add_u32 s17, s20, 1097728
    buffer_load_dwordx4 v49, s[8:11], s17 offen lds
    ds_read_b64_tr_b16 a[88:89], v3 offset:20480
    ds_read_b64_tr_b16 a[90:91], v3 offset:20992
    ds_read_b64_tr_b16 a[92:93], v4 offset:20480
    ds_read_b64_tr_b16 a[94:95], v4 offset:20992
    s_waitcnt vmcnt(24)
    ds_read_b64_tr_b16 a[96:97], v8 offset:24576
    ds_read_b64_tr_b16 a[98:99], v8 offset:25088
    ds_read_b64_tr_b16 a[100:101], v2 offset:24576
    ds_read_b64_tr_b16 a[102:103], v2 offset:25088
    s_waitcnt lgkmcnt(4)
    s_add_u32 m0, s19, 20480
    s_add_u32 s17, s20, 1114112
    buffer_load_dwordx4 v7, s[8:11], s17 offen lds
    s_add_u32 m0, s19, 21504
    s_add_u32 s17, s20, 1130496
    buffer_load_dwordx4 v49, s[8:11], s17 offen lds
    s_add_u32 m0, s19, 22528
    s_add_u32 s17, s20, 1146880
    buffer_load_dwordx4 v7, s[8:11], s17 offen lds
    s_add_u32 m0, s19, 23552
    s_add_u32 s17, s20, 1163264
    buffer_load_dwordx4 v49, s[8:11], s17 offen lds
    ds_read_b64_tr_b16 a[104:105], v3 offset:24576
    ds_read_b64_tr_b16 a[106:107], v3 offset:25088
    ds_read_b64_tr_b16 a[108:109], v4 offset:24576
    ds_read_b64_tr_b16 a[110:111], v4 offset:25088
    s_waitcnt vmcnt(24)
    ds_read_b64_tr_b16 a[112:113], v8 offset:28672
    ds_read_b64_tr_b16 a[114:115], v8 offset:29184
    ds_read_b64_tr_b16 a[116:117], v2 offset:28672
    ds_read_b64_tr_b16 a[118:119], v2 offset:29184
    s_waitcnt lgkmcnt(4)
    s_add_u32 m0, s19, 24576
    s_add_u32 s17, s20, 1179648
    buffer_load_dwordx4 v7, s[8:11], s17 offen lds
    s_add_u32 m0, s19, 25600
    s_add_u32 s17, s20, 1196032
    buffer_load_dwordx4 v49, s[8:11], s17 offen lds
    s_add_u32 m0, s19, 26624
    s_add_u32 s17, s20, 1212416
    buffer_load_dwordx4 v7, s[8:11], s17 offen lds
    s_add_u32 m0, s19, 27648
    s_add_u32 s17, s20, 1228800
    buffer_load_dwordx4 v49, s[8:11], s17 offen lds
    ds_read_b64_tr_b16 a[120:121], v3 offset:28672
    ds_read_b64_tr_b16 a[122:123], v3 offset:29184
    ds_read_b64_tr_b16 a[124:125], v4 offset:28672
    ds_read_b64_tr_b16 a[126:127], v4 offset:29184
    s_waitcnt vmcnt(24)
    ds_read_b64_tr_b16 a[128:129], v8 offset:0
    ds_read_b64_tr_b16 a[130:131], v8 offset:512
    ds_read_b64_tr_b16 a[132:133], v2 offset:0
    ds_read_b64_tr_b16 a[134:135], v2 offset:512
    s_waitcnt lgkmcnt(4)
    s_add_u32 m0, s19, 28672
    s_add_u32 s17, s20, 1310720
    buffer_load_dwordx4 v7, s[8:11], s17 offen lds
    s_add_u32 m0, s19, 29696
    s_add_u32 s17, s20, 1327104
    buffer_load_dwordx4 v49, s[8:11], s17 offen lds
    s_add_u32 m0, s19, 30720
    s_add_u32 s17, s20, 1343488
    buffer_load_dwordx4 v7, s[8:11], s17 offen lds
    s_add_u32 m0, s19, 31744
    s_add_u32 s17, s20, 1359872
    buffer_load_dwordx4 v49, s[8:11], s17 offen lds
    ds_read_b64_tr_b16 a[136:137], v3 offset:0
    ds_read_b64_tr_b16 a[138:139], v3 offset:512
    ds_read_b64_tr_b16 a[140:141], v4 offset:0
    ds_read_b64_tr_b16 a[142:143], v4 offset:512
    s_waitcnt vmcnt(24)
    ds_read_b64_tr_b16 a[144:145], v8 offset:4096
    ds_read_b64_tr_b16 a[146:147], v8 offset:4608
    ds_read_b64_tr_b16 a[148:149], v2 offset:4096
    ds_read_b64_tr_b16 a[150:151], v2 offset:4608
    s_waitcnt lgkmcnt(4)
    s_add_u32 m0, s19, 0
    s_add_u32 s17, s20, 1376256
    buffer_load_dwordx4 v7, s[8:11], s17 offen lds
    s_add_u32 m0, s19, 1024
    s_add_u32 s17, s20, 1392640
    buffer_load_dwordx4 v49, s[8:11], s17 offen lds
    s_add_u32 m0, s19, 2048
    s_add_u32 s17, s20, 1409024
    buffer_load_dwordx4 v7, s[8:11], s17 offen lds
    s_add_u32 m0, s19, 3072
    s_add_u32 s17, s20, 1425408
    buffer_load_dwordx4 v49, s[8:11], s17 offen lds
    ds_read_b64_tr_b16 a[152:153], v3 offset:4096
    ds_read_b64_tr_b16 a[154:155], v3 offset:4608
    ds_read_b64_tr_b16 a[156:157], v4 offset:4096
    ds_read_b64_tr_b16 a[158:159], v4 offset:4608
    s_waitcnt vmcnt(24)
    ds_read_b64_tr_b16 a[160:161], v8 offset:8192
    ds_read_b64_tr_b16 a[162:163], v8 offset:8704
    ds_read_b64_tr_b16 a[164:165], v2 offset:8192
    ds_read_b64_tr_b16 a[166:167], v2 offset:8704
    s_waitcnt lgkmcnt(4)
    s_add_u32 m0, s19, 4096
    s_add_u32 s17, s20, 1441792
    buffer_load_dwordx4 v7, s[8:11], s17 offen lds
    s_add_u32 m0, s19, 5120
    s_add_u32 s17, s20, 1458176
    buffer_load_dwordx4 v49, s[8:11], s17 offen lds
    s_add_u32 m0, s19, 6144
    s_add_u32 s17, s20, 1474560
    buffer_load_dwordx4 v7, s[8:11], s17 offen lds
    s_add_u32 m0, s19, 7168
    s_add_u32 s17, s20, 1490944
    buffer_load_dwordx4 v49, s[8:11], s17 offen lds
    ds_read_b64_tr_b16 a[168:169], v3 offset:8192
    ds_read_b64_tr_b16 a[170:171], v3 offset:8704
    ds_read_b64_tr_b16 a[172:173], v4 offset:8192
    ds_read_b64_tr_b16 a[174:175], v4 offset:8704
    s_waitcnt vmcnt(24)
    ds_read_b64_tr_b16 a[176:177], v8 offset:12288
    ds_read_b64_tr_b16 a[178:179], v8 offset:12800
    ds_read_b64_tr_b16 a[180:181], v2 offset:12288
    ds_read_b64_tr_b16 a[182:183], v2 offset:12800
    s_waitcnt lgkmcnt(4)
    s_add_u32 m0, s19, 8192
    s_add_u32 s17, s20, 1572864
    buffer_load_dwordx4 v7, s[8:11], s17 offen lds
    s_add_u32 m0, s19, 9216
    s_add_u32 s17, s20, 1589248
    buffer_load_dwordx4 v49, s[8:11], s17 offen lds
    s_add_u32 m0, s19, 10240
    s_add_u32 s17, s20, 1605632
    buffer_load_dwordx4 v7, s[8:11], s17 offen lds
    s_add_u32 m0, s19, 11264
    s_add_u32 s17, s20, 1622016
    buffer_load_dwordx4 v49, s[8:11], s17 offen lds
    ds_read_b64_tr_b16 a[184:185], v3 offset:12288
    ds_read_b64_tr_b16 a[186:187], v3 offset:12800
    ds_read_b64_tr_b16 a[188:189], v4 offset:12288
    ds_read_b64_tr_b16 a[190:191], v4 offset:12800
    s_waitcnt vmcnt(24)
    ds_read_b64_tr_b16 a[192:193], v8 offset:16384
    ds_read_b64_tr_b16 a[194:195], v8 offset:16896
    ds_read_b64_tr_b16 a[196:197], v2 offset:16384
    ds_read_b64_tr_b16 a[198:199], v2 offset:16896
    s_waitcnt lgkmcnt(4)
    s_add_u32 m0, s19, 12288
    s_add_u32 s17, s20, 1638400
    buffer_load_dwordx4 v7, s[8:11], s17 offen lds
    s_add_u32 m0, s19, 13312
    s_add_u32 s17, s20, 1654784
    buffer_load_dwordx4 v49, s[8:11], s17 offen lds
    s_add_u32 m0, s19, 14336
    s_add_u32 s17, s20, 1671168
    buffer_load_dwordx4 v7, s[8:11], s17 offen lds
    s_add_u32 m0, s19, 15360
    s_add_u32 s17, s20, 1687552
    buffer_load_dwordx4 v49, s[8:11], s17 offen lds
    ds_read_b64_tr_b16 a[200:201], v3 offset:16384
    ds_read_b64_tr_b16 a[202:203], v3 offset:16896
    ds_read_b64_tr_b16 a[204:205], v4 offset:16384
    ds_read_b64_tr_b16 a[206:207], v4 offset:16896
    s_waitcnt vmcnt(24)
    ds_read_b64_tr_b16 a[208:209], v8 offset:20480
    ds_read_b64_tr_b16 a[210:211], v8 offset:20992
    ds_read_b64_tr_b16 a[212:213], v2 offset:20480
    ds_read_b64_tr_b16 a[214:215], v2 offset:20992
    s_waitcnt lgkmcnt(4)
    s_add_u32 m0, s19, 16384
    s_add_u32 s17, s20, 1703936
    buffer_load_dwordx4 v7, s[8:11], s17 offen lds
    s_add_u32 m0, s19, 17408
    s_add_u32 s17, s20, 1720320
    buffer_load_dwordx4 v49, s[8:11], s17 offen lds
    s_add_u32 m0, s19, 18432
    s_add_u32 s17, s20, 1736704
    buffer_load_dwordx4 v7, s[8:11], s17 offen lds
    s_add_u32 m0, s19, 19456
    s_add_u32 s17, s20, 1753088
    buffer_load_dwordx4 v49, s[8:11], s17 offen lds
    ds_read_b64_tr_b16 a[216:217], v3 offset:20480
    ds_read_b64_tr_b16 a[218:219], v3 offset:20992
    ds_read_b64_tr_b16 a[220:221], v4 offset:20480
    ds_read_b64_tr_b16 a[222:223], v4 offset:20992
    s_waitcnt vmcnt(24)
    ds_read_b64_tr_b16 a[224:225], v8 offset:24576
    ds_read_b64_tr_b16 a[226:227], v8 offset:25088
    ds_read_b64_tr_b16 a[228:229], v2 offset:24576
    ds_read_b64_tr_b16 a[230:231], v2 offset:25088
    s_waitcnt lgkmcnt(4)
    s_add_u32 m0, s19, 20480
    s_add_u32 s17, s20, 1835008
    buffer_load_dwordx4 v7, s[8:11], s17 offen lds
    s_add_u32 m0, s19, 21504
    s_add_u32 s17, s20, 1851392
    buffer_load_dwordx4 v49, s[8:11], s17 offen lds
    s_add_u32 m0, s19, 22528
    s_add_u32 s17, s20, 1867776
    buffer_load_dwordx4 v7, s[8:11], s17 offen lds
    s_add_u32 m0, s19, 23552
    s_add_u32 s17, s20, 1884160
    buffer_load_dwordx4 v49, s[8:11], s17 offen lds
    ds_read_b64_tr_b16 a[232:233], v3 offset:24576
    ds_read_b64_tr_b16 a[234:235], v3 offset:25088
    ds_read_b64_tr_b16 a[236:237], v4 offset:24576
    ds_read_b64_tr_b16 a[238:239], v4 offset:25088
    s_waitcnt vmcnt(24)
    ds_read_b64_tr_b16 a[240:241], v8 offset:28672
    ds_read_b64_tr_b16 a[242:243], v8 offset:29184
    ds_read_b64_tr_b16 a[244:245], v2 offset:28672
    ds_read_b64_tr_b16 a[246:247], v2 offset:29184
    s_waitcnt lgkmcnt(4)
    s_add_u32 m0, s19, 24576
    s_add_u32 s17, s20, 1900544
    buffer_load_dwordx4 v7, s[8:11], s17 offen lds
    s_add_u32 m0, s19, 25600
    s_add_u32 s17, s20, 1916928
    buffer_load_dwordx4 v49, s[8:11], s17 offen lds
    s_add_u32 m0, s19, 26624
    s_add_u32 s17, s20, 1933312
    buffer_load_dwordx4 v7, s[8:11], s17 offen lds
    s_add_u32 m0, s19, 27648
    s_add_u32 s17, s20, 1949696
    buffer_load_dwordx4 v49, s[8:11], s17 offen lds
    ds_read_b64_tr_b16 a[248:249], v3 offset:28672
    ds_read_b64_tr_b16 a[250:251], v3 offset:29184
    ds_read_b64_tr_b16 a[252:253], v4 offset:28672
    ds_read_b64_tr_b16 a[254:255], v4 offset:29184
    s_waitcnt vmcnt(24)
    ds_read_b64_tr_b16 v[128:129], v8 offset:0
    ds_read_b64_tr_b16 v[130:131], v8 offset:512
    ds_read_b64_tr_b16 v[132:133], v2 offset:0
    ds_read_b64_tr_b16 v[134:135], v2 offset:512
    s_waitcnt lgkmcnt(4)
    s_add_u32 m0, s19, 28672
    s_add_u32 s17, s20, 1966080
    buffer_load_dwordx4 v7, s[8:11], s17 offen lds
    s_add_u32 m0, s19, 29696
    s_add_u32 s17, s20, 1982464
    buffer_load_dwordx4 v49, s[8:11], s17 offen lds
    s_add_u32 m0, s19, 30720
    s_add_u32 s17, s20, 1998848
    buffer_load_dwordx4 v7, s[8:11], s17 offen lds
    s_add_u32 m0, s19, 31744
    s_add_u32 s17, s20, 2015232
    buffer_load_dwordx4 v49, s[8:11], s17 offen lds
    ds_read_b64_tr_b16 v[136:137], v3 offset:0
    ds_read_b64_tr_b16 v[138:139], v3 offset:512
    ds_read_b64_tr_b16 v[140:141], v4 offset:0
    ds_read_b64_tr_b16 v[142:143], v4 offset:512
    s_waitcnt vmcnt(24)
    ds_read_b64_tr_b16 v[144:145], v8 offset:4096
    ds_read_b64_tr_b16 v[146:147], v8 offset:4608
    ds_read_b64_tr_b16 v[148:149], v2 offset:4096
    ds_read_b64_tr_b16 v[150:151], v2 offset:4608
    s_waitcnt lgkmcnt(4)
    s_add_u32 m0, s19, 0
    s_add_u32 s17, s20, 196608
    buffer_load_dwordx4 v7, s[8:11], s17 offen lds
    s_add_u32 m0, s19, 1024
    s_add_u32 s17, s20, 212992
    buffer_load_dwordx4 v49, s[8:11], s17 offen lds
    s_add_u32 m0, s19, 2048
    s_add_u32 s17, s20, 229376
    buffer_load_dwordx4 v7, s[8:11], s17 offen lds
    s_add_u32 m0, s19, 3072
    s_add_u32 s17, s20, 245760
    buffer_load_dwordx4 v49, s[8:11], s17 offen lds
    ds_read_b64_tr_b16 v[152:153], v3 offset:4096
    ds_read_b64_tr_b16 v[154:155], v3 offset:4608
    ds_read_b64_tr_b16 v[156:157], v4 offset:4096
    ds_read_b64_tr_b16 v[158:159], v4 offset:4608
    s_waitcnt vmcnt(24)
    ds_read_b64_tr_b16 v[160:161], v8 offset:8192
    ds_read_b64_tr_b16 v[162:163], v8 offset:8704
    ds_read_b64_tr_b16 v[164:165], v2 offset:8192
    ds_read_b64_tr_b16 v[166:167], v2 offset:8704
    s_waitcnt lgkmcnt(4)
    s_add_u32 m0, s19, 4096
    s_add_u32 s17, s20, 458752
    buffer_load_dwordx4 v7, s[8:11], s17 offen lds
    s_add_u32 m0, s19, 5120
    s_add_u32 s17, s20, 475136
    buffer_load_dwordx4 v49, s[8:11], s17 offen lds
    s_add_u32 m0, s19, 6144
    s_add_u32 s17, s20, 491520
    buffer_load_dwordx4 v7, s[8:11], s17 offen lds
    s_add_u32 m0, s19, 7168
    s_add_u32 s17, s20, 507904
    buffer_load_dwordx4 v49, s[8:11], s17 offen lds
    ds_read_b64_tr_b16 v[168:169], v3 offset:8192
    ds_read_b64_tr_b16 v[170:171], v3 offset:8704
    ds_read_b64_tr_b16 v[172:173], v4 offset:8192
    ds_read_b64_tr_b16 v[174:175], v4 offset:8704
    s_waitcnt vmcnt(24)
    ds_read_b64_tr_b16 v[176:177], v8 offset:12288
    ds_read_b64_tr_b16 v[178:179], v8 offset:12800
    ds_read_b64_tr_b16 v[180:181], v2 offset:12288
    ds_read_b64_tr_b16 v[182:183], v2 offset:12800
    s_waitcnt lgkmcnt(4)
    s_add_u32 m0, s19, 8192
    s_add_u32 s17, s20, 720896
    buffer_load_dwordx4 v7, s[8:11], s17 offen lds
    s_add_u32 m0, s19, 9216
    s_add_u32 s17, s20, 737280
    buffer_load_dwordx4 v49, s[8:11], s17 offen lds
    s_add_u32 m0, s19, 10240
    s_add_u32 s17, s20, 753664
    buffer_load_dwordx4 v7, s[8:11], s17 offen lds
    s_add_u32 m0, s19, 11264
    s_add_u32 s17, s20, 770048
    buffer_load_dwordx4 v49, s[8:11], s17 offen lds
    ds_read_b64_tr_b16 v[184:185], v3 offset:12288
    ds_read_b64_tr_b16 v[186:187], v3 offset:12800
    ds_read_b64_tr_b16 v[188:189], v4 offset:12288
    ds_read_b64_tr_b16 v[190:191], v4 offset:12800
    s_waitcnt vmcnt(24)
    ds_read_b64_tr_b16 v[192:193], v8 offset:16384
    ds_read_b64_tr_b16 v[194:195], v8 offset:16896
    ds_read_b64_tr_b16 v[196:197], v2 offset:16384
    ds_read_b64_tr_b16 v[198:199], v2 offset:16896
    s_waitcnt lgkmcnt(4)
    s_add_u32 m0, s19, 12288
    s_add_u32 s17, s20, 983040
    buffer_load_dwordx4 v7, s[8:11], s17 offen lds
    s_add_u32 m0, s19, 13312
    s_add_u32 s17, s20, 999424
    buffer_load_dwordx4 v49, s[8:11], s17 offen lds
    s_add_u32 m0, s19, 14336
    s_add_u32 s17, s20, 1015808
    buffer_load_dwordx4 v7, s[8:11], s17 offen lds
    s_add_u32 m0, s19, 15360
    s_add_u32 s17, s20, 1032192
    buffer_load_dwordx4 v49, s[8:11], s17 offen lds
    ds_read_b64_tr_b16 v[200:201], v3 offset:16384
    ds_read_b64_tr_b16 v[202:203], v3 offset:16896
    ds_read_b64_tr_b16 v[204:205], v4 offset:16384
    ds_read_b64_tr_b16 v[206:207], v4 offset:16896
    s_waitcnt vmcnt(24)
    ds_read_b64_tr_b16 v[208:209], v8 offset:20480
    ds_read_b64_tr_b16 v[210:211], v8 offset:20992
    ds_read_b64_tr_b16 v[212:213], v2 offset:20480
    ds_read_b64_tr_b16 v[214:215], v2 offset:20992
    s_waitcnt lgkmcnt(4)
    s_add_u32 m0, s19, 16384
    s_add_u32 s17, s20, 1245184
    buffer_load_dwordx4 v7, s[8:11], s17 offen lds
    s_add_u32 m0, s19, 17408
    s_add_u32 s17, s20, 1261568
    buffer_load_dwordx4 v49, s[8:11], s17 offen lds
    s_add_u32 m0, s19, 18432
    s_add_u32 s17, s20, 1277952
    buffer_load_dwordx4 v7, s[8:11], s17 offen lds
    s_add_u32 m0, s19, 19456
    s_add_u32 s17, s20, 1294336
    buffer_load_dwordx4 v49, s[8:11], s17 offen lds
    ds_read_b64_tr_b16 v[216:217], v3 offset:20480
    ds_read_b64_tr_b16 v[218:219], v3 offset:20992
    ds_read_b64_tr_b16 v[220:221], v4 offset:20480
    ds_read_b64_tr_b16 v[222:223], v4 offset:20992
    s_waitcnt vmcnt(24)
    ds_read_b64_tr_b16 v[224:225], v8 offset:24576
    ds_read_b64_tr_b16 v[226:227], v8 offset:25088
    ds_read_b64_tr_b16 v[228:229], v2 offset:24576
    ds_read_b64_tr_b16 v[230:231], v2 offset:25088
    s_waitcnt lgkmcnt(4)
    s_add_u32 m0, s19, 20480
    s_add_u32 s17, s20, 1507328
    buffer_load_dwordx4 v7, s[8:11], s17 offen lds
    s_add_u32 m0, s19, 21504
    s_add_u32 s17, s20, 1523712
    buffer_load_dwordx4 v49, s[8:11], s17 offen lds
    s_add_u32 m0, s19, 22528
    s_add_u32 s17, s20, 1540096
    buffer_load_dwordx4 v7, s[8:11], s17 offen lds
    s_add_u32 m0, s19, 23552
    s_add_u32 s17, s20, 1556480
    buffer_load_dwordx4 v49, s[8:11], s17 offen lds
    ds_read_b64_tr_b16 v[232:233], v3 offset:24576
    ds_read_b64_tr_b16 v[234:235], v3 offset:25088
    ds_read_b64_tr_b16 v[236:237], v4 offset:24576
    ds_read_b64_tr_b16 v[238:239], v4 offset:25088
    s_waitcnt vmcnt(24)
    ds_read_b64_tr_b16 v[240:241], v8 offset:28672
    ds_read_b64_tr_b16 v[242:243], v8 offset:29184
    ds_read_b64_tr_b16 v[244:245], v2 offset:28672
    ds_read_b64_tr_b16 v[246:247], v2 offset:29184
    s_waitcnt lgkmcnt(4)
    s_add_u32 m0, s19, 24576
    s_add_u32 s17, s20, 1769472
    buffer_load_dwordx4 v7, s[8:11], s17 offen lds
    s_add_u32 m0, s19, 25600
    s_add_u32 s17, s20, 1785856
    buffer_load_dwordx4 v49, s[8:11], s17 offen lds
    s_add_u32 m0, s19, 26624
    s_add_u32 s17, s20, 1802240
    buffer_load_dwordx4 v7, s[8:11], s17 offen lds
    s_add_u32 m0, s19, 27648
    s_add_u32 s17, s20, 1818624
    buffer_load_dwordx4 v49, s[8:11], s17 offen lds
    ds_read_b64_tr_b16 v[248:249], v3 offset:28672
    ds_read_b64_tr_b16 v[250:251], v3 offset:29184
    ds_read_b64_tr_b16 v[252:253], v4 offset:28672
    ds_read_b64_tr_b16 v[254:255], v4 offset:29184
    s_waitcnt lgkmcnt(0)
    s_add_u32 m0, s19, 28672
    s_add_u32 s17, s20, 2031616
    buffer_load_dwordx4 v7, s[8:11], s17 offen lds
    s_add_u32 m0, s19, 29696
    s_add_u32 s17, s20, 2048000
    buffer_load_dwordx4 v49, s[8:11], s17 offen lds
    s_add_u32 m0, s19, 30720
    s_add_u32 s17, s20, 2064384
    buffer_load_dwordx4 v7, s[8:11], s17 offen lds
    s_add_u32 m0, s19, 31744
    s_add_u32 s17, s20, 2080768
    buffer_load_dwordx4 v49, s[8:11], s17 offen lds
    s_lshr_b32 s37, s37, 6
    s_add_u32 s37, s37, 54525952
    v_lshlrev_b32 v15, 4, v1
    v_add_u32 v10, s19, v15
    s_lshl_b32 s17, s16, 10
    s_add_u32 s17, s17, 131072
    v_add_u32 v14, s17, v15
    s_lshl_b32 s17, s16, 12
    s_add_u32 s18, s17, 147456
    v_add_u32 v15, s18, v15
    v_bfe_u32 v11, v1, 3, 2
    v_and_b32 v5, 7, v1
    v_lshlrev_b32 v5, 9, v5
    v_lshl_add_u32 v11, v11, 7, v5
    s_add_u32 s17, s17, 100728832
    v_add_u32 v11, s17, v11
    v_mov_b32 v12, 0
    v_and_b32 v13, 15, v1
    v_lshrrev_b32 v5, 4, v1
    v_lshlrev_b32 v5, 3, v5
    v_lshl_add_u32 v13, v13, 12, v5
    s_lshl_b32 s17, s35, 7
    s_lshl_b32 s18, s16, 5
    s_add_u32 s17, s17, s18
    s_add_u32 s17, s17, 2048
    v_add_u32 v13, s17, v13
    s_waitcnt vmcnt(0)
    v_add_u32 v10, s19, v10
    s_xor_b32 s37, s89, 201334784
    s_mov_b32 s36, 0
U_wait:
    s_mov_b32 s29, s92
U_fl:
    s_lshr_b32 s17, s28, 3
    v_cmp_ge_u32 vcc, s17, v12
    s_lshl_b32 s18, s28, 2
    s_and_b32 s18, s18, 24
    s_lshr_b32 s17, vcc_lo, s18
    s_and_b32 s17, s17, 0xff
    s_cbranch_scc0 U_go
    s_cmp_ge_u32 s29, 1048576
    s_cselect_b32 s92, 1048576, s92
    s_cbranch_scc1 U_go
    s_lshl_b32 s17, s17, s18
    s_cmp_eq_u32 s29, 0
    s_cselect_b32 exec_lo, -1, s17
    s_mov_b32 exec_hi, 0
    s_add_u32 s29, s29, 1
    buffer_load_dword v12, v11, s[4:7], 0 offen sc1
    s_mov_b64 exec, -1
    s_sleep 2
    s_waitcnt vmcnt(0)
    s_branch U_fl
U_go:
    s_mul_i32 s30, s28, 263168
    s_and_b32 s30, s30, 33300480
    s_xor_b32 s30, s30, s37
    buffer_load_dwordx4 v[64:67], v10, s[4:7], s30 offen offset:0
    buffer_load_dwordx4 v[68:71], v10, s[4:7], s30 offen offset:1024
    buffer_load_dwordx4 v[72:75], v10, s[4:7], s30 offen offset:2048
    buffer_load_dwordx4 v[76:79], v10, s[4:7], s30 offen offset:3072
    s_add_u32 s30, s30, 4096
    buffer_load_dwordx4 v[80:83], v10, s[4:7], s30 offen offset:0
    buffer_load_dwordx4 v[84:87], v10, s[4:7], s30 offen offset:1024
    buffer_load_dwordx4 v[88:91], v10, s[4:7], s30 offen offset:2048
    buffer_load_dwordx4 v[92:95], v10, s[4:7], s30 offen offset:3072
    s_add_u32 s30, s30, 12288
    buffer_load_dwordx4 v[96:99], v10, s[4:7], s30 offen offset:0
    buffer_load_dwordx4 v[100:103], v10, s[4:7], s30 offen offset:1024
    buffer_load_dwordx4 v[104:107], v10, s[4:7], s30 offen offset:2048
    buffer_load_dwordx4 v[108:111], v10, s[4:7], s30 offen offset:3072
    s_add_u32 s30, s30, 4096
    buffer_load_dwordx4 v[112:115], v10, s[4:7], s30 offen offset:0
    buffer_load_dwordx4 v[116:119], v10, s[4:7], s30 offen offset:1024
    buffer_load_dwordx4 v[120:123], v10, s[4:7], s30 offen offset:2048
    s_mov_b32 s34, 0
    s_mov_b32 s31, 1073741824
    ds_read_b128 v[48:51], v15 offset:0
    ds_read_b128 v[52:55], v15 offset:1024
    ds_read_b128 v[56:59], v15 offset:2048
    ds_read_b128 v[60:63], v15 offset:3072
.p2align 6
U_item:
    s_waitcnt vmcnt(14)
    v_mfma_f32_16x16x32_bf16 v[16:19], a[0:3], v[64:67], 0
    buffer_load_dwordx4 v[124:127], v10, s[4:7], s30 offen offset:3072
    s_cmp_lt_u32 s28, 16
    s_cselect_b32 s33, 4, 6
    v_mfma_f32_16x16x32_bf16 v[20:23], a[4:7], v[64:67], 0
    s_add_u32 s33, s28, s33
    s_lshr_b32 s17, s33, 3
    v_cmp_ge_u32 vcc, s17, v12
    s_lshl_b32 s18, s33, 2
    s_and_b32 s18, s18, 24
    ds_read_b64_tr_b16 v[32:33], v8 offset:0
    v_mfma_f32_16x16x32_bf16 v[24:27], a[8:11], v[64:67], 0
    s_lshr_b32 s17, vcc_lo, s18
    s_and_b32 s17, s17, 0xff
    s_lshl_b32 exec_lo, s17, s18
    s_mov_b32 exec_hi, 0
    buffer_load_dword v12, v11, s[4:7], 0 offen sc1
    s_mov_b64 exec, -1
    ds_read_b64_tr_b16 v[34:35], v8 offset:512
    v_mfma_f32_16x16x32_bf16 v[28:31], a[12:15], v[64:67], 0
    ds_read_b64_tr_b16 v[36:37], v2 offset:0
    ds_read_b64_tr_b16 v[38:39], v2 offset:512
    s_waitcnt vmcnt(15)
    v_mfma_f32_16x16x32_bf16 v[16:19], a[16:19], v[68:71], v[16:19]
    s_add_u32 s30, s30, 12288
    buffer_load_dwordx4 v[64:67], v10, s[4:7], s30 offen offset:0
    v_mfma_f32_16x16x32_bf16 v[20:23], a[20:23], v[68:71], v[20:23]
    ds_read_b64_tr_b16 v[40:41], v3 offset:0
    v_mfma_f32_16x16x32_bf16 v[24:27], a[24:27], v[68:71], v[24:27]
    ds_read_b64_tr_b16 v[42:43], v3 offset:512
    v_mfma_f32_16x16x32_bf16 v[28:31], a[28:31], v[68:71], v[28:31]
    ds_read_b64_tr_b16 v[44:45], v4 offset:0
    ds_read_b64_tr_b16 v[46:47], v4 offset:512
    s_waitcnt vmcnt(15)
    v_mfma_f32_16x16x32_bf16 v[16:19], a[32:35], v[72:75], v[16:19]
    buffer_load_dwordx4 v[68:71], v10, s[4:7], s30 offen offset:1024
    v_mfma_f32_16x16x32_bf16 v[20:23], a[36:39], v[72:75], v[20:23]
    s_waitcnt lgkmcnt(8)
    s_cmp_eq_u32 s34, 0
    s_cbranch_scc1 U_nb
    s_barrier
U_nb:
    v_mfma_f32_16x16x32_bf16 v[24:27], a[40:43], v[72:75], v[24:27]
    ds_read_b128 v[48:51], v15 offset:0
    ds_read_b128 v[52:55], v15 offset:1024
    v_mfma_f32_16x16x32_bf16 v[28:31], a[44:47], v[72:75], v[28:31]
    ds_read_b128 v[56:59], v15 offset:2048
    ds_read_b128 v[60:63], v15 offset:3072
    s_waitcnt vmcnt(15)
    s_waitcnt lgkmcnt(4)
    v_mfma_f32_16x16x32_bf16 v[16:19], v[32:35], v[76:79], v[16:19]
    buffer_load_dwordx4 v[72:75], v10, s[4:7], s30 offen offset:2048
    v_mfma_f32_16x16x32_bf16 v[20:23], v[36:39], v[76:79], v[20:23]
    v_mfma_f32_16x16x32_bf16 v[24:27], v[40:43], v[76:79], v[24:27]
    v_mfma_f32_16x16x32_bf16 v[28:31], v[44:47], v[76:79], v[28:31]
    s_waitcnt vmcnt(15)
    v_mfma_f32_16x16x32_bf16 v[16:19], a[48:51], v[80:83], v[16:19]
    buffer_load_dwordx4 v[76:79], v10, s[4:7], s30 offen offset:3072
    s_waitcnt lgkmcnt(0)
    v_mfma_f32_16x16x32_bf16 v[20:23], a[52:55], v[80:83], v[20:23]
    v_add_f32 v48, v48, v52
    v_add_f32 v49, v49, v53
    ds_read_b64_tr_b16 v[32:33], v8 offset:4096
    v_mfma_f32_16x16x32_bf16 v[24:27], a[56:59], v[80:83], v[24:27]
    v_add_f32 v50, v50, v54
    v_add_f32 v51, v51, v55
    ds_read_b64_tr_b16 v[34:35], v8 offset:4608
    v_mfma_f32_16x16x32_bf16 v[28:31], a[60:63], v[80:83], v[28:31]
    ds_read_b64_tr_b16 v[36:37], v2 offset:4096
    ds_read_b64_tr_b16 v[38:39], v2 offset:4608
    s_waitcnt vmcnt(15)
    v_mfma_f32_16x16x32_bf16 v[16:19], a[64:67], v[84:87], v[16:19]
    s_add_u32 s30, s30, 4096
    buffer_load_dwordx4 v[80:83], v10, s[4:7], s30 offen offset:0
    v_mfma_f32_16x16x32_bf16 v[20:23], a[68:71], v[84:87], v[20:23]
    v_add_f32 v56, v56, v60
    v_add_f32 v57, v57, v61
    ds_read_b64_tr_b16 v[40:41], v3 offset:4096
    v_mfma_f32_16x16x32_bf16 v[24:27], a[72:75], v[84:87], v[24:27]
    v_add_f32 v58, v58, v62
    v_add_f32 v59, v59, v63
    ds_read_b64_tr_b16 v[42:43], v3 offset:4608
    v_mfma_f32_16x16x32_bf16 v[28:31], a[76:79], v[84:87], v[28:31]
    ds_read_b64_tr_b16 v[44:45], v4 offset:4096
    ds_read_b64_tr_b16 v[46:47], v4 offset:4608
    s_waitcnt vmcnt(15)
    v_mfma_f32_16x16x32_bf16 v[16:19], a[80:83], v[88:91], v[16:19]
    buffer_load_dwordx4 v[84:87], v10, s[4:7], s30 offen offset:1024
    v_mfma_f32_16x16x32_bf16 v[20:23], a[84:87], v[88:91], v[20:23]
    v_add_f32 v48, v48, v56
    v_add_f32 v49, v49, v57
    v_mfma_f32_16x16x32_bf16 v[24:27], a[88:91], v[88:91], v[24:27]
    v_add_f32 v50, v50, v58
    v_add_f32 v51, v51, v59
    v_mfma_f32_16x16x32_bf16 v[28:31], a[92:95], v[88:91], v[28:31]
    s_waitcnt vmcnt(15)
    s_waitcnt lgkmcnt(0)
    v_mfma_f32_16x16x32_bf16 v[16:19], v[32:35], v[92:95], v[16:19]
    buffer_load_dwordx4 v[88:91], v10, s[4:7], s30 offen offset:2048
    v_mfma_f32_16x16x32_bf16 v[20:23], v[36:39], v[92:95], v[20:23]
    v_cvt_pk_bf16_f32 v52, v48, v49
    v_cvt_pk_bf16_f32 v53, v50, v51
    v_mfma_f32_16x16x32_bf16 v[24:27], v[40:43], v[92:95], v[24:27]
    v_mfma_f32_16x16x32_bf16 v[28:31], v[44:47], v[92:95], v[28:31]
    s_waitcnt vmcnt(15)
    v_mfma_f32_16x16x32_bf16 v[16:19], a[96:99], v[96:99], v[16:19]
    buffer_load_dwordx4 v[92:95], v10, s[4:7], s30 offen offset:3072
    v_mfma_f32_16x16x32_bf16 v[20:23], a[100:103], v[96:99], v[20:23]
    buffer_store_dwordx2 v[52:53], v13, s[12:15], s31 offen
    v_xor_b32 v15, 0x4000, v15
    ds_read_b64_tr_b16 v[32:33], v8 offset:8192
    v_mfma_f32_16x16x32_bf16 v[24:27], a[104:107], v[96:99], v[24:27]
    ds_read_b64_tr_b16 v[34:35], v8 offset:8704
    v_mfma_f32_16x16x32_bf16 v[28:31], a[108:111], v[96:99], v[28:31]
    ds_read_b64_tr_b16 v[36:37], v2 offset:8192
    ds_read_b64_tr_b16 v[38:39], v2 offset:8704
    s_waitcnt vmcnt(16)
    v_mfma_f32_16x16x32_bf16 v[16:19], a[112:115], v[100:103], v[16:19]
    s_add_u32 s30, s30, 12288
    buffer_load_dwordx4 v[96:99], v10, s[4:7], s30 offen offset:0
    v_mfma_f32_16x16x32_bf16 v[20:23], a[116:119], v[100:103], v[20:23]
    ds_read_b64_tr_b16 v[40:41], v3 offset:8192
    v_mfma_f32_16x16x32_bf16 v[24:27], a[120:123], v[100:103], v[24:27]
    ds_read_b64_tr_b16 v[42:43], v3 offset:8704
    v_mfma_f32_16x16x32_bf16 v[28:31], a[124:127], v[100:103], v[28:31]
    ds_read_b64_tr_b16 v[44:45], v4 offset:8192
    ds_read_b64_tr_b16 v[46:47], v4 offset:8704
    s_waitcnt vmcnt(16)
    v_mfma_f32_16x16x32_bf16 v[16:19], a[128:131], v[104:107], v[16:19]
    buffer_load_dwordx4 v[100:103], v10, s[4:7], s30 offen offset:1024
    v_mfma_f32_16x16x32_bf16 v[20:23], a[132:135], v[104:107], v[20:23]
    v_mfma_f32_16x16x32_bf16 v[24:27], a[136:139], v[104:107], v[24:27]
    v_mfma_f32_16x16x32_bf16 v[28:31], a[140:143], v[104:107], v[28:31]
    s_waitcnt vmcnt(16)
    s_waitcnt lgkmcnt(0)
    v_mfma_f32_16x16x32_bf16 v[16:19], v[32:35], v[108:111], v[16:19]
    buffer_load_dwordx4 v[104:107], v10, s[4:7], s30 offen offset:2048
    v_mfma_f32_16x16x32_bf16 v[20:23], v[36:39], v[108:111], v[20:23]
    v_mfma_f32_16x16x32_bf16 v[24:27], v[40:43], v[108:111], v[24:27]
    v_mfma_f32_16x16x32_bf16 v[28:31], v[44:47], v[108:111], v[28:31]
    s_waitcnt vmcnt(16)
    v_mfma_f32_16x16x32_bf16 v[16:19], a[144:147], v[112:115], v[16:19]
    buffer_load_dwordx4 v[108:111], v10, s[4:7], s30 offen offset:3072
    v_mfma_f32_16x16x32_bf16 v[20:23], a[148:151], v[112:115], v[20:23]
    ds_read_b64_tr_b16 v[32:33], v8 offset:12288
    v_mfma_f32_16x16x32_bf16 v[24:27], a[152:155], v[112:115], v[24:27]
    ds_read_b64_tr_b16 v[34:35], v8 offset:12800
    v_mfma_f32_16x16x32_bf16 v[28:31], a[156:159], v[112:115], v[28:31]
    ds_read_b64_tr_b16 v[36:37], v2 offset:12288
    ds_read_b64_tr_b16 v[38:39], v2 offset:12800
    s_waitcnt vmcnt(16)
    v_mfma_f32_16x16x32_bf16 v[16:19], a[160:163], v[116:119], v[16:19]
    s_add_u32 s30, s30, 4096
    buffer_load_dwordx4 v[112:115], v10, s[4:7], s30 offen offset:0
    v_mfma_f32_16x16x32_bf16 v[20:23], a[164:167], v[116:119], v[20:23]
    ds_read_b64_tr_b16 v[40:41], v3 offset:12288
    v_mfma_f32_16x16x32_bf16 v[24:27], a[168:171], v[116:119], v[24:27]
    ds_read_b64_tr_b16 v[42:43], v3 offset:12800
    v_mfma_f32_16x16x32_bf16 v[28:31], a[172:175], v[116:119], v[28:31]
    ds_read_b64_tr_b16 v[44:45], v4 offset:12288
    ds_read_b64_tr_b16 v[46:47], v4 offset:12800
    s_waitcnt vmcnt(16)
    v_mfma_f32_16x16x32_bf16 v[16:19], a[176:179], v[120:123], v[16:19]
    buffer_load_dwordx4 v[116:119], v10, s[4:7], s30 offen offset:1024
    v_mfma_f32_16x16x32_bf16 v[20:23], a[180:183], v[120:123], v[20:23]
    v_mfma_f32_16x16x32_bf16 v[24:27], a[184:187], v[120:123], v[24:27]
    v_mfma_f32_16x16x32_bf16 v[28:31], a[188:191], v[120:123], v[28:31]
    s_waitcnt vmcnt(16)
    s_waitcnt lgkmcnt(0)
    v_mfma_f32_16x16x32_bf16 v[16:19], v[32:35], v[124:127], v[16:19]
    buffer_load_dwordx4 v[120:123], v10, s[4:7], s30 offen offset:2048
    v_mfma_f32_16x16x32_bf16 v[20:23], v[36:39], v[124:127], v[20:23]
    v_mfma_f32_16x16x32_bf16 v[24:27], v[40:43], v[124:127], v[24:27]
    v_mfma_f32_16x16x32_bf16 v[28:31], v[44:47], v[124:127], v[28:31]
    s_waitcnt vmcnt(15)
    v_mfma_f32_16x16x32_bf16 v[16:19], a[192:195], v[64:67], v[16:19]
    buffer_load_dwordx4 v[124:127], v10, s[4:7], s30 offen offset:3072
    v_mfma_f32_16x16x32_bf16 v[20:23], a[196:199], v[64:67], v[20:23]
    s_lshr_b32 s17, s33, 3
    v_cmp_ge_u32 vcc, s17, v12
    s_lshl_b32 s18, s33, 2
    s_and_b32 s18, s18, 24
    ds_read_b64_tr_b16 v[32:33], v8 offset:16384
    v_mfma_f32_16x16x32_bf16 v[24:27], a[200:203], v[64:67], v[24:27]
    s_mul_i32 s30, s33, 263168
    s_and_b32 s30, s30, 33300480
    s_xor_b32 s30, s30, s37
    s_lshr_b32 s17, vcc_lo, s18
    s_and_b32 s17, s17, 0xff
    s_cselect_b32 s34, 0, 1
    s_cselect_b32 s30, 1073741824, s30
    ds_read_b64_tr_b16 v[34:35], v8 offset:16896
    v_mfma_f32_16x16x32_bf16 v[28:31], a[204:207], v[64:67], v[28:31]
    ds_read_b64_tr_b16 v[36:37], v2 offset:16384
    ds_read_b64_tr_b16 v[38:39], v2 offset:16896
    s_waitcnt vmcnt(15)
    v_mfma_f32_16x16x32_bf16 v[16:19], a[208:211], v[68:71], v[16:19]
    buffer_load_dwordx4 v[64:67], v10, s[4:7], s30 offen offset:0
    v_mfma_f32_16x16x32_bf16 v[20:23], a[212:215], v[68:71], v[20:23]
    ds_read_b64_tr_b16 v[40:41], v3 offset:16384
    v_mfma_f32_16x16x32_bf16 v[24:27], a[216:219], v[68:71], v[24:27]
    ds_read_b64_tr_b16 v[42:43], v3 offset:16896
    v_mfma_f32_16x16x32_bf16 v[28:31], a[220:223], v[68:71], v[28:31]
    ds_read_b64_tr_b16 v[44:45], v4 offset:16384
    ds_read_b64_tr_b16 v[46:47], v4 offset:16896
    s_waitcnt vmcnt(15)
    v_mfma_f32_16x16x32_bf16 v[16:19], a[224:227], v[72:75], v[16:19]
    buffer_load_dwordx4 v[68:71], v10, s[4:7], s30 offen offset:1024
    v_mfma_f32_16x16x32_bf16 v[20:23], a[228:231], v[72:75], v[20:23]
    v_mfma_f32_16x16x32_bf16 v[24:27], a[232:235], v[72:75], v[24:27]
    v_mfma_f32_16x16x32_bf16 v[28:31], a[236:239], v[72:75], v[28:31]
    s_waitcnt vmcnt(15)
    s_waitcnt lgkmcnt(0)
    v_mfma_f32_16x16x32_bf16 v[16:19], v[32:35], v[76:79], v[16:19]
    buffer_load_dwordx4 v[72:75], v10, s[4:7], s30 offen offset:2048
    v_mfma_f32_16x16x32_bf16 v[20:23], v[36:39], v[76:79], v[20:23]
    v_mfma_f32_16x16x32_bf16 v[24:27], v[40:43], v[76:79], v[24:27]
    v_mfma_f32_16x16x32_bf16 v[28:31], v[44:47], v[76:79], v[28:31]
    s_waitcnt vmcnt(15)
    v_mfma_f32_16x16x32_bf16 v[16:19], a[240:243], v[80:83], v[16:19]
    buffer_load_dwordx4 v[76:79], v10, s[4:7], s30 offen offset:3072
    v_mfma_f32_16x16x32_bf16 v[20:23], a[244:247], v[80:83], v[20:23]
    ds_read_b64_tr_b16 v[32:33], v8 offset:20480
    v_mfma_f32_16x16x32_bf16 v[24:27], a[248:251], v[80:83], v[24:27]
    ds_read_b64_tr_b16 v[34:35], v8 offset:20992
    v_mfma_f32_16x16x32_bf16 v[28:31], a[252:255], v[80:83], v[28:31]
    ds_read_b64_tr_b16 v[36:37], v2 offset:20480
    ds_read_b64_tr_b16 v[38:39], v2 offset:20992
    s_waitcnt vmcnt(15)
    v_mfma_f32_16x16x32_bf16 v[16:19], v[128:131], v[84:87], v[16:19]
    s_add_u32 s30, s30, 4096
    buffer_load_dwordx4 v[80:83], v10, s[4:7], s30 offen offset:0
    v_mfma_f32_16x16x32_bf16 v[20:23], v[132:135], v[84:87], v[20:23]
    ds_read_b64_tr_b16 v[40:41], v3 offset:20480
    v_mfma_f32_16x16x32_bf16 v[24:27], v[136:139], v[84:87], v[24:27]
    ds_read_b64_tr_b16 v[42:43], v3 offset:20992
    v_mfma_f32_16x16x32_bf16 v[28:31], v[140:143], v[84:87], v[28:31]
    ds_read_b64_tr_b16 v[44:45], v4 offset:20480
    ds_read_b64_tr_b16 v[46:47], v4 offset:20992
    s_waitcnt vmcnt(15)
    v_mfma_f32_16x16x32_bf16 v[16:19], v[144:147], v[88:91], v[16:19]
    buffer_load_dwordx4 v[84:87], v10, s[4:7], s30 offen offset:1024
    v_mfma_f32_16x16x32_bf16 v[20:23], v[148:151], v[88:91], v[20:23]
    v_mfma_f32_16x16x32_bf16 v[24:27], v[152:155], v[88:91], v[24:27]
    v_mfma_f32_16x16x32_bf16 v[28:31], v[156:159], v[88:91], v[28:31]
    s_waitcnt vmcnt(15)
    s_waitcnt lgkmcnt(0)
    v_mfma_f32_16x16x32_bf16 v[16:19], v[32:35], v[92:95], v[16:19]
    buffer_load_dwordx4 v[88:91], v10, s[4:7], s30 offen offset:2048
    v_mfma_f32_16x16x32_bf16 v[20:23], v[36:39], v[92:95], v[20:23]
    v_mfma_f32_16x16x32_bf16 v[24:27], v[40:43], v[92:95], v[24:27]
    v_mfma_f32_16x16x32_bf16 v[28:31], v[44:47], v[92:95], v[28:31]
    s_waitcnt vmcnt(14)
    v_mfma_f32_16x16x32_bf16 v[16:19], v[160:163], v[96:99], v[16:19]
    buffer_load_dwordx4 v[92:95], v10, s[4:7], s30 offen offset:3072
    v_mfma_f32_16x16x32_bf16 v[20:23], v[164:167], v[96:99], v[20:23]
    ds_read_b64_tr_b16 v[32:33], v8 offset:24576
    v_mfma_f32_16x16x32_bf16 v[24:27], v[168:171], v[96:99], v[24:27]
    ds_read_b64_tr_b16 v[34:35], v8 offset:25088
    v_mfma_f32_16x16x32_bf16 v[28:31], v[172:175], v[96:99], v[28:31]
    ds_read_b64_tr_b16 v[36:37], v2 offset:24576
    ds_read_b64_tr_b16 v[38:39], v2 offset:25088
    s_waitcnt vmcnt(14)
    v_mfma_f32_16x16x32_bf16 v[16:19], v[176:179], v[100:103], v[16:19]
    s_add_u32 s30, s30, 12288
    buffer_load_dwordx4 v[96:99], v10, s[4:7], s30 offen offset:0
    v_mfma_f32_16x16x32_bf16 v[20:23], v[180:183], v[100:103], v[20:23]
    ds_read_b64_tr_b16 v[40:41], v3 offset:24576
    v_mfma_f32_16x16x32_bf16 v[24:27], v[184:187], v[100:103], v[24:27]
    ds_read_b64_tr_b16 v[42:43], v3 offset:25088
    v_mfma_f32_16x16x32_bf16 v[28:31], v[188:191], v[100:103], v[28:31]
    ds_read_b64_tr_b16 v[44:45], v4 offset:24576
    ds_read_b64_tr_b16 v[46:47], v4 offset:25088
    s_waitcnt vmcnt(14)
    v_mfma_f32_16x16x32_bf16 v[16:19], v[192:195], v[104:107], v[16:19]
    buffer_load_dwordx4 v[100:103], v10, s[4:7], s30 offen offset:1024
    v_mfma_f32_16x16x32_bf16 v[20:23], v[196:199], v[104:107], v[20:23]
    v_mfma_f32_16x16x32_bf16 v[24:27], v[200:203], v[104:107], v[24:27]
    v_mfma_f32_16x16x32_bf16 v[28:31], v[204:207], v[104:107], v[28:31]
    s_waitcnt vmcnt(14)
    s_waitcnt lgkmcnt(0)
    v_mfma_f32_16x16x32_bf16 v[16:19], v[32:35], v[108:111], v[16:19]
    buffer_load_dwordx4 v[104:107], v10, s[4:7], s30 offen offset:2048
    v_mfma_f32_16x16x32_bf16 v[20:23], v[36:39], v[108:111], v[20:23]
    v_mfma_f32_16x16x32_bf16 v[24:27], v[40:43], v[108:111], v[24:27]
    v_mfma_f32_16x16x32_bf16 v[28:31], v[44:47], v[108:111], v[28:31]
    s_waitcnt vmcnt(14)
    v_mfma_f32_16x16x32_bf16 v[16:19], v[208:211], v[112:115], v[16:19]
    buffer_load_dwordx4 v[108:111], v10, s[4:7], s30 offen offset:3072
    v_mfma_f32_16x16x32_bf16 v[20:23], v[212:215], v[112:115], v[20:23]
    ds_read_b64_tr_b16 v[32:33], v8 offset:28672
    v_mfma_f32_16x16x32_bf16 v[24:27], v[216:219], v[112:115], v[24:27]
    ds_read_b64_tr_b16 v[34:35], v8 offset:29184
    v_mfma_f32_16x16x32_bf16 v[28:31], v[220:223], v[112:115], v[28:31]
    ds_read_b64_tr_b16 v[36:37], v2 offset:28672
    ds_read_b64_tr_b16 v[38:39], v2 offset:29184
    s_waitcnt vmcnt(14)
    v_mfma_f32_16x16x32_bf16 v[16:19], v[224:227], v[116:119], v[16:19]
    s_add_u32 s30, s30, 4096
    buffer_load_dwordx4 v[112:115], v10, s[4:7], s30 offen offset:0
    v_mfma_f32_16x16x32_bf16 v[20:23], v[228:231], v[116:119], v[20:23]
    ds_read_b64_tr_b16 v[40:41], v3 offset:28672
    v_mfma_f32_16x16x32_bf16 v[24:27], v[232:235], v[116:119], v[24:27]
    ds_read_b64_tr_b16 v[42:43], v3 offset:29184
    v_mfma_f32_16x16x32_bf16 v[28:31], v[236:239], v[116:119], v[28:31]
    ds_read_b64_tr_b16 v[44:45], v4 offset:28672
    ds_read_b64_tr_b16 v[46:47], v4 offset:29184
    s_waitcnt vmcnt(14)
    v_mfma_f32_16x16x32_bf16 v[16:19], v[240:243], v[120:123], v[16:19]
    buffer_load_dwordx4 v[116:119], v10, s[4:7], s30 offen offset:1024
    v_mfma_f32_16x16x32_bf16 v[20:23], v[244:247], v[120:123], v[20:23]
    v_mfma_f32_16x16x32_bf16 v[24:27], v[248:251], v[120:123], v[24:27]
    v_mfma_f32_16x16x32_bf16 v[28:31], v[252:255], v[120:123], v[28:31]
    s_waitcnt vmcnt(14)
    s_waitcnt lgkmcnt(0)
    v_mfma_f32_16x16x32_bf16 v[16:19], v[32:35], v[124:127], v[16:19]
    buffer_load_dwordx4 v[120:123], v10, s[4:7], s30 offen offset:2048
    v_mfma_f32_16x16x32_bf16 v[20:23], v[36:39], v[124:127], v[20:23]
    v_mfma_f32_16x16x32_bf16 v[24:27], v[40:43], v[124:127], v[24:27]
    v_mfma_f32_16x16x32_bf16 v[28:31], v[44:47], v[124:127], v[28:31]
    s_lshl_b32 s31, s28, 16
    s_mov_b32 s28, s33
    s_cmp_eq_u32 s34, 1
    ds_write_b128 v14, v[16:19] offset:0
    ds_write_b128 v14, v[20:23] offset:4096
    ds_write_b128 v14, v[24:27] offset:8192
    s_nop 1
    ds_write_b128 v14, v[28:31] offset:12288
    v_xor_b32 v14, 0x4000, v14
    s_cbranch_scc1 U_item
    s_waitcnt lgkmcnt(0)
    s_barrier
    ds_read_b128 v[48:51], v15 offset:0
    ds_read_b128 v[52:55], v15 offset:1024
    ds_read_b128 v[56:59], v15 offset:2048
    ds_read_b128 v[60:63], v15 offset:3072
    s_waitcnt lgkmcnt(0)
    v_add_f32 v48, v48, v52
    v_add_f32 v49, v49, v53
    v_add_f32 v50, v50, v54
    v_add_f32 v51, v51, v55
    v_add_f32 v56, v56, v60
    v_add_f32 v57, v57, v61
    v_add_f32 v58, v58, v62
    v_add_f32 v59, v59, v63
    v_add_f32 v48, v48, v56
    v_add_f32 v49, v49, v57
    v_add_f32 v50, v50, v58
    v_add_f32 v51, v51, v59
    v_cvt_pk_bf16_f32 v52, v48, v49
    v_cvt_pk_bf16_f32 v53, v50, v51
    buffer_store_dwordx2 v[52:53], v13, s[12:15], s31 offen
    s_cmp_lt_u32 s28, 128
    s_cbranch_scc1 U_wait
    s_branch W_fin
W_F:
    s_waitcnt vmcnt(0)
    s_barrier
    s_cmp_lg_u32 s16, 0
    s_cbranch_scc1 reg_18
    s_and_b32 s17, s2, 3
    s_lshl_b32 s17, s17, 3
    s_lshl_b32 s18, s98, 2
    s_add_u32 s17, s17, s18
    s_lshl_b32 s17, 1, s17
    s_andn2_b32 s18, s2, 3
    v_mov_b32 v5, s18
    v_mov_b32 v6, s17
    s_mov_b64 exec, 1
    global_atomic_add v5, v6, s[100:101] sc1
    s_mov_b64 exec, -1
reg_18:
    s_load_dwordx2 s[48:49], s[0:1], 8
    s_load_dwordx2 s[52:53], s[0:1], 16
    s_mov_b32 s50, 2101248
    s_mov_b32 s51, 0x20000
    s_mov_b32 s54, 2101248
    s_mov_b32 s55, 0x20000
    s_load_dwordx2 s[40:41], s[0:1], 0
    s_load_dwordx2 s[44:45], s[0:1], 24
    s_mov_b32 s42, 4194304
    s_mov_b32 s43, 0x20000
    s_mov_b32 s46, 4194304
    s_mov_b32 s47, 0x20000
    s_lshr_b32 s28, s93, 3
    s_and_b32 s29, s93, 7
    s_lshl_b32 s29, s29, 2
    s_add_u32 s29, s29, s16
    v_bfe_u32 v5, v1, 2, 2
    v_and_b32 v7, 3, v1
    v_lshl_add_u32 v7, v5, 3, v7
    s_lshl_b32 s17, s29, 5
    v_add_u32 v7, s17, v7
    v_lshrrev_b32 v8, 4, v1
    v_cvt_f32_u32 v8, v8
    s_mov_b32 s31, 981467136
    v_add_u32 v5, 0, v7
    v_lshrrev_b32 v6, 1, v5
    v_and_b32 v30, 1, v5
    v_cmp_eq_u32 vcc, 1, v5
    v_mov_b32 v5, 512
    s_nop 0
    v_cndmask_b32 v6, v6, v5, vcc
    v_cndmask_b32 v30, v30, 0, vcc
    v_add_u32 v5, v6, v30
    v_bfe_i32 v40, v5, 1, 1
    v_add_u32 v5, v6, v5
    v_bfe_i32 v42, v5, 1, 1
    v_add_u32 v5, v6, v5
    v_bfe_i32 v44, v5, 1, 1
    v_and_b32 v40, 0x80008000, v40
    v_and_b32 v42, 0x80008000, v42
    v_and_b32 v44, 0x80008000, v44
    v_cvt_f32_u32 v6, v6
    v_cvt_f32_u32 v30, v30
    v_mul_f32 v32, s31, v6
    v_mul_f32 v30, 0x3e800000, v30
    v_mov_b32 v34, v32
    v_mul_f32 v36, 0x42000000, v32
    v_mul_f32 v5, 0x41000000, v32
    v_fma_f32 v30, v5, v8, v30
    v_add_u32 v5, 4, v7
    v_lshrrev_b32 v6, 1, v5
    v_and_b32 v31, 1, v5
    v_cmp_eq_u32 vcc, 1, v5
    v_mov_b32 v5, 512
    s_nop 0
    v_cndmask_b32 v6, v6, v5, vcc
    v_cndmask_b32 v31, v31, 0, vcc
    v_add_u32 v5, v6, v31
    v_bfe_i32 v41, v5, 1, 1
    v_add_u32 v5, v6, v5
    v_bfe_i32 v43, v5, 1, 1
    v_add_u32 v5, v6, v5
    v_bfe_i32 v45, v5, 1, 1
    v_and_b32 v41, 0x80008000, v41
    v_and_b32 v43, 0x80008000, v43
    v_and_b32 v45, 0x80008000, v45
    v_cvt_f32_u32 v6, v6
    v_cvt_f32_u32 v31, v31
    v_mul_f32 v33, s31, v6
    v_mul_f32 v31, 0x3e800000, v31
    v_mov_b32 v35, v33
    v_mul_f32 v37, 0x42000000, v33
    v_mul_f32 v5, 0x41000000, v33
    v_fma_f32 v31, v5, v8, v31
    v_fract_f32 v48, v30
    v_add_f32 v49, v48, v32
    v_cos_f32 v56, v48
    v_add_f32 v50, v49, v34
    v_cos_f32 v57, v49
    v_add_f32 v51, v50, v32
    v_cos_f32 v58, v50
    v_add_f32 v52, v51, v34
    v_cos_f32 v59, v51
    v_add_f32 v53, v52, v32
    v_cos_f32 v60, v52
    v_add_f32 v54, v53, v34
    v_cos_f32 v61, v53
    v_add_f32 v55, v54, v32
    v_cos_f32 v62, v54
    v_cos_f32 v63, v55
    v_add_f32 v30, v48, v36
    v_cvt_pk_bf16_f32 v64, v56, v57
    v_cvt_pk_bf16_f32 v65, v58, v59
    v_cvt_pk_bf16_f32 v66, v60, v61
    v_cvt_pk_bf16_f32 v67, v62, v63
    v_accvgpr_write_b32 a0, v64
    v_accvgpr_write_b32 a1, v65
    v_accvgpr_write_b32 a2, v66
    v_accvgpr_write_b32 a3, v67
    v_xor_b32_dpp v68, v64, v40 quad_perm:[0,1,3,2] row_mask:0xf bank_mask:0xf
    v_xor_b32_dpp v69, v65, v40 quad_perm:[0,1,3,2] row_mask:0xf bank_mask:0xf
    v_xor_b32_dpp v70, v66, v40 quad_perm:[0,1,3,2] row_mask:0xf bank_mask:0xf
    v_xor_b32_dpp v71, v67, v40 quad_perm:[0,1,3,2] row_mask:0xf bank_mask:0xf
    v_accvgpr_write_b32 a64, v68
    v_accvgpr_write_b32 a65, v69
    v_accvgpr_write_b32 a66, v70
    v_accvgpr_write_b32 a67, v71
    v_xor_b32 v68, v64, v42
    v_xor_b32 v69, v65, v42
    v_xor_b32 v70, v66, v42
    v_xor_b32 v71, v67, v42
    v_accvgpr_write_b32 a128, v68
    v_accvgpr_write_b32 a129, v69
    v_accvgpr_write_b32 a130, v70
    v_accvgpr_write_b32 a131, v71
    v_xor_b32_dpp v68, v64, v44 quad_perm:[0,1,3,2] row_mask:0xf bank_mask:0xf
    v_xor_b32_dpp v69, v65, v44 quad_perm:[0,1,3,2] row_mask:0xf bank_mask:0xf
    v_xor_b32_dpp v70, v66, v44 quad_perm:[0,1,3,2] row_mask:0xf bank_mask:0xf
    v_xor_b32_dpp v71, v67, v44 quad_perm:[0,1,3,2] row_mask:0xf bank_mask:0xf
    v_accvgpr_write_b32 a192, v68
    v_accvgpr_write_b32 a193, v69
    v_accvgpr_write_b32 a194, v70
    v_accvgpr_write_b32 a195, v71
    v_fract_f32 v48, v31
    v_add_f32 v49, v48, v33
    v_cos_f32 v56, v48
    v_add_f32 v50, v49, v35
    v_cos_f32 v57, v49
    v_add_f32 v51, v50, v33
    v_cos_f32 v58, v50
    v_add_f32 v52, v51, v35
    v_cos_f32 v59, v51
    v_add_f32 v53, v52, v33
    v_cos_f32 v60, v52
    v_add_f32 v54, v53, v35
    v_cos_f32 v61, v53
    v_add_f32 v55, v54, v33
    v_cos_f32 v62, v54
    v_cos_f32 v63, v55
    v_add_f32 v31, v48, v37
    v_cvt_pk_bf16_f32 v64, v56, v57
    v_cvt_pk_bf16_f32 v65, v58, v59
    v_cvt_pk_bf16_f32 v66, v60, v61
    v_cvt_pk_bf16_f32 v67, v62, v63
    v_accvgpr_write_b32 a4, v64
    v_accvgpr_write_b32 a5, v65
    v_accvgpr_write_b32 a6, v66
    v_accvgpr_write_b32 a7, v67
    v_xor_b32_dpp v68, v64, v41 quad_perm:[0,1,3,2] row_mask:0xf bank_mask:0xf
    v_xor_b32_dpp v69, v65, v41 quad_perm:[0,1,3,2] row_mask:0xf bank_mask:0xf
    v_xor_b32_dpp v70, v66, v41 quad_perm:[0,1,3,2] row_mask:0xf bank_mask:0xf
    v_xor_b32_dpp v71, v67, v41 quad_perm:[0,1,3,2] row_mask:0xf bank_mask:0xf
    v_accvgpr_write_b32 a68, v68
    v_accvgpr_write_b32 a69, v69
    v_accvgpr_write_b32 a70, v70
    v_accvgpr_write_b32 a71, v71
    v_xor_b32 v68, v64, v43
    v_xor_b32 v69, v65, v43
    v_xor_b32 v70, v66, v43
    v_xor_b32 v71, v67, v43
    v_accvgpr_write_b32 a132, v68
    v_accvgpr_write_b32 a133, v69
    v_accvgpr_write_b32 a134, v70
    v_accvgpr_write_b32 a135, v71
    v_xor_b32_dpp v68, v64, v45 quad_perm:[0,1,3,2] row_mask:0xf bank_mask:0xf
    v_xor_b32_dpp v69, v65, v45 quad_perm:[0,1,3,2] row_mask:0xf bank_mask:0xf
    v_xor_b32_dpp v70, v66, v45 quad_perm:[0,1,3,2] row_mask:0xf bank_mask:0xf
    v_xor_b32_dpp v71, v67, v45 quad_perm:[0,1,3,2] row_mask:0xf bank_mask:0xf
    v_accvgpr_write_b32 a196, v68
    v_accvgpr_write_b32 a197, v69
    v_accvgpr_write_b32 a198, v70
    v_accvgpr_write_b32 a199, v71
    v_fract_f32 v48, v30
    v_add_f32 v49, v48, v32
    v_cos_f32 v56, v48
    v_add_f32 v50, v49, v34
    v_cos_f32 v57, v49
    v_add_f32 v51, v50, v32
    v_cos_f32 v58, v50
    v_add_f32 v52, v51, v34
    v_cos_f32 v59, v51
    v_add_f32 v53, v52, v32
    v_cos_f32 v60, v52
    v_add_f32 v54, v53, v34
    v_cos_f32 v61, v53
    v_add_f32 v55, v54, v32
    v_cos_f32 v62, v54
    v_cos_f32 v63, v55
    v_add_f32 v30, v48, v36
    v_cvt_pk_bf16_f32 v64, v56, v57
    v_cvt_pk_bf16_f32 v65, v58, v59
    v_cvt_pk_bf16_f32 v66, v60, v61
    v_cvt_pk_bf16_f32 v67, v62, v63
    v_accvgpr_write_b32 a8, v64
    v_accvgpr_write_b32 a9, v65
    v_accvgpr_write_b32 a10, v66
    v_accvgpr_write_b32 a11, v67
    v_xor_b32_dpp v68, v64, v40 quad_perm:[0,1,3,2] row_mask:0xf bank_mask:0xf
    v_xor_b32_dpp v69, v65, v40 quad_perm:[0,1,3,2] row_mask:0xf bank_mask:0xf
    v_xor_b32_dpp v70, v66, v40 quad_perm:[0,1,3,2] row_mask:0xf bank_mask:0xf
    v_xor_b32_dpp v71, v67, v40 quad_perm:[0,1,3,2] row_mask:0xf bank_mask:0xf
    v_accvgpr_write_b32 a72, v68
    v_accvgpr_write_b32 a73, v69
    v_accvgpr_write_b32 a74, v70
    v_accvgpr_write_b32 a75, v71
    v_xor_b32 v68, v64, v42
    v_xor_b32 v69, v65, v42
    v_xor_b32 v70, v66, v42
    v_xor_b32 v71, v67, v42
    v_accvgpr_write_b32 a136, v68
    v_accvgpr_write_b32 a137, v69
    v_accvgpr_write_b32 a138, v70
    v_accvgpr_write_b32 a139, v71
    v_xor_b32_dpp v68, v64, v44 quad_perm:[0,1,3,2] row_mask:0xf bank_mask:0xf
    v_xor_b32_dpp v69, v65, v44 quad_perm:[0,1,3,2] row_mask:0xf bank_mask:0xf
    v_xor_b32_dpp v70, v66, v44 quad_perm:[0,1,3,2] row_mask:0xf bank_mask:0xf
    v_xor_b32_dpp v71, v67, v44 quad_perm:[0,1,3,2] row_mask:0xf bank_mask:0xf
    v_accvgpr_write_b32 a200, v68
    v_accvgpr_write_b32 a201, v69
    v_accvgpr_write_b32 a202, v70
    v_accvgpr_write_b32 a203, v71
    v_fract_f32 v48, v31
    v_add_f32 v49, v48, v33
    v_cos_f32 v56, v48
    v_add_f32 v50, v49, v35
    v_cos_f32 v57, v49
    v_add_f32 v51, v50, v33
    v_cos_f32 v58, v50
    v_add_f32 v52, v51, v35
    v_cos_f32 v59, v51
    v_add_f32 v53, v52, v33
    v_cos_f32 v60, v52
    v_add_f32 v54, v53, v35
    v_cos_f32 v61, v53
    v_add_f32 v55, v54, v33
    v_cos_f32 v62, v54
    v_cos_f32 v63, v55
    v_add_f32 v31, v48, v37
    v_cvt_pk_bf16_f32 v64, v56, v57
    v_cvt_pk_bf16_f32 v65, v58, v59
    v_cvt_pk_bf16_f32 v66, v60, v61
    v_cvt_pk_bf16_f32 v67, v62, v63
    v_accvgpr_write_b32 a12, v64
    v_accvgpr_write_b32 a13, v65
    v_accvgpr_write_b32 a14, v66
    v_accvgpr_write_b32 a15, v67
    v_xor_b32_dpp v68, v64, v41 quad_perm:[0,1,3,2] row_mask:0xf bank_mask:0xf
    v_xor_b32_dpp v69, v65, v41 quad_perm:[0,1,3,2] row_mask:0xf bank_mask:0xf
    v_xor_b32_dpp v70, v66, v41 quad_perm:[0,1,3,2] row_mask:0xf bank_mask:0xf
    v_xor_b32_dpp v71, v67, v41 quad_perm:[0,1,3,2] row_mask:0xf bank_mask:0xf
    v_accvgpr_write_b32 a76, v68
    v_accvgpr_write_b32 a77, v69
    v_accvgpr_write_b32 a78, v70
    v_accvgpr_write_b32 a79, v71
    v_xor_b32 v68, v64, v43
    v_xor_b32 v69, v65, v43
    v_xor_b32 v70, v66, v43
    v_xor_b32 v71, v67, v43
    v_accvgpr_write_b32 a140, v68
    v_accvgpr_write_b32 a141, v69
    v_accvgpr_write_b32 a142, v70
    v_accvgpr_write_b32 a143, v71
    v_xor_b32_dpp v68, v64, v45 quad_perm:[0,1,3,2] row_mask:0xf bank_mask:0xf
    v_xor_b32_dpp v69, v65, v45 quad_perm:[0,1,3,2] row_mask:0xf bank_mask:0xf
    v_xor_b32_dpp v70, v66, v45 quad_perm:[0,1,3,2] row_mask:0xf bank_mask:0xf
    v_xor_b32_dpp v71, v67, v45 quad_perm:[0,1,3,2] row_mask:0xf bank_mask:0xf
    v_accvgpr_write_b32 a204, v68
    v_accvgpr_write_b32 a205, v69
    v_accvgpr_write_b32 a206, v70
    v_accvgpr_write_b32 a207, v71
    v_fract_f32 v48, v30
    v_add_f32 v49, v48, v32
    v_cos_f32 v56, v48
    v_add_f32 v50, v49, v34
    v_cos_f32 v57, v49
    v_add_f32 v51, v50, v32
    v_cos_f32 v58, v50
    v_add_f32 v52, v51, v34
    v_cos_f32 v59, v51
    v_add_f32 v53, v52, v32
    v_cos_f32 v60, v52
    v_add_f32 v54, v53, v34
    v_cos_f32 v61, v53
    v_add_f32 v55, v54, v32
    v_cos_f32 v62, v54
    v_cos_f32 v63, v55
    v_add_f32 v30, v48, v36
    v_cvt_pk_bf16_f32 v64, v56, v57
    v_cvt_pk_bf16_f32 v65, v58, v59
    v_cvt_pk_bf16_f32 v66, v60, v61
    v_cvt_pk_bf16_f32 v67, v62, v63
    v_accvgpr_write_b32 a16, v64
    v_accvgpr_write_b32 a17, v65
    v_accvgpr_write_b32 a18, v66
    v_accvgpr_write_b32 a19, v67
    v_xor_b32_dpp v68, v64, v40 quad_perm:[0,1,3,2] row_mask:0xf bank_mask:0xf
    v_xor_b32_dpp v69, v65, v40 quad_perm:[0,1,3,2] row_mask:0xf bank_mask:0xf
    v_xor_b32_dpp v70, v66, v40 quad_perm:[0,1,3,2] row_mask:0xf bank_mask:0xf
    v_xor_b32_dpp v71, v67, v40 quad_perm:[0,1,3,2] row_mask:0xf bank_mask:0xf
    v_accvgpr_write_b32 a80, v68
    v_accvgpr_write_b32 a81, v69
    v_accvgpr_write_b32 a82, v70
    v_accvgpr_write_b32 a83, v71
    v_xor_b32 v68, v64, v42
    v_xor_b32 v69, v65, v42
    v_xor_b32 v70, v66, v42
    v_xor_b32 v71, v67, v42
    v_accvgpr_write_b32 a144, v68
    v_accvgpr_write_b32 a145, v69
    v_accvgpr_write_b32 a146, v70
    v_accvgpr_write_b32 a147, v71
    v_xor_b32_dpp v68, v64, v44 quad_perm:[0,1,3,2] row_mask:0xf bank_mask:0xf
    v_xor_b32_dpp v69, v65, v44 quad_perm:[0,1,3,2] row_mask:0xf bank_mask:0xf
    v_xor_b32_dpp v70, v66, v44 quad_perm:[0,1,3,2] row_mask:0xf bank_mask:0xf
    v_xor_b32_dpp v71, v67, v44 quad_perm:[0,1,3,2] row_mask:0xf bank_mask:0xf
    v_accvgpr_write_b32 a208, v68
    v_accvgpr_write_b32 a209, v69
    v_accvgpr_write_b32 a210, v70
    v_accvgpr_write_b32 a211, v71
    v_fract_f32 v48, v31
    v_add_f32 v49, v48, v33
    v_cos_f32 v56, v48
    v_add_f32 v50, v49, v35
    v_cos_f32 v57, v49
    v_add_f32 v51, v50, v33
    v_cos_f32 v58, v50
    v_add_f32 v52, v51, v35
    v_cos_f32 v59, v51
    v_add_f32 v53, v52, v33
    v_cos_f32 v60, v52
    v_add_f32 v54, v53, v35
    v_cos_f32 v61, v53
    v_add_f32 v55, v54, v33
    v_cos_f32 v62, v54
    v_cos_f32 v63, v55
    v_add_f32 v31, v48, v37
    v_cvt_pk_bf16_f32 v64, v56, v57
    v_cvt_pk_bf16_f32 v65, v58, v59
    v_cvt_pk_bf16_f32 v66, v60, v61
    v_cvt_pk_bf16_f32 v67, v62, v63
    v_accvgpr_write_b32 a20, v64
    v_accvgpr_write_b32 a21, v65
    v_accvgpr_write_b32 a22, v66
    v_accvgpr_write_b32 a23, v67
    v_xor_b32_dpp v68, v64, v41 quad_perm:[0,1,3,2] row_mask:0xf bank_mask:0xf
    v_xor_b32_dpp v69, v65, v41 quad_perm:[0,1,3,2] row_mask:0xf bank_mask:0xf
    v_xor_b32_dpp v70, v66, v41 quad_perm:[0,1,3,2] row_mask:0xf bank_mask:0xf
    v_xor_b32_dpp v71, v67, v41 quad_perm:[0,1,3,2] row_mask:0xf bank_mask:0xf
    v_accvgpr_write_b32 a84, v68
    v_accvgpr_write_b32 a85, v69
    v_accvgpr_write_b32 a86, v70
    v_accvgpr_write_b32 a87, v71
    v_xor_b32 v68, v64, v43
    v_xor_b32 v69, v65, v43
    v_xor_b32 v70, v66, v43
    v_xor_b32 v71, v67, v43
    v_accvgpr_write_b32 a148, v68
    v_accvgpr_write_b32 a149, v69
    v_accvgpr_write_b32 a150, v70
    v_accvgpr_write_b32 a151, v71
    v_xor_b32_dpp v68, v64, v45 quad_perm:[0,1,3,2] row_mask:0xf bank_mask:0xf
    v_xor_b32_dpp v69, v65, v45 quad_perm:[0,1,3,2] row_mask:0xf bank_mask:0xf
    v_xor_b32_dpp v70, v66, v45 quad_perm:[0,1,3,2] row_mask:0xf bank_mask:0xf
    v_xor_b32_dpp v71, v67, v45 quad_perm:[0,1,3,2] row_mask:0xf bank_mask:0xf
    v_accvgpr_write_b32 a212, v68
    v_accvgpr_write_b32 a213, v69
    v_accvgpr_write_b32 a214, v70
    v_accvgpr_write_b32 a215, v71
    v_fract_f32 v48, v30
    v_add_f32 v49, v48, v32
    v_cos_f32 v56, v48
    v_add_f32 v50, v49, v34
    v_cos_f32 v57, v49
    v_add_f32 v51, v50, v32
    v_cos_f32 v58, v50
    v_add_f32 v52, v51, v34
    v_cos_f32 v59, v51
    v_add_f32 v53, v52, v32
    v_cos_f32 v60, v52
    v_add_f32 v54, v53, v34
    v_cos_f32 v61, v53
    v_add_f32 v55, v54, v32
    v_cos_f32 v62, v54
    v_cos_f32 v63, v55
    v_add_f32 v30, v48, v36
    v_cvt_pk_bf16_f32 v64, v56, v57
    v_cvt_pk_bf16_f32 v65, v58, v59
    v_cvt_pk_bf16_f32 v66, v60, v61
    v_cvt_pk_bf16_f32 v67, v62, v63
    v_accvgpr_write_b32 a24, v64
    v_accvgpr_write_b32 a25, v65
    v_accvgpr_write_b32 a26, v66
    v_accvgpr_write_b32 a27, v67
    v_xor_b32_dpp v68, v64, v40 quad_perm:[0,1,3,2] row_mask:0xf bank_mask:0xf
    v_xor_b32_dpp v69, v65, v40 quad_perm:[0,1,3,2] row_mask:0xf bank_mask:0xf
    v_xor_b32_dpp v70, v66, v40 quad_perm:[0,1,3,2] row_mask:0xf bank_mask:0xf
    v_xor_b32_dpp v71, v67, v40 quad_perm:[0,1,3,2] row_mask:0xf bank_mask:0xf
    v_accvgpr_write_b32 a88, v68
    v_accvgpr_write_b32 a89, v69
    v_accvgpr_write_b32 a90, v70
    v_accvgpr_write_b32 a91, v71
    v_xor_b32 v68, v64, v42
    v_xor_b32 v69, v65, v42
    v_xor_b32 v70, v66, v42
    v_xor_b32 v71, v67, v42
    v_accvgpr_write_b32 a152, v68
    v_accvgpr_write_b32 a153, v69
    v_accvgpr_write_b32 a154, v70
    v_accvgpr_write_b32 a155, v71
    v_xor_b32_dpp v68, v64, v44 quad_perm:[0,1,3,2] row_mask:0xf bank_mask:0xf
    v_xor_b32_dpp v69, v65, v44 quad_perm:[0,1,3,2] row_mask:0xf bank_mask:0xf
    v_xor_b32_dpp v70, v66, v44 quad_perm:[0,1,3,2] row_mask:0xf bank_mask:0xf
    v_xor_b32_dpp v71, v67, v44 quad_perm:[0,1,3,2] row_mask:0xf bank_mask:0xf
    v_accvgpr_write_b32 a216, v68
    v_accvgpr_write_b32 a217, v69
    v_accvgpr_write_b32 a218, v70
    v_accvgpr_write_b32 a219, v71
    v_fract_f32 v48, v31
    v_add_f32 v49, v48, v33
    v_cos_f32 v56, v48
    v_add_f32 v50, v49, v35
    v_cos_f32 v57, v49
    v_add_f32 v51, v50, v33
    v_cos_f32 v58, v50
    v_add_f32 v52, v51, v35
    v_cos_f32 v59, v51
    v_add_f32 v53, v52, v33
    v_cos_f32 v60, v52
    v_add_f32 v54, v53, v35
    v_cos_f32 v61, v53
    v_add_f32 v55, v54, v33
    v_cos_f32 v62, v54
    v_cos_f32 v63, v55
    v_add_f32 v31, v48, v37
    v_cvt_pk_bf16_f32 v64, v56, v57
    v_cvt_pk_bf16_f32 v65, v58, v59
    v_cvt_pk_bf16_f32 v66, v60, v61
    v_cvt_pk_bf16_f32 v67, v62, v63
    v_accvgpr_write_b32 a28, v64
    v_accvgpr_write_b32 a29, v65
    v_accvgpr_write_b32 a30, v66
    v_accvgpr_write_b32 a31, v67
    v_xor_b32_dpp v68, v64, v41 quad_perm:[0,1,3,2] row_mask:0xf bank_mask:0xf
    v_xor_b32_dpp v69, v65, v41 quad_perm:[0,1,3,2] row_mask:0xf bank_mask:0xf
    v_xor_b32_dpp v70, v66, v41 quad_perm:[0,1,3,2] row_mask:0xf bank_mask:0xf
    v_xor_b32_dpp v71, v67, v41 quad_perm:[0,1,3,2] row_mask:0xf bank_mask:0xf
    v_accvgpr_write_b32 a92, v68
    v_accvgpr_write_b32 a93, v69
    v_accvgpr_write_b32 a94, v70
    v_accvgpr_write_b32 a95, v71
    v_xor_b32 v68, v64, v43
    v_xor_b32 v69, v65, v43
    v_xor_b32 v70, v66, v43
    v_xor_b32 v71, v67, v43
    v_accvgpr_write_b32 a156, v68
    v_accvgpr_write_b32 a157, v69
    v_accvgpr_write_b32 a158, v70
    v_accvgpr_write_b32 a159, v71
    v_xor_b32_dpp v68, v64, v45 quad_perm:[0,1,3,2] row_mask:0xf bank_mask:0xf
    v_xor_b32_dpp v69, v65, v45 quad_perm:[0,1,3,2] row_mask:0xf bank_mask:0xf
    v_xor_b32_dpp v70, v66, v45 quad_perm:[0,1,3,2] row_mask:0xf bank_mask:0xf
    v_xor_b32_dpp v71, v67, v45 quad_perm:[0,1,3,2] row_mask:0xf bank_mask:0xf
    v_accvgpr_write_b32 a220, v68
    v_accvgpr_write_b32 a221, v69
    v_accvgpr_write_b32 a222, v70
    v_accvgpr_write_b32 a223, v71
    v_fract_f32 v48, v30
    v_add_f32 v49, v48, v32
    v_cos_f32 v56, v48
    v_add_f32 v50, v49, v34
    v_cos_f32 v57, v49
    v_add_f32 v51, v50, v32
    v_cos_f32 v58, v50
    v_add_f32 v52, v51, v34
    v_cos_f32 v59, v51
    v_add_f32 v53, v52, v32
    v_cos_f32 v60, v52
    v_add_f32 v54, v53, v34
    v_cos_f32 v61, v53
    v_add_f32 v55, v54, v32
    v_cos_f32 v62, v54
    v_cos_f32 v63, v55
    v_add_f32 v30, v48, v36
    v_cvt_pk_bf16_f32 v64, v56, v57
    v_cvt_pk_bf16_f32 v65, v58, v59
    v_cvt_pk_bf16_f32 v66, v60, v61
    v_cvt_pk_bf16_f32 v67, v62, v63
    v_accvgpr_write_b32 a32, v64
    v_accvgpr_write_b32 a33, v65
    v_accvgpr_write_b32 a34, v66
    v_accvgpr_write_b32 a35, v67
    v_xor_b32_dpp v68, v64, v40 quad_perm:[0,1,3,2] row_mask:0xf bank_mask:0xf
    v_xor_b32_dpp v69, v65, v40 quad_perm:[0,1,3,2] row_mask:0xf bank_mask:0xf
    v_xor_b32_dpp v70, v66, v40 quad_perm:[0,1,3,2] row_mask:0xf bank_mask:0xf
    v_xor_b32_dpp v71, v67, v40 quad_perm:[0,1,3,2] row_mask:0xf bank_mask:0xf
    v_accvgpr_write_b32 a96, v68
    v_accvgpr_write_b32 a97, v69
    v_accvgpr_write_b32 a98, v70
    v_accvgpr_write_b32 a99, v71
    v_xor_b32 v68, v64, v42
    v_xor_b32 v69, v65, v42
    v_xor_b32 v70, v66, v42
    v_xor_b32 v71, v67, v42
    v_accvgpr_write_b32 a160, v68
    v_accvgpr_write_b32 a161, v69
    v_accvgpr_write_b32 a162, v70
    v_accvgpr_write_b32 a163, v71
    v_xor_b32_dpp v68, v64, v44 quad_perm:[0,1,3,2] row_mask:0xf bank_mask:0xf
    v_xor_b32_dpp v69, v65, v44 quad_perm:[0,1,3,2] row_mask:0xf bank_mask:0xf
    v_xor_b32_dpp v70, v66, v44 quad_perm:[0,1,3,2] row_mask:0xf bank_mask:0xf
    v_xor_b32_dpp v71, v67, v44 quad_perm:[0,1,3,2] row_mask:0xf bank_mask:0xf
    v_accvgpr_write_b32 a224, v68
    v_accvgpr_write_b32 a225, v69
    v_accvgpr_write_b32 a226, v70
    v_accvgpr_write_b32 a227, v71
    v_fract_f32 v48, v31
    v_add_f32 v49, v48, v33
    v_cos_f32 v56, v48
    v_add_f32 v50, v49, v35
    v_cos_f32 v57, v49
    v_add_f32 v51, v50, v33
    v_cos_f32 v58, v50
    v_add_f32 v52, v51, v35
    v_cos_f32 v59, v51
    v_add_f32 v53, v52, v33
    v_cos_f32 v60, v52
    v_add_f32 v54, v53, v35
    v_cos_f32 v61, v53
    v_add_f32 v55, v54, v33
    v_cos_f32 v62, v54
    v_cos_f32 v63, v55
    v_add_f32 v31, v48, v37
    v_cvt_pk_bf16_f32 v64, v56, v57
    v_cvt_pk_bf16_f32 v65, v58, v59
    v_cvt_pk_bf16_f32 v66, v60, v61
    v_cvt_pk_bf16_f32 v67, v62, v63
    v_accvgpr_write_b32 a36, v64
    v_accvgpr_write_b32 a37, v65
    v_accvgpr_write_b32 a38, v66
    v_accvgpr_write_b32 a39, v67
    v_xor_b32_dpp v68, v64, v41 quad_perm:[0,1,3,2] row_mask:0xf bank_mask:0xf
    v_xor_b32_dpp v69, v65, v41 quad_perm:[0,1,3,2] row_mask:0xf bank_mask:0xf
    v_xor_b32_dpp v70, v66, v41 quad_perm:[0,1,3,2] row_mask:0xf bank_mask:0xf
    v_xor_b32_dpp v71, v67, v41 quad_perm:[0,1,3,2] row_mask:0xf bank_mask:0xf
    v_accvgpr_write_b32 a100, v68
    v_accvgpr_write_b32 a101, v69
    v_accvgpr_write_b32 a102, v70
    v_accvgpr_write_b32 a103, v71
    v_xor_b32 v68, v64, v43
    v_xor_b32 v69, v65, v43
    v_xor_b32 v70, v66, v43
    v_xor_b32 v71, v67, v43
    v_accvgpr_write_b32 a164, v68
    v_accvgpr_write_b32 a165, v69
    v_accvgpr_write_b32 a166, v70
    v_accvgpr_write_b32 a167, v71
    v_xor_b32_dpp v68, v64, v45 quad_perm:[0,1,3,2] row_mask:0xf bank_mask:0xf
    v_xor_b32_dpp v69, v65, v45 quad_perm:[0,1,3,2] row_mask:0xf bank_mask:0xf
    v_xor_b32_dpp v70, v66, v45 quad_perm:[0,1,3,2] row_mask:0xf bank_mask:0xf
    v_xor_b32_dpp v71, v67, v45 quad_perm:[0,1,3,2] row_mask:0xf bank_mask:0xf
    v_accvgpr_write_b32 a228, v68
    v_accvgpr_write_b32 a229, v69
    v_accvgpr_write_b32 a230, v70
    v_accvgpr_write_b32 a231, v71
    v_fract_f32 v48, v30
    v_add_f32 v49, v48, v32
    v_cos_f32 v56, v48
    v_add_f32 v50, v49, v34
    v_cos_f32 v57, v49
    v_add_f32 v51, v50, v32
    v_cos_f32 v58, v50
    v_add_f32 v52, v51, v34
    v_cos_f32 v59, v51
    v_add_f32 v53, v52, v32
    v_cos_f32 v60, v52
    v_add_f32 v54, v53, v34
    v_cos_f32 v61, v53
    v_add_f32 v55, v54, v32
    v_cos_f32 v62, v54
    v_cos_f32 v63, v55
    v_add_f32 v30, v48, v36
    v_cvt_pk_bf16_f32 v64, v56, v57
    v_cvt_pk_bf16_f32 v65, v58, v59
    v_cvt_pk_bf16_f32 v66, v60, v61
    v_cvt_pk_bf16_f32 v67, v62, v63
    v_accvgpr_write_b32 a40, v64
    v_accvgpr_write_b32 a41, v65
    v_accvgpr_write_b32 a42, v66
    v_accvgpr_write_b32 a43, v67
    v_xor_b32_dpp v68, v64, v40 quad_perm:[0,1,3,2] row_mask:0xf bank_mask:0xf
    v_xor_b32_dpp v69, v65, v40 quad_perm:[0,1,3,2] row_mask:0xf bank_mask:0xf
    v_xor_b32_dpp v70, v66, v40 quad_perm:[0,1,3,2] row_mask:0xf bank_mask:0xf
    v_xor_b32_dpp v71, v67, v40 quad_perm:[0,1,3,2] row_mask:0xf bank_mask:0xf
    v_accvgpr_write_b32 a104, v68
    v_accvgpr_write_b32 a105, v69
    v_accvgpr_write_b32 a106, v70
    v_accvgpr_write_b32 a107, v71
    v_xor_b32 v68, v64, v42
    v_xor_b32 v69, v65, v42
    v_xor_b32 v70, v66, v42
    v_xor_b32 v71, v67, v42
    v_accvgpr_write_b32 a168, v68
    v_accvgpr_write_b32 a169, v69
    v_accvgpr_write_b32 a170, v70
    v_accvgpr_write_b32 a171, v71
    v_xor_b32_dpp v68, v64, v44 quad_perm:[0,1,3,2] row_mask:0xf bank_mask:0xf
    v_xor_b32_dpp v69, v65, v44 quad_perm:[0,1,3,2] row_mask:0xf bank_mask:0xf
    v_xor_b32_dpp v70, v66, v44 quad_perm:[0,1,3,2] row_mask:0xf bank_mask:0xf
    v_xor_b32_dpp v71, v67, v44 quad_perm:[0,1,3,2] row_mask:0xf bank_mask:0xf
    v_accvgpr_write_b32 a232, v68
    v_accvgpr_write_b32 a233, v69
    v_accvgpr_write_b32 a234, v70
    v_accvgpr_write_b32 a235, v71
    v_fract_f32 v48, v31
    v_add_f32 v49, v48, v33
    v_cos_f32 v56, v48
    v_add_f32 v50, v49, v35
    v_cos_f32 v57, v49
    v_add_f32 v51, v50, v33
    v_cos_f32 v58, v50
    v_add_f32 v52, v51, v35
    v_cos_f32 v59, v51
    v_add_f32 v53, v52, v33
    v_cos_f32 v60, v52
    v_add_f32 v54, v53, v35
    v_cos_f32 v61, v53
    v_add_f32 v55, v54, v33
    v_cos_f32 v62, v54
    v_cos_f32 v63, v55
    v_add_f32 v31, v48, v37
    v_cvt_pk_bf16_f32 v64, v56, v57
    v_cvt_pk_bf16_f32 v65, v58, v59
    v_cvt_pk_bf16_f32 v66, v60, v61
    v_cvt_pk_bf16_f32 v67, v62, v63
    v_accvgpr_write_b32 a44, v64
    v_accvgpr_write_b32 a45, v65
    v_accvgpr_write_b32 a46, v66
    v_accvgpr_write_b32 a47, v67
    v_xor_b32_dpp v68, v64, v41 quad_perm:[0,1,3,2] row_mask:0xf bank_mask:0xf
    v_xor_b32_dpp v69, v65, v41 quad_perm:[0,1,3,2] row_mask:0xf bank_mask:0xf
    v_xor_b32_dpp v70, v66, v41 quad_perm:[0,1,3,2] row_mask:0xf bank_mask:0xf
    v_xor_b32_dpp v71, v67, v41 quad_perm:[0,1,3,2] row_mask:0xf bank_mask:0xf
    v_accvgpr_write_b32 a108, v68
    v_accvgpr_write_b32 a109, v69
    v_accvgpr_write_b32 a110, v70
    v_accvgpr_write_b32 a111, v71
    v_xor_b32 v68, v64, v43
    v_xor_b32 v69, v65, v43
    v_xor_b32 v70, v66, v43
    v_xor_b32 v71, v67, v43
    v_accvgpr_write_b32 a172, v68
    v_accvgpr_write_b32 a173, v69
    v_accvgpr_write_b32 a174, v70
    v_accvgpr_write_b32 a175, v71
    v_xor_b32_dpp v68, v64, v45 quad_perm:[0,1,3,2] row_mask:0xf bank_mask:0xf
    v_xor_b32_dpp v69, v65, v45 quad_perm:[0,1,3,2] row_mask:0xf bank_mask:0xf
    v_xor_b32_dpp v70, v66, v45 quad_perm:[0,1,3,2] row_mask:0xf bank_mask:0xf
    v_xor_b32_dpp v71, v67, v45 quad_perm:[0,1,3,2] row_mask:0xf bank_mask:0xf
    v_accvgpr_write_b32 a236, v68
    v_accvgpr_write_b32 a237, v69
    v_accvgpr_write_b32 a238, v70
    v_accvgpr_write_b32 a239, v71
    v_fract_f32 v48, v30
    v_add_f32 v49, v48, v32
    v_cos_f32 v56, v48
    v_add_f32 v50, v49, v34
    v_cos_f32 v57, v49
    v_add_f32 v51, v50, v32
    v_cos_f32 v58, v50
    v_add_f32 v52, v51, v34
    v_cos_f32 v59, v51
    v_add_f32 v53, v52, v32
    v_cos_f32 v60, v52
    v_add_f32 v54, v53, v34
    v_cos_f32 v61, v53
    v_add_f32 v55, v54, v32
    v_cos_f32 v62, v54
    v_cos_f32 v63, v55
    v_add_f32 v30, v48, v36
    v_cvt_pk_bf16_f32 v64, v56, v57
    v_cvt_pk_bf16_f32 v65, v58, v59
    v_cvt_pk_bf16_f32 v66, v60, v61
    v_cvt_pk_bf16_f32 v67, v62, v63
    v_accvgpr_write_b32 a48, v64
    v_accvgpr_write_b32 a49, v65
    v_accvgpr_write_b32 a50, v66
    v_accvgpr_write_b32 a51, v67
    v_xor_b32_dpp v68, v64, v40 quad_perm:[0,1,3,2] row_mask:0xf bank_mask:0xf
    v_xor_b32_dpp v69, v65, v40 quad_perm:[0,1,3,2] row_mask:0xf bank_mask:0xf
    v_xor_b32_dpp v70, v66, v40 quad_perm:[0,1,3,2] row_mask:0xf bank_mask:0xf
    v_xor_b32_dpp v71, v67, v40 quad_perm:[0,1,3,2] row_mask:0xf bank_mask:0xf
    v_accvgpr_write_b32 a112, v68
    v_accvgpr_write_b32 a113, v69
    v_accvgpr_write_b32 a114, v70
    v_accvgpr_write_b32 a115, v71
    v_xor_b32 v68, v64, v42
    v_xor_b32 v69, v65, v42
    v_xor_b32 v70, v66, v42
    v_xor_b32 v71, v67, v42
    v_accvgpr_write_b32 a176, v68
    v_accvgpr_write_b32 a177, v69
    v_accvgpr_write_b32 a178, v70
    v_accvgpr_write_b32 a179, v71
    v_xor_b32_dpp v68, v64, v44 quad_perm:[0,1,3,2] row_mask:0xf bank_mask:0xf
    v_xor_b32_dpp v69, v65, v44 quad_perm:[0,1,3,2] row_mask:0xf bank_mask:0xf
    v_xor_b32_dpp v70, v66, v44 quad_perm:[0,1,3,2] row_mask:0xf bank_mask:0xf
    v_xor_b32_dpp v71, v67, v44 quad_perm:[0,1,3,2] row_mask:0xf bank_mask:0xf
    v_accvgpr_write_b32 a240, v68
    v_accvgpr_write_b32 a241, v69
    v_accvgpr_write_b32 a242, v70
    v_accvgpr_write_b32 a243, v71
    v_fract_f32 v48, v31
    v_add_f32 v49, v48, v33
    v_cos_f32 v56, v48
    v_add_f32 v50, v49, v35
    v_cos_f32 v57, v49
    v_add_f32 v51, v50, v33
    v_cos_f32 v58, v50
    v_add_f32 v52, v51, v35
    v_cos_f32 v59, v51
    v_add_f32 v53, v52, v33
    v_cos_f32 v60, v52
    v_add_f32 v54, v53, v35
    v_cos_f32 v61, v53
    v_add_f32 v55, v54, v33
    v_cos_f32 v62, v54
    v_cos_f32 v63, v55
    v_add_f32 v31, v48, v37
    v_cvt_pk_bf16_f32 v64, v56, v57
    v_cvt_pk_bf16_f32 v65, v58, v59
    v_cvt_pk_bf16_f32 v66, v60, v61
    v_cvt_pk_bf16_f32 v67, v62, v63
    v_accvgpr_write_b32 a52, v64
    v_accvgpr_write_b32 a53, v65
    v_accvgpr_write_b32 a54, v66
    v_accvgpr_write_b32 a55, v67
    v_xor_b32_dpp v68, v64, v41 quad_perm:[0,1,3,2] row_mask:0xf bank_mask:0xf
    v_xor_b32_dpp v69, v65, v41 quad_perm:[0,1,3,2] row_mask:0xf bank_mask:0xf
    v_xor_b32_dpp v70, v66, v41 quad_perm:[0,1,3,2] row_mask:0xf bank_mask:0xf
    v_xor_b32_dpp v71, v67, v41 quad_perm:[0,1,3,2] row_mask:0xf bank_mask:0xf
    v_accvgpr_write_b32 a116, v68
    v_accvgpr_write_b32 a117, v69
    v_accvgpr_write_b32 a118, v70
    v_accvgpr_write_b32 a119, v71
    v_xor_b32 v68, v64, v43
    v_xor_b32 v69, v65, v43
    v_xor_b32 v70, v66, v43
    v_xor_b32 v71, v67, v43
    v_accvgpr_write_b32 a180, v68
    v_accvgpr_write_b32 a181, v69
    v_accvgpr_write_b32 a182, v70
    v_accvgpr_write_b32 a183, v71
    v_xor_b32_dpp v68, v64, v45 quad_perm:[0,1,3,2] row_mask:0xf bank_mask:0xf
    v_xor_b32_dpp v69, v65, v45 quad_perm:[0,1,3,2] row_mask:0xf bank_mask:0xf
    v_xor_b32_dpp v70, v66, v45 quad_perm:[0,1,3,2] row_mask:0xf bank_mask:0xf
    v_xor_b32_dpp v71, v67, v45 quad_perm:[0,1,3,2] row_mask:0xf bank_mask:0xf
    v_accvgpr_write_b32 a244, v68
    v_accvgpr_write_b32 a245, v69
    v_accvgpr_write_b32 a246, v70
    v_accvgpr_write_b32 a247, v71
    v_fract_f32 v48, v30
    v_add_f32 v49, v48, v32
    v_cos_f32 v56, v48
    v_add_f32 v50, v49, v34
    v_cos_f32 v57, v49
    v_add_f32 v51, v50, v32
    v_cos_f32 v58, v50
    v_add_f32 v52, v51, v34
    v_cos_f32 v59, v51
    v_add_f32 v53, v52, v32
    v_cos_f32 v60, v52
    v_add_f32 v54, v53, v34
    v_cos_f32 v61, v53
    v_add_f32 v55, v54, v32
    v_cos_f32 v62, v54
    v_cos_f32 v63, v55
    v_add_f32 v30, v48, v36
    v_cvt_pk_bf16_f32 v64, v56, v57
    v_cvt_pk_bf16_f32 v65, v58, v59
    v_cvt_pk_bf16_f32 v66, v60, v61
    v_cvt_pk_bf16_f32 v67, v62, v63
    v_accvgpr_write_b32 a56, v64
    v_accvgpr_write_b32 a57, v65
    v_accvgpr_write_b32 a58, v66
    v_accvgpr_write_b32 a59, v67
    v_xor_b32_dpp v68, v64, v40 quad_perm:[0,1,3,2] row_mask:0xf bank_mask:0xf
    v_xor_b32_dpp v69, v65, v40 quad_perm:[0,1,3,2] row_mask:0xf bank_mask:0xf
    v_xor_b32_dpp v70, v66, v40 quad_perm:[0,1,3,2] row_mask:0xf bank_mask:0xf
    v_xor_b32_dpp v71, v67, v40 quad_perm:[0,1,3,2] row_mask:0xf bank_mask:0xf
    v_accvgpr_write_b32 a120, v68
    v_accvgpr_write_b32 a121, v69
    v_accvgpr_write_b32 a122, v70
    v_accvgpr_write_b32 a123, v71
    v_xor_b32 v68, v64, v42
    v_xor_b32 v69, v65, v42
    v_xor_b32 v70, v66, v42
    v_xor_b32 v71, v67, v42
    v_accvgpr_write_b32 a184, v68
    v_accvgpr_write_b32 a185, v69
    v_accvgpr_write_b32 a186, v70
    v_accvgpr_write_b32 a187, v71
    v_xor_b32_dpp v68, v64, v44 quad_perm:[0,1,3,2] row_mask:0xf bank_mask:0xf
    v_xor_b32_dpp v69, v65, v44 quad_perm:[0,1,3,2] row_mask:0xf bank_mask:0xf
    v_xor_b32_dpp v70, v66, v44 quad_perm:[0,1,3,2] row_mask:0xf bank_mask:0xf
    v_xor_b32_dpp v71, v67, v44 quad_perm:[0,1,3,2] row_mask:0xf bank_mask:0xf
    v_accvgpr_write_b32 a248, v68
    v_accvgpr_write_b32 a249, v69
    v_accvgpr_write_b32 a250, v70
    v_accvgpr_write_b32 a251, v71
    v_fract_f32 v48, v31
    v_add_f32 v49, v48, v33
    v_cos_f32 v56, v48
    v_add_f32 v50, v49, v35
    v_cos_f32 v57, v49
    v_add_f32 v51, v50, v33
    v_cos_f32 v58, v50
    v_add_f32 v52, v51, v35
    v_cos_f32 v59, v51
    v_add_f32 v53, v52, v33
    v_cos_f32 v60, v52
    v_add_f32 v54, v53, v35
    v_cos_f32 v61, v53
    v_add_f32 v55, v54, v33
    v_cos_f32 v62, v54
    v_cos_f32 v63, v55
    v_add_f32 v31, v48, v37
    v_cvt_pk_bf16_f32 v64, v56, v57
    v_cvt_pk_bf16_f32 v65, v58, v59
    v_cvt_pk_bf16_f32 v66, v60, v61
    v_cvt_pk_bf16_f32 v67, v62, v63
    v_accvgpr_write_b32 a60, v64
    v_accvgpr_write_b32 a61, v65
    v_accvgpr_write_b32 a62, v66
    v_accvgpr_write_b32 a63, v67
    v_xor_b32_dpp v68, v64, v41 quad_perm:[0,1,3,2] row_mask:0xf bank_mask:0xf
    v_xor_b32_dpp v69, v65, v41 quad_perm:[0,1,3,2] row_mask:0xf bank_mask:0xf
    v_xor_b32_dpp v70, v66, v41 quad_perm:[0,1,3,2] row_mask:0xf bank_mask:0xf
    v_xor_b32_dpp v71, v67, v41 quad_perm:[0,1,3,2] row_mask:0xf bank_mask:0xf
    v_accvgpr_write_b32 a124, v68
    v_accvgpr_write_b32 a125, v69
    v_accvgpr_write_b32 a126, v70
    v_accvgpr_write_b32 a127, v71
    v_xor_b32 v68, v64, v43
    v_xor_b32 v69, v65, v43
    v_xor_b32 v70, v66, v43
    v_xor_b32 v71, v67, v43
    v_accvgpr_write_b32 a188, v68
    v_accvgpr_write_b32 a189, v69
    v_accvgpr_write_b32 a190, v70
    v_accvgpr_write_b32 a191, v71
    v_xor_b32_dpp v68, v64, v45 quad_perm:[0,1,3,2] row_mask:0xf bank_mask:0xf
    v_xor_b32_dpp v69, v65, v45 quad_perm:[0,1,3,2] row_mask:0xf bank_mask:0xf
    v_xor_b32_dpp v70, v66, v45 quad_perm:[0,1,3,2] row_mask:0xf bank_mask:0xf
    v_xor_b32_dpp v71, v67, v45 quad_perm:[0,1,3,2] row_mask:0xf bank_mask:0xf
    v_accvgpr_write_b32 a252, v68
    v_accvgpr_write_b32 a253, v69
    v_accvgpr_write_b32 a254, v70
    v_accvgpr_write_b32 a255, v71
    s_and_b32 s17, s28, 1
    s_lshl_b32 s17, s17, 15
    s_lshr_b32 s18, s28, 1
    s_lshl_b32 s18, s18, 21
    s_add_u32 s17, s17, s18
    s_lshl_b32 s18, s29, 16
    s_add_u32 s17, s17, s18
    v_lshlrev_b32 v15, 7, v1
    s_waitcnt lgkmcnt(0)
    s_mov_b32 s35, s17
    s_lshl_b32 s34, s93, 2
    s_add_u32 s34, s34, s16
    s_lshl_b32 s34, s34, 13
    s_sub_u32 s34, s34, 262144
    v_mov_b32 v247, v15
    s_lshl_b32 s17, s29, 6
    v_add_u32 v246, s17, v1
    v_mul_u32_u24 v246, 1026, v246
    s_lshl_b32 s17, s28, 8
    v_add_u32 v246, s17, v246
    v_and_b32 v246, -4, v246
    s_load_dwordx2 s[8:9], s[0:1], 0
    s_mov_b32 s10, 4194304
    s_mov_b32 s11, 0x20000
    s_waitcnt lgkmcnt(0)
    v_and_b32 v5, 15, v1
    v_bfe_u32 v6, v1, 1, 3
    v_lshrrev_b32 v7, 4, v1
    v_xor_b32 v6, v6, v7
    v_lshlrev_b32 v6, 4, v6
    v_lshl_add_u32 v10, v5, 7, v6
    s_lshl_b32 s19, s16, 10
    v_xor_b32 v11, 64, v10
    v_add_u32 v12, 0x10000, v10
    v_add_u32 v13, 0x10000, v11
    v_lshrrev_b32 v7, 3, v1
    s_lshl_b32 s17, s16, 3
    v_add_u32 v7, s17, v7
    v_bfe_u32 v8, v7, 1, 3
    v_xor_b32 v8, v8, v1
    v_and_b32 v8, 7, v8
    v_bfe_u32 v5, v7, 2, 2
    v_and_b32 v2, 3, v7
    v_lshl_add_u32 v2, v5, 3, v2
    v_bfe_u32 v5, v7, 4, 1
    v_lshl_add_u32 v2, v5, 2, v2
    v_bfe_u32 v5, v1, 2, 2
    v_and_b32 v3, 3, v1
    v_lshl_add_u32 v3, v5, 3, v3
    v_lshlrev_b32 v2, 16, v2
    v_lshl_add_u32 v2, v8, 4, v2
    v_and_b32 v5, 48, v1
    v_lshl_add_u32 v3, v3, 6, v5
    s_mul_i32 s21, s29, 139776
    s_mul_i32 s17, s28, 34816
    s_add_u32 s21, s21, s17
    s_add_u32 s21, s21, 104857600
    s_and_b32 s20, s28, 1
    s_lshl_b32 s20, s20, 15
    s_lshr_b32 s17, s28, 1
    s_lshl_b32 s17, s17, 21
    s_add_u32 s20, s20, s17
    s_mov_b32 s24, 2048
    s_mov_b32 s25, 2176
    s_barrier
    s_mov_b32 s26, s25
    s_sub_u32 s25, s21, 1073741824
    s_mov_b32 s21, 1073741824
    s_mov_b32 s23, 0
    s_mov_b32 s22, 0
    s_add_u32 m0, s19, 0
    s_nop 0
    buffer_load_dwordx4 v2, s[8:11], s20 offen offset:0 lds
    s_add_u32 m0, s19, 3968
    s_nop 0
    buffer_load_dwordx4 v2, s[8:11], s20 offen offset:128 lds
    s_add_u32 m0, s19, 7936
    s_nop 0
    buffer_load_dwordx4 v2, s[8:11], s20 offen offset:256 lds
    s_add_u32 m0, s19, 11904
    s_nop 0
    buffer_load_dwordx4 v2, s[8:11], s20 offen offset:384 lds
    s_add_u32 m0, s19, 15872
    s_nop 0
    buffer_load_dwordx4 v2, s[8:11], s20 offen offset:512 lds
    s_add_u32 m0, s19, 19840
    s_nop 0
    buffer_load_dwordx4 v2, s[8:11], s20 offen offset:640 lds
    s_add_u32 m0, s19, 23808
    s_nop 0
    buffer_load_dwordx4 v2, s[8:11], s20 offen offset:768 lds
    s_add_u32 m0, s19, 27776
    s_nop 0
    buffer_load_dwordx4 v2, s[8:11], s20 offen offset:896 lds
    s_add_u32 m0, s19, 31744
    s_nop 0
    buffer_load_dwordx4 v2, s[8:11], s20 offen offset:1024 lds
    s_add_u32 m0, s19, 35712
    s_nop 0
    buffer_load_dwordx4 v2, s[8:11], s20 offen offset:1152 lds
    s_add_u32 m0, s19, 39680
    s_nop 0
    buffer_load_dwordx4 v2, s[8:11], s20 offen offset:1280 lds
    s_add_u32 m0, s19, 43648
    s_nop 0
    buffer_load_dwordx4 v2, s[8:11], s20 offen offset:1408 lds
    s_add_u32 m0, s19, 47616
    s_nop 0
    buffer_load_dwordx4 v2, s[8:11], s20 offen offset:1536 lds
    s_add_u32 m0, s19, 51584
    s_nop 0
    buffer_load_dwordx4 v2, s[8:11], s20 offen offset:1664 lds
    s_add_u32 m0, s19, 55552
    s_nop 0
    buffer_load_dwordx4 v2, s[8:11], s20 offen offset:1792 lds
    s_add_u32 m0, s19, 59520
    s_nop 0
    buffer_load_dwordx4 v2, s[8:11], s20 offen offset:1920 lds
    s_add_u32 s20, s20, s24
    s_add_u32 m0, s19, 65536
    s_nop 0
    buffer_load_dwordx4 v2, s[8:11], s20 offen offset:0 lds
    s_add_u32 m0, s19, 69504
    s_nop 0
    buffer_load_dwordx4 v2, s[8:11], s20 offen offset:128 lds
    s_add_u32 m0, s19, 73472
    s_nop 0
    buffer_load_dwordx4 v2, s[8:11], s20 offen offset:256 lds
    s_waitcnt vmcnt(11)
    s_barrier
    ds_read_b128 v[20:23], v10 offset:0
    ds_read_b128 v[24:27], v10 offset:2048
    ds_read_b128 v[28:31], v11 offset:0
    ds_read_b128 v[32:35], v11 offset:2048
    ds_read_b128 v[36:39], v10 offset:4096
    ds_read_b128 v[40:43], v10 offset:6144
    ds_read_b128 v[44:47], v11 offset:4096
.p2align 6
F1_top:
    s_waitcnt lgkmcnt(6)
    v_mfma_f32_16x16x32_bf16 v[52:55], v[20:23], a[0:3], 0
    ds_read_b128 v[48:51], v11 offset:6144
    v_mfma_f32_16x16x32_bf16 v[60:63], v[20:23], a[4:7], 0
    s_waitcnt lgkmcnt(6)
    v_mfma_f32_16x16x32_bf16 v[56:59], v[24:27], a[0:3], 0
    ds_read_b128 v[20:23], v10 offset:8192
    s_add_u32 m0, s19, 77440
    v_mfma_f32_16x16x32_bf16 v[64:67], v[24:27], a[4:7], 0
    buffer_load_dwordx4 v2, s[8:11], s20 offen offset:384 lds
    s_waitcnt lgkmcnt(6)
    v_mfma_f32_16x16x32_bf16 v[52:55], v[28:31], a[8:11], v[52:55]
    ds_read_b128 v[24:27], v10 offset:10240
    v_mfma_f32_16x16x32_bf16 v[60:63], v[28:31], a[12:15], v[60:63]
    s_waitcnt lgkmcnt(6)
    v_mfma_f32_16x16x32_bf16 v[56:59], v[32:35], a[8:11], v[56:59]
    ds_read_b128 v[28:31], v11 offset:8192
    s_add_u32 m0, s19, 81408
    v_mfma_f32_16x16x32_bf16 v[64:67], v[32:35], a[12:15], v[64:67]
    buffer_load_dwordx4 v2, s[8:11], s20 offen offset:512 lds
    s_waitcnt lgkmcnt(6)
    v_mfma_f32_16x16x32_bf16 v[52:55], v[36:39], a[16:19], v[52:55]
    ds_read_b128 v[32:35], v11 offset:10240
    v_mfma_f32_16x16x32_bf16 v[60:63], v[36:39], a[20:23], v[60:63]
    s_waitcnt lgkmcnt(6)
    v_mfma_f32_16x16x32_bf16 v[56:59], v[40:43], a[16:19], v[56:59]
    ds_read_b128 v[36:39], v10 offset:12288
    s_add_u32 m0, s19, 85376
    v_mfma_f32_16x16x32_bf16 v[64:67], v[40:43], a[20:23], v[64:67]
    buffer_load_dwordx4 v2, s[8:11], s20 offen offset:640 lds
    s_waitcnt lgkmcnt(6)
    v_mfma_f32_16x16x32_bf16 v[52:55], v[44:47], a[24:27], v[52:55]
    ds_read_b128 v[40:43], v10 offset:14336
    v_mfma_f32_16x16x32_bf16 v[60:63], v[44:47], a[28:31], v[60:63]
    s_waitcnt lgkmcnt(6)
    v_mfma_f32_16x16x32_bf16 v[56:59], v[48:51], a[24:27], v[56:59]
    ds_read_b128 v[44:47], v11 offset:12288
    s_add_u32 m0, s19, 89344
    v_mfma_f32_16x16x32_bf16 v[64:67], v[48:51], a[28:31], v[64:67]
    buffer_load_dwordx4 v2, s[8:11], s20 offen offset:768 lds
    s_waitcnt lgkmcnt(6)
    v_mfma_f32_16x16x32_bf16 v[52:55], v[20:23], a[32:35], v[52:55]
    ds_read_b128 v[48:51], v11 offset:14336
    v_mfma_f32_16x16x32_bf16 v[60:63], v[20:23], a[36:39], v[60:63]
    s_waitcnt lgkmcnt(6)
    v_mfma_f32_16x16x32_bf16 v[56:59], v[24:27], a[32:35], v[56:59]
    ds_read_b128 v[20:23], v10 offset:16384
    s_add_u32 m0, s19, 93312
    v_mfma_f32_16x16x32_bf16 v[64:67], v[24:27], a[36:39], v[64:67]
    buffer_load_dwordx4 v2, s[8:11], s20 offen offset:896 lds
    s_waitcnt lgkmcnt(6)
    v_mfma_f32_16x16x32_bf16 v[52:55], v[28:31], a[40:43], v[52:55]
    ds_read_b128 v[24:27], v10 offset:18432
    v_mfma_f32_16x16x32_bf16 v[60:63], v[28:31], a[44:47], v[60:63]
    v_cvt_pk_bf16_f32 v84, v68, v69
    s_waitcnt lgkmcnt(6)
    v_mfma_f32_16x16x32_bf16 v[56:59], v[32:35], a[40:43], v[56:59]
    ds_read_b128 v[28:31], v11 offset:16384
    v_mfma_f32_16x16x32_bf16 v[64:67], v[32:35], a[44:47], v[64:67]
    v_cvt_pk_bf16_f32 v85, v70, v71
    s_waitcnt lgkmcnt(6)
    v_mfma_f32_16x16x32_bf16 v[52:55], v[36:39], a[48:51], v[52:55]
    ds_read_b128 v[32:35], v11 offset:18432
    v_mfma_f32_16x16x32_bf16 v[60:63], v[36:39], a[52:55], v[60:63]
    v_cvt_pk_bf16_f32 v86, v72, v73
    s_waitcnt lgkmcnt(6)
    v_mfma_f32_16x16x32_bf16 v[56:59], v[40:43], a[48:51], v[56:59]
    ds_read_b128 v[36:39], v10 offset:20480
    v_mfma_f32_16x16x32_bf16 v[64:67], v[40:43], a[52:55], v[64:67]
    v_cvt_pk_bf16_f32 v87, v74, v75
    s_waitcnt lgkmcnt(6)
    v_mfma_f32_16x16x32_bf16 v[52:55], v[44:47], a[56:59], v[52:55]
    ds_read_b128 v[40:43], v10 offset:22528
    v_mfma_f32_16x16x32_bf16 v[60:63], v[44:47], a[60:63], v[60:63]
    v_cvt_pk_bf16_f32 v88, v76, v77
    s_waitcnt lgkmcnt(6)
    v_mfma_f32_16x16x32_bf16 v[56:59], v[48:51], a[56:59], v[56:59]
    ds_read_b128 v[44:47], v11 offset:20480
    v_mfma_f32_16x16x32_bf16 v[64:67], v[48:51], a[60:63], v[64:67]
    v_cvt_pk_bf16_f32 v89, v78, v79
    buffer_store_dwordx4 v[84:87], v3, s[4:7], s21 offen offset:0 sc1
    s_waitcnt lgkmcnt(6)
    v_mfma_f32_16x16x32_bf16 v[52:55], v[20:23], a[64:67], v[52:55]
    ds_read_b128 v[48:51], v11 offset:22528
    v_mfma_f32_16x16x32_bf16 v[60:63], v[20:23], a[68:71], v[60:63]
    v_cvt_pk_bf16_f32 v90, v80, v81
    s_waitcnt lgkmcnt(6)
    v_mfma_f32_16x16x32_bf16 v[56:59], v[24:27], a[64:67], v[56:59]
    ds_read_b128 v[20:23], v10 offset:24576
    v_mfma_f32_16x16x32_bf16 v[64:67], v[24:27], a[68:71], v[64:67]
    v_cvt_pk_bf16_f32 v91, v82, v83
    s_waitcnt lgkmcnt(6)
    v_mfma_f32_16x16x32_bf16 v[52:55], v[28:31], a[72:75], v[52:55]
    ds_read_b128 v[24:27], v10 offset:26624
    v_mfma_f32_16x16x32_bf16 v[60:63], v[28:31], a[76:79], v[60:63]
    s_waitcnt lgkmcnt(6)
    v_mfma_f32_16x16x32_bf16 v[56:59], v[32:35], a[72:75], v[56:59]
    ds_read_b128 v[28:31], v11 offset:24576
    v_mfma_f32_16x16x32_bf16 v[64:67], v[32:35], a[76:79], v[64:67]
    buffer_store_dwordx4 v[88:91], v3, s[4:7], s21 offen offset:256 sc1
    s_waitcnt lgkmcnt(6)
    v_mfma_f32_16x16x32_bf16 v[52:55], v[36:39], a[80:83], v[52:55]
    ds_read_b128 v[32:35], v11 offset:26624
    v_mfma_f32_16x16x32_bf16 v[60:63], v[36:39], a[84:87], v[60:63]
    s_add_u32 s21, s21, s25
    s_mov_b32 s25, s26
    s_waitcnt lgkmcnt(6)
    v_mfma_f32_16x16x32_bf16 v[56:59], v[40:43], a[80:83], v[56:59]
    ds_read_b128 v[36:39], v10 offset:28672
    v_mfma_f32_16x16x32_bf16 v[64:67], v[40:43], a[84:87], v[64:67]
    s_waitcnt lgkmcnt(6)
    v_mfma_f32_16x16x32_bf16 v[52:55], v[44:47], a[88:91], v[52:55]
    ds_read_b128 v[40:43], v10 offset:30720
    v_mfma_f32_16x16x32_bf16 v[60:63], v[44:47], a[92:95], v[60:63]
    buffer_load_dword v248, v247, s[44:47], s34 offen
    s_add_u32 s34, s34, 1048576
    s_sub_u32 s31, s22, 10
    s_lshl_b32 s31, s31, 6
    s_cmp_lt_u32 s31, 384
    s_cselect_b32 s31, s31, 1073741824
    buffer_load_dword v249, v246, s[48:51], s31 offen
    buffer_load_dword v250, v246, s[52:55], s31 offen
    s_cmp_eq_u32 s22, 2
    s_cselect_b32 s31, s35, 1073741824
    buffer_load_dword v251, v247, s[40:43], s31 offen
    s_add_u32 s31, s31, 8192
    buffer_load_dword v251, v247, s[40:43], s31 offen
    s_add_u32 s31, s31, 8192
    buffer_load_dword v251, v247, s[40:43], s31 offen
    s_add_u32 s31, s31, 8192
    buffer_load_dword v251, v247, s[40:43], s31 offen
    s_add_u32 s31, s31, 8192
    s_waitcnt lgkmcnt(6)
    v_mfma_f32_16x16x32_bf16 v[56:59], v[48:51], a[88:91], v[56:59]
    ds_read_b128 v[44:47], v11 offset:28672
    v_mfma_f32_16x16x32_bf16 v[64:67], v[48:51], a[92:95], v[64:67]
    s_waitcnt lgkmcnt(6)
    v_mfma_f32_16x16x32_bf16 v[52:55], v[20:23], a[96:99], v[52:55]
    ds_read_b128 v[48:51], v11 offset:30720
    v_mfma_f32_16x16x32_bf16 v[60:63], v[20:23], a[100:103], v[60:63]
    s_waitcnt lgkmcnt(6)
    v_mfma_f32_16x16x32_bf16 v[56:59], v[24:27], a[96:99], v[56:59]
    s_waitcnt vmcnt(17)
    s_barrier
    ds_read_b128 v[20:23], v10 offset:32768
    v_mfma_f32_16x16x32_bf16 v[64:67], v[24:27], a[100:103], v[64:67]
    s_waitcnt lgkmcnt(6)
    v_mfma_f32_16x16x32_bf16 v[52:55], v[28:31], a[104:107], v[52:55]
    ds_read_b128 v[24:27], v10 offset:34816
    s_add_u32 m0, s19, 97280
    v_mfma_f32_16x16x32_bf16 v[60:63], v[28:31], a[108:111], v[60:63]
    buffer_load_dwordx4 v2, s[8:11], s20 offen offset:1024 lds
    s_waitcnt lgkmcnt(6)
    v_mfma_f32_16x16x32_bf16 v[56:59], v[32:35], a[104:107], v[56:59]
    ds_read_b128 v[28:31], v11 offset:32768
    v_mfma_f32_16x16x32_bf16 v[64:67], v[32:35], a[108:111], v[64:67]
    s_waitcnt lgkmcnt(6)
    v_mfma_f32_16x16x32_bf16 v[52:55], v[36:39], a[112:115], v[52:55]
    ds_read_b128 v[32:35], v11 offset:34816
    s_add_u32 m0, s19, 101248
    v_mfma_f32_16x16x32_bf16 v[60:63], v[36:39], a[116:119], v[60:63]
    buffer_load_dwordx4 v2, s[8:11], s20 offen offset:1152 lds
    s_waitcnt lgkmcnt(6)
    v_mfma_f32_16x16x32_bf16 v[56:59], v[40:43], a[112:115], v[56:59]
    ds_read_b128 v[36:39], v10 offset:36864
    v_mfma_f32_16x16x32_bf16 v[64:67], v[40:43], a[116:119], v[64:67]
    s_waitcnt lgkmcnt(6)
    v_mfma_f32_16x16x32_bf16 v[52:55], v[44:47], a[120:123], v[52:55]
    ds_read_b128 v[40:43], v10 offset:38912
    s_add_u32 m0, s19, 105216
    v_mfma_f32_16x16x32_bf16 v[60:63], v[44:47], a[124:127], v[60:63]
    buffer_load_dwordx4 v2, s[8:11], s20 offen offset:1280 lds
    s_waitcnt lgkmcnt(6)
    v_mfma_f32_16x16x32_bf16 v[56:59], v[48:51], a[120:123], v[56:59]
    ds_read_b128 v[44:47], v11 offset:36864
    v_mfma_f32_16x16x32_bf16 v[64:67], v[48:51], a[124:127], v[64:67]
    s_waitcnt lgkmcnt(6)
    v_mfma_f32_16x16x32_bf16 v[52:55], v[20:23], a[128:131], v[52:55]
    ds_read_b128 v[48:51], v11 offset:38912
    v_mfma_f32_16x16x32_bf16 v[60:63], v[20:23], a[132:135], v[60:63]
    s_waitcnt lgkmcnt(6)
    v_mfma_f32_16x16x32_bf16 v[56:59], v[24:27], a[128:131], v[56:59]
    ds_read_b128 v[20:23], v10 offset:40960
    s_add_u32 m0, s19, 109184
    v_mfma_f32_16x16x32_bf16 v[64:67], v[24:27], a[132:135], v[64:67]
    buffer_load_dwordx4 v2, s[8:11], s20 offen offset:1408 lds
    s_waitcnt lgkmcnt(6)
    v_mfma_f32_16x16x32_bf16 v[52:55], v[28:31], a[136:139], v[52:55]
    ds_read_b128 v[24:27], v10 offset:43008
    v_mfma_f32_16x16x32_bf16 v[60:63], v[28:31], a[140:143], v[60:63]
    s_waitcnt lgkmcnt(6)
    v_mfma_f32_16x16x32_bf16 v[56:59], v[32:35], a[136:139], v[56:59]
    ds_read_b128 v[28:31], v11 offset:40960
    s_add_u32 m0, s19, 113152
    v_mfma_f32_16x16x32_bf16 v[64:67], v[32:35], a[140:143], v[64:67]
    buffer_load_dwordx4 v2, s[8:11], s20 offen offset:1536 lds
    s_waitcnt lgkmcnt(6)
    v_mfma_f32_16x16x32_bf16 v[52:55], v[36:39], a[144:147], v[52:55]
    ds_read_b128 v[32:35], v11 offset:43008
    v_mfma_f32_16x16x32_bf16 v[60:63], v[36:39], a[148:151], v[60:63]
    s_waitcnt lgkmcnt(6)
    v_mfma_f32_16x16x32_bf16 v[56:59], v[40:43], a[144:147], v[56:59]
    ds_read_b128 v[36:39], v10 offset:45056
    s_add_u32 m0, s19, 117120
    v_mfma_f32_16x16x32_bf16 v[64:67], v[40:43], a[148:151], v[64:67]
    buffer_load_dwordx4 v2, s[8:11], s20 offen offset:1664 lds
    s_waitcnt lgkmcnt(6)
    v_mfma_f32_16x16x32_bf16 v[52:55], v[44:47], a[152:155], v[52:55]
    ds_read_b128 v[40:43], v10 offset:47104
    v_mfma_f32_16x16x32_bf16 v[60:63], v[44:47], a[156:159], v[60:63]
    s_waitcnt lgkmcnt(6)
    v_mfma_f32_16x16x32_bf16 v[56:59], v[48:51], a[152:155], v[56:59]
    ds_read_b128 v[44:47], v11 offset:45056
    s_add_u32 m0, s19, 121088
    v_mfma_f32_16x16x32_bf16 v[64:67], v[48:51], a[156:159], v[64:67]
    buffer_load_dwordx4 v2, s[8:11], s20 offen offset:1792 lds
    s_waitcnt lgkmcnt(6)
    v_mfma_f32_16x16x32_bf16 v[52:55], v[20:23], a[160:163], v[52:55]
    ds_read_b128 v[48:51], v11 offset:47104
    v_mfma_f32_16x16x32_bf16 v[60:63], v[20:23], a[164:167], v[60:63]
    s_waitcnt lgkmcnt(6)
    v_mfma_f32_16x16x32_bf16 v[56:59], v[24:27], a[160:163], v[56:59]
    ds_read_b128 v[20:23], v10 offset:49152
    s_add_u32 m0, s19, 125056
    v_mfma_f32_16x16x32_bf16 v[64:67], v[24:27], a[164:167], v[64:67]
    buffer_load_dwordx4 v2, s[8:11], s20 offen offset:1920 lds
    s_waitcnt lgkmcnt(6)
    v_mfma_f32_16x16x32_bf16 v[52:55], v[28:31], a[168:171], v[52:55]
    ds_read_b128 v[24:27], v10 offset:51200
    v_mfma_f32_16x16x32_bf16 v[60:63], v[28:31], a[172:175], v[60:63]
    s_add_u32 s20, s20, s24
    s_waitcnt lgkmcnt(6)
    v_mfma_f32_16x16x32_bf16 v[56:59], v[32:35], a[168:171], v[56:59]
    ds_read_b128 v[28:31], v11 offset:49152
    v_mfma_f32_16x16x32_bf16 v[64:67], v[32:35], a[172:175], v[64:67]
    s_waitcnt lgkmcnt(6)
    v_mfma_f32_16x16x32_bf16 v[52:55], v[36:39], a[176:179], v[52:55]
    ds_read_b128 v[32:35], v11 offset:51200
    v_mfma_f32_16x16x32_bf16 v[60:63], v[36:39], a[180:183], v[60:63]
    s_waitcnt lgkmcnt(6)
    v_mfma_f32_16x16x32_bf16 v[56:59], v[40:43], a[176:179], v[56:59]
    ds_read_b128 v[36:39], v10 offset:53248
    v_mfma_f32_16x16x32_bf16 v[64:67], v[40:43], a[180:183], v[64:67]
    s_waitcnt lgkmcnt(6)
    v_mfma_f32_16x16x32_bf16 v[52:55], v[44:47], a[184:187], v[52:55]
    ds_read_b128 v[40:43], v10 offset:55296
    v_mfma_f32_16x16x32_bf16 v[60:63], v[44:47], a[188:191], v[60:63]
    s_waitcnt lgkmcnt(6)
    v_mfma_f32_16x16x32_bf16 v[56:59], v[48:51], a[184:187], v[56:59]
    ds_read_b128 v[44:47], v11 offset:53248
    v_mfma_f32_16x16x32_bf16 v[64:67], v[48:51], a[188:191], v[64:67]
    s_waitcnt lgkmcnt(6)
    v_mfma_f32_16x16x32_bf16 v[52:55], v[20:23], a[192:195], v[52:55]
    ds_read_b128 v[48:51], v11 offset:55296
    v_mfma_f32_16x16x32_bf16 v[60:63], v[20:23], a[196:199], v[60:63]
    s_waitcnt lgkmcnt(6)
    v_mfma_f32_16x16x32_bf16 v[56:59], v[24:27], a[192:195], v[56:59]
    ds_read_b128 v[20:23], v10 offset:57344
    v_mfma_f32_16x16x32_bf16 v[64:67], v[24:27], a[196:199], v[64:67]
    s_waitcnt lgkmcnt(6)
    v_mfma_f32_16x16x32_bf16 v[52:55], v[28:31], a[200:203], v[52:55]
    ds_read_b128 v[24:27], v10 offset:59392
    v_mfma_f32_16x16x32_bf16 v[60:63], v[28:31], a[204:207], v[60:63]
    s_waitcnt lgkmcnt(6)
    v_mfma_f32_16x16x32_bf16 v[56:59], v[32:35], a[200:203], v[56:59]
    ds_read_b128 v[28:31], v11 offset:57344
    v_mfma_f32_16x16x32_bf16 v[64:67], v[32:35], a[204:207], v[64:67]
    s_waitcnt lgkmcnt(6)
    v_mfma_f32_16x16x32_bf16 v[52:55], v[36:39], a[208:211], v[52:55]
    ds_read_b128 v[32:35], v11 offset:59392
    v_mfma_f32_16x16x32_bf16 v[60:63], v[36:39], a[212:215], v[60:63]
    s_waitcnt lgkmcnt(6)
    v_mfma_f32_16x16x32_bf16 v[56:59], v[40:43], a[208:211], v[56:59]
    ds_read_b128 v[36:39], v10 offset:61440
    v_mfma_f32_16x16x32_bf16 v[64:67], v[40:43], a[212:215], v[64:67]
    s_waitcnt lgkmcnt(6)
    v_mfma_f32_16x16x32_bf16 v[52:55], v[44:47], a[216:219], v[52:55]
    ds_read_b128 v[40:43], v10 offset:63488
    v_mfma_f32_16x16x32_bf16 v[60:63], v[44:47], a[220:223], v[60:63]
    s_waitcnt lgkmcnt(6)
    v_mfma_f32_16x16x32_bf16 v[56:59], v[48:51], a[216:219], v[56:59]
    ds_read_b128 v[44:47], v11 offset:61440
    v_mfma_f32_16x16x32_bf16 v[64:67], v[48:51], a[220:223], v[64:67]
    s_waitcnt lgkmcnt(6)
    v_mfma_f32_16x16x32_bf16 v[52:55], v[20:23], a[224:227], v[52:55]
    ds_read_b128 v[48:51], v11 offset:63488
    v_mfma_f32_16x16x32_bf16 v[60:63], v[20:23], a[228:231], v[60:63]
    s_waitcnt lgkmcnt(6)
    v_mfma_f32_16x16x32_bf16 v[56:59], v[24:27], a[224:227], v[56:59]
    s_waitcnt vmcnt(8)
    s_barrier
    ds_read_b128 v[20:23], v12 offset:0
    v_mfma_f32_16x16x32_bf16 v[64:67], v[24:27], a[228:231], v[64:67]
    s_waitcnt lgkmcnt(6)
    v_mfma_f32_16x16x32_bf16 v[52:55], v[28:31], a[232:235], v[52:55]
    ds_read_b128 v[24:27], v12 offset:2048
    s_add_u32 m0, s19, 0
    v_mfma_f32_16x16x32_bf16 v[60:63], v[28:31], a[236:239], v[60:63]
    buffer_load_dwordx4 v2, s[8:11], s20 offen offset:0 lds
    s_waitcnt lgkmcnt(6)
    v_mfma_f32_16x16x32_bf16 v[56:59], v[32:35], a[232:235], v[56:59]
    ds_read_b128 v[28:31], v13 offset:0
    v_mfma_f32_16x16x32_bf16 v[64:67], v[32:35], a[236:239], v[64:67]
    s_waitcnt lgkmcnt(6)
    v_mfma_f32_16x16x32_bf16 v[52:55], v[36:39], a[240:243], v[52:55]
    ds_read_b128 v[32:35], v13 offset:2048
    s_add_u32 m0, s19, 3968
    v_mfma_f32_16x16x32_bf16 v[60:63], v[36:39], a[244:247], v[60:63]
    buffer_load_dwordx4 v2, s[8:11], s20 offen offset:128 lds
    s_waitcnt lgkmcnt(6)
    v_mfma_f32_16x16x32_bf16 v[56:59], v[40:43], a[240:243], v[56:59]
    ds_read_b128 v[36:39], v12 offset:4096
    v_mfma_f32_16x16x32_bf16 v[64:67], v[40:43], a[244:247], v[64:67]
    s_waitcnt lgkmcnt(6)
    v_mfma_f32_16x16x32_bf16 v[52:55], v[44:47], a[248:251], v[52:55]
    ds_read_b128 v[40:43], v12 offset:6144
    s_add_u32 m0, s19, 7936
    v_mfma_f32_16x16x32_bf16 v[60:63], v[44:47], a[252:255], v[60:63]
    buffer_load_dwordx4 v2, s[8:11], s20 offen offset:256 lds
    s_waitcnt lgkmcnt(6)
    v_mfma_f32_16x16x32_bf16 v[56:59], v[48:51], a[248:251], v[56:59]
    ds_read_b128 v[44:47], v13 offset:4096
    v_mfma_f32_16x16x32_bf16 v[64:67], v[48:51], a[252:255], v[64:67]
    s_waitcnt lgkmcnt(6)
    v_mfma_f32_16x16x32_bf16 v[68:71], v[20:23], a[0:3], 0
    ds_read_b128 v[48:51], v13 offset:6144
    v_mfma_f32_16x16x32_bf16 v[76:79], v[20:23], a[4:7], 0
    s_waitcnt lgkmcnt(6)
    v_mfma_f32_16x16x32_bf16 v[72:75], v[24:27], a[0:3], 0
    ds_read_b128 v[20:23], v12 offset:8192
    s_add_u32 m0, s19, 11904
    v_mfma_f32_16x16x32_bf16 v[80:83], v[24:27], a[4:7], 0
    buffer_load_dwordx4 v2, s[8:11], s20 offen offset:384 lds
    s_waitcnt lgkmcnt(6)
    v_mfma_f32_16x16x32_bf16 v[68:71], v[28:31], a[8:11], v[68:71]
    ds_read_b128 v[24:27], v12 offset:10240
    v_mfma_f32_16x16x32_bf16 v[76:79], v[28:31], a[12:15], v[76:79]
    s_waitcnt lgkmcnt(6)
    v_mfma_f32_16x16x32_bf16 v[72:75], v[32:35], a[8:11], v[72:75]
    ds_read_b128 v[28:31], v13 offset:8192
    s_add_u32 m0, s19, 15872
    v_mfma_f32_16x16x32_bf16 v[80:83], v[32:35], a[12:15], v[80:83]
    buffer_load_dwordx4 v2, s[8:11], s20 offen offset:512 lds
    s_waitcnt lgkmcnt(6)
    v_mfma_f32_16x16x32_bf16 v[68:71], v[36:39], a[16:19], v[68:71]
    ds_read_b128 v[32:35], v13 offset:10240
    v_mfma_f32_16x16x32_bf16 v[76:79], v[36:39], a[20:23], v[76:79]
    s_waitcnt lgkmcnt(6)
    v_mfma_f32_16x16x32_bf16 v[72:75], v[40:43], a[16:19], v[72:75]
    ds_read_b128 v[36:39], v12 offset:12288
    s_add_u32 m0, s19, 19840
    v_mfma_f32_16x16x32_bf16 v[80:83], v[40:43], a[20:23], v[80:83]
    buffer_load_dwordx4 v2, s[8:11], s20 offen offset:640 lds
    s_waitcnt lgkmcnt(6)
    v_mfma_f32_16x16x32_bf16 v[68:71], v[44:47], a[24:27], v[68:71]
    ds_read_b128 v[40:43], v12 offset:14336
    v_mfma_f32_16x16x32_bf16 v[76:79], v[44:47], a[28:31], v[76:79]
    s_waitcnt lgkmcnt(6)
    v_mfma_f32_16x16x32_bf16 v[72:75], v[48:51], a[24:27], v[72:75]
    ds_read_b128 v[44:47], v13 offset:12288
    s_add_u32 m0, s19, 23808
    v_mfma_f32_16x16x32_bf16 v[80:83], v[48:51], a[28:31], v[80:83]
    buffer_load_dwordx4 v2, s[8:11], s20 offen offset:768 lds
    s_waitcnt lgkmcnt(6)
    v_mfma_f32_16x16x32_bf16 v[68:71], v[20:23], a[32:35], v[68:71]
    ds_read_b128 v[48:51], v13 offset:14336
    v_mfma_f32_16x16x32_bf16 v[76:79], v[20:23], a[36:39], v[76:79]
    s_waitcnt lgkmcnt(6)
    v_mfma_f32_16x16x32_bf16 v[72:75], v[24:27], a[32:35], v[72:75]
    ds_read_b128 v[20:23], v12 offset:16384
    s_add_u32 m0, s19, 27776
    v_mfma_f32_16x16x32_bf16 v[80:83], v[24:27], a[36:39], v[80:83]
    buffer_load_dwordx4 v2, s[8:11], s20 offen offset:896 lds
    s_waitcnt lgkmcnt(6)
    v_mfma_f32_16x16x32_bf16 v[68:71], v[28:31], a[40:43], v[68:71]
    ds_read_b128 v[24:27], v12 offset:18432
    v_mfma_f32_16x16x32_bf16 v[76:79], v[28:31], a[44:47], v[76:79]
    v_cvt_pk_bf16_f32 v84, v52, v53
    s_waitcnt lgkmcnt(6)
    v_mfma_f32_16x16x32_bf16 v[72:75], v[32:35], a[40:43], v[72:75]
    ds_read_b128 v[28:31], v13 offset:16384
    v_mfma_f32_16x16x32_bf16 v[80:83], v[32:35], a[44:47], v[80:83]
    v_cvt_pk_bf16_f32 v85, v54, v55
    s_waitcnt lgkmcnt(6)
    v_mfma_f32_16x16x32_bf16 v[68:71], v[36:39], a[48:51], v[68:71]
    ds_read_b128 v[32:35], v13 offset:18432
    v_mfma_f32_16x16x32_bf16 v[76:79], v[36:39], a[52:55], v[76:79]
    v_cvt_pk_bf16_f32 v86, v56, v57
    s_waitcnt lgkmcnt(6)
    v_mfma_f32_16x16x32_bf16 v[72:75], v[40:43], a[48:51], v[72:75]
    ds_read_b128 v[36:39], v12 offset:20480
    v_mfma_f32_16x16x32_bf16 v[80:83], v[40:43], a[52:55], v[80:83]
    v_cvt_pk_bf16_f32 v87, v58, v59
    s_waitcnt lgkmcnt(6)
    v_mfma_f32_16x16x32_bf16 v[68:71], v[44:47], a[56:59], v[68:71]
    ds_read_b128 v[40:43], v12 offset:22528
    v_mfma_f32_16x16x32_bf16 v[76:79], v[44:47], a[60:63], v[76:79]
    v_cvt_pk_bf16_f32 v88, v60, v61
    s_waitcnt lgkmcnt(6)
    v_mfma_f32_16x16x32_bf16 v[72:75], v[48:51], a[56:59], v[72:75]
    ds_read_b128 v[44:47], v13 offset:20480
    v_mfma_f32_16x16x32_bf16 v[80:83], v[48:51], a[60:63], v[80:83]
    v_cvt_pk_bf16_f32 v89, v62, v63
    buffer_store_dwordx4 v[84:87], v3, s[4:7], s21 offen offset:0 sc1
    s_waitcnt lgkmcnt(6)
    v_mfma_f32_16x16x32_bf16 v[68:71], v[20:23], a[64:67], v[68:71]
    ds_read_b128 v[48:51], v13 offset:22528
    v_mfma_f32_16x16x32_bf16 v[76:79], v[20:23], a[68:71], v[76:79]
    v_cvt_pk_bf16_f32 v90, v64, v65
    s_waitcnt lgkmcnt(6)
    v_mfma_f32_16x16x32_bf16 v[72:75], v[24:27], a[64:67], v[72:75]
    ds_read_b128 v[20:23], v12 offset:24576
    v_mfma_f32_16x16x32_bf16 v[80:83], v[24:27], a[68:71], v[80:83]
    v_cvt_pk_bf16_f32 v91, v66, v67
    s_waitcnt lgkmcnt(6)
    v_mfma_f32_16x16x32_bf16 v[68:71], v[28:31], a[72:75], v[68:71]
    ds_read_b128 v[24:27], v12 offset:26624
    v_mfma_f32_16x16x32_bf16 v[76:79], v[28:31], a[76:79], v[76:79]
    s_waitcnt lgkmcnt(6)
    v_mfma_f32_16x16x32_bf16 v[72:75], v[32:35], a[72:75], v[72:75]
    ds_read_b128 v[28:31], v13 offset:24576
    v_mfma_f32_16x16x32_bf16 v[80:83], v[32:35], a[76:79], v[80:83]
    buffer_store_dwordx4 v[88:91], v3, s[4:7], s21 offen offset:256 sc1
    s_waitcnt lgkmcnt(6)
    v_mfma_f32_16x16x32_bf16 v[68:71], v[36:39], a[80:83], v[68:71]
    ds_read_b128 v[32:35], v13 offset:26624
    v_mfma_f32_16x16x32_bf16 v[76:79], v[36:39], a[84:87], v[76:79]
    s_add_u32 s21, s21, s25
    s_mov_b32 s25, s26
    s_waitcnt lgkmcnt(6)
    v_mfma_f32_16x16x32_bf16 v[72:75], v[40:43], a[80:83], v[72:75]
    ds_read_b128 v[36:39], v12 offset:28672
    v_mfma_f32_16x16x32_bf16 v[80:83], v[40:43], a[84:87], v[80:83]
    s_waitcnt lgkmcnt(6)
    v_mfma_f32_16x16x32_bf16 v[68:71], v[44:47], a[88:91], v[68:71]
    ds_read_b128 v[40:43], v12 offset:30720
    v_mfma_f32_16x16x32_bf16 v[76:79], v[44:47], a[92:95], v[76:79]
    s_waitcnt lgkmcnt(6)
    v_mfma_f32_16x16x32_bf16 v[72:75], v[48:51], a[88:91], v[72:75]
    ds_read_b128 v[44:47], v13 offset:28672
    v_mfma_f32_16x16x32_bf16 v[80:83], v[48:51], a[92:95], v[80:83]
    s_waitcnt lgkmcnt(6)
    v_mfma_f32_16x16x32_bf16 v[68:71], v[20:23], a[96:99], v[68:71]
    ds_read_b128 v[48:51], v13 offset:30720
    v_mfma_f32_16x16x32_bf16 v[76:79], v[20:23], a[100:103], v[76:79]
    s_waitcnt lgkmcnt(6)
    v_mfma_f32_16x16x32_bf16 v[72:75], v[24:27], a[96:99], v[72:75]
    s_waitcnt vmcnt(10)
    s_barrier
    ds_read_b128 v[20:23], v12 offset:32768
    v_mfma_f32_16x16x32_bf16 v[80:83], v[24:27], a[100:103], v[80:83]
    s_waitcnt lgkmcnt(6)
    v_mfma_f32_16x16x32_bf16 v[68:71], v[28:31], a[104:107], v[68:71]
    ds_read_b128 v[24:27], v12 offset:34816
    s_add_u32 m0, s19, 31744
    v_mfma_f32_16x16x32_bf16 v[76:79], v[28:31], a[108:111], v[76:79]
    buffer_load_dwordx4 v2, s[8:11], s20 offen offset:1024 lds
    s_waitcnt lgkmcnt(6)
    v_mfma_f32_16x16x32_bf16 v[72:75], v[32:35], a[104:107], v[72:75]
    ds_read_b128 v[28:31], v13 offset:32768
    v_mfma_f32_16x16x32_bf16 v[80:83], v[32:35], a[108:111], v[80:83]
    s_waitcnt lgkmcnt(6)
    v_mfma_f32_16x16x32_bf16 v[68:71], v[36:39], a[112:115], v[68:71]
    ds_read_b128 v[32:35], v13 offset:34816
    s_add_u32 m0, s19, 35712
    v_mfma_f32_16x16x32_bf16 v[76:79], v[36:39], a[116:119], v[76:79]
    buffer_load_dwordx4 v2, s[8:11], s20 offen offset:1152 lds
    s_waitcnt lgkmcnt(6)
    v_mfma_f32_16x16x32_bf16 v[72:75], v[40:43], a[112:115], v[72:75]
    ds_read_b128 v[36:39], v12 offset:36864
    v_mfma_f32_16x16x32_bf16 v[80:83], v[40:43], a[116:119], v[80:83]
    s_waitcnt lgkmcnt(6)
    v_mfma_f32_16x16x32_bf16 v[68:71], v[44:47], a[120:123], v[68:71]
    ds_read_b128 v[40:43], v12 offset:38912
    s_add_u32 m0, s19, 39680
    v_mfma_f32_16x16x32_bf16 v[76:79], v[44:47], a[124:127], v[76:79]
    buffer_load_dwordx4 v2, s[8:11], s20 offen offset:1280 lds
    s_waitcnt lgkmcnt(6)
    v_mfma_f32_16x16x32_bf16 v[72:75], v[48:51], a[120:123], v[72:75]
    ds_read_b128 v[44:47], v13 offset:36864
    v_mfma_f32_16x16x32_bf16 v[80:83], v[48:51], a[124:127], v[80:83]
    s_waitcnt lgkmcnt(6)
    v_mfma_f32_16x16x32_bf16 v[68:71], v[20:23], a[128:131], v[68:71]
    ds_read_b128 v[48:51], v13 offset:38912
    v_mfma_f32_16x16x32_bf16 v[76:79], v[20:23], a[132:135], v[76:79]
    s_waitcnt lgkmcnt(6)
    v_mfma_f32_16x16x32_bf16 v[72:75], v[24:27], a[128:131], v[72:75]
    ds_read_b128 v[20:23], v12 offset:40960
    s_add_u32 m0, s19, 43648
    v_mfma_f32_16x16x32_bf16 v[80:83], v[24:27], a[132:135], v[80:83]
    buffer_load_dwordx4 v2, s[8:11], s20 offen offset:1408 lds
    s_waitcnt lgkmcnt(6)
    v_mfma_f32_16x16x32_bf16 v[68:71], v[28:31], a[136:139], v[68:71]
    ds_read_b128 v[24:27], v12 offset:43008
    v_mfma_f32_16x16x32_bf16 v[76:79], v[28:31], a[140:143], v[76:79]
    s_waitcnt lgkmcnt(6)
    v_mfma_f32_16x16x32_bf16 v[72:75], v[32:35], a[136:139], v[72:75]
    ds_read_b128 v[28:31], v13 offset:40960
    s_add_u32 m0, s19, 47616
    v_mfma_f32_16x16x32_bf16 v[80:83], v[32:35], a[140:143], v[80:83]
    buffer_load_dwordx4 v2, s[8:11], s20 offen offset:1536 lds
    s_waitcnt lgkmcnt(6)
    v_mfma_f32_16x16x32_bf16 v[68:71], v[36:39], a[144:147], v[68:71]
    ds_read_b128 v[32:35], v13 offset:43008
    v_mfma_f32_16x16x32_bf16 v[76:79], v[36:39], a[148:151], v[76:79]
    s_waitcnt lgkmcnt(6)
    v_mfma_f32_16x16x32_bf16 v[72:75], v[40:43], a[144:147], v[72:75]
    ds_read_b128 v[36:39], v12 offset:45056
    s_add_u32 m0, s19, 51584
    v_mfma_f32_16x16x32_bf16 v[80:83], v[40:43], a[148:151], v[80:83]
    buffer_load_dwordx4 v2, s[8:11], s20 offen offset:1664 lds
    s_waitcnt lgkmcnt(6)
    v_mfma_f32_16x16x32_bf16 v[68:71], v[44:47], a[152:155], v[68:71]
    ds_read_b128 v[40:43], v12 offset:47104
    v_mfma_f32_16x16x32_bf16 v[76:79], v[44:47], a[156:159], v[76:79]
    s_waitcnt lgkmcnt(6)
    v_mfma_f32_16x16x32_bf16 v[72:75], v[48:51], a[152:155], v[72:75]
    ds_read_b128 v[44:47], v13 offset:45056
    s_add_u32 m0, s19, 55552
    v_mfma_f32_16x16x32_bf16 v[80:83], v[48:51], a[156:159], v[80:83]
    buffer_load_dwordx4 v2, s[8:11], s20 offen offset:1792 lds
    s_waitcnt lgkmcnt(6)
    v_mfma_f32_16x16x32_bf16 v[68:71], v[20:23], a[160:163], v[68:71]
    ds_read_b128 v[48:51], v13 offset:47104
    v_mfma_f32_16x16x32_bf16 v[76:79], v[20:23], a[164:167], v[76:79]
    s_waitcnt lgkmcnt(6)
    v_mfma_f32_16x16x32_bf16 v[72:75], v[24:27], a[160:163], v[72:75]
    ds_read_b128 v[20:23], v12 offset:49152
    s_add_u32 m0, s19, 59520
    v_mfma_f32_16x16x32_bf16 v[80:83], v[24:27], a[164:167], v[80:83]
    buffer_load_dwordx4 v2, s[8:11], s20 offen offset:1920 lds
    s_waitcnt lgkmcnt(6)
    v_mfma_f32_16x16x32_bf16 v[68:71], v[28:31], a[168:171], v[68:71]
    ds_read_b128 v[24:27], v12 offset:51200
    v_mfma_f32_16x16x32_bf16 v[76:79], v[28:31], a[172:175], v[76:79]
    s_add_u32 s20, s20, s24
    s_waitcnt lgkmcnt(6)
    v_mfma_f32_16x16x32_bf16 v[72:75], v[32:35], a[168:171], v[72:75]
    ds_read_b128 v[28:31], v13 offset:49152
    v_mfma_f32_16x16x32_bf16 v[80:83], v[32:35], a[172:175], v[80:83]
    s_waitcnt lgkmcnt(6)
    v_mfma_f32_16x16x32_bf16 v[68:71], v[36:39], a[176:179], v[68:71]
    ds_read_b128 v[32:35], v13 offset:51200
    v_mfma_f32_16x16x32_bf16 v[76:79], v[36:39], a[180:183], v[76:79]
    s_waitcnt lgkmcnt(6)
    v_mfma_f32_16x16x32_bf16 v[72:75], v[40:43], a[176:179], v[72:75]
    ds_read_b128 v[36:39], v12 offset:53248
    v_mfma_f32_16x16x32_bf16 v[80:83], v[40:43], a[180:183], v[80:83]
    s_waitcnt lgkmcnt(6)
    v_mfma_f32_16x16x32_bf16 v[68:71], v[44:47], a[184:187], v[68:71]
    ds_read_b128 v[40:43], v12 offset:55296
    v_mfma_f32_16x16x32_bf16 v[76:79], v[44:47], a[188:191], v[76:79]
    s_waitcnt lgkmcnt(6)
    v_mfma_f32_16x16x32_bf16 v[72:75], v[48:51], a[184:187], v[72:75]
    ds_read_b128 v[44:47], v13 offset:53248
    v_mfma_f32_16x16x32_bf16 v[80:83], v[48:51], a[188:191], v[80:83]
    s_waitcnt lgkmcnt(6)
    v_mfma_f32_16x16x32_bf16 v[68:71], v[20:23], a[192:195], v[68:71]
    ds_read_b128 v[48:51], v13 offset:55296
    v_mfma_f32_16x16x32_bf16 v[76:79], v[20:23], a[196:199], v[76:79]
    s_waitcnt lgkmcnt(6)
    v_mfma_f32_16x16x32_bf16 v[72:75], v[24:27], a[192:195], v[72:75]
    ds_read_b128 v[20:23], v12 offset:57344
    v_mfma_f32_16x16x32_bf16 v[80:83], v[24:27], a[196:199], v[80:83]
    s_waitcnt lgkmcnt(6)
    v_mfma_f32_16x16x32_bf16 v[68:71], v[28:31], a[200:203], v[68:71]
    ds_read_b128 v[24:27], v12 offset:59392
    v_mfma_f32_16x16x32_bf16 v[76:79], v[28:31], a[204:207], v[76:79]
    s_waitcnt lgkmcnt(6)
    v_mfma_f32_16x16x32_bf16 v[72:75], v[32:35], a[200:203], v[72:75]
    ds_read_b128 v[28:31], v13 offset:57344
    v_mfma_f32_16x16x32_bf16 v[80:83], v[32:35], a[204:207], v[80:83]
    s_waitcnt lgkmcnt(6)
    v_mfma_f32_16x16x32_bf16 v[68:71], v[36:39], a[208:211], v[68:71]
    ds_read_b128 v[32:35], v13 offset:59392
    v_mfma_f32_16x16x32_bf16 v[76:79], v[36:39], a[212:215], v[76:79]
    s_waitcnt lgkmcnt(6)
    v_mfma_f32_16x16x32_bf16 v[72:75], v[40:43], a[208:211], v[72:75]
    ds_read_b128 v[36:39], v12 offset:61440
    v_mfma_f32_16x16x32_bf16 v[80:83], v[40:43], a[212:215], v[80:83]
    s_waitcnt lgkmcnt(6)
    v_mfma_f32_16x16x32_bf16 v[68:71], v[44:47], a[216:219], v[68:71]
    ds_read_b128 v[40:43], v12 offset:63488
    v_mfma_f32_16x16x32_bf16 v[76:79], v[44:47], a[220:223], v[76:79]
    s_waitcnt lgkmcnt(6)
    v_mfma_f32_16x16x32_bf16 v[72:75], v[48:51], a[216:219], v[72:75]
    ds_read_b128 v[44:47], v13 offset:61440
    v_mfma_f32_16x16x32_bf16 v[80:83], v[48:51], a[220:223], v[80:83]
    s_waitcnt lgkmcnt(6)
    v_mfma_f32_16x16x32_bf16 v[68:71], v[20:23], a[224:227], v[68:71]
    ds_read_b128 v[48:51], v13 offset:63488
    v_mfma_f32_16x16x32_bf16 v[76:79], v[20:23], a[228:231], v[76:79]
    s_waitcnt lgkmcnt(6)
    v_mfma_f32_16x16x32_bf16 v[72:75], v[24:27], a[224:227], v[72:75]
    s_waitcnt vmcnt(8)
    s_barrier
    ds_read_b128 v[20:23], v10 offset:0
    v_mfma_f32_16x16x32_bf16 v[80:83], v[24:27], a[228:231], v[80:83]
    s_waitcnt lgkmcnt(6)
    v_mfma_f32_16x16x32_bf16 v[68:71], v[28:31], a[232:235], v[68:71]
    ds_read_b128 v[24:27], v10 offset:2048
    s_add_u32 m0, s19, 65536
    v_mfma_f32_16x16x32_bf16 v[76:79], v[28:31], a[236:239], v[76:79]
    buffer_load_dwordx4 v2, s[8:11], s20 offen offset:0 lds
    s_waitcnt lgkmcnt(6)
    v_mfma_f32_16x16x32_bf16 v[72:75], v[32:35], a[232:235], v[72:75]
    ds_read_b128 v[28:31], v11 offset:0
    v_mfma_f32_16x16x32_bf16 v[80:83], v[32:35], a[236:239], v[80:83]
    s_waitcnt lgkmcnt(6)
    v_mfma_f32_16x16x32_bf16 v[68:71], v[36:39], a[240:243], v[68:71]
    ds_read_b128 v[32:35], v11 offset:2048
    s_add_u32 m0, s19, 69504
    v_mfma_f32_16x16x32_bf16 v[76:79], v[36:39], a[244:247], v[76:79]
    buffer_load_dwordx4 v2, s[8:11], s20 offen offset:128 lds
    s_waitcnt lgkmcnt(6)
    v_mfma_f32_16x16x32_bf16 v[72:75], v[40:43], a[240:243], v[72:75]
    ds_read_b128 v[36:39], v10 offset:4096
    v_mfma_f32_16x16x32_bf16 v[80:83], v[40:43], a[244:247], v[80:83]
    s_waitcnt lgkmcnt(6)
    v_mfma_f32_16x16x32_bf16 v[68:71], v[44:47], a[248:251], v[68:71]
    ds_read_b128 v[40:43], v10 offset:6144
    s_add_u32 m0, s19, 73472
    v_mfma_f32_16x16x32_bf16 v[76:79], v[44:47], a[252:255], v[76:79]
    buffer_load_dwordx4 v2, s[8:11], s20 offen offset:256 lds
    s_waitcnt lgkmcnt(6)
    v_mfma_f32_16x16x32_bf16 v[72:75], v[48:51], a[248:251], v[72:75]
    ds_read_b128 v[44:47], v11 offset:4096
    v_mfma_f32_16x16x32_bf16 v[80:83], v[48:51], a[252:255], v[80:83]
    s_add_u32 s22, s22, 2
    s_cmp_lt_u32 s22, 16
    s_cbranch_scc1 F1_top
    v_cvt_pk_bf16_f32 v84, v68, v69
    v_cvt_pk_bf16_f32 v85, v70, v71
    s_nop 0
    v_cvt_pk_bf16_f32 v86, v72, v73
    v_cvt_pk_bf16_f32 v87, v74, v75
    v_cvt_pk_bf16_f32 v88, v76, v77
    v_cvt_pk_bf16_f32 v89, v78, v79
    v_cvt_pk_bf16_f32 v90, v80, v81
    v_cvt_pk_bf16_f32 v91, v82, v83
    buffer_store_dwordx4 v[84:87], v3, s[4:7], s21 offen offset:0 sc1
    buffer_store_dwordx4 v[88:91], v3, s[4:7], s21 offen offset:256 sc1
    s_waitcnt vmcnt(0) lgkmcnt(0)
    v_lshlrev_b32 v5, 2, v1
    s_mov_b32 s18, 0
rdv_19:
    global_load_dword v6, v5, s[100:101] sc1
    s_waitcnt vmcnt(0)
rdv_19p:
    s_lshl_b32 s17, s98, 2
    v_lshrrev_b32 v9, s17, v6
    s_cmp_eq_u32 s98, 0
    s_cselect_b32 s17, 0x0f0f0f0f, s17
    s_cselect_b32 s17, s17, 0x01010101
    v_and_b32 v9, s17, v9
    v_cmp_ne_u32 vcc, 0x01010101, v9
    s_nop 0
    s_cbranch_vccz rdvok_20
    v_sad_u8 v9, v9, 0, 0
    s_nop 1
    v_add_u32_dpp v9, v9, v9 quad_perm:[1,0,3,2] row_mask:0xf bank_mask:0xf
    v_cmp_ne_u32 vcc, 8, v9
    s_nop 0
    s_cbranch_vccnz rdvw_21
    s_mov_b32 s98, 1
    s_and_b32 s3, s97, 7
    s_waitcnt vmcnt(0) lgkmcnt(0)
    s_barrier
    s_branch role_start
rdvw_21:
    s_sleep 4
    s_add_u32 s18, s18, 1
    s_cmp_lt_u32 s18, 262144
    s_cbranch_scc1 rdv_19
    s_mov_b32 s92, 1048576
rdvok_20:
    v_and_b32 v9, 0x40404040, v6
    v_bcnt_u32_b32 v9, v9, 0
    s_mov_b32 s89, 0
    v_cmp_le_u32 vcc, 1, v9
    s_nop 0
    s_bcnt1_i32_b64 s17, vcc
    s_add_u32 s89, s89, s17
    v_cmp_le_u32 vcc, 2, v9
    s_nop 0
    s_bcnt1_i32_b64 s17, vcc
    s_add_u32 s89, s89, s17
    v_cmp_le_u32 vcc, 3, v9
    s_nop 0
    s_bcnt1_i32_b64 s17, vcc
    s_add_u32 s89, s89, s17
    v_cmp_le_u32 vcc, 4, v9
    s_nop 0
    s_bcnt1_i32_b64 s17, vcc
    s_add_u32 s89, s89, s17
    s_cmp_gt_u32 s89, 16
    s_cselect_b32 s89, 8192, 0
    s_barrier
    s_lshl_b32 s31, s29, 2
    s_add_u32 s31, s31, s28
    s_lshl_b32 s17, s31, 7
    s_add_u32 s17, s17, 100745216
    v_lshl_add_u32 v5, v1, 2, s17
    v_mov_b32 v6, 1
    s_mov_b64 exec, 0xffffffff
    buffer_store_dword v6, v5, s[4:7], 0 offen sc1
    s_mov_b64 exec, -1
    v_and_b32 v10, 19, v1
    v_bfe_u32 v5, v1, 2, 1
    v_bfe_u32 v6, v1, 3, 1
    v_lshl_add_u32 v10, v5, 3, v10
    v_lshl_add_u32 v10, v6, 2, v10
    v_lshrrev_b32 v8, 1, v1
    v_and_b32 v19, 19, v8
    v_bfe_u32 v5, v8, 2, 1
    v_bfe_u32 v6, v8, 3, 1
    v_lshl_add_u32 v19, v5, 3, v19
    v_lshl_add_u32 v19, v6, 2, v19
    s_load_dwordx2 s[12:13], s[0:1], 80
    s_mov_b32 s14, 8388608
    s_mov_b32 s15, 0x20000
    v_lshrrev_b32 v11, 5, v1
    v_lshl_add_u32 v12, v11, 9, v10
    v_mul_u32_u24 v12, 1026, v12
    v_and_b32 v13, 1, v1
    v_lshlrev_b32 v13, 4, v13
    v_lshlrev_b32 v14, 4, v1
    s_lshr_b32 s17, s16, 1
    s_and_b32 s18, s16, 1
    s_lshl_b32 s17, s17, 5
    s_lshl_b32 s18, s18, 10
    s_add_u32 s17, s17, s18
    s_mul_i32 s20, s17, 1026
    s_lshl_b32 s17, s93, 5
    s_add_u32 s20, s20, s17
    v_mul_u32_u24 v19, 1026, v19
    v_add_u32 v19, v19, v13
    s_mov_b32 s32, 0x05040100
    s_mov_b32 s33, 0x07060302
    v_cvt_f32_u32 v16, v10
    v_lshlrev_b32 v17, 3, v11
    v_cvt_f32_u32 v17, v17
    s_add_u32 s17, s20, 0
    buffer_load_dwordx4 v[60:63], v19, s[48:51], s17 offen
    v_add_f32 v5, 0, v16
    v_mul_f32 v5, 1015021568, v5
    v_mul_f32 v6, v5, v17
    v_mul_f32 v7, 0x41800000, v5
    v_fract_f32 v32, v6
    v_add_f32 v33, v32, v5
    v_add_f32 v34, v33, v5
    v_add_f32 v35, v34, v5
    v_add_f32 v36, v35, v5
    v_add_f32 v37, v36, v5
    v_add_f32 v38, v37, v5
    v_add_f32 v39, v38, v5
    v_add_f32 v6, v32, v7
    v_cos_f32 v40, v32
    v_sin_f32 v48, v32
    v_cos_f32 v41, v33
    buffer_load_dwordx4 v[64:67], v19, s[52:55], s17 offen
    v_sin_f32 v49, v33
    v_cos_f32 v42, v34
    v_sin_f32 v50, v34
    v_cos_f32 v43, v35
    v_sin_f32 v51, v35
    v_cos_f32 v44, v36
    v_sin_f32 v52, v36
    v_cos_f32 v45, v37
    v_sin_f32 v53, v37
    v_cos_f32 v46, v38
    v_sin_f32 v54, v38
    v_cos_f32 v47, v39
    v_sin_f32 v55, v39
    v_cvt_pk_bf16_f32 v56, v40, v41
    v_cvt_pk_bf16_f32 v57, v48, v49
    v_accvgpr_write_b32 a0, v56
    v_xor_b32 v58, 0x80008000, v57
    s_add_u32 s17, s20, 131328
    buffer_load_dwordx4 v[68:71], v19, s[48:51], s17 offen
    v_accvgpr_write_b32 a32, v57
    v_accvgpr_write_b32 a64, v58
    v_cvt_pk_bf16_f32 v56, v42, v43
    v_cvt_pk_bf16_f32 v57, v50, v51
    v_accvgpr_write_b32 a1, v56
    v_xor_b32 v58, 0x80008000, v57
    v_accvgpr_write_b32 a33, v57
    v_accvgpr_write_b32 a65, v58
    v_cvt_pk_bf16_f32 v56, v44, v45
    v_cvt_pk_bf16_f32 v57, v52, v53
    v_accvgpr_write_b32 a2, v56
    v_xor_b32 v58, 0x80008000, v57
    v_accvgpr_write_b32 a34, v57
    v_accvgpr_write_b32 a66, v58
    v_cvt_pk_bf16_f32 v56, v46, v47
    v_cvt_pk_bf16_f32 v57, v54, v55
    v_accvgpr_write_b32 a3, v56
    buffer_load_dwordx4 v[72:75], v19, s[52:55], s17 offen
    v_xor_b32 v58, 0x80008000, v57
    v_accvgpr_write_b32 a35, v57
    v_accvgpr_write_b32 a67, v58
    v_fract_f32 v32, v6
    v_add_f32 v33, v32, v5
    v_add_f32 v34, v33, v5
    v_add_f32 v35, v34, v5
    v_add_f32 v36, v35, v5
    v_add_f32 v37, v36, v5
    v_add_f32 v38, v37, v5
    v_add_f32 v39, v38, v5
    v_add_f32 v6, v32, v7
    v_cos_f32 v40, v32
    v_sin_f32 v48, v32
    v_cos_f32 v41, v33
    v_sin_f32 v49, v33
    s_add_u32 s17, s20, 262656
    buffer_load_dwordx4 v[76:79], v19, s[48:51], s17 offen
    v_cos_f32 v42, v34
    v_sin_f32 v50, v34
    v_cos_f32 v43, v35
    v_sin_f32 v51, v35
    v_cos_f32 v44, v36
    v_sin_f32 v52, v36
    v_cos_f32 v45, v37
    v_sin_f32 v53, v37
    v_cos_f32 v46, v38
    v_sin_f32 v54, v38
    v_cos_f32 v47, v39
    v_sin_f32 v55, v39
    v_cvt_pk_bf16_f32 v56, v40, v41
    v_cvt_pk_bf16_f32 v57, v48, v49
    v_accvgpr_write_b32 a4, v56
    v_xor_b32 v58, 0x80008000, v57
    v_accvgpr_write_b32 a36, v57
    buffer_load_dwordx4 v[80:83], v19, s[52:55], s17 offen
    v_accvgpr_write_b32 a68, v58
    v_cvt_pk_bf16_f32 v56, v42, v43
    v_cvt_pk_bf16_f32 v57, v50, v51
    v_accvgpr_write_b32 a5, v56
    v_xor_b32 v58, 0x80008000, v57
    v_accvgpr_write_b32 a37, v57
    v_accvgpr_write_b32 a69, v58
    v_cvt_pk_bf16_f32 v56, v44, v45
    v_cvt_pk_bf16_f32 v57, v52, v53
    v_accvgpr_write_b32 a6, v56
    v_xor_b32 v58, 0x80008000, v57
    v_accvgpr_write_b32 a38, v57
    v_accvgpr_write_b32 a70, v58
    v_cvt_pk_bf16_f32 v56, v46, v47
    v_cvt_pk_bf16_f32 v57, v54, v55
    v_accvgpr_write_b32 a7, v56
    v_xor_b32 v58, 0x80008000, v57
    s_add_u32 s17, s20, 393984
    buffer_load_dwordx4 v[84:87], v19, s[48:51], s17 offen
    v_accvgpr_write_b32 a39, v57
    v_accvgpr_write_b32 a71, v58
    v_fract_f32 v32, v6
    v_add_f32 v33, v32, v5
    v_add_f32 v34, v33, v5
    v_add_f32 v35, v34, v5
    v_add_f32 v36, v35, v5
    v_add_f32 v37, v36, v5
    v_add_f32 v38, v37, v5
    v_add_f32 v39, v38, v5
    v_add_f32 v6, v32, v7
    v_cos_f32 v40, v32
    v_sin_f32 v48, v32
    v_cos_f32 v41, v33
    v_sin_f32 v49, v33
    v_cos_f32 v42, v34
    buffer_load_dwordx4 v[88:91], v19, s[52:55], s17 offen
    v_sin_f32 v50, v34
    v_cos_f32 v43, v35
    v_sin_f32 v51, v35
    v_cos_f32 v44, v36
    v_sin_f32 v52, v36
    v_cos_f32 v45, v37
    v_sin_f32 v53, v37
    v_cos_f32 v46, v38
    v_sin_f32 v54, v38
    v_cos_f32 v47, v39
    v_sin_f32 v55, v39
    v_cvt_pk_bf16_f32 v56, v40, v41
    v_cvt_pk_bf16_f32 v57, v48, v49
    v_accvgpr_write_b32 a8, v56
    v_xor_b32 v58, 0x80008000, v57
    v_accvgpr_write_b32 a40, v57
    v_accvgpr_write_b32 a72, v58
    s_add_u32 s17, s20, 525312
    buffer_load_dwordx4 v[92:95], v19, s[48:51], s17 offen
    v_cvt_pk_bf16_f32 v56, v42, v43
    v_cvt_pk_bf16_f32 v57, v50, v51
    v_accvgpr_write_b32 a9, v56
    v_xor_b32 v58, 0x80008000, v57
    v_accvgpr_write_b32 a41, v57
    v_accvgpr_write_b32 a73, v58
    v_cvt_pk_bf16_f32 v56, v44, v45
    v_cvt_pk_bf16_f32 v57, v52, v53
    v_accvgpr_write_b32 a10, v56
    v_xor_b32 v58, 0x80008000, v57
    v_accvgpr_write_b32 a42, v57
    v_accvgpr_write_b32 a74, v58
    v_cvt_pk_bf16_f32 v56, v46, v47
    v_cvt_pk_bf16_f32 v57, v54, v55
    v_accvgpr_write_b32 a11, v56
    v_xor_b32 v58, 0x80008000, v57
    v_accvgpr_write_b32 a43, v57
    buffer_load_dwordx4 v[96:99], v19, s[52:55], s17 offen
    v_accvgpr_write_b32 a75, v58
    v_fract_f32 v32, v6
    v_add_f32 v33, v32, v5
    v_add_f32 v34, v33, v5
    v_add_f32 v35, v34, v5
    v_add_f32 v36, v35, v5
    v_add_f32 v37, v36, v5
    v_add_f32 v38, v37, v5
    v_add_f32 v39, v38, v5
    v_add_f32 v6, v32, v7
    v_cos_f32 v40, v32
    v_sin_f32 v48, v32
    v_cos_f32 v41, v33
    v_sin_f32 v49, v33
    v_cos_f32 v42, v34
    v_sin_f32 v50, v34
    s_add_u32 s17, s20, 656640
    buffer_load_dwordx4 v[100:103], v19, s[48:51], s17 offen
    v_cos_f32 v43, v35
    v_sin_f32 v51, v35
    v_cos_f32 v44, v36
    v_sin_f32 v52, v36
    v_cos_f32 v45, v37
    v_sin_f32 v53, v37
    v_cos_f32 v46, v38
    v_sin_f32 v54, v38
    v_cos_f32 v47, v39
    v_sin_f32 v55, v39
    v_cvt_pk_bf16_f32 v56, v40, v41
    v_cvt_pk_bf16_f32 v57, v48, v49
    v_accvgpr_write_b32 a12, v56
    v_xor_b32 v58, 0x80008000, v57
    v_accvgpr_write_b32 a44, v57
    v_accvgpr_write_b32 a76, v58
    v_cvt_pk_bf16_f32 v56, v42, v43
    buffer_load_dwordx4 v[104:107], v19, s[52:55], s17 offen
    v_cvt_pk_bf16_f32 v57, v50, v51
    v_accvgpr_write_b32 a13, v56
    v_xor_b32 v58, 0x80008000, v57
    v_accvgpr_write_b32 a45, v57
    v_accvgpr_write_b32 a77, v58
    v_cvt_pk_bf16_f32 v56, v44, v45
    v_cvt_pk_bf16_f32 v57, v52, v53
    v_accvgpr_write_b32 a14, v56
    v_xor_b32 v58, 0x80008000, v57
    v_accvgpr_write_b32 a46, v57
    v_accvgpr_write_b32 a78, v58
    v_cvt_pk_bf16_f32 v56, v46, v47
    v_cvt_pk_bf16_f32 v57, v54, v55
    v_accvgpr_write_b32 a15, v56
    v_xor_b32 v58, 0x80008000, v57
    v_accvgpr_write_b32 a47, v57
    v_accvgpr_write_b32 a79, v58
    s_add_u32 s17, s20, 787968
    buffer_load_dwordx4 v[108:111], v19, s[48:51], s17 offen
    v_add_f32 v5, 1107296256, v16
    v_mul_f32 v5, 1015021568, v5
    v_mul_f32 v6, v5, v17
    v_mul_f32 v7, 0x41800000, v5
    v_fract_f32 v32, v6
    v_add_f32 v33, v32, v5
    v_add_f32 v34, v33, v5
    v_add_f32 v35, v34, v5
    v_add_f32 v36, v35, v5
    v_add_f32 v37, v36, v5
    v_add_f32 v38, v37, v5
    v_add_f32 v39, v38, v5
    v_add_f32 v6, v32, v7
    v_cos_f32 v40, v32
    v_sin_f32 v48, v32
    v_cos_f32 v41, v33
    buffer_load_dwordx4 v[112:115], v19, s[52:55], s17 offen
    v_sin_f32 v49, v33
    v_cos_f32 v42, v34
    v_sin_f32 v50, v34
    v_cos_f32 v43, v35
    v_sin_f32 v51, v35
    v_cos_f32 v44, v36
    v_sin_f32 v52, v36
    v_cos_f32 v45, v37
    v_sin_f32 v53, v37
    v_cos_f32 v46, v38
    v_sin_f32 v54, v38
    v_cos_f32 v47, v39
    v_sin_f32 v55, v39
    v_cvt_pk_bf16_f32 v56, v40, v41
    v_cvt_pk_bf16_f32 v57, v48, v49
    v_accvgpr_write_b32 a16, v56
    v_xor_b32 v58, 0x80008000, v57
    s_add_u32 s17, s20, 919296
    buffer_load_dwordx4 v[116:119], v19, s[48:51], s17 offen
    v_accvgpr_write_b32 a48, v57
    v_accvgpr_write_b32 a80, v58
    v_cvt_pk_bf16_f32 v56, v42, v43
    v_cvt_pk_bf16_f32 v57, v50, v51
    v_accvgpr_write_b32 a17, v56
    v_xor_b32 v58, 0x80008000, v57
    v_accvgpr_write_b32 a49, v57
    v_accvgpr_write_b32 a81, v58
    v_cvt_pk_bf16_f32 v56, v44, v45
    v_cvt_pk_bf16_f32 v57, v52, v53
    v_accvgpr_write_b32 a18, v56
    v_xor_b32 v58, 0x80008000, v57
    v_accvgpr_write_b32 a50, v57
    v_accvgpr_write_b32 a82, v58
    v_cvt_pk_bf16_f32 v56, v46, v47
    v_cvt_pk_bf16_f32 v57, v54, v55
    v_accvgpr_write_b32 a19, v56
    buffer_load_dwordx4 v[120:123], v19, s[52:55], s17 offen
    v_xor_b32 v58, 0x80008000, v57
    v_accvgpr_write_b32 a51, v57
    v_accvgpr_write_b32 a83, v58
    v_fract_f32 v32, v6
    v_add_f32 v33, v32, v5
    v_add_f32 v34, v33, v5
    v_add_f32 v35, v34, v5
    v_add_f32 v36, v35, v5
    v_add_f32 v37, v36, v5
    v_add_f32 v38, v37, v5
    v_add_f32 v39, v38, v5
    v_add_f32 v6, v32, v7
    v_cos_f32 v40, v32
    v_sin_f32 v48, v32
    v_cos_f32 v41, v33
    v_sin_f32 v49, v33
    v_cos_f32 v42, v34
    s_add_u32 s17, s20, 65664
    buffer_load_dwordx4 v[124:127], v19, s[48:51], s17 offen
    v_sin_f32 v50, v34
    v_cos_f32 v43, v35
    v_sin_f32 v51, v35
    v_cos_f32 v44, v36
    v_sin_f32 v52, v36
    v_cos_f32 v45, v37
    v_sin_f32 v53, v37
    v_cos_f32 v46, v38
    v_sin_f32 v54, v38
    v_cos_f32 v47, v39
    v_sin_f32 v55, v39
    v_cvt_pk_bf16_f32 v56, v40, v41
    v_cvt_pk_bf16_f32 v57, v48, v49
    v_accvgpr_write_b32 a20, v56
    v_xor_b32 v58, 0x80008000, v57
    v_accvgpr_write_b32 a52, v57
    buffer_load_dwordx4 v[128:131], v19, s[52:55], s17 offen
    v_accvgpr_write_b32 a84, v58
    v_cvt_pk_bf16_f32 v56, v42, v43
    v_cvt_pk_bf16_f32 v57, v50, v51
    v_accvgpr_write_b32 a21, v56
    v_xor_b32 v58, 0x80008000, v57
    v_accvgpr_write_b32 a53, v57
    v_accvgpr_write_b32 a85, v58
    v_cvt_pk_bf16_f32 v56, v44, v45
    v_cvt_pk_bf16_f32 v57, v52, v53
    v_accvgpr_write_b32 a22, v56
    v_xor_b32 v58, 0x80008000, v57
    v_accvgpr_write_b32 a54, v57
    v_accvgpr_write_b32 a86, v58
    v_cvt_pk_bf16_f32 v56, v46, v47
    v_cvt_pk_bf16_f32 v57, v54, v55
    v_accvgpr_write_b32 a23, v56
    v_xor_b32 v58, 0x80008000, v57
    s_add_u32 s17, s20, 196992
    buffer_load_dwordx4 v[132:135], v19, s[48:51], s17 offen
    v_accvgpr_write_b32 a55, v57
    v_accvgpr_write_b32 a87, v58
    v_fract_f32 v32, v6
    v_add_f32 v33, v32, v5
    v_add_f32 v34, v33, v5
    v_add_f32 v35, v34, v5
    v_add_f32 v36, v35, v5
    v_add_f32 v37, v36, v5
    v_add_f32 v38, v37, v5
    v_add_f32 v39, v38, v5
    v_add_f32 v6, v32, v7
    v_cos_f32 v40, v32
    v_sin_f32 v48, v32
    v_cos_f32 v41, v33
    v_sin_f32 v49, v33
    v_cos_f32 v42, v34
    v_sin_f32 v50, v34
    buffer_load_dwordx4 v[136:139], v19, s[52:55], s17 offen
    v_cos_f32 v43, v35
    v_sin_f32 v51, v35
    v_cos_f32 v44, v36
    v_sin_f32 v52, v36
    v_cos_f32 v45, v37
    v_sin_f32 v53, v37
    v_cos_f32 v46, v38
    v_sin_f32 v54, v38
    v_cos_f32 v47, v39
    v_sin_f32 v55, v39
    v_cvt_pk_bf16_f32 v56, v40, v41
    v_cvt_pk_bf16_f32 v57, v48, v49
    v_accvgpr_write_b32 a24, v56
    v_xor_b32 v58, 0x80008000, v57
    v_accvgpr_write_b32 a56, v57
    v_accvgpr_write_b32 a88, v58
    s_add_u32 s17, s20, 328320
    buffer_load_dwordx4 v[140:143], v19, s[48:51], s17 offen
    v_cvt_pk_bf16_f32 v56, v42, v43
    v_cvt_pk_bf16_f32 v57, v50, v51
    v_accvgpr_write_b32 a25, v56
    v_xor_b32 v58, 0x80008000, v57
    v_accvgpr_write_b32 a57, v57
    v_accvgpr_write_b32 a89, v58
    v_cvt_pk_bf16_f32 v56, v44, v45
    v_cvt_pk_bf16_f32 v57, v52, v53
    v_accvgpr_write_b32 a26, v56
    v_xor_b32 v58, 0x80008000, v57
    v_accvgpr_write_b32 a58, v57
    v_accvgpr_write_b32 a90, v58
    v_cvt_pk_bf16_f32 v56, v46, v47
    v_cvt_pk_bf16_f32 v57, v54, v55
    v_accvgpr_write_b32 a27, v56
    v_xor_b32 v58, 0x80008000, v57
    v_accvgpr_write_b32 a59, v57
    buffer_load_dwordx4 v[144:147], v19, s[52:55], s17 offen
    v_accvgpr_write_b32 a91, v58
    v_fract_f32 v32, v6
    v_add_f32 v33, v32, v5
    v_add_f32 v34, v33, v5
    v_add_f32 v35, v34, v5
    v_add_f32 v36, v35, v5
    v_add_f32 v37, v36, v5
    v_add_f32 v38, v37, v5
    v_add_f32 v39, v38, v5
    v_add_f32 v6, v32, v7
    v_cos_f32 v40, v32
    v_sin_f32 v48, v32
    v_cos_f32 v41, v33
    v_sin_f32 v49, v33
    v_cos_f32 v42, v34
    v_sin_f32 v50, v34
    v_cos_f32 v43, v35
    s_add_u32 s17, s20, 459648
    buffer_load_dwordx4 v[148:151], v19, s[48:51], s17 offen
    v_sin_f32 v51, v35
    v_cos_f32 v44, v36
    v_sin_f32 v52, v36
    v_cos_f32 v45, v37
    v_sin_f32 v53, v37
    v_cos_f32 v46, v38
    v_sin_f32 v54, v38
    v_cos_f32 v47, v39
    v_sin_f32 v55, v39
    v_cvt_pk_bf16_f32 v56, v40, v41
    v_cvt_pk_bf16_f32 v57, v48, v49
    v_accvgpr_write_b32 a28, v56
    v_xor_b32 v58, 0x80008000, v57
    v_accvgpr_write_b32 a60, v57
    v_accvgpr_write_b32 a92, v58
    v_cvt_pk_bf16_f32 v56, v42, v43
    buffer_load_dwordx4 v[152:155], v19, s[52:55], s17 offen
    v_cvt_pk_bf16_f32 v57, v50, v51
    v_accvgpr_write_b32 a29, v56
    v_xor_b32 v58, 0x80008000, v57
    v_accvgpr_write_b32 a61, v57
    v_accvgpr_write_b32 a93, v58
    v_cvt_pk_bf16_f32 v56, v44, v45
    v_cvt_pk_bf16_f32 v57, v52, v53
    v_accvgpr_write_b32 a30, v56
    v_xor_b32 v58, 0x80008000, v57
    v_accvgpr_write_b32 a62, v57
    v_accvgpr_write_b32 a94, v58
    v_cvt_pk_bf16_f32 v56, v46, v47
    v_cvt_pk_bf16_f32 v57, v54, v55
    v_accvgpr_write_b32 a31, v56
    v_xor_b32 v58, 0x80008000, v57
    v_accvgpr_write_b32 a63, v57
    v_accvgpr_write_b32 a95, v58
    s_add_u32 s17, s20, 590976
    buffer_load_dwordx4 v[156:159], v19, s[48:51], s17 offen
    v_add_f32 v5, 0, v16
    v_mul_f32 v5, 1023410176, v5
    v_mul_f32 v6, v5, v17
    v_mul_f32 v7, 0x41800000, v5
    v_fract_f32 v32, v6
    v_add_f32 v33, v32, v5
    v_add_f32 v34, v33, v5
    v_add_f32 v35, v34, v5
    v_add_f32 v36, v35, v5
    v_add_f32 v37, v36, v5
    v_add_f32 v38, v37, v5
    v_add_f32 v39, v38, v5
    v_add_f32 v6, v32, v7
    v_cos_f32 v40, v32
    v_sin_f32 v48, v32
    v_cos_f32 v41, v33
    v_sin_f32 v49, v33
    buffer_load_dwordx4 v[160:163], v19, s[52:55], s17 offen
    v_cos_f32 v42, v34
    v_sin_f32 v50, v34
    v_cos_f32 v43, v35
    v_sin_f32 v51, v35
    v_cos_f32 v44, v36
    v_sin_f32 v52, v36
    v_cos_f32 v45, v37
    v_sin_f32 v53, v37
    v_cos_f32 v46, v38
    v_sin_f32 v54, v38
    v_cos_f32 v47, v39
    v_sin_f32 v55, v39
    v_mul_f32 v40, 981467136, v40
    v_mul_f32 v41, 981467136, v41
    v_mul_f32 v42, 981467136, v42
    v_mul_f32 v43, 981467136, v43
    s_add_u32 s17, s20, 722304
    buffer_load_dwordx4 v[164:167], v19, s[48:51], s17 offen
    v_mul_f32 v44, 981467136, v44
    v_mul_f32 v45, 981467136, v45
    v_mul_f32 v46, 981467136, v46
    v_mul_f32 v47, 981467136, v47
    v_mul_f32 v48, 981467136, v48
    v_mul_f32 v49, 981467136, v49
    v_mul_f32 v50, 981467136, v50
    v_mul_f32 v51, 981467136, v51
    v_mul_f32 v52, 981467136, v52
    v_mul_f32 v53, 981467136, v53
    v_mul_f32 v54, 981467136, v54
    v_mul_f32 v55, 981467136, v55
    v_cvt_pk_bf16_f32 v56, v40, v41
    v_cvt_pk_bf16_f32 v57, v48, v49
    v_accvgpr_write_b32 a96, v56
    v_xor_b32 v58, 0x80008000, v57
    v_accvgpr_write_b32 a104, v57
    buffer_load_dwordx4 v[168:171], v19, s[52:55], s17 offen
    v_accvgpr_write_b32 a112, v58
    v_cvt_pk_bf16_f32 v56, v42, v43
    v_cvt_pk_bf16_f32 v57, v50, v51
    v_accvgpr_write_b32 a97, v56
    v_xor_b32 v58, 0x80008000, v57
    v_accvgpr_write_b32 a105, v57
    v_accvgpr_write_b32 a113, v58
    v_cvt_pk_bf16_f32 v56, v44, v45
    v_cvt_pk_bf16_f32 v57, v52, v53
    v_accvgpr_write_b32 a98, v56
    v_xor_b32 v58, 0x80008000, v57
    v_accvgpr_write_b32 a106, v57
    v_accvgpr_write_b32 a114, v58
    v_cvt_pk_bf16_f32 v56, v46, v47
    v_cvt_pk_bf16_f32 v57, v54, v55
    v_accvgpr_write_b32 a99, v56
    v_xor_b32 v58, 0x80008000, v57
    s_add_u32 s17, s20, 853632
    buffer_load_dwordx4 v[172:175], v19, s[48:51], s17 offen
    v_accvgpr_write_b32 a107, v57
    v_accvgpr_write_b32 a115, v58
    v_fract_f32 v32, v6
    v_add_f32 v33, v32, v5
    v_add_f32 v34, v33, v5
    v_add_f32 v35, v34, v5
    v_add_f32 v36, v35, v5
    v_add_f32 v37, v36, v5
    v_add_f32 v38, v37, v5
    v_add_f32 v39, v38, v5
    v_add_f32 v6, v32, v7
    v_cos_f32 v40, v32
    v_sin_f32 v48, v32
    v_cos_f32 v41, v33
    v_sin_f32 v49, v33
    v_cos_f32 v42, v34
    buffer_load_dwordx4 v[176:179], v19, s[52:55], s17 offen
    v_sin_f32 v50, v34
    v_cos_f32 v43, v35
    v_sin_f32 v51, v35
    v_cos_f32 v44, v36
    v_sin_f32 v52, v36
    v_cos_f32 v45, v37
    v_sin_f32 v53, v37
    v_cos_f32 v46, v38
    v_sin_f32 v54, v38
    v_cos_f32 v47, v39
    v_sin_f32 v55, v39
    v_mul_f32 v40, 981467136, v40
    v_mul_f32 v41, 981467136, v41
    v_mul_f32 v42, 981467136, v42
    v_mul_f32 v43, 981467136, v43
    v_mul_f32 v44, 981467136, v44
    v_mul_f32 v45, 981467136, v45
    s_add_u32 s17, s20, 984960
    buffer_load_dwordx4 v[180:183], v19, s[48:51], s17 offen
    v_mul_f32 v46, 981467136, v46
    v_mul_f32 v47, 981467136, v47
    v_mul_f32 v48, 981467136, v48
    v_mul_f32 v49, 981467136, v49
    v_mul_f32 v50, 981467136, v50
    v_mul_f32 v51, 981467136, v51
    v_mul_f32 v52, 981467136, v52
    v_mul_f32 v53, 981467136, v53
    v_mul_f32 v54, 981467136, v54
    v_mul_f32 v55, 981467136, v55
    v_cvt_pk_bf16_f32 v56, v40, v41
    v_cvt_pk_bf16_f32 v57, v48, v49
    v_accvgpr_write_b32 a100, v56
    v_xor_b32 v58, 0x80008000, v57
    v_accvgpr_write_b32 a108, v57
    v_accvgpr_write_b32 a116, v58
    v_cvt_pk_bf16_f32 v56, v42, v43
    buffer_load_dwordx4 v[184:187], v19, s[52:55], s17 offen
    v_cvt_pk_bf16_f32 v57, v50, v51
    v_accvgpr_write_b32 a101, v56
    v_xor_b32 v58, 0x80008000, v57
    v_accvgpr_write_b32 a109, v57
    v_accvgpr_write_b32 a117, v58
    v_cvt_pk_bf16_f32 v56, v44, v45
    v_cvt_pk_bf16_f32 v57, v52, v53
    v_accvgpr_write_b32 a102, v56
    v_xor_b32 v58, 0x80008000, v57
    v_accvgpr_write_b32 a110, v57
    v_accvgpr_write_b32 a118, v58
    v_cvt_pk_bf16_f32 v56, v46, v47
    v_cvt_pk_bf16_f32 v57, v54, v55
    v_accvgpr_write_b32 a103, v56
    v_xor_b32 v58, 0x80008000, v57
    v_accvgpr_write_b32 a111, v57
    v_accvgpr_write_b32 a119, v58
    s_lshl_b32 s17, s16, 11
    v_lshlrev_b32 v5, 12, v13
    v_lshl_add_u32 v5, v8, 4, v5
    v_add_u32 v5, s17, v5
    s_cmp_eq_u32 s16, 0
    s_cselect_b32 s17, 0, 10240
    s_add_u32 s17, s17, 0x20000
    v_add_u32 v13, s17, v14
    s_waitcnt vmcnt(24)
    v_perm_b32 v236, v64, v60, s32
    v_perm_b32 v237, v72, v68, s32
    v_perm_b32 v238, v80, v76, s32
    v_perm_b32 v239, v88, v84, s32
    ds_write_b128 v5, v[236:239] offset:0
    v_perm_b32 v240, v64, v60, s33
    v_perm_b32 v241, v72, v68, s33
    v_perm_b32 v242, v80, v76, s33
    v_perm_b32 v243, v88, v84, s33
    ds_write_b128 v5, v[240:243] offset:8192
    v_perm_b32 v244, v65, v61, s32
    v_perm_b32 v245, v73, v69, s32
    v_perm_b32 v246, v81, v77, s32
    v_perm_b32 v247, v89, v85, s32
    ds_write_b128 v5, v[244:247] offset:16384
    v_perm_b32 v248, v65, v61, s33
    v_perm_b32 v249, v73, v69, s33
    v_perm_b32 v250, v81, v77, s33
    v_perm_b32 v251, v89, v85, s33
    ds_write_b128 v5, v[248:251] offset:24576
    v_perm_b32 v236, v66, v62, s32
    v_perm_b32 v237, v74, v70, s32
    v_perm_b32 v238, v82, v78, s32
    v_perm_b32 v239, v90, v86, s32
    ds_write_b128 v5, v[236:239] offset:32768
    v_perm_b32 v240, v66, v62, s33
    v_perm_b32 v241, v74, v70, s33
    v_perm_b32 v242, v82, v78, s33
    v_perm_b32 v243, v90, v86, s33
    ds_write_b128 v5, v[240:243] offset:40960
    v_perm_b32 v244, v67, v63, s32
    v_perm_b32 v245, v75, v71, s32
    v_perm_b32 v246, v83, v79, s32
    v_perm_b32 v247, v91, v87, s32
    ds_write_b128 v5, v[244:247] offset:49152
    v_perm_b32 v248, v67, v63, s33
    v_perm_b32 v249, v75, v71, s33
    v_perm_b32 v250, v83, v79, s33
    v_perm_b32 v251, v91, v87, s33
    ds_write_b128 v5, v[248:251] offset:57344
    s_waitcnt vmcnt(16)
    v_perm_b32 v236, v96, v92, s32
    v_perm_b32 v237, v104, v100, s32
    v_perm_b32 v238, v112, v108, s32
    v_perm_b32 v239, v120, v116, s32
    ds_write_b128 v5, v[236:239] offset:512
    v_perm_b32 v240, v96, v92, s33
    v_perm_b32 v241, v104, v100, s33
    v_perm_b32 v242, v112, v108, s33
    v_perm_b32 v243, v120, v116, s33
    ds_write_b128 v5, v[240:243] offset:8704
    v_perm_b32 v244, v97, v93, s32
    v_perm_b32 v245, v105, v101, s32
    v_perm_b32 v246, v113, v109, s32
    v_perm_b32 v247, v121, v117, s32
    ds_write_b128 v5, v[244:247] offset:16896
    v_perm_b32 v248, v97, v93, s33
    v_perm_b32 v249, v105, v101, s33
    v_perm_b32 v250, v113, v109, s33
    v_perm_b32 v251, v121, v117, s33
    ds_write_b128 v5, v[248:251] offset:25088
    v_perm_b32 v236, v98, v94, s32
    v_perm_b32 v237, v106, v102, s32
    v_perm_b32 v238, v114, v110, s32
    v_perm_b32 v239, v122, v118, s32
    ds_write_b128 v5, v[236:239] offset:33280
    v_perm_b32 v240, v98, v94, s33
    v_perm_b32 v241, v106, v102, s33
    v_perm_b32 v242, v114, v110, s33
    v_perm_b32 v243, v122, v118, s33
    ds_write_b128 v5, v[240:243] offset:41472
    v_perm_b32 v244, v99, v95, s32
    v_perm_b32 v245, v107, v103, s32
    v_perm_b32 v246, v115, v111, s32
    v_perm_b32 v247, v123, v119, s32
    ds_write_b128 v5, v[244:247] offset:49664
    v_perm_b32 v248, v99, v95, s33
    v_perm_b32 v249, v107, v103, s33
    v_perm_b32 v250, v115, v111, s33
    v_perm_b32 v251, v123, v119, s33
    ds_write_b128 v5, v[248:251] offset:57856
    s_waitcnt vmcnt(8)
    v_perm_b32 v236, v128, v124, s32
    v_perm_b32 v237, v136, v132, s32
    v_perm_b32 v238, v144, v140, s32
    v_perm_b32 v239, v152, v148, s32
    ds_write_b128 v5, v[236:239] offset:1024
    v_perm_b32 v240, v128, v124, s33
    v_perm_b32 v241, v136, v132, s33
    v_perm_b32 v242, v144, v140, s33
    v_perm_b32 v243, v152, v148, s33
    ds_write_b128 v5, v[240:243] offset:9216
    v_perm_b32 v244, v129, v125, s32
    v_perm_b32 v245, v137, v133, s32
    v_perm_b32 v246, v145, v141, s32
    v_perm_b32 v247, v153, v149, s32
    ds_write_b128 v5, v[244:247] offset:17408
    v_perm_b32 v248, v129, v125, s33
    v_perm_b32 v249, v137, v133, s33
    v_perm_b32 v250, v145, v141, s33
    v_perm_b32 v251, v153, v149, s33
    ds_write_b128 v5, v[248:251] offset:25600
    v_perm_b32 v236, v130, v126, s32
    v_perm_b32 v237, v138, v134, s32
    v_perm_b32 v238, v146, v142, s32
    v_perm_b32 v239, v154, v150, s32
    ds_write_b128 v5, v[236:239] offset:33792
    v_perm_b32 v240, v130, v126, s33
    v_perm_b32 v241, v138, v134, s33
    v_perm_b32 v242, v146, v142, s33
    v_perm_b32 v243, v154, v150, s33
    ds_write_b128 v5, v[240:243] offset:41984
    v_perm_b32 v244, v131, v127, s32
    v_perm_b32 v245, v139, v135, s32
    v_perm_b32 v246, v147, v143, s32
    v_perm_b32 v247, v155, v151, s32
    ds_write_b128 v5, v[244:247] offset:50176
    v_perm_b32 v248, v131, v127, s33
    v_perm_b32 v249, v139, v135, s33
    v_perm_b32 v250, v147, v143, s33
    v_perm_b32 v251, v155, v151, s33
    ds_write_b128 v5, v[248:251] offset:58368
    s_waitcnt vmcnt(0)
    v_perm_b32 v236, v160, v156, s32
    v_perm_b32 v237, v168, v164, s32
    v_perm_b32 v238, v176, v172, s32
    v_perm_b32 v239, v184, v180, s32
    ds_write_b128 v5, v[236:239] offset:1536
    v_perm_b32 v240, v160, v156, s33
    v_perm_b32 v241, v168, v164, s33
    v_perm_b32 v242, v176, v172, s33
    v_perm_b32 v243, v184, v180, s33
    ds_write_b128 v5, v[240:243] offset:9728
    v_perm_b32 v244, v161, v157, s32
    v_perm_b32 v245, v169, v165, s32
    v_perm_b32 v246, v177, v173, s32
    v_perm_b32 v247, v185, v181, s32
    ds_write_b128 v5, v[244:247] offset:17920
    v_perm_b32 v248, v161, v157, s33
    v_perm_b32 v249, v169, v165, s33
    v_perm_b32 v250, v177, v173, s33
    v_perm_b32 v251, v185, v181, s33
    ds_write_b128 v5, v[248:251] offset:26112
    v_perm_b32 v236, v162, v158, s32
    v_perm_b32 v237, v170, v166, s32
    v_perm_b32 v238, v178, v174, s32
    v_perm_b32 v239, v186, v182, s32
    ds_write_b128 v5, v[236:239] offset:34304
    v_perm_b32 v240, v162, v158, s33
    v_perm_b32 v241, v170, v166, s33
    v_perm_b32 v242, v178, v174, s33
    v_perm_b32 v243, v186, v182, s33
    ds_write_b128 v5, v[240:243] offset:42496
    v_perm_b32 v244, v163, v159, s32
    v_perm_b32 v245, v171, v167, s32
    v_perm_b32 v246, v179, v175, s32
    v_perm_b32 v247, v187, v183, s32
    ds_write_b128 v5, v[244:247] offset:50688
    v_perm_b32 v248, v163, v159, s33
    v_perm_b32 v249, v171, v167, s33
    v_perm_b32 v250, v179, v175, s33
    v_perm_b32 v251, v187, v183, s33
    ds_write_b128 v5, v[248:251] offset:58880
    v_mul_u32_u24 v15, 2176, v10
    v_lshl_add_u32 v15, v11, 4, v15
    v_lshlrev_b32 v18, 12, v11
    v_lshl_add_u32 v18, v10, 4, v18
    s_mul_i32 s32, s93, 139776
    s_lshl_b32 s17, s16, 9
    s_add_u32 s32, s32, s17
    s_add_u32 s32, s32, 104857600
    s_add_u32 s33, s32, 64
    s_lshl_b32 s31, s93, 2
    s_add_u32 s31, s31, s16
    s_lshl_b32 s35, s16, 15
    s_mov_b32 s38, 0xffff0000
    s_mov_b32 s36, 0
    s_cmp_eq_u32 s31, 0
    s_cselect_b32 s37, 5, 4
    s_cselect_b32 s33, 1073741824, s33
    s_cselect_b32 s34, 1024, 1073741824
    v_and_b32 v8, 3, v1
    v_lshlrev_b32 v8, 7, v8
    s_lshl_b32 s17, s93, 9
    s_add_u32 s17, s17, 100745216
    v_add_u32 v8, s17, v8
    s_waitcnt lgkmcnt(0)
    s_mov_b32 s30, s92
F2_w:
    buffer_load_dword v5, v8, s[4:7], 0 offen sc1
    s_waitcnt vmcnt(0)
    v_cmp_gt_u32 vcc, 1, v5
    s_nop 0
    s_and_b32 s17, vcc_lo, 15
    s_cbranch_scc0 F2_w_ok
    s_cmp_ge_u32 s30, 1048576
    s_cselect_b32 s92, 1048576, s92
    s_cbranch_scc1 F2_w_ok
    s_add_u32 s30, s30, 1
    s_sleep 8
    s_branch F2_w
F2_w_ok:
    buffer_load_dwordx4 v[128:131], v15, s[4:7], s32 offen offset:0
    buffer_load_dwordx4 v[132:135], v15, s[4:7], s32 offen offset:32
    s_add_u32 s17, s32, 69632
    buffer_load_dwordx4 v[136:139], v15, s[4:7], s17 offen offset:0
    buffer_load_dwordx4 v[140:143], v15, s[4:7], s17 offen offset:32
    buffer_load_dwordx4 v[144:147], v15, s[4:7], s33 offen offset:0
    buffer_load_dwordx4 v[148:151], v15, s[4:7], s33 offen offset:32
    s_add_u32 s17, s33, 69632
    buffer_load_dwordx4 v[152:155], v15, s[4:7], s17 offen offset:0
    buffer_load_dwordx4 v[156:159], v15, s[4:7], s17 offen offset:32
    v_add_f32 v5, 0, v16
    v_mul_f32 v5, 973078528, v5
    v_add_f32 v6, 0, v17
    v_mul_f32 v6, v6, v5
    v_cos_f32 v160, v6
    v_sin_f32 v176, v6
    v_add_f32 v6, 1065353216, v17
    v_mul_f32 v6, v6, v5
    v_cos_f32 v161, v6
    v_sin_f32 v177, v6
    v_add_f32 v6, 1073741824, v17
    v_mul_f32 v6, v6, v5
    v_cos_f32 v162, v6
    v_sin_f32 v178, v6
    v_add_f32 v6, 1077936128, v17
    v_mul_f32 v6, v6, v5
    v_cos_f32 v163, v6
    v_sin_f32 v179, v6
    v_add_f32 v6, 1082130432, v17
    v_mul_f32 v6, v6, v5
    v_cos_f32 v164, v6
    v_sin_f32 v180, v6
    v_add_f32 v6, 1084227584, v17
    v_mul_f32 v6, v6, v5
    v_cos_f32 v165, v6
    v_sin_f32 v181, v6
    v_add_f32 v6, 1086324736, v17
    v_mul_f32 v6, v6, v5
    v_cos_f32 v166, v6
    v_sin_f32 v182, v6
    v_add_f32 v6, 1088421888, v17
    v_mul_f32 v6, v6, v5
    v_cos_f32 v167, v6
    v_sin_f32 v183, v6
    v_add_f32 v6, 1098907648, v17
    v_mul_f32 v6, v6, v5
    v_cos_f32 v168, v6
    v_sin_f32 v184, v6
    v_add_f32 v6, 1099431936, v17
    v_mul_f32 v6, v6, v5
    v_cos_f32 v169, v6
    v_sin_f32 v185, v6
    v_add_f32 v6, 1099956224, v17
    v_mul_f32 v6, v6, v5
    v_cos_f32 v170, v6
    v_sin_f32 v186, v6
    v_add_f32 v6, 1100480512, v17
    v_mul_f32 v6, v6, v5
    v_cos_f32 v171, v6
    v_sin_f32 v187, v6
    v_add_f32 v6, 1101004800, v17
    v_mul_f32 v6, v6, v5
    v_cos_f32 v172, v6
    v_sin_f32 v188, v6
    v_add_f32 v6, 1101529088, v17
    v_mul_f32 v6, v6, v5
    v_cos_f32 v173, v6
    v_sin_f32 v189, v6
    v_add_f32 v6, 1102053376, v17
    v_mul_f32 v6, v6, v5
    v_cos_f32 v174, v6
    v_sin_f32 v190, v6
    v_add_f32 v6, 1102577664, v17
    v_mul_f32 v6, v6, v5
    v_cos_f32 v175, v6
    v_sin_f32 v191, v6
    v_add_f32 v5, 1107296256, v16
    v_mul_f32 v5, 973078528, v5
    v_add_f32 v6, 0, v17
    v_mul_f32 v6, v6, v5
    v_cos_f32 v192, v6
    v_sin_f32 v208, v6
    v_add_f32 v6, 1065353216, v17
    v_mul_f32 v6, v6, v5
    v_cos_f32 v193, v6
    v_sin_f32 v209, v6
    v_add_f32 v6, 1073741824, v17
    v_mul_f32 v6, v6, v5
    v_cos_f32 v194, v6
    v_sin_f32 v210, v6
    v_add_f32 v6, 1077936128, v17
    v_mul_f32 v6, v6, v5
    v_cos_f32 v195, v6
    v_sin_f32 v211, v6
    v_add_f32 v6, 1082130432, v17
    v_mul_f32 v6, v6, v5
    v_cos_f32 v196, v6
    v_sin_f32 v212, v6
    v_add_f32 v6, 1084227584, v17
    v_mul_f32 v6, v6, v5
    v_cos_f32 v197, v6
    v_sin_f32 v213, v6
    v_add_f32 v6, 1086324736, v17
    v_mul_f32 v6, v6, v5
    v_cos_f32 v198, v6
    v_sin_f32 v214, v6
    v_add_f32 v6, 1088421888, v17
    v_mul_f32 v6, v6, v5
    v_cos_f32 v199, v6
    v_sin_f32 v215, v6
    v_add_f32 v6, 1098907648, v17
    v_mul_f32 v6, v6, v5
    v_cos_f32 v200, v6
    v_sin_f32 v216, v6
    v_add_f32 v6, 1099431936, v17
    v_mul_f32 v6, v6, v5
    v_cos_f32 v201, v6
    v_sin_f32 v217, v6
    v_add_f32 v6, 1099956224, v17
    v_mul_f32 v6, v6, v5
    v_cos_f32 v202, v6
    v_sin_f32 v218, v6
    v_add_f32 v6, 1100480512, v17
    v_mul_f32 v6, v6, v5
    v_cos_f32 v203, v6
    v_sin_f32 v219, v6
    v_add_f32 v6, 1101004800, v17
    v_mul_f32 v6, v6, v5
    v_cos_f32 v204, v6
    v_sin_f32 v220, v6
    v_add_f32 v6, 1101529088, v17
    v_mul_f32 v6, v6, v5
    v_cos_f32 v205, v6
    v_sin_f32 v221, v6
    v_add_f32 v6, 1102053376, v17
    v_mul_f32 v6, v6, v5
    v_cos_f32 v206, v6
    v_sin_f32 v222, v6
    v_add_f32 v6, 1102577664, v17
    v_mul_f32 v6, v6, v5
    v_cos_f32 v207, v6
    v_sin_f32 v223, v6
    v_add_f32 v5, 0, v16
    v_mul_f32 v5, 973078528, v5
    v_add_f32 v6, 1107296256, v17
    v_mul_f32 v6, v6, v5
    v_cos_f32 v224, v6
    v_sin_f32 v240, v6
    v_add_f32 v6, 1107558400, v17
    v_mul_f32 v6, v6, v5
    v_cos_f32 v225, v6
    v_sin_f32 v241, v6
    v_add_f32 v6, 1107820544, v17
    v_mul_f32 v6, v6, v5
    v_cos_f32 v226, v6
    v_sin_f32 v242, v6
    v_add_f32 v6, 1108082688, v17
    v_mul_f32 v6, v6, v5
    v_cos_f32 v227, v6
    v_sin_f32 v243, v6
    v_add_f32 v6, 1108344832, v17
    v_mul_f32 v6, v6, v5
    v_cos_f32 v228, v6
    v_sin_f32 v244, v6
    v_add_f32 v6, 1108606976, v17
    v_mul_f32 v6, v6, v5
    v_cos_f32 v229, v6
    v_sin_f32 v245, v6
    v_add_f32 v6, 1108869120, v17
    v_mul_f32 v6, v6, v5
    v_cos_f32 v230, v6
    v_sin_f32 v246, v6
    v_add_f32 v6, 1109131264, v17
    v_mul_f32 v6, v6, v5
    v_cos_f32 v231, v6
    v_sin_f32 v247, v6
    v_add_f32 v6, 1111490560, v17
    v_mul_f32 v6, v6, v5
    v_cos_f32 v232, v6
    v_sin_f32 v248, v6
    v_add_f32 v6, 1111752704, v17
    v_mul_f32 v6, v6, v5
    v_cos_f32 v233, v6
    v_sin_f32 v249, v6
    v_add_f32 v6, 1112014848, v17
    v_mul_f32 v6, v6, v5
    v_cos_f32 v234, v6
    v_sin_f32 v250, v6
    v_add_f32 v6, 1112276992, v17
    v_mul_f32 v6, v6, v5
    v_cos_f32 v235, v6
    v_sin_f32 v251, v6
    v_add_f32 v6, 1112539136, v17
    v_mul_f32 v6, v6, v5
    v_cos_f32 v236, v6
    v_sin_f32 v252, v6
    v_add_f32 v6, 1112801280, v17
    v_mul_f32 v6, v6, v5
    v_cos_f32 v237, v6
    v_sin_f32 v253, v6
    v_add_f32 v6, 1113063424, v17
    v_mul_f32 v6, v6, v5
    v_cos_f32 v238, v6
    v_sin_f32 v254, v6
    v_add_f32 v6, 1113325568, v17
    v_mul_f32 v6, v6, v5
    v_cos_f32 v239, v6
    v_sin_f32 v255, v6
    s_barrier
.p2align 6
F2_top:
    s_waitcnt vmcnt(0)
    v_mfma_f32_32x32x16_bf16 v[32:47], v[128:131], a[0:3], 0
    v_mfma_f32_32x32x16_bf16 v[48:63], v[144:147], a[0:3], 0
    v_mfma_f32_32x32x16_bf16 v[32:47], v[144:147], a[32:35], v[32:47]
    ds_write_b128 v13, a[248:251]
    v_mfma_f32_32x32x16_bf16 v[48:63], v[128:131], a[64:67], v[48:63]
    ds_write_b128 v13, a[252:255] offset:1024
    ds_write_b16 v13, v2 offset:2
    v_mfma_f32_32x32x16_bf16 v[32:47], v[132:135], a[4:7], v[32:47]
    ds_write_b16 v13, v3 offset:1026
    v_mfma_f32_32x32x16_bf16 v[48:63], v[148:151], a[4:7], v[48:63]
    ds_write_b16 v13, v4 offset:6
    ds_write_b16 v13, v7 offset:1030
    v_mfma_f32_32x32x16_bf16 v[32:47], v[148:151], a[36:39], v[32:47]
    ds_write_b16 v13, v8 offset:10
    v_mfma_f32_32x32x16_bf16 v[48:63], v[132:135], a[68:71], v[48:63]
    ds_write_b16 v13, v10 offset:1034
    ds_write_b16 v13, v11 offset:14
    v_mfma_f32_32x32x16_bf16 v[32:47], v[136:139], a[8:11], v[32:47]
    ds_write_b16 v13, v16 offset:1038
    v_mfma_f32_32x32x16_bf16 v[48:63], v[152:155], a[8:11], v[48:63]
    v_add_u32 v13, 2048, v13
    s_add_u32 s36, s36, 1
    v_mfma_f32_32x32x16_bf16 v[32:47], v[152:155], a[40:43], v[32:47]
    s_add_u32 s32, s32, 128
    v_mfma_f32_32x32x16_bf16 v[48:63], v[136:139], a[72:75], v[48:63]
    s_add_u32 s33, s32, 64
    s_cmp_eq_u32 s36, 4
    v_mfma_f32_32x32x16_bf16 v[32:47], v[140:143], a[12:15], v[32:47]
    s_cselect_b32 s32, 104857664, s32
    v_mfma_f32_32x32x16_bf16 v[48:63], v[156:159], a[12:15], v[48:63]
    s_cselect_b32 s33, 1073741824, s33
    s_cmp_lt_u32 s36, s37
    v_mfma_f32_32x32x16_bf16 v[32:47], v[156:159], a[44:47], v[32:47]
    s_cselect_b32 s32, s32, 1073741824
    v_mfma_f32_32x32x16_bf16 v[48:63], v[140:143], a[76:79], v[48:63]
    s_cselect_b32 s33, s33, 1073741824
    v_add_u32 v19, s35, v14
    v_mfma_f32_32x32x16_bf16 v[64:79], v[128:131], a[16:19], 0
    v_mfma_f32_32x32x16_bf16 v[80:95], v[144:147], a[16:19], 0
    s_add_u32 s18, s34, 0
    buffer_load_ushort a248, v12, s[48:51], s18 offen
    buffer_load_ushort v2, v12, s[52:55], s18 offen
    v_mfma_f32_32x32x16_bf16 v[64:79], v[144:147], a[48:51], v[64:79]
    v_mul_f32 v20, v32, v160
    s_nop 0
    v_mul_f32 v22, v48, v160
    v_mul_f32 v21, v33, v161
    v_mul_f32 v23, v49, v161
    v_fma_f32 v20, v48, v176, v20
    v_mfma_f32_32x32x16_bf16 v[80:95], v[128:131], a[80:83], v[80:95]
    v_fma_f32 v22, -v32, v176, v22
    v_fma_f32 v21, v49, v177, v21
    v_fma_f32 v23, -v33, v177, v23
    v_cvt_pk_bf16_f32 v96, v20, v21
    v_cvt_pk_bf16_f32 v112, v22, v23
    v_mul_f32 v24, v34, v162
    v_mfma_f32_32x32x16_bf16 v[64:79], v[132:135], a[20:23], v[64:79]
    v_mul_f32 v26, v50, v162
    v_mul_f32 v25, v35, v163
    v_mul_f32 v27, v51, v163
    v_fma_f32 v24, v50, v178, v24
    v_fma_f32 v26, -v34, v178, v26
    v_fma_f32 v25, v51, v179, v25
    v_mfma_f32_32x32x16_bf16 v[80:95], v[148:151], a[20:23], v[80:95]
    v_fma_f32 v27, -v35, v179, v27
    v_cvt_pk_bf16_f32 v97, v24, v25
    v_cvt_pk_bf16_f32 v113, v26, v27
    v_mul_f32 v20, v36, v164
    v_mul_f32 v22, v52, v164
    v_mfma_f32_32x32x16_bf16 v[64:79], v[148:151], a[52:55], v[64:79]
    v_mul_f32 v21, v37, v165
    v_mul_f32 v23, v53, v165
    v_fma_f32 v20, v52, v180, v20
    v_fma_f32 v22, -v36, v180, v22
    v_fma_f32 v21, v53, v181, v21
    v_fma_f32 v23, -v37, v181, v23
    v_mfma_f32_32x32x16_bf16 v[80:95], v[132:135], a[84:87], v[80:95]
    v_cvt_pk_bf16_f32 v98, v20, v21
    v_cvt_pk_bf16_f32 v114, v22, v23
    v_mul_f32 v24, v38, v166
    v_mul_f32 v26, v54, v166
    v_mul_f32 v25, v39, v167
    v_mul_f32 v27, v55, v167
    v_mfma_f32_32x32x16_bf16 v[64:79], v[136:139], a[24:27], v[64:79]
    v_fma_f32 v24, v54, v182, v24
    v_fma_f32 v26, -v38, v182, v26
    v_fma_f32 v25, v55, v183, v25
    v_fma_f32 v27, -v39, v183, v27
    v_cvt_pk_bf16_f32 v99, v24, v25
    v_cvt_pk_bf16_f32 v115, v26, v27
    v_mfma_f32_32x32x16_bf16 v[80:95], v[152:155], a[24:27], v[80:95]
    v_mul_f32 v20, v40, v168
    v_mul_f32 v22, v56, v168
    v_mul_f32 v21, v41, v169
    v_mul_f32 v23, v57, v169
    v_fma_f32 v20, v56, v184, v20
    v_mfma_f32_32x32x16_bf16 v[64:79], v[152:155], a[56:59], v[64:79]
    v_fma_f32 v22, -v40, v184, v22
    v_fma_f32 v21, v57, v185, v21
    v_fma_f32 v23, -v41, v185, v23
    v_cvt_pk_bf16_f32 v100, v20, v21
    v_cvt_pk_bf16_f32 v116, v22, v23
    v_mul_f32 v24, v42, v170
    v_mfma_f32_32x32x16_bf16 v[80:95], v[136:139], a[88:91], v[80:95]
    v_mul_f32 v26, v58, v170
    v_mul_f32 v25, v43, v171
    v_mul_f32 v27, v59, v171
    v_fma_f32 v24, v58, v186, v24
    v_fma_f32 v26, -v42, v186, v26
    v_fma_f32 v25, v59, v187, v25
    v_mfma_f32_32x32x16_bf16 v[64:79], v[140:143], a[28:31], v[64:79]
    v_fma_f32 v27, -v43, v187, v27
    v_cvt_pk_bf16_f32 v101, v24, v25
    v_cvt_pk_bf16_f32 v117, v26, v27
    v_mul_f32 v20, v44, v172
    v_mul_f32 v22, v60, v172
    v_mfma_f32_32x32x16_bf16 v[80:95], v[156:159], a[28:31], v[80:95]
    v_mul_f32 v21, v45, v173
    v_mul_f32 v23, v61, v173
    v_fma_f32 v20, v60, v188, v20
    v_fma_f32 v22, -v44, v188, v22
    v_fma_f32 v21, v61, v189, v21
    v_fma_f32 v23, -v45, v189, v23
    v_mfma_f32_32x32x16_bf16 v[64:79], v[156:159], a[60:63], v[64:79]
    v_cvt_pk_bf16_f32 v102, v20, v21
    v_cvt_pk_bf16_f32 v118, v22, v23
    v_mul_f32 v24, v46, v174
    v_mul_f32 v26, v62, v174
    v_mul_f32 v25, v47, v175
    v_mul_f32 v27, v63, v175
    v_mfma_f32_32x32x16_bf16 v[80:95], v[140:143], a[92:95], v[80:95]
    v_fma_f32 v24, v62, v190, v24
    v_fma_f32 v26, -v46, v190, v26
    v_fma_f32 v25, v63, v191, v25
    v_fma_f32 v27, -v47, v191, v27
    v_cvt_pk_bf16_f32 v103, v24, v25
    v_cvt_pk_bf16_f32 v119, v26, v27
    v_mfma_f32_32x32x16_bf16 v[32:47], a[96:99], v[96:99], 0
    buffer_load_dwordx4 v[128:131], v15, s[4:7], s32 offen offset:0
    v_mfma_f32_32x32x16_bf16 v[48:63], a[96:99], v[112:115], 0
    buffer_load_dwordx4 v[132:135], v15, s[4:7], s32 offen offset:32
    v_mfma_f32_32x32x16_bf16 v[32:47], a[104:107], v[112:115], v[32:47]
    s_add_u32 s17, s32, 69632
    buffer_load_dwordx4 v[136:139], v15, s[4:7], s17 offen offset:0
    v_mul_f32 v20, v64, v192
    v_mul_f32 v22, v80, v192
    v_mul_f32 v21, v65, v193
    v_mul_f32 v23, v81, v193
    v_fma_f32 v20, v80, v208, v20
    v_fma_f32 v22, -v64, v208, v22
    v_fma_f32 v21, v81, v209, v21
    v_fma_f32 v23, -v65, v209, v23
    v_cvt_pk_bf16_f32 v104, v20, v21
    v_cvt_pk_bf16_f32 v120, v22, v23
    v_mul_f32 v24, v66, v194
    v_mul_f32 v26, v82, v194
    v_mul_f32 v25, v67, v195
    v_mfma_f32_32x32x16_bf16 v[48:63], a[112:115], v[96:99], v[48:63]
    buffer_load_dwordx4 v[140:143], v15, s[4:7], s17 offen offset:32
    v_mul_f32 v27, v83, v195
    v_fma_f32 v24, v82, v210, v24
    v_fma_f32 v26, -v66, v210, v26
    v_fma_f32 v25, v83, v211, v25
    v_fma_f32 v27, -v67, v211, v27
    v_cvt_pk_bf16_f32 v105, v24, v25
    v_cvt_pk_bf16_f32 v121, v26, v27
    v_mul_f32 v20, v68, v196
    v_mul_f32 v22, v84, v196
    v_mul_f32 v21, v69, v197
    v_mul_f32 v23, v85, v197
    v_fma_f32 v20, v84, v212, v20
    v_fma_f32 v22, -v68, v212, v22
    v_mfma_f32_32x32x16_bf16 v[32:47], a[100:103], v[100:103], v[32:47]
    buffer_load_dwordx4 v[144:147], v15, s[4:7], s33 offen offset:0
    v_fma_f32 v21, v85, v213, v21
    v_fma_f32 v23, -v69, v213, v23
    v_cvt_pk_bf16_f32 v106, v20, v21
    v_cvt_pk_bf16_f32 v122, v22, v23
    v_mul_f32 v24, v70, v198
    v_mul_f32 v26, v86, v198
    v_mul_f32 v25, v71, v199
    v_mul_f32 v27, v87, v199
    v_fma_f32 v24, v86, v214, v24
    v_fma_f32 v26, -v70, v214, v26
    v_fma_f32 v25, v87, v215, v25
    v_fma_f32 v27, -v71, v215, v27
    v_cvt_pk_bf16_f32 v107, v24, v25
    v_cvt_pk_bf16_f32 v123, v26, v27
    v_mfma_f32_32x32x16_bf16 v[48:63], a[100:103], v[116:119], v[48:63]
    buffer_load_dwordx4 v[148:151], v15, s[4:7], s33 offen offset:32
    v_mul_f32 v20, v72, v200
    v_mul_f32 v22, v88, v200
    v_mul_f32 v21, v73, v201
    v_mul_f32 v23, v89, v201
    v_fma_f32 v20, v88, v216, v20
    v_fma_f32 v22, -v72, v216, v22
    v_fma_f32 v21, v89, v217, v21
    v_fma_f32 v23, -v73, v217, v23
    v_cvt_pk_bf16_f32 v108, v20, v21
    v_cvt_pk_bf16_f32 v124, v22, v23
    v_mul_f32 v24, v74, v202
    v_mul_f32 v26, v90, v202
    v_mul_f32 v25, v75, v203
    v_mfma_f32_32x32x16_bf16 v[32:47], a[108:111], v[116:119], v[32:47]
    s_add_u32 s17, s33, 69632
    buffer_load_dwordx4 v[152:155], v15, s[4:7], s17 offen offset:0
    v_mul_f32 v27, v91, v203
    v_fma_f32 v24, v90, v218, v24
    v_fma_f32 v26, -v74, v218, v26
    v_fma_f32 v25, v91, v219, v25
    v_fma_f32 v27, -v75, v219, v27
    v_cvt_pk_bf16_f32 v109, v24, v25
    v_cvt_pk_bf16_f32 v125, v26, v27
    v_mul_f32 v20, v76, v204
    v_mul_f32 v22, v92, v204
    v_mul_f32 v21, v77, v205
    v_mul_f32 v23, v93, v205
    v_fma_f32 v20, v92, v220, v20
    v_fma_f32 v22, -v76, v220, v22
    v_mfma_f32_32x32x16_bf16 v[48:63], a[116:119], v[100:103], v[48:63]
    buffer_load_dwordx4 v[156:159], v15, s[4:7], s17 offen offset:32
    s_nop 1
    ds_read_b128 v[96:99], v19 offset:0
    ds_read_b128 v[112:115], v19 offset:1024
    ds_read_b128 v[100:103], v19 offset:2048
    ds_read_b128 v[116:119], v19 offset:3072
    v_fma_f32 v21, v93, v221, v21
    v_fma_f32 v23, -v77, v221, v23
    v_cvt_pk_bf16_f32 v110, v20, v21
    v_cvt_pk_bf16_f32 v126, v22, v23
    v_mul_f32 v24, v78, v206
    v_mul_f32 v26, v94, v206
    v_mul_f32 v25, v79, v207
    v_mul_f32 v27, v95, v207
    v_fma_f32 v24, v94, v222, v24
    v_fma_f32 v26, -v78, v222, v26
    v_fma_f32 v25, v95, v223, v25
    v_fma_f32 v27, -v79, v223, v27
    v_cvt_pk_bf16_f32 v111, v24, v25
    v_cvt_pk_bf16_f32 v127, v26, v27
    v_mfma_f32_32x32x16_bf16 v[64:79], a[96:99], v[104:107], 0
    v_mfma_f32_32x32x16_bf16 v[80:95], a[96:99], v[120:123], 0
    s_add_u32 s18, s34, 65664
    buffer_load_ushort a252, v12, s[48:51], s18 offen
    buffer_load_ushort v3, v12, s[52:55], s18 offen
    v_mfma_f32_32x32x16_bf16 v[64:79], a[104:107], v[120:123], v[64:79]
    s_waitcnt lgkmcnt(0)
    v_lshlrev_b32 v28, 16, v96
    v_and_b32 v30, s38, v96
    v_lshlrev_b32 v29, 16, v112
    v_and_b32 v31, s38, v112
    v_mul_f32 v20, v32, v28
    v_mul_f32 v22, v48, v28
    v_mul_f32 v21, v33, v29
    v_mul_f32 v23, v49, v29
    v_fma_f32 v20, -v48, v30, v20
    v_fma_f32 v22, v32, v30, v22
    v_fma_f32 v21, -v49, v31, v21
    v_fma_f32 v23, v33, v31, v23
    v_cvt_pk_bf16_f32 v96, v20, v21
    v_cvt_pk_bf16_f32 v112, v22, v23
    v_lshlrev_b32 v28, 16, v97
    v_and_b32 v30, s38, v97
    v_lshlrev_b32 v29, 16, v113
    v_mfma_f32_32x32x16_bf16 v[80:95], a[112:115], v[104:107], v[80:95]
    v_and_b32 v31, s38, v113
    v_mul_f32 v24, v34, v28
    v_mul_f32 v26, v50, v28
    v_mul_f32 v25, v35, v29
    v_mul_f32 v27, v51, v29
    v_fma_f32 v24, -v50, v30, v24
    v_fma_f32 v26, v34, v30, v26
    v_fma_f32 v25, -v51, v31, v25
    v_fma_f32 v27, v35, v31, v27
    v_cvt_pk_bf16_f32 v97, v24, v25
    v_cvt_pk_bf16_f32 v113, v26, v27
    v_lshlrev_b32 v28, 16, v98
    v_and_b32 v30, s38, v98
    v_lshlrev_b32 v29, 16, v114
    v_and_b32 v31, s38, v114
    v_mul_f32 v20, v36, v28
    v_mul_f32 v22, v52, v28
    v_mul_f32 v21, v37, v29
    v_mul_f32 v23, v53, v29
    v_mfma_f32_32x32x16_bf16 v[64:79], a[100:103], v[108:111], v[64:79]
    v_fma_f32 v20, -v52, v30, v20
    v_fma_f32 v22, v36, v30, v22
    v_fma_f32 v21, -v53, v31, v21
    v_fma_f32 v23, v37, v31, v23
    v_cvt_pk_bf16_f32 v98, v20, v21
    v_cvt_pk_bf16_f32 v114, v22, v23
    v_lshlrev_b32 v28, 16, v99
    v_and_b32 v30, s38, v99
    v_lshlrev_b32 v29, 16, v115
    v_and_b32 v31, s38, v115
    v_mul_f32 v24, v38, v28
    v_mul_f32 v26, v54, v28
    v_mul_f32 v25, v39, v29
    v_mul_f32 v27, v55, v29
    v_fma_f32 v24, -v54, v30, v24
    v_fma_f32 v26, v38, v30, v26
    v_fma_f32 v25, -v55, v31, v25
    v_fma_f32 v27, v39, v31, v27
    v_cvt_pk_bf16_f32 v99, v24, v25
    v_mfma_f32_32x32x16_bf16 v[80:95], a[100:103], v[124:127], v[80:95]
    v_cvt_pk_bf16_f32 v115, v26, v27
    v_lshlrev_b32 v28, 16, v100
    v_and_b32 v30, s38, v100
    v_lshlrev_b32 v29, 16, v116
    v_and_b32 v31, s38, v116
    v_mul_f32 v20, v40, v28
    v_mul_f32 v22, v56, v28
    v_mul_f32 v21, v41, v29
    v_mul_f32 v23, v57, v29
    v_fma_f32 v20, -v56, v30, v20
    v_fma_f32 v22, v40, v30, v22
    v_fma_f32 v21, -v57, v31, v21
    v_fma_f32 v23, v41, v31, v23
    v_cvt_pk_bf16_f32 v100, v20, v21
    v_cvt_pk_bf16_f32 v116, v22, v23
    v_lshlrev_b32 v28, 16, v101
    v_and_b32 v30, s38, v101
    v_lshlrev_b32 v29, 16, v117
    v_and_b32 v31, s38, v117
    v_mfma_f32_32x32x16_bf16 v[64:79], a[108:111], v[124:127], v[64:79]
    v_mul_f32 v24, v42, v28
    v_mul_f32 v26, v58, v28
    v_mul_f32 v25, v43, v29
    v_mul_f32 v27, v59, v29
    v_fma_f32 v24, -v58, v30, v24
    v_fma_f32 v26, v42, v30, v26
    v_fma_f32 v25, -v59, v31, v25
    v_fma_f32 v27, v43, v31, v27
    v_cvt_pk_bf16_f32 v101, v24, v25
    v_cvt_pk_bf16_f32 v117, v26, v27
    v_lshlrev_b32 v28, 16, v102
    v_and_b32 v30, s38, v102
    v_lshlrev_b32 v29, 16, v118
    v_and_b32 v31, s38, v118
    v_mul_f32 v20, v44, v28
    v_mul_f32 v22, v60, v28
    v_mul_f32 v21, v45, v29
    v_mul_f32 v23, v61, v29
    v_fma_f32 v20, -v60, v30, v20
    v_mfma_f32_32x32x16_bf16 v[80:95], a[116:119], v[108:111], v[80:95]
    s_nop 1
    ds_read_b128 v[104:107], v19 offset:4096
    ds_read_b128 v[120:123], v19 offset:5120
    ds_read_b128 v[108:111], v19 offset:6144
    ds_read_b128 v[124:127], v19 offset:7168
    v_fma_f32 v22, v44, v30, v22
    v_fma_f32 v21, -v61, v31, v21
    v_fma_f32 v23, v45, v31, v23
    v_cvt_pk_bf16_f32 v102, v20, v21
    v_cvt_pk_bf16_f32 v118, v22, v23
    v_lshlrev_b32 v28, 16, v103
    v_and_b32 v30, s38, v103
    v_lshlrev_b32 v29, 16, v119
    v_and_b32 v31, s38, v119
    v_mul_f32 v24, v46, v28
    v_mul_f32 v26, v62, v28
    v_mul_f32 v25, v47, v29
    v_mul_f32 v27, v63, v29
    v_fma_f32 v24, -v62, v30, v24
    v_fma_f32 v26, v46, v30, v26
    v_fma_f32 v25, -v63, v31, v25
    v_fma_f32 v27, v47, v31, v27
    v_cvt_pk_bf16_f32 v103, v24, v25
    v_cvt_pk_bf16_f32 v119, v26, v27
    v_mfma_f32_32x32x16_bf16 v[32:47], v[96:99], a[96:99], 0
    v_mfma_f32_32x32x16_bf16 v[48:63], v[112:115], a[96:99], 0
    s_add_u32 s18, s34, 131328
    buffer_load_ushort a249, v12, s[48:51], s18 offen
    buffer_load_ushort v4, v12, s[52:55], s18 offen
    v_mfma_f32_32x32x16_bf16 v[32:47], v[112:115], a[112:115], v[32:47]
    s_waitcnt lgkmcnt(0)
    v_lshlrev_b32 v28, 16, v104
    v_and_b32 v30, s38, v104
    v_lshlrev_b32 v29, 16, v120
    v_and_b32 v31, s38, v120
    v_mul_f32 v20, v64, v28
    v_mul_f32 v22, v80, v28
    v_mul_f32 v21, v65, v29
    v_mul_f32 v23, v81, v29
    v_fma_f32 v20, -v80, v30, v20
    v_fma_f32 v22, v64, v30, v22
    v_fma_f32 v21, -v81, v31, v21
    v_fma_f32 v23, v65, v31, v23
    v_cvt_pk_bf16_f32 v104, v20, v21
    v_cvt_pk_bf16_f32 v120, v22, v23
    v_lshlrev_b32 v28, 16, v105
    v_and_b32 v30, s38, v105
    v_lshlrev_b32 v29, 16, v121
    v_mfma_f32_32x32x16_bf16 v[48:63], v[96:99], a[104:107], v[48:63]
    v_and_b32 v31, s38, v121
    v_mul_f32 v24, v66, v28
    v_mul_f32 v26, v82, v28
    v_mul_f32 v25, v67, v29
    v_mul_f32 v27, v83, v29
    v_fma_f32 v24, -v82, v30, v24
    v_fma_f32 v26, v66, v30, v26
    v_fma_f32 v25, -v83, v31, v25
    v_fma_f32 v27, v67, v31, v27
    v_cvt_pk_bf16_f32 v105, v24, v25
    v_cvt_pk_bf16_f32 v121, v26, v27
    v_lshlrev_b32 v28, 16, v106
    v_and_b32 v30, s38, v106
    v_lshlrev_b32 v29, 16, v122
    v_and_b32 v31, s38, v122
    v_mul_f32 v20, v68, v28
    v_mul_f32 v22, v84, v28
    v_mul_f32 v21, v69, v29
    v_mul_f32 v23, v85, v29
    v_mfma_f32_32x32x16_bf16 v[32:47], v[100:103], a[100:103], v[32:47]
    v_fma_f32 v20, -v84, v30, v20
    v_fma_f32 v22, v68, v30, v22
    v_fma_f32 v21, -v85, v31, v21
    v_fma_f32 v23, v69, v31, v23
    v_cvt_pk_bf16_f32 v106, v20, v21
    v_cvt_pk_bf16_f32 v122, v22, v23
    v_lshlrev_b32 v28, 16, v107
    v_and_b32 v30, s38, v107
    v_lshlrev_b32 v29, 16, v123
    v_and_b32 v31, s38, v123
    v_mul_f32 v24, v70, v28
    v_mul_f32 v26, v86, v28
    v_mul_f32 v25, v71, v29
    v_mul_f32 v27, v87, v29
    v_fma_f32 v24, -v86, v30, v24
    v_fma_f32 v26, v70, v30, v26
    v_fma_f32 v25, -v87, v31, v25
    v_fma_f32 v27, v71, v31, v27
    v_cvt_pk_bf16_f32 v107, v24, v25
    v_mfma_f32_32x32x16_bf16 v[48:63], v[116:119], a[100:103], v[48:63]
    v_cvt_pk_bf16_f32 v123, v26, v27
    v_lshlrev_b32 v28, 16, v108
    v_and_b32 v30, s38, v108
    v_lshlrev_b32 v29, 16, v124
    v_and_b32 v31, s38, v124
    v_mul_f32 v20, v72, v28
    v_mul_f32 v22, v88, v28
    v_mul_f32 v21, v73, v29
    v_mul_f32 v23, v89, v29
    v_fma_f32 v20, -v88, v30, v20
    v_fma_f32 v22, v72, v30, v22
    v_fma_f32 v21, -v89, v31, v21
    v_fma_f32 v23, v73, v31, v23
    v_cvt_pk_bf16_f32 v108, v20, v21
    v_cvt_pk_bf16_f32 v124, v22, v23
    v_lshlrev_b32 v28, 16, v109
    v_and_b32 v30, s38, v109
    v_lshlrev_b32 v29, 16, v125
    v_and_b32 v31, s38, v125
    v_mfma_f32_32x32x16_bf16 v[32:47], v[116:119], a[116:119], v[32:47]
    v_mul_f32 v24, v74, v28
    v_mul_f32 v26, v90, v28
    v_mul_f32 v25, v75, v29
    v_mul_f32 v27, v91, v29
    v_fma_f32 v24, -v90, v30, v24
    v_fma_f32 v26, v74, v30, v26
    v_fma_f32 v25, -v91, v31, v25
    v_fma_f32 v27, v75, v31, v27
    v_cvt_pk_bf16_f32 v109, v24, v25
    v_cvt_pk_bf16_f32 v125, v26, v27
    v_lshlrev_b32 v28, 16, v110
    v_and_b32 v30, s38, v110
    v_lshlrev_b32 v29, 16, v126
    v_and_b32 v31, s38, v126
    v_mul_f32 v20, v76, v28
    v_mul_f32 v22, v92, v28
    v_mul_f32 v21, v77, v29
    v_mul_f32 v23, v93, v29
    v_fma_f32 v20, -v92, v30, v20
    v_mfma_f32_32x32x16_bf16 v[48:63], v[100:103], a[108:111], v[48:63]
    v_fma_f32 v22, v76, v30, v22
    v_fma_f32 v21, -v93, v31, v21
    v_fma_f32 v23, v77, v31, v23
    v_cvt_pk_bf16_f32 v110, v20, v21
    v_cvt_pk_bf16_f32 v126, v22, v23
    v_lshlrev_b32 v28, 16, v111
    v_and_b32 v30, s38, v111
    v_lshlrev_b32 v29, 16, v127
    v_and_b32 v31, s38, v127
    v_mul_f32 v24, v78, v28
    v_mul_f32 v26, v94, v28
    v_mul_f32 v25, v79, v29
    v_mul_f32 v27, v95, v29
    v_fma_f32 v24, -v94, v30, v24
    v_fma_f32 v26, v78, v30, v26
    v_fma_f32 v25, -v95, v31, v25
    v_fma_f32 v27, v79, v31, v27
    v_cvt_pk_bf16_f32 v111, v24, v25
    v_cvt_pk_bf16_f32 v127, v26, v27
    v_mfma_f32_32x32x16_bf16 v[64:79], v[104:107], a[96:99], 0
    v_mfma_f32_32x32x16_bf16 v[80:95], v[120:123], a[96:99], 0
    s_add_u32 s18, s34, 196992
    buffer_load_ushort a253, v12, s[48:51], s18 offen
    buffer_load_ushort v7, v12, s[52:55], s18 offen
    v_mfma_f32_32x32x16_bf16 v[64:79], v[120:123], a[112:115], v[64:79]
    v_mul_f32 v20, v32, v160
    v_mul_f32 v22, v48, v160
    v_mul_f32 v21, v33, v161
    v_mul_f32 v23, v49, v161
    v_fma_f32 v20, -v48, v176, v20
    v_fma_f32 v22, v32, v176, v22
    v_fma_f32 v21, -v49, v177, v21
    v_fma_f32 v23, v33, v177, v23
    v_cvt_pk_bf16_f32 v96, v20, v21
    v_cvt_pk_bf16_f32 v112, v22, v23
    v_mul_f32 v24, v34, v162
    v_mul_f32 v26, v50, v162
    v_mul_f32 v25, v35, v163
    v_mfma_f32_32x32x16_bf16 v[80:95], v[104:107], a[104:107], v[80:95]
    v_mul_f32 v27, v51, v163
    v_fma_f32 v24, -v50, v178, v24
    v_fma_f32 v26, v34, v178, v26
    v_fma_f32 v25, -v51, v179, v25
    v_fma_f32 v27, v35, v179, v27
    v_cvt_pk_bf16_f32 v97, v24, v25
    v_cvt_pk_bf16_f32 v113, v26, v27
    v_mul_f32 v20, v36, v164
    v_mul_f32 v22, v52, v164
    v_mul_f32 v21, v37, v165
    v_mul_f32 v23, v53, v165
    v_fma_f32 v20, -v52, v180, v20
    v_fma_f32 v22, v36, v180, v22
    v_mfma_f32_32x32x16_bf16 v[64:79], v[108:111], a[100:103], v[64:79]
    v_fma_f32 v21, -v53, v181, v21
    v_fma_f32 v23, v37, v181, v23
    v_cvt_pk_bf16_f32 v98, v20, v21
    v_cvt_pk_bf16_f32 v114, v22, v23
    v_mul_f32 v24, v38, v166
    v_mul_f32 v26, v54, v166
    v_mul_f32 v25, v39, v167
    v_mul_f32 v27, v55, v167
    v_fma_f32 v24, -v54, v182, v24
    v_fma_f32 v26, v38, v182, v26
    v_fma_f32 v25, -v55, v183, v25
    v_fma_f32 v27, v39, v183, v27
    v_cvt_pk_bf16_f32 v99, v24, v25
    v_cvt_pk_bf16_f32 v115, v26, v27
    v_mfma_f32_32x32x16_bf16 v[80:95], v[124:127], a[100:103], v[80:95]
    v_mul_f32 v20, v40, v168
    v_mul_f32 v22, v56, v168
    v_mul_f32 v21, v41, v169
    v_mul_f32 v23, v57, v169
    v_fma_f32 v20, -v56, v184, v20
    v_fma_f32 v22, v40, v184, v22
    v_fma_f32 v21, -v57, v185, v21
    v_fma_f32 v23, v41, v185, v23
    v_cvt_pk_bf16_f32 v100, v20, v21
    v_cvt_pk_bf16_f32 v116, v22, v23
    v_mul_f32 v24, v42, v170
    v_mul_f32 v26, v58, v170
    v_mul_f32 v25, v43, v171
    v_mfma_f32_32x32x16_bf16 v[64:79], v[124:127], a[116:119], v[64:79]
    v_mul_f32 v27, v59, v171
    v_fma_f32 v24, -v58, v186, v24
    v_fma_f32 v26, v42, v186, v26
    v_fma_f32 v25, -v59, v187, v25
    v_fma_f32 v27, v43, v187, v27
    v_cvt_pk_bf16_f32 v101, v24, v25
    v_cvt_pk_bf16_f32 v117, v26, v27
    v_mul_f32 v20, v44, v172
    v_mul_f32 v22, v60, v172
    v_mul_f32 v21, v45, v173
    v_mul_f32 v23, v61, v173
    v_fma_f32 v20, -v60, v188, v20
    v_fma_f32 v22, v44, v188, v22
    v_mfma_f32_32x32x16_bf16 v[80:95], v[108:111], a[108:111], v[80:95]
    v_fma_f32 v21, -v61, v189, v21
    v_fma_f32 v23, v45, v189, v23
    v_cvt_pk_bf16_f32 v102, v20, v21
    v_cvt_pk_bf16_f32 v118, v22, v23
    v_mul_f32 v24, v46, v174
    v_mul_f32 v26, v62, v174
    v_mul_f32 v25, v47, v175
    v_mul_f32 v27, v63, v175
    v_fma_f32 v24, -v62, v190, v24
    v_fma_f32 v26, v46, v190, v26
    v_fma_f32 v25, -v63, v191, v25
    v_fma_f32 v27, v47, v191, v27
    v_cvt_pk_bf16_f32 v103, v24, v25
    v_cvt_pk_bf16_f32 v119, v26, v27
    v_mfma_f32_32x32x16_bf16 v[32:47], a[0:3], v[96:99], 0
    v_mfma_f32_32x32x16_bf16 v[48:63], a[0:3], v[112:115], 0
    s_add_u32 s18, s34, 262656
    buffer_load_ushort a250, v12, s[48:51], s18 offen
    buffer_load_ushort v8, v12, s[52:55], s18 offen
    v_mfma_f32_32x32x16_bf16 v[32:47], a[64:67], v[112:115], v[32:47]
    v_mul_f32 v20, v64, v224
    v_mul_f32 v22, v80, v224
    v_mul_f32 v21, v65, v225
    v_mul_f32 v23, v81, v225
    v_fma_f32 v20, -v80, v240, v20
    v_fma_f32 v22, v64, v240, v22
    v_fma_f32 v21, -v81, v241, v21
    v_fma_f32 v23, v65, v241, v23
    v_cvt_pk_bf16_f32 v104, v20, v21
    v_cvt_pk_bf16_f32 v120, v22, v23
    v_mul_f32 v24, v66, v226
    v_mul_f32 v26, v82, v226
    v_mul_f32 v25, v67, v227
    v_mfma_f32_32x32x16_bf16 v[48:63], a[32:35], v[96:99], v[48:63]
    v_mul_f32 v27, v83, v227
    v_fma_f32 v24, -v82, v242, v24
    v_fma_f32 v26, v66, v242, v26
    v_fma_f32 v25, -v83, v243, v25
    v_fma_f32 v27, v67, v243, v27
    v_cvt_pk_bf16_f32 v105, v24, v25
    v_cvt_pk_bf16_f32 v121, v26, v27
    v_mul_f32 v20, v68, v228
    v_mul_f32 v22, v84, v228
    v_mul_f32 v21, v69, v229
    v_mul_f32 v23, v85, v229
    v_fma_f32 v20, -v84, v244, v20
    v_fma_f32 v22, v68, v244, v22
    v_mfma_f32_32x32x16_bf16 v[32:47], a[4:7], v[100:103], v[32:47]
    v_fma_f32 v21, -v85, v245, v21
    v_fma_f32 v23, v69, v245, v23
    v_cvt_pk_bf16_f32 v106, v20, v21
    v_cvt_pk_bf16_f32 v122, v22, v23
    v_mul_f32 v24, v70, v230
    v_mul_f32 v26, v86, v230
    v_mul_f32 v25, v71, v231
    v_mul_f32 v27, v87, v231
    v_fma_f32 v24, -v86, v246, v24
    v_fma_f32 v26, v70, v246, v26
    v_fma_f32 v25, -v87, v247, v25
    v_fma_f32 v27, v71, v247, v27
    v_cvt_pk_bf16_f32 v107, v24, v25
    v_cvt_pk_bf16_f32 v123, v26, v27
    v_mfma_f32_32x32x16_bf16 v[48:63], a[4:7], v[116:119], v[48:63]
    v_mul_f32 v20, v72, v232
    v_mul_f32 v22, v88, v232
    v_mul_f32 v21, v73, v233
    v_mul_f32 v23, v89, v233
    v_fma_f32 v20, -v88, v248, v20
    v_fma_f32 v22, v72, v248, v22
    v_fma_f32 v21, -v89, v249, v21
    v_fma_f32 v23, v73, v249, v23
    v_cvt_pk_bf16_f32 v108, v20, v21
    v_cvt_pk_bf16_f32 v124, v22, v23
    v_mul_f32 v24, v74, v234
    v_mul_f32 v26, v90, v234
    v_mul_f32 v25, v75, v235
    v_mfma_f32_32x32x16_bf16 v[32:47], a[68:71], v[116:119], v[32:47]
    v_mul_f32 v27, v91, v235
    v_fma_f32 v24, -v90, v250, v24
    v_fma_f32 v26, v74, v250, v26
    v_fma_f32 v25, -v91, v251, v25
    v_fma_f32 v27, v75, v251, v27
    v_cvt_pk_bf16_f32 v109, v24, v25
    v_cvt_pk_bf16_f32 v125, v26, v27
    v_mul_f32 v20, v76, v236
    v_mul_f32 v22, v92, v236
    v_mul_f32 v21, v77, v237
    v_mul_f32 v23, v93, v237
    v_fma_f32 v20, -v92, v252, v20
    v_fma_f32 v22, v76, v252, v22
    v_mfma_f32_32x32x16_bf16 v[48:63], a[36:39], v[100:103], v[48:63]
    v_fma_f32 v21, -v93, v253, v21
    v_fma_f32 v23, v77, v253, v23
    v_cvt_pk_bf16_f32 v110, v20, v21
    v_cvt_pk_bf16_f32 v126, v22, v23
    v_mul_f32 v24, v78, v238
    v_mul_f32 v26, v94, v238
    v_mul_f32 v25, v79, v239
    v_mul_f32 v27, v95, v239
    v_fma_f32 v24, -v94, v254, v24
    v_fma_f32 v26, v78, v254, v26
    v_fma_f32 v25, -v95, v255, v25
    v_fma_f32 v27, v79, v255, v27
    v_cvt_pk_bf16_f32 v111, v24, v25
    v_cvt_pk_bf16_f32 v127, v26, v27
    v_mfma_f32_32x32x16_bf16 v[32:47], a[8:11], v[104:107], v[32:47]
    s_add_u32 s18, s34, 328320
    buffer_load_ushort a254, v12, s[48:51], s18 offen
    buffer_load_ushort v10, v12, s[52:55], s18 offen
    v_mfma_f32_32x32x16_bf16 v[48:63], a[8:11], v[120:123], v[48:63]
    v_mfma_f32_32x32x16_bf16 v[32:47], a[72:75], v[120:123], v[32:47]
    v_mfma_f32_32x32x16_bf16 v[48:63], a[40:43], v[104:107], v[48:63]
    v_mfma_f32_32x32x16_bf16 v[32:47], a[12:15], v[108:111], v[32:47]
    s_add_u32 s18, s34, 393984
    buffer_load_ushort a251, v12, s[48:51], s18 offen
    buffer_load_ushort v11, v12, s[52:55], s18 offen
    v_mfma_f32_32x32x16_bf16 v[48:63], a[12:15], v[124:127], v[48:63]
    v_mfma_f32_32x32x16_bf16 v[32:47], a[76:79], v[124:127], v[32:47]
    v_mfma_f32_32x32x16_bf16 v[48:63], a[44:47], v[108:111], v[48:63]
    v_mfma_f32_32x32x16_bf16 v[64:79], a[16:19], v[96:99], 0
    s_add_u32 s18, s34, 459648
    buffer_load_ushort a255, v12, s[48:51], s18 offen
    buffer_load_ushort v16, v12, s[52:55], s18 offen
    v_mfma_f32_32x32x16_bf16 v[80:95], a[16:19], v[112:115], 0
    v_mfma_f32_32x32x16_bf16 v[64:79], a[80:83], v[112:115], v[64:79]
    s_nop 1
    v_cvt_pk_bf16_f32 v32, v32, v48
    v_mfma_f32_32x32x16_bf16 v[80:95], a[48:51], v[96:99], v[80:95]
    v_cvt_pk_bf16_f32 v33, v33, v49
    v_mfma_f32_32x32x16_bf16 v[64:79], a[20:23], v[100:103], v[64:79]
    v_cvt_pk_bf16_f32 v34, v34, v50
    v_mfma_f32_32x32x16_bf16 v[80:95], a[20:23], v[116:119], v[80:95]
    v_cvt_pk_bf16_f32 v35, v35, v51
    v_mfma_f32_32x32x16_bf16 v[64:79], a[84:87], v[116:119], v[64:79]
    v_cvt_pk_bf16_f32 v36, v36, v52
    v_mfma_f32_32x32x16_bf16 v[80:95], a[52:55], v[100:103], v[80:95]
    v_cvt_pk_bf16_f32 v37, v37, v53
    v_mfma_f32_32x32x16_bf16 v[64:79], a[24:27], v[104:107], v[64:79]
    v_cvt_pk_bf16_f32 v38, v38, v54
    v_cvt_pk_bf16_f32 v39, v39, v55
    v_mfma_f32_32x32x16_bf16 v[80:95], a[24:27], v[120:123], v[80:95]
    v_cvt_pk_bf16_f32 v40, v40, v56
    v_mfma_f32_32x32x16_bf16 v[64:79], a[88:91], v[120:123], v[64:79]
    v_cvt_pk_bf16_f32 v41, v41, v57
    v_mfma_f32_32x32x16_bf16 v[80:95], a[56:59], v[104:107], v[80:95]
    v_cvt_pk_bf16_f32 v42, v42, v58
    v_mfma_f32_32x32x16_bf16 v[64:79], a[28:31], v[108:111], v[64:79]
    v_cvt_pk_bf16_f32 v43, v43, v59
    v_mfma_f32_32x32x16_bf16 v[80:95], a[28:31], v[124:127], v[80:95]
    v_cvt_pk_bf16_f32 v44, v44, v60
    v_mfma_f32_32x32x16_bf16 v[64:79], a[92:95], v[124:127], v[64:79]
    v_cvt_pk_bf16_f32 v45, v45, v61
    v_mfma_f32_32x32x16_bf16 v[80:95], a[60:63], v[108:111], v[80:95]
    v_cvt_pk_bf16_f32 v46, v46, v62
    v_cvt_pk_bf16_f32 v47, v47, v63
    s_nop 9
    v_cvt_pk_bf16_f32 v64, v64, v80
    v_cvt_pk_bf16_f32 v65, v65, v81
    v_cvt_pk_bf16_f32 v66, v66, v82
    v_cvt_pk_bf16_f32 v67, v67, v83
    v_cvt_pk_bf16_f32 v68, v68, v84
    v_cvt_pk_bf16_f32 v69, v69, v85
    v_cvt_pk_bf16_f32 v70, v70, v86
    v_cvt_pk_bf16_f32 v71, v71, v87
    v_cvt_pk_bf16_f32 v72, v72, v88
    v_cvt_pk_bf16_f32 v73, v73, v89
    v_cvt_pk_bf16_f32 v74, v74, v90
    v_cvt_pk_bf16_f32 v75, v75, v91
    v_cvt_pk_bf16_f32 v76, v76, v92
    v_cvt_pk_bf16_f32 v77, v77, v93
    v_cvt_pk_bf16_f32 v78, v78, v94
    v_cvt_pk_bf16_f32 v79, v79, v95
    s_cmp_eq_u32 s36, 2
    s_cbranch_scc1 F2_o1
    s_cmp_eq_u32 s36, 3
    s_cbranch_scc1 F2_o2
    s_cmp_eq_u32 s36, 4
    s_cbranch_scc1 F2_o3
    s_cmp_eq_u32 s36, 5
    s_cbranch_scc1 F2_o4
    v_accvgpr_write_b32 a120, v32
    v_accvgpr_write_b32 a124, v33
    v_accvgpr_write_b32 a128, v34
    v_accvgpr_write_b32 a132, v35
    v_accvgpr_write_b32 a136, v36
    v_accvgpr_write_b32 a140, v37
    v_accvgpr_write_b32 a144, v38
    v_accvgpr_write_b32 a148, v39
    v_accvgpr_write_b32 a152, v40
    v_accvgpr_write_b32 a156, v41
    v_accvgpr_write_b32 a160, v42
    v_accvgpr_write_b32 a164, v43
    v_accvgpr_write_b32 a168, v44
    v_accvgpr_write_b32 a172, v45
    v_accvgpr_write_b32 a176, v46
    v_accvgpr_write_b32 a180, v47
    v_accvgpr_write_b32 a184, v64
    v_accvgpr_write_b32 a188, v65
    v_accvgpr_write_b32 a192, v66
    v_accvgpr_write_b32 a196, v67
    v_accvgpr_write_b32 a200, v68
    v_accvgpr_write_b32 a204, v69
    v_accvgpr_write_b32 a208, v70
    v_accvgpr_write_b32 a212, v71
    v_accvgpr_write_b32 a216, v72
    v_accvgpr_write_b32 a220, v73
    v_accvgpr_write_b32 a224, v74
    v_accvgpr_write_b32 a228, v75
    v_accvgpr_write_b32 a232, v76
    v_accvgpr_write_b32 a236, v77
    v_accvgpr_write_b32 a240, v78
    v_accvgpr_write_b32 a244, v79
    s_branch F2_nx
F2_o1:
    v_accvgpr_write_b32 a121, v32
    v_accvgpr_write_b32 a125, v33
    v_accvgpr_write_b32 a129, v34
    v_accvgpr_write_b32 a133, v35
    v_accvgpr_write_b32 a137, v36
    v_accvgpr_write_b32 a141, v37
    v_accvgpr_write_b32 a145, v38
    v_accvgpr_write_b32 a149, v39
    v_accvgpr_write_b32 a153, v40
    v_accvgpr_write_b32 a157, v41
    v_accvgpr_write_b32 a161, v42
    v_accvgpr_write_b32 a165, v43
    v_accvgpr_write_b32 a169, v44
    v_accvgpr_write_b32 a173, v45
    v_accvgpr_write_b32 a177, v46
    v_accvgpr_write_b32 a181, v47
    v_accvgpr_write_b32 a185, v64
    v_accvgpr_write_b32 a189, v65
    v_accvgpr_write_b32 a193, v66
    v_accvgpr_write_b32 a197, v67
    v_accvgpr_write_b32 a201, v68
    v_accvgpr_write_b32 a205, v69
    v_accvgpr_write_b32 a209, v70
    v_accvgpr_write_b32 a213, v71
    v_accvgpr_write_b32 a217, v72
    v_accvgpr_write_b32 a221, v73
    v_accvgpr_write_b32 a225, v74
    v_accvgpr_write_b32 a229, v75
    v_accvgpr_write_b32 a233, v76
    v_accvgpr_write_b32 a237, v77
    v_accvgpr_write_b32 a241, v78
    v_accvgpr_write_b32 a245, v79
    s_branch F2_nx
F2_o2:
    v_accvgpr_write_b32 a122, v32
    v_accvgpr_write_b32 a126, v33
    v_accvgpr_write_b32 a130, v34
    v_accvgpr_write_b32 a134, v35
    v_accvgpr_write_b32 a138, v36
    v_accvgpr_write_b32 a142, v37
    v_accvgpr_write_b32 a146, v38
    v_accvgpr_write_b32 a150, v39
    v_accvgpr_write_b32 a154, v40
    v_accvgpr_write_b32 a158, v41
    v_accvgpr_write_b32 a162, v42
    v_accvgpr_write_b32 a166, v43
    v_accvgpr_write_b32 a170, v44
    v_accvgpr_write_b32 a174, v45
    v_accvgpr_write_b32 a178, v46
    v_accvgpr_write_b32 a182, v47
    v_accvgpr_write_b32 a186, v64
    v_accvgpr_write_b32 a190, v65
    v_accvgpr_write_b32 a194, v66
    v_accvgpr_write_b32 a198, v67
    v_accvgpr_write_b32 a202, v68
    v_accvgpr_write_b32 a206, v69
    v_accvgpr_write_b32 a210, v70
    v_accvgpr_write_b32 a214, v71
    v_accvgpr_write_b32 a218, v72
    v_accvgpr_write_b32 a222, v73
    v_accvgpr_write_b32 a226, v74
    v_accvgpr_write_b32 a230, v75
    v_accvgpr_write_b32 a234, v76
    v_accvgpr_write_b32 a238, v77
    v_accvgpr_write_b32 a242, v78
    v_accvgpr_write_b32 a246, v79
    s_branch F2_nx
F2_o3:
    v_accvgpr_write_b32 a123, v32
    v_accvgpr_write_b32 a127, v33
    v_accvgpr_write_b32 a131, v34
    v_accvgpr_write_b32 a135, v35
    v_accvgpr_write_b32 a139, v36
    v_accvgpr_write_b32 a143, v37
    v_accvgpr_write_b32 a147, v38
    v_accvgpr_write_b32 a151, v39
    v_accvgpr_write_b32 a155, v40
    v_accvgpr_write_b32 a159, v41
    v_accvgpr_write_b32 a163, v42
    v_accvgpr_write_b32 a167, v43
    v_accvgpr_write_b32 a171, v44
    v_accvgpr_write_b32 a175, v45
    v_accvgpr_write_b32 a179, v46
    v_accvgpr_write_b32 a183, v47
    v_accvgpr_write_b32 a187, v64
    v_accvgpr_write_b32 a191, v65
    v_accvgpr_write_b32 a195, v66
    v_accvgpr_write_b32 a199, v67
    v_accvgpr_write_b32 a203, v68
    v_accvgpr_write_b32 a207, v69
    v_accvgpr_write_b32 a211, v70
    v_accvgpr_write_b32 a215, v71
    v_accvgpr_write_b32 a219, v72
    v_accvgpr_write_b32 a223, v73
    v_accvgpr_write_b32 a227, v74
    v_accvgpr_write_b32 a231, v75
    v_accvgpr_write_b32 a235, v76
    v_accvgpr_write_b32 a239, v77
    v_accvgpr_write_b32 a243, v78
    v_accvgpr_write_b32 a247, v79
    s_branch F2_nx
F2_o4:
    v_accvgpr_read_b32 v5, a120
    v_lshlrev_b32 v6, 16, v32
    v_bfi_b32 v5, s38, v6, v5
    v_accvgpr_write_b32 a120, v5
    v_accvgpr_read_b32 v5, a124
    v_lshlrev_b32 v6, 16, v33
    v_bfi_b32 v5, s38, v6, v5
    v_accvgpr_write_b32 a124, v5
    v_accvgpr_read_b32 v5, a128
    v_lshlrev_b32 v6, 16, v34
    v_bfi_b32 v5, s38, v6, v5
    v_accvgpr_write_b32 a128, v5
    v_accvgpr_read_b32 v5, a132
    v_lshlrev_b32 v6, 16, v35
    v_bfi_b32 v5, s38, v6, v5
    v_accvgpr_write_b32 a132, v5
    v_accvgpr_read_b32 v5, a136
    v_lshlrev_b32 v6, 16, v36
    v_bfi_b32 v5, s38, v6, v5
    v_accvgpr_write_b32 a136, v5
    v_accvgpr_read_b32 v5, a140
    v_lshlrev_b32 v6, 16, v37
    v_bfi_b32 v5, s38, v6, v5
    v_accvgpr_write_b32 a140, v5
    v_accvgpr_read_b32 v5, a144
    v_lshlrev_b32 v6, 16, v38
    v_bfi_b32 v5, s38, v6, v5
    v_accvgpr_write_b32 a144, v5
    v_accvgpr_read_b32 v5, a148
    v_lshlrev_b32 v6, 16, v39
    v_bfi_b32 v5, s38, v6, v5
    v_accvgpr_write_b32 a148, v5
    v_accvgpr_read_b32 v5, a152
    v_lshlrev_b32 v6, 16, v40
    v_bfi_b32 v5, s38, v6, v5
    v_accvgpr_write_b32 a152, v5
    v_accvgpr_read_b32 v5, a156
    v_lshlrev_b32 v6, 16, v41
    v_bfi_b32 v5, s38, v6, v5
    v_accvgpr_write_b32 a156, v5
    v_accvgpr_read_b32 v5, a160
    v_lshlrev_b32 v6, 16, v42
    v_bfi_b32 v5, s38, v6, v5
    v_accvgpr_write_b32 a160, v5
    v_accvgpr_read_b32 v5, a164
    v_lshlrev_b32 v6, 16, v43
    v_bfi_b32 v5, s38, v6, v5
    v_accvgpr_write_b32 a164, v5
    v_accvgpr_read_b32 v5, a168
    v_lshlrev_b32 v6, 16, v44
    v_bfi_b32 v5, s38, v6, v5
    v_accvgpr_write_b32 a168, v5
    v_accvgpr_read_b32 v5, a172
    v_lshlrev_b32 v6, 16, v45
    v_bfi_b32 v5, s38, v6, v5
    v_accvgpr_write_b32 a172, v5
    v_accvgpr_read_b32 v5, a176
    v_lshlrev_b32 v6, 16, v46
    v_bfi_b32 v5, s38, v6, v5
    v_accvgpr_write_b32 a176, v5
    v_accvgpr_read_b32 v5, a180
    v_lshlrev_b32 v6, 16, v47
    v_bfi_b32 v5, s38, v6, v5
    v_accvgpr_write_b32 a180, v5
    v_accvgpr_read_b32 v5, a184
    v_lshlrev_b32 v6, 16, v64
    v_bfi_b32 v5, s38, v6, v5
    v_accvgpr_write_b32 a184, v5
    v_accvgpr_read_b32 v5, a188
    v_lshlrev_b32 v6, 16, v65
    v_bfi_b32 v5, s38, v6, v5
    v_accvgpr_write_b32 a188, v5
    v_accvgpr_read_b32 v5, a192
    v_lshlrev_b32 v6, 16, v66
    v_bfi_b32 v5, s38, v6, v5
    v_accvgpr_write_b32 a192, v5
    v_accvgpr_read_b32 v5, a196
    v_lshlrev_b32 v6, 16, v67
    v_bfi_b32 v5, s38, v6, v5
    v_accvgpr_write_b32 a196, v5
    v_accvgpr_read_b32 v5, a200
    v_lshlrev_b32 v6, 16, v68
    v_bfi_b32 v5, s38, v6, v5
    v_accvgpr_write_b32 a200, v5
    v_accvgpr_read_b32 v5, a204
    v_lshlrev_b32 v6, 16, v69
    v_bfi_b32 v5, s38, v6, v5
    v_accvgpr_write_b32 a204, v5
    v_accvgpr_read_b32 v5, a208
    v_lshlrev_b32 v6, 16, v70
    v_bfi_b32 v5, s38, v6, v5
    v_accvgpr_write_b32 a208, v5
    v_accvgpr_read_b32 v5, a212
    v_lshlrev_b32 v6, 16, v71
    v_bfi_b32 v5, s38, v6, v5
    v_accvgpr_write_b32 a212, v5
    v_accvgpr_read_b32 v5, a216
    v_lshlrev_b32 v6, 16, v72
    v_bfi_b32 v5, s38, v6, v5
    v_accvgpr_write_b32 a216, v5
    v_accvgpr_read_b32 v5, a220
    v_lshlrev_b32 v6, 16, v73
    v_bfi_b32 v5, s38, v6, v5
    v_accvgpr_write_b32 a220, v5
    v_accvgpr_read_b32 v5, a224
    v_lshlrev_b32 v6, 16, v74
    v_bfi_b32 v5, s38, v6, v5
    v_accvgpr_write_b32 a224, v5
    v_accvgpr_read_b32 v5, a228
    v_lshlrev_b32 v6, 16, v75
    v_bfi_b32 v5, s38, v6, v5
    v_accvgpr_write_b32 a228, v5
    v_accvgpr_read_b32 v5, a232
    v_lshlrev_b32 v6, 16, v76
    v_bfi_b32 v5, s38, v6, v5
    v_accvgpr_write_b32 a232, v5
    v_accvgpr_read_b32 v5, a236
    v_lshlrev_b32 v6, 16, v77
    v_bfi_b32 v5, s38, v6, v5
    v_accvgpr_write_b32 a236, v5
    v_accvgpr_read_b32 v5, a240
    v_lshlrev_b32 v6, 16, v78
    v_bfi_b32 v5, s38, v6, v5
    v_accvgpr_write_b32 a240, v5
    v_accvgpr_read_b32 v5, a244
    v_lshlrev_b32 v6, 16, v79
    v_bfi_b32 v5, s38, v6, v5
    v_accvgpr_write_b32 a244, v5
F2_nx:
    s_add_u32 s35, s35, 8192
    s_bitcmp1_b32 s36, 0
    s_cselect_b32 s17, 0, 2068416
    s_add_u32 s34, s34, 1050624
    s_sub_u32 s34, s34, s17
    s_cmp_eq_u32 s36, 4
    s_cselect_b32 s35, 133120, s35
    s_cselect_b32 s34, 1073741824, s34
    s_cmp_lt_u32 s36, s37
    s_cbranch_scc1 F2_top
    s_mul_i32 s21, s31, 33024
    s_add_u32 s21, s21, 111149056
    s_add_u32 s17, s21, 0
    buffer_store_dwordx4 a[120:123], v18, s[4:7], s17 offen offset:0 sc1
    buffer_store_dwordx4 a[124:127], v18, s[4:7], s17 offen offset:512 sc1
    buffer_store_dwordx4 a[128:131], v18, s[4:7], s17 offen offset:1024 sc1
    buffer_store_dwordx4 a[132:135], v18, s[4:7], s17 offen offset:1536 sc1
    buffer_store_dwordx4 a[136:139], v18, s[4:7], s17 offen offset:2048 sc1
    buffer_store_dwordx4 a[140:143], v18, s[4:7], s17 offen offset:2560 sc1
    buffer_store_dwordx4 a[144:147], v18, s[4:7], s17 offen offset:3072 sc1
    buffer_store_dwordx4 a[148:151], v18, s[4:7], s17 offen offset:3584 sc1
    s_add_u32 s17, s21, 8192
    buffer_store_dwordx4 a[152:155], v18, s[4:7], s17 offen offset:0 sc1
    buffer_store_dwordx4 a[156:159], v18, s[4:7], s17 offen offset:512 sc1
    buffer_store_dwordx4 a[160:163], v18, s[4:7], s17 offen offset:1024 sc1
    buffer_store_dwordx4 a[164:167], v18, s[4:7], s17 offen offset:1536 sc1
    buffer_store_dwordx4 a[168:171], v18, s[4:7], s17 offen offset:2048 sc1
    buffer_store_dwordx4 a[172:175], v18, s[4:7], s17 offen offset:2560 sc1
    buffer_store_dwordx4 a[176:179], v18, s[4:7], s17 offen offset:3072 sc1
    buffer_store_dwordx4 a[180:183], v18, s[4:7], s17 offen offset:3584 sc1
    s_add_u32 s17, s21, 16384
    buffer_store_dwordx4 a[184:187], v18, s[4:7], s17 offen offset:0 sc1
    buffer_store_dwordx4 a[188:191], v18, s[4:7], s17 offen offset:512 sc1
    buffer_store_dwordx4 a[192:195], v18, s[4:7], s17 offen offset:1024 sc1
    buffer_store_dwordx4 a[196:199], v18, s[4:7], s17 offen offset:1536 sc1
    buffer_store_dwordx4 a[200:203], v18, s[4:7], s17 offen offset:2048 sc1
    buffer_store_dwordx4 a[204:207], v18, s[4:7], s17 offen offset:2560 sc1
    buffer_store_dwordx4 a[208:211], v18, s[4:7], s17 offen offset:3072 sc1
    buffer_store_dwordx4 a[212:215], v18, s[4:7], s17 offen offset:3584 sc1
    s_add_u32 s17, s21, 24576
    buffer_store_dwordx4 a[216:219], v18, s[4:7], s17 offen offset:0 sc1
    buffer_store_dwordx4 a[220:223], v18, s[4:7], s17 offen offset:512 sc1
    buffer_store_dwordx4 a[224:227], v18, s[4:7], s17 offen offset:1024 sc1
    buffer_store_dwordx4 a[228:231], v18, s[4:7], s17 offen offset:1536 sc1
    buffer_store_dwordx4 a[232:235], v18, s[4:7], s17 offen offset:2048 sc1
    buffer_store_dwordx4 a[236:239], v18, s[4:7], s17 offen offset:2560 sc1
    buffer_store_dwordx4 a[240:243], v18, s[4:7], s17 offen offset:3072 sc1
    buffer_store_dwordx4 a[244:247], v18, s[4:7], s17 offen offset:3584 sc1
    s_waitcnt vmcnt(0)
    s_lshl_b32 s17, s31, 7
    s_add_u32 s17, s17, 100761600
    v_lshl_add_u32 v5, v1, 2, s17
    v_mov_b32 v6, 1
    s_mov_b64 exec, 0xffffffff
    buffer_store_dword v6, v5, s[4:7], 0 offen sc1
    s_mov_b64 exec, -1
    v_bfe_u32 v5, v1, 2, 2
    v_and_b32 v7, 3, v1
    v_lshl_add_u32 v7, v5, 3, v7
    s_lshl_b32 s17, s29, 5
    v_add_u32 v7, s17, v7
    v_lshrrev_b32 v8, 4, v1
    v_cvt_f32_u32 v8, v8
    s_mov_b32 s31, 981467136
    v_and_b32 v38, 1, v7
    v_add_u32 v5, 0, v7
    v_cvt_f32_u32 v6, v5
    v_mul_f32 v6, s31, v6
    v_mov_b32 v32, 0x3e800000
    v_sub_f32 v34, v6, v32
    v_mul_f32 v36, 0x41800000, v6
    v_mul_f32 v5, 4.0, v6
    v_mul_f32 v30, v5, v8
    v_add_u32 v5, 4, v7
    v_cvt_f32_u32 v6, v5
    v_mul_f32 v6, s31, v6
    v_mov_b32 v33, 0x3e800000
    v_sub_f32 v35, v6, v33
    v_mul_f32 v37, 0x41800000, v6
    v_mul_f32 v5, 4.0, v6
    v_mul_f32 v31, v5, v8
    v_lshlrev_b32 v40, 4, v38
    v_bfe_u32 v5, v7, 1, 1
    v_add_u32 v6, 1, v7
    v_bfe_u32 v6, v6, 1, 1
    v_lshlrev_b32 v5, 15, v5
    v_lshl_or_b32 v41, v6, 31, v5
    v_fract_f32 v48, v30
    v_add_f32 v49, v48, v32
    v_cos_f32 v56, v48
    v_add_f32 v50, v49, v34
    v_cos_f32 v57, v49
    v_add_f32 v51, v50, v32
    v_cos_f32 v58, v50
    v_add_f32 v52, v51, v34
    v_cos_f32 v59, v51
    v_add_f32 v53, v52, v32
    v_cos_f32 v60, v52
    v_add_f32 v54, v53, v34
    v_cos_f32 v61, v53
    v_add_f32 v55, v54, v32
    v_cos_f32 v62, v54
    v_cos_f32 v63, v55
    v_add_f32 v30, v48, v36
    v_cvt_pk_bf16_f32 v64, v56, v57
    v_cvt_pk_bf16_f32 v65, v58, v59
    v_cvt_pk_bf16_f32 v66, v60, v61
    v_cvt_pk_bf16_f32 v67, v62, v63
    v_accvgpr_write_b32 a0, v64
    v_accvgpr_write_b32 a1, v65
    v_accvgpr_write_b32 a2, v66
    v_accvgpr_write_b32 a3, v67
    v_alignbit_b32 v68, v64, v64, v40
    v_xor_b32 v68, v68, v41
    v_alignbit_b32 v69, v65, v65, v40
    v_xor_b32 v69, v69, v41
    v_alignbit_b32 v70, v66, v66, v40
    v_xor_b32 v70, v70, v41
    v_alignbit_b32 v71, v67, v67, v40
    v_xor_b32 v71, v71, v41
    v_accvgpr_write_b32 a128, v68
    v_accvgpr_write_b32 a129, v69
    v_accvgpr_write_b32 a130, v70
    v_accvgpr_write_b32 a131, v71
    v_fract_f32 v48, v31
    v_add_f32 v49, v48, v33
    v_cos_f32 v56, v48
    v_add_f32 v50, v49, v35
    v_cos_f32 v57, v49
    v_add_f32 v51, v50, v33
    v_cos_f32 v58, v50
    v_add_f32 v52, v51, v35
    v_cos_f32 v59, v51
    v_add_f32 v53, v52, v33
    v_cos_f32 v60, v52
    v_add_f32 v54, v53, v35
    v_cos_f32 v61, v53
    v_add_f32 v55, v54, v33
    v_cos_f32 v62, v54
    v_cos_f32 v63, v55
    v_add_f32 v31, v48, v37
    v_cvt_pk_bf16_f32 v64, v56, v57
    v_cvt_pk_bf16_f32 v65, v58, v59
    v_cvt_pk_bf16_f32 v66, v60, v61
    v_cvt_pk_bf16_f32 v67, v62, v63
    v_accvgpr_write_b32 a4, v64
    v_accvgpr_write_b32 a5, v65
    v_accvgpr_write_b32 a6, v66
    v_accvgpr_write_b32 a7, v67
    v_alignbit_b32 v68, v64, v64, v40
    v_xor_b32 v68, v68, v41
    v_alignbit_b32 v69, v65, v65, v40
    v_xor_b32 v69, v69, v41
    v_alignbit_b32 v70, v66, v66, v40
    v_xor_b32 v70, v70, v41
    v_alignbit_b32 v71, v67, v67, v40
    v_xor_b32 v71, v71, v41
    v_accvgpr_write_b32 a132, v68
    v_accvgpr_write_b32 a133, v69
    v_accvgpr_write_b32 a134, v70
    v_accvgpr_write_b32 a135, v71
    v_fract_f32 v48, v30
    v_add_f32 v49, v48, v32
    v_cos_f32 v56, v48
    v_add_f32 v50, v49, v34
    v_cos_f32 v57, v49
    v_add_f32 v51, v50, v32
    v_cos_f32 v58, v50
    v_add_f32 v52, v51, v34
    v_cos_f32 v59, v51
    v_add_f32 v53, v52, v32
    v_cos_f32 v60, v52
    v_add_f32 v54, v53, v34
    v_cos_f32 v61, v53
    v_add_f32 v55, v54, v32
    v_cos_f32 v62, v54
    v_cos_f32 v63, v55
    v_add_f32 v30, v48, v36
    v_cvt_pk_bf16_f32 v64, v56, v57
    v_cvt_pk_bf16_f32 v65, v58, v59
    v_cvt_pk_bf16_f32 v66, v60, v61
    v_cvt_pk_bf16_f32 v67, v62, v63
    v_accvgpr_write_b32 a8, v64
    v_accvgpr_write_b32 a9, v65
    v_accvgpr_write_b32 a10, v66
    v_accvgpr_write_b32 a11, v67
    v_alignbit_b32 v68, v64, v64, v40
    v_xor_b32 v68, v68, v41
    v_alignbit_b32 v69, v65, v65, v40
    v_xor_b32 v69, v69, v41
    v_alignbit_b32 v70, v66, v66, v40
    v_xor_b32 v70, v70, v41
    v_alignbit_b32 v71, v67, v67, v40
    v_xor_b32 v71, v71, v41
    v_accvgpr_write_b32 a136, v68
    v_accvgpr_write_b32 a137, v69
    v_accvgpr_write_b32 a138, v70
    v_accvgpr_write_b32 a139, v71
    v_fract_f32 v48, v31
    v_add_f32 v49, v48, v33
    v_cos_f32 v56, v48
    v_add_f32 v50, v49, v35
    v_cos_f32 v57, v49
    v_add_f32 v51, v50, v33
    v_cos_f32 v58, v50
    v_add_f32 v52, v51, v35
    v_cos_f32 v59, v51
    v_add_f32 v53, v52, v33
    v_cos_f32 v60, v52
    v_add_f32 v54, v53, v35
    v_cos_f32 v61, v53
    v_add_f32 v55, v54, v33
    v_cos_f32 v62, v54
    v_cos_f32 v63, v55
    v_add_f32 v31, v48, v37
    v_cvt_pk_bf16_f32 v64, v56, v57
    v_cvt_pk_bf16_f32 v65, v58, v59
    v_cvt_pk_bf16_f32 v66, v60, v61
    v_cvt_pk_bf16_f32 v67, v62, v63
    v_accvgpr_write_b32 a12, v64
    v_accvgpr_write_b32 a13, v65
    v_accvgpr_write_b32 a14, v66
    v_accvgpr_write_b32 a15, v67
    v_alignbit_b32 v68, v64, v64, v40
    v_xor_b32 v68, v68, v41
    v_alignbit_b32 v69, v65, v65, v40
    v_xor_b32 v69, v69, v41
    v_alignbit_b32 v70, v66, v66, v40
    v_xor_b32 v70, v70, v41
    v_alignbit_b32 v71, v67, v67, v40
    v_xor_b32 v71, v71, v41
    v_accvgpr_write_b32 a140, v68
    v_accvgpr_write_b32 a141, v69
    v_accvgpr_write_b32 a142, v70
    v_accvgpr_write_b32 a143, v71
    v_fract_f32 v48, v30
    v_add_f32 v49, v48, v32
    v_cos_f32 v56, v48
    v_add_f32 v50, v49, v34
    v_cos_f32 v57, v49
    v_add_f32 v51, v50, v32
    v_cos_f32 v58, v50
    v_add_f32 v52, v51, v34
    v_cos_f32 v59, v51
    v_add_f32 v53, v52, v32
    v_cos_f32 v60, v52
    v_add_f32 v54, v53, v34
    v_cos_f32 v61, v53
    v_add_f32 v55, v54, v32
    v_cos_f32 v62, v54
    v_cos_f32 v63, v55
    v_add_f32 v30, v48, v36
    v_cvt_pk_bf16_f32 v64, v56, v57
    v_cvt_pk_bf16_f32 v65, v58, v59
    v_cvt_pk_bf16_f32 v66, v60, v61
    v_cvt_pk_bf16_f32 v67, v62, v63
    v_accvgpr_write_b32 a16, v64
    v_accvgpr_write_b32 a17, v65
    v_accvgpr_write_b32 a18, v66
    v_accvgpr_write_b32 a19, v67
    v_alignbit_b32 v68, v64, v64, v40
    v_xor_b32 v68, v68, v41
    v_alignbit_b32 v69, v65, v65, v40
    v_xor_b32 v69, v69, v41
    v_alignbit_b32 v70, v66, v66, v40
    v_xor_b32 v70, v70, v41
    v_alignbit_b32 v71, v67, v67, v40
    v_xor_b32 v71, v71, v41
    v_accvgpr_write_b32 a144, v68
    v_accvgpr_write_b32 a145, v69
    v_accvgpr_write_b32 a146, v70
    v_accvgpr_write_b32 a147, v71
    v_fract_f32 v48, v31
    v_add_f32 v49, v48, v33
    v_cos_f32 v56, v48
    v_add_f32 v50, v49, v35
    v_cos_f32 v57, v49
    v_add_f32 v51, v50, v33
    v_cos_f32 v58, v50
    v_add_f32 v52, v51, v35
    v_cos_f32 v59, v51
    v_add_f32 v53, v52, v33
    v_cos_f32 v60, v52
    v_add_f32 v54, v53, v35
    v_cos_f32 v61, v53
    v_add_f32 v55, v54, v33
    v_cos_f32 v62, v54
    v_cos_f32 v63, v55
    v_add_f32 v31, v48, v37
    v_cvt_pk_bf16_f32 v64, v56, v57
    v_cvt_pk_bf16_f32 v65, v58, v59
    v_cvt_pk_bf16_f32 v66, v60, v61
    v_cvt_pk_bf16_f32 v67, v62, v63
    v_accvgpr_write_b32 a20, v64
    v_accvgpr_write_b32 a21, v65
    v_accvgpr_write_b32 a22, v66
    v_accvgpr_write_b32 a23, v67
    v_alignbit_b32 v68, v64, v64, v40
    v_xor_b32 v68, v68, v41
    v_alignbit_b32 v69, v65, v65, v40
    v_xor_b32 v69, v69, v41
    v_alignbit_b32 v70, v66, v66, v40
    v_xor_b32 v70, v70, v41
    v_alignbit_b32 v71, v67, v67, v40
    v_xor_b32 v71, v71, v41
    v_accvgpr_write_b32 a148, v68
    v_accvgpr_write_b32 a149, v69
    v_accvgpr_write_b32 a150, v70
    v_accvgpr_write_b32 a151, v71
    v_fract_f32 v48, v30
    v_add_f32 v49, v48, v32
    v_cos_f32 v56, v48
    v_add_f32 v50, v49, v34
    v_cos_f32 v57, v49
    v_add_f32 v51, v50, v32
    v_cos_f32 v58, v50
    v_add_f32 v52, v51, v34
    v_cos_f32 v59, v51
    v_add_f32 v53, v52, v32
    v_cos_f32 v60, v52
    v_add_f32 v54, v53, v34
    v_cos_f32 v61, v53
    v_add_f32 v55, v54, v32
    v_cos_f32 v62, v54
    v_cos_f32 v63, v55
    v_add_f32 v30, v48, v36
    v_cvt_pk_bf16_f32 v64, v56, v57
    v_cvt_pk_bf16_f32 v65, v58, v59
    v_cvt_pk_bf16_f32 v66, v60, v61
    v_cvt_pk_bf16_f32 v67, v62, v63
    v_accvgpr_write_b32 a24, v64
    v_accvgpr_write_b32 a25, v65
    v_accvgpr_write_b32 a26, v66
    v_accvgpr_write_b32 a27, v67
    v_alignbit_b32 v68, v64, v64, v40
    v_xor_b32 v68, v68, v41
    v_alignbit_b32 v69, v65, v65, v40
    v_xor_b32 v69, v69, v41
    v_alignbit_b32 v70, v66, v66, v40
    v_xor_b32 v70, v70, v41
    v_alignbit_b32 v71, v67, v67, v40
    v_xor_b32 v71, v71, v41
    v_accvgpr_write_b32 a152, v68
    v_accvgpr_write_b32 a153, v69
    v_accvgpr_write_b32 a154, v70
    v_accvgpr_write_b32 a155, v71
    v_fract_f32 v48, v31
    v_add_f32 v49, v48, v33
    v_cos_f32 v56, v48
    v_add_f32 v50, v49, v35
    v_cos_f32 v57, v49
    v_add_f32 v51, v50, v33
    v_cos_f32 v58, v50
    v_add_f32 v52, v51, v35
    v_cos_f32 v59, v51
    v_add_f32 v53, v52, v33
    v_cos_f32 v60, v52
    v_add_f32 v54, v53, v35
    v_cos_f32 v61, v53
    v_add_f32 v55, v54, v33
    v_cos_f32 v62, v54
    v_cos_f32 v63, v55
    v_add_f32 v31, v48, v37
    v_cvt_pk_bf16_f32 v64, v56, v57
    v_cvt_pk_bf16_f32 v65, v58, v59
    v_cvt_pk_bf16_f32 v66, v60, v61
    v_cvt_pk_bf16_f32 v67, v62, v63
    v_accvgpr_write_b32 a28, v64
    v_accvgpr_write_b32 a29, v65
    v_accvgpr_write_b32 a30, v66
    v_accvgpr_write_b32 a31, v67
    v_alignbit_b32 v68, v64, v64, v40
    v_xor_b32 v68, v68, v41
    v_alignbit_b32 v69, v65, v65, v40
    v_xor_b32 v69, v69, v41
    v_alignbit_b32 v70, v66, v66, v40
    v_xor_b32 v70, v70, v41
    v_alignbit_b32 v71, v67, v67, v40
    v_xor_b32 v71, v71, v41
    v_accvgpr_write_b32 a156, v68
    v_accvgpr_write_b32 a157, v69
    v_accvgpr_write_b32 a158, v70
    v_accvgpr_write_b32 a159, v71
    v_fract_f32 v48, v30
    v_add_f32 v49, v48, v32
    v_cos_f32 v56, v48
    v_add_f32 v50, v49, v34
    v_cos_f32 v57, v49
    v_add_f32 v51, v50, v32
    v_cos_f32 v58, v50
    v_add_f32 v52, v51, v34
    v_cos_f32 v59, v51
    v_add_f32 v53, v52, v32
    v_cos_f32 v60, v52
    v_add_f32 v54, v53, v34
    v_cos_f32 v61, v53
    v_add_f32 v55, v54, v32
    v_cos_f32 v62, v54
    v_cos_f32 v63, v55
    v_add_f32 v30, v48, v36
    v_cvt_pk_bf16_f32 v64, v56, v57
    v_cvt_pk_bf16_f32 v65, v58, v59
    v_cvt_pk_bf16_f32 v66, v60, v61
    v_cvt_pk_bf16_f32 v67, v62, v63
    v_accvgpr_write_b32 a32, v64
    v_accvgpr_write_b32 a33, v65
    v_accvgpr_write_b32 a34, v66
    v_accvgpr_write_b32 a35, v67
    v_alignbit_b32 v68, v64, v64, v40
    v_xor_b32 v68, v68, v41
    v_alignbit_b32 v69, v65, v65, v40
    v_xor_b32 v69, v69, v41
    v_alignbit_b32 v70, v66, v66, v40
    v_xor_b32 v70, v70, v41
    v_alignbit_b32 v71, v67, v67, v40
    v_xor_b32 v71, v71, v41
    v_accvgpr_write_b32 a160, v68
    v_accvgpr_write_b32 a161, v69
    v_accvgpr_write_b32 a162, v70
    v_accvgpr_write_b32 a163, v71
    v_fract_f32 v48, v31
    v_add_f32 v49, v48, v33
    v_cos_f32 v56, v48
    v_add_f32 v50, v49, v35
    v_cos_f32 v57, v49
    v_add_f32 v51, v50, v33
    v_cos_f32 v58, v50
    v_add_f32 v52, v51, v35
    v_cos_f32 v59, v51
    v_add_f32 v53, v52, v33
    v_cos_f32 v60, v52
    v_add_f32 v54, v53, v35
    v_cos_f32 v61, v53
    v_add_f32 v55, v54, v33
    v_cos_f32 v62, v54
    v_cos_f32 v63, v55
    v_add_f32 v31, v48, v37
    v_cvt_pk_bf16_f32 v64, v56, v57
    v_cvt_pk_bf16_f32 v65, v58, v59
    v_cvt_pk_bf16_f32 v66, v60, v61
    v_cvt_pk_bf16_f32 v67, v62, v63
    v_accvgpr_write_b32 a36, v64
    v_accvgpr_write_b32 a37, v65
    v_accvgpr_write_b32 a38, v66
    v_accvgpr_write_b32 a39, v67
    v_alignbit_b32 v68, v64, v64, v40
    v_xor_b32 v68, v68, v41
    v_alignbit_b32 v69, v65, v65, v40
    v_xor_b32 v69, v69, v41
    v_alignbit_b32 v70, v66, v66, v40
    v_xor_b32 v70, v70, v41
    v_alignbit_b32 v71, v67, v67, v40
    v_xor_b32 v71, v71, v41
    v_accvgpr_write_b32 a164, v68
    v_accvgpr_write_b32 a165, v69
    v_accvgpr_write_b32 a166, v70
    v_accvgpr_write_b32 a167, v71
    v_fract_f32 v48, v30
    v_add_f32 v49, v48, v32
    v_cos_f32 v56, v48
    v_add_f32 v50, v49, v34
    v_cos_f32 v57, v49
    v_add_f32 v51, v50, v32
    v_cos_f32 v58, v50
    v_add_f32 v52, v51, v34
    v_cos_f32 v59, v51
    v_add_f32 v53, v52, v32
    v_cos_f32 v60, v52
    v_add_f32 v54, v53, v34
    v_cos_f32 v61, v53
    v_add_f32 v55, v54, v32
    v_cos_f32 v62, v54
    v_cos_f32 v63, v55
    v_add_f32 v30, v48, v36
    v_cvt_pk_bf16_f32 v64, v56, v57
    v_cvt_pk_bf16_f32 v65, v58, v59
    v_cvt_pk_bf16_f32 v66, v60, v61
    v_cvt_pk_bf16_f32 v67, v62, v63
    v_accvgpr_write_b32 a40, v64
    v_accvgpr_write_b32 a41, v65
    v_accvgpr_write_b32 a42, v66
    v_accvgpr_write_b32 a43, v67
    v_alignbit_b32 v68, v64, v64, v40
    v_xor_b32 v68, v68, v41
    v_alignbit_b32 v69, v65, v65, v40
    v_xor_b32 v69, v69, v41
    v_alignbit_b32 v70, v66, v66, v40
    v_xor_b32 v70, v70, v41
    v_alignbit_b32 v71, v67, v67, v40
    v_xor_b32 v71, v71, v41
    v_accvgpr_write_b32 a168, v68
    v_accvgpr_write_b32 a169, v69
    v_accvgpr_write_b32 a170, v70
    v_accvgpr_write_b32 a171, v71
    v_fract_f32 v48, v31
    v_add_f32 v49, v48, v33
    v_cos_f32 v56, v48
    v_add_f32 v50, v49, v35
    v_cos_f32 v57, v49
    v_add_f32 v51, v50, v33
    v_cos_f32 v58, v50
    v_add_f32 v52, v51, v35
    v_cos_f32 v59, v51
    v_add_f32 v53, v52, v33
    v_cos_f32 v60, v52
    v_add_f32 v54, v53, v35
    v_cos_f32 v61, v53
    v_add_f32 v55, v54, v33
    v_cos_f32 v62, v54
    v_cos_f32 v63, v55
    v_add_f32 v31, v48, v37
    v_cvt_pk_bf16_f32 v64, v56, v57
    v_cvt_pk_bf16_f32 v65, v58, v59
    v_cvt_pk_bf16_f32 v66, v60, v61
    v_cvt_pk_bf16_f32 v67, v62, v63
    v_accvgpr_write_b32 a44, v64
    v_accvgpr_write_b32 a45, v65
    v_accvgpr_write_b32 a46, v66
    v_accvgpr_write_b32 a47, v67
    v_alignbit_b32 v68, v64, v64, v40
    v_xor_b32 v68, v68, v41
    v_alignbit_b32 v69, v65, v65, v40
    v_xor_b32 v69, v69, v41
    v_alignbit_b32 v70, v66, v66, v40
    v_xor_b32 v70, v70, v41
    v_alignbit_b32 v71, v67, v67, v40
    v_xor_b32 v71, v71, v41
    v_accvgpr_write_b32 a172, v68
    v_accvgpr_write_b32 a173, v69
    v_accvgpr_write_b32 a174, v70
    v_accvgpr_write_b32 a175, v71
    v_fract_f32 v48, v30
    v_add_f32 v49, v48, v32
    v_cos_f32 v56, v48
    v_add_f32 v50, v49, v34
    v_cos_f32 v57, v49
    v_add_f32 v51, v50, v32
    v_cos_f32 v58, v50
    v_add_f32 v52, v51, v34
    v_cos_f32 v59, v51
    v_add_f32 v53, v52, v32
    v_cos_f32 v60, v52
    v_add_f32 v54, v53, v34
    v_cos_f32 v61, v53
    v_add_f32 v55, v54, v32
    v_cos_f32 v62, v54
    v_cos_f32 v63, v55
    v_add_f32 v30, v48, v36
    v_cvt_pk_bf16_f32 v64, v56, v57
    v_cvt_pk_bf16_f32 v65, v58, v59
    v_cvt_pk_bf16_f32 v66, v60, v61
    v_cvt_pk_bf16_f32 v67, v62, v63
    v_accvgpr_write_b32 a48, v64
    v_accvgpr_write_b32 a49, v65
    v_accvgpr_write_b32 a50, v66
    v_accvgpr_write_b32 a51, v67
    v_alignbit_b32 v68, v64, v64, v40
    v_xor_b32 v68, v68, v41
    v_alignbit_b32 v69, v65, v65, v40
    v_xor_b32 v69, v69, v41
    v_alignbit_b32 v70, v66, v66, v40
    v_xor_b32 v70, v70, v41
    v_alignbit_b32 v71, v67, v67, v40
    v_xor_b32 v71, v71, v41
    v_accvgpr_write_b32 a176, v68
    v_accvgpr_write_b32 a177, v69
    v_accvgpr_write_b32 a178, v70
    v_accvgpr_write_b32 a179, v71
    v_fract_f32 v48, v31
    v_add_f32 v49, v48, v33
    v_cos_f32 v56, v48
    v_add_f32 v50, v49, v35
    v_cos_f32 v57, v49
    v_add_f32 v51, v50, v33
    v_cos_f32 v58, v50
    v_add_f32 v52, v51, v35
    v_cos_f32 v59, v51
    v_add_f32 v53, v52, v33
    v_cos_f32 v60, v52
    v_add_f32 v54, v53, v35
    v_cos_f32 v61, v53
    v_add_f32 v55, v54, v33
    v_cos_f32 v62, v54
    v_cos_f32 v63, v55
    v_add_f32 v31, v48, v37
    v_cvt_pk_bf16_f32 v64, v56, v57
    v_cvt_pk_bf16_f32 v65, v58, v59
    v_cvt_pk_bf16_f32 v66, v60, v61
    v_cvt_pk_bf16_f32 v67, v62, v63
    v_accvgpr_write_b32 a52, v64
    v_accvgpr_write_b32 a53, v65
    v_accvgpr_write_b32 a54, v66
    v_accvgpr_write_b32 a55, v67
    v_alignbit_b32 v68, v64, v64, v40
    v_xor_b32 v68, v68, v41
    v_alignbit_b32 v69, v65, v65, v40
    v_xor_b32 v69, v69, v41
    v_alignbit_b32 v70, v66, v66, v40
    v_xor_b32 v70, v70, v41
    v_alignbit_b32 v71, v67, v67, v40
    v_xor_b32 v71, v71, v41
    v_accvgpr_write_b32 a180, v68
    v_accvgpr_write_b32 a181, v69
    v_accvgpr_write_b32 a182, v70
    v_accvgpr_write_b32 a183, v71
    v_fract_f32 v48, v30
    v_add_f32 v49, v48, v32
    v_cos_f32 v56, v48
    v_add_f32 v50, v49, v34
    v_cos_f32 v57, v49
    v_add_f32 v51, v50, v32
    v_cos_f32 v58, v50
    v_add_f32 v52, v51, v34
    v_cos_f32 v59, v51
    v_add_f32 v53, v52, v32
    v_cos_f32 v60, v52
    v_add_f32 v54, v53, v34
    v_cos_f32 v61, v53
    v_add_f32 v55, v54, v32
    v_cos_f32 v62, v54
    v_cos_f32 v63, v55
    v_add_f32 v30, v48, v36
    v_cvt_pk_bf16_f32 v64, v56, v57
    v_cvt_pk_bf16_f32 v65, v58, v59
    v_cvt_pk_bf16_f32 v66, v60, v61
    v_cvt_pk_bf16_f32 v67, v62, v63
    v_accvgpr_write_b32 a56, v64
    v_accvgpr_write_b32 a57, v65
    v_accvgpr_write_b32 a58, v66
    v_accvgpr_write_b32 a59, v67
    v_alignbit_b32 v68, v64, v64, v40
    v_xor_b32 v68, v68, v41
    v_alignbit_b32 v69, v65, v65, v40
    v_xor_b32 v69, v69, v41
    v_alignbit_b32 v70, v66, v66, v40
    v_xor_b32 v70, v70, v41
    v_alignbit_b32 v71, v67, v67, v40
    v_xor_b32 v71, v71, v41
    v_accvgpr_write_b32 a184, v68
    v_accvgpr_write_b32 a185, v69
    v_accvgpr_write_b32 a186, v70
    v_accvgpr_write_b32 a187, v71
    v_fract_f32 v48, v31
    v_add_f32 v49, v48, v33
    v_cos_f32 v56, v48
    v_add_f32 v50, v49, v35
    v_cos_f32 v57, v49
    v_add_f32 v51, v50, v33
    v_cos_f32 v58, v50
    v_add_f32 v52, v51, v35
    v_cos_f32 v59, v51
    v_add_f32 v53, v52, v33
    v_cos_f32 v60, v52
    v_add_f32 v54, v53, v35
    v_cos_f32 v61, v53
    v_add_f32 v55, v54, v33
    v_cos_f32 v62, v54
    v_cos_f32 v63, v55
    v_add_f32 v31, v48, v37
    v_cvt_pk_bf16_f32 v64, v56, v57
    v_cvt_pk_bf16_f32 v65, v58, v59
    v_cvt_pk_bf16_f32 v66, v60, v61
    v_cvt_pk_bf16_f32 v67, v62, v63
    v_accvgpr_write_b32 a60, v64
    v_accvgpr_write_b32 a61, v65
    v_accvgpr_write_b32 a62, v66
    v_accvgpr_write_b32 a63, v67
    v_alignbit_b32 v68, v64, v64, v40
    v_xor_b32 v68, v68, v41
    v_alignbit_b32 v69, v65, v65, v40
    v_xor_b32 v69, v69, v41
    v_alignbit_b32 v70, v66, v66, v40
    v_xor_b32 v70, v70, v41
    v_alignbit_b32 v71, v67, v67, v40
    v_xor_b32 v71, v71, v41
    v_accvgpr_write_b32 a188, v68
    v_accvgpr_write_b32 a189, v69
    v_accvgpr_write_b32 a190, v70
    v_accvgpr_write_b32 a191, v71
    v_fract_f32 v48, v30
    v_add_f32 v49, v48, v32
    v_cos_f32 v56, v48
    v_add_f32 v50, v49, v34
    v_cos_f32 v57, v49
    v_add_f32 v51, v50, v32
    v_cos_f32 v58, v50
    v_add_f32 v52, v51, v34
    v_cos_f32 v59, v51
    v_add_f32 v53, v52, v32
    v_cos_f32 v60, v52
    v_add_f32 v54, v53, v34
    v_cos_f32 v61, v53
    v_add_f32 v55, v54, v32
    v_cos_f32 v62, v54
    v_cos_f32 v63, v55
    v_add_f32 v30, v48, v36
    v_cvt_pk_bf16_f32 v64, v56, v57
    v_cvt_pk_bf16_f32 v65, v58, v59
    v_cvt_pk_bf16_f32 v66, v60, v61
    v_cvt_pk_bf16_f32 v67, v62, v63
    v_accvgpr_write_b32 a64, v64
    v_accvgpr_write_b32 a65, v65
    v_accvgpr_write_b32 a66, v66
    v_accvgpr_write_b32 a67, v67
    v_alignbit_b32 v68, v64, v64, v40
    v_xor_b32 v68, v68, v41
    v_alignbit_b32 v69, v65, v65, v40
    v_xor_b32 v69, v69, v41
    v_alignbit_b32 v70, v66, v66, v40
    v_xor_b32 v70, v70, v41
    v_alignbit_b32 v71, v67, v67, v40
    v_xor_b32 v71, v71, v41
    v_accvgpr_write_b32 a192, v68
    v_accvgpr_write_b32 a193, v69
    v_accvgpr_write_b32 a194, v70
    v_accvgpr_write_b32 a195, v71
    v_fract_f32 v48, v31
    v_add_f32 v49, v48, v33
    v_cos_f32 v56, v48
    v_add_f32 v50, v49, v35
    v_cos_f32 v57, v49
    v_add_f32 v51, v50, v33
    v_cos_f32 v58, v50
    v_add_f32 v52, v51, v35
    v_cos_f32 v59, v51
    v_add_f32 v53, v52, v33
    v_cos_f32 v60, v52
    v_add_f32 v54, v53, v35
    v_cos_f32 v61, v53
    v_add_f32 v55, v54, v33
    v_cos_f32 v62, v54
    v_cos_f32 v63, v55
    v_add_f32 v31, v48, v37
    v_cvt_pk_bf16_f32 v64, v56, v57
    v_cvt_pk_bf16_f32 v65, v58, v59
    v_cvt_pk_bf16_f32 v66, v60, v61
    v_cvt_pk_bf16_f32 v67, v62, v63
    v_accvgpr_write_b32 a68, v64
    v_accvgpr_write_b32 a69, v65
    v_accvgpr_write_b32 a70, v66
    v_accvgpr_write_b32 a71, v67
    v_alignbit_b32 v68, v64, v64, v40
    v_xor_b32 v68, v68, v41
    v_alignbit_b32 v69, v65, v65, v40
    v_xor_b32 v69, v69, v41
    v_alignbit_b32 v70, v66, v66, v40
    v_xor_b32 v70, v70, v41
    v_alignbit_b32 v71, v67, v67, v40
    v_xor_b32 v71, v71, v41
    v_accvgpr_write_b32 a196, v68
    v_accvgpr_write_b32 a197, v69
    v_accvgpr_write_b32 a198, v70
    v_accvgpr_write_b32 a199, v71
    v_fract_f32 v48, v30
    v_add_f32 v49, v48, v32
    v_cos_f32 v56, v48
    v_add_f32 v50, v49, v34
    v_cos_f32 v57, v49
    v_add_f32 v51, v50, v32
    v_cos_f32 v58, v50
    v_add_f32 v52, v51, v34
    v_cos_f32 v59, v51
    v_add_f32 v53, v52, v32
    v_cos_f32 v60, v52
    v_add_f32 v54, v53, v34
    v_cos_f32 v61, v53
    v_add_f32 v55, v54, v32
    v_cos_f32 v62, v54
    v_cos_f32 v63, v55
    v_add_f32 v30, v48, v36
    v_cvt_pk_bf16_f32 v64, v56, v57
    v_cvt_pk_bf16_f32 v65, v58, v59
    v_cvt_pk_bf16_f32 v66, v60, v61
    v_cvt_pk_bf16_f32 v67, v62, v63
    v_accvgpr_write_b32 a72, v64
    v_accvgpr_write_b32 a73, v65
    v_accvgpr_write_b32 a74, v66
    v_accvgpr_write_b32 a75, v67
    v_alignbit_b32 v68, v64, v64, v40
    v_xor_b32 v68, v68, v41
    v_alignbit_b32 v69, v65, v65, v40
    v_xor_b32 v69, v69, v41
    v_alignbit_b32 v70, v66, v66, v40
    v_xor_b32 v70, v70, v41
    v_alignbit_b32 v71, v67, v67, v40
    v_xor_b32 v71, v71, v41
    v_accvgpr_write_b32 a200, v68
    v_accvgpr_write_b32 a201, v69
    v_accvgpr_write_b32 a202, v70
    v_accvgpr_write_b32 a203, v71
    v_fract_f32 v48, v31
    v_add_f32 v49, v48, v33
    v_cos_f32 v56, v48
    v_add_f32 v50, v49, v35
    v_cos_f32 v57, v49
    v_add_f32 v51, v50, v33
    v_cos_f32 v58, v50
    v_add_f32 v52, v51, v35
    v_cos_f32 v59, v51
    v_add_f32 v53, v52, v33
    v_cos_f32 v60, v52
    v_add_f32 v54, v53, v35
    v_cos_f32 v61, v53
    v_add_f32 v55, v54, v33
    v_cos_f32 v62, v54
    v_cos_f32 v63, v55
    v_add_f32 v31, v48, v37
    v_cvt_pk_bf16_f32 v64, v56, v57
    v_cvt_pk_bf16_f32 v65, v58, v59
    v_cvt_pk_bf16_f32 v66, v60, v61
    v_cvt_pk_bf16_f32 v67, v62, v63
    v_accvgpr_write_b32 a76, v64
    v_accvgpr_write_b32 a77, v65
    v_accvgpr_write_b32 a78, v66
    v_accvgpr_write_b32 a79, v67
    v_alignbit_b32 v68, v64, v64, v40
    v_xor_b32 v68, v68, v41
    v_alignbit_b32 v69, v65, v65, v40
    v_xor_b32 v69, v69, v41
    v_alignbit_b32 v70, v66, v66, v40
    v_xor_b32 v70, v70, v41
    v_alignbit_b32 v71, v67, v67, v40
    v_xor_b32 v71, v71, v41
    v_accvgpr_write_b32 a204, v68
    v_accvgpr_write_b32 a205, v69
    v_accvgpr_write_b32 a206, v70
    v_accvgpr_write_b32 a207, v71
    v_fract_f32 v48, v30
    v_add_f32 v49, v48, v32
    v_cos_f32 v56, v48
    v_add_f32 v50, v49, v34
    v_cos_f32 v57, v49
    v_add_f32 v51, v50, v32
    v_cos_f32 v58, v50
    v_add_f32 v52, v51, v34
    v_cos_f32 v59, v51
    v_add_f32 v53, v52, v32
    v_cos_f32 v60, v52
    v_add_f32 v54, v53, v34
    v_cos_f32 v61, v53
    v_add_f32 v55, v54, v32
    v_cos_f32 v62, v54
    v_cos_f32 v63, v55
    v_add_f32 v30, v48, v36
    v_cvt_pk_bf16_f32 v64, v56, v57
    v_cvt_pk_bf16_f32 v65, v58, v59
    v_cvt_pk_bf16_f32 v66, v60, v61
    v_cvt_pk_bf16_f32 v67, v62, v63
    v_accvgpr_write_b32 a80, v64
    v_accvgpr_write_b32 a81, v65
    v_accvgpr_write_b32 a82, v66
    v_accvgpr_write_b32 a83, v67
    v_alignbit_b32 v68, v64, v64, v40
    v_xor_b32 v68, v68, v41
    v_alignbit_b32 v69, v65, v65, v40
    v_xor_b32 v69, v69, v41
    v_alignbit_b32 v70, v66, v66, v40
    v_xor_b32 v70, v70, v41
    v_alignbit_b32 v71, v67, v67, v40
    v_xor_b32 v71, v71, v41
    v_accvgpr_write_b32 a208, v68
    v_accvgpr_write_b32 a209, v69
    v_accvgpr_write_b32 a210, v70
    v_accvgpr_write_b32 a211, v71
    v_fract_f32 v48, v31
    v_add_f32 v49, v48, v33
    v_cos_f32 v56, v48
    v_add_f32 v50, v49, v35
    v_cos_f32 v57, v49
    v_add_f32 v51, v50, v33
    v_cos_f32 v58, v50
    v_add_f32 v52, v51, v35
    v_cos_f32 v59, v51
    v_add_f32 v53, v52, v33
    v_cos_f32 v60, v52
    v_add_f32 v54, v53, v35
    v_cos_f32 v61, v53
    v_add_f32 v55, v54, v33
    v_cos_f32 v62, v54
    v_cos_f32 v63, v55
    v_add_f32 v31, v48, v37
    v_cvt_pk_bf16_f32 v64, v56, v57
    v_cvt_pk_bf16_f32 v65, v58, v59
    v_cvt_pk_bf16_f32 v66, v60, v61
    v_cvt_pk_bf16_f32 v67, v62, v63
    v_accvgpr_write_b32 a84, v64
    v_accvgpr_write_b32 a85, v65
    v_accvgpr_write_b32 a86, v66
    v_accvgpr_write_b32 a87, v67
    v_alignbit_b32 v68, v64, v64, v40
    v_xor_b32 v68, v68, v41
    v_alignbit_b32 v69, v65, v65, v40
    v_xor_b32 v69, v69, v41
    v_alignbit_b32 v70, v66, v66, v40
    v_xor_b32 v70, v70, v41
    v_alignbit_b32 v71, v67, v67, v40
    v_xor_b32 v71, v71, v41
    v_accvgpr_write_b32 a212, v68
    v_accvgpr_write_b32 a213, v69
    v_accvgpr_write_b32 a214, v70
    v_accvgpr_write_b32 a215, v71
    v_fract_f32 v48, v30
    v_add_f32 v49, v48, v32
    v_cos_f32 v56, v48
    v_add_f32 v50, v49, v34
    v_cos_f32 v57, v49
    v_add_f32 v51, v50, v32
    v_cos_f32 v58, v50
    v_add_f32 v52, v51, v34
    v_cos_f32 v59, v51
    v_add_f32 v53, v52, v32
    v_cos_f32 v60, v52
    v_add_f32 v54, v53, v34
    v_cos_f32 v61, v53
    v_add_f32 v55, v54, v32
    v_cos_f32 v62, v54
    v_cos_f32 v63, v55
    v_add_f32 v30, v48, v36
    v_cvt_pk_bf16_f32 v64, v56, v57
    v_cvt_pk_bf16_f32 v65, v58, v59
    v_cvt_pk_bf16_f32 v66, v60, v61
    v_cvt_pk_bf16_f32 v67, v62, v63
    v_accvgpr_write_b32 a88, v64
    v_accvgpr_write_b32 a89, v65
    v_accvgpr_write_b32 a90, v66
    v_accvgpr_write_b32 a91, v67
    v_alignbit_b32 v68, v64, v64, v40
    v_xor_b32 v68, v68, v41
    v_alignbit_b32 v69, v65, v65, v40
    v_xor_b32 v69, v69, v41
    v_alignbit_b32 v70, v66, v66, v40
    v_xor_b32 v70, v70, v41
    v_alignbit_b32 v71, v67, v67, v40
    v_xor_b32 v71, v71, v41
    v_accvgpr_write_b32 a216, v68
    v_accvgpr_write_b32 a217, v69
    v_accvgpr_write_b32 a218, v70
    v_accvgpr_write_b32 a219, v71
    v_fract_f32 v48, v31
    v_add_f32 v49, v48, v33
    v_cos_f32 v56, v48
    v_add_f32 v50, v49, v35
    v_cos_f32 v57, v49
    v_add_f32 v51, v50, v33
    v_cos_f32 v58, v50
    v_add_f32 v52, v51, v35
    v_cos_f32 v59, v51
    v_add_f32 v53, v52, v33
    v_cos_f32 v60, v52
    v_add_f32 v54, v53, v35
    v_cos_f32 v61, v53
    v_add_f32 v55, v54, v33
    v_cos_f32 v62, v54
    v_cos_f32 v63, v55
    v_add_f32 v31, v48, v37
    v_cvt_pk_bf16_f32 v64, v56, v57
    v_cvt_pk_bf16_f32 v65, v58, v59
    v_cvt_pk_bf16_f32 v66, v60, v61
    v_cvt_pk_bf16_f32 v67, v62, v63
    v_accvgpr_write_b32 a92, v64
    v_accvgpr_write_b32 a93, v65
    v_accvgpr_write_b32 a94, v66
    v_accvgpr_write_b32 a95, v67
    v_alignbit_b32 v68, v64, v64, v40
    v_xor_b32 v68, v68, v41
    v_alignbit_b32 v69, v65, v65, v40
    v_xor_b32 v69, v69, v41
    v_alignbit_b32 v70, v66, v66, v40
    v_xor_b32 v70, v70, v41
    v_alignbit_b32 v71, v67, v67, v40
    v_xor_b32 v71, v71, v41
    v_accvgpr_write_b32 a220, v68
    v_accvgpr_write_b32 a221, v69
    v_accvgpr_write_b32 a222, v70
    v_accvgpr_write_b32 a223, v71
    v_fract_f32 v48, v30
    v_add_f32 v49, v48, v32
    v_cos_f32 v56, v48
    v_add_f32 v50, v49, v34
    v_cos_f32 v57, v49
    v_add_f32 v51, v50, v32
    v_cos_f32 v58, v50
    v_add_f32 v52, v51, v34
    v_cos_f32 v59, v51
    v_add_f32 v53, v52, v32
    v_cos_f32 v60, v52
    v_add_f32 v54, v53, v34
    v_cos_f32 v61, v53
    v_add_f32 v55, v54, v32
    v_cos_f32 v62, v54
    v_cos_f32 v63, v55
    v_add_f32 v30, v48, v36
    v_cvt_pk_bf16_f32 v64, v56, v57
    v_cvt_pk_bf16_f32 v65, v58, v59
    v_cvt_pk_bf16_f32 v66, v60, v61
    v_cvt_pk_bf16_f32 v67, v62, v63
    v_accvgpr_write_b32 a96, v64
    v_accvgpr_write_b32 a97, v65
    v_accvgpr_write_b32 a98, v66
    v_accvgpr_write_b32 a99, v67
    v_alignbit_b32 v68, v64, v64, v40
    v_xor_b32 v68, v68, v41
    v_alignbit_b32 v69, v65, v65, v40
    v_xor_b32 v69, v69, v41
    v_alignbit_b32 v70, v66, v66, v40
    v_xor_b32 v70, v70, v41
    v_alignbit_b32 v71, v67, v67, v40
    v_xor_b32 v71, v71, v41
    v_accvgpr_write_b32 a224, v68
    v_accvgpr_write_b32 a225, v69
    v_accvgpr_write_b32 a226, v70
    v_accvgpr_write_b32 a227, v71
    v_fract_f32 v48, v31
    v_add_f32 v49, v48, v33
    v_cos_f32 v56, v48
    v_add_f32 v50, v49, v35
    v_cos_f32 v57, v49
    v_add_f32 v51, v50, v33
    v_cos_f32 v58, v50
    v_add_f32 v52, v51, v35
    v_cos_f32 v59, v51
    v_add_f32 v53, v52, v33
    v_cos_f32 v60, v52
    v_add_f32 v54, v53, v35
    v_cos_f32 v61, v53
    v_add_f32 v55, v54, v33
    v_cos_f32 v62, v54
    v_cos_f32 v63, v55
    v_add_f32 v31, v48, v37
    v_cvt_pk_bf16_f32 v64, v56, v57
    v_cvt_pk_bf16_f32 v65, v58, v59
    v_cvt_pk_bf16_f32 v66, v60, v61
    v_cvt_pk_bf16_f32 v67, v62, v63
    v_accvgpr_write_b32 a100, v64
    v_accvgpr_write_b32 a101, v65
    v_accvgpr_write_b32 a102, v66
    v_accvgpr_write_b32 a103, v67
    v_alignbit_b32 v68, v64, v64, v40
    v_xor_b32 v68, v68, v41
    v_alignbit_b32 v69, v65, v65, v40
    v_xor_b32 v69, v69, v41
    v_alignbit_b32 v70, v66, v66, v40
    v_xor_b32 v70, v70, v41
    v_alignbit_b32 v71, v67, v67, v40
    v_xor_b32 v71, v71, v41
    v_accvgpr_write_b32 a228, v68
    v_accvgpr_write_b32 a229, v69
    v_accvgpr_write_b32 a230, v70
    v_accvgpr_write_b32 a231, v71
    v_fract_f32 v48, v30
    v_add_f32 v49, v48, v32
    v_cos_f32 v56, v48
    v_add_f32 v50, v49, v34
    v_cos_f32 v57, v49
    v_add_f32 v51, v50, v32
    v_cos_f32 v58, v50
    v_add_f32 v52, v51, v34
    v_cos_f32 v59, v51
    v_add_f32 v53, v52, v32
    v_cos_f32 v60, v52
    v_add_f32 v54, v53, v34
    v_cos_f32 v61, v53
    v_add_f32 v55, v54, v32
    v_cos_f32 v62, v54
    v_cos_f32 v63, v55
    v_add_f32 v30, v48, v36
    v_cvt_pk_bf16_f32 v64, v56, v57
    v_cvt_pk_bf16_f32 v65, v58, v59
    v_cvt_pk_bf16_f32 v66, v60, v61
    v_cvt_pk_bf16_f32 v67, v62, v63
    v_accvgpr_write_b32 a104, v64
    v_accvgpr_write_b32 a105, v65
    v_accvgpr_write_b32 a106, v66
    v_accvgpr_write_b32 a107, v67
    v_alignbit_b32 v68, v64, v64, v40
    v_xor_b32 v68, v68, v41
    v_alignbit_b32 v69, v65, v65, v40
    v_xor_b32 v69, v69, v41
    v_alignbit_b32 v70, v66, v66, v40
    v_xor_b32 v70, v70, v41
    v_alignbit_b32 v71, v67, v67, v40
    v_xor_b32 v71, v71, v41
    v_accvgpr_write_b32 a232, v68
    v_accvgpr_write_b32 a233, v69
    v_accvgpr_write_b32 a234, v70
    v_accvgpr_write_b32 a235, v71
    v_fract_f32 v48, v31
    v_add_f32 v49, v48, v33
    v_cos_f32 v56, v48
    v_add_f32 v50, v49, v35
    v_cos_f32 v57, v49
    v_add_f32 v51, v50, v33
    v_cos_f32 v58, v50
    v_add_f32 v52, v51, v35
    v_cos_f32 v59, v51
    v_add_f32 v53, v52, v33
    v_cos_f32 v60, v52
    v_add_f32 v54, v53, v35
    v_cos_f32 v61, v53
    v_add_f32 v55, v54, v33
    v_cos_f32 v62, v54
    v_cos_f32 v63, v55
    v_add_f32 v31, v48, v37
    v_cvt_pk_bf16_f32 v64, v56, v57
    v_cvt_pk_bf16_f32 v65, v58, v59
    v_cvt_pk_bf16_f32 v66, v60, v61
    v_cvt_pk_bf16_f32 v67, v62, v63
    v_accvgpr_write_b32 a108, v64
    v_accvgpr_write_b32 a109, v65
    v_accvgpr_write_b32 a110, v66
    v_accvgpr_write_b32 a111, v67
    v_alignbit_b32 v68, v64, v64, v40
    v_xor_b32 v68, v68, v41
    v_alignbit_b32 v69, v65, v65, v40
    v_xor_b32 v69, v69, v41
    v_alignbit_b32 v70, v66, v66, v40
    v_xor_b32 v70, v70, v41
    v_alignbit_b32 v71, v67, v67, v40
    v_xor_b32 v71, v71, v41
    v_accvgpr_write_b32 a236, v68
    v_accvgpr_write_b32 a237, v69
    v_accvgpr_write_b32 a238, v70
    v_accvgpr_write_b32 a239, v71
    v_fract_f32 v48, v30
    v_add_f32 v49, v48, v32
    v_cos_f32 v56, v48
    v_add_f32 v50, v49, v34
    v_cos_f32 v57, v49
    v_add_f32 v51, v50, v32
    v_cos_f32 v58, v50
    v_add_f32 v52, v51, v34
    v_cos_f32 v59, v51
    v_add_f32 v53, v52, v32
    v_cos_f32 v60, v52
    v_add_f32 v54, v53, v34
    v_cos_f32 v61, v53
    v_add_f32 v55, v54, v32
    v_cos_f32 v62, v54
    v_cos_f32 v63, v55
    v_add_f32 v30, v48, v36
    v_cvt_pk_bf16_f32 v64, v56, v57
    v_cvt_pk_bf16_f32 v65, v58, v59
    v_cvt_pk_bf16_f32 v66, v60, v61
    v_cvt_pk_bf16_f32 v67, v62, v63
    v_accvgpr_write_b32 a112, v64
    v_accvgpr_write_b32 a113, v65
    v_accvgpr_write_b32 a114, v66
    v_accvgpr_write_b32 a115, v67
    v_alignbit_b32 v68, v64, v64, v40
    v_xor_b32 v68, v68, v41
    v_alignbit_b32 v69, v65, v65, v40
    v_xor_b32 v69, v69, v41
    v_alignbit_b32 v70, v66, v66, v40
    v_xor_b32 v70, v70, v41
    v_alignbit_b32 v71, v67, v67, v40
    v_xor_b32 v71, v71, v41
    v_accvgpr_write_b32 a240, v68
    v_accvgpr_write_b32 a241, v69
    v_accvgpr_write_b32 a242, v70
    v_accvgpr_write_b32 a243, v71
    v_fract_f32 v48, v31
    v_add_f32 v49, v48, v33
    v_cos_f32 v56, v48
    v_add_f32 v50, v49, v35
    v_cos_f32 v57, v49
    v_add_f32 v51, v50, v33
    v_cos_f32 v58, v50
    v_add_f32 v52, v51, v35
    v_cos_f32 v59, v51
    v_add_f32 v53, v52, v33
    v_cos_f32 v60, v52
    v_add_f32 v54, v53, v35
    v_cos_f32 v61, v53
    v_add_f32 v55, v54, v33
    v_cos_f32 v62, v54
    v_cos_f32 v63, v55
    v_add_f32 v31, v48, v37
    v_cvt_pk_bf16_f32 v64, v56, v57
    v_cvt_pk_bf16_f32 v65, v58, v59
    v_cvt_pk_bf16_f32 v66, v60, v61
    v_cvt_pk_bf16_f32 v67, v62, v63
    v_accvgpr_write_b32 a116, v64
    v_accvgpr_write_b32 a117, v65
    v_accvgpr_write_b32 a118, v66
    v_accvgpr_write_b32 a119, v67
    v_alignbit_b32 v68, v64, v64, v40
    v_xor_b32 v68, v68, v41
    v_alignbit_b32 v69, v65, v65, v40
    v_xor_b32 v69, v69, v41
    v_alignbit_b32 v70, v66, v66, v40
    v_xor_b32 v70, v70, v41
    v_alignbit_b32 v71, v67, v67, v40
    v_xor_b32 v71, v71, v41
    v_accvgpr_write_b32 a244, v68
    v_accvgpr_write_b32 a245, v69
    v_accvgpr_write_b32 a246, v70
    v_accvgpr_write_b32 a247, v71
    v_fract_f32 v48, v30
    v_add_f32 v49, v48, v32
    v_cos_f32 v56, v48
    v_add_f32 v50, v49, v34
    v_cos_f32 v57, v49
    v_add_f32 v51, v50, v32
    v_cos_f32 v58, v50
    v_add_f32 v52, v51, v34
    v_cos_f32 v59, v51
    v_add_f32 v53, v52, v32
    v_cos_f32 v60, v52
    v_add_f32 v54, v53, v34
    v_cos_f32 v61, v53
    v_add_f32 v55, v54, v32
    v_cos_f32 v62, v54
    v_cos_f32 v63, v55
    v_add_f32 v30, v48, v36
    v_cvt_pk_bf16_f32 v64, v56, v57
    v_cvt_pk_bf16_f32 v65, v58, v59
    v_cvt_pk_bf16_f32 v66, v60, v61
    v_cvt_pk_bf16_f32 v67, v62, v63
    v_accvgpr_write_b32 a120, v64
    v_accvgpr_write_b32 a121, v65
    v_accvgpr_write_b32 a122, v66
    v_accvgpr_write_b32 a123, v67
    v_alignbit_b32 v68, v64, v64, v40
    v_xor_b32 v68, v68, v41
    v_alignbit_b32 v69, v65, v65, v40
    v_xor_b32 v69, v69, v41
    v_alignbit_b32 v70, v66, v66, v40
    v_xor_b32 v70, v70, v41
    v_alignbit_b32 v71, v67, v67, v40
    v_xor_b32 v71, v71, v41
    v_accvgpr_write_b32 a248, v68
    v_accvgpr_write_b32 a249, v69
    v_accvgpr_write_b32 a250, v70
    v_accvgpr_write_b32 a251, v71
    v_fract_f32 v48, v31
    v_add_f32 v49, v48, v33
    v_cos_f32 v56, v48
    v_add_f32 v50, v49, v35
    v_cos_f32 v57, v49
    v_add_f32 v51, v50, v33
    v_cos_f32 v58, v50
    v_add_f32 v52, v51, v35
    v_cos_f32 v59, v51
    v_add_f32 v53, v52, v33
    v_cos_f32 v60, v52
    v_add_f32 v54, v53, v35
    v_cos_f32 v61, v53
    v_add_f32 v55, v54, v33
    v_cos_f32 v62, v54
    v_cos_f32 v63, v55
    v_add_f32 v31, v48, v37
    v_cvt_pk_bf16_f32 v64, v56, v57
    v_cvt_pk_bf16_f32 v65, v58, v59
    v_cvt_pk_bf16_f32 v66, v60, v61
    v_cvt_pk_bf16_f32 v67, v62, v63
    v_accvgpr_write_b32 a124, v64
    v_accvgpr_write_b32 a125, v65
    v_accvgpr_write_b32 a126, v66
    v_accvgpr_write_b32 a127, v67
    v_alignbit_b32 v68, v64, v64, v40
    v_xor_b32 v68, v68, v41
    v_alignbit_b32 v69, v65, v65, v40
    v_xor_b32 v69, v69, v41
    v_alignbit_b32 v70, v66, v66, v40
    v_xor_b32 v70, v70, v41
    v_alignbit_b32 v71, v67, v67, v40
    v_xor_b32 v71, v71, v41
    v_accvgpr_write_b32 a252, v68
    v_accvgpr_write_b32 a253, v69
    v_accvgpr_write_b32 a254, v70
    v_accvgpr_write_b32 a255, v71
    v_lshlrev_b32 v6, 31, v38
    v_or_b32 v6, 0x3f003f00, v6
    v_cmp_gt_u32 vcc, 16, v1
    v_accvgpr_read_b32 v5, a0
    s_nop 0
    v_cndmask_b32 v5, v5, v6, vcc
    v_accvgpr_write_b32 a0, v5
    v_accvgpr_read_b32 v5, a4
    v_cndmask_b32 v5, v5, v6, vcc
    v_accvgpr_write_b32 a4, v5
    v_and_b32 v5, 15, v1
    v_lshrrev_b32 v6, 4, v1
    v_lshlrev_b32 v5, 4, v5
    v_lshl_add_u32 v10, v6, 9, v5
    v_add_u32 v11, 2048, v10
    v_add_u32 v12, 0x10000, v10
    v_add_u32 v13, 0x10000, v11
    s_lshl_b32 s19, s16, 10
    s_lshl_b32 s17, s16, 1
    v_lshrrev_b32 v8, 5, v1
    v_add_u32 v8, s17, v8
    v_and_b32 v7, 31, v1
    v_mul_u32_u24 v2, 33024, v8
    v_lshl_add_u32 v2, v7, 4, v2
    v_and_b32 v3, 15, v1
    v_and_b32 v5, 48, v1
    v_lshl_add_u32 v3, v3, 12, v5
    v_add_u32 v4, 0x10000, v3
    s_lshl_b32 s21, s28, 21
    s_lshl_b32 s17, s29, 6
    s_add_u32 s21, s21, s17
    s_lshl_b32 s20, s28, 13
    s_add_u32 s20, s20, 111149056
    s_mov_b32 s24, 512
    s_mov_b32 s25, 131072
    v_and_b32 v7, 31, v1
    v_lshlrev_b32 v7, 7, v7
    s_lshl_b32 s17, s16, 12
    s_add_u32 s17, s17, 100761600
    v_add_u32 v7, s17, v7
    s_mov_b32 s30, s92
F3_w0:
    buffer_load_dword v5, v7, s[4:7], 0 offen sc1
    s_waitcnt vmcnt(0)
    v_cmp_gt_u32 vcc, 1, v5
    s_nop 0
    s_cmp_lg_u64 vcc, 0
    s_cbranch_scc0 F3_w0_ok
    s_cmp_ge_u32 s30, 1048576
    s_cselect_b32 s92, 1048576, s92
    s_cbranch_scc1 F3_w0_ok
    s_add_u32 s30, s30, 1
    s_sleep 8
    s_branch F3_w0
F3_w0_ok:
    s_barrier
    s_mov_b32 s26, s25
    s_sub_u32 s25, s21, 1073741824
    s_mov_b32 s21, 1073741824
    s_mov_b32 s23, 0
    s_mov_b32 s22, 0
    s_add_u32 m0, s19, 0
    s_add_u32 s17, s20, 0
    buffer_load_dwordx4 v2, s[4:7], s17 offen lds
    s_add_u32 m0, s19, 4096
    s_add_u32 s17, s20, 264192
    buffer_load_dwordx4 v2, s[4:7], s17 offen lds
    s_add_u32 m0, s19, 8192
    s_add_u32 s17, s20, 528384
    buffer_load_dwordx4 v2, s[4:7], s17 offen lds
    s_add_u32 m0, s19, 12288
    s_add_u32 s17, s20, 792576
    buffer_load_dwordx4 v2, s[4:7], s17 offen lds
    s_add_u32 m0, s19, 16384
    s_add_u32 s17, s20, 1056768
    buffer_load_dwordx4 v2, s[4:7], s17 offen lds
    s_add_u32 m0, s19, 20480
    s_add_u32 s17, s20, 1320960
    buffer_load_dwordx4 v2, s[4:7], s17 offen lds
    s_add_u32 m0, s19, 24576
    s_add_u32 s17, s20, 1585152
    buffer_load_dwordx4 v2, s[4:7], s17 offen lds
    s_add_u32 m0, s19, 28672
    s_add_u32 s17, s20, 1849344
    buffer_load_dwordx4 v2, s[4:7], s17 offen lds
    s_add_u32 m0, s19, 32768
    s_add_u32 s17, s20, 2113536
    buffer_load_dwordx4 v2, s[4:7], s17 offen lds
    s_add_u32 m0, s19, 36864
    s_add_u32 s17, s20, 2377728
    buffer_load_dwordx4 v2, s[4:7], s17 offen lds
    s_add_u32 m0, s19, 40960
    s_add_u32 s17, s20, 2641920
    buffer_load_dwordx4 v2, s[4:7], s17 offen lds
    s_add_u32 m0, s19, 45056
    s_add_u32 s17, s20, 2906112
    buffer_load_dwordx4 v2, s[4:7], s17 offen lds
    s_add_u32 m0, s19, 49152
    s_add_u32 s17, s20, 3170304
    buffer_load_dwordx4 v2, s[4:7], s17 offen lds
    s_add_u32 m0, s19, 53248
    s_add_u32 s17, s20, 3434496
    buffer_load_dwordx4 v2, s[4:7], s17 offen lds
    s_add_u32 m0, s19, 57344
    s_add_u32 s17, s20, 3698688
    buffer_load_dwordx4 v2, s[4:7], s17 offen lds
    s_add_u32 m0, s19, 61440
    s_add_u32 s17, s20, 3962880
    buffer_load_dwordx4 v2, s[4:7], s17 offen lds
    s_add_u32 s20, s20, s24
    s_add_u32 m0, s19, 65536
    s_add_u32 s17, s20, 0
    buffer_load_dwordx4 v2, s[4:7], s17 offen lds
    s_add_u32 m0, s19, 69632
    s_add_u32 s17, s20, 264192
    buffer_load_dwordx4 v2, s[4:7], s17 offen lds
    s_add_u32 m0, s19, 73728
    s_add_u32 s17, s20, 528384
    buffer_load_dwordx4 v2, s[4:7], s17 offen lds
    s_waitcnt vmcnt(11)
    s_barrier
    ds_read_b128 v[20:23], v10 offset:0
    ds_read_b128 v[24:27], v10 offset:256
    ds_read_b128 v[28:31], v11 offset:0
    ds_read_b128 v[32:35], v11 offset:256
    ds_read_b128 v[36:39], v10 offset:4096
    ds_read_b128 v[40:43], v10 offset:4352
    ds_read_b128 v[44:47], v11 offset:4096
.p2align 6
F3_top:
    s_waitcnt lgkmcnt(6)
    v_mfma_f32_16x16x32_bf16 v[52:55], a[0:3], v[20:23], 0
    ds_read_b128 v[48:51], v11 offset:4352
    v_mfma_f32_16x16x32_bf16 v[56:59], a[4:7], v[20:23], 0
    s_waitcnt lgkmcnt(6)
    v_mfma_f32_16x16x32_bf16 v[60:63], a[0:3], v[24:27], 0
    ds_read_b128 v[20:23], v10 offset:8192
    s_add_u32 m0, s19, 77824
    v_mfma_f32_16x16x32_bf16 v[64:67], a[4:7], v[24:27], 0
    s_add_u32 s17, s20, 792576
    buffer_load_dwordx4 v2, s[4:7], s17 offen lds
    s_waitcnt lgkmcnt(6)
    v_mfma_f32_16x16x32_bf16 v[52:55], a[8:11], v[28:31], v[52:55]
    ds_read_b128 v[24:27], v10 offset:8448
    v_mfma_f32_16x16x32_bf16 v[56:59], a[12:15], v[28:31], v[56:59]
    s_waitcnt lgkmcnt(6)
    v_mfma_f32_16x16x32_bf16 v[60:63], a[8:11], v[32:35], v[60:63]
    ds_read_b128 v[28:31], v11 offset:8192
    s_add_u32 m0, s19, 81920
    v_mfma_f32_16x16x32_bf16 v[64:67], a[12:15], v[32:35], v[64:67]
    s_add_u32 s17, s20, 1056768
    buffer_load_dwordx4 v2, s[4:7], s17 offen lds
    s_waitcnt lgkmcnt(6)
    v_mfma_f32_16x16x32_bf16 v[52:55], a[16:19], v[36:39], v[52:55]
    ds_read_b128 v[32:35], v11 offset:8448
    v_mfma_f32_16x16x32_bf16 v[56:59], a[20:23], v[36:39], v[56:59]
    s_waitcnt lgkmcnt(6)
    v_mfma_f32_16x16x32_bf16 v[60:63], a[16:19], v[40:43], v[60:63]
    ds_read_b128 v[36:39], v10 offset:12288
    s_add_u32 m0, s19, 86016
    v_mfma_f32_16x16x32_bf16 v[64:67], a[20:23], v[40:43], v[64:67]
    s_add_u32 s17, s20, 1320960
    buffer_load_dwordx4 v2, s[4:7], s17 offen lds
    s_waitcnt lgkmcnt(6)
    v_mfma_f32_16x16x32_bf16 v[52:55], a[24:27], v[44:47], v[52:55]
    ds_read_b128 v[40:43], v10 offset:12544
    v_mfma_f32_16x16x32_bf16 v[56:59], a[28:31], v[44:47], v[56:59]
    s_waitcnt lgkmcnt(6)
    v_mfma_f32_16x16x32_bf16 v[60:63], a[24:27], v[48:51], v[60:63]
    ds_read_b128 v[44:47], v11 offset:12288
    s_add_u32 m0, s19, 90112
    v_mfma_f32_16x16x32_bf16 v[64:67], a[28:31], v[48:51], v[64:67]
    s_add_u32 s17, s20, 1585152
    buffer_load_dwordx4 v2, s[4:7], s17 offen lds
    s_waitcnt lgkmcnt(6)
    v_mfma_f32_16x16x32_bf16 v[52:55], a[32:35], v[20:23], v[52:55]
    ds_read_b128 v[48:51], v11 offset:12544
    v_mfma_f32_16x16x32_bf16 v[56:59], a[36:39], v[20:23], v[56:59]
    s_waitcnt lgkmcnt(6)
    v_mfma_f32_16x16x32_bf16 v[60:63], a[32:35], v[24:27], v[60:63]
    ds_read_b128 v[20:23], v10 offset:16384
    s_add_u32 m0, s19, 94208
    v_mfma_f32_16x16x32_bf16 v[64:67], a[36:39], v[24:27], v[64:67]
    s_add_u32 s17, s20, 1849344
    buffer_load_dwordx4 v2, s[4:7], s17 offen lds
    s_waitcnt lgkmcnt(6)
    v_mfma_f32_16x16x32_bf16 v[52:55], a[40:43], v[28:31], v[52:55]
    ds_read_b128 v[24:27], v10 offset:16640
    v_mfma_f32_16x16x32_bf16 v[56:59], a[44:47], v[28:31], v[56:59]
    v_cvt_pk_bf16_f32 v84, v68, v69
    s_waitcnt lgkmcnt(6)
    v_mfma_f32_16x16x32_bf16 v[60:63], a[40:43], v[32:35], v[60:63]
    ds_read_b128 v[28:31], v11 offset:16384
    v_mfma_f32_16x16x32_bf16 v[64:67], a[44:47], v[32:35], v[64:67]
    v_cvt_pk_bf16_f32 v85, v70, v71
    s_waitcnt lgkmcnt(6)
    v_mfma_f32_16x16x32_bf16 v[52:55], a[48:51], v[36:39], v[52:55]
    ds_read_b128 v[32:35], v11 offset:16640
    v_mfma_f32_16x16x32_bf16 v[56:59], a[52:55], v[36:39], v[56:59]
    v_cvt_pk_bf16_f32 v86, v72, v73
    s_waitcnt lgkmcnt(6)
    v_mfma_f32_16x16x32_bf16 v[60:63], a[48:51], v[40:43], v[60:63]
    ds_read_b128 v[36:39], v10 offset:20480
    v_mfma_f32_16x16x32_bf16 v[64:67], a[52:55], v[40:43], v[64:67]
    v_cvt_pk_bf16_f32 v87, v74, v75
    s_waitcnt lgkmcnt(6)
    v_mfma_f32_16x16x32_bf16 v[52:55], a[56:59], v[44:47], v[52:55]
    ds_read_b128 v[40:43], v10 offset:20736
    v_mfma_f32_16x16x32_bf16 v[56:59], a[60:63], v[44:47], v[56:59]
    v_cvt_pk_bf16_f32 v88, v76, v77
    s_waitcnt lgkmcnt(6)
    v_mfma_f32_16x16x32_bf16 v[60:63], a[56:59], v[48:51], v[60:63]
    ds_read_b128 v[44:47], v11 offset:20480
    v_mfma_f32_16x16x32_bf16 v[64:67], a[60:63], v[48:51], v[64:67]
    v_cvt_pk_bf16_f32 v89, v78, v79
    buffer_store_dwordx4 v[84:87], v3, s[12:15], s21 offen
    s_waitcnt lgkmcnt(6)
    v_mfma_f32_16x16x32_bf16 v[52:55], a[64:67], v[20:23], v[52:55]
    ds_read_b128 v[48:51], v11 offset:20736
    v_mfma_f32_16x16x32_bf16 v[56:59], a[68:71], v[20:23], v[56:59]
    v_cvt_pk_bf16_f32 v90, v80, v81
    s_waitcnt lgkmcnt(6)
    v_mfma_f32_16x16x32_bf16 v[60:63], a[64:67], v[24:27], v[60:63]
    ds_read_b128 v[20:23], v10 offset:24576
    v_mfma_f32_16x16x32_bf16 v[64:67], a[68:71], v[24:27], v[64:67]
    v_cvt_pk_bf16_f32 v91, v82, v83
    s_waitcnt lgkmcnt(6)
    v_mfma_f32_16x16x32_bf16 v[52:55], a[72:75], v[28:31], v[52:55]
    ds_read_b128 v[24:27], v10 offset:24832
    v_mfma_f32_16x16x32_bf16 v[56:59], a[76:79], v[28:31], v[56:59]
    s_waitcnt lgkmcnt(6)
    v_mfma_f32_16x16x32_bf16 v[60:63], a[72:75], v[32:35], v[60:63]
    ds_read_b128 v[28:31], v11 offset:24576
    v_mfma_f32_16x16x32_bf16 v[64:67], a[76:79], v[32:35], v[64:67]
    buffer_store_dwordx4 v[88:91], v4, s[12:15], s21 offen
    s_waitcnt lgkmcnt(6)
    v_mfma_f32_16x16x32_bf16 v[52:55], a[80:83], v[36:39], v[52:55]
    ds_read_b128 v[32:35], v11 offset:24832
    v_mfma_f32_16x16x32_bf16 v[56:59], a[84:87], v[36:39], v[56:59]
    s_add_u32 s21, s21, s25
    s_mov_b32 s25, s26
    s_waitcnt lgkmcnt(6)
    v_mfma_f32_16x16x32_bf16 v[60:63], a[80:83], v[40:43], v[60:63]
    ds_read_b128 v[36:39], v10 offset:28672
    v_mfma_f32_16x16x32_bf16 v[64:67], a[84:87], v[40:43], v[64:67]
    s_waitcnt lgkmcnt(6)
    v_mfma_f32_16x16x32_bf16 v[52:55], a[88:91], v[44:47], v[52:55]
    ds_read_b128 v[40:43], v10 offset:28928
    v_mfma_f32_16x16x32_bf16 v[56:59], a[92:95], v[44:47], v[56:59]
    s_waitcnt lgkmcnt(6)
    v_mfma_f32_16x16x32_bf16 v[60:63], a[88:91], v[48:51], v[60:63]
    ds_read_b128 v[44:47], v11 offset:28672
    v_mfma_f32_16x16x32_bf16 v[64:67], a[92:95], v[48:51], v[64:67]
    s_waitcnt lgkmcnt(6)
    v_mfma_f32_16x16x32_bf16 v[52:55], a[96:99], v[20:23], v[52:55]
    ds_read_b128 v[48:51], v11 offset:28928
    v_mfma_f32_16x16x32_bf16 v[56:59], a[100:103], v[20:23], v[56:59]
    s_waitcnt lgkmcnt(6)
    v_mfma_f32_16x16x32_bf16 v[60:63], a[96:99], v[24:27], v[60:63]
    s_waitcnt vmcnt(10)
    s_barrier
    ds_read_b128 v[20:23], v10 offset:32768
    v_mfma_f32_16x16x32_bf16 v[64:67], a[100:103], v[24:27], v[64:67]
    s_waitcnt lgkmcnt(6)
    v_mfma_f32_16x16x32_bf16 v[52:55], a[104:107], v[28:31], v[52:55]
    ds_read_b128 v[24:27], v10 offset:33024
    s_add_u32 m0, s19, 98304
    v_mfma_f32_16x16x32_bf16 v[56:59], a[108:111], v[28:31], v[56:59]
    s_add_u32 s17, s20, 2113536
    buffer_load_dwordx4 v2, s[4:7], s17 offen lds
    s_waitcnt lgkmcnt(6)
    v_mfma_f32_16x16x32_bf16 v[60:63], a[104:107], v[32:35], v[60:63]
    ds_read_b128 v[28:31], v11 offset:32768
    v_mfma_f32_16x16x32_bf16 v[64:67], a[108:111], v[32:35], v[64:67]
    s_waitcnt lgkmcnt(6)
    v_mfma_f32_16x16x32_bf16 v[52:55], a[112:115], v[36:39], v[52:55]
    ds_read_b128 v[32:35], v11 offset:33024
    s_add_u32 m0, s19, 102400
    v_mfma_f32_16x16x32_bf16 v[56:59], a[116:119], v[36:39], v[56:59]
    s_add_u32 s17, s20, 2377728
    buffer_load_dwordx4 v2, s[4:7], s17 offen lds
    s_waitcnt lgkmcnt(6)
    v_mfma_f32_16x16x32_bf16 v[60:63], a[112:115], v[40:43], v[60:63]
    ds_read_b128 v[36:39], v10 offset:36864
    v_mfma_f32_16x16x32_bf16 v[64:67], a[116:119], v[40:43], v[64:67]
    s_waitcnt lgkmcnt(6)
    v_mfma_f32_16x16x32_bf16 v[52:55], a[120:123], v[44:47], v[52:55]
    ds_read_b128 v[40:43], v10 offset:37120
    s_add_u32 m0, s19, 106496
    v_mfma_f32_16x16x32_bf16 v[56:59], a[124:127], v[44:47], v[56:59]
    s_add_u32 s17, s20, 2641920
    buffer_load_dwordx4 v2, s[4:7], s17 offen lds
    s_waitcnt lgkmcnt(6)
    v_mfma_f32_16x16x32_bf16 v[60:63], a[120:123], v[48:51], v[60:63]
    ds_read_b128 v[44:47], v11 offset:36864
    v_mfma_f32_16x16x32_bf16 v[64:67], a[124:127], v[48:51], v[64:67]
    s_waitcnt lgkmcnt(6)
    v_mfma_f32_16x16x32_bf16 v[52:55], a[128:131], v[20:23], v[52:55]
    ds_read_b128 v[48:51], v11 offset:37120
    v_mfma_f32_16x16x32_bf16 v[56:59], a[132:135], v[20:23], v[56:59]
    s_waitcnt lgkmcnt(6)
    v_mfma_f32_16x16x32_bf16 v[60:63], a[128:131], v[24:27], v[60:63]
    ds_read_b128 v[20:23], v10 offset:40960
    s_add_u32 m0, s19, 110592
    v_mfma_f32_16x16x32_bf16 v[64:67], a[132:135], v[24:27], v[64:67]
    s_add_u32 s17, s20, 2906112
    buffer_load_dwordx4 v2, s[4:7], s17 offen lds
    s_waitcnt lgkmcnt(6)
    v_mfma_f32_16x16x32_bf16 v[52:55], a[136:139], v[28:31], v[52:55]
    ds_read_b128 v[24:27], v10 offset:41216
    v_mfma_f32_16x16x32_bf16 v[56:59], a[140:143], v[28:31], v[56:59]
    s_waitcnt lgkmcnt(6)
    v_mfma_f32_16x16x32_bf16 v[60:63], a[136:139], v[32:35], v[60:63]
    ds_read_b128 v[28:31], v11 offset:40960
    s_add_u32 m0, s19, 114688
    v_mfma_f32_16x16x32_bf16 v[64:67], a[140:143], v[32:35], v[64:67]
    s_add_u32 s17, s20, 3170304
    buffer_load_dwordx4 v2, s[4:7], s17 offen lds
    s_waitcnt lgkmcnt(6)
    v_mfma_f32_16x16x32_bf16 v[52:55], a[144:147], v[36:39], v[52:55]
    ds_read_b128 v[32:35], v11 offset:41216
    v_mfma_f32_16x16x32_bf16 v[56:59], a[148:151], v[36:39], v[56:59]
    s_waitcnt lgkmcnt(6)
    v_mfma_f32_16x16x32_bf16 v[60:63], a[144:147], v[40:43], v[60:63]
    ds_read_b128 v[36:39], v10 offset:45056
    s_add_u32 m0, s19, 118784
    v_mfma_f32_16x16x32_bf16 v[64:67], a[148:151], v[40:43], v[64:67]
    s_add_u32 s17, s20, 3434496
    buffer_load_dwordx4 v2, s[4:7], s17 offen lds
    s_waitcnt lgkmcnt(6)
    v_mfma_f32_16x16x32_bf16 v[52:55], a[152:155], v[44:47], v[52:55]
    ds_read_b128 v[40:43], v10 offset:45312
    v_mfma_f32_16x16x32_bf16 v[56:59], a[156:159], v[44:47], v[56:59]
    s_waitcnt lgkmcnt(6)
    v_mfma_f32_16x16x32_bf16 v[60:63], a[152:155], v[48:51], v[60:63]
    ds_read_b128 v[44:47], v11 offset:45056
    s_add_u32 m0, s19, 122880
    v_mfma_f32_16x16x32_bf16 v[64:67], a[156:159], v[48:51], v[64:67]
    s_add_u32 s17, s20, 3698688
    buffer_load_dwordx4 v2, s[4:7], s17 offen lds
    s_waitcnt lgkmcnt(6)
    v_mfma_f32_16x16x32_bf16 v[52:55], a[160:163], v[20:23], v[52:55]
    ds_read_b128 v[48:51], v11 offset:45312
    v_mfma_f32_16x16x32_bf16 v[56:59], a[164:167], v[20:23], v[56:59]
    s_waitcnt lgkmcnt(6)
    v_mfma_f32_16x16x32_bf16 v[60:63], a[160:163], v[24:27], v[60:63]
    ds_read_b128 v[20:23], v10 offset:49152
    s_add_u32 m0, s19, 126976
    v_mfma_f32_16x16x32_bf16 v[64:67], a[164:167], v[24:27], v[64:67]
    s_add_u32 s17, s20, 3962880
    buffer_load_dwordx4 v2, s[4:7], s17 offen lds
    s_waitcnt lgkmcnt(6)
    v_mfma_f32_16x16x32_bf16 v[52:55], a[168:171], v[28:31], v[52:55]
    ds_read_b128 v[24:27], v10 offset:49408
    v_mfma_f32_16x16x32_bf16 v[56:59], a[172:175], v[28:31], v[56:59]
    s_add_u32 s20, s20, s24
    s_waitcnt lgkmcnt(6)
    v_mfma_f32_16x16x32_bf16 v[60:63], a[168:171], v[32:35], v[60:63]
    ds_read_b128 v[28:31], v11 offset:49152
    v_mfma_f32_16x16x32_bf16 v[64:67], a[172:175], v[32:35], v[64:67]
    s_waitcnt lgkmcnt(6)
    v_mfma_f32_16x16x32_bf16 v[52:55], a[176:179], v[36:39], v[52:55]
    ds_read_b128 v[32:35], v11 offset:49408
    v_mfma_f32_16x16x32_bf16 v[56:59], a[180:183], v[36:39], v[56:59]
    s_waitcnt lgkmcnt(6)
    v_mfma_f32_16x16x32_bf16 v[60:63], a[176:179], v[40:43], v[60:63]
    ds_read_b128 v[36:39], v10 offset:53248
    v_mfma_f32_16x16x32_bf16 v[64:67], a[180:183], v[40:43], v[64:67]
    s_waitcnt lgkmcnt(6)
    v_mfma_f32_16x16x32_bf16 v[52:55], a[184:187], v[44:47], v[52:55]
    ds_read_b128 v[40:43], v10 offset:53504
    v_mfma_f32_16x16x32_bf16 v[56:59], a[188:191], v[44:47], v[56:59]
    s_waitcnt lgkmcnt(6)
    v_mfma_f32_16x16x32_bf16 v[60:63], a[184:187], v[48:51], v[60:63]
    ds_read_b128 v[44:47], v11 offset:53248
    v_mfma_f32_16x16x32_bf16 v[64:67], a[188:191], v[48:51], v[64:67]
    s_waitcnt lgkmcnt(6)
    v_mfma_f32_16x16x32_bf16 v[52:55], a[192:195], v[20:23], v[52:55]
    ds_read_b128 v[48:51], v11 offset:53504
    v_mfma_f32_16x16x32_bf16 v[56:59], a[196:199], v[20:23], v[56:59]
    s_waitcnt lgkmcnt(6)
    v_mfma_f32_16x16x32_bf16 v[60:63], a[192:195], v[24:27], v[60:63]
    ds_read_b128 v[20:23], v10 offset:57344
    v_mfma_f32_16x16x32_bf16 v[64:67], a[196:199], v[24:27], v[64:67]
    s_waitcnt lgkmcnt(6)
    v_mfma_f32_16x16x32_bf16 v[52:55], a[200:203], v[28:31], v[52:55]
    ds_read_b128 v[24:27], v10 offset:57600
    v_mfma_f32_16x16x32_bf16 v[56:59], a[204:207], v[28:31], v[56:59]
    s_waitcnt lgkmcnt(6)
    v_mfma_f32_16x16x32_bf16 v[60:63], a[200:203], v[32:35], v[60:63]
    ds_read_b128 v[28:31], v11 offset:57344
    v_mfma_f32_16x16x32_bf16 v[64:67], a[204:207], v[32:35], v[64:67]
    s_waitcnt lgkmcnt(6)
    v_mfma_f32_16x16x32_bf16 v[52:55], a[208:211], v[36:39], v[52:55]
    ds_read_b128 v[32:35], v11 offset:57600
    v_mfma_f32_16x16x32_bf16 v[56:59], a[212:215], v[36:39], v[56:59]
    s_waitcnt lgkmcnt(6)
    v_mfma_f32_16x16x32_bf16 v[60:63], a[208:211], v[40:43], v[60:63]
    ds_read_b128 v[36:39], v10 offset:61440
    v_mfma_f32_16x16x32_bf16 v[64:67], a[212:215], v[40:43], v[64:67]
    s_waitcnt lgkmcnt(6)
    v_mfma_f32_16x16x32_bf16 v[52:55], a[216:219], v[44:47], v[52:55]
    ds_read_b128 v[40:43], v10 offset:61696
    v_mfma_f32_16x16x32_bf16 v[56:59], a[220:223], v[44:47], v[56:59]
    s_waitcnt lgkmcnt(6)
    v_mfma_f32_16x16x32_bf16 v[60:63], a[216:219], v[48:51], v[60:63]
    ds_read_b128 v[44:47], v11 offset:61440
    v_mfma_f32_16x16x32_bf16 v[64:67], a[220:223], v[48:51], v[64:67]
    s_waitcnt lgkmcnt(6)
    v_mfma_f32_16x16x32_bf16 v[52:55], a[224:227], v[20:23], v[52:55]
    ds_read_b128 v[48:51], v11 offset:61696
    v_mfma_f32_16x16x32_bf16 v[56:59], a[228:231], v[20:23], v[56:59]
    s_waitcnt lgkmcnt(6)
    v_mfma_f32_16x16x32_bf16 v[60:63], a[224:227], v[24:27], v[60:63]
    s_waitcnt vmcnt(8)
    s_barrier
    ds_read_b128 v[20:23], v12 offset:0
    v_mfma_f32_16x16x32_bf16 v[64:67], a[228:231], v[24:27], v[64:67]
    s_waitcnt lgkmcnt(6)
    v_mfma_f32_16x16x32_bf16 v[52:55], a[232:235], v[28:31], v[52:55]
    ds_read_b128 v[24:27], v12 offset:256
    s_add_u32 m0, s19, 0
    v_mfma_f32_16x16x32_bf16 v[56:59], a[236:239], v[28:31], v[56:59]
    s_add_u32 s17, s20, 0
    buffer_load_dwordx4 v2, s[4:7], s17 offen lds
    s_waitcnt lgkmcnt(6)
    v_mfma_f32_16x16x32_bf16 v[60:63], a[232:235], v[32:35], v[60:63]
    ds_read_b128 v[28:31], v13 offset:0
    v_mfma_f32_16x16x32_bf16 v[64:67], a[236:239], v[32:35], v[64:67]
    s_waitcnt lgkmcnt(6)
    v_mfma_f32_16x16x32_bf16 v[52:55], a[240:243], v[36:39], v[52:55]
    ds_read_b128 v[32:35], v13 offset:256
    s_add_u32 m0, s19, 4096
    v_mfma_f32_16x16x32_bf16 v[56:59], a[244:247], v[36:39], v[56:59]
    s_add_u32 s17, s20, 264192
    buffer_load_dwordx4 v2, s[4:7], s17 offen lds
    s_waitcnt lgkmcnt(6)
    v_mfma_f32_16x16x32_bf16 v[60:63], a[240:243], v[40:43], v[60:63]
    ds_read_b128 v[36:39], v12 offset:4096
    v_mfma_f32_16x16x32_bf16 v[64:67], a[244:247], v[40:43], v[64:67]
    s_waitcnt lgkmcnt(6)
    v_mfma_f32_16x16x32_bf16 v[52:55], a[248:251], v[44:47], v[52:55]
    ds_read_b128 v[40:43], v12 offset:4352
    s_add_u32 m0, s19, 8192
    v_mfma_f32_16x16x32_bf16 v[56:59], a[252:255], v[44:47], v[56:59]
    s_add_u32 s17, s20, 528384
    buffer_load_dwordx4 v2, s[4:7], s17 offen lds
    s_waitcnt lgkmcnt(6)
    v_mfma_f32_16x16x32_bf16 v[60:63], a[248:251], v[48:51], v[60:63]
    ds_read_b128 v[44:47], v13 offset:4096
    v_mfma_f32_16x16x32_bf16 v[64:67], a[252:255], v[48:51], v[64:67]
    s_waitcnt lgkmcnt(6)
    v_mfma_f32_16x16x32_bf16 v[68:71], a[0:3], v[20:23], 0
    ds_read_b128 v[48:51], v13 offset:4352
    v_mfma_f32_16x16x32_bf16 v[72:75], a[4:7], v[20:23], 0
    s_waitcnt lgkmcnt(6)
    v_mfma_f32_16x16x32_bf16 v[76:79], a[0:3], v[24:27], 0
    ds_read_b128 v[20:23], v12 offset:8192
    s_add_u32 m0, s19, 12288
    v_mfma_f32_16x16x32_bf16 v[80:83], a[4:7], v[24:27], 0
    s_add_u32 s17, s20, 792576
    buffer_load_dwordx4 v2, s[4:7], s17 offen lds
    s_waitcnt lgkmcnt(6)
    v_mfma_f32_16x16x32_bf16 v[68:71], a[8:11], v[28:31], v[68:71]
    ds_read_b128 v[24:27], v12 offset:8448
    v_mfma_f32_16x16x32_bf16 v[72:75], a[12:15], v[28:31], v[72:75]
    s_waitcnt lgkmcnt(6)
    v_mfma_f32_16x16x32_bf16 v[76:79], a[8:11], v[32:35], v[76:79]
    ds_read_b128 v[28:31], v13 offset:8192
    s_add_u32 m0, s19, 16384
    v_mfma_f32_16x16x32_bf16 v[80:83], a[12:15], v[32:35], v[80:83]
    s_add_u32 s17, s20, 1056768
    buffer_load_dwordx4 v2, s[4:7], s17 offen lds
    s_waitcnt lgkmcnt(6)
    v_mfma_f32_16x16x32_bf16 v[68:71], a[16:19], v[36:39], v[68:71]
    ds_read_b128 v[32:35], v13 offset:8448
    v_mfma_f32_16x16x32_bf16 v[72:75], a[20:23], v[36:39], v[72:75]
    s_waitcnt lgkmcnt(6)
    v_mfma_f32_16x16x32_bf16 v[76:79], a[16:19], v[40:43], v[76:79]
    ds_read_b128 v[36:39], v12 offset:12288
    s_add_u32 m0, s19, 20480
    v_mfma_f32_16x16x32_bf16 v[80:83], a[20:23], v[40:43], v[80:83]
    s_add_u32 s17, s20, 1320960
    buffer_load_dwordx4 v2, s[4:7], s17 offen lds
    s_waitcnt lgkmcnt(6)
    v_mfma_f32_16x16x32_bf16 v[68:71], a[24:27], v[44:47], v[68:71]
    ds_read_b128 v[40:43], v12 offset:12544
    v_mfma_f32_16x16x32_bf16 v[72:75], a[28:31], v[44:47], v[72:75]
    s_waitcnt lgkmcnt(6)
    v_mfma_f32_16x16x32_bf16 v[76:79], a[24:27], v[48:51], v[76:79]
    ds_read_b128 v[44:47], v13 offset:12288
    s_add_u32 m0, s19, 24576
    v_mfma_f32_16x16x32_bf16 v[80:83], a[28:31], v[48:51], v[80:83]
    s_add_u32 s17, s20, 1585152
    buffer_load_dwordx4 v2, s[4:7], s17 offen lds
    s_waitcnt lgkmcnt(6)
    v_mfma_f32_16x16x32_bf16 v[68:71], a[32:35], v[20:23], v[68:71]
    ds_read_b128 v[48:51], v13 offset:12544
    v_mfma_f32_16x16x32_bf16 v[72:75], a[36:39], v[20:23], v[72:75]
    s_waitcnt lgkmcnt(6)
    v_mfma_f32_16x16x32_bf16 v[76:79], a[32:35], v[24:27], v[76:79]
    ds_read_b128 v[20:23], v12 offset:16384
    s_add_u32 m0, s19, 28672
    v_mfma_f32_16x16x32_bf16 v[80:83], a[36:39], v[24:27], v[80:83]
    s_add_u32 s17, s20, 1849344
    buffer_load_dwordx4 v2, s[4:7], s17 offen lds
    s_waitcnt lgkmcnt(6)
    v_mfma_f32_16x16x32_bf16 v[68:71], a[40:43], v[28:31], v[68:71]
    ds_read_b128 v[24:27], v12 offset:16640
    v_mfma_f32_16x16x32_bf16 v[72:75], a[44:47], v[28:31], v[72:75]
    v_cvt_pk_bf16_f32 v84, v52, v53
    s_waitcnt lgkmcnt(6)
    v_mfma_f32_16x16x32_bf16 v[76:79], a[40:43], v[32:35], v[76:79]
    ds_read_b128 v[28:31], v13 offset:16384
    v_mfma_f32_16x16x32_bf16 v[80:83], a[44:47], v[32:35], v[80:83]
    v_cvt_pk_bf16_f32 v85, v54, v55
    s_waitcnt lgkmcnt(6)
    v_mfma_f32_16x16x32_bf16 v[68:71], a[48:51], v[36:39], v[68:71]
    ds_read_b128 v[32:35], v13 offset:16640
    v_mfma_f32_16x16x32_bf16 v[72:75], a[52:55], v[36:39], v[72:75]
    v_cvt_pk_bf16_f32 v86, v56, v57
    s_waitcnt lgkmcnt(6)
    v_mfma_f32_16x16x32_bf16 v[76:79], a[48:51], v[40:43], v[76:79]
    ds_read_b128 v[36:39], v12 offset:20480
    v_mfma_f32_16x16x32_bf16 v[80:83], a[52:55], v[40:43], v[80:83]
    v_cvt_pk_bf16_f32 v87, v58, v59
    s_waitcnt lgkmcnt(6)
    v_mfma_f32_16x16x32_bf16 v[68:71], a[56:59], v[44:47], v[68:71]
    ds_read_b128 v[40:43], v12 offset:20736
    v_mfma_f32_16x16x32_bf16 v[72:75], a[60:63], v[44:47], v[72:75]
    v_cvt_pk_bf16_f32 v88, v60, v61
    s_waitcnt lgkmcnt(6)
    v_mfma_f32_16x16x32_bf16 v[76:79], a[56:59], v[48:51], v[76:79]
    ds_read_b128 v[44:47], v13 offset:20480
    v_mfma_f32_16x16x32_bf16 v[80:83], a[60:63], v[48:51], v[80:83]
    v_cvt_pk_bf16_f32 v89, v62, v63
    buffer_store_dwordx4 v[84:87], v3, s[12:15], s21 offen
    s_waitcnt lgkmcnt(6)
    v_mfma_f32_16x16x32_bf16 v[68:71], a[64:67], v[20:23], v[68:71]
    ds_read_b128 v[48:51], v13 offset:20736
    v_mfma_f32_16x16x32_bf16 v[72:75], a[68:71], v[20:23], v[72:75]
    v_cvt_pk_bf16_f32 v90, v64, v65
    s_waitcnt lgkmcnt(6)
    v_mfma_f32_16x16x32_bf16 v[76:79], a[64:67], v[24:27], v[76:79]
    ds_read_b128 v[20:23], v12 offset:24576
    v_mfma_f32_16x16x32_bf16 v[80:83], a[68:71], v[24:27], v[80:83]
    v_cvt_pk_bf16_f32 v91, v66, v67
    s_waitcnt lgkmcnt(6)
    v_mfma_f32_16x16x32_bf16 v[68:71], a[72:75], v[28:31], v[68:71]
    ds_read_b128 v[24:27], v12 offset:24832
    v_mfma_f32_16x16x32_bf16 v[72:75], a[76:79], v[28:31], v[72:75]
    s_waitcnt lgkmcnt(6)
    v_mfma_f32_16x16x32_bf16 v[76:79], a[72:75], v[32:35], v[76:79]
    ds_read_b128 v[28:31], v13 offset:24576
    v_mfma_f32_16x16x32_bf16 v[80:83], a[76:79], v[32:35], v[80:83]
    buffer_store_dwordx4 v[88:91], v4, s[12:15], s21 offen
    s_waitcnt lgkmcnt(6)
    v_mfma_f32_16x16x32_bf16 v[68:71], a[80:83], v[36:39], v[68:71]
    ds_read_b128 v[32:35], v13 offset:24832
    v_mfma_f32_16x16x32_bf16 v[72:75], a[84:87], v[36:39], v[72:75]
    s_add_u32 s21, s21, s25
    s_mov_b32 s25, s26
    s_waitcnt lgkmcnt(6)
    v_mfma_f32_16x16x32_bf16 v[76:79], a[80:83], v[40:43], v[76:79]
    ds_read_b128 v[36:39], v12 offset:28672
    v_mfma_f32_16x16x32_bf16 v[80:83], a[84:87], v[40:43], v[80:83]
    s_waitcnt lgkmcnt(6)
    v_mfma_f32_16x16x32_bf16 v[68:71], a[88:91], v[44:47], v[68:71]
    ds_read_b128 v[40:43], v12 offset:28928
    v_mfma_f32_16x16x32_bf16 v[72:75], a[92:95], v[44:47], v[72:75]
    s_waitcnt lgkmcnt(6)
    v_mfma_f32_16x16x32_bf16 v[76:79], a[88:91], v[48:51], v[76:79]
    ds_read_b128 v[44:47], v13 offset:28672
    v_mfma_f32_16x16x32_bf16 v[80:83], a[92:95], v[48:51], v[80:83]
    s_waitcnt lgkmcnt(6)
    v_mfma_f32_16x16x32_bf16 v[68:71], a[96:99], v[20:23], v[68:71]
    ds_read_b128 v[48:51], v13 offset:28928
    v_mfma_f32_16x16x32_bf16 v[72:75], a[100:103], v[20:23], v[72:75]
    s_waitcnt lgkmcnt(6)
    v_mfma_f32_16x16x32_bf16 v[76:79], a[96:99], v[24:27], v[76:79]
    s_waitcnt vmcnt(10)
    s_barrier
    ds_read_b128 v[20:23], v12 offset:32768
    v_mfma_f32_16x16x32_bf16 v[80:83], a[100:103], v[24:27], v[80:83]
    s_waitcnt lgkmcnt(6)
    v_mfma_f32_16x16x32_bf16 v[68:71], a[104:107], v[28:31], v[68:71]
    ds_read_b128 v[24:27], v12 offset:33024
    s_add_u32 m0, s19, 32768
    v_mfma_f32_16x16x32_bf16 v[72:75], a[108:111], v[28:31], v[72:75]
    s_add_u32 s17, s20, 2113536
    buffer_load_dwordx4 v2, s[4:7], s17 offen lds
    s_waitcnt lgkmcnt(6)
    v_mfma_f32_16x16x32_bf16 v[76:79], a[104:107], v[32:35], v[76:79]
    ds_read_b128 v[28:31], v13 offset:32768
    v_mfma_f32_16x16x32_bf16 v[80:83], a[108:111], v[32:35], v[80:83]
    s_waitcnt lgkmcnt(6)
    v_mfma_f32_16x16x32_bf16 v[68:71], a[112:115], v[36:39], v[68:71]
    ds_read_b128 v[32:35], v13 offset:33024
    s_add_u32 m0, s19, 36864
    v_mfma_f32_16x16x32_bf16 v[72:75], a[116:119], v[36:39], v[72:75]
    s_add_u32 s17, s20, 2377728
    buffer_load_dwordx4 v2, s[4:7], s17 offen lds
    s_waitcnt lgkmcnt(6)
    v_mfma_f32_16x16x32_bf16 v[76:79], a[112:115], v[40:43], v[76:79]
    ds_read_b128 v[36:39], v12 offset:36864
    v_mfma_f32_16x16x32_bf16 v[80:83], a[116:119], v[40:43], v[80:83]
    s_waitcnt lgkmcnt(6)
    v_mfma_f32_16x16x32_bf16 v[68:71], a[120:123], v[44:47], v[68:71]
    ds_read_b128 v[40:43], v12 offset:37120
    s_add_u32 m0, s19, 40960
    v_mfma_f32_16x16x32_bf16 v[72:75], a[124:127], v[44:47], v[72:75]
    s_add_u32 s17, s20, 2641920
    buffer_load_dwordx4 v2, s[4:7], s17 offen lds
    s_waitcnt lgkmcnt(6)
    v_mfma_f32_16x16x32_bf16 v[76:79], a[120:123], v[48:51], v[76:79]
    ds_read_b128 v[44:47], v13 offset:36864
    v_mfma_f32_16x16x32_bf16 v[80:83], a[124:127], v[48:51], v[80:83]
    s_waitcnt lgkmcnt(6)
    v_mfma_f32_16x16x32_bf16 v[68:71], a[128:131], v[20:23], v[68:71]
    ds_read_b128 v[48:51], v13 offset:37120
    v_mfma_f32_16x16x32_bf16 v[72:75], a[132:135], v[20:23], v[72:75]
    s_waitcnt lgkmcnt(6)
    v_mfma_f32_16x16x32_bf16 v[76:79], a[128:131], v[24:27], v[76:79]
    ds_read_b128 v[20:23], v12 offset:40960
    s_add_u32 m0, s19, 45056
    v_mfma_f32_16x16x32_bf16 v[80:83], a[132:135], v[24:27], v[80:83]
    s_add_u32 s17, s20, 2906112
    buffer_load_dwordx4 v2, s[4:7], s17 offen lds
    s_waitcnt lgkmcnt(6)
    v_mfma_f32_16x16x32_bf16 v[68:71], a[136:139], v[28:31], v[68:71]
    ds_read_b128 v[24:27], v12 offset:41216
    v_mfma_f32_16x16x32_bf16 v[72:75], a[140:143], v[28:31], v[72:75]
    s_waitcnt lgkmcnt(6)
    v_mfma_f32_16x16x32_bf16 v[76:79], a[136:139], v[32:35], v[76:79]
    ds_read_b128 v[28:31], v13 offset:40960
    s_add_u32 m0, s19, 49152
    v_mfma_f32_16x16x32_bf16 v[80:83], a[140:143], v[32:35], v[80:83]
    s_add_u32 s17, s20, 3170304
    buffer_load_dwordx4 v2, s[4:7], s17 offen lds
    s_waitcnt lgkmcnt(6)
    v_mfma_f32_16x16x32_bf16 v[68:71], a[144:147], v[36:39], v[68:71]
    ds_read_b128 v[32:35], v13 offset:41216
    v_mfma_f32_16x16x32_bf16 v[72:75], a[148:151], v[36:39], v[72:75]
    s_waitcnt lgkmcnt(6)
    v_mfma_f32_16x16x32_bf16 v[76:79], a[144:147], v[40:43], v[76:79]
    ds_read_b128 v[36:39], v12 offset:45056
    s_add_u32 m0, s19, 53248
    v_mfma_f32_16x16x32_bf16 v[80:83], a[148:151], v[40:43], v[80:83]
    s_add_u32 s17, s20, 3434496
    buffer_load_dwordx4 v2, s[4:7], s17 offen lds
    s_waitcnt lgkmcnt(6)
    v_mfma_f32_16x16x32_bf16 v[68:71], a[152:155], v[44:47], v[68:71]
    ds_read_b128 v[40:43], v12 offset:45312
    v_mfma_f32_16x16x32_bf16 v[72:75], a[156:159], v[44:47], v[72:75]
    s_waitcnt lgkmcnt(6)
    v_mfma_f32_16x16x32_bf16 v[76:79], a[152:155], v[48:51], v[76:79]
    ds_read_b128 v[44:47], v13 offset:45056
    s_add_u32 m0, s19, 57344
    v_mfma_f32_16x16x32_bf16 v[80:83], a[156:159], v[48:51], v[80:83]
    s_add_u32 s17, s20, 3698688
    buffer_load_dwordx4 v2, s[4:7], s17 offen lds
    s_waitcnt lgkmcnt(6)
    v_mfma_f32_16x16x32_bf16 v[68:71], a[160:163], v[20:23], v[68:71]
    ds_read_b128 v[48:51], v13 offset:45312
    v_mfma_f32_16x16x32_bf16 v[72:75], a[164:167], v[20:23], v[72:75]
    s_waitcnt lgkmcnt(6)
    v_mfma_f32_16x16x32_bf16 v[76:79], a[160:163], v[24:27], v[76:79]
    ds_read_b128 v[20:23], v12 offset:49152
    s_add_u32 m0, s19, 61440
    v_mfma_f32_16x16x32_bf16 v[80:83], a[164:167], v[24:27], v[80:83]
    s_add_u32 s17, s20, 3962880
    buffer_load_dwordx4 v2, s[4:7], s17 offen lds
    s_waitcnt lgkmcnt(6)
    v_mfma_f32_16x16x32_bf16 v[68:71], a[168:171], v[28:31], v[68:71]
    ds_read_b128 v[24:27], v12 offset:49408
    v_mfma_f32_16x16x32_bf16 v[72:75], a[172:175], v[28:31], v[72:75]
    s_add_u32 s20, s20, s24
    s_waitcnt lgkmcnt(6)
    v_mfma_f32_16x16x32_bf16 v[76:79], a[168:171], v[32:35], v[76:79]
    ds_read_b128 v[28:31], v13 offset:49152
    v_mfma_f32_16x16x32_bf16 v[80:83], a[172:175], v[32:35], v[80:83]
    s_waitcnt lgkmcnt(6)
    v_mfma_f32_16x16x32_bf16 v[68:71], a[176:179], v[36:39], v[68:71]
    ds_read_b128 v[32:35], v13 offset:49408
    v_mfma_f32_16x16x32_bf16 v[72:75], a[180:183], v[36:39], v[72:75]
    s_waitcnt lgkmcnt(6)
    v_mfma_f32_16x16x32_bf16 v[76:79], a[176:179], v[40:43], v[76:79]
    ds_read_b128 v[36:39], v12 offset:53248
    v_mfma_f32_16x16x32_bf16 v[80:83], a[180:183], v[40:43], v[80:83]
    s_waitcnt lgkmcnt(6)
    v_mfma_f32_16x16x32_bf16 v[68:71], a[184:187], v[44:47], v[68:71]
    ds_read_b128 v[40:43], v12 offset:53504
    v_mfma_f32_16x16x32_bf16 v[72:75], a[188:191], v[44:47], v[72:75]
    s_waitcnt lgkmcnt(6)
    v_mfma_f32_16x16x32_bf16 v[76:79], a[184:187], v[48:51], v[76:79]
    ds_read_b128 v[44:47], v13 offset:53248
    v_mfma_f32_16x16x32_bf16 v[80:83], a[188:191], v[48:51], v[80:83]
    s_waitcnt lgkmcnt(6)
    v_mfma_f32_16x16x32_bf16 v[68:71], a[192:195], v[20:23], v[68:71]
    ds_read_b128 v[48:51], v13 offset:53504
    v_mfma_f32_16x16x32_bf16 v[72:75], a[196:199], v[20:23], v[72:75]
    s_waitcnt lgkmcnt(6)
    v_mfma_f32_16x16x32_bf16 v[76:79], a[192:195], v[24:27], v[76:79]
    ds_read_b128 v[20:23], v12 offset:57344
    v_mfma_f32_16x16x32_bf16 v[80:83], a[196:199], v[24:27], v[80:83]
    s_waitcnt lgkmcnt(6)
    v_mfma_f32_16x16x32_bf16 v[68:71], a[200:203], v[28:31], v[68:71]
    ds_read_b128 v[24:27], v12 offset:57600
    v_mfma_f32_16x16x32_bf16 v[72:75], a[204:207], v[28:31], v[72:75]
    s_waitcnt lgkmcnt(6)
    v_mfma_f32_16x16x32_bf16 v[76:79], a[200:203], v[32:35], v[76:79]
    ds_read_b128 v[28:31], v13 offset:57344
    v_mfma_f32_16x16x32_bf16 v[80:83], a[204:207], v[32:35], v[80:83]
    s_waitcnt lgkmcnt(6)
    v_mfma_f32_16x16x32_bf16 v[68:71], a[208:211], v[36:39], v[68:71]
    ds_read_b128 v[32:35], v13 offset:57600
    v_mfma_f32_16x16x32_bf16 v[72:75], a[212:215], v[36:39], v[72:75]
    s_waitcnt lgkmcnt(6)
    v_mfma_f32_16x16x32_bf16 v[76:79], a[208:211], v[40:43], v[76:79]
    ds_read_b128 v[36:39], v12 offset:61440
    v_mfma_f32_16x16x32_bf16 v[80:83], a[212:215], v[40:43], v[80:83]
    s_waitcnt lgkmcnt(6)
    v_mfma_f32_16x16x32_bf16 v[68:71], a[216:219], v[44:47], v[68:71]
    ds_read_b128 v[40:43], v12 offset:61696
    v_mfma_f32_16x16x32_bf16 v[72:75], a[220:223], v[44:47], v[72:75]
    s_waitcnt lgkmcnt(6)
    v_mfma_f32_16x16x32_bf16 v[76:79], a[216:219], v[48:51], v[76:79]
    ds_read_b128 v[44:47], v13 offset:61440
    v_mfma_f32_16x16x32_bf16 v[80:83], a[220:223], v[48:51], v[80:83]
    s_waitcnt lgkmcnt(6)
    v_mfma_f32_16x16x32_bf16 v[68:71], a[224:227], v[20:23], v[68:71]
    ds_read_b128 v[48:51], v13 offset:61696
    v_mfma_f32_16x16x32_bf16 v[72:75], a[228:231], v[20:23], v[72:75]
    s_waitcnt lgkmcnt(6)
    v_mfma_f32_16x16x32_bf16 v[76:79], a[224:227], v[24:27], v[76:79]
    s_waitcnt vmcnt(8)
    s_barrier
    ds_read_b128 v[20:23], v10 offset:0
    v_mfma_f32_16x16x32_bf16 v[80:83], a[228:231], v[24:27], v[80:83]
    s_waitcnt lgkmcnt(6)
    v_mfma_f32_16x16x32_bf16 v[68:71], a[232:235], v[28:31], v[68:71]
    ds_read_b128 v[24:27], v10 offset:256
    s_add_u32 m0, s19, 65536
    v_mfma_f32_16x16x32_bf16 v[72:75], a[236:239], v[28:31], v[72:75]
    s_add_u32 s17, s20, 0
    buffer_load_dwordx4 v2, s[4:7], s17 offen lds
    s_waitcnt lgkmcnt(6)
    v_mfma_f32_16x16x32_bf16 v[76:79], a[232:235], v[32:35], v[76:79]
    ds_read_b128 v[28:31], v11 offset:0
    v_mfma_f32_16x16x32_bf16 v[80:83], a[236:239], v[32:35], v[80:83]
    s_waitcnt lgkmcnt(6)
    v_mfma_f32_16x16x32_bf16 v[68:71], a[240:243], v[36:39], v[68:71]
    ds_read_b128 v[32:35], v11 offset:256
    s_add_u32 m0, s19, 69632
    v_mfma_f32_16x16x32_bf16 v[72:75], a[244:247], v[36:39], v[72:75]
    s_add_u32 s17, s20, 264192
    buffer_load_dwordx4 v2, s[4:7], s17 offen lds
    s_waitcnt lgkmcnt(6)
    v_mfma_f32_16x16x32_bf16 v[76:79], a[240:243], v[40:43], v[76:79]
    ds_read_b128 v[36:39], v10 offset:4096
    v_mfma_f32_16x16x32_bf16 v[80:83], a[244:247], v[40:43], v[80:83]
    s_waitcnt lgkmcnt(6)
    v_mfma_f32_16x16x32_bf16 v[68:71], a[248:251], v[44:47], v[68:71]
    ds_read_b128 v[40:43], v10 offset:4352
    s_add_u32 m0, s19, 73728
    v_mfma_f32_16x16x32_bf16 v[72:75], a[252:255], v[44:47], v[72:75]
    s_add_u32 s17, s20, 528384
    buffer_load_dwordx4 v2, s[4:7], s17 offen lds
    s_waitcnt lgkmcnt(6)
    v_mfma_f32_16x16x32_bf16 v[76:79], a[248:251], v[48:51], v[76:79]
    ds_read_b128 v[44:47], v11 offset:4096
    v_mfma_f32_16x16x32_bf16 v[80:83], a[252:255], v[48:51], v[80:83]
    s_add_u32 s22, s22, 2
    s_cmp_lt_u32 s22, 16
    s_cbranch_scc1 F3_top
    v_cvt_pk_bf16_f32 v84, v68, v69
    v_cvt_pk_bf16_f32 v85, v70, v71
    v_cvt_pk_bf16_f32 v86, v72, v73
    v_cvt_pk_bf16_f32 v87, v74, v75
    v_cvt_pk_bf16_f32 v88, v76, v77
    v_cvt_pk_bf16_f32 v89, v78, v79
    v_cvt_pk_bf16_f32 v90, v80, v81
    v_cvt_pk_bf16_f32 v91, v82, v83
    buffer_store_dwordx4 v[84:87], v3, s[12:15], s21 offen
    buffer_store_dwordx4 v[88:91], v4, s[12:15], s21 offen
    s_waitcnt vmcnt(0) lgkmcnt(0)
    s_branch W_T
W_T:
    v_and_b32 v7, 19, v1
    v_bfe_u32 v5, v1, 2, 1
    v_bfe_u32 v6, v1, 3, 1
    v_lshl_add_u32 v7, v5, 3, v7
    v_lshl_add_u32 v7, v6, 2, v7
    v_lshrrev_b32 v5, 5, v1
    v_and_b32 v6, 31, v1
    v_lshlrev_b32 v8, 4, v5
    v_lshl_add_u32 v10, v6, 6, v8
    v_lshl_add_u32 v11, v7, 6, v8
    v_mov_b32 v17, 1073741824
    v_cmp_gt_u32 vcc, 8, v6
    s_nop 1
    v_cndmask_b32 v12, v17, v10, vcc
    v_lshlrev_b32 v13, 3, v5
    v_lshl_add_u32 v13, v7, 4, v13
    v_and_b32 v14, 15, v1
    v_lshlrev_b32 v14, 4, v14
    v_lshl_add_u32 v14, v5, 8, v14
    v_bfe_u32 v8, v1, 4, 1
    v_lshl_add_u32 v14, v8, 18, v14
    v_lshrrev_b32 v15, 2, v1
    v_and_b32 v8, 3, v1
    v_lshl_add_u32 v15, v15, 7, v8
    s_lshl_b32 s17, s93, 2
    v_add_u32 v15, s17, v15
    v_lshlrev_b32 v15, 7, v15
    v_add_u32 v15, 100663296, v15
    v_cmp_gt_u32 vcc, 16, v1
    s_nop 1
    v_cndmask_b32 v15, v17, v15, vcc
    v_mov_b32 v16, 0
    s_add_u32 s18, s16, s17
    s_lshl_b32 s18, s18, 7
    s_add_u32 s18, s18, 100728832
    v_lshl_add_u32 v4, v1, 2, s18
    v_cmp_gt_u32 vcc, 32, v1
    s_nop 1
    v_cndmask_b32 v4, v17, v4, vcc
    v_lshlrev_b32 v5, 3, v5
    v_sub_u32 v6, v6, v5
    s_mov_b32 s29, 1040356334
    s_mov_b32 s28, s16
    s_mul_i32 s31, s17, 133120
    s_lshl_b32 s18, s28, 11
    s_add_u32 s31, s31, s18
    s_mul_i32 s32, s17, 33280
    s_lshl_b32 s18, s28, 9
    s_add_u32 s32, s32, s18
    s_add_u32 s32, s32, 71303168
    s_lshl_b32 s33, s28, 18
    s_lshl_b32 s18, s93, 12
    s_add_u32 s33, s33, s18
    s_add_u32 s33, s33, 54525952
    v_mov_b32 v17, 0xff800000
    s_mov_b32 s35, 0
    v_mov_b32 v9, 0
    s_lshl_b32 s33, s28, 19
    s_lshr_b32 s18, s93, 1
    s_lshl_b32 s18, s18, 14
    s_add_u32 s33, s33, s18
    s_and_b32 s18, s93, 1
    s_lshl_b32 s18, s18, 12
    s_add_u32 s33, s33, s18
    s_add_u32 s33, s33, 201334784
    s_xor_b32 s33, s33, s89
    v_and_b32 v10, 31, v1
    v_lshlrev_b32 v10, 5, v10
    v_lshl_add_u32 v10, v5, 1, v10
    v_lshlrev_b32 v11, 5, v7
    v_lshl_add_u32 v11, v5, 1, v11
    v_cmp_le_i32 s[36:37], 0, v6
    v_cmp_le_i32 s[38:39], 1, v6
    v_cmp_le_i32 s[40:41], 2, v6
    v_cmp_le_i32 s[42:43], 3, v6
    v_cmp_le_i32 s[44:45], 4, v6
    v_cmp_le_i32 s[46:47], 5, v6
    v_cmp_le_i32 s[48:49], 6, v6
    v_cmp_le_i32 s[50:51], 7, v6
    v_cmp_le_i32 s[52:53], 16, v6
    v_cmp_le_i32 s[54:55], 17, v6
    v_cmp_le_i32 s[56:57], 18, v6
    v_cmp_le_i32 s[58:59], 19, v6
    v_cmp_le_i32 s[60:61], 20, v6
    v_cmp_le_i32 s[62:63], 21, v6
    v_cmp_le_i32 s[64:65], 22, v6
    v_cmp_le_i32 s[66:67], 23, v6
    v_mov_b32 v54, 0
    v_mov_b32 v55, 0
    v_mov_b32 v58, 0
    v_mov_b32 v59, 0
    v_mov_b32 v62, 0
    v_mov_b32 v63, 0
    v_mov_b32 v66, 0
    v_mov_b32 v67, 0
    v_mov_b32 v102, 0
    v_mov_b32 v103, 0
    v_mov_b32 v106, 0
    v_mov_b32 v107, 0
    v_mov_b32 v110, 0
    v_mov_b32 v111, 0
    v_mov_b32 v114, 0
    v_mov_b32 v115, 0
    v_mov_b32 v158, 0
    v_mov_b32 v159, 0
    s_mov_b32 s30, s92
T_p:
    v_cmp_ge_u32 vcc, s28, v16
    s_nop 0
    s_and_b32 s17, vcc_lo, 4095
    s_cbranch_scc0 T_pk
    s_cmp_ge_u32 s30, 1048576
    s_cselect_b32 s92, 1048576, s92
    s_cbranch_scc1 T_pk
    s_add_u32 s30, s30, 1
    buffer_load_dword v16, v15, s[4:7], 0 offen sc1
    s_sleep 8
    s_waitcnt vmcnt(0)
    s_branch T_p
T_pk:
    s_add_u32 s17, s31, 0
    buffer_load_dwordx4 a[0:3], v10, s[4:7], s17 offen offset:0
    buffer_load_dwordx4 a[4:7], v10, s[4:7], s17 offen offset:1024
    s_add_u32 s17, s31, 133120
    buffer_load_dwordx4 a[8:11], v10, s[4:7], s17 offen offset:0
    buffer_load_dwordx4 a[12:15], v10, s[4:7], s17 offen offset:1024
    s_add_u32 s17, s31, 266240
    buffer_load_dwordx4 a[16:19], v10, s[4:7], s17 offen offset:0
    buffer_load_dwordx4 a[20:23], v10, s[4:7], s17 offen offset:1024
    s_add_u32 s17, s31, 399360
    buffer_load_dwordx4 a[24:27], v10, s[4:7], s17 offen offset:0
    buffer_load_dwordx4 a[28:31], v10, s[4:7], s17 offen offset:1024
    s_add_u32 s17, s31, 17825792
    buffer_load_dwordx4 a[32:35], v11, s[4:7], s17 offen offset:0
    buffer_load_dwordx4 a[36:39], v11, s[4:7], s17 offen offset:1024
    s_add_u32 s17, s31, 17958912
    buffer_load_dwordx4 a[40:43], v11, s[4:7], s17 offen offset:0
    buffer_load_dwordx4 a[44:47], v11, s[4:7], s17 offen offset:1024
    s_add_u32 s17, s31, 18092032
    buffer_load_dwordx4 a[48:51], v11, s[4:7], s17 offen offset:0
    buffer_load_dwordx4 a[52:55], v11, s[4:7], s17 offen offset:1024
    s_add_u32 s17, s31, 18225152
    buffer_load_dwordx4 a[56:59], v11, s[4:7], s17 offen offset:0
    buffer_load_dwordx4 a[60:63], v11, s[4:7], s17 offen offset:1024
    s_add_u32 s17, s31, 35651584
    buffer_load_dwordx4 a[64:67], v11, s[4:7], s17 offen offset:0
    buffer_load_dwordx4 a[68:71], v11, s[4:7], s17 offen offset:1024
    s_add_u32 s17, s31, 35784704
    buffer_load_dwordx4 a[72:75], v11, s[4:7], s17 offen offset:0
    buffer_load_dwordx4 a[76:79], v11, s[4:7], s17 offen offset:1024
    s_add_u32 s17, s31, 35917824
    buffer_load_dwordx4 a[80:83], v11, s[4:7], s17 offen offset:0
    buffer_load_dwordx4 a[84:87], v11, s[4:7], s17 offen offset:1024
    s_add_u32 s17, s31, 36050944
    buffer_load_dwordx4 a[88:91], v11, s[4:7], s17 offen offset:0
    buffer_load_dwordx4 a[92:95], v11, s[4:7], s17 offen offset:1024
T_top0:
    s_cmp_eq_u32 s35, 0
    s_cbranch_scc1 T_slow0
T_go0:
    s_add_u32 s34, s28, 4
    s_min_u32 s68, s34, 63
    s_waitcnt vmcnt(8)
    v_cmp_ge_u32 vcc, s68, v16
    s_nop 0
    s_and_b32 s17, vcc_lo, 0xfff
    s_cbranch_scc1 T_pw0
T_pok0:
    s_add_u32 s31, s31, 8192
    s_add_u32 s32, s32, 2048
    s_and_b32 s17, vcc_lo, 61440
    s_cselect_b32 s35, 0, 1
    s_cselect_b32 s69, 1073741824, s32
    s_cmp_lt_u32 s34, 64
    s_cselect_b32 s68, s31, 1073741824
    s_cselect_b32 s69, s69, 1073741824
    buffer_load_dword v16, v15, s[4:7], 0 offen sc1
    v_mfma_f32_32x32x16_bf16 v[116:131], a[32:35], a[0:3], 0
    s_add_u32 s17, s68, 0
    buffer_load_dwordx4 a[96:99], v10, s[4:7], s17 offen offset:0
    buffer_load_dwordx4 a[100:103], v10, s[4:7], s17 offen offset:1024
    v_mfma_f32_32x32x16_bf16 v[116:131], a[36:39], a[4:7], v[116:131]
    s_add_u32 s17, s68, 133120
    buffer_load_dwordx4 a[104:107], v10, s[4:7], s17 offen offset:0
    buffer_load_dwordx4 a[108:111], v10, s[4:7], s17 offen offset:1024
    v_mfma_f32_32x32x16_bf16 v[116:131], a[40:43], a[8:11], v[116:131]
    s_add_u32 s17, s68, 266240
    buffer_load_dwordx4 a[112:115], v10, s[4:7], s17 offen offset:0
    buffer_load_dwordx4 a[116:119], v10, s[4:7], s17 offen offset:1024
    v_mfma_f32_32x32x16_bf16 v[116:131], a[44:47], a[12:15], v[116:131]
    s_add_u32 s17, s68, 399360
    buffer_load_dwordx4 a[120:123], v10, s[4:7], s17 offen offset:0
    buffer_load_dwordx4 a[124:127], v10, s[4:7], s17 offen offset:1024
    v_mfma_f32_32x32x16_bf16 v[116:131], a[48:51], a[16:19], v[116:131]
    s_add_u32 s17, s68, 17825792
    buffer_load_dwordx4 a[128:131], v11, s[4:7], s17 offen offset:0
    buffer_load_dwordx4 a[132:135], v11, s[4:7], s17 offen offset:1024
    v_mfma_f32_32x32x16_bf16 v[116:131], a[52:55], a[20:23], v[116:131]
    s_add_u32 s17, s68, 17958912
    buffer_load_dwordx4 a[136:139], v11, s[4:7], s17 offen offset:0
    buffer_load_dwordx4 a[140:143], v11, s[4:7], s17 offen offset:1024
    v_mfma_f32_32x32x16_bf16 v[116:131], a[56:59], a[24:27], v[116:131]
    s_add_u32 s17, s68, 18092032
    buffer_load_dwordx4 a[144:147], v11, s[4:7], s17 offen offset:0
    buffer_load_dwordx4 a[148:151], v11, s[4:7], s17 offen offset:1024
    v_mfma_f32_32x32x16_bf16 v[116:131], a[60:63], a[28:31], v[116:131]
    s_add_u32 s17, s68, 18225152
    buffer_load_dwordx4 a[152:155], v11, s[4:7], s17 offen offset:0
    buffer_load_dwordx4 a[156:159], v11, s[4:7], s17 offen offset:1024
    v_mfma_f32_32x32x16_bf16 v[132:147], v[20:23], a[0:3], 0
    s_add_u32 s17, s68, 35651584
    buffer_load_dwordx4 a[160:163], v11, s[4:7], s17 offen offset:0
    buffer_load_dwordx4 a[164:167], v11, s[4:7], s17 offen offset:1024
    v_mfma_f32_32x32x16_bf16 v[132:147], v[24:27], a[4:7], v[132:147]
    s_add_u32 s17, s68, 35784704
    buffer_load_dwordx4 a[168:171], v11, s[4:7], s17 offen offset:0
    buffer_load_dwordx4 a[172:175], v11, s[4:7], s17 offen offset:1024
    v_mfma_f32_32x32x16_bf16 v[132:147], v[28:31], a[8:11], v[132:147]
    s_add_u32 s17, s68, 35917824
    buffer_load_dwordx4 a[176:179], v11, s[4:7], s17 offen offset:0
    buffer_load_dwordx4 a[180:183], v11, s[4:7], s17 offen offset:1024
    v_mfma_f32_32x32x16_bf16 v[132:147], v[32:35], a[12:15], v[132:147]
    s_add_u32 s17, s68, 36050944
    buffer_load_dwordx4 a[184:187], v11, s[4:7], s17 offen offset:0
    buffer_load_dwordx4 a[188:191], v11, s[4:7], s17 offen offset:1024
    v_mfma_f32_32x32x16_bf16 v[132:147], v[36:39], a[16:19], v[132:147]
    s_add_u32 s17, s69, 0
    s_add_u32 s18, s69, 5242880
    buffer_load_dwordx4 v[68:71], v12, s[4:7], s17 offen offset:0
    buffer_load_dwordx4 v[72:75], v12, s[4:7], s17 offen offset:32
    buffer_load_dwordx2 v[100:101], v13, s[4:7], s18 offen
    v_mfma_f32_32x32x16_bf16 v[132:147], v[40:43], a[20:23], v[132:147]
    s_add_u32 s17, s69, 33280
    s_add_u32 s18, s69, 5276160
    buffer_load_dwordx4 v[76:79], v12, s[4:7], s17 offen offset:0
    buffer_load_dwordx4 v[80:83], v12, s[4:7], s17 offen offset:32
    buffer_load_dwordx2 v[104:105], v13, s[4:7], s18 offen
    v_mfma_f32_32x32x16_bf16 v[132:147], v[44:47], a[24:27], v[132:147]
    s_add_u32 s17, s69, 66560
    s_add_u32 s18, s69, 5309440
    buffer_load_dwordx4 v[84:87], v12, s[4:7], s17 offen offset:0
    buffer_load_dwordx4 v[88:91], v12, s[4:7], s17 offen offset:32
    buffer_load_dwordx2 v[108:109], v13, s[4:7], s18 offen
    v_mfma_f32_32x32x16_bf16 v[132:147], v[48:51], a[28:31], v[132:147]
    s_add_u32 s17, s69, 99840
    s_add_u32 s18, s69, 5342720
    buffer_load_dwordx4 v[92:95], v12, s[4:7], s17 offen offset:0
    buffer_load_dwordx4 v[96:99], v12, s[4:7], s17 offen offset:32
    buffer_load_dwordx2 v[112:113], v13, s[4:7], s18 offen
    v_cndmask_b32 v116, v17, v116, s[36:37]
    v_cndmask_b32 v117, v17, v117, s[38:39]
    v_cndmask_b32 v118, v17, v118, s[40:41]
    v_cndmask_b32 v119, v17, v119, s[42:43]
    v_cndmask_b32 v120, v17, v120, s[44:45]
    v_cndmask_b32 v121, v17, v121, s[46:47]
    v_cndmask_b32 v122, v17, v122, s[48:49]
    v_cndmask_b32 v123, v17, v123, s[50:51]
    v_cndmask_b32 v124, v17, v124, s[52:53]
    v_cndmask_b32 v125, v17, v125, s[54:55]
    v_cndmask_b32 v126, v17, v126, s[56:57]
    v_cndmask_b32 v127, v17, v127, s[58:59]
    v_cndmask_b32 v128, v17, v128, s[60:61]
    v_cndmask_b32 v129, v17, v129, s[62:63]
    v_cndmask_b32 v130, v17, v130, s[64:65]
    v_cndmask_b32 v131, v17, v131, s[66:67]
    v_max3_f32 v18, v116, v117, v118
    v_max3_f32 v18, v18, v119, v120
    v_max3_f32 v18, v18, v121, v122
    v_max3_f32 v18, v18, v123, v124
    v_max3_f32 v18, v18, v125, v126
    v_max3_f32 v18, v18, v127, v128
    v_max3_f32 v18, v18, v129, v130
    v_max3_f32 v18, v18, v131, v132
    v_max3_f32 v18, v18, v133, v134
    v_max_f32 v18, v18, v135
    v_mov_b32 v5, v18
    s_nop 1
    v_permlane32_swap_b32 v18, v5
    v_max_f32 v18, v18, v5
    v_mul_f32 v18, s29, v18
    v_fma_f32 v116, v116, s29, -v18
    v_fma_f32 v117, v117, s29, -v18
    v_fma_f32 v118, v118, s29, -v18
    v_fma_f32 v119, v119, s29, -v18
    v_fma_f32 v120, v120, s29, -v18
    v_fma_f32 v121, v121, s29, -v18
    v_fma_f32 v122, v122, s29, -v18
    v_fma_f32 v123, v123, s29, -v18
    v_fma_f32 v124, v124, s29, -v18
    v_fma_f32 v125, v125, s29, -v18
    v_fma_f32 v126, v126, s29, -v18
    v_fma_f32 v127, v127, s29, -v18
    v_fma_f32 v128, v128, s29, -v18
    v_fma_f32 v129, v129, s29, -v18
    v_fma_f32 v130, v130, s29, -v18
    v_fma_f32 v131, v131, s29, -v18
    v_fma_f32 v132, v132, s29, -v18
    v_fma_f32 v133, v133, s29, -v18
    v_fma_f32 v134, v134, s29, -v18
    v_fma_f32 v135, v135, s29, -v18
    v_exp_f32 v116, v116
    v_exp_f32 v117, v117
    v_exp_f32 v118, v118
    v_exp_f32 v119, v119
    v_exp_f32 v120, v120
    v_exp_f32 v121, v121
    v_exp_f32 v122, v122
    v_exp_f32 v123, v123
    v_exp_f32 v124, v124
    v_exp_f32 v125, v125
    v_exp_f32 v126, v126
    v_exp_f32 v127, v127
    v_exp_f32 v128, v128
    v_exp_f32 v129, v129
    v_exp_f32 v130, v130
    v_exp_f32 v131, v131
    v_exp_f32 v132, v132
    v_exp_f32 v133, v133
    v_exp_f32 v134, v134
    v_exp_f32 v135, v135
    s_waitcnt vmcnt(37)
    buffer_store_dword v9, v4, s[4:7], 0 offen sc1
    v_add_f32 v19, v116, v117
    v_add_f32 v6, v118, v119
    v_add_f32 v19, v19, v120
    v_add_f32 v6, v6, v121
    v_add_f32 v19, v19, v122
    v_add_f32 v6, v6, v123
    v_add_f32 v19, v19, v124
    v_add_f32 v6, v6, v125
    v_add_f32 v19, v19, v126
    v_add_f32 v6, v6, v127
    v_add_f32 v19, v19, v128
    v_add_f32 v6, v6, v129
    v_add_f32 v19, v19, v130
    v_add_f32 v6, v6, v131
    v_add_f32 v19, v19, v132
    v_add_f32 v6, v6, v133
    v_add_f32 v19, v19, v134
    v_add_f32 v6, v6, v135
    v_add_f32 v19, v19, v6
    v_mov_b32 v5, v19
    s_nop 1
    v_permlane32_swap_b32 v19, v5
    v_add_f32 v19, v19, v5
    v_rcp_f32 v19, v19
    s_nop 0
    v_mul_f32 v116, v116, v19
    v_mul_f32 v117, v117, v19
    v_mul_f32 v118, v118, v19
    v_mul_f32 v119, v119, v19
    v_mul_f32 v120, v120, v19
    v_mul_f32 v121, v121, v19
    v_mul_f32 v122, v122, v19
    v_mul_f32 v123, v123, v19
    v_mul_f32 v124, v124, v19
    v_mul_f32 v125, v125, v19
    v_mul_f32 v126, v126, v19
    v_mul_f32 v127, v127, v19
    v_mul_f32 v128, v128, v19
    v_mul_f32 v129, v129, v19
    v_mul_f32 v130, v130, v19
    v_mul_f32 v131, v131, v19
    v_mul_f32 v132, v132, v19
    v_mul_f32 v133, v133, v19
    v_mul_f32 v134, v134, v19
    v_mul_f32 v135, v135, v19
    v_cvt_pk_bf16_f32 v148, v116, v117
    v_cvt_pk_bf16_f32 v149, v118, v119
    v_cvt_pk_bf16_f32 v150, v120, v121
    v_cvt_pk_bf16_f32 v151, v122, v123
    v_cvt_pk_bf16_f32 v152, v124, v125
    v_cvt_pk_bf16_f32 v153, v126, v127
    v_cvt_pk_bf16_f32 v154, v128, v129
    v_cvt_pk_bf16_f32 v155, v130, v131
    v_cvt_pk_bf16_f32 v156, v132, v133
    v_cvt_pk_bf16_f32 v157, v134, v135
    v_mfma_f32_32x32x16_bf16 v[160:175], a[64:67], v[148:151], 0
    v_mfma_f32_32x32x16_bf16 v[160:175], a[68:71], v[152:155], v[160:175]
    v_mfma_f32_32x32x16_bf16 v[160:175], v[52:55], v[156:159], v[160:175]
    v_mfma_f32_32x32x16_bf16 v[176:191], a[72:75], v[148:151], 0
    v_mfma_f32_32x32x16_bf16 v[176:191], a[76:79], v[152:155], v[176:191]
    v_mfma_f32_32x32x16_bf16 v[176:191], v[56:59], v[156:159], v[176:191]
    s_nop 2
    v_cvt_pk_bf16_f32 v224, v160, v161
    v_cvt_pk_bf16_f32 v225, v162, v163
    v_cvt_pk_bf16_f32 v226, v164, v165
    v_cvt_pk_bf16_f32 v227, v166, v167
    v_cvt_pk_bf16_f32 v228, v168, v169
    v_cvt_pk_bf16_f32 v229, v170, v171
    v_cvt_pk_bf16_f32 v230, v172, v173
    v_cvt_pk_bf16_f32 v231, v174, v175
    buffer_store_dwordx4 v[224:227], v14, s[4:7], s33 offen offset:0 sc1
    buffer_store_dwordx4 v[228:231], v14, s[4:7], s33 offen offset:512 sc1
    v_mfma_f32_32x32x16_bf16 v[192:207], a[80:83], v[148:151], 0
    v_mfma_f32_32x32x16_bf16 v[192:207], a[84:87], v[152:155], v[192:207]
    v_mfma_f32_32x32x16_bf16 v[192:207], v[60:63], v[156:159], v[192:207]
    v_cvt_pk_bf16_f32 v232, v176, v177
    v_cvt_pk_bf16_f32 v233, v178, v179
    v_cvt_pk_bf16_f32 v234, v180, v181
    v_cvt_pk_bf16_f32 v235, v182, v183
    v_cvt_pk_bf16_f32 v236, v184, v185
    v_cvt_pk_bf16_f32 v237, v186, v187
    v_cvt_pk_bf16_f32 v238, v188, v189
    v_cvt_pk_bf16_f32 v239, v190, v191
    buffer_store_dwordx4 v[232:235], v14, s[4:7], s33 offen offset:1024 sc1
    buffer_store_dwordx4 v[236:239], v14, s[4:7], s33 offen offset:1536 sc1
    v_mfma_f32_32x32x16_bf16 v[208:223], a[88:91], v[148:151], 0
    v_mfma_f32_32x32x16_bf16 v[208:223], a[92:95], v[152:155], v[208:223]
    v_mfma_f32_32x32x16_bf16 v[208:223], v[64:67], v[156:159], v[208:223]
    v_cvt_pk_bf16_f32 v240, v192, v193
    v_cvt_pk_bf16_f32 v241, v194, v195
    v_cvt_pk_bf16_f32 v242, v196, v197
    v_cvt_pk_bf16_f32 v243, v198, v199
    v_cvt_pk_bf16_f32 v244, v200, v201
    v_cvt_pk_bf16_f32 v245, v202, v203
    v_cvt_pk_bf16_f32 v246, v204, v205
    v_cvt_pk_bf16_f32 v247, v206, v207
    buffer_store_dwordx4 v[240:243], v14, s[4:7], s33 offen offset:2048 sc1
    buffer_store_dwordx4 v[244:247], v14, s[4:7], s33 offen offset:2560 sc1
    v_add_u32 v9, 1, v9
    s_nop 0
    v_cvt_pk_bf16_f32 v248, v208, v209
    v_cvt_pk_bf16_f32 v249, v210, v211
    v_cvt_pk_bf16_f32 v250, v212, v213
    v_cvt_pk_bf16_f32 v251, v214, v215
    v_cvt_pk_bf16_f32 v252, v216, v217
    v_cvt_pk_bf16_f32 v253, v218, v219
    v_cvt_pk_bf16_f32 v254, v220, v221
    v_cvt_pk_bf16_f32 v255, v222, v223
    buffer_store_dwordx4 v[248:251], v14, s[4:7], s33 offen offset:3072 sc1
    buffer_store_dwordx4 v[252:255], v14, s[4:7], s33 offen offset:3584 sc1
    s_mov_b32 s28, s34
    s_add_u32 s33, s33, 2097152
    s_xor_b32 s33, s33, 8192
T_top1:
    s_cmp_eq_u32 s35, 0
    s_cbranch_scc1 T_slow1
T_go1:
    s_add_u32 s34, s28, 4
    s_min_u32 s68, s34, 63
    s_waitcnt vmcnt(8)
    v_cmp_ge_u32 vcc, s68, v16
    s_nop 0
    s_and_b32 s17, vcc_lo, 0xfff
    s_cbranch_scc1 T_pw1
T_pok1:
    s_add_u32 s31, s31, 8192
    s_add_u32 s32, s32, 2048
    s_and_b32 s17, vcc_lo, 61440
    s_cselect_b32 s35, 0, 1
    s_cselect_b32 s69, 1073741824, s32
    s_cmp_lt_u32 s34, 64
    s_cselect_b32 s68, s31, 1073741824
    s_cselect_b32 s69, s69, 1073741824
    buffer_load_dword v16, v15, s[4:7], 0 offen sc1
    v_mfma_f32_32x32x16_bf16 v[116:131], a[128:131], a[96:99], 0
    s_add_u32 s17, s68, 0
    buffer_load_dwordx4 a[0:3], v10, s[4:7], s17 offen offset:0
    buffer_load_dwordx4 a[4:7], v10, s[4:7], s17 offen offset:1024
    v_mfma_f32_32x32x16_bf16 v[116:131], a[132:135], a[100:103], v[116:131]
    s_add_u32 s17, s68, 133120
    buffer_load_dwordx4 a[8:11], v10, s[4:7], s17 offen offset:0
    buffer_load_dwordx4 a[12:15], v10, s[4:7], s17 offen offset:1024
    v_mfma_f32_32x32x16_bf16 v[116:131], a[136:139], a[104:107], v[116:131]
    s_add_u32 s17, s68, 266240
    buffer_load_dwordx4 a[16:19], v10, s[4:7], s17 offen offset:0
    buffer_load_dwordx4 a[20:23], v10, s[4:7], s17 offen offset:1024
    v_mfma_f32_32x32x16_bf16 v[116:131], a[140:143], a[108:111], v[116:131]
    s_add_u32 s17, s68, 399360
    buffer_load_dwordx4 a[24:27], v10, s[4:7], s17 offen offset:0
    buffer_load_dwordx4 a[28:31], v10, s[4:7], s17 offen offset:1024
    v_mfma_f32_32x32x16_bf16 v[116:131], a[144:147], a[112:115], v[116:131]
    s_add_u32 s17, s68, 17825792
    buffer_load_dwordx4 a[32:35], v11, s[4:7], s17 offen offset:0
    buffer_load_dwordx4 a[36:39], v11, s[4:7], s17 offen offset:1024
    v_mfma_f32_32x32x16_bf16 v[116:131], a[148:151], a[116:119], v[116:131]
    s_add_u32 s17, s68, 17958912
    buffer_load_dwordx4 a[40:43], v11, s[4:7], s17 offen offset:0
    buffer_load_dwordx4 a[44:47], v11, s[4:7], s17 offen offset:1024
    v_mfma_f32_32x32x16_bf16 v[116:131], a[152:155], a[120:123], v[116:131]
    s_add_u32 s17, s68, 18092032
    buffer_load_dwordx4 a[48:51], v11, s[4:7], s17 offen offset:0
    buffer_load_dwordx4 a[52:55], v11, s[4:7], s17 offen offset:1024
    v_mfma_f32_32x32x16_bf16 v[116:131], a[156:159], a[124:127], v[116:131]
    s_add_u32 s17, s68, 18225152
    buffer_load_dwordx4 a[56:59], v11, s[4:7], s17 offen offset:0
    buffer_load_dwordx4 a[60:63], v11, s[4:7], s17 offen offset:1024
    v_mfma_f32_32x32x16_bf16 v[132:147], v[68:71], a[96:99], 0
    s_add_u32 s17, s68, 35651584
    buffer_load_dwordx4 a[64:67], v11, s[4:7], s17 offen offset:0
    buffer_load_dwordx4 a[68:71], v11, s[4:7], s17 offen offset:1024
    v_mfma_f32_32x32x16_bf16 v[132:147], v[72:75], a[100:103], v[132:147]
    s_add_u32 s17, s68, 35784704
    buffer_load_dwordx4 a[72:75], v11, s[4:7], s17 offen offset:0
    buffer_load_dwordx4 a[76:79], v11, s[4:7], s17 offen offset:1024
    v_mfma_f32_32x32x16_bf16 v[132:147], v[76:79], a[104:107], v[132:147]
    s_add_u32 s17, s68, 35917824
    buffer_load_dwordx4 a[80:83], v11, s[4:7], s17 offen offset:0
    buffer_load_dwordx4 a[84:87], v11, s[4:7], s17 offen offset:1024
    v_mfma_f32_32x32x16_bf16 v[132:147], v[80:83], a[108:111], v[132:147]
    s_add_u32 s17, s68, 36050944
    buffer_load_dwordx4 a[88:91], v11, s[4:7], s17 offen offset:0
    buffer_load_dwordx4 a[92:95], v11, s[4:7], s17 offen offset:1024
    v_mfma_f32_32x32x16_bf16 v[132:147], v[84:87], a[112:115], v[132:147]
    s_add_u32 s17, s69, 0
    s_add_u32 s18, s69, 5242880
    buffer_load_dwordx4 v[20:23], v12, s[4:7], s17 offen offset:0
    buffer_load_dwordx4 v[24:27], v12, s[4:7], s17 offen offset:32
    buffer_load_dwordx2 v[52:53], v13, s[4:7], s18 offen
    v_mfma_f32_32x32x16_bf16 v[132:147], v[88:91], a[116:119], v[132:147]
    s_add_u32 s17, s69, 33280
    s_add_u32 s18, s69, 5276160
    buffer_load_dwordx4 v[28:31], v12, s[4:7], s17 offen offset:0
    buffer_load_dwordx4 v[32:35], v12, s[4:7], s17 offen offset:32
    buffer_load_dwordx2 v[56:57], v13, s[4:7], s18 offen
    v_mfma_f32_32x32x16_bf16 v[132:147], v[92:95], a[120:123], v[132:147]
    s_add_u32 s17, s69, 66560
    s_add_u32 s18, s69, 5309440
    buffer_load_dwordx4 v[36:39], v12, s[4:7], s17 offen offset:0
    buffer_load_dwordx4 v[40:43], v12, s[4:7], s17 offen offset:32
    buffer_load_dwordx2 v[60:61], v13, s[4:7], s18 offen
    v_mfma_f32_32x32x16_bf16 v[132:147], v[96:99], a[124:127], v[132:147]
    s_add_u32 s17, s69, 99840
    s_add_u32 s18, s69, 5342720
    buffer_load_dwordx4 v[44:47], v12, s[4:7], s17 offen offset:0
    buffer_load_dwordx4 v[48:51], v12, s[4:7], s17 offen offset:32
    buffer_load_dwordx2 v[64:65], v13, s[4:7], s18 offen
    v_cndmask_b32 v116, v17, v116, s[36:37]
    v_cndmask_b32 v117, v17, v117, s[38:39]
    v_cndmask_b32 v118, v17, v118, s[40:41]
    v_cndmask_b32 v119, v17, v119, s[42:43]
    v_cndmask_b32 v120, v17, v120, s[44:45]
    v_cndmask_b32 v121, v17, v121, s[46:47]
    v_cndmask_b32 v122, v17, v122, s[48:49]
    v_cndmask_b32 v123, v17, v123, s[50:51]
    v_cndmask_b32 v124, v17, v124, s[52:53]
    v_cndmask_b32 v125, v17, v125, s[54:55]
    v_cndmask_b32 v126, v17, v126, s[56:57]
    v_cndmask_b32 v127, v17, v127, s[58:59]
    v_cndmask_b32 v128, v17, v128, s[60:61]
    v_cndmask_b32 v129, v17, v129, s[62:63]
    v_cndmask_b32 v130, v17, v130, s[64:65]
    v_cndmask_b32 v131, v17, v131, s[66:67]
    v_max3_f32 v18, v116, v117, v118
    v_max3_f32 v18, v18, v119, v120
    v_max3_f32 v18, v18, v121, v122
    v_max3_f32 v18, v18, v123, v124
    v_max3_f32 v18, v18, v125, v126
    v_max3_f32 v18, v18, v127, v128
    v_max3_f32 v18, v18, v129, v130
    v_max3_f32 v18, v18, v131, v132
    v_max3_f32 v18, v18, v133, v134
    v_max_f32 v18, v18, v135
    v_mov_b32 v5, v18
    s_nop 1
    v_permlane32_swap_b32 v18, v5
    v_max_f32 v18, v18, v5
    v_mul_f32 v18, s29, v18
    v_fma_f32 v116, v116, s29, -v18
    v_fma_f32 v117, v117, s29, -v18
    v_fma_f32 v118, v118, s29, -v18
    v_fma_f32 v119, v119, s29, -v18
    v_fma_f32 v120, v120, s29, -v18
    v_fma_f32 v121, v121, s29, -v18
    v_fma_f32 v122, v122, s29, -v18
    v_fma_f32 v123, v123, s29, -v18
    v_fma_f32 v124, v124, s29, -v18
    v_fma_f32 v125, v125, s29, -v18
    v_fma_f32 v126, v126, s29, -v18
    v_fma_f32 v127, v127, s29, -v18
    v_fma_f32 v128, v128, s29, -v18
    v_fma_f32 v129, v129, s29, -v18
    v_fma_f32 v130, v130, s29, -v18
    v_fma_f32 v131, v131, s29, -v18
    v_fma_f32 v132, v132, s29, -v18
    v_fma_f32 v133, v133, s29, -v18
    v_fma_f32 v134, v134, s29, -v18
    v_fma_f32 v135, v135, s29, -v18
    v_exp_f32 v116, v116
    v_exp_f32 v117, v117
    v_exp_f32 v118, v118
    v_exp_f32 v119, v119
    v_exp_f32 v120, v120
    v_exp_f32 v121, v121
    v_exp_f32 v122, v122
    v_exp_f32 v123, v123
    v_exp_f32 v124, v124
    v_exp_f32 v125, v125
    v_exp_f32 v126, v126
    v_exp_f32 v127, v127
    v_exp_f32 v128, v128
    v_exp_f32 v129, v129
    v_exp_f32 v130, v130
    v_exp_f32 v131, v131
    v_exp_f32 v132, v132
    v_exp_f32 v133, v133
    v_exp_f32 v134, v134
    v_exp_f32 v135, v135
    s_waitcnt vmcnt(37)
    buffer_store_dword v9, v4, s[4:7], 0 offen sc1
    v_add_f32 v19, v116, v117
    v_add_f32 v6, v118, v119
    v_add_f32 v19, v19, v120
    v_add_f32 v6, v6, v121
    v_add_f32 v19, v19, v122
    v_add_f32 v6, v6, v123
    v_add_f32 v19, v19, v124
    v_add_f32 v6, v6, v125
    v_add_f32 v19, v19, v126
    v_add_f32 v6, v6, v127
    v_add_f32 v19, v19, v128
    v_add_f32 v6, v6, v129
    v_add_f32 v19, v19, v130
    v_add_f32 v6, v6, v131
    v_add_f32 v19, v19, v132
    v_add_f32 v6, v6, v133
    v_add_f32 v19, v19, v134
    v_add_f32 v6, v6, v135
    v_add_f32 v19, v19, v6
    v_mov_b32 v5, v19
    s_nop 1
    v_permlane32_swap_b32 v19, v5
    v_add_f32 v19, v19, v5
    v_rcp_f32 v19, v19
    s_nop 0
    v_mul_f32 v116, v116, v19
    v_mul_f32 v117, v117, v19
    v_mul_f32 v118, v118, v19
    v_mul_f32 v119, v119, v19
    v_mul_f32 v120, v120, v19
    v_mul_f32 v121, v121, v19
    v_mul_f32 v122, v122, v19
    v_mul_f32 v123, v123, v19
    v_mul_f32 v124, v124, v19
    v_mul_f32 v125, v125, v19
    v_mul_f32 v126, v126, v19
    v_mul_f32 v127, v127, v19
    v_mul_f32 v128, v128, v19
    v_mul_f32 v129, v129, v19
    v_mul_f32 v130, v130, v19
    v_mul_f32 v131, v131, v19
    v_mul_f32 v132, v132, v19
    v_mul_f32 v133, v133, v19
    v_mul_f32 v134, v134, v19
    v_mul_f32 v135, v135, v19
    v_cvt_pk_bf16_f32 v148, v116, v117
    v_cvt_pk_bf16_f32 v149, v118, v119
    v_cvt_pk_bf16_f32 v150, v120, v121
    v_cvt_pk_bf16_f32 v151, v122, v123
    v_cvt_pk_bf16_f32 v152, v124, v125
    v_cvt_pk_bf16_f32 v153, v126, v127
    v_cvt_pk_bf16_f32 v154, v128, v129
    v_cvt_pk_bf16_f32 v155, v130, v131
    v_cvt_pk_bf16_f32 v156, v132, v133
    v_cvt_pk_bf16_f32 v157, v134, v135
    v_mfma_f32_32x32x16_bf16 v[160:175], a[160:163], v[148:151], 0
    v_mfma_f32_32x32x16_bf16 v[160:175], a[164:167], v[152:155], v[160:175]
    v_mfma_f32_32x32x16_bf16 v[160:175], v[100:103], v[156:159], v[160:175]
    v_mfma_f32_32x32x16_bf16 v[176:191], a[168:171], v[148:151], 0
    v_mfma_f32_32x32x16_bf16 v[176:191], a[172:175], v[152:155], v[176:191]
    v_mfma_f32_32x32x16_bf16 v[176:191], v[104:107], v[156:159], v[176:191]
    s_nop 2
    v_cvt_pk_bf16_f32 v224, v160, v161
    v_cvt_pk_bf16_f32 v225, v162, v163
    v_cvt_pk_bf16_f32 v226, v164, v165
    v_cvt_pk_bf16_f32 v227, v166, v167
    v_cvt_pk_bf16_f32 v228, v168, v169
    v_cvt_pk_bf16_f32 v229, v170, v171
    v_cvt_pk_bf16_f32 v230, v172, v173
    v_cvt_pk_bf16_f32 v231, v174, v175
    buffer_store_dwordx4 v[224:227], v14, s[4:7], s33 offen offset:0 sc1
    buffer_store_dwordx4 v[228:231], v14, s[4:7], s33 offen offset:512 sc1
    v_mfma_f32_32x32x16_bf16 v[192:207], a[176:179], v[148:151], 0
    v_mfma_f32_32x32x16_bf16 v[192:207], a[180:183], v[152:155], v[192:207]
    v_mfma_f32_32x32x16_bf16 v[192:207], v[108:111], v[156:159], v[192:207]
    v_cvt_pk_bf16_f32 v232, v176, v177
    v_cvt_pk_bf16_f32 v233, v178, v179
    v_cvt_pk_bf16_f32 v234, v180, v181
    v_cvt_pk_bf16_f32 v235, v182, v183
    v_cvt_pk_bf16_f32 v236, v184, v185
    v_cvt_pk_bf16_f32 v237, v186, v187
    v_cvt_pk_bf16_f32 v238, v188, v189
    v_cvt_pk_bf16_f32 v239, v190, v191
    buffer_store_dwordx4 v[232:235], v14, s[4:7], s33 offen offset:1024 sc1
    buffer_store_dwordx4 v[236:239], v14, s[4:7], s33 offen offset:1536 sc1
    v_mfma_f32_32x32x16_bf16 v[208:223], a[184:187], v[148:151], 0
    v_mfma_f32_32x32x16_bf16 v[208:223], a[188:191], v[152:155], v[208:223]
    v_mfma_f32_32x32x16_bf16 v[208:223], v[112:115], v[156:159], v[208:223]
    v_cvt_pk_bf16_f32 v240, v192, v193
    v_cvt_pk_bf16_f32 v241, v194, v195
    v_cvt_pk_bf16_f32 v242, v196, v197
    v_cvt_pk_bf16_f32 v243, v198, v199
    v_cvt_pk_bf16_f32 v244, v200, v201
    v_cvt_pk_bf16_f32 v245, v202, v203
    v_cvt_pk_bf16_f32 v246, v204, v205
    v_cvt_pk_bf16_f32 v247, v206, v207
    buffer_store_dwordx4 v[240:243], v14, s[4:7], s33 offen offset:2048 sc1
    buffer_store_dwordx4 v[244:247], v14, s[4:7], s33 offen offset:2560 sc1
    v_add_u32 v9, 1, v9
    s_nop 0
    v_cvt_pk_bf16_f32 v248, v208, v209
    v_cvt_pk_bf16_f32 v249, v210, v211
    v_cvt_pk_bf16_f32 v250, v212, v213
    v_cvt_pk_bf16_f32 v251, v214, v215
    v_cvt_pk_bf16_f32 v252, v216, v217
    v_cvt_pk_bf16_f32 v253, v218, v219
    v_cvt_pk_bf16_f32 v254, v220, v221
    v_cvt_pk_bf16_f32 v255, v222, v223
    buffer_store_dwordx4 v[248:251], v14, s[4:7], s33 offen offset:3072 sc1
    buffer_store_dwordx4 v[252:255], v14, s[4:7], s33 offen offset:3584 sc1
    s_mov_b32 s28, s34
    s_add_u32 s33, s33, 2097152
    s_xor_b32 s33, s33, 8192
    s_cmp_lt_u32 s28, 64
    s_cbranch_scc1 T_top0
T_fin:
    s_waitcnt vmcnt(0)
    buffer_store_dword v9, v4, s[4:7], 0 offen sc1
    s_branch W_fin
T_slow0:
    s_waitcnt vmcnt(0)
    buffer_store_dword v9, v4, s[4:7], 0 offen sc1
    s_mov_b32 s30, s92
T_s0:
    v_cmp_ge_u32 vcc, s28, v16
    s_nop 0
    s_and_b32 s17, vcc_lo, 61440
    s_cbranch_scc0 T_sk0
    s_cmp_ge_u32 s30, 1048576
    s_cselect_b32 s92, 1048576, s92
    s_cbranch_scc1 T_sk0
    s_add_u32 s30, s30, 1
    buffer_load_dword v16, v15, s[4:7], 0 offen sc1
    s_sleep 2
    s_waitcnt vmcnt(0)
    s_branch T_s0
T_sk0:
    s_add_u32 s17, s32, 0
    s_add_u32 s18, s32, 5242880
    buffer_load_dwordx4 v[20:23], v12, s[4:7], s17 offen offset:0
    buffer_load_dwordx4 v[24:27], v12, s[4:7], s17 offen offset:32
    buffer_load_dwordx2 v[52:53], v13, s[4:7], s18 offen
    s_add_u32 s17, s32, 33280
    s_add_u32 s18, s32, 5276160
    buffer_load_dwordx4 v[28:31], v12, s[4:7], s17 offen offset:0
    buffer_load_dwordx4 v[32:35], v12, s[4:7], s17 offen offset:32
    buffer_load_dwordx2 v[56:57], v13, s[4:7], s18 offen
    s_add_u32 s17, s32, 66560
    s_add_u32 s18, s32, 5309440
    buffer_load_dwordx4 v[36:39], v12, s[4:7], s17 offen offset:0
    buffer_load_dwordx4 v[40:43], v12, s[4:7], s17 offen offset:32
    buffer_load_dwordx2 v[60:61], v13, s[4:7], s18 offen
    s_add_u32 s17, s32, 99840
    s_add_u32 s18, s32, 5342720
    buffer_load_dwordx4 v[44:47], v12, s[4:7], s17 offen offset:0
    buffer_load_dwordx4 v[48:51], v12, s[4:7], s17 offen offset:32
    buffer_load_dwordx2 v[64:65], v13, s[4:7], s18 offen
    s_waitcnt vmcnt(0)
    s_branch T_go0
T_pw0:
    s_mov_b32 s30, s92
T_q0:
    v_cmp_ge_u32 vcc, s68, v16
    s_nop 0
    s_and_b32 s17, vcc_lo, 4095
    s_cbranch_scc0 T_pok0
    s_cmp_ge_u32 s30, 1048576
    s_cselect_b32 s92, 1048576, s92
    s_cbranch_scc1 T_pok0
    s_add_u32 s30, s30, 1
    buffer_load_dword v16, v15, s[4:7], 0 offen sc1
    s_sleep 8
    s_waitcnt vmcnt(0)
    s_branch T_q0
T_slow1:
    s_waitcnt vmcnt(0)
    buffer_store_dword v9, v4, s[4:7], 0 offen sc1
    s_cmp_ge_u32 s28, 60
    s_cbranch_scc1 T_last
    s_mov_b32 s30, s92
T_s1:
    v_cmp_ge_u32 vcc, s28, v16
    s_nop 0
    s_and_b32 s17, vcc_lo, 61440
    s_cbranch_scc0 T_sk1
    s_cmp_ge_u32 s30, 1048576
    s_cselect_b32 s92, 1048576, s92
    s_cbranch_scc1 T_sk1
    s_add_u32 s30, s30, 1
    buffer_load_dword v16, v15, s[4:7], 0 offen sc1
    s_sleep 2
    s_waitcnt vmcnt(0)
    s_branch T_s1
T_sk1:
    s_add_u32 s17, s32, 0
    s_add_u32 s18, s32, 5242880
    buffer_load_dwordx4 v[68:71], v12, s[4:7], s17 offen offset:0
    buffer_load_dwordx4 v[72:75], v12, s[4:7], s17 offen offset:32
    buffer_load_dwordx2 v[100:101], v13, s[4:7], s18 offen
    s_add_u32 s17, s32, 33280
    s_add_u32 s18, s32, 5276160
    buffer_load_dwordx4 v[76:79], v12, s[4:7], s17 offen offset:0
    buffer_load_dwordx4 v[80:83], v12, s[4:7], s17 offen offset:32
    buffer_load_dwordx2 v[104:105], v13, s[4:7], s18 offen
    s_add_u32 s17, s32, 66560
    s_add_u32 s18, s32, 5309440
    buffer_load_dwordx4 v[84:87], v12, s[4:7], s17 offen offset:0
    buffer_load_dwordx4 v[88:91], v12, s[4:7], s17 offen offset:32
    buffer_load_dwordx2 v[108:109], v13, s[4:7], s18 offen
    s_add_u32 s17, s32, 99840
    s_add_u32 s18, s32, 5342720
    buffer_load_dwordx4 v[92:95], v12, s[4:7], s17 offen offset:0
    buffer_load_dwordx4 v[96:99], v12, s[4:7], s17 offen offset:32
    buffer_load_dwordx2 v[112:113], v13, s[4:7], s18 offen
    s_waitcnt vmcnt(0)
    s_branch T_go1
T_pw1:
    s_mov_b32 s30, s92
T_q1:
    v_cmp_ge_u32 vcc, s68, v16
    s_nop 0
    s_and_b32 s17, vcc_lo, 4095
    s_cbranch_scc0 T_pok1
    s_cmp_ge_u32 s30, 1048576
    s_cselect_b32 s92, 1048576, s92
    s_cbranch_scc1 T_pok1
    s_add_u32 s30, s30, 1
    buffer_load_dword v16, v15, s[4:7], 0 offen sc1
    s_sleep 8
    s_waitcnt vmcnt(0)
    s_branch T_q1
T_last:
    v_mfma_f32_32x32x16_bf16 v[116:131], a[128:131], a[96:99], 0
    v_mfma_f32_32x32x16_bf16 v[116:131], a[132:135], a[100:103], v[116:131]
    v_mfma_f32_32x32x16_bf16 v[116:131], a[136:139], a[104:107], v[116:131]
    v_mfma_f32_32x32x16_bf16 v[116:131], a[140:143], a[108:111], v[116:131]
    v_mfma_f32_32x32x16_bf16 v[116:131], a[144:147], a[112:115], v[116:131]
    v_mfma_f32_32x32x16_bf16 v[116:131], a[148:151], a[116:119], v[116:131]
    v_mfma_f32_32x32x16_bf16 v[116:131], a[152:155], a[120:123], v[116:131]
    v_mfma_f32_32x32x16_bf16 v[116:131], a[156:159], a[124:127], v[116:131]
    s_nop 11
    v_cndmask_b32 v116, v17, v116, s[36:37]
    v_cndmask_b32 v117, v17, v117, s[38:39]
    v_cndmask_b32 v118, v17, v118, s[40:41]
    v_cndmask_b32 v119, v17, v119, s[42:43]
    v_cndmask_b32 v120, v17, v120, s[44:45]
    v_cndmask_b32 v121, v17, v121, s[46:47]
    v_cndmask_b32 v122, v17, v122, s[48:49]
    v_cndmask_b32 v123, v17, v123, s[50:51]
    v_cndmask_b32 v124, v17, v124, s[52:53]
    v_cndmask_b32 v125, v17, v125, s[54:55]
    v_cndmask_b32 v126, v17, v126, s[56:57]
    v_cndmask_b32 v127, v17, v127, s[58:59]
    v_cndmask_b32 v128, v17, v128, s[60:61]
    v_cndmask_b32 v129, v17, v129, s[62:63]
    v_cndmask_b32 v130, v17, v130, s[64:65]
    v_cndmask_b32 v131, v17, v131, s[66:67]
    v_max3_f32 v20, v116, v117, v118
    v_max3_f32 v20, v20, v119, v120
    v_max3_f32 v20, v20, v121, v122
    v_max3_f32 v20, v20, v123, v124
    v_max3_f32 v20, v20, v125, v126
    v_max3_f32 v20, v20, v127, v128
    v_max3_f32 v20, v20, v129, v130
    v_max_f32 v20, v20, v131
    v_mov_b32 v5, v20
    s_nop 1
    v_permlane32_swap_b32 v20, v5
    v_max_f32 v20, v20, v5
    v_mul_f32 v18, s29, v20
    v_fma_f32 v116, v116, s29, -v18
    v_fma_f32 v117, v117, s29, -v18
    v_fma_f32 v118, v118, s29, -v18
    v_fma_f32 v119, v119, s29, -v18
    v_fma_f32 v120, v120, s29, -v18
    v_fma_f32 v121, v121, s29, -v18
    v_fma_f32 v122, v122, s29, -v18
    v_fma_f32 v123, v123, s29, -v18
    v_fma_f32 v124, v124, s29, -v18
    v_fma_f32 v125, v125, s29, -v18
    v_fma_f32 v126, v126, s29, -v18
    v_fma_f32 v127, v127, s29, -v18
    v_fma_f32 v128, v128, s29, -v18
    v_fma_f32 v129, v129, s29, -v18
    v_fma_f32 v130, v130, s29, -v18
    v_fma_f32 v131, v131, s29, -v18
    v_exp_f32 v116, v116
    v_exp_f32 v117, v117
    v_exp_f32 v118, v118
    v_exp_f32 v119, v119
    v_exp_f32 v120, v120
    v_exp_f32 v121, v121
    v_exp_f32 v122, v122
    v_exp_f32 v123, v123
    v_exp_f32 v124, v124
    v_exp_f32 v125, v125
    v_exp_f32 v126, v126
    v_exp_f32 v127, v127
    v_exp_f32 v128, v128
    v_exp_f32 v129, v129
    v_exp_f32 v130, v130
    v_exp_f32 v131, v131
    v_add_f32 v19, v116, v117
    v_add_f32 v19, v19, v118
    v_add_f32 v19, v19, v119
    v_add_f32 v19, v19, v120
    v_add_f32 v19, v19, v121
    v_add_f32 v19, v19, v122
    v_add_f32 v19, v19, v123
    v_add_f32 v19, v19, v124
    v_add_f32 v19, v19, v125
    v_add_f32 v19, v19, v126
    v_add_f32 v19, v19, v127
    v_add_f32 v19, v19, v128
    v_add_f32 v19, v19, v129
    v_add_f32 v19, v19, v130
    v_add_f32 v19, v19, v131
    v_cvt_pk_bf16_f32 v148, v116, v117
    v_cvt_pk_bf16_f32 v149, v118, v119
    v_cvt_pk_bf16_f32 v150, v120, v121
    v_cvt_pk_bf16_f32 v151, v122, v123
    v_cvt_pk_bf16_f32 v152, v124, v125
    v_cvt_pk_bf16_f32 v153, v126, v127
    v_cvt_pk_bf16_f32 v154, v128, v129
    v_cvt_pk_bf16_f32 v155, v130, v131
    v_mfma_f32_32x32x16_bf16 v[160:175], a[160:163], v[148:151], 0
    s_nop 0
    v_mfma_f32_32x32x16_bf16 v[160:175], a[164:167], v[152:155], v[160:175]
    v_mfma_f32_32x32x16_bf16 v[176:191], a[168:171], v[148:151], 0
    v_mfma_f32_32x32x16_bf16 v[176:191], a[172:175], v[152:155], v[176:191]
    v_mfma_f32_32x32x16_bf16 v[192:207], a[176:179], v[148:151], 0
    v_mfma_f32_32x32x16_bf16 v[192:207], a[180:183], v[152:155], v[192:207]
    v_mfma_f32_32x32x16_bf16 v[208:223], a[184:187], v[148:151], 0
    v_mfma_f32_32x32x16_bf16 v[208:223], a[188:191], v[152:155], v[208:223]
    s_cmp_ge_u32 s28, 61
    s_cselect_b64 s[48:49], 0xffff, 0
    s_sub_u32 s34, s28, 2
    s_add_u32 s36, s32, 0
    s_add_u32 s40, s32, 5242880
    s_add_u32 s37, s32, 33280
    s_add_u32 s41, s32, 5276160
    s_add_u32 s38, s32, 66560
    s_add_u32 s42, s32, 5309440
    s_add_u32 s39, s32, 99840
    s_add_u32 s43, s32, 5342720
    v_add_u32 v9, 1, v9
    s_mov_b32 s30, s92
T_l0:
    v_cmp_ge_u32 vcc, s34, v16
    s_nop 0
    s_and_b32 s17, vcc_lo, 61440
    s_cbranch_scc0 T_l1
    s_cmp_ge_u32 s30, 1048576
    s_cselect_b32 s92, 1048576, s92
    s_cbranch_scc1 T_l1
    s_add_u32 s30, s30, 1
    buffer_load_dword v16, v15, s[4:7], 0 offen sc1
    s_sleep 2
    s_waitcnt vmcnt(0)
    s_branch T_l0
T_l2:
    v_max3_u32 v5, v68, v69, v70
    v_max3_u32 v5, v5, v71, v72
    v_max3_u32 v5, v5, v73, v74
    v_max3_u32 v5, v5, v75, v76
    v_max3_u32 v5, v5, v77, v78
    v_max3_u32 v5, v5, v79, v80
    v_max3_u32 v5, v5, v81, v82
    v_max3_u32 v5, v5, v83, v84
    v_max3_u32 v5, v5, v85, v86
    v_max3_u32 v5, v5, v87, v88
    v_max3_u32 v5, v5, v89, v90
    v_max3_u32 v5, v5, v91, v92
    v_max3_u32 v5, v5, v93, v94
    v_max3_u32 v5, v5, v95, v96
    v_max3_u32 v5, v5, v97, v98
    v_max3_u32 v5, v5, v99, v6
    v_cmp_eq_u32 vcc, -1, v5
    s_nop 0
    s_cbranch_vccz T_l3
    s_add_u32 s30, s30, 1
    s_cmp_ge_u32 s30, 1048576
    s_cbranch_scc1 T_l3
T_l1:
    buffer_load_dwordx4 v[68:71], v12, s[4:7], s36 offen offset:0 sc1
    buffer_load_dwordx4 v[72:75], v12, s[4:7], s36 offen offset:32 sc1
    buffer_load_dwordx4 v[76:79], v12, s[4:7], s37 offen offset:0 sc1
    buffer_load_dwordx4 v[80:83], v12, s[4:7], s37 offen offset:32 sc1
    buffer_load_dwordx4 v[84:87], v12, s[4:7], s38 offen offset:0 sc1
    buffer_load_dwordx4 v[88:91], v12, s[4:7], s38 offen offset:32 sc1
    buffer_load_dwordx4 v[92:95], v12, s[4:7], s39 offen offset:0 sc1
    buffer_load_dwordx4 v[96:99], v12, s[4:7], s39 offen offset:32 sc1
    buffer_load_dwordx2 v[100:101], v13, s[4:7], s40 offen sc1
    buffer_load_dwordx2 v[104:105], v13, s[4:7], s41 offen sc1
    buffer_load_dwordx2 v[108:109], v13, s[4:7], s42 offen sc1
    buffer_load_dwordx2 v[112:113], v13, s[4:7], s43 offen sc1
    s_waitcnt vmcnt(11)
    v_mfma_f32_32x32x16_bf16 v[132:147], v[68:71], a[96:99], 0
    s_waitcnt vmcnt(10)
    v_mfma_f32_32x32x16_bf16 v[132:147], v[72:75], a[100:103], v[132:147]
    s_waitcnt vmcnt(9)
    v_mfma_f32_32x32x16_bf16 v[132:147], v[76:79], a[104:107], v[132:147]
    s_waitcnt vmcnt(8)
    v_mfma_f32_32x32x16_bf16 v[132:147], v[80:83], a[108:111], v[132:147]
    s_waitcnt vmcnt(7)
    v_mfma_f32_32x32x16_bf16 v[132:147], v[84:87], a[112:115], v[132:147]
    s_waitcnt vmcnt(6)
    v_mfma_f32_32x32x16_bf16 v[132:147], v[88:91], a[116:119], v[132:147]
    s_waitcnt vmcnt(5)
    v_mfma_f32_32x32x16_bf16 v[132:147], v[92:95], a[120:123], v[132:147]
    s_waitcnt vmcnt(4)
    v_mfma_f32_32x32x16_bf16 v[132:147], v[96:99], a[124:127], v[132:147]
    s_waitcnt vmcnt(0)
    v_max3_u32 v6, v100, v101, v104
    v_max3_u32 v6, v6, v105, v108
    v_max3_u32 v6, v6, v109, v112
    v_max_u32 v6, v6, v113
    v_cmp_eq_u32 s[44:45], -1, v6
    s_nop 5
    v_cmp_u_f32 s[46:47], v132, v133
    v_cmp_u_f32 vcc, v134, v135
    v_max3_f32 v18, v132, v133, v20
    s_or_b64 s[44:45], s[44:45], s[46:47]
    v_max3_f32 v18, v134, v135, v18
    s_or_b64 vcc, vcc, s[44:45]
    s_cbranch_vccnz T_l2
T_l3:
    v_mov_b32 v5, v18
    s_nop 1
    v_permlane32_swap_b32 v18, v5
    v_max_f32 v18, v18, v5
    v_mul_f32 v18, s29, v18
    v_fma_f32 v21, v20, s29, -v18
    v_fma_f32 v132, v132, s29, -v18
    v_fma_f32 v133, v133, s29, -v18
    v_fma_f32 v134, v134, s29, -v18
    v_fma_f32 v135, v135, s29, -v18
    v_exp_f32 v21, v21
    v_exp_f32 v132, v132
    v_exp_f32 v133, v133
    v_exp_f32 v134, v134
    v_exp_f32 v135, v135
    v_fma_f32 v19, v19, v21, v132
    v_add_f32 v6, v133, v134
    v_add_f32 v19, v19, v135
    v_add_f32 v19, v19, v6
    v_mov_b32 v5, v19
    s_nop 1
    v_permlane32_swap_b32 v19, v5
    v_add_f32 v19, v19, v5
    v_rcp_f32 v19, v19
    s_nop 0
    v_mul_f32 v21, v21, v19
    v_mul_f32 v132, v132, v19
    v_mul_f32 v133, v133, v19
    v_mul_f32 v134, v134, v19
    v_mul_f32 v135, v135, v19
    v_cvt_pk_bf16_f32 v156, v132, v133
    v_cvt_pk_bf16_f32 v157, v134, v135
    v_mul_f32 v160, v160, v21
    v_mul_f32 v161, v161, v21
    v_mul_f32 v162, v162, v21
    v_mul_f32 v163, v163, v21
    v_mul_f32 v164, v164, v21
    v_mul_f32 v165, v165, v21
    v_mul_f32 v166, v166, v21
    v_mul_f32 v167, v167, v21
    v_mul_f32 v168, v168, v21
    v_mul_f32 v169, v169, v21
    v_mul_f32 v170, v170, v21
    v_mul_f32 v171, v171, v21
    v_mul_f32 v172, v172, v21
    v_mul_f32 v173, v173, v21
    v_mul_f32 v174, v174, v21
    v_mul_f32 v175, v175, v21
    s_nop 1
    v_mfma_f32_32x32x16_bf16 v[160:175], v[100:103], v[156:159], v[160:175]
    v_mul_f32 v176, v176, v21
    v_mul_f32 v177, v177, v21
    v_mul_f32 v178, v178, v21
    v_mul_f32 v179, v179, v21
    v_mul_f32 v180, v180, v21
    v_mul_f32 v181, v181, v21
    v_mul_f32 v182, v182, v21
    v_mul_f32 v183, v183, v21
    v_mul_f32 v184, v184, v21
    v_mul_f32 v185, v185, v21
    v_mul_f32 v186, v186, v21
    v_mul_f32 v187, v187, v21
    v_mul_f32 v188, v188, v21
    v_mul_f32 v189, v189, v21
    v_mul_f32 v190, v190, v21
    v_mul_f32 v191, v191, v21
    s_nop 1
    v_mfma_f32_32x32x16_bf16 v[176:191], v[104:107], v[156:159], v[176:191]
    v_cvt_pk_bf16_f32 v224, v160, v161
    v_cvt_pk_bf16_f32 v225, v162, v163
    v_cvt_pk_bf16_f32 v226, v164, v165
    v_cvt_pk_bf16_f32 v227, v166, v167
    v_cvt_pk_bf16_f32 v228, v168, v169
    v_cvt_pk_bf16_f32 v229, v170, v171
    v_cvt_pk_bf16_f32 v230, v172, v173
    v_cvt_pk_bf16_f32 v231, v174, v175
    buffer_store_dwordx4 v[224:227], v14, s[4:7], s33 offen offset:0 sc1
    buffer_store_dwordx4 v[228:231], v14, s[4:7], s33 offen offset:512 sc1
    v_mul_f32 v192, v192, v21
    v_mul_f32 v193, v193, v21
    v_mul_f32 v194, v194, v21
    v_mul_f32 v195, v195, v21
    v_mul_f32 v196, v196, v21
    v_mul_f32 v197, v197, v21
    v_mul_f32 v198, v198, v21
    v_mul_f32 v199, v199, v21
    v_mul_f32 v200, v200, v21
    v_mul_f32 v201, v201, v21
    v_mul_f32 v202, v202, v21
    v_mul_f32 v203, v203, v21
    v_mul_f32 v204, v204, v21
    v_mul_f32 v205, v205, v21
    v_mul_f32 v206, v206, v21
    v_mul_f32 v207, v207, v21
    s_nop 1
    v_mfma_f32_32x32x16_bf16 v[192:207], v[108:111], v[156:159], v[192:207]
    v_cvt_pk_bf16_f32 v232, v176, v177
    v_cvt_pk_bf16_f32 v233, v178, v179
    v_cvt_pk_bf16_f32 v234, v180, v181
    v_cvt_pk_bf16_f32 v235, v182, v183
    v_cvt_pk_bf16_f32 v236, v184, v185
    v_cvt_pk_bf16_f32 v237, v186, v187
    v_cvt_pk_bf16_f32 v238, v188, v189
    v_cvt_pk_bf16_f32 v239, v190, v191
    buffer_store_dwordx4 v[232:235], v14, s[4:7], s33 offen offset:1024 sc1
    buffer_store_dwordx4 v[236:239], v14, s[4:7], s33 offen offset:1536 sc1
    v_mul_f32 v208, v208, v21
    v_mul_f32 v209, v209, v21
    v_mul_f32 v210, v210, v21
    v_mul_f32 v211, v211, v21
    v_mul_f32 v212, v212, v21
    v_mul_f32 v213, v213, v21
    v_mul_f32 v214, v214, v21
    v_mul_f32 v215, v215, v21
    v_mul_f32 v216, v216, v21
    v_mul_f32 v217, v217, v21
    v_mul_f32 v218, v218, v21
    v_mul_f32 v219, v219, v21
    v_mul_f32 v220, v220, v21
    v_mul_f32 v221, v221, v21
    v_mul_f32 v222, v222, v21
    v_mul_f32 v223, v223, v21
    s_nop 1
    v_mfma_f32_32x32x16_bf16 v[208:223], v[112:115], v[156:159], v[208:223]
    v_cvt_pk_bf16_f32 v240, v192, v193
    v_cvt_pk_bf16_f32 v241, v194, v195
    v_cvt_pk_bf16_f32 v242, v196, v197
    v_cvt_pk_bf16_f32 v243, v198, v199
    v_cvt_pk_bf16_f32 v244, v200, v201
    v_cvt_pk_bf16_f32 v245, v202, v203
    v_cvt_pk_bf16_f32 v246, v204, v205
    v_cvt_pk_bf16_f32 v247, v206, v207
    buffer_store_dwordx4 v[240:243], v14, s[4:7], s33 offen offset:2048 sc1
    buffer_store_dwordx4 v[244:247], v14, s[4:7], s33 offen offset:2560 sc1
    s_nop 1
    v_cvt_pk_bf16_f32 v248, v208, v209
    v_cvt_pk_bf16_f32 v249, v210, v211
    v_cvt_pk_bf16_f32 v250, v212, v213
    v_cvt_pk_bf16_f32 v251, v214, v215
    v_cvt_pk_bf16_f32 v252, v216, v217
    v_cvt_pk_bf16_f32 v253, v218, v219
    v_cvt_pk_bf16_f32 v254, v220, v221
    v_cvt_pk_bf16_f32 v255, v222, v223
    buffer_store_dwordx4 v[248:251], v14, s[4:7], s33 offen offset:3072 sc1
    buffer_store_dwordx4 v[252:255], v14, s[4:7], s33 offen offset:3584 sc1
    s_branch T_fin
W_fin:
W_end:
    s_endpgm
R_entry:
    s_mov_b32 s12, s3
    s_lshr_b32 s13, s2, 3
    s_load_dwordx2 s[4:5], s[0:1], 96
    s_load_dwordx2 s[28:29], s[0:1], 32
    s_load_dwordx2 s[30:31], s[0:1], 40
    s_load_dwordx2 s[32:33], s[0:1], 48
    s_load_dwordx2 s[34:35], s[0:1], 56
    s_load_dwordx2 s[36:37], s[0:1], 64
    v_lshrrev_b32 v19, 6, v0
    v_and_b32 v1, 63, v0
    v_readfirstlane_b32 s14, v19
    s_mov_b32 s6, 268435456
    s_mov_b32 s7, 0x20000
    s_mov_b32 s10, 8388608
    s_mov_b32 s11, 0x20000
    s_mov_b32 s25, 0
    s_mov_b32 s24, 1040356334
    s_waitcnt lgkmcnt(0)
    v_and_b32 v96, 7, v1
    v_bfe_u32 v97, v1, 3, 1
    v_lshrrev_b32 v98, 4, v1
    v_lshlrev_b32 v19, 4, v1
    s_lshl_b32 s21, s12, 14
    s_lshl_b32 s22, s14, 12
    s_add_u32 s21, s21, s22
    s_add_u32 s22, s21, 0
    v_add_u32 v2, s22, v19
    s_add_u32 s22, s21, 229376
    v_add_u32 v8, s22, v19
    s_lshr_b32 s21, s13, 1
    s_lshl_b32 s21, s21, 10
    s_and_b32 s22, s13, 1
    s_lshl_b32 s22, s22, 7
    s_add_u32 s21, s21, s22
    s_lshl_b32 s22, s12, 14
    s_add_u32 s21, s21, s22
    v_lshlrev_b32 v20, 8, v98
    v_lshl_add_u32 v20, v96, 4, v20
    v_lshl_add_u32 v20, v97, 3, v20
    s_add_u32 s22, s21, 229376
    v_add_u32 v7, s22, v20
    s_add_u32 s22, s21, 0
    v_add_u32 v11, s22, v20
    s_lshr_b32 s21, s13, 1
    s_lshl_b32 s21, s21, 14
    s_and_b32 s22, s13, 1
    s_lshl_b32 s22, s22, 12
    s_add_u32 s21, s21, s22
    s_lshl_b32 s22, s12, 10
    s_add_u32 s22, s21, s22
    v_add_u32 v9, s22, v19
    v_xor_b32 v10, 1024, v9
    v_xor_b32 v23, 2048, v9
    v_xor_b32 v244, 3072, v9
    s_mov_b32 s95, 150994944
    s_lshr_b32 s40, s13, 2
    s_lshl_b32 s21, s12, 3
    s_add_u32 s40, s40, s21
    s_and_b32 s41, s13, 3
    s_mul_i32 s21, s40, 5120
    s_add_u32 s21, s21, 65536
    v_add_u32 v5, s21, v19
    v_lshlrev_b32 v20, 2, v1
    s_add_u32 s22, s21, 4096
    v_add_u32 v6, s22, v20
    s_lshl_b32 s22, s41, 10
    s_add_u32 s22, s22, s21
    v_add_u32 v3, s22, v19
    v_mov_b32 v21, 1073741824
    v_cmp_eq_u32 vcc, 0, v97
    s_nop 1
    v_cndmask_b32 v3, v21, v3, vcc
    s_lshl_b32 s22, s41, 8
    s_add_u32 s22, s22, s21
    s_add_u32 s22, s22, 4096
    v_lshlrev_b32 v20, 4, v98
    v_lshl_add_u32 v20, v96, 5, v20
    v_add_u32 v4, s22, v20
    v_cndmask_b32 v4, v4, v21, vcc
    v_cmp_gt_u32 vcc, 2, v98
    s_nop 1
    v_cndmask_b32 v4, v21, v4, vcc
    s_lshl_b32 s27, s40, 7
    s_lshl_b32 s21, s41, 5
    s_add_u32 s27, s27, s21
    v_bfe_u32 v20, v1, 2, 2
    v_and_b32 v22, 3, v1
    v_lshl_add_u32 v20, v20, 3, v22
    v_and_b32 v12, 16, v1
    v_lshl_add_u32 v12, v20, 5, v12
    v_and_b32 v13, 32, v1
    v_lshl_add_u32 v12, v13, 5, v12
    s_and_b32 s21, s14, 1
    s_lshl_b32 s21, s21, 14
    s_lshl_b32 s22, s27, 2
    s_add_u32 s21, s21, s22
    s_add_u32 s21, s21, 100679680
    v_mov_b32 v245, s21
    s_mov_b32 s47, s21
    s_mov_b32 s85, 0
    s_mul_i32 s21, s27, 4160
    v_add_u32 v12, s21, v12
    v_mov_b32 v13, v12
    v_and_b32 v173, 15, v1
    v_lshl_add_u32 v173, v173, 7, s21
    v_mul_u32_u24 v175, 69632, v98
    v_lshl_add_u32 v173, v175, 8, v173
    s_add_u32 s22, s22, 100679680
    v_lshl_add_u32 v174, v98, 14, s22
    v_mov_b32 v175, 0
    v_lshlrev_b32 v15, 4, v20
    v_lshl_add_u32 v15, v98, 5, v15
    s_mul_i32 s21, s27, 1040
    v_add_u32 v15, s21, v15
    v_and_b32 v22, 1, v98
    v_cmp_eq_u32 vcc, 0, v22
    s_nop 1
    v_cndmask_b32 v15, v21, v15, vcc
    v_lshlrev_b32 v14, 6, v96
    v_lshl_add_u32 v14, v98, 4, v14
    v_add_u32 v14, s21, v14
    v_cmp_eq_u32 vcc, 1, v97
    s_nop 1
    v_cndmask_b32 v14, v21, v14, vcc
    v_mov_b32 v16, v19
    s_lshl_b32 s21, s14, 11
    v_add_u32 v17, s21, v19
    v_and_b32 v20, 15, v1
    v_bfe_u32 v22, v1, 2, 2
    v_and_b32 v18, 1, v1
    v_lshl_add_u32 v18, v22, 1, v18
    v_bfe_u32 v22, v1, 1, 1
    v_lshl_add_u32 v18, v22, 3, v18
    s_cmp_eq_u32 s14, 1
    s_cselect_b64 vcc, -1, 0
    v_cndmask_b32 v20, v20, v18, vcc
    v_and_b32 v22, 1, v98
    v_lshlrev_b32 v22, 2, v22
    v_sub_u32 v20, v20, v22
    v_mov_b32 v22, 0x3f80
    v_mov_b32 v18, 0x3f800000
    v_mov_b32 v172, 0x4444
    v_mov_b32 v84, 0xeeee
    v_cmp_eq_u32 vcc, 1, v97
    s_nop 1
    v_cndmask_b32 v172, v172, v84, vcc
    v_cmp_eq_u32 vcc, 0, v20
    s_nop 1
    v_cndmask_b32 v84, 0, v22, vcc
    v_cmp_eq_u32 vcc, 1, v20
    s_nop 1
    v_cndmask_b32 v84, v84, v18, vcc
    v_cmp_eq_u32 vcc, 2, v20
    s_nop 1
    v_cndmask_b32 v85, 0, v22, vcc
    v_cmp_eq_u32 vcc, 3, v20
    s_nop 1
    v_cndmask_b32 v85, v85, v18, vcc
    v_cmp_eq_u32 vcc, 8, v20
    s_nop 1
    v_cndmask_b32 v86, 0, v22, vcc
    v_cmp_eq_u32 vcc, 9, v20
    s_nop 1
    v_cndmask_b32 v86, v86, v18, vcc
    v_cmp_eq_u32 vcc, 10, v20
    s_nop 1
    v_cndmask_b32 v87, 0, v22, vcc
    v_cmp_eq_u32 vcc, 11, v20
    s_nop 1
    v_cndmask_b32 v87, v87, v18, vcc
    s_mov_b32 s16, 81788928
    s_mov_b32 s42, 82083840
    s_mov_b32 s43, 82378752
    s_mov_b32 s44, 82673664
    s_mov_b32 s17, 17825792
    s_mov_b32 s18, 35651584
    s_mov_b32 s19, 71303168
    s_mov_b32 s20, 76546048
    s_mov_b32 s15, 0
    v_mov_b32 v204, -1
    v_mov_b32 v205, -1
    v_mov_b32 v206, -1
    v_mov_b32 v207, -1
    v_mov_b32 v236, 0x3f803f80
    v_mov_b32 v237, 0x3f803f80
    v_mov_b32 v238, 0x3f803f80
    v_mov_b32 v239, 0x3f803f80
    s_mul_i32 s22, s14, 294912
    s_add_u32 s22, s22, 81788928
    buffer_store_dwordx4 v[204:207], v3, s[4:7], s22 offen sc1
    buffer_store_dwordx4 v[204:207], v3, s[4:7], s22 offen offset:128 sc1
    buffer_store_dwordx4 v[204:207], v4, s[4:7], s22 offen sc1
    buffer_store_dwordx2 v[204:205], v7, s[4:7], s22 offen sc1
    buffer_store_dwordx2 v[204:205], v11, s[4:7], s22 offen sc1
    s_lshl_b32 s22, s14, 18
    s_add_u32 s22, s22, 150994944
    buffer_store_dwordx4 v[204:207], v9, s[4:7], s22 offen sc1
    s_add_u32 s22, s22, 8192
    buffer_store_dwordx4 v[204:207], v9, s[4:7], s22 offen sc1
    s_lshl_b32 s22, s14, 9
    s_add_u32 s22, s22, 71333888
    buffer_store_dwordx4 v[204:207], v14, s[4:7], s22 offen sc1
    s_add_u32 s22, s22, 5242880
    buffer_store_dwordx4 v[204:207], v15, s[4:7], s22 offen sc1
    s_lshl_b32 s22, s27, 2
    s_add_u32 s22, s22, 100712448
    v_lshlrev_b32 v246, 2, v1
    v_add_u32 v246, s22, v246
    v_cmp_gt_u32 vcc, 32, v1
    s_nop 1
    v_cndmask_b32 v246, v21, v246, vcc
    v_mov_b32 v247, 0
    buffer_store_dword v247, v246, s[4:7], 0 offen sc1
    v_lshrrev_b32 v19, 2, v1
    v_and_b32 v22, 3, v1
    v_lshlrev_b32 v22, 4, v22
    v_lshl_add_u32 v140, v19, 13, v22
    v_lshl_add_u32 v141, v19, 11, v22
    s_mul_i32 s86, s14, 40960
    s_lshr_b32 s21, s13, 3
    s_cmp_eq_u32 s21, 1
    s_cselect_b64 s[88:89], s[32:33], s[30:31]
    s_cmp_eq_u32 s21, 2
    s_cselect_b64 s[88:89], s[34:35], s[88:89]
    s_cmp_eq_u32 s21, 3
    s_cselect_b64 s[88:89], s[36:37], s[88:89]
    s_mov_b32 s90, 8388608
    s_mov_b32 s91, 0x20000
    s_cselect_b32 s21, 11, 13
    s_cselect_b32 s92, 21, 11
    s_lshl_b32 s92, s12, s92
    s_and_b32 s22, s13, 3
    s_lshl_b32 s22, s22, 8
    v_add_u32 v142, s22, v0
    v_lshlrev_b32 v142, s21, v142
    s_and_b32 s22, s13, 4
    s_lshl_b32 s22, s22, 8
    s_add_u32 s92, s92, s22
    s_lshr_b32 s22, s13, 3
    s_lshl2_add_u32 s22, s12, s22
    s_bitcmp1_b32 26214, s22
    s_cselect_b32 s21, s92, 1073741824
    s_cmp_ge_u32 s14, 2
    s_cselect_b32 s21, s21, 1073741824
    buffer_load_dword v143, v142, s[88:91], s21 offen offset:384
    s_cmp_eq_u32 s92, 7168
    s_cselect_b32 s92, s92, 1073741824
    s_bitcmp1_b32 26214, s22
    s_cselect_b32 s21, s92, 1073741824
    s_cmp_ge_u32 s14, 2
    s_cselect_b32 s21, s21, 1073741824
    buffer_load_dword v143, v142, s[88:91], s21 offen offset:896
    s_mov_b32 s8, s32
    s_mov_b32 s9, s33
    s_lshl_b32 s87, s14, 21
    s_lshl_b32 s22, s27, 1
    s_add_u32 s87, s87, s22
    s_add_u32 m0, s86, 0
    s_nop 0
    buffer_load_dwordx4 v140, s[8:11], s87 offen lds
    s_add_u32 s87, s87, 131072
    s_add_u32 m0, s86, 1024
    s_nop 0
    buffer_load_dwordx4 v140, s[8:11], s87 offen lds
    s_add_u32 s87, s87, 131072
    s_add_u32 m0, s86, 2048
    s_nop 0
    buffer_load_dwordx4 v140, s[8:11], s87 offen lds
    s_add_u32 s87, s87, 131072
    s_add_u32 m0, s86, 3072
    s_nop 0
    buffer_load_dwordx4 v140, s[8:11], s87 offen lds
    s_add_u32 s87, s87, 131072
    v_bfe_u32 v19, v1, 2, 1
    v_lshl_add_u32 v19, v98, 2, v19
    v_lshl_add_u32 v19, v97, 5, v19
    v_lshl_add_u32 v22, v19, 6, v22
    v_add_u32 v22, s86, v22
    s_waitcnt vmcnt(6)
    s_barrier
    s_cmp_lg_u32 s14, 0
    s_cbranch_scc1 reg_22
    s_and_b32 s21, s2, 3
    s_lshl_b32 s21, s21, 3
    s_lshl_b32 s22, s98, 2
    s_add_u32 s21, s21, s22
    s_lshl_b32 s21, 1, s21
    s_andn2_b32 s22, s2, 3
    v_mov_b32 v20, s22
    v_mov_b32 v21, s21
    s_mov_b64 exec, 1
    global_atomic_add v20, v21, s[100:101] sc1
    s_mov_b64 exec, -1
reg_22:
    s_barrier
    s_add_u32 m0, s86, 4096
    s_nop 0
    buffer_load_dwordx4 v140, s[8:11], s87 offen lds
    s_add_u32 s87, s87, 131072
    s_add_u32 m0, s86, 5120
    s_nop 0
    buffer_load_dwordx4 v140, s[8:11], s87 offen lds
    s_add_u32 s87, s87, 131072
    s_add_u32 m0, s86, 6144
    s_nop 0
    buffer_load_dwordx4 v140, s[8:11], s87 offen lds
    s_add_u32 s87, s87, 131072
    s_add_u32 m0, s86, 7168
    s_nop 0
    buffer_load_dwordx4 v140, s[8:11], s87 offen lds
    s_add_u32 s87, s87, 131072
    s_add_u32 m0, s86, 8192
    s_nop 0
    buffer_load_dwordx4 v140, s[8:11], s87 offen lds
    s_add_u32 s87, s87, 131072
    s_add_u32 m0, s86, 9216
    s_nop 0
    buffer_load_dwordx4 v140, s[8:11], s87 offen lds
    s_add_u32 s87, s87, 131072
    s_add_u32 m0, s86, 10240
    s_nop 0
    buffer_load_dwordx4 v140, s[8:11], s87 offen lds
    s_add_u32 s87, s87, 131072
    s_add_u32 m0, s86, 11264
    s_nop 0
    buffer_load_dwordx4 v140, s[8:11], s87 offen lds
    s_add_u32 s87, s87, 131072
    s_add_u32 m0, s86, 12288
    s_nop 0
    buffer_load_dwordx4 v140, s[8:11], s87 offen lds
    s_add_u32 s87, s87, 131072
    s_add_u32 m0, s86, 13312
    s_nop 0
    buffer_load_dwordx4 v140, s[8:11], s87 offen lds
    s_add_u32 s87, s87, 131072
    s_add_u32 m0, s86, 14336
    s_nop 0
    buffer_load_dwordx4 v140, s[8:11], s87 offen lds
    s_add_u32 s87, s87, 131072
    s_add_u32 m0, s86, 15360
    s_nop 0
    buffer_load_dwordx4 v140, s[8:11], s87 offen lds
    s_add_u32 s87, s87, 131072
    s_mov_b32 s8, s34
    s_mov_b32 s9, s35
    s_lshl_b32 s87, s14, 21
    s_lshl_b32 s22, s27, 1
    s_add_u32 s87, s87, s22
    s_add_u32 m0, s86, 16384
    s_nop 0
    buffer_load_dwordx4 v140, s[8:11], s87 offen lds
    s_add_u32 s87, s87, 131072
    s_add_u32 m0, s86, 17408
    s_nop 0
    buffer_load_dwordx4 v140, s[8:11], s87 offen lds
    s_add_u32 s87, s87, 131072
    s_add_u32 m0, s86, 18432
    s_nop 0
    buffer_load_dwordx4 v140, s[8:11], s87 offen lds
    s_add_u32 s87, s87, 131072
    s_add_u32 m0, s86, 19456
    s_nop 0
    buffer_load_dwordx4 v140, s[8:11], s87 offen lds
    s_add_u32 s87, s87, 131072
    s_add_u32 m0, s86, 20480
    s_nop 0
    buffer_load_dwordx4 v140, s[8:11], s87 offen lds
    s_add_u32 s87, s87, 131072
    s_add_u32 m0, s86, 21504
    s_nop 0
    buffer_load_dwordx4 v140, s[8:11], s87 offen lds
    s_add_u32 s87, s87, 131072
    s_add_u32 m0, s86, 22528
    s_nop 0
    buffer_load_dwordx4 v140, s[8:11], s87 offen lds
    s_add_u32 s87, s87, 131072
    s_add_u32 m0, s86, 23552
    s_nop 0
    buffer_load_dwordx4 v140, s[8:11], s87 offen lds
    s_add_u32 s87, s87, 131072
    s_add_u32 m0, s86, 24576
    s_nop 0
    buffer_load_dwordx4 v140, s[8:11], s87 offen lds
    s_add_u32 s87, s87, 131072
    s_add_u32 m0, s86, 25600
    s_nop 0
    buffer_load_dwordx4 v140, s[8:11], s87 offen lds
    s_add_u32 s87, s87, 131072
    s_add_u32 m0, s86, 26624
    s_nop 0
    buffer_load_dwordx4 v140, s[8:11], s87 offen lds
    s_add_u32 s87, s87, 131072
    s_add_u32 m0, s86, 27648
    s_nop 0
    buffer_load_dwordx4 v140, s[8:11], s87 offen lds
    s_add_u32 s87, s87, 131072
    s_add_u32 m0, s86, 28672
    s_nop 0
    buffer_load_dwordx4 v140, s[8:11], s87 offen lds
    s_add_u32 s87, s87, 131072
    s_add_u32 m0, s86, 29696
    s_nop 0
    buffer_load_dwordx4 v140, s[8:11], s87 offen lds
    s_add_u32 s87, s87, 131072
    s_add_u32 m0, s86, 30720
    s_nop 0
    buffer_load_dwordx4 v140, s[8:11], s87 offen lds
    s_add_u32 s87, s87, 131072
    s_add_u32 m0, s86, 31744
    s_nop 0
    buffer_load_dwordx4 v140, s[8:11], s87 offen lds
    s_add_u32 s87, s87, 131072
    s_mov_b32 s8, s30
    s_mov_b32 s9, s31
    s_lshl_b32 s87, s14, 21
    s_lshl_b32 s22, s27, 1
    s_add_u32 s87, s87, s22
    s_add_u32 m0, s86, 32768
    s_nop 0
    buffer_load_dwordx4 v140, s[8:11], s87 offen lds
    s_add_u32 s87, s87, 131072
    s_add_u32 m0, s86, 33792
    s_nop 0
    buffer_load_dwordx4 v140, s[8:11], s87 offen lds
    s_add_u32 s87, s87, 131072
    s_add_u32 m0, s86, 34816
    s_nop 0
    buffer_load_dwordx4 v140, s[8:11], s87 offen lds
    s_add_u32 s87, s87, 131072
    s_add_u32 m0, s86, 35840
    s_nop 0
    buffer_load_dwordx4 v140, s[8:11], s87 offen lds
    s_add_u32 s87, s87, 131072
    s_lshr_b32 s21, s13, 3
    s_cmp_eq_u32 s21, 1
    s_cselect_b64 s[88:89], s[32:33], s[30:31]
    s_cmp_eq_u32 s21, 2
    s_cselect_b64 s[88:89], s[34:35], s[88:89]
    s_cmp_eq_u32 s21, 3
    s_cselect_b64 s[88:89], s[36:37], s[88:89]
    s_mov_b32 s90, 8388608
    s_mov_b32 s91, 0x20000
    s_cselect_b32 s21, 11, 13
    s_cselect_b32 s92, 21, 11
    s_lshl_b32 s92, s12, s92
    s_and_b32 s22, s13, 3
    s_lshl_b32 s22, s22, 8
    v_add_u32 v142, s22, v0
    v_lshlrev_b32 v142, s21, v142
    s_and_b32 s22, s13, 4
    s_lshl_b32 s22, s22, 8
    s_add_u32 s92, s92, s22
    s_lshr_b32 s22, s13, 3
    s_lshl2_add_u32 s22, s12, s22
    s_bitcmp1_b32 39321, s22
    s_cselect_b32 s21, s92, 1073741824
    s_cmp_ge_u32 s14, 2
    s_cselect_b32 s21, s21, 1073741824
    buffer_load_dword v143, v142, s[88:91], s21 offen offset:384
    s_cmp_eq_u32 s92, 7168
    s_cselect_b32 s92, s92, 1073741824
    s_bitcmp1_b32 39321, s22
    s_cselect_b32 s21, s92, 1073741824
    s_cmp_ge_u32 s14, 2
    s_cselect_b32 s21, s21, 1073741824
    buffer_load_dword v143, v142, s[88:91], s21 offen offset:896
    s_add_u32 m0, s86, 36864
    s_nop 0
    buffer_load_dwordx4 v140, s[8:11], s87 offen lds
    s_add_u32 s87, s87, 131072
    s_add_u32 m0, s86, 37888
    s_nop 0
    buffer_load_dwordx4 v140, s[8:11], s87 offen lds
    s_add_u32 s87, s87, 131072
    s_add_u32 m0, s86, 38912
    s_nop 0
    buffer_load_dwordx4 v140, s[8:11], s87 offen lds
    s_add_u32 s87, s87, 131072
    s_add_u32 m0, s86, 39936
    s_nop 0
    buffer_load_dwordx4 v140, s[8:11], s87 offen lds
    s_add_u32 s87, s87, 131072
    s_waitcnt vmcnt(38)
    ds_read_b64_tr_b16 a[64:65], v22 offset:0
    ds_read_b64_tr_b16 a[66:67], v22 offset:128
    ds_read_b64_tr_b16 a[68:69], v22 offset:1024
    ds_read_b64_tr_b16 a[70:71], v22 offset:1152
    s_waitcnt lgkmcnt(4)
    ds_read_b64_tr_b16 a[96:97], v22 offset:8
    ds_read_b64_tr_b16 a[98:99], v22 offset:136
    ds_read_b64_tr_b16 a[100:101], v22 offset:1032
    ds_read_b64_tr_b16 a[102:103], v22 offset:1160
    s_waitcnt vmcnt(34)
    ds_read_b64_tr_b16 a[72:73], v22 offset:4096
    ds_read_b64_tr_b16 a[74:75], v22 offset:4224
    ds_read_b64_tr_b16 a[76:77], v22 offset:5120
    ds_read_b64_tr_b16 a[78:79], v22 offset:5248
    s_waitcnt lgkmcnt(4)
    ds_read_b64_tr_b16 a[104:105], v22 offset:4104
    ds_read_b64_tr_b16 a[106:107], v22 offset:4232
    ds_read_b64_tr_b16 a[108:109], v22 offset:5128
    ds_read_b64_tr_b16 a[110:111], v22 offset:5256
    s_add_u32 m0, s86, 0
    s_nop 0
    buffer_load_dwordx4 v140, s[8:11], s87 offen lds
    s_add_u32 s87, s87, 131072
    s_add_u32 m0, s86, 1024
    s_nop 0
    buffer_load_dwordx4 v140, s[8:11], s87 offen lds
    s_add_u32 s87, s87, 131072
    s_add_u32 m0, s86, 2048
    s_nop 0
    buffer_load_dwordx4 v140, s[8:11], s87 offen lds
    s_add_u32 s87, s87, 131072
    s_add_u32 m0, s86, 3072
    s_nop 0
    buffer_load_dwordx4 v140, s[8:11], s87 offen lds
    s_add_u32 s87, s87, 131072
    s_waitcnt vmcnt(34)
    ds_read_b64_tr_b16 a[80:81], v22 offset:8192
    ds_read_b64_tr_b16 a[82:83], v22 offset:8320
    ds_read_b64_tr_b16 a[84:85], v22 offset:9216
    ds_read_b64_tr_b16 a[86:87], v22 offset:9344
    s_waitcnt lgkmcnt(4)
    ds_read_b64_tr_b16 a[112:113], v22 offset:8200
    ds_read_b64_tr_b16 a[114:115], v22 offset:8328
    ds_read_b64_tr_b16 a[116:117], v22 offset:9224
    ds_read_b64_tr_b16 a[118:119], v22 offset:9352
    s_add_u32 m0, s86, 4096
    s_nop 0
    buffer_load_dwordx4 v140, s[8:11], s87 offen lds
    s_add_u32 s87, s87, 131072
    s_add_u32 m0, s86, 5120
    s_nop 0
    buffer_load_dwordx4 v140, s[8:11], s87 offen lds
    s_add_u32 s87, s87, 131072
    s_add_u32 m0, s86, 6144
    s_nop 0
    buffer_load_dwordx4 v140, s[8:11], s87 offen lds
    s_add_u32 s87, s87, 131072
    s_add_u32 m0, s86, 7168
    s_nop 0
    buffer_load_dwordx4 v140, s[8:11], s87 offen lds
    s_add_u32 s87, s87, 131072
    s_waitcnt vmcnt(34)
    ds_read_b64_tr_b16 a[88:89], v22 offset:12288
    ds_read_b64_tr_b16 a[90:91], v22 offset:12416
    ds_read_b64_tr_b16 a[92:93], v22 offset:13312
    ds_read_b64_tr_b16 a[94:95], v22 offset:13440
    s_waitcnt lgkmcnt(4)
    ds_read_b64_tr_b16 a[120:121], v22 offset:12296
    ds_read_b64_tr_b16 a[122:123], v22 offset:12424
    ds_read_b64_tr_b16 a[124:125], v22 offset:13320
    ds_read_b64_tr_b16 a[126:127], v22 offset:13448
    s_mov_b32 s8, s36
    s_mov_b32 s9, s37
    s_lshl_b32 s87, s12, 21
    s_lshl_b32 s22, s14, 19
    s_add_u32 s87, s87, s22
    s_lshl_b32 s22, s13, 6
    s_add_u32 s87, s87, s22
    s_add_u32 m0, s86, 8192
    s_nop 0
    buffer_load_dwordx4 v141, s[8:11], s87 offen lds
    s_add_u32 s87, s87, 32768
    s_add_u32 m0, s86, 9216
    s_nop 0
    buffer_load_dwordx4 v141, s[8:11], s87 offen lds
    s_add_u32 s87, s87, 32768
    s_add_u32 m0, s86, 10240
    s_nop 0
    buffer_load_dwordx4 v141, s[8:11], s87 offen lds
    s_add_u32 s87, s87, 32768
    s_add_u32 m0, s86, 11264
    s_nop 0
    buffer_load_dwordx4 v141, s[8:11], s87 offen lds
    s_add_u32 s87, s87, 32768
    s_mov_b32 s88, s28
    s_mov_b32 s89, s29
    s_mov_b32 s90, 16384
    s_mov_b32 s91, 0x20000
    v_lshlrev_b32 v20, 11, v96
    v_lshl_add_u32 v20, v98, 4, v20
    v_lshl_add_u32 v20, v97, 3, v20
    s_lshl_b32 s21, s13, 6
    buffer_load_dwordx2 v[88:89], v20, s[88:91], s21 offen
    v_lshlrev_b32 v90, 2, v1
    global_load_dword v91, v90, s[100:101] sc1
    s_waitcnt vmcnt(36)
    ds_read_b64_tr_b16 a[128:129], v22 offset:16384
    ds_read_b64_tr_b16 a[130:131], v22 offset:16512
    ds_read_b64_tr_b16 a[132:133], v22 offset:17408
    ds_read_b64_tr_b16 a[134:135], v22 offset:17536
    s_waitcnt lgkmcnt(4)
    ds_read_b64_tr_b16 a[160:161], v22 offset:16392
    ds_read_b64_tr_b16 a[162:163], v22 offset:16520
    ds_read_b64_tr_b16 a[164:165], v22 offset:17416
    ds_read_b64_tr_b16 a[166:167], v22 offset:17544
    s_add_u32 m0, s86, 12288
    s_nop 0
    buffer_load_dwordx4 v141, s[8:11], s87 offen lds
    s_add_u32 s87, s87, 32768
    s_add_u32 m0, s86, 13312
    s_nop 0
    buffer_load_dwordx4 v141, s[8:11], s87 offen lds
    s_add_u32 s87, s87, 32768
    s_add_u32 m0, s86, 14336
    s_nop 0
    buffer_load_dwordx4 v141, s[8:11], s87 offen lds
    s_add_u32 s87, s87, 32768
    s_add_u32 m0, s86, 15360
    s_nop 0
    buffer_load_dwordx4 v141, s[8:11], s87 offen lds
    s_add_u32 s87, s87, 32768
    s_waitcnt vmcnt(36)
    ds_read_b64_tr_b16 a[136:137], v22 offset:20480
    ds_read_b64_tr_b16 a[138:139], v22 offset:20608
    ds_read_b64_tr_b16 a[140:141], v22 offset:21504
    ds_read_b64_tr_b16 a[142:143], v22 offset:21632
    s_waitcnt lgkmcnt(4)
    ds_read_b64_tr_b16 a[168:169], v22 offset:20488
    ds_read_b64_tr_b16 a[170:171], v22 offset:20616
    ds_read_b64_tr_b16 a[172:173], v22 offset:21512
    ds_read_b64_tr_b16 a[174:175], v22 offset:21640
    s_add_u32 m0, s86, 16384
    s_nop 0
    buffer_load_dwordx4 v141, s[8:11], s87 offen lds
    s_add_u32 s87, s87, 32768
    s_add_u32 m0, s86, 17408
    s_nop 0
    buffer_load_dwordx4 v141, s[8:11], s87 offen lds
    s_add_u32 s87, s87, 32768
    s_add_u32 m0, s86, 18432
    s_nop 0
    buffer_load_dwordx4 v141, s[8:11], s87 offen lds
    s_add_u32 s87, s87, 32768
    s_add_u32 m0, s86, 19456
    s_nop 0
    buffer_load_dwordx4 v141, s[8:11], s87 offen lds
    s_add_u32 s87, s87, 32768
    s_waitcnt vmcnt(36)
    ds_read_b64_tr_b16 a[144:145], v22 offset:24576
    ds_read_b64_tr_b16 a[146:147], v22 offset:24704
    ds_read_b64_tr_b16 a[148:149], v22 offset:25600
    ds_read_b64_tr_b16 a[150:151], v22 offset:25728
    s_waitcnt lgkmcnt(4)
    ds_read_b64_tr_b16 a[176:177], v22 offset:24584
    ds_read_b64_tr_b16 a[178:179], v22 offset:24712
    ds_read_b64_tr_b16 a[180:181], v22 offset:25608
    ds_read_b64_tr_b16 a[182:183], v22 offset:25736
    s_add_u32 m0, s86, 20480
    s_nop 0
    buffer_load_dwordx4 v141, s[8:11], s87 offen lds
    s_add_u32 s87, s87, 32768
    s_add_u32 m0, s86, 21504
    s_nop 0
    buffer_load_dwordx4 v141, s[8:11], s87 offen lds
    s_add_u32 s87, s87, 32768
    s_add_u32 m0, s86, 22528
    s_nop 0
    buffer_load_dwordx4 v141, s[8:11], s87 offen lds
    s_add_u32 s87, s87, 32768
    s_add_u32 m0, s86, 23552
    s_nop 0
    buffer_load_dwordx4 v141, s[8:11], s87 offen lds
    s_add_u32 s87, s87, 32768
    s_waitcnt vmcnt(36)
    ds_read_b64_tr_b16 a[152:153], v22 offset:28672
    ds_read_b64_tr_b16 a[154:155], v22 offset:28800
    ds_read_b64_tr_b16 a[156:157], v22 offset:29696
    ds_read_b64_tr_b16 a[158:159], v22 offset:29824
    s_waitcnt lgkmcnt(4)
    ds_read_b64_tr_b16 a[184:185], v22 offset:28680
    ds_read_b64_tr_b16 a[186:187], v22 offset:28808
    ds_read_b64_tr_b16 a[188:189], v22 offset:29704
    ds_read_b64_tr_b16 a[190:191], v22 offset:29832
    s_waitcnt vmcnt(32)
    ds_read_b64_tr_b16 a[0:1], v22 offset:32768
    ds_read_b64_tr_b16 a[2:3], v22 offset:32896
    ds_read_b64_tr_b16 a[4:5], v22 offset:33792
    ds_read_b64_tr_b16 a[6:7], v22 offset:33920
    s_waitcnt lgkmcnt(4)
    ds_read_b64_tr_b16 a[32:33], v22 offset:32776
    ds_read_b64_tr_b16 a[34:35], v22 offset:32904
    ds_read_b64_tr_b16 a[36:37], v22 offset:33800
    ds_read_b64_tr_b16 a[38:39], v22 offset:33928
    s_waitcnt vmcnt(26)
    ds_read_b64_tr_b16 a[8:9], v22 offset:36864
    ds_read_b64_tr_b16 a[10:11], v22 offset:36992
    ds_read_b64_tr_b16 a[12:13], v22 offset:37888
    ds_read_b64_tr_b16 a[14:15], v22 offset:38016
    s_waitcnt lgkmcnt(4)
    ds_read_b64_tr_b16 a[40:41], v22 offset:36872
    ds_read_b64_tr_b16 a[42:43], v22 offset:37000
    ds_read_b64_tr_b16 a[44:45], v22 offset:37896
    ds_read_b64_tr_b16 a[46:47], v22 offset:38024
    s_waitcnt vmcnt(22)
    ds_read_b64_tr_b16 a[16:17], v22 offset:0
    ds_read_b64_tr_b16 a[18:19], v22 offset:128
    ds_read_b64_tr_b16 a[20:21], v22 offset:1024
    ds_read_b64_tr_b16 a[22:23], v22 offset:1152
    s_waitcnt lgkmcnt(4)
    ds_read_b64_tr_b16 a[48:49], v22 offset:8
    ds_read_b64_tr_b16 a[50:51], v22 offset:136
    ds_read_b64_tr_b16 a[52:53], v22 offset:1032
    ds_read_b64_tr_b16 a[54:55], v22 offset:1160
    s_waitcnt vmcnt(18)
    ds_read_b64_tr_b16 a[24:25], v22 offset:4096
    ds_read_b64_tr_b16 a[26:27], v22 offset:4224
    ds_read_b64_tr_b16 a[28:29], v22 offset:5120
    ds_read_b64_tr_b16 a[30:31], v22 offset:5248
    s_waitcnt lgkmcnt(4)
    ds_read_b64_tr_b16 a[56:57], v22 offset:4104
    ds_read_b64_tr_b16 a[58:59], v22 offset:4232
    ds_read_b64_tr_b16 a[60:61], v22 offset:5128
    ds_read_b64_tr_b16 a[62:63], v22 offset:5256
    s_waitcnt vmcnt(14)
    ds_read_b64_tr_b16 a[192:193], v22 offset:8192
    ds_read_b64_tr_b16 a[194:195], v22 offset:8320
    ds_read_b64_tr_b16 a[196:197], v22 offset:9216
    ds_read_b64_tr_b16 a[198:199], v22 offset:9344
    s_waitcnt lgkmcnt(4)
    ds_read_b64_tr_b16 a[224:225], v22 offset:8200
    ds_read_b64_tr_b16 a[226:227], v22 offset:8328
    ds_read_b64_tr_b16 a[228:229], v22 offset:9224
    ds_read_b64_tr_b16 a[230:231], v22 offset:9352
    s_waitcnt vmcnt(8)
    ds_read_b64_tr_b16 a[200:201], v22 offset:12288
    ds_read_b64_tr_b16 a[202:203], v22 offset:12416
    ds_read_b64_tr_b16 a[204:205], v22 offset:13312
    ds_read_b64_tr_b16 a[206:207], v22 offset:13440
    s_waitcnt lgkmcnt(4)
    ds_read_b64_tr_b16 a[232:233], v22 offset:12296
    ds_read_b64_tr_b16 a[234:235], v22 offset:12424
    ds_read_b64_tr_b16 a[236:237], v22 offset:13320
    ds_read_b64_tr_b16 a[238:239], v22 offset:13448
    v_lshlrev_b32 v90, 2, v1
    s_mov_b32 s22, 0
    s_branch rdv_23p
rdv_23:
    global_load_dword v91, v90, s[100:101] sc1
    s_waitcnt vmcnt(0)
rdv_23p:
    s_lshl_b32 s21, s98, 2
    v_lshrrev_b32 v92, s21, v91
    s_cmp_eq_u32 s98, 0
    s_cselect_b32 s21, 0x0f0f0f0f, s21
    s_cselect_b32 s21, s21, 0x01010101
    v_and_b32 v92, s21, v92
    v_cmp_ne_u32 vcc, 0x01010101, v92
    s_nop 0
    s_cbranch_vccz rdvok_24
    v_sad_u8 v92, v92, 0, 0
    s_nop 1
    v_add_u32_dpp v92, v92, v92 quad_perm:[1,0,3,2] row_mask:0xf bank_mask:0xf
    v_cmp_ne_u32 vcc, 8, v92
    s_nop 0
    s_cbranch_vccnz rdvw_25
    s_mov_b32 s98, 1
    s_and_b32 s3, s97, 7
    s_waitcnt vmcnt(0) lgkmcnt(0)
    s_barrier
    s_branch role_start
rdvw_25:
    s_sleep 4
    s_add_u32 s22, s22, 1
    s_cmp_lt_u32 s22, 262144
    s_cbranch_scc1 rdv_23
    s_mov_b32 s25, 200000
rdvok_24:
    v_and_b32 v92, 0x40404040, v91
    v_bcnt_u32_b32 v92, v92, 0
    s_mov_b32 s46, 0
    v_cmp_le_u32 vcc, 1, v92
    s_nop 0
    s_bcnt1_i32_b64 s21, vcc
    s_add_u32 s46, s46, s21
    v_cmp_le_u32 vcc, 2, v92
    s_nop 0
    s_bcnt1_i32_b64 s21, vcc
    s_add_u32 s46, s46, s21
    v_cmp_le_u32 vcc, 3, v92
    s_nop 0
    s_bcnt1_i32_b64 s21, vcc
    s_add_u32 s46, s46, s21
    v_cmp_le_u32 vcc, 4, v92
    s_nop 0
    s_bcnt1_i32_b64 s21, vcc
    s_add_u32 s46, s46, s21
    s_cmp_gt_u32 s46, 16
    s_cselect_b32 s46, 8192, 0
    s_add_u32 s84, s95, s46
    s_xor_b32 s45, s98, 1
    v_min_u32 v88, -2, v88
    v_min_u32 v89, -2, v89
    buffer_store_dwordx2 v[88:89], v11, s[4:7], s16 offen sc1
    s_waitcnt vmcnt(5)
    ds_read_b64_tr_b16 a[208:209], v22 offset:16384
    ds_read_b64_tr_b16 a[210:211], v22 offset:16512
    ds_read_b64_tr_b16 a[212:213], v22 offset:17408
    ds_read_b64_tr_b16 a[214:215], v22 offset:17536
    s_waitcnt lgkmcnt(4)
    ds_read_b64_tr_b16 a[240:241], v22 offset:16392
    ds_read_b64_tr_b16 a[242:243], v22 offset:16520
    ds_read_b64_tr_b16 a[244:245], v22 offset:17416
    ds_read_b64_tr_b16 a[246:247], v22 offset:17544
    s_mul_i32 s22, s14, 294912
    s_add_u32 s22, s22, 81788928
    buffer_load_dword v145, v3, s[4:7], s22 offen offset:0 sc1
    buffer_load_dword v146, v3, s[4:7], s22 offen offset:128 sc1
    buffer_load_dword v147, v4, s[4:7], s22 offen offset:0 sc1
    buffer_load_dword v148, v7, s[4:7], s22 offen offset:0 sc1
    buffer_load_dword v149, v11, s[4:7], s22 offen offset:0 sc1
    buffer_load_dword v247, v245, s[4:7], 0 offen sc1
    s_waitcnt vmcnt(7)
    ds_read_b64_tr_b16 a[216:217], v22 offset:20480
    ds_read_b64_tr_b16 a[218:219], v22 offset:20608
    ds_read_b64_tr_b16 a[220:221], v22 offset:21504
    ds_read_b64_tr_b16 a[222:223], v22 offset:21632
    s_waitcnt lgkmcnt(4)
    ds_read_b64_tr_b16 a[248:249], v22 offset:20488
    ds_read_b64_tr_b16 a[250:251], v22 offset:20616
    ds_read_b64_tr_b16 a[252:253], v22 offset:21512
    ds_read_b64_tr_b16 a[254:255], v22 offset:21640
    s_waitcnt lgkmcnt(0)
    v_mov_b32 v155, 0
    v_mov_b32 v159, 0
    v_mov_b32 v163, 0
    v_mov_b32 v167, 0
    v_mov_b32 v179, 0
    s_waitcnt vmcnt(0)
    v_readfirstlane_b32 s85, v247
    v_mov_b32 v40, 0
    v_mov_b32 v41, 0
    v_mov_b32 v42, 0
    v_mov_b32 v43, 0
    v_mov_b32 v44, 0
    v_mov_b32 v45, 0
    v_mov_b32 v46, 0
    v_mov_b32 v47, 0
    v_mov_b32 v48, 0
    v_mov_b32 v49, 0
    v_mov_b32 v50, 0
    v_mov_b32 v51, 0
    v_mov_b32 v52, 0
    v_mov_b32 v53, 0
    v_mov_b32 v54, 0
    v_mov_b32 v55, 0
    v_mov_b32 v56, 0
    v_mov_b32 v57, 0
    v_mov_b32 v58, 0
    v_mov_b32 v59, 0
    v_mov_b32 v60, 0
    v_mov_b32 v61, 0
    v_mov_b32 v62, 0
    v_mov_b32 v63, 0
    v_mov_b32 v64, 0
    v_mov_b32 v65, 0
    v_mov_b32 v66, 0
    v_mov_b32 v67, 0
    v_mov_b32 v68, 0
    v_mov_b32 v69, 0
    v_mov_b32 v70, 0
    v_mov_b32 v71, 0
    s_cmp_ge_u32 s14, 2
    s_cbranch_scc1 kv_26
    s_mov_b32 s94, 1
    s_mov_b32 s23, s25
fw_28:
    s_cmp_ge_u32 s85, s94
    s_cbranch_scc1 fo_29
    buffer_load_dword v247, v245, s[4:7], 0 offen sc1
    s_add_u32 s23, s23, 1
    s_waitcnt vmcnt(0)
    v_readfirstlane_b32 s85, v247
    s_cmp_lt_u32 s23, 200000
    s_cbranch_scc1 fw_28
    s_mov_b32 s25, 200000
fo_29:
    s_cmp_eq_u32 s14, 1
    s_cbranch_scc1 kv_27
    buffer_load_dwordx4 v[132:135], v12, s[4:7], s17 offen sc1
    buffer_load_dwordx4 v[136:139], v12, s[4:7], s17 offen offset:128 sc1
    s_add_u32 s17, s17, 2048
    s_min_u32 s17, s17, 17954816
    s_branch kv_26
kv_27:
    buffer_load_dwordx4 v[228:231], v13, s[4:7], s18 offen offset:0 sc1
    buffer_load_dwordx4 v[232:235], v13, s[4:7], s18 offen offset:128 sc1
    s_add_u32 s18, s18, 2048
    s_min_u32 s18, s18, 35780608
kv_26:
    s_mul_i32 s86, s27, 4160
    s_add_u32 s86, s86, 17825792
    s_mov_b32 s23, s25
    s_barrier
    s_cmp_eq_u32 s45, 0
    s_cbranch_scc1 recur_slow_disp
    s_cmp_eq_u32 s14, 1
    s_cbranch_scc1 recur_fast_w1
    s_cmp_eq_u32 s14, 2
    s_cbranch_scc1 recur_fast_w2
    s_cmp_eq_u32 s14, 3
    s_cbranch_scc1 recur_fast_w3
    s_branch recur_fast_w0
recur_slow_disp:
    s_cmp_eq_u32 s14, 1
    s_cbranch_scc1 recur_slow_w1
    s_cmp_eq_u32 s14, 2
    s_cbranch_scc1 recur_slow_w2
    s_cmp_eq_u32 s14, 3
    s_cbranch_scc1 recur_slow_w3
    s_branch recur_slow_w0
.p2align 6
recur_fast_w0:
    s_nop 15
    s_mov_b32 s23, s25
    buffer_load_dwordx4 v[24:27], v2, s[4:7], s16 offen offset:0 sc1
    s_nop 11
    buffer_load_dwordx4 v[28:31], v2, s[4:7], s16 offen offset:1024 sc1
    s_nop 11
    buffer_load_dwordx4 v[32:35], v2, s[4:7], s16 offen offset:2048 sc1
    s_nop 11
    buffer_load_dwordx4 v[36:39], v2, s[4:7], s16 offen offset:3072 sc1
    s_waitcnt vmcnt(3)
    v_max3_u32 v19, v24, v25, v26
    v_max_u32 v19, v19, v27
    v_cmp_eq_u32 vcc, -1, v19
    s_nop 0
    s_cbranch_vccnz g_30F15_0
    v_smfmac_f32_16x16x64_bf16 v[40:43], v[24:27], a[0:7], v172
    s_waitcnt vmcnt(2)
    v_max3_u32 v19, v28, v29, v30
    v_max_u32 v19, v19, v31
    v_smfmac_f32_16x16x64_bf16 v[44:47], v[24:27], a[64:71], v172
    v_cmp_eq_u32 vcc, -1, v19
    v_smfmac_f32_16x16x64_bf16 v[48:51], v[24:27], a[32:39], v172
    v_smfmac_f32_16x16x64_bf16 v[52:55], v[24:27], a[96:103], v172
    s_cbranch_vccnz g_30F14_1
    v_smfmac_f32_16x16x64_bf16 v[40:43], v[28:31], a[8:15], v172
    s_waitcnt vmcnt(1)
    v_max3_u32 v19, v32, v33, v34
    v_max_u32 v19, v19, v35
    v_smfmac_f32_16x16x64_bf16 v[44:47], v[28:31], a[72:79], v172
    v_cmp_eq_u32 vcc, -1, v19
    v_smfmac_f32_16x16x64_bf16 v[48:51], v[28:31], a[40:47], v172
    v_smfmac_f32_16x16x64_bf16 v[52:55], v[28:31], a[104:111], v172
    s_cbranch_vccnz g_30F12_2
    v_smfmac_f32_16x16x64_bf16 v[40:43], v[32:35], a[16:23], v172
    s_waitcnt vmcnt(0)
    v_max3_u32 v19, v36, v37, v38
    v_max_u32 v19, v19, v39
    v_smfmac_f32_16x16x64_bf16 v[44:47], v[32:35], a[80:87], v172
    v_cmp_eq_u32 vcc, -1, v19
    v_smfmac_f32_16x16x64_bf16 v[48:51], v[32:35], a[48:55], v172
    v_smfmac_f32_16x16x64_bf16 v[52:55], v[32:35], a[112:119], v172
    s_cbranch_vccnz g_30F8_3
    v_smfmac_f32_16x16x64_bf16 v[40:43], v[36:39], a[24:31], v172
    v_smfmac_f32_16x16x64_bf16 v[44:47], v[36:39], a[88:95], v172
    v_smfmac_f32_16x16x64_bf16 v[48:51], v[36:39], a[56:63], v172
    v_smfmac_f32_16x16x64_bf16 v[52:55], v[36:39], a[120:127], v172
gc_31:
    v_cvt_pk_bf16_f32 v72, v40, v41
    v_cvt_pk_bf16_f32 v73, v42, v43
    v_cvt_pk_bf16_f32 v74, v44, v45
    v_cvt_pk_bf16_f32 v75, v46, v47
    v_smfmac_f32_16x16x64_bf16 v[56:59], v[24:27], a[128:135], v172
    v_cvt_pk_bf16_f32 v76, v48, v49
    v_cvt_pk_bf16_f32 v77, v50, v51
    s_nop 0
    v_cvt_pk_bf16_f32 v78, v52, v53
    v_cvt_pk_bf16_f32 v79, v54, v55
    v_smfmac_f32_16x16x64_bf16 v[60:63], v[24:27], a[160:167], v172
    v_mfma_f32_16x16x32_bf16 v[88:91], v[72:75], v[84:87], 0
    v_mfma_f32_16x16x32_bf16 v[92:95], v[76:79], v[84:87], 0
    v_smfmac_f32_16x16x64_bf16 v[56:59], v[28:31], a[136:143], v172
    v_smfmac_f32_16x16x64_bf16 v[60:63], v[28:31], a[168:175], v172
    s_barrier
    ds_read_b128 v[104:107], v16 offset:2048
    ds_read_b128 v[108:111], v16 offset:3072
    ds_read_b128 v[112:115], v16 offset:4096
    ds_read_b128 v[116:119], v16 offset:5120
    ds_read_b128 v[120:123], v16 offset:6144
    ds_read_b128 v[124:127], v16 offset:7168
    v_smfmac_f32_16x16x64_bf16 v[56:59], v[32:35], a[144:151], v172
    v_smfmac_f32_16x16x64_bf16 v[60:63], v[32:35], a[176:183], v172
    v_smfmac_f32_16x16x64_bf16 v[56:59], v[36:39], a[152:159], v172
    v_smfmac_f32_16x16x64_bf16 v[60:63], v[36:39], a[184:191], v172
    s_waitcnt lgkmcnt(5)
    v_mfma_f32_16x16x32_bf16 v[88:91], v[104:107], v[84:87], v[88:91]
    s_waitcnt lgkmcnt(4)
    v_mfma_f32_16x16x32_bf16 v[92:95], v[108:111], v[84:87], v[92:95]
    s_waitcnt lgkmcnt(3)
    v_mfma_f32_16x16x32_bf16 v[88:91], v[112:115], v[84:87], v[88:91]
    s_waitcnt lgkmcnt(2)
    v_mfma_f32_16x16x32_bf16 v[92:95], v[116:119], v[84:87], v[92:95]
    s_waitcnt lgkmcnt(1)
    v_mfma_f32_16x16x32_bf16 v[88:91], v[120:123], v[84:87], v[88:91]
    s_waitcnt lgkmcnt(0)
    v_mfma_f32_16x16x32_bf16 v[92:95], v[124:127], v[84:87], v[92:95]
    v_cvt_pk_bf16_f32 v80, v56, v57
    v_cvt_pk_bf16_f32 v81, v58, v59
    v_cvt_pk_bf16_f32 v82, v60, v61
    v_cvt_pk_bf16_f32 v83, v62, v63
    ds_write_b128 v17, v[80:83] offset:8192
    s_nop 0
    v_cvt_pk_bf16_f32 v128, v88, v89
    v_cvt_pk_bf16_f32 v129, v90, v91
    v_cvt_pk_bf16_f32 v130, v92, v93
    v_cvt_pk_bf16_f32 v131, v94, v95
    s_nop 1
    v_mfma_f32_16x16x32_bf16 v[144:147], v[132:135], v[128:131], 0
    v_mfma_f32_16x16x32_bf16 v[148:151], v[136:139], v[128:131], 0
    v_mfma_f32_16x16x32_bf16 v[140:143], v[128:131], v[128:131], 0
    s_nop 1
    buffer_store_dwordx4 v[144:147], v3, s[4:7], s16 offen
    s_nop 1
    buffer_store_dwordx4 v[148:151], v3, s[4:7], s16 offen offset:128
    s_nop 1
    buffer_store_dwordx4 v[140:143], v4, s[4:7], s16 offen
    s_cmp_eq_u32 s15, 63
    s_waitcnt lgkmcnt(0)
    s_barrier
    s_cbranch_scc1 recur_fast_last0
    v_readfirstlane_b32 s85, v247
    s_add_u32 s94, s15, 2
    s_barrier
    s_nop 15
    s_mov_b32 s23, s25
    buffer_load_dwordx4 v[24:27], v8, s[4:7], s16 offen offset:0 sc1
    s_nop 11
    buffer_load_dwordx4 v[28:31], v8, s[4:7], s16 offen offset:1024 sc1
    s_nop 11
    buffer_load_dwordx4 v[32:35], v8, s[4:7], s16 offen offset:2048 sc1
    s_nop 11
    buffer_load_dwordx4 v[36:39], v8, s[4:7], s16 offen offset:3072 sc1
    s_waitcnt vmcnt(3)
    v_max3_u32 v19, v24, v25, v26
    v_max_u32 v19, v19, v27
    v_cmp_eq_u32 vcc, -1, v19
    s_nop 0
    s_cbranch_vccnz g_32F15_0
    v_smfmac_f32_16x16x64_bf16 v[64:67], v[24:27], a[192:199], v172
    v_smfmac_f32_16x16x64_bf16 v[68:71], v[24:27], a[224:231], v172
    s_waitcnt vmcnt(2)
    v_max3_u32 v19, v28, v29, v30
    v_max_u32 v19, v19, v31
    v_cmp_eq_u32 vcc, -1, v19
    s_nop 0
    s_cbranch_vccnz g_32F14_1
    v_smfmac_f32_16x16x64_bf16 v[64:67], v[28:31], a[200:207], v172
    v_smfmac_f32_16x16x64_bf16 v[68:71], v[28:31], a[232:239], v172
    s_waitcnt vmcnt(1)
    v_max3_u32 v19, v32, v33, v34
    v_max_u32 v19, v19, v35
    v_cmp_eq_u32 vcc, -1, v19
    s_nop 0
    s_cbranch_vccnz g_32F12_2
    v_smfmac_f32_16x16x64_bf16 v[64:67], v[32:35], a[208:215], v172
    v_smfmac_f32_16x16x64_bf16 v[68:71], v[32:35], a[240:247], v172
    s_waitcnt vmcnt(0)
    v_max3_u32 v19, v36, v37, v38
    v_max_u32 v19, v19, v39
    v_cmp_eq_u32 vcc, -1, v19
    s_nop 0
    s_cbranch_vccnz g_32F8_3
    v_smfmac_f32_16x16x64_bf16 v[64:67], v[36:39], a[216:223], v172
    v_smfmac_f32_16x16x64_bf16 v[68:71], v[36:39], a[248:255], v172
    s_nop 4
    v_cvt_pk_bf16_f32 v80, v64, v65
    v_cvt_pk_bf16_f32 v81, v66, v67
    s_nop 0
    v_cvt_pk_bf16_f32 v82, v68, v69
    v_cvt_pk_bf16_f32 v83, v70, v71
    ds_write_b128 v17, v[80:83] offset:9216
gc_33:
    s_waitcnt lgkmcnt(0)
    s_barrier
    s_mov_b32 s23, s25
fw_34:
    s_cmp_ge_u32 s85, s94
    s_cbranch_scc1 fo_35
    buffer_load_dword v247, v245, s[4:7], 0 offen sc1
    s_add_u32 s23, s23, 1
    s_waitcnt vmcnt(0)
    v_readfirstlane_b32 s85, v247
    s_cmp_lt_u32 s23, 200000
    s_cbranch_scc1 fw_34
    s_mov_b32 s25, 200000
fo_35:
    buffer_load_dwordx4 v[132:135], v12, s[4:7], s17 offen sc1
    buffer_load_dwordx4 v[136:139], v12, s[4:7], s17 offen offset:128 sc1
    s_add_u32 s17, s17, 2048
    s_min_u32 s17, s17, 17954816
    s_nop 15
    s_nop 15
    s_nop 15
    s_nop 15
    buffer_store_dwordx4 v[128:131], v14, s[4:7], s19 offen sc1
    s_add_u32 s19, s19, 512
    s_add_u32 s21, s15, 3
    s_min_u32 s21, s21, 64
    s_cmp_lt_u32 s85, s21
    s_cselect_b64 exec, 1, 0
    buffer_load_dword v247, v245, s[4:7], 0 offen sc1
    s_mov_b64 exec, -1
    v_mov_b32 v40, 0
    v_mov_b32 v41, 0
    v_mov_b32 v42, 0
    v_mov_b32 v43, 0
    v_mov_b32 v44, 0
    v_mov_b32 v45, 0
    v_mov_b32 v46, 0
    v_mov_b32 v47, 0
    v_mov_b32 v48, 0
    v_mov_b32 v49, 0
    v_mov_b32 v50, 0
    v_mov_b32 v51, 0
    v_mov_b32 v52, 0
    v_mov_b32 v53, 0
    v_mov_b32 v54, 0
    v_mov_b32 v55, 0
    v_mov_b32 v56, 0
    v_mov_b32 v57, 0
    v_mov_b32 v58, 0
    v_mov_b32 v59, 0
    v_mov_b32 v60, 0
    v_mov_b32 v61, 0
    v_mov_b32 v62, 0
    v_mov_b32 v63, 0
    v_mov_b32 v64, 0
    v_mov_b32 v65, 0
    v_mov_b32 v66, 0
    v_mov_b32 v67, 0
    v_mov_b32 v68, 0
    v_mov_b32 v69, 0
    v_mov_b32 v70, 0
    v_mov_b32 v71, 0
    s_mov_b32 s21, s16
    s_mov_b32 s16, s42
    s_mov_b32 s42, s43
    s_mov_b32 s43, s44
    s_mov_b32 s44, s21
    s_add_u32 s95, s95, 524288
    s_lshr_b32 s84, s95, 8
    s_and_b32 s84, s84, 8192
    s_xor_b32 s84, s84, s46
    s_add_u32 s84, s84, s95
    s_add_u32 s15, s15, 1
    s_barrier
    s_branch recur_fast_w0
g_30L15_0:
    s_waitcnt vmcnt(3)
    v_max3_u32 v19, v24, v25, v26
    v_max_u32 v19, v19, v27
    v_cmp_eq_u32 vcc, -1, v19
    s_nop 0
    s_cbranch_vccnz g_30F15_0
    v_smfmac_f32_16x16x64_bf16 v[40:43], v[24:27], a[0:7], v172
    v_smfmac_f32_16x16x64_bf16 v[44:47], v[24:27], a[64:71], v172
    v_smfmac_f32_16x16x64_bf16 v[48:51], v[24:27], a[32:39], v172
    v_smfmac_f32_16x16x64_bf16 v[52:55], v[24:27], a[96:103], v172
g_30L14_1:
    s_waitcnt vmcnt(2)
    v_max3_u32 v19, v28, v29, v30
    v_max_u32 v19, v19, v31
    v_cmp_eq_u32 vcc, -1, v19
    s_nop 0
    s_cbranch_vccnz g_30F14_1
    v_smfmac_f32_16x16x64_bf16 v[40:43], v[28:31], a[8:15], v172
    v_smfmac_f32_16x16x64_bf16 v[44:47], v[28:31], a[72:79], v172
    v_smfmac_f32_16x16x64_bf16 v[48:51], v[28:31], a[40:47], v172
    v_smfmac_f32_16x16x64_bf16 v[52:55], v[28:31], a[104:111], v172
g_30L12_2:
    s_waitcnt vmcnt(1)
    v_max3_u32 v19, v32, v33, v34
    v_max_u32 v19, v19, v35
    v_cmp_eq_u32 vcc, -1, v19
    s_nop 0
    s_cbranch_vccnz g_30F12_2
    v_smfmac_f32_16x16x64_bf16 v[40:43], v[32:35], a[16:23], v172
    v_smfmac_f32_16x16x64_bf16 v[44:47], v[32:35], a[80:87], v172
    v_smfmac_f32_16x16x64_bf16 v[48:51], v[32:35], a[48:55], v172
    v_smfmac_f32_16x16x64_bf16 v[52:55], v[32:35], a[112:119], v172
g_30L8_3:
    s_waitcnt vmcnt(0)
    v_max3_u32 v19, v36, v37, v38
    v_max_u32 v19, v19, v39
    v_cmp_eq_u32 vcc, -1, v19
    s_nop 0
    s_cbranch_vccnz g_30F8_3
    v_smfmac_f32_16x16x64_bf16 v[40:43], v[36:39], a[24:31], v172
    v_smfmac_f32_16x16x64_bf16 v[44:47], v[36:39], a[88:95], v172
    v_smfmac_f32_16x16x64_bf16 v[48:51], v[36:39], a[56:63], v172
    v_smfmac_f32_16x16x64_bf16 v[52:55], v[36:39], a[120:127], v172
    s_branch gc_31
g_30L15_1:
    s_waitcnt vmcnt(3)
    v_max3_u32 v19, v28, v29, v30
    v_max_u32 v19, v19, v31
    v_cmp_eq_u32 vcc, -1, v19
    s_nop 0
    s_cbranch_vccnz g_30F15_1
    v_smfmac_f32_16x16x64_bf16 v[40:43], v[28:31], a[8:15], v172
    v_smfmac_f32_16x16x64_bf16 v[44:47], v[28:31], a[72:79], v172
    v_smfmac_f32_16x16x64_bf16 v[48:51], v[28:31], a[40:47], v172
    v_smfmac_f32_16x16x64_bf16 v[52:55], v[28:31], a[104:111], v172
g_30L13_2:
    s_waitcnt vmcnt(2)
    v_max3_u32 v19, v32, v33, v34
    v_max_u32 v19, v19, v35
    v_cmp_eq_u32 vcc, -1, v19
    s_nop 0
    s_cbranch_vccnz g_30F13_2
    v_smfmac_f32_16x16x64_bf16 v[40:43], v[32:35], a[16:23], v172
    v_smfmac_f32_16x16x64_bf16 v[44:47], v[32:35], a[80:87], v172
    v_smfmac_f32_16x16x64_bf16 v[48:51], v[32:35], a[48:55], v172
    v_smfmac_f32_16x16x64_bf16 v[52:55], v[32:35], a[112:119], v172
g_30L9_3:
    s_waitcnt vmcnt(1)
    v_max3_u32 v19, v36, v37, v38
    v_max_u32 v19, v19, v39
    v_cmp_eq_u32 vcc, -1, v19
    s_nop 0
    s_cbranch_vccnz g_30F9_3
    v_smfmac_f32_16x16x64_bf16 v[40:43], v[36:39], a[24:31], v172
    v_smfmac_f32_16x16x64_bf16 v[44:47], v[36:39], a[88:95], v172
    v_smfmac_f32_16x16x64_bf16 v[48:51], v[36:39], a[56:63], v172
    v_smfmac_f32_16x16x64_bf16 v[52:55], v[36:39], a[120:127], v172
g_30L1_0:
    s_waitcnt vmcnt(0)
    v_max3_u32 v19, v24, v25, v26
    v_max_u32 v19, v19, v27
    v_cmp_eq_u32 vcc, -1, v19
    s_nop 0
    s_cbranch_vccnz g_30F1_0
    v_smfmac_f32_16x16x64_bf16 v[40:43], v[24:27], a[0:7], v172
    v_smfmac_f32_16x16x64_bf16 v[44:47], v[24:27], a[64:71], v172
    v_smfmac_f32_16x16x64_bf16 v[48:51], v[24:27], a[32:39], v172
    v_smfmac_f32_16x16x64_bf16 v[52:55], v[24:27], a[96:103], v172
    s_branch gc_31
g_30L15_2:
    s_waitcnt vmcnt(3)
    v_max3_u32 v19, v32, v33, v34
    v_max_u32 v19, v19, v35
    v_cmp_eq_u32 vcc, -1, v19
    s_nop 0
    s_cbranch_vccnz g_30F15_2
    v_smfmac_f32_16x16x64_bf16 v[40:43], v[32:35], a[16:23], v172
    v_smfmac_f32_16x16x64_bf16 v[44:47], v[32:35], a[80:87], v172
    v_smfmac_f32_16x16x64_bf16 v[48:51], v[32:35], a[48:55], v172
    v_smfmac_f32_16x16x64_bf16 v[52:55], v[32:35], a[112:119], v172
g_30L11_3:
    s_waitcnt vmcnt(2)
    v_max3_u32 v19, v36, v37, v38
    v_max_u32 v19, v19, v39
    v_cmp_eq_u32 vcc, -1, v19
    s_nop 0
    s_cbranch_vccnz g_30F11_3
    v_smfmac_f32_16x16x64_bf16 v[40:43], v[36:39], a[24:31], v172
    v_smfmac_f32_16x16x64_bf16 v[44:47], v[36:39], a[88:95], v172
    v_smfmac_f32_16x16x64_bf16 v[48:51], v[36:39], a[56:63], v172
    v_smfmac_f32_16x16x64_bf16 v[52:55], v[36:39], a[120:127], v172
g_30L3_0:
    s_waitcnt vmcnt(1)
    v_max3_u32 v19, v24, v25, v26
    v_max_u32 v19, v19, v27
    v_cmp_eq_u32 vcc, -1, v19
    s_nop 0
    s_cbranch_vccnz g_30F3_0
    v_smfmac_f32_16x16x64_bf16 v[40:43], v[24:27], a[0:7], v172
    v_smfmac_f32_16x16x64_bf16 v[44:47], v[24:27], a[64:71], v172
    v_smfmac_f32_16x16x64_bf16 v[48:51], v[24:27], a[32:39], v172
    v_smfmac_f32_16x16x64_bf16 v[52:55], v[24:27], a[96:103], v172
g_30L2_1:
    s_waitcnt vmcnt(0)
    v_max3_u32 v19, v28, v29, v30
    v_max_u32 v19, v19, v31
    v_cmp_eq_u32 vcc, -1, v19
    s_nop 0
    s_cbranch_vccnz g_30F2_1
    v_smfmac_f32_16x16x64_bf16 v[40:43], v[28:31], a[8:15], v172
    v_smfmac_f32_16x16x64_bf16 v[44:47], v[28:31], a[72:79], v172
    v_smfmac_f32_16x16x64_bf16 v[48:51], v[28:31], a[40:47], v172
    v_smfmac_f32_16x16x64_bf16 v[52:55], v[28:31], a[104:111], v172
    s_branch gc_31
g_30L15_3:
    s_waitcnt vmcnt(3)
    v_max3_u32 v19, v36, v37, v38
    v_max_u32 v19, v19, v39
    v_cmp_eq_u32 vcc, -1, v19
    s_nop 0
    s_cbranch_vccnz g_30F15_3
    v_smfmac_f32_16x16x64_bf16 v[40:43], v[36:39], a[24:31], v172
    v_smfmac_f32_16x16x64_bf16 v[44:47], v[36:39], a[88:95], v172
    v_smfmac_f32_16x16x64_bf16 v[48:51], v[36:39], a[56:63], v172
    v_smfmac_f32_16x16x64_bf16 v[52:55], v[36:39], a[120:127], v172
g_30L7_0:
    s_waitcnt vmcnt(2)
    v_max3_u32 v19, v24, v25, v26
    v_max_u32 v19, v19, v27
    v_cmp_eq_u32 vcc, -1, v19
    s_nop 0
    s_cbranch_vccnz g_30F7_0
    v_smfmac_f32_16x16x64_bf16 v[40:43], v[24:27], a[0:7], v172
    v_smfmac_f32_16x16x64_bf16 v[44:47], v[24:27], a[64:71], v172
    v_smfmac_f32_16x16x64_bf16 v[48:51], v[24:27], a[32:39], v172
    v_smfmac_f32_16x16x64_bf16 v[52:55], v[24:27], a[96:103], v172
g_30L6_1:
    s_waitcnt vmcnt(1)
    v_max3_u32 v19, v28, v29, v30
    v_max_u32 v19, v19, v31
    v_cmp_eq_u32 vcc, -1, v19
    s_nop 0
    s_cbranch_vccnz g_30F6_1
    v_smfmac_f32_16x16x64_bf16 v[40:43], v[28:31], a[8:15], v172
    v_smfmac_f32_16x16x64_bf16 v[44:47], v[28:31], a[72:79], v172
    v_smfmac_f32_16x16x64_bf16 v[48:51], v[28:31], a[40:47], v172
    v_smfmac_f32_16x16x64_bf16 v[52:55], v[28:31], a[104:111], v172
g_30L4_2:
    s_waitcnt vmcnt(0)
    v_max3_u32 v19, v32, v33, v34
    v_max_u32 v19, v19, v35
    v_cmp_eq_u32 vcc, -1, v19
    s_nop 0
    s_cbranch_vccnz g_30F4_2
    v_smfmac_f32_16x16x64_bf16 v[40:43], v[32:35], a[16:23], v172
    v_smfmac_f32_16x16x64_bf16 v[44:47], v[32:35], a[80:87], v172
    v_smfmac_f32_16x16x64_bf16 v[48:51], v[32:35], a[48:55], v172
    v_smfmac_f32_16x16x64_bf16 v[52:55], v[32:35], a[112:119], v172
    s_branch gc_31
g_30L7_1:
    s_waitcnt vmcnt(2)
    v_max3_u32 v19, v28, v29, v30
    v_max_u32 v19, v19, v31
    v_cmp_eq_u32 vcc, -1, v19
    s_nop 0
    s_cbranch_vccnz g_30F7_1
    v_smfmac_f32_16x16x64_bf16 v[40:43], v[28:31], a[8:15], v172
    v_smfmac_f32_16x16x64_bf16 v[44:47], v[28:31], a[72:79], v172
    v_smfmac_f32_16x16x64_bf16 v[48:51], v[28:31], a[40:47], v172
    v_smfmac_f32_16x16x64_bf16 v[52:55], v[28:31], a[104:111], v172
g_30L5_2:
    s_waitcnt vmcnt(1)
    v_max3_u32 v19, v32, v33, v34
    v_max_u32 v19, v19, v35
    v_cmp_eq_u32 vcc, -1, v19
    s_nop 0
    s_cbranch_vccnz g_30F5_2
    v_smfmac_f32_16x16x64_bf16 v[40:43], v[32:35], a[16:23], v172
    v_smfmac_f32_16x16x64_bf16 v[44:47], v[32:35], a[80:87], v172
    v_smfmac_f32_16x16x64_bf16 v[48:51], v[32:35], a[48:55], v172
    v_smfmac_f32_16x16x64_bf16 v[52:55], v[32:35], a[112:119], v172
    s_branch g_30L1_0
g_30L7_2:
    s_waitcnt vmcnt(2)
    v_max3_u32 v19, v32, v33, v34
    v_max_u32 v19, v19, v35
    v_cmp_eq_u32 vcc, -1, v19
    s_nop 0
    s_cbranch_vccnz g_30F7_2
    v_smfmac_f32_16x16x64_bf16 v[40:43], v[32:35], a[16:23], v172
    v_smfmac_f32_16x16x64_bf16 v[44:47], v[32:35], a[80:87], v172
    v_smfmac_f32_16x16x64_bf16 v[48:51], v[32:35], a[48:55], v172
    v_smfmac_f32_16x16x64_bf16 v[52:55], v[32:35], a[112:119], v172
    s_branch g_30L3_0
g_30L11_0:
    s_waitcnt vmcnt(2)
    v_max3_u32 v19, v24, v25, v26
    v_max_u32 v19, v19, v27
    v_cmp_eq_u32 vcc, -1, v19
    s_nop 0
    s_cbranch_vccnz g_30F11_0
    v_smfmac_f32_16x16x64_bf16 v[40:43], v[24:27], a[0:7], v172
    v_smfmac_f32_16x16x64_bf16 v[44:47], v[24:27], a[64:71], v172
    v_smfmac_f32_16x16x64_bf16 v[48:51], v[24:27], a[32:39], v172
    v_smfmac_f32_16x16x64_bf16 v[52:55], v[24:27], a[96:103], v172
g_30L10_1:
    s_waitcnt vmcnt(1)
    v_max3_u32 v19, v28, v29, v30
    v_max_u32 v19, v19, v31
    v_cmp_eq_u32 vcc, -1, v19
    s_nop 0
    s_cbranch_vccnz g_30F10_1
    v_smfmac_f32_16x16x64_bf16 v[40:43], v[28:31], a[8:15], v172
    v_smfmac_f32_16x16x64_bf16 v[44:47], v[28:31], a[72:79], v172
    v_smfmac_f32_16x16x64_bf16 v[48:51], v[28:31], a[40:47], v172
    v_smfmac_f32_16x16x64_bf16 v[52:55], v[28:31], a[104:111], v172
    s_branch g_30L8_3
g_30L11_1:
    s_waitcnt vmcnt(2)
    v_max3_u32 v19, v28, v29, v30
    v_max_u32 v19, v19, v31
    v_cmp_eq_u32 vcc, -1, v19
    s_nop 0
    s_cbranch_vccnz g_30F11_1
    v_smfmac_f32_16x16x64_bf16 v[40:43], v[28:31], a[8:15], v172
    v_smfmac_f32_16x16x64_bf16 v[44:47], v[28:31], a[72:79], v172
    v_smfmac_f32_16x16x64_bf16 v[48:51], v[28:31], a[40:47], v172
    v_smfmac_f32_16x16x64_bf16 v[52:55], v[28:31], a[104:111], v172
    s_branch g_30L9_3
g_30L13_0:
    s_waitcnt vmcnt(2)
    v_max3_u32 v19, v24, v25, v26
    v_max_u32 v19, v19, v27
    v_cmp_eq_u32 vcc, -1, v19
    s_nop 0
    s_cbranch_vccnz g_30F13_0
    v_smfmac_f32_16x16x64_bf16 v[40:43], v[24:27], a[0:7], v172
    v_smfmac_f32_16x16x64_bf16 v[44:47], v[24:27], a[64:71], v172
    v_smfmac_f32_16x16x64_bf16 v[48:51], v[24:27], a[32:39], v172
    v_smfmac_f32_16x16x64_bf16 v[52:55], v[24:27], a[96:103], v172
    s_branch g_30L12_2
g_30L13_3:
    s_waitcnt vmcnt(2)
    v_max3_u32 v19, v36, v37, v38
    v_max_u32 v19, v19, v39
    v_cmp_eq_u32 vcc, -1, v19
    s_nop 0
    s_cbranch_vccnz g_30F13_3
    v_smfmac_f32_16x16x64_bf16 v[40:43], v[36:39], a[24:31], v172
    v_smfmac_f32_16x16x64_bf16 v[44:47], v[36:39], a[88:95], v172
    v_smfmac_f32_16x16x64_bf16 v[48:51], v[36:39], a[56:63], v172
    v_smfmac_f32_16x16x64_bf16 v[52:55], v[36:39], a[120:127], v172
g_30L5_0:
    s_waitcnt vmcnt(1)
    v_max3_u32 v19, v24, v25, v26
    v_max_u32 v19, v19, v27
    v_cmp_eq_u32 vcc, -1, v19
    s_nop 0
    s_cbranch_vccnz g_30F5_0
    v_smfmac_f32_16x16x64_bf16 v[40:43], v[24:27], a[0:7], v172
    v_smfmac_f32_16x16x64_bf16 v[44:47], v[24:27], a[64:71], v172
    v_smfmac_f32_16x16x64_bf16 v[48:51], v[24:27], a[32:39], v172
    v_smfmac_f32_16x16x64_bf16 v[52:55], v[24:27], a[96:103], v172
    s_branch g_30L4_2
g_30L14_2:
    s_waitcnt vmcnt(2)
    v_max3_u32 v19, v32, v33, v34
    v_max_u32 v19, v19, v35
    v_cmp_eq_u32 vcc, -1, v19
    s_nop 0
    s_cbranch_vccnz g_30F14_2
    v_smfmac_f32_16x16x64_bf16 v[40:43], v[32:35], a[16:23], v172
    v_smfmac_f32_16x16x64_bf16 v[44:47], v[32:35], a[80:87], v172
    v_smfmac_f32_16x16x64_bf16 v[48:51], v[32:35], a[48:55], v172
    v_smfmac_f32_16x16x64_bf16 v[52:55], v[32:35], a[112:119], v172
g_30L10_3:
    s_waitcnt vmcnt(1)
    v_max3_u32 v19, v36, v37, v38
    v_max_u32 v19, v19, v39
    v_cmp_eq_u32 vcc, -1, v19
    s_nop 0
    s_cbranch_vccnz g_30F10_3
    v_smfmac_f32_16x16x64_bf16 v[40:43], v[36:39], a[24:31], v172
    v_smfmac_f32_16x16x64_bf16 v[44:47], v[36:39], a[88:95], v172
    v_smfmac_f32_16x16x64_bf16 v[48:51], v[36:39], a[56:63], v172
    v_smfmac_f32_16x16x64_bf16 v[52:55], v[36:39], a[120:127], v172
    s_branch g_30L2_1
g_30L14_3:
    s_waitcnt vmcnt(2)
    v_max3_u32 v19, v36, v37, v38
    v_max_u32 v19, v19, v39
    v_cmp_eq_u32 vcc, -1, v19
    s_nop 0
    s_cbranch_vccnz g_30F14_3
    v_smfmac_f32_16x16x64_bf16 v[40:43], v[36:39], a[24:31], v172
    v_smfmac_f32_16x16x64_bf16 v[44:47], v[36:39], a[88:95], v172
    v_smfmac_f32_16x16x64_bf16 v[48:51], v[36:39], a[56:63], v172
    v_smfmac_f32_16x16x64_bf16 v[52:55], v[36:39], a[120:127], v172
    s_branch g_30L6_1
g_30L3_1:
    s_waitcnt vmcnt(1)
    v_max3_u32 v19, v28, v29, v30
    v_max_u32 v19, v19, v31
    v_cmp_eq_u32 vcc, -1, v19
    s_nop 0
    s_cbranch_vccnz g_30F3_1
    v_smfmac_f32_16x16x64_bf16 v[40:43], v[28:31], a[8:15], v172
    v_smfmac_f32_16x16x64_bf16 v[44:47], v[28:31], a[72:79], v172
    v_smfmac_f32_16x16x64_bf16 v[48:51], v[28:31], a[40:47], v172
    v_smfmac_f32_16x16x64_bf16 v[52:55], v[28:31], a[104:111], v172
    s_branch g_30L1_0
g_30L6_2:
    s_waitcnt vmcnt(1)
    v_max3_u32 v19, v32, v33, v34
    v_max_u32 v19, v19, v35
    v_cmp_eq_u32 vcc, -1, v19
    s_nop 0
    s_cbranch_vccnz g_30F6_2
    v_smfmac_f32_16x16x64_bf16 v[40:43], v[32:35], a[16:23], v172
    v_smfmac_f32_16x16x64_bf16 v[44:47], v[32:35], a[80:87], v172
    v_smfmac_f32_16x16x64_bf16 v[48:51], v[32:35], a[48:55], v172
    v_smfmac_f32_16x16x64_bf16 v[52:55], v[32:35], a[112:119], v172
    s_branch g_30L2_1
g_30L9_0:
    s_waitcnt vmcnt(1)
    v_max3_u32 v19, v24, v25, v26
    v_max_u32 v19, v19, v27
    v_cmp_eq_u32 vcc, -1, v19
    s_nop 0
    s_cbranch_vccnz g_30F9_0
    v_smfmac_f32_16x16x64_bf16 v[40:43], v[24:27], a[0:7], v172
    v_smfmac_f32_16x16x64_bf16 v[44:47], v[24:27], a[64:71], v172
    v_smfmac_f32_16x16x64_bf16 v[48:51], v[24:27], a[32:39], v172
    v_smfmac_f32_16x16x64_bf16 v[52:55], v[24:27], a[96:103], v172
    s_branch g_30L8_3
g_30L12_3:
    s_waitcnt vmcnt(1)
    v_max3_u32 v19, v36, v37, v38
    v_max_u32 v19, v19, v39
    v_cmp_eq_u32 vcc, -1, v19
    s_nop 0
    s_cbranch_vccnz g_30F12_3
    v_smfmac_f32_16x16x64_bf16 v[40:43], v[36:39], a[24:31], v172
    v_smfmac_f32_16x16x64_bf16 v[44:47], v[36:39], a[88:95], v172
    v_smfmac_f32_16x16x64_bf16 v[48:51], v[36:39], a[56:63], v172
    v_smfmac_f32_16x16x64_bf16 v[52:55], v[36:39], a[120:127], v172
    s_branch g_30L4_2
g_30F15_0:
    s_mov_b64 exec, vcc
    buffer_load_dwordx4 v[24:27], v2, s[4:7], s16 offen offset:0 sc1
    s_mov_b64 exec, -1
    s_add_u32 s23, s23, 1
    s_cmp_lt_u32 s23, 200000
    s_cbranch_scc1 g_30L15_1
    s_mov_b32 s25, 200000
    s_branch gc_31
g_30F15_1:
    s_mov_b64 exec, vcc
    buffer_load_dwordx4 v[28:31], v2, s[4:7], s16 offen offset:1024 sc1
    s_mov_b64 exec, -1
    s_add_u32 s23, s23, 1
    s_cmp_lt_u32 s23, 200000
    s_cbranch_scc1 g_30L15_2
    s_mov_b32 s25, 200000
    s_branch gc_31
g_30F15_2:
    s_mov_b64 exec, vcc
    buffer_load_dwordx4 v[32:35], v2, s[4:7], s16 offen offset:2048 sc1
    s_mov_b64 exec, -1
    s_add_u32 s23, s23, 1
    s_cmp_lt_u32 s23, 200000
    s_cbranch_scc1 g_30L15_3
    s_mov_b32 s25, 200000
    s_branch gc_31
g_30F15_3:
    s_mov_b64 exec, vcc
    buffer_load_dwordx4 v[36:39], v2, s[4:7], s16 offen offset:3072 sc1
    s_mov_b64 exec, -1
    s_add_u32 s23, s23, 1
    s_cmp_lt_u32 s23, 200000
    s_cbranch_scc1 g_30L15_0
    s_mov_b32 s25, 200000
    s_branch gc_31
g_30F7_0:
    s_mov_b64 exec, vcc
    buffer_load_dwordx4 v[24:27], v2, s[4:7], s16 offen offset:0 sc1
    s_mov_b64 exec, -1
    s_add_u32 s23, s23, 1
    s_cmp_lt_u32 s23, 200000
    s_cbranch_scc1 g_30L7_1
    s_mov_b32 s25, 200000
    s_branch gc_31
g_30F7_1:
    s_mov_b64 exec, vcc
    buffer_load_dwordx4 v[28:31], v2, s[4:7], s16 offen offset:1024 sc1
    s_mov_b64 exec, -1
    s_add_u32 s23, s23, 1
    s_cmp_lt_u32 s23, 200000
    s_cbranch_scc1 g_30L7_2
    s_mov_b32 s25, 200000
    s_branch gc_31
g_30F7_2:
    s_mov_b64 exec, vcc
    buffer_load_dwordx4 v[32:35], v2, s[4:7], s16 offen offset:2048 sc1
    s_mov_b64 exec, -1
    s_add_u32 s23, s23, 1
    s_cmp_lt_u32 s23, 200000
    s_cbranch_scc1 g_30L7_0
    s_mov_b32 s25, 200000
    s_branch gc_31
g_30F11_0:
    s_mov_b64 exec, vcc
    buffer_load_dwordx4 v[24:27], v2, s[4:7], s16 offen offset:0 sc1
    s_mov_b64 exec, -1
    s_add_u32 s23, s23, 1
    s_cmp_lt_u32 s23, 200000
    s_cbranch_scc1 g_30L11_1
    s_mov_b32 s25, 200000
    s_branch gc_31
g_30F11_1:
    s_mov_b64 exec, vcc
    buffer_load_dwordx4 v[28:31], v2, s[4:7], s16 offen offset:1024 sc1
    s_mov_b64 exec, -1
    s_add_u32 s23, s23, 1
    s_cmp_lt_u32 s23, 200000
    s_cbranch_scc1 g_30L11_3
    s_mov_b32 s25, 200000
    s_branch gc_31
g_30F11_3:
    s_mov_b64 exec, vcc
    buffer_load_dwordx4 v[36:39], v2, s[4:7], s16 offen offset:3072 sc1
    s_mov_b64 exec, -1
    s_add_u32 s23, s23, 1
    s_cmp_lt_u32 s23, 200000
    s_cbranch_scc1 g_30L11_0
    s_mov_b32 s25, 200000
    s_branch gc_31
g_30F13_0:
    s_mov_b64 exec, vcc
    buffer_load_dwordx4 v[24:27], v2, s[4:7], s16 offen offset:0 sc1
    s_mov_b64 exec, -1
    s_add_u32 s23, s23, 1
    s_cmp_lt_u32 s23, 200000
    s_cbranch_scc1 g_30L13_2
    s_mov_b32 s25, 200000
    s_branch gc_31
g_30F13_2:
    s_mov_b64 exec, vcc
    buffer_load_dwordx4 v[32:35], v2, s[4:7], s16 offen offset:2048 sc1
    s_mov_b64 exec, -1
    s_add_u32 s23, s23, 1
    s_cmp_lt_u32 s23, 200000
    s_cbranch_scc1 g_30L13_3
    s_mov_b32 s25, 200000
    s_branch gc_31
g_30F13_3:
    s_mov_b64 exec, vcc
    buffer_load_dwordx4 v[36:39], v2, s[4:7], s16 offen offset:3072 sc1
    s_mov_b64 exec, -1
    s_add_u32 s23, s23, 1
    s_cmp_lt_u32 s23, 200000
    s_cbranch_scc1 g_30L13_0
    s_mov_b32 s25, 200000
    s_branch gc_31
g_30F14_1:
    s_mov_b64 exec, vcc
    buffer_load_dwordx4 v[28:31], v2, s[4:7], s16 offen offset:1024 sc1
    s_mov_b64 exec, -1
    s_add_u32 s23, s23, 1
    s_cmp_lt_u32 s23, 200000
    s_cbranch_scc1 g_30L14_2
    s_mov_b32 s25, 200000
    s_branch gc_31
g_30F14_2:
    s_mov_b64 exec, vcc
    buffer_load_dwordx4 v[32:35], v2, s[4:7], s16 offen offset:2048 sc1
    s_mov_b64 exec, -1
    s_add_u32 s23, s23, 1
    s_cmp_lt_u32 s23, 200000
    s_cbranch_scc1 g_30L14_3
    s_mov_b32 s25, 200000
    s_branch gc_31
g_30F14_3:
    s_mov_b64 exec, vcc
    buffer_load_dwordx4 v[36:39], v2, s[4:7], s16 offen offset:3072 sc1
    s_mov_b64 exec, -1
    s_add_u32 s23, s23, 1
    s_cmp_lt_u32 s23, 200000
    s_cbranch_scc1 g_30L14_1
    s_mov_b32 s25, 200000
    s_branch gc_31
g_30F3_0:
    s_mov_b64 exec, vcc
    buffer_load_dwordx4 v[24:27], v2, s[4:7], s16 offen offset:0 sc1
    s_mov_b64 exec, -1
    s_add_u32 s23, s23, 1
    s_cmp_lt_u32 s23, 200000
    s_cbranch_scc1 g_30L3_1
    s_mov_b32 s25, 200000
    s_branch gc_31
g_30F3_1:
    s_mov_b64 exec, vcc
    buffer_load_dwordx4 v[28:31], v2, s[4:7], s16 offen offset:1024 sc1
    s_mov_b64 exec, -1
    s_add_u32 s23, s23, 1
    s_cmp_lt_u32 s23, 200000
    s_cbranch_scc1 g_30L3_0
    s_mov_b32 s25, 200000
    s_branch gc_31
g_30F5_0:
    s_mov_b64 exec, vcc
    buffer_load_dwordx4 v[24:27], v2, s[4:7], s16 offen offset:0 sc1
    s_mov_b64 exec, -1
    s_add_u32 s23, s23, 1
    s_cmp_lt_u32 s23, 200000
    s_cbranch_scc1 g_30L5_2
    s_mov_b32 s25, 200000
    s_branch gc_31
g_30F5_2:
    s_mov_b64 exec, vcc
    buffer_load_dwordx4 v[32:35], v2, s[4:7], s16 offen offset:2048 sc1
    s_mov_b64 exec, -1
    s_add_u32 s23, s23, 1
    s_cmp_lt_u32 s23, 200000
    s_cbranch_scc1 g_30L5_0
    s_mov_b32 s25, 200000
    s_branch gc_31
g_30F6_1:
    s_mov_b64 exec, vcc
    buffer_load_dwordx4 v[28:31], v2, s[4:7], s16 offen offset:1024 sc1
    s_mov_b64 exec, -1
    s_add_u32 s23, s23, 1
    s_cmp_lt_u32 s23, 200000
    s_cbranch_scc1 g_30L6_2
    s_mov_b32 s25, 200000
    s_branch gc_31
g_30F6_2:
    s_mov_b64 exec, vcc
    buffer_load_dwordx4 v[32:35], v2, s[4:7], s16 offen offset:2048 sc1
    s_mov_b64 exec, -1
    s_add_u32 s23, s23, 1
    s_cmp_lt_u32 s23, 200000
    s_cbranch_scc1 g_30L6_1
    s_mov_b32 s25, 200000
    s_branch gc_31
g_30F9_0:
    s_mov_b64 exec, vcc
    buffer_load_dwordx4 v[24:27], v2, s[4:7], s16 offen offset:0 sc1
    s_mov_b64 exec, -1
    s_add_u32 s23, s23, 1
    s_cmp_lt_u32 s23, 200000
    s_cbranch_scc1 g_30L9_3
    s_mov_b32 s25, 200000
    s_branch gc_31
g_30F9_3:
    s_mov_b64 exec, vcc
    buffer_load_dwordx4 v[36:39], v2, s[4:7], s16 offen offset:3072 sc1
    s_mov_b64 exec, -1
    s_add_u32 s23, s23, 1
    s_cmp_lt_u32 s23, 200000
    s_cbranch_scc1 g_30L9_0
    s_mov_b32 s25, 200000
    s_branch gc_31
g_30F10_1:
    s_mov_b64 exec, vcc
    buffer_load_dwordx4 v[28:31], v2, s[4:7], s16 offen offset:1024 sc1
    s_mov_b64 exec, -1
    s_add_u32 s23, s23, 1
    s_cmp_lt_u32 s23, 200000
    s_cbranch_scc1 g_30L10_3
    s_mov_b32 s25, 200000
    s_branch gc_31
g_30F10_3:
    s_mov_b64 exec, vcc
    buffer_load_dwordx4 v[36:39], v2, s[4:7], s16 offen offset:3072 sc1
    s_mov_b64 exec, -1
    s_add_u32 s23, s23, 1
    s_cmp_lt_u32 s23, 200000
    s_cbranch_scc1 g_30L10_1
    s_mov_b32 s25, 200000
    s_branch gc_31
g_30F12_2:
    s_mov_b64 exec, vcc
    buffer_load_dwordx4 v[32:35], v2, s[4:7], s16 offen offset:2048 sc1
    s_mov_b64 exec, -1
    s_add_u32 s23, s23, 1
    s_cmp_lt_u32 s23, 200000
    s_cbranch_scc1 g_30L12_3
    s_mov_b32 s25, 200000
    s_branch gc_31
g_30F12_3:
    s_mov_b64 exec, vcc
    buffer_load_dwordx4 v[36:39], v2, s[4:7], s16 offen offset:3072 sc1
    s_mov_b64 exec, -1
    s_add_u32 s23, s23, 1
    s_cmp_lt_u32 s23, 200000
    s_cbranch_scc1 g_30L12_2
    s_mov_b32 s25, 200000
    s_branch gc_31
g_30F1_0:
    s_mov_b64 exec, vcc
    buffer_load_dwordx4 v[24:27], v2, s[4:7], s16 offen offset:0 sc1
    s_mov_b64 exec, -1
    s_add_u32 s23, s23, 1
    s_cmp_lt_u32 s23, 200000
    s_cbranch_scc1 g_30L1_0
    s_mov_b32 s25, 200000
    s_branch gc_31
g_30F2_1:
    s_mov_b64 exec, vcc
    buffer_load_dwordx4 v[28:31], v2, s[4:7], s16 offen offset:1024 sc1
    s_mov_b64 exec, -1
    s_add_u32 s23, s23, 1
    s_cmp_lt_u32 s23, 200000
    s_cbranch_scc1 g_30L2_1
    s_mov_b32 s25, 200000
    s_branch gc_31
g_30F4_2:
    s_mov_b64 exec, vcc
    buffer_load_dwordx4 v[32:35], v2, s[4:7], s16 offen offset:2048 sc1
    s_mov_b64 exec, -1
    s_add_u32 s23, s23, 1
    s_cmp_lt_u32 s23, 200000
    s_cbranch_scc1 g_30L4_2
    s_mov_b32 s25, 200000
    s_branch gc_31
g_30F8_3:
    s_mov_b64 exec, vcc
    buffer_load_dwordx4 v[36:39], v2, s[4:7], s16 offen offset:3072 sc1
    s_mov_b64 exec, -1
    s_add_u32 s23, s23, 1
    s_cmp_lt_u32 s23, 200000
    s_cbranch_scc1 g_30L8_3
    s_mov_b32 s25, 200000
    s_branch gc_31
recur_fast_last0:
    buffer_store_dwordx4 v[128:131], v14, s[4:7], s19 offen sc1
    s_waitcnt vmcnt(0)
    s_branch recur_end
g_32L15_0:
    s_waitcnt vmcnt(3)
    v_max3_u32 v19, v24, v25, v26
    v_max_u32 v19, v19, v27
    v_cmp_eq_u32 vcc, -1, v19
    s_nop 0
    s_cbranch_vccnz g_32F15_0
    v_smfmac_f32_16x16x64_bf16 v[64:67], v[24:27], a[192:199], v172
    v_smfmac_f32_16x16x64_bf16 v[68:71], v[24:27], a[224:231], v172
g_32L14_1:
    s_waitcnt vmcnt(2)
    v_max3_u32 v19, v28, v29, v30
    v_max_u32 v19, v19, v31
    v_cmp_eq_u32 vcc, -1, v19
    s_nop 0
    s_cbranch_vccnz g_32F14_1
    v_smfmac_f32_16x16x64_bf16 v[64:67], v[28:31], a[200:207], v172
    v_smfmac_f32_16x16x64_bf16 v[68:71], v[28:31], a[232:239], v172
g_32L12_2:
    s_waitcnt vmcnt(1)
    v_max3_u32 v19, v32, v33, v34
    v_max_u32 v19, v19, v35
    v_cmp_eq_u32 vcc, -1, v19
    s_nop 0
    s_cbranch_vccnz g_32F12_2
    v_smfmac_f32_16x16x64_bf16 v[64:67], v[32:35], a[208:215], v172
    v_smfmac_f32_16x16x64_bf16 v[68:71], v[32:35], a[240:247], v172
g_32L8_3:
    s_waitcnt vmcnt(0)
    v_max3_u32 v19, v36, v37, v38
    v_max_u32 v19, v19, v39
    v_cmp_eq_u32 vcc, -1, v19
    s_nop 0
    s_cbranch_vccnz g_32F8_3
    v_smfmac_f32_16x16x64_bf16 v[64:67], v[36:39], a[216:223], v172
    v_smfmac_f32_16x16x64_bf16 v[68:71], v[36:39], a[248:255], v172
    s_nop 4
    v_cvt_pk_bf16_f32 v80, v64, v65
    v_cvt_pk_bf16_f32 v81, v66, v67
    s_nop 0
    v_cvt_pk_bf16_f32 v82, v68, v69
    v_cvt_pk_bf16_f32 v83, v70, v71
    ds_write_b128 v17, v[80:83] offset:9216
    s_branch gc_33
g_32L15_1:
    s_waitcnt vmcnt(3)
    v_max3_u32 v19, v28, v29, v30
    v_max_u32 v19, v19, v31
    v_cmp_eq_u32 vcc, -1, v19
    s_nop 0
    s_cbranch_vccnz g_32F15_1
    v_smfmac_f32_16x16x64_bf16 v[64:67], v[28:31], a[200:207], v172
    v_smfmac_f32_16x16x64_bf16 v[68:71], v[28:31], a[232:239], v172
g_32L13_2:
    s_waitcnt vmcnt(2)
    v_max3_u32 v19, v32, v33, v34
    v_max_u32 v19, v19, v35
    v_cmp_eq_u32 vcc, -1, v19
    s_nop 0
    s_cbranch_vccnz g_32F13_2
    v_smfmac_f32_16x16x64_bf16 v[64:67], v[32:35], a[208:215], v172
    v_smfmac_f32_16x16x64_bf16 v[68:71], v[32:35], a[240:247], v172
g_32L9_3:
    s_waitcnt vmcnt(1)
    v_max3_u32 v19, v36, v37, v38
    v_max_u32 v19, v19, v39
    v_cmp_eq_u32 vcc, -1, v19
    s_nop 0
    s_cbranch_vccnz g_32F9_3
    v_smfmac_f32_16x16x64_bf16 v[64:67], v[36:39], a[216:223], v172
    v_smfmac_f32_16x16x64_bf16 v[68:71], v[36:39], a[248:255], v172
g_32L1_0:
    s_waitcnt vmcnt(0)
    v_max3_u32 v19, v24, v25, v26
    v_max_u32 v19, v19, v27
    v_cmp_eq_u32 vcc, -1, v19
    s_nop 0
    s_cbranch_vccnz g_32F1_0
    v_smfmac_f32_16x16x64_bf16 v[64:67], v[24:27], a[192:199], v172
    v_smfmac_f32_16x16x64_bf16 v[68:71], v[24:27], a[224:231], v172
    s_nop 4
    v_cvt_pk_bf16_f32 v80, v64, v65
    v_cvt_pk_bf16_f32 v81, v66, v67
    s_nop 0
    v_cvt_pk_bf16_f32 v82, v68, v69
    v_cvt_pk_bf16_f32 v83, v70, v71
    ds_write_b128 v17, v[80:83] offset:9216
    s_branch gc_33
g_32L15_2:
    s_waitcnt vmcnt(3)
    v_max3_u32 v19, v32, v33, v34
    v_max_u32 v19, v19, v35
    v_cmp_eq_u32 vcc, -1, v19
    s_nop 0
    s_cbranch_vccnz g_32F15_2
    v_smfmac_f32_16x16x64_bf16 v[64:67], v[32:35], a[208:215], v172
    v_smfmac_f32_16x16x64_bf16 v[68:71], v[32:35], a[240:247], v172
g_32L11_3:
    s_waitcnt vmcnt(2)
    v_max3_u32 v19, v36, v37, v38
    v_max_u32 v19, v19, v39
    v_cmp_eq_u32 vcc, -1, v19
    s_nop 0
    s_cbranch_vccnz g_32F11_3
    v_smfmac_f32_16x16x64_bf16 v[64:67], v[36:39], a[216:223], v172
    v_smfmac_f32_16x16x64_bf16 v[68:71], v[36:39], a[248:255], v172
g_32L3_0:
    s_waitcnt vmcnt(1)
    v_max3_u32 v19, v24, v25, v26
    v_max_u32 v19, v19, v27
    v_cmp_eq_u32 vcc, -1, v19
    s_nop 0
    s_cbranch_vccnz g_32F3_0
    v_smfmac_f32_16x16x64_bf16 v[64:67], v[24:27], a[192:199], v172
    v_smfmac_f32_16x16x64_bf16 v[68:71], v[24:27], a[224:231], v172
g_32L2_1:
    s_waitcnt vmcnt(0)
    v_max3_u32 v19, v28, v29, v30
    v_max_u32 v19, v19, v31
    v_cmp_eq_u32 vcc, -1, v19
    s_nop 0
    s_cbranch_vccnz g_32F2_1
    v_smfmac_f32_16x16x64_bf16 v[64:67], v[28:31], a[200:207], v172
    v_smfmac_f32_16x16x64_bf16 v[68:71], v[28:31], a[232:239], v172
    s_nop 4
    v_cvt_pk_bf16_f32 v80, v64, v65
    v_cvt_pk_bf16_f32 v81, v66, v67
    s_nop 0
    v_cvt_pk_bf16_f32 v82, v68, v69
    v_cvt_pk_bf16_f32 v83, v70, v71
    ds_write_b128 v17, v[80:83] offset:9216
    s_branch gc_33
g_32L15_3:
    s_waitcnt vmcnt(3)
    v_max3_u32 v19, v36, v37, v38
    v_max_u32 v19, v19, v39
    v_cmp_eq_u32 vcc, -1, v19
    s_nop 0
    s_cbranch_vccnz g_32F15_3
    v_smfmac_f32_16x16x64_bf16 v[64:67], v[36:39], a[216:223], v172
    v_smfmac_f32_16x16x64_bf16 v[68:71], v[36:39], a[248:255], v172
g_32L7_0:
    s_waitcnt vmcnt(2)
    v_max3_u32 v19, v24, v25, v26
    v_max_u32 v19, v19, v27
    v_cmp_eq_u32 vcc, -1, v19
    s_nop 0
    s_cbranch_vccnz g_32F7_0
    v_smfmac_f32_16x16x64_bf16 v[64:67], v[24:27], a[192:199], v172
    v_smfmac_f32_16x16x64_bf16 v[68:71], v[24:27], a[224:231], v172
g_32L6_1:
    s_waitcnt vmcnt(1)
    v_max3_u32 v19, v28, v29, v30
    v_max_u32 v19, v19, v31
    v_cmp_eq_u32 vcc, -1, v19
    s_nop 0
    s_cbranch_vccnz g_32F6_1
    v_smfmac_f32_16x16x64_bf16 v[64:67], v[28:31], a[200:207], v172
    v_smfmac_f32_16x16x64_bf16 v[68:71], v[28:31], a[232:239], v172
g_32L4_2:
    s_waitcnt vmcnt(0)
    v_max3_u32 v19, v32, v33, v34
    v_max_u32 v19, v19, v35
    v_cmp_eq_u32 vcc, -1, v19
    s_nop 0
    s_cbranch_vccnz g_32F4_2
    v_smfmac_f32_16x16x64_bf16 v[64:67], v[32:35], a[208:215], v172
    v_smfmac_f32_16x16x64_bf16 v[68:71], v[32:35], a[240:247], v172
    s_nop 4
    v_cvt_pk_bf16_f32 v80, v64, v65
    v_cvt_pk_bf16_f32 v81, v66, v67
    s_nop 0
    v_cvt_pk_bf16_f32 v82, v68, v69
    v_cvt_pk_bf16_f32 v83, v70, v71
    ds_write_b128 v17, v[80:83] offset:9216
    s_branch gc_33
g_32L7_1:
    s_waitcnt vmcnt(2)
    v_max3_u32 v19, v28, v29, v30
    v_max_u32 v19, v19, v31
    v_cmp_eq_u32 vcc, -1, v19
    s_nop 0
    s_cbranch_vccnz g_32F7_1
    v_smfmac_f32_16x16x64_bf16 v[64:67], v[28:31], a[200:207], v172
    v_smfmac_f32_16x16x64_bf16 v[68:71], v[28:31], a[232:239], v172
g_32L5_2:
    s_waitcnt vmcnt(1)
    v_max3_u32 v19, v32, v33, v34
    v_max_u32 v19, v19, v35
    v_cmp_eq_u32 vcc, -1, v19
    s_nop 0
    s_cbranch_vccnz g_32F5_2
    v_smfmac_f32_16x16x64_bf16 v[64:67], v[32:35], a[208:215], v172
    v_smfmac_f32_16x16x64_bf16 v[68:71], v[32:35], a[240:247], v172
    s_branch g_32L1_0
g_32L7_2:
    s_waitcnt vmcnt(2)
    v_max3_u32 v19, v32, v33, v34
    v_max_u32 v19, v19, v35
    v_cmp_eq_u32 vcc, -1, v19
    s_nop 0
    s_cbranch_vccnz g_32F7_2
    v_smfmac_f32_16x16x64_bf16 v[64:67], v[32:35], a[208:215], v172
    v_smfmac_f32_16x16x64_bf16 v[68:71], v[32:35], a[240:247], v172
    s_branch g_32L3_0
g_32L11_0:
    s_waitcnt vmcnt(2)
    v_max3_u32 v19, v24, v25, v26
    v_max_u32 v19, v19, v27
    v_cmp_eq_u32 vcc, -1, v19
    s_nop 0
    s_cbranch_vccnz g_32F11_0
    v_smfmac_f32_16x16x64_bf16 v[64:67], v[24:27], a[192:199], v172
    v_smfmac_f32_16x16x64_bf16 v[68:71], v[24:27], a[224:231], v172
g_32L10_1:
    s_waitcnt vmcnt(1)
    v_max3_u32 v19, v28, v29, v30
    v_max_u32 v19, v19, v31
    v_cmp_eq_u32 vcc, -1, v19
    s_nop 0
    s_cbranch_vccnz g_32F10_1
    v_smfmac_f32_16x16x64_bf16 v[64:67], v[28:31], a[200:207], v172
    v_smfmac_f32_16x16x64_bf16 v[68:71], v[28:31], a[232:239], v172
    s_branch g_32L8_3
g_32L11_1:
    s_waitcnt vmcnt(2)
    v_max3_u32 v19, v28, v29, v30
    v_max_u32 v19, v19, v31
    v_cmp_eq_u32 vcc, -1, v19
    s_nop 0
    s_cbranch_vccnz g_32F11_1
    v_smfmac_f32_16x16x64_bf16 v[64:67], v[28:31], a[200:207], v172
    v_smfmac_f32_16x16x64_bf16 v[68:71], v[28:31], a[232:239], v172
    s_branch g_32L9_3
g_32L13_0:
    s_waitcnt vmcnt(2)
    v_max3_u32 v19, v24, v25, v26
    v_max_u32 v19, v19, v27
    v_cmp_eq_u32 vcc, -1, v19
    s_nop 0
    s_cbranch_vccnz g_32F13_0
    v_smfmac_f32_16x16x64_bf16 v[64:67], v[24:27], a[192:199], v172
    v_smfmac_f32_16x16x64_bf16 v[68:71], v[24:27], a[224:231], v172
    s_branch g_32L12_2
g_32L13_3:
    s_waitcnt vmcnt(2)
    v_max3_u32 v19, v36, v37, v38
    v_max_u32 v19, v19, v39
    v_cmp_eq_u32 vcc, -1, v19
    s_nop 0
    s_cbranch_vccnz g_32F13_3
    v_smfmac_f32_16x16x64_bf16 v[64:67], v[36:39], a[216:223], v172
    v_smfmac_f32_16x16x64_bf16 v[68:71], v[36:39], a[248:255], v172
g_32L5_0:
    s_waitcnt vmcnt(1)
    v_max3_u32 v19, v24, v25, v26
    v_max_u32 v19, v19, v27
    v_cmp_eq_u32 vcc, -1, v19
    s_nop 0
    s_cbranch_vccnz g_32F5_0
    v_smfmac_f32_16x16x64_bf16 v[64:67], v[24:27], a[192:199], v172
    v_smfmac_f32_16x16x64_bf16 v[68:71], v[24:27], a[224:231], v172
    s_branch g_32L4_2
g_32L14_2:
    s_waitcnt vmcnt(2)
    v_max3_u32 v19, v32, v33, v34
    v_max_u32 v19, v19, v35
    v_cmp_eq_u32 vcc, -1, v19
    s_nop 0
    s_cbranch_vccnz g_32F14_2
    v_smfmac_f32_16x16x64_bf16 v[64:67], v[32:35], a[208:215], v172
    v_smfmac_f32_16x16x64_bf16 v[68:71], v[32:35], a[240:247], v172
g_32L10_3:
    s_waitcnt vmcnt(1)
    v_max3_u32 v19, v36, v37, v38
    v_max_u32 v19, v19, v39
    v_cmp_eq_u32 vcc, -1, v19
    s_nop 0
    s_cbranch_vccnz g_32F10_3
    v_smfmac_f32_16x16x64_bf16 v[64:67], v[36:39], a[216:223], v172
    v_smfmac_f32_16x16x64_bf16 v[68:71], v[36:39], a[248:255], v172
    s_branch g_32L2_1
g_32L14_3:
    s_waitcnt vmcnt(2)
    v_max3_u32 v19, v36, v37, v38
    v_max_u32 v19, v19, v39
    v_cmp_eq_u32 vcc, -1, v19
    s_nop 0
    s_cbranch_vccnz g_32F14_3
    v_smfmac_f32_16x16x64_bf16 v[64:67], v[36:39], a[216:223], v172
    v_smfmac_f32_16x16x64_bf16 v[68:71], v[36:39], a[248:255], v172
    s_branch g_32L6_1
g_32L3_1:
    s_waitcnt vmcnt(1)
    v_max3_u32 v19, v28, v29, v30
    v_max_u32 v19, v19, v31
    v_cmp_eq_u32 vcc, -1, v19
    s_nop 0
    s_cbranch_vccnz g_32F3_1
    v_smfmac_f32_16x16x64_bf16 v[64:67], v[28:31], a[200:207], v172
    v_smfmac_f32_16x16x64_bf16 v[68:71], v[28:31], a[232:239], v172
    s_branch g_32L1_0
g_32L6_2:
    s_waitcnt vmcnt(1)
    v_max3_u32 v19, v32, v33, v34
    v_max_u32 v19, v19, v35
    v_cmp_eq_u32 vcc, -1, v19
    s_nop 0
    s_cbranch_vccnz g_32F6_2
    v_smfmac_f32_16x16x64_bf16 v[64:67], v[32:35], a[208:215], v172
    v_smfmac_f32_16x16x64_bf16 v[68:71], v[32:35], a[240:247], v172
    s_branch g_32L2_1
g_32L9_0:
    s_waitcnt vmcnt(1)
    v_max3_u32 v19, v24, v25, v26
    v_max_u32 v19, v19, v27
    v_cmp_eq_u32 vcc, -1, v19
    s_nop 0
    s_cbranch_vccnz g_32F9_0
    v_smfmac_f32_16x16x64_bf16 v[64:67], v[24:27], a[192:199], v172
    v_smfmac_f32_16x16x64_bf16 v[68:71], v[24:27], a[224:231], v172
    s_branch g_32L8_3
g_32L12_3:
    s_waitcnt vmcnt(1)
    v_max3_u32 v19, v36, v37, v38
    v_max_u32 v19, v19, v39
    v_cmp_eq_u32 vcc, -1, v19
    s_nop 0
    s_cbranch_vccnz g_32F12_3
    v_smfmac_f32_16x16x64_bf16 v[64:67], v[36:39], a[216:223], v172
    v_smfmac_f32_16x16x64_bf16 v[68:71], v[36:39], a[248:255], v172
    s_branch g_32L4_2
g_32F15_0:
    s_mov_b64 exec, vcc
    buffer_load_dwordx4 v[24:27], v8, s[4:7], s16 offen offset:0 sc1
    s_mov_b64 exec, -1
    s_add_u32 s23, s23, 1
    s_cmp_lt_u32 s23, 200000
    s_cbranch_scc1 g_32L15_1
    s_mov_b32 s25, 200000
    s_branch gc_33
g_32F15_1:
    s_mov_b64 exec, vcc
    buffer_load_dwordx4 v[28:31], v8, s[4:7], s16 offen offset:1024 sc1
    s_mov_b64 exec, -1
    s_add_u32 s23, s23, 1
    s_cmp_lt_u32 s23, 200000
    s_cbranch_scc1 g_32L15_2
    s_mov_b32 s25, 200000
    s_branch gc_33
g_32F15_2:
    s_mov_b64 exec, vcc
    buffer_load_dwordx4 v[32:35], v8, s[4:7], s16 offen offset:2048 sc1
    s_mov_b64 exec, -1
    s_add_u32 s23, s23, 1
    s_cmp_lt_u32 s23, 200000
    s_cbranch_scc1 g_32L15_3
    s_mov_b32 s25, 200000
    s_branch gc_33
g_32F15_3:
    s_mov_b64 exec, vcc
    buffer_load_dwordx4 v[36:39], v8, s[4:7], s16 offen offset:3072 sc1
    s_mov_b64 exec, -1
    s_add_u32 s23, s23, 1
    s_cmp_lt_u32 s23, 200000
    s_cbranch_scc1 g_32L15_0
    s_mov_b32 s25, 200000
    s_branch gc_33
g_32F7_0:
    s_mov_b64 exec, vcc
    buffer_load_dwordx4 v[24:27], v8, s[4:7], s16 offen offset:0 sc1
    s_mov_b64 exec, -1
    s_add_u32 s23, s23, 1
    s_cmp_lt_u32 s23, 200000
    s_cbranch_scc1 g_32L7_1
    s_mov_b32 s25, 200000
    s_branch gc_33
g_32F7_1:
    s_mov_b64 exec, vcc
    buffer_load_dwordx4 v[28:31], v8, s[4:7], s16 offen offset:1024 sc1
    s_mov_b64 exec, -1
    s_add_u32 s23, s23, 1
    s_cmp_lt_u32 s23, 200000
    s_cbranch_scc1 g_32L7_2
    s_mov_b32 s25, 200000
    s_branch gc_33
g_32F7_2:
    s_mov_b64 exec, vcc
    buffer_load_dwordx4 v[32:35], v8, s[4:7], s16 offen offset:2048 sc1
    s_mov_b64 exec, -1
    s_add_u32 s23, s23, 1
    s_cmp_lt_u32 s23, 200000
    s_cbranch_scc1 g_32L7_0
    s_mov_b32 s25, 200000
    s_branch gc_33
g_32F11_0:
    s_mov_b64 exec, vcc
    buffer_load_dwordx4 v[24:27], v8, s[4:7], s16 offen offset:0 sc1
    s_mov_b64 exec, -1
    s_add_u32 s23, s23, 1
    s_cmp_lt_u32 s23, 200000
    s_cbranch_scc1 g_32L11_1
    s_mov_b32 s25, 200000
    s_branch gc_33
g_32F11_1:
    s_mov_b64 exec, vcc
    buffer_load_dwordx4 v[28:31], v8, s[4:7], s16 offen offset:1024 sc1
    s_mov_b64 exec, -1
    s_add_u32 s23, s23, 1
    s_cmp_lt_u32 s23, 200000
    s_cbranch_scc1 g_32L11_3
    s_mov_b32 s25, 200000
    s_branch gc_33
g_32F11_3:
    s_mov_b64 exec, vcc
    buffer_load_dwordx4 v[36:39], v8, s[4:7], s16 offen offset:3072 sc1
    s_mov_b64 exec, -1
    s_add_u32 s23, s23, 1
    s_cmp_lt_u32 s23, 200000
    s_cbranch_scc1 g_32L11_0
    s_mov_b32 s25, 200000
    s_branch gc_33
g_32F13_0:
    s_mov_b64 exec, vcc
    buffer_load_dwordx4 v[24:27], v8, s[4:7], s16 offen offset:0 sc1
    s_mov_b64 exec, -1
    s_add_u32 s23, s23, 1
    s_cmp_lt_u32 s23, 200000
    s_cbranch_scc1 g_32L13_2
    s_mov_b32 s25, 200000
    s_branch gc_33
g_32F13_2:
    s_mov_b64 exec, vcc
    buffer_load_dwordx4 v[32:35], v8, s[4:7], s16 offen offset:2048 sc1
    s_mov_b64 exec, -1
    s_add_u32 s23, s23, 1
    s_cmp_lt_u32 s23, 200000
    s_cbranch_scc1 g_32L13_3
    s_mov_b32 s25, 200000
    s_branch gc_33
g_32F13_3:
    s_mov_b64 exec, vcc
    buffer_load_dwordx4 v[36:39], v8, s[4:7], s16 offen offset:3072 sc1
    s_mov_b64 exec, -1
    s_add_u32 s23, s23, 1
    s_cmp_lt_u32 s23, 200000
    s_cbranch_scc1 g_32L13_0
    s_mov_b32 s25, 200000
    s_branch gc_33
g_32F14_1:
    s_mov_b64 exec, vcc
    buffer_load_dwordx4 v[28:31], v8, s[4:7], s16 offen offset:1024 sc1
    s_mov_b64 exec, -1
    s_add_u32 s23, s23, 1
    s_cmp_lt_u32 s23, 200000
    s_cbranch_scc1 g_32L14_2
    s_mov_b32 s25, 200000
    s_branch gc_33
g_32F14_2:
    s_mov_b64 exec, vcc
    buffer_load_dwordx4 v[32:35], v8, s[4:7], s16 offen offset:2048 sc1
    s_mov_b64 exec, -1
    s_add_u32 s23, s23, 1
    s_cmp_lt_u32 s23, 200000
    s_cbranch_scc1 g_32L14_3
    s_mov_b32 s25, 200000
    s_branch gc_33
g_32F14_3:
    s_mov_b64 exec, vcc
    buffer_load_dwordx4 v[36:39], v8, s[4:7], s16 offen offset:3072 sc1
    s_mov_b64 exec, -1
    s_add_u32 s23, s23, 1
    s_cmp_lt_u32 s23, 200000
    s_cbranch_scc1 g_32L14_1
    s_mov_b32 s25, 200000
    s_branch gc_33
g_32F3_0:
    s_mov_b64 exec, vcc
    buffer_load_dwordx4 v[24:27], v8, s[4:7], s16 offen offset:0 sc1
    s_mov_b64 exec, -1
    s_add_u32 s23, s23, 1
    s_cmp_lt_u32 s23, 200000
    s_cbranch_scc1 g_32L3_1
    s_mov_b32 s25, 200000
    s_branch gc_33
g_32F3_1:
    s_mov_b64 exec, vcc
    buffer_load_dwordx4 v[28:31], v8, s[4:7], s16 offen offset:1024 sc1
    s_mov_b64 exec, -1
    s_add_u32 s23, s23, 1
    s_cmp_lt_u32 s23, 200000
    s_cbranch_scc1 g_32L3_0
    s_mov_b32 s25, 200000
    s_branch gc_33
g_32F5_0:
    s_mov_b64 exec, vcc
    buffer_load_dwordx4 v[24:27], v8, s[4:7], s16 offen offset:0 sc1
    s_mov_b64 exec, -1
    s_add_u32 s23, s23, 1
    s_cmp_lt_u32 s23, 200000
    s_cbranch_scc1 g_32L5_2
    s_mov_b32 s25, 200000
    s_branch gc_33
g_32F5_2:
    s_mov_b64 exec, vcc
    buffer_load_dwordx4 v[32:35], v8, s[4:7], s16 offen offset:2048 sc1
    s_mov_b64 exec, -1
    s_add_u32 s23, s23, 1
    s_cmp_lt_u32 s23, 200000
    s_cbranch_scc1 g_32L5_0
    s_mov_b32 s25, 200000
    s_branch gc_33
g_32F6_1:
    s_mov_b64 exec, vcc
    buffer_load_dwordx4 v[28:31], v8, s[4:7], s16 offen offset:1024 sc1
    s_mov_b64 exec, -1
    s_add_u32 s23, s23, 1
    s_cmp_lt_u32 s23, 200000
    s_cbranch_scc1 g_32L6_2
    s_mov_b32 s25, 200000
    s_branch gc_33
g_32F6_2:
    s_mov_b64 exec, vcc
    buffer_load_dwordx4 v[32:35], v8, s[4:7], s16 offen offset:2048 sc1
    s_mov_b64 exec, -1
    s_add_u32 s23, s23, 1
    s_cmp_lt_u32 s23, 200000
    s_cbranch_scc1 g_32L6_1
    s_mov_b32 s25, 200000
    s_branch gc_33
g_32F9_0:
    s_mov_b64 exec, vcc
    buffer_load_dwordx4 v[24:27], v8, s[4:7], s16 offen offset:0 sc1
    s_mov_b64 exec, -1
    s_add_u32 s23, s23, 1
    s_cmp_lt_u32 s23, 200000
    s_cbranch_scc1 g_32L9_3
    s_mov_b32 s25, 200000
    s_branch gc_33
g_32F9_3:
    s_mov_b64 exec, vcc
    buffer_load_dwordx4 v[36:39], v8, s[4:7], s16 offen offset:3072 sc1
    s_mov_b64 exec, -1
    s_add_u32 s23, s23, 1
    s_cmp_lt_u32 s23, 200000
    s_cbranch_scc1 g_32L9_0
    s_mov_b32 s25, 200000
    s_branch gc_33
g_32F10_1:
    s_mov_b64 exec, vcc
    buffer_load_dwordx4 v[28:31], v8, s[4:7], s16 offen offset:1024 sc1
    s_mov_b64 exec, -1
    s_add_u32 s23, s23, 1
    s_cmp_lt_u32 s23, 200000
    s_cbranch_scc1 g_32L10_3
    s_mov_b32 s25, 200000
    s_branch gc_33
g_32F10_3:
    s_mov_b64 exec, vcc
    buffer_load_dwordx4 v[36:39], v8, s[4:7], s16 offen offset:3072 sc1
    s_mov_b64 exec, -1
    s_add_u32 s23, s23, 1
    s_cmp_lt_u32 s23, 200000
    s_cbranch_scc1 g_32L10_1
    s_mov_b32 s25, 200000
    s_branch gc_33
g_32F12_2:
    s_mov_b64 exec, vcc
    buffer_load_dwordx4 v[32:35], v8, s[4:7], s16 offen offset:2048 sc1
    s_mov_b64 exec, -1
    s_add_u32 s23, s23, 1
    s_cmp_lt_u32 s23, 200000
    s_cbranch_scc1 g_32L12_3
    s_mov_b32 s25, 200000
    s_branch gc_33
g_32F12_3:
    s_mov_b64 exec, vcc
    buffer_load_dwordx4 v[36:39], v8, s[4:7], s16 offen offset:3072 sc1
    s_mov_b64 exec, -1
    s_add_u32 s23, s23, 1
    s_cmp_lt_u32 s23, 200000
    s_cbranch_scc1 g_32L12_2
    s_mov_b32 s25, 200000
    s_branch gc_33
g_32F1_0:
    s_mov_b64 exec, vcc
    buffer_load_dwordx4 v[24:27], v8, s[4:7], s16 offen offset:0 sc1
    s_mov_b64 exec, -1
    s_add_u32 s23, s23, 1
    s_cmp_lt_u32 s23, 200000
    s_cbranch_scc1 g_32L1_0
    s_mov_b32 s25, 200000
    s_branch gc_33
g_32F2_1:
    s_mov_b64 exec, vcc
    buffer_load_dwordx4 v[28:31], v8, s[4:7], s16 offen offset:1024 sc1
    s_mov_b64 exec, -1
    s_add_u32 s23, s23, 1
    s_cmp_lt_u32 s23, 200000
    s_cbranch_scc1 g_32L2_1
    s_mov_b32 s25, 200000
    s_branch gc_33
g_32F4_2:
    s_mov_b64 exec, vcc
    buffer_load_dwordx4 v[32:35], v8, s[4:7], s16 offen offset:2048 sc1
    s_mov_b64 exec, -1
    s_add_u32 s23, s23, 1
    s_cmp_lt_u32 s23, 200000
    s_cbranch_scc1 g_32L4_2
    s_mov_b32 s25, 200000
    s_branch gc_33
g_32F8_3:
    s_mov_b64 exec, vcc
    buffer_load_dwordx4 v[36:39], v8, s[4:7], s16 offen offset:3072 sc1
    s_mov_b64 exec, -1
    s_add_u32 s23, s23, 1
    s_cmp_lt_u32 s23, 200000
    s_cbranch_scc1 g_32L8_3
    s_mov_b32 s25, 200000
    s_branch gc_33
.p2align 6
recur_fast_w1:
    s_nop 15
    s_mov_b32 s23, s25
    buffer_load_dwordx4 v[24:27], v2, s[4:7], s16 offen offset:0 sc1
    s_nop 11
    buffer_load_dwordx4 v[28:31], v2, s[4:7], s16 offen offset:1024 sc1
    s_nop 11
    buffer_load_dwordx4 v[32:35], v2, s[4:7], s16 offen offset:2048 sc1
    s_nop 11
    buffer_load_dwordx4 v[36:39], v2, s[4:7], s16 offen offset:3072 sc1
    s_waitcnt vmcnt(3)
    v_max3_u32 v19, v24, v25, v26
    v_max_u32 v19, v19, v27
    v_cmp_eq_u32 vcc, -1, v19
    s_nop 0
    s_cbranch_vccnz g_36F15_0
    v_smfmac_f32_16x16x64_bf16 v[40:43], v[24:27], a[0:7], v172
    s_waitcnt vmcnt(2)
    v_max3_u32 v19, v28, v29, v30
    v_max_u32 v19, v19, v31
    v_smfmac_f32_16x16x64_bf16 v[44:47], v[24:27], a[64:71], v172
    v_cmp_eq_u32 vcc, -1, v19
    v_smfmac_f32_16x16x64_bf16 v[48:51], v[24:27], a[32:39], v172
    v_smfmac_f32_16x16x64_bf16 v[52:55], v[24:27], a[96:103], v172
    s_cbranch_vccnz g_36F14_1
    v_smfmac_f32_16x16x64_bf16 v[40:43], v[28:31], a[8:15], v172
    s_waitcnt vmcnt(1)
    v_max3_u32 v19, v32, v33, v34
    v_max_u32 v19, v19, v35
    v_smfmac_f32_16x16x64_bf16 v[44:47], v[28:31], a[72:79], v172
    v_cmp_eq_u32 vcc, -1, v19
    v_smfmac_f32_16x16x64_bf16 v[48:51], v[28:31], a[40:47], v172
    v_smfmac_f32_16x16x64_bf16 v[52:55], v[28:31], a[104:111], v172
    s_cbranch_vccnz g_36F12_2
    v_smfmac_f32_16x16x64_bf16 v[40:43], v[32:35], a[16:23], v172
    s_waitcnt vmcnt(0)
    v_max3_u32 v19, v36, v37, v38
    v_max_u32 v19, v19, v39
    v_smfmac_f32_16x16x64_bf16 v[44:47], v[32:35], a[80:87], v172
    v_cmp_eq_u32 vcc, -1, v19
    v_smfmac_f32_16x16x64_bf16 v[48:51], v[32:35], a[48:55], v172
    v_smfmac_f32_16x16x64_bf16 v[52:55], v[32:35], a[112:119], v172
    s_cbranch_vccnz g_36F8_3
    v_smfmac_f32_16x16x64_bf16 v[40:43], v[36:39], a[24:31], v172
    v_smfmac_f32_16x16x64_bf16 v[44:47], v[36:39], a[88:95], v172
    v_smfmac_f32_16x16x64_bf16 v[48:51], v[36:39], a[56:63], v172
    v_smfmac_f32_16x16x64_bf16 v[52:55], v[36:39], a[120:127], v172
gc_37:
    v_cvt_pk_bf16_f32 v72, v40, v41
    v_cvt_pk_bf16_f32 v73, v42, v43
    v_cvt_pk_bf16_f32 v74, v44, v45
    v_cvt_pk_bf16_f32 v75, v46, v47
    ds_write_b128 v17, v[72:75] offset:0
    v_cvt_pk_bf16_f32 v76, v48, v49
    v_cvt_pk_bf16_f32 v77, v50, v51
    s_nop 0
    v_cvt_pk_bf16_f32 v78, v52, v53
    v_cvt_pk_bf16_f32 v79, v54, v55
    ds_write_b128 v17, v[76:79] offset:1024
    v_smfmac_f32_16x16x64_bf16 v[56:59], v[24:27], a[128:135], v172
    v_smfmac_f32_16x16x64_bf16 v[60:63], v[24:27], a[160:167], v172
    v_smfmac_f32_16x16x64_bf16 v[56:59], v[28:31], a[136:143], v172
    s_waitcnt lgkmcnt(0)
    s_barrier
    v_smfmac_f32_16x16x64_bf16 v[60:63], v[28:31], a[168:175], v172
    v_smfmac_f32_16x16x64_bf16 v[56:59], v[32:35], a[144:151], v172
    v_smfmac_f32_16x16x64_bf16 v[60:63], v[32:35], a[176:183], v172
    v_smfmac_f32_16x16x64_bf16 v[56:59], v[36:39], a[152:159], v172
    v_smfmac_f32_16x16x64_bf16 v[60:63], v[36:39], a[184:191], v172
    s_nop 4
    v_cvt_pk_bf16_f32 v80, v56, v57
    v_cvt_pk_bf16_f32 v81, v58, v59
    s_nop 0
    v_cvt_pk_bf16_f32 v82, v60, v61
    v_cvt_pk_bf16_f32 v83, v62, v63
    ds_write_b128 v17, v[80:83] offset:8192
    v_mov_b32 v152, v228
    v_mov_b32 v153, v229
    v_mov_b32 v156, v230
    v_mov_b32 v157, v231
    v_mov_b32 v160, v232
    v_mov_b32 v161, v233
    v_mov_b32 v164, v234
    v_mov_b32 v165, v235
    s_cmp_eq_u32 s15, 63
    s_waitcnt lgkmcnt(0)
    s_barrier
    s_cbranch_scc1 recur_end
    s_nop 15
    s_nop 15
    s_nop 7
    buffer_load_dwordx4 v[208:211], v5, s[4:7], s16 offen offset:0 sc1
    buffer_load_dwordx4 v[212:215], v5, s[4:7], s16 offen offset:1024 sc1
    buffer_load_dwordx4 v[216:219], v5, s[4:7], s16 offen offset:2048 sc1
    buffer_load_dwordx4 v[220:223], v5, s[4:7], s16 offen offset:3072 sc1
    buffer_load_dword v224, v6, s[4:7], s16 offen offset:0 sc1
    buffer_load_dword v225, v6, s[4:7], s16 offen offset:256 sc1
    buffer_load_dword v226, v6, s[4:7], s16 offen offset:512 sc1
    buffer_load_dword v227, v6, s[4:7], s16 offen offset:768 sc1
    s_mov_b32 s23, s25
    ds_read_b128 v[96:99], v16 offset:8192
    ds_read_b128 v[104:107], v16 offset:12288
    ds_read_b128 v[108:111], v16 offset:14336
    v_mfma_f32_16x16x32_bf16 v[140:143], v[84:87], v[80:83], 0
    s_waitcnt lgkmcnt(2)
    v_mfma_f32_16x16x32_bf16 v[140:143], v[84:87], v[96:99], v[140:143]
    s_waitcnt lgkmcnt(1)
    v_mfma_f32_16x16x32_bf16 v[140:143], v[84:87], v[104:107], v[140:143]
    s_waitcnt lgkmcnt(0)
    v_mfma_f32_16x16x32_bf16 v[140:143], v[84:87], v[108:111], v[140:143]
    buffer_load_dwordx4 v[24:27], v5, s[4:7], s16 offen offset:0 sc1
    buffer_load_dwordx4 v[28:31], v5, s[4:7], s16 offen offset:1024 sc1
    buffer_load_dwordx4 v[32:35], v5, s[4:7], s16 offen offset:2048 sc1
    buffer_load_dwordx4 v[36:39], v5, s[4:7], s16 offen offset:3072 sc1
    buffer_load_dword v40, v6, s[4:7], s16 offen offset:0 sc1
    buffer_load_dword v41, v6, s[4:7], s16 offen offset:256 sc1
    buffer_load_dword v42, v6, s[4:7], s16 offen offset:512 sc1
    buffer_load_dword v43, v6, s[4:7], s16 offen offset:768 sc1
    v_cvt_pk_bf16_f32 v154, v140, v179
    v_cvt_pk_bf16_f32 v158, v141, v179
    v_cvt_pk_bf16_f32 v162, v142, v179
    v_cvt_pk_bf16_f32 v166, v143, v179
    s_waitcnt vmcnt(14)
    v_pk_add_f32 v[180:181], v[208:209], v[212:213]
    v_pk_add_f32 v[182:183], v[210:211], v[214:215]
    s_waitcnt vmcnt(12)
    v_pk_add_f32 v[188:189], v[216:217], v[220:221]
    v_pk_add_f32 v[190:191], v[218:219], v[222:223]
    v_pk_add_f32 v[180:181], v[180:181], v[188:189]
    v_pk_add_f32 v[182:183], v[182:183], v[190:191]
    v_pk_add_f32 v[188:189], v[180:181], v[182:183]
    v_max3_f32 v185, v180, v181, v182
    s_waitcnt vmcnt(8)
    v_pk_add_f32 v[192:193], v[224:225], v[226:227]
    v_add_f32 v188, v188, v189
    v_add_f32 v184, v192, v193
    v_max3_f32 v185, v185, v183, v184
    v_cmp_u_f32 vcc, v188, v184
    s_nop 0
    v_max_f32_dpp v185, v185, v185 row_ror:8 row_mask:0xf bank_mask:0xf
    v_mov_b32 v186, v185
    s_nop 1
    v_permlane16_swap_b32 v185, v186
    v_max_f32 v185, v185, v186
    v_mov_b32 v186, v185
    s_cbranch_vccnz ss_38r
sg_40:
    s_nop 0
    v_permlane32_swap_b32 v185, v186
    v_max_f32 v185, v185, v186
    v_mul_f32 v185, s24, v185
    v_fma_f32 v180, v180, s24, -v185
    v_fma_f32 v181, v181, s24, -v185
    v_fma_f32 v182, v182, s24, -v185
    v_fma_f32 v183, v183, s24, -v185
    v_fma_f32 v184, v184, s24, -v185
    v_exp_f32 v180, v180
    v_exp_f32 v181, v181
    v_exp_f32 v182, v182
    v_exp_f32 v183, v183
    v_exp_f32 v184, v184
    v_cvt_pk_bf16_f32 v176, v180, v181
    v_cvt_pk_bf16_f32 v177, v182, v183
    v_cvt_pk_bf16_f32 v178, v184, v179
    s_nop 1
    v_mfma_f32_16x16x32_bf16 v[240:243], v[236:239], v[176:179], 0
    v_mfma_f32_16x16x32_bf16 v[188:191], v[152:155], v[176:179], 0
    v_mfma_f32_16x16x32_bf16 v[192:195], v[156:159], v[176:179], 0
    v_mfma_f32_16x16x32_bf16 v[196:199], v[160:163], v[176:179], 0
    v_mfma_f32_16x16x32_bf16 v[200:203], v[164:167], v[176:179], 0
    v_add_f32_dpp v185, v240, v240 row_ror:8 row_mask:0xf bank_mask:0xf
    v_rcp_f32 v185, v185
    v_add_f32_dpp v88, v192, v188 row_ror:8 row_mask:0xf bank_mask:0x3
    v_add_f32_dpp v89, v193, v189 row_ror:8 row_mask:0xf bank_mask:0x3
    v_add_f32_dpp v90, v194, v190 row_ror:8 row_mask:0xf bank_mask:0x3
    v_add_f32_dpp v91, v195, v191 row_ror:8 row_mask:0xf bank_mask:0x3
    s_nop 1
    v_add_f32_dpp v88, v196, v200 row_ror:8 row_mask:0xf bank_mask:0xc
    v_add_f32_dpp v89, v197, v201 row_ror:8 row_mask:0xf bank_mask:0xc
    v_add_f32_dpp v90, v198, v202 row_ror:8 row_mask:0xf bank_mask:0xc
    v_add_f32_dpp v91, v199, v203 row_ror:8 row_mask:0xf bank_mask:0xc
    v_mul_f32 v88, v88, v185
    v_mul_f32 v89, v89, v185
    v_mul_f32 v90, v90, v185
    v_mul_f32 v91, v91, v185
    v_cvt_pk_bf16_f32 v88, v88, v89
    v_cvt_pk_bf16_f32 v89, v90, v91
    buffer_store_dwordx2 v[88:89], v7, s[4:7], s16 offen
    v_readfirstlane_b32 s85, v247
    s_add_u32 s94, s15, 2
    s_barrier
    s_nop 15
    s_mov_b32 s23, s25
    buffer_load_dwordx4 v[24:27], v8, s[4:7], s16 offen offset:0 sc1
    s_nop 11
    buffer_load_dwordx4 v[28:31], v8, s[4:7], s16 offen offset:1024 sc1
    s_nop 11
    buffer_load_dwordx4 v[32:35], v8, s[4:7], s16 offen offset:2048 sc1
    s_nop 11
    buffer_load_dwordx4 v[36:39], v8, s[4:7], s16 offen offset:3072 sc1
    s_waitcnt vmcnt(3)
    v_max3_u32 v19, v24, v25, v26
    v_max_u32 v19, v19, v27
    v_cmp_eq_u32 vcc, -1, v19
    s_nop 0
    s_cbranch_vccnz g_41F15_0
    v_smfmac_f32_16x16x64_bf16 v[64:67], v[24:27], a[192:199], v172
    v_smfmac_f32_16x16x64_bf16 v[68:71], v[24:27], a[224:231], v172
    s_waitcnt vmcnt(2)
    v_max3_u32 v19, v28, v29, v30
    v_max_u32 v19, v19, v31
    v_cmp_eq_u32 vcc, -1, v19
    s_nop 0
    s_cbranch_vccnz g_41F14_1
    v_smfmac_f32_16x16x64_bf16 v[64:67], v[28:31], a[200:207], v172
    v_smfmac_f32_16x16x64_bf16 v[68:71], v[28:31], a[232:239], v172
    s_waitcnt vmcnt(1)
    v_max3_u32 v19, v32, v33, v34
    v_max_u32 v19, v19, v35
    v_cmp_eq_u32 vcc, -1, v19
    s_nop 0
    s_cbranch_vccnz g_41F12_2
    v_smfmac_f32_16x16x64_bf16 v[64:67], v[32:35], a[208:215], v172
    v_smfmac_f32_16x16x64_bf16 v[68:71], v[32:35], a[240:247], v172
    s_waitcnt vmcnt(0)
    v_max3_u32 v19, v36, v37, v38
    v_max_u32 v19, v19, v39
    v_cmp_eq_u32 vcc, -1, v19
    s_nop 0
    s_cbranch_vccnz g_41F8_3
    v_smfmac_f32_16x16x64_bf16 v[64:67], v[36:39], a[216:223], v172
    v_smfmac_f32_16x16x64_bf16 v[68:71], v[36:39], a[248:255], v172
    s_nop 4
    v_cvt_pk_bf16_f32 v80, v64, v65
    v_cvt_pk_bf16_f32 v81, v66, v67
    s_nop 0
    v_cvt_pk_bf16_f32 v82, v68, v69
    v_cvt_pk_bf16_f32 v83, v70, v71
    ds_write_b128 v17, v[80:83] offset:9216
gc_42:
    s_waitcnt lgkmcnt(0)
    s_barrier
    s_mov_b32 s23, s25
fw_43:
    s_cmp_ge_u32 s85, s94
    s_cbranch_scc1 fo_44
    buffer_load_dword v247, v245, s[4:7], 0 offen sc1
    s_add_u32 s23, s23, 1
    s_waitcnt vmcnt(0)
    v_readfirstlane_b32 s85, v247
    s_cmp_lt_u32 s23, 200000
    s_cbranch_scc1 fw_43
    s_mov_b32 s25, 200000
fo_44:
    buffer_load_dwordx4 v[228:231], v13, s[4:7], s18 offen offset:0 sc1
    buffer_load_dwordx4 v[232:235], v13, s[4:7], s18 offen offset:128 sc1
    s_add_u32 s18, s18, 2048
    s_min_u32 s18, s18, 35780608
    s_nop 15
    s_nop 15
    s_nop 15
    s_nop 15
    s_add_u32 s21, s15, 3
    s_min_u32 s21, s21, 64
    s_cmp_lt_u32 s85, s21
    s_cselect_b64 exec, 1, 0
    buffer_load_dword v247, v245, s[4:7], 0 offen sc1
    s_mov_b64 exec, -1
    v_mov_b32 v40, 0
    v_mov_b32 v41, 0
    v_mov_b32 v42, 0
    v_mov_b32 v43, 0
    v_mov_b32 v44, 0
    v_mov_b32 v45, 0
    v_mov_b32 v46, 0
    v_mov_b32 v47, 0
    v_mov_b32 v48, 0
    v_mov_b32 v49, 0
    v_mov_b32 v50, 0
    v_mov_b32 v51, 0
    v_mov_b32 v52, 0
    v_mov_b32 v53, 0
    v_mov_b32 v54, 0
    v_mov_b32 v55, 0
    v_mov_b32 v56, 0
    v_mov_b32 v57, 0
    v_mov_b32 v58, 0
    v_mov_b32 v59, 0
    v_mov_b32 v60, 0
    v_mov_b32 v61, 0
    v_mov_b32 v62, 0
    v_mov_b32 v63, 0
    v_mov_b32 v64, 0
    v_mov_b32 v65, 0
    v_mov_b32 v66, 0
    v_mov_b32 v67, 0
    v_mov_b32 v68, 0
    v_mov_b32 v69, 0
    v_mov_b32 v70, 0
    v_mov_b32 v71, 0
    s_mov_b32 s21, s16
    s_mov_b32 s16, s42
    s_mov_b32 s42, s43
    s_mov_b32 s43, s44
    s_mov_b32 s44, s21
    s_add_u32 s95, s95, 524288
    s_lshr_b32 s84, s95, 8
    s_and_b32 s84, s84, 8192
    s_xor_b32 s84, s84, s46
    s_add_u32 s84, s84, s95
    s_add_u32 s15, s15, 1
    s_barrier
    s_branch recur_fast_w1
g_36L15_0:
    s_waitcnt vmcnt(3)
    v_max3_u32 v19, v24, v25, v26
    v_max_u32 v19, v19, v27
    v_cmp_eq_u32 vcc, -1, v19
    s_nop 0
    s_cbranch_vccnz g_36F15_0
    v_smfmac_f32_16x16x64_bf16 v[40:43], v[24:27], a[0:7], v172
    v_smfmac_f32_16x16x64_bf16 v[44:47], v[24:27], a[64:71], v172
    v_smfmac_f32_16x16x64_bf16 v[48:51], v[24:27], a[32:39], v172
    v_smfmac_f32_16x16x64_bf16 v[52:55], v[24:27], a[96:103], v172
g_36L14_1:
    s_waitcnt vmcnt(2)
    v_max3_u32 v19, v28, v29, v30
    v_max_u32 v19, v19, v31
    v_cmp_eq_u32 vcc, -1, v19
    s_nop 0
    s_cbranch_vccnz g_36F14_1
    v_smfmac_f32_16x16x64_bf16 v[40:43], v[28:31], a[8:15], v172
    v_smfmac_f32_16x16x64_bf16 v[44:47], v[28:31], a[72:79], v172
    v_smfmac_f32_16x16x64_bf16 v[48:51], v[28:31], a[40:47], v172
    v_smfmac_f32_16x16x64_bf16 v[52:55], v[28:31], a[104:111], v172
g_36L12_2:
    s_waitcnt vmcnt(1)
    v_max3_u32 v19, v32, v33, v34
    v_max_u32 v19, v19, v35
    v_cmp_eq_u32 vcc, -1, v19
    s_nop 0
    s_cbranch_vccnz g_36F12_2
    v_smfmac_f32_16x16x64_bf16 v[40:43], v[32:35], a[16:23], v172
    v_smfmac_f32_16x16x64_bf16 v[44:47], v[32:35], a[80:87], v172
    v_smfmac_f32_16x16x64_bf16 v[48:51], v[32:35], a[48:55], v172
    v_smfmac_f32_16x16x64_bf16 v[52:55], v[32:35], a[112:119], v172
g_36L8_3:
    s_waitcnt vmcnt(0)
    v_max3_u32 v19, v36, v37, v38
    v_max_u32 v19, v19, v39
    v_cmp_eq_u32 vcc, -1, v19
    s_nop 0
    s_cbranch_vccnz g_36F8_3
    v_smfmac_f32_16x16x64_bf16 v[40:43], v[36:39], a[24:31], v172
    v_smfmac_f32_16x16x64_bf16 v[44:47], v[36:39], a[88:95], v172
    v_smfmac_f32_16x16x64_bf16 v[48:51], v[36:39], a[56:63], v172
    v_smfmac_f32_16x16x64_bf16 v[52:55], v[36:39], a[120:127], v172
    s_branch gc_37
g_36L15_1:
    s_waitcnt vmcnt(3)
    v_max3_u32 v19, v28, v29, v30
    v_max_u32 v19, v19, v31
    v_cmp_eq_u32 vcc, -1, v19
    s_nop 0
    s_cbranch_vccnz g_36F15_1
    v_smfmac_f32_16x16x64_bf16 v[40:43], v[28:31], a[8:15], v172
    v_smfmac_f32_16x16x64_bf16 v[44:47], v[28:31], a[72:79], v172
    v_smfmac_f32_16x16x64_bf16 v[48:51], v[28:31], a[40:47], v172
    v_smfmac_f32_16x16x64_bf16 v[52:55], v[28:31], a[104:111], v172
g_36L13_2:
    s_waitcnt vmcnt(2)
    v_max3_u32 v19, v32, v33, v34
    v_max_u32 v19, v19, v35
    v_cmp_eq_u32 vcc, -1, v19
    s_nop 0
    s_cbranch_vccnz g_36F13_2
    v_smfmac_f32_16x16x64_bf16 v[40:43], v[32:35], a[16:23], v172
    v_smfmac_f32_16x16x64_bf16 v[44:47], v[32:35], a[80:87], v172
    v_smfmac_f32_16x16x64_bf16 v[48:51], v[32:35], a[48:55], v172
    v_smfmac_f32_16x16x64_bf16 v[52:55], v[32:35], a[112:119], v172
g_36L9_3:
    s_waitcnt vmcnt(1)
    v_max3_u32 v19, v36, v37, v38
    v_max_u32 v19, v19, v39
    v_cmp_eq_u32 vcc, -1, v19
    s_nop 0
    s_cbranch_vccnz g_36F9_3
    v_smfmac_f32_16x16x64_bf16 v[40:43], v[36:39], a[24:31], v172
    v_smfmac_f32_16x16x64_bf16 v[44:47], v[36:39], a[88:95], v172
    v_smfmac_f32_16x16x64_bf16 v[48:51], v[36:39], a[56:63], v172
    v_smfmac_f32_16x16x64_bf16 v[52:55], v[36:39], a[120:127], v172
g_36L1_0:
    s_waitcnt vmcnt(0)
    v_max3_u32 v19, v24, v25, v26
    v_max_u32 v19, v19, v27
    v_cmp_eq_u32 vcc, -1, v19
    s_nop 0
    s_cbranch_vccnz g_36F1_0
    v_smfmac_f32_16x16x64_bf16 v[40:43], v[24:27], a[0:7], v172
    v_smfmac_f32_16x16x64_bf16 v[44:47], v[24:27], a[64:71], v172
    v_smfmac_f32_16x16x64_bf16 v[48:51], v[24:27], a[32:39], v172
    v_smfmac_f32_16x16x64_bf16 v[52:55], v[24:27], a[96:103], v172
    s_branch gc_37
g_36L15_2:
    s_waitcnt vmcnt(3)
    v_max3_u32 v19, v32, v33, v34
    v_max_u32 v19, v19, v35
    v_cmp_eq_u32 vcc, -1, v19
    s_nop 0
    s_cbranch_vccnz g_36F15_2
    v_smfmac_f32_16x16x64_bf16 v[40:43], v[32:35], a[16:23], v172
    v_smfmac_f32_16x16x64_bf16 v[44:47], v[32:35], a[80:87], v172
    v_smfmac_f32_16x16x64_bf16 v[48:51], v[32:35], a[48:55], v172
    v_smfmac_f32_16x16x64_bf16 v[52:55], v[32:35], a[112:119], v172
g_36L11_3:
    s_waitcnt vmcnt(2)
    v_max3_u32 v19, v36, v37, v38
    v_max_u32 v19, v19, v39
    v_cmp_eq_u32 vcc, -1, v19
    s_nop 0
    s_cbranch_vccnz g_36F11_3
    v_smfmac_f32_16x16x64_bf16 v[40:43], v[36:39], a[24:31], v172
    v_smfmac_f32_16x16x64_bf16 v[44:47], v[36:39], a[88:95], v172
    v_smfmac_f32_16x16x64_bf16 v[48:51], v[36:39], a[56:63], v172
    v_smfmac_f32_16x16x64_bf16 v[52:55], v[36:39], a[120:127], v172
g_36L3_0:
    s_waitcnt vmcnt(1)
    v_max3_u32 v19, v24, v25, v26
    v_max_u32 v19, v19, v27
    v_cmp_eq_u32 vcc, -1, v19
    s_nop 0
    s_cbranch_vccnz g_36F3_0
    v_smfmac_f32_16x16x64_bf16 v[40:43], v[24:27], a[0:7], v172
    v_smfmac_f32_16x16x64_bf16 v[44:47], v[24:27], a[64:71], v172
    v_smfmac_f32_16x16x64_bf16 v[48:51], v[24:27], a[32:39], v172
    v_smfmac_f32_16x16x64_bf16 v[52:55], v[24:27], a[96:103], v172
g_36L2_1:
    s_waitcnt vmcnt(0)
    v_max3_u32 v19, v28, v29, v30
    v_max_u32 v19, v19, v31
    v_cmp_eq_u32 vcc, -1, v19
    s_nop 0
    s_cbranch_vccnz g_36F2_1
    v_smfmac_f32_16x16x64_bf16 v[40:43], v[28:31], a[8:15], v172
    v_smfmac_f32_16x16x64_bf16 v[44:47], v[28:31], a[72:79], v172
    v_smfmac_f32_16x16x64_bf16 v[48:51], v[28:31], a[40:47], v172
    v_smfmac_f32_16x16x64_bf16 v[52:55], v[28:31], a[104:111], v172
    s_branch gc_37
g_36L15_3:
    s_waitcnt vmcnt(3)
    v_max3_u32 v19, v36, v37, v38
    v_max_u32 v19, v19, v39
    v_cmp_eq_u32 vcc, -1, v19
    s_nop 0
    s_cbranch_vccnz g_36F15_3
    v_smfmac_f32_16x16x64_bf16 v[40:43], v[36:39], a[24:31], v172
    v_smfmac_f32_16x16x64_bf16 v[44:47], v[36:39], a[88:95], v172
    v_smfmac_f32_16x16x64_bf16 v[48:51], v[36:39], a[56:63], v172
    v_smfmac_f32_16x16x64_bf16 v[52:55], v[36:39], a[120:127], v172
g_36L7_0:
    s_waitcnt vmcnt(2)
    v_max3_u32 v19, v24, v25, v26
    v_max_u32 v19, v19, v27
    v_cmp_eq_u32 vcc, -1, v19
    s_nop 0
    s_cbranch_vccnz g_36F7_0
    v_smfmac_f32_16x16x64_bf16 v[40:43], v[24:27], a[0:7], v172
    v_smfmac_f32_16x16x64_bf16 v[44:47], v[24:27], a[64:71], v172
    v_smfmac_f32_16x16x64_bf16 v[48:51], v[24:27], a[32:39], v172
    v_smfmac_f32_16x16x64_bf16 v[52:55], v[24:27], a[96:103], v172
g_36L6_1:
    s_waitcnt vmcnt(1)
    v_max3_u32 v19, v28, v29, v30
    v_max_u32 v19, v19, v31
    v_cmp_eq_u32 vcc, -1, v19
    s_nop 0
    s_cbranch_vccnz g_36F6_1
    v_smfmac_f32_16x16x64_bf16 v[40:43], v[28:31], a[8:15], v172
    v_smfmac_f32_16x16x64_bf16 v[44:47], v[28:31], a[72:79], v172
    v_smfmac_f32_16x16x64_bf16 v[48:51], v[28:31], a[40:47], v172
    v_smfmac_f32_16x16x64_bf16 v[52:55], v[28:31], a[104:111], v172
g_36L4_2:
    s_waitcnt vmcnt(0)
    v_max3_u32 v19, v32, v33, v34
    v_max_u32 v19, v19, v35
    v_cmp_eq_u32 vcc, -1, v19
    s_nop 0
    s_cbranch_vccnz g_36F4_2
    v_smfmac_f32_16x16x64_bf16 v[40:43], v[32:35], a[16:23], v172
    v_smfmac_f32_16x16x64_bf16 v[44:47], v[32:35], a[80:87], v172
    v_smfmac_f32_16x16x64_bf16 v[48:51], v[32:35], a[48:55], v172
    v_smfmac_f32_16x16x64_bf16 v[52:55], v[32:35], a[112:119], v172
    s_branch gc_37
g_36L7_1:
    s_waitcnt vmcnt(2)
    v_max3_u32 v19, v28, v29, v30
    v_max_u32 v19, v19, v31
    v_cmp_eq_u32 vcc, -1, v19
    s_nop 0
    s_cbranch_vccnz g_36F7_1
    v_smfmac_f32_16x16x64_bf16 v[40:43], v[28:31], a[8:15], v172
    v_smfmac_f32_16x16x64_bf16 v[44:47], v[28:31], a[72:79], v172
    v_smfmac_f32_16x16x64_bf16 v[48:51], v[28:31], a[40:47], v172
    v_smfmac_f32_16x16x64_bf16 v[52:55], v[28:31], a[104:111], v172
g_36L5_2:
    s_waitcnt vmcnt(1)
    v_max3_u32 v19, v32, v33, v34
    v_max_u32 v19, v19, v35
    v_cmp_eq_u32 vcc, -1, v19
    s_nop 0
    s_cbranch_vccnz g_36F5_2
    v_smfmac_f32_16x16x64_bf16 v[40:43], v[32:35], a[16:23], v172
    v_smfmac_f32_16x16x64_bf16 v[44:47], v[32:35], a[80:87], v172
    v_smfmac_f32_16x16x64_bf16 v[48:51], v[32:35], a[48:55], v172
    v_smfmac_f32_16x16x64_bf16 v[52:55], v[32:35], a[112:119], v172
    s_branch g_36L1_0
g_36L7_2:
    s_waitcnt vmcnt(2)
    v_max3_u32 v19, v32, v33, v34
    v_max_u32 v19, v19, v35
    v_cmp_eq_u32 vcc, -1, v19
    s_nop 0
    s_cbranch_vccnz g_36F7_2
    v_smfmac_f32_16x16x64_bf16 v[40:43], v[32:35], a[16:23], v172
    v_smfmac_f32_16x16x64_bf16 v[44:47], v[32:35], a[80:87], v172
    v_smfmac_f32_16x16x64_bf16 v[48:51], v[32:35], a[48:55], v172
    v_smfmac_f32_16x16x64_bf16 v[52:55], v[32:35], a[112:119], v172
    s_branch g_36L3_0
g_36L11_0:
    s_waitcnt vmcnt(2)
    v_max3_u32 v19, v24, v25, v26
    v_max_u32 v19, v19, v27
    v_cmp_eq_u32 vcc, -1, v19
    s_nop 0
    s_cbranch_vccnz g_36F11_0
    v_smfmac_f32_16x16x64_bf16 v[40:43], v[24:27], a[0:7], v172
    v_smfmac_f32_16x16x64_bf16 v[44:47], v[24:27], a[64:71], v172
    v_smfmac_f32_16x16x64_bf16 v[48:51], v[24:27], a[32:39], v172
    v_smfmac_f32_16x16x64_bf16 v[52:55], v[24:27], a[96:103], v172
g_36L10_1:
    s_waitcnt vmcnt(1)
    v_max3_u32 v19, v28, v29, v30
    v_max_u32 v19, v19, v31
    v_cmp_eq_u32 vcc, -1, v19
    s_nop 0
    s_cbranch_vccnz g_36F10_1
    v_smfmac_f32_16x16x64_bf16 v[40:43], v[28:31], a[8:15], v172
    v_smfmac_f32_16x16x64_bf16 v[44:47], v[28:31], a[72:79], v172
    v_smfmac_f32_16x16x64_bf16 v[48:51], v[28:31], a[40:47], v172
    v_smfmac_f32_16x16x64_bf16 v[52:55], v[28:31], a[104:111], v172
    s_branch g_36L8_3
g_36L11_1:
    s_waitcnt vmcnt(2)
    v_max3_u32 v19, v28, v29, v30
    v_max_u32 v19, v19, v31
    v_cmp_eq_u32 vcc, -1, v19
    s_nop 0
    s_cbranch_vccnz g_36F11_1
    v_smfmac_f32_16x16x64_bf16 v[40:43], v[28:31], a[8:15], v172
    v_smfmac_f32_16x16x64_bf16 v[44:47], v[28:31], a[72:79], v172
    v_smfmac_f32_16x16x64_bf16 v[48:51], v[28:31], a[40:47], v172
    v_smfmac_f32_16x16x64_bf16 v[52:55], v[28:31], a[104:111], v172
    s_branch g_36L9_3
g_36L13_0:
    s_waitcnt vmcnt(2)
    v_max3_u32 v19, v24, v25, v26
    v_max_u32 v19, v19, v27
    v_cmp_eq_u32 vcc, -1, v19
    s_nop 0
    s_cbranch_vccnz g_36F13_0
    v_smfmac_f32_16x16x64_bf16 v[40:43], v[24:27], a[0:7], v172
    v_smfmac_f32_16x16x64_bf16 v[44:47], v[24:27], a[64:71], v172
    v_smfmac_f32_16x16x64_bf16 v[48:51], v[24:27], a[32:39], v172
    v_smfmac_f32_16x16x64_bf16 v[52:55], v[24:27], a[96:103], v172
    s_branch g_36L12_2
g_36L13_3:
    s_waitcnt vmcnt(2)
    v_max3_u32 v19, v36, v37, v38
    v_max_u32 v19, v19, v39
    v_cmp_eq_u32 vcc, -1, v19
    s_nop 0
    s_cbranch_vccnz g_36F13_3
    v_smfmac_f32_16x16x64_bf16 v[40:43], v[36:39], a[24:31], v172
    v_smfmac_f32_16x16x64_bf16 v[44:47], v[36:39], a[88:95], v172
    v_smfmac_f32_16x16x64_bf16 v[48:51], v[36:39], a[56:63], v172
    v_smfmac_f32_16x16x64_bf16 v[52:55], v[36:39], a[120:127], v172
g_36L5_0:
    s_waitcnt vmcnt(1)
    v_max3_u32 v19, v24, v25, v26
    v_max_u32 v19, v19, v27
    v_cmp_eq_u32 vcc, -1, v19
    s_nop 0
    s_cbranch_vccnz g_36F5_0
    v_smfmac_f32_16x16x64_bf16 v[40:43], v[24:27], a[0:7], v172
    v_smfmac_f32_16x16x64_bf16 v[44:47], v[24:27], a[64:71], v172
    v_smfmac_f32_16x16x64_bf16 v[48:51], v[24:27], a[32:39], v172
    v_smfmac_f32_16x16x64_bf16 v[52:55], v[24:27], a[96:103], v172
    s_branch g_36L4_2
g_36L14_2:
    s_waitcnt vmcnt(2)
    v_max3_u32 v19, v32, v33, v34
    v_max_u32 v19, v19, v35
    v_cmp_eq_u32 vcc, -1, v19
    s_nop 0
    s_cbranch_vccnz g_36F14_2
    v_smfmac_f32_16x16x64_bf16 v[40:43], v[32:35], a[16:23], v172
    v_smfmac_f32_16x16x64_bf16 v[44:47], v[32:35], a[80:87], v172
    v_smfmac_f32_16x16x64_bf16 v[48:51], v[32:35], a[48:55], v172
    v_smfmac_f32_16x16x64_bf16 v[52:55], v[32:35], a[112:119], v172
g_36L10_3:
    s_waitcnt vmcnt(1)
    v_max3_u32 v19, v36, v37, v38
    v_max_u32 v19, v19, v39
    v_cmp_eq_u32 vcc, -1, v19
    s_nop 0
    s_cbranch_vccnz g_36F10_3
    v_smfmac_f32_16x16x64_bf16 v[40:43], v[36:39], a[24:31], v172
    v_smfmac_f32_16x16x64_bf16 v[44:47], v[36:39], a[88:95], v172
    v_smfmac_f32_16x16x64_bf16 v[48:51], v[36:39], a[56:63], v172
    v_smfmac_f32_16x16x64_bf16 v[52:55], v[36:39], a[120:127], v172
    s_branch g_36L2_1
g_36L14_3:
    s_waitcnt vmcnt(2)
    v_max3_u32 v19, v36, v37, v38
    v_max_u32 v19, v19, v39
    v_cmp_eq_u32 vcc, -1, v19
    s_nop 0
    s_cbranch_vccnz g_36F14_3
    v_smfmac_f32_16x16x64_bf16 v[40:43], v[36:39], a[24:31], v172
    v_smfmac_f32_16x16x64_bf16 v[44:47], v[36:39], a[88:95], v172
    v_smfmac_f32_16x16x64_bf16 v[48:51], v[36:39], a[56:63], v172
    v_smfmac_f32_16x16x64_bf16 v[52:55], v[36:39], a[120:127], v172
    s_branch g_36L6_1
g_36L3_1:
    s_waitcnt vmcnt(1)
    v_max3_u32 v19, v28, v29, v30
    v_max_u32 v19, v19, v31
    v_cmp_eq_u32 vcc, -1, v19
    s_nop 0
    s_cbranch_vccnz g_36F3_1
    v_smfmac_f32_16x16x64_bf16 v[40:43], v[28:31], a[8:15], v172
    v_smfmac_f32_16x16x64_bf16 v[44:47], v[28:31], a[72:79], v172
    v_smfmac_f32_16x16x64_bf16 v[48:51], v[28:31], a[40:47], v172
    v_smfmac_f32_16x16x64_bf16 v[52:55], v[28:31], a[104:111], v172
    s_branch g_36L1_0
g_36L6_2:
    s_waitcnt vmcnt(1)
    v_max3_u32 v19, v32, v33, v34
    v_max_u32 v19, v19, v35
    v_cmp_eq_u32 vcc, -1, v19
    s_nop 0
    s_cbranch_vccnz g_36F6_2
    v_smfmac_f32_16x16x64_bf16 v[40:43], v[32:35], a[16:23], v172
    v_smfmac_f32_16x16x64_bf16 v[44:47], v[32:35], a[80:87], v172
    v_smfmac_f32_16x16x64_bf16 v[48:51], v[32:35], a[48:55], v172
    v_smfmac_f32_16x16x64_bf16 v[52:55], v[32:35], a[112:119], v172
    s_branch g_36L2_1
g_36L9_0:
    s_waitcnt vmcnt(1)
    v_max3_u32 v19, v24, v25, v26
    v_max_u32 v19, v19, v27
    v_cmp_eq_u32 vcc, -1, v19
    s_nop 0
    s_cbranch_vccnz g_36F9_0
    v_smfmac_f32_16x16x64_bf16 v[40:43], v[24:27], a[0:7], v172
    v_smfmac_f32_16x16x64_bf16 v[44:47], v[24:27], a[64:71], v172
    v_smfmac_f32_16x16x64_bf16 v[48:51], v[24:27], a[32:39], v172
    v_smfmac_f32_16x16x64_bf16 v[52:55], v[24:27], a[96:103], v172
    s_branch g_36L8_3
g_36L12_3:
    s_waitcnt vmcnt(1)
    v_max3_u32 v19, v36, v37, v38
    v_max_u32 v19, v19, v39
    v_cmp_eq_u32 vcc, -1, v19
    s_nop 0
    s_cbranch_vccnz g_36F12_3
    v_smfmac_f32_16x16x64_bf16 v[40:43], v[36:39], a[24:31], v172
    v_smfmac_f32_16x16x64_bf16 v[44:47], v[36:39], a[88:95], v172
    v_smfmac_f32_16x16x64_bf16 v[48:51], v[36:39], a[56:63], v172
    v_smfmac_f32_16x16x64_bf16 v[52:55], v[36:39], a[120:127], v172
    s_branch g_36L4_2
g_36F15_0:
    s_mov_b64 exec, vcc
    buffer_load_dwordx4 v[24:27], v2, s[4:7], s16 offen offset:0 sc1
    s_mov_b64 exec, -1
    s_add_u32 s23, s23, 1
    s_cmp_lt_u32 s23, 200000
    s_cbranch_scc1 g_36L15_1
    s_mov_b32 s25, 200000
    s_branch gc_37
g_36F15_1:
    s_mov_b64 exec, vcc
    buffer_load_dwordx4 v[28:31], v2, s[4:7], s16 offen offset:1024 sc1
    s_mov_b64 exec, -1
    s_add_u32 s23, s23, 1
    s_cmp_lt_u32 s23, 200000
    s_cbranch_scc1 g_36L15_2
    s_mov_b32 s25, 200000
    s_branch gc_37
g_36F15_2:
    s_mov_b64 exec, vcc
    buffer_load_dwordx4 v[32:35], v2, s[4:7], s16 offen offset:2048 sc1
    s_mov_b64 exec, -1
    s_add_u32 s23, s23, 1
    s_cmp_lt_u32 s23, 200000
    s_cbranch_scc1 g_36L15_3
    s_mov_b32 s25, 200000
    s_branch gc_37
g_36F15_3:
    s_mov_b64 exec, vcc
    buffer_load_dwordx4 v[36:39], v2, s[4:7], s16 offen offset:3072 sc1
    s_mov_b64 exec, -1
    s_add_u32 s23, s23, 1
    s_cmp_lt_u32 s23, 200000
    s_cbranch_scc1 g_36L15_0
    s_mov_b32 s25, 200000
    s_branch gc_37
g_36F7_0:
    s_mov_b64 exec, vcc
    buffer_load_dwordx4 v[24:27], v2, s[4:7], s16 offen offset:0 sc1
    s_mov_b64 exec, -1
    s_add_u32 s23, s23, 1
    s_cmp_lt_u32 s23, 200000
    s_cbranch_scc1 g_36L7_1
    s_mov_b32 s25, 200000
    s_branch gc_37
g_36F7_1:
    s_mov_b64 exec, vcc
    buffer_load_dwordx4 v[28:31], v2, s[4:7], s16 offen offset:1024 sc1
    s_mov_b64 exec, -1
    s_add_u32 s23, s23, 1
    s_cmp_lt_u32 s23, 200000
    s_cbranch_scc1 g_36L7_2
    s_mov_b32 s25, 200000
    s_branch gc_37
g_36F7_2:
    s_mov_b64 exec, vcc
    buffer_load_dwordx4 v[32:35], v2, s[4:7], s16 offen offset:2048 sc1
    s_mov_b64 exec, -1
    s_add_u32 s23, s23, 1
    s_cmp_lt_u32 s23, 200000
    s_cbranch_scc1 g_36L7_0
    s_mov_b32 s25, 200000
    s_branch gc_37
g_36F11_0:
    s_mov_b64 exec, vcc
    buffer_load_dwordx4 v[24:27], v2, s[4:7], s16 offen offset:0 sc1
    s_mov_b64 exec, -1
    s_add_u32 s23, s23, 1
    s_cmp_lt_u32 s23, 200000
    s_cbranch_scc1 g_36L11_1
    s_mov_b32 s25, 200000
    s_branch gc_37
g_36F11_1:
    s_mov_b64 exec, vcc
    buffer_load_dwordx4 v[28:31], v2, s[4:7], s16 offen offset:1024 sc1
    s_mov_b64 exec, -1
    s_add_u32 s23, s23, 1
    s_cmp_lt_u32 s23, 200000
    s_cbranch_scc1 g_36L11_3
    s_mov_b32 s25, 200000
    s_branch gc_37
g_36F11_3:
    s_mov_b64 exec, vcc
    buffer_load_dwordx4 v[36:39], v2, s[4:7], s16 offen offset:3072 sc1
    s_mov_b64 exec, -1
    s_add_u32 s23, s23, 1
    s_cmp_lt_u32 s23, 200000
    s_cbranch_scc1 g_36L11_0
    s_mov_b32 s25, 200000
    s_branch gc_37
g_36F13_0:
    s_mov_b64 exec, vcc
    buffer_load_dwordx4 v[24:27], v2, s[4:7], s16 offen offset:0 sc1
    s_mov_b64 exec, -1
    s_add_u32 s23, s23, 1
    s_cmp_lt_u32 s23, 200000
    s_cbranch_scc1 g_36L13_2
    s_mov_b32 s25, 200000
    s_branch gc_37
g_36F13_2:
    s_mov_b64 exec, vcc
    buffer_load_dwordx4 v[32:35], v2, s[4:7], s16 offen offset:2048 sc1
    s_mov_b64 exec, -1
    s_add_u32 s23, s23, 1
    s_cmp_lt_u32 s23, 200000
    s_cbranch_scc1 g_36L13_3
    s_mov_b32 s25, 200000
    s_branch gc_37
g_36F13_3:
    s_mov_b64 exec, vcc
    buffer_load_dwordx4 v[36:39], v2, s[4:7], s16 offen offset:3072 sc1
    s_mov_b64 exec, -1
    s_add_u32 s23, s23, 1
    s_cmp_lt_u32 s23, 200000
    s_cbranch_scc1 g_36L13_0
    s_mov_b32 s25, 200000
    s_branch gc_37
g_36F14_1:
    s_mov_b64 exec, vcc
    buffer_load_dwordx4 v[28:31], v2, s[4:7], s16 offen offset:1024 sc1
    s_mov_b64 exec, -1
    s_add_u32 s23, s23, 1
    s_cmp_lt_u32 s23, 200000
    s_cbranch_scc1 g_36L14_2
    s_mov_b32 s25, 200000
    s_branch gc_37
g_36F14_2:
    s_mov_b64 exec, vcc
    buffer_load_dwordx4 v[32:35], v2, s[4:7], s16 offen offset:2048 sc1
    s_mov_b64 exec, -1
    s_add_u32 s23, s23, 1
    s_cmp_lt_u32 s23, 200000
    s_cbranch_scc1 g_36L14_3
    s_mov_b32 s25, 200000
    s_branch gc_37
g_36F14_3:
    s_mov_b64 exec, vcc
    buffer_load_dwordx4 v[36:39], v2, s[4:7], s16 offen offset:3072 sc1
    s_mov_b64 exec, -1
    s_add_u32 s23, s23, 1
    s_cmp_lt_u32 s23, 200000
    s_cbranch_scc1 g_36L14_1
    s_mov_b32 s25, 200000
    s_branch gc_37
g_36F3_0:
    s_mov_b64 exec, vcc
    buffer_load_dwordx4 v[24:27], v2, s[4:7], s16 offen offset:0 sc1
    s_mov_b64 exec, -1
    s_add_u32 s23, s23, 1
    s_cmp_lt_u32 s23, 200000
    s_cbranch_scc1 g_36L3_1
    s_mov_b32 s25, 200000
    s_branch gc_37
g_36F3_1:
    s_mov_b64 exec, vcc
    buffer_load_dwordx4 v[28:31], v2, s[4:7], s16 offen offset:1024 sc1
    s_mov_b64 exec, -1
    s_add_u32 s23, s23, 1
    s_cmp_lt_u32 s23, 200000
    s_cbranch_scc1 g_36L3_0
    s_mov_b32 s25, 200000
    s_branch gc_37
g_36F5_0:
    s_mov_b64 exec, vcc
    buffer_load_dwordx4 v[24:27], v2, s[4:7], s16 offen offset:0 sc1
    s_mov_b64 exec, -1
    s_add_u32 s23, s23, 1
    s_cmp_lt_u32 s23, 200000
    s_cbranch_scc1 g_36L5_2
    s_mov_b32 s25, 200000
    s_branch gc_37
g_36F5_2:
    s_mov_b64 exec, vcc
    buffer_load_dwordx4 v[32:35], v2, s[4:7], s16 offen offset:2048 sc1
    s_mov_b64 exec, -1
    s_add_u32 s23, s23, 1
    s_cmp_lt_u32 s23, 200000
    s_cbranch_scc1 g_36L5_0
    s_mov_b32 s25, 200000
    s_branch gc_37
g_36F6_1:
    s_mov_b64 exec, vcc
    buffer_load_dwordx4 v[28:31], v2, s[4:7], s16 offen offset:1024 sc1
    s_mov_b64 exec, -1
    s_add_u32 s23, s23, 1
    s_cmp_lt_u32 s23, 200000
    s_cbranch_scc1 g_36L6_2
    s_mov_b32 s25, 200000
    s_branch gc_37
g_36F6_2:
    s_mov_b64 exec, vcc
    buffer_load_dwordx4 v[32:35], v2, s[4:7], s16 offen offset:2048 sc1
    s_mov_b64 exec, -1
    s_add_u32 s23, s23, 1
    s_cmp_lt_u32 s23, 200000
    s_cbranch_scc1 g_36L6_1
    s_mov_b32 s25, 200000
    s_branch gc_37
g_36F9_0:
    s_mov_b64 exec, vcc
    buffer_load_dwordx4 v[24:27], v2, s[4:7], s16 offen offset:0 sc1
    s_mov_b64 exec, -1
    s_add_u32 s23, s23, 1
    s_cmp_lt_u32 s23, 200000
    s_cbranch_scc1 g_36L9_3
    s_mov_b32 s25, 200000
    s_branch gc_37
g_36F9_3:
    s_mov_b64 exec, vcc
    buffer_load_dwordx4 v[36:39], v2, s[4:7], s16 offen offset:3072 sc1
    s_mov_b64 exec, -1
    s_add_u32 s23, s23, 1
    s_cmp_lt_u32 s23, 200000
    s_cbranch_scc1 g_36L9_0
    s_mov_b32 s25, 200000
    s_branch gc_37
g_36F10_1:
    s_mov_b64 exec, vcc
    buffer_load_dwordx4 v[28:31], v2, s[4:7], s16 offen offset:1024 sc1
    s_mov_b64 exec, -1
    s_add_u32 s23, s23, 1
    s_cmp_lt_u32 s23, 200000
    s_cbranch_scc1 g_36L10_3
    s_mov_b32 s25, 200000
    s_branch gc_37
g_36F10_3:
    s_mov_b64 exec, vcc
    buffer_load_dwordx4 v[36:39], v2, s[4:7], s16 offen offset:3072 sc1
    s_mov_b64 exec, -1
    s_add_u32 s23, s23, 1
    s_cmp_lt_u32 s23, 200000
    s_cbranch_scc1 g_36L10_1
    s_mov_b32 s25, 200000
    s_branch gc_37
g_36F12_2:
    s_mov_b64 exec, vcc
    buffer_load_dwordx4 v[32:35], v2, s[4:7], s16 offen offset:2048 sc1
    s_mov_b64 exec, -1
    s_add_u32 s23, s23, 1
    s_cmp_lt_u32 s23, 200000
    s_cbranch_scc1 g_36L12_3
    s_mov_b32 s25, 200000
    s_branch gc_37
g_36F12_3:
    s_mov_b64 exec, vcc
    buffer_load_dwordx4 v[36:39], v2, s[4:7], s16 offen offset:3072 sc1
    s_mov_b64 exec, -1
    s_add_u32 s23, s23, 1
    s_cmp_lt_u32 s23, 200000
    s_cbranch_scc1 g_36L12_2
    s_mov_b32 s25, 200000
    s_branch gc_37
g_36F1_0:
    s_mov_b64 exec, vcc
    buffer_load_dwordx4 v[24:27], v2, s[4:7], s16 offen offset:0 sc1
    s_mov_b64 exec, -1
    s_add_u32 s23, s23, 1
    s_cmp_lt_u32 s23, 200000
    s_cbranch_scc1 g_36L1_0
    s_mov_b32 s25, 200000
    s_branch gc_37
g_36F2_1:
    s_mov_b64 exec, vcc
    buffer_load_dwordx4 v[28:31], v2, s[4:7], s16 offen offset:1024 sc1
    s_mov_b64 exec, -1
    s_add_u32 s23, s23, 1
    s_cmp_lt_u32 s23, 200000
    s_cbranch_scc1 g_36L2_1
    s_mov_b32 s25, 200000
    s_branch gc_37
g_36F4_2:
    s_mov_b64 exec, vcc
    buffer_load_dwordx4 v[32:35], v2, s[4:7], s16 offen offset:2048 sc1
    s_mov_b64 exec, -1
    s_add_u32 s23, s23, 1
    s_cmp_lt_u32 s23, 200000
    s_cbranch_scc1 g_36L4_2
    s_mov_b32 s25, 200000
    s_branch gc_37
g_36F8_3:
    s_mov_b64 exec, vcc
    buffer_load_dwordx4 v[36:39], v2, s[4:7], s16 offen offset:3072 sc1
    s_mov_b64 exec, -1
    s_add_u32 s23, s23, 1
    s_cmp_lt_u32 s23, 200000
    s_cbranch_scc1 g_36L8_3
    s_mov_b32 s25, 200000
    s_branch gc_37
ss_38r:
    buffer_load_dwordx4 v[208:211], v5, s[4:7], s16 offen offset:0 sc1
    buffer_load_dwordx4 v[212:215], v5, s[4:7], s16 offen offset:1024 sc1
    buffer_load_dwordx4 v[216:219], v5, s[4:7], s16 offen offset:2048 sc1
    buffer_load_dwordx4 v[220:223], v5, s[4:7], s16 offen offset:3072 sc1
    buffer_load_dword v224, v6, s[4:7], s16 offen offset:0 sc1
    buffer_load_dword v225, v6, s[4:7], s16 offen offset:256 sc1
    buffer_load_dword v226, v6, s[4:7], s16 offen offset:512 sc1
    buffer_load_dword v227, v6, s[4:7], s16 offen offset:768 sc1
    s_waitcnt vmcnt(14)
    v_pk_add_f32 v[180:181], v[24:25], v[28:29]
    v_pk_add_f32 v[182:183], v[26:27], v[30:31]
    s_waitcnt vmcnt(12)
    v_pk_add_f32 v[188:189], v[32:33], v[36:37]
    v_pk_add_f32 v[190:191], v[34:35], v[38:39]
    v_pk_add_f32 v[180:181], v[180:181], v[188:189]
    v_pk_add_f32 v[182:183], v[182:183], v[190:191]
    v_pk_add_f32 v[188:189], v[180:181], v[182:183]
    v_max3_f32 v185, v180, v181, v182
    s_waitcnt vmcnt(8)
    v_pk_add_f32 v[192:193], v[40:41], v[42:43]
    v_add_f32 v188, v188, v189
    v_add_f32 v184, v192, v193
    v_max3_f32 v185, v185, v183, v184
    v_cmp_u_f32 vcc, v188, v184
    s_nop 0
    v_max_f32_dpp v185, v185, v185 row_ror:8 row_mask:0xf bank_mask:0xf
    v_mov_b32 v186, v185
    s_nop 1
    v_permlane16_swap_b32 v185, v186
    v_max_f32 v185, v185, v186
    v_mov_b32 v186, v185
    s_cbranch_vccz sg_40
    buffer_load_dwordx4 v[24:27], v5, s[4:7], s16 offen offset:0 sc1
    buffer_load_dwordx4 v[28:31], v5, s[4:7], s16 offen offset:1024 sc1
    buffer_load_dwordx4 v[32:35], v5, s[4:7], s16 offen offset:2048 sc1
    buffer_load_dwordx4 v[36:39], v5, s[4:7], s16 offen offset:3072 sc1
    buffer_load_dword v40, v6, s[4:7], s16 offen offset:0 sc1
    buffer_load_dword v41, v6, s[4:7], s16 offen offset:256 sc1
    buffer_load_dword v42, v6, s[4:7], s16 offen offset:512 sc1
    buffer_load_dword v43, v6, s[4:7], s16 offen offset:768 sc1
    s_waitcnt vmcnt(14)
    v_pk_add_f32 v[180:181], v[208:209], v[212:213]
    v_pk_add_f32 v[182:183], v[210:211], v[214:215]
    s_waitcnt vmcnt(12)
    v_pk_add_f32 v[188:189], v[216:217], v[220:221]
    v_pk_add_f32 v[190:191], v[218:219], v[222:223]
    v_pk_add_f32 v[180:181], v[180:181], v[188:189]
    v_pk_add_f32 v[182:183], v[182:183], v[190:191]
    v_pk_add_f32 v[188:189], v[180:181], v[182:183]
    v_max3_f32 v185, v180, v181, v182
    s_waitcnt vmcnt(8)
    v_pk_add_f32 v[192:193], v[224:225], v[226:227]
    v_add_f32 v188, v188, v189
    v_add_f32 v184, v192, v193
    v_max3_f32 v185, v185, v183, v184
    v_cmp_u_f32 vcc, v188, v184
    s_nop 0
    v_max_f32_dpp v185, v185, v185 row_ror:8 row_mask:0xf bank_mask:0xf
    v_mov_b32 v186, v185
    s_nop 1
    v_permlane16_swap_b32 v185, v186
    v_max_f32 v185, v185, v186
    v_mov_b32 v186, v185
    s_cbranch_vccz sg_40
    s_branch ss_38
sb_39:
    v_max3_u32 v19, v24, v25, v26
    v_max3_u32 v19, v19, v27, v28
    v_max3_u32 v19, v19, v29, v30
    v_max3_u32 v19, v19, v31, v32
    v_max3_u32 v19, v19, v33, v34
    v_max3_u32 v19, v19, v35, v36
    v_max3_u32 v19, v19, v37, v38
    v_max3_u32 v19, v19, v39, v40
    v_max3_u32 v19, v19, v41, v42
    v_max_u32 v19, v19, v43
    v_cmp_eq_u32 vcc, -1, v19
    s_nop 0
    s_cbranch_vccz sg_40
    buffer_load_dwordx4 v[24:27], v5, s[4:7], s16 offen offset:0 sc1
    buffer_load_dwordx4 v[28:31], v5, s[4:7], s16 offen offset:1024 sc1
    buffer_load_dwordx4 v[32:35], v5, s[4:7], s16 offen offset:2048 sc1
    buffer_load_dwordx4 v[36:39], v5, s[4:7], s16 offen offset:3072 sc1
    buffer_load_dword v40, v6, s[4:7], s16 offen offset:0 sc1
    buffer_load_dword v41, v6, s[4:7], s16 offen offset:256 sc1
    buffer_load_dword v42, v6, s[4:7], s16 offen offset:512 sc1
    buffer_load_dword v43, v6, s[4:7], s16 offen offset:768 sc1
    s_add_u32 s23, s23, 1
    s_cmp_lt_u32 s23, 200000
    s_cbranch_scc1 ss_38
    s_mov_b32 s25, 200000
    s_branch sg_40
ss_38:
    s_waitcnt vmcnt(6)
    v_pk_add_f32 v[180:181], v[24:25], v[28:29]
    v_pk_add_f32 v[182:183], v[26:27], v[30:31]
    s_waitcnt vmcnt(4)
    v_pk_add_f32 v[188:189], v[32:33], v[36:37]
    v_pk_add_f32 v[190:191], v[34:35], v[38:39]
    v_pk_add_f32 v[180:181], v[180:181], v[188:189]
    v_pk_add_f32 v[182:183], v[182:183], v[190:191]
    v_pk_add_f32 v[188:189], v[180:181], v[182:183]
    v_max3_f32 v185, v180, v181, v182
    s_waitcnt vmcnt(0)
    v_pk_add_f32 v[192:193], v[40:41], v[42:43]
    v_add_f32 v188, v188, v189
    v_add_f32 v184, v192, v193
    v_max3_f32 v185, v185, v183, v184
    v_cmp_u_f32 vcc, v188, v184
    s_nop 0
    v_max_f32_dpp v185, v185, v185 row_ror:8 row_mask:0xf bank_mask:0xf
    v_mov_b32 v186, v185
    s_nop 1
    v_permlane16_swap_b32 v185, v186
    v_max_f32 v185, v185, v186
    v_mov_b32 v186, v185
    s_cbranch_vccnz sb_39
    s_branch sg_40
g_41L15_0:
    s_waitcnt vmcnt(3)
    v_max3_u32 v19, v24, v25, v26
    v_max_u32 v19, v19, v27
    v_cmp_eq_u32 vcc, -1, v19
    s_nop 0
    s_cbranch_vccnz g_41F15_0
    v_smfmac_f32_16x16x64_bf16 v[64:67], v[24:27], a[192:199], v172
    v_smfmac_f32_16x16x64_bf16 v[68:71], v[24:27], a[224:231], v172
g_41L14_1:
    s_waitcnt vmcnt(2)
    v_max3_u32 v19, v28, v29, v30
    v_max_u32 v19, v19, v31
    v_cmp_eq_u32 vcc, -1, v19
    s_nop 0
    s_cbranch_vccnz g_41F14_1
    v_smfmac_f32_16x16x64_bf16 v[64:67], v[28:31], a[200:207], v172
    v_smfmac_f32_16x16x64_bf16 v[68:71], v[28:31], a[232:239], v172
g_41L12_2:
    s_waitcnt vmcnt(1)
    v_max3_u32 v19, v32, v33, v34
    v_max_u32 v19, v19, v35
    v_cmp_eq_u32 vcc, -1, v19
    s_nop 0
    s_cbranch_vccnz g_41F12_2
    v_smfmac_f32_16x16x64_bf16 v[64:67], v[32:35], a[208:215], v172
    v_smfmac_f32_16x16x64_bf16 v[68:71], v[32:35], a[240:247], v172
g_41L8_3:
    s_waitcnt vmcnt(0)
    v_max3_u32 v19, v36, v37, v38
    v_max_u32 v19, v19, v39
    v_cmp_eq_u32 vcc, -1, v19
    s_nop 0
    s_cbranch_vccnz g_41F8_3
    v_smfmac_f32_16x16x64_bf16 v[64:67], v[36:39], a[216:223], v172
    v_smfmac_f32_16x16x64_bf16 v[68:71], v[36:39], a[248:255], v172
    s_nop 4
    v_cvt_pk_bf16_f32 v80, v64, v65
    v_cvt_pk_bf16_f32 v81, v66, v67
    s_nop 0
    v_cvt_pk_bf16_f32 v82, v68, v69
    v_cvt_pk_bf16_f32 v83, v70, v71
    ds_write_b128 v17, v[80:83] offset:9216
    s_branch gc_42
g_41L15_1:
    s_waitcnt vmcnt(3)
    v_max3_u32 v19, v28, v29, v30
    v_max_u32 v19, v19, v31
    v_cmp_eq_u32 vcc, -1, v19
    s_nop 0
    s_cbranch_vccnz g_41F15_1
    v_smfmac_f32_16x16x64_bf16 v[64:67], v[28:31], a[200:207], v172
    v_smfmac_f32_16x16x64_bf16 v[68:71], v[28:31], a[232:239], v172
g_41L13_2:
    s_waitcnt vmcnt(2)
    v_max3_u32 v19, v32, v33, v34
    v_max_u32 v19, v19, v35
    v_cmp_eq_u32 vcc, -1, v19
    s_nop 0
    s_cbranch_vccnz g_41F13_2
    v_smfmac_f32_16x16x64_bf16 v[64:67], v[32:35], a[208:215], v172
    v_smfmac_f32_16x16x64_bf16 v[68:71], v[32:35], a[240:247], v172
g_41L9_3:
    s_waitcnt vmcnt(1)
    v_max3_u32 v19, v36, v37, v38
    v_max_u32 v19, v19, v39
    v_cmp_eq_u32 vcc, -1, v19
    s_nop 0
    s_cbranch_vccnz g_41F9_3
    v_smfmac_f32_16x16x64_bf16 v[64:67], v[36:39], a[216:223], v172
    v_smfmac_f32_16x16x64_bf16 v[68:71], v[36:39], a[248:255], v172
g_41L1_0:
    s_waitcnt vmcnt(0)
    v_max3_u32 v19, v24, v25, v26
    v_max_u32 v19, v19, v27
    v_cmp_eq_u32 vcc, -1, v19
    s_nop 0
    s_cbranch_vccnz g_41F1_0
    v_smfmac_f32_16x16x64_bf16 v[64:67], v[24:27], a[192:199], v172
    v_smfmac_f32_16x16x64_bf16 v[68:71], v[24:27], a[224:231], v172
    s_nop 4
    v_cvt_pk_bf16_f32 v80, v64, v65
    v_cvt_pk_bf16_f32 v81, v66, v67
    s_nop 0
    v_cvt_pk_bf16_f32 v82, v68, v69
    v_cvt_pk_bf16_f32 v83, v70, v71
    ds_write_b128 v17, v[80:83] offset:9216
    s_branch gc_42
g_41L15_2:
    s_waitcnt vmcnt(3)
    v_max3_u32 v19, v32, v33, v34
    v_max_u32 v19, v19, v35
    v_cmp_eq_u32 vcc, -1, v19
    s_nop 0
    s_cbranch_vccnz g_41F15_2
    v_smfmac_f32_16x16x64_bf16 v[64:67], v[32:35], a[208:215], v172
    v_smfmac_f32_16x16x64_bf16 v[68:71], v[32:35], a[240:247], v172
g_41L11_3:
    s_waitcnt vmcnt(2)
    v_max3_u32 v19, v36, v37, v38
    v_max_u32 v19, v19, v39
    v_cmp_eq_u32 vcc, -1, v19
    s_nop 0
    s_cbranch_vccnz g_41F11_3
    v_smfmac_f32_16x16x64_bf16 v[64:67], v[36:39], a[216:223], v172
    v_smfmac_f32_16x16x64_bf16 v[68:71], v[36:39], a[248:255], v172
g_41L3_0:
    s_waitcnt vmcnt(1)
    v_max3_u32 v19, v24, v25, v26
    v_max_u32 v19, v19, v27
    v_cmp_eq_u32 vcc, -1, v19
    s_nop 0
    s_cbranch_vccnz g_41F3_0
    v_smfmac_f32_16x16x64_bf16 v[64:67], v[24:27], a[192:199], v172
    v_smfmac_f32_16x16x64_bf16 v[68:71], v[24:27], a[224:231], v172
g_41L2_1:
    s_waitcnt vmcnt(0)
    v_max3_u32 v19, v28, v29, v30
    v_max_u32 v19, v19, v31
    v_cmp_eq_u32 vcc, -1, v19
    s_nop 0
    s_cbranch_vccnz g_41F2_1
    v_smfmac_f32_16x16x64_bf16 v[64:67], v[28:31], a[200:207], v172
    v_smfmac_f32_16x16x64_bf16 v[68:71], v[28:31], a[232:239], v172
    s_nop 4
    v_cvt_pk_bf16_f32 v80, v64, v65
    v_cvt_pk_bf16_f32 v81, v66, v67
    s_nop 0
    v_cvt_pk_bf16_f32 v82, v68, v69
    v_cvt_pk_bf16_f32 v83, v70, v71
    ds_write_b128 v17, v[80:83] offset:9216
    s_branch gc_42
g_41L15_3:
    s_waitcnt vmcnt(3)
    v_max3_u32 v19, v36, v37, v38
    v_max_u32 v19, v19, v39
    v_cmp_eq_u32 vcc, -1, v19
    s_nop 0
    s_cbranch_vccnz g_41F15_3
    v_smfmac_f32_16x16x64_bf16 v[64:67], v[36:39], a[216:223], v172
    v_smfmac_f32_16x16x64_bf16 v[68:71], v[36:39], a[248:255], v172
g_41L7_0:
    s_waitcnt vmcnt(2)
    v_max3_u32 v19, v24, v25, v26
    v_max_u32 v19, v19, v27
    v_cmp_eq_u32 vcc, -1, v19
    s_nop 0
    s_cbranch_vccnz g_41F7_0
    v_smfmac_f32_16x16x64_bf16 v[64:67], v[24:27], a[192:199], v172
    v_smfmac_f32_16x16x64_bf16 v[68:71], v[24:27], a[224:231], v172
g_41L6_1:
    s_waitcnt vmcnt(1)
    v_max3_u32 v19, v28, v29, v30
    v_max_u32 v19, v19, v31
    v_cmp_eq_u32 vcc, -1, v19
    s_nop 0
    s_cbranch_vccnz g_41F6_1
    v_smfmac_f32_16x16x64_bf16 v[64:67], v[28:31], a[200:207], v172
    v_smfmac_f32_16x16x64_bf16 v[68:71], v[28:31], a[232:239], v172
g_41L4_2:
    s_waitcnt vmcnt(0)
    v_max3_u32 v19, v32, v33, v34
    v_max_u32 v19, v19, v35
    v_cmp_eq_u32 vcc, -1, v19
    s_nop 0
    s_cbranch_vccnz g_41F4_2
    v_smfmac_f32_16x16x64_bf16 v[64:67], v[32:35], a[208:215], v172
    v_smfmac_f32_16x16x64_bf16 v[68:71], v[32:35], a[240:247], v172
    s_nop 4
    v_cvt_pk_bf16_f32 v80, v64, v65
    v_cvt_pk_bf16_f32 v81, v66, v67
    s_nop 0
    v_cvt_pk_bf16_f32 v82, v68, v69
    v_cvt_pk_bf16_f32 v83, v70, v71
    ds_write_b128 v17, v[80:83] offset:9216
    s_branch gc_42
g_41L7_1:
    s_waitcnt vmcnt(2)
    v_max3_u32 v19, v28, v29, v30
    v_max_u32 v19, v19, v31
    v_cmp_eq_u32 vcc, -1, v19
    s_nop 0
    s_cbranch_vccnz g_41F7_1
    v_smfmac_f32_16x16x64_bf16 v[64:67], v[28:31], a[200:207], v172
    v_smfmac_f32_16x16x64_bf16 v[68:71], v[28:31], a[232:239], v172
g_41L5_2:
    s_waitcnt vmcnt(1)
    v_max3_u32 v19, v32, v33, v34
    v_max_u32 v19, v19, v35
    v_cmp_eq_u32 vcc, -1, v19
    s_nop 0
    s_cbranch_vccnz g_41F5_2
    v_smfmac_f32_16x16x64_bf16 v[64:67], v[32:35], a[208:215], v172
    v_smfmac_f32_16x16x64_bf16 v[68:71], v[32:35], a[240:247], v172
    s_branch g_41L1_0
g_41L7_2:
    s_waitcnt vmcnt(2)
    v_max3_u32 v19, v32, v33, v34
    v_max_u32 v19, v19, v35
    v_cmp_eq_u32 vcc, -1, v19
    s_nop 0
    s_cbranch_vccnz g_41F7_2
    v_smfmac_f32_16x16x64_bf16 v[64:67], v[32:35], a[208:215], v172
    v_smfmac_f32_16x16x64_bf16 v[68:71], v[32:35], a[240:247], v172
    s_branch g_41L3_0
g_41L11_0:
    s_waitcnt vmcnt(2)
    v_max3_u32 v19, v24, v25, v26
    v_max_u32 v19, v19, v27
    v_cmp_eq_u32 vcc, -1, v19
    s_nop 0
    s_cbranch_vccnz g_41F11_0
    v_smfmac_f32_16x16x64_bf16 v[64:67], v[24:27], a[192:199], v172
    v_smfmac_f32_16x16x64_bf16 v[68:71], v[24:27], a[224:231], v172
g_41L10_1:
    s_waitcnt vmcnt(1)
    v_max3_u32 v19, v28, v29, v30
    v_max_u32 v19, v19, v31
    v_cmp_eq_u32 vcc, -1, v19
    s_nop 0
    s_cbranch_vccnz g_41F10_1
    v_smfmac_f32_16x16x64_bf16 v[64:67], v[28:31], a[200:207], v172
    v_smfmac_f32_16x16x64_bf16 v[68:71], v[28:31], a[232:239], v172
    s_branch g_41L8_3
g_41L11_1:
    s_waitcnt vmcnt(2)
    v_max3_u32 v19, v28, v29, v30
    v_max_u32 v19, v19, v31
    v_cmp_eq_u32 vcc, -1, v19
    s_nop 0
    s_cbranch_vccnz g_41F11_1
    v_smfmac_f32_16x16x64_bf16 v[64:67], v[28:31], a[200:207], v172
    v_smfmac_f32_16x16x64_bf16 v[68:71], v[28:31], a[232:239], v172
    s_branch g_41L9_3
g_41L13_0:
    s_waitcnt vmcnt(2)
    v_max3_u32 v19, v24, v25, v26
    v_max_u32 v19, v19, v27
    v_cmp_eq_u32 vcc, -1, v19
    s_nop 0
    s_cbranch_vccnz g_41F13_0
    v_smfmac_f32_16x16x64_bf16 v[64:67], v[24:27], a[192:199], v172
    v_smfmac_f32_16x16x64_bf16 v[68:71], v[24:27], a[224:231], v172
    s_branch g_41L12_2
g_41L13_3:
    s_waitcnt vmcnt(2)
    v_max3_u32 v19, v36, v37, v38
    v_max_u32 v19, v19, v39
    v_cmp_eq_u32 vcc, -1, v19
    s_nop 0
    s_cbranch_vccnz g_41F13_3
    v_smfmac_f32_16x16x64_bf16 v[64:67], v[36:39], a[216:223], v172
    v_smfmac_f32_16x16x64_bf16 v[68:71], v[36:39], a[248:255], v172
g_41L5_0:
    s_waitcnt vmcnt(1)
    v_max3_u32 v19, v24, v25, v26
    v_max_u32 v19, v19, v27
    v_cmp_eq_u32 vcc, -1, v19
    s_nop 0
    s_cbranch_vccnz g_41F5_0
    v_smfmac_f32_16x16x64_bf16 v[64:67], v[24:27], a[192:199], v172
    v_smfmac_f32_16x16x64_bf16 v[68:71], v[24:27], a[224:231], v172
    s_branch g_41L4_2
g_41L14_2:
    s_waitcnt vmcnt(2)
    v_max3_u32 v19, v32, v33, v34
    v_max_u32 v19, v19, v35
    v_cmp_eq_u32 vcc, -1, v19
    s_nop 0
    s_cbranch_vccnz g_41F14_2
    v_smfmac_f32_16x16x64_bf16 v[64:67], v[32:35], a[208:215], v172
    v_smfmac_f32_16x16x64_bf16 v[68:71], v[32:35], a[240:247], v172
g_41L10_3:
    s_waitcnt vmcnt(1)
    v_max3_u32 v19, v36, v37, v38
    v_max_u32 v19, v19, v39
    v_cmp_eq_u32 vcc, -1, v19
    s_nop 0
    s_cbranch_vccnz g_41F10_3
    v_smfmac_f32_16x16x64_bf16 v[64:67], v[36:39], a[216:223], v172
    v_smfmac_f32_16x16x64_bf16 v[68:71], v[36:39], a[248:255], v172
    s_branch g_41L2_1
g_41L14_3:
    s_waitcnt vmcnt(2)
    v_max3_u32 v19, v36, v37, v38
    v_max_u32 v19, v19, v39
    v_cmp_eq_u32 vcc, -1, v19
    s_nop 0
    s_cbranch_vccnz g_41F14_3
    v_smfmac_f32_16x16x64_bf16 v[64:67], v[36:39], a[216:223], v172
    v_smfmac_f32_16x16x64_bf16 v[68:71], v[36:39], a[248:255], v172
    s_branch g_41L6_1
g_41L3_1:
    s_waitcnt vmcnt(1)
    v_max3_u32 v19, v28, v29, v30
    v_max_u32 v19, v19, v31
    v_cmp_eq_u32 vcc, -1, v19
    s_nop 0
    s_cbranch_vccnz g_41F3_1
    v_smfmac_f32_16x16x64_bf16 v[64:67], v[28:31], a[200:207], v172
    v_smfmac_f32_16x16x64_bf16 v[68:71], v[28:31], a[232:239], v172
    s_branch g_41L1_0
g_41L6_2:
    s_waitcnt vmcnt(1)
    v_max3_u32 v19, v32, v33, v34
    v_max_u32 v19, v19, v35
    v_cmp_eq_u32 vcc, -1, v19
    s_nop 0
    s_cbranch_vccnz g_41F6_2
    v_smfmac_f32_16x16x64_bf16 v[64:67], v[32:35], a[208:215], v172
    v_smfmac_f32_16x16x64_bf16 v[68:71], v[32:35], a[240:247], v172
    s_branch g_41L2_1
g_41L9_0:
    s_waitcnt vmcnt(1)
    v_max3_u32 v19, v24, v25, v26
    v_max_u32 v19, v19, v27
    v_cmp_eq_u32 vcc, -1, v19
    s_nop 0
    s_cbranch_vccnz g_41F9_0
    v_smfmac_f32_16x16x64_bf16 v[64:67], v[24:27], a[192:199], v172
    v_smfmac_f32_16x16x64_bf16 v[68:71], v[24:27], a[224:231], v172
    s_branch g_41L8_3
g_41L12_3:
    s_waitcnt vmcnt(1)
    v_max3_u32 v19, v36, v37, v38
    v_max_u32 v19, v19, v39
    v_cmp_eq_u32 vcc, -1, v19
    s_nop 0
    s_cbranch_vccnz g_41F12_3
    v_smfmac_f32_16x16x64_bf16 v[64:67], v[36:39], a[216:223], v172
    v_smfmac_f32_16x16x64_bf16 v[68:71], v[36:39], a[248:255], v172
    s_branch g_41L4_2
g_41F15_0:
    s_mov_b64 exec, vcc
    buffer_load_dwordx4 v[24:27], v8, s[4:7], s16 offen offset:0 sc1
    s_mov_b64 exec, -1
    s_add_u32 s23, s23, 1
    s_cmp_lt_u32 s23, 200000
    s_cbranch_scc1 g_41L15_1
    s_mov_b32 s25, 200000
    s_branch gc_42
g_41F15_1:
    s_mov_b64 exec, vcc
    buffer_load_dwordx4 v[28:31], v8, s[4:7], s16 offen offset:1024 sc1
    s_mov_b64 exec, -1
    s_add_u32 s23, s23, 1
    s_cmp_lt_u32 s23, 200000
    s_cbranch_scc1 g_41L15_2
    s_mov_b32 s25, 200000
    s_branch gc_42
g_41F15_2:
    s_mov_b64 exec, vcc
    buffer_load_dwordx4 v[32:35], v8, s[4:7], s16 offen offset:2048 sc1
    s_mov_b64 exec, -1
    s_add_u32 s23, s23, 1
    s_cmp_lt_u32 s23, 200000
    s_cbranch_scc1 g_41L15_3
    s_mov_b32 s25, 200000
    s_branch gc_42
g_41F15_3:
    s_mov_b64 exec, vcc
    buffer_load_dwordx4 v[36:39], v8, s[4:7], s16 offen offset:3072 sc1
    s_mov_b64 exec, -1
    s_add_u32 s23, s23, 1
    s_cmp_lt_u32 s23, 200000
    s_cbranch_scc1 g_41L15_0
    s_mov_b32 s25, 200000
    s_branch gc_42
g_41F7_0:
    s_mov_b64 exec, vcc
    buffer_load_dwordx4 v[24:27], v8, s[4:7], s16 offen offset:0 sc1
    s_mov_b64 exec, -1
    s_add_u32 s23, s23, 1
    s_cmp_lt_u32 s23, 200000
    s_cbranch_scc1 g_41L7_1
    s_mov_b32 s25, 200000
    s_branch gc_42
g_41F7_1:
    s_mov_b64 exec, vcc
    buffer_load_dwordx4 v[28:31], v8, s[4:7], s16 offen offset:1024 sc1
    s_mov_b64 exec, -1
    s_add_u32 s23, s23, 1
    s_cmp_lt_u32 s23, 200000
    s_cbranch_scc1 g_41L7_2
    s_mov_b32 s25, 200000
    s_branch gc_42
g_41F7_2:
    s_mov_b64 exec, vcc
    buffer_load_dwordx4 v[32:35], v8, s[4:7], s16 offen offset:2048 sc1
    s_mov_b64 exec, -1
    s_add_u32 s23, s23, 1
    s_cmp_lt_u32 s23, 200000
    s_cbranch_scc1 g_41L7_0
    s_mov_b32 s25, 200000
    s_branch gc_42
g_41F11_0:
    s_mov_b64 exec, vcc
    buffer_load_dwordx4 v[24:27], v8, s[4:7], s16 offen offset:0 sc1
    s_mov_b64 exec, -1
    s_add_u32 s23, s23, 1
    s_cmp_lt_u32 s23, 200000
    s_cbranch_scc1 g_41L11_1
    s_mov_b32 s25, 200000
    s_branch gc_42
g_41F11_1:
    s_mov_b64 exec, vcc
    buffer_load_dwordx4 v[28:31], v8, s[4:7], s16 offen offset:1024 sc1
    s_mov_b64 exec, -1
    s_add_u32 s23, s23, 1
    s_cmp_lt_u32 s23, 200000
    s_cbranch_scc1 g_41L11_3
    s_mov_b32 s25, 200000
    s_branch gc_42
g_41F11_3:
    s_mov_b64 exec, vcc
    buffer_load_dwordx4 v[36:39], v8, s[4:7], s16 offen offset:3072 sc1
    s_mov_b64 exec, -1
    s_add_u32 s23, s23, 1
    s_cmp_lt_u32 s23, 200000
    s_cbranch_scc1 g_41L11_0
    s_mov_b32 s25, 200000
    s_branch gc_42
g_41F13_0:
    s_mov_b64 exec, vcc
    buffer_load_dwordx4 v[24:27], v8, s[4:7], s16 offen offset:0 sc1
    s_mov_b64 exec, -1
    s_add_u32 s23, s23, 1
    s_cmp_lt_u32 s23, 200000
    s_cbranch_scc1 g_41L13_2
    s_mov_b32 s25, 200000
    s_branch gc_42
g_41F13_2:
    s_mov_b64 exec, vcc
    buffer_load_dwordx4 v[32:35], v8, s[4:7], s16 offen offset:2048 sc1
    s_mov_b64 exec, -1
    s_add_u32 s23, s23, 1
    s_cmp_lt_u32 s23, 200000
    s_cbranch_scc1 g_41L13_3
    s_mov_b32 s25, 200000
    s_branch gc_42
g_41F13_3:
    s_mov_b64 exec, vcc
    buffer_load_dwordx4 v[36:39], v8, s[4:7], s16 offen offset:3072 sc1
    s_mov_b64 exec, -1
    s_add_u32 s23, s23, 1
    s_cmp_lt_u32 s23, 200000
    s_cbranch_scc1 g_41L13_0
    s_mov_b32 s25, 200000
    s_branch gc_42
g_41F14_1:
    s_mov_b64 exec, vcc
    buffer_load_dwordx4 v[28:31], v8, s[4:7], s16 offen offset:1024 sc1
    s_mov_b64 exec, -1
    s_add_u32 s23, s23, 1
    s_cmp_lt_u32 s23, 200000
    s_cbranch_scc1 g_41L14_2
    s_mov_b32 s25, 200000
    s_branch gc_42
g_41F14_2:
    s_mov_b64 exec, vcc
    buffer_load_dwordx4 v[32:35], v8, s[4:7], s16 offen offset:2048 sc1
    s_mov_b64 exec, -1
    s_add_u32 s23, s23, 1
    s_cmp_lt_u32 s23, 200000
    s_cbranch_scc1 g_41L14_3
    s_mov_b32 s25, 200000
    s_branch gc_42
g_41F14_3:
    s_mov_b64 exec, vcc
    buffer_load_dwordx4 v[36:39], v8, s[4:7], s16 offen offset:3072 sc1
    s_mov_b64 exec, -1
    s_add_u32 s23, s23, 1
    s_cmp_lt_u32 s23, 200000
    s_cbranch_scc1 g_41L14_1
    s_mov_b32 s25, 200000
    s_branch gc_42
g_41F3_0:
    s_mov_b64 exec, vcc
    buffer_load_dwordx4 v[24:27], v8, s[4:7], s16 offen offset:0 sc1
    s_mov_b64 exec, -1
    s_add_u32 s23, s23, 1
    s_cmp_lt_u32 s23, 200000
    s_cbranch_scc1 g_41L3_1
    s_mov_b32 s25, 200000
    s_branch gc_42
g_41F3_1:
    s_mov_b64 exec, vcc
    buffer_load_dwordx4 v[28:31], v8, s[4:7], s16 offen offset:1024 sc1
    s_mov_b64 exec, -1
    s_add_u32 s23, s23, 1
    s_cmp_lt_u32 s23, 200000
    s_cbranch_scc1 g_41L3_0
    s_mov_b32 s25, 200000
    s_branch gc_42
g_41F5_0:
    s_mov_b64 exec, vcc
    buffer_load_dwordx4 v[24:27], v8, s[4:7], s16 offen offset:0 sc1
    s_mov_b64 exec, -1
    s_add_u32 s23, s23, 1
    s_cmp_lt_u32 s23, 200000
    s_cbranch_scc1 g_41L5_2
    s_mov_b32 s25, 200000
    s_branch gc_42
g_41F5_2:
    s_mov_b64 exec, vcc
    buffer_load_dwordx4 v[32:35], v8, s[4:7], s16 offen offset:2048 sc1
    s_mov_b64 exec, -1
    s_add_u32 s23, s23, 1
    s_cmp_lt_u32 s23, 200000
    s_cbranch_scc1 g_41L5_0
    s_mov_b32 s25, 200000
    s_branch gc_42
g_41F6_1:
    s_mov_b64 exec, vcc
    buffer_load_dwordx4 v[28:31], v8, s[4:7], s16 offen offset:1024 sc1
    s_mov_b64 exec, -1
    s_add_u32 s23, s23, 1
    s_cmp_lt_u32 s23, 200000
    s_cbranch_scc1 g_41L6_2
    s_mov_b32 s25, 200000
    s_branch gc_42
g_41F6_2:
    s_mov_b64 exec, vcc
    buffer_load_dwordx4 v[32:35], v8, s[4:7], s16 offen offset:2048 sc1
    s_mov_b64 exec, -1
    s_add_u32 s23, s23, 1
    s_cmp_lt_u32 s23, 200000
    s_cbranch_scc1 g_41L6_1
    s_mov_b32 s25, 200000
    s_branch gc_42
g_41F9_0:
    s_mov_b64 exec, vcc
    buffer_load_dwordx4 v[24:27], v8, s[4:7], s16 offen offset:0 sc1
    s_mov_b64 exec, -1
    s_add_u32 s23, s23, 1
    s_cmp_lt_u32 s23, 200000
    s_cbranch_scc1 g_41L9_3
    s_mov_b32 s25, 200000
    s_branch gc_42
g_41F9_3:
    s_mov_b64 exec, vcc
    buffer_load_dwordx4 v[36:39], v8, s[4:7], s16 offen offset:3072 sc1
    s_mov_b64 exec, -1
    s_add_u32 s23, s23, 1
    s_cmp_lt_u32 s23, 200000
    s_cbranch_scc1 g_41L9_0
    s_mov_b32 s25, 200000
    s_branch gc_42
g_41F10_1:
    s_mov_b64 exec, vcc
    buffer_load_dwordx4 v[28:31], v8, s[4:7], s16 offen offset:1024 sc1
    s_mov_b64 exec, -1
    s_add_u32 s23, s23, 1
    s_cmp_lt_u32 s23, 200000
    s_cbranch_scc1 g_41L10_3
    s_mov_b32 s25, 200000
    s_branch gc_42
g_41F10_3:
    s_mov_b64 exec, vcc
    buffer_load_dwordx4 v[36:39], v8, s[4:7], s16 offen offset:3072 sc1
    s_mov_b64 exec, -1
    s_add_u32 s23, s23, 1
    s_cmp_lt_u32 s23, 200000
    s_cbranch_scc1 g_41L10_1
    s_mov_b32 s25, 200000
    s_branch gc_42
g_41F12_2:
    s_mov_b64 exec, vcc
    buffer_load_dwordx4 v[32:35], v8, s[4:7], s16 offen offset:2048 sc1
    s_mov_b64 exec, -1
    s_add_u32 s23, s23, 1
    s_cmp_lt_u32 s23, 200000
    s_cbranch_scc1 g_41L12_3
    s_mov_b32 s25, 200000
    s_branch gc_42
g_41F12_3:
    s_mov_b64 exec, vcc
    buffer_load_dwordx4 v[36:39], v8, s[4:7], s16 offen offset:3072 sc1
    s_mov_b64 exec, -1
    s_add_u32 s23, s23, 1
    s_cmp_lt_u32 s23, 200000
    s_cbranch_scc1 g_41L12_2
    s_mov_b32 s25, 200000
    s_branch gc_42
g_41F1_0:
    s_mov_b64 exec, vcc
    buffer_load_dwordx4 v[24:27], v8, s[4:7], s16 offen offset:0 sc1
    s_mov_b64 exec, -1
    s_add_u32 s23, s23, 1
    s_cmp_lt_u32 s23, 200000
    s_cbranch_scc1 g_41L1_0
    s_mov_b32 s25, 200000
    s_branch gc_42
g_41F2_1:
    s_mov_b64 exec, vcc
    buffer_load_dwordx4 v[28:31], v8, s[4:7], s16 offen offset:1024 sc1
    s_mov_b64 exec, -1
    s_add_u32 s23, s23, 1
    s_cmp_lt_u32 s23, 200000
    s_cbranch_scc1 g_41L2_1
    s_mov_b32 s25, 200000
    s_branch gc_42
g_41F4_2:
    s_mov_b64 exec, vcc
    buffer_load_dwordx4 v[32:35], v8, s[4:7], s16 offen offset:2048 sc1
    s_mov_b64 exec, -1
    s_add_u32 s23, s23, 1
    s_cmp_lt_u32 s23, 200000
    s_cbranch_scc1 g_41L4_2
    s_mov_b32 s25, 200000
    s_branch gc_42
g_41F8_3:
    s_mov_b64 exec, vcc
    buffer_load_dwordx4 v[36:39], v8, s[4:7], s16 offen offset:3072 sc1
    s_mov_b64 exec, -1
    s_add_u32 s23, s23, 1
    s_cmp_lt_u32 s23, 200000
    s_cbranch_scc1 g_41L8_3
    s_mov_b32 s25, 200000
    s_branch gc_42
.p2align 6
recur_fast_w2:
    s_nop 15
    s_mov_b32 s23, s25
    buffer_load_dwordx4 v[24:27], v2, s[4:7], s16 offen offset:0 sc1
    s_nop 11
    buffer_load_dwordx4 v[28:31], v2, s[4:7], s16 offen offset:1024 sc1
    s_nop 11
    buffer_load_dwordx4 v[32:35], v2, s[4:7], s16 offen offset:2048 sc1
    s_nop 11
    buffer_load_dwordx4 v[36:39], v2, s[4:7], s16 offen offset:3072 sc1
    s_waitcnt vmcnt(3)
    v_max3_u32 v19, v24, v25, v26
    v_max_u32 v19, v19, v27
    v_cmp_eq_u32 vcc, -1, v19
    s_nop 0
    s_cbranch_vccnz g_45F15_0
    v_smfmac_f32_16x16x64_bf16 v[40:43], v[24:27], a[0:7], v172
    s_waitcnt vmcnt(2)
    v_max3_u32 v19, v28, v29, v30
    v_max_u32 v19, v19, v31
    v_smfmac_f32_16x16x64_bf16 v[44:47], v[24:27], a[64:71], v172
    v_cmp_eq_u32 vcc, -1, v19
    v_smfmac_f32_16x16x64_bf16 v[48:51], v[24:27], a[32:39], v172
    v_smfmac_f32_16x16x64_bf16 v[52:55], v[24:27], a[96:103], v172
    s_cbranch_vccnz g_45F14_1
    v_smfmac_f32_16x16x64_bf16 v[40:43], v[28:31], a[8:15], v172
    s_waitcnt vmcnt(1)
    v_max3_u32 v19, v32, v33, v34
    v_max_u32 v19, v19, v35
    v_smfmac_f32_16x16x64_bf16 v[44:47], v[28:31], a[72:79], v172
    v_cmp_eq_u32 vcc, -1, v19
    v_smfmac_f32_16x16x64_bf16 v[48:51], v[28:31], a[40:47], v172
    v_smfmac_f32_16x16x64_bf16 v[52:55], v[28:31], a[104:111], v172
    s_cbranch_vccnz g_45F12_2
    v_smfmac_f32_16x16x64_bf16 v[40:43], v[32:35], a[16:23], v172
    s_waitcnt vmcnt(0)
    v_max3_u32 v19, v36, v37, v38
    v_max_u32 v19, v19, v39
    v_smfmac_f32_16x16x64_bf16 v[44:47], v[32:35], a[80:87], v172
    v_cmp_eq_u32 vcc, -1, v19
    v_smfmac_f32_16x16x64_bf16 v[48:51], v[32:35], a[48:55], v172
    v_smfmac_f32_16x16x64_bf16 v[52:55], v[32:35], a[112:119], v172
    s_cbranch_vccnz g_45F8_3
    v_smfmac_f32_16x16x64_bf16 v[40:43], v[36:39], a[24:31], v172
    v_smfmac_f32_16x16x64_bf16 v[44:47], v[36:39], a[88:95], v172
    v_smfmac_f32_16x16x64_bf16 v[48:51], v[36:39], a[56:63], v172
    v_smfmac_f32_16x16x64_bf16 v[52:55], v[36:39], a[120:127], v172
gc_46:
    v_cvt_pk_bf16_f32 v72, v40, v41
    v_cvt_pk_bf16_f32 v73, v42, v43
    v_cvt_pk_bf16_f32 v74, v44, v45
    v_cvt_pk_bf16_f32 v75, v46, v47
    ds_write_b128 v17, v[72:75] offset:0
    v_cvt_pk_bf16_f32 v76, v48, v49
    v_cvt_pk_bf16_f32 v77, v50, v51
    s_nop 0
    v_cvt_pk_bf16_f32 v78, v52, v53
    v_cvt_pk_bf16_f32 v79, v54, v55
    ds_write_b128 v17, v[76:79] offset:1024
    v_smfmac_f32_16x16x64_bf16 v[56:59], v[24:27], a[128:135], v172
    v_smfmac_f32_16x16x64_bf16 v[60:63], v[24:27], a[160:167], v172
    v_smfmac_f32_16x16x64_bf16 v[56:59], v[28:31], a[136:143], v172
    s_waitcnt lgkmcnt(0)
    s_barrier
    v_smfmac_f32_16x16x64_bf16 v[60:63], v[28:31], a[168:175], v172
    v_smfmac_f32_16x16x64_bf16 v[56:59], v[32:35], a[144:151], v172
    v_smfmac_f32_16x16x64_bf16 v[60:63], v[32:35], a[176:183], v172
    v_smfmac_f32_16x16x64_bf16 v[56:59], v[36:39], a[152:159], v172
    v_smfmac_f32_16x16x64_bf16 v[60:63], v[36:39], a[184:191], v172
    s_nop 4
    v_cvt_pk_bf16_f32 v80, v56, v57
    v_cvt_pk_bf16_f32 v81, v58, v59
    s_nop 0
    v_cvt_pk_bf16_f32 v82, v60, v61
    v_cvt_pk_bf16_f32 v83, v62, v63
    ds_write_b128 v17, v[80:83] offset:8192
    s_cmp_eq_u32 s15, 63
    s_waitcnt lgkmcnt(0)
    s_barrier
    ds_read_b128 v[96:99], v16 offset:8192
    ds_read_b128 v[100:103], v16 offset:10240
    ds_read_b128 v[108:111], v16 offset:14336
    v_mfma_f32_16x16x32_bf16 v[140:143], v[84:87], v[80:83], 0
    s_waitcnt lgkmcnt(2)
    v_mfma_f32_16x16x32_bf16 v[140:143], v[84:87], v[96:99], v[140:143]
    s_waitcnt lgkmcnt(1)
    v_mfma_f32_16x16x32_bf16 v[140:143], v[84:87], v[100:103], v[140:143]
    s_waitcnt lgkmcnt(0)
    v_mfma_f32_16x16x32_bf16 v[140:143], v[84:87], v[108:111], v[140:143]
    s_nop 7
    v_cvt_pk_bf16_f32 v168, v140, v141
    v_cvt_pk_bf16_f32 v169, v142, v143
    v_mov_b32 v170, v168
    v_mov_b32 v171, v169
    s_nop 0
    v_permlane16_swap_b32 v168, v170
    v_permlane16_swap_b32 v169, v171
    v_mov_b32 v247, s15
    s_cbranch_scc1 recur_fast_last2
    s_barrier
    s_nop 15
    s_mov_b32 s23, s25
    buffer_load_dwordx4 v[24:27], v8, s[4:7], s16 offen offset:0 sc1
    s_nop 11
    buffer_load_dwordx4 v[28:31], v8, s[4:7], s16 offen offset:1024 sc1
    s_nop 11
    buffer_load_dwordx4 v[32:35], v8, s[4:7], s16 offen offset:2048 sc1
    s_nop 11
    buffer_load_dwordx4 v[36:39], v8, s[4:7], s16 offen offset:3072 sc1
    s_waitcnt vmcnt(3)
    v_max3_u32 v19, v24, v25, v26
    v_max_u32 v19, v19, v27
    v_cmp_eq_u32 vcc, -1, v19
    s_nop 0
    s_cbranch_vccnz g_47F15_0
    v_smfmac_f32_16x16x64_bf16 v[64:67], v[24:27], a[192:199], v172
    v_smfmac_f32_16x16x64_bf16 v[68:71], v[24:27], a[224:231], v172
    s_waitcnt vmcnt(2)
    v_max3_u32 v19, v28, v29, v30
    v_max_u32 v19, v19, v31
    v_cmp_eq_u32 vcc, -1, v19
    s_nop 0
    s_cbranch_vccnz g_47F14_1
    v_smfmac_f32_16x16x64_bf16 v[64:67], v[28:31], a[200:207], v172
    v_smfmac_f32_16x16x64_bf16 v[68:71], v[28:31], a[232:239], v172
    s_waitcnt vmcnt(1)
    v_max3_u32 v19, v32, v33, v34
    v_max_u32 v19, v19, v35
    v_cmp_eq_u32 vcc, -1, v19
    s_nop 0
    s_cbranch_vccnz g_47F12_2
    v_smfmac_f32_16x16x64_bf16 v[64:67], v[32:35], a[208:215], v172
    v_smfmac_f32_16x16x64_bf16 v[68:71], v[32:35], a[240:247], v172
    s_waitcnt vmcnt(0)
    v_max3_u32 v19, v36, v37, v38
    v_max_u32 v19, v19, v39
    v_cmp_eq_u32 vcc, -1, v19
    s_nop 0
    s_cbranch_vccnz g_47F8_3
    v_smfmac_f32_16x16x64_bf16 v[64:67], v[36:39], a[216:223], v172
    v_smfmac_f32_16x16x64_bf16 v[68:71], v[36:39], a[248:255], v172
    s_nop 4
    v_cvt_pk_bf16_f32 v80, v64, v65
    v_cvt_pk_bf16_f32 v81, v66, v67
    s_nop 0
    v_cvt_pk_bf16_f32 v82, v68, v69
    v_cvt_pk_bf16_f32 v83, v70, v71
    ds_write_b128 v17, v[80:83] offset:9216
gc_48:
    s_waitcnt lgkmcnt(0)
    s_barrier
    s_nop 15
    s_nop 15
    s_nop 15
    s_nop 15
    buffer_store_dwordx4 v[168:171], v15, s[4:7], s20 offen sc1
    s_add_u32 s20, s20, 512
    s_add_u32 s21, s95, 1048576
    s_lshr_b32 s22, s21, 8
    s_and_b32 s22, s22, 8192
    s_xor_b32 s22, s22, s46
    s_add_u32 s21, s21, s22
    buffer_store_dwordx4 v[204:207], v9, s[4:7], s21 offen sc1
    s_add_u32 s21, s21, 262144
    buffer_store_dwordx4 v[204:207], v9, s[4:7], s21 offen sc1
    buffer_store_dword v247, v246, s[4:7], 0 offen sc1
    v_mov_b32 v40, 0
    v_mov_b32 v41, 0
    v_mov_b32 v42, 0
    v_mov_b32 v43, 0
    v_mov_b32 v44, 0
    v_mov_b32 v45, 0
    v_mov_b32 v46, 0
    v_mov_b32 v47, 0
    v_mov_b32 v48, 0
    v_mov_b32 v49, 0
    v_mov_b32 v50, 0
    v_mov_b32 v51, 0
    v_mov_b32 v52, 0
    v_mov_b32 v53, 0
    v_mov_b32 v54, 0
    v_mov_b32 v55, 0
    v_mov_b32 v56, 0
    v_mov_b32 v57, 0
    v_mov_b32 v58, 0
    v_mov_b32 v59, 0
    v_mov_b32 v60, 0
    v_mov_b32 v61, 0
    v_mov_b32 v62, 0
    v_mov_b32 v63, 0
    v_mov_b32 v64, 0
    v_mov_b32 v65, 0
    v_mov_b32 v66, 0
    v_mov_b32 v67, 0
    v_mov_b32 v68, 0
    v_mov_b32 v69, 0
    v_mov_b32 v70, 0
    v_mov_b32 v71, 0
    s_mov_b32 s21, s16
    s_mov_b32 s16, s42
    s_mov_b32 s42, s43
    s_mov_b32 s43, s44
    s_mov_b32 s44, s21
    s_add_u32 s95, s95, 524288
    s_lshr_b32 s84, s95, 8
    s_and_b32 s84, s84, 8192
    s_xor_b32 s84, s84, s46
    s_add_u32 s84, s84, s95
    s_add_u32 s15, s15, 1
    s_barrier
    s_branch recur_fast_w2
g_45L15_0:
    s_waitcnt vmcnt(3)
    v_max3_u32 v19, v24, v25, v26
    v_max_u32 v19, v19, v27
    v_cmp_eq_u32 vcc, -1, v19
    s_nop 0
    s_cbranch_vccnz g_45F15_0
    v_smfmac_f32_16x16x64_bf16 v[40:43], v[24:27], a[0:7], v172
    v_smfmac_f32_16x16x64_bf16 v[44:47], v[24:27], a[64:71], v172
    v_smfmac_f32_16x16x64_bf16 v[48:51], v[24:27], a[32:39], v172
    v_smfmac_f32_16x16x64_bf16 v[52:55], v[24:27], a[96:103], v172
g_45L14_1:
    s_waitcnt vmcnt(2)
    v_max3_u32 v19, v28, v29, v30
    v_max_u32 v19, v19, v31
    v_cmp_eq_u32 vcc, -1, v19
    s_nop 0
    s_cbranch_vccnz g_45F14_1
    v_smfmac_f32_16x16x64_bf16 v[40:43], v[28:31], a[8:15], v172
    v_smfmac_f32_16x16x64_bf16 v[44:47], v[28:31], a[72:79], v172
    v_smfmac_f32_16x16x64_bf16 v[48:51], v[28:31], a[40:47], v172
    v_smfmac_f32_16x16x64_bf16 v[52:55], v[28:31], a[104:111], v172
g_45L12_2:
    s_waitcnt vmcnt(1)
    v_max3_u32 v19, v32, v33, v34
    v_max_u32 v19, v19, v35
    v_cmp_eq_u32 vcc, -1, v19
    s_nop 0
    s_cbranch_vccnz g_45F12_2
    v_smfmac_f32_16x16x64_bf16 v[40:43], v[32:35], a[16:23], v172
    v_smfmac_f32_16x16x64_bf16 v[44:47], v[32:35], a[80:87], v172
    v_smfmac_f32_16x16x64_bf16 v[48:51], v[32:35], a[48:55], v172
    v_smfmac_f32_16x16x64_bf16 v[52:55], v[32:35], a[112:119], v172
g_45L8_3:
    s_waitcnt vmcnt(0)
    v_max3_u32 v19, v36, v37, v38
    v_max_u32 v19, v19, v39
    v_cmp_eq_u32 vcc, -1, v19
    s_nop 0
    s_cbranch_vccnz g_45F8_3
    v_smfmac_f32_16x16x64_bf16 v[40:43], v[36:39], a[24:31], v172
    v_smfmac_f32_16x16x64_bf16 v[44:47], v[36:39], a[88:95], v172
    v_smfmac_f32_16x16x64_bf16 v[48:51], v[36:39], a[56:63], v172
    v_smfmac_f32_16x16x64_bf16 v[52:55], v[36:39], a[120:127], v172
    s_branch gc_46
g_45L15_1:
    s_waitcnt vmcnt(3)
    v_max3_u32 v19, v28, v29, v30
    v_max_u32 v19, v19, v31
    v_cmp_eq_u32 vcc, -1, v19
    s_nop 0
    s_cbranch_vccnz g_45F15_1
    v_smfmac_f32_16x16x64_bf16 v[40:43], v[28:31], a[8:15], v172
    v_smfmac_f32_16x16x64_bf16 v[44:47], v[28:31], a[72:79], v172
    v_smfmac_f32_16x16x64_bf16 v[48:51], v[28:31], a[40:47], v172
    v_smfmac_f32_16x16x64_bf16 v[52:55], v[28:31], a[104:111], v172
g_45L13_2:
    s_waitcnt vmcnt(2)
    v_max3_u32 v19, v32, v33, v34
    v_max_u32 v19, v19, v35
    v_cmp_eq_u32 vcc, -1, v19
    s_nop 0
    s_cbranch_vccnz g_45F13_2
    v_smfmac_f32_16x16x64_bf16 v[40:43], v[32:35], a[16:23], v172
    v_smfmac_f32_16x16x64_bf16 v[44:47], v[32:35], a[80:87], v172
    v_smfmac_f32_16x16x64_bf16 v[48:51], v[32:35], a[48:55], v172
    v_smfmac_f32_16x16x64_bf16 v[52:55], v[32:35], a[112:119], v172
g_45L9_3:
    s_waitcnt vmcnt(1)
    v_max3_u32 v19, v36, v37, v38
    v_max_u32 v19, v19, v39
    v_cmp_eq_u32 vcc, -1, v19
    s_nop 0
    s_cbranch_vccnz g_45F9_3
    v_smfmac_f32_16x16x64_bf16 v[40:43], v[36:39], a[24:31], v172
    v_smfmac_f32_16x16x64_bf16 v[44:47], v[36:39], a[88:95], v172
    v_smfmac_f32_16x16x64_bf16 v[48:51], v[36:39], a[56:63], v172
    v_smfmac_f32_16x16x64_bf16 v[52:55], v[36:39], a[120:127], v172
g_45L1_0:
    s_waitcnt vmcnt(0)
    v_max3_u32 v19, v24, v25, v26
    v_max_u32 v19, v19, v27
    v_cmp_eq_u32 vcc, -1, v19
    s_nop 0
    s_cbranch_vccnz g_45F1_0
    v_smfmac_f32_16x16x64_bf16 v[40:43], v[24:27], a[0:7], v172
    v_smfmac_f32_16x16x64_bf16 v[44:47], v[24:27], a[64:71], v172
    v_smfmac_f32_16x16x64_bf16 v[48:51], v[24:27], a[32:39], v172
    v_smfmac_f32_16x16x64_bf16 v[52:55], v[24:27], a[96:103], v172
    s_branch gc_46
g_45L15_2:
    s_waitcnt vmcnt(3)
    v_max3_u32 v19, v32, v33, v34
    v_max_u32 v19, v19, v35
    v_cmp_eq_u32 vcc, -1, v19
    s_nop 0
    s_cbranch_vccnz g_45F15_2
    v_smfmac_f32_16x16x64_bf16 v[40:43], v[32:35], a[16:23], v172
    v_smfmac_f32_16x16x64_bf16 v[44:47], v[32:35], a[80:87], v172
    v_smfmac_f32_16x16x64_bf16 v[48:51], v[32:35], a[48:55], v172
    v_smfmac_f32_16x16x64_bf16 v[52:55], v[32:35], a[112:119], v172
g_45L11_3:
    s_waitcnt vmcnt(2)
    v_max3_u32 v19, v36, v37, v38
    v_max_u32 v19, v19, v39
    v_cmp_eq_u32 vcc, -1, v19
    s_nop 0
    s_cbranch_vccnz g_45F11_3
    v_smfmac_f32_16x16x64_bf16 v[40:43], v[36:39], a[24:31], v172
    v_smfmac_f32_16x16x64_bf16 v[44:47], v[36:39], a[88:95], v172
    v_smfmac_f32_16x16x64_bf16 v[48:51], v[36:39], a[56:63], v172
    v_smfmac_f32_16x16x64_bf16 v[52:55], v[36:39], a[120:127], v172
g_45L3_0:
    s_waitcnt vmcnt(1)
    v_max3_u32 v19, v24, v25, v26
    v_max_u32 v19, v19, v27
    v_cmp_eq_u32 vcc, -1, v19
    s_nop 0
    s_cbranch_vccnz g_45F3_0
    v_smfmac_f32_16x16x64_bf16 v[40:43], v[24:27], a[0:7], v172
    v_smfmac_f32_16x16x64_bf16 v[44:47], v[24:27], a[64:71], v172
    v_smfmac_f32_16x16x64_bf16 v[48:51], v[24:27], a[32:39], v172
    v_smfmac_f32_16x16x64_bf16 v[52:55], v[24:27], a[96:103], v172
g_45L2_1:
    s_waitcnt vmcnt(0)
    v_max3_u32 v19, v28, v29, v30
    v_max_u32 v19, v19, v31
    v_cmp_eq_u32 vcc, -1, v19
    s_nop 0
    s_cbranch_vccnz g_45F2_1
    v_smfmac_f32_16x16x64_bf16 v[40:43], v[28:31], a[8:15], v172
    v_smfmac_f32_16x16x64_bf16 v[44:47], v[28:31], a[72:79], v172
    v_smfmac_f32_16x16x64_bf16 v[48:51], v[28:31], a[40:47], v172
    v_smfmac_f32_16x16x64_bf16 v[52:55], v[28:31], a[104:111], v172
    s_branch gc_46
g_45L15_3:
    s_waitcnt vmcnt(3)
    v_max3_u32 v19, v36, v37, v38
    v_max_u32 v19, v19, v39
    v_cmp_eq_u32 vcc, -1, v19
    s_nop 0
    s_cbranch_vccnz g_45F15_3
    v_smfmac_f32_16x16x64_bf16 v[40:43], v[36:39], a[24:31], v172
    v_smfmac_f32_16x16x64_bf16 v[44:47], v[36:39], a[88:95], v172
    v_smfmac_f32_16x16x64_bf16 v[48:51], v[36:39], a[56:63], v172
    v_smfmac_f32_16x16x64_bf16 v[52:55], v[36:39], a[120:127], v172
g_45L7_0:
    s_waitcnt vmcnt(2)
    v_max3_u32 v19, v24, v25, v26
    v_max_u32 v19, v19, v27
    v_cmp_eq_u32 vcc, -1, v19
    s_nop 0
    s_cbranch_vccnz g_45F7_0
    v_smfmac_f32_16x16x64_bf16 v[40:43], v[24:27], a[0:7], v172
    v_smfmac_f32_16x16x64_bf16 v[44:47], v[24:27], a[64:71], v172
    v_smfmac_f32_16x16x64_bf16 v[48:51], v[24:27], a[32:39], v172
    v_smfmac_f32_16x16x64_bf16 v[52:55], v[24:27], a[96:103], v172
g_45L6_1:
    s_waitcnt vmcnt(1)
    v_max3_u32 v19, v28, v29, v30
    v_max_u32 v19, v19, v31
    v_cmp_eq_u32 vcc, -1, v19
    s_nop 0
    s_cbranch_vccnz g_45F6_1
    v_smfmac_f32_16x16x64_bf16 v[40:43], v[28:31], a[8:15], v172
    v_smfmac_f32_16x16x64_bf16 v[44:47], v[28:31], a[72:79], v172
    v_smfmac_f32_16x16x64_bf16 v[48:51], v[28:31], a[40:47], v172
    v_smfmac_f32_16x16x64_bf16 v[52:55], v[28:31], a[104:111], v172
g_45L4_2:
    s_waitcnt vmcnt(0)
    v_max3_u32 v19, v32, v33, v34
    v_max_u32 v19, v19, v35
    v_cmp_eq_u32 vcc, -1, v19
    s_nop 0
    s_cbranch_vccnz g_45F4_2
    v_smfmac_f32_16x16x64_bf16 v[40:43], v[32:35], a[16:23], v172
    v_smfmac_f32_16x16x64_bf16 v[44:47], v[32:35], a[80:87], v172
    v_smfmac_f32_16x16x64_bf16 v[48:51], v[32:35], a[48:55], v172
    v_smfmac_f32_16x16x64_bf16 v[52:55], v[32:35], a[112:119], v172
    s_branch gc_46
g_45L7_1:
    s_waitcnt vmcnt(2)
    v_max3_u32 v19, v28, v29, v30
    v_max_u32 v19, v19, v31
    v_cmp_eq_u32 vcc, -1, v19
    s_nop 0
    s_cbranch_vccnz g_45F7_1
    v_smfmac_f32_16x16x64_bf16 v[40:43], v[28:31], a[8:15], v172
    v_smfmac_f32_16x16x64_bf16 v[44:47], v[28:31], a[72:79], v172
    v_smfmac_f32_16x16x64_bf16 v[48:51], v[28:31], a[40:47], v172
    v_smfmac_f32_16x16x64_bf16 v[52:55], v[28:31], a[104:111], v172
g_45L5_2:
    s_waitcnt vmcnt(1)
    v_max3_u32 v19, v32, v33, v34
    v_max_u32 v19, v19, v35
    v_cmp_eq_u32 vcc, -1, v19
    s_nop 0
    s_cbranch_vccnz g_45F5_2
    v_smfmac_f32_16x16x64_bf16 v[40:43], v[32:35], a[16:23], v172
    v_smfmac_f32_16x16x64_bf16 v[44:47], v[32:35], a[80:87], v172
    v_smfmac_f32_16x16x64_bf16 v[48:51], v[32:35], a[48:55], v172
    v_smfmac_f32_16x16x64_bf16 v[52:55], v[32:35], a[112:119], v172
    s_branch g_45L1_0
g_45L7_2:
    s_waitcnt vmcnt(2)
    v_max3_u32 v19, v32, v33, v34
    v_max_u32 v19, v19, v35
    v_cmp_eq_u32 vcc, -1, v19
    s_nop 0
    s_cbranch_vccnz g_45F7_2
    v_smfmac_f32_16x16x64_bf16 v[40:43], v[32:35], a[16:23], v172
    v_smfmac_f32_16x16x64_bf16 v[44:47], v[32:35], a[80:87], v172
    v_smfmac_f32_16x16x64_bf16 v[48:51], v[32:35], a[48:55], v172
    v_smfmac_f32_16x16x64_bf16 v[52:55], v[32:35], a[112:119], v172
    s_branch g_45L3_0
g_45L11_0:
    s_waitcnt vmcnt(2)
    v_max3_u32 v19, v24, v25, v26
    v_max_u32 v19, v19, v27
    v_cmp_eq_u32 vcc, -1, v19
    s_nop 0
    s_cbranch_vccnz g_45F11_0
    v_smfmac_f32_16x16x64_bf16 v[40:43], v[24:27], a[0:7], v172
    v_smfmac_f32_16x16x64_bf16 v[44:47], v[24:27], a[64:71], v172
    v_smfmac_f32_16x16x64_bf16 v[48:51], v[24:27], a[32:39], v172
    v_smfmac_f32_16x16x64_bf16 v[52:55], v[24:27], a[96:103], v172
g_45L10_1:
    s_waitcnt vmcnt(1)
    v_max3_u32 v19, v28, v29, v30
    v_max_u32 v19, v19, v31
    v_cmp_eq_u32 vcc, -1, v19
    s_nop 0
    s_cbranch_vccnz g_45F10_1
    v_smfmac_f32_16x16x64_bf16 v[40:43], v[28:31], a[8:15], v172
    v_smfmac_f32_16x16x64_bf16 v[44:47], v[28:31], a[72:79], v172
    v_smfmac_f32_16x16x64_bf16 v[48:51], v[28:31], a[40:47], v172
    v_smfmac_f32_16x16x64_bf16 v[52:55], v[28:31], a[104:111], v172
    s_branch g_45L8_3
g_45L11_1:
    s_waitcnt vmcnt(2)
    v_max3_u32 v19, v28, v29, v30
    v_max_u32 v19, v19, v31
    v_cmp_eq_u32 vcc, -1, v19
    s_nop 0
    s_cbranch_vccnz g_45F11_1
    v_smfmac_f32_16x16x64_bf16 v[40:43], v[28:31], a[8:15], v172
    v_smfmac_f32_16x16x64_bf16 v[44:47], v[28:31], a[72:79], v172
    v_smfmac_f32_16x16x64_bf16 v[48:51], v[28:31], a[40:47], v172
    v_smfmac_f32_16x16x64_bf16 v[52:55], v[28:31], a[104:111], v172
    s_branch g_45L9_3
g_45L13_0:
    s_waitcnt vmcnt(2)
    v_max3_u32 v19, v24, v25, v26
    v_max_u32 v19, v19, v27
    v_cmp_eq_u32 vcc, -1, v19
    s_nop 0
    s_cbranch_vccnz g_45F13_0
    v_smfmac_f32_16x16x64_bf16 v[40:43], v[24:27], a[0:7], v172
    v_smfmac_f32_16x16x64_bf16 v[44:47], v[24:27], a[64:71], v172
    v_smfmac_f32_16x16x64_bf16 v[48:51], v[24:27], a[32:39], v172
    v_smfmac_f32_16x16x64_bf16 v[52:55], v[24:27], a[96:103], v172
    s_branch g_45L12_2
g_45L13_3:
    s_waitcnt vmcnt(2)
    v_max3_u32 v19, v36, v37, v38
    v_max_u32 v19, v19, v39
    v_cmp_eq_u32 vcc, -1, v19
    s_nop 0
    s_cbranch_vccnz g_45F13_3
    v_smfmac_f32_16x16x64_bf16 v[40:43], v[36:39], a[24:31], v172
    v_smfmac_f32_16x16x64_bf16 v[44:47], v[36:39], a[88:95], v172
    v_smfmac_f32_16x16x64_bf16 v[48:51], v[36:39], a[56:63], v172
    v_smfmac_f32_16x16x64_bf16 v[52:55], v[36:39], a[120:127], v172
g_45L5_0:
    s_waitcnt vmcnt(1)
    v_max3_u32 v19, v24, v25, v26
    v_max_u32 v19, v19, v27
    v_cmp_eq_u32 vcc, -1, v19
    s_nop 0
    s_cbranch_vccnz g_45F5_0
    v_smfmac_f32_16x16x64_bf16 v[40:43], v[24:27], a[0:7], v172
    v_smfmac_f32_16x16x64_bf16 v[44:47], v[24:27], a[64:71], v172
    v_smfmac_f32_16x16x64_bf16 v[48:51], v[24:27], a[32:39], v172
    v_smfmac_f32_16x16x64_bf16 v[52:55], v[24:27], a[96:103], v172
    s_branch g_45L4_2
g_45L14_2:
    s_waitcnt vmcnt(2)
    v_max3_u32 v19, v32, v33, v34
    v_max_u32 v19, v19, v35
    v_cmp_eq_u32 vcc, -1, v19
    s_nop 0
    s_cbranch_vccnz g_45F14_2
    v_smfmac_f32_16x16x64_bf16 v[40:43], v[32:35], a[16:23], v172
    v_smfmac_f32_16x16x64_bf16 v[44:47], v[32:35], a[80:87], v172
    v_smfmac_f32_16x16x64_bf16 v[48:51], v[32:35], a[48:55], v172
    v_smfmac_f32_16x16x64_bf16 v[52:55], v[32:35], a[112:119], v172
g_45L10_3:
    s_waitcnt vmcnt(1)
    v_max3_u32 v19, v36, v37, v38
    v_max_u32 v19, v19, v39
    v_cmp_eq_u32 vcc, -1, v19
    s_nop 0
    s_cbranch_vccnz g_45F10_3
    v_smfmac_f32_16x16x64_bf16 v[40:43], v[36:39], a[24:31], v172
    v_smfmac_f32_16x16x64_bf16 v[44:47], v[36:39], a[88:95], v172
    v_smfmac_f32_16x16x64_bf16 v[48:51], v[36:39], a[56:63], v172
    v_smfmac_f32_16x16x64_bf16 v[52:55], v[36:39], a[120:127], v172
    s_branch g_45L2_1
g_45L14_3:
    s_waitcnt vmcnt(2)
    v_max3_u32 v19, v36, v37, v38
    v_max_u32 v19, v19, v39
    v_cmp_eq_u32 vcc, -1, v19
    s_nop 0
    s_cbranch_vccnz g_45F14_3
    v_smfmac_f32_16x16x64_bf16 v[40:43], v[36:39], a[24:31], v172
    v_smfmac_f32_16x16x64_bf16 v[44:47], v[36:39], a[88:95], v172
    v_smfmac_f32_16x16x64_bf16 v[48:51], v[36:39], a[56:63], v172
    v_smfmac_f32_16x16x64_bf16 v[52:55], v[36:39], a[120:127], v172
    s_branch g_45L6_1
g_45L3_1:
    s_waitcnt vmcnt(1)
    v_max3_u32 v19, v28, v29, v30
    v_max_u32 v19, v19, v31
    v_cmp_eq_u32 vcc, -1, v19
    s_nop 0
    s_cbranch_vccnz g_45F3_1
    v_smfmac_f32_16x16x64_bf16 v[40:43], v[28:31], a[8:15], v172
    v_smfmac_f32_16x16x64_bf16 v[44:47], v[28:31], a[72:79], v172
    v_smfmac_f32_16x16x64_bf16 v[48:51], v[28:31], a[40:47], v172
    v_smfmac_f32_16x16x64_bf16 v[52:55], v[28:31], a[104:111], v172
    s_branch g_45L1_0
g_45L6_2:
    s_waitcnt vmcnt(1)
    v_max3_u32 v19, v32, v33, v34
    v_max_u32 v19, v19, v35
    v_cmp_eq_u32 vcc, -1, v19
    s_nop 0
    s_cbranch_vccnz g_45F6_2
    v_smfmac_f32_16x16x64_bf16 v[40:43], v[32:35], a[16:23], v172
    v_smfmac_f32_16x16x64_bf16 v[44:47], v[32:35], a[80:87], v172
    v_smfmac_f32_16x16x64_bf16 v[48:51], v[32:35], a[48:55], v172
    v_smfmac_f32_16x16x64_bf16 v[52:55], v[32:35], a[112:119], v172
    s_branch g_45L2_1
g_45L9_0:
    s_waitcnt vmcnt(1)
    v_max3_u32 v19, v24, v25, v26
    v_max_u32 v19, v19, v27
    v_cmp_eq_u32 vcc, -1, v19
    s_nop 0
    s_cbranch_vccnz g_45F9_0
    v_smfmac_f32_16x16x64_bf16 v[40:43], v[24:27], a[0:7], v172
    v_smfmac_f32_16x16x64_bf16 v[44:47], v[24:27], a[64:71], v172
    v_smfmac_f32_16x16x64_bf16 v[48:51], v[24:27], a[32:39], v172
    v_smfmac_f32_16x16x64_bf16 v[52:55], v[24:27], a[96:103], v172
    s_branch g_45L8_3
g_45L12_3:
    s_waitcnt vmcnt(1)
    v_max3_u32 v19, v36, v37, v38
    v_max_u32 v19, v19, v39
    v_cmp_eq_u32 vcc, -1, v19
    s_nop 0
    s_cbranch_vccnz g_45F12_3
    v_smfmac_f32_16x16x64_bf16 v[40:43], v[36:39], a[24:31], v172
    v_smfmac_f32_16x16x64_bf16 v[44:47], v[36:39], a[88:95], v172
    v_smfmac_f32_16x16x64_bf16 v[48:51], v[36:39], a[56:63], v172
    v_smfmac_f32_16x16x64_bf16 v[52:55], v[36:39], a[120:127], v172
    s_branch g_45L4_2
g_45F15_0:
    s_mov_b64 exec, vcc
    buffer_load_dwordx4 v[24:27], v2, s[4:7], s16 offen offset:0 sc1
    s_mov_b64 exec, -1
    s_add_u32 s23, s23, 1
    s_cmp_lt_u32 s23, 200000
    s_cbranch_scc1 g_45L15_1
    s_mov_b32 s25, 200000
    s_branch gc_46
g_45F15_1:
    s_mov_b64 exec, vcc
    buffer_load_dwordx4 v[28:31], v2, s[4:7], s16 offen offset:1024 sc1
    s_mov_b64 exec, -1
    s_add_u32 s23, s23, 1
    s_cmp_lt_u32 s23, 200000
    s_cbranch_scc1 g_45L15_2
    s_mov_b32 s25, 200000
    s_branch gc_46
g_45F15_2:
    s_mov_b64 exec, vcc
    buffer_load_dwordx4 v[32:35], v2, s[4:7], s16 offen offset:2048 sc1
    s_mov_b64 exec, -1
    s_add_u32 s23, s23, 1
    s_cmp_lt_u32 s23, 200000
    s_cbranch_scc1 g_45L15_3
    s_mov_b32 s25, 200000
    s_branch gc_46
g_45F15_3:
    s_mov_b64 exec, vcc
    buffer_load_dwordx4 v[36:39], v2, s[4:7], s16 offen offset:3072 sc1
    s_mov_b64 exec, -1
    s_add_u32 s23, s23, 1
    s_cmp_lt_u32 s23, 200000
    s_cbranch_scc1 g_45L15_0
    s_mov_b32 s25, 200000
    s_branch gc_46
g_45F7_0:
    s_mov_b64 exec, vcc
    buffer_load_dwordx4 v[24:27], v2, s[4:7], s16 offen offset:0 sc1
    s_mov_b64 exec, -1
    s_add_u32 s23, s23, 1
    s_cmp_lt_u32 s23, 200000
    s_cbranch_scc1 g_45L7_1
    s_mov_b32 s25, 200000
    s_branch gc_46
g_45F7_1:
    s_mov_b64 exec, vcc
    buffer_load_dwordx4 v[28:31], v2, s[4:7], s16 offen offset:1024 sc1
    s_mov_b64 exec, -1
    s_add_u32 s23, s23, 1
    s_cmp_lt_u32 s23, 200000
    s_cbranch_scc1 g_45L7_2
    s_mov_b32 s25, 200000
    s_branch gc_46
g_45F7_2:
    s_mov_b64 exec, vcc
    buffer_load_dwordx4 v[32:35], v2, s[4:7], s16 offen offset:2048 sc1
    s_mov_b64 exec, -1
    s_add_u32 s23, s23, 1
    s_cmp_lt_u32 s23, 200000
    s_cbranch_scc1 g_45L7_0
    s_mov_b32 s25, 200000
    s_branch gc_46
g_45F11_0:
    s_mov_b64 exec, vcc
    buffer_load_dwordx4 v[24:27], v2, s[4:7], s16 offen offset:0 sc1
    s_mov_b64 exec, -1
    s_add_u32 s23, s23, 1
    s_cmp_lt_u32 s23, 200000
    s_cbranch_scc1 g_45L11_1
    s_mov_b32 s25, 200000
    s_branch gc_46
g_45F11_1:
    s_mov_b64 exec, vcc
    buffer_load_dwordx4 v[28:31], v2, s[4:7], s16 offen offset:1024 sc1
    s_mov_b64 exec, -1
    s_add_u32 s23, s23, 1
    s_cmp_lt_u32 s23, 200000
    s_cbranch_scc1 g_45L11_3
    s_mov_b32 s25, 200000
    s_branch gc_46
g_45F11_3:
    s_mov_b64 exec, vcc
    buffer_load_dwordx4 v[36:39], v2, s[4:7], s16 offen offset:3072 sc1
    s_mov_b64 exec, -1
    s_add_u32 s23, s23, 1
    s_cmp_lt_u32 s23, 200000
    s_cbranch_scc1 g_45L11_0
    s_mov_b32 s25, 200000
    s_branch gc_46
g_45F13_0:
    s_mov_b64 exec, vcc
    buffer_load_dwordx4 v[24:27], v2, s[4:7], s16 offen offset:0 sc1
    s_mov_b64 exec, -1
    s_add_u32 s23, s23, 1
    s_cmp_lt_u32 s23, 200000
    s_cbranch_scc1 g_45L13_2
    s_mov_b32 s25, 200000
    s_branch gc_46
g_45F13_2:
    s_mov_b64 exec, vcc
    buffer_load_dwordx4 v[32:35], v2, s[4:7], s16 offen offset:2048 sc1
    s_mov_b64 exec, -1
    s_add_u32 s23, s23, 1
    s_cmp_lt_u32 s23, 200000
    s_cbranch_scc1 g_45L13_3
    s_mov_b32 s25, 200000
    s_branch gc_46
g_45F13_3:
    s_mov_b64 exec, vcc
    buffer_load_dwordx4 v[36:39], v2, s[4:7], s16 offen offset:3072 sc1
    s_mov_b64 exec, -1
    s_add_u32 s23, s23, 1
    s_cmp_lt_u32 s23, 200000
    s_cbranch_scc1 g_45L13_0
    s_mov_b32 s25, 200000
    s_branch gc_46
g_45F14_1:
    s_mov_b64 exec, vcc
    buffer_load_dwordx4 v[28:31], v2, s[4:7], s16 offen offset:1024 sc1
    s_mov_b64 exec, -1
    s_add_u32 s23, s23, 1
    s_cmp_lt_u32 s23, 200000
    s_cbranch_scc1 g_45L14_2
    s_mov_b32 s25, 200000
    s_branch gc_46
g_45F14_2:
    s_mov_b64 exec, vcc
    buffer_load_dwordx4 v[32:35], v2, s[4:7], s16 offen offset:2048 sc1
    s_mov_b64 exec, -1
    s_add_u32 s23, s23, 1
    s_cmp_lt_u32 s23, 200000
    s_cbranch_scc1 g_45L14_3
    s_mov_b32 s25, 200000
    s_branch gc_46
g_45F14_3:
    s_mov_b64 exec, vcc
    buffer_load_dwordx4 v[36:39], v2, s[4:7], s16 offen offset:3072 sc1
    s_mov_b64 exec, -1
    s_add_u32 s23, s23, 1
    s_cmp_lt_u32 s23, 200000
    s_cbranch_scc1 g_45L14_1
    s_mov_b32 s25, 200000
    s_branch gc_46
g_45F3_0:
    s_mov_b64 exec, vcc
    buffer_load_dwordx4 v[24:27], v2, s[4:7], s16 offen offset:0 sc1
    s_mov_b64 exec, -1
    s_add_u32 s23, s23, 1
    s_cmp_lt_u32 s23, 200000
    s_cbranch_scc1 g_45L3_1
    s_mov_b32 s25, 200000
    s_branch gc_46
g_45F3_1:
    s_mov_b64 exec, vcc
    buffer_load_dwordx4 v[28:31], v2, s[4:7], s16 offen offset:1024 sc1
    s_mov_b64 exec, -1
    s_add_u32 s23, s23, 1
    s_cmp_lt_u32 s23, 200000
    s_cbranch_scc1 g_45L3_0
    s_mov_b32 s25, 200000
    s_branch gc_46
g_45F5_0:
    s_mov_b64 exec, vcc
    buffer_load_dwordx4 v[24:27], v2, s[4:7], s16 offen offset:0 sc1
    s_mov_b64 exec, -1
    s_add_u32 s23, s23, 1
    s_cmp_lt_u32 s23, 200000
    s_cbranch_scc1 g_45L5_2
    s_mov_b32 s25, 200000
    s_branch gc_46
g_45F5_2:
    s_mov_b64 exec, vcc
    buffer_load_dwordx4 v[32:35], v2, s[4:7], s16 offen offset:2048 sc1
    s_mov_b64 exec, -1
    s_add_u32 s23, s23, 1
    s_cmp_lt_u32 s23, 200000
    s_cbranch_scc1 g_45L5_0
    s_mov_b32 s25, 200000
    s_branch gc_46
g_45F6_1:
    s_mov_b64 exec, vcc
    buffer_load_dwordx4 v[28:31], v2, s[4:7], s16 offen offset:1024 sc1
    s_mov_b64 exec, -1
    s_add_u32 s23, s23, 1
    s_cmp_lt_u32 s23, 200000
    s_cbranch_scc1 g_45L6_2
    s_mov_b32 s25, 200000
    s_branch gc_46
g_45F6_2:
    s_mov_b64 exec, vcc
    buffer_load_dwordx4 v[32:35], v2, s[4:7], s16 offen offset:2048 sc1
    s_mov_b64 exec, -1
    s_add_u32 s23, s23, 1
    s_cmp_lt_u32 s23, 200000
    s_cbranch_scc1 g_45L6_1
    s_mov_b32 s25, 200000
    s_branch gc_46
g_45F9_0:
    s_mov_b64 exec, vcc
    buffer_load_dwordx4 v[24:27], v2, s[4:7], s16 offen offset:0 sc1
    s_mov_b64 exec, -1
    s_add_u32 s23, s23, 1
    s_cmp_lt_u32 s23, 200000
    s_cbranch_scc1 g_45L9_3
    s_mov_b32 s25, 200000
    s_branch gc_46
g_45F9_3:
    s_mov_b64 exec, vcc
    buffer_load_dwordx4 v[36:39], v2, s[4:7], s16 offen offset:3072 sc1
    s_mov_b64 exec, -1
    s_add_u32 s23, s23, 1
    s_cmp_lt_u32 s23, 200000
    s_cbranch_scc1 g_45L9_0
    s_mov_b32 s25, 200000
    s_branch gc_46
g_45F10_1:
    s_mov_b64 exec, vcc
    buffer_load_dwordx4 v[28:31], v2, s[4:7], s16 offen offset:1024 sc1
    s_mov_b64 exec, -1
    s_add_u32 s23, s23, 1
    s_cmp_lt_u32 s23, 200000
    s_cbranch_scc1 g_45L10_3
    s_mov_b32 s25, 200000
    s_branch gc_46
g_45F10_3:
    s_mov_b64 exec, vcc
    buffer_load_dwordx4 v[36:39], v2, s[4:7], s16 offen offset:3072 sc1
    s_mov_b64 exec, -1
    s_add_u32 s23, s23, 1
    s_cmp_lt_u32 s23, 200000
    s_cbranch_scc1 g_45L10_1
    s_mov_b32 s25, 200000
    s_branch gc_46
g_45F12_2:
    s_mov_b64 exec, vcc
    buffer_load_dwordx4 v[32:35], v2, s[4:7], s16 offen offset:2048 sc1
    s_mov_b64 exec, -1
    s_add_u32 s23, s23, 1
    s_cmp_lt_u32 s23, 200000
    s_cbranch_scc1 g_45L12_3
    s_mov_b32 s25, 200000
    s_branch gc_46
g_45F12_3:
    s_mov_b64 exec, vcc
    buffer_load_dwordx4 v[36:39], v2, s[4:7], s16 offen offset:3072 sc1
    s_mov_b64 exec, -1
    s_add_u32 s23, s23, 1
    s_cmp_lt_u32 s23, 200000
    s_cbranch_scc1 g_45L12_2
    s_mov_b32 s25, 200000
    s_branch gc_46
g_45F1_0:
    s_mov_b64 exec, vcc
    buffer_load_dwordx4 v[24:27], v2, s[4:7], s16 offen offset:0 sc1
    s_mov_b64 exec, -1
    s_add_u32 s23, s23, 1
    s_cmp_lt_u32 s23, 200000
    s_cbranch_scc1 g_45L1_0
    s_mov_b32 s25, 200000
    s_branch gc_46
g_45F2_1:
    s_mov_b64 exec, vcc
    buffer_load_dwordx4 v[28:31], v2, s[4:7], s16 offen offset:1024 sc1
    s_mov_b64 exec, -1
    s_add_u32 s23, s23, 1
    s_cmp_lt_u32 s23, 200000
    s_cbranch_scc1 g_45L2_1
    s_mov_b32 s25, 200000
    s_branch gc_46
g_45F4_2:
    s_mov_b64 exec, vcc
    buffer_load_dwordx4 v[32:35], v2, s[4:7], s16 offen offset:2048 sc1
    s_mov_b64 exec, -1
    s_add_u32 s23, s23, 1
    s_cmp_lt_u32 s23, 200000
    s_cbranch_scc1 g_45L4_2
    s_mov_b32 s25, 200000
    s_branch gc_46
g_45F8_3:
    s_mov_b64 exec, vcc
    buffer_load_dwordx4 v[36:39], v2, s[4:7], s16 offen offset:3072 sc1
    s_mov_b64 exec, -1
    s_add_u32 s23, s23, 1
    s_cmp_lt_u32 s23, 200000
    s_cbranch_scc1 g_45L8_3
    s_mov_b32 s25, 200000
    s_branch gc_46
recur_fast_last2:
    buffer_store_dwordx4 v[168:171], v15, s[4:7], s20 offen sc1
    s_waitcnt vmcnt(0)
    s_branch recur_end
g_47L15_0:
    s_waitcnt vmcnt(3)
    v_max3_u32 v19, v24, v25, v26
    v_max_u32 v19, v19, v27
    v_cmp_eq_u32 vcc, -1, v19
    s_nop 0
    s_cbranch_vccnz g_47F15_0
    v_smfmac_f32_16x16x64_bf16 v[64:67], v[24:27], a[192:199], v172
    v_smfmac_f32_16x16x64_bf16 v[68:71], v[24:27], a[224:231], v172
g_47L14_1:
    s_waitcnt vmcnt(2)
    v_max3_u32 v19, v28, v29, v30
    v_max_u32 v19, v19, v31
    v_cmp_eq_u32 vcc, -1, v19
    s_nop 0
    s_cbranch_vccnz g_47F14_1
    v_smfmac_f32_16x16x64_bf16 v[64:67], v[28:31], a[200:207], v172
    v_smfmac_f32_16x16x64_bf16 v[68:71], v[28:31], a[232:239], v172
g_47L12_2:
    s_waitcnt vmcnt(1)
    v_max3_u32 v19, v32, v33, v34
    v_max_u32 v19, v19, v35
    v_cmp_eq_u32 vcc, -1, v19
    s_nop 0
    s_cbranch_vccnz g_47F12_2
    v_smfmac_f32_16x16x64_bf16 v[64:67], v[32:35], a[208:215], v172
    v_smfmac_f32_16x16x64_bf16 v[68:71], v[32:35], a[240:247], v172
g_47L8_3:
    s_waitcnt vmcnt(0)
    v_max3_u32 v19, v36, v37, v38
    v_max_u32 v19, v19, v39
    v_cmp_eq_u32 vcc, -1, v19
    s_nop 0
    s_cbranch_vccnz g_47F8_3
    v_smfmac_f32_16x16x64_bf16 v[64:67], v[36:39], a[216:223], v172
    v_smfmac_f32_16x16x64_bf16 v[68:71], v[36:39], a[248:255], v172
    s_nop 4
    v_cvt_pk_bf16_f32 v80, v64, v65
    v_cvt_pk_bf16_f32 v81, v66, v67
    s_nop 0
    v_cvt_pk_bf16_f32 v82, v68, v69
    v_cvt_pk_bf16_f32 v83, v70, v71
    ds_write_b128 v17, v[80:83] offset:9216
    s_branch gc_48
g_47L15_1:
    s_waitcnt vmcnt(3)
    v_max3_u32 v19, v28, v29, v30
    v_max_u32 v19, v19, v31
    v_cmp_eq_u32 vcc, -1, v19
    s_nop 0
    s_cbranch_vccnz g_47F15_1
    v_smfmac_f32_16x16x64_bf16 v[64:67], v[28:31], a[200:207], v172
    v_smfmac_f32_16x16x64_bf16 v[68:71], v[28:31], a[232:239], v172
g_47L13_2:
    s_waitcnt vmcnt(2)
    v_max3_u32 v19, v32, v33, v34
    v_max_u32 v19, v19, v35
    v_cmp_eq_u32 vcc, -1, v19
    s_nop 0
    s_cbranch_vccnz g_47F13_2
    v_smfmac_f32_16x16x64_bf16 v[64:67], v[32:35], a[208:215], v172
    v_smfmac_f32_16x16x64_bf16 v[68:71], v[32:35], a[240:247], v172
g_47L9_3:
    s_waitcnt vmcnt(1)
    v_max3_u32 v19, v36, v37, v38
    v_max_u32 v19, v19, v39
    v_cmp_eq_u32 vcc, -1, v19
    s_nop 0
    s_cbranch_vccnz g_47F9_3
    v_smfmac_f32_16x16x64_bf16 v[64:67], v[36:39], a[216:223], v172
    v_smfmac_f32_16x16x64_bf16 v[68:71], v[36:39], a[248:255], v172
g_47L1_0:
    s_waitcnt vmcnt(0)
    v_max3_u32 v19, v24, v25, v26
    v_max_u32 v19, v19, v27
    v_cmp_eq_u32 vcc, -1, v19
    s_nop 0
    s_cbranch_vccnz g_47F1_0
    v_smfmac_f32_16x16x64_bf16 v[64:67], v[24:27], a[192:199], v172
    v_smfmac_f32_16x16x64_bf16 v[68:71], v[24:27], a[224:231], v172
    s_nop 4
    v_cvt_pk_bf16_f32 v80, v64, v65
    v_cvt_pk_bf16_f32 v81, v66, v67
    s_nop 0
    v_cvt_pk_bf16_f32 v82, v68, v69
    v_cvt_pk_bf16_f32 v83, v70, v71
    ds_write_b128 v17, v[80:83] offset:9216
    s_branch gc_48
g_47L15_2:
    s_waitcnt vmcnt(3)
    v_max3_u32 v19, v32, v33, v34
    v_max_u32 v19, v19, v35
    v_cmp_eq_u32 vcc, -1, v19
    s_nop 0
    s_cbranch_vccnz g_47F15_2
    v_smfmac_f32_16x16x64_bf16 v[64:67], v[32:35], a[208:215], v172
    v_smfmac_f32_16x16x64_bf16 v[68:71], v[32:35], a[240:247], v172
g_47L11_3:
    s_waitcnt vmcnt(2)
    v_max3_u32 v19, v36, v37, v38
    v_max_u32 v19, v19, v39
    v_cmp_eq_u32 vcc, -1, v19
    s_nop 0
    s_cbranch_vccnz g_47F11_3
    v_smfmac_f32_16x16x64_bf16 v[64:67], v[36:39], a[216:223], v172
    v_smfmac_f32_16x16x64_bf16 v[68:71], v[36:39], a[248:255], v172
g_47L3_0:
    s_waitcnt vmcnt(1)
    v_max3_u32 v19, v24, v25, v26
    v_max_u32 v19, v19, v27
    v_cmp_eq_u32 vcc, -1, v19
    s_nop 0
    s_cbranch_vccnz g_47F3_0
    v_smfmac_f32_16x16x64_bf16 v[64:67], v[24:27], a[192:199], v172
    v_smfmac_f32_16x16x64_bf16 v[68:71], v[24:27], a[224:231], v172
g_47L2_1:
    s_waitcnt vmcnt(0)
    v_max3_u32 v19, v28, v29, v30
    v_max_u32 v19, v19, v31
    v_cmp_eq_u32 vcc, -1, v19
    s_nop 0
    s_cbranch_vccnz g_47F2_1
    v_smfmac_f32_16x16x64_bf16 v[64:67], v[28:31], a[200:207], v172
    v_smfmac_f32_16x16x64_bf16 v[68:71], v[28:31], a[232:239], v172
    s_nop 4
    v_cvt_pk_bf16_f32 v80, v64, v65
    v_cvt_pk_bf16_f32 v81, v66, v67
    s_nop 0
    v_cvt_pk_bf16_f32 v82, v68, v69
    v_cvt_pk_bf16_f32 v83, v70, v71
    ds_write_b128 v17, v[80:83] offset:9216
    s_branch gc_48
g_47L15_3:
    s_waitcnt vmcnt(3)
    v_max3_u32 v19, v36, v37, v38
    v_max_u32 v19, v19, v39
    v_cmp_eq_u32 vcc, -1, v19
    s_nop 0
    s_cbranch_vccnz g_47F15_3
    v_smfmac_f32_16x16x64_bf16 v[64:67], v[36:39], a[216:223], v172
    v_smfmac_f32_16x16x64_bf16 v[68:71], v[36:39], a[248:255], v172
g_47L7_0:
    s_waitcnt vmcnt(2)
    v_max3_u32 v19, v24, v25, v26
    v_max_u32 v19, v19, v27
    v_cmp_eq_u32 vcc, -1, v19
    s_nop 0
    s_cbranch_vccnz g_47F7_0
    v_smfmac_f32_16x16x64_bf16 v[64:67], v[24:27], a[192:199], v172
    v_smfmac_f32_16x16x64_bf16 v[68:71], v[24:27], a[224:231], v172
g_47L6_1:
    s_waitcnt vmcnt(1)
    v_max3_u32 v19, v28, v29, v30
    v_max_u32 v19, v19, v31
    v_cmp_eq_u32 vcc, -1, v19
    s_nop 0
    s_cbranch_vccnz g_47F6_1
    v_smfmac_f32_16x16x64_bf16 v[64:67], v[28:31], a[200:207], v172
    v_smfmac_f32_16x16x64_bf16 v[68:71], v[28:31], a[232:239], v172
g_47L4_2:
    s_waitcnt vmcnt(0)
    v_max3_u32 v19, v32, v33, v34
    v_max_u32 v19, v19, v35
    v_cmp_eq_u32 vcc, -1, v19
    s_nop 0
    s_cbranch_vccnz g_47F4_2
    v_smfmac_f32_16x16x64_bf16 v[64:67], v[32:35], a[208:215], v172
    v_smfmac_f32_16x16x64_bf16 v[68:71], v[32:35], a[240:247], v172
    s_nop 4
    v_cvt_pk_bf16_f32 v80, v64, v65
    v_cvt_pk_bf16_f32 v81, v66, v67
    s_nop 0
    v_cvt_pk_bf16_f32 v82, v68, v69
    v_cvt_pk_bf16_f32 v83, v70, v71
    ds_write_b128 v17, v[80:83] offset:9216
    s_branch gc_48
g_47L7_1:
    s_waitcnt vmcnt(2)
    v_max3_u32 v19, v28, v29, v30
    v_max_u32 v19, v19, v31
    v_cmp_eq_u32 vcc, -1, v19
    s_nop 0
    s_cbranch_vccnz g_47F7_1
    v_smfmac_f32_16x16x64_bf16 v[64:67], v[28:31], a[200:207], v172
    v_smfmac_f32_16x16x64_bf16 v[68:71], v[28:31], a[232:239], v172
g_47L5_2:
    s_waitcnt vmcnt(1)
    v_max3_u32 v19, v32, v33, v34
    v_max_u32 v19, v19, v35
    v_cmp_eq_u32 vcc, -1, v19
    s_nop 0
    s_cbranch_vccnz g_47F5_2
    v_smfmac_f32_16x16x64_bf16 v[64:67], v[32:35], a[208:215], v172
    v_smfmac_f32_16x16x64_bf16 v[68:71], v[32:35], a[240:247], v172
    s_branch g_47L1_0
g_47L7_2:
    s_waitcnt vmcnt(2)
    v_max3_u32 v19, v32, v33, v34
    v_max_u32 v19, v19, v35
    v_cmp_eq_u32 vcc, -1, v19
    s_nop 0
    s_cbranch_vccnz g_47F7_2
    v_smfmac_f32_16x16x64_bf16 v[64:67], v[32:35], a[208:215], v172
    v_smfmac_f32_16x16x64_bf16 v[68:71], v[32:35], a[240:247], v172
    s_branch g_47L3_0
g_47L11_0:
    s_waitcnt vmcnt(2)
    v_max3_u32 v19, v24, v25, v26
    v_max_u32 v19, v19, v27
    v_cmp_eq_u32 vcc, -1, v19
    s_nop 0
    s_cbranch_vccnz g_47F11_0
    v_smfmac_f32_16x16x64_bf16 v[64:67], v[24:27], a[192:199], v172
    v_smfmac_f32_16x16x64_bf16 v[68:71], v[24:27], a[224:231], v172
g_47L10_1:
    s_waitcnt vmcnt(1)
    v_max3_u32 v19, v28, v29, v30
    v_max_u32 v19, v19, v31
    v_cmp_eq_u32 vcc, -1, v19
    s_nop 0
    s_cbranch_vccnz g_47F10_1
    v_smfmac_f32_16x16x64_bf16 v[64:67], v[28:31], a[200:207], v172
    v_smfmac_f32_16x16x64_bf16 v[68:71], v[28:31], a[232:239], v172
    s_branch g_47L8_3
g_47L11_1:
    s_waitcnt vmcnt(2)
    v_max3_u32 v19, v28, v29, v30
    v_max_u32 v19, v19, v31
    v_cmp_eq_u32 vcc, -1, v19
    s_nop 0
    s_cbranch_vccnz g_47F11_1
    v_smfmac_f32_16x16x64_bf16 v[64:67], v[28:31], a[200:207], v172
    v_smfmac_f32_16x16x64_bf16 v[68:71], v[28:31], a[232:239], v172
    s_branch g_47L9_3
g_47L13_0:
    s_waitcnt vmcnt(2)
    v_max3_u32 v19, v24, v25, v26
    v_max_u32 v19, v19, v27
    v_cmp_eq_u32 vcc, -1, v19
    s_nop 0
    s_cbranch_vccnz g_47F13_0
    v_smfmac_f32_16x16x64_bf16 v[64:67], v[24:27], a[192:199], v172
    v_smfmac_f32_16x16x64_bf16 v[68:71], v[24:27], a[224:231], v172
    s_branch g_47L12_2
g_47L13_3:
    s_waitcnt vmcnt(2)
    v_max3_u32 v19, v36, v37, v38
    v_max_u32 v19, v19, v39
    v_cmp_eq_u32 vcc, -1, v19
    s_nop 0
    s_cbranch_vccnz g_47F13_3
    v_smfmac_f32_16x16x64_bf16 v[64:67], v[36:39], a[216:223], v172
    v_smfmac_f32_16x16x64_bf16 v[68:71], v[36:39], a[248:255], v172
g_47L5_0:
    s_waitcnt vmcnt(1)
    v_max3_u32 v19, v24, v25, v26
    v_max_u32 v19, v19, v27
    v_cmp_eq_u32 vcc, -1, v19
    s_nop 0
    s_cbranch_vccnz g_47F5_0
    v_smfmac_f32_16x16x64_bf16 v[64:67], v[24:27], a[192:199], v172
    v_smfmac_f32_16x16x64_bf16 v[68:71], v[24:27], a[224:231], v172
    s_branch g_47L4_2
g_47L14_2:
    s_waitcnt vmcnt(2)
    v_max3_u32 v19, v32, v33, v34
    v_max_u32 v19, v19, v35
    v_cmp_eq_u32 vcc, -1, v19
    s_nop 0
    s_cbranch_vccnz g_47F14_2
    v_smfmac_f32_16x16x64_bf16 v[64:67], v[32:35], a[208:215], v172
    v_smfmac_f32_16x16x64_bf16 v[68:71], v[32:35], a[240:247], v172
g_47L10_3:
    s_waitcnt vmcnt(1)
    v_max3_u32 v19, v36, v37, v38
    v_max_u32 v19, v19, v39
    v_cmp_eq_u32 vcc, -1, v19
    s_nop 0
    s_cbranch_vccnz g_47F10_3
    v_smfmac_f32_16x16x64_bf16 v[64:67], v[36:39], a[216:223], v172
    v_smfmac_f32_16x16x64_bf16 v[68:71], v[36:39], a[248:255], v172
    s_branch g_47L2_1
g_47L14_3:
    s_waitcnt vmcnt(2)
    v_max3_u32 v19, v36, v37, v38
    v_max_u32 v19, v19, v39
    v_cmp_eq_u32 vcc, -1, v19
    s_nop 0
    s_cbranch_vccnz g_47F14_3
    v_smfmac_f32_16x16x64_bf16 v[64:67], v[36:39], a[216:223], v172
    v_smfmac_f32_16x16x64_bf16 v[68:71], v[36:39], a[248:255], v172
    s_branch g_47L6_1
g_47L3_1:
    s_waitcnt vmcnt(1)
    v_max3_u32 v19, v28, v29, v30
    v_max_u32 v19, v19, v31
    v_cmp_eq_u32 vcc, -1, v19
    s_nop 0
    s_cbranch_vccnz g_47F3_1
    v_smfmac_f32_16x16x64_bf16 v[64:67], v[28:31], a[200:207], v172
    v_smfmac_f32_16x16x64_bf16 v[68:71], v[28:31], a[232:239], v172
    s_branch g_47L1_0
g_47L6_2:
    s_waitcnt vmcnt(1)
    v_max3_u32 v19, v32, v33, v34
    v_max_u32 v19, v19, v35
    v_cmp_eq_u32 vcc, -1, v19
    s_nop 0
    s_cbranch_vccnz g_47F6_2
    v_smfmac_f32_16x16x64_bf16 v[64:67], v[32:35], a[208:215], v172
    v_smfmac_f32_16x16x64_bf16 v[68:71], v[32:35], a[240:247], v172
    s_branch g_47L2_1
g_47L9_0:
    s_waitcnt vmcnt(1)
    v_max3_u32 v19, v24, v25, v26
    v_max_u32 v19, v19, v27
    v_cmp_eq_u32 vcc, -1, v19
    s_nop 0
    s_cbranch_vccnz g_47F9_0
    v_smfmac_f32_16x16x64_bf16 v[64:67], v[24:27], a[192:199], v172
    v_smfmac_f32_16x16x64_bf16 v[68:71], v[24:27], a[224:231], v172
    s_branch g_47L8_3
g_47L12_3:
    s_waitcnt vmcnt(1)
    v_max3_u32 v19, v36, v37, v38
    v_max_u32 v19, v19, v39
    v_cmp_eq_u32 vcc, -1, v19
    s_nop 0
    s_cbranch_vccnz g_47F12_3
    v_smfmac_f32_16x16x64_bf16 v[64:67], v[36:39], a[216:223], v172
    v_smfmac_f32_16x16x64_bf16 v[68:71], v[36:39], a[248:255], v172
    s_branch g_47L4_2
g_47F15_0:
    s_mov_b64 exec, vcc
    buffer_load_dwordx4 v[24:27], v8, s[4:7], s16 offen offset:0 sc1
    s_mov_b64 exec, -1
    s_add_u32 s23, s23, 1
    s_cmp_lt_u32 s23, 200000
    s_cbranch_scc1 g_47L15_1
    s_mov_b32 s25, 200000
    s_branch gc_48
g_47F15_1:
    s_mov_b64 exec, vcc
    buffer_load_dwordx4 v[28:31], v8, s[4:7], s16 offen offset:1024 sc1
    s_mov_b64 exec, -1
    s_add_u32 s23, s23, 1
    s_cmp_lt_u32 s23, 200000
    s_cbranch_scc1 g_47L15_2
    s_mov_b32 s25, 200000
    s_branch gc_48
g_47F15_2:
    s_mov_b64 exec, vcc
    buffer_load_dwordx4 v[32:35], v8, s[4:7], s16 offen offset:2048 sc1
    s_mov_b64 exec, -1
    s_add_u32 s23, s23, 1
    s_cmp_lt_u32 s23, 200000
    s_cbranch_scc1 g_47L15_3
    s_mov_b32 s25, 200000
    s_branch gc_48
g_47F15_3:
    s_mov_b64 exec, vcc
    buffer_load_dwordx4 v[36:39], v8, s[4:7], s16 offen offset:3072 sc1
    s_mov_b64 exec, -1
    s_add_u32 s23, s23, 1
    s_cmp_lt_u32 s23, 200000
    s_cbranch_scc1 g_47L15_0
    s_mov_b32 s25, 200000
    s_branch gc_48
g_47F7_0:
    s_mov_b64 exec, vcc
    buffer_load_dwordx4 v[24:27], v8, s[4:7], s16 offen offset:0 sc1
    s_mov_b64 exec, -1
    s_add_u32 s23, s23, 1
    s_cmp_lt_u32 s23, 200000
    s_cbranch_scc1 g_47L7_1
    s_mov_b32 s25, 200000
    s_branch gc_48
g_47F7_1:
    s_mov_b64 exec, vcc
    buffer_load_dwordx4 v[28:31], v8, s[4:7], s16 offen offset:1024 sc1
    s_mov_b64 exec, -1
    s_add_u32 s23, s23, 1
    s_cmp_lt_u32 s23, 200000
    s_cbranch_scc1 g_47L7_2
    s_mov_b32 s25, 200000
    s_branch gc_48
g_47F7_2:
    s_mov_b64 exec, vcc
    buffer_load_dwordx4 v[32:35], v8, s[4:7], s16 offen offset:2048 sc1
    s_mov_b64 exec, -1
    s_add_u32 s23, s23, 1
    s_cmp_lt_u32 s23, 200000
    s_cbranch_scc1 g_47L7_0
    s_mov_b32 s25, 200000
    s_branch gc_48
g_47F11_0:
    s_mov_b64 exec, vcc
    buffer_load_dwordx4 v[24:27], v8, s[4:7], s16 offen offset:0 sc1
    s_mov_b64 exec, -1
    s_add_u32 s23, s23, 1
    s_cmp_lt_u32 s23, 200000
    s_cbranch_scc1 g_47L11_1
    s_mov_b32 s25, 200000
    s_branch gc_48
g_47F11_1:
    s_mov_b64 exec, vcc
    buffer_load_dwordx4 v[28:31], v8, s[4:7], s16 offen offset:1024 sc1
    s_mov_b64 exec, -1
    s_add_u32 s23, s23, 1
    s_cmp_lt_u32 s23, 200000
    s_cbranch_scc1 g_47L11_3
    s_mov_b32 s25, 200000
    s_branch gc_48
g_47F11_3:
    s_mov_b64 exec, vcc
    buffer_load_dwordx4 v[36:39], v8, s[4:7], s16 offen offset:3072 sc1
    s_mov_b64 exec, -1
    s_add_u32 s23, s23, 1
    s_cmp_lt_u32 s23, 200000
    s_cbranch_scc1 g_47L11_0
    s_mov_b32 s25, 200000
    s_branch gc_48
g_47F13_0:
    s_mov_b64 exec, vcc
    buffer_load_dwordx4 v[24:27], v8, s[4:7], s16 offen offset:0 sc1
    s_mov_b64 exec, -1
    s_add_u32 s23, s23, 1
    s_cmp_lt_u32 s23, 200000
    s_cbranch_scc1 g_47L13_2
    s_mov_b32 s25, 200000
    s_branch gc_48
g_47F13_2:
    s_mov_b64 exec, vcc
    buffer_load_dwordx4 v[32:35], v8, s[4:7], s16 offen offset:2048 sc1
    s_mov_b64 exec, -1
    s_add_u32 s23, s23, 1
    s_cmp_lt_u32 s23, 200000
    s_cbranch_scc1 g_47L13_3
    s_mov_b32 s25, 200000
    s_branch gc_48
g_47F13_3:
    s_mov_b64 exec, vcc
    buffer_load_dwordx4 v[36:39], v8, s[4:7], s16 offen offset:3072 sc1
    s_mov_b64 exec, -1
    s_add_u32 s23, s23, 1
    s_cmp_lt_u32 s23, 200000
    s_cbranch_scc1 g_47L13_0
    s_mov_b32 s25, 200000
    s_branch gc_48
g_47F14_1:
    s_mov_b64 exec, vcc
    buffer_load_dwordx4 v[28:31], v8, s[4:7], s16 offen offset:1024 sc1
    s_mov_b64 exec, -1
    s_add_u32 s23, s23, 1
    s_cmp_lt_u32 s23, 200000
    s_cbranch_scc1 g_47L14_2
    s_mov_b32 s25, 200000
    s_branch gc_48
g_47F14_2:
    s_mov_b64 exec, vcc
    buffer_load_dwordx4 v[32:35], v8, s[4:7], s16 offen offset:2048 sc1
    s_mov_b64 exec, -1
    s_add_u32 s23, s23, 1
    s_cmp_lt_u32 s23, 200000
    s_cbranch_scc1 g_47L14_3
    s_mov_b32 s25, 200000
    s_branch gc_48
g_47F14_3:
    s_mov_b64 exec, vcc
    buffer_load_dwordx4 v[36:39], v8, s[4:7], s16 offen offset:3072 sc1
    s_mov_b64 exec, -1
    s_add_u32 s23, s23, 1
    s_cmp_lt_u32 s23, 200000
    s_cbranch_scc1 g_47L14_1
    s_mov_b32 s25, 200000
    s_branch gc_48
g_47F3_0:
    s_mov_b64 exec, vcc
    buffer_load_dwordx4 v[24:27], v8, s[4:7], s16 offen offset:0 sc1
    s_mov_b64 exec, -1
    s_add_u32 s23, s23, 1
    s_cmp_lt_u32 s23, 200000
    s_cbranch_scc1 g_47L3_1
    s_mov_b32 s25, 200000
    s_branch gc_48
g_47F3_1:
    s_mov_b64 exec, vcc
    buffer_load_dwordx4 v[28:31], v8, s[4:7], s16 offen offset:1024 sc1
    s_mov_b64 exec, -1
    s_add_u32 s23, s23, 1
    s_cmp_lt_u32 s23, 200000
    s_cbranch_scc1 g_47L3_0
    s_mov_b32 s25, 200000
    s_branch gc_48
g_47F5_0:
    s_mov_b64 exec, vcc
    buffer_load_dwordx4 v[24:27], v8, s[4:7], s16 offen offset:0 sc1
    s_mov_b64 exec, -1
    s_add_u32 s23, s23, 1
    s_cmp_lt_u32 s23, 200000
    s_cbranch_scc1 g_47L5_2
    s_mov_b32 s25, 200000
    s_branch gc_48
g_47F5_2:
    s_mov_b64 exec, vcc
    buffer_load_dwordx4 v[32:35], v8, s[4:7], s16 offen offset:2048 sc1
    s_mov_b64 exec, -1
    s_add_u32 s23, s23, 1
    s_cmp_lt_u32 s23, 200000
    s_cbranch_scc1 g_47L5_0
    s_mov_b32 s25, 200000
    s_branch gc_48
g_47F6_1:
    s_mov_b64 exec, vcc
    buffer_load_dwordx4 v[28:31], v8, s[4:7], s16 offen offset:1024 sc1
    s_mov_b64 exec, -1
    s_add_u32 s23, s23, 1
    s_cmp_lt_u32 s23, 200000
    s_cbranch_scc1 g_47L6_2
    s_mov_b32 s25, 200000
    s_branch gc_48
g_47F6_2:
    s_mov_b64 exec, vcc
    buffer_load_dwordx4 v[32:35], v8, s[4:7], s16 offen offset:2048 sc1
    s_mov_b64 exec, -1
    s_add_u32 s23, s23, 1
    s_cmp_lt_u32 s23, 200000
    s_cbranch_scc1 g_47L6_1
    s_mov_b32 s25, 200000
    s_branch gc_48
g_47F9_0:
    s_mov_b64 exec, vcc
    buffer_load_dwordx4 v[24:27], v8, s[4:7], s16 offen offset:0 sc1
    s_mov_b64 exec, -1
    s_add_u32 s23, s23, 1
    s_cmp_lt_u32 s23, 200000
    s_cbranch_scc1 g_47L9_3
    s_mov_b32 s25, 200000
    s_branch gc_48
g_47F9_3:
    s_mov_b64 exec, vcc
    buffer_load_dwordx4 v[36:39], v8, s[4:7], s16 offen offset:3072 sc1
    s_mov_b64 exec, -1
    s_add_u32 s23, s23, 1
    s_cmp_lt_u32 s23, 200000
    s_cbranch_scc1 g_47L9_0
    s_mov_b32 s25, 200000
    s_branch gc_48
g_47F10_1:
    s_mov_b64 exec, vcc
    buffer_load_dwordx4 v[28:31], v8, s[4:7], s16 offen offset:1024 sc1
    s_mov_b64 exec, -1
    s_add_u32 s23, s23, 1
    s_cmp_lt_u32 s23, 200000
    s_cbranch_scc1 g_47L10_3
    s_mov_b32 s25, 200000
    s_branch gc_48
g_47F10_3:
    s_mov_b64 exec, vcc
    buffer_load_dwordx4 v[36:39], v8, s[4:7], s16 offen offset:3072 sc1
    s_mov_b64 exec, -1
    s_add_u32 s23, s23, 1
    s_cmp_lt_u32 s23, 200000
    s_cbranch_scc1 g_47L10_1
    s_mov_b32 s25, 200000
    s_branch gc_48
g_47F12_2:
    s_mov_b64 exec, vcc
    buffer_load_dwordx4 v[32:35], v8, s[4:7], s16 offen offset:2048 sc1
    s_mov_b64 exec, -1
    s_add_u32 s23, s23, 1
    s_cmp_lt_u32 s23, 200000
    s_cbranch_scc1 g_47L12_3
    s_mov_b32 s25, 200000
    s_branch gc_48
g_47F12_3:
    s_mov_b64 exec, vcc
    buffer_load_dwordx4 v[36:39], v8, s[4:7], s16 offen offset:3072 sc1
    s_mov_b64 exec, -1
    s_add_u32 s23, s23, 1
    s_cmp_lt_u32 s23, 200000
    s_cbranch_scc1 g_47L12_2
    s_mov_b32 s25, 200000
    s_branch gc_48
g_47F1_0:
    s_mov_b64 exec, vcc
    buffer_load_dwordx4 v[24:27], v8, s[4:7], s16 offen offset:0 sc1
    s_mov_b64 exec, -1
    s_add_u32 s23, s23, 1
    s_cmp_lt_u32 s23, 200000
    s_cbranch_scc1 g_47L1_0
    s_mov_b32 s25, 200000
    s_branch gc_48
g_47F2_1:
    s_mov_b64 exec, vcc
    buffer_load_dwordx4 v[28:31], v8, s[4:7], s16 offen offset:1024 sc1
    s_mov_b64 exec, -1
    s_add_u32 s23, s23, 1
    s_cmp_lt_u32 s23, 200000
    s_cbranch_scc1 g_47L2_1
    s_mov_b32 s25, 200000
    s_branch gc_48
g_47F4_2:
    s_mov_b64 exec, vcc
    buffer_load_dwordx4 v[32:35], v8, s[4:7], s16 offen offset:2048 sc1
    s_mov_b64 exec, -1
    s_add_u32 s23, s23, 1
    s_cmp_lt_u32 s23, 200000
    s_cbranch_scc1 g_47L4_2
    s_mov_b32 s25, 200000
    s_branch gc_48
g_47F8_3:
    s_mov_b64 exec, vcc
    buffer_load_dwordx4 v[36:39], v8, s[4:7], s16 offen offset:3072 sc1
    s_mov_b64 exec, -1
    s_add_u32 s23, s23, 1
    s_cmp_lt_u32 s23, 200000
    s_cbranch_scc1 g_47L8_3
    s_mov_b32 s25, 200000
    s_branch gc_48
.p2align 6
recur_fast_w3:
    s_nop 15
    s_mov_b32 s23, s25
    buffer_load_dwordx4 v[24:27], v2, s[4:7], s16 offen offset:0 sc1
    s_nop 11
    buffer_load_dwordx4 v[28:31], v2, s[4:7], s16 offen offset:1024 sc1
    s_nop 11
    buffer_load_dwordx4 v[32:35], v2, s[4:7], s16 offen offset:2048 sc1
    s_nop 11
    buffer_load_dwordx4 v[36:39], v2, s[4:7], s16 offen offset:3072 sc1
    s_waitcnt vmcnt(3)
    v_max3_u32 v19, v24, v25, v26
    v_max_u32 v19, v19, v27
    v_cmp_eq_u32 vcc, -1, v19
    s_nop 0
    s_cbranch_vccnz g_49F15_0
    v_smfmac_f32_16x16x64_bf16 v[40:43], v[24:27], a[0:7], v172
    s_waitcnt vmcnt(2)
    v_max3_u32 v19, v28, v29, v30
    v_max_u32 v19, v19, v31
    v_smfmac_f32_16x16x64_bf16 v[44:47], v[24:27], a[64:71], v172
    v_cmp_eq_u32 vcc, -1, v19
    v_smfmac_f32_16x16x64_bf16 v[48:51], v[24:27], a[32:39], v172
    v_smfmac_f32_16x16x64_bf16 v[52:55], v[24:27], a[96:103], v172
    s_cbranch_vccnz g_49F14_1
    v_smfmac_f32_16x16x64_bf16 v[40:43], v[28:31], a[8:15], v172
    s_waitcnt vmcnt(1)
    v_max3_u32 v19, v32, v33, v34
    v_max_u32 v19, v19, v35
    v_smfmac_f32_16x16x64_bf16 v[44:47], v[28:31], a[72:79], v172
    v_cmp_eq_u32 vcc, -1, v19
    v_smfmac_f32_16x16x64_bf16 v[48:51], v[28:31], a[40:47], v172
    v_smfmac_f32_16x16x64_bf16 v[52:55], v[28:31], a[104:111], v172
    s_cbranch_vccnz g_49F12_2
    v_smfmac_f32_16x16x64_bf16 v[40:43], v[32:35], a[16:23], v172
    s_waitcnt vmcnt(0)
    v_max3_u32 v19, v36, v37, v38
    v_max_u32 v19, v19, v39
    v_smfmac_f32_16x16x64_bf16 v[44:47], v[32:35], a[80:87], v172
    v_cmp_eq_u32 vcc, -1, v19
    v_smfmac_f32_16x16x64_bf16 v[48:51], v[32:35], a[48:55], v172
    v_smfmac_f32_16x16x64_bf16 v[52:55], v[32:35], a[112:119], v172
    s_cbranch_vccnz g_49F8_3
    v_smfmac_f32_16x16x64_bf16 v[40:43], v[36:39], a[24:31], v172
    v_smfmac_f32_16x16x64_bf16 v[44:47], v[36:39], a[88:95], v172
    v_smfmac_f32_16x16x64_bf16 v[48:51], v[36:39], a[56:63], v172
    v_smfmac_f32_16x16x64_bf16 v[52:55], v[36:39], a[120:127], v172
gc_50:
    v_cvt_pk_bf16_f32 v72, v40, v41
    v_cvt_pk_bf16_f32 v73, v42, v43
    v_cvt_pk_bf16_f32 v74, v44, v45
    v_cvt_pk_bf16_f32 v75, v46, v47
    ds_write_b128 v17, v[72:75] offset:0
    v_cvt_pk_bf16_f32 v76, v48, v49
    v_cvt_pk_bf16_f32 v77, v50, v51
    s_nop 0
    v_cvt_pk_bf16_f32 v78, v52, v53
    v_cvt_pk_bf16_f32 v79, v54, v55
    ds_write_b128 v17, v[76:79] offset:1024
    v_smfmac_f32_16x16x64_bf16 v[56:59], v[24:27], a[128:135], v172
    v_smfmac_f32_16x16x64_bf16 v[60:63], v[24:27], a[160:167], v172
    v_smfmac_f32_16x16x64_bf16 v[56:59], v[28:31], a[136:143], v172
    s_waitcnt lgkmcnt(0)
    s_barrier
    v_smfmac_f32_16x16x64_bf16 v[60:63], v[28:31], a[168:175], v172
    v_smfmac_f32_16x16x64_bf16 v[56:59], v[32:35], a[144:151], v172
    v_smfmac_f32_16x16x64_bf16 v[60:63], v[32:35], a[176:183], v172
    v_smfmac_f32_16x16x64_bf16 v[56:59], v[36:39], a[152:159], v172
    v_smfmac_f32_16x16x64_bf16 v[60:63], v[36:39], a[184:191], v172
    s_nop 4
    v_cvt_pk_bf16_f32 v80, v56, v57
    v_cvt_pk_bf16_f32 v81, v58, v59
    s_nop 0
    v_cvt_pk_bf16_f32 v82, v60, v61
    v_cvt_pk_bf16_f32 v83, v62, v63
    ds_write_b128 v17, v[80:83] offset:8192
    buffer_store_dwordx4 v[204:207], v3, s[4:7], s43 offen
    buffer_store_dwordx4 v[204:207], v3, s[4:7], s43 offen offset:128
    buffer_store_dwordx4 v[204:207], v4, s[4:7], s43 offen
    buffer_store_dwordx2 v[204:205], v7, s[4:7], s43 offen
    buffer_store_dwordx2 v[204:205], v11, s[4:7], s43 offen
    s_cmp_eq_u32 s15, 63
    s_waitcnt lgkmcnt(0)
    s_barrier
    s_cbranch_scc1 recur_end
    s_barrier
    s_nop 15
    s_mov_b32 s23, s25
    buffer_load_dwordx4 v[24:27], v8, s[4:7], s16 offen offset:0 sc1
    s_nop 11
    buffer_load_dwordx4 v[28:31], v8, s[4:7], s16 offen offset:1024 sc1
    s_nop 11
    buffer_load_dwordx4 v[32:35], v8, s[4:7], s16 offen offset:2048 sc1
    s_nop 11
    buffer_load_dwordx4 v[36:39], v8, s[4:7], s16 offen offset:3072 sc1
    s_waitcnt vmcnt(3)
    v_max3_u32 v19, v24, v25, v26
    v_max_u32 v19, v19, v27
    v_cmp_eq_u32 vcc, -1, v19
    s_nop 0
    s_cbranch_vccnz g_51F15_0
    v_smfmac_f32_16x16x64_bf16 v[64:67], v[24:27], a[192:199], v172
    v_smfmac_f32_16x16x64_bf16 v[68:71], v[24:27], a[224:231], v172
    s_waitcnt vmcnt(2)
    v_max3_u32 v19, v28, v29, v30
    v_max_u32 v19, v19, v31
    v_cmp_eq_u32 vcc, -1, v19
    s_nop 0
    s_cbranch_vccnz g_51F14_1
    v_smfmac_f32_16x16x64_bf16 v[64:67], v[28:31], a[200:207], v172
    v_smfmac_f32_16x16x64_bf16 v[68:71], v[28:31], a[232:239], v172
    s_waitcnt vmcnt(1)
    v_max3_u32 v19, v32, v33, v34
    v_max_u32 v19, v19, v35
    v_cmp_eq_u32 vcc, -1, v19
    s_nop 0
    s_cbranch_vccnz g_51F12_2
    v_smfmac_f32_16x16x64_bf16 v[64:67], v[32:35], a[208:215], v172
    v_smfmac_f32_16x16x64_bf16 v[68:71], v[32:35], a[240:247], v172
    s_waitcnt vmcnt(0)
    v_max3_u32 v19, v36, v37, v38
    v_max_u32 v19, v19, v39
    v_cmp_eq_u32 vcc, -1, v19
    s_nop 0
    s_cbranch_vccnz g_51F8_3
    v_smfmac_f32_16x16x64_bf16 v[64:67], v[36:39], a[216:223], v172
    v_smfmac_f32_16x16x64_bf16 v[68:71], v[36:39], a[248:255], v172
    s_nop 4
    v_cvt_pk_bf16_f32 v80, v64, v65
    v_cvt_pk_bf16_f32 v81, v66, v67
    s_nop 0
    v_cvt_pk_bf16_f32 v82, v68, v69
    v_cvt_pk_bf16_f32 v83, v70, v71
    s_nop 1
    v_mfma_f32_16x16x32_bf16 v[88:91], v[80:83], v[84:87], 0
gc_52:
    s_barrier
    ds_read_b128 v[96:99], v16 offset:9216
    ds_read_b128 v[100:103], v16 offset:11264
    ds_read_b128 v[104:107], v16 offset:13312
    s_waitcnt lgkmcnt(2)
    v_mfma_f32_16x16x32_bf16 v[88:91], v[96:99], v[84:87], v[88:91]
    s_waitcnt lgkmcnt(1)
    v_mfma_f32_16x16x32_bf16 v[88:91], v[100:103], v[84:87], v[88:91]
    s_waitcnt lgkmcnt(0)
    v_mfma_f32_16x16x32_bf16 v[88:91], v[104:107], v[84:87], v[88:91]
    s_nop 7
    buffer_store_dwordx4 v[88:91], v9, s[4:7], s84 offen sc1
    s_add_u32 s22, s84, 262144
    buffer_store_dwordx4 v[88:91], v9, s[4:7], s22 offen sc1
    s_nop 15
    s_nop 15
    s_nop 15
    s_nop 15
    s_nop 15
    s_nop 15
    s_nop 15
    s_nop 7
    s_mov_b32 s23, s25
    buffer_load_dwordx4 v[96:99], v10, s[4:7], s84 offen sc1
    buffer_load_dwordx4 v[100:103], v23, s[4:7], s84 offen sc1
    buffer_load_dwordx4 v[104:107], v244, s[4:7], s84 offen sc1
    s_nop 15
    s_nop 15
    s_nop 7
    buffer_load_dwordx4 v[108:111], v10, s[4:7], s22 offen sc1
    buffer_load_dwordx4 v[112:115], v23, s[4:7], s22 offen sc1
    buffer_load_dwordx4 v[116:119], v244, s[4:7], s22 offen sc1
    v_mov_b32 v40, 0
    v_mov_b32 v41, 0
    v_mov_b32 v42, 0
    v_mov_b32 v43, 0
    v_mov_b32 v44, 0
    v_mov_b32 v45, 0
    v_mov_b32 v46, 0
    v_mov_b32 v47, 0
    v_mov_b32 v48, 0
    v_mov_b32 v49, 0
    v_mov_b32 v50, 0
    v_mov_b32 v51, 0
    v_mov_b32 v52, 0
    v_mov_b32 v53, 0
    v_mov_b32 v54, 0
    v_mov_b32 v55, 0
    v_mov_b32 v56, 0
    v_mov_b32 v57, 0
    v_mov_b32 v58, 0
    v_mov_b32 v59, 0
    v_mov_b32 v60, 0
    v_mov_b32 v61, 0
    v_mov_b32 v62, 0
    v_mov_b32 v63, 0
    v_mov_b32 v64, 0
    v_mov_b32 v65, 0
    v_mov_b32 v66, 0
    v_mov_b32 v67, 0
    v_mov_b32 v68, 0
    v_mov_b32 v69, 0
    v_mov_b32 v70, 0
    v_mov_b32 v71, 0
    s_waitcnt vmcnt(5)
    v_pk_add_f32 v[120:121], v[88:89], v[96:97]
    v_pk_add_f32 v[122:123], v[90:91], v[98:99]
    s_waitcnt vmcnt(4)
    v_pk_add_f32 v[120:121], v[120:121], v[100:101]
    v_pk_add_f32 v[122:123], v[122:123], v[102:103]
    s_waitcnt vmcnt(3)
    v_pk_add_f32 v[120:121], v[120:121], v[104:105]
    v_pk_add_f32 v[122:123], v[122:123], v[106:107]
    v_cvt_pk_bf16_f32 v180, v120, v121
    v_pk_add_f32 v[124:125], v[120:121], v[122:123]
    v_cvt_pk_bf16_f32 v181, v122, v123
    v_cmpx_o_f32 vcc, v124, v125
    buffer_store_dwordx2 v[180:181], v11, s[4:7], s42 offen
    s_cmp_eq_u64 vcc, -1
    s_mov_b64 exec, -1
    s_cbranch_scc0 pr_53
pg_54:
    s_barrier
    s_mov_b32 s21, s16
    s_mov_b32 s16, s42
    s_mov_b32 s42, s43
    s_mov_b32 s43, s44
    s_mov_b32 s44, s21
    s_add_u32 s95, s95, 524288
    s_lshr_b32 s84, s95, 8
    s_and_b32 s84, s84, 8192
    s_xor_b32 s84, s84, s46
    s_add_u32 s84, s84, s95
    s_add_u32 s15, s15, 1
    s_branch recur_fast_w3
g_49L15_0:
    s_waitcnt vmcnt(3)
    v_max3_u32 v19, v24, v25, v26
    v_max_u32 v19, v19, v27
    v_cmp_eq_u32 vcc, -1, v19
    s_nop 0
    s_cbranch_vccnz g_49F15_0
    v_smfmac_f32_16x16x64_bf16 v[40:43], v[24:27], a[0:7], v172
    v_smfmac_f32_16x16x64_bf16 v[44:47], v[24:27], a[64:71], v172
    v_smfmac_f32_16x16x64_bf16 v[48:51], v[24:27], a[32:39], v172
    v_smfmac_f32_16x16x64_bf16 v[52:55], v[24:27], a[96:103], v172
g_49L14_1:
    s_waitcnt vmcnt(2)
    v_max3_u32 v19, v28, v29, v30
    v_max_u32 v19, v19, v31
    v_cmp_eq_u32 vcc, -1, v19
    s_nop 0
    s_cbranch_vccnz g_49F14_1
    v_smfmac_f32_16x16x64_bf16 v[40:43], v[28:31], a[8:15], v172
    v_smfmac_f32_16x16x64_bf16 v[44:47], v[28:31], a[72:79], v172
    v_smfmac_f32_16x16x64_bf16 v[48:51], v[28:31], a[40:47], v172
    v_smfmac_f32_16x16x64_bf16 v[52:55], v[28:31], a[104:111], v172
g_49L12_2:
    s_waitcnt vmcnt(1)
    v_max3_u32 v19, v32, v33, v34
    v_max_u32 v19, v19, v35
    v_cmp_eq_u32 vcc, -1, v19
    s_nop 0
    s_cbranch_vccnz g_49F12_2
    v_smfmac_f32_16x16x64_bf16 v[40:43], v[32:35], a[16:23], v172
    v_smfmac_f32_16x16x64_bf16 v[44:47], v[32:35], a[80:87], v172
    v_smfmac_f32_16x16x64_bf16 v[48:51], v[32:35], a[48:55], v172
    v_smfmac_f32_16x16x64_bf16 v[52:55], v[32:35], a[112:119], v172
g_49L8_3:
    s_waitcnt vmcnt(0)
    v_max3_u32 v19, v36, v37, v38
    v_max_u32 v19, v19, v39
    v_cmp_eq_u32 vcc, -1, v19
    s_nop 0
    s_cbranch_vccnz g_49F8_3
    v_smfmac_f32_16x16x64_bf16 v[40:43], v[36:39], a[24:31], v172
    v_smfmac_f32_16x16x64_bf16 v[44:47], v[36:39], a[88:95], v172
    v_smfmac_f32_16x16x64_bf16 v[48:51], v[36:39], a[56:63], v172
    v_smfmac_f32_16x16x64_bf16 v[52:55], v[36:39], a[120:127], v172
    s_branch gc_50
g_49L15_1:
    s_waitcnt vmcnt(3)
    v_max3_u32 v19, v28, v29, v30
    v_max_u32 v19, v19, v31
    v_cmp_eq_u32 vcc, -1, v19
    s_nop 0
    s_cbranch_vccnz g_49F15_1
    v_smfmac_f32_16x16x64_bf16 v[40:43], v[28:31], a[8:15], v172
    v_smfmac_f32_16x16x64_bf16 v[44:47], v[28:31], a[72:79], v172
    v_smfmac_f32_16x16x64_bf16 v[48:51], v[28:31], a[40:47], v172
    v_smfmac_f32_16x16x64_bf16 v[52:55], v[28:31], a[104:111], v172
g_49L13_2:
    s_waitcnt vmcnt(2)
    v_max3_u32 v19, v32, v33, v34
    v_max_u32 v19, v19, v35
    v_cmp_eq_u32 vcc, -1, v19
    s_nop 0
    s_cbranch_vccnz g_49F13_2
    v_smfmac_f32_16x16x64_bf16 v[40:43], v[32:35], a[16:23], v172
    v_smfmac_f32_16x16x64_bf16 v[44:47], v[32:35], a[80:87], v172
    v_smfmac_f32_16x16x64_bf16 v[48:51], v[32:35], a[48:55], v172
    v_smfmac_f32_16x16x64_bf16 v[52:55], v[32:35], a[112:119], v172
g_49L9_3:
    s_waitcnt vmcnt(1)
    v_max3_u32 v19, v36, v37, v38
    v_max_u32 v19, v19, v39
    v_cmp_eq_u32 vcc, -1, v19
    s_nop 0
    s_cbranch_vccnz g_49F9_3
    v_smfmac_f32_16x16x64_bf16 v[40:43], v[36:39], a[24:31], v172
    v_smfmac_f32_16x16x64_bf16 v[44:47], v[36:39], a[88:95], v172
    v_smfmac_f32_16x16x64_bf16 v[48:51], v[36:39], a[56:63], v172
    v_smfmac_f32_16x16x64_bf16 v[52:55], v[36:39], a[120:127], v172
g_49L1_0:
    s_waitcnt vmcnt(0)
    v_max3_u32 v19, v24, v25, v26
    v_max_u32 v19, v19, v27
    v_cmp_eq_u32 vcc, -1, v19
    s_nop 0
    s_cbranch_vccnz g_49F1_0
    v_smfmac_f32_16x16x64_bf16 v[40:43], v[24:27], a[0:7], v172
    v_smfmac_f32_16x16x64_bf16 v[44:47], v[24:27], a[64:71], v172
    v_smfmac_f32_16x16x64_bf16 v[48:51], v[24:27], a[32:39], v172
    v_smfmac_f32_16x16x64_bf16 v[52:55], v[24:27], a[96:103], v172
    s_branch gc_50
g_49L15_2:
    s_waitcnt vmcnt(3)
    v_max3_u32 v19, v32, v33, v34
    v_max_u32 v19, v19, v35
    v_cmp_eq_u32 vcc, -1, v19
    s_nop 0
    s_cbranch_vccnz g_49F15_2
    v_smfmac_f32_16x16x64_bf16 v[40:43], v[32:35], a[16:23], v172
    v_smfmac_f32_16x16x64_bf16 v[44:47], v[32:35], a[80:87], v172
    v_smfmac_f32_16x16x64_bf16 v[48:51], v[32:35], a[48:55], v172
    v_smfmac_f32_16x16x64_bf16 v[52:55], v[32:35], a[112:119], v172
g_49L11_3:
    s_waitcnt vmcnt(2)
    v_max3_u32 v19, v36, v37, v38
    v_max_u32 v19, v19, v39
    v_cmp_eq_u32 vcc, -1, v19
    s_nop 0
    s_cbranch_vccnz g_49F11_3
    v_smfmac_f32_16x16x64_bf16 v[40:43], v[36:39], a[24:31], v172
    v_smfmac_f32_16x16x64_bf16 v[44:47], v[36:39], a[88:95], v172
    v_smfmac_f32_16x16x64_bf16 v[48:51], v[36:39], a[56:63], v172
    v_smfmac_f32_16x16x64_bf16 v[52:55], v[36:39], a[120:127], v172
g_49L3_0:
    s_waitcnt vmcnt(1)
    v_max3_u32 v19, v24, v25, v26
    v_max_u32 v19, v19, v27
    v_cmp_eq_u32 vcc, -1, v19
    s_nop 0
    s_cbranch_vccnz g_49F3_0
    v_smfmac_f32_16x16x64_bf16 v[40:43], v[24:27], a[0:7], v172
    v_smfmac_f32_16x16x64_bf16 v[44:47], v[24:27], a[64:71], v172
    v_smfmac_f32_16x16x64_bf16 v[48:51], v[24:27], a[32:39], v172
    v_smfmac_f32_16x16x64_bf16 v[52:55], v[24:27], a[96:103], v172
g_49L2_1:
    s_waitcnt vmcnt(0)
    v_max3_u32 v19, v28, v29, v30
    v_max_u32 v19, v19, v31
    v_cmp_eq_u32 vcc, -1, v19
    s_nop 0
    s_cbranch_vccnz g_49F2_1
    v_smfmac_f32_16x16x64_bf16 v[40:43], v[28:31], a[8:15], v172
    v_smfmac_f32_16x16x64_bf16 v[44:47], v[28:31], a[72:79], v172
    v_smfmac_f32_16x16x64_bf16 v[48:51], v[28:31], a[40:47], v172
    v_smfmac_f32_16x16x64_bf16 v[52:55], v[28:31], a[104:111], v172
    s_branch gc_50
g_49L15_3:
    s_waitcnt vmcnt(3)
    v_max3_u32 v19, v36, v37, v38
    v_max_u32 v19, v19, v39
    v_cmp_eq_u32 vcc, -1, v19
    s_nop 0
    s_cbranch_vccnz g_49F15_3
    v_smfmac_f32_16x16x64_bf16 v[40:43], v[36:39], a[24:31], v172
    v_smfmac_f32_16x16x64_bf16 v[44:47], v[36:39], a[88:95], v172
    v_smfmac_f32_16x16x64_bf16 v[48:51], v[36:39], a[56:63], v172
    v_smfmac_f32_16x16x64_bf16 v[52:55], v[36:39], a[120:127], v172
g_49L7_0:
    s_waitcnt vmcnt(2)
    v_max3_u32 v19, v24, v25, v26
    v_max_u32 v19, v19, v27
    v_cmp_eq_u32 vcc, -1, v19
    s_nop 0
    s_cbranch_vccnz g_49F7_0
    v_smfmac_f32_16x16x64_bf16 v[40:43], v[24:27], a[0:7], v172
    v_smfmac_f32_16x16x64_bf16 v[44:47], v[24:27], a[64:71], v172
    v_smfmac_f32_16x16x64_bf16 v[48:51], v[24:27], a[32:39], v172
    v_smfmac_f32_16x16x64_bf16 v[52:55], v[24:27], a[96:103], v172
g_49L6_1:
    s_waitcnt vmcnt(1)
    v_max3_u32 v19, v28, v29, v30
    v_max_u32 v19, v19, v31
    v_cmp_eq_u32 vcc, -1, v19
    s_nop 0
    s_cbranch_vccnz g_49F6_1
    v_smfmac_f32_16x16x64_bf16 v[40:43], v[28:31], a[8:15], v172
    v_smfmac_f32_16x16x64_bf16 v[44:47], v[28:31], a[72:79], v172
    v_smfmac_f32_16x16x64_bf16 v[48:51], v[28:31], a[40:47], v172
    v_smfmac_f32_16x16x64_bf16 v[52:55], v[28:31], a[104:111], v172
g_49L4_2:
    s_waitcnt vmcnt(0)
    v_max3_u32 v19, v32, v33, v34
    v_max_u32 v19, v19, v35
    v_cmp_eq_u32 vcc, -1, v19
    s_nop 0
    s_cbranch_vccnz g_49F4_2
    v_smfmac_f32_16x16x64_bf16 v[40:43], v[32:35], a[16:23], v172
    v_smfmac_f32_16x16x64_bf16 v[44:47], v[32:35], a[80:87], v172
    v_smfmac_f32_16x16x64_bf16 v[48:51], v[32:35], a[48:55], v172
    v_smfmac_f32_16x16x64_bf16 v[52:55], v[32:35], a[112:119], v172
    s_branch gc_50
g_49L7_1:
    s_waitcnt vmcnt(2)
    v_max3_u32 v19, v28, v29, v30
    v_max_u32 v19, v19, v31
    v_cmp_eq_u32 vcc, -1, v19
    s_nop 0
    s_cbranch_vccnz g_49F7_1
    v_smfmac_f32_16x16x64_bf16 v[40:43], v[28:31], a[8:15], v172
    v_smfmac_f32_16x16x64_bf16 v[44:47], v[28:31], a[72:79], v172
    v_smfmac_f32_16x16x64_bf16 v[48:51], v[28:31], a[40:47], v172
    v_smfmac_f32_16x16x64_bf16 v[52:55], v[28:31], a[104:111], v172
g_49L5_2:
    s_waitcnt vmcnt(1)
    v_max3_u32 v19, v32, v33, v34
    v_max_u32 v19, v19, v35
    v_cmp_eq_u32 vcc, -1, v19
    s_nop 0
    s_cbranch_vccnz g_49F5_2
    v_smfmac_f32_16x16x64_bf16 v[40:43], v[32:35], a[16:23], v172
    v_smfmac_f32_16x16x64_bf16 v[44:47], v[32:35], a[80:87], v172
    v_smfmac_f32_16x16x64_bf16 v[48:51], v[32:35], a[48:55], v172
    v_smfmac_f32_16x16x64_bf16 v[52:55], v[32:35], a[112:119], v172
    s_branch g_49L1_0
g_49L7_2:
    s_waitcnt vmcnt(2)
    v_max3_u32 v19, v32, v33, v34
    v_max_u32 v19, v19, v35
    v_cmp_eq_u32 vcc, -1, v19
    s_nop 0
    s_cbranch_vccnz g_49F7_2
    v_smfmac_f32_16x16x64_bf16 v[40:43], v[32:35], a[16:23], v172
    v_smfmac_f32_16x16x64_bf16 v[44:47], v[32:35], a[80:87], v172
    v_smfmac_f32_16x16x64_bf16 v[48:51], v[32:35], a[48:55], v172
    v_smfmac_f32_16x16x64_bf16 v[52:55], v[32:35], a[112:119], v172
    s_branch g_49L3_0
g_49L11_0:
    s_waitcnt vmcnt(2)
    v_max3_u32 v19, v24, v25, v26
    v_max_u32 v19, v19, v27
    v_cmp_eq_u32 vcc, -1, v19
    s_nop 0
    s_cbranch_vccnz g_49F11_0
    v_smfmac_f32_16x16x64_bf16 v[40:43], v[24:27], a[0:7], v172
    v_smfmac_f32_16x16x64_bf16 v[44:47], v[24:27], a[64:71], v172
    v_smfmac_f32_16x16x64_bf16 v[48:51], v[24:27], a[32:39], v172
    v_smfmac_f32_16x16x64_bf16 v[52:55], v[24:27], a[96:103], v172
g_49L10_1:
    s_waitcnt vmcnt(1)
    v_max3_u32 v19, v28, v29, v30
    v_max_u32 v19, v19, v31
    v_cmp_eq_u32 vcc, -1, v19
    s_nop 0
    s_cbranch_vccnz g_49F10_1
    v_smfmac_f32_16x16x64_bf16 v[40:43], v[28:31], a[8:15], v172
    v_smfmac_f32_16x16x64_bf16 v[44:47], v[28:31], a[72:79], v172
    v_smfmac_f32_16x16x64_bf16 v[48:51], v[28:31], a[40:47], v172
    v_smfmac_f32_16x16x64_bf16 v[52:55], v[28:31], a[104:111], v172
    s_branch g_49L8_3
g_49L11_1:
    s_waitcnt vmcnt(2)
    v_max3_u32 v19, v28, v29, v30
    v_max_u32 v19, v19, v31
    v_cmp_eq_u32 vcc, -1, v19
    s_nop 0
    s_cbranch_vccnz g_49F11_1
    v_smfmac_f32_16x16x64_bf16 v[40:43], v[28:31], a[8:15], v172
    v_smfmac_f32_16x16x64_bf16 v[44:47], v[28:31], a[72:79], v172
    v_smfmac_f32_16x16x64_bf16 v[48:51], v[28:31], a[40:47], v172
    v_smfmac_f32_16x16x64_bf16 v[52:55], v[28:31], a[104:111], v172
    s_branch g_49L9_3
g_49L13_0:
    s_waitcnt vmcnt(2)
    v_max3_u32 v19, v24, v25, v26
    v_max_u32 v19, v19, v27
    v_cmp_eq_u32 vcc, -1, v19
    s_nop 0
    s_cbranch_vccnz g_49F13_0
    v_smfmac_f32_16x16x64_bf16 v[40:43], v[24:27], a[0:7], v172
    v_smfmac_f32_16x16x64_bf16 v[44:47], v[24:27], a[64:71], v172
    v_smfmac_f32_16x16x64_bf16 v[48:51], v[24:27], a[32:39], v172
    v_smfmac_f32_16x16x64_bf16 v[52:55], v[24:27], a[96:103], v172
    s_branch g_49L12_2
g_49L13_3:
    s_waitcnt vmcnt(2)
    v_max3_u32 v19, v36, v37, v38
    v_max_u32 v19, v19, v39
    v_cmp_eq_u32 vcc, -1, v19
    s_nop 0
    s_cbranch_vccnz g_49F13_3
    v_smfmac_f32_16x16x64_bf16 v[40:43], v[36:39], a[24:31], v172
    v_smfmac_f32_16x16x64_bf16 v[44:47], v[36:39], a[88:95], v172
    v_smfmac_f32_16x16x64_bf16 v[48:51], v[36:39], a[56:63], v172
    v_smfmac_f32_16x16x64_bf16 v[52:55], v[36:39], a[120:127], v172
g_49L5_0:
    s_waitcnt vmcnt(1)
    v_max3_u32 v19, v24, v25, v26
    v_max_u32 v19, v19, v27
    v_cmp_eq_u32 vcc, -1, v19
    s_nop 0
    s_cbranch_vccnz g_49F5_0
    v_smfmac_f32_16x16x64_bf16 v[40:43], v[24:27], a[0:7], v172
    v_smfmac_f32_16x16x64_bf16 v[44:47], v[24:27], a[64:71], v172
    v_smfmac_f32_16x16x64_bf16 v[48:51], v[24:27], a[32:39], v172
    v_smfmac_f32_16x16x64_bf16 v[52:55], v[24:27], a[96:103], v172
    s_branch g_49L4_2
g_49L14_2:
    s_waitcnt vmcnt(2)
    v_max3_u32 v19, v32, v33, v34
    v_max_u32 v19, v19, v35
    v_cmp_eq_u32 vcc, -1, v19
    s_nop 0
    s_cbranch_vccnz g_49F14_2
    v_smfmac_f32_16x16x64_bf16 v[40:43], v[32:35], a[16:23], v172
    v_smfmac_f32_16x16x64_bf16 v[44:47], v[32:35], a[80:87], v172
    v_smfmac_f32_16x16x64_bf16 v[48:51], v[32:35], a[48:55], v172
    v_smfmac_f32_16x16x64_bf16 v[52:55], v[32:35], a[112:119], v172
g_49L10_3:
    s_waitcnt vmcnt(1)
    v_max3_u32 v19, v36, v37, v38
    v_max_u32 v19, v19, v39
    v_cmp_eq_u32 vcc, -1, v19
    s_nop 0
    s_cbranch_vccnz g_49F10_3
    v_smfmac_f32_16x16x64_bf16 v[40:43], v[36:39], a[24:31], v172
    v_smfmac_f32_16x16x64_bf16 v[44:47], v[36:39], a[88:95], v172
    v_smfmac_f32_16x16x64_bf16 v[48:51], v[36:39], a[56:63], v172
    v_smfmac_f32_16x16x64_bf16 v[52:55], v[36:39], a[120:127], v172
    s_branch g_49L2_1
g_49L14_3:
    s_waitcnt vmcnt(2)
    v_max3_u32 v19, v36, v37, v38
    v_max_u32 v19, v19, v39
    v_cmp_eq_u32 vcc, -1, v19
    s_nop 0
    s_cbranch_vccnz g_49F14_3
    v_smfmac_f32_16x16x64_bf16 v[40:43], v[36:39], a[24:31], v172
    v_smfmac_f32_16x16x64_bf16 v[44:47], v[36:39], a[88:95], v172
    v_smfmac_f32_16x16x64_bf16 v[48:51], v[36:39], a[56:63], v172
    v_smfmac_f32_16x16x64_bf16 v[52:55], v[36:39], a[120:127], v172
    s_branch g_49L6_1
g_49L3_1:
    s_waitcnt vmcnt(1)
    v_max3_u32 v19, v28, v29, v30
    v_max_u32 v19, v19, v31
    v_cmp_eq_u32 vcc, -1, v19
    s_nop 0
    s_cbranch_vccnz g_49F3_1
    v_smfmac_f32_16x16x64_bf16 v[40:43], v[28:31], a[8:15], v172
    v_smfmac_f32_16x16x64_bf16 v[44:47], v[28:31], a[72:79], v172
    v_smfmac_f32_16x16x64_bf16 v[48:51], v[28:31], a[40:47], v172
    v_smfmac_f32_16x16x64_bf16 v[52:55], v[28:31], a[104:111], v172
    s_branch g_49L1_0
g_49L6_2:
    s_waitcnt vmcnt(1)
    v_max3_u32 v19, v32, v33, v34
    v_max_u32 v19, v19, v35
    v_cmp_eq_u32 vcc, -1, v19
    s_nop 0
    s_cbranch_vccnz g_49F6_2
    v_smfmac_f32_16x16x64_bf16 v[40:43], v[32:35], a[16:23], v172
    v_smfmac_f32_16x16x64_bf16 v[44:47], v[32:35], a[80:87], v172
    v_smfmac_f32_16x16x64_bf16 v[48:51], v[32:35], a[48:55], v172
    v_smfmac_f32_16x16x64_bf16 v[52:55], v[32:35], a[112:119], v172
    s_branch g_49L2_1
g_49L9_0:
    s_waitcnt vmcnt(1)
    v_max3_u32 v19, v24, v25, v26
    v_max_u32 v19, v19, v27
    v_cmp_eq_u32 vcc, -1, v19
    s_nop 0
    s_cbranch_vccnz g_49F9_0
    v_smfmac_f32_16x16x64_bf16 v[40:43], v[24:27], a[0:7], v172
    v_smfmac_f32_16x16x64_bf16 v[44:47], v[24:27], a[64:71], v172
    v_smfmac_f32_16x16x64_bf16 v[48:51], v[24:27], a[32:39], v172
    v_smfmac_f32_16x16x64_bf16 v[52:55], v[24:27], a[96:103], v172
    s_branch g_49L8_3
g_49L12_3:
    s_waitcnt vmcnt(1)
    v_max3_u32 v19, v36, v37, v38
    v_max_u32 v19, v19, v39
    v_cmp_eq_u32 vcc, -1, v19
    s_nop 0
    s_cbranch_vccnz g_49F12_3
    v_smfmac_f32_16x16x64_bf16 v[40:43], v[36:39], a[24:31], v172
    v_smfmac_f32_16x16x64_bf16 v[44:47], v[36:39], a[88:95], v172
    v_smfmac_f32_16x16x64_bf16 v[48:51], v[36:39], a[56:63], v172
    v_smfmac_f32_16x16x64_bf16 v[52:55], v[36:39], a[120:127], v172
    s_branch g_49L4_2
g_49F15_0:
    s_mov_b64 exec, vcc
    buffer_load_dwordx4 v[24:27], v2, s[4:7], s16 offen offset:0 sc1
    s_mov_b64 exec, -1
    s_add_u32 s23, s23, 1
    s_cmp_lt_u32 s23, 200000
    s_cbranch_scc1 g_49L15_1
    s_mov_b32 s25, 200000
    s_branch gc_50
g_49F15_1:
    s_mov_b64 exec, vcc
    buffer_load_dwordx4 v[28:31], v2, s[4:7], s16 offen offset:1024 sc1
    s_mov_b64 exec, -1
    s_add_u32 s23, s23, 1
    s_cmp_lt_u32 s23, 200000
    s_cbranch_scc1 g_49L15_2
    s_mov_b32 s25, 200000
    s_branch gc_50
g_49F15_2:
    s_mov_b64 exec, vcc
    buffer_load_dwordx4 v[32:35], v2, s[4:7], s16 offen offset:2048 sc1
    s_mov_b64 exec, -1
    s_add_u32 s23, s23, 1
    s_cmp_lt_u32 s23, 200000
    s_cbranch_scc1 g_49L15_3
    s_mov_b32 s25, 200000
    s_branch gc_50
g_49F15_3:
    s_mov_b64 exec, vcc
    buffer_load_dwordx4 v[36:39], v2, s[4:7], s16 offen offset:3072 sc1
    s_mov_b64 exec, -1
    s_add_u32 s23, s23, 1
    s_cmp_lt_u32 s23, 200000
    s_cbranch_scc1 g_49L15_0
    s_mov_b32 s25, 200000
    s_branch gc_50
g_49F7_0:
    s_mov_b64 exec, vcc
    buffer_load_dwordx4 v[24:27], v2, s[4:7], s16 offen offset:0 sc1
    s_mov_b64 exec, -1
    s_add_u32 s23, s23, 1
    s_cmp_lt_u32 s23, 200000
    s_cbranch_scc1 g_49L7_1
    s_mov_b32 s25, 200000
    s_branch gc_50
g_49F7_1:
    s_mov_b64 exec, vcc
    buffer_load_dwordx4 v[28:31], v2, s[4:7], s16 offen offset:1024 sc1
    s_mov_b64 exec, -1
    s_add_u32 s23, s23, 1
    s_cmp_lt_u32 s23, 200000
    s_cbranch_scc1 g_49L7_2
    s_mov_b32 s25, 200000
    s_branch gc_50
g_49F7_2:
    s_mov_b64 exec, vcc
    buffer_load_dwordx4 v[32:35], v2, s[4:7], s16 offen offset:2048 sc1
    s_mov_b64 exec, -1
    s_add_u32 s23, s23, 1
    s_cmp_lt_u32 s23, 200000
    s_cbranch_scc1 g_49L7_0
    s_mov_b32 s25, 200000
    s_branch gc_50
g_49F11_0:
    s_mov_b64 exec, vcc
    buffer_load_dwordx4 v[24:27], v2, s[4:7], s16 offen offset:0 sc1
    s_mov_b64 exec, -1
    s_add_u32 s23, s23, 1
    s_cmp_lt_u32 s23, 200000
    s_cbranch_scc1 g_49L11_1
    s_mov_b32 s25, 200000
    s_branch gc_50
g_49F11_1:
    s_mov_b64 exec, vcc
    buffer_load_dwordx4 v[28:31], v2, s[4:7], s16 offen offset:1024 sc1
    s_mov_b64 exec, -1
    s_add_u32 s23, s23, 1
    s_cmp_lt_u32 s23, 200000
    s_cbranch_scc1 g_49L11_3
    s_mov_b32 s25, 200000
    s_branch gc_50
g_49F11_3:
    s_mov_b64 exec, vcc
    buffer_load_dwordx4 v[36:39], v2, s[4:7], s16 offen offset:3072 sc1
    s_mov_b64 exec, -1
    s_add_u32 s23, s23, 1
    s_cmp_lt_u32 s23, 200000
    s_cbranch_scc1 g_49L11_0
    s_mov_b32 s25, 200000
    s_branch gc_50
g_49F13_0:
    s_mov_b64 exec, vcc
    buffer_load_dwordx4 v[24:27], v2, s[4:7], s16 offen offset:0 sc1
    s_mov_b64 exec, -1
    s_add_u32 s23, s23, 1
    s_cmp_lt_u32 s23, 200000
    s_cbranch_scc1 g_49L13_2
    s_mov_b32 s25, 200000
    s_branch gc_50
g_49F13_2:
    s_mov_b64 exec, vcc
    buffer_load_dwordx4 v[32:35], v2, s[4:7], s16 offen offset:2048 sc1
    s_mov_b64 exec, -1
    s_add_u32 s23, s23, 1
    s_cmp_lt_u32 s23, 200000
    s_cbranch_scc1 g_49L13_3
    s_mov_b32 s25, 200000
    s_branch gc_50
g_49F13_3:
    s_mov_b64 exec, vcc
    buffer_load_dwordx4 v[36:39], v2, s[4:7], s16 offen offset:3072 sc1
    s_mov_b64 exec, -1
    s_add_u32 s23, s23, 1
    s_cmp_lt_u32 s23, 200000
    s_cbranch_scc1 g_49L13_0
    s_mov_b32 s25, 200000
    s_branch gc_50
g_49F14_1:
    s_mov_b64 exec, vcc
    buffer_load_dwordx4 v[28:31], v2, s[4:7], s16 offen offset:1024 sc1
    s_mov_b64 exec, -1
    s_add_u32 s23, s23, 1
    s_cmp_lt_u32 s23, 200000
    s_cbranch_scc1 g_49L14_2
    s_mov_b32 s25, 200000
    s_branch gc_50
g_49F14_2:
    s_mov_b64 exec, vcc
    buffer_load_dwordx4 v[32:35], v2, s[4:7], s16 offen offset:2048 sc1
    s_mov_b64 exec, -1
    s_add_u32 s23, s23, 1
    s_cmp_lt_u32 s23, 200000
    s_cbranch_scc1 g_49L14_3
    s_mov_b32 s25, 200000
    s_branch gc_50
g_49F14_3:
    s_mov_b64 exec, vcc
    buffer_load_dwordx4 v[36:39], v2, s[4:7], s16 offen offset:3072 sc1
    s_mov_b64 exec, -1
    s_add_u32 s23, s23, 1
    s_cmp_lt_u32 s23, 200000
    s_cbranch_scc1 g_49L14_1
    s_mov_b32 s25, 200000
    s_branch gc_50
g_49F3_0:
    s_mov_b64 exec, vcc
    buffer_load_dwordx4 v[24:27], v2, s[4:7], s16 offen offset:0 sc1
    s_mov_b64 exec, -1
    s_add_u32 s23, s23, 1
    s_cmp_lt_u32 s23, 200000
    s_cbranch_scc1 g_49L3_1
    s_mov_b32 s25, 200000
    s_branch gc_50
g_49F3_1:
    s_mov_b64 exec, vcc
    buffer_load_dwordx4 v[28:31], v2, s[4:7], s16 offen offset:1024 sc1
    s_mov_b64 exec, -1
    s_add_u32 s23, s23, 1
    s_cmp_lt_u32 s23, 200000
    s_cbranch_scc1 g_49L3_0
    s_mov_b32 s25, 200000
    s_branch gc_50
g_49F5_0:
    s_mov_b64 exec, vcc
    buffer_load_dwordx4 v[24:27], v2, s[4:7], s16 offen offset:0 sc1
    s_mov_b64 exec, -1
    s_add_u32 s23, s23, 1
    s_cmp_lt_u32 s23, 200000
    s_cbranch_scc1 g_49L5_2
    s_mov_b32 s25, 200000
    s_branch gc_50
g_49F5_2:
    s_mov_b64 exec, vcc
    buffer_load_dwordx4 v[32:35], v2, s[4:7], s16 offen offset:2048 sc1
    s_mov_b64 exec, -1
    s_add_u32 s23, s23, 1
    s_cmp_lt_u32 s23, 200000
    s_cbranch_scc1 g_49L5_0
    s_mov_b32 s25, 200000
    s_branch gc_50
g_49F6_1:
    s_mov_b64 exec, vcc
    buffer_load_dwordx4 v[28:31], v2, s[4:7], s16 offen offset:1024 sc1
    s_mov_b64 exec, -1
    s_add_u32 s23, s23, 1
    s_cmp_lt_u32 s23, 200000
    s_cbranch_scc1 g_49L6_2
    s_mov_b32 s25, 200000
    s_branch gc_50
g_49F6_2:
    s_mov_b64 exec, vcc
    buffer_load_dwordx4 v[32:35], v2, s[4:7], s16 offen offset:2048 sc1
    s_mov_b64 exec, -1
    s_add_u32 s23, s23, 1
    s_cmp_lt_u32 s23, 200000
    s_cbranch_scc1 g_49L6_1
    s_mov_b32 s25, 200000
    s_branch gc_50
g_49F9_0:
    s_mov_b64 exec, vcc
    buffer_load_dwordx4 v[24:27], v2, s[4:7], s16 offen offset:0 sc1
    s_mov_b64 exec, -1
    s_add_u32 s23, s23, 1
    s_cmp_lt_u32 s23, 200000
    s_cbranch_scc1 g_49L9_3
    s_mov_b32 s25, 200000
    s_branch gc_50
g_49F9_3:
    s_mov_b64 exec, vcc
    buffer_load_dwordx4 v[36:39], v2, s[4:7], s16 offen offset:3072 sc1
    s_mov_b64 exec, -1
    s_add_u32 s23, s23, 1
    s_cmp_lt_u32 s23, 200000
    s_cbranch_scc1 g_49L9_0
    s_mov_b32 s25, 200000
    s_branch gc_50
g_49F10_1:
    s_mov_b64 exec, vcc
    buffer_load_dwordx4 v[28:31], v2, s[4:7], s16 offen offset:1024 sc1
    s_mov_b64 exec, -1
    s_add_u32 s23, s23, 1
    s_cmp_lt_u32 s23, 200000
    s_cbranch_scc1 g_49L10_3
    s_mov_b32 s25, 200000
    s_branch gc_50
g_49F10_3:
    s_mov_b64 exec, vcc
    buffer_load_dwordx4 v[36:39], v2, s[4:7], s16 offen offset:3072 sc1
    s_mov_b64 exec, -1
    s_add_u32 s23, s23, 1
    s_cmp_lt_u32 s23, 200000
    s_cbranch_scc1 g_49L10_1
    s_mov_b32 s25, 200000
    s_branch gc_50
g_49F12_2:
    s_mov_b64 exec, vcc
    buffer_load_dwordx4 v[32:35], v2, s[4:7], s16 offen offset:2048 sc1
    s_mov_b64 exec, -1
    s_add_u32 s23, s23, 1
    s_cmp_lt_u32 s23, 200000
    s_cbranch_scc1 g_49L12_3
    s_mov_b32 s25, 200000
    s_branch gc_50
g_49F12_3:
    s_mov_b64 exec, vcc
    buffer_load_dwordx4 v[36:39], v2, s[4:7], s16 offen offset:3072 sc1
    s_mov_b64 exec, -1
    s_add_u32 s23, s23, 1
    s_cmp_lt_u32 s23, 200000
    s_cbranch_scc1 g_49L12_2
    s_mov_b32 s25, 200000
    s_branch gc_50
g_49F1_0:
    s_mov_b64 exec, vcc
    buffer_load_dwordx4 v[24:27], v2, s[4:7], s16 offen offset:0 sc1
    s_mov_b64 exec, -1
    s_add_u32 s23, s23, 1
    s_cmp_lt_u32 s23, 200000
    s_cbranch_scc1 g_49L1_0
    s_mov_b32 s25, 200000
    s_branch gc_50
g_49F2_1:
    s_mov_b64 exec, vcc
    buffer_load_dwordx4 v[28:31], v2, s[4:7], s16 offen offset:1024 sc1
    s_mov_b64 exec, -1
    s_add_u32 s23, s23, 1
    s_cmp_lt_u32 s23, 200000
    s_cbranch_scc1 g_49L2_1
    s_mov_b32 s25, 200000
    s_branch gc_50
g_49F4_2:
    s_mov_b64 exec, vcc
    buffer_load_dwordx4 v[32:35], v2, s[4:7], s16 offen offset:2048 sc1
    s_mov_b64 exec, -1
    s_add_u32 s23, s23, 1
    s_cmp_lt_u32 s23, 200000
    s_cbranch_scc1 g_49L4_2
    s_mov_b32 s25, 200000
    s_branch gc_50
g_49F8_3:
    s_mov_b64 exec, vcc
    buffer_load_dwordx4 v[36:39], v2, s[4:7], s16 offen offset:3072 sc1
    s_mov_b64 exec, -1
    s_add_u32 s23, s23, 1
    s_cmp_lt_u32 s23, 200000
    s_cbranch_scc1 g_49L8_3
    s_mov_b32 s25, 200000
    s_branch gc_50
g_51L15_0:
    s_waitcnt vmcnt(3)
    v_max3_u32 v19, v24, v25, v26
    v_max_u32 v19, v19, v27
    v_cmp_eq_u32 vcc, -1, v19
    s_nop 0
    s_cbranch_vccnz g_51F15_0
    v_smfmac_f32_16x16x64_bf16 v[64:67], v[24:27], a[192:199], v172
    v_smfmac_f32_16x16x64_bf16 v[68:71], v[24:27], a[224:231], v172
g_51L14_1:
    s_waitcnt vmcnt(2)
    v_max3_u32 v19, v28, v29, v30
    v_max_u32 v19, v19, v31
    v_cmp_eq_u32 vcc, -1, v19
    s_nop 0
    s_cbranch_vccnz g_51F14_1
    v_smfmac_f32_16x16x64_bf16 v[64:67], v[28:31], a[200:207], v172
    v_smfmac_f32_16x16x64_bf16 v[68:71], v[28:31], a[232:239], v172
g_51L12_2:
    s_waitcnt vmcnt(1)
    v_max3_u32 v19, v32, v33, v34
    v_max_u32 v19, v19, v35
    v_cmp_eq_u32 vcc, -1, v19
    s_nop 0
    s_cbranch_vccnz g_51F12_2
    v_smfmac_f32_16x16x64_bf16 v[64:67], v[32:35], a[208:215], v172
    v_smfmac_f32_16x16x64_bf16 v[68:71], v[32:35], a[240:247], v172
g_51L8_3:
    s_waitcnt vmcnt(0)
    v_max3_u32 v19, v36, v37, v38
    v_max_u32 v19, v19, v39
    v_cmp_eq_u32 vcc, -1, v19
    s_nop 0
    s_cbranch_vccnz g_51F8_3
    v_smfmac_f32_16x16x64_bf16 v[64:67], v[36:39], a[216:223], v172
    v_smfmac_f32_16x16x64_bf16 v[68:71], v[36:39], a[248:255], v172
    s_nop 4
    v_cvt_pk_bf16_f32 v80, v64, v65
    v_cvt_pk_bf16_f32 v81, v66, v67
    s_nop 0
    v_cvt_pk_bf16_f32 v82, v68, v69
    v_cvt_pk_bf16_f32 v83, v70, v71
    s_nop 1
    v_mfma_f32_16x16x32_bf16 v[88:91], v[80:83], v[84:87], 0
    s_branch gc_52
g_51L15_1:
    s_waitcnt vmcnt(3)
    v_max3_u32 v19, v28, v29, v30
    v_max_u32 v19, v19, v31
    v_cmp_eq_u32 vcc, -1, v19
    s_nop 0
    s_cbranch_vccnz g_51F15_1
    v_smfmac_f32_16x16x64_bf16 v[64:67], v[28:31], a[200:207], v172
    v_smfmac_f32_16x16x64_bf16 v[68:71], v[28:31], a[232:239], v172
g_51L13_2:
    s_waitcnt vmcnt(2)
    v_max3_u32 v19, v32, v33, v34
    v_max_u32 v19, v19, v35
    v_cmp_eq_u32 vcc, -1, v19
    s_nop 0
    s_cbranch_vccnz g_51F13_2
    v_smfmac_f32_16x16x64_bf16 v[64:67], v[32:35], a[208:215], v172
    v_smfmac_f32_16x16x64_bf16 v[68:71], v[32:35], a[240:247], v172
g_51L9_3:
    s_waitcnt vmcnt(1)
    v_max3_u32 v19, v36, v37, v38
    v_max_u32 v19, v19, v39
    v_cmp_eq_u32 vcc, -1, v19
    s_nop 0
    s_cbranch_vccnz g_51F9_3
    v_smfmac_f32_16x16x64_bf16 v[64:67], v[36:39], a[216:223], v172
    v_smfmac_f32_16x16x64_bf16 v[68:71], v[36:39], a[248:255], v172
g_51L1_0:
    s_waitcnt vmcnt(0)
    v_max3_u32 v19, v24, v25, v26
    v_max_u32 v19, v19, v27
    v_cmp_eq_u32 vcc, -1, v19
    s_nop 0
    s_cbranch_vccnz g_51F1_0
    v_smfmac_f32_16x16x64_bf16 v[64:67], v[24:27], a[192:199], v172
    v_smfmac_f32_16x16x64_bf16 v[68:71], v[24:27], a[224:231], v172
    s_nop 4
    v_cvt_pk_bf16_f32 v80, v64, v65
    v_cvt_pk_bf16_f32 v81, v66, v67
    s_nop 0
    v_cvt_pk_bf16_f32 v82, v68, v69
    v_cvt_pk_bf16_f32 v83, v70, v71
    s_nop 1
    v_mfma_f32_16x16x32_bf16 v[88:91], v[80:83], v[84:87], 0
    s_branch gc_52
g_51L15_2:
    s_waitcnt vmcnt(3)
    v_max3_u32 v19, v32, v33, v34
    v_max_u32 v19, v19, v35
    v_cmp_eq_u32 vcc, -1, v19
    s_nop 0
    s_cbranch_vccnz g_51F15_2
    v_smfmac_f32_16x16x64_bf16 v[64:67], v[32:35], a[208:215], v172
    v_smfmac_f32_16x16x64_bf16 v[68:71], v[32:35], a[240:247], v172
g_51L11_3:
    s_waitcnt vmcnt(2)
    v_max3_u32 v19, v36, v37, v38
    v_max_u32 v19, v19, v39
    v_cmp_eq_u32 vcc, -1, v19
    s_nop 0
    s_cbranch_vccnz g_51F11_3
    v_smfmac_f32_16x16x64_bf16 v[64:67], v[36:39], a[216:223], v172
    v_smfmac_f32_16x16x64_bf16 v[68:71], v[36:39], a[248:255], v172
g_51L3_0:
    s_waitcnt vmcnt(1)
    v_max3_u32 v19, v24, v25, v26
    v_max_u32 v19, v19, v27
    v_cmp_eq_u32 vcc, -1, v19
    s_nop 0
    s_cbranch_vccnz g_51F3_0
    v_smfmac_f32_16x16x64_bf16 v[64:67], v[24:27], a[192:199], v172
    v_smfmac_f32_16x16x64_bf16 v[68:71], v[24:27], a[224:231], v172
g_51L2_1:
    s_waitcnt vmcnt(0)
    v_max3_u32 v19, v28, v29, v30
    v_max_u32 v19, v19, v31
    v_cmp_eq_u32 vcc, -1, v19
    s_nop 0
    s_cbranch_vccnz g_51F2_1
    v_smfmac_f32_16x16x64_bf16 v[64:67], v[28:31], a[200:207], v172
    v_smfmac_f32_16x16x64_bf16 v[68:71], v[28:31], a[232:239], v172
    s_nop 4
    v_cvt_pk_bf16_f32 v80, v64, v65
    v_cvt_pk_bf16_f32 v81, v66, v67
    s_nop 0
    v_cvt_pk_bf16_f32 v82, v68, v69
    v_cvt_pk_bf16_f32 v83, v70, v71
    s_nop 1
    v_mfma_f32_16x16x32_bf16 v[88:91], v[80:83], v[84:87], 0
    s_branch gc_52
g_51L15_3:
    s_waitcnt vmcnt(3)
    v_max3_u32 v19, v36, v37, v38
    v_max_u32 v19, v19, v39
    v_cmp_eq_u32 vcc, -1, v19
    s_nop 0
    s_cbranch_vccnz g_51F15_3
    v_smfmac_f32_16x16x64_bf16 v[64:67], v[36:39], a[216:223], v172
    v_smfmac_f32_16x16x64_bf16 v[68:71], v[36:39], a[248:255], v172
g_51L7_0:
    s_waitcnt vmcnt(2)
    v_max3_u32 v19, v24, v25, v26
    v_max_u32 v19, v19, v27
    v_cmp_eq_u32 vcc, -1, v19
    s_nop 0
    s_cbranch_vccnz g_51F7_0
    v_smfmac_f32_16x16x64_bf16 v[64:67], v[24:27], a[192:199], v172
    v_smfmac_f32_16x16x64_bf16 v[68:71], v[24:27], a[224:231], v172
g_51L6_1:
    s_waitcnt vmcnt(1)
    v_max3_u32 v19, v28, v29, v30
    v_max_u32 v19, v19, v31
    v_cmp_eq_u32 vcc, -1, v19
    s_nop 0
    s_cbranch_vccnz g_51F6_1
    v_smfmac_f32_16x16x64_bf16 v[64:67], v[28:31], a[200:207], v172
    v_smfmac_f32_16x16x64_bf16 v[68:71], v[28:31], a[232:239], v172
g_51L4_2:
    s_waitcnt vmcnt(0)
    v_max3_u32 v19, v32, v33, v34
    v_max_u32 v19, v19, v35
    v_cmp_eq_u32 vcc, -1, v19
    s_nop 0
    s_cbranch_vccnz g_51F4_2
    v_smfmac_f32_16x16x64_bf16 v[64:67], v[32:35], a[208:215], v172
    v_smfmac_f32_16x16x64_bf16 v[68:71], v[32:35], a[240:247], v172
    s_nop 4
    v_cvt_pk_bf16_f32 v80, v64, v65
    v_cvt_pk_bf16_f32 v81, v66, v67
    s_nop 0
    v_cvt_pk_bf16_f32 v82, v68, v69
    v_cvt_pk_bf16_f32 v83, v70, v71
    s_nop 1
    v_mfma_f32_16x16x32_bf16 v[88:91], v[80:83], v[84:87], 0
    s_branch gc_52
g_51L7_1:
    s_waitcnt vmcnt(2)
    v_max3_u32 v19, v28, v29, v30
    v_max_u32 v19, v19, v31
    v_cmp_eq_u32 vcc, -1, v19
    s_nop 0
    s_cbranch_vccnz g_51F7_1
    v_smfmac_f32_16x16x64_bf16 v[64:67], v[28:31], a[200:207], v172
    v_smfmac_f32_16x16x64_bf16 v[68:71], v[28:31], a[232:239], v172
g_51L5_2:
    s_waitcnt vmcnt(1)
    v_max3_u32 v19, v32, v33, v34
    v_max_u32 v19, v19, v35
    v_cmp_eq_u32 vcc, -1, v19
    s_nop 0
    s_cbranch_vccnz g_51F5_2
    v_smfmac_f32_16x16x64_bf16 v[64:67], v[32:35], a[208:215], v172
    v_smfmac_f32_16x16x64_bf16 v[68:71], v[32:35], a[240:247], v172
    s_branch g_51L1_0
g_51L7_2:
    s_waitcnt vmcnt(2)
    v_max3_u32 v19, v32, v33, v34
    v_max_u32 v19, v19, v35
    v_cmp_eq_u32 vcc, -1, v19
    s_nop 0
    s_cbranch_vccnz g_51F7_2
    v_smfmac_f32_16x16x64_bf16 v[64:67], v[32:35], a[208:215], v172
    v_smfmac_f32_16x16x64_bf16 v[68:71], v[32:35], a[240:247], v172
    s_branch g_51L3_0
g_51L11_0:
    s_waitcnt vmcnt(2)
    v_max3_u32 v19, v24, v25, v26
    v_max_u32 v19, v19, v27
    v_cmp_eq_u32 vcc, -1, v19
    s_nop 0
    s_cbranch_vccnz g_51F11_0
    v_smfmac_f32_16x16x64_bf16 v[64:67], v[24:27], a[192:199], v172
    v_smfmac_f32_16x16x64_bf16 v[68:71], v[24:27], a[224:231], v172
g_51L10_1:
    s_waitcnt vmcnt(1)
    v_max3_u32 v19, v28, v29, v30
    v_max_u32 v19, v19, v31
    v_cmp_eq_u32 vcc, -1, v19
    s_nop 0
    s_cbranch_vccnz g_51F10_1
    v_smfmac_f32_16x16x64_bf16 v[64:67], v[28:31], a[200:207], v172
    v_smfmac_f32_16x16x64_bf16 v[68:71], v[28:31], a[232:239], v172
    s_branch g_51L8_3
g_51L11_1:
    s_waitcnt vmcnt(2)
    v_max3_u32 v19, v28, v29, v30
    v_max_u32 v19, v19, v31
    v_cmp_eq_u32 vcc, -1, v19
    s_nop 0
    s_cbranch_vccnz g_51F11_1
    v_smfmac_f32_16x16x64_bf16 v[64:67], v[28:31], a[200:207], v172
    v_smfmac_f32_16x16x64_bf16 v[68:71], v[28:31], a[232:239], v172
    s_branch g_51L9_3
g_51L13_0:
    s_waitcnt vmcnt(2)
    v_max3_u32 v19, v24, v25, v26
    v_max_u32 v19, v19, v27
    v_cmp_eq_u32 vcc, -1, v19
    s_nop 0
    s_cbranch_vccnz g_51F13_0
    v_smfmac_f32_16x16x64_bf16 v[64:67], v[24:27], a[192:199], v172
    v_smfmac_f32_16x16x64_bf16 v[68:71], v[24:27], a[224:231], v172
    s_branch g_51L12_2
g_51L13_3:
    s_waitcnt vmcnt(2)
    v_max3_u32 v19, v36, v37, v38
    v_max_u32 v19, v19, v39
    v_cmp_eq_u32 vcc, -1, v19
    s_nop 0
    s_cbranch_vccnz g_51F13_3
    v_smfmac_f32_16x16x64_bf16 v[64:67], v[36:39], a[216:223], v172
    v_smfmac_f32_16x16x64_bf16 v[68:71], v[36:39], a[248:255], v172
g_51L5_0:
    s_waitcnt vmcnt(1)
    v_max3_u32 v19, v24, v25, v26
    v_max_u32 v19, v19, v27
    v_cmp_eq_u32 vcc, -1, v19
    s_nop 0
    s_cbranch_vccnz g_51F5_0
    v_smfmac_f32_16x16x64_bf16 v[64:67], v[24:27], a[192:199], v172
    v_smfmac_f32_16x16x64_bf16 v[68:71], v[24:27], a[224:231], v172
    s_branch g_51L4_2
g_51L14_2:
    s_waitcnt vmcnt(2)
    v_max3_u32 v19, v32, v33, v34
    v_max_u32 v19, v19, v35
    v_cmp_eq_u32 vcc, -1, v19
    s_nop 0
    s_cbranch_vccnz g_51F14_2
    v_smfmac_f32_16x16x64_bf16 v[64:67], v[32:35], a[208:215], v172
    v_smfmac_f32_16x16x64_bf16 v[68:71], v[32:35], a[240:247], v172
g_51L10_3:
    s_waitcnt vmcnt(1)
    v_max3_u32 v19, v36, v37, v38
    v_max_u32 v19, v19, v39
    v_cmp_eq_u32 vcc, -1, v19
    s_nop 0
    s_cbranch_vccnz g_51F10_3
    v_smfmac_f32_16x16x64_bf16 v[64:67], v[36:39], a[216:223], v172
    v_smfmac_f32_16x16x64_bf16 v[68:71], v[36:39], a[248:255], v172
    s_branch g_51L2_1
g_51L14_3:
    s_waitcnt vmcnt(2)
    v_max3_u32 v19, v36, v37, v38
    v_max_u32 v19, v19, v39
    v_cmp_eq_u32 vcc, -1, v19
    s_nop 0
    s_cbranch_vccnz g_51F14_3
    v_smfmac_f32_16x16x64_bf16 v[64:67], v[36:39], a[216:223], v172
    v_smfmac_f32_16x16x64_bf16 v[68:71], v[36:39], a[248:255], v172
    s_branch g_51L6_1
g_51L3_1:
    s_waitcnt vmcnt(1)
    v_max3_u32 v19, v28, v29, v30
    v_max_u32 v19, v19, v31
    v_cmp_eq_u32 vcc, -1, v19
    s_nop 0
    s_cbranch_vccnz g_51F3_1
    v_smfmac_f32_16x16x64_bf16 v[64:67], v[28:31], a[200:207], v172
    v_smfmac_f32_16x16x64_bf16 v[68:71], v[28:31], a[232:239], v172
    s_branch g_51L1_0
g_51L6_2:
    s_waitcnt vmcnt(1)
    v_max3_u32 v19, v32, v33, v34
    v_max_u32 v19, v19, v35
    v_cmp_eq_u32 vcc, -1, v19
    s_nop 0
    s_cbranch_vccnz g_51F6_2
    v_smfmac_f32_16x16x64_bf16 v[64:67], v[32:35], a[208:215], v172
    v_smfmac_f32_16x16x64_bf16 v[68:71], v[32:35], a[240:247], v172
    s_branch g_51L2_1
g_51L9_0:
    s_waitcnt vmcnt(1)
    v_max3_u32 v19, v24, v25, v26
    v_max_u32 v19, v19, v27
    v_cmp_eq_u32 vcc, -1, v19
    s_nop 0
    s_cbranch_vccnz g_51F9_0
    v_smfmac_f32_16x16x64_bf16 v[64:67], v[24:27], a[192:199], v172
    v_smfmac_f32_16x16x64_bf16 v[68:71], v[24:27], a[224:231], v172
    s_branch g_51L8_3
g_51L12_3:
    s_waitcnt vmcnt(1)
    v_max3_u32 v19, v36, v37, v38
    v_max_u32 v19, v19, v39
    v_cmp_eq_u32 vcc, -1, v19
    s_nop 0
    s_cbranch_vccnz g_51F12_3
    v_smfmac_f32_16x16x64_bf16 v[64:67], v[36:39], a[216:223], v172
    v_smfmac_f32_16x16x64_bf16 v[68:71], v[36:39], a[248:255], v172
    s_branch g_51L4_2
g_51F15_0:
    s_mov_b64 exec, vcc
    buffer_load_dwordx4 v[24:27], v8, s[4:7], s16 offen offset:0 sc1
    s_mov_b64 exec, -1
    s_add_u32 s23, s23, 1
    s_cmp_lt_u32 s23, 200000
    s_cbranch_scc1 g_51L15_1
    s_mov_b32 s25, 200000
    s_branch gc_52
g_51F15_1:
    s_mov_b64 exec, vcc
    buffer_load_dwordx4 v[28:31], v8, s[4:7], s16 offen offset:1024 sc1
    s_mov_b64 exec, -1
    s_add_u32 s23, s23, 1
    s_cmp_lt_u32 s23, 200000
    s_cbranch_scc1 g_51L15_2
    s_mov_b32 s25, 200000
    s_branch gc_52
g_51F15_2:
    s_mov_b64 exec, vcc
    buffer_load_dwordx4 v[32:35], v8, s[4:7], s16 offen offset:2048 sc1
    s_mov_b64 exec, -1
    s_add_u32 s23, s23, 1
    s_cmp_lt_u32 s23, 200000
    s_cbranch_scc1 g_51L15_3
    s_mov_b32 s25, 200000
    s_branch gc_52
g_51F15_3:
    s_mov_b64 exec, vcc
    buffer_load_dwordx4 v[36:39], v8, s[4:7], s16 offen offset:3072 sc1
    s_mov_b64 exec, -1
    s_add_u32 s23, s23, 1
    s_cmp_lt_u32 s23, 200000
    s_cbranch_scc1 g_51L15_0
    s_mov_b32 s25, 200000
    s_branch gc_52
g_51F7_0:
    s_mov_b64 exec, vcc
    buffer_load_dwordx4 v[24:27], v8, s[4:7], s16 offen offset:0 sc1
    s_mov_b64 exec, -1
    s_add_u32 s23, s23, 1
    s_cmp_lt_u32 s23, 200000
    s_cbranch_scc1 g_51L7_1
    s_mov_b32 s25, 200000
    s_branch gc_52
g_51F7_1:
    s_mov_b64 exec, vcc
    buffer_load_dwordx4 v[28:31], v8, s[4:7], s16 offen offset:1024 sc1
    s_mov_b64 exec, -1
    s_add_u32 s23, s23, 1
    s_cmp_lt_u32 s23, 200000
    s_cbranch_scc1 g_51L7_2
    s_mov_b32 s25, 200000
    s_branch gc_52
g_51F7_2:
    s_mov_b64 exec, vcc
    buffer_load_dwordx4 v[32:35], v8, s[4:7], s16 offen offset:2048 sc1
    s_mov_b64 exec, -1
    s_add_u32 s23, s23, 1
    s_cmp_lt_u32 s23, 200000
    s_cbranch_scc1 g_51L7_0
    s_mov_b32 s25, 200000
    s_branch gc_52
g_51F11_0:
    s_mov_b64 exec, vcc
    buffer_load_dwordx4 v[24:27], v8, s[4:7], s16 offen offset:0 sc1
    s_mov_b64 exec, -1
    s_add_u32 s23, s23, 1
    s_cmp_lt_u32 s23, 200000
    s_cbranch_scc1 g_51L11_1
    s_mov_b32 s25, 200000
    s_branch gc_52
g_51F11_1:
    s_mov_b64 exec, vcc
    buffer_load_dwordx4 v[28:31], v8, s[4:7], s16 offen offset:1024 sc1
    s_mov_b64 exec, -1
    s_add_u32 s23, s23, 1
    s_cmp_lt_u32 s23, 200000
    s_cbranch_scc1 g_51L11_3
    s_mov_b32 s25, 200000
    s_branch gc_52
g_51F11_3:
    s_mov_b64 exec, vcc
    buffer_load_dwordx4 v[36:39], v8, s[4:7], s16 offen offset:3072 sc1
    s_mov_b64 exec, -1
    s_add_u32 s23, s23, 1
    s_cmp_lt_u32 s23, 200000
    s_cbranch_scc1 g_51L11_0
    s_mov_b32 s25, 200000
    s_branch gc_52
g_51F13_0:
    s_mov_b64 exec, vcc
    buffer_load_dwordx4 v[24:27], v8, s[4:7], s16 offen offset:0 sc1
    s_mov_b64 exec, -1
    s_add_u32 s23, s23, 1
    s_cmp_lt_u32 s23, 200000
    s_cbranch_scc1 g_51L13_2
    s_mov_b32 s25, 200000
    s_branch gc_52
g_51F13_2:
    s_mov_b64 exec, vcc
    buffer_load_dwordx4 v[32:35], v8, s[4:7], s16 offen offset:2048 sc1
    s_mov_b64 exec, -1
    s_add_u32 s23, s23, 1
    s_cmp_lt_u32 s23, 200000
    s_cbranch_scc1 g_51L13_3
    s_mov_b32 s25, 200000
    s_branch gc_52
g_51F13_3:
    s_mov_b64 exec, vcc
    buffer_load_dwordx4 v[36:39], v8, s[4:7], s16 offen offset:3072 sc1
    s_mov_b64 exec, -1
    s_add_u32 s23, s23, 1
    s_cmp_lt_u32 s23, 200000
    s_cbranch_scc1 g_51L13_0
    s_mov_b32 s25, 200000
    s_branch gc_52
g_51F14_1:
    s_mov_b64 exec, vcc
    buffer_load_dwordx4 v[28:31], v8, s[4:7], s16 offen offset:1024 sc1
    s_mov_b64 exec, -1
    s_add_u32 s23, s23, 1
    s_cmp_lt_u32 s23, 200000
    s_cbranch_scc1 g_51L14_2
    s_mov_b32 s25, 200000
    s_branch gc_52
g_51F14_2:
    s_mov_b64 exec, vcc
    buffer_load_dwordx4 v[32:35], v8, s[4:7], s16 offen offset:2048 sc1
    s_mov_b64 exec, -1
    s_add_u32 s23, s23, 1
    s_cmp_lt_u32 s23, 200000
    s_cbranch_scc1 g_51L14_3
    s_mov_b32 s25, 200000
    s_branch gc_52
g_51F14_3:
    s_mov_b64 exec, vcc
    buffer_load_dwordx4 v[36:39], v8, s[4:7], s16 offen offset:3072 sc1
    s_mov_b64 exec, -1
    s_add_u32 s23, s23, 1
    s_cmp_lt_u32 s23, 200000
    s_cbranch_scc1 g_51L14_1
    s_mov_b32 s25, 200000
    s_branch gc_52
g_51F3_0:
    s_mov_b64 exec, vcc
    buffer_load_dwordx4 v[24:27], v8, s[4:7], s16 offen offset:0 sc1
    s_mov_b64 exec, -1
    s_add_u32 s23, s23, 1
    s_cmp_lt_u32 s23, 200000
    s_cbranch_scc1 g_51L3_1
    s_mov_b32 s25, 200000
    s_branch gc_52
g_51F3_1:
    s_mov_b64 exec, vcc
    buffer_load_dwordx4 v[28:31], v8, s[4:7], s16 offen offset:1024 sc1
    s_mov_b64 exec, -1
    s_add_u32 s23, s23, 1
    s_cmp_lt_u32 s23, 200000
    s_cbranch_scc1 g_51L3_0
    s_mov_b32 s25, 200000
    s_branch gc_52
g_51F5_0:
    s_mov_b64 exec, vcc
    buffer_load_dwordx4 v[24:27], v8, s[4:7], s16 offen offset:0 sc1
    s_mov_b64 exec, -1
    s_add_u32 s23, s23, 1
    s_cmp_lt_u32 s23, 200000
    s_cbranch_scc1 g_51L5_2
    s_mov_b32 s25, 200000
    s_branch gc_52
g_51F5_2:
    s_mov_b64 exec, vcc
    buffer_load_dwordx4 v[32:35], v8, s[4:7], s16 offen offset:2048 sc1
    s_mov_b64 exec, -1
    s_add_u32 s23, s23, 1
    s_cmp_lt_u32 s23, 200000
    s_cbranch_scc1 g_51L5_0
    s_mov_b32 s25, 200000
    s_branch gc_52
g_51F6_1:
    s_mov_b64 exec, vcc
    buffer_load_dwordx4 v[28:31], v8, s[4:7], s16 offen offset:1024 sc1
    s_mov_b64 exec, -1
    s_add_u32 s23, s23, 1
    s_cmp_lt_u32 s23, 200000
    s_cbranch_scc1 g_51L6_2
    s_mov_b32 s25, 200000
    s_branch gc_52
g_51F6_2:
    s_mov_b64 exec, vcc
    buffer_load_dwordx4 v[32:35], v8, s[4:7], s16 offen offset:2048 sc1
    s_mov_b64 exec, -1
    s_add_u32 s23, s23, 1
    s_cmp_lt_u32 s23, 200000
    s_cbranch_scc1 g_51L6_1
    s_mov_b32 s25, 200000
    s_branch gc_52
g_51F9_0:
    s_mov_b64 exec, vcc
    buffer_load_dwordx4 v[24:27], v8, s[4:7], s16 offen offset:0 sc1
    s_mov_b64 exec, -1
    s_add_u32 s23, s23, 1
    s_cmp_lt_u32 s23, 200000
    s_cbranch_scc1 g_51L9_3
    s_mov_b32 s25, 200000
    s_branch gc_52
g_51F9_3:
    s_mov_b64 exec, vcc
    buffer_load_dwordx4 v[36:39], v8, s[4:7], s16 offen offset:3072 sc1
    s_mov_b64 exec, -1
    s_add_u32 s23, s23, 1
    s_cmp_lt_u32 s23, 200000
    s_cbranch_scc1 g_51L9_0
    s_mov_b32 s25, 200000
    s_branch gc_52
g_51F10_1:
    s_mov_b64 exec, vcc
    buffer_load_dwordx4 v[28:31], v8, s[4:7], s16 offen offset:1024 sc1
    s_mov_b64 exec, -1
    s_add_u32 s23, s23, 1
    s_cmp_lt_u32 s23, 200000
    s_cbranch_scc1 g_51L10_3
    s_mov_b32 s25, 200000
    s_branch gc_52
g_51F10_3:
    s_mov_b64 exec, vcc
    buffer_load_dwordx4 v[36:39], v8, s[4:7], s16 offen offset:3072 sc1
    s_mov_b64 exec, -1
    s_add_u32 s23, s23, 1
    s_cmp_lt_u32 s23, 200000
    s_cbranch_scc1 g_51L10_1
    s_mov_b32 s25, 200000
    s_branch gc_52
g_51F12_2:
    s_mov_b64 exec, vcc
    buffer_load_dwordx4 v[32:35], v8, s[4:7], s16 offen offset:2048 sc1
    s_mov_b64 exec, -1
    s_add_u32 s23, s23, 1
    s_cmp_lt_u32 s23, 200000
    s_cbranch_scc1 g_51L12_3
    s_mov_b32 s25, 200000
    s_branch gc_52
g_51F12_3:
    s_mov_b64 exec, vcc
    buffer_load_dwordx4 v[36:39], v8, s[4:7], s16 offen offset:3072 sc1
    s_mov_b64 exec, -1
    s_add_u32 s23, s23, 1
    s_cmp_lt_u32 s23, 200000
    s_cbranch_scc1 g_51L12_2
    s_mov_b32 s25, 200000
    s_branch gc_52
g_51F1_0:
    s_mov_b64 exec, vcc
    buffer_load_dwordx4 v[24:27], v8, s[4:7], s16 offen offset:0 sc1
    s_mov_b64 exec, -1
    s_add_u32 s23, s23, 1
    s_cmp_lt_u32 s23, 200000
    s_cbranch_scc1 g_51L1_0
    s_mov_b32 s25, 200000
    s_branch gc_52
g_51F2_1:
    s_mov_b64 exec, vcc
    buffer_load_dwordx4 v[28:31], v8, s[4:7], s16 offen offset:1024 sc1
    s_mov_b64 exec, -1
    s_add_u32 s23, s23, 1
    s_cmp_lt_u32 s23, 200000
    s_cbranch_scc1 g_51L2_1
    s_mov_b32 s25, 200000
    s_branch gc_52
g_51F4_2:
    s_mov_b64 exec, vcc
    buffer_load_dwordx4 v[32:35], v8, s[4:7], s16 offen offset:2048 sc1
    s_mov_b64 exec, -1
    s_add_u32 s23, s23, 1
    s_cmp_lt_u32 s23, 200000
    s_cbranch_scc1 g_51L4_2
    s_mov_b32 s25, 200000
    s_branch gc_52
g_51F8_3:
    s_mov_b64 exec, vcc
    buffer_load_dwordx4 v[36:39], v8, s[4:7], s16 offen offset:3072 sc1
    s_mov_b64 exec, -1
    s_add_u32 s23, s23, 1
    s_cmp_lt_u32 s23, 200000
    s_cbranch_scc1 g_51L8_3
    s_mov_b32 s25, 200000
    s_branch gc_52
pr_53:
    s_waitcnt vmcnt(3)
    v_pk_add_f32 v[120:121], v[88:89], v[108:109]
    v_pk_add_f32 v[122:123], v[90:91], v[110:111]
    s_waitcnt vmcnt(2)
    v_pk_add_f32 v[120:121], v[120:121], v[112:113]
    v_pk_add_f32 v[122:123], v[122:123], v[114:115]
    s_waitcnt vmcnt(1)
    v_pk_add_f32 v[120:121], v[120:121], v[116:117]
    v_pk_add_f32 v[122:123], v[122:123], v[118:119]
    v_cvt_pk_bf16_f32 v180, v120, v121
    v_pk_add_f32 v[124:125], v[120:121], v[122:123]
    v_cvt_pk_bf16_f32 v181, v122, v123
    v_cmpx_o_f32 vcc, v124, v125
    buffer_store_dwordx2 v[180:181], v11, s[4:7], s42 offen
    s_cmp_eq_u64 vcc, -1
    s_mov_b64 exec, -1
    s_cbranch_scc0 pq_56
    s_branch pg_54
pb_55:
    s_waitcnt vmcnt(2)
    v_pk_add_f32 v[120:121], v[88:89], v[108:109]
    v_pk_add_f32 v[122:123], v[90:91], v[110:111]
    s_waitcnt vmcnt(1)
    v_pk_add_f32 v[120:121], v[120:121], v[112:113]
    v_pk_add_f32 v[122:123], v[122:123], v[114:115]
    s_waitcnt vmcnt(0)
    v_pk_add_f32 v[120:121], v[120:121], v[116:117]
    v_pk_add_f32 v[122:123], v[122:123], v[118:119]
    v_cvt_pk_bf16_f32 v180, v120, v121
    v_pk_add_f32 v[124:125], v[120:121], v[122:123]
    v_cvt_pk_bf16_f32 v181, v122, v123
    v_cmpx_o_f32 vcc, v124, v125
    buffer_store_dwordx2 v[180:181], v11, s[4:7], s42 offen
    s_cmp_eq_u64 vcc, -1
    s_mov_b64 exec, -1
    s_cbranch_scc0 pq_56
    s_branch pg_54
pq_56:
    v_max3_u32 v19, v108, v109, v110
    v_max3_u32 v19, v19, v111, v112
    v_max3_u32 v19, v19, v113, v114
    v_max3_u32 v19, v19, v115, v116
    v_max3_u32 v19, v19, v117, v118
    v_max_u32 v19, v19, v119
    v_cmp_eq_u32 vcc, -1, v19
    s_nop 0
    s_cbranch_vccz pf_57
    buffer_load_dwordx4 v[108:111], v10, s[4:7], s22 offen sc1
    buffer_load_dwordx4 v[112:115], v23, s[4:7], s22 offen sc1
    buffer_load_dwordx4 v[116:119], v244, s[4:7], s22 offen sc1
    s_add_u32 s23, s23, 1
    s_cmp_lt_u32 s23, 200000
    s_cbranch_scc1 pb_55
    s_mov_b32 s25, 200000
pf_57:
    buffer_store_dwordx2 v[180:181], v11, s[4:7], s42 offen
    s_branch pg_54
.p2align 6
recur_slow_w0:
    s_nop 15
    s_mov_b32 s23, s25
g_58:
    buffer_load_dwordx4 v[24:27], v2, s[4:7], s16 offen offset:0 sc1
    buffer_load_dwordx4 v[28:31], v2, s[4:7], s16 offen offset:1024 sc1
    buffer_load_dwordx4 v[32:35], v2, s[4:7], s16 offen offset:2048 sc1
    buffer_load_dwordx4 v[36:39], v2, s[4:7], s16 offen offset:3072 sc1
    s_waitcnt vmcnt(0)
    v_max3_u32 v19, v24, v25, v26
    v_max3_u32 v19, v19, v27, v28
    v_max3_u32 v19, v19, v29, v30
    v_max3_u32 v19, v19, v31, v32
    v_max3_u32 v19, v19, v33, v34
    v_max3_u32 v19, v19, v35, v36
    v_max3_u32 v19, v19, v37, v38
    v_max_u32 v19, v19, v39
    v_cmp_eq_u32 vcc, -1, v19
    s_nop 0
    s_cbranch_vccz g_58k
    s_add_u32 s23, s23, 1
    s_cmp_lt_u32 s23, 200000
    s_cbranch_scc1 g_58
    s_mov_b32 s25, 200000
g_58k:
    v_smfmac_f32_16x16x64_bf16 v[40:43], v[24:27], a[0:7], v172
    v_smfmac_f32_16x16x64_bf16 v[44:47], v[24:27], a[64:71], v172
    v_smfmac_f32_16x16x64_bf16 v[48:51], v[24:27], a[32:39], v172
    v_smfmac_f32_16x16x64_bf16 v[52:55], v[24:27], a[96:103], v172
    v_smfmac_f32_16x16x64_bf16 v[40:43], v[28:31], a[8:15], v172
    v_smfmac_f32_16x16x64_bf16 v[44:47], v[28:31], a[72:79], v172
    v_smfmac_f32_16x16x64_bf16 v[48:51], v[28:31], a[40:47], v172
    v_smfmac_f32_16x16x64_bf16 v[52:55], v[28:31], a[104:111], v172
    v_smfmac_f32_16x16x64_bf16 v[40:43], v[32:35], a[16:23], v172
    v_smfmac_f32_16x16x64_bf16 v[44:47], v[32:35], a[80:87], v172
    v_smfmac_f32_16x16x64_bf16 v[48:51], v[32:35], a[48:55], v172
    v_smfmac_f32_16x16x64_bf16 v[52:55], v[32:35], a[112:119], v172
    v_smfmac_f32_16x16x64_bf16 v[40:43], v[36:39], a[24:31], v172
    v_smfmac_f32_16x16x64_bf16 v[44:47], v[36:39], a[88:95], v172
    v_smfmac_f32_16x16x64_bf16 v[48:51], v[36:39], a[56:63], v172
    v_smfmac_f32_16x16x64_bf16 v[52:55], v[36:39], a[120:127], v172
    v_cvt_pk_bf16_f32 v72, v40, v41
    v_cvt_pk_bf16_f32 v73, v42, v43
    v_cvt_pk_bf16_f32 v74, v44, v45
    v_cvt_pk_bf16_f32 v75, v46, v47
    v_smfmac_f32_16x16x64_bf16 v[56:59], v[24:27], a[128:135], v172
    v_cvt_pk_bf16_f32 v76, v48, v49
    v_cvt_pk_bf16_f32 v77, v50, v51
    s_nop 0
    v_cvt_pk_bf16_f32 v78, v52, v53
    v_cvt_pk_bf16_f32 v79, v54, v55
    v_smfmac_f32_16x16x64_bf16 v[60:63], v[24:27], a[160:167], v172
    v_mfma_f32_16x16x32_bf16 v[88:91], v[72:75], v[84:87], 0
    v_mfma_f32_16x16x32_bf16 v[92:95], v[76:79], v[84:87], 0
    v_smfmac_f32_16x16x64_bf16 v[56:59], v[28:31], a[136:143], v172
    v_smfmac_f32_16x16x64_bf16 v[60:63], v[28:31], a[168:175], v172
    s_barrier
    ds_read_b128 v[104:107], v16 offset:2048
    ds_read_b128 v[108:111], v16 offset:3072
    ds_read_b128 v[112:115], v16 offset:4096
    ds_read_b128 v[116:119], v16 offset:5120
    ds_read_b128 v[120:123], v16 offset:6144
    ds_read_b128 v[124:127], v16 offset:7168
    v_smfmac_f32_16x16x64_bf16 v[56:59], v[32:35], a[144:151], v172
    v_smfmac_f32_16x16x64_bf16 v[60:63], v[32:35], a[176:183], v172
    v_smfmac_f32_16x16x64_bf16 v[56:59], v[36:39], a[152:159], v172
    v_smfmac_f32_16x16x64_bf16 v[60:63], v[36:39], a[184:191], v172
    s_waitcnt lgkmcnt(5)
    v_mfma_f32_16x16x32_bf16 v[88:91], v[104:107], v[84:87], v[88:91]
    s_waitcnt lgkmcnt(4)
    v_mfma_f32_16x16x32_bf16 v[92:95], v[108:111], v[84:87], v[92:95]
    s_waitcnt lgkmcnt(3)
    v_mfma_f32_16x16x32_bf16 v[88:91], v[112:115], v[84:87], v[88:91]
    s_waitcnt lgkmcnt(2)
    v_mfma_f32_16x16x32_bf16 v[92:95], v[116:119], v[84:87], v[92:95]
    s_waitcnt lgkmcnt(1)
    v_mfma_f32_16x16x32_bf16 v[88:91], v[120:123], v[84:87], v[88:91]
    s_waitcnt lgkmcnt(0)
    v_mfma_f32_16x16x32_bf16 v[92:95], v[124:127], v[84:87], v[92:95]
    v_cvt_pk_bf16_f32 v80, v56, v57
    v_cvt_pk_bf16_f32 v81, v58, v59
    v_cvt_pk_bf16_f32 v82, v60, v61
    v_cvt_pk_bf16_f32 v83, v62, v63
    ds_write_b128 v17, v[80:83] offset:8192
    s_nop 0
    v_cvt_pk_bf16_f32 v128, v88, v89
    v_cvt_pk_bf16_f32 v129, v90, v91
    v_cvt_pk_bf16_f32 v130, v92, v93
    v_cvt_pk_bf16_f32 v131, v94, v95
    s_nop 1
    v_mfma_f32_16x16x32_bf16 v[144:147], v[132:135], v[128:131], 0
    v_mfma_f32_16x16x32_bf16 v[148:151], v[136:139], v[128:131], 0
    v_mfma_f32_16x16x32_bf16 v[140:143], v[128:131], v[128:131], 0
    s_nop 1
    buffer_store_dwordx4 v[144:147], v3, s[4:7], s16 offen sc1
    s_nop 1
    buffer_store_dwordx4 v[148:151], v3, s[4:7], s16 offen offset:128 sc1
    s_nop 1
    buffer_store_dwordx4 v[140:143], v4, s[4:7], s16 offen sc1
    s_cmp_eq_u32 s15, 63
    s_waitcnt lgkmcnt(0)
    s_barrier
    s_cbranch_scc1 recur_slow_last0
    v_readfirstlane_b32 s85, v247
    s_add_u32 s94, s15, 2
    s_barrier
    s_nop 15
    s_mov_b32 s23, s25
g_59:
    buffer_load_dwordx4 v[24:27], v8, s[4:7], s16 offen offset:0 sc1
    buffer_load_dwordx4 v[28:31], v8, s[4:7], s16 offen offset:1024 sc1
    buffer_load_dwordx4 v[32:35], v8, s[4:7], s16 offen offset:2048 sc1
    buffer_load_dwordx4 v[36:39], v8, s[4:7], s16 offen offset:3072 sc1
    s_waitcnt vmcnt(0)
    v_max3_u32 v19, v24, v25, v26
    v_max3_u32 v19, v19, v27, v28
    v_max3_u32 v19, v19, v29, v30
    v_max3_u32 v19, v19, v31, v32
    v_max3_u32 v19, v19, v33, v34
    v_max3_u32 v19, v19, v35, v36
    v_max3_u32 v19, v19, v37, v38
    v_max_u32 v19, v19, v39
    v_cmp_eq_u32 vcc, -1, v19
    s_nop 0
    s_cbranch_vccz g_59k
    s_add_u32 s23, s23, 1
    s_cmp_lt_u32 s23, 200000
    s_cbranch_scc1 g_59
    s_mov_b32 s25, 200000
g_59k:
    v_smfmac_f32_16x16x64_bf16 v[64:67], v[24:27], a[192:199], v172
    v_smfmac_f32_16x16x64_bf16 v[68:71], v[24:27], a[224:231], v172
    v_smfmac_f32_16x16x64_bf16 v[64:67], v[28:31], a[200:207], v172
    v_smfmac_f32_16x16x64_bf16 v[68:71], v[28:31], a[232:239], v172
    v_smfmac_f32_16x16x64_bf16 v[64:67], v[32:35], a[208:215], v172
    v_smfmac_f32_16x16x64_bf16 v[68:71], v[32:35], a[240:247], v172
    v_smfmac_f32_16x16x64_bf16 v[64:67], v[36:39], a[216:223], v172
    v_smfmac_f32_16x16x64_bf16 v[68:71], v[36:39], a[248:255], v172
    s_nop 4
    v_cvt_pk_bf16_f32 v80, v64, v65
    v_cvt_pk_bf16_f32 v81, v66, v67
    s_nop 0
    v_cvt_pk_bf16_f32 v82, v68, v69
    v_cvt_pk_bf16_f32 v83, v70, v71
    ds_write_b128 v17, v[80:83] offset:9216
    s_waitcnt lgkmcnt(0)
    s_barrier
    s_mov_b32 s23, s25
fw_60:
    s_cmp_ge_u32 s85, s94
    s_cbranch_scc1 fo_61
    buffer_load_dword v247, v245, s[4:7], 0 offen sc1
    s_add_u32 s23, s23, 1
    s_waitcnt vmcnt(0)
    v_readfirstlane_b32 s85, v247
    s_cmp_lt_u32 s23, 200000
    s_cbranch_scc1 fw_60
    s_mov_b32 s25, 200000
fo_61:
    buffer_load_dwordx4 v[132:135], v12, s[4:7], s17 offen sc1
    buffer_load_dwordx4 v[136:139], v12, s[4:7], s17 offen offset:128 sc1
    s_add_u32 s17, s17, 2048
    s_min_u32 s17, s17, 17954816
    s_nop 15
    s_nop 15
    s_nop 15
    s_nop 15
    buffer_store_dwordx4 v[128:131], v14, s[4:7], s19 offen sc1
    s_add_u32 s19, s19, 512
    s_add_u32 s21, s15, 3
    s_min_u32 s21, s21, 64
    s_cmp_lt_u32 s85, s21
    s_cselect_b64 exec, 1, 0
    buffer_load_dword v247, v245, s[4:7], 0 offen sc1
    s_mov_b64 exec, -1
    v_mov_b32 v40, 0
    v_mov_b32 v41, 0
    v_mov_b32 v42, 0
    v_mov_b32 v43, 0
    v_mov_b32 v44, 0
    v_mov_b32 v45, 0
    v_mov_b32 v46, 0
    v_mov_b32 v47, 0
    v_mov_b32 v48, 0
    v_mov_b32 v49, 0
    v_mov_b32 v50, 0
    v_mov_b32 v51, 0
    v_mov_b32 v52, 0
    v_mov_b32 v53, 0
    v_mov_b32 v54, 0
    v_mov_b32 v55, 0
    v_mov_b32 v56, 0
    v_mov_b32 v57, 0
    v_mov_b32 v58, 0
    v_mov_b32 v59, 0
    v_mov_b32 v60, 0
    v_mov_b32 v61, 0
    v_mov_b32 v62, 0
    v_mov_b32 v63, 0
    v_mov_b32 v64, 0
    v_mov_b32 v65, 0
    v_mov_b32 v66, 0
    v_mov_b32 v67, 0
    v_mov_b32 v68, 0
    v_mov_b32 v69, 0
    v_mov_b32 v70, 0
    v_mov_b32 v71, 0
    s_mov_b32 s21, s16
    s_mov_b32 s16, s42
    s_mov_b32 s42, s43
    s_mov_b32 s43, s44
    s_mov_b32 s44, s21
    s_add_u32 s95, s95, 524288
    s_lshr_b32 s84, s95, 8
    s_and_b32 s84, s84, 8192
    s_xor_b32 s84, s84, s46
    s_add_u32 s84, s84, s95
    s_add_u32 s15, s15, 1
    s_barrier
    s_branch recur_slow_w0
recur_slow_last0:
    buffer_store_dwordx4 v[128:131], v14, s[4:7], s19 offen sc1
    s_waitcnt vmcnt(0)
    s_branch recur_end
.p2align 6
recur_slow_w1:
    s_nop 15
    s_mov_b32 s23, s25
g_62:
    buffer_load_dwordx4 v[24:27], v2, s[4:7], s16 offen offset:0 sc1
    buffer_load_dwordx4 v[28:31], v2, s[4:7], s16 offen offset:1024 sc1
    buffer_load_dwordx4 v[32:35], v2, s[4:7], s16 offen offset:2048 sc1
    buffer_load_dwordx4 v[36:39], v2, s[4:7], s16 offen offset:3072 sc1
    s_waitcnt vmcnt(0)
    v_max3_u32 v19, v24, v25, v26
    v_max3_u32 v19, v19, v27, v28
    v_max3_u32 v19, v19, v29, v30
    v_max3_u32 v19, v19, v31, v32
    v_max3_u32 v19, v19, v33, v34
    v_max3_u32 v19, v19, v35, v36
    v_max3_u32 v19, v19, v37, v38
    v_max_u32 v19, v19, v39
    v_cmp_eq_u32 vcc, -1, v19
    s_nop 0
    s_cbranch_vccz g_62k
    s_add_u32 s23, s23, 1
    s_cmp_lt_u32 s23, 200000
    s_cbranch_scc1 g_62
    s_mov_b32 s25, 200000
g_62k:
    v_smfmac_f32_16x16x64_bf16 v[40:43], v[24:27], a[0:7], v172
    v_smfmac_f32_16x16x64_bf16 v[44:47], v[24:27], a[64:71], v172
    v_smfmac_f32_16x16x64_bf16 v[48:51], v[24:27], a[32:39], v172
    v_smfmac_f32_16x16x64_bf16 v[52:55], v[24:27], a[96:103], v172
    v_smfmac_f32_16x16x64_bf16 v[40:43], v[28:31], a[8:15], v172
    v_smfmac_f32_16x16x64_bf16 v[44:47], v[28:31], a[72:79], v172
    v_smfmac_f32_16x16x64_bf16 v[48:51], v[28:31], a[40:47], v172
    v_smfmac_f32_16x16x64_bf16 v[52:55], v[28:31], a[104:111], v172
    v_smfmac_f32_16x16x64_bf16 v[40:43], v[32:35], a[16:23], v172
    v_smfmac_f32_16x16x64_bf16 v[44:47], v[32:35], a[80:87], v172
    v_smfmac_f32_16x16x64_bf16 v[48:51], v[32:35], a[48:55], v172
    v_smfmac_f32_16x16x64_bf16 v[52:55], v[32:35], a[112:119], v172
    v_smfmac_f32_16x16x64_bf16 v[40:43], v[36:39], a[24:31], v172
    v_smfmac_f32_16x16x64_bf16 v[44:47], v[36:39], a[88:95], v172
    v_smfmac_f32_16x16x64_bf16 v[48:51], v[36:39], a[56:63], v172
    v_smfmac_f32_16x16x64_bf16 v[52:55], v[36:39], a[120:127], v172
    v_cvt_pk_bf16_f32 v72, v40, v41
    v_cvt_pk_bf16_f32 v73, v42, v43
    v_cvt_pk_bf16_f32 v74, v44, v45
    v_cvt_pk_bf16_f32 v75, v46, v47
    ds_write_b128 v17, v[72:75] offset:0
    v_cvt_pk_bf16_f32 v76, v48, v49
    v_cvt_pk_bf16_f32 v77, v50, v51
    s_nop 0
    v_cvt_pk_bf16_f32 v78, v52, v53
    v_cvt_pk_bf16_f32 v79, v54, v55
    ds_write_b128 v17, v[76:79] offset:1024
    v_smfmac_f32_16x16x64_bf16 v[56:59], v[24:27], a[128:135], v172
    v_smfmac_f32_16x16x64_bf16 v[60:63], v[24:27], a[160:167], v172
    v_smfmac_f32_16x16x64_bf16 v[56:59], v[28:31], a[136:143], v172
    s_waitcnt lgkmcnt(0)
    s_barrier
    v_smfmac_f32_16x16x64_bf16 v[60:63], v[28:31], a[168:175], v172
    v_smfmac_f32_16x16x64_bf16 v[56:59], v[32:35], a[144:151], v172
    v_smfmac_f32_16x16x64_bf16 v[60:63], v[32:35], a[176:183], v172
    v_smfmac_f32_16x16x64_bf16 v[56:59], v[36:39], a[152:159], v172
    v_smfmac_f32_16x16x64_bf16 v[60:63], v[36:39], a[184:191], v172
    s_nop 4
    v_cvt_pk_bf16_f32 v80, v56, v57
    v_cvt_pk_bf16_f32 v81, v58, v59
    s_nop 0
    v_cvt_pk_bf16_f32 v82, v60, v61
    v_cvt_pk_bf16_f32 v83, v62, v63
    ds_write_b128 v17, v[80:83] offset:8192
    v_mov_b32 v152, v228
    v_mov_b32 v153, v229
    v_mov_b32 v156, v230
    v_mov_b32 v157, v231
    v_mov_b32 v160, v232
    v_mov_b32 v161, v233
    v_mov_b32 v164, v234
    v_mov_b32 v165, v235
    s_cmp_eq_u32 s15, 63
    s_waitcnt lgkmcnt(0)
    s_barrier
    s_cbranch_scc1 recur_end
    s_nop 15
    s_nop 15
    s_nop 7
    buffer_load_dwordx4 v[208:211], v5, s[4:7], s16 offen offset:0 sc1
    buffer_load_dwordx4 v[212:215], v5, s[4:7], s16 offen offset:1024 sc1
    buffer_load_dwordx4 v[216:219], v5, s[4:7], s16 offen offset:2048 sc1
    buffer_load_dwordx4 v[220:223], v5, s[4:7], s16 offen offset:3072 sc1
    buffer_load_dword v224, v6, s[4:7], s16 offen offset:0 sc1
    buffer_load_dword v225, v6, s[4:7], s16 offen offset:256 sc1
    buffer_load_dword v226, v6, s[4:7], s16 offen offset:512 sc1
    buffer_load_dword v227, v6, s[4:7], s16 offen offset:768 sc1
    s_mov_b32 s23, s25
    ds_read_b128 v[96:99], v16 offset:8192
    ds_read_b128 v[104:107], v16 offset:12288
    ds_read_b128 v[108:111], v16 offset:14336
    v_mfma_f32_16x16x32_bf16 v[140:143], v[84:87], v[80:83], 0
    s_waitcnt lgkmcnt(2)
    v_mfma_f32_16x16x32_bf16 v[140:143], v[84:87], v[96:99], v[140:143]
    s_waitcnt lgkmcnt(1)
    v_mfma_f32_16x16x32_bf16 v[140:143], v[84:87], v[104:107], v[140:143]
    s_waitcnt lgkmcnt(0)
    v_mfma_f32_16x16x32_bf16 v[140:143], v[84:87], v[108:111], v[140:143]
    buffer_load_dwordx4 v[24:27], v5, s[4:7], s16 offen offset:0 sc1
    buffer_load_dwordx4 v[28:31], v5, s[4:7], s16 offen offset:1024 sc1
    buffer_load_dwordx4 v[32:35], v5, s[4:7], s16 offen offset:2048 sc1
    buffer_load_dwordx4 v[36:39], v5, s[4:7], s16 offen offset:3072 sc1
    buffer_load_dword v40, v6, s[4:7], s16 offen offset:0 sc1
    buffer_load_dword v41, v6, s[4:7], s16 offen offset:256 sc1
    buffer_load_dword v42, v6, s[4:7], s16 offen offset:512 sc1
    buffer_load_dword v43, v6, s[4:7], s16 offen offset:768 sc1
    v_cvt_pk_bf16_f32 v154, v140, v179
    v_cvt_pk_bf16_f32 v158, v141, v179
    v_cvt_pk_bf16_f32 v162, v142, v179
    v_cvt_pk_bf16_f32 v166, v143, v179
    s_waitcnt vmcnt(14)
    v_pk_add_f32 v[180:181], v[208:209], v[212:213]
    v_pk_add_f32 v[182:183], v[210:211], v[214:215]
    s_waitcnt vmcnt(12)
    v_pk_add_f32 v[188:189], v[216:217], v[220:221]
    v_pk_add_f32 v[190:191], v[218:219], v[222:223]
    v_pk_add_f32 v[180:181], v[180:181], v[188:189]
    v_pk_add_f32 v[182:183], v[182:183], v[190:191]
    v_pk_add_f32 v[188:189], v[180:181], v[182:183]
    v_max3_f32 v185, v180, v181, v182
    s_waitcnt vmcnt(8)
    v_pk_add_f32 v[192:193], v[224:225], v[226:227]
    v_add_f32 v188, v188, v189
    v_add_f32 v184, v192, v193
    v_max3_f32 v185, v185, v183, v184
    v_cmp_u_f32 vcc, v188, v184
    s_nop 0
    v_max_f32_dpp v185, v185, v185 row_ror:8 row_mask:0xf bank_mask:0xf
    v_mov_b32 v186, v185
    s_nop 1
    v_permlane16_swap_b32 v185, v186
    v_max_f32 v185, v185, v186
    v_mov_b32 v186, v185
    s_cbranch_vccnz ss_63r
sg_65:
    s_nop 0
    v_permlane32_swap_b32 v185, v186
    v_max_f32 v185, v185, v186
    v_mul_f32 v185, s24, v185
    v_fma_f32 v180, v180, s24, -v185
    v_fma_f32 v181, v181, s24, -v185
    v_fma_f32 v182, v182, s24, -v185
    v_fma_f32 v183, v183, s24, -v185
    v_fma_f32 v184, v184, s24, -v185
    v_exp_f32 v180, v180
    v_exp_f32 v181, v181
    v_exp_f32 v182, v182
    v_exp_f32 v183, v183
    v_exp_f32 v184, v184
    v_cvt_pk_bf16_f32 v176, v180, v181
    v_cvt_pk_bf16_f32 v177, v182, v183
    v_cvt_pk_bf16_f32 v178, v184, v179
    s_nop 1
    v_mfma_f32_16x16x32_bf16 v[240:243], v[236:239], v[176:179], 0
    v_mfma_f32_16x16x32_bf16 v[188:191], v[152:155], v[176:179], 0
    v_mfma_f32_16x16x32_bf16 v[192:195], v[156:159], v[176:179], 0
    v_mfma_f32_16x16x32_bf16 v[196:199], v[160:163], v[176:179], 0
    v_mfma_f32_16x16x32_bf16 v[200:203], v[164:167], v[176:179], 0
    v_add_f32_dpp v185, v240, v240 row_ror:8 row_mask:0xf bank_mask:0xf
    v_rcp_f32 v185, v185
    v_add_f32_dpp v88, v192, v188 row_ror:8 row_mask:0xf bank_mask:0x3
    v_add_f32_dpp v89, v193, v189 row_ror:8 row_mask:0xf bank_mask:0x3
    v_add_f32_dpp v90, v194, v190 row_ror:8 row_mask:0xf bank_mask:0x3
    v_add_f32_dpp v91, v195, v191 row_ror:8 row_mask:0xf bank_mask:0x3
    s_nop 1
    v_add_f32_dpp v88, v196, v200 row_ror:8 row_mask:0xf bank_mask:0xc
    v_add_f32_dpp v89, v197, v201 row_ror:8 row_mask:0xf bank_mask:0xc
    v_add_f32_dpp v90, v198, v202 row_ror:8 row_mask:0xf bank_mask:0xc
    v_add_f32_dpp v91, v199, v203 row_ror:8 row_mask:0xf bank_mask:0xc
    v_mul_f32 v88, v88, v185
    v_mul_f32 v89, v89, v185
    v_mul_f32 v90, v90, v185
    v_mul_f32 v91, v91, v185
    v_cvt_pk_bf16_f32 v88, v88, v89
    v_cvt_pk_bf16_f32 v89, v90, v91
    buffer_store_dwordx2 v[88:89], v7, s[4:7], s16 offen sc1
    v_readfirstlane_b32 s85, v247
    s_add_u32 s94, s15, 2
    s_barrier
    s_nop 15
    s_mov_b32 s23, s25
g_66:
    buffer_load_dwordx4 v[24:27], v8, s[4:7], s16 offen offset:0 sc1
    buffer_load_dwordx4 v[28:31], v8, s[4:7], s16 offen offset:1024 sc1
    buffer_load_dwordx4 v[32:35], v8, s[4:7], s16 offen offset:2048 sc1
    buffer_load_dwordx4 v[36:39], v8, s[4:7], s16 offen offset:3072 sc1
    s_waitcnt vmcnt(0)
    v_max3_u32 v19, v24, v25, v26
    v_max3_u32 v19, v19, v27, v28
    v_max3_u32 v19, v19, v29, v30
    v_max3_u32 v19, v19, v31, v32
    v_max3_u32 v19, v19, v33, v34
    v_max3_u32 v19, v19, v35, v36
    v_max3_u32 v19, v19, v37, v38
    v_max_u32 v19, v19, v39
    v_cmp_eq_u32 vcc, -1, v19
    s_nop 0
    s_cbranch_vccz g_66k
    s_add_u32 s23, s23, 1
    s_cmp_lt_u32 s23, 200000
    s_cbranch_scc1 g_66
    s_mov_b32 s25, 200000
g_66k:
    v_smfmac_f32_16x16x64_bf16 v[64:67], v[24:27], a[192:199], v172
    v_smfmac_f32_16x16x64_bf16 v[68:71], v[24:27], a[224:231], v172
    v_smfmac_f32_16x16x64_bf16 v[64:67], v[28:31], a[200:207], v172
    v_smfmac_f32_16x16x64_bf16 v[68:71], v[28:31], a[232:239], v172
    v_smfmac_f32_16x16x64_bf16 v[64:67], v[32:35], a[208:215], v172
    v_smfmac_f32_16x16x64_bf16 v[68:71], v[32:35], a[240:247], v172
    v_smfmac_f32_16x16x64_bf16 v[64:67], v[36:39], a[216:223], v172
    v_smfmac_f32_16x16x64_bf16 v[68:71], v[36:39], a[248:255], v172
    s_nop 4
    v_cvt_pk_bf16_f32 v80, v64, v65
    v_cvt_pk_bf16_f32 v81, v66, v67
    s_nop 0
    v_cvt_pk_bf16_f32 v82, v68, v69
    v_cvt_pk_bf16_f32 v83, v70, v71
    ds_write_b128 v17, v[80:83] offset:9216
    s_waitcnt lgkmcnt(0)
    s_barrier
    s_mov_b32 s23, s25
fw_67:
    s_cmp_ge_u32 s85, s94
    s_cbranch_scc1 fo_68
    buffer_load_dword v247, v245, s[4:7], 0 offen sc1
    s_add_u32 s23, s23, 1
    s_waitcnt vmcnt(0)
    v_readfirstlane_b32 s85, v247
    s_cmp_lt_u32 s23, 200000
    s_cbranch_scc1 fw_67
    s_mov_b32 s25, 200000
fo_68:
    buffer_load_dwordx4 v[228:231], v13, s[4:7], s18 offen offset:0 sc1
    buffer_load_dwordx4 v[232:235], v13, s[4:7], s18 offen offset:128 sc1
    s_add_u32 s18, s18, 2048
    s_min_u32 s18, s18, 35780608
    s_nop 15
    s_nop 15
    s_nop 15
    s_nop 15
    s_add_u32 s21, s15, 3
    s_min_u32 s21, s21, 64
    s_cmp_lt_u32 s85, s21
    s_cselect_b64 exec, 1, 0
    buffer_load_dword v247, v245, s[4:7], 0 offen sc1
    s_mov_b64 exec, -1
    v_mov_b32 v40, 0
    v_mov_b32 v41, 0
    v_mov_b32 v42, 0
    v_mov_b32 v43, 0
    v_mov_b32 v44, 0
    v_mov_b32 v45, 0
    v_mov_b32 v46, 0
    v_mov_b32 v47, 0
    v_mov_b32 v48, 0
    v_mov_b32 v49, 0
    v_mov_b32 v50, 0
    v_mov_b32 v51, 0
    v_mov_b32 v52, 0
    v_mov_b32 v53, 0
    v_mov_b32 v54, 0
    v_mov_b32 v55, 0
    v_mov_b32 v56, 0
    v_mov_b32 v57, 0
    v_mov_b32 v58, 0
    v_mov_b32 v59, 0
    v_mov_b32 v60, 0
    v_mov_b32 v61, 0
    v_mov_b32 v62, 0
    v_mov_b32 v63, 0
    v_mov_b32 v64, 0
    v_mov_b32 v65, 0
    v_mov_b32 v66, 0
    v_mov_b32 v67, 0
    v_mov_b32 v68, 0
    v_mov_b32 v69, 0
    v_mov_b32 v70, 0
    v_mov_b32 v71, 0
    s_mov_b32 s21, s16
    s_mov_b32 s16, s42
    s_mov_b32 s42, s43
    s_mov_b32 s43, s44
    s_mov_b32 s44, s21
    s_add_u32 s95, s95, 524288
    s_lshr_b32 s84, s95, 8
    s_and_b32 s84, s84, 8192
    s_xor_b32 s84, s84, s46
    s_add_u32 s84, s84, s95
    s_add_u32 s15, s15, 1
    s_barrier
    s_branch recur_slow_w1
ss_63r:
    buffer_load_dwordx4 v[208:211], v5, s[4:7], s16 offen offset:0 sc1
    buffer_load_dwordx4 v[212:215], v5, s[4:7], s16 offen offset:1024 sc1
    buffer_load_dwordx4 v[216:219], v5, s[4:7], s16 offen offset:2048 sc1
    buffer_load_dwordx4 v[220:223], v5, s[4:7], s16 offen offset:3072 sc1
    buffer_load_dword v224, v6, s[4:7], s16 offen offset:0 sc1
    buffer_load_dword v225, v6, s[4:7], s16 offen offset:256 sc1
    buffer_load_dword v226, v6, s[4:7], s16 offen offset:512 sc1
    buffer_load_dword v227, v6, s[4:7], s16 offen offset:768 sc1
    s_waitcnt vmcnt(14)
    v_pk_add_f32 v[180:181], v[24:25], v[28:29]
    v_pk_add_f32 v[182:183], v[26:27], v[30:31]
    s_waitcnt vmcnt(12)
    v_pk_add_f32 v[188:189], v[32:33], v[36:37]
    v_pk_add_f32 v[190:191], v[34:35], v[38:39]
    v_pk_add_f32 v[180:181], v[180:181], v[188:189]
    v_pk_add_f32 v[182:183], v[182:183], v[190:191]
    v_pk_add_f32 v[188:189], v[180:181], v[182:183]
    v_max3_f32 v185, v180, v181, v182
    s_waitcnt vmcnt(8)
    v_pk_add_f32 v[192:193], v[40:41], v[42:43]
    v_add_f32 v188, v188, v189
    v_add_f32 v184, v192, v193
    v_max3_f32 v185, v185, v183, v184
    v_cmp_u_f32 vcc, v188, v184
    s_nop 0
    v_max_f32_dpp v185, v185, v185 row_ror:8 row_mask:0xf bank_mask:0xf
    v_mov_b32 v186, v185
    s_nop 1
    v_permlane16_swap_b32 v185, v186
    v_max_f32 v185, v185, v186
    v_mov_b32 v186, v185
    s_cbranch_vccz sg_65
    buffer_load_dwordx4 v[24:27], v5, s[4:7], s16 offen offset:0 sc1
    buffer_load_dwordx4 v[28:31], v5, s[4:7], s16 offen offset:1024 sc1
    buffer_load_dwordx4 v[32:35], v5, s[4:7], s16 offen offset:2048 sc1
    buffer_load_dwordx4 v[36:39], v5, s[4:7], s16 offen offset:3072 sc1
    buffer_load_dword v40, v6, s[4:7], s16 offen offset:0 sc1
    buffer_load_dword v41, v6, s[4:7], s16 offen offset:256 sc1
    buffer_load_dword v42, v6, s[4:7], s16 offen offset:512 sc1
    buffer_load_dword v43, v6, s[4:7], s16 offen offset:768 sc1
    s_waitcnt vmcnt(14)
    v_pk_add_f32 v[180:181], v[208:209], v[212:213]
    v_pk_add_f32 v[182:183], v[210:211], v[214:215]
    s_waitcnt vmcnt(12)
    v_pk_add_f32 v[188:189], v[216:217], v[220:221]
    v_pk_add_f32 v[190:191], v[218:219], v[222:223]
    v_pk_add_f32 v[180:181], v[180:181], v[188:189]
    v_pk_add_f32 v[182:183], v[182:183], v[190:191]
    v_pk_add_f32 v[188:189], v[180:181], v[182:183]
    v_max3_f32 v185, v180, v181, v182
    s_waitcnt vmcnt(8)
    v_pk_add_f32 v[192:193], v[224:225], v[226:227]
    v_add_f32 v188, v188, v189
    v_add_f32 v184, v192, v193
    v_max3_f32 v185, v185, v183, v184
    v_cmp_u_f32 vcc, v188, v184
    s_nop 0
    v_max_f32_dpp v185, v185, v185 row_ror:8 row_mask:0xf bank_mask:0xf
    v_mov_b32 v186, v185
    s_nop 1
    v_permlane16_swap_b32 v185, v186
    v_max_f32 v185, v185, v186
    v_mov_b32 v186, v185
    s_cbranch_vccz sg_65
    s_branch ss_63
sb_64:
    v_max3_u32 v19, v24, v25, v26
    v_max3_u32 v19, v19, v27, v28
    v_max3_u32 v19, v19, v29, v30
    v_max3_u32 v19, v19, v31, v32
    v_max3_u32 v19, v19, v33, v34
    v_max3_u32 v19, v19, v35, v36
    v_max3_u32 v19, v19, v37, v38
    v_max3_u32 v19, v19, v39, v40
    v_max3_u32 v19, v19, v41, v42
    v_max_u32 v19, v19, v43
    v_cmp_eq_u32 vcc, -1, v19
    s_nop 0
    s_cbranch_vccz sg_65
    buffer_load_dwordx4 v[24:27], v5, s[4:7], s16 offen offset:0 sc1
    buffer_load_dwordx4 v[28:31], v5, s[4:7], s16 offen offset:1024 sc1
    buffer_load_dwordx4 v[32:35], v5, s[4:7], s16 offen offset:2048 sc1
    buffer_load_dwordx4 v[36:39], v5, s[4:7], s16 offen offset:3072 sc1
    buffer_load_dword v40, v6, s[4:7], s16 offen offset:0 sc1
    buffer_load_dword v41, v6, s[4:7], s16 offen offset:256 sc1
    buffer_load_dword v42, v6, s[4:7], s16 offen offset:512 sc1
    buffer_load_dword v43, v6, s[4:7], s16 offen offset:768 sc1
    s_add_u32 s23, s23, 1
    s_cmp_lt_u32 s23, 200000
    s_cbranch_scc1 ss_63
    s_mov_b32 s25, 200000
    s_branch sg_65
ss_63:
    s_waitcnt vmcnt(6)
    v_pk_add_f32 v[180:181], v[24:25], v[28:29]
    v_pk_add_f32 v[182:183], v[26:27], v[30:31]
    s_waitcnt vmcnt(4)
    v_pk_add_f32 v[188:189], v[32:33], v[36:37]
    v_pk_add_f32 v[190:191], v[34:35], v[38:39]
    v_pk_add_f32 v[180:181], v[180:181], v[188:189]
    v_pk_add_f32 v[182:183], v[182:183], v[190:191]
    v_pk_add_f32 v[188:189], v[180:181], v[182:183]
    v_max3_f32 v185, v180, v181, v182
    s_waitcnt vmcnt(0)
    v_pk_add_f32 v[192:193], v[40:41], v[42:43]
    v_add_f32 v188, v188, v189
    v_add_f32 v184, v192, v193
    v_max3_f32 v185, v185, v183, v184
    v_cmp_u_f32 vcc, v188, v184
    s_nop 0
    v_max_f32_dpp v185, v185, v185 row_ror:8 row_mask:0xf bank_mask:0xf
    v_mov_b32 v186, v185
    s_nop 1
    v_permlane16_swap_b32 v185, v186
    v_max_f32 v185, v185, v186
    v_mov_b32 v186, v185
    s_cbranch_vccnz sb_64
    s_branch sg_65
.p2align 6
recur_slow_w2:
    s_nop 15
    s_mov_b32 s23, s25
g_69:
    buffer_load_dwordx4 v[24:27], v2, s[4:7], s16 offen offset:0 sc1
    buffer_load_dwordx4 v[28:31], v2, s[4:7], s16 offen offset:1024 sc1
    buffer_load_dwordx4 v[32:35], v2, s[4:7], s16 offen offset:2048 sc1
    buffer_load_dwordx4 v[36:39], v2, s[4:7], s16 offen offset:3072 sc1
    s_waitcnt vmcnt(0)
    v_max3_u32 v19, v24, v25, v26
    v_max3_u32 v19, v19, v27, v28
    v_max3_u32 v19, v19, v29, v30
    v_max3_u32 v19, v19, v31, v32
    v_max3_u32 v19, v19, v33, v34
    v_max3_u32 v19, v19, v35, v36
    v_max3_u32 v19, v19, v37, v38
    v_max_u32 v19, v19, v39
    v_cmp_eq_u32 vcc, -1, v19
    s_nop 0
    s_cbranch_vccz g_69k
    s_add_u32 s23, s23, 1
    s_cmp_lt_u32 s23, 200000
    s_cbranch_scc1 g_69
    s_mov_b32 s25, 200000
g_69k:
    v_smfmac_f32_16x16x64_bf16 v[40:43], v[24:27], a[0:7], v172
    v_smfmac_f32_16x16x64_bf16 v[44:47], v[24:27], a[64:71], v172
    v_smfmac_f32_16x16x64_bf16 v[48:51], v[24:27], a[32:39], v172
    v_smfmac_f32_16x16x64_bf16 v[52:55], v[24:27], a[96:103], v172
    v_smfmac_f32_16x16x64_bf16 v[40:43], v[28:31], a[8:15], v172
    v_smfmac_f32_16x16x64_bf16 v[44:47], v[28:31], a[72:79], v172
    v_smfmac_f32_16x16x64_bf16 v[48:51], v[28:31], a[40:47], v172
    v_smfmac_f32_16x16x64_bf16 v[52:55], v[28:31], a[104:111], v172
    v_smfmac_f32_16x16x64_bf16 v[40:43], v[32:35], a[16:23], v172
    v_smfmac_f32_16x16x64_bf16 v[44:47], v[32:35], a[80:87], v172
    v_smfmac_f32_16x16x64_bf16 v[48:51], v[32:35], a[48:55], v172
    v_smfmac_f32_16x16x64_bf16 v[52:55], v[32:35], a[112:119], v172
    v_smfmac_f32_16x16x64_bf16 v[40:43], v[36:39], a[24:31], v172
    v_smfmac_f32_16x16x64_bf16 v[44:47], v[36:39], a[88:95], v172
    v_smfmac_f32_16x16x64_bf16 v[48:51], v[36:39], a[56:63], v172
    v_smfmac_f32_16x16x64_bf16 v[52:55], v[36:39], a[120:127], v172
    v_cvt_pk_bf16_f32 v72, v40, v41
    v_cvt_pk_bf16_f32 v73, v42, v43
    v_cvt_pk_bf16_f32 v74, v44, v45
    v_cvt_pk_bf16_f32 v75, v46, v47
    ds_write_b128 v17, v[72:75] offset:0
    v_cvt_pk_bf16_f32 v76, v48, v49
    v_cvt_pk_bf16_f32 v77, v50, v51
    s_nop 0
    v_cvt_pk_bf16_f32 v78, v52, v53
    v_cvt_pk_bf16_f32 v79, v54, v55
    ds_write_b128 v17, v[76:79] offset:1024
    v_smfmac_f32_16x16x64_bf16 v[56:59], v[24:27], a[128:135], v172
    v_smfmac_f32_16x16x64_bf16 v[60:63], v[24:27], a[160:167], v172
    v_smfmac_f32_16x16x64_bf16 v[56:59], v[28:31], a[136:143], v172
    s_waitcnt lgkmcnt(0)
    s_barrier
    v_smfmac_f32_16x16x64_bf16 v[60:63], v[28:31], a[168:175], v172
    v_smfmac_f32_16x16x64_bf16 v[56:59], v[32:35], a[144:151], v172
    v_smfmac_f32_16x16x64_bf16 v[60:63], v[32:35], a[176:183], v172
    v_smfmac_f32_16x16x64_bf16 v[56:59], v[36:39], a[152:159], v172
    v_smfmac_f32_16x16x64_bf16 v[60:63], v[36:39], a[184:191], v172
    s_nop 4
    v_cvt_pk_bf16_f32 v80, v56, v57
    v_cvt_pk_bf16_f32 v81, v58, v59
    s_nop 0
    v_cvt_pk_bf16_f32 v82, v60, v61
    v_cvt_pk_bf16_f32 v83, v62, v63
    ds_write_b128 v17, v[80:83] offset:8192
    s_cmp_eq_u32 s15, 63
    s_waitcnt lgkmcnt(0)
    s_barrier
    ds_read_b128 v[96:99], v16 offset:8192
    ds_read_b128 v[100:103], v16 offset:10240
    ds_read_b128 v[108:111], v16 offset:14336
    v_mfma_f32_16x16x32_bf16 v[140:143], v[84:87], v[80:83], 0
    s_waitcnt lgkmcnt(2)
    v_mfma_f32_16x16x32_bf16 v[140:143], v[84:87], v[96:99], v[140:143]
    s_waitcnt lgkmcnt(1)
    v_mfma_f32_16x16x32_bf16 v[140:143], v[84:87], v[100:103], v[140:143]
    s_waitcnt lgkmcnt(0)
    v_mfma_f32_16x16x32_bf16 v[140:143], v[84:87], v[108:111], v[140:143]
    s_nop 7
    v_cvt_pk_bf16_f32 v168, v140, v141
    v_cvt_pk_bf16_f32 v169, v142, v143
    v_mov_b32 v170, v168
    v_mov_b32 v171, v169
    s_nop 0
    v_permlane16_swap_b32 v168, v170
    v_permlane16_swap_b32 v169, v171
    v_mov_b32 v247, s15
    s_cbranch_scc1 recur_slow_last2
    s_barrier
    s_nop 15
    s_mov_b32 s23, s25
g_70:
    buffer_load_dwordx4 v[24:27], v8, s[4:7], s16 offen offset:0 sc1
    buffer_load_dwordx4 v[28:31], v8, s[4:7], s16 offen offset:1024 sc1
    buffer_load_dwordx4 v[32:35], v8, s[4:7], s16 offen offset:2048 sc1
    buffer_load_dwordx4 v[36:39], v8, s[4:7], s16 offen offset:3072 sc1
    s_waitcnt vmcnt(0)
    v_max3_u32 v19, v24, v25, v26
    v_max3_u32 v19, v19, v27, v28
    v_max3_u32 v19, v19, v29, v30
    v_max3_u32 v19, v19, v31, v32
    v_max3_u32 v19, v19, v33, v34
    v_max3_u32 v19, v19, v35, v36
    v_max3_u32 v19, v19, v37, v38
    v_max_u32 v19, v19, v39
    v_cmp_eq_u32 vcc, -1, v19
    s_nop 0
    s_cbranch_vccz g_70k
    s_add_u32 s23, s23, 1
    s_cmp_lt_u32 s23, 200000
    s_cbranch_scc1 g_70
    s_mov_b32 s25, 200000
g_70k:
    v_smfmac_f32_16x16x64_bf16 v[64:67], v[24:27], a[192:199], v172
    v_smfmac_f32_16x16x64_bf16 v[68:71], v[24:27], a[224:231], v172
    v_smfmac_f32_16x16x64_bf16 v[64:67], v[28:31], a[200:207], v172
    v_smfmac_f32_16x16x64_bf16 v[68:71], v[28:31], a[232:239], v172
    v_smfmac_f32_16x16x64_bf16 v[64:67], v[32:35], a[208:215], v172
    v_smfmac_f32_16x16x64_bf16 v[68:71], v[32:35], a[240:247], v172
    v_smfmac_f32_16x16x64_bf16 v[64:67], v[36:39], a[216:223], v172
    v_smfmac_f32_16x16x64_bf16 v[68:71], v[36:39], a[248:255], v172
    s_nop 4
    v_cvt_pk_bf16_f32 v80, v64, v65
    v_cvt_pk_bf16_f32 v81, v66, v67
    s_nop 0
    v_cvt_pk_bf16_f32 v82, v68, v69
    v_cvt_pk_bf16_f32 v83, v70, v71
    ds_write_b128 v17, v[80:83] offset:9216
    s_waitcnt lgkmcnt(0)
    s_barrier
    s_nop 15
    s_nop 15
    s_nop 15
    s_nop 15
    buffer_store_dwordx4 v[168:171], v15, s[4:7], s20 offen sc1
    s_add_u32 s20, s20, 512
    s_add_u32 s21, s95, 1048576
    s_lshr_b32 s22, s21, 8
    s_and_b32 s22, s22, 8192
    s_xor_b32 s22, s22, s46
    s_add_u32 s21, s21, s22
    buffer_store_dwordx4 v[204:207], v9, s[4:7], s21 offen sc1
    s_add_u32 s21, s21, 262144
    buffer_store_dwordx4 v[204:207], v9, s[4:7], s21 offen sc1
    buffer_store_dword v247, v246, s[4:7], 0 offen sc1
    v_mov_b32 v40, 0
    v_mov_b32 v41, 0
    v_mov_b32 v42, 0
    v_mov_b32 v43, 0
    v_mov_b32 v44, 0
    v_mov_b32 v45, 0
    v_mov_b32 v46, 0
    v_mov_b32 v47, 0
    v_mov_b32 v48, 0
    v_mov_b32 v49, 0
    v_mov_b32 v50, 0
    v_mov_b32 v51, 0
    v_mov_b32 v52, 0
    v_mov_b32 v53, 0
    v_mov_b32 v54, 0
    v_mov_b32 v55, 0
    v_mov_b32 v56, 0
    v_mov_b32 v57, 0
    v_mov_b32 v58, 0
    v_mov_b32 v59, 0
    v_mov_b32 v60, 0
    v_mov_b32 v61, 0
    v_mov_b32 v62, 0
    v_mov_b32 v63, 0
    v_mov_b32 v64, 0
    v_mov_b32 v65, 0
    v_mov_b32 v66, 0
    v_mov_b32 v67, 0
    v_mov_b32 v68, 0
    v_mov_b32 v69, 0
    v_mov_b32 v70, 0
    v_mov_b32 v71, 0
    s_mov_b32 s21, s16
    s_mov_b32 s16, s42
    s_mov_b32 s42, s43
    s_mov_b32 s43, s44
    s_mov_b32 s44, s21
    s_add_u32 s95, s95, 524288
    s_lshr_b32 s84, s95, 8
    s_and_b32 s84, s84, 8192
    s_xor_b32 s84, s84, s46
    s_add_u32 s84, s84, s95
    s_add_u32 s15, s15, 1
    s_barrier
    s_branch recur_slow_w2
recur_slow_last2:
    buffer_store_dwordx4 v[168:171], v15, s[4:7], s20 offen sc1
    s_waitcnt vmcnt(0)
    s_branch recur_end
.p2align 6
recur_slow_w3:
    s_nop 15
    s_mov_b32 s23, s25
g_71:
    buffer_load_dwordx4 v[24:27], v2, s[4:7], s16 offen offset:0 sc1
    buffer_load_dwordx4 v[28:31], v2, s[4:7], s16 offen offset:1024 sc1
    buffer_load_dwordx4 v[32:35], v2, s[4:7], s16 offen offset:2048 sc1
    buffer_load_dwordx4 v[36:39], v2, s[4:7], s16 offen offset:3072 sc1
    s_waitcnt vmcnt(0)
    v_max3_u32 v19, v24, v25, v26
    v_max3_u32 v19, v19, v27, v28
    v_max3_u32 v19, v19, v29, v30
    v_max3_u32 v19, v19, v31, v32
    v_max3_u32 v19, v19, v33, v34
    v_max3_u32 v19, v19, v35, v36
    v_max3_u32 v19, v19, v37, v38
    v_max_u32 v19, v19, v39
    v_cmp_eq_u32 vcc, -1, v19
    s_nop 0
    s_cbranch_vccz g_71k
    s_add_u32 s23, s23, 1
    s_cmp_lt_u32 s23, 200000
    s_cbranch_scc1 g_71
    s_mov_b32 s25, 200000
g_71k:
    v_smfmac_f32_16x16x64_bf16 v[40:43], v[24:27], a[0:7], v172
    v_smfmac_f32_16x16x64_bf16 v[44:47], v[24:27], a[64:71], v172
    v_smfmac_f32_16x16x64_bf16 v[48:51], v[24:27], a[32:39], v172
    v_smfmac_f32_16x16x64_bf16 v[52:55], v[24:27], a[96:103], v172
    v_smfmac_f32_16x16x64_bf16 v[40:43], v[28:31], a[8:15], v172
    v_smfmac_f32_16x16x64_bf16 v[44:47], v[28:31], a[72:79], v172
    v_smfmac_f32_16x16x64_bf16 v[48:51], v[28:31], a[40:47], v172
    v_smfmac_f32_16x16x64_bf16 v[52:55], v[28:31], a[104:111], v172
    v_smfmac_f32_16x16x64_bf16 v[40:43], v[32:35], a[16:23], v172
    v_smfmac_f32_16x16x64_bf16 v[44:47], v[32:35], a[80:87], v172
    v_smfmac_f32_16x16x64_bf16 v[48:51], v[32:35], a[48:55], v172
    v_smfmac_f32_16x16x64_bf16 v[52:55], v[32:35], a[112:119], v172
    v_smfmac_f32_16x16x64_bf16 v[40:43], v[36:39], a[24:31], v172
    v_smfmac_f32_16x16x64_bf16 v[44:47], v[36:39], a[88:95], v172
    v_smfmac_f32_16x16x64_bf16 v[48:51], v[36:39], a[56:63], v172
    v_smfmac_f32_16x16x64_bf16 v[52:55], v[36:39], a[120:127], v172
    v_cvt_pk_bf16_f32 v72, v40, v41
    v_cvt_pk_bf16_f32 v73, v42, v43
    v_cvt_pk_bf16_f32 v74, v44, v45
    v_cvt_pk_bf16_f32 v75, v46, v47
    ds_write_b128 v17, v[72:75] offset:0
    v_cvt_pk_bf16_f32 v76, v48, v49
    v_cvt_pk_bf16_f32 v77, v50, v51
    s_nop 0
    v_cvt_pk_bf16_f32 v78, v52, v53
    v_cvt_pk_bf16_f32 v79, v54, v55
    ds_write_b128 v17, v[76:79] offset:1024
    v_smfmac_f32_16x16x64_bf16 v[56:59], v[24:27], a[128:135], v172
    v_smfmac_f32_16x16x64_bf16 v[60:63], v[24:27], a[160:167], v172
    v_smfmac_f32_16x16x64_bf16 v[56:59], v[28:31], a[136:143], v172
    s_waitcnt lgkmcnt(0)
    s_barrier
    v_smfmac_f32_16x16x64_bf16 v[60:63], v[28:31], a[168:175], v172
    v_smfmac_f32_16x16x64_bf16 v[56:59], v[32:35], a[144:151], v172
    v_smfmac_f32_16x16x64_bf16 v[60:63], v[32:35], a[176:183], v172
    v_smfmac_f32_16x16x64_bf16 v[56:59], v[36:39], a[152:159], v172
    v_smfmac_f32_16x16x64_bf16 v[60:63], v[36:39], a[184:191], v172
    s_nop 4
    v_cvt_pk_bf16_f32 v80, v56, v57
    v_cvt_pk_bf16_f32 v81, v58, v59
    s_nop 0
    v_cvt_pk_bf16_f32 v82, v60, v61
    v_cvt_pk_bf16_f32 v83, v62, v63
    ds_write_b128 v17, v[80:83] offset:8192
    buffer_store_dwordx4 v[204:207], v3, s[4:7], s43 offen sc1
    buffer_store_dwordx4 v[204:207], v3, s[4:7], s43 offen offset:128 sc1
    buffer_store_dwordx4 v[204:207], v4, s[4:7], s43 offen sc1
    buffer_store_dwordx2 v[204:205], v7, s[4:7], s43 offen sc1
    buffer_store_dwordx2 v[204:205], v11, s[4:7], s43 offen sc1
    s_cmp_eq_u32 s15, 63
    s_waitcnt lgkmcnt(0)
    s_barrier
    s_cbranch_scc1 recur_end
    s_barrier
    s_nop 15
    s_mov_b32 s23, s25
g_72:
    buffer_load_dwordx4 v[24:27], v8, s[4:7], s16 offen offset:0 sc1
    buffer_load_dwordx4 v[28:31], v8, s[4:7], s16 offen offset:1024 sc1
    buffer_load_dwordx4 v[32:35], v8, s[4:7], s16 offen offset:2048 sc1
    buffer_load_dwordx4 v[36:39], v8, s[4:7], s16 offen offset:3072 sc1
    s_waitcnt vmcnt(0)
    v_max3_u32 v19, v24, v25, v26
    v_max3_u32 v19, v19, v27, v28
    v_max3_u32 v19, v19, v29, v30
    v_max3_u32 v19, v19, v31, v32
    v_max3_u32 v19, v19, v33, v34
    v_max3_u32 v19, v19, v35, v36
    v_max3_u32 v19, v19, v37, v38
    v_max_u32 v19, v19, v39
    v_cmp_eq_u32 vcc, -1, v19
    s_nop 0
    s_cbranch_vccz g_72k
    s_add_u32 s23, s23, 1
    s_cmp_lt_u32 s23, 200000
    s_cbranch_scc1 g_72
    s_mov_b32 s25, 200000
g_72k:
    v_smfmac_f32_16x16x64_bf16 v[64:67], v[24:27], a[192:199], v172
    v_smfmac_f32_16x16x64_bf16 v[68:71], v[24:27], a[224:231], v172
    v_smfmac_f32_16x16x64_bf16 v[64:67], v[28:31], a[200:207], v172
    v_smfmac_f32_16x16x64_bf16 v[68:71], v[28:31], a[232:239], v172
    v_smfmac_f32_16x16x64_bf16 v[64:67], v[32:35], a[208:215], v172
    v_smfmac_f32_16x16x64_bf16 v[68:71], v[32:35], a[240:247], v172
    v_smfmac_f32_16x16x64_bf16 v[64:67], v[36:39], a[216:223], v172
    v_smfmac_f32_16x16x64_bf16 v[68:71], v[36:39], a[248:255], v172
    s_nop 4
    v_cvt_pk_bf16_f32 v80, v64, v65
    v_cvt_pk_bf16_f32 v81, v66, v67
    s_nop 0
    v_cvt_pk_bf16_f32 v82, v68, v69
    v_cvt_pk_bf16_f32 v83, v70, v71
    s_nop 1
    v_mfma_f32_16x16x32_bf16 v[88:91], v[80:83], v[84:87], 0
    s_barrier
    ds_read_b128 v[96:99], v16 offset:9216
    ds_read_b128 v[100:103], v16 offset:11264
    ds_read_b128 v[104:107], v16 offset:13312
    s_waitcnt lgkmcnt(2)
    v_mfma_f32_16x16x32_bf16 v[88:91], v[96:99], v[84:87], v[88:91]
    s_waitcnt lgkmcnt(1)
    v_mfma_f32_16x16x32_bf16 v[88:91], v[100:103], v[84:87], v[88:91]
    s_waitcnt lgkmcnt(0)
    v_mfma_f32_16x16x32_bf16 v[88:91], v[104:107], v[84:87], v[88:91]
    s_nop 7
    buffer_store_dwordx4 v[88:91], v9, s[4:7], s84 offen sc1
    s_add_u32 s22, s84, 262144
    buffer_store_dwordx4 v[88:91], v9, s[4:7], s22 offen sc1
    s_nop 15
    s_nop 15
    s_nop 15
    s_nop 15
    s_nop 15
    s_nop 15
    s_nop 15
    s_nop 7
    s_mov_b32 s23, s25
    buffer_load_dwordx4 v[96:99], v10, s[4:7], s84 offen sc1
    buffer_load_dwordx4 v[100:103], v23, s[4:7], s84 offen sc1
    buffer_load_dwordx4 v[104:107], v244, s[4:7], s84 offen sc1
    s_nop 15
    s_nop 15
    s_nop 7
    buffer_load_dwordx4 v[108:111], v10, s[4:7], s22 offen sc1
    buffer_load_dwordx4 v[112:115], v23, s[4:7], s22 offen sc1
    buffer_load_dwordx4 v[116:119], v244, s[4:7], s22 offen sc1
    v_mov_b32 v40, 0
    v_mov_b32 v41, 0
    v_mov_b32 v42, 0
    v_mov_b32 v43, 0
    v_mov_b32 v44, 0
    v_mov_b32 v45, 0
    v_mov_b32 v46, 0
    v_mov_b32 v47, 0
    v_mov_b32 v48, 0
    v_mov_b32 v49, 0
    v_mov_b32 v50, 0
    v_mov_b32 v51, 0
    v_mov_b32 v52, 0
    v_mov_b32 v53, 0
    v_mov_b32 v54, 0
    v_mov_b32 v55, 0
    v_mov_b32 v56, 0
    v_mov_b32 v57, 0
    v_mov_b32 v58, 0
    v_mov_b32 v59, 0
    v_mov_b32 v60, 0
    v_mov_b32 v61, 0
    v_mov_b32 v62, 0
    v_mov_b32 v63, 0
    v_mov_b32 v64, 0
    v_mov_b32 v65, 0
    v_mov_b32 v66, 0
    v_mov_b32 v67, 0
    v_mov_b32 v68, 0
    v_mov_b32 v69, 0
    v_mov_b32 v70, 0
    v_mov_b32 v71, 0
    s_waitcnt vmcnt(5)
    v_pk_add_f32 v[120:121], v[88:89], v[96:97]
    v_pk_add_f32 v[122:123], v[90:91], v[98:99]
    s_waitcnt vmcnt(4)
    v_pk_add_f32 v[120:121], v[120:121], v[100:101]
    v_pk_add_f32 v[122:123], v[122:123], v[102:103]
    s_waitcnt vmcnt(3)
    v_pk_add_f32 v[120:121], v[120:121], v[104:105]
    v_pk_add_f32 v[122:123], v[122:123], v[106:107]
    v_cvt_pk_bf16_f32 v180, v120, v121
    v_pk_add_f32 v[124:125], v[120:121], v[122:123]
    v_cvt_pk_bf16_f32 v181, v122, v123
    v_cmpx_o_f32 vcc, v124, v125
    buffer_store_dwordx2 v[180:181], v11, s[4:7], s42 offen sc1
    s_cmp_eq_u64 vcc, -1
    s_mov_b64 exec, -1
    s_cbranch_scc0 pr_73
pg_74:
    s_barrier
    s_mov_b32 s21, s16
    s_mov_b32 s16, s42
    s_mov_b32 s42, s43
    s_mov_b32 s43, s44
    s_mov_b32 s44, s21
    s_add_u32 s95, s95, 524288
    s_lshr_b32 s84, s95, 8
    s_and_b32 s84, s84, 8192
    s_xor_b32 s84, s84, s46
    s_add_u32 s84, s84, s95
    s_add_u32 s15, s15, 1
    s_branch recur_slow_w3
pr_73:
    s_waitcnt vmcnt(3)
    v_pk_add_f32 v[120:121], v[88:89], v[108:109]
    v_pk_add_f32 v[122:123], v[90:91], v[110:111]
    s_waitcnt vmcnt(2)
    v_pk_add_f32 v[120:121], v[120:121], v[112:113]
    v_pk_add_f32 v[122:123], v[122:123], v[114:115]
    s_waitcnt vmcnt(1)
    v_pk_add_f32 v[120:121], v[120:121], v[116:117]
    v_pk_add_f32 v[122:123], v[122:123], v[118:119]
    v_cvt_pk_bf16_f32 v180, v120, v121
    v_pk_add_f32 v[124:125], v[120:121], v[122:123]
    v_cvt_pk_bf16_f32 v181, v122, v123
    v_cmpx_o_f32 vcc, v124, v125
    buffer_store_dwordx2 v[180:181], v11, s[4:7], s42 offen sc1
    s_cmp_eq_u64 vcc, -1
    s_mov_b64 exec, -1
    s_cbranch_scc0 pq_76
    s_branch pg_74
pb_75:
    s_waitcnt vmcnt(2)
    v_pk_add_f32 v[120:121], v[88:89], v[108:109]
    v_pk_add_f32 v[122:123], v[90:91], v[110:111]
    s_waitcnt vmcnt(1)
    v_pk_add_f32 v[120:121], v[120:121], v[112:113]
    v_pk_add_f32 v[122:123], v[122:123], v[114:115]
    s_waitcnt vmcnt(0)
    v_pk_add_f32 v[120:121], v[120:121], v[116:117]
    v_pk_add_f32 v[122:123], v[122:123], v[118:119]
    v_cvt_pk_bf16_f32 v180, v120, v121
    v_pk_add_f32 v[124:125], v[120:121], v[122:123]
    v_cvt_pk_bf16_f32 v181, v122, v123
    v_cmpx_o_f32 vcc, v124, v125
    buffer_store_dwordx2 v[180:181], v11, s[4:7], s42 offen sc1
    s_cmp_eq_u64 vcc, -1
    s_mov_b64 exec, -1
    s_cbranch_scc0 pq_76
    s_branch pg_74
pq_76:
    v_max3_u32 v19, v108, v109, v110
    v_max3_u32 v19, v19, v111, v112
    v_max3_u32 v19, v19, v113, v114
    v_max3_u32 v19, v19, v115, v116
    v_max3_u32 v19, v19, v117, v118
    v_max_u32 v19, v19, v119
    v_cmp_eq_u32 vcc, -1, v19
    s_nop 0
    s_cbranch_vccz pf_77
    buffer_load_dwordx4 v[108:111], v10, s[4:7], s22 offen sc1
    buffer_load_dwordx4 v[112:115], v23, s[4:7], s22 offen sc1
    buffer_load_dwordx4 v[116:119], v244, s[4:7], s22 offen sc1
    s_add_u32 s23, s23, 1
    s_cmp_lt_u32 s23, 200000
    s_cbranch_scc1 pb_75
    s_mov_b32 s25, 200000
pf_77:
    buffer_store_dwordx2 v[180:181], v11, s[4:7], s42 offen sc1
    s_branch pg_74
recur_end:
    s_barrier
    v_mov_b32 v247, 64
    buffer_store_dword v247, v246, s[4:7], 0 offen sc1
    s_endpgm
.section .rodata,"a"
.p2align 6
.amdhsa_kernel concat_heads__spectral_gfnet__memory_aug_recurrent_mem_tr__prompt_kernel
  .amdhsa_next_free_vgpr 512
  .amdhsa_next_free_sgpr 102
  .amdhsa_accum_offset 256
  .amdhsa_group_segment_fixed_size 0
  .amdhsa_kernarg_size 104
  .amdhsa_user_sgpr_count 2
  .amdhsa_user_sgpr_kernarg_segment_ptr 1
  .amdhsa_system_sgpr_workgroup_id_x 1
  .amdhsa_float_denorm_mode_32 3
.end_amdhsa_kernel
```

```asm
; @launch kernel=concat_heads__spectral_gfnet__memory_aug_recurrent_mem_tr__prompt_kernel grid=(256,1,1) block=(256,1,1) lds=163840
.amdgcn_target "amdgcn-amd-amdhsa--gfx950"
.text
.globl concat_heads__spectral_gfnet__memory_aug_recurrent_mem_tr__prompt_kernel
.p2align 8
.type concat_heads__spectral_gfnet__memory_aug_recurrent_mem_tr__prompt_kernel,@function
concat_heads__spectral_gfnet__memory_aug_recurrent_mem_tr__prompt_kernel:
    s_cmp_ge_u32 s2, 256
    s_cbranch_scc1 W_end
    s_load_dwordx2 s[100:101], s[0:1], 88
    s_mov_b32 s97, s2
    s_mov_b32 s98, 0
    s_getreg_b32 s3, hwreg(HW_REG_XCC_ID, 0, 3)
role_start:
    s_andn2_b32 s2, s97, 7
    s_or_b32 s2, s2, s3
    s_bitcmp1_b32 s3, 2
    s_cbranch_scc0 R_entry
    s_cmp_ge_u32 s2, 256
    s_cbranch_scc1 W_end
    s_load_dwordx2 s[4:5], s[0:1], 96
    v_lshrrev_b32 v5, 6, v0
    v_and_b32 v1, 63, v0
    v_readfirstlane_b32 s16, v5
    s_mov_b32 s6, 268435456
    s_mov_b32 s7, 0x20000
    s_waitcnt lgkmcnt(0)
    s_lshr_b32 s90, s2, 6
    s_bfe_u32 s91, s2, 0x30003
    s_lshl_b32 s91, s91, 2
    s_and_b32 s17, s3, 3
    s_add_u32 s91, s91, s17
    s_lshl_b32 s93, s17, 3
    s_lshr_b32 s17, s91, 2
    s_add_u32 s93, s93, s17
    s_mov_b32 s92, 0
    s_lshl_b32 s17, s93, 2
    s_add_u32 s17, s17, s16
    s_lshl_b32 s18, s90, 7
    s_add_u32 s18, s18, s17
    s_lshl_b32 s18, s18, 7
    s_add_u32 s18, s18, 100663296
    s_lshl_b32 s20, s17, 7
    s_add_u32 s20, s20, 100728832
    s_cmp_eq_u32 s90, 3
    s_cselect_b32 s18, s20, s18
    s_cselect_b64 exec, 7, 1
    v_mov_b32 v5, s18
    s_and_b32 s18, s17, 31
    s_lshl_b32 s18, s18, 2
    s_lshr_b32 s20, s93, 3
    s_add_u32 s18, s18, s20
    s_lshl_b32 s18, s18, 7
    s_add_u32 s18, s18, 100745216
    v_writelane_b32 v5, s18, 1
    s_lshl_b32 s18, s17, 7
    s_add_u32 s18, s18, 100761600
    v_writelane_b32 v5, s18, 2
    v_mov_b32 v6, 0
    buffer_store_dword v6, v5, s[4:7], 0 offen sc1
    s_mov_b64 exec, -1
    s_cmp_eq_u32 s90, 3
    s_cbranch_scc1 W_F
    s_load_dwordx2 s[8:9], s[0:1], 24
    s_mov_b32 s10, 4194304
    s_mov_b32 s11, 0x20000
    s_lshr_b32 s17, s2, 3
    s_lshl_b32 s17, s17, 15
    v_lshlrev_b32 v5, 7, v0
    s_waitcnt lgkmcnt(0)
    buffer_load_dword v254, v5, s[8:11], s17 offen
    s_cmp_lg_u32 s90, 0
    s_cbranch_scc1 W_P
    s_waitcnt vmcnt(0)
    s_barrier
    s_or_b32 s17, s16, s98
    s_cmp_lg_u32 s17, 0
    s_cbranch_scc1 vote_1
    s_lshl_b32 s17, s91, 14
    s_add_u32 s17, s17, 239075328
    v_lshlrev_b32 v5, 2, v1
    v_add_u32 v5, s17, v5
    v_add_u32 v6, 8192, v5
    s_mov_b32 s20, -1
    s_mov_b32 s21, -1
    s_mov_b64 exec, 1
    buffer_store_dword v1, v5, s[4:7], 0 offen sc1
    s_mov_b32 s22, 0
vp_2:
    s_add_u32 s22, s22, 1
    s_getreg_b32 s18, hwreg(HW_REG_IB_STS, 0, 4)
    s_cmp_lt_u32 s22, 2048
    s_cselect_b32 s18, s18, 0
    s_cmp_lg_u32 s18, 0
    s_cbranch_scc1 vp_2
    s_min_u32 s20, s20, s22
    buffer_store_dword v1, v6, s[4:7], 0 offen sc1
    s_mov_b32 s22, 0
vp_3:
    s_add_u32 s22, s22, 1
    s_getreg_b32 s18, hwreg(HW_REG_IB_STS, 0, 4)
    s_cmp_lt_u32 s22, 2048
    s_cselect_b32 s18, s18, 0
    s_cmp_lg_u32 s18, 0
    s_cbranch_scc1 vp_3
    s_min_u32 s21, s21, s22
    buffer_store_dword v1, v5, s[4:7], 0 offen sc1
    s_mov_b32 s22, 0
vp_4:
    s_add_u32 s22, s22, 1
    s_getreg_b32 s18, hwreg(HW_REG_IB_STS, 0, 4)
    s_cmp_lt_u32 s22, 2048
    s_cselect_b32 s18, s18, 0
    s_cmp_lg_u32 s18, 0
    s_cbranch_scc1 vp_4
    s_min_u32 s20, s20, s22
    buffer_store_dword v1, v6, s[4:7], 0 offen sc1
    s_mov_b32 s22, 0
vp_5:
    s_add_u32 s22, s22, 1
    s_getreg_b32 s18, hwreg(HW_REG_IB_STS, 0, 4)
    s_cmp_lt_u32 s22, 2048
    s_cselect_b32 s18, s18, 0
    s_cmp_lg_u32 s18, 0
    s_cbranch_scc1 vp_5
    s_min_u32 s21, s21, s22
    buffer_store_dword v1, v5, s[4:7], 0 offen sc1
    s_mov_b32 s22, 0
vp_6:
    s_add_u32 s22, s22, 1
    s_getreg_b32 s18, hwreg(HW_REG_IB_STS, 0, 4)
    s_cmp_lt_u32 s22, 2048
    s_cselect_b32 s18, s18, 0
    s_cmp_lg_u32 s18, 0
    s_cbranch_scc1 vp_6
    s_min_u32 s20, s20, s22
    buffer_store_dword v1, v6, s[4:7], 0 offen sc1
    s_mov_b32 s22, 0
vp_7:
    s_add_u32 s22, s22, 1
    s_getreg_b32 s18, hwreg(HW_REG_IB_STS, 0, 4)
    s_cmp_lt_u32 s22, 2048
    s_cselect_b32 s18, s18, 0
    s_cmp_lg_u32 s18, 0
    s_cbranch_scc1 vp_7
    s_min_u32 s21, s21, s22
    buffer_store_dword v1, v5, s[4:7], 0 offen sc1
    s_mov_b32 s22, 0
vp_8:
    s_add_u32 s22, s22, 1
    s_getreg_b32 s18, hwreg(HW_REG_IB_STS, 0, 4)
    s_cmp_lt_u32 s22, 2048
    s_cselect_b32 s18, s18, 0
    s_cmp_lg_u32 s18, 0
    s_cbranch_scc1 vp_8
    s_min_u32 s20, s20, s22
    buffer_store_dword v1, v6, s[4:7], 0 offen sc1
    s_mov_b32 s22, 0
vp_9:
    s_add_u32 s22, s22, 1
    s_getreg_b32 s18, hwreg(HW_REG_IB_STS, 0, 4)
    s_cmp_lt_u32 s22, 2048
    s_cselect_b32 s18, s18, 0
    s_cmp_lg_u32 s18, 0
    s_cbranch_scc1 vp_9
    s_min_u32 s21, s21, s22
    s_and_b32 s17, s97, 3
    s_lshl_b32 s17, s17, 3
    s_lshl_b32 s17, 0x40, s17
    s_cmp_lt_u32 s20, s21
    s_cselect_b32 s17, s17, 0
    s_andn2_b32 s18, s97, 3
    v_mov_b32 v5, s18
    v_mov_b32 v6, s17
    global_atomic_add v5, v6, s[100:101] sc1
    s_mov_b64 exec, -1
    s_waitcnt vmcnt(0)
vote_1:
    s_waitcnt vmcnt(0)
    s_barrier
    s_cmp_lg_u32 s16, 0
    s_cbranch_scc1 reg_10
    s_and_b32 s17, s2, 3
    s_lshl_b32 s17, s17, 3
    s_lshl_b32 s18, s98, 2
    s_add_u32 s17, s17, s18
    s_lshl_b32 s17, 1, s17
    s_andn2_b32 s18, s2, 3
    v_mov_b32 v5, s18
    v_mov_b32 v6, s17
    s_mov_b64 exec, 1
    global_atomic_add v5, v6, s[100:101] sc1
    s_mov_b64 exec, -1
reg_10:
W_P:
    s_load_dwordx2 s[12:13], s[0:1], 40
    s_load_dwordx2 s[28:29], s[0:1], 48
    s_load_dwordx2 s[30:31], s[0:1], 56
    s_load_dwordx2 s[8:9], s[0:1], 24
    s_mov_b32 s10, 4194304
    s_mov_b32 s11, 0x20000
    s_mov_b32 s14, 8388608
    s_mov_b32 s15, 0x20000
    s_waitcnt lgkmcnt(0)
    s_cmp_eq_u32 s90, 1
    s_cselect_b64 s[12:13], s[28:29], s[12:13]
    s_cmp_eq_u32 s90, 2
    s_cselect_b64 s[12:13], s[30:31], s[12:13]
    s_lshl_b32 s28, s93, 2
    s_add_u32 s28, s28, s16
    s_lshl_b32 s20, s28, 6
    v_lshrrev_b32 v5, 2, v1
    v_and_b32 v6, 3, v1
    v_lshlrev_b32 v8, 4, v6
    v_lshl_add_u32 v7, v5, 13, v8
    s_mul_i32 s19, s16, 40960
    s_and_b32 s17, s93, 3
    s_lshl_b32 s17, s17, 8
    v_add_lshl_u32 v2, v0, s17, 13
    s_andn2_b32 s17, s93, 3
    s_lshl_b32 s17, s17, 8
    buffer_load_dword v253, v2, s[12:15], s17 offen offset:384
    s_add_u32 m0, s19, 0
    s_nop 0
    buffer_load_dwordx4 v7, s[12:15], s20 offen lds
    s_add_u32 s20, s20, 131072
    s_add_u32 m0, s19, 1024
    s_nop 0
    buffer_load_dwordx4 v7, s[12:15], s20 offen lds
    s_add_u32 s20, s20, 131072
    s_add_u32 m0, s19, 2048
    s_nop 0
    buffer_load_dwordx4 v7, s[12:15], s20 offen lds
    s_add_u32 s20, s20, 131072
    s_add_u32 m0, s19, 3072
    s_nop 0
    buffer_load_dwordx4 v7, s[12:15], s20 offen lds
    s_add_u32 s20, s20, 131072
    v_bfe_u32 v5, v1, 2, 2
    v_lshrrev_b32 v6, 4, v1
    v_lshl_add_u32 v5, v6, 3, v5
    v_lshl_add_u32 v8, v5, 6, v8
    v_add_u32 v8, s19, v8
    s_cmp_eq_u32 s90, 0
    s_cbranch_scc1 nq_13
    s_waitcnt vmcnt(6)
    s_barrier
    s_cmp_lg_u32 s16, 0
    s_cbranch_scc1 reg_14
    s_and_b32 s17, s2, 3
    s_lshl_b32 s17, s17, 3
    s_lshl_b32 s18, s98, 2
    s_add_u32 s17, s17, s18
    s_lshl_b32 s17, 1, s17
    s_andn2_b32 s18, s2, 3
    v_mov_b32 v5, s18
    v_mov_b32 v6, s17
    s_mov_b64 exec, 1
    global_atomic_add v5, v6, s[100:101] sc1
    s_mov_b64 exec, -1
reg_14:
    s_barrier
nq_13:
    s_add_u32 m0, s19, 4096
    s_nop 0
    buffer_load_dwordx4 v7, s[12:15], s20 offen lds
    s_add_u32 s20, s20, 131072
    s_add_u32 m0, s19, 5120
    s_nop 0
    buffer_load_dwordx4 v7, s[12:15], s20 offen lds
    s_add_u32 s20, s20, 131072
    s_add_u32 m0, s19, 6144
    s_nop 0
    buffer_load_dwordx4 v7, s[12:15], s20 offen lds
    s_add_u32 s20, s20, 131072
    s_add_u32 m0, s19, 7168
    s_nop 0
    buffer_load_dwordx4 v7, s[12:15], s20 offen lds
    s_add_u32 s20, s20, 131072
    s_add_u32 m0, s19, 8192
    s_nop 0
    buffer_load_dwordx4 v7, s[12:15], s20 offen lds
    s_add_u32 s20, s20, 131072
    s_add_u32 m0, s19, 9216
    s_nop 0
    buffer_load_dwordx4 v7, s[12:15], s20 offen lds
    s_add_u32 s20, s20, 131072
    s_add_u32 m0, s19, 10240
    s_nop 0
    buffer_load_dwordx4 v7, s[12:15], s20 offen lds
    s_add_u32 s20, s20, 131072
    s_add_u32 m0, s19, 11264
    s_nop 0
    buffer_load_dwordx4 v7, s[12:15], s20 offen lds
    s_add_u32 s20, s20, 131072
    s_add_u32 m0, s19, 12288
    s_nop 0
    buffer_load_dwordx4 v7, s[12:15], s20 offen lds
    s_add_u32 s20, s20, 131072
    s_add_u32 m0, s19, 13312
    s_nop 0
    buffer_load_dwordx4 v7, s[12:15], s20 offen lds
    s_add_u32 s20, s20, 131072
    s_add_u32 m0, s19, 14336
    s_nop 0
    buffer_load_dwordx4 v7, s[12:15], s20 offen lds
    s_add_u32 s20, s20, 131072
    s_add_u32 m0, s19, 15360
    s_nop 0
    buffer_load_dwordx4 v7, s[12:15], s20 offen lds
    s_add_u32 s20, s20, 131072
    s_add_u32 m0, s19, 16384
    s_nop 0
    buffer_load_dwordx4 v7, s[12:15], s20 offen lds
    s_add_u32 s20, s20, 131072
    s_add_u32 m0, s19, 17408
    s_nop 0
    buffer_load_dwordx4 v7, s[12:15], s20 offen lds
    s_add_u32 s20, s20, 131072
    s_add_u32 m0, s19, 18432
    s_nop 0
    buffer_load_dwordx4 v7, s[12:15], s20 offen lds
    s_add_u32 s20, s20, 131072
    s_add_u32 m0, s19, 19456
    s_nop 0
    buffer_load_dwordx4 v7, s[12:15], s20 offen lds
    s_add_u32 s20, s20, 131072
    s_add_u32 m0, s19, 20480
    s_nop 0
    buffer_load_dwordx4 v7, s[12:15], s20 offen lds
    s_add_u32 s20, s20, 131072
    s_add_u32 m0, s19, 21504
    s_nop 0
    buffer_load_dwordx4 v7, s[12:15], s20 offen lds
    s_add_u32 s20, s20, 131072
    s_add_u32 m0, s19, 22528
    s_nop 0
    buffer_load_dwordx4 v7, s[12:15], s20 offen lds
    s_add_u32 s20, s20, 131072
    s_add_u32 m0, s19, 23552
    s_nop 0
    buffer_load_dwordx4 v7, s[12:15], s20 offen lds
    s_add_u32 s20, s20, 131072
    s_add_u32 m0, s19, 24576
    s_nop 0
    buffer_load_dwordx4 v7, s[12:15], s20 offen lds
    s_add_u32 s20, s20, 131072
    s_add_u32 m0, s19, 25600
    s_nop 0
    buffer_load_dwordx4 v7, s[12:15], s20 offen lds
    s_add_u32 s20, s20, 131072
    s_add_u32 m0, s19, 26624
    s_nop 0
    buffer_load_dwordx4 v7, s[12:15], s20 offen lds
    s_add_u32 s20, s20, 131072
    s_add_u32 m0, s19, 27648
    s_nop 0
    buffer_load_dwordx4 v7, s[12:15], s20 offen lds
    s_add_u32 s20, s20, 131072
    s_add_u32 m0, s19, 28672
    s_nop 0
    buffer_load_dwordx4 v7, s[12:15], s20 offen lds
    s_add_u32 s20, s20, 131072
    s_add_u32 m0, s19, 29696
    s_nop 0
    buffer_load_dwordx4 v7, s[12:15], s20 offen lds
    s_add_u32 s20, s20, 131072
    s_add_u32 m0, s19, 30720
    s_nop 0
    buffer_load_dwordx4 v7, s[12:15], s20 offen lds
    s_add_u32 s20, s20, 131072
    s_add_u32 m0, s19, 31744
    s_nop 0
    buffer_load_dwordx4 v7, s[12:15], s20 offen lds
    s_add_u32 s20, s20, 131072
    s_add_u32 m0, s19, 32768
    s_nop 0
    buffer_load_dwordx4 v7, s[12:15], s20 offen lds
    s_add_u32 s20, s20, 131072
    s_add_u32 m0, s19, 33792
    s_nop 0
    buffer_load_dwordx4 v7, s[12:15], s20 offen lds
    s_add_u32 s20, s20, 131072
    s_add_u32 m0, s19, 34816
    s_nop 0
    buffer_load_dwordx4 v7, s[12:15], s20 offen lds
    s_add_u32 s20, s20, 131072
    s_add_u32 m0, s19, 35840
    s_nop 0
    buffer_load_dwordx4 v7, s[12:15], s20 offen lds
    s_add_u32 s20, s20, 131072
    s_add_u32 m0, s19, 36864
    s_nop 0
    buffer_load_dwordx4 v7, s[12:15], s20 offen lds
    s_add_u32 s20, s20, 131072
    s_add_u32 m0, s19, 37888
    s_nop 0
    buffer_load_dwordx4 v7, s[12:15], s20 offen lds
    s_add_u32 s20, s20, 131072
    s_add_u32 m0, s19, 38912
    s_nop 0
    buffer_load_dwordx4 v7, s[12:15], s20 offen lds
    s_add_u32 s20, s20, 131072
    s_add_u32 m0, s19, 39936
    s_nop 0
    buffer_load_dwordx4 v7, s[12:15], s20 offen lds
    s_add_u32 s20, s20, 131072
    s_waitcnt vmcnt(38)
    ds_read_b64_tr_b16 a[0:1], v8 offset:0
    ds_read_b64_tr_b16 a[2:3], v8 offset:256
    ds_read_b64_tr_b16 a[4:5], v8 offset:8
    ds_read_b64_tr_b16 a[6:7], v8 offset:264
    s_waitcnt vmcnt(36)
    ds_read_b64_tr_b16 a[8:9], v8 offset:2048
    ds_read_b64_tr_b16 a[10:11], v8 offset:2304
    ds_read_b64_tr_b16 a[12:13], v8 offset:2056
    ds_read_b64_tr_b16 a[14:15], v8 offset:2312
    s_waitcnt lgkmcnt(4)
    s_add_u32 m0, s19, 0
    s_nop 0
    buffer_load_dwordx4 v7, s[12:15], s20 offen lds
    s_add_u32 s20, s20, 131072
    s_add_u32 m0, s19, 1024
    s_nop 0
    buffer_load_dwordx4 v7, s[12:15], s20 offen lds
    s_add_u32 s20, s20, 131072
    s_waitcnt vmcnt(36)
    ds_read_b64_tr_b16 a[16:17], v8 offset:4096
    ds_read_b64_tr_b16 a[18:19], v8 offset:4352
    ds_read_b64_tr_b16 a[20:21], v8 offset:4104
    ds_read_b64_tr_b16 a[22:23], v8 offset:4360
    s_waitcnt lgkmcnt(4)
    s_add_u32 m0, s19, 2048
    s_nop 0
    buffer_load_dwordx4 v7, s[12:15], s20 offen lds
    s_add_u32 s20, s20, 131072
    s_add_u32 m0, s19, 3072
    s_nop 0
    buffer_load_dwordx4 v7, s[12:15], s20 offen lds
    s_add_u32 s20, s20, 131072
    s_waitcnt vmcnt(36)
    ds_read_b64_tr_b16 a[24:25], v8 offset:6144
    ds_read_b64_tr_b16 a[26:27], v8 offset:6400
    ds_read_b64_tr_b16 a[28:29], v8 offset:6152
    ds_read_b64_tr_b16 a[30:31], v8 offset:6408
    s_waitcnt lgkmcnt(4)
    s_add_u32 m0, s19, 4096
    s_nop 0
    buffer_load_dwordx4 v7, s[12:15], s20 offen lds
    s_add_u32 s20, s20, 131072
    s_add_u32 m0, s19, 5120
    s_nop 0
    buffer_load_dwordx4 v7, s[12:15], s20 offen lds
    s_add_u32 s20, s20, 131072
    s_waitcnt vmcnt(36)
    ds_read_b64_tr_b16 a[32:33], v8 offset:8192
    ds_read_b64_tr_b16 a[34:35], v8 offset:8448
    ds_read_b64_tr_b16 a[36:37], v8 offset:8200
    ds_read_b64_tr_b16 a[38:39], v8 offset:8456
    s_waitcnt lgkmcnt(4)
    s_add_u32 m0, s19, 6144
    s_nop 0
    buffer_load_dwordx4 v7, s[12:15], s20 offen lds
    s_add_u32 s20, s20, 131072
    s_add_u32 m0, s19, 7168
    s_nop 0
    buffer_load_dwordx4 v7, s[12:15], s20 offen lds
    s_add_u32 s20, s20, 131072
    s_waitcnt vmcnt(36)
    ds_read_b64_tr_b16 a[40:41], v8 offset:10240
    ds_read_b64_tr_b16 a[42:43], v8 offset:10496
    ds_read_b64_tr_b16 a[44:45], v8 offset:10248
    ds_read_b64_tr_b16 a[46:47], v8 offset:10504
    s_waitcnt lgkmcnt(4)
    s_add_u32 m0, s19, 8192
    s_nop 0
    buffer_load_dwordx4 v7, s[12:15], s20 offen lds
    s_add_u32 s20, s20, 131072
    s_add_u32 m0, s19, 9216
    s_nop 0
    buffer_load_dwordx4 v7, s[12:15], s20 offen lds
    s_add_u32 s20, s20, 131072
    s_waitcnt vmcnt(36)
    ds_read_b64_tr_b16 a[48:49], v8 offset:12288
    ds_read_b64_tr_b16 a[50:51], v8 offset:12544
    ds_read_b64_tr_b16 a[52:53], v8 offset:12296
    ds_read_b64_tr_b16 a[54:55], v8 offset:12552
    s_waitcnt lgkmcnt(4)
    s_add_u32 m0, s19, 10240
    s_nop 0
    buffer_load_dwordx4 v7, s[12:15], s20 offen lds
    s_add_u32 s20, s20, 131072
    s_add_u32 m0, s19, 11264
    s_nop 0
    buffer_load_dwordx4 v7, s[12:15], s20 offen lds
    s_add_u32 s20, s20, 131072
    s_waitcnt vmcnt(36)
    ds_read_b64_tr_b16 a[56:57], v8 offset:14336
    ds_read_b64_tr_b16 a[58:59], v8 offset:14592
    ds_read_b64_tr_b16 a[60:61], v8 offset:14344
    ds_read_b64_tr_b16 a[62:63], v8 offset:14600
    s_waitcnt lgkmcnt(4)
    s_add_u32 m0, s19, 12288
    s_nop 0
    buffer_load_dwordx4 v7, s[12:15], s20 offen lds
    s_add_u32 s20, s20, 131072
    s_add_u32 m0, s19, 13312
    s_nop 0
    buffer_load_dwordx4 v7, s[12:15], s20 offen lds
    s_add_u32 s20, s20, 131072
    s_waitcnt vmcnt(36)
    ds_read_b64_tr_b16 a[64:65], v8 offset:16384
    ds_read_b64_tr_b16 a[66:67], v8 offset:16640
    ds_read_b64_tr_b16 a[68:69], v8 offset:16392
    ds_read_b64_tr_b16 a[70:71], v8 offset:16648
    s_waitcnt lgkmcnt(4)
    s_add_u32 m0, s19, 14336
    s_nop 0
    buffer_load_dwordx4 v7, s[12:15], s20 offen lds
    s_add_u32 s20, s20, 131072
    s_add_u32 m0, s19, 15360
    s_nop 0
    buffer_load_dwordx4 v7, s[12:15], s20 offen lds
    s_add_u32 s20, s20, 131072
    s_waitcnt vmcnt(36)
    ds_read_b64_tr_b16 a[72:73], v8 offset:18432
    ds_read_b64_tr_b16 a[74:75], v8 offset:18688
    ds_read_b64_tr_b16 a[76:77], v8 offset:18440
    ds_read_b64_tr_b16 a[78:79], v8 offset:18696
    s_waitcnt lgkmcnt(4)
    s_add_u32 m0, s19, 16384
    s_nop 0
    buffer_load_dwordx4 v7, s[12:15], s20 offen lds
    s_add_u32 s20, s20, 131072
    s_add_u32 m0, s19, 17408
    s_nop 0
    buffer_load_dwordx4 v7, s[12:15], s20 offen lds
    s_add_u32 s20, s20, 131072
    s_waitcnt vmcnt(36)
    ds_read_b64_tr_b16 a[80:81], v8 offset:20480
    ds_read_b64_tr_b16 a[82:83], v8 offset:20736
    ds_read_b64_tr_b16 a[84:85], v8 offset:20488
    ds_read_b64_tr_b16 a[86:87], v8 offset:20744
    s_waitcnt lgkmcnt(4)
    s_add_u32 m0, s19, 18432
    s_nop 0
    buffer_load_dwordx4 v7, s[12:15], s20 offen lds
    s_add_u32 s20, s20, 131072
    s_add_u32 m0, s19, 19456
    s_nop 0
    buffer_load_dwordx4 v7, s[12:15], s20 offen lds
    s_add_u32 s20, s20, 131072
    s_waitcnt vmcnt(36)
    ds_read_b64_tr_b16 a[88:89], v8 offset:22528
    ds_read_b64_tr_b16 a[90:91], v8 offset:22784
    ds_read_b64_tr_b16 a[92:93], v8 offset:22536
    ds_read_b64_tr_b16 a[94:95], v8 offset:22792
    s_waitcnt lgkmcnt(4)
    s_add_u32 m0, s19, 20480
    s_nop 0
    buffer_load_dwordx4 v7, s[12:15], s20 offen lds
    s_add_u32 s20, s20, 131072
    s_add_u32 m0, s19, 21504
    s_nop 0
    buffer_load_dwordx4 v7, s[12:15], s20 offen lds
    s_add_u32 s20, s20, 131072
    s_waitcnt vmcnt(36)
    ds_read_b64_tr_b16 a[96:97], v8 offset:24576
    ds_read_b64_tr_b16 a[98:99], v8 offset:24832
    ds_read_b64_tr_b16 a[100:101], v8 offset:24584
    ds_read_b64_tr_b16 a[102:103], v8 offset:24840
    s_waitcnt lgkmcnt(4)
    s_add_u32 m0, s19, 22528
    s_nop 0
    buffer_load_dwordx4 v7, s[12:15], s20 offen lds
    s_add_u32 s20, s20, 131072
    s_add_u32 m0, s19, 23552
    s_nop 0
    buffer_load_dwordx4 v7, s[12:15], s20 offen lds
    s_add_u32 s20, s20, 131072
    s_waitcnt vmcnt(36)
    ds_read_b64_tr_b16 a[104:105], v8 offset:26624
    ds_read_b64_tr_b16 a[106:107], v8 offset:26880
    ds_read_b64_tr_b16 a[108:109], v8 offset:26632
    ds_read_b64_tr_b16 a[110:111], v8 offset:26888
    s_waitcnt lgkmcnt(7)
    s_waitcnt vmcnt(34)
    ds_read_b64_tr_b16 a[112:113], v8 offset:28672
    ds_read_b64_tr_b16 a[114:115], v8 offset:28928
    ds_read_b64_tr_b16 a[116:117], v8 offset:28680
    ds_read_b64_tr_b16 a[118:119], v8 offset:28936
    s_waitcnt vmcnt(32)
    ds_read_b64_tr_b16 a[120:121], v8 offset:30720
    ds_read_b64_tr_b16 a[122:123], v8 offset:30976
    ds_read_b64_tr_b16 a[124:125], v8 offset:30728
    ds_read_b64_tr_b16 a[126:127], v8 offset:30984
    s_waitcnt lgkmcnt(7)
    s_waitcnt vmcnt(30)
    ds_read_b64_tr_b16 a[128:129], v8 offset:32768
    ds_read_b64_tr_b16 a[130:131], v8 offset:33024
    ds_read_b64_tr_b16 a[132:133], v8 offset:32776
    ds_read_b64_tr_b16 a[134:135], v8 offset:33032
    s_waitcnt vmcnt(28)
    ds_read_b64_tr_b16 a[136:137], v8 offset:34816
    ds_read_b64_tr_b16 a[138:139], v8 offset:35072
    ds_read_b64_tr_b16 a[140:141], v8 offset:34824
    ds_read_b64_tr_b16 a[142:143], v8 offset:35080
    s_waitcnt lgkmcnt(7)
    s_waitcnt vmcnt(26)
    ds_read_b64_tr_b16 a[144:145], v8 offset:36864
    ds_read_b64_tr_b16 a[146:147], v8 offset:37120
    ds_read_b64_tr_b16 a[148:149], v8 offset:36872
    ds_read_b64_tr_b16 a[150:151], v8 offset:37128
    s_waitcnt vmcnt(24)
    ds_read_b64_tr_b16 a[152:153], v8 offset:38912
    ds_read_b64_tr_b16 a[154:155], v8 offset:39168
    ds_read_b64_tr_b16 a[156:157], v8 offset:38920
    ds_read_b64_tr_b16 a[158:159], v8 offset:39176
    s_waitcnt lgkmcnt(7)
    s_waitcnt vmcnt(22)
    ds_read_b64_tr_b16 a[160:161], v8 offset:0
    ds_read_b64_tr_b16 a[162:163], v8 offset:256
    ds_read_b64_tr_b16 a[164:165], v8 offset:8
    ds_read_b64_tr_b16 a[166:167], v8 offset:264
    s_waitcnt vmcnt(20)
    ds_read_b64_tr_b16 a[168:169], v8 offset:2048
    ds_read_b64_tr_b16 a[170:171], v8 offset:2304
    ds_read_b64_tr_b16 a[172:173], v8 offset:2056
    ds_read_b64_tr_b16 a[174:175], v8 offset:2312
    s_waitcnt lgkmcnt(7)
    s_waitcnt vmcnt(18)
    ds_read_b64_tr_b16 a[176:177], v8 offset:4096
    ds_read_b64_tr_b16 a[178:179], v8 offset:4352
    ds_read_b64_tr_b16 a[180:181], v8 offset:4104
    ds_read_b64_tr_b16 a[182:183], v8 offset:4360
    s_waitcnt vmcnt(16)
    ds_read_b64_tr_b16 a[184:185], v8 offset:6144
    ds_read_b64_tr_b16 a[186:187], v8 offset:6400
    ds_read_b64_tr_b16 a[188:189], v8 offset:6152
    ds_read_b64_tr_b16 a[190:191], v8 offset:6408
    s_waitcnt lgkmcnt(7)
    s_waitcnt vmcnt(14)
    ds_read_b64_tr_b16 a[192:193], v8 offset:8192
    ds_read_b64_tr_b16 a[194:195], v8 offset:8448
    ds_read_b64_tr_b16 a[196:197], v8 offset:8200
    ds_read_b64_tr_b16 a[198:199], v8 offset:8456
    s_waitcnt vmcnt(12)
    ds_read_b64_tr_b16 a[200:201], v8 offset:10240
    ds_read_b64_tr_b16 a[202:203], v8 offset:10496
    ds_read_b64_tr_b16 a[204:205], v8 offset:10248
    ds_read_b64_tr_b16 a[206:207], v8 offset:10504
    s_waitcnt lgkmcnt(7)
    s_waitcnt vmcnt(10)
    ds_read_b64_tr_b16 a[208:209], v8 offset:12288
    ds_read_b64_tr_b16 a[210:211], v8 offset:12544
    ds_read_b64_tr_b16 a[212:213], v8 offset:12296
    ds_read_b64_tr_b16 a[214:215], v8 offset:12552
    s_waitcnt vmcnt(8)
    ds_read_b64_tr_b16 a[216:217], v8 offset:14336
    ds_read_b64_tr_b16 a[218:219], v8 offset:14592
    ds_read_b64_tr_b16 a[220:221], v8 offset:14344
    ds_read_b64_tr_b16 a[222:223], v8 offset:14600
    s_waitcnt lgkmcnt(7)
    s_waitcnt vmcnt(6)
    ds_read_b64_tr_b16 a[224:225], v8 offset:16384
    ds_read_b64_tr_b16 a[226:227], v8 offset:16640
    ds_read_b64_tr_b16 a[228:229], v8 offset:16392
    ds_read_b64_tr_b16 a[230:231], v8 offset:16648
    s_waitcnt vmcnt(4)
    ds_read_b64_tr_b16 a[232:233], v8 offset:18432
    ds_read_b64_tr_b16 a[234:235], v8 offset:18688
    ds_read_b64_tr_b16 a[236:237], v8 offset:18440
    ds_read_b64_tr_b16 a[238:239], v8 offset:18696
    s_waitcnt lgkmcnt(7)
    s_waitcnt vmcnt(2)
    ds_read_b64_tr_b16 a[240:241], v8 offset:20480
    ds_read_b64_tr_b16 a[242:243], v8 offset:20736
    ds_read_b64_tr_b16 a[244:245], v8 offset:20488
    ds_read_b64_tr_b16 a[246:247], v8 offset:20744
    s_waitcnt vmcnt(0)
    ds_read_b64_tr_b16 a[248:249], v8 offset:22528
    ds_read_b64_tr_b16 a[250:251], v8 offset:22784
    ds_read_b64_tr_b16 a[252:253], v8 offset:22536
    ds_read_b64_tr_b16 a[254:255], v8 offset:22792
    s_waitcnt lgkmcnt(7)
    s_waitcnt lgkmcnt(0)
weven_12:
    v_and_b32 v5, 15, v1
    v_bfe_u32 v6, v1, 1, 3
    v_lshrrev_b32 v7, 4, v1
    v_xor_b32 v6, v6, v7
    v_lshlrev_b32 v6, 4, v6
    v_lshl_add_u32 v10, v5, 7, v6
    s_lshl_b32 s19, s16, 10
    v_xor_b32 v11, 64, v10
    v_add_u32 v12, 0x10000, v10
    v_add_u32 v13, 0x10000, v11
    v_lshrrev_b32 v7, 3, v1
    s_lshl_b32 s17, s16, 3
    v_add_u32 v7, s17, v7
    v_bfe_u32 v8, v7, 1, 3
    v_xor_b32 v8, v8, v1
    v_and_b32 v8, 7, v8
    v_bfe_u32 v5, v7, 2, 2
    v_and_b32 v2, 3, v7
    v_lshl_add_u32 v2, v5, 3, v2
    v_bfe_u32 v5, v7, 4, 1
    v_lshl_add_u32 v2, v5, 2, v2
    v_bfe_u32 v5, v1, 2, 2
    v_and_b32 v3, 3, v1
    v_lshl_add_u32 v3, v5, 3, v3
    v_lshlrev_b32 v2, 11, v2
    v_lshl_add_u32 v2, v8, 4, v2
    v_and_b32 v5, 16, v1
    v_lshl_add_u32 v3, v3, 5, v5
    v_and_b32 v5, 32, v1
    v_lshl_add_u32 v3, v5, 5, v3
    s_mul_i32 s21, s28, 133120
    s_mul_i32 s18, s90, 17825792
    s_add_u32 s21, s21, s18
    s_lshl_b32 s18, s90, 7
    s_add_u32 s17, s28, s18
    s_lshl_b32 s17, s17, 7
    s_add_u32 s17, s17, 100663296
    v_mov_b32 v4, s17
    v_mov_b32 v5, 1073741824
    v_cmp_eq_u32 vcc, 0, v1
    s_nop 1
    v_cndmask_b32 v4, v5, v4, vcc
    v_lshlrev_b32 v252, 7, v1
    s_cmp_eq_u32 s90, 0
    s_cselect_b32 s20, 0, 32
    v_cmp_gt_u32 vcc, s20, v1
    s_nop 1
    v_cndmask_b32 v252, v5, v252, vcc
    s_mov_b32 s20, 0
    s_mov_b32 s24, 65536
    s_mov_b32 s25, 2048
    s_barrier
    s_cmp_eq_u32 s90, 2
    s_cbranch_scc1 P_v
    s_mov_b32 s26, s25
    s_sub_u32 s25, s21, 1073741824
    s_mov_b32 s21, 1073741824
    s_mov_b32 s23, 0
    s_mov_b32 s22, 0
    s_add_u32 m0, s19, 0
    s_nop 0
    buffer_load_dwordx4 v2, s[8:11], s20 offen offset:0 lds
    s_add_u32 m0, s19, 3968
    s_nop 0
    buffer_load_dwordx4 v2, s[8:11], s20 offen offset:128 lds
    s_add_u32 m0, s19, 7936
    s_nop 0
    buffer_load_dwordx4 v2, s[8:11], s20 offen offset:256 lds
    s_add_u32 m0, s19, 11904
    s_nop 0
    buffer_load_dwordx4 v2, s[8:11], s20 offen offset:384 lds
    s_add_u32 m0, s19, 15872
    s_nop 0
    buffer_load_dwordx4 v2, s[8:11], s20 offen offset:512 lds
    s_add_u32 m0, s19, 19840
    s_nop 0
    buffer_load_dwordx4 v2, s[8:11], s20 offen offset:640 lds
    s_add_u32 m0, s19, 23808
    s_nop 0
    buffer_load_dwordx4 v2, s[8:11], s20 offen offset:768 lds
    s_add_u32 m0, s19, 27776
    s_nop 0
    buffer_load_dwordx4 v2, s[8:11], s20 offen offset:896 lds
    s_add_u32 m0, s19, 31744
    s_nop 0
    buffer_load_dwordx4 v2, s[8:11], s20 offen offset:1024 lds
    s_add_u32 m0, s19, 35712
    s_nop 0
    buffer_load_dwordx4 v2, s[8:11], s20 offen offset:1152 lds
    s_add_u32 m0, s19, 39680
    s_nop 0
    buffer_load_dwordx4 v2, s[8:11], s20 offen offset:1280 lds
    s_add_u32 m0, s19, 43648
    s_nop 0
    buffer_load_dwordx4 v2, s[8:11], s20 offen offset:1408 lds
    s_add_u32 m0, s19, 47616
    s_nop 0
    buffer_load_dwordx4 v2, s[8:11], s20 offen offset:1536 lds
    s_add_u32 m0, s19, 51584
    s_nop 0
    buffer_load_dwordx4 v2, s[8:11], s20 offen offset:1664 lds
    s_add_u32 m0, s19, 55552
    s_nop 0
    buffer_load_dwordx4 v2, s[8:11], s20 offen offset:1792 lds
    s_add_u32 m0, s19, 59520
    s_nop 0
    buffer_load_dwordx4 v2, s[8:11], s20 offen offset:1920 lds
    s_add_u32 s20, s20, s24
    s_add_u32 m0, s19, 65536
    s_nop 0
    buffer_load_dwordx4 v2, s[8:11], s20 offen offset:0 lds
    s_add_u32 m0, s19, 69504
    s_nop 0
    buffer_load_dwordx4 v2, s[8:11], s20 offen offset:128 lds
    s_add_u32 m0, s19, 73472
    s_nop 0
    buffer_load_dwordx4 v2, s[8:11], s20 offen offset:256 lds
    v_mov_b32 v9, s23
    s_add_u32 s23, s23, 1
    buffer_store_dword v9, v4, s[4:7], 0 offen sc1
    s_mov_b32 s23, 0
    s_waitcnt vmcnt(12)
    s_barrier
    ds_read_b128 v[20:23], v10 offset:0
    ds_read_b128 v[24:27], v10 offset:2048
    ds_read_b128 v[28:31], v11 offset:0
    ds_read_b128 v[32:35], v11 offset:2048
    ds_read_b128 v[36:39], v10 offset:4096
    ds_read_b128 v[40:43], v10 offset:6144
    ds_read_b128 v[44:47], v11 offset:4096
.p2align 6
P_qk_top:
    s_waitcnt lgkmcnt(6)
    v_mfma_f32_16x16x32_bf16 v[52:55], a[0:3], v[20:23], 0
    ds_read_b128 v[48:51], v11 offset:6144
    v_mfma_f32_16x16x32_bf16 v[56:59], a[4:7], v[20:23], 0
    s_waitcnt lgkmcnt(6)
    v_mfma_f32_16x16x32_bf16 v[60:63], a[0:3], v[24:27], 0
    ds_read_b128 v[20:23], v10 offset:8192
    s_add_u32 m0, s19, 77440
    v_mfma_f32_16x16x32_bf16 v[64:67], a[4:7], v[24:27], 0
    buffer_load_dwordx4 v2, s[8:11], s20 offen offset:384 lds
    s_waitcnt lgkmcnt(6)
    v_mfma_f32_16x16x32_bf16 v[52:55], a[8:11], v[28:31], v[52:55]
    ds_read_b128 v[24:27], v10 offset:10240
    v_mfma_f32_16x16x32_bf16 v[56:59], a[12:15], v[28:31], v[56:59]
    s_waitcnt lgkmcnt(6)
    v_mfma_f32_16x16x32_bf16 v[60:63], a[8:11], v[32:35], v[60:63]
    ds_read_b128 v[28:31], v11 offset:8192
    s_add_u32 m0, s19, 81408
    v_mfma_f32_16x16x32_bf16 v[64:67], a[12:15], v[32:35], v[64:67]
    buffer_load_dwordx4 v2, s[8:11], s20 offen offset:512 lds
    s_waitcnt lgkmcnt(6)
    v_mfma_f32_16x16x32_bf16 v[52:55], a[16:19], v[36:39], v[52:55]
    ds_read_b128 v[32:35], v11 offset:10240
    v_mfma_f32_16x16x32_bf16 v[56:59], a[20:23], v[36:39], v[56:59]
    s_waitcnt lgkmcnt(6)
    v_mfma_f32_16x16x32_bf16 v[60:63], a[16:19], v[40:43], v[60:63]
    ds_read_b128 v[36:39], v10 offset:12288
    s_add_u32 m0, s19, 85376
    v_mfma_f32_16x16x32_bf16 v[64:67], a[20:23], v[40:43], v[64:67]
    buffer_load_dwordx4 v2, s[8:11], s20 offen offset:640 lds
    s_waitcnt lgkmcnt(6)
    v_mfma_f32_16x16x32_bf16 v[52:55], a[24:27], v[44:47], v[52:55]
    ds_read_b128 v[40:43], v10 offset:14336
    v_mfma_f32_16x16x32_bf16 v[56:59], a[28:31], v[44:47], v[56:59]
    s_waitcnt lgkmcnt(6)
    v_mfma_f32_16x16x32_bf16 v[60:63], a[24:27], v[48:51], v[60:63]
    ds_read_b128 v[44:47], v11 offset:12288
    s_add_u32 m0, s19, 89344
    v_mfma_f32_16x16x32_bf16 v[64:67], a[28:31], v[48:51], v[64:67]
    buffer_load_dwordx4 v2, s[8:11], s20 offen offset:768 lds
    s_waitcnt lgkmcnt(6)
    v_mfma_f32_16x16x32_bf16 v[52:55], a[32:35], v[20:23], v[52:55]
    ds_read_b128 v[48:51], v11 offset:14336
    v_mfma_f32_16x16x32_bf16 v[56:59], a[36:39], v[20:23], v[56:59]
    s_waitcnt lgkmcnt(6)
    v_mfma_f32_16x16x32_bf16 v[60:63], a[32:35], v[24:27], v[60:63]
    ds_read_b128 v[20:23], v10 offset:16384
    s_add_u32 m0, s19, 93312
    v_mfma_f32_16x16x32_bf16 v[64:67], a[36:39], v[24:27], v[64:67]
    buffer_load_dwordx4 v2, s[8:11], s20 offen offset:896 lds
    s_waitcnt lgkmcnt(6)
    v_mfma_f32_16x16x32_bf16 v[52:55], a[40:43], v[28:31], v[52:55]
    ds_read_b128 v[24:27], v10 offset:18432
    v_mfma_f32_16x16x32_bf16 v[56:59], a[44:47], v[28:31], v[56:59]
    v_cvt_pk_bf16_f32 v84, v68, v69
    s_waitcnt lgkmcnt(6)
    v_mfma_f32_16x16x32_bf16 v[60:63], a[40:43], v[32:35], v[60:63]
    ds_read_b128 v[28:31], v11 offset:16384
    v_mfma_f32_16x16x32_bf16 v[64:67], a[44:47], v[32:35], v[64:67]
    v_cvt_pk_bf16_f32 v85, v70, v71
    s_waitcnt lgkmcnt(6)
    v_mfma_f32_16x16x32_bf16 v[52:55], a[48:51], v[36:39], v[52:55]
    ds_read_b128 v[32:35], v11 offset:18432
    v_mfma_f32_16x16x32_bf16 v[56:59], a[52:55], v[36:39], v[56:59]
    v_cvt_pk_bf16_f32 v86, v72, v73
    s_waitcnt lgkmcnt(6)
    v_mfma_f32_16x16x32_bf16 v[60:63], a[48:51], v[40:43], v[60:63]
    ds_read_b128 v[36:39], v10 offset:20480
    v_mfma_f32_16x16x32_bf16 v[64:67], a[52:55], v[40:43], v[64:67]
    v_cvt_pk_bf16_f32 v87, v74, v75
    s_waitcnt lgkmcnt(6)
    v_mfma_f32_16x16x32_bf16 v[52:55], a[56:59], v[44:47], v[52:55]
    ds_read_b128 v[40:43], v10 offset:22528
    v_mfma_f32_16x16x32_bf16 v[56:59], a[60:63], v[44:47], v[56:59]
    v_cvt_pk_bf16_f32 v88, v76, v77
    s_waitcnt lgkmcnt(6)
    v_mfma_f32_16x16x32_bf16 v[60:63], a[56:59], v[48:51], v[60:63]
    ds_read_b128 v[44:47], v11 offset:20480
    v_mfma_f32_16x16x32_bf16 v[64:67], a[60:63], v[48:51], v[64:67]
    v_cvt_pk_bf16_f32 v89, v78, v79
    buffer_store_dwordx4 v[84:87], v3, s[4:7], s21 offen offset:0 sc1
    s_waitcnt lgkmcnt(6)
    v_mfma_f32_16x16x32_bf16 v[52:55], a[64:67], v[20:23], v[52:55]
    ds_read_b128 v[48:51], v11 offset:22528
    v_mfma_f32_16x16x32_bf16 v[56:59], a[68:71], v[20:23], v[56:59]
    v_cvt_pk_bf16_f32 v90, v80, v81
    s_waitcnt lgkmcnt(6)
    v_mfma_f32_16x16x32_bf16 v[60:63], a[64:67], v[24:27], v[60:63]
    ds_read_b128 v[20:23], v10 offset:24576
    v_mfma_f32_16x16x32_bf16 v[64:67], a[68:71], v[24:27], v[64:67]
    v_cvt_pk_bf16_f32 v91, v82, v83
    s_waitcnt lgkmcnt(6)
    v_mfma_f32_16x16x32_bf16 v[52:55], a[72:75], v[28:31], v[52:55]
    ds_read_b128 v[24:27], v10 offset:26624
    v_mfma_f32_16x16x32_bf16 v[56:59], a[76:79], v[28:31], v[56:59]
    s_waitcnt lgkmcnt(6)
    v_mfma_f32_16x16x32_bf16 v[60:63], a[72:75], v[32:35], v[60:63]
    ds_read_b128 v[28:31], v11 offset:24576
    v_mfma_f32_16x16x32_bf16 v[64:67], a[76:79], v[32:35], v[64:67]
    buffer_store_dwordx4 v[88:91], v3, s[4:7], s21 offen offset:128 sc1
    s_waitcnt lgkmcnt(6)
    v_mfma_f32_16x16x32_bf16 v[52:55], a[80:83], v[36:39], v[52:55]
    ds_read_b128 v[32:35], v11 offset:26624
    v_mfma_f32_16x16x32_bf16 v[56:59], a[84:87], v[36:39], v[56:59]
    s_add_u32 s21, s21, s25
    s_mov_b32 s25, s26
    s_waitcnt lgkmcnt(6)
    v_mfma_f32_16x16x32_bf16 v[60:63], a[80:83], v[40:43], v[60:63]
    ds_read_b128 v[36:39], v10 offset:28672
    v_mfma_f32_16x16x32_bf16 v[64:67], a[84:87], v[40:43], v[64:67]
    s_waitcnt lgkmcnt(6)
    v_mfma_f32_16x16x32_bf16 v[52:55], a[88:91], v[44:47], v[52:55]
    ds_read_b128 v[40:43], v10 offset:30720
    v_mfma_f32_16x16x32_bf16 v[56:59], a[92:95], v[44:47], v[56:59]
    s_waitcnt lgkmcnt(6)
    v_mfma_f32_16x16x32_bf16 v[60:63], a[88:91], v[48:51], v[60:63]
    ds_read_b128 v[44:47], v11 offset:28672
    v_mfma_f32_16x16x32_bf16 v[64:67], a[92:95], v[48:51], v[64:67]
    s_waitcnt lgkmcnt(6)
    v_mfma_f32_16x16x32_bf16 v[52:55], a[96:99], v[20:23], v[52:55]
    ds_read_b128 v[48:51], v11 offset:30720
    v_mfma_f32_16x16x32_bf16 v[56:59], a[100:103], v[20:23], v[56:59]
    s_waitcnt lgkmcnt(6)
    v_mfma_f32_16x16x32_bf16 v[60:63], a[96:99], v[24:27], v[60:63]
    s_waitcnt vmcnt(11)
    s_barrier
    ds_read_b128 v[20:23], v10 offset:32768
    v_mfma_f32_16x16x32_bf16 v[64:67], a[100:103], v[24:27], v[64:67]
    s_waitcnt lgkmcnt(6)
    v_mfma_f32_16x16x32_bf16 v[52:55], a[104:107], v[28:31], v[52:55]
    ds_read_b128 v[24:27], v10 offset:34816
    s_add_u32 m0, s19, 97280
    v_mfma_f32_16x16x32_bf16 v[56:59], a[108:111], v[28:31], v[56:59]
    buffer_load_dwordx4 v2, s[8:11], s20 offen offset:1024 lds
    s_waitcnt lgkmcnt(6)
    v_mfma_f32_16x16x32_bf16 v[60:63], a[104:107], v[32:35], v[60:63]
    ds_read_b128 v[28:31], v11 offset:32768
    v_mfma_f32_16x16x32_bf16 v[64:67], a[108:111], v[32:35], v[64:67]
    s_waitcnt lgkmcnt(6)
    v_mfma_f32_16x16x32_bf16 v[52:55], a[112:115], v[36:39], v[52:55]
    ds_read_b128 v[32:35], v11 offset:34816
    s_add_u32 m0, s19, 101248
    v_mfma_f32_16x16x32_bf16 v[56:59], a[116:119], v[36:39], v[56:59]
    buffer_load_dwordx4 v2, s[8:11], s20 offen offset:1152 lds
    s_waitcnt lgkmcnt(6)
    v_mfma_f32_16x16x32_bf16 v[60:63], a[112:115], v[40:43], v[60:63]
    ds_read_b128 v[36:39], v10 offset:36864
    v_mfma_f32_16x16x32_bf16 v[64:67], a[116:119], v[40:43], v[64:67]
    s_waitcnt lgkmcnt(6)
    v_mfma_f32_16x16x32_bf16 v[52:55], a[120:123], v[44:47], v[52:55]
    ds_read_b128 v[40:43], v10 offset:38912
    s_add_u32 m0, s19, 105216
    v_mfma_f32_16x16x32_bf16 v[56:59], a[124:127], v[44:47], v[56:59]
    buffer_load_dwordx4 v2, s[8:11], s20 offen offset:1280 lds
    s_waitcnt lgkmcnt(6)
    v_mfma_f32_16x16x32_bf16 v[60:63], a[120:123], v[48:51], v[60:63]
    ds_read_b128 v[44:47], v11 offset:36864
    v_mfma_f32_16x16x32_bf16 v[64:67], a[124:127], v[48:51], v[64:67]
    s_waitcnt lgkmcnt(6)
    v_mfma_f32_16x16x32_bf16 v[52:55], a[128:131], v[20:23], v[52:55]
    ds_read_b128 v[48:51], v11 offset:38912
    v_mfma_f32_16x16x32_bf16 v[56:59], a[132:135], v[20:23], v[56:59]
    s_waitcnt lgkmcnt(6)
    v_mfma_f32_16x16x32_bf16 v[60:63], a[128:131], v[24:27], v[60:63]
    ds_read_b128 v[20:23], v10 offset:40960
    s_add_u32 m0, s19, 109184
    v_mfma_f32_16x16x32_bf16 v[64:67], a[132:135], v[24:27], v[64:67]
    buffer_load_dwordx4 v2, s[8:11], s20 offen offset:1408 lds
    s_waitcnt lgkmcnt(6)
    v_mfma_f32_16x16x32_bf16 v[52:55], a[136:139], v[28:31], v[52:55]
    ds_read_b128 v[24:27], v10 offset:43008
    v_mfma_f32_16x16x32_bf16 v[56:59], a[140:143], v[28:31], v[56:59]
    s_waitcnt lgkmcnt(6)
    v_mfma_f32_16x16x32_bf16 v[60:63], a[136:139], v[32:35], v[60:63]
    ds_read_b128 v[28:31], v11 offset:40960
    s_add_u32 m0, s19, 113152
    v_mfma_f32_16x16x32_bf16 v[64:67], a[140:143], v[32:35], v[64:67]
    buffer_load_dwordx4 v2, s[8:11], s20 offen offset:1536 lds
    s_waitcnt lgkmcnt(6)
    v_mfma_f32_16x16x32_bf16 v[52:55], a[144:147], v[36:39], v[52:55]
    ds_read_b128 v[32:35], v11 offset:43008
    v_mfma_f32_16x16x32_bf16 v[56:59], a[148:151], v[36:39], v[56:59]
    s_waitcnt lgkmcnt(6)
    v_mfma_f32_16x16x32_bf16 v[60:63], a[144:147], v[40:43], v[60:63]
    ds_read_b128 v[36:39], v10 offset:45056
    s_add_u32 m0, s19, 117120
    v_mfma_f32_16x16x32_bf16 v[64:67], a[148:151], v[40:43], v[64:67]
    buffer_load_dwordx4 v2, s[8:11], s20 offen offset:1664 lds
    s_waitcnt lgkmcnt(6)
    v_mfma_f32_16x16x32_bf16 v[52:55], a[152:155], v[44:47], v[52:55]
    ds_read_b128 v[40:43], v10 offset:47104
    v_mfma_f32_16x16x32_bf16 v[56:59], a[156:159], v[44:47], v[56:59]
    s_waitcnt lgkmcnt(6)
    v_mfma_f32_16x16x32_bf16 v[60:63], a[152:155], v[48:51], v[60:63]
    ds_read_b128 v[44:47], v11 offset:45056
    s_add_u32 m0, s19, 121088
    v_mfma_f32_16x16x32_bf16 v[64:67], a[156:159], v[48:51], v[64:67]
    buffer_load_dwordx4 v2, s[8:11], s20 offen offset:1792 lds
    s_waitcnt lgkmcnt(6)
    v_mfma_f32_16x16x32_bf16 v[52:55], a[160:163], v[20:23], v[52:55]
    ds_read_b128 v[48:51], v11 offset:47104
    v_mfma_f32_16x16x32_bf16 v[56:59], a[164:167], v[20:23], v[56:59]
    s_waitcnt lgkmcnt(6)
    v_mfma_f32_16x16x32_bf16 v[60:63], a[160:163], v[24:27], v[60:63]
    ds_read_b128 v[20:23], v10 offset:49152
    s_add_u32 m0, s19, 125056
    v_mfma_f32_16x16x32_bf16 v[64:67], a[164:167], v[24:27], v[64:67]
    buffer_load_dwordx4 v2, s[8:11], s20 offen offset:1920 lds
    s_waitcnt lgkmcnt(6)
    v_mfma_f32_16x16x32_bf16 v[52:55], a[168:171], v[28:31], v[52:55]
    ds_read_b128 v[24:27], v10 offset:51200
    v_mfma_f32_16x16x32_bf16 v[56:59], a[172:175], v[28:31], v[56:59]
    s_add_u32 s20, s20, s24
    s_waitcnt lgkmcnt(6)
    v_mfma_f32_16x16x32_bf16 v[60:63], a[168:171], v[32:35], v[60:63]
    ds_read_b128 v[28:31], v11 offset:49152
    v_mfma_f32_16x16x32_bf16 v[64:67], a[172:175], v[32:35], v[64:67]
    s_waitcnt lgkmcnt(6)
    v_mfma_f32_16x16x32_bf16 v[52:55], a[176:179], v[36:39], v[52:55]
    ds_read_b128 v[32:35], v11 offset:51200
    v_mfma_f32_16x16x32_bf16 v[56:59], a[180:183], v[36:39], v[56:59]
    s_waitcnt lgkmcnt(6)
    v_mfma_f32_16x16x32_bf16 v[60:63], a[176:179], v[40:43], v[60:63]
    ds_read_b128 v[36:39], v10 offset:53248
    v_mfma_f32_16x16x32_bf16 v[64:67], a[180:183], v[40:43], v[64:67]
    s_waitcnt lgkmcnt(6)
    v_mfma_f32_16x16x32_bf16 v[52:55], a[184:187], v[44:47], v[52:55]
    ds_read_b128 v[40:43], v10 offset:55296
    v_mfma_f32_16x16x32_bf16 v[56:59], a[188:191], v[44:47], v[56:59]
    s_waitcnt lgkmcnt(6)
    v_mfma_f32_16x16x32_bf16 v[60:63], a[184:187], v[48:51], v[60:63]
    ds_read_b128 v[44:47], v11 offset:53248
    v_mfma_f32_16x16x32_bf16 v[64:67], a[188:191], v[48:51], v[64:67]
    s_waitcnt lgkmcnt(6)
    v_mfma_f32_16x16x32_bf16 v[52:55], a[192:195], v[20:23], v[52:55]
    ds_read_b128 v[48:51], v11 offset:55296
    v_mfma_f32_16x16x32_bf16 v[56:59], a[196:199], v[20:23], v[56:59]
    s_waitcnt lgkmcnt(6)
    v_mfma_f32_16x16x32_bf16 v[60:63], a[192:195], v[24:27], v[60:63]
    ds_read_b128 v[20:23], v10 offset:57344
    v_mfma_f32_16x16x32_bf16 v[64:67], a[196:199], v[24:27], v[64:67]
    s_waitcnt lgkmcnt(6)
    v_mfma_f32_16x16x32_bf16 v[52:55], a[200:203], v[28:31], v[52:55]
    ds_read_b128 v[24:27], v10 offset:59392
    v_mfma_f32_16x16x32_bf16 v[56:59], a[204:207], v[28:31], v[56:59]
    s_waitcnt lgkmcnt(6)
    v_mfma_f32_16x16x32_bf16 v[60:63], a[200:203], v[32:35], v[60:63]
    ds_read_b128 v[28:31], v11 offset:57344
    v_mfma_f32_16x16x32_bf16 v[64:67], a[204:207], v[32:35], v[64:67]
    s_waitcnt lgkmcnt(6)
    v_mfma_f32_16x16x32_bf16 v[52:55], a[208:211], v[36:39], v[52:55]
    ds_read_b128 v[32:35], v11 offset:59392
    v_mfma_f32_16x16x32_bf16 v[56:59], a[212:215], v[36:39], v[56:59]
    s_waitcnt lgkmcnt(6)
    v_mfma_f32_16x16x32_bf16 v[60:63], a[208:211], v[40:43], v[60:63]
    ds_read_b128 v[36:39], v10 offset:61440
    v_mfma_f32_16x16x32_bf16 v[64:67], a[212:215], v[40:43], v[64:67]
    s_waitcnt lgkmcnt(6)
    v_mfma_f32_16x16x32_bf16 v[52:55], a[216:219], v[44:47], v[52:55]
    ds_read_b128 v[40:43], v10 offset:63488
    v_mfma_f32_16x16x32_bf16 v[56:59], a[220:223], v[44:47], v[56:59]
    s_waitcnt lgkmcnt(6)
    v_mfma_f32_16x16x32_bf16 v[60:63], a[216:219], v[48:51], v[60:63]
    ds_read_b128 v[44:47], v11 offset:61440
    v_mfma_f32_16x16x32_bf16 v[64:67], a[220:223], v[48:51], v[64:67]
    s_waitcnt lgkmcnt(6)
    v_mfma_f32_16x16x32_bf16 v[52:55], a[224:227], v[20:23], v[52:55]
    ds_read_b128 v[48:51], v11 offset:63488
    v_mfma_f32_16x16x32_bf16 v[56:59], a[228:231], v[20:23], v[56:59]
    s_waitcnt lgkmcnt(6)
    v_mfma_f32_16x16x32_bf16 v[60:63], a[224:227], v[24:27], v[60:63]
    s_waitcnt vmcnt(8)
    s_barrier
    ds_read_b128 v[20:23], v12 offset:0
    v_mfma_f32_16x16x32_bf16 v[64:67], a[228:231], v[24:27], v[64:67]
    s_waitcnt lgkmcnt(6)
    v_mfma_f32_16x16x32_bf16 v[52:55], a[232:235], v[28:31], v[52:55]
    ds_read_b128 v[24:27], v12 offset:2048
    s_add_u32 m0, s19, 0
    v_mfma_f32_16x16x32_bf16 v[56:59], a[236:239], v[28:31], v[56:59]
    buffer_load_dwordx4 v2, s[8:11], s20 offen offset:0 lds
    s_waitcnt lgkmcnt(6)
    v_mfma_f32_16x16x32_bf16 v[60:63], a[232:235], v[32:35], v[60:63]
    ds_read_b128 v[28:31], v13 offset:0
    v_mfma_f32_16x16x32_bf16 v[64:67], a[236:239], v[32:35], v[64:67]
    v_mov_b32 v9, s23
    s_add_u32 s23, s23, 1
    buffer_store_dword v9, v4, s[4:7], 0 offen sc1
    s_waitcnt lgkmcnt(6)
    v_mfma_f32_16x16x32_bf16 v[52:55], a[240:243], v[36:39], v[52:55]
    ds_read_b128 v[32:35], v13 offset:2048
    s_add_u32 m0, s19, 3968
    v_mfma_f32_16x16x32_bf16 v[56:59], a[244:247], v[36:39], v[56:59]
    buffer_load_dwordx4 v2, s[8:11], s20 offen offset:128 lds
    s_waitcnt lgkmcnt(6)
    v_mfma_f32_16x16x32_bf16 v[60:63], a[240:243], v[40:43], v[60:63]
    ds_read_b128 v[36:39], v12 offset:4096
    v_mfma_f32_16x16x32_bf16 v[64:67], a[244:247], v[40:43], v[64:67]
    s_waitcnt lgkmcnt(6)
    v_mfma_f32_16x16x32_bf16 v[52:55], a[248:251], v[44:47], v[52:55]
    ds_read_b128 v[40:43], v12 offset:6144
    s_add_u32 m0, s19, 7936
    v_mfma_f32_16x16x32_bf16 v[56:59], a[252:255], v[44:47], v[56:59]
    buffer_load_dwordx4 v2, s[8:11], s20 offen offset:256 lds
    s_waitcnt lgkmcnt(6)
    v_mfma_f32_16x16x32_bf16 v[60:63], a[248:251], v[48:51], v[60:63]
    ds_read_b128 v[44:47], v13 offset:4096
    v_mfma_f32_16x16x32_bf16 v[64:67], a[252:255], v[48:51], v[64:67]
    s_waitcnt lgkmcnt(6)
    v_mfma_f32_16x16x32_bf16 v[68:71], a[0:3], v[20:23], 0
    ds_read_b128 v[48:51], v13 offset:6144
    v_mfma_f32_16x16x32_bf16 v[72:75], a[4:7], v[20:23], 0
    s_waitcnt lgkmcnt(6)
    v_mfma_f32_16x16x32_bf16 v[76:79], a[0:3], v[24:27], 0
    ds_read_b128 v[20:23], v12 offset:8192
    s_add_u32 m0, s19, 11904
    v_mfma_f32_16x16x32_bf16 v[80:83], a[4:7], v[24:27], 0
    buffer_load_dwordx4 v2, s[8:11], s20 offen offset:384 lds
    s_waitcnt lgkmcnt(6)
    v_mfma_f32_16x16x32_bf16 v[68:71], a[8:11], v[28:31], v[68:71]
    ds_read_b128 v[24:27], v12 offset:10240
    v_mfma_f32_16x16x32_bf16 v[72:75], a[12:15], v[28:31], v[72:75]
    s_waitcnt lgkmcnt(6)
    v_mfma_f32_16x16x32_bf16 v[76:79], a[8:11], v[32:35], v[76:79]
    ds_read_b128 v[28:31], v13 offset:8192
    s_add_u32 m0, s19, 15872
    v_mfma_f32_16x16x32_bf16 v[80:83], a[12:15], v[32:35], v[80:83]
    buffer_load_dwordx4 v2, s[8:11], s20 offen offset:512 lds
    s_waitcnt lgkmcnt(6)
    v_mfma_f32_16x16x32_bf16 v[68:71], a[16:19], v[36:39], v[68:71]
    ds_read_b128 v[32:35], v13 offset:10240
    v_mfma_f32_16x16x32_bf16 v[72:75], a[20:23], v[36:39], v[72:75]
    s_waitcnt lgkmcnt(6)
    v_mfma_f32_16x16x32_bf16 v[76:79], a[16:19], v[40:43], v[76:79]
    ds_read_b128 v[36:39], v12 offset:12288
    s_add_u32 m0, s19, 19840
    v_mfma_f32_16x16x32_bf16 v[80:83], a[20:23], v[40:43], v[80:83]
    buffer_load_dwordx4 v2, s[8:11], s20 offen offset:640 lds
    s_waitcnt lgkmcnt(6)
    v_mfma_f32_16x16x32_bf16 v[68:71], a[24:27], v[44:47], v[68:71]
    ds_read_b128 v[40:43], v12 offset:14336
    v_mfma_f32_16x16x32_bf16 v[72:75], a[28:31], v[44:47], v[72:75]
    s_waitcnt lgkmcnt(6)
    v_mfma_f32_16x16x32_bf16 v[76:79], a[24:27], v[48:51], v[76:79]
    ds_read_b128 v[44:47], v13 offset:12288
    s_add_u32 m0, s19, 23808
    v_mfma_f32_16x16x32_bf16 v[80:83], a[28:31], v[48:51], v[80:83]
    buffer_load_dwordx4 v2, s[8:11], s20 offen offset:768 lds
    s_waitcnt lgkmcnt(6)
    v_mfma_f32_16x16x32_bf16 v[68:71], a[32:35], v[20:23], v[68:71]
    ds_read_b128 v[48:51], v13 offset:14336
    v_mfma_f32_16x16x32_bf16 v[72:75], a[36:39], v[20:23], v[72:75]
    s_waitcnt lgkmcnt(6)
    v_mfma_f32_16x16x32_bf16 v[76:79], a[32:35], v[24:27], v[76:79]
    ds_read_b128 v[20:23], v12 offset:16384
    s_add_u32 m0, s19, 27776
    v_mfma_f32_16x16x32_bf16 v[80:83], a[36:39], v[24:27], v[80:83]
    buffer_load_dwordx4 v2, s[8:11], s20 offen offset:896 lds
    s_waitcnt lgkmcnt(6)
    v_mfma_f32_16x16x32_bf16 v[68:71], a[40:43], v[28:31], v[68:71]
    ds_read_b128 v[24:27], v12 offset:18432
    v_mfma_f32_16x16x32_bf16 v[72:75], a[44:47], v[28:31], v[72:75]
    v_cvt_pk_bf16_f32 v84, v52, v53
    s_waitcnt lgkmcnt(6)
    v_mfma_f32_16x16x32_bf16 v[76:79], a[40:43], v[32:35], v[76:79]
    ds_read_b128 v[28:31], v13 offset:16384
    v_mfma_f32_16x16x32_bf16 v[80:83], a[44:47], v[32:35], v[80:83]
    v_cvt_pk_bf16_f32 v85, v54, v55
    s_waitcnt lgkmcnt(6)
    v_mfma_f32_16x16x32_bf16 v[68:71], a[48:51], v[36:39], v[68:71]
    ds_read_b128 v[32:35], v13 offset:18432
    v_mfma_f32_16x16x32_bf16 v[72:75], a[52:55], v[36:39], v[72:75]
    v_cvt_pk_bf16_f32 v86, v56, v57
    s_waitcnt lgkmcnt(6)
    v_mfma_f32_16x16x32_bf16 v[76:79], a[48:51], v[40:43], v[76:79]
    ds_read_b128 v[36:39], v12 offset:20480
    v_mfma_f32_16x16x32_bf16 v[80:83], a[52:55], v[40:43], v[80:83]
    v_cvt_pk_bf16_f32 v87, v58, v59
    s_waitcnt lgkmcnt(6)
    v_mfma_f32_16x16x32_bf16 v[68:71], a[56:59], v[44:47], v[68:71]
    ds_read_b128 v[40:43], v12 offset:22528
    v_mfma_f32_16x16x32_bf16 v[72:75], a[60:63], v[44:47], v[72:75]
    v_cvt_pk_bf16_f32 v88, v60, v61
    s_waitcnt lgkmcnt(6)
    v_mfma_f32_16x16x32_bf16 v[76:79], a[56:59], v[48:51], v[76:79]
    ds_read_b128 v[44:47], v13 offset:20480
    v_mfma_f32_16x16x32_bf16 v[80:83], a[60:63], v[48:51], v[80:83]
    v_cvt_pk_bf16_f32 v89, v62, v63
    buffer_store_dwordx4 v[84:87], v3, s[4:7], s21 offen offset:0 sc1
    s_waitcnt lgkmcnt(6)
    v_mfma_f32_16x16x32_bf16 v[68:71], a[64:67], v[20:23], v[68:71]
    ds_read_b128 v[48:51], v13 offset:22528
    v_mfma_f32_16x16x32_bf16 v[72:75], a[68:71], v[20:23], v[72:75]
    v_cvt_pk_bf16_f32 v90, v64, v65
    s_waitcnt lgkmcnt(6)
    v_mfma_f32_16x16x32_bf16 v[76:79], a[64:67], v[24:27], v[76:79]
    ds_read_b128 v[20:23], v12 offset:24576
    v_mfma_f32_16x16x32_bf16 v[80:83], a[68:71], v[24:27], v[80:83]
    v_cvt_pk_bf16_f32 v91, v66, v67
    s_waitcnt lgkmcnt(6)
    v_mfma_f32_16x16x32_bf16 v[68:71], a[72:75], v[28:31], v[68:71]
    ds_read_b128 v[24:27], v12 offset:26624
    v_mfma_f32_16x16x32_bf16 v[72:75], a[76:79], v[28:31], v[72:75]
    s_waitcnt lgkmcnt(6)
    v_mfma_f32_16x16x32_bf16 v[76:79], a[72:75], v[32:35], v[76:79]
    ds_read_b128 v[28:31], v13 offset:24576
    v_mfma_f32_16x16x32_bf16 v[80:83], a[76:79], v[32:35], v[80:83]
    buffer_store_dwordx4 v[88:91], v3, s[4:7], s21 offen offset:128 sc1
    s_waitcnt lgkmcnt(6)
    v_mfma_f32_16x16x32_bf16 v[68:71], a[80:83], v[36:39], v[68:71]
    ds_read_b128 v[32:35], v13 offset:26624
    v_mfma_f32_16x16x32_bf16 v[72:75], a[84:87], v[36:39], v[72:75]
    s_add_u32 s21, s21, s25
    s_mov_b32 s25, s26
    s_waitcnt lgkmcnt(6)
    v_mfma_f32_16x16x32_bf16 v[76:79], a[80:83], v[40:43], v[76:79]
    ds_read_b128 v[36:39], v12 offset:28672
    v_mfma_f32_16x16x32_bf16 v[80:83], a[84:87], v[40:43], v[80:83]
    s_waitcnt lgkmcnt(6)
    v_mfma_f32_16x16x32_bf16 v[68:71], a[88:91], v[44:47], v[68:71]
    ds_read_b128 v[40:43], v12 offset:30720
    v_mfma_f32_16x16x32_bf16 v[72:75], a[92:95], v[44:47], v[72:75]
    s_waitcnt lgkmcnt(6)
    v_mfma_f32_16x16x32_bf16 v[76:79], a[88:91], v[48:51], v[76:79]
    ds_read_b128 v[44:47], v13 offset:28672
    v_mfma_f32_16x16x32_bf16 v[80:83], a[92:95], v[48:51], v[80:83]
    s_waitcnt lgkmcnt(6)
    v_mfma_f32_16x16x32_bf16 v[68:71], a[96:99], v[20:23], v[68:71]
    ds_read_b128 v[48:51], v13 offset:30720
    v_mfma_f32_16x16x32_bf16 v[72:75], a[100:103], v[20:23], v[72:75]
    s_waitcnt lgkmcnt(6)
    v_mfma_f32_16x16x32_bf16 v[76:79], a[96:99], v[24:27], v[76:79]
    s_waitcnt vmcnt(11)
    s_barrier
    ds_read_b128 v[20:23], v12 offset:32768
    v_mfma_f32_16x16x32_bf16 v[80:83], a[100:103], v[24:27], v[80:83]
    s_waitcnt lgkmcnt(6)
    v_mfma_f32_16x16x32_bf16 v[68:71], a[104:107], v[28:31], v[68:71]
    ds_read_b128 v[24:27], v12 offset:34816
    s_add_u32 m0, s19, 31744
    v_mfma_f32_16x16x32_bf16 v[72:75], a[108:111], v[28:31], v[72:75]
    buffer_load_dwordx4 v2, s[8:11], s20 offen offset:1024 lds
    s_waitcnt lgkmcnt(6)
    v_mfma_f32_16x16x32_bf16 v[76:79], a[104:107], v[32:35], v[76:79]
    ds_read_b128 v[28:31], v13 offset:32768
    v_mfma_f32_16x16x32_bf16 v[80:83], a[108:111], v[32:35], v[80:83]
    s_waitcnt lgkmcnt(6)
    v_mfma_f32_16x16x32_bf16 v[68:71], a[112:115], v[36:39], v[68:71]
    ds_read_b128 v[32:35], v13 offset:34816
    s_add_u32 m0, s19, 35712
    v_mfma_f32_16x16x32_bf16 v[72:75], a[116:119], v[36:39], v[72:75]
    buffer_load_dwordx4 v2, s[8:11], s20 offen offset:1152 lds
    s_waitcnt lgkmcnt(6)
    v_mfma_f32_16x16x32_bf16 v[76:79], a[112:115], v[40:43], v[76:79]
    ds_read_b128 v[36:39], v12 offset:36864
    v_mfma_f32_16x16x32_bf16 v[80:83], a[116:119], v[40:43], v[80:83]
    s_waitcnt lgkmcnt(6)
    v_mfma_f32_16x16x32_bf16 v[68:71], a[120:123], v[44:47], v[68:71]
    ds_read_b128 v[40:43], v12 offset:38912
    s_add_u32 m0, s19, 39680
    v_mfma_f32_16x16x32_bf16 v[72:75], a[124:127], v[44:47], v[72:75]
    buffer_load_dwordx4 v2, s[8:11], s20 offen offset:1280 lds
    s_waitcnt lgkmcnt(6)
    v_mfma_f32_16x16x32_bf16 v[76:79], a[120:123], v[48:51], v[76:79]
    ds_read_b128 v[44:47], v13 offset:36864
    v_mfma_f32_16x16x32_bf16 v[80:83], a[124:127], v[48:51], v[80:83]
    s_waitcnt lgkmcnt(6)
    v_mfma_f32_16x16x32_bf16 v[68:71], a[128:131], v[20:23], v[68:71]
    ds_read_b128 v[48:51], v13 offset:38912
    v_mfma_f32_16x16x32_bf16 v[72:75], a[132:135], v[20:23], v[72:75]
    s_waitcnt lgkmcnt(6)
    v_mfma_f32_16x16x32_bf16 v[76:79], a[128:131], v[24:27], v[76:79]
    ds_read_b128 v[20:23], v12 offset:40960
    s_add_u32 m0, s19, 43648
    v_mfma_f32_16x16x32_bf16 v[80:83], a[132:135], v[24:27], v[80:83]
    buffer_load_dwordx4 v2, s[8:11], s20 offen offset:1408 lds
    s_waitcnt lgkmcnt(6)
    v_mfma_f32_16x16x32_bf16 v[68:71], a[136:139], v[28:31], v[68:71]
    ds_read_b128 v[24:27], v12 offset:43008
    v_mfma_f32_16x16x32_bf16 v[72:75], a[140:143], v[28:31], v[72:75]
    s_waitcnt lgkmcnt(6)
    v_mfma_f32_16x16x32_bf16 v[76:79], a[136:139], v[32:35], v[76:79]
    ds_read_b128 v[28:31], v13 offset:40960
    s_add_u32 m0, s19, 47616
    v_mfma_f32_16x16x32_bf16 v[80:83], a[140:143], v[32:35], v[80:83]
    buffer_load_dwordx4 v2, s[8:11], s20 offen offset:1536 lds
    s_waitcnt lgkmcnt(6)
    v_mfma_f32_16x16x32_bf16 v[68:71], a[144:147], v[36:39], v[68:71]
    ds_read_b128 v[32:35], v13 offset:43008
    v_mfma_f32_16x16x32_bf16 v[72:75], a[148:151], v[36:39], v[72:75]
    s_waitcnt lgkmcnt(6)
    v_mfma_f32_16x16x32_bf16 v[76:79], a[144:147], v[40:43], v[76:79]
    ds_read_b128 v[36:39], v12 offset:45056
    s_add_u32 m0, s19, 51584
    v_mfma_f32_16x16x32_bf16 v[80:83], a[148:151], v[40:43], v[80:83]
    buffer_load_dwordx4 v2, s[8:11], s20 offen offset:1664 lds
    s_waitcnt lgkmcnt(6)
    v_mfma_f32_16x16x32_bf16 v[68:71], a[152:155], v[44:47], v[68:71]
    ds_read_b128 v[40:43], v12 offset:47104
    v_mfma_f32_16x16x32_bf16 v[72:75], a[156:159], v[44:47], v[72:75]
    s_waitcnt lgkmcnt(6)
    v_mfma_f32_16x16x32_bf16 v[76:79], a[152:155], v[48:51], v[76:79]
    ds_read_b128 v[44:47], v13 offset:45056
    s_add_u32 m0, s19, 55552
    v_mfma_f32_16x16x32_bf16 v[80:83], a[156:159], v[48:51], v[80:83]
    buffer_load_dwordx4 v2, s[8:11], s20 offen offset:1792 lds
    s_waitcnt lgkmcnt(6)
    v_mfma_f32_16x16x32_bf16 v[68:71], a[160:163], v[20:23], v[68:71]
    ds_read_b128 v[48:51], v13 offset:47104
    v_mfma_f32_16x16x32_bf16 v[72:75], a[164:167], v[20:23], v[72:75]
    s_waitcnt lgkmcnt(6)
    v_mfma_f32_16x16x32_bf16 v[76:79], a[160:163], v[24:27], v[76:79]
    ds_read_b128 v[20:23], v12 offset:49152
    s_add_u32 m0, s19, 59520
    v_mfma_f32_16x16x32_bf16 v[80:83], a[164:167], v[24:27], v[80:83]
    buffer_load_dwordx4 v2, s[8:11], s20 offen offset:1920 lds
    s_waitcnt lgkmcnt(6)
    v_mfma_f32_16x16x32_bf16 v[68:71], a[168:171], v[28:31], v[68:71]
    ds_read_b128 v[24:27], v12 offset:51200
    v_mfma_f32_16x16x32_bf16 v[72:75], a[172:175], v[28:31], v[72:75]
    s_add_u32 s20, s20, s24
    s_waitcnt lgkmcnt(6)
    v_mfma_f32_16x16x32_bf16 v[76:79], a[168:171], v[32:35], v[76:79]
    ds_read_b128 v[28:31], v13 offset:49152
    v_mfma_f32_16x16x32_bf16 v[80:83], a[172:175], v[32:35], v[80:83]
    s_waitcnt lgkmcnt(6)
    v_mfma_f32_16x16x32_bf16 v[68:71], a[176:179], v[36:39], v[68:71]
    ds_read_b128 v[32:35], v13 offset:51200
    v_mfma_f32_16x16x32_bf16 v[72:75], a[180:183], v[36:39], v[72:75]
    s_waitcnt lgkmcnt(6)
    v_mfma_f32_16x16x32_bf16 v[76:79], a[176:179], v[40:43], v[76:79]
    ds_read_b128 v[36:39], v12 offset:53248
    v_mfma_f32_16x16x32_bf16 v[80:83], a[180:183], v[40:43], v[80:83]
    s_waitcnt lgkmcnt(6)
    v_mfma_f32_16x16x32_bf16 v[68:71], a[184:187], v[44:47], v[68:71]
    ds_read_b128 v[40:43], v12 offset:55296
    v_mfma_f32_16x16x32_bf16 v[72:75], a[188:191], v[44:47], v[72:75]
    s_waitcnt lgkmcnt(6)
    v_mfma_f32_16x16x32_bf16 v[76:79], a[184:187], v[48:51], v[76:79]
    ds_read_b128 v[44:47], v13 offset:53248
    v_mfma_f32_16x16x32_bf16 v[80:83], a[188:191], v[48:51], v[80:83]
    s_waitcnt lgkmcnt(6)
    v_mfma_f32_16x16x32_bf16 v[68:71], a[192:195], v[20:23], v[68:71]
    ds_read_b128 v[48:51], v13 offset:55296
    v_mfma_f32_16x16x32_bf16 v[72:75], a[196:199], v[20:23], v[72:75]
    s_waitcnt lgkmcnt(6)
    v_mfma_f32_16x16x32_bf16 v[76:79], a[192:195], v[24:27], v[76:79]
    ds_read_b128 v[20:23], v12 offset:57344
    v_mfma_f32_16x16x32_bf16 v[80:83], a[196:199], v[24:27], v[80:83]
    s_waitcnt lgkmcnt(6)
    v_mfma_f32_16x16x32_bf16 v[68:71], a[200:203], v[28:31], v[68:71]
    ds_read_b128 v[24:27], v12 offset:59392
    v_mfma_f32_16x16x32_bf16 v[72:75], a[204:207], v[28:31], v[72:75]
    s_waitcnt lgkmcnt(6)
    v_mfma_f32_16x16x32_bf16 v[76:79], a[200:203], v[32:35], v[76:79]
    ds_read_b128 v[28:31], v13 offset:57344
    v_mfma_f32_16x16x32_bf16 v[80:83], a[204:207], v[32:35], v[80:83]
    s_waitcnt lgkmcnt(6)
    v_mfma_f32_16x16x32_bf16 v[68:71], a[208:211], v[36:39], v[68:71]
    ds_read_b128 v[32:35], v13 offset:59392
    v_mfma_f32_16x16x32_bf16 v[72:75], a[212:215], v[36:39], v[72:75]
    s_waitcnt lgkmcnt(6)
    v_mfma_f32_16x16x32_bf16 v[76:79], a[208:211], v[40:43], v[76:79]
    ds_read_b128 v[36:39], v12 offset:61440
    v_mfma_f32_16x16x32_bf16 v[80:83], a[212:215], v[40:43], v[80:83]
    s_waitcnt lgkmcnt(6)
    v_mfma_f32_16x16x32_bf16 v[68:71], a[216:219], v[44:47], v[68:71]
    ds_read_b128 v[40:43], v12 offset:63488
    v_mfma_f32_16x16x32_bf16 v[72:75], a[220:223], v[44:47], v[72:75]
    s_waitcnt lgkmcnt(6)
    v_mfma_f32_16x16x32_bf16 v[76:79], a[216:219], v[48:51], v[76:79]
    ds_read_b128 v[44:47], v13 offset:61440
    v_mfma_f32_16x16x32_bf16 v[80:83], a[220:223], v[48:51], v[80:83]
    s_waitcnt lgkmcnt(6)
    v_mfma_f32_16x16x32_bf16 v[68:71], a[224:227], v[20:23], v[68:71]
    ds_read_b128 v[48:51], v13 offset:63488
    v_mfma_f32_16x16x32_bf16 v[72:75], a[228:231], v[20:23], v[72:75]
    s_waitcnt lgkmcnt(6)
    v_mfma_f32_16x16x32_bf16 v[76:79], a[224:227], v[24:27], v[76:79]
    s_waitcnt vmcnt(8)
    s_barrier
    ds_read_b128 v[20:23], v10 offset:0
    v_mfma_f32_16x16x32_bf16 v[80:83], a[228:231], v[24:27], v[80:83]
    s_waitcnt lgkmcnt(6)
    v_mfma_f32_16x16x32_bf16 v[68:71], a[232:235], v[28:31], v[68:71]
    ds_read_b128 v[24:27], v10 offset:2048
    s_add_u32 m0, s19, 65536
    v_mfma_f32_16x16x32_bf16 v[72:75], a[236:239], v[28:31], v[72:75]
    buffer_load_dwordx4 v2, s[8:11], s20 offen offset:0 lds
    s_waitcnt lgkmcnt(6)
    v_mfma_f32_16x16x32_bf16 v[76:79], a[232:235], v[32:35], v[76:79]
    ds_read_b128 v[28:31], v11 offset:0
    v_mfma_f32_16x16x32_bf16 v[80:83], a[236:239], v[32:35], v[80:83]
    v_mov_b32 v9, s23
    s_add_u32 s23, s23, 1
    buffer_store_dword v9, v4, s[4:7], 0 offen sc1
    s_waitcnt lgkmcnt(6)
    v_mfma_f32_16x16x32_bf16 v[68:71], a[240:243], v[36:39], v[68:71]
    ds_read_b128 v[32:35], v11 offset:2048
    s_add_u32 m0, s19, 69504
    v_mfma_f32_16x16x32_bf16 v[72:75], a[244:247], v[36:39], v[72:75]
    buffer_load_dwordx4 v2, s[8:11], s20 offen offset:128 lds
    s_waitcnt lgkmcnt(6)
    v_mfma_f32_16x16x32_bf16 v[76:79], a[240:243], v[40:43], v[76:79]
    ds_read_b128 v[36:39], v10 offset:4096
    v_mfma_f32_16x16x32_bf16 v[80:83], a[244:247], v[40:43], v[80:83]
    s_waitcnt lgkmcnt(6)
    v_mfma_f32_16x16x32_bf16 v[68:71], a[248:251], v[44:47], v[68:71]
    ds_read_b128 v[40:43], v10 offset:6144
    s_add_u32 m0, s19, 73472
    v_mfma_f32_16x16x32_bf16 v[72:75], a[252:255], v[44:47], v[72:75]
    buffer_load_dwordx4 v2, s[8:11], s20 offen offset:256 lds
    s_waitcnt lgkmcnt(6)
    v_mfma_f32_16x16x32_bf16 v[76:79], a[248:251], v[48:51], v[76:79]
    ds_read_b128 v[44:47], v11 offset:4096
    v_mfma_f32_16x16x32_bf16 v[80:83], a[252:255], v[48:51], v[80:83]
    s_add_u32 s22, s22, 2
    s_cmp_lt_u32 s22, 64
    s_cbranch_scc1 P_qk_top
    v_cvt_pk_bf16_f32 v84, v68, v69
    v_cvt_pk_bf16_f32 v85, v70, v71
    v_cvt_pk_bf16_f32 v86, v72, v73
    v_cvt_pk_bf16_f32 v87, v74, v75
    v_cvt_pk_bf16_f32 v88, v76, v77
    v_cvt_pk_bf16_f32 v89, v78, v79
    v_cvt_pk_bf16_f32 v90, v80, v81
    v_cvt_pk_bf16_f32 v91, v82, v83
    buffer_store_dwordx4 v[84:87], v3, s[4:7], s21 offen offset:0 sc1
    buffer_store_dwordx4 v[88:91], v3, s[4:7], s21 offen offset:128 sc1
    s_waitcnt vmcnt(0) lgkmcnt(0)
    v_mov_b32 v9, s23
    s_add_u32 s23, s23, 1
    buffer_store_dword v9, v4, s[4:7], 0 offen sc1
    s_branch W_U
P_v:
    s_mov_b32 s26, s25
    s_sub_u32 s25, s21, 1073741824
    s_mov_b32 s21, 1073741824
    s_mov_b32 s23, 0
    s_mov_b32 s22, 0
    s_add_u32 m0, s19, 0
    s_nop 0
    buffer_load_dwordx4 v2, s[8:11], s20 offen offset:0 lds
    s_add_u32 m0, s19, 3968
    s_nop 0
    buffer_load_dwordx4 v2, s[8:11], s20 offen offset:128 lds
    s_add_u32 m0, s19, 7936
    s_nop 0
    buffer_load_dwordx4 v2, s[8:11], s20 offen offset:256 lds
    s_add_u32 m0, s19, 11904
    s_nop 0
    buffer_load_dwordx4 v2, s[8:11], s20 offen offset:384 lds
    s_add_u32 m0, s19, 15872
    s_nop 0
    buffer_load_dwordx4 v2, s[8:11], s20 offen offset:512 lds
    s_add_u32 m0, s19, 19840
    s_nop 0
    buffer_load_dwordx4 v2, s[8:11], s20 offen offset:640 lds
    s_add_u32 m0, s19, 23808
    s_nop 0
    buffer_load_dwordx4 v2, s[8:11], s20 offen offset:768 lds
    s_add_u32 m0, s19, 27776
    s_nop 0
    buffer_load_dwordx4 v2, s[8:11], s20 offen offset:896 lds
    s_add_u32 m0, s19, 31744
    s_nop 0
    buffer_load_dwordx4 v2, s[8:11], s20 offen offset:1024 lds
    s_add_u32 m0, s19, 35712
    s_nop 0
    buffer_load_dwordx4 v2, s[8:11], s20 offen offset:1152 lds
    s_add_u32 m0, s19, 39680
    s_nop 0
    buffer_load_dwordx4 v2, s[8:11], s20 offen offset:1280 lds
    s_add_u32 m0, s19, 43648
    s_nop 0
    buffer_load_dwordx4 v2, s[8:11], s20 offen offset:1408 lds
    s_add_u32 m0, s19, 47616
    s_nop 0
    buffer_load_dwordx4 v2, s[8:11], s20 offen offset:1536 lds
    s_add_u32 m0, s19, 51584
    s_nop 0
    buffer_load_dwordx4 v2, s[8:11], s20 offen offset:1664 lds
    s_add_u32 m0, s19, 55552
    s_nop 0
    buffer_load_dwordx4 v2, s[8:11], s20 offen offset:1792 lds
    s_add_u32 m0, s19, 59520
    s_nop 0
    buffer_load_dwordx4 v2, s[8:11], s20 offen offset:1920 lds
    s_add_u32 s20, s20, s24
    s_add_u32 m0, s19, 65536
    s_nop 0
    buffer_load_dwordx4 v2, s[8:11], s20 offen offset:0 lds
    s_add_u32 m0, s19, 69504
    s_nop 0
    buffer_load_dwordx4 v2, s[8:11], s20 offen offset:128 lds
    s_add_u32 m0, s19, 73472
    s_nop 0
    buffer_load_dwordx4 v2, s[8:11], s20 offen offset:256 lds
    v_mov_b32 v9, s23
    s_add_u32 s23, s23, 1
    buffer_store_dword v9, v4, s[4:7], 0 offen sc1
    s_mov_b32 s23, 0
    s_waitcnt vmcnt(12)
    s_barrier
    ds_read_b128 v[20:23], v10 offset:0
    ds_read_b128 v[24:27], v10 offset:2048
    ds_read_b128 v[28:31], v11 offset:0
    ds_read_b128 v[32:35], v11 offset:2048
    ds_read_b128 v[36:39], v10 offset:4096
    ds_read_b128 v[40:43], v10 offset:6144
    ds_read_b128 v[44:47], v11 offset:4096
.p2align 6
P_v_top:
    s_waitcnt lgkmcnt(6)
    v_mfma_f32_16x16x32_bf16 v[52:55], v[20:23], a[0:3], 0
    ds_read_b128 v[48:51], v11 offset:6144
    v_mfma_f32_16x16x32_bf16 v[60:63], v[20:23], a[4:7], 0
    s_waitcnt lgkmcnt(6)
    v_mfma_f32_16x16x32_bf16 v[56:59], v[24:27], a[0:3], 0
    ds_read_b128 v[20:23], v10 offset:8192
    s_add_u32 m0, s19, 77440
    v_mfma_f32_16x16x32_bf16 v[64:67], v[24:27], a[4:7], 0
    buffer_load_dwordx4 v2, s[8:11], s20 offen offset:384 lds
    s_waitcnt lgkmcnt(6)
    v_mfma_f32_16x16x32_bf16 v[52:55], v[28:31], a[8:11], v[52:55]
    ds_read_b128 v[24:27], v10 offset:10240
    v_mfma_f32_16x16x32_bf16 v[60:63], v[28:31], a[12:15], v[60:63]
    s_waitcnt lgkmcnt(6)
    v_mfma_f32_16x16x32_bf16 v[56:59], v[32:35], a[8:11], v[56:59]
    ds_read_b128 v[28:31], v11 offset:8192
    s_add_u32 m0, s19, 81408
    v_mfma_f32_16x16x32_bf16 v[64:67], v[32:35], a[12:15], v[64:67]
    buffer_load_dwordx4 v2, s[8:11], s20 offen offset:512 lds
    s_waitcnt lgkmcnt(6)
    v_mfma_f32_16x16x32_bf16 v[52:55], v[36:39], a[16:19], v[52:55]
    ds_read_b128 v[32:35], v11 offset:10240
    v_mfma_f32_16x16x32_bf16 v[60:63], v[36:39], a[20:23], v[60:63]
    s_waitcnt lgkmcnt(6)
    v_mfma_f32_16x16x32_bf16 v[56:59], v[40:43], a[16:19], v[56:59]
    ds_read_b128 v[36:39], v10 offset:12288
    s_add_u32 m0, s19, 85376
    v_mfma_f32_16x16x32_bf16 v[64:67], v[40:43], a[20:23], v[64:67]
    buffer_load_dwordx4 v2, s[8:11], s20 offen offset:640 lds
    s_waitcnt lgkmcnt(6)
    v_mfma_f32_16x16x32_bf16 v[52:55], v[44:47], a[24:27], v[52:55]
    ds_read_b128 v[40:43], v10 offset:14336
    v_mfma_f32_16x16x32_bf16 v[60:63], v[44:47], a[28:31], v[60:63]
    s_waitcnt lgkmcnt(6)
    v_mfma_f32_16x16x32_bf16 v[56:59], v[48:51], a[24:27], v[56:59]
    ds_read_b128 v[44:47], v11 offset:12288
    s_add_u32 m0, s19, 89344
    v_mfma_f32_16x16x32_bf16 v[64:67], v[48:51], a[28:31], v[64:67]
    buffer_load_dwordx4 v2, s[8:11], s20 offen offset:768 lds
    s_waitcnt lgkmcnt(6)
    v_mfma_f32_16x16x32_bf16 v[52:55], v[20:23], a[32:35], v[52:55]
    ds_read_b128 v[48:51], v11 offset:14336
    v_mfma_f32_16x16x32_bf16 v[60:63], v[20:23], a[36:39], v[60:63]
    s_waitcnt lgkmcnt(6)
    v_mfma_f32_16x16x32_bf16 v[56:59], v[24:27], a[32:35], v[56:59]
    ds_read_b128 v[20:23], v10 offset:16384
    s_add_u32 m0, s19, 93312
    v_mfma_f32_16x16x32_bf16 v[64:67], v[24:27], a[36:39], v[64:67]
    buffer_load_dwordx4 v2, s[8:11], s20 offen offset:896 lds
    s_waitcnt lgkmcnt(6)
    v_mfma_f32_16x16x32_bf16 v[52:55], v[28:31], a[40:43], v[52:55]
    ds_read_b128 v[24:27], v10 offset:18432
    v_mfma_f32_16x16x32_bf16 v[60:63], v[28:31], a[44:47], v[60:63]
    v_cvt_pk_bf16_f32 v84, v68, v69
    s_waitcnt lgkmcnt(6)
    v_mfma_f32_16x16x32_bf16 v[56:59], v[32:35], a[40:43], v[56:59]
    ds_read_b128 v[28:31], v11 offset:16384
    v_mfma_f32_16x16x32_bf16 v[64:67], v[32:35], a[44:47], v[64:67]
    v_cvt_pk_bf16_f32 v85, v70, v71
    s_waitcnt lgkmcnt(6)
    v_mfma_f32_16x16x32_bf16 v[52:55], v[36:39], a[48:51], v[52:55]
    ds_read_b128 v[32:35], v11 offset:18432
    v_mfma_f32_16x16x32_bf16 v[60:63], v[36:39], a[52:55], v[60:63]
    v_cvt_pk_bf16_f32 v86, v72, v73
    s_waitcnt lgkmcnt(6)
    v_mfma_f32_16x16x32_bf16 v[56:59], v[40:43], a[48:51], v[56:59]
    ds_read_b128 v[36:39], v10 offset:20480
    v_mfma_f32_16x16x32_bf16 v[64:67], v[40:43], a[52:55], v[64:67]
    v_cvt_pk_bf16_f32 v87, v74, v75
    s_waitcnt lgkmcnt(6)
    v_mfma_f32_16x16x32_bf16 v[52:55], v[44:47], a[56:59], v[52:55]
    ds_read_b128 v[40:43], v10 offset:22528
    v_mfma_f32_16x16x32_bf16 v[60:63], v[44:47], a[60:63], v[60:63]
    v_cvt_pk_bf16_f32 v88, v76, v77
    s_waitcnt lgkmcnt(6)
    v_mfma_f32_16x16x32_bf16 v[56:59], v[48:51], a[56:59], v[56:59]
    ds_read_b128 v[44:47], v11 offset:20480
    v_mfma_f32_16x16x32_bf16 v[64:67], v[48:51], a[60:63], v[64:67]
    v_cvt_pk_bf16_f32 v89, v78, v79
    buffer_store_dwordx4 v[84:87], v3, s[4:7], s21 offen offset:0 sc1
    s_waitcnt lgkmcnt(6)
    v_mfma_f32_16x16x32_bf16 v[52:55], v[20:23], a[64:67], v[52:55]
    ds_read_b128 v[48:51], v11 offset:22528
    v_mfma_f32_16x16x32_bf16 v[60:63], v[20:23], a[68:71], v[60:63]
    v_cvt_pk_bf16_f32 v90, v80, v81
    s_waitcnt lgkmcnt(6)
    v_mfma_f32_16x16x32_bf16 v[56:59], v[24:27], a[64:67], v[56:59]
    ds_read_b128 v[20:23], v10 offset:24576
    v_mfma_f32_16x16x32_bf16 v[64:67], v[24:27], a[68:71], v[64:67]
    v_cvt_pk_bf16_f32 v91, v82, v83
    s_waitcnt lgkmcnt(6)
    v_mfma_f32_16x16x32_bf16 v[52:55], v[28:31], a[72:75], v[52:55]
    ds_read_b128 v[24:27], v10 offset:26624
    v_mfma_f32_16x16x32_bf16 v[60:63], v[28:31], a[76:79], v[60:63]
    s_waitcnt lgkmcnt(6)
    v_mfma_f32_16x16x32_bf16 v[56:59], v[32:35], a[72:75], v[56:59]
    ds_read_b128 v[28:31], v11 offset:24576
    v_mfma_f32_16x16x32_bf16 v[64:67], v[32:35], a[76:79], v[64:67]
    buffer_store_dwordx4 v[88:91], v3, s[4:7], s21 offen offset:128 sc1
    s_waitcnt lgkmcnt(6)
    v_mfma_f32_16x16x32_bf16 v[52:55], v[36:39], a[80:83], v[52:55]
    ds_read_b128 v[32:35], v11 offset:26624
    v_mfma_f32_16x16x32_bf16 v[60:63], v[36:39], a[84:87], v[60:63]
    s_add_u32 s21, s21, s25
    s_mov_b32 s25, s26
    s_waitcnt lgkmcnt(6)
    v_mfma_f32_16x16x32_bf16 v[56:59], v[40:43], a[80:83], v[56:59]
    ds_read_b128 v[36:39], v10 offset:28672
    v_mfma_f32_16x16x32_bf16 v[64:67], v[40:43], a[84:87], v[64:67]
    s_waitcnt lgkmcnt(6)
    v_mfma_f32_16x16x32_bf16 v[52:55], v[44:47], a[88:91], v[52:55]
    ds_read_b128 v[40:43], v10 offset:30720
    v_mfma_f32_16x16x32_bf16 v[60:63], v[44:47], a[92:95], v[60:63]
    s_waitcnt lgkmcnt(6)
    v_mfma_f32_16x16x32_bf16 v[56:59], v[48:51], a[88:91], v[56:59]
    ds_read_b128 v[44:47], v11 offset:28672
    v_mfma_f32_16x16x32_bf16 v[64:67], v[48:51], a[92:95], v[64:67]
    s_waitcnt lgkmcnt(6)
    v_mfma_f32_16x16x32_bf16 v[52:55], v[20:23], a[96:99], v[52:55]
    ds_read_b128 v[48:51], v11 offset:30720
    v_mfma_f32_16x16x32_bf16 v[60:63], v[20:23], a[100:103], v[60:63]
    s_waitcnt lgkmcnt(6)
    v_mfma_f32_16x16x32_bf16 v[56:59], v[24:27], a[96:99], v[56:59]
    s_waitcnt vmcnt(11)
    s_barrier
    ds_read_b128 v[20:23], v10 offset:32768
    v_mfma_f32_16x16x32_bf16 v[64:67], v[24:27], a[100:103], v[64:67]
    s_waitcnt lgkmcnt(6)
    v_mfma_f32_16x16x32_bf16 v[52:55], v[28:31], a[104:107], v[52:55]
    ds_read_b128 v[24:27], v10 offset:34816
    s_add_u32 m0, s19, 97280
    v_mfma_f32_16x16x32_bf16 v[60:63], v[28:31], a[108:111], v[60:63]
    buffer_load_dwordx4 v2, s[8:11], s20 offen offset:1024 lds
    s_waitcnt lgkmcnt(6)
    v_mfma_f32_16x16x32_bf16 v[56:59], v[32:35], a[104:107], v[56:59]
    ds_read_b128 v[28:31], v11 offset:32768
    v_mfma_f32_16x16x32_bf16 v[64:67], v[32:35], a[108:111], v[64:67]
    s_waitcnt lgkmcnt(6)
    v_mfma_f32_16x16x32_bf16 v[52:55], v[36:39], a[112:115], v[52:55]
    ds_read_b128 v[32:35], v11 offset:34816
    s_add_u32 m0, s19, 101248
    v_mfma_f32_16x16x32_bf16 v[60:63], v[36:39], a[116:119], v[60:63]
    buffer_load_dwordx4 v2, s[8:11], s20 offen offset:1152 lds
    s_waitcnt lgkmcnt(6)
    v_mfma_f32_16x16x32_bf16 v[56:59], v[40:43], a[112:115], v[56:59]
    ds_read_b128 v[36:39], v10 offset:36864
    v_mfma_f32_16x16x32_bf16 v[64:67], v[40:43], a[116:119], v[64:67]
    s_waitcnt lgkmcnt(6)
    v_mfma_f32_16x16x32_bf16 v[52:55], v[44:47], a[120:123], v[52:55]
    ds_read_b128 v[40:43], v10 offset:38912
    s_add_u32 m0, s19, 105216
    v_mfma_f32_16x16x32_bf16 v[60:63], v[44:47], a[124:127], v[60:63]
    buffer_load_dwordx4 v2, s[8:11], s20 offen offset:1280 lds
    s_waitcnt lgkmcnt(6)
    v_mfma_f32_16x16x32_bf16 v[56:59], v[48:51], a[120:123], v[56:59]
    ds_read_b128 v[44:47], v11 offset:36864
    v_mfma_f32_16x16x32_bf16 v[64:67], v[48:51], a[124:127], v[64:67]
    s_waitcnt lgkmcnt(6)
    v_mfma_f32_16x16x32_bf16 v[52:55], v[20:23], a[128:131], v[52:55]
    ds_read_b128 v[48:51], v11 offset:38912
    v_mfma_f32_16x16x32_bf16 v[60:63], v[20:23], a[132:135], v[60:63]
    s_waitcnt lgkmcnt(6)
    v_mfma_f32_16x16x32_bf16 v[56:59], v[24:27], a[128:131], v[56:59]
    ds_read_b128 v[20:23], v10 offset:40960
    s_add_u32 m0, s19, 109184
    v_mfma_f32_16x16x32_bf16 v[64:67], v[24:27], a[132:135], v[64:67]
    buffer_load_dwordx4 v2, s[8:11], s20 offen offset:1408 lds
    s_waitcnt lgkmcnt(6)
    v_mfma_f32_16x16x32_bf16 v[52:55], v[28:31], a[136:139], v[52:55]
    ds_read_b128 v[24:27], v10 offset:43008
    v_mfma_f32_16x16x32_bf16 v[60:63], v[28:31], a[140:143], v[60:63]
    s_waitcnt lgkmcnt(6)
    v_mfma_f32_16x16x32_bf16 v[56:59], v[32:35], a[136:139], v[56:59]
    ds_read_b128 v[28:31], v11 offset:40960
    s_add_u32 m0, s19, 113152
    v_mfma_f32_16x16x32_bf16 v[64:67], v[32:35], a[140:143], v[64:67]
    buffer_load_dwordx4 v2, s[8:11], s20 offen offset:1536 lds
    s_waitcnt lgkmcnt(6)
    v_mfma_f32_16x16x32_bf16 v[52:55], v[36:39], a[144:147], v[52:55]
    ds_read_b128 v[32:35], v11 offset:43008
    v_mfma_f32_16x16x32_bf16 v[60:63], v[36:39], a[148:151], v[60:63]
    s_waitcnt lgkmcnt(6)
    v_mfma_f32_16x16x32_bf16 v[56:59], v[40:43], a[144:147], v[56:59]
    ds_read_b128 v[36:39], v10 offset:45056
    s_add_u32 m0, s19, 117120
    v_mfma_f32_16x16x32_bf16 v[64:67], v[40:43], a[148:151], v[64:67]
    buffer_load_dwordx4 v2, s[8:11], s20 offen offset:1664 lds
    s_waitcnt lgkmcnt(6)
    v_mfma_f32_16x16x32_bf16 v[52:55], v[44:47], a[152:155], v[52:55]
    ds_read_b128 v[40:43], v10 offset:47104
    v_mfma_f32_16x16x32_bf16 v[60:63], v[44:47], a[156:159], v[60:63]
    s_waitcnt lgkmcnt(6)
    v_mfma_f32_16x16x32_bf16 v[56:59], v[48:51], a[152:155], v[56:59]
    ds_read_b128 v[44:47], v11 offset:45056
    s_add_u32 m0, s19, 121088
    v_mfma_f32_16x16x32_bf16 v[64:67], v[48:51], a[156:159], v[64:67]
    buffer_load_dwordx4 v2, s[8:11], s20 offen offset:1792 lds
    s_waitcnt lgkmcnt(6)
    v_mfma_f32_16x16x32_bf16 v[52:55], v[20:23], a[160:163], v[52:55]
    ds_read_b128 v[48:51], v11 offset:47104
    v_mfma_f32_16x16x32_bf16 v[60:63], v[20:23], a[164:167], v[60:63]
    s_waitcnt lgkmcnt(6)
    v_mfma_f32_16x16x32_bf16 v[56:59], v[24:27], a[160:163], v[56:59]
    ds_read_b128 v[20:23], v10 offset:49152
    s_add_u32 m0, s19, 125056
    v_mfma_f32_16x16x32_bf16 v[64:67], v[24:27], a[164:167], v[64:67]
    buffer_load_dwordx4 v2, s[8:11], s20 offen offset:1920 lds
    s_waitcnt lgkmcnt(6)
    v_mfma_f32_16x16x32_bf16 v[52:55], v[28:31], a[168:171], v[52:55]
    ds_read_b128 v[24:27], v10 offset:51200
    v_mfma_f32_16x16x32_bf16 v[60:63], v[28:31], a[172:175], v[60:63]
    s_add_u32 s20, s20, s24
    s_waitcnt lgkmcnt(6)
    v_mfma_f32_16x16x32_bf16 v[56:59], v[32:35], a[168:171], v[56:59]
    ds_read_b128 v[28:31], v11 offset:49152
    v_mfma_f32_16x16x32_bf16 v[64:67], v[32:35], a[172:175], v[64:67]
    s_waitcnt lgkmcnt(6)
    v_mfma_f32_16x16x32_bf16 v[52:55], v[36:39], a[176:179], v[52:55]
    ds_read_b128 v[32:35], v11 offset:51200
    v_mfma_f32_16x16x32_bf16 v[60:63], v[36:39], a[180:183], v[60:63]
    s_waitcnt lgkmcnt(6)
    v_mfma_f32_16x16x32_bf16 v[56:59], v[40:43], a[176:179], v[56:59]
    ds_read_b128 v[36:39], v10 offset:53248
    v_mfma_f32_16x16x32_bf16 v[64:67], v[40:43], a[180:183], v[64:67]
    s_waitcnt lgkmcnt(6)
    v_mfma_f32_16x16x32_bf16 v[52:55], v[44:47], a[184:187], v[52:55]
    ds_read_b128 v[40:43], v10 offset:55296
    v_mfma_f32_16x16x32_bf16 v[60:63], v[44:47], a[188:191], v[60:63]
    s_waitcnt lgkmcnt(6)
    v_mfma_f32_16x16x32_bf16 v[56:59], v[48:51], a[184:187], v[56:59]
    ds_read_b128 v[44:47], v11 offset:53248
    v_mfma_f32_16x16x32_bf16 v[64:67], v[48:51], a[188:191], v[64:67]
    s_waitcnt lgkmcnt(6)
    v_mfma_f32_16x16x32_bf16 v[52:55], v[20:23], a[192:195], v[52:55]
    ds_read_b128 v[48:51], v11 offset:55296
    v_mfma_f32_16x16x32_bf16 v[60:63], v[20:23], a[196:199], v[60:63]
    s_waitcnt lgkmcnt(6)
    v_mfma_f32_16x16x32_bf16 v[56:59], v[24:27], a[192:195], v[56:59]
    ds_read_b128 v[20:23], v10 offset:57344
    v_mfma_f32_16x16x32_bf16 v[64:67], v[24:27], a[196:199], v[64:67]
    s_waitcnt lgkmcnt(6)
    v_mfma_f32_16x16x32_bf16 v[52:55], v[28:31], a[200:203], v[52:55]
    ds_read_b128 v[24:27], v10 offset:59392
    v_mfma_f32_16x16x32_bf16 v[60:63], v[28:31], a[204:207], v[60:63]
    s_waitcnt lgkmcnt(6)
    v_mfma_f32_16x16x32_bf16 v[56:59], v[32:35], a[200:203], v[56:59]
    ds_read_b128 v[28:31], v11 offset:57344
    v_mfma_f32_16x16x32_bf16 v[64:67], v[32:35], a[204:207], v[64:67]
    s_waitcnt lgkmcnt(6)
    v_mfma_f32_16x16x32_bf16 v[52:55], v[36:39], a[208:211], v[52:55]
    ds_read_b128 v[32:35], v11 offset:59392
    v_mfma_f32_16x16x32_bf16 v[60:63], v[36:39], a[212:215], v[60:63]
    s_waitcnt lgkmcnt(6)
    v_mfma_f32_16x16x32_bf16 v[56:59], v[40:43], a[208:211], v[56:59]
    ds_read_b128 v[36:39], v10 offset:61440
    v_mfma_f32_16x16x32_bf16 v[64:67], v[40:43], a[212:215], v[64:67]
    s_waitcnt lgkmcnt(6)
    v_mfma_f32_16x16x32_bf16 v[52:55], v[44:47], a[216:219], v[52:55]
    ds_read_b128 v[40:43], v10 offset:63488
    v_mfma_f32_16x16x32_bf16 v[60:63], v[44:47], a[220:223], v[60:63]
    s_waitcnt lgkmcnt(6)
    v_mfma_f32_16x16x32_bf16 v[56:59], v[48:51], a[216:219], v[56:59]
    ds_read_b128 v[44:47], v11 offset:61440
    v_mfma_f32_16x16x32_bf16 v[64:67], v[48:51], a[220:223], v[64:67]
    s_waitcnt lgkmcnt(6)
    v_mfma_f32_16x16x32_bf16 v[52:55], v[20:23], a[224:227], v[52:55]
    ds_read_b128 v[48:51], v11 offset:63488
    v_mfma_f32_16x16x32_bf16 v[60:63], v[20:23], a[228:231], v[60:63]
    s_waitcnt lgkmcnt(6)
    v_mfma_f32_16x16x32_bf16 v[56:59], v[24:27], a[224:227], v[56:59]
    s_waitcnt vmcnt(8)
    s_barrier
    ds_read_b128 v[20:23], v12 offset:0
    v_mfma_f32_16x16x32_bf16 v[64:67], v[24:27], a[228:231], v[64:67]
    s_waitcnt lgkmcnt(6)
    v_mfma_f32_16x16x32_bf16 v[52:55], v[28:31], a[232:235], v[52:55]
    ds_read_b128 v[24:27], v12 offset:2048
    s_add_u32 m0, s19, 0
    v_mfma_f32_16x16x32_bf16 v[60:63], v[28:31], a[236:239], v[60:63]
    buffer_load_dwordx4 v2, s[8:11], s20 offen offset:0 lds
    s_waitcnt lgkmcnt(6)
    v_mfma_f32_16x16x32_bf16 v[56:59], v[32:35], a[232:235], v[56:59]
    ds_read_b128 v[28:31], v13 offset:0
    v_mfma_f32_16x16x32_bf16 v[64:67], v[32:35], a[236:239], v[64:67]
    v_mov_b32 v9, s23
    s_add_u32 s23, s23, 1
    buffer_store_dword v9, v4, s[4:7], 0 offen sc1
    s_waitcnt lgkmcnt(6)
    v_mfma_f32_16x16x32_bf16 v[52:55], v[36:39], a[240:243], v[52:55]
    ds_read_b128 v[32:35], v13 offset:2048
    s_add_u32 m0, s19, 3968
    v_mfma_f32_16x16x32_bf16 v[60:63], v[36:39], a[244:247], v[60:63]
    buffer_load_dwordx4 v2, s[8:11], s20 offen offset:128 lds
    s_waitcnt lgkmcnt(6)
    v_mfma_f32_16x16x32_bf16 v[56:59], v[40:43], a[240:243], v[56:59]
    ds_read_b128 v[36:39], v12 offset:4096
    v_mfma_f32_16x16x32_bf16 v[64:67], v[40:43], a[244:247], v[64:67]
    s_waitcnt lgkmcnt(6)
    v_mfma_f32_16x16x32_bf16 v[52:55], v[44:47], a[248:251], v[52:55]
    ds_read_b128 v[40:43], v12 offset:6144
    s_add_u32 m0, s19, 7936
    v_mfma_f32_16x16x32_bf16 v[60:63], v[44:47], a[252:255], v[60:63]
    buffer_load_dwordx4 v2, s[8:11], s20 offen offset:256 lds
    s_waitcnt lgkmcnt(6)
    v_mfma_f32_16x16x32_bf16 v[56:59], v[48:51], a[248:251], v[56:59]
    ds_read_b128 v[44:47], v13 offset:4096
    v_mfma_f32_16x16x32_bf16 v[64:67], v[48:51], a[252:255], v[64:67]
    s_waitcnt lgkmcnt(6)
    v_mfma_f32_16x16x32_bf16 v[68:71], v[20:23], a[0:3], 0
    ds_read_b128 v[48:51], v13 offset:6144
    v_mfma_f32_16x16x32_bf16 v[76:79], v[20:23], a[4:7], 0
    s_waitcnt lgkmcnt(6)
    v_mfma_f32_16x16x32_bf16 v[72:75], v[24:27], a[0:3], 0
    ds_read_b128 v[20:23], v12 offset:8192
    s_add_u32 m0, s19, 11904
    v_mfma_f32_16x16x32_bf16 v[80:83], v[24:27], a[4:7], 0
    buffer_load_dwordx4 v2, s[8:11], s20 offen offset:384 lds
    s_waitcnt lgkmcnt(6)
    v_mfma_f32_16x16x32_bf16 v[68:71], v[28:31], a[8:11], v[68:71]
    ds_read_b128 v[24:27], v12 offset:10240
    v_mfma_f32_16x16x32_bf16 v[76:79], v[28:31], a[12:15], v[76:79]
    s_waitcnt lgkmcnt(6)
    v_mfma_f32_16x16x32_bf16 v[72:75], v[32:35], a[8:11], v[72:75]
    ds_read_b128 v[28:31], v13 offset:8192
    s_add_u32 m0, s19, 15872
    v_mfma_f32_16x16x32_bf16 v[80:83], v[32:35], a[12:15], v[80:83]
    buffer_load_dwordx4 v2, s[8:11], s20 offen offset:512 lds
    s_waitcnt lgkmcnt(6)
    v_mfma_f32_16x16x32_bf16 v[68:71], v[36:39], a[16:19], v[68:71]
    ds_read_b128 v[32:35], v13 offset:10240
    v_mfma_f32_16x16x32_bf16 v[76:79], v[36:39], a[20:23], v[76:79]
    s_waitcnt lgkmcnt(6)
    v_mfma_f32_16x16x32_bf16 v[72:75], v[40:43], a[16:19], v[72:75]
    ds_read_b128 v[36:39], v12 offset:12288
    s_add_u32 m0, s19, 19840
    v_mfma_f32_16x16x32_bf16 v[80:83], v[40:43], a[20:23], v[80:83]
    buffer_load_dwordx4 v2, s[8:11], s20 offen offset:640 lds
    s_waitcnt lgkmcnt(6)
    v_mfma_f32_16x16x32_bf16 v[68:71], v[44:47], a[24:27], v[68:71]
    ds_read_b128 v[40:43], v12 offset:14336
    v_mfma_f32_16x16x32_bf16 v[76:79], v[44:47], a[28:31], v[76:79]
    s_waitcnt lgkmcnt(6)
    v_mfma_f32_16x16x32_bf16 v[72:75], v[48:51], a[24:27], v[72:75]
    ds_read_b128 v[44:47], v13 offset:12288
    s_add_u32 m0, s19, 23808
    v_mfma_f32_16x16x32_bf16 v[80:83], v[48:51], a[28:31], v[80:83]
    buffer_load_dwordx4 v2, s[8:11], s20 offen offset:768 lds
    s_waitcnt lgkmcnt(6)
    v_mfma_f32_16x16x32_bf16 v[68:71], v[20:23], a[32:35], v[68:71]
    ds_read_b128 v[48:51], v13 offset:14336
    v_mfma_f32_16x16x32_bf16 v[76:79], v[20:23], a[36:39], v[76:79]
    s_waitcnt lgkmcnt(6)
    v_mfma_f32_16x16x32_bf16 v[72:75], v[24:27], a[32:35], v[72:75]
    ds_read_b128 v[20:23], v12 offset:16384
    s_add_u32 m0, s19, 27776
    v_mfma_f32_16x16x32_bf16 v[80:83], v[24:27], a[36:39], v[80:83]
    buffer_load_dwordx4 v2, s[8:11], s20 offen offset:896 lds
    s_waitcnt lgkmcnt(6)
    v_mfma_f32_16x16x32_bf16 v[68:71], v[28:31], a[40:43], v[68:71]
    ds_read_b128 v[24:27], v12 offset:18432
    v_mfma_f32_16x16x32_bf16 v[76:79], v[28:31], a[44:47], v[76:79]
    v_cvt_pk_bf16_f32 v84, v52, v53
    s_waitcnt lgkmcnt(6)
    v_mfma_f32_16x16x32_bf16 v[72:75], v[32:35], a[40:43], v[72:75]
    ds_read_b128 v[28:31], v13 offset:16384
    v_mfma_f32_16x16x32_bf16 v[80:83], v[32:35], a[44:47], v[80:83]
    v_cvt_pk_bf16_f32 v85, v54, v55
    s_waitcnt lgkmcnt(6)
    v_mfma_f32_16x16x32_bf16 v[68:71], v[36:39], a[48:51], v[68:71]
    ds_read_b128 v[32:35], v13 offset:18432
    v_mfma_f32_16x16x32_bf16 v[76:79], v[36:39], a[52:55], v[76:79]
    v_cvt_pk_bf16_f32 v86, v56, v57
    s_waitcnt lgkmcnt(6)
    v_mfma_f32_16x16x32_bf16 v[72:75], v[40:43], a[48:51], v[72:75]
    ds_read_b128 v[36:39], v12 offset:20480
    v_mfma_f32_16x16x32_bf16 v[80:83], v[40:43], a[52:55], v[80:83]
    v_cvt_pk_bf16_f32 v87, v58, v59
    s_waitcnt lgkmcnt(6)
    v_mfma_f32_16x16x32_bf16 v[68:71], v[44:47], a[56:59], v[68:71]
    ds_read_b128 v[40:43], v12 offset:22528
    v_mfma_f32_16x16x32_bf16 v[76:79], v[44:47], a[60:63], v[76:79]
    v_cvt_pk_bf16_f32 v88, v60, v61
    s_waitcnt lgkmcnt(6)
    v_mfma_f32_16x16x32_bf16 v[72:75], v[48:51], a[56:59], v[72:75]
    ds_read_b128 v[44:47], v13 offset:20480
    v_mfma_f32_16x16x32_bf16 v[80:83], v[48:51], a[60:63], v[80:83]
    v_cvt_pk_bf16_f32 v89, v62, v63
    buffer_store_dwordx4 v[84:87], v3, s[4:7], s21 offen offset:0 sc1
    s_waitcnt lgkmcnt(6)
    v_mfma_f32_16x16x32_bf16 v[68:71], v[20:23], a[64:67], v[68:71]
    ds_read_b128 v[48:51], v13 offset:22528
    v_mfma_f32_16x16x32_bf16 v[76:79], v[20:23], a[68:71], v[76:79]
    v_cvt_pk_bf16_f32 v90, v64, v65
    s_waitcnt lgkmcnt(6)
    v_mfma_f32_16x16x32_bf16 v[72:75], v[24:27], a[64:67], v[72:75]
    ds_read_b128 v[20:23], v12 offset:24576
    v_mfma_f32_16x16x32_bf16 v[80:83], v[24:27], a[68:71], v[80:83]
    v_cvt_pk_bf16_f32 v91, v66, v67
    s_waitcnt lgkmcnt(6)
    v_mfma_f32_16x16x32_bf16 v[68:71], v[28:31], a[72:75], v[68:71]
    ds_read_b128 v[24:27], v12 offset:26624
    v_mfma_f32_16x16x32_bf16 v[76:79], v[28:31], a[76:79], v[76:79]
    s_waitcnt lgkmcnt(6)
    v_mfma_f32_16x16x32_bf16 v[72:75], v[32:35], a[72:75], v[72:75]
    ds_read_b128 v[28:31], v13 offset:24576
    v_mfma_f32_16x16x32_bf16 v[80:83], v[32:35], a[76:79], v[80:83]
    buffer_store_dwordx4 v[88:91], v3, s[4:7], s21 offen offset:128 sc1
    s_waitcnt lgkmcnt(6)
    v_mfma_f32_16x16x32_bf16 v[68:71], v[36:39], a[80:83], v[68:71]
    ds_read_b128 v[32:35], v13 offset:26624
    v_mfma_f32_16x16x32_bf16 v[76:79], v[36:39], a[84:87], v[76:79]
    s_add_u32 s21, s21, s25
    s_mov_b32 s25, s26
    s_waitcnt lgkmcnt(6)
    v_mfma_f32_16x16x32_bf16 v[72:75], v[40:43], a[80:83], v[72:75]
    ds_read_b128 v[36:39], v12 offset:28672
    v_mfma_f32_16x16x32_bf16 v[80:83], v[40:43], a[84:87], v[80:83]
    s_waitcnt lgkmcnt(6)
    v_mfma_f32_16x16x32_bf16 v[68:71], v[44:47], a[88:91], v[68:71]
    ds_read_b128 v[40:43], v12 offset:30720
    v_mfma_f32_16x16x32_bf16 v[76:79], v[44:47], a[92:95], v[76:79]
    s_waitcnt lgkmcnt(6)
    v_mfma_f32_16x16x32_bf16 v[72:75], v[48:51], a[88:91], v[72:75]
    ds_read_b128 v[44:47], v13 offset:28672
    v_mfma_f32_16x16x32_bf16 v[80:83], v[48:51], a[92:95], v[80:83]
    s_waitcnt lgkmcnt(6)
    v_mfma_f32_16x16x32_bf16 v[68:71], v[20:23], a[96:99], v[68:71]
    ds_read_b128 v[48:51], v13 offset:30720
    v_mfma_f32_16x16x32_bf16 v[76:79], v[20:23], a[100:103], v[76:79]
    s_waitcnt lgkmcnt(6)
    v_mfma_f32_16x16x32_bf16 v[72:75], v[24:27], a[96:99], v[72:75]
    s_waitcnt vmcnt(11)
    s_barrier
    ds_read_b128 v[20:23], v12 offset:32768
    v_mfma_f32_16x16x32_bf16 v[80:83], v[24:27], a[100:103], v[80:83]
    s_waitcnt lgkmcnt(6)
    v_mfma_f32_16x16x32_bf16 v[68:71], v[28:31], a[104:107], v[68:71]
    ds_read_b128 v[24:27], v12 offset:34816
    s_add_u32 m0, s19, 31744
    v_mfma_f32_16x16x32_bf16 v[76:79], v[28:31], a[108:111], v[76:79]
    buffer_load_dwordx4 v2, s[8:11], s20 offen offset:1024 lds
    s_waitcnt lgkmcnt(6)
    v_mfma_f32_16x16x32_bf16 v[72:75], v[32:35], a[104:107], v[72:75]
    ds_read_b128 v[28:31], v13 offset:32768
    v_mfma_f32_16x16x32_bf16 v[80:83], v[32:35], a[108:111], v[80:83]
    s_waitcnt lgkmcnt(6)
    v_mfma_f32_16x16x32_bf16 v[68:71], v[36:39], a[112:115], v[68:71]
    ds_read_b128 v[32:35], v13 offset:34816
    s_add_u32 m0, s19, 35712
    v_mfma_f32_16x16x32_bf16 v[76:79], v[36:39], a[116:119], v[76:79]
    buffer_load_dwordx4 v2, s[8:11], s20 offen offset:1152 lds
    s_waitcnt lgkmcnt(6)
    v_mfma_f32_16x16x32_bf16 v[72:75], v[40:43], a[112:115], v[72:75]
    ds_read_b128 v[36:39], v12 offset:36864
    v_mfma_f32_16x16x32_bf16 v[80:83], v[40:43], a[116:119], v[80:83]
    s_waitcnt lgkmcnt(6)
    v_mfma_f32_16x16x32_bf16 v[68:71], v[44:47], a[120:123], v[68:71]
    ds_read_b128 v[40:43], v12 offset:38912
    s_add_u32 m0, s19, 39680
    v_mfma_f32_16x16x32_bf16 v[76:79], v[44:47], a[124:127], v[76:79]
    buffer_load_dwordx4 v2, s[8:11], s20 offen offset:1280 lds
    s_waitcnt lgkmcnt(6)
    v_mfma_f32_16x16x32_bf16 v[72:75], v[48:51], a[120:123], v[72:75]
    ds_read_b128 v[44:47], v13 offset:36864
    v_mfma_f32_16x16x32_bf16 v[80:83], v[48:51], a[124:127], v[80:83]
    s_waitcnt lgkmcnt(6)
    v_mfma_f32_16x16x32_bf16 v[68:71], v[20:23], a[128:131], v[68:71]
    ds_read_b128 v[48:51], v13 offset:38912
    v_mfma_f32_16x16x32_bf16 v[76:79], v[20:23], a[132:135], v[76:79]
    s_waitcnt lgkmcnt(6)
    v_mfma_f32_16x16x32_bf16 v[72:75], v[24:27], a[128:131], v[72:75]
    ds_read_b128 v[20:23], v12 offset:40960
    s_add_u32 m0, s19, 43648
    v_mfma_f32_16x16x32_bf16 v[80:83], v[24:27], a[132:135], v[80:83]
    buffer_load_dwordx4 v2, s[8:11], s20 offen offset:1408 lds
    s_waitcnt lgkmcnt(6)
    v_mfma_f32_16x16x32_bf16 v[68:71], v[28:31], a[136:139], v[68:71]
    ds_read_b128 v[24:27], v12 offset:43008
    v_mfma_f32_16x16x32_bf16 v[76:79], v[28:31], a[140:143], v[76:79]
    s_waitcnt lgkmcnt(6)
    v_mfma_f32_16x16x32_bf16 v[72:75], v[32:35], a[136:139], v[72:75]
    ds_read_b128 v[28:31], v13 offset:40960
    s_add_u32 m0, s19, 47616
    v_mfma_f32_16x16x32_bf16 v[80:83], v[32:35], a[140:143], v[80:83]
    buffer_load_dwordx4 v2, s[8:11], s20 offen offset:1536 lds
    s_waitcnt lgkmcnt(6)
    v_mfma_f32_16x16x32_bf16 v[68:71], v[36:39], a[144:147], v[68:71]
    ds_read_b128 v[32:35], v13 offset:43008
    v_mfma_f32_16x16x32_bf16 v[76:79], v[36:39], a[148:151], v[76:79]
    s_waitcnt lgkmcnt(6)
    v_mfma_f32_16x16x32_bf16 v[72:75], v[40:43], a[144:147], v[72:75]
    ds_read_b128 v[36:39], v12 offset:45056
    s_add_u32 m0, s19, 51584
    v_mfma_f32_16x16x32_bf16 v[80:83], v[40:43], a[148:151], v[80:83]
    buffer_load_dwordx4 v2, s[8:11], s20 offen offset:1664 lds
    s_waitcnt lgkmcnt(6)
    v_mfma_f32_16x16x32_bf16 v[68:71], v[44:47], a[152:155], v[68:71]
    ds_read_b128 v[40:43], v12 offset:47104
    v_mfma_f32_16x16x32_bf16 v[76:79], v[44:47], a[156:159], v[76:79]
    s_waitcnt lgkmcnt(6)
    v_mfma_f32_16x16x32_bf16 v[72:75], v[48:51], a[152:155], v[72:75]
    ds_read_b128 v[44:47], v13 offset:45056
    s_add_u32 m0, s19, 55552
    v_mfma_f32_16x16x32_bf16 v[80:83], v[48:51], a[156:159], v[80:83]
    buffer_load_dwordx4 v2, s[8:11], s20 offen offset:1792 lds
    s_waitcnt lgkmcnt(6)
    v_mfma_f32_16x16x32_bf16 v[68:71], v[20:23], a[160:163], v[68:71]
    ds_read_b128 v[48:51], v13 offset:47104
    v_mfma_f32_16x16x32_bf16 v[76:79], v[20:23], a[164:167], v[76:79]
    s_waitcnt lgkmcnt(6)
    v_mfma_f32_16x16x32_bf16 v[72:75], v[24:27], a[160:163], v[72:75]
    ds_read_b128 v[20:23], v12 offset:49152
    s_add_u32 m0, s19, 59520
    v_mfma_f32_16x16x32_bf16 v[80:83], v[24:27], a[164:167], v[80:83]
    buffer_load_dwordx4 v2, s[8:11], s20 offen offset:1920 lds
    s_waitcnt lgkmcnt(6)
    v_mfma_f32_16x16x32_bf16 v[68:71], v[28:31], a[168:171], v[68:71]
    ds_read_b128 v[24:27], v12 offset:51200
    v_mfma_f32_16x16x32_bf16 v[76:79], v[28:31], a[172:175], v[76:79]
    s_add_u32 s20, s20, s24
    s_waitcnt lgkmcnt(6)
    v_mfma_f32_16x16x32_bf16 v[72:75], v[32:35], a[168:171], v[72:75]
    ds_read_b128 v[28:31], v13 offset:49152
    v_mfma_f32_16x16x32_bf16 v[80:83], v[32:35], a[172:175], v[80:83]
    s_waitcnt lgkmcnt(6)
    v_mfma_f32_16x16x32_bf16 v[68:71], v[36:39], a[176:179], v[68:71]
    ds_read_b128 v[32:35], v13 offset:51200
    v_mfma_f32_16x16x32_bf16 v[76:79], v[36:39], a[180:183], v[76:79]
    s_waitcnt lgkmcnt(6)
    v_mfma_f32_16x16x32_bf16 v[72:75], v[40:43], a[176:179], v[72:75]
    ds_read_b128 v[36:39], v12 offset:53248
    v_mfma_f32_16x16x32_bf16 v[80:83], v[40:43], a[180:183], v[80:83]
    s_waitcnt lgkmcnt(6)
    v_mfma_f32_16x16x32_bf16 v[68:71], v[44:47], a[184:187], v[68:71]
    ds_read_b128 v[40:43], v12 offset:55296
    v_mfma_f32_16x16x32_bf16 v[76:79], v[44:47], a[188:191], v[76:79]
    s_waitcnt lgkmcnt(6)
    v_mfma_f32_16x16x32_bf16 v[72:75], v[48:51], a[184:187], v[72:75]
    ds_read_b128 v[44:47], v13 offset:53248
    v_mfma_f32_16x16x32_bf16 v[80:83], v[48:51], a[188:191], v[80:83]
    s_waitcnt lgkmcnt(6)
    v_mfma_f32_16x16x32_bf16 v[68:71], v[20:23], a[192:195], v[68:71]
    ds_read_b128 v[48:51], v13 offset:55296
    v_mfma_f32_16x16x32_bf16 v[76:79], v[20:23], a[196:199], v[76:79]
    s_waitcnt lgkmcnt(6)
    v_mfma_f32_16x16x32_bf16 v[72:75], v[24:27], a[192:195], v[72:75]
    ds_read_b128 v[20:23], v12 offset:57344
    v_mfma_f32_16x16x32_bf16 v[80:83], v[24:27], a[196:199], v[80:83]
    s_waitcnt lgkmcnt(6)
    v_mfma_f32_16x16x32_bf16 v[68:71], v[28:31], a[200:203], v[68:71]
    ds_read_b128 v[24:27], v12 offset:59392
    v_mfma_f32_16x16x32_bf16 v[76:79], v[28:31], a[204:207], v[76:79]
    s_waitcnt lgkmcnt(6)
    v_mfma_f32_16x16x32_bf16 v[72:75], v[32:35], a[200:203], v[72:75]
    ds_read_b128 v[28:31], v13 offset:57344
    v_mfma_f32_16x16x32_bf16 v[80:83], v[32:35], a[204:207], v[80:83]
    s_waitcnt lgkmcnt(6)
    v_mfma_f32_16x16x32_bf16 v[68:71], v[36:39], a[208:211], v[68:71]
    ds_read_b128 v[32:35], v13 offset:59392
    v_mfma_f32_16x16x32_bf16 v[76:79], v[36:39], a[212:215], v[76:79]
    s_waitcnt lgkmcnt(6)
    v_mfma_f32_16x16x32_bf16 v[72:75], v[40:43], a[208:211], v[72:75]
    ds_read_b128 v[36:39], v12 offset:61440
    v_mfma_f32_16x16x32_bf16 v[80:83], v[40:43], a[212:215], v[80:83]
    s_waitcnt lgkmcnt(6)
    v_mfma_f32_16x16x32_bf16 v[68:71], v[44:47], a[216:219], v[68:71]
    ds_read_b128 v[40:43], v12 offset:63488
    v_mfma_f32_16x16x32_bf16 v[76:79], v[44:47], a[220:223], v[76:79]
    s_waitcnt lgkmcnt(6)
    v_mfma_f32_16x16x32_bf16 v[72:75], v[48:51], a[216:219], v[72:75]
    ds_read_b128 v[44:47], v13 offset:61440
    v_mfma_f32_16x16x32_bf16 v[80:83], v[48:51], a[220:223], v[80:83]
    s_waitcnt lgkmcnt(6)
    v_mfma_f32_16x16x32_bf16 v[68:71], v[20:23], a[224:227], v[68:71]
    ds_read_b128 v[48:51], v13 offset:63488
    v_mfma_f32_16x16x32_bf16 v[76:79], v[20:23], a[228:231], v[76:79]
    s_waitcnt lgkmcnt(6)
    v_mfma_f32_16x16x32_bf16 v[72:75], v[24:27], a[224:227], v[72:75]
    s_waitcnt vmcnt(8)
    s_barrier
    ds_read_b128 v[20:23], v10 offset:0
    v_mfma_f32_16x16x32_bf16 v[80:83], v[24:27], a[228:231], v[80:83]
    s_waitcnt lgkmcnt(6)
    v_mfma_f32_16x16x32_bf16 v[68:71], v[28:31], a[232:235], v[68:71]
    ds_read_b128 v[24:27], v10 offset:2048
    s_add_u32 m0, s19, 65536
    v_mfma_f32_16x16x32_bf16 v[76:79], v[28:31], a[236:239], v[76:79]
    buffer_load_dwordx4 v2, s[8:11], s20 offen offset:0 lds
    s_waitcnt lgkmcnt(6)
    v_mfma_f32_16x16x32_bf16 v[72:75], v[32:35], a[232:235], v[72:75]
    ds_read_b128 v[28:31], v11 offset:0
    v_mfma_f32_16x16x32_bf16 v[80:83], v[32:35], a[236:239], v[80:83]
    v_mov_b32 v9, s23
    s_add_u32 s23, s23, 1
    buffer_store_dword v9, v4, s[4:7], 0 offen sc1
    s_waitcnt lgkmcnt(6)
    v_mfma_f32_16x16x32_bf16 v[68:71], v[36:39], a[240:243], v[68:71]
    ds_read_b128 v[32:35], v11 offset:2048
    s_add_u32 m0, s19, 69504
    v_mfma_f32_16x16x32_bf16 v[76:79], v[36:39], a[244:247], v[76:79]
    buffer_load_dwordx4 v2, s[8:11], s20 offen offset:128 lds
    s_waitcnt lgkmcnt(6)
    v_mfma_f32_16x16x32_bf16 v[72:75], v[40:43], a[240:243], v[72:75]
    ds_read_b128 v[36:39], v10 offset:4096
    v_mfma_f32_16x16x32_bf16 v[80:83], v[40:43], a[244:247], v[80:83]
    s_waitcnt lgkmcnt(6)
    v_mfma_f32_16x16x32_bf16 v[68:71], v[44:47], a[248:251], v[68:71]
    ds_read_b128 v[40:43], v10 offset:6144
    s_add_u32 m0, s19, 73472
    v_mfma_f32_16x16x32_bf16 v[76:79], v[44:47], a[252:255], v[76:79]
    buffer_load_dwordx4 v2, s[8:11], s20 offen offset:256 lds
    s_waitcnt lgkmcnt(6)
    v_mfma_f32_16x16x32_bf16 v[72:75], v[48:51], a[248:251], v[72:75]
    ds_read_b128 v[44:47], v11 offset:4096
    v_mfma_f32_16x16x32_bf16 v[80:83], v[48:51], a[252:255], v[80:83]
    s_add_u32 s22, s22, 2
    s_cmp_lt_u32 s22, 64
    s_cbranch_scc1 P_v_top
    v_cvt_pk_bf16_f32 v84, v68, v69
    v_cvt_pk_bf16_f32 v85, v70, v71
    s_nop 0
    v_cvt_pk_bf16_f32 v86, v72, v73
    v_cvt_pk_bf16_f32 v87, v74, v75
    v_cvt_pk_bf16_f32 v88, v76, v77
    v_cvt_pk_bf16_f32 v89, v78, v79
    v_cvt_pk_bf16_f32 v90, v80, v81
    v_cvt_pk_bf16_f32 v91, v82, v83
    buffer_store_dwordx4 v[84:87], v3, s[4:7], s21 offen offset:0 sc1
    buffer_store_dwordx4 v[88:91], v3, s[4:7], s21 offen offset:128 sc1
    s_waitcnt vmcnt(0) lgkmcnt(0)
    v_mov_b32 v9, s23
    s_add_u32 s23, s23, 1
    buffer_store_dword v9, v4, s[4:7], 0 offen sc1
    s_branch W_U
W_U:
    v_lshlrev_b32 v5, 2, v1
    s_mov_b32 s18, 0
rdv_15:
    global_load_dword v6, v5, s[100:101] sc1
    s_waitcnt vmcnt(0)
rdv_15p:
    s_lshl_b32 s17, s98, 2
    v_lshrrev_b32 v9, s17, v6
    s_cmp_eq_u32 s98, 0
    s_cselect_b32 s17, 0x0f0f0f0f, s17
    s_cselect_b32 s17, s17, 0x01010101
    v_and_b32 v9, s17, v9
    v_cmp_ne_u32 vcc, 0x01010101, v9
    s_nop 0
    s_cbranch_vccz rdvok_16
    v_sad_u8 v9, v9, 0, 0
    s_nop 1
    v_add_u32_dpp v9, v9, v9 quad_perm:[1,0,3,2] row_mask:0xf bank_mask:0xf
    v_cmp_ne_u32 vcc, 8, v9
    s_nop 0
    s_cbranch_vccnz rdvw_17
    s_mov_b32 s98, 1
    s_and_b32 s3, s97, 7
    s_waitcnt vmcnt(0) lgkmcnt(0)
    s_barrier
    s_branch role_start
rdvw_17:
    s_sleep 4
    s_add_u32 s18, s18, 1
    s_cmp_lt_u32 s18, 262144
    s_cbranch_scc1 rdv_15
    s_mov_b32 s92, 1048576
rdvok_16:
    v_and_b32 v9, 0x40404040, v6
    v_bcnt_u32_b32 v9, v9, 0
    s_mov_b32 s89, 0
    v_cmp_le_u32 vcc, 1, v9
    s_nop 0
    s_bcnt1_i32_b64 s17, vcc
    s_add_u32 s89, s89, s17
    v_cmp_le_u32 vcc, 2, v9
    s_nop 0
    s_bcnt1_i32_b64 s17, vcc
    s_add_u32 s89, s89, s17
    v_cmp_le_u32 vcc, 3, v9
    s_nop 0
    s_bcnt1_i32_b64 s17, vcc
    s_add_u32 s89, s89, s17
    v_cmp_le_u32 vcc, 4, v9
    s_nop 0
    s_bcnt1_i32_b64 s17, vcc
    s_add_u32 s89, s89, s17
    s_cmp_gt_u32 s89, 16
    s_cselect_b32 s89, 8192, 0
    s_load_dwordx2 s[8:9], s[0:1], 64
    s_load_dwordx2 s[12:13], s[0:1], 80
    s_mov_b32 s10, 8388608
    s_mov_b32 s11, 0x20000
    s_mov_b32 s14, 8388608
    s_mov_b32 s15, 0x20000
    s_lshl_b32 s17, s90, 2
    s_lshr_b32 s17, 0, s17
    s_add_u32 s35, s93, s17
    s_and_b32 s35, s35, 15
    s_lshr_b32 s28, s93, 4
    s_lshl_b32 s17, s90, 2
    s_lshr_b32 s17, 516, s17
    s_and_b32 s17, s17, 15
    s_add_u32 s28, s28, s17
    s_cmp_ge_u32 s28, 4
    s_cselect_b32 s17, 24, 0
    s_add_u32 s28, s28, s17
    s_lshl_b32 s20, s16, 21
    s_lshl_b32 s17, s35, 7
    s_add_u32 s20, s20, s17
    v_lshrrev_b32 v5, 2, v1
    v_and_b32 v6, 3, v1
    v_lshlrev_b32 v7, 4, v6
    v_lshl_add_u32 v7, v5, 11, v7
    v_lshlrev_b32 v8, 3, v6
    v_bfe_u32 v5, v1, 2, 2
    v_lshrrev_b32 v6, 4, v1
    v_lshl_add_u32 v5, v6, 3, v5
    v_lshl_add_u32 v8, v5, 6, v8
    s_lshl_b32 s19, s16, 15
    v_add_u32 v8, s19, v8
    s_and_b32 s37, s93, 0
    s_lshl_b32 s37, s37, 18
    s_waitcnt lgkmcnt(0)
    s_barrier
    v_lshrrev_b32 v5, 3, v1
    v_and_b32 v6, 3, v5
    v_lshlrev_b32 v6, 1, v6
    v_xor_b32 v6, v6, v1
    v_and_b32 v6, 7, v6
    v_lshlrev_b32 v6, 4, v6
    v_lshl_add_u32 v7, v5, 11, v6
    v_xor_b32 v49, 32, v7
    v_bfe_u32 v5, v1, 2, 2
    v_lshrrev_b32 v6, 4, v1
    v_lshl_add_u32 v8, v6, 3, v5
    v_lshl_add_u32 v8, v8, 7, s19
    v_and_b32 v6, 1, v6
    v_xor_b32 v5, v5, v6
    v_lshl_add_u32 v8, v5, 5, v8
    v_and_b32 v6, 3, v1
    v_lshl_add_u32 v8, v6, 3, v8
    v_xor_b32 v2, 32, v8
    v_xor_b32 v3, 64, v8
    v_xor_b32 v4, 96, v8
    s_sub_u32 s17, s90, 1
    s_and_b32 s17, s17, 3
    s_lshl_b32 s17, s17, 3
    s_and_b32 s18, s93, 7
    s_add_u32 s17, s17, s18
    s_lshl_b32 s17, s17, 8
    v_add_lshl_u32 v5, v0, s17, 11
    s_and_b32 s17, s93, 8
    s_lshl_b32 s17, s17, 7
    buffer_load_dword v48, v5, s[8:11], s17 offen offset:384
    s_add_u32 m0, s19, 0
    s_add_u32 s17, s20, 0
    buffer_load_dwordx4 v7, s[8:11], s17 offen lds
    s_add_u32 m0, s19, 1024
    s_add_u32 s17, s20, 16384
    buffer_load_dwordx4 v49, s[8:11], s17 offen lds
    s_add_u32 m0, s19, 2048
    s_add_u32 s17, s20, 32768
    buffer_load_dwordx4 v7, s[8:11], s17 offen lds
    s_add_u32 m0, s19, 3072
    s_add_u32 s17, s20, 49152
    buffer_load_dwordx4 v49, s[8:11], s17 offen lds
    s_add_u32 m0, s19, 4096
    s_add_u32 s17, s20, 65536
    buffer_load_dwordx4 v7, s[8:11], s17 offen lds
    s_add_u32 m0, s19, 5120
    s_add_u32 s17, s20, 81920
    buffer_load_dwordx4 v49, s[8:11], s17 offen lds
    s_add_u32 m0, s19, 6144
    s_add_u32 s17, s20, 98304
    buffer_load_dwordx4 v7, s[8:11], s17 offen lds
    s_add_u32 m0, s19, 7168
    s_add_u32 s17, s20, 114688
    buffer_load_dwordx4 v49, s[8:11], s17 offen lds
    s_add_u32 m0, s19, 8192
    s_add_u32 s17, s20, 131072
    buffer_load_dwordx4 v7, s[8:11], s17 offen lds
    s_add_u32 m0, s19, 9216
    s_add_u32 s17, s20, 147456
    buffer_load_dwordx4 v49, s[8:11], s17 offen lds
    s_add_u32 m0, s19, 10240
    s_add_u32 s17, s20, 163840
    buffer_load_dwordx4 v7, s[8:11], s17 offen lds
    s_add_u32 m0, s19, 11264
    s_add_u32 s17, s20, 180224
    buffer_load_dwordx4 v49, s[8:11], s17 offen lds
    s_add_u32 m0, s19, 12288
    s_add_u32 s17, s20, 262144
    buffer_load_dwordx4 v7, s[8:11], s17 offen lds
    s_add_u32 m0, s19, 13312
    s_add_u32 s17, s20, 278528
    buffer_load_dwordx4 v49, s[8:11], s17 offen lds
    s_add_u32 m0, s19, 14336
    s_add_u32 s17, s20, 294912
    buffer_load_dwordx4 v7, s[8:11], s17 offen lds
    s_add_u32 m0, s19, 15360
    s_add_u32 s17, s20, 311296
    buffer_load_dwordx4 v49, s[8:11], s17 offen lds
    s_add_u32 m0, s19, 16384
    s_add_u32 s17, s20, 327680
    buffer_load_dwordx4 v7, s[8:11], s17 offen lds
    s_add_u32 m0, s19, 17408
    s_add_u32 s17, s20, 344064
    buffer_load_dwordx4 v49, s[8:11], s17 offen lds
    s_add_u32 m0, s19, 18432
    s_add_u32 s17, s20, 360448
    buffer_load_dwordx4 v7, s[8:11], s17 offen lds
    s_add_u32 m0, s19, 19456
    s_add_u32 s17, s20, 376832
    buffer_load_dwordx4 v49, s[8:11], s17 offen lds
    s_add_u32 m0, s19, 20480
    s_add_u32 s17, s20, 393216
    buffer_load_dwordx4 v7, s[8:11], s17 offen lds
    s_add_u32 m0, s19, 21504
    s_add_u32 s17, s20, 409600
    buffer_load_dwordx4 v49, s[8:11], s17 offen lds
    s_add_u32 m0, s19, 22528
    s_add_u32 s17, s20, 425984
    buffer_load_dwordx4 v7, s[8:11], s17 offen lds
    s_add_u32 m0, s19, 23552
    s_add_u32 s17, s20, 442368
    buffer_load_dwordx4 v49, s[8:11], s17 offen lds
    s_add_u32 m0, s19, 24576
    s_add_u32 s17, s20, 524288
    buffer_load_dwordx4 v7, s[8:11], s17 offen lds
    s_add_u32 m0, s19, 25600
    s_add_u32 s17, s20, 540672
    buffer_load_dwordx4 v49, s[8:11], s17 offen lds
    s_add_u32 m0, s19, 26624
    s_add_u32 s17, s20, 557056
    buffer_load_dwordx4 v7, s[8:11], s17 offen lds
    s_add_u32 m0, s19, 27648
    s_add_u32 s17, s20, 573440
    buffer_load_dwordx4 v49, s[8:11], s17 offen lds
    s_add_u32 m0, s19, 28672
    s_add_u32 s17, s20, 589824
    buffer_load_dwordx4 v7, s[8:11], s17 offen lds
    s_add_u32 m0, s19, 29696
    s_add_u32 s17, s20, 606208
    buffer_load_dwordx4 v49, s[8:11], s17 offen lds
    s_add_u32 m0, s19, 30720
    s_add_u32 s17, s20, 622592
    buffer_load_dwordx4 v7, s[8:11], s17 offen lds
    s_add_u32 m0, s19, 31744
    s_add_u32 s17, s20, 638976
    buffer_load_dwordx4 v49, s[8:11], s17 offen lds
    s_waitcnt vmcnt(28)
    ds_read_b64_tr_b16 a[0:1], v8 offset:0
    ds_read_b64_tr_b16 a[2:3], v8 offset:512
    ds_read_b64_tr_b16 a[4:5], v2 offset:0
    ds_read_b64_tr_b16 a[6:7], v2 offset:512
    ds_read_b64_tr_b16 a[8:9], v3 offset:0
    ds_read_b64_tr_b16 a[10:11], v3 offset:512
    ds_read_b64_tr_b16 a[12:13], v4 offset:0
    ds_read_b64_tr_b16 a[14:15], v4 offset:512
    s_waitcnt vmcnt(24)
    ds_read_b64_tr_b16 a[16:17], v8 offset:4096
    ds_read_b64_tr_b16 a[18:19], v8 offset:4608
    ds_read_b64_tr_b16 a[20:21], v2 offset:4096
    ds_read_b64_tr_b16 a[22:23], v2 offset:4608
    s_waitcnt lgkmcnt(4)
    s_add_u32 m0, s19, 0
    s_add_u32 s17, s20, 655360
    buffer_load_dwordx4 v7, s[8:11], s17 offen lds
    s_add_u32 m0, s19, 1024
    s_add_u32 s17, s20, 671744
    buffer_load_dwordx4 v49, s[8:11], s17 offen lds
    s_add_u32 m0, s19, 2048
    s_add_u32 s17, s20, 688128
    buffer_load_dwordx4 v7, s[8:11], s17 offen lds
    s_add_u32 m0, s19, 3072
    s_add_u32 s17, s20, 704512
    buffer_load_dwordx4 v49, s[8:11], s17 offen lds
    ds_read_b64_tr_b16 a[24:25], v3 offset:4096
    ds_read_b64_tr_b16 a[26:27], v3 offset:4608
    ds_read_b64_tr_b16 a[28:29], v4 offset:4096
    ds_read_b64_tr_b16 a[30:31], v4 offset:4608
    s_waitcnt vmcnt(24)
    ds_read_b64_tr_b16 a[32:33], v8 offset:8192
    ds_read_b64_tr_b16 a[34:35], v8 offset:8704
    ds_read_b64_tr_b16 a[36:37], v2 offset:8192
    ds_read_b64_tr_b16 a[38:39], v2 offset:8704
    s_waitcnt lgkmcnt(4)
    s_add_u32 m0, s19, 4096
    s_add_u32 s17, s20, 786432
    buffer_load_dwordx4 v7, s[8:11], s17 offen lds
    s_add_u32 m0, s19, 5120
    s_add_u32 s17, s20, 802816
    buffer_load_dwordx4 v49, s[8:11], s17 offen lds
    s_add_u32 m0, s19, 6144
    s_add_u32 s17, s20, 819200
    buffer_load_dwordx4 v7, s[8:11], s17 offen lds
    s_add_u32 m0, s19, 7168
    s_add_u32 s17, s20, 835584
    buffer_load_dwordx4 v49, s[8:11], s17 offen lds
    ds_read_b64_tr_b16 a[40:41], v3 offset:8192
    ds_read_b64_tr_b16 a[42:43], v3 offset:8704
    ds_read_b64_tr_b16 a[44:45], v4 offset:8192
    ds_read_b64_tr_b16 a[46:47], v4 offset:8704
    s_waitcnt vmcnt(24)
    ds_read_b64_tr_b16 a[48:49], v8 offset:12288
    ds_read_b64_tr_b16 a[50:51], v8 offset:12800
    ds_read_b64_tr_b16 a[52:53], v2 offset:12288
    ds_read_b64_tr_b16 a[54:55], v2 offset:12800
    s_waitcnt lgkmcnt(4)
    s_add_u32 m0, s19, 8192
    s_add_u32 s17, s20, 851968
    buffer_load_dwordx4 v7, s[8:11], s17 offen lds
    s_add_u32 m0, s19, 9216
    s_add_u32 s17, s20, 868352
    buffer_load_dwordx4 v49, s[8:11], s17 offen lds
    s_add_u32 m0, s19, 10240
    s_add_u32 s17, s20, 884736
    buffer_load_dwordx4 v7, s[8:11], s17 offen lds
    s_add_u32 m0, s19, 11264
    s_add_u32 s17, s20, 901120
    buffer_load_dwordx4 v49, s[8:11], s17 offen lds
    ds_read_b64_tr_b16 a[56:57], v3 offset:12288
    ds_read_b64_tr_b16 a[58:59], v3 offset:12800
    ds_read_b64_tr_b16 a[60:61], v4 offset:12288
    ds_read_b64_tr_b16 a[62:63], v4 offset:12800
    s_waitcnt vmcnt(24)
    ds_read_b64_tr_b16 a[64:65], v8 offset:16384
    ds_read_b64_tr_b16 a[66:67], v8 offset:16896
    ds_read_b64_tr_b16 a[68:69], v2 offset:16384
    ds_read_b64_tr_b16 a[70:71], v2 offset:16896
    s_waitcnt lgkmcnt(4)
    s_add_u32 m0, s19, 12288
    s_add_u32 s17, s20, 917504
    buffer_load_dwordx4 v7, s[8:11], s17 offen lds
    s_add_u32 m0, s19, 13312
    s_add_u32 s17, s20, 933888
    buffer_load_dwordx4 v49, s[8:11], s17 offen lds
    s_add_u32 m0, s19, 14336
    s_add_u32 s17, s20, 950272
    buffer_load_dwordx4 v7, s[8:11], s17 offen lds
    s_add_u32 m0, s19, 15360
    s_add_u32 s17, s20, 966656
    buffer_load_dwordx4 v49, s[8:11], s17 offen lds
    ds_read_b64_tr_b16 a[72:73], v3 offset:16384
    ds_read_b64_tr_b16 a[74:75], v3 offset:16896
    ds_read_b64_tr_b16 a[76:77], v4 offset:16384
    ds_read_b64_tr_b16 a[78:79], v4 offset:16896
    s_waitcnt vmcnt(24)
    ds_read_b64_tr_b16 a[80:81], v8 offset:20480
    ds_read_b64_tr_b16 a[82:83], v8 offset:20992
    ds_read_b64_tr_b16 a[84:85], v2 offset:20480
    ds_read_b64_tr_b16 a[86:87], v2 offset:20992
    s_waitcnt lgkmcnt(4)
    s_add_u32 m0, s19, 16384
    s_add_u32 s17, s20, 1048576
    buffer_load_dwordx4 v7, s[8:11], s17 offen lds
    s_add_u32 m0, s19, 17408
    s_add_u32 s17, s20, 1064960
    buffer_load_dwordx4 v49, s[8:11], s17 offen lds
    s_add_u32 m0, s19, 18432
    s_add_u32 s17, s20, 1081344
    buffer_load_dwordx4 v7, s[8:11], s17 offen lds
    s_add_u32 m0, s19, 19456
    s_add_u32 s17, s20, 1097728
    buffer_load_dwordx4 v49, s[8:11], s17 offen lds
    ds_read_b64_tr_b16 a[88:89], v3 offset:20480
    ds_read_b64_tr_b16 a[90:91], v3 offset:20992
    ds_read_b64_tr_b16 a[92:93], v4 offset:20480
    ds_read_b64_tr_b16 a[94:95], v4 offset:20992
    s_waitcnt vmcnt(24)
    ds_read_b64_tr_b16 a[96:97], v8 offset:24576
    ds_read_b64_tr_b16 a[98:99], v8 offset:25088
    ds_read_b64_tr_b16 a[100:101], v2 offset:24576
    ds_read_b64_tr_b16 a[102:103], v2 offset:25088
    s_waitcnt lgkmcnt(4)
    s_add_u32 m0, s19, 20480
    s_add_u32 s17, s20, 1114112
    buffer_load_dwordx4 v7, s[8:11], s17 offen lds
    s_add_u32 m0, s19, 21504
    s_add_u32 s17, s20, 1130496
    buffer_load_dwordx4 v49, s[8:11], s17 offen lds
    s_add_u32 m0, s19, 22528
    s_add_u32 s17, s20, 1146880
    buffer_load_dwordx4 v7, s[8:11], s17 offen lds
    s_add_u32 m0, s19, 23552
    s_add_u32 s17, s20, 1163264
    buffer_load_dwordx4 v49, s[8:11], s17 offen lds
    ds_read_b64_tr_b16 a[104:105], v3 offset:24576
    ds_read_b64_tr_b16 a[106:107], v3 offset:25088
    ds_read_b64_tr_b16 a[108:109], v4 offset:24576
    ds_read_b64_tr_b16 a[110:111], v4 offset:25088
    s_waitcnt vmcnt(24)
    ds_read_b64_tr_b16 a[112:113], v8 offset:28672
    ds_read_b64_tr_b16 a[114:115], v8 offset:29184
    ds_read_b64_tr_b16 a[116:117], v2 offset:28672
    ds_read_b64_tr_b16 a[118:119], v2 offset:29184
    s_waitcnt lgkmcnt(4)
    s_add_u32 m0, s19, 24576
    s_add_u32 s17, s20, 1179648
    buffer_load_dwordx4 v7, s[8:11], s17 offen lds
    s_add_u32 m0, s19, 25600
    s_add_u32 s17, s20, 1196032
    buffer_load_dwordx4 v49, s[8:11], s17 offen lds
    s_add_u32 m0, s19, 26624
    s_add_u32 s17, s20, 1212416
    buffer_load_dwordx4 v7, s[8:11], s17 offen lds
    s_add_u32 m0, s19, 27648
    s_add_u32 s17, s20, 1228800
    buffer_load_dwordx4 v49, s[8:11], s17 offen lds
    ds_read_b64_tr_b16 a[120:121], v3 offset:28672
    ds_read_b64_tr_b16 a[122:123], v3 offset:29184
    ds_read_b64_tr_b16 a[124:125], v4 offset:28672
    ds_read_b64_tr_b16 a[126:127], v4 offset:29184
    s_waitcnt vmcnt(24)
    ds_read_b64_tr_b16 a[128:129], v8 offset:0
    ds_read_b64_tr_b16 a[130:131], v8 offset:512
    ds_read_b64_tr_b16 a[132:133], v2 offset:0
    ds_read_b64_tr_b16 a[134:135], v2 offset:512
    s_waitcnt lgkmcnt(4)
    s_add_u32 m0, s19, 28672
    s_add_u32 s17, s20, 1310720
    buffer_load_dwordx4 v7, s[8:11], s17 offen lds
    s_add_u32 m0, s19, 29696
    s_add_u32 s17, s20, 1327104
    buffer_load_dwordx4 v49, s[8:11], s17 offen lds
    s_add_u32 m0, s19, 30720
    s_add_u32 s17, s20, 1343488
    buffer_load_dwordx4 v7, s[8:11], s17 offen lds
    s_add_u32 m0, s19, 31744
    s_add_u32 s17, s20, 1359872
    buffer_load_dwordx4 v49, s[8:11], s17 offen lds
    ds_read_b64_tr_b16 a[136:137], v3 offset:0
    ds_read_b64_tr_b16 a[138:139], v3 offset:512
    ds_read_b64_tr_b16 a[140:141], v4 offset:0
    ds_read_b64_tr_b16 a[142:143], v4 offset:512
    s_waitcnt vmcnt(24)
    ds_read_b64_tr_b16 a[144:145], v8 offset:4096
    ds_read_b64_tr_b16 a[146:147], v8 offset:4608
    ds_read_b64_tr_b16 a[148:149], v2 offset:4096
    ds_read_b64_tr_b16 a[150:151], v2 offset:4608
    s_waitcnt lgkmcnt(4)
    s_add_u32 m0, s19, 0
    s_add_u32 s17, s20, 1376256
    buffer_load_dwordx4 v7, s[8:11], s17 offen lds
    s_add_u32 m0, s19, 1024
    s_add_u32 s17, s20, 1392640
    buffer_load_dwordx4 v49, s[8:11], s17 offen lds
    s_add_u32 m0, s19, 2048
    s_add_u32 s17, s20, 1409024
    buffer_load_dwordx4 v7, s[8:11], s17 offen lds
    s_add_u32 m0, s19, 3072
    s_add_u32 s17, s20, 1425408
    buffer_load_dwordx4 v49, s[8:11], s17 offen lds
    ds_read_b64_tr_b16 a[152:153], v3 offset:4096
    ds_read_b64_tr_b16 a[154:155], v3 offset:4608
    ds_read_b64_tr_b16 a[156:157], v4 offset:4096
    ds_read_b64_tr_b16 a[158:159], v4 offset:4608
    s_waitcnt vmcnt(24)
    ds_read_b64_tr_b16 a[160:161], v8 offset:8192
    ds_read_b64_tr_b16 a[162:163], v8 offset:8704
    ds_read_b64_tr_b16 a[164:165], v2 offset:8192
    ds_read_b64_tr_b16 a[166:167], v2 offset:8704
    s_waitcnt lgkmcnt(4)
    s_add_u32 m0, s19, 4096
    s_add_u32 s17, s20, 1441792
    buffer_load_dwordx4 v7, s[8:11], s17 offen lds
    s_add_u32 m0, s19, 5120
    s_add_u32 s17, s20, 1458176
    buffer_load_dwordx4 v49, s[8:11], s17 offen lds
    s_add_u32 m0, s19, 6144
    s_add_u32 s17, s20, 1474560
    buffer_load_dwordx4 v7, s[8:11], s17 offen lds
    s_add_u32 m0, s19, 7168
    s_add_u32 s17, s20, 1490944
    buffer_load_dwordx4 v49, s[8:11], s17 offen lds
    ds_read_b64_tr_b16 a[168:169], v3 offset:8192
    ds_read_b64_tr_b16 a[170:171], v3 offset:8704
    ds_read_b64_tr_b16 a[172:173], v4 offset:8192
    ds_read_b64_tr_b16 a[174:175], v4 offset:8704
    s_waitcnt vmcnt(24)
    ds_read_b64_tr_b16 a[176:177], v8 offset:12288
    ds_read_b64_tr_b16 a[178:179], v8 offset:12800
    ds_read_b64_tr_b16 a[180:181], v2 offset:12288
    ds_read_b64_tr_b16 a[182:183], v2 offset:12800
    s_waitcnt lgkmcnt(4)
    s_add_u32 m0, s19, 8192
    s_add_u32 s17, s20, 1572864
    buffer_load_dwordx4 v7, s[8:11], s17 offen lds
    s_add_u32 m0, s19, 9216
    s_add_u32 s17, s20, 1589248
    buffer_load_dwordx4 v49, s[8:11], s17 offen lds
    s_add_u32 m0, s19, 10240
    s_add_u32 s17, s20, 1605632
    buffer_load_dwordx4 v7, s[8:11], s17 offen lds
    s_add_u32 m0, s19, 11264
    s_add_u32 s17, s20, 1622016
    buffer_load_dwordx4 v49, s[8:11], s17 offen lds
    ds_read_b64_tr_b16 a[184:185], v3 offset:12288
    ds_read_b64_tr_b16 a[186:187], v3 offset:12800
    ds_read_b64_tr_b16 a[188:189], v4 offset:12288
    ds_read_b64_tr_b16 a[190:191], v4 offset:12800
    s_waitcnt vmcnt(24)
    ds_read_b64_tr_b16 a[192:193], v8 offset:16384
    ds_read_b64_tr_b16 a[194:195], v8 offset:16896
    ds_read_b64_tr_b16 a[196:197], v2 offset:16384
    ds_read_b64_tr_b16 a[198:199], v2 offset:16896
    s_waitcnt lgkmcnt(4)
    s_add_u32 m0, s19, 12288
    s_add_u32 s17, s20, 1638400
    buffer_load_dwordx4 v7, s[8:11], s17 offen lds
    s_add_u32 m0, s19, 13312
    s_add_u32 s17, s20, 1654784
    buffer_load_dwordx4 v49, s[8:11], s17 offen lds
    s_add_u32 m0, s19, 14336
    s_add_u32 s17, s20, 1671168
    buffer_load_dwordx4 v7, s[8:11], s17 offen lds
    s_add_u32 m0, s19, 15360
    s_add_u32 s17, s20, 1687552
    buffer_load_dwordx4 v49, s[8:11], s17 offen lds
    ds_read_b64_tr_b16 a[200:201], v3 offset:16384
    ds_read_b64_tr_b16 a[202:203], v3 offset:16896
    ds_read_b64_tr_b16 a[204:205], v4 offset:16384
    ds_read_b64_tr_b16 a[206:207], v4 offset:16896
    s_waitcnt vmcnt(24)
    ds_read_b64_tr_b16 a[208:209], v8 offset:20480
    ds_read_b64_tr_b16 a[210:211], v8 offset:20992
    ds_read_b64_tr_b16 a[212:213], v2 offset:20480
    ds_read_b64_tr_b16 a[214:215], v2 offset:20992
    s_waitcnt lgkmcnt(4)
    s_add_u32 m0, s19, 16384
    s_add_u32 s17, s20, 1703936
    buffer_load_dwordx4 v7, s[8:11], s17 offen lds
    s_add_u32 m0, s19, 17408
    s_add_u32 s17, s20, 1720320
    buffer_load_dwordx4 v49, s[8:11], s17 offen lds
    s_add_u32 m0, s19, 18432
    s_add_u32 s17, s20, 1736704
    buffer_load_dwordx4 v7, s[8:11], s17 offen lds
    s_add_u32 m0, s19, 19456
    s_add_u32 s17, s20, 1753088
    buffer_load_dwordx4 v49, s[8:11], s17 offen lds
    ds_read_b64_tr_b16 a[216:217], v3 offset:20480
    ds_read_b64_tr_b16 a[218:219], v3 offset:20992
    ds_read_b64_tr_b16 a[220:221], v4 offset:20480
    ds_read_b64_tr_b16 a[222:223], v4 offset:20992
    s_waitcnt vmcnt(24)
    ds_read_b64_tr_b16 a[224:225], v8 offset:24576
    ds_read_b64_tr_b16 a[226:227], v8 offset:25088
    ds_read_b64_tr_b16 a[228:229], v2 offset:24576
    ds_read_b64_tr_b16 a[230:231], v2 offset:25088
    s_waitcnt lgkmcnt(4)
    s_add_u32 m0, s19, 20480
    s_add_u32 s17, s20, 1835008
    buffer_load_dwordx4 v7, s[8:11], s17 offen lds
    s_add_u32 m0, s19, 21504
    s_add_u32 s17, s20, 1851392
    buffer_load_dwordx4 v49, s[8:11], s17 offen lds
    s_add_u32 m0, s19, 22528
    s_add_u32 s17, s20, 1867776
    buffer_load_dwordx4 v7, s[8:11], s17 offen lds
    s_add_u32 m0, s19, 23552
    s_add_u32 s17, s20, 1884160
    buffer_load_dwordx4 v49, s[8:11], s17 offen lds
    ds_read_b64_tr_b16 a[232:233], v3 offset:24576
    ds_read_b64_tr_b16 a[234:235], v3 offset:25088
    ds_read_b64_tr_b16 a[236:237], v4 offset:24576
    ds_read_b64_tr_b16 a[238:239], v4 offset:25088
    s_waitcnt vmcnt(24)
    ds_read_b64_tr_b16 a[240:241], v8 offset:28672
    ds_read_b64_tr_b16 a[242:243], v8 offset:29184
    ds_read_b64_tr_b16 a[244:245], v2 offset:28672
    ds_read_b64_tr_b16 a[246:247], v2 offset:29184
    s_waitcnt lgkmcnt(4)
    s_add_u32 m0, s19, 24576
    s_add_u32 s17, s20, 1900544
    buffer_load_dwordx4 v7, s[8:11], s17 offen lds
    s_add_u32 m0, s19, 25600
    s_add_u32 s17, s20, 1916928
    buffer_load_dwordx4 v49, s[8:11], s17 offen lds
    s_add_u32 m0, s19, 26624
    s_add_u32 s17, s20, 1933312
    buffer_load_dwordx4 v7, s[8:11], s17 offen lds
    s_add_u32 m0, s19, 27648
    s_add_u32 s17, s20, 1949696
    buffer_load_dwordx4 v49, s[8:11], s17 offen lds
    ds_read_b64_tr_b16 a[248:249], v3 offset:28672
    ds_read_b64_tr_b16 a[250:251], v3 offset:29184
    ds_read_b64_tr_b16 a[252:253], v4 offset:28672
    ds_read_b64_tr_b16 a[254:255], v4 offset:29184
    s_waitcnt vmcnt(24)
    ds_read_b64_tr_b16 v[128:129], v8 offset:0
    ds_read_b64_tr_b16 v[130:131], v8 offset:512
    ds_read_b64_tr_b16 v[132:133], v2 offset:0
    ds_read_b64_tr_b16 v[134:135], v2 offset:512
    s_waitcnt lgkmcnt(4)
    s_add_u32 m0, s19, 28672
    s_add_u32 s17, s20, 1966080
    buffer_load_dwordx4 v7, s[8:11], s17 offen lds
    s_add_u32 m0, s19, 29696
    s_add_u32 s17, s20, 1982464
    buffer_load_dwordx4 v49, s[8:11], s17 offen lds
    s_add_u32 m0, s19, 30720
    s_add_u32 s17, s20, 1998848
    buffer_load_dwordx4 v7, s[8:11], s17 offen lds
    s_add_u32 m0, s19, 31744
    s_add_u32 s17, s20, 2015232
    buffer_load_dwordx4 v49, s[8:11], s17 offen lds
    ds_read_b64_tr_b16 v[136:137], v3 offset:0
    ds_read_b64_tr_b16 v[138:139], v3 offset:512
    ds_read_b64_tr_b16 v[140:141], v4 offset:0
    ds_read_b64_tr_b16 v[142:143], v4 offset:512
    s_waitcnt vmcnt(24)
    ds_read_b64_tr_b16 v[144:145], v8 offset:4096
    ds_read_b64_tr_b16 v[146:147], v8 offset:4608
    ds_read_b64_tr_b16 v[148:149], v2 offset:4096
    ds_read_b64_tr_b16 v[150:151], v2 offset:4608
    s_waitcnt lgkmcnt(4)
    s_add_u32 m0, s19, 0
    s_add_u32 s17, s20, 196608
    buffer_load_dwordx4 v7, s[8:11], s17 offen lds
    s_add_u32 m0, s19, 1024
    s_add_u32 s17, s20, 212992
    buffer_load_dwordx4 v49, s[8:11], s17 offen lds
    s_add_u32 m0, s19, 2048
    s_add_u32 s17, s20, 229376
    buffer_load_dwordx4 v7, s[8:11], s17 offen lds
    s_add_u32 m0, s19, 3072
    s_add_u32 s17, s20, 245760
    buffer_load_dwordx4 v49, s[8:11], s17 offen lds
    ds_read_b64_tr_b16 v[152:153], v3 offset:4096
    ds_read_b64_tr_b16 v[154:155], v3 offset:4608
    ds_read_b64_tr_b16 v[156:157], v4 offset:4096
    ds_read_b64_tr_b16 v[158:159], v4 offset:4608
    s_waitcnt vmcnt(24)
    ds_read_b64_tr_b16 v[160:161], v8 offset:8192
    ds_read_b64_tr_b16 v[162:163], v8 offset:8704
    ds_read_b64_tr_b16 v[164:165], v2 offset:8192
    ds_read_b64_tr_b16 v[166:167], v2 offset:8704
    s_waitcnt lgkmcnt(4)
    s_add_u32 m0, s19, 4096
    s_add_u32 s17, s20, 458752
    buffer_load_dwordx4 v7, s[8:11], s17 offen lds
    s_add_u32 m0, s19, 5120
    s_add_u32 s17, s20, 475136
    buffer_load_dwordx4 v49, s[8:11], s17 offen lds
    s_add_u32 m0, s19, 6144
    s_add_u32 s17, s20, 491520
    buffer_load_dwordx4 v7, s[8:11], s17 offen lds
    s_add_u32 m0, s19, 7168
    s_add_u32 s17, s20, 507904
    buffer_load_dwordx4 v49, s[8:11], s17 offen lds
    ds_read_b64_tr_b16 v[168:169], v3 offset:8192
    ds_read_b64_tr_b16 v[170:171], v3 offset:8704
    ds_read_b64_tr_b16 v[172:173], v4 offset:8192
    ds_read_b64_tr_b16 v[174:175], v4 offset:8704
    s_waitcnt vmcnt(24)
    ds_read_b64_tr_b16 v[176:177], v8 offset:12288
    ds_read_b64_tr_b16 v[178:179], v8 offset:12800
    ds_read_b64_tr_b16 v[180:181], v2 offset:12288
    ds_read_b64_tr_b16 v[182:183], v2 offset:12800
    s_waitcnt lgkmcnt(4)
    s_add_u32 m0, s19, 8192
    s_add_u32 s17, s20, 720896
    buffer_load_dwordx4 v7, s[8:11], s17 offen lds
    s_add_u32 m0, s19, 9216
    s_add_u32 s17, s20, 737280
    buffer_load_dwordx4 v49, s[8:11], s17 offen lds
    s_add_u32 m0, s19, 10240
    s_add_u32 s17, s20, 753664
    buffer_load_dwordx4 v7, s[8:11], s17 offen lds
    s_add_u32 m0, s19, 11264
    s_add_u32 s17, s20, 770048
    buffer_load_dwordx4 v49, s[8:11], s17 offen lds
    ds_read_b64_tr_b16 v[184:185], v3 offset:12288
    ds_read_b64_tr_b16 v[186:187], v3 offset:12800
    ds_read_b64_tr_b16 v[188:189], v4 offset:12288
    ds_read_b64_tr_b16 v[190:191], v4 offset:12800
    s_waitcnt vmcnt(24)
    ds_read_b64_tr_b16 v[192:193], v8 offset:16384
    ds_read_b64_tr_b16 v[194:195], v8 offset:16896
    ds_read_b64_tr_b16 v[196:197], v2 offset:16384
    ds_read_b64_tr_b16 v[198:199], v2 offset:16896
    s_waitcnt lgkmcnt(4)
    s_add_u32 m0, s19, 12288
    s_add_u32 s17, s20, 983040
    buffer_load_dwordx4 v7, s[8:11], s17 offen lds
    s_add_u32 m0, s19, 13312
    s_add_u32 s17, s20, 999424
    buffer_load_dwordx4 v49, s[8:11], s17 offen lds
    s_add_u32 m0, s19, 14336
    s_add_u32 s17, s20, 1015808
    buffer_load_dwordx4 v7, s[8:11], s17 offen lds
    s_add_u32 m0, s19, 15360
    s_add_u32 s17, s20, 1032192
    buffer_load_dwordx4 v49, s[8:11], s17 offen lds
    ds_read_b64_tr_b16 v[200:201], v3 offset:16384
    ds_read_b64_tr_b16 v[202:203], v3 offset:16896
    ds_read_b64_tr_b16 v[204:205], v4 offset:16384
    ds_read_b64_tr_b16 v[206:207], v4 offset:16896
    s_waitcnt vmcnt(24)
    ds_read_b64_tr_b16 v[208:209], v8 offset:20480
    ds_read_b64_tr_b16 v[210:211], v8 offset:20992
    ds_read_b64_tr_b16 v[212:213], v2 offset:20480
    ds_read_b64_tr_b16 v[214:215], v2 offset:20992
    s_waitcnt lgkmcnt(4)
    s_add_u32 m0, s19, 16384
    s_add_u32 s17, s20, 1245184
    buffer_load_dwordx4 v7, s[8:11], s17 offen lds
    s_add_u32 m0, s19, 17408
    s_add_u32 s17, s20, 1261568
    buffer_load_dwordx4 v49, s[8:11], s17 offen lds
    s_add_u32 m0, s19, 18432
    s_add_u32 s17, s20, 1277952
    buffer_load_dwordx4 v7, s[8:11], s17 offen lds
    s_add_u32 m0, s19, 19456
    s_add_u32 s17, s20, 1294336
    buffer_load_dwordx4 v49, s[8:11], s17 offen lds
    ds_read_b64_tr_b16 v[216:217], v3 offset:20480
    ds_read_b64_tr_b16 v[218:219], v3 offset:20992
    ds_read_b64_tr_b16 v[220:221], v4 offset:20480
    ds_read_b64_tr_b16 v[222:223], v4 offset:20992
    s_waitcnt vmcnt(24)
    ds_read_b64_tr_b16 v[224:225], v8 offset:24576
    ds_read_b64_tr_b16 v[226:227], v8 offset:25088
    ds_read_b64_tr_b16 v[228:229], v2 offset:24576
    ds_read_b64_tr_b16 v[230:231], v2 offset:25088
    s_waitcnt lgkmcnt(4)
    s_add_u32 m0, s19, 20480
    s_add_u32 s17, s20, 1507328
    buffer_load_dwordx4 v7, s[8:11], s17 offen lds
    s_add_u32 m0, s19, 21504
    s_add_u32 s17, s20, 1523712
    buffer_load_dwordx4 v49, s[8:11], s17 offen lds
    s_add_u32 m0, s19, 22528
    s_add_u32 s17, s20, 1540096
    buffer_load_dwordx4 v7, s[8:11], s17 offen lds
    s_add_u32 m0, s19, 23552
    s_add_u32 s17, s20, 1556480
    buffer_load_dwordx4 v49, s[8:11], s17 offen lds
    ds_read_b64_tr_b16 v[232:233], v3 offset:24576
    ds_read_b64_tr_b16 v[234:235], v3 offset:25088
    ds_read_b64_tr_b16 v[236:237], v4 offset:24576
    ds_read_b64_tr_b16 v[238:239], v4 offset:25088
    s_waitcnt vmcnt(24)
    ds_read_b64_tr_b16 v[240:241], v8 offset:28672
    ds_read_b64_tr_b16 v[242:243], v8 offset:29184
    ds_read_b64_tr_b16 v[244:245], v2 offset:28672
    ds_read_b64_tr_b16 v[246:247], v2 offset:29184
    s_waitcnt lgkmcnt(4)
    s_add_u32 m0, s19, 24576
    s_add_u32 s17, s20, 1769472
    buffer_load_dwordx4 v7, s[8:11], s17 offen lds
    s_add_u32 m0, s19, 25600
    s_add_u32 s17, s20, 1785856
    buffer_load_dwordx4 v49, s[8:11], s17 offen lds
    s_add_u32 m0, s19, 26624
    s_add_u32 s17, s20, 1802240
    buffer_load_dwordx4 v7, s[8:11], s17 offen lds
    s_add_u32 m0, s19, 27648
    s_add_u32 s17, s20, 1818624
    buffer_load_dwordx4 v49, s[8:11], s17 offen lds
    ds_read_b64_tr_b16 v[248:249], v3 offset:28672
    ds_read_b64_tr_b16 v[250:251], v3 offset:29184
    ds_read_b64_tr_b16 v[252:253], v4 offset:28672
    ds_read_b64_tr_b16 v[254:255], v4 offset:29184
    s_waitcnt lgkmcnt(0)
    s_add_u32 m0, s19, 28672
    s_add_u32 s17, s20, 2031616
    buffer_load_dwordx4 v7, s[8:11], s17 offen lds
    s_add_u32 m0, s19, 29696
    s_add_u32 s17, s20, 2048000
    buffer_load_dwordx4 v49, s[8:11], s17 offen lds
    s_add_u32 m0, s19, 30720
    s_add_u32 s17, s20, 2064384
    buffer_load_dwordx4 v7, s[8:11], s17 offen lds
    s_add_u32 m0, s19, 31744
    s_add_u32 s17, s20, 2080768
    buffer_load_dwordx4 v49, s[8:11], s17 offen lds
    s_lshr_b32 s37, s37, 6
    s_add_u32 s37, s37, 54525952
    v_lshlrev_b32 v15, 4, v1
    v_add_u32 v10, s19, v15
    s_lshl_b32 s17, s16, 10
    s_add_u32 s17, s17, 131072
    v_add_u32 v14, s17, v15
    s_lshl_b32 s17, s16, 12
    s_add_u32 s18, s17, 147456
    v_add_u32 v15, s18, v15
    v_bfe_u32 v11, v1, 3, 2
    v_and_b32 v5, 7, v1
    v_lshlrev_b32 v5, 9, v5
    v_lshl_add_u32 v11, v11, 7, v5
    s_add_u32 s17, s17, 100728832
    v_add_u32 v11, s17, v11
    v_mov_b32 v12, 0
    v_and_b32 v13, 15, v1
    v_lshrrev_b32 v5, 4, v1
    v_lshlrev_b32 v5, 3, v5
    v_lshl_add_u32 v13, v13, 12, v5
    s_lshl_b32 s17, s35, 7
    s_lshl_b32 s18, s16, 5
    s_add_u32 s17, s17, s18
    s_add_u32 s17, s17, 2048
    v_add_u32 v13, s17, v13
    s_waitcnt vmcnt(0)
    v_add_u32 v10, s19, v10
    s_xor_b32 s37, s89, 201334784
    s_mov_b32 s36, 0
U_wait:
    s_mov_b32 s29, s92
U_fl:
    s_lshr_b32 s17, s28, 3
    v_cmp_ge_u32 vcc, s17, v12
    s_lshl_b32 s18, s28, 2
    s_and_b32 s18, s18, 24
    s_lshr_b32 s17, vcc_lo, s18
    s_and_b32 s17, s17, 0xff
    s_cbranch_scc0 U_go
    s_cmp_ge_u32 s29, 1048576
    s_cselect_b32 s92, 1048576, s92
    s_cbranch_scc1 U_go
    s_lshl_b32 s17, s17, s18
    s_cmp_eq_u32 s29, 0
    s_cselect_b32 exec_lo, -1, s17
    s_mov_b32 exec_hi, 0
    s_add_u32 s29, s29, 1
    buffer_load_dword v12, v11, s[4:7], 0 offen sc1
    s_mov_b64 exec, -1
    s_sleep 2
    s_waitcnt vmcnt(0)
    s_branch U_fl
U_go:
    s_mul_i32 s30, s28, 263168
    s_and_b32 s30, s30, 33300480
    s_xor_b32 s30, s30, s37
    buffer_load_dwordx4 v[64:67], v10, s[4:7], s30 offen offset:0
    buffer_load_dwordx4 v[68:71], v10, s[4:7], s30 offen offset:1024
    buffer_load_dwordx4 v[72:75], v10, s[4:7], s30 offen offset:2048
    buffer_load_dwordx4 v[76:79], v10, s[4:7], s30 offen offset:3072
    s_add_u32 s30, s30, 4096
    buffer_load_dwordx4 v[80:83], v10, s[4:7], s30 offen offset:0
    buffer_load_dwordx4 v[84:87], v10, s[4:7], s30 offen offset:1024
    buffer_load_dwordx4 v[88:91], v10, s[4:7], s30 offen offset:2048
    buffer_load_dwordx4 v[92:95], v10, s[4:7], s30 offen offset:3072
    s_add_u32 s30, s30, 12288
    buffer_load_dwordx4 v[96:99], v10, s[4:7], s30 offen offset:0
    buffer_load_dwordx4 v[100:103], v10, s[4:7], s30 offen offset:1024
    buffer_load_dwordx4 v[104:107], v10, s[4:7], s30 offen offset:2048
    buffer_load_dwordx4 v[108:111], v10, s[4:7], s30 offen offset:3072
    s_add_u32 s30, s30, 4096
    buffer_load_dwordx4 v[112:115], v10, s[4:7], s30 offen offset:0
    buffer_load_dwordx4 v[116:119], v10, s[4:7], s30 offen offset:1024
    buffer_load_dwordx4 v[120:123], v10, s[4:7], s30 offen offset:2048
    s_mov_b32 s34, 0
    s_mov_b32 s31, 1073741824
    ds_read_b128 v[48:51], v15 offset:0
    ds_read_b128 v[52:55], v15 offset:1024
    ds_read_b128 v[56:59], v15 offset:2048
    ds_read_b128 v[60:63], v15 offset:3072
.p2align 6
U_item:
    s_waitcnt vmcnt(14)
    v_mfma_f32_16x16x32_bf16 v[16:19], a[0:3], v[64:67], 0
    buffer_load_dwordx4 v[124:127], v10, s[4:7], s30 offen offset:3072
    s_cmp_lt_u32 s28, 24
    s_cselect_b32 s33, 4, 6
    v_mfma_f32_16x16x32_bf16 v[20:23], a[4:7], v[64:67], 0
    s_add_u32 s33, s28, s33
    s_lshr_b32 s17, s33, 3
    v_cmp_ge_u32 vcc, s17, v12
    s_lshl_b32 s18, s33, 2
    s_and_b32 s18, s18, 24
    ds_read_b64_tr_b16 v[32:33], v8 offset:0
    v_mfma_f32_16x16x32_bf16 v[24:27], a[8:11], v[64:67], 0
    s_lshr_b32 s17, vcc_lo, s18
    s_and_b32 s17, s17, 0xff
    s_lshl_b32 exec_lo, s17, s18
    s_mov_b32 exec_hi, 0
    buffer_load_dword v12, v11, s[4:7], 0 offen sc1
    s_mov_b64 exec, -1
    ds_read_b64_tr_b16 v[34:35], v8 offset:512
    v_mfma_f32_16x16x32_bf16 v[28:31], a[12:15], v[64:67], 0
    ds_read_b64_tr_b16 v[36:37], v2 offset:0
    ds_read_b64_tr_b16 v[38:39], v2 offset:512
    s_waitcnt vmcnt(15)
    v_mfma_f32_16x16x32_bf16 v[16:19], a[16:19], v[68:71], v[16:19]
    s_add_u32 s30, s30, 12288
    buffer_load_dwordx4 v[64:67], v10, s[4:7], s30 offen offset:0
    v_mfma_f32_16x16x32_bf16 v[20:23], a[20:23], v[68:71], v[20:23]
    ds_read_b64_tr_b16 v[40:41], v3 offset:0
    v_mfma_f32_16x16x32_bf16 v[24:27], a[24:27], v[68:71], v[24:27]
    ds_read_b64_tr_b16 v[42:43], v3 offset:512
    v_mfma_f32_16x16x32_bf16 v[28:31], a[28:31], v[68:71], v[28:31]
    ds_read_b64_tr_b16 v[44:45], v4 offset:0
    ds_read_b64_tr_b16 v[46:47], v4 offset:512
    s_waitcnt vmcnt(15)
    v_mfma_f32_16x16x32_bf16 v[16:19], a[32:35], v[72:75], v[16:19]
    buffer_load_dwordx4 v[68:71], v10, s[4:7], s30 offen offset:1024
    v_mfma_f32_16x16x32_bf16 v[20:23], a[36:39], v[72:75], v[20:23]
    s_waitcnt lgkmcnt(8)
    s_cmp_eq_u32 s34, 0
    s_cbranch_scc1 U_nb
    s_barrier
U_nb:
    v_mfma_f32_16x16x32_bf16 v[24:27], a[40:43], v[72:75], v[24:27]
    ds_read_b128 v[48:51], v15 offset:0
    ds_read_b128 v[52:55], v15 offset:1024
    v_mfma_f32_16x16x32_bf16 v[28:31], a[44:47], v[72:75], v[28:31]
    ds_read_b128 v[56:59], v15 offset:2048
    ds_read_b128 v[60:63], v15 offset:3072
    s_waitcnt vmcnt(15)
    s_waitcnt lgkmcnt(4)
    v_mfma_f32_16x16x32_bf16 v[16:19], v[32:35], v[76:79], v[16:19]
    buffer_load_dwordx4 v[72:75], v10, s[4:7], s30 offen offset:2048
    v_mfma_f32_16x16x32_bf16 v[20:23], v[36:39], v[76:79], v[20:23]
    v_mfma_f32_16x16x32_bf16 v[24:27], v[40:43], v[76:79], v[24:27]
    v_mfma_f32_16x16x32_bf16 v[28:31], v[44:47], v[76:79], v[28:31]
    s_waitcnt vmcnt(15)
    v_mfma_f32_16x16x32_bf16 v[16:19], a[48:51], v[80:83], v[16:19]
    buffer_load_dwordx4 v[76:79], v10, s[4:7], s30 offen offset:3072
    s_waitcnt lgkmcnt(0)
    v_mfma_f32_16x16x32_bf16 v[20:23], a[52:55], v[80:83], v[20:23]
    v_add_f32 v48, v48, v52
    v_add_f32 v49, v49, v53
    ds_read_b64_tr_b16 v[32:33], v8 offset:4096
    v_mfma_f32_16x16x32_bf16 v[24:27], a[56:59], v[80:83], v[24:27]
    v_add_f32 v50, v50, v54
    v_add_f32 v51, v51, v55
    ds_read_b64_tr_b16 v[34:35], v8 offset:4608
    v_mfma_f32_16x16x32_bf16 v[28:31], a[60:63], v[80:83], v[28:31]
    ds_read_b64_tr_b16 v[36:37], v2 offset:4096
    ds_read_b64_tr_b16 v[38:39], v2 offset:4608
    s_waitcnt vmcnt(15)
    v_mfma_f32_16x16x32_bf16 v[16:19], a[64:67], v[84:87], v[16:19]
    s_add_u32 s30, s30, 4096
    buffer_load_dwordx4 v[80:83], v10, s[4:7], s30 offen offset:0
    v_mfma_f32_16x16x32_bf16 v[20:23], a[68:71], v[84:87], v[20:23]
    v_add_f32 v56, v56, v60
    v_add_f32 v57, v57, v61
    ds_read_b64_tr_b16 v[40:41], v3 offset:4096
    v_mfma_f32_16x16x32_bf16 v[24:27], a[72:75], v[84:87], v[24:27]
    v_add_f32 v58, v58, v62
    v_add_f32 v59, v59, v63
    ds_read_b64_tr_b16 v[42:43], v3 offset:4608
    v_mfma_f32_16x16x32_bf16 v[28:31], a[76:79], v[84:87], v[28:31]
    ds_read_b64_tr_b16 v[44:45], v4 offset:4096
    ds_read_b64_tr_b16 v[46:47], v4 offset:4608
    s_waitcnt vmcnt(15)
    v_mfma_f32_16x16x32_bf16 v[16:19], a[80:83], v[88:91], v[16:19]
    buffer_load_dwordx4 v[84:87], v10, s[4:7], s30 offen offset:1024
    v_mfma_f32_16x16x32_bf16 v[20:23], a[84:87], v[88:91], v[20:23]
    v_add_f32 v48, v48, v56
    v_add_f32 v49, v49, v57
    v_mfma_f32_16x16x32_bf16 v[24:27], a[88:91], v[88:91], v[24:27]
    v_add_f32 v50, v50, v58
    v_add_f32 v51, v51, v59
    v_mfma_f32_16x16x32_bf16 v[28:31], a[92:95], v[88:91], v[28:31]
    s_waitcnt vmcnt(15)
    s_waitcnt lgkmcnt(0)
    v_mfma_f32_16x16x32_bf16 v[16:19], v[32:35], v[92:95], v[16:19]
    buffer_load_dwordx4 v[88:91], v10, s[4:7], s30 offen offset:2048
    v_mfma_f32_16x16x32_bf16 v[20:23], v[36:39], v[92:95], v[20:23]
    v_cvt_pk_bf16_f32 v52, v48, v49
    v_cvt_pk_bf16_f32 v53, v50, v51
    v_mfma_f32_16x16x32_bf16 v[24:27], v[40:43], v[92:95], v[24:27]
    v_mfma_f32_16x16x32_bf16 v[28:31], v[44:47], v[92:95], v[28:31]
    s_waitcnt vmcnt(15)
    v_mfma_f32_16x16x32_bf16 v[16:19], a[96:99], v[96:99], v[16:19]
    buffer_load_dwordx4 v[92:95], v10, s[4:7], s30 offen offset:3072
    v_mfma_f32_16x16x32_bf16 v[20:23], a[100:103], v[96:99], v[20:23]
    buffer_store_dwordx2 v[52:53], v13, s[12:15], s31 offen
    v_xor_b32 v15, 0x4000, v15
    ds_read_b64_tr_b16 v[32:33], v8 offset:8192
    v_mfma_f32_16x16x32_bf16 v[24:27], a[104:107], v[96:99], v[24:27]
    ds_read_b64_tr_b16 v[34:35], v8 offset:8704
    v_mfma_f32_16x16x32_bf16 v[28:31], a[108:111], v[96:99], v[28:31]
    ds_read_b64_tr_b16 v[36:37], v2 offset:8192
    ds_read_b64_tr_b16 v[38:39], v2 offset:8704
    s_waitcnt vmcnt(16)
    v_mfma_f32_16x16x32_bf16 v[16:19], a[112:115], v[100:103], v[16:19]
    s_add_u32 s30, s30, 12288
    buffer_load_dwordx4 v[96:99], v10, s[4:7], s30 offen offset:0
    v_mfma_f32_16x16x32_bf16 v[20:23], a[116:119], v[100:103], v[20:23]
    ds_read_b64_tr_b16 v[40:41], v3 offset:8192
    v_mfma_f32_16x16x32_bf16 v[24:27], a[120:123], v[100:103], v[24:27]
    ds_read_b64_tr_b16 v[42:43], v3 offset:8704
    v_mfma_f32_16x16x32_bf16 v[28:31], a[124:127], v[100:103], v[28:31]
    ds_read_b64_tr_b16 v[44:45], v4 offset:8192
    ds_read_b64_tr_b16 v[46:47], v4 offset:8704
    s_waitcnt vmcnt(16)
    v_mfma_f32_16x16x32_bf16 v[16:19], a[128:131], v[104:107], v[16:19]
    buffer_load_dwordx4 v[100:103], v10, s[4:7], s30 offen offset:1024
    v_mfma_f32_16x16x32_bf16 v[20:23], a[132:135], v[104:107], v[20:23]
    v_mfma_f32_16x16x32_bf16 v[24:27], a[136:139], v[104:107], v[24:27]
    v_mfma_f32_16x16x32_bf16 v[28:31], a[140:143], v[104:107], v[28:31]
    s_waitcnt vmcnt(16)
    s_waitcnt lgkmcnt(0)
    v_mfma_f32_16x16x32_bf16 v[16:19], v[32:35], v[108:111], v[16:19]
    buffer_load_dwordx4 v[104:107], v10, s[4:7], s30 offen offset:2048
    v_mfma_f32_16x16x32_bf16 v[20:23], v[36:39], v[108:111], v[20:23]
    v_mfma_f32_16x16x32_bf16 v[24:27], v[40:43], v[108:111], v[24:27]
    v_mfma_f32_16x16x32_bf16 v[28:31], v[44:47], v[108:111], v[28:31]
    s_waitcnt vmcnt(16)
    v_mfma_f32_16x16x32_bf16 v[16:19], a[144:147], v[112:115], v[16:19]
    buffer_load_dwordx4 v[108:111], v10, s[4:7], s30 offen offset:3072
    v_mfma_f32_16x16x32_bf16 v[20:23], a[148:151], v[112:115], v[20:23]
    ds_read_b64_tr_b16 v[32:33], v8 offset:12288
    v_mfma_f32_16x16x32_bf16 v[24:27], a[152:155], v[112:115], v[24:27]
    ds_read_b64_tr_b16 v[34:35], v8 offset:12800
    v_mfma_f32_16x16x32_bf16 v[28:31], a[156:159], v[112:115], v[28:31]
    ds_read_b64_tr_b16 v[36:37], v2 offset:12288
    ds_read_b64_tr_b16 v[38:39], v2 offset:12800
    s_waitcnt vmcnt(16)
    v_mfma_f32_16x16x32_bf16 v[16:19], a[160:163], v[116:119], v[16:19]
    s_add_u32 s30, s30, 4096
    buffer_load_dwordx4 v[112:115], v10, s[4:7], s30 offen offset:0
    v_mfma_f32_16x16x32_bf16 v[20:23], a[164:167], v[116:119], v[20:23]
    ds_read_b64_tr_b16 v[40:41], v3 offset:12288
    v_mfma_f32_16x16x32_bf16 v[24:27], a[168:171], v[116:119], v[24:27]
    ds_read_b64_tr_b16 v[42:43], v3 offset:12800
    v_mfma_f32_16x16x32_bf16 v[28:31], a[172:175], v[116:119], v[28:31]
    ds_read_b64_tr_b16 v[44:45], v4 offset:12288
    ds_read_b64_tr_b16 v[46:47], v4 offset:12800
    s_waitcnt vmcnt(16)
    v_mfma_f32_16x16x32_bf16 v[16:19], a[176:179], v[120:123], v[16:19]
    buffer_load_dwordx4 v[116:119], v10, s[4:7], s30 offen offset:1024
    v_mfma_f32_16x16x32_bf16 v[20:23], a[180:183], v[120:123], v[20:23]
    v_mfma_f32_16x16x32_bf16 v[24:27], a[184:187], v[120:123], v[24:27]
    v_mfma_f32_16x16x32_bf16 v[28:31], a[188:191], v[120:123], v[28:31]
    s_waitcnt vmcnt(16)
    s_waitcnt lgkmcnt(0)
    v_mfma_f32_16x16x32_bf16 v[16:19], v[32:35], v[124:127], v[16:19]
    buffer_load_dwordx4 v[120:123], v10, s[4:7], s30 offen offset:2048
    v_mfma_f32_16x16x32_bf16 v[20:23], v[36:39], v[124:127], v[20:23]
    v_mfma_f32_16x16x32_bf16 v[24:27], v[40:43], v[124:127], v[24:27]
    v_mfma_f32_16x16x32_bf16 v[28:31], v[44:47], v[124:127], v[28:31]
    s_waitcnt vmcnt(15)
    v_mfma_f32_16x16x32_bf16 v[16:19], a[192:195], v[64:67], v[16:19]
    buffer_load_dwordx4 v[124:127], v10, s[4:7], s30 offen offset:3072
    v_mfma_f32_16x16x32_bf16 v[20:23], a[196:199], v[64:67], v[20:23]
    s_lshr_b32 s17, s33, 3
    v_cmp_ge_u32 vcc, s17, v12
    s_lshl_b32 s18, s33, 2
    s_and_b32 s18, s18, 24
    ds_read_b64_tr_b16 v[32:33], v8 offset:16384
    v_mfma_f32_16x16x32_bf16 v[24:27], a[200:203], v[64:67], v[24:27]
    s_mul_i32 s30, s33, 263168
    s_and_b32 s30, s30, 33300480
    s_xor_b32 s30, s30, s37
    s_lshr_b32 s17, vcc_lo, s18
    s_and_b32 s17, s17, 0xff
    s_cselect_b32 s34, 0, 1
    s_cselect_b32 s30, 1073741824, s30
    ds_read_b64_tr_b16 v[34:35], v8 offset:16896
    v_mfma_f32_16x16x32_bf16 v[28:31], a[204:207], v[64:67], v[28:31]
    ds_read_b64_tr_b16 v[36:37], v2 offset:16384
    ds_read_b64_tr_b16 v[38:39], v2 offset:16896
    s_waitcnt vmcnt(15)
    v_mfma_f32_16x16x32_bf16 v[16:19], a[208:211], v[68:71], v[16:19]
    buffer_load_dwordx4 v[64:67], v10, s[4:7], s30 offen offset:0
    v_mfma_f32_16x16x32_bf16 v[20:23], a[212:215], v[68:71], v[20:23]
    ds_read_b64_tr_b16 v[40:41], v3 offset:16384
    v_mfma_f32_16x16x32_bf16 v[24:27], a[216:219], v[68:71], v[24:27]
    ds_read_b64_tr_b16 v[42:43], v3 offset:16896
    v_mfma_f32_16x16x32_bf16 v[28:31], a[220:223], v[68:71], v[28:31]
    ds_read_b64_tr_b16 v[44:45], v4 offset:16384
    ds_read_b64_tr_b16 v[46:47], v4 offset:16896
    s_waitcnt vmcnt(15)
    v_mfma_f32_16x16x32_bf16 v[16:19], a[224:227], v[72:75], v[16:19]
    buffer_load_dwordx4 v[68:71], v10, s[4:7], s30 offen offset:1024
    v_mfma_f32_16x16x32_bf16 v[20:23], a[228:231], v[72:75], v[20:23]
    v_mfma_f32_16x16x32_bf16 v[24:27], a[232:235], v[72:75], v[24:27]
    v_mfma_f32_16x16x32_bf16 v[28:31], a[236:239], v[72:75], v[28:31]
    s_waitcnt vmcnt(15)
    s_waitcnt lgkmcnt(0)
    v_mfma_f32_16x16x32_bf16 v[16:19], v[32:35], v[76:79], v[16:19]
    buffer_load_dwordx4 v[72:75], v10, s[4:7], s30 offen offset:2048
    v_mfma_f32_16x16x32_bf16 v[20:23], v[36:39], v[76:79], v[20:23]
    v_mfma_f32_16x16x32_bf16 v[24:27], v[40:43], v[76:79], v[24:27]
    v_mfma_f32_16x16x32_bf16 v[28:31], v[44:47], v[76:79], v[28:31]
    s_waitcnt vmcnt(15)
    v_mfma_f32_16x16x32_bf16 v[16:19], a[240:243], v[80:83], v[16:19]
    buffer_load_dwordx4 v[76:79], v10, s[4:7], s30 offen offset:3072
    v_mfma_f32_16x16x32_bf16 v[20:23], a[244:247], v[80:83], v[20:23]
    ds_read_b64_tr_b16 v[32:33], v8 offset:20480
    v_mfma_f32_16x16x32_bf16 v[24:27], a[248:251], v[80:83], v[24:27]
    ds_read_b64_tr_b16 v[34:35], v8 offset:20992
    v_mfma_f32_16x16x32_bf16 v[28:31], a[252:255], v[80:83], v[28:31]
    ds_read_b64_tr_b16 v[36:37], v2 offset:20480
    ds_read_b64_tr_b16 v[38:39], v2 offset:20992
    s_waitcnt vmcnt(15)
    v_mfma_f32_16x16x32_bf16 v[16:19], v[128:131], v[84:87], v[16:19]
    s_add_u32 s30, s30, 4096
    buffer_load_dwordx4 v[80:83], v10, s[4:7], s30 offen offset:0
    v_mfma_f32_16x16x32_bf16 v[20:23], v[132:135], v[84:87], v[20:23]
    ds_read_b64_tr_b16 v[40:41], v3 offset:20480
    v_mfma_f32_16x16x32_bf16 v[24:27], v[136:139], v[84:87], v[24:27]
    ds_read_b64_tr_b16 v[42:43], v3 offset:20992
    v_mfma_f32_16x16x32_bf16 v[28:31], v[140:143], v[84:87], v[28:31]
    ds_read_b64_tr_b16 v[44:45], v4 offset:20480
    ds_read_b64_tr_b16 v[46:47], v4 offset:20992
    s_waitcnt vmcnt(15)
    v_mfma_f32_16x16x32_bf16 v[16:19], v[144:147], v[88:91], v[16:19]
    buffer_load_dwordx4 v[84:87], v10, s[4:7], s30 offen offset:1024
    v_mfma_f32_16x16x32_bf16 v[20:23], v[148:151], v[88:91], v[20:23]
    v_mfma_f32_16x16x32_bf16 v[24:27], v[152:155], v[88:91], v[24:27]
    v_mfma_f32_16x16x32_bf16 v[28:31], v[156:159], v[88:91], v[28:31]
    s_waitcnt vmcnt(15)
    s_waitcnt lgkmcnt(0)
    v_mfma_f32_16x16x32_bf16 v[16:19], v[32:35], v[92:95], v[16:19]
    buffer_load_dwordx4 v[88:91], v10, s[4:7], s30 offen offset:2048
    v_mfma_f32_16x16x32_bf16 v[20:23], v[36:39], v[92:95], v[20:23]
    v_mfma_f32_16x16x32_bf16 v[24:27], v[40:43], v[92:95], v[24:27]
    v_mfma_f32_16x16x32_bf16 v[28:31], v[44:47], v[92:95], v[28:31]
    s_waitcnt vmcnt(14)
    v_mfma_f32_16x16x32_bf16 v[16:19], v[160:163], v[96:99], v[16:19]
    buffer_load_dwordx4 v[92:95], v10, s[4:7], s30 offen offset:3072
    v_mfma_f32_16x16x32_bf16 v[20:23], v[164:167], v[96:99], v[20:23]
    ds_read_b64_tr_b16 v[32:33], v8 offset:24576
    v_mfma_f32_16x16x32_bf16 v[24:27], v[168:171], v[96:99], v[24:27]
    ds_read_b64_tr_b16 v[34:35], v8 offset:25088
    v_mfma_f32_16x16x32_bf16 v[28:31], v[172:175], v[96:99], v[28:31]
    ds_read_b64_tr_b16 v[36:37], v2 offset:24576
    ds_read_b64_tr_b16 v[38:39], v2 offset:25088
    s_waitcnt vmcnt(14)
    v_mfma_f32_16x16x32_bf16 v[16:19], v[176:179], v[100:103], v[16:19]
    s_add_u32 s30, s30, 12288
    buffer_load_dwordx4 v[96:99], v10, s[4:7], s30 offen offset:0
    v_mfma_f32_16x16x32_bf16 v[20:23], v[180:183], v[100:103], v[20:23]
    ds_read_b64_tr_b16 v[40:41], v3 offset:24576
    v_mfma_f32_16x16x32_bf16 v[24:27], v[184:187], v[100:103], v[24:27]
    ds_read_b64_tr_b16 v[42:43], v3 offset:25088
    v_mfma_f32_16x16x32_bf16 v[28:31], v[188:191], v[100:103], v[28:31]
    ds_read_b64_tr_b16 v[44:45], v4 offset:24576
    ds_read_b64_tr_b16 v[46:47], v4 offset:25088
    s_waitcnt vmcnt(14)
    v_mfma_f32_16x16x32_bf16 v[16:19], v[192:195], v[104:107], v[16:19]
    buffer_load_dwordx4 v[100:103], v10, s[4:7], s30 offen offset:1024
    v_mfma_f32_16x16x32_bf16 v[20:23], v[196:199], v[104:107], v[20:23]
    v_mfma_f32_16x16x32_bf16 v[24:27], v[200:203], v[104:107], v[24:27]
    v_mfma_f32_16x16x32_bf16 v[28:31], v[204:207], v[104:107], v[28:31]
    s_waitcnt vmcnt(14)
    s_waitcnt lgkmcnt(0)
    v_mfma_f32_16x16x32_bf16 v[16:19], v[32:35], v[108:111], v[16:19]
    buffer_load_dwordx4 v[104:107], v10, s[4:7], s30 offen offset:2048
    v_mfma_f32_16x16x32_bf16 v[20:23], v[36:39], v[108:111], v[20:23]
    v_mfma_f32_16x16x32_bf16 v[24:27], v[40:43], v[108:111], v[24:27]
    v_mfma_f32_16x16x32_bf16 v[28:31], v[44:47], v[108:111], v[28:31]
    s_waitcnt vmcnt(14)
    v_mfma_f32_16x16x32_bf16 v[16:19], v[208:211], v[112:115], v[16:19]
    buffer_load_dwordx4 v[108:111], v10, s[4:7], s30 offen offset:3072
    v_mfma_f32_16x16x32_bf16 v[20:23], v[212:215], v[112:115], v[20:23]
    ds_read_b64_tr_b16 v[32:33], v8 offset:28672
    v_mfma_f32_16x16x32_bf16 v[24:27], v[216:219], v[112:115], v[24:27]
    ds_read_b64_tr_b16 v[34:35], v8 offset:29184
    v_mfma_f32_16x16x32_bf16 v[28:31], v[220:223], v[112:115], v[28:31]
    ds_read_b64_tr_b16 v[36:37], v2 offset:28672
    ds_read_b64_tr_b16 v[38:39], v2 offset:29184
    s_waitcnt vmcnt(14)
    v_mfma_f32_16x16x32_bf16 v[16:19], v[224:227], v[116:119], v[16:19]
    s_add_u32 s30, s30, 4096
    buffer_load_dwordx4 v[112:115], v10, s[4:7], s30 offen offset:0
    v_mfma_f32_16x16x32_bf16 v[20:23], v[228:231], v[116:119], v[20:23]
    ds_read_b64_tr_b16 v[40:41], v3 offset:28672
    v_mfma_f32_16x16x32_bf16 v[24:27], v[232:235], v[116:119], v[24:27]
    ds_read_b64_tr_b16 v[42:43], v3 offset:29184
    v_mfma_f32_16x16x32_bf16 v[28:31], v[236:239], v[116:119], v[28:31]
    ds_read_b64_tr_b16 v[44:45], v4 offset:28672
    ds_read_b64_tr_b16 v[46:47], v4 offset:29184
    s_waitcnt vmcnt(14)
    v_mfma_f32_16x16x32_bf16 v[16:19], v[240:243], v[120:123], v[16:19]
    buffer_load_dwordx4 v[116:119], v10, s[4:7], s30 offen offset:1024
    v_mfma_f32_16x16x32_bf16 v[20:23], v[244:247], v[120:123], v[20:23]
    v_mfma_f32_16x16x32_bf16 v[24:27], v[248:251], v[120:123], v[24:27]
    v_mfma_f32_16x16x32_bf16 v[28:31], v[252:255], v[120:123], v[28:31]
    s_waitcnt vmcnt(14)
    s_waitcnt lgkmcnt(0)
    v_mfma_f32_16x16x32_bf16 v[16:19], v[32:35], v[124:127], v[16:19]
    buffer_load_dwordx4 v[120:123], v10, s[4:7], s30 offen offset:2048
    v_mfma_f32_16x16x32_bf16 v[20:23], v[36:39], v[124:127], v[20:23]
    v_mfma_f32_16x16x32_bf16 v[24:27], v[40:43], v[124:127], v[24:27]
    v_mfma_f32_16x16x32_bf16 v[28:31], v[44:47], v[124:127], v[28:31]
    s_lshl_b32 s31, s28, 16
    s_mov_b32 s28, s33
    s_cmp_eq_u32 s34, 1
    ds_write_b128 v14, v[16:19] offset:0
    ds_write_b128 v14, v[20:23] offset:4096
    ds_write_b128 v14, v[24:27] offset:8192
    s_nop 1
    ds_write_b128 v14, v[28:31] offset:12288
    v_xor_b32 v14, 0x4000, v14
    s_cbranch_scc1 U_item
    s_waitcnt lgkmcnt(0)
    s_barrier
    ds_read_b128 v[48:51], v15 offset:0
    ds_read_b128 v[52:55], v15 offset:1024
    ds_read_b128 v[56:59], v15 offset:2048
    ds_read_b128 v[60:63], v15 offset:3072
    s_waitcnt lgkmcnt(0)
    v_add_f32 v48, v48, v52
    v_add_f32 v49, v49, v53
    v_add_f32 v50, v50, v54
    v_add_f32 v51, v51, v55
    v_add_f32 v56, v56, v60
    v_add_f32 v57, v57, v61
    v_add_f32 v58, v58, v62
    v_add_f32 v59, v59, v63
    v_add_f32 v48, v48, v56
    v_add_f32 v49, v49, v57
    v_add_f32 v50, v50, v58
    v_add_f32 v51, v51, v59
    v_cvt_pk_bf16_f32 v52, v48, v49
    v_cvt_pk_bf16_f32 v53, v50, v51
    buffer_store_dwordx2 v[52:53], v13, s[12:15], s31 offen
    s_cmp_lt_u32 s28, 128
    s_cbranch_scc1 U_wait
    s_branch W_fin
W_F:
    s_waitcnt vmcnt(0)
    s_barrier
    s_cmp_lg_u32 s16, 0
    s_cbranch_scc1 reg_18
    s_and_b32 s17, s2, 3
    s_lshl_b32 s17, s17, 3
    s_lshl_b32 s18, s98, 2
    s_add_u32 s17, s17, s18
    s_lshl_b32 s17, 1, s17
    s_andn2_b32 s18, s2, 3
    v_mov_b32 v5, s18
    v_mov_b32 v6, s17
    s_mov_b64 exec, 1
    global_atomic_add v5, v6, s[100:101] sc1
    s_mov_b64 exec, -1
reg_18:
    s_load_dwordx2 s[48:49], s[0:1], 8
    s_load_dwordx2 s[52:53], s[0:1], 16
    s_mov_b32 s50, 2101248
    s_mov_b32 s51, 0x20000
    s_mov_b32 s54, 2101248
    s_mov_b32 s55, 0x20000
    s_load_dwordx2 s[40:41], s[0:1], 0
    s_load_dwordx2 s[44:45], s[0:1], 24
    s_mov_b32 s42, 4194304
    s_mov_b32 s43, 0x20000
    s_mov_b32 s46, 4194304
    s_mov_b32 s47, 0x20000
    s_lshr_b32 s28, s93, 3
    s_and_b32 s29, s93, 7
    s_lshl_b32 s29, s29, 2
    s_add_u32 s29, s29, s16
    v_bfe_u32 v5, v1, 2, 2
    v_and_b32 v7, 3, v1
    v_lshl_add_u32 v7, v5, 3, v7
    s_lshl_b32 s17, s29, 5
    v_add_u32 v7, s17, v7
    v_lshrrev_b32 v8, 4, v1
    v_cvt_f32_u32 v8, v8
    s_mov_b32 s31, 981467136
    v_add_u32 v5, 0, v7
    v_lshrrev_b32 v6, 1, v5
    v_and_b32 v30, 1, v5
    v_cmp_eq_u32 vcc, 1, v5
    v_mov_b32 v5, 512
    s_nop 0
    v_cndmask_b32 v6, v6, v5, vcc
    v_cndmask_b32 v30, v30, 0, vcc
    v_add_u32 v5, v6, v30
    v_bfe_i32 v40, v5, 1, 1
    v_add_u32 v5, v6, v5
    v_bfe_i32 v42, v5, 1, 1
    v_add_u32 v5, v6, v5
    v_bfe_i32 v44, v5, 1, 1
    v_and_b32 v40, 0x80008000, v40
    v_and_b32 v42, 0x80008000, v42
    v_and_b32 v44, 0x80008000, v44
    v_cvt_f32_u32 v6, v6
    v_cvt_f32_u32 v30, v30
    v_mul_f32 v32, s31, v6
    v_mul_f32 v30, 0x3e800000, v30
    v_mov_b32 v34, v32
    v_mul_f32 v36, 0x42000000, v32
    v_mul_f32 v5, 0x41000000, v32
    v_fma_f32 v30, v5, v8, v30
    v_add_u32 v5, 4, v7
    v_lshrrev_b32 v6, 1, v5
    v_and_b32 v31, 1, v5
    v_cmp_eq_u32 vcc, 1, v5
    v_mov_b32 v5, 512
    s_nop 0
    v_cndmask_b32 v6, v6, v5, vcc
    v_cndmask_b32 v31, v31, 0, vcc
    v_add_u32 v5, v6, v31
    v_bfe_i32 v41, v5, 1, 1
    v_add_u32 v5, v6, v5
    v_bfe_i32 v43, v5, 1, 1
    v_add_u32 v5, v6, v5
    v_bfe_i32 v45, v5, 1, 1
    v_and_b32 v41, 0x80008000, v41
    v_and_b32 v43, 0x80008000, v43
    v_and_b32 v45, 0x80008000, v45
    v_cvt_f32_u32 v6, v6
    v_cvt_f32_u32 v31, v31
    v_mul_f32 v33, s31, v6
    v_mul_f32 v31, 0x3e800000, v31
    v_mov_b32 v35, v33
    v_mul_f32 v37, 0x42000000, v33
    v_mul_f32 v5, 0x41000000, v33
    v_fma_f32 v31, v5, v8, v31
    v_fract_f32 v48, v30
    v_add_f32 v49, v48, v32
    v_cos_f32 v56, v48
    v_add_f32 v50, v49, v34
    v_cos_f32 v57, v49
    v_add_f32 v51, v50, v32
    v_cos_f32 v58, v50
    v_add_f32 v52, v51, v34
    v_cos_f32 v59, v51
    v_add_f32 v53, v52, v32
    v_cos_f32 v60, v52
    v_add_f32 v54, v53, v34
    v_cos_f32 v61, v53
    v_add_f32 v55, v54, v32
    v_cos_f32 v62, v54
    v_cos_f32 v63, v55
    v_add_f32 v30, v48, v36
    v_cvt_pk_bf16_f32 v64, v56, v57
    v_cvt_pk_bf16_f32 v65, v58, v59
    v_cvt_pk_bf16_f32 v66, v60, v61
    v_cvt_pk_bf16_f32 v67, v62, v63
    v_accvgpr_write_b32 a0, v64
    v_accvgpr_write_b32 a1, v65
    v_accvgpr_write_b32 a2, v66
    v_accvgpr_write_b32 a3, v67
    v_xor_b32_dpp v68, v64, v40 quad_perm:[0,1,3,2] row_mask:0xf bank_mask:0xf
    v_xor_b32_dpp v69, v65, v40 quad_perm:[0,1,3,2] row_mask:0xf bank_mask:0xf
    v_xor_b32_dpp v70, v66, v40 quad_perm:[0,1,3,2] row_mask:0xf bank_mask:0xf
    v_xor_b32_dpp v71, v67, v40 quad_perm:[0,1,3,2] row_mask:0xf bank_mask:0xf
    v_accvgpr_write_b32 a64, v68
    v_accvgpr_write_b32 a65, v69
    v_accvgpr_write_b32 a66, v70
    v_accvgpr_write_b32 a67, v71
    v_xor_b32 v68, v64, v42
    v_xor_b32 v69, v65, v42
    v_xor_b32 v70, v66, v42
    v_xor_b32 v71, v67, v42
    v_accvgpr_write_b32 a128, v68
    v_accvgpr_write_b32 a129, v69
    v_accvgpr_write_b32 a130, v70
    v_accvgpr_write_b32 a131, v71
    v_xor_b32_dpp v68, v64, v44 quad_perm:[0,1,3,2] row_mask:0xf bank_mask:0xf
    v_xor_b32_dpp v69, v65, v44 quad_perm:[0,1,3,2] row_mask:0xf bank_mask:0xf
    v_xor_b32_dpp v70, v66, v44 quad_perm:[0,1,3,2] row_mask:0xf bank_mask:0xf
    v_xor_b32_dpp v71, v67, v44 quad_perm:[0,1,3,2] row_mask:0xf bank_mask:0xf
    v_accvgpr_write_b32 a192, v68
    v_accvgpr_write_b32 a193, v69
    v_accvgpr_write_b32 a194, v70
    v_accvgpr_write_b32 a195, v71
    v_fract_f32 v48, v31
    v_add_f32 v49, v48, v33
    v_cos_f32 v56, v48
    v_add_f32 v50, v49, v35
    v_cos_f32 v57, v49
    v_add_f32 v51, v50, v33
    v_cos_f32 v58, v50
    v_add_f32 v52, v51, v35
    v_cos_f32 v59, v51
    v_add_f32 v53, v52, v33
    v_cos_f32 v60, v52
    v_add_f32 v54, v53, v35
    v_cos_f32 v61, v53
    v_add_f32 v55, v54, v33
    v_cos_f32 v62, v54
    v_cos_f32 v63, v55
    v_add_f32 v31, v48, v37
    v_cvt_pk_bf16_f32 v64, v56, v57
    v_cvt_pk_bf16_f32 v65, v58, v59
    v_cvt_pk_bf16_f32 v66, v60, v61
    v_cvt_pk_bf16_f32 v67, v62, v63
    v_accvgpr_write_b32 a4, v64
    v_accvgpr_write_b32 a5, v65
    v_accvgpr_write_b32 a6, v66
    v_accvgpr_write_b32 a7, v67
    v_xor_b32_dpp v68, v64, v41 quad_perm:[0,1,3,2] row_mask:0xf bank_mask:0xf
    v_xor_b32_dpp v69, v65, v41 quad_perm:[0,1,3,2] row_mask:0xf bank_mask:0xf
    v_xor_b32_dpp v70, v66, v41 quad_perm:[0,1,3,2] row_mask:0xf bank_mask:0xf
    v_xor_b32_dpp v71, v67, v41 quad_perm:[0,1,3,2] row_mask:0xf bank_mask:0xf
    v_accvgpr_write_b32 a68, v68
    v_accvgpr_write_b32 a69, v69
    v_accvgpr_write_b32 a70, v70
    v_accvgpr_write_b32 a71, v71
    v_xor_b32 v68, v64, v43
    v_xor_b32 v69, v65, v43
    v_xor_b32 v70, v66, v43
    v_xor_b32 v71, v67, v43
    v_accvgpr_write_b32 a132, v68
    v_accvgpr_write_b32 a133, v69
    v_accvgpr_write_b32 a134, v70
    v_accvgpr_write_b32 a135, v71
    v_xor_b32_dpp v68, v64, v45 quad_perm:[0,1,3,2] row_mask:0xf bank_mask:0xf
    v_xor_b32_dpp v69, v65, v45 quad_perm:[0,1,3,2] row_mask:0xf bank_mask:0xf
    v_xor_b32_dpp v70, v66, v45 quad_perm:[0,1,3,2] row_mask:0xf bank_mask:0xf
    v_xor_b32_dpp v71, v67, v45 quad_perm:[0,1,3,2] row_mask:0xf bank_mask:0xf
    v_accvgpr_write_b32 a196, v68
    v_accvgpr_write_b32 a197, v69
    v_accvgpr_write_b32 a198, v70
    v_accvgpr_write_b32 a199, v71
    v_fract_f32 v48, v30
    v_add_f32 v49, v48, v32
    v_cos_f32 v56, v48
    v_add_f32 v50, v49, v34
    v_cos_f32 v57, v49
    v_add_f32 v51, v50, v32
    v_cos_f32 v58, v50
    v_add_f32 v52, v51, v34
    v_cos_f32 v59, v51
    v_add_f32 v53, v52, v32
    v_cos_f32 v60, v52
    v_add_f32 v54, v53, v34
    v_cos_f32 v61, v53
    v_add_f32 v55, v54, v32
    v_cos_f32 v62, v54
    v_cos_f32 v63, v55
    v_add_f32 v30, v48, v36
    v_cvt_pk_bf16_f32 v64, v56, v57
    v_cvt_pk_bf16_f32 v65, v58, v59
    v_cvt_pk_bf16_f32 v66, v60, v61
    v_cvt_pk_bf16_f32 v67, v62, v63
    v_accvgpr_write_b32 a8, v64
    v_accvgpr_write_b32 a9, v65
    v_accvgpr_write_b32 a10, v66
    v_accvgpr_write_b32 a11, v67
    v_xor_b32_dpp v68, v64, v40 quad_perm:[0,1,3,2] row_mask:0xf bank_mask:0xf
    v_xor_b32_dpp v69, v65, v40 quad_perm:[0,1,3,2] row_mask:0xf bank_mask:0xf
    v_xor_b32_dpp v70, v66, v40 quad_perm:[0,1,3,2] row_mask:0xf bank_mask:0xf
    v_xor_b32_dpp v71, v67, v40 quad_perm:[0,1,3,2] row_mask:0xf bank_mask:0xf
    v_accvgpr_write_b32 a72, v68
    v_accvgpr_write_b32 a73, v69
    v_accvgpr_write_b32 a74, v70
    v_accvgpr_write_b32 a75, v71
    v_xor_b32 v68, v64, v42
    v_xor_b32 v69, v65, v42
    v_xor_b32 v70, v66, v42
    v_xor_b32 v71, v67, v42
    v_accvgpr_write_b32 a136, v68
    v_accvgpr_write_b32 a137, v69
    v_accvgpr_write_b32 a138, v70
    v_accvgpr_write_b32 a139, v71
    v_xor_b32_dpp v68, v64, v44 quad_perm:[0,1,3,2] row_mask:0xf bank_mask:0xf
    v_xor_b32_dpp v69, v65, v44 quad_perm:[0,1,3,2] row_mask:0xf bank_mask:0xf
    v_xor_b32_dpp v70, v66, v44 quad_perm:[0,1,3,2] row_mask:0xf bank_mask:0xf
    v_xor_b32_dpp v71, v67, v44 quad_perm:[0,1,3,2] row_mask:0xf bank_mask:0xf
    v_accvgpr_write_b32 a200, v68
    v_accvgpr_write_b32 a201, v69
    v_accvgpr_write_b32 a202, v70
    v_accvgpr_write_b32 a203, v71
    v_fract_f32 v48, v31
    v_add_f32 v49, v48, v33
    v_cos_f32 v56, v48
    v_add_f32 v50, v49, v35
    v_cos_f32 v57, v49
    v_add_f32 v51, v50, v33
    v_cos_f32 v58, v50
    v_add_f32 v52, v51, v35
    v_cos_f32 v59, v51
    v_add_f32 v53, v52, v33
    v_cos_f32 v60, v52
    v_add_f32 v54, v53, v35
    v_cos_f32 v61, v53
    v_add_f32 v55, v54, v33
    v_cos_f32 v62, v54
    v_cos_f32 v63, v55
    v_add_f32 v31, v48, v37
    v_cvt_pk_bf16_f32 v64, v56, v57
    v_cvt_pk_bf16_f32 v65, v58, v59
    v_cvt_pk_bf16_f32 v66, v60, v61
    v_cvt_pk_bf16_f32 v67, v62, v63
    v_accvgpr_write_b32 a12, v64
    v_accvgpr_write_b32 a13, v65
    v_accvgpr_write_b32 a14, v66
    v_accvgpr_write_b32 a15, v67
    v_xor_b32_dpp v68, v64, v41 quad_perm:[0,1,3,2] row_mask:0xf bank_mask:0xf
    v_xor_b32_dpp v69, v65, v41 quad_perm:[0,1,3,2] row_mask:0xf bank_mask:0xf
    v_xor_b32_dpp v70, v66, v41 quad_perm:[0,1,3,2] row_mask:0xf bank_mask:0xf
    v_xor_b32_dpp v71, v67, v41 quad_perm:[0,1,3,2] row_mask:0xf bank_mask:0xf
    v_accvgpr_write_b32 a76, v68
    v_accvgpr_write_b32 a77, v69
    v_accvgpr_write_b32 a78, v70
    v_accvgpr_write_b32 a79, v71
    v_xor_b32 v68, v64, v43
    v_xor_b32 v69, v65, v43
    v_xor_b32 v70, v66, v43
    v_xor_b32 v71, v67, v43
    v_accvgpr_write_b32 a140, v68
    v_accvgpr_write_b32 a141, v69
    v_accvgpr_write_b32 a142, v70
    v_accvgpr_write_b32 a143, v71
    v_xor_b32_dpp v68, v64, v45 quad_perm:[0,1,3,2] row_mask:0xf bank_mask:0xf
    v_xor_b32_dpp v69, v65, v45 quad_perm:[0,1,3,2] row_mask:0xf bank_mask:0xf
    v_xor_b32_dpp v70, v66, v45 quad_perm:[0,1,3,2] row_mask:0xf bank_mask:0xf
    v_xor_b32_dpp v71, v67, v45 quad_perm:[0,1,3,2] row_mask:0xf bank_mask:0xf
    v_accvgpr_write_b32 a204, v68
    v_accvgpr_write_b32 a205, v69
    v_accvgpr_write_b32 a206, v70
    v_accvgpr_write_b32 a207, v71
    v_fract_f32 v48, v30
    v_add_f32 v49, v48, v32
    v_cos_f32 v56, v48
    v_add_f32 v50, v49, v34
    v_cos_f32 v57, v49
    v_add_f32 v51, v50, v32
    v_cos_f32 v58, v50
    v_add_f32 v52, v51, v34
    v_cos_f32 v59, v51
    v_add_f32 v53, v52, v32
    v_cos_f32 v60, v52
    v_add_f32 v54, v53, v34
    v_cos_f32 v61, v53
    v_add_f32 v55, v54, v32
    v_cos_f32 v62, v54
    v_cos_f32 v63, v55
    v_add_f32 v30, v48, v36
    v_cvt_pk_bf16_f32 v64, v56, v57
    v_cvt_pk_bf16_f32 v65, v58, v59
    v_cvt_pk_bf16_f32 v66, v60, v61
    v_cvt_pk_bf16_f32 v67, v62, v63
    v_accvgpr_write_b32 a16, v64
    v_accvgpr_write_b32 a17, v65
    v_accvgpr_write_b32 a18, v66
    v_accvgpr_write_b32 a19, v67
    v_xor_b32_dpp v68, v64, v40 quad_perm:[0,1,3,2] row_mask:0xf bank_mask:0xf
    v_xor_b32_dpp v69, v65, v40 quad_perm:[0,1,3,2] row_mask:0xf bank_mask:0xf
    v_xor_b32_dpp v70, v66, v40 quad_perm:[0,1,3,2] row_mask:0xf bank_mask:0xf
    v_xor_b32_dpp v71, v67, v40 quad_perm:[0,1,3,2] row_mask:0xf bank_mask:0xf
    v_accvgpr_write_b32 a80, v68
    v_accvgpr_write_b32 a81, v69
    v_accvgpr_write_b32 a82, v70
    v_accvgpr_write_b32 a83, v71
    v_xor_b32 v68, v64, v42
    v_xor_b32 v69, v65, v42
    v_xor_b32 v70, v66, v42
    v_xor_b32 v71, v67, v42
    v_accvgpr_write_b32 a144, v68
    v_accvgpr_write_b32 a145, v69
    v_accvgpr_write_b32 a146, v70
    v_accvgpr_write_b32 a147, v71
    v_xor_b32_dpp v68, v64, v44 quad_perm:[0,1,3,2] row_mask:0xf bank_mask:0xf
    v_xor_b32_dpp v69, v65, v44 quad_perm:[0,1,3,2] row_mask:0xf bank_mask:0xf
    v_xor_b32_dpp v70, v66, v44 quad_perm:[0,1,3,2] row_mask:0xf bank_mask:0xf
    v_xor_b32_dpp v71, v67, v44 quad_perm:[0,1,3,2] row_mask:0xf bank_mask:0xf
    v_accvgpr_write_b32 a208, v68
    v_accvgpr_write_b32 a209, v69
    v_accvgpr_write_b32 a210, v70
    v_accvgpr_write_b32 a211, v71
    v_fract_f32 v48, v31
    v_add_f32 v49, v48, v33
    v_cos_f32 v56, v48
    v_add_f32 v50, v49, v35
    v_cos_f32 v57, v49
    v_add_f32 v51, v50, v33
    v_cos_f32 v58, v50
    v_add_f32 v52, v51, v35
    v_cos_f32 v59, v51
    v_add_f32 v53, v52, v33
    v_cos_f32 v60, v52
    v_add_f32 v54, v53, v35
    v_cos_f32 v61, v53
    v_add_f32 v55, v54, v33
    v_cos_f32 v62, v54
    v_cos_f32 v63, v55
    v_add_f32 v31, v48, v37
    v_cvt_pk_bf16_f32 v64, v56, v57
    v_cvt_pk_bf16_f32 v65, v58, v59
    v_cvt_pk_bf16_f32 v66, v60, v61
    v_cvt_pk_bf16_f32 v67, v62, v63
    v_accvgpr_write_b32 a20, v64
    v_accvgpr_write_b32 a21, v65
    v_accvgpr_write_b32 a22, v66
    v_accvgpr_write_b32 a23, v67
    v_xor_b32_dpp v68, v64, v41 quad_perm:[0,1,3,2] row_mask:0xf bank_mask:0xf
    v_xor_b32_dpp v69, v65, v41 quad_perm:[0,1,3,2] row_mask:0xf bank_mask:0xf
    v_xor_b32_dpp v70, v66, v41 quad_perm:[0,1,3,2] row_mask:0xf bank_mask:0xf
    v_xor_b32_dpp v71, v67, v41 quad_perm:[0,1,3,2] row_mask:0xf bank_mask:0xf
    v_accvgpr_write_b32 a84, v68
    v_accvgpr_write_b32 a85, v69
    v_accvgpr_write_b32 a86, v70
    v_accvgpr_write_b32 a87, v71
    v_xor_b32 v68, v64, v43
    v_xor_b32 v69, v65, v43
    v_xor_b32 v70, v66, v43
    v_xor_b32 v71, v67, v43
    v_accvgpr_write_b32 a148, v68
    v_accvgpr_write_b32 a149, v69
    v_accvgpr_write_b32 a150, v70
    v_accvgpr_write_b32 a151, v71
    v_xor_b32_dpp v68, v64, v45 quad_perm:[0,1,3,2] row_mask:0xf bank_mask:0xf
    v_xor_b32_dpp v69, v65, v45 quad_perm:[0,1,3,2] row_mask:0xf bank_mask:0xf
    v_xor_b32_dpp v70, v66, v45 quad_perm:[0,1,3,2] row_mask:0xf bank_mask:0xf
    v_xor_b32_dpp v71, v67, v45 quad_perm:[0,1,3,2] row_mask:0xf bank_mask:0xf
    v_accvgpr_write_b32 a212, v68
    v_accvgpr_write_b32 a213, v69
    v_accvgpr_write_b32 a214, v70
    v_accvgpr_write_b32 a215, v71
    v_fract_f32 v48, v30
    v_add_f32 v49, v48, v32
    v_cos_f32 v56, v48
    v_add_f32 v50, v49, v34
    v_cos_f32 v57, v49
    v_add_f32 v51, v50, v32
    v_cos_f32 v58, v50
    v_add_f32 v52, v51, v34
    v_cos_f32 v59, v51
    v_add_f32 v53, v52, v32
    v_cos_f32 v60, v52
    v_add_f32 v54, v53, v34
    v_cos_f32 v61, v53
    v_add_f32 v55, v54, v32
    v_cos_f32 v62, v54
    v_cos_f32 v63, v55
    v_add_f32 v30, v48, v36
    v_cvt_pk_bf16_f32 v64, v56, v57
    v_cvt_pk_bf16_f32 v65, v58, v59
    v_cvt_pk_bf16_f32 v66, v60, v61
    v_cvt_pk_bf16_f32 v67, v62, v63
    v_accvgpr_write_b32 a24, v64
    v_accvgpr_write_b32 a25, v65
    v_accvgpr_write_b32 a26, v66
    v_accvgpr_write_b32 a27, v67
    v_xor_b32_dpp v68, v64, v40 quad_perm:[0,1,3,2] row_mask:0xf bank_mask:0xf
    v_xor_b32_dpp v69, v65, v40 quad_perm:[0,1,3,2] row_mask:0xf bank_mask:0xf
    v_xor_b32_dpp v70, v66, v40 quad_perm:[0,1,3,2] row_mask:0xf bank_mask:0xf
    v_xor_b32_dpp v71, v67, v40 quad_perm:[0,1,3,2] row_mask:0xf bank_mask:0xf
    v_accvgpr_write_b32 a88, v68
    v_accvgpr_write_b32 a89, v69
    v_accvgpr_write_b32 a90, v70
    v_accvgpr_write_b32 a91, v71
    v_xor_b32 v68, v64, v42
    v_xor_b32 v69, v65, v42
    v_xor_b32 v70, v66, v42
    v_xor_b32 v71, v67, v42
    v_accvgpr_write_b32 a152, v68
    v_accvgpr_write_b32 a153, v69
    v_accvgpr_write_b32 a154, v70
    v_accvgpr_write_b32 a155, v71
    v_xor_b32_dpp v68, v64, v44 quad_perm:[0,1,3,2] row_mask:0xf bank_mask:0xf
    v_xor_b32_dpp v69, v65, v44 quad_perm:[0,1,3,2] row_mask:0xf bank_mask:0xf
    v_xor_b32_dpp v70, v66, v44 quad_perm:[0,1,3,2] row_mask:0xf bank_mask:0xf
    v_xor_b32_dpp v71, v67, v44 quad_perm:[0,1,3,2] row_mask:0xf bank_mask:0xf
    v_accvgpr_write_b32 a216, v68
    v_accvgpr_write_b32 a217, v69
    v_accvgpr_write_b32 a218, v70
    v_accvgpr_write_b32 a219, v71
    v_fract_f32 v48, v31
    v_add_f32 v49, v48, v33
    v_cos_f32 v56, v48
    v_add_f32 v50, v49, v35
    v_cos_f32 v57, v49
    v_add_f32 v51, v50, v33
    v_cos_f32 v58, v50
    v_add_f32 v52, v51, v35
    v_cos_f32 v59, v51
    v_add_f32 v53, v52, v33
    v_cos_f32 v60, v52
    v_add_f32 v54, v53, v35
    v_cos_f32 v61, v53
    v_add_f32 v55, v54, v33
    v_cos_f32 v62, v54
    v_cos_f32 v63, v55
    v_add_f32 v31, v48, v37
    v_cvt_pk_bf16_f32 v64, v56, v57
    v_cvt_pk_bf16_f32 v65, v58, v59
    v_cvt_pk_bf16_f32 v66, v60, v61
    v_cvt_pk_bf16_f32 v67, v62, v63
    v_accvgpr_write_b32 a28, v64
    v_accvgpr_write_b32 a29, v65
    v_accvgpr_write_b32 a30, v66
    v_accvgpr_write_b32 a31, v67
    v_xor_b32_dpp v68, v64, v41 quad_perm:[0,1,3,2] row_mask:0xf bank_mask:0xf
    v_xor_b32_dpp v69, v65, v41 quad_perm:[0,1,3,2] row_mask:0xf bank_mask:0xf
    v_xor_b32_dpp v70, v66, v41 quad_perm:[0,1,3,2] row_mask:0xf bank_mask:0xf
    v_xor_b32_dpp v71, v67, v41 quad_perm:[0,1,3,2] row_mask:0xf bank_mask:0xf
    v_accvgpr_write_b32 a92, v68
    v_accvgpr_write_b32 a93, v69
    v_accvgpr_write_b32 a94, v70
    v_accvgpr_write_b32 a95, v71
    v_xor_b32 v68, v64, v43
    v_xor_b32 v69, v65, v43
    v_xor_b32 v70, v66, v43
    v_xor_b32 v71, v67, v43
    v_accvgpr_write_b32 a156, v68
    v_accvgpr_write_b32 a157, v69
    v_accvgpr_write_b32 a158, v70
    v_accvgpr_write_b32 a159, v71
    v_xor_b32_dpp v68, v64, v45 quad_perm:[0,1,3,2] row_mask:0xf bank_mask:0xf
    v_xor_b32_dpp v69, v65, v45 quad_perm:[0,1,3,2] row_mask:0xf bank_mask:0xf
    v_xor_b32_dpp v70, v66, v45 quad_perm:[0,1,3,2] row_mask:0xf bank_mask:0xf
    v_xor_b32_dpp v71, v67, v45 quad_perm:[0,1,3,2] row_mask:0xf bank_mask:0xf
    v_accvgpr_write_b32 a220, v68
    v_accvgpr_write_b32 a221, v69
    v_accvgpr_write_b32 a222, v70
    v_accvgpr_write_b32 a223, v71
    v_fract_f32 v48, v30
    v_add_f32 v49, v48, v32
    v_cos_f32 v56, v48
    v_add_f32 v50, v49, v34
    v_cos_f32 v57, v49
    v_add_f32 v51, v50, v32
    v_cos_f32 v58, v50
    v_add_f32 v52, v51, v34
    v_cos_f32 v59, v51
    v_add_f32 v53, v52, v32
    v_cos_f32 v60, v52
    v_add_f32 v54, v53, v34
    v_cos_f32 v61, v53
    v_add_f32 v55, v54, v32
    v_cos_f32 v62, v54
    v_cos_f32 v63, v55
    v_add_f32 v30, v48, v36
    v_cvt_pk_bf16_f32 v64, v56, v57
    v_cvt_pk_bf16_f32 v65, v58, v59
    v_cvt_pk_bf16_f32 v66, v60, v61
    v_cvt_pk_bf16_f32 v67, v62, v63
    v_accvgpr_write_b32 a32, v64
    v_accvgpr_write_b32 a33, v65
    v_accvgpr_write_b32 a34, v66
    v_accvgpr_write_b32 a35, v67
    v_xor_b32_dpp v68, v64, v40 quad_perm:[0,1,3,2] row_mask:0xf bank_mask:0xf
    v_xor_b32_dpp v69, v65, v40 quad_perm:[0,1,3,2] row_mask:0xf bank_mask:0xf
    v_xor_b32_dpp v70, v66, v40 quad_perm:[0,1,3,2] row_mask:0xf bank_mask:0xf
    v_xor_b32_dpp v71, v67, v40 quad_perm:[0,1,3,2] row_mask:0xf bank_mask:0xf
    v_accvgpr_write_b32 a96, v68
    v_accvgpr_write_b32 a97, v69
    v_accvgpr_write_b32 a98, v70
    v_accvgpr_write_b32 a99, v71
    v_xor_b32 v68, v64, v42
    v_xor_b32 v69, v65, v42
    v_xor_b32 v70, v66, v42
    v_xor_b32 v71, v67, v42
    v_accvgpr_write_b32 a160, v68
    v_accvgpr_write_b32 a161, v69
    v_accvgpr_write_b32 a162, v70
    v_accvgpr_write_b32 a163, v71
    v_xor_b32_dpp v68, v64, v44 quad_perm:[0,1,3,2] row_mask:0xf bank_mask:0xf
    v_xor_b32_dpp v69, v65, v44 quad_perm:[0,1,3,2] row_mask:0xf bank_mask:0xf
    v_xor_b32_dpp v70, v66, v44 quad_perm:[0,1,3,2] row_mask:0xf bank_mask:0xf
    v_xor_b32_dpp v71, v67, v44 quad_perm:[0,1,3,2] row_mask:0xf bank_mask:0xf
    v_accvgpr_write_b32 a224, v68
    v_accvgpr_write_b32 a225, v69
    v_accvgpr_write_b32 a226, v70
    v_accvgpr_write_b32 a227, v71
    v_fract_f32 v48, v31
    v_add_f32 v49, v48, v33
    v_cos_f32 v56, v48
    v_add_f32 v50, v49, v35
    v_cos_f32 v57, v49
    v_add_f32 v51, v50, v33
    v_cos_f32 v58, v50
    v_add_f32 v52, v51, v35
    v_cos_f32 v59, v51
    v_add_f32 v53, v52, v33
    v_cos_f32 v60, v52
    v_add_f32 v54, v53, v35
    v_cos_f32 v61, v53
    v_add_f32 v55, v54, v33
    v_cos_f32 v62, v54
    v_cos_f32 v63, v55
    v_add_f32 v31, v48, v37
    v_cvt_pk_bf16_f32 v64, v56, v57
    v_cvt_pk_bf16_f32 v65, v58, v59
    v_cvt_pk_bf16_f32 v66, v60, v61
    v_cvt_pk_bf16_f32 v67, v62, v63
    v_accvgpr_write_b32 a36, v64
    v_accvgpr_write_b32 a37, v65
    v_accvgpr_write_b32 a38, v66
    v_accvgpr_write_b32 a39, v67
    v_xor_b32_dpp v68, v64, v41 quad_perm:[0,1,3,2] row_mask:0xf bank_mask:0xf
    v_xor_b32_dpp v69, v65, v41 quad_perm:[0,1,3,2] row_mask:0xf bank_mask:0xf
    v_xor_b32_dpp v70, v66, v41 quad_perm:[0,1,3,2] row_mask:0xf bank_mask:0xf
    v_xor_b32_dpp v71, v67, v41 quad_perm:[0,1,3,2] row_mask:0xf bank_mask:0xf
    v_accvgpr_write_b32 a100, v68
    v_accvgpr_write_b32 a101, v69
    v_accvgpr_write_b32 a102, v70
    v_accvgpr_write_b32 a103, v71
    v_xor_b32 v68, v64, v43
    v_xor_b32 v69, v65, v43
    v_xor_b32 v70, v66, v43
    v_xor_b32 v71, v67, v43
    v_accvgpr_write_b32 a164, v68
    v_accvgpr_write_b32 a165, v69
    v_accvgpr_write_b32 a166, v70
    v_accvgpr_write_b32 a167, v71
    v_xor_b32_dpp v68, v64, v45 quad_perm:[0,1,3,2] row_mask:0xf bank_mask:0xf
    v_xor_b32_dpp v69, v65, v45 quad_perm:[0,1,3,2] row_mask:0xf bank_mask:0xf
    v_xor_b32_dpp v70, v66, v45 quad_perm:[0,1,3,2] row_mask:0xf bank_mask:0xf
    v_xor_b32_dpp v71, v67, v45 quad_perm:[0,1,3,2] row_mask:0xf bank_mask:0xf
    v_accvgpr_write_b32 a228, v68
    v_accvgpr_write_b32 a229, v69
    v_accvgpr_write_b32 a230, v70
    v_accvgpr_write_b32 a231, v71
    v_fract_f32 v48, v30
    v_add_f32 v49, v48, v32
    v_cos_f32 v56, v48
    v_add_f32 v50, v49, v34
    v_cos_f32 v57, v49
    v_add_f32 v51, v50, v32
    v_cos_f32 v58, v50
    v_add_f32 v52, v51, v34
    v_cos_f32 v59, v51
    v_add_f32 v53, v52, v32
    v_cos_f32 v60, v52
    v_add_f32 v54, v53, v34
    v_cos_f32 v61, v53
    v_add_f32 v55, v54, v32
    v_cos_f32 v62, v54
    v_cos_f32 v63, v55
    v_add_f32 v30, v48, v36
    v_cvt_pk_bf16_f32 v64, v56, v57
    v_cvt_pk_bf16_f32 v65, v58, v59
    v_cvt_pk_bf16_f32 v66, v60, v61
    v_cvt_pk_bf16_f32 v67, v62, v63
    v_accvgpr_write_b32 a40, v64
    v_accvgpr_write_b32 a41, v65
    v_accvgpr_write_b32 a42, v66
    v_accvgpr_write_b32 a43, v67
    v_xor_b32_dpp v68, v64, v40 quad_perm:[0,1,3,2] row_mask:0xf bank_mask:0xf
    v_xor_b32_dpp v69, v65, v40 quad_perm:[0,1,3,2] row_mask:0xf bank_mask:0xf
    v_xor_b32_dpp v70, v66, v40 quad_perm:[0,1,3,2] row_mask:0xf bank_mask:0xf
    v_xor_b32_dpp v71, v67, v40 quad_perm:[0,1,3,2] row_mask:0xf bank_mask:0xf
    v_accvgpr_write_b32 a104, v68
    v_accvgpr_write_b32 a105, v69
    v_accvgpr_write_b32 a106, v70
    v_accvgpr_write_b32 a107, v71
    v_xor_b32 v68, v64, v42
    v_xor_b32 v69, v65, v42
    v_xor_b32 v70, v66, v42
    v_xor_b32 v71, v67, v42
    v_accvgpr_write_b32 a168, v68
    v_accvgpr_write_b32 a169, v69
    v_accvgpr_write_b32 a170, v70
    v_accvgpr_write_b32 a171, v71
    v_xor_b32_dpp v68, v64, v44 quad_perm:[0,1,3,2] row_mask:0xf bank_mask:0xf
    v_xor_b32_dpp v69, v65, v44 quad_perm:[0,1,3,2] row_mask:0xf bank_mask:0xf
    v_xor_b32_dpp v70, v66, v44 quad_perm:[0,1,3,2] row_mask:0xf bank_mask:0xf
    v_xor_b32_dpp v71, v67, v44 quad_perm:[0,1,3,2] row_mask:0xf bank_mask:0xf
    v_accvgpr_write_b32 a232, v68
    v_accvgpr_write_b32 a233, v69
    v_accvgpr_write_b32 a234, v70
    v_accvgpr_write_b32 a235, v71
    v_fract_f32 v48, v31
    v_add_f32 v49, v48, v33
    v_cos_f32 v56, v48
    v_add_f32 v50, v49, v35
    v_cos_f32 v57, v49
    v_add_f32 v51, v50, v33
    v_cos_f32 v58, v50
    v_add_f32 v52, v51, v35
    v_cos_f32 v59, v51
    v_add_f32 v53, v52, v33
    v_cos_f32 v60, v52
    v_add_f32 v54, v53, v35
    v_cos_f32 v61, v53
    v_add_f32 v55, v54, v33
    v_cos_f32 v62, v54
    v_cos_f32 v63, v55
    v_add_f32 v31, v48, v37
    v_cvt_pk_bf16_f32 v64, v56, v57
    v_cvt_pk_bf16_f32 v65, v58, v59
    v_cvt_pk_bf16_f32 v66, v60, v61
    v_cvt_pk_bf16_f32 v67, v62, v63
    v_accvgpr_write_b32 a44, v64
    v_accvgpr_write_b32 a45, v65
    v_accvgpr_write_b32 a46, v66
    v_accvgpr_write_b32 a47, v67
    v_xor_b32_dpp v68, v64, v41 quad_perm:[0,1,3,2] row_mask:0xf bank_mask:0xf
    v_xor_b32_dpp v69, v65, v41 quad_perm:[0,1,3,2] row_mask:0xf bank_mask:0xf
    v_xor_b32_dpp v70, v66, v41 quad_perm:[0,1,3,2] row_mask:0xf bank_mask:0xf
    v_xor_b32_dpp v71, v67, v41 quad_perm:[0,1,3,2] row_mask:0xf bank_mask:0xf
    v_accvgpr_write_b32 a108, v68
    v_accvgpr_write_b32 a109, v69
    v_accvgpr_write_b32 a110, v70
    v_accvgpr_write_b32 a111, v71
    v_xor_b32 v68, v64, v43
    v_xor_b32 v69, v65, v43
    v_xor_b32 v70, v66, v43
    v_xor_b32 v71, v67, v43
    v_accvgpr_write_b32 a172, v68
    v_accvgpr_write_b32 a173, v69
    v_accvgpr_write_b32 a174, v70
    v_accvgpr_write_b32 a175, v71
    v_xor_b32_dpp v68, v64, v45 quad_perm:[0,1,3,2] row_mask:0xf bank_mask:0xf
    v_xor_b32_dpp v69, v65, v45 quad_perm:[0,1,3,2] row_mask:0xf bank_mask:0xf
    v_xor_b32_dpp v70, v66, v45 quad_perm:[0,1,3,2] row_mask:0xf bank_mask:0xf
    v_xor_b32_dpp v71, v67, v45 quad_perm:[0,1,3,2] row_mask:0xf bank_mask:0xf
    v_accvgpr_write_b32 a236, v68
    v_accvgpr_write_b32 a237, v69
    v_accvgpr_write_b32 a238, v70
    v_accvgpr_write_b32 a239, v71
    v_fract_f32 v48, v30
    v_add_f32 v49, v48, v32
    v_cos_f32 v56, v48
    v_add_f32 v50, v49, v34
    v_cos_f32 v57, v49
    v_add_f32 v51, v50, v32
    v_cos_f32 v58, v50
    v_add_f32 v52, v51, v34
    v_cos_f32 v59, v51
    v_add_f32 v53, v52, v32
    v_cos_f32 v60, v52
    v_add_f32 v54, v53, v34
    v_cos_f32 v61, v53
    v_add_f32 v55, v54, v32
    v_cos_f32 v62, v54
    v_cos_f32 v63, v55
    v_add_f32 v30, v48, v36
    v_cvt_pk_bf16_f32 v64, v56, v57
    v_cvt_pk_bf16_f32 v65, v58, v59
    v_cvt_pk_bf16_f32 v66, v60, v61
    v_cvt_pk_bf16_f32 v67, v62, v63
    v_accvgpr_write_b32 a48, v64
    v_accvgpr_write_b32 a49, v65
    v_accvgpr_write_b32 a50, v66
    v_accvgpr_write_b32 a51, v67
    v_xor_b32_dpp v68, v64, v40 quad_perm:[0,1,3,2] row_mask:0xf bank_mask:0xf
    v_xor_b32_dpp v69, v65, v40 quad_perm:[0,1,3,2] row_mask:0xf bank_mask:0xf
    v_xor_b32_dpp v70, v66, v40 quad_perm:[0,1,3,2] row_mask:0xf bank_mask:0xf
    v_xor_b32_dpp v71, v67, v40 quad_perm:[0,1,3,2] row_mask:0xf bank_mask:0xf
    v_accvgpr_write_b32 a112, v68
    v_accvgpr_write_b32 a113, v69
    v_accvgpr_write_b32 a114, v70
    v_accvgpr_write_b32 a115, v71
    v_xor_b32 v68, v64, v42
    v_xor_b32 v69, v65, v42
    v_xor_b32 v70, v66, v42
    v_xor_b32 v71, v67, v42
    v_accvgpr_write_b32 a176, v68
    v_accvgpr_write_b32 a177, v69
    v_accvgpr_write_b32 a178, v70
    v_accvgpr_write_b32 a179, v71
    v_xor_b32_dpp v68, v64, v44 quad_perm:[0,1,3,2] row_mask:0xf bank_mask:0xf
    v_xor_b32_dpp v69, v65, v44 quad_perm:[0,1,3,2] row_mask:0xf bank_mask:0xf
    v_xor_b32_dpp v70, v66, v44 quad_perm:[0,1,3,2] row_mask:0xf bank_mask:0xf
    v_xor_b32_dpp v71, v67, v44 quad_perm:[0,1,3,2] row_mask:0xf bank_mask:0xf
    v_accvgpr_write_b32 a240, v68
    v_accvgpr_write_b32 a241, v69
    v_accvgpr_write_b32 a242, v70
    v_accvgpr_write_b32 a243, v71
    v_fract_f32 v48, v31
    v_add_f32 v49, v48, v33
    v_cos_f32 v56, v48
    v_add_f32 v50, v49, v35
    v_cos_f32 v57, v49
    v_add_f32 v51, v50, v33
    v_cos_f32 v58, v50
    v_add_f32 v52, v51, v35
    v_cos_f32 v59, v51
    v_add_f32 v53, v52, v33
    v_cos_f32 v60, v52
    v_add_f32 v54, v53, v35
    v_cos_f32 v61, v53
    v_add_f32 v55, v54, v33
    v_cos_f32 v62, v54
    v_cos_f32 v63, v55
    v_add_f32 v31, v48, v37
    v_cvt_pk_bf16_f32 v64, v56, v57
    v_cvt_pk_bf16_f32 v65, v58, v59
    v_cvt_pk_bf16_f32 v66, v60, v61
    v_cvt_pk_bf16_f32 v67, v62, v63
    v_accvgpr_write_b32 a52, v64
    v_accvgpr_write_b32 a53, v65
    v_accvgpr_write_b32 a54, v66
    v_accvgpr_write_b32 a55, v67
    v_xor_b32_dpp v68, v64, v41 quad_perm:[0,1,3,2] row_mask:0xf bank_mask:0xf
    v_xor_b32_dpp v69, v65, v41 quad_perm:[0,1,3,2] row_mask:0xf bank_mask:0xf
    v_xor_b32_dpp v70, v66, v41 quad_perm:[0,1,3,2] row_mask:0xf bank_mask:0xf
    v_xor_b32_dpp v71, v67, v41 quad_perm:[0,1,3,2] row_mask:0xf bank_mask:0xf
    v_accvgpr_write_b32 a116, v68
    v_accvgpr_write_b32 a117, v69
    v_accvgpr_write_b32 a118, v70
    v_accvgpr_write_b32 a119, v71
    v_xor_b32 v68, v64, v43
    v_xor_b32 v69, v65, v43
    v_xor_b32 v70, v66, v43
    v_xor_b32 v71, v67, v43
    v_accvgpr_write_b32 a180, v68
    v_accvgpr_write_b32 a181, v69
    v_accvgpr_write_b32 a182, v70
    v_accvgpr_write_b32 a183, v71
    v_xor_b32_dpp v68, v64, v45 quad_perm:[0,1,3,2] row_mask:0xf bank_mask:0xf
    v_xor_b32_dpp v69, v65, v45 quad_perm:[0,1,3,2] row_mask:0xf bank_mask:0xf
    v_xor_b32_dpp v70, v66, v45 quad_perm:[0,1,3,2] row_mask:0xf bank_mask:0xf
    v_xor_b32_dpp v71, v67, v45 quad_perm:[0,1,3,2] row_mask:0xf bank_mask:0xf
    v_accvgpr_write_b32 a244, v68
    v_accvgpr_write_b32 a245, v69
    v_accvgpr_write_b32 a246, v70
    v_accvgpr_write_b32 a247, v71
    v_fract_f32 v48, v30
    v_add_f32 v49, v48, v32
    v_cos_f32 v56, v48
    v_add_f32 v50, v49, v34
    v_cos_f32 v57, v49
    v_add_f32 v51, v50, v32
    v_cos_f32 v58, v50
    v_add_f32 v52, v51, v34
    v_cos_f32 v59, v51
    v_add_f32 v53, v52, v32
    v_cos_f32 v60, v52
    v_add_f32 v54, v53, v34
    v_cos_f32 v61, v53
    v_add_f32 v55, v54, v32
    v_cos_f32 v62, v54
    v_cos_f32 v63, v55
    v_add_f32 v30, v48, v36
    v_cvt_pk_bf16_f32 v64, v56, v57
    v_cvt_pk_bf16_f32 v65, v58, v59
    v_cvt_pk_bf16_f32 v66, v60, v61
    v_cvt_pk_bf16_f32 v67, v62, v63
    v_accvgpr_write_b32 a56, v64
    v_accvgpr_write_b32 a57, v65
    v_accvgpr_write_b32 a58, v66
    v_accvgpr_write_b32 a59, v67
    v_xor_b32_dpp v68, v64, v40 quad_perm:[0,1,3,2] row_mask:0xf bank_mask:0xf
    v_xor_b32_dpp v69, v65, v40 quad_perm:[0,1,3,2] row_mask:0xf bank_mask:0xf
    v_xor_b32_dpp v70, v66, v40 quad_perm:[0,1,3,2] row_mask:0xf bank_mask:0xf
    v_xor_b32_dpp v71, v67, v40 quad_perm:[0,1,3,2] row_mask:0xf bank_mask:0xf
    v_accvgpr_write_b32 a120, v68
    v_accvgpr_write_b32 a121, v69
    v_accvgpr_write_b32 a122, v70
    v_accvgpr_write_b32 a123, v71
    v_xor_b32 v68, v64, v42
    v_xor_b32 v69, v65, v42
    v_xor_b32 v70, v66, v42
    v_xor_b32 v71, v67, v42
    v_accvgpr_write_b32 a184, v68
    v_accvgpr_write_b32 a185, v69
    v_accvgpr_write_b32 a186, v70
    v_accvgpr_write_b32 a187, v71
    v_xor_b32_dpp v68, v64, v44 quad_perm:[0,1,3,2] row_mask:0xf bank_mask:0xf
    v_xor_b32_dpp v69, v65, v44 quad_perm:[0,1,3,2] row_mask:0xf bank_mask:0xf
    v_xor_b32_dpp v70, v66, v44 quad_perm:[0,1,3,2] row_mask:0xf bank_mask:0xf
    v_xor_b32_dpp v71, v67, v44 quad_perm:[0,1,3,2] row_mask:0xf bank_mask:0xf
    v_accvgpr_write_b32 a248, v68
    v_accvgpr_write_b32 a249, v69
    v_accvgpr_write_b32 a250, v70
    v_accvgpr_write_b32 a251, v71
    v_fract_f32 v48, v31
    v_add_f32 v49, v48, v33
    v_cos_f32 v56, v48
    v_add_f32 v50, v49, v35
    v_cos_f32 v57, v49
    v_add_f32 v51, v50, v33
    v_cos_f32 v58, v50
    v_add_f32 v52, v51, v35
    v_cos_f32 v59, v51
    v_add_f32 v53, v52, v33
    v_cos_f32 v60, v52
    v_add_f32 v54, v53, v35
    v_cos_f32 v61, v53
    v_add_f32 v55, v54, v33
    v_cos_f32 v62, v54
    v_cos_f32 v63, v55
    v_add_f32 v31, v48, v37
    v_cvt_pk_bf16_f32 v64, v56, v57
    v_cvt_pk_bf16_f32 v65, v58, v59
    v_cvt_pk_bf16_f32 v66, v60, v61
    v_cvt_pk_bf16_f32 v67, v62, v63
    v_accvgpr_write_b32 a60, v64
    v_accvgpr_write_b32 a61, v65
    v_accvgpr_write_b32 a62, v66
    v_accvgpr_write_b32 a63, v67
    v_xor_b32_dpp v68, v64, v41 quad_perm:[0,1,3,2] row_mask:0xf bank_mask:0xf
    v_xor_b32_dpp v69, v65, v41 quad_perm:[0,1,3,2] row_mask:0xf bank_mask:0xf
    v_xor_b32_dpp v70, v66, v41 quad_perm:[0,1,3,2] row_mask:0xf bank_mask:0xf
    v_xor_b32_dpp v71, v67, v41 quad_perm:[0,1,3,2] row_mask:0xf bank_mask:0xf
    v_accvgpr_write_b32 a124, v68
    v_accvgpr_write_b32 a125, v69
    v_accvgpr_write_b32 a126, v70
    v_accvgpr_write_b32 a127, v71
    v_xor_b32 v68, v64, v43
    v_xor_b32 v69, v65, v43
    v_xor_b32 v70, v66, v43
    v_xor_b32 v71, v67, v43
    v_accvgpr_write_b32 a188, v68
    v_accvgpr_write_b32 a189, v69
    v_accvgpr_write_b32 a190, v70
    v_accvgpr_write_b32 a191, v71
    v_xor_b32_dpp v68, v64, v45 quad_perm:[0,1,3,2] row_mask:0xf bank_mask:0xf
    v_xor_b32_dpp v69, v65, v45 quad_perm:[0,1,3,2] row_mask:0xf bank_mask:0xf
    v_xor_b32_dpp v70, v66, v45 quad_perm:[0,1,3,2] row_mask:0xf bank_mask:0xf
    v_xor_b32_dpp v71, v67, v45 quad_perm:[0,1,3,2] row_mask:0xf bank_mask:0xf
    v_accvgpr_write_b32 a252, v68
    v_accvgpr_write_b32 a253, v69
    v_accvgpr_write_b32 a254, v70
    v_accvgpr_write_b32 a255, v71
    s_and_b32 s17, s28, 1
    s_lshl_b32 s17, s17, 15
    s_lshr_b32 s18, s28, 1
    s_lshl_b32 s18, s18, 21
    s_add_u32 s17, s17, s18
    s_lshl_b32 s18, s29, 16
    s_add_u32 s17, s17, s18
    v_lshlrev_b32 v15, 7, v1
    s_waitcnt lgkmcnt(0)
    s_mov_b32 s35, s17
    s_lshl_b32 s34, s93, 2
    s_add_u32 s34, s34, s16
    s_lshl_b32 s34, s34, 13
    s_sub_u32 s34, s34, 262144
    v_mov_b32 v247, v15
    s_lshl_b32 s17, s29, 6
    v_add_u32 v246, s17, v1
    v_mul_u32_u24 v246, 1026, v246
    s_lshl_b32 s17, s28, 8
    v_add_u32 v246, s17, v246
    v_and_b32 v246, -4, v246
    s_load_dwordx2 s[8:9], s[0:1], 0
    s_mov_b32 s10, 4194304
    s_mov_b32 s11, 0x20000
    s_waitcnt lgkmcnt(0)
    v_and_b32 v5, 15, v1
    v_bfe_u32 v6, v1, 1, 3
    v_lshrrev_b32 v7, 4, v1
    v_xor_b32 v6, v6, v7
    v_lshlrev_b32 v6, 4, v6
    v_lshl_add_u32 v10, v5, 7, v6
    s_lshl_b32 s19, s16, 10
    v_xor_b32 v11, 64, v10
    v_add_u32 v12, 0x10000, v10
    v_add_u32 v13, 0x10000, v11
    v_lshrrev_b32 v7, 3, v1
    s_lshl_b32 s17, s16, 3
    v_add_u32 v7, s17, v7
    v_bfe_u32 v8, v7, 1, 3
    v_xor_b32 v8, v8, v1
    v_and_b32 v8, 7, v8
    v_bfe_u32 v5, v7, 2, 2
    v_and_b32 v2, 3, v7
    v_lshl_add_u32 v2, v5, 3, v2
    v_bfe_u32 v5, v7, 4, 1
    v_lshl_add_u32 v2, v5, 2, v2
    v_bfe_u32 v5, v1, 2, 2
    v_and_b32 v3, 3, v1
    v_lshl_add_u32 v3, v5, 3, v3
    v_lshlrev_b32 v2, 16, v2
    v_lshl_add_u32 v2, v8, 4, v2
    v_and_b32 v5, 48, v1
    v_lshl_add_u32 v3, v3, 6, v5
    s_mul_i32 s21, s29, 139776
    s_mul_i32 s17, s28, 34816
    s_add_u32 s21, s21, s17
    s_add_u32 s21, s21, 104857600
    s_and_b32 s20, s28, 1
    s_lshl_b32 s20, s20, 15
    s_lshr_b32 s17, s28, 1
    s_lshl_b32 s17, s17, 21
    s_add_u32 s20, s20, s17
    s_mov_b32 s24, 2048
    s_mov_b32 s25, 2176
    s_barrier
    s_mov_b32 s26, s25
    s_sub_u32 s25, s21, 1073741824
    s_mov_b32 s21, 1073741824
    s_mov_b32 s23, 0
    s_mov_b32 s22, 0
    s_add_u32 m0, s19, 0
    s_nop 0
    buffer_load_dwordx4 v2, s[8:11], s20 offen offset:0 lds
    s_add_u32 m0, s19, 3968
    s_nop 0
    buffer_load_dwordx4 v2, s[8:11], s20 offen offset:128 lds
    s_add_u32 m0, s19, 7936
    s_nop 0
    buffer_load_dwordx4 v2, s[8:11], s20 offen offset:256 lds
    s_add_u32 m0, s19, 11904
    s_nop 0
    buffer_load_dwordx4 v2, s[8:11], s20 offen offset:384 lds
    s_add_u32 m0, s19, 15872
    s_nop 0
    buffer_load_dwordx4 v2, s[8:11], s20 offen offset:512 lds
    s_add_u32 m0, s19, 19840
    s_nop 0
    buffer_load_dwordx4 v2, s[8:11], s20 offen offset:640 lds
    s_add_u32 m0, s19, 23808
    s_nop 0
    buffer_load_dwordx4 v2, s[8:11], s20 offen offset:768 lds
    s_add_u32 m0, s19, 27776
    s_nop 0
    buffer_load_dwordx4 v2, s[8:11], s20 offen offset:896 lds
    s_add_u32 m0, s19, 31744
    s_nop 0
    buffer_load_dwordx4 v2, s[8:11], s20 offen offset:1024 lds
    s_add_u32 m0, s19, 35712
    s_nop 0
    buffer_load_dwordx4 v2, s[8:11], s20 offen offset:1152 lds
    s_add_u32 m0, s19, 39680
    s_nop 0
    buffer_load_dwordx4 v2, s[8:11], s20 offen offset:1280 lds
    s_add_u32 m0, s19, 43648
    s_nop 0
    buffer_load_dwordx4 v2, s[8:11], s20 offen offset:1408 lds
    s_add_u32 m0, s19, 47616
    s_nop 0
    buffer_load_dwordx4 v2, s[8:11], s20 offen offset:1536 lds
    s_add_u32 m0, s19, 51584
    s_nop 0
    buffer_load_dwordx4 v2, s[8:11], s20 offen offset:1664 lds
    s_add_u32 m0, s19, 55552
    s_nop 0
    buffer_load_dwordx4 v2, s[8:11], s20 offen offset:1792 lds
    s_add_u32 m0, s19, 59520
    s_nop 0
    buffer_load_dwordx4 v2, s[8:11], s20 offen offset:1920 lds
    s_add_u32 s20, s20, s24
    s_add_u32 m0, s19, 65536
    s_nop 0
    buffer_load_dwordx4 v2, s[8:11], s20 offen offset:0 lds
    s_add_u32 m0, s19, 69504
    s_nop 0
    buffer_load_dwordx4 v2, s[8:11], s20 offen offset:128 lds
    s_add_u32 m0, s19, 73472
    s_nop 0
    buffer_load_dwordx4 v2, s[8:11], s20 offen offset:256 lds
    s_waitcnt vmcnt(11)
    s_barrier
    ds_read_b128 v[20:23], v10 offset:0
    ds_read_b128 v[24:27], v10 offset:2048
    ds_read_b128 v[28:31], v11 offset:0
    ds_read_b128 v[32:35], v11 offset:2048
    ds_read_b128 v[36:39], v10 offset:4096
    ds_read_b128 v[40:43], v10 offset:6144
    ds_read_b128 v[44:47], v11 offset:4096
.p2align 6
F1_top:
    s_waitcnt lgkmcnt(6)
    v_mfma_f32_16x16x32_bf16 v[52:55], v[20:23], a[0:3], 0
    ds_read_b128 v[48:51], v11 offset:6144
    v_mfma_f32_16x16x32_bf16 v[60:63], v[20:23], a[4:7], 0
    s_waitcnt lgkmcnt(6)
    v_mfma_f32_16x16x32_bf16 v[56:59], v[24:27], a[0:3], 0
    ds_read_b128 v[20:23], v10 offset:8192
    s_add_u32 m0, s19, 77440
    v_mfma_f32_16x16x32_bf16 v[64:67], v[24:27], a[4:7], 0
    buffer_load_dwordx4 v2, s[8:11], s20 offen offset:384 lds
    s_waitcnt lgkmcnt(6)
    v_mfma_f32_16x16x32_bf16 v[52:55], v[28:31], a[8:11], v[52:55]
    ds_read_b128 v[24:27], v10 offset:10240
    v_mfma_f32_16x16x32_bf16 v[60:63], v[28:31], a[12:15], v[60:63]
    s_waitcnt lgkmcnt(6)
    v_mfma_f32_16x16x32_bf16 v[56:59], v[32:35], a[8:11], v[56:59]
    ds_read_b128 v[28:31], v11 offset:8192
    s_add_u32 m0, s19, 81408
    v_mfma_f32_16x16x32_bf16 v[64:67], v[32:35], a[12:15], v[64:67]
    buffer_load_dwordx4 v2, s[8:11], s20 offen offset:512 lds
    s_waitcnt lgkmcnt(6)
    v_mfma_f32_16x16x32_bf16 v[52:55], v[36:39], a[16:19], v[52:55]
    ds_read_b128 v[32:35], v11 offset:10240
    v_mfma_f32_16x16x32_bf16 v[60:63], v[36:39], a[20:23], v[60:63]
    s_waitcnt lgkmcnt(6)
    v_mfma_f32_16x16x32_bf16 v[56:59], v[40:43], a[16:19], v[56:59]
    ds_read_b128 v[36:39], v10 offset:12288
    s_add_u32 m0, s19, 85376
    v_mfma_f32_16x16x32_bf16 v[64:67], v[40:43], a[20:23], v[64:67]
    buffer_load_dwordx4 v2, s[8:11], s20 offen offset:640 lds
    s_waitcnt lgkmcnt(6)
    v_mfma_f32_16x16x32_bf16 v[52:55], v[44:47], a[24:27], v[52:55]
    ds_read_b128 v[40:43], v10 offset:14336
    v_mfma_f32_16x16x32_bf16 v[60:63], v[44:47], a[28:31], v[60:63]
    s_waitcnt lgkmcnt(6)
    v_mfma_f32_16x16x32_bf16 v[56:59], v[48:51], a[24:27], v[56:59]
    ds_read_b128 v[44:47], v11 offset:12288
    s_add_u32 m0, s19, 89344
    v_mfma_f32_16x16x32_bf16 v[64:67], v[48:51], a[28:31], v[64:67]
    buffer_load_dwordx4 v2, s[8:11], s20 offen offset:768 lds
    s_waitcnt lgkmcnt(6)
    v_mfma_f32_16x16x32_bf16 v[52:55], v[20:23], a[32:35], v[52:55]
    ds_read_b128 v[48:51], v11 offset:14336
    v_mfma_f32_16x16x32_bf16 v[60:63], v[20:23], a[36:39], v[60:63]
    s_waitcnt lgkmcnt(6)
    v_mfma_f32_16x16x32_bf16 v[56:59], v[24:27], a[32:35], v[56:59]
    ds_read_b128 v[20:23], v10 offset:16384
    s_add_u32 m0, s19, 93312
    v_mfma_f32_16x16x32_bf16 v[64:67], v[24:27], a[36:39], v[64:67]
    buffer_load_dwordx4 v2, s[8:11], s20 offen offset:896 lds
    s_waitcnt lgkmcnt(6)
    v_mfma_f32_16x16x32_bf16 v[52:55], v[28:31], a[40:43], v[52:55]
    ds_read_b128 v[24:27], v10 offset:18432
    v_mfma_f32_16x16x32_bf16 v[60:63], v[28:31], a[44:47], v[60:63]
    v_cvt_pk_bf16_f32 v84, v68, v69
    s_waitcnt lgkmcnt(6)
    v_mfma_f32_16x16x32_bf16 v[56:59], v[32:35], a[40:43], v[56:59]
    ds_read_b128 v[28:31], v11 offset:16384
    v_mfma_f32_16x16x32_bf16 v[64:67], v[32:35], a[44:47], v[64:67]
    v_cvt_pk_bf16_f32 v85, v70, v71
    s_waitcnt lgkmcnt(6)
    v_mfma_f32_16x16x32_bf16 v[52:55], v[36:39], a[48:51], v[52:55]
    ds_read_b128 v[32:35], v11 offset:18432
    v_mfma_f32_16x16x32_bf16 v[60:63], v[36:39], a[52:55], v[60:63]
    v_cvt_pk_bf16_f32 v86, v72, v73
    s_waitcnt lgkmcnt(6)
    v_mfma_f32_16x16x32_bf16 v[56:59], v[40:43], a[48:51], v[56:59]
    ds_read_b128 v[36:39], v10 offset:20480
    v_mfma_f32_16x16x32_bf16 v[64:67], v[40:43], a[52:55], v[64:67]
    v_cvt_pk_bf16_f32 v87, v74, v75
    s_waitcnt lgkmcnt(6)
    v_mfma_f32_16x16x32_bf16 v[52:55], v[44:47], a[56:59], v[52:55]
    ds_read_b128 v[40:43], v10 offset:22528
    v_mfma_f32_16x16x32_bf16 v[60:63], v[44:47], a[60:63], v[60:63]
    v_cvt_pk_bf16_f32 v88, v76, v77
    s_waitcnt lgkmcnt(6)
    v_mfma_f32_16x16x32_bf16 v[56:59], v[48:51], a[56:59], v[56:59]
    ds_read_b128 v[44:47], v11 offset:20480
    v_mfma_f32_16x16x32_bf16 v[64:67], v[48:51], a[60:63], v[64:67]
    v_cvt_pk_bf16_f32 v89, v78, v79
    buffer_store_dwordx4 v[84:87], v3, s[4:7], s21 offen offset:0 sc1
    s_waitcnt lgkmcnt(6)
    v_mfma_f32_16x16x32_bf16 v[52:55], v[20:23], a[64:67], v[52:55]
    ds_read_b128 v[48:51], v11 offset:22528
    v_mfma_f32_16x16x32_bf16 v[60:63], v[20:23], a[68:71], v[60:63]
    v_cvt_pk_bf16_f32 v90, v80, v81
    s_waitcnt lgkmcnt(6)
    v_mfma_f32_16x16x32_bf16 v[56:59], v[24:27], a[64:67], v[56:59]
    ds_read_b128 v[20:23], v10 offset:24576
    v_mfma_f32_16x16x32_bf16 v[64:67], v[24:27], a[68:71], v[64:67]
    v_cvt_pk_bf16_f32 v91, v82, v83
    s_waitcnt lgkmcnt(6)
    v_mfma_f32_16x16x32_bf16 v[52:55], v[28:31], a[72:75], v[52:55]
    ds_read_b128 v[24:27], v10 offset:26624
    v_mfma_f32_16x16x32_bf16 v[60:63], v[28:31], a[76:79], v[60:63]
    s_waitcnt lgkmcnt(6)
    v_mfma_f32_16x16x32_bf16 v[56:59], v[32:35], a[72:75], v[56:59]
    ds_read_b128 v[28:31], v11 offset:24576
    v_mfma_f32_16x16x32_bf16 v[64:67], v[32:35], a[76:79], v[64:67]
    buffer_store_dwordx4 v[88:91], v3, s[4:7], s21 offen offset:256 sc1
    s_waitcnt lgkmcnt(6)
    v_mfma_f32_16x16x32_bf16 v[52:55], v[36:39], a[80:83], v[52:55]
    ds_read_b128 v[32:35], v11 offset:26624
    v_mfma_f32_16x16x32_bf16 v[60:63], v[36:39], a[84:87], v[60:63]
    s_add_u32 s21, s21, s25
    s_mov_b32 s25, s26
    s_waitcnt lgkmcnt(6)
    v_mfma_f32_16x16x32_bf16 v[56:59], v[40:43], a[80:83], v[56:59]
    ds_read_b128 v[36:39], v10 offset:28672
    v_mfma_f32_16x16x32_bf16 v[64:67], v[40:43], a[84:87], v[64:67]
    s_waitcnt lgkmcnt(6)
    v_mfma_f32_16x16x32_bf16 v[52:55], v[44:47], a[88:91], v[52:55]
    ds_read_b128 v[40:43], v10 offset:30720
    v_mfma_f32_16x16x32_bf16 v[60:63], v[44:47], a[92:95], v[60:63]
    s_cmp_lt_u32 s34, 4194304
    s_cbranch_scc0 F1s0
    buffer_load_dword v248, v247, s[44:47], s34 offen
F1s0:
    s_add_u32 s34, s34, 1048576
    s_sub_u32 s31, s22, 10
    s_lshl_b32 s31, s31, 6
    s_cmp_lt_u32 s31, 384
    s_cselect_b32 s31, s31, 1073741824
    s_cbranch_scc0 F1s1
    buffer_load_dword v249, v246, s[48:51], s31 offen
    buffer_load_dword v250, v246, s[52:55], s31 offen
F1s1:
    s_cmp_eq_u32 s22, 2
    s_cselect_b32 s31, s35, 1073741824
    s_cbranch_scc0 F1s2
    buffer_load_dword v251, v247, s[40:43], s31 offen
    s_add_u32 s31, s31, 8192
    buffer_load_dword v251, v247, s[40:43], s31 offen
    s_add_u32 s31, s31, 8192
    buffer_load_dword v251, v247, s[40:43], s31 offen
    s_add_u32 s31, s31, 8192
    buffer_load_dword v251, v247, s[40:43], s31 offen
    s_add_u32 s31, s31, 8192
F1s2:
    s_waitcnt lgkmcnt(6)
    v_mfma_f32_16x16x32_bf16 v[56:59], v[48:51], a[88:91], v[56:59]
    ds_read_b128 v[44:47], v11 offset:28672
    v_mfma_f32_16x16x32_bf16 v[64:67], v[48:51], a[92:95], v[64:67]
    s_waitcnt lgkmcnt(6)
    v_mfma_f32_16x16x32_bf16 v[52:55], v[20:23], a[96:99], v[52:55]
    ds_read_b128 v[48:51], v11 offset:30720
    v_mfma_f32_16x16x32_bf16 v[60:63], v[20:23], a[100:103], v[60:63]
    s_waitcnt lgkmcnt(6)
    v_mfma_f32_16x16x32_bf16 v[56:59], v[24:27], a[96:99], v[56:59]
    s_waitcnt vmcnt(10)
    s_barrier
    ds_read_b128 v[20:23], v10 offset:32768
    v_mfma_f32_16x16x32_bf16 v[64:67], v[24:27], a[100:103], v[64:67]
    s_waitcnt lgkmcnt(6)
    v_mfma_f32_16x16x32_bf16 v[52:55], v[28:31], a[104:107], v[52:55]
    ds_read_b128 v[24:27], v10 offset:34816
    s_add_u32 m0, s19, 97280
    v_mfma_f32_16x16x32_bf16 v[60:63], v[28:31], a[108:111], v[60:63]
    buffer_load_dwordx4 v2, s[8:11], s20 offen offset:1024 lds
    s_waitcnt lgkmcnt(6)
    v_mfma_f32_16x16x32_bf16 v[56:59], v[32:35], a[104:107], v[56:59]
    ds_read_b128 v[28:31], v11 offset:32768
    v_mfma_f32_16x16x32_bf16 v[64:67], v[32:35], a[108:111], v[64:67]
    s_waitcnt lgkmcnt(6)
    v_mfma_f32_16x16x32_bf16 v[52:55], v[36:39], a[112:115], v[52:55]
    ds_read_b128 v[32:35], v11 offset:34816
    s_add_u32 m0, s19, 101248
    v_mfma_f32_16x16x32_bf16 v[60:63], v[36:39], a[116:119], v[60:63]
    buffer_load_dwordx4 v2, s[8:11], s20 offen offset:1152 lds
    s_waitcnt lgkmcnt(6)
    v_mfma_f32_16x16x32_bf16 v[56:59], v[40:43], a[112:115], v[56:59]
    ds_read_b128 v[36:39], v10 offset:36864
    v_mfma_f32_16x16x32_bf16 v[64:67], v[40:43], a[116:119], v[64:67]
    s_waitcnt lgkmcnt(6)
    v_mfma_f32_16x16x32_bf16 v[52:55], v[44:47], a[120:123], v[52:55]
    ds_read_b128 v[40:43], v10 offset:38912
    s_add_u32 m0, s19, 105216
    v_mfma_f32_16x16x32_bf16 v[60:63], v[44:47], a[124:127], v[60:63]
    buffer_load_dwordx4 v2, s[8:11], s20 offen offset:1280 lds
    s_waitcnt lgkmcnt(6)
    v_mfma_f32_16x16x32_bf16 v[56:59], v[48:51], a[120:123], v[56:59]
    ds_read_b128 v[44:47], v11 offset:36864
    v_mfma_f32_16x16x32_bf16 v[64:67], v[48:51], a[124:127], v[64:67]
    s_waitcnt lgkmcnt(6)
    v_mfma_f32_16x16x32_bf16 v[52:55], v[20:23], a[128:131], v[52:55]
    ds_read_b128 v[48:51], v11 offset:38912
    v_mfma_f32_16x16x32_bf16 v[60:63], v[20:23], a[132:135], v[60:63]
    s_waitcnt lgkmcnt(6)
    v_mfma_f32_16x16x32_bf16 v[56:59], v[24:27], a[128:131], v[56:59]
    ds_read_b128 v[20:23], v10 offset:40960
    s_add_u32 m0, s19, 109184
    v_mfma_f32_16x16x32_bf16 v[64:67], v[24:27], a[132:135], v[64:67]
    buffer_load_dwordx4 v2, s[8:11], s20 offen offset:1408 lds
    s_waitcnt lgkmcnt(6)
    v_mfma_f32_16x16x32_bf16 v[52:55], v[28:31], a[136:139], v[52:55]
    ds_read_b128 v[24:27], v10 offset:43008
    v_mfma_f32_16x16x32_bf16 v[60:63], v[28:31], a[140:143], v[60:63]
    s_waitcnt lgkmcnt(6)
    v_mfma_f32_16x16x32_bf16 v[56:59], v[32:35], a[136:139], v[56:59]
    ds_read_b128 v[28:31], v11 offset:40960
    s_add_u32 m0, s19, 113152
    v_mfma_f32_16x16x32_bf16 v[64:67], v[32:35], a[140:143], v[64:67]
    buffer_load_dwordx4 v2, s[8:11], s20 offen offset:1536 lds
    s_waitcnt lgkmcnt(6)
    v_mfma_f32_16x16x32_bf16 v[52:55], v[36:39], a[144:147], v[52:55]
    ds_read_b128 v[32:35], v11 offset:43008
    v_mfma_f32_16x16x32_bf16 v[60:63], v[36:39], a[148:151], v[60:63]
    s_waitcnt lgkmcnt(6)
    v_mfma_f32_16x16x32_bf16 v[56:59], v[40:43], a[144:147], v[56:59]
    ds_read_b128 v[36:39], v10 offset:45056
    s_add_u32 m0, s19, 117120
    v_mfma_f32_16x16x32_bf16 v[64:67], v[40:43], a[148:151], v[64:67]
    buffer_load_dwordx4 v2, s[8:11], s20 offen offset:1664 lds
    s_waitcnt lgkmcnt(6)
    v_mfma_f32_16x16x32_bf16 v[52:55], v[44:47], a[152:155], v[52:55]
    ds_read_b128 v[40:43], v10 offset:47104
    v_mfma_f32_16x16x32_bf16 v[60:63], v[44:47], a[156:159], v[60:63]
    s_waitcnt lgkmcnt(6)
    v_mfma_f32_16x16x32_bf16 v[56:59], v[48:51], a[152:155], v[56:59]
    ds_read_b128 v[44:47], v11 offset:45056
    s_add_u32 m0, s19, 121088
    v_mfma_f32_16x16x32_bf16 v[64:67], v[48:51], a[156:159], v[64:67]
    buffer_load_dwordx4 v2, s[8:11], s20 offen offset:1792 lds
    s_waitcnt lgkmcnt(6)
    v_mfma_f32_16x16x32_bf16 v[52:55], v[20:23], a[160:163], v[52:55]
    ds_read_b128 v[48:51], v11 offset:47104
    v_mfma_f32_16x16x32_bf16 v[60:63], v[20:23], a[164:167], v[60:63]
    s_waitcnt lgkmcnt(6)
    v_mfma_f32_16x16x32_bf16 v[56:59], v[24:27], a[160:163], v[56:59]
    ds_read_b128 v[20:23], v10 offset:49152
    s_add_u32 m0, s19, 125056
    v_mfma_f32_16x16x32_bf16 v[64:67], v[24:27], a[164:167], v[64:67]
    buffer_load_dwordx4 v2, s[8:11], s20 offen offset:1920 lds
    s_waitcnt lgkmcnt(6)
    v_mfma_f32_16x16x32_bf16 v[52:55], v[28:31], a[168:171], v[52:55]
    ds_read_b128 v[24:27], v10 offset:51200
    v_mfma_f32_16x16x32_bf16 v[60:63], v[28:31], a[172:175], v[60:63]
    s_add_u32 s20, s20, s24
    s_waitcnt lgkmcnt(6)
    v_mfma_f32_16x16x32_bf16 v[56:59], v[32:35], a[168:171], v[56:59]
    ds_read_b128 v[28:31], v11 offset:49152
    v_mfma_f32_16x16x32_bf16 v[64:67], v[32:35], a[172:175], v[64:67]
    s_waitcnt lgkmcnt(6)
    v_mfma_f32_16x16x32_bf16 v[52:55], v[36:39], a[176:179], v[52:55]
    ds_read_b128 v[32:35], v11 offset:51200
    v_mfma_f32_16x16x32_bf16 v[60:63], v[36:39], a[180:183], v[60:63]
    s_waitcnt lgkmcnt(6)
    v_mfma_f32_16x16x32_bf16 v[56:59], v[40:43], a[176:179], v[56:59]
    ds_read_b128 v[36:39], v10 offset:53248
    v_mfma_f32_16x16x32_bf16 v[64:67], v[40:43], a[180:183], v[64:67]
    s_waitcnt lgkmcnt(6)
    v_mfma_f32_16x16x32_bf16 v[52:55], v[44:47], a[184:187], v[52:55]
    ds_read_b128 v[40:43], v10 offset:55296
    v_mfma_f32_16x16x32_bf16 v[60:63], v[44:47], a[188:191], v[60:63]
    s_waitcnt lgkmcnt(6)
    v_mfma_f32_16x16x32_bf16 v[56:59], v[48:51], a[184:187], v[56:59]
    ds_read_b128 v[44:47], v11 offset:53248
    v_mfma_f32_16x16x32_bf16 v[64:67], v[48:51], a[188:191], v[64:67]
    s_waitcnt lgkmcnt(6)
    v_mfma_f32_16x16x32_bf16 v[52:55], v[20:23], a[192:195], v[52:55]
    ds_read_b128 v[48:51], v11 offset:55296
    v_mfma_f32_16x16x32_bf16 v[60:63], v[20:23], a[196:199], v[60:63]
    s_waitcnt lgkmcnt(6)
    v_mfma_f32_16x16x32_bf16 v[56:59], v[24:27], a[192:195], v[56:59]
    ds_read_b128 v[20:23], v10 offset:57344
    v_mfma_f32_16x16x32_bf16 v[64:67], v[24:27], a[196:199], v[64:67]
    s_waitcnt lgkmcnt(6)
    v_mfma_f32_16x16x32_bf16 v[52:55], v[28:31], a[200:203], v[52:55]
    ds_read_b128 v[24:27], v10 offset:59392
    v_mfma_f32_16x16x32_bf16 v[60:63], v[28:31], a[204:207], v[60:63]
    s_waitcnt lgkmcnt(6)
    v_mfma_f32_16x16x32_bf16 v[56:59], v[32:35], a[200:203], v[56:59]
    ds_read_b128 v[28:31], v11 offset:57344
    v_mfma_f32_16x16x32_bf16 v[64:67], v[32:35], a[204:207], v[64:67]
    s_waitcnt lgkmcnt(6)
    v_mfma_f32_16x16x32_bf16 v[52:55], v[36:39], a[208:211], v[52:55]
    ds_read_b128 v[32:35], v11 offset:59392
    v_mfma_f32_16x16x32_bf16 v[60:63], v[36:39], a[212:215], v[60:63]
    s_waitcnt lgkmcnt(6)
    v_mfma_f32_16x16x32_bf16 v[56:59], v[40:43], a[208:211], v[56:59]
    ds_read_b128 v[36:39], v10 offset:61440
    v_mfma_f32_16x16x32_bf16 v[64:67], v[40:43], a[212:215], v[64:67]
    s_waitcnt lgkmcnt(6)
    v_mfma_f32_16x16x32_bf16 v[52:55], v[44:47], a[216:219], v[52:55]
    ds_read_b128 v[40:43], v10 offset:63488
    v_mfma_f32_16x16x32_bf16 v[60:63], v[44:47], a[220:223], v[60:63]
    s_waitcnt lgkmcnt(6)
    v_mfma_f32_16x16x32_bf16 v[56:59], v[48:51], a[216:219], v[56:59]
    ds_read_b128 v[44:47], v11 offset:61440
    v_mfma_f32_16x16x32_bf16 v[64:67], v[48:51], a[220:223], v[64:67]
    s_waitcnt lgkmcnt(6)
    v_mfma_f32_16x16x32_bf16 v[52:55], v[20:23], a[224:227], v[52:55]
    ds_read_b128 v[48:51], v11 offset:63488
    v_mfma_f32_16x16x32_bf16 v[60:63], v[20:23], a[228:231], v[60:63]
    s_waitcnt lgkmcnt(6)
    v_mfma_f32_16x16x32_bf16 v[56:59], v[24:27], a[224:227], v[56:59]
    s_waitcnt vmcnt(8)
    s_barrier
    ds_read_b128 v[20:23], v12 offset:0
    v_mfma_f32_16x16x32_bf16 v[64:67], v[24:27], a[228:231], v[64:67]
    s_waitcnt lgkmcnt(6)
    v_mfma_f32_16x16x32_bf16 v[52:55], v[28:31], a[232:235], v[52:55]
    ds_read_b128 v[24:27], v12 offset:2048
    s_add_u32 m0, s19, 0
    v_mfma_f32_16x16x32_bf16 v[60:63], v[28:31], a[236:239], v[60:63]
    buffer_load_dwordx4 v2, s[8:11], s20 offen offset:0 lds
    s_waitcnt lgkmcnt(6)
    v_mfma_f32_16x16x32_bf16 v[56:59], v[32:35], a[232:235], v[56:59]
    ds_read_b128 v[28:31], v13 offset:0
    v_mfma_f32_16x16x32_bf16 v[64:67], v[32:35], a[236:239], v[64:67]
    s_waitcnt lgkmcnt(6)
    v_mfma_f32_16x16x32_bf16 v[52:55], v[36:39], a[240:243], v[52:55]
    ds_read_b128 v[32:35], v13 offset:2048
    s_add_u32 m0, s19, 3968
    v_mfma_f32_16x16x32_bf16 v[60:63], v[36:39], a[244:247], v[60:63]
    buffer_load_dwordx4 v2, s[8:11], s20 offen offset:128 lds
    s_waitcnt lgkmcnt(6)
    v_mfma_f32_16x16x32_bf16 v[56:59], v[40:43], a[240:243], v[56:59]
    ds_read_b128 v[36:39], v12 offset:4096
    v_mfma_f32_16x16x32_bf16 v[64:67], v[40:43], a[244:247], v[64:67]
    s_waitcnt lgkmcnt(6)
    v_mfma_f32_16x16x32_bf16 v[52:55], v[44:47], a[248:251], v[52:55]
    ds_read_b128 v[40:43], v12 offset:6144
    s_add_u32 m0, s19, 7936
    v_mfma_f32_16x16x32_bf16 v[60:63], v[44:47], a[252:255], v[60:63]
    buffer_load_dwordx4 v2, s[8:11], s20 offen offset:256 lds
    s_waitcnt lgkmcnt(6)
    v_mfma_f32_16x16x32_bf16 v[56:59], v[48:51], a[248:251], v[56:59]
    ds_read_b128 v[44:47], v13 offset:4096
    v_mfma_f32_16x16x32_bf16 v[64:67], v[48:51], a[252:255], v[64:67]
    s_waitcnt lgkmcnt(6)
    v_mfma_f32_16x16x32_bf16 v[68:71], v[20:23], a[0:3], 0
    ds_read_b128 v[48:51], v13 offset:6144
    v_mfma_f32_16x16x32_bf16 v[76:79], v[20:23], a[4:7], 0
    s_waitcnt lgkmcnt(6)
    v_mfma_f32_16x16x32_bf16 v[72:75], v[24:27], a[0:3], 0
    ds_read_b128 v[20:23], v12 offset:8192
    s_add_u32 m0, s19, 11904
    v_mfma_f32_16x16x32_bf16 v[80:83], v[24:27], a[4:7], 0
    buffer_load_dwordx4 v2, s[8:11], s20 offen offset:384 lds
    s_waitcnt lgkmcnt(6)
    v_mfma_f32_16x16x32_bf16 v[68:71], v[28:31], a[8:11], v[68:71]
    ds_read_b128 v[24:27], v12 offset:10240
    v_mfma_f32_16x16x32_bf16 v[76:79], v[28:31], a[12:15], v[76:79]
    s_waitcnt lgkmcnt(6)
    v_mfma_f32_16x16x32_bf16 v[72:75], v[32:35], a[8:11], v[72:75]
    ds_read_b128 v[28:31], v13 offset:8192
    s_add_u32 m0, s19, 15872
    v_mfma_f32_16x16x32_bf16 v[80:83], v[32:35], a[12:15], v[80:83]
    buffer_load_dwordx4 v2, s[8:11], s20 offen offset:512 lds
    s_waitcnt lgkmcnt(6)
    v_mfma_f32_16x16x32_bf16 v[68:71], v[36:39], a[16:19], v[68:71]
    ds_read_b128 v[32:35], v13 offset:10240
    v_mfma_f32_16x16x32_bf16 v[76:79], v[36:39], a[20:23], v[76:79]
    s_waitcnt lgkmcnt(6)
    v_mfma_f32_16x16x32_bf16 v[72:75], v[40:43], a[16:19], v[72:75]
    ds_read_b128 v[36:39], v12 offset:12288
    s_add_u32 m0, s19, 19840
    v_mfma_f32_16x16x32_bf16 v[80:83], v[40:43], a[20:23], v[80:83]
    buffer_load_dwordx4 v2, s[8:11], s20 offen offset:640 lds
    s_waitcnt lgkmcnt(6)
    v_mfma_f32_16x16x32_bf16 v[68:71], v[44:47], a[24:27], v[68:71]
    ds_read_b128 v[40:43], v12 offset:14336
    v_mfma_f32_16x16x32_bf16 v[76:79], v[44:47], a[28:31], v[76:79]
    s_waitcnt lgkmcnt(6)
    v_mfma_f32_16x16x32_bf16 v[72:75], v[48:51], a[24:27], v[72:75]
    ds_read_b128 v[44:47], v13 offset:12288
    s_add_u32 m0, s19, 23808
    v_mfma_f32_16x16x32_bf16 v[80:83], v[48:51], a[28:31], v[80:83]
    buffer_load_dwordx4 v2, s[8:11], s20 offen offset:768 lds
    s_waitcnt lgkmcnt(6)
    v_mfma_f32_16x16x32_bf16 v[68:71], v[20:23], a[32:35], v[68:71]
    ds_read_b128 v[48:51], v13 offset:14336
    v_mfma_f32_16x16x32_bf16 v[76:79], v[20:23], a[36:39], v[76:79]
    s_waitcnt lgkmcnt(6)
    v_mfma_f32_16x16x32_bf16 v[72:75], v[24:27], a[32:35], v[72:75]
    ds_read_b128 v[20:23], v12 offset:16384
    s_add_u32 m0, s19, 27776
    v_mfma_f32_16x16x32_bf16 v[80:83], v[24:27], a[36:39], v[80:83]
    buffer_load_dwordx4 v2, s[8:11], s20 offen offset:896 lds
    s_waitcnt lgkmcnt(6)
    v_mfma_f32_16x16x32_bf16 v[68:71], v[28:31], a[40:43], v[68:71]
    ds_read_b128 v[24:27], v12 offset:18432
    v_mfma_f32_16x16x32_bf16 v[76:79], v[28:31], a[44:47], v[76:79]
    v_cvt_pk_bf16_f32 v84, v52, v53
    s_waitcnt lgkmcnt(6)
    v_mfma_f32_16x16x32_bf16 v[72:75], v[32:35], a[40:43], v[72:75]
    ds_read_b128 v[28:31], v13 offset:16384
    v_mfma_f32_16x16x32_bf16 v[80:83], v[32:35], a[44:47], v[80:83]
    v_cvt_pk_bf16_f32 v85, v54, v55
    s_waitcnt lgkmcnt(6)
    v_mfma_f32_16x16x32_bf16 v[68:71], v[36:39], a[48:51], v[68:71]
    ds_read_b128 v[32:35], v13 offset:18432
    v_mfma_f32_16x16x32_bf16 v[76:79], v[36:39], a[52:55], v[76:79]
    v_cvt_pk_bf16_f32 v86, v56, v57
    s_waitcnt lgkmcnt(6)
    v_mfma_f32_16x16x32_bf16 v[72:75], v[40:43], a[48:51], v[72:75]
    ds_read_b128 v[36:39], v12 offset:20480
    v_mfma_f32_16x16x32_bf16 v[80:83], v[40:43], a[52:55], v[80:83]
    v_cvt_pk_bf16_f32 v87, v58, v59
    s_waitcnt lgkmcnt(6)
    v_mfma_f32_16x16x32_bf16 v[68:71], v[44:47], a[56:59], v[68:71]
    ds_read_b128 v[40:43], v12 offset:22528
    v_mfma_f32_16x16x32_bf16 v[76:79], v[44:47], a[60:63], v[76:79]
    v_cvt_pk_bf16_f32 v88, v60, v61
    s_waitcnt lgkmcnt(6)
    v_mfma_f32_16x16x32_bf16 v[72:75], v[48:51], a[56:59], v[72:75]
    ds_read_b128 v[44:47], v13 offset:20480
    v_mfma_f32_16x16x32_bf16 v[80:83], v[48:51], a[60:63], v[80:83]
    v_cvt_pk_bf16_f32 v89, v62, v63
    buffer_store_dwordx4 v[84:87], v3, s[4:7], s21 offen offset:0 sc1
    s_waitcnt lgkmcnt(6)
    v_mfma_f32_16x16x32_bf16 v[68:71], v[20:23], a[64:67], v[68:71]
    ds_read_b128 v[48:51], v13 offset:22528
    v_mfma_f32_16x16x32_bf16 v[76:79], v[20:23], a[68:71], v[76:79]
    v_cvt_pk_bf16_f32 v90, v64, v65
    s_waitcnt lgkmcnt(6)
    v_mfma_f32_16x16x32_bf16 v[72:75], v[24:27], a[64:67], v[72:75]
    ds_read_b128 v[20:23], v12 offset:24576
    v_mfma_f32_16x16x32_bf16 v[80:83], v[24:27], a[68:71], v[80:83]
    v_cvt_pk_bf16_f32 v91, v66, v67
    s_waitcnt lgkmcnt(6)
    v_mfma_f32_16x16x32_bf16 v[68:71], v[28:31], a[72:75], v[68:71]
    ds_read_b128 v[24:27], v12 offset:26624
    v_mfma_f32_16x16x32_bf16 v[76:79], v[28:31], a[76:79], v[76:79]
    s_waitcnt lgkmcnt(6)
    v_mfma_f32_16x16x32_bf16 v[72:75], v[32:35], a[72:75], v[72:75]
    ds_read_b128 v[28:31], v13 offset:24576
    v_mfma_f32_16x16x32_bf16 v[80:83], v[32:35], a[76:79], v[80:83]
    buffer_store_dwordx4 v[88:91], v3, s[4:7], s21 offen offset:256 sc1
    s_waitcnt lgkmcnt(6)
    v_mfma_f32_16x16x32_bf16 v[68:71], v[36:39], a[80:83], v[68:71]
    ds_read_b128 v[32:35], v13 offset:26624
    v_mfma_f32_16x16x32_bf16 v[76:79], v[36:39], a[84:87], v[76:79]
    s_add_u32 s21, s21, s25
    s_mov_b32 s25, s26
    s_waitcnt lgkmcnt(6)
    v_mfma_f32_16x16x32_bf16 v[72:75], v[40:43], a[80:83], v[72:75]
    ds_read_b128 v[36:39], v12 offset:28672
    v_mfma_f32_16x16x32_bf16 v[80:83], v[40:43], a[84:87], v[80:83]
    s_waitcnt lgkmcnt(6)
    v_mfma_f32_16x16x32_bf16 v[68:71], v[44:47], a[88:91], v[68:71]
    ds_read_b128 v[40:43], v12 offset:30720
    v_mfma_f32_16x16x32_bf16 v[76:79], v[44:47], a[92:95], v[76:79]
    s_waitcnt lgkmcnt(6)
    v_mfma_f32_16x16x32_bf16 v[72:75], v[48:51], a[88:91], v[72:75]
    ds_read_b128 v[44:47], v13 offset:28672
    v_mfma_f32_16x16x32_bf16 v[80:83], v[48:51], a[92:95], v[80:83]
    s_waitcnt lgkmcnt(6)
    v_mfma_f32_16x16x32_bf16 v[68:71], v[20:23], a[96:99], v[68:71]
    ds_read_b128 v[48:51], v13 offset:30720
    v_mfma_f32_16x16x32_bf16 v[76:79], v[20:23], a[100:103], v[76:79]
    s_waitcnt lgkmcnt(6)
    v_mfma_f32_16x16x32_bf16 v[72:75], v[24:27], a[96:99], v[72:75]
    s_waitcnt vmcnt(10)
    s_barrier
    ds_read_b128 v[20:23], v12 offset:32768
    v_mfma_f32_16x16x32_bf16 v[80:83], v[24:27], a[100:103], v[80:83]
    s_waitcnt lgkmcnt(6)
    v_mfma_f32_16x16x32_bf16 v[68:71], v[28:31], a[104:107], v[68:71]
    ds_read_b128 v[24:27], v12 offset:34816
    s_add_u32 m0, s19, 31744
    v_mfma_f32_16x16x32_bf16 v[76:79], v[28:31], a[108:111], v[76:79]
    buffer_load_dwordx4 v2, s[8:11], s20 offen offset:1024 lds
    s_waitcnt lgkmcnt(6)
    v_mfma_f32_16x16x32_bf16 v[72:75], v[32:35], a[104:107], v[72:75]
    ds_read_b128 v[28:31], v13 offset:32768
    v_mfma_f32_16x16x32_bf16 v[80:83], v[32:35], a[108:111], v[80:83]
    s_waitcnt lgkmcnt(6)
    v_mfma_f32_16x16x32_bf16 v[68:71], v[36:39], a[112:115], v[68:71]
    ds_read_b128 v[32:35], v13 offset:34816
    s_add_u32 m0, s19, 35712
    v_mfma_f32_16x16x32_bf16 v[76:79], v[36:39], a[116:119], v[76:79]
    buffer_load_dwordx4 v2, s[8:11], s20 offen offset:1152 lds
    s_waitcnt lgkmcnt(6)
    v_mfma_f32_16x16x32_bf16 v[72:75], v[40:43], a[112:115], v[72:75]
    ds_read_b128 v[36:39], v12 offset:36864
    v_mfma_f32_16x16x32_bf16 v[80:83], v[40:43], a[116:119], v[80:83]
    s_waitcnt lgkmcnt(6)
    v_mfma_f32_16x16x32_bf16 v[68:71], v[44:47], a[120:123], v[68:71]
    ds_read_b128 v[40:43], v12 offset:38912
    s_add_u32 m0, s19, 39680
    v_mfma_f32_16x16x32_bf16 v[76:79], v[44:47], a[124:127], v[76:79]
    buffer_load_dwordx4 v2, s[8:11], s20 offen offset:1280 lds
    s_waitcnt lgkmcnt(6)
    v_mfma_f32_16x16x32_bf16 v[72:75], v[48:51], a[120:123], v[72:75]
    ds_read_b128 v[44:47], v13 offset:36864
    v_mfma_f32_16x16x32_bf16 v[80:83], v[48:51], a[124:127], v[80:83]
    s_waitcnt lgkmcnt(6)
    v_mfma_f32_16x16x32_bf16 v[68:71], v[20:23], a[128:131], v[68:71]
    ds_read_b128 v[48:51], v13 offset:38912
    v_mfma_f32_16x16x32_bf16 v[76:79], v[20:23], a[132:135], v[76:79]
    s_waitcnt lgkmcnt(6)
    v_mfma_f32_16x16x32_bf16 v[72:75], v[24:27], a[128:131], v[72:75]
    ds_read_b128 v[20:23], v12 offset:40960
    s_add_u32 m0, s19, 43648
    v_mfma_f32_16x16x32_bf16 v[80:83], v[24:27], a[132:135], v[80:83]
    buffer_load_dwordx4 v2, s[8:11], s20 offen offset:1408 lds
    s_waitcnt lgkmcnt(6)
    v_mfma_f32_16x16x32_bf16 v[68:71], v[28:31], a[136:139], v[68:71]
    ds_read_b128 v[24:27], v12 offset:43008
    v_mfma_f32_16x16x32_bf16 v[76:79], v[28:31], a[140:143], v[76:79]
    s_waitcnt lgkmcnt(6)
    v_mfma_f32_16x16x32_bf16 v[72:75], v[32:35], a[136:139], v[72:75]
    ds_read_b128 v[28:31], v13 offset:40960
    s_add_u32 m0, s19, 47616
    v_mfma_f32_16x16x32_bf16 v[80:83], v[32:35], a[140:143], v[80:83]
    buffer_load_dwordx4 v2, s[8:11], s20 offen offset:1536 lds
    s_waitcnt lgkmcnt(6)
    v_mfma_f32_16x16x32_bf16 v[68:71], v[36:39], a[144:147], v[68:71]
    ds_read_b128 v[32:35], v13 offset:43008
    v_mfma_f32_16x16x32_bf16 v[76:79], v[36:39], a[148:151], v[76:79]
    s_waitcnt lgkmcnt(6)
    v_mfma_f32_16x16x32_bf16 v[72:75], v[40:43], a[144:147], v[72:75]
    ds_read_b128 v[36:39], v12 offset:45056
    s_add_u32 m0, s19, 51584
    v_mfma_f32_16x16x32_bf16 v[80:83], v[40:43], a[148:151], v[80:83]
    buffer_load_dwordx4 v2, s[8:11], s20 offen offset:1664 lds
    s_waitcnt lgkmcnt(6)
    v_mfma_f32_16x16x32_bf16 v[68:71], v[44:47], a[152:155], v[68:71]
    ds_read_b128 v[40:43], v12 offset:47104
    v_mfma_f32_16x16x32_bf16 v[76:79], v[44:47], a[156:159], v[76:79]
    s_waitcnt lgkmcnt(6)
    v_mfma_f32_16x16x32_bf16 v[72:75], v[48:51], a[152:155], v[72:75]
    ds_read_b128 v[44:47], v13 offset:45056
    s_add_u32 m0, s19, 55552
    v_mfma_f32_16x16x32_bf16 v[80:83], v[48:51], a[156:159], v[80:83]
    buffer_load_dwordx4 v2, s[8:11], s20 offen offset:1792 lds
    s_waitcnt lgkmcnt(6)
    v_mfma_f32_16x16x32_bf16 v[68:71], v[20:23], a[160:163], v[68:71]
    ds_read_b128 v[48:51], v13 offset:47104
    v_mfma_f32_16x16x32_bf16 v[76:79], v[20:23], a[164:167], v[76:79]
    s_waitcnt lgkmcnt(6)
    v_mfma_f32_16x16x32_bf16 v[72:75], v[24:27], a[160:163], v[72:75]
    ds_read_b128 v[20:23], v12 offset:49152
    s_add_u32 m0, s19, 59520
    v_mfma_f32_16x16x32_bf16 v[80:83], v[24:27], a[164:167], v[80:83]
    buffer_load_dwordx4 v2, s[8:11], s20 offen offset:1920 lds
    s_waitcnt lgkmcnt(6)
    v_mfma_f32_16x16x32_bf16 v[68:71], v[28:31], a[168:171], v[68:71]
    ds_read_b128 v[24:27], v12 offset:51200
    v_mfma_f32_16x16x32_bf16 v[76:79], v[28:31], a[172:175], v[76:79]
    s_add_u32 s20, s20, s24
    s_waitcnt lgkmcnt(6)
    v_mfma_f32_16x16x32_bf16 v[72:75], v[32:35], a[168:171], v[72:75]
    ds_read_b128 v[28:31], v13 offset:49152
    v_mfma_f32_16x16x32_bf16 v[80:83], v[32:35], a[172:175], v[80:83]
    s_waitcnt lgkmcnt(6)
    v_mfma_f32_16x16x32_bf16 v[68:71], v[36:39], a[176:179], v[68:71]
    ds_read_b128 v[32:35], v13 offset:51200
    v_mfma_f32_16x16x32_bf16 v[76:79], v[36:39], a[180:183], v[76:79]
    s_waitcnt lgkmcnt(6)
    v_mfma_f32_16x16x32_bf16 v[72:75], v[40:43], a[176:179], v[72:75]
    ds_read_b128 v[36:39], v12 offset:53248
    v_mfma_f32_16x16x32_bf16 v[80:83], v[40:43], a[180:183], v[80:83]
    s_waitcnt lgkmcnt(6)
    v_mfma_f32_16x16x32_bf16 v[68:71], v[44:47], a[184:187], v[68:71]
    ds_read_b128 v[40:43], v12 offset:55296
    v_mfma_f32_16x16x32_bf16 v[76:79], v[44:47], a[188:191], v[76:79]
    s_waitcnt lgkmcnt(6)
    v_mfma_f32_16x16x32_bf16 v[72:75], v[48:51], a[184:187], v[72:75]
    ds_read_b128 v[44:47], v13 offset:53248
    v_mfma_f32_16x16x32_bf16 v[80:83], v[48:51], a[188:191], v[80:83]
    s_waitcnt lgkmcnt(6)
    v_mfma_f32_16x16x32_bf16 v[68:71], v[20:23], a[192:195], v[68:71]
    ds_read_b128 v[48:51], v13 offset:55296
    v_mfma_f32_16x16x32_bf16 v[76:79], v[20:23], a[196:199], v[76:79]
    s_waitcnt lgkmcnt(6)
    v_mfma_f32_16x16x32_bf16 v[72:75], v[24:27], a[192:195], v[72:75]
    ds_read_b128 v[20:23], v12 offset:57344
    v_mfma_f32_16x16x32_bf16 v[80:83], v[24:27], a[196:199], v[80:83]
    s_waitcnt lgkmcnt(6)
    v_mfma_f32_16x16x32_bf16 v[68:71], v[28:31], a[200:203], v[68:71]
    ds_read_b128 v[24:27], v12 offset:59392
    v_mfma_f32_16x16x32_bf16 v[76:79], v[28:31], a[204:207], v[76:79]
    s_waitcnt lgkmcnt(6)
    v_mfma_f32_16x16x32_bf16 v[72:75], v[32:35], a[200:203], v[72:75]
    ds_read_b128 v[28:31], v13 offset:57344
    v_mfma_f32_16x16x32_bf16 v[80:83], v[32:35], a[204:207], v[80:83]
    s_waitcnt lgkmcnt(6)
    v_mfma_f32_16x16x32_bf16 v[68:71], v[36:39], a[208:211], v[68:71]
    ds_read_b128 v[32:35], v13 offset:59392
    v_mfma_f32_16x16x32_bf16 v[76:79], v[36:39], a[212:215], v[76:79]
    s_waitcnt lgkmcnt(6)
    v_mfma_f32_16x16x32_bf16 v[72:75], v[40:43], a[208:211], v[72:75]
    ds_read_b128 v[36:39], v12 offset:61440
    v_mfma_f32_16x16x32_bf16 v[80:83], v[40:43], a[212:215], v[80:83]
    s_waitcnt lgkmcnt(6)
    v_mfma_f32_16x16x32_bf16 v[68:71], v[44:47], a[216:219], v[68:71]
    ds_read_b128 v[40:43], v12 offset:63488
    v_mfma_f32_16x16x32_bf16 v[76:79], v[44:47], a[220:223], v[76:79]
    s_waitcnt lgkmcnt(6)
    v_mfma_f32_16x16x32_bf16 v[72:75], v[48:51], a[216:219], v[72:75]
    ds_read_b128 v[44:47], v13 offset:61440
    v_mfma_f32_16x16x32_bf16 v[80:83], v[48:51], a[220:223], v[80:83]
    s_waitcnt lgkmcnt(6)
    v_mfma_f32_16x16x32_bf16 v[68:71], v[20:23], a[224:227], v[68:71]
    ds_read_b128 v[48:51], v13 offset:63488
    v_mfma_f32_16x16x32_bf16 v[76:79], v[20:23], a[228:231], v[76:79]
    s_waitcnt lgkmcnt(6)
    v_mfma_f32_16x16x32_bf16 v[72:75], v[24:27], a[224:227], v[72:75]
    s_waitcnt vmcnt(8)
    s_barrier
    ds_read_b128 v[20:23], v10 offset:0
    v_mfma_f32_16x16x32_bf16 v[80:83], v[24:27], a[228:231], v[80:83]
    s_waitcnt lgkmcnt(6)
    v_mfma_f32_16x16x32_bf16 v[68:71], v[28:31], a[232:235], v[68:71]
    ds_read_b128 v[24:27], v10 offset:2048
    s_add_u32 m0, s19, 65536
    v_mfma_f32_16x16x32_bf16 v[76:79], v[28:31], a[236:239], v[76:79]
    buffer_load_dwordx4 v2, s[8:11], s20 offen offset:0 lds
    s_waitcnt lgkmcnt(6)
    v_mfma_f32_16x16x32_bf16 v[72:75], v[32:35], a[232:235], v[72:75]
    ds_read_b128 v[28:31], v11 offset:0
    v_mfma_f32_16x16x32_bf16 v[80:83], v[32:35], a[236:239], v[80:83]
    s_waitcnt lgkmcnt(6)
    v_mfma_f32_16x16x32_bf16 v[68:71], v[36:39], a[240:243], v[68:71]
    ds_read_b128 v[32:35], v11 offset:2048
    s_add_u32 m0, s19, 69504
    v_mfma_f32_16x16x32_bf16 v[76:79], v[36:39], a[244:247], v[76:79]
    buffer_load_dwordx4 v2, s[8:11], s20 offen offset:128 lds
    s_waitcnt lgkmcnt(6)
    v_mfma_f32_16x16x32_bf16 v[72:75], v[40:43], a[240:243], v[72:75]
    ds_read_b128 v[36:39], v10 offset:4096
    v_mfma_f32_16x16x32_bf16 v[80:83], v[40:43], a[244:247], v[80:83]
    s_waitcnt lgkmcnt(6)
    v_mfma_f32_16x16x32_bf16 v[68:71], v[44:47], a[248:251], v[68:71]
    ds_read_b128 v[40:43], v10 offset:6144
    s_add_u32 m0, s19, 73472
    v_mfma_f32_16x16x32_bf16 v[76:79], v[44:47], a[252:255], v[76:79]
    buffer_load_dwordx4 v2, s[8:11], s20 offen offset:256 lds
    s_waitcnt lgkmcnt(6)
    v_mfma_f32_16x16x32_bf16 v[72:75], v[48:51], a[248:251], v[72:75]
    ds_read_b128 v[44:47], v11 offset:4096
    v_mfma_f32_16x16x32_bf16 v[80:83], v[48:51], a[252:255], v[80:83]
    s_add_u32 s22, s22, 2
    s_cmp_lt_u32 s22, 16
    s_cbranch_scc1 F1_top
    v_cvt_pk_bf16_f32 v84, v68, v69
    v_cvt_pk_bf16_f32 v85, v70, v71
    s_nop 0
    v_cvt_pk_bf16_f32 v86, v72, v73
    v_cvt_pk_bf16_f32 v87, v74, v75
    v_cvt_pk_bf16_f32 v88, v76, v77
    v_cvt_pk_bf16_f32 v89, v78, v79
    v_cvt_pk_bf16_f32 v90, v80, v81
    v_cvt_pk_bf16_f32 v91, v82, v83
    buffer_store_dwordx4 v[84:87], v3, s[4:7], s21 offen offset:0 sc1
    buffer_store_dwordx4 v[88:91], v3, s[4:7], s21 offen offset:256 sc1
    s_waitcnt vmcnt(0) lgkmcnt(0)
    v_lshlrev_b32 v5, 2, v1
    s_mov_b32 s18, 0
rdv_19:
    global_load_dword v6, v5, s[100:101] sc1
    s_waitcnt vmcnt(0)
rdv_19p:
    s_lshl_b32 s17, s98, 2
    v_lshrrev_b32 v9, s17, v6
    s_cmp_eq_u32 s98, 0
    s_cselect_b32 s17, 0x0f0f0f0f, s17
    s_cselect_b32 s17, s17, 0x01010101
    v_and_b32 v9, s17, v9
    v_cmp_ne_u32 vcc, 0x01010101, v9
    s_nop 0
    s_cbranch_vccz rdvok_20
    v_sad_u8 v9, v9, 0, 0
    s_nop 1
    v_add_u32_dpp v9, v9, v9 quad_perm:[1,0,3,2] row_mask:0xf bank_mask:0xf
    v_cmp_ne_u32 vcc, 8, v9
    s_nop 0
    s_cbranch_vccnz rdvw_21
    s_mov_b32 s98, 1
    s_and_b32 s3, s97, 7
    s_waitcnt vmcnt(0) lgkmcnt(0)
    s_barrier
    s_branch role_start
rdvw_21:
    s_sleep 4
    s_add_u32 s18, s18, 1
    s_cmp_lt_u32 s18, 262144
    s_cbranch_scc1 rdv_19
    s_mov_b32 s92, 1048576
rdvok_20:
    v_and_b32 v9, 0x40404040, v6
    v_bcnt_u32_b32 v9, v9, 0
    s_mov_b32 s89, 0
    v_cmp_le_u32 vcc, 1, v9
    s_nop 0
    s_bcnt1_i32_b64 s17, vcc
    s_add_u32 s89, s89, s17
    v_cmp_le_u32 vcc, 2, v9
    s_nop 0
    s_bcnt1_i32_b64 s17, vcc
    s_add_u32 s89, s89, s17
    v_cmp_le_u32 vcc, 3, v9
    s_nop 0
    s_bcnt1_i32_b64 s17, vcc
    s_add_u32 s89, s89, s17
    v_cmp_le_u32 vcc, 4, v9
    s_nop 0
    s_bcnt1_i32_b64 s17, vcc
    s_add_u32 s89, s89, s17
    s_cmp_gt_u32 s89, 16
    s_cselect_b32 s89, 8192, 0
    s_barrier
    s_lshl_b32 s31, s29, 2
    s_add_u32 s31, s31, s28
    s_lshl_b32 s17, s31, 7
    s_add_u32 s17, s17, 100745216
    v_lshl_add_u32 v5, v1, 2, s17
    v_mov_b32 v6, 1
    s_mov_b64 exec, 0xffffffff
    buffer_store_dword v6, v5, s[4:7], 0 offen sc1
    s_mov_b64 exec, -1
    v_and_b32 v10, 19, v1
    v_bfe_u32 v5, v1, 2, 1
    v_bfe_u32 v6, v1, 3, 1
    v_lshl_add_u32 v10, v5, 3, v10
    v_lshl_add_u32 v10, v6, 2, v10
    v_lshrrev_b32 v8, 1, v1
    v_and_b32 v19, 19, v8
    v_bfe_u32 v5, v8, 2, 1
    v_bfe_u32 v6, v8, 3, 1
    v_lshl_add_u32 v19, v5, 3, v19
    v_lshl_add_u32 v19, v6, 2, v19
    s_load_dwordx2 s[12:13], s[0:1], 80
    s_mov_b32 s14, 8388608
    s_mov_b32 s15, 0x20000
    v_lshrrev_b32 v11, 5, v1
    v_lshl_add_u32 v12, v11, 9, v10
    v_mul_u32_u24 v12, 1026, v12
    v_and_b32 v13, 1, v1
    v_lshlrev_b32 v13, 4, v13
    v_lshlrev_b32 v14, 4, v1
    s_lshr_b32 s17, s16, 1
    s_and_b32 s18, s16, 1
    s_lshl_b32 s17, s17, 5
    s_lshl_b32 s18, s18, 10
    s_add_u32 s17, s17, s18
    s_mul_i32 s20, s17, 1026
    s_lshl_b32 s17, s93, 5
    s_add_u32 s20, s20, s17
    v_mul_u32_u24 v19, 1026, v19
    v_add_u32 v19, v19, v13
    s_mov_b32 s32, 0x05040100
    s_mov_b32 s33, 0x07060302
    v_cvt_f32_u32 v16, v10
    v_lshlrev_b32 v17, 3, v11
    v_cvt_f32_u32 v17, v17
    s_add_u32 s17, s20, 0
    buffer_load_dwordx4 v[60:63], v19, s[48:51], s17 offen
    v_add_f32 v5, 0, v16
    v_mul_f32 v5, 1015021568, v5
    v_mul_f32 v6, v5, v17
    v_mul_f32 v7, 0x41800000, v5
    v_fract_f32 v32, v6
    v_add_f32 v33, v32, v5
    v_add_f32 v34, v33, v5
    v_add_f32 v35, v34, v5
    v_add_f32 v36, v35, v5
    v_add_f32 v37, v36, v5
    v_add_f32 v38, v37, v5
    v_add_f32 v39, v38, v5
    v_add_f32 v6, v32, v7
    v_cos_f32 v40, v32
    v_sin_f32 v48, v32
    v_cos_f32 v41, v33
    buffer_load_dwordx4 v[64:67], v19, s[52:55], s17 offen
    v_sin_f32 v49, v33
    v_cos_f32 v42, v34
    v_sin_f32 v50, v34
    v_cos_f32 v43, v35
    v_sin_f32 v51, v35
    v_cos_f32 v44, v36
    v_sin_f32 v52, v36
    v_cos_f32 v45, v37
    v_sin_f32 v53, v37
    v_cos_f32 v46, v38
    v_sin_f32 v54, v38
    v_cos_f32 v47, v39
    v_sin_f32 v55, v39
    v_cvt_pk_bf16_f32 v56, v40, v41
    v_cvt_pk_bf16_f32 v57, v48, v49
    v_accvgpr_write_b32 a0, v56
    v_xor_b32 v58, 0x80008000, v57
    s_add_u32 s17, s20, 131328
    buffer_load_dwordx4 v[68:71], v19, s[48:51], s17 offen
    v_accvgpr_write_b32 a32, v57
    v_accvgpr_write_b32 a64, v58
    v_cvt_pk_bf16_f32 v56, v42, v43
    v_cvt_pk_bf16_f32 v57, v50, v51
    v_accvgpr_write_b32 a1, v56
    v_xor_b32 v58, 0x80008000, v57
    v_accvgpr_write_b32 a33, v57
    v_accvgpr_write_b32 a65, v58
    v_cvt_pk_bf16_f32 v56, v44, v45
    v_cvt_pk_bf16_f32 v57, v52, v53
    v_accvgpr_write_b32 a2, v56
    v_xor_b32 v58, 0x80008000, v57
    v_accvgpr_write_b32 a34, v57
    v_accvgpr_write_b32 a66, v58
    v_cvt_pk_bf16_f32 v56, v46, v47
    v_cvt_pk_bf16_f32 v57, v54, v55
    v_accvgpr_write_b32 a3, v56
    buffer_load_dwordx4 v[72:75], v19, s[52:55], s17 offen
    v_xor_b32 v58, 0x80008000, v57
    v_accvgpr_write_b32 a35, v57
    v_accvgpr_write_b32 a67, v58
    v_fract_f32 v32, v6
    v_add_f32 v33, v32, v5
    v_add_f32 v34, v33, v5
    v_add_f32 v35, v34, v5
    v_add_f32 v36, v35, v5
    v_add_f32 v37, v36, v5
    v_add_f32 v38, v37, v5
    v_add_f32 v39, v38, v5
    v_add_f32 v6, v32, v7
    v_cos_f32 v40, v32
    v_sin_f32 v48, v32
    v_cos_f32 v41, v33
    v_sin_f32 v49, v33
    s_add_u32 s17, s20, 262656
    buffer_load_dwordx4 v[76:79], v19, s[48:51], s17 offen
    v_cos_f32 v42, v34
    v_sin_f32 v50, v34
    v_cos_f32 v43, v35
    v_sin_f32 v51, v35
    v_cos_f32 v44, v36
    v_sin_f32 v52, v36
    v_cos_f32 v45, v37
    v_sin_f32 v53, v37
    v_cos_f32 v46, v38
    v_sin_f32 v54, v38
    v_cos_f32 v47, v39
    v_sin_f32 v55, v39
    v_cvt_pk_bf16_f32 v56, v40, v41
    v_cvt_pk_bf16_f32 v57, v48, v49
    v_accvgpr_write_b32 a4, v56
    v_xor_b32 v58, 0x80008000, v57
    v_accvgpr_write_b32 a36, v57
    buffer_load_dwordx4 v[80:83], v19, s[52:55], s17 offen
    v_accvgpr_write_b32 a68, v58
    v_cvt_pk_bf16_f32 v56, v42, v43
    v_cvt_pk_bf16_f32 v57, v50, v51
    v_accvgpr_write_b32 a5, v56
    v_xor_b32 v58, 0x80008000, v57
    v_accvgpr_write_b32 a37, v57
    v_accvgpr_write_b32 a69, v58
    v_cvt_pk_bf16_f32 v56, v44, v45
    v_cvt_pk_bf16_f32 v57, v52, v53
    v_accvgpr_write_b32 a6, v56
    v_xor_b32 v58, 0x80008000, v57
    v_accvgpr_write_b32 a38, v57
    v_accvgpr_write_b32 a70, v58
    v_cvt_pk_bf16_f32 v56, v46, v47
    v_cvt_pk_bf16_f32 v57, v54, v55
    v_accvgpr_write_b32 a7, v56
    v_xor_b32 v58, 0x80008000, v57
    s_add_u32 s17, s20, 393984
    buffer_load_dwordx4 v[84:87], v19, s[48:51], s17 offen
    v_accvgpr_write_b32 a39, v57
    v_accvgpr_write_b32 a71, v58
    v_fract_f32 v32, v6
    v_add_f32 v33, v32, v5
    v_add_f32 v34, v33, v5
    v_add_f32 v35, v34, v5
    v_add_f32 v36, v35, v5
    v_add_f32 v37, v36, v5
    v_add_f32 v38, v37, v5
    v_add_f32 v39, v38, v5
    v_add_f32 v6, v32, v7
    v_cos_f32 v40, v32
    v_sin_f32 v48, v32
    v_cos_f32 v41, v33
    v_sin_f32 v49, v33
    v_cos_f32 v42, v34
    buffer_load_dwordx4 v[88:91], v19, s[52:55], s17 offen
    v_sin_f32 v50, v34
    v_cos_f32 v43, v35
    v_sin_f32 v51, v35
    v_cos_f32 v44, v36
    v_sin_f32 v52, v36
    v_cos_f32 v45, v37
    v_sin_f32 v53, v37
    v_cos_f32 v46, v38
    v_sin_f32 v54, v38
    v_cos_f32 v47, v39
    v_sin_f32 v55, v39
    v_cvt_pk_bf16_f32 v56, v40, v41
    v_cvt_pk_bf16_f32 v57, v48, v49
    v_accvgpr_write_b32 a8, v56
    v_xor_b32 v58, 0x80008000, v57
    v_accvgpr_write_b32 a40, v57
    v_accvgpr_write_b32 a72, v58
    s_add_u32 s17, s20, 525312
    buffer_load_dwordx4 v[92:95], v19, s[48:51], s17 offen
    v_cvt_pk_bf16_f32 v56, v42, v43
    v_cvt_pk_bf16_f32 v57, v50, v51
    v_accvgpr_write_b32 a9, v56
    v_xor_b32 v58, 0x80008000, v57
    v_accvgpr_write_b32 a41, v57
    v_accvgpr_write_b32 a73, v58
    v_cvt_pk_bf16_f32 v56, v44, v45
    v_cvt_pk_bf16_f32 v57, v52, v53
    v_accvgpr_write_b32 a10, v56
    v_xor_b32 v58, 0x80008000, v57
    v_accvgpr_write_b32 a42, v57
    v_accvgpr_write_b32 a74, v58
    v_cvt_pk_bf16_f32 v56, v46, v47
    v_cvt_pk_bf16_f32 v57, v54, v55
    v_accvgpr_write_b32 a11, v56
    v_xor_b32 v58, 0x80008000, v57
    v_accvgpr_write_b32 a43, v57
    buffer_load_dwordx4 v[96:99], v19, s[52:55], s17 offen
    v_accvgpr_write_b32 a75, v58
    v_fract_f32 v32, v6
    v_add_f32 v33, v32, v5
    v_add_f32 v34, v33, v5
    v_add_f32 v35, v34, v5
    v_add_f32 v36, v35, v5
    v_add_f32 v37, v36, v5
    v_add_f32 v38, v37, v5
    v_add_f32 v39, v38, v5
    v_add_f32 v6, v32, v7
    v_cos_f32 v40, v32
    v_sin_f32 v48, v32
    v_cos_f32 v41, v33
    v_sin_f32 v49, v33
    v_cos_f32 v42, v34
    v_sin_f32 v50, v34
    s_add_u32 s17, s20, 656640
    buffer_load_dwordx4 v[100:103], v19, s[48:51], s17 offen
    v_cos_f32 v43, v35
    v_sin_f32 v51, v35
    v_cos_f32 v44, v36
    v_sin_f32 v52, v36
    v_cos_f32 v45, v37
    v_sin_f32 v53, v37
    v_cos_f32 v46, v38
    v_sin_f32 v54, v38
    v_cos_f32 v47, v39
    v_sin_f32 v55, v39
    v_cvt_pk_bf16_f32 v56, v40, v41
    v_cvt_pk_bf16_f32 v57, v48, v49
    v_accvgpr_write_b32 a12, v56
    v_xor_b32 v58, 0x80008000, v57
    v_accvgpr_write_b32 a44, v57
    v_accvgpr_write_b32 a76, v58
    v_cvt_pk_bf16_f32 v56, v42, v43
    buffer_load_dwordx4 v[104:107], v19, s[52:55], s17 offen
    v_cvt_pk_bf16_f32 v57, v50, v51
    v_accvgpr_write_b32 a13, v56
    v_xor_b32 v58, 0x80008000, v57
    v_accvgpr_write_b32 a45, v57
    v_accvgpr_write_b32 a77, v58
    v_cvt_pk_bf16_f32 v56, v44, v45
    v_cvt_pk_bf16_f32 v57, v52, v53
    v_accvgpr_write_b32 a14, v56
    v_xor_b32 v58, 0x80008000, v57
    v_accvgpr_write_b32 a46, v57
    v_accvgpr_write_b32 a78, v58
    v_cvt_pk_bf16_f32 v56, v46, v47
    v_cvt_pk_bf16_f32 v57, v54, v55
    v_accvgpr_write_b32 a15, v56
    v_xor_b32 v58, 0x80008000, v57
    v_accvgpr_write_b32 a47, v57
    v_accvgpr_write_b32 a79, v58
    s_add_u32 s17, s20, 787968
    buffer_load_dwordx4 v[108:111], v19, s[48:51], s17 offen
    v_add_f32 v5, 1107296256, v16
    v_mul_f32 v5, 1015021568, v5
    v_mul_f32 v6, v5, v17
    v_mul_f32 v7, 0x41800000, v5
    v_fract_f32 v32, v6
    v_add_f32 v33, v32, v5
    v_add_f32 v34, v33, v5
    v_add_f32 v35, v34, v5
    v_add_f32 v36, v35, v5
    v_add_f32 v37, v36, v5
    v_add_f32 v38, v37, v5
    v_add_f32 v39, v38, v5
    v_add_f32 v6, v32, v7
    v_cos_f32 v40, v32
    v_sin_f32 v48, v32
    v_cos_f32 v41, v33
    buffer_load_dwordx4 v[112:115], v19, s[52:55], s17 offen
    v_sin_f32 v49, v33
    v_cos_f32 v42, v34
    v_sin_f32 v50, v34
    v_cos_f32 v43, v35
    v_sin_f32 v51, v35
    v_cos_f32 v44, v36
    v_sin_f32 v52, v36
    v_cos_f32 v45, v37
    v_sin_f32 v53, v37
    v_cos_f32 v46, v38
    v_sin_f32 v54, v38
    v_cos_f32 v47, v39
    v_sin_f32 v55, v39
    v_cvt_pk_bf16_f32 v56, v40, v41
    v_cvt_pk_bf16_f32 v57, v48, v49
    v_accvgpr_write_b32 a16, v56
    v_xor_b32 v58, 0x80008000, v57
    s_add_u32 s17, s20, 919296
    buffer_load_dwordx4 v[116:119], v19, s[48:51], s17 offen
    v_accvgpr_write_b32 a48, v57
    v_accvgpr_write_b32 a80, v58
    v_cvt_pk_bf16_f32 v56, v42, v43
    v_cvt_pk_bf16_f32 v57, v50, v51
    v_accvgpr_write_b32 a17, v56
    v_xor_b32 v58, 0x80008000, v57
    v_accvgpr_write_b32 a49, v57
    v_accvgpr_write_b32 a81, v58
    v_cvt_pk_bf16_f32 v56, v44, v45
    v_cvt_pk_bf16_f32 v57, v52, v53
    v_accvgpr_write_b32 a18, v56
    v_xor_b32 v58, 0x80008000, v57
    v_accvgpr_write_b32 a50, v57
    v_accvgpr_write_b32 a82, v58
    v_cvt_pk_bf16_f32 v56, v46, v47
    v_cvt_pk_bf16_f32 v57, v54, v55
    v_accvgpr_write_b32 a19, v56
    buffer_load_dwordx4 v[120:123], v19, s[52:55], s17 offen
    v_xor_b32 v58, 0x80008000, v57
    v_accvgpr_write_b32 a51, v57
    v_accvgpr_write_b32 a83, v58
    v_fract_f32 v32, v6
    v_add_f32 v33, v32, v5
    v_add_f32 v34, v33, v5
    v_add_f32 v35, v34, v5
    v_add_f32 v36, v35, v5
    v_add_f32 v37, v36, v5
    v_add_f32 v38, v37, v5
    v_add_f32 v39, v38, v5
    v_add_f32 v6, v32, v7
    v_cos_f32 v40, v32
    v_sin_f32 v48, v32
    v_cos_f32 v41, v33
    v_sin_f32 v49, v33
    v_cos_f32 v42, v34
    s_add_u32 s17, s20, 65664
    buffer_load_dwordx4 v[124:127], v19, s[48:51], s17 offen
    v_sin_f32 v50, v34
    v_cos_f32 v43, v35
    v_sin_f32 v51, v35
    v_cos_f32 v44, v36
    v_sin_f32 v52, v36
    v_cos_f32 v45, v37
    v_sin_f32 v53, v37
    v_cos_f32 v46, v38
    v_sin_f32 v54, v38
    v_cos_f32 v47, v39
    v_sin_f32 v55, v39
    v_cvt_pk_bf16_f32 v56, v40, v41
    v_cvt_pk_bf16_f32 v57, v48, v49
    v_accvgpr_write_b32 a20, v56
    v_xor_b32 v58, 0x80008000, v57
    v_accvgpr_write_b32 a52, v57
    buffer_load_dwordx4 v[128:131], v19, s[52:55], s17 offen
    v_accvgpr_write_b32 a84, v58
    v_cvt_pk_bf16_f32 v56, v42, v43
    v_cvt_pk_bf16_f32 v57, v50, v51
    v_accvgpr_write_b32 a21, v56
    v_xor_b32 v58, 0x80008000, v57
    v_accvgpr_write_b32 a53, v57
    v_accvgpr_write_b32 a85, v58
    v_cvt_pk_bf16_f32 v56, v44, v45
    v_cvt_pk_bf16_f32 v57, v52, v53
    v_accvgpr_write_b32 a22, v56
    v_xor_b32 v58, 0x80008000, v57
    v_accvgpr_write_b32 a54, v57
    v_accvgpr_write_b32 a86, v58
    v_cvt_pk_bf16_f32 v56, v46, v47
    v_cvt_pk_bf16_f32 v57, v54, v55
    v_accvgpr_write_b32 a23, v56
    v_xor_b32 v58, 0x80008000, v57
    s_add_u32 s17, s20, 196992
    buffer_load_dwordx4 v[132:135], v19, s[48:51], s17 offen
    v_accvgpr_write_b32 a55, v57
    v_accvgpr_write_b32 a87, v58
    v_fract_f32 v32, v6
    v_add_f32 v33, v32, v5
    v_add_f32 v34, v33, v5
    v_add_f32 v35, v34, v5
    v_add_f32 v36, v35, v5
    v_add_f32 v37, v36, v5
    v_add_f32 v38, v37, v5
    v_add_f32 v39, v38, v5
    v_add_f32 v6, v32, v7
    v_cos_f32 v40, v32
    v_sin_f32 v48, v32
    v_cos_f32 v41, v33
    v_sin_f32 v49, v33
    v_cos_f32 v42, v34
    v_sin_f32 v50, v34
    buffer_load_dwordx4 v[136:139], v19, s[52:55], s17 offen
    v_cos_f32 v43, v35
    v_sin_f32 v51, v35
    v_cos_f32 v44, v36
    v_sin_f32 v52, v36
    v_cos_f32 v45, v37
    v_sin_f32 v53, v37
    v_cos_f32 v46, v38
    v_sin_f32 v54, v38
    v_cos_f32 v47, v39
    v_sin_f32 v55, v39
    v_cvt_pk_bf16_f32 v56, v40, v41
    v_cvt_pk_bf16_f32 v57, v48, v49
    v_accvgpr_write_b32 a24, v56
    v_xor_b32 v58, 0x80008000, v57
    v_accvgpr_write_b32 a56, v57
    v_accvgpr_write_b32 a88, v58
    s_add_u32 s17, s20, 328320
    buffer_load_dwordx4 v[140:143], v19, s[48:51], s17 offen
    v_cvt_pk_bf16_f32 v56, v42, v43
    v_cvt_pk_bf16_f32 v57, v50, v51
    v_accvgpr_write_b32 a25, v56
    v_xor_b32 v58, 0x80008000, v57
    v_accvgpr_write_b32 a57, v57
    v_accvgpr_write_b32 a89, v58
    v_cvt_pk_bf16_f32 v56, v44, v45
    v_cvt_pk_bf16_f32 v57, v52, v53
    v_accvgpr_write_b32 a26, v56
    v_xor_b32 v58, 0x80008000, v57
    v_accvgpr_write_b32 a58, v57
    v_accvgpr_write_b32 a90, v58
    v_cvt_pk_bf16_f32 v56, v46, v47
    v_cvt_pk_bf16_f32 v57, v54, v55
    v_accvgpr_write_b32 a27, v56
    v_xor_b32 v58, 0x80008000, v57
    v_accvgpr_write_b32 a59, v57
    buffer_load_dwordx4 v[144:147], v19, s[52:55], s17 offen
    v_accvgpr_write_b32 a91, v58
    v_fract_f32 v32, v6
    v_add_f32 v33, v32, v5
    v_add_f32 v34, v33, v5
    v_add_f32 v35, v34, v5
    v_add_f32 v36, v35, v5
    v_add_f32 v37, v36, v5
    v_add_f32 v38, v37, v5
    v_add_f32 v39, v38, v5
    v_add_f32 v6, v32, v7
    v_cos_f32 v40, v32
    v_sin_f32 v48, v32
    v_cos_f32 v41, v33
    v_sin_f32 v49, v33
    v_cos_f32 v42, v34
    v_sin_f32 v50, v34
    v_cos_f32 v43, v35
    s_add_u32 s17, s20, 459648
    buffer_load_dwordx4 v[148:151], v19, s[48:51], s17 offen
    v_sin_f32 v51, v35
    v_cos_f32 v44, v36
    v_sin_f32 v52, v36
    v_cos_f32 v45, v37
    v_sin_f32 v53, v37
    v_cos_f32 v46, v38
    v_sin_f32 v54, v38
    v_cos_f32 v47, v39
    v_sin_f32 v55, v39
    v_cvt_pk_bf16_f32 v56, v40, v41
    v_cvt_pk_bf16_f32 v57, v48, v49
    v_accvgpr_write_b32 a28, v56
    v_xor_b32 v58, 0x80008000, v57
    v_accvgpr_write_b32 a60, v57
    v_accvgpr_write_b32 a92, v58
    v_cvt_pk_bf16_f32 v56, v42, v43
    buffer_load_dwordx4 v[152:155], v19, s[52:55], s17 offen
    v_cvt_pk_bf16_f32 v57, v50, v51
    v_accvgpr_write_b32 a29, v56
    v_xor_b32 v58, 0x80008000, v57
    v_accvgpr_write_b32 a61, v57
    v_accvgpr_write_b32 a93, v58
    v_cvt_pk_bf16_f32 v56, v44, v45
    v_cvt_pk_bf16_f32 v57, v52, v53
    v_accvgpr_write_b32 a30, v56
    v_xor_b32 v58, 0x80008000, v57
    v_accvgpr_write_b32 a62, v57
    v_accvgpr_write_b32 a94, v58
    v_cvt_pk_bf16_f32 v56, v46, v47
    v_cvt_pk_bf16_f32 v57, v54, v55
    v_accvgpr_write_b32 a31, v56
    v_xor_b32 v58, 0x80008000, v57
    v_accvgpr_write_b32 a63, v57
    v_accvgpr_write_b32 a95, v58
    s_add_u32 s17, s20, 590976
    buffer_load_dwordx4 v[156:159], v19, s[48:51], s17 offen
    v_add_f32 v5, 0, v16
    v_mul_f32 v5, 1023410176, v5
    v_mul_f32 v6, v5, v17
    v_mul_f32 v7, 0x41800000, v5
    v_fract_f32 v32, v6
    v_add_f32 v33, v32, v5
    v_add_f32 v34, v33, v5
    v_add_f32 v35, v34, v5
    v_add_f32 v36, v35, v5
    v_add_f32 v37, v36, v5
    v_add_f32 v38, v37, v5
    v_add_f32 v39, v38, v5
    v_add_f32 v6, v32, v7
    v_cos_f32 v40, v32
    v_sin_f32 v48, v32
    v_cos_f32 v41, v33
    v_sin_f32 v49, v33
    buffer_load_dwordx4 v[160:163], v19, s[52:55], s17 offen
    v_cos_f32 v42, v34
    v_sin_f32 v50, v34
    v_cos_f32 v43, v35
    v_sin_f32 v51, v35
    v_cos_f32 v44, v36
    v_sin_f32 v52, v36
    v_cos_f32 v45, v37
    v_sin_f32 v53, v37
    v_cos_f32 v46, v38
    v_sin_f32 v54, v38
    v_cos_f32 v47, v39
    v_sin_f32 v55, v39
    v_mul_f32 v40, 981467136, v40
    v_mul_f32 v41, 981467136, v41
    v_mul_f32 v42, 981467136, v42
    v_mul_f32 v43, 981467136, v43
    s_add_u32 s17, s20, 722304
    buffer_load_dwordx4 v[164:167], v19, s[48:51], s17 offen
    v_mul_f32 v44, 981467136, v44
    v_mul_f32 v45, 981467136, v45
    v_mul_f32 v46, 981467136, v46
    v_mul_f32 v47, 981467136, v47
    v_mul_f32 v48, 981467136, v48
    v_mul_f32 v49, 981467136, v49
    v_mul_f32 v50, 981467136, v50
    v_mul_f32 v51, 981467136, v51
    v_mul_f32 v52, 981467136, v52
    v_mul_f32 v53, 981467136, v53
    v_mul_f32 v54, 981467136, v54
    v_mul_f32 v55, 981467136, v55
    v_cvt_pk_bf16_f32 v56, v40, v41
    v_cvt_pk_bf16_f32 v57, v48, v49
    v_accvgpr_write_b32 a96, v56
    v_xor_b32 v58, 0x80008000, v57
    v_accvgpr_write_b32 a104, v57
    buffer_load_dwordx4 v[168:171], v19, s[52:55], s17 offen
    v_accvgpr_write_b32 a112, v58
    v_cvt_pk_bf16_f32 v56, v42, v43
    v_cvt_pk_bf16_f32 v57, v50, v51
    v_accvgpr_write_b32 a97, v56
    v_xor_b32 v58, 0x80008000, v57
    v_accvgpr_write_b32 a105, v57
    v_accvgpr_write_b32 a113, v58
    v_cvt_pk_bf16_f32 v56, v44, v45
    v_cvt_pk_bf16_f32 v57, v52, v53
    v_accvgpr_write_b32 a98, v56
    v_xor_b32 v58, 0x80008000, v57
    v_accvgpr_write_b32 a106, v57
    v_accvgpr_write_b32 a114, v58
    v_cvt_pk_bf16_f32 v56, v46, v47
    v_cvt_pk_bf16_f32 v57, v54, v55
    v_accvgpr_write_b32 a99, v56
    v_xor_b32 v58, 0x80008000, v57
    s_add_u32 s17, s20, 853632
    buffer_load_dwordx4 v[172:175], v19, s[48:51], s17 offen
    v_accvgpr_write_b32 a107, v57
    v_accvgpr_write_b32 a115, v58
    v_fract_f32 v32, v6
    v_add_f32 v33, v32, v5
    v_add_f32 v34, v33, v5
    v_add_f32 v35, v34, v5
    v_add_f32 v36, v35, v5
    v_add_f32 v37, v36, v5
    v_add_f32 v38, v37, v5
    v_add_f32 v39, v38, v5
    v_add_f32 v6, v32, v7
    v_cos_f32 v40, v32
    v_sin_f32 v48, v32
    v_cos_f32 v41, v33
    v_sin_f32 v49, v33
    v_cos_f32 v42, v34
    buffer_load_dwordx4 v[176:179], v19, s[52:55], s17 offen
    v_sin_f32 v50, v34
    v_cos_f32 v43, v35
    v_sin_f32 v51, v35
    v_cos_f32 v44, v36
    v_sin_f32 v52, v36
    v_cos_f32 v45, v37
    v_sin_f32 v53, v37
    v_cos_f32 v46, v38
    v_sin_f32 v54, v38
    v_cos_f32 v47, v39
    v_sin_f32 v55, v39
    v_mul_f32 v40, 981467136, v40
    v_mul_f32 v41, 981467136, v41
    v_mul_f32 v42, 981467136, v42
    v_mul_f32 v43, 981467136, v43
    v_mul_f32 v44, 981467136, v44
    v_mul_f32 v45, 981467136, v45
    s_add_u32 s17, s20, 984960
    buffer_load_dwordx4 v[180:183], v19, s[48:51], s17 offen
    v_mul_f32 v46, 981467136, v46
    v_mul_f32 v47, 981467136, v47
    v_mul_f32 v48, 981467136, v48
    v_mul_f32 v49, 981467136, v49
    v_mul_f32 v50, 981467136, v50
    v_mul_f32 v51, 981467136, v51
    v_mul_f32 v52, 981467136, v52
    v_mul_f32 v53, 981467136, v53
    v_mul_f32 v54, 981467136, v54
    v_mul_f32 v55, 981467136, v55
    v_cvt_pk_bf16_f32 v56, v40, v41
    v_cvt_pk_bf16_f32 v57, v48, v49
    v_accvgpr_write_b32 a100, v56
    v_xor_b32 v58, 0x80008000, v57
    v_accvgpr_write_b32 a108, v57
    v_accvgpr_write_b32 a116, v58
    v_cvt_pk_bf16_f32 v56, v42, v43
    buffer_load_dwordx4 v[184:187], v19, s[52:55], s17 offen
    v_cvt_pk_bf16_f32 v57, v50, v51
    v_accvgpr_write_b32 a101, v56
    v_xor_b32 v58, 0x80008000, v57
    v_accvgpr_write_b32 a109, v57
    v_accvgpr_write_b32 a117, v58
    v_cvt_pk_bf16_f32 v56, v44, v45
    v_cvt_pk_bf16_f32 v57, v52, v53
    v_accvgpr_write_b32 a102, v56
    v_xor_b32 v58, 0x80008000, v57
    v_accvgpr_write_b32 a110, v57
    v_accvgpr_write_b32 a118, v58
    v_cvt_pk_bf16_f32 v56, v46, v47
    v_cvt_pk_bf16_f32 v57, v54, v55
    v_accvgpr_write_b32 a103, v56
    v_xor_b32 v58, 0x80008000, v57
    v_accvgpr_write_b32 a111, v57
    v_accvgpr_write_b32 a119, v58
    s_lshl_b32 s17, s16, 11
    v_lshlrev_b32 v5, 12, v13
    v_lshl_add_u32 v5, v8, 4, v5
    v_add_u32 v5, s17, v5
    s_cmp_eq_u32 s16, 0
    s_cselect_b32 s17, 0, 10240
    s_add_u32 s17, s17, 0x20000
    v_add_u32 v13, s17, v14
    s_waitcnt vmcnt(24)
    v_perm_b32 v236, v64, v60, s32
    v_perm_b32 v237, v72, v68, s32
    v_perm_b32 v238, v80, v76, s32
    v_perm_b32 v239, v88, v84, s32
    ds_write_b128 v5, v[236:239] offset:0
    v_perm_b32 v240, v64, v60, s33
    v_perm_b32 v241, v72, v68, s33
    v_perm_b32 v242, v80, v76, s33
    v_perm_b32 v243, v88, v84, s33
    ds_write_b128 v5, v[240:243] offset:8192
    v_perm_b32 v244, v65, v61, s32
    v_perm_b32 v245, v73, v69, s32
    v_perm_b32 v246, v81, v77, s32
    v_perm_b32 v247, v89, v85, s32
    ds_write_b128 v5, v[244:247] offset:16384
    v_perm_b32 v248, v65, v61, s33
    v_perm_b32 v249, v73, v69, s33
    v_perm_b32 v250, v81, v77, s33
    v_perm_b32 v251, v89, v85, s33
    ds_write_b128 v5, v[248:251] offset:24576
    v_perm_b32 v236, v66, v62, s32
    v_perm_b32 v237, v74, v70, s32
    v_perm_b32 v238, v82, v78, s32
    v_perm_b32 v239, v90, v86, s32
    ds_write_b128 v5, v[236:239] offset:32768
    v_perm_b32 v240, v66, v62, s33
    v_perm_b32 v241, v74, v70, s33
    v_perm_b32 v242, v82, v78, s33
    v_perm_b32 v243, v90, v86, s33
    ds_write_b128 v5, v[240:243] offset:40960
    v_perm_b32 v244, v67, v63, s32
    v_perm_b32 v245, v75, v71, s32
    v_perm_b32 v246, v83, v79, s32
    v_perm_b32 v247, v91, v87, s32
    ds_write_b128 v5, v[244:247] offset:49152
    v_perm_b32 v248, v67, v63, s33
    v_perm_b32 v249, v75, v71, s33
    v_perm_b32 v250, v83, v79, s33
    v_perm_b32 v251, v91, v87, s33
    ds_write_b128 v5, v[248:251] offset:57344
    s_waitcnt vmcnt(16)
    v_perm_b32 v236, v96, v92, s32
    v_perm_b32 v237, v104, v100, s32
    v_perm_b32 v238, v112, v108, s32
    v_perm_b32 v239, v120, v116, s32
    ds_write_b128 v5, v[236:239] offset:512
    v_perm_b32 v240, v96, v92, s33
    v_perm_b32 v241, v104, v100, s33
    v_perm_b32 v242, v112, v108, s33
    v_perm_b32 v243, v120, v116, s33
    ds_write_b128 v5, v[240:243] offset:8704
    v_perm_b32 v244, v97, v93, s32
    v_perm_b32 v245, v105, v101, s32
    v_perm_b32 v246, v113, v109, s32
    v_perm_b32 v247, v121, v117, s32
    ds_write_b128 v5, v[244:247] offset:16896
    v_perm_b32 v248, v97, v93, s33
    v_perm_b32 v249, v105, v101, s33
    v_perm_b32 v250, v113, v109, s33
    v_perm_b32 v251, v121, v117, s33
    ds_write_b128 v5, v[248:251] offset:25088
    v_perm_b32 v236, v98, v94, s32
    v_perm_b32 v237, v106, v102, s32
    v_perm_b32 v238, v114, v110, s32
    v_perm_b32 v239, v122, v118, s32
    ds_write_b128 v5, v[236:239] offset:33280
    v_perm_b32 v240, v98, v94, s33
    v_perm_b32 v241, v106, v102, s33
    v_perm_b32 v242, v114, v110, s33
    v_perm_b32 v243, v122, v118, s33
    ds_write_b128 v5, v[240:243] offset:41472
    v_perm_b32 v244, v99, v95, s32
    v_perm_b32 v245, v107, v103, s32
    v_perm_b32 v246, v115, v111, s32
    v_perm_b32 v247, v123, v119, s32
    ds_write_b128 v5, v[244:247] offset:49664
    v_perm_b32 v248, v99, v95, s33
    v_perm_b32 v249, v107, v103, s33
    v_perm_b32 v250, v115, v111, s33
    v_perm_b32 v251, v123, v119, s33
    ds_write_b128 v5, v[248:251] offset:57856
    s_waitcnt vmcnt(8)
    v_perm_b32 v236, v128, v124, s32
    v_perm_b32 v237, v136, v132, s32
    v_perm_b32 v238, v144, v140, s32
    v_perm_b32 v239, v152, v148, s32
    ds_write_b128 v5, v[236:239] offset:1024
    v_perm_b32 v240, v128, v124, s33
    v_perm_b32 v241, v136, v132, s33
    v_perm_b32 v242, v144, v140, s33
    v_perm_b32 v243, v152, v148, s33
    ds_write_b128 v5, v[240:243] offset:9216
    v_perm_b32 v244, v129, v125, s32
    v_perm_b32 v245, v137, v133, s32
    v_perm_b32 v246, v145, v141, s32
    v_perm_b32 v247, v153, v149, s32
    ds_write_b128 v5, v[244:247] offset:17408
    v_perm_b32 v248, v129, v125, s33
    v_perm_b32 v249, v137, v133, s33
    v_perm_b32 v250, v145, v141, s33
    v_perm_b32 v251, v153, v149, s33
    ds_write_b128 v5, v[248:251] offset:25600
    v_perm_b32 v236, v130, v126, s32
    v_perm_b32 v237, v138, v134, s32
    v_perm_b32 v238, v146, v142, s32
    v_perm_b32 v239, v154, v150, s32
    ds_write_b128 v5, v[236:239] offset:33792
    v_perm_b32 v240, v130, v126, s33
    v_perm_b32 v241, v138, v134, s33
    v_perm_b32 v242, v146, v142, s33
    v_perm_b32 v243, v154, v150, s33
    ds_write_b128 v5, v[240:243] offset:41984
    v_perm_b32 v244, v131, v127, s32
    v_perm_b32 v245, v139, v135, s32
    v_perm_b32 v246, v147, v143, s32
    v_perm_b32 v247, v155, v151, s32
    ds_write_b128 v5, v[244:247] offset:50176
    v_perm_b32 v248, v131, v127, s33
    v_perm_b32 v249, v139, v135, s33
    v_perm_b32 v250, v147, v143, s33
    v_perm_b32 v251, v155, v151, s33
    ds_write_b128 v5, v[248:251] offset:58368
    s_waitcnt vmcnt(0)
    v_perm_b32 v236, v160, v156, s32
    v_perm_b32 v237, v168, v164, s32
    v_perm_b32 v238, v176, v172, s32
    v_perm_b32 v239, v184, v180, s32
    ds_write_b128 v5, v[236:239] offset:1536
    v_perm_b32 v240, v160, v156, s33
    v_perm_b32 v241, v168, v164, s33
    v_perm_b32 v242, v176, v172, s33
    v_perm_b32 v243, v184, v180, s33
    ds_write_b128 v5, v[240:243] offset:9728
    v_perm_b32 v244, v161, v157, s32
    v_perm_b32 v245, v169, v165, s32
    v_perm_b32 v246, v177, v173, s32
    v_perm_b32 v247, v185, v181, s32
    ds_write_b128 v5, v[244:247] offset:17920
    v_perm_b32 v248, v161, v157, s33
    v_perm_b32 v249, v169, v165, s33
    v_perm_b32 v250, v177, v173, s33
    v_perm_b32 v251, v185, v181, s33
    ds_write_b128 v5, v[248:251] offset:26112
    v_perm_b32 v236, v162, v158, s32
    v_perm_b32 v237, v170, v166, s32
    v_perm_b32 v238, v178, v174, s32
    v_perm_b32 v239, v186, v182, s32
    ds_write_b128 v5, v[236:239] offset:34304
    v_perm_b32 v240, v162, v158, s33
    v_perm_b32 v241, v170, v166, s33
    v_perm_b32 v242, v178, v174, s33
    v_perm_b32 v243, v186, v182, s33
    ds_write_b128 v5, v[240:243] offset:42496
    v_perm_b32 v244, v163, v159, s32
    v_perm_b32 v245, v171, v167, s32
    v_perm_b32 v246, v179, v175, s32
    v_perm_b32 v247, v187, v183, s32
    ds_write_b128 v5, v[244:247] offset:50688
    v_perm_b32 v248, v163, v159, s33
    v_perm_b32 v249, v171, v167, s33
    v_perm_b32 v250, v179, v175, s33
    v_perm_b32 v251, v187, v183, s33
    ds_write_b128 v5, v[248:251] offset:58880
    v_mul_u32_u24 v15, 2176, v10
    v_lshl_add_u32 v15, v11, 4, v15
    v_lshlrev_b32 v18, 12, v11
    v_lshl_add_u32 v18, v10, 4, v18
    s_mul_i32 s32, s93, 139776
    s_lshl_b32 s17, s16, 9
    s_add_u32 s32, s32, s17
    s_add_u32 s32, s32, 104857600
    s_add_u32 s33, s32, 64
    s_lshl_b32 s31, s93, 2
    s_add_u32 s31, s31, s16
    s_lshl_b32 s35, s16, 15
    s_mov_b32 s38, 0xffff0000
    s_mov_b32 s36, 0
    s_cmp_eq_u32 s31, 0
    s_cselect_b32 s37, 5, 4
    s_cselect_b32 s33, 1073741824, s33
    s_cselect_b32 s34, 1024, 1073741824
    v_and_b32 v8, 3, v1
    v_lshlrev_b32 v8, 7, v8
    s_lshl_b32 s17, s93, 9
    s_add_u32 s17, s17, 100745216
    v_add_u32 v8, s17, v8
    s_waitcnt lgkmcnt(0)
    s_mov_b32 s30, s92
F2_w:
    buffer_load_dword v5, v8, s[4:7], 0 offen sc1
    s_waitcnt vmcnt(0)
    v_cmp_gt_u32 vcc, 1, v5
    s_nop 0
    s_and_b32 s17, vcc_lo, 15
    s_cbranch_scc0 F2_w_ok
    s_cmp_ge_u32 s30, 1048576
    s_cselect_b32 s92, 1048576, s92
    s_cbranch_scc1 F2_w_ok
    s_add_u32 s30, s30, 1
    s_sleep 8
    s_branch F2_w
F2_w_ok:
    buffer_load_dwordx4 v[128:131], v15, s[4:7], s32 offen offset:0
    buffer_load_dwordx4 v[132:135], v15, s[4:7], s32 offen offset:32
    s_add_u32 s17, s32, 69632
    buffer_load_dwordx4 v[136:139], v15, s[4:7], s17 offen offset:0
    buffer_load_dwordx4 v[140:143], v15, s[4:7], s17 offen offset:32
    buffer_load_dwordx4 v[144:147], v15, s[4:7], s33 offen offset:0
    buffer_load_dwordx4 v[148:151], v15, s[4:7], s33 offen offset:32
    s_add_u32 s17, s33, 69632
    buffer_load_dwordx4 v[152:155], v15, s[4:7], s17 offen offset:0
    buffer_load_dwordx4 v[156:159], v15, s[4:7], s17 offen offset:32
    v_add_f32 v5, 0, v16
    v_mul_f32 v5, 973078528, v5
    v_add_f32 v6, 0, v17
    v_mul_f32 v6, v6, v5
    v_cos_f32 v160, v6
    v_sin_f32 v176, v6
    v_add_f32 v6, 1065353216, v17
    v_mul_f32 v6, v6, v5
    v_cos_f32 v161, v6
    v_sin_f32 v177, v6
    v_add_f32 v6, 1073741824, v17
    v_mul_f32 v6, v6, v5
    v_cos_f32 v162, v6
    v_sin_f32 v178, v6
    v_add_f32 v6, 1077936128, v17
    v_mul_f32 v6, v6, v5
    v_cos_f32 v163, v6
    v_sin_f32 v179, v6
    v_add_f32 v6, 1082130432, v17
    v_mul_f32 v6, v6, v5
    v_cos_f32 v164, v6
    v_sin_f32 v180, v6
    v_add_f32 v6, 1084227584, v17
    v_mul_f32 v6, v6, v5
    v_cos_f32 v165, v6
    v_sin_f32 v181, v6
    v_add_f32 v6, 1086324736, v17
    v_mul_f32 v6, v6, v5
    v_cos_f32 v166, v6
    v_sin_f32 v182, v6
    v_add_f32 v6, 1088421888, v17
    v_mul_f32 v6, v6, v5
    v_cos_f32 v167, v6
    v_sin_f32 v183, v6
    v_add_f32 v6, 1098907648, v17
    v_mul_f32 v6, v6, v5
    v_cos_f32 v168, v6
    v_sin_f32 v184, v6
    v_add_f32 v6, 1099431936, v17
    v_mul_f32 v6, v6, v5
    v_cos_f32 v169, v6
    v_sin_f32 v185, v6
    v_add_f32 v6, 1099956224, v17
    v_mul_f32 v6, v6, v5
    v_cos_f32 v170, v6
    v_sin_f32 v186, v6
    v_add_f32 v6, 1100480512, v17
    v_mul_f32 v6, v6, v5
    v_cos_f32 v171, v6
    v_sin_f32 v187, v6
    v_add_f32 v6, 1101004800, v17
    v_mul_f32 v6, v6, v5
    v_cos_f32 v172, v6
    v_sin_f32 v188, v6
    v_add_f32 v6, 1101529088, v17
    v_mul_f32 v6, v6, v5
    v_cos_f32 v173, v6
    v_sin_f32 v189, v6
    v_add_f32 v6, 1102053376, v17
    v_mul_f32 v6, v6, v5
    v_cos_f32 v174, v6
    v_sin_f32 v190, v6
    v_add_f32 v6, 1102577664, v17
    v_mul_f32 v6, v6, v5
    v_cos_f32 v175, v6
    v_sin_f32 v191, v6
    v_add_f32 v5, 1107296256, v16
    v_mul_f32 v5, 973078528, v5
    v_add_f32 v6, 0, v17
    v_mul_f32 v6, v6, v5
    v_cos_f32 v192, v6
    v_sin_f32 v208, v6
    v_add_f32 v6, 1065353216, v17
    v_mul_f32 v6, v6, v5
    v_cos_f32 v193, v6
    v_sin_f32 v209, v6
    v_add_f32 v6, 1073741824, v17
    v_mul_f32 v6, v6, v5
    v_cos_f32 v194, v6
    v_sin_f32 v210, v6
    v_add_f32 v6, 1077936128, v17
    v_mul_f32 v6, v6, v5
    v_cos_f32 v195, v6
    v_sin_f32 v211, v6
    v_add_f32 v6, 1082130432, v17
    v_mul_f32 v6, v6, v5
    v_cos_f32 v196, v6
    v_sin_f32 v212, v6
    v_add_f32 v6, 1084227584, v17
    v_mul_f32 v6, v6, v5
    v_cos_f32 v197, v6
    v_sin_f32 v213, v6
    v_add_f32 v6, 1086324736, v17
    v_mul_f32 v6, v6, v5
    v_cos_f32 v198, v6
    v_sin_f32 v214, v6
    v_add_f32 v6, 1088421888, v17
    v_mul_f32 v6, v6, v5
    v_cos_f32 v199, v6
    v_sin_f32 v215, v6
    v_add_f32 v6, 1098907648, v17
    v_mul_f32 v6, v6, v5
    v_cos_f32 v200, v6
    v_sin_f32 v216, v6
    v_add_f32 v6, 1099431936, v17
    v_mul_f32 v6, v6, v5
    v_cos_f32 v201, v6
    v_sin_f32 v217, v6
    v_add_f32 v6, 1099956224, v17
    v_mul_f32 v6, v6, v5
    v_cos_f32 v202, v6
    v_sin_f32 v218, v6
    v_add_f32 v6, 1100480512, v17
    v_mul_f32 v6, v6, v5
    v_cos_f32 v203, v6
    v_sin_f32 v219, v6
    v_add_f32 v6, 1101004800, v17
    v_mul_f32 v6, v6, v5
    v_cos_f32 v204, v6
    v_sin_f32 v220, v6
    v_add_f32 v6, 1101529088, v17
    v_mul_f32 v6, v6, v5
    v_cos_f32 v205, v6
    v_sin_f32 v221, v6
    v_add_f32 v6, 1102053376, v17
    v_mul_f32 v6, v6, v5
    v_cos_f32 v206, v6
    v_sin_f32 v222, v6
    v_add_f32 v6, 1102577664, v17
    v_mul_f32 v6, v6, v5
    v_cos_f32 v207, v6
    v_sin_f32 v223, v6
    v_add_f32 v5, 0, v16
    v_mul_f32 v5, 973078528, v5
    v_add_f32 v6, 1107296256, v17
    v_mul_f32 v6, v6, v5
    v_cos_f32 v224, v6
    v_sin_f32 v240, v6
    v_add_f32 v6, 1107558400, v17
    v_mul_f32 v6, v6, v5
    v_cos_f32 v225, v6
    v_sin_f32 v241, v6
    v_add_f32 v6, 1107820544, v17
    v_mul_f32 v6, v6, v5
    v_cos_f32 v226, v6
    v_sin_f32 v242, v6
    v_add_f32 v6, 1108082688, v17
    v_mul_f32 v6, v6, v5
    v_cos_f32 v227, v6
    v_sin_f32 v243, v6
    v_add_f32 v6, 1108344832, v17
    v_mul_f32 v6, v6, v5
    v_cos_f32 v228, v6
    v_sin_f32 v244, v6
    v_add_f32 v6, 1108606976, v17
    v_mul_f32 v6, v6, v5
    v_cos_f32 v229, v6
    v_sin_f32 v245, v6
    v_add_f32 v6, 1108869120, v17
    v_mul_f32 v6, v6, v5
    v_cos_f32 v230, v6
    v_sin_f32 v246, v6
    v_add_f32 v6, 1109131264, v17
    v_mul_f32 v6, v6, v5
    v_cos_f32 v231, v6
    v_sin_f32 v247, v6
    v_add_f32 v6, 1111490560, v17
    v_mul_f32 v6, v6, v5
    v_cos_f32 v232, v6
    v_sin_f32 v248, v6
    v_add_f32 v6, 1111752704, v17
    v_mul_f32 v6, v6, v5
    v_cos_f32 v233, v6
    v_sin_f32 v249, v6
    v_add_f32 v6, 1112014848, v17
    v_mul_f32 v6, v6, v5
    v_cos_f32 v234, v6
    v_sin_f32 v250, v6
    v_add_f32 v6, 1112276992, v17
    v_mul_f32 v6, v6, v5
    v_cos_f32 v235, v6
    v_sin_f32 v251, v6
    v_add_f32 v6, 1112539136, v17
    v_mul_f32 v6, v6, v5
    v_cos_f32 v236, v6
    v_sin_f32 v252, v6
    v_add_f32 v6, 1112801280, v17
    v_mul_f32 v6, v6, v5
    v_cos_f32 v237, v6
    v_sin_f32 v253, v6
    v_add_f32 v6, 1113063424, v17
    v_mul_f32 v6, v6, v5
    v_cos_f32 v238, v6
    v_sin_f32 v254, v6
    v_add_f32 v6, 1113325568, v17
    v_mul_f32 v6, v6, v5
    v_cos_f32 v239, v6
    v_sin_f32 v255, v6
    s_barrier
.p2align 6
F2_top:
    s_waitcnt vmcnt(0)
    v_mfma_f32_32x32x16_bf16 v[32:47], v[128:131], a[0:3], 0
    v_mfma_f32_32x32x16_bf16 v[48:63], v[144:147], a[0:3], 0
    v_mfma_f32_32x32x16_bf16 v[32:47], v[144:147], a[32:35], v[32:47]
    ds_write_b128 v13, a[248:251]
    v_mfma_f32_32x32x16_bf16 v[48:63], v[128:131], a[64:67], v[48:63]
    ds_write_b128 v13, a[252:255] offset:1024
    ds_write_b16 v13, v2 offset:2
    v_mfma_f32_32x32x16_bf16 v[32:47], v[132:135], a[4:7], v[32:47]
    ds_write_b16 v13, v3 offset:1026
    v_mfma_f32_32x32x16_bf16 v[48:63], v[148:151], a[4:7], v[48:63]
    ds_write_b16 v13, v4 offset:6
    ds_write_b16 v13, v7 offset:1030
    v_mfma_f32_32x32x16_bf16 v[32:47], v[148:151], a[36:39], v[32:47]
    ds_write_b16 v13, v8 offset:10
    v_mfma_f32_32x32x16_bf16 v[48:63], v[132:135], a[68:71], v[48:63]
    ds_write_b16 v13, v10 offset:1034
    ds_write_b16 v13, v11 offset:14
    v_mfma_f32_32x32x16_bf16 v[32:47], v[136:139], a[8:11], v[32:47]
    ds_write_b16 v13, v16 offset:1038
    v_mfma_f32_32x32x16_bf16 v[48:63], v[152:155], a[8:11], v[48:63]
    v_add_u32 v13, 2048, v13
    s_add_u32 s36, s36, 1
    v_mfma_f32_32x32x16_bf16 v[32:47], v[152:155], a[40:43], v[32:47]
    s_add_u32 s32, s32, 128
    v_mfma_f32_32x32x16_bf16 v[48:63], v[136:139], a[72:75], v[48:63]
    s_add_u32 s33, s32, 64
    s_cmp_eq_u32 s36, 4
    v_mfma_f32_32x32x16_bf16 v[32:47], v[140:143], a[12:15], v[32:47]
    s_cselect_b32 s32, 104857664, s32
    v_mfma_f32_32x32x16_bf16 v[48:63], v[156:159], a[12:15], v[48:63]
    s_cselect_b32 s33, 1073741824, s33
    s_cmp_lt_u32 s36, s37
    v_mfma_f32_32x32x16_bf16 v[32:47], v[156:159], a[44:47], v[32:47]
    s_cselect_b32 s32, s32, 1073741824
    v_mfma_f32_32x32x16_bf16 v[48:63], v[140:143], a[76:79], v[48:63]
    s_cselect_b32 s33, s33, 1073741824
    v_add_u32 v19, s35, v14
    v_mfma_f32_32x32x16_bf16 v[64:79], v[128:131], a[16:19], 0
    v_mfma_f32_32x32x16_bf16 v[80:95], v[144:147], a[16:19], 0
    s_add_u32 s18, s34, 0
    buffer_load_ushort a248, v12, s[48:51], s18 offen
    buffer_load_ushort v2, v12, s[52:55], s18 offen
    v_mfma_f32_32x32x16_bf16 v[64:79], v[144:147], a[48:51], v[64:79]
    v_mul_f32 v20, v32, v160
    s_nop 0
    v_mul_f32 v22, v48, v160
    v_mul_f32 v21, v33, v161
    v_mul_f32 v23, v49, v161
    v_fma_f32 v20, v48, v176, v20
    v_mfma_f32_32x32x16_bf16 v[80:95], v[128:131], a[80:83], v[80:95]
    v_fma_f32 v22, -v32, v176, v22
    v_fma_f32 v21, v49, v177, v21
    v_fma_f32 v23, -v33, v177, v23
    v_cvt_pk_bf16_f32 v96, v20, v21
    v_cvt_pk_bf16_f32 v112, v22, v23
    v_mul_f32 v24, v34, v162
    v_mfma_f32_32x32x16_bf16 v[64:79], v[132:135], a[20:23], v[64:79]
    v_mul_f32 v26, v50, v162
    v_mul_f32 v25, v35, v163
    v_mul_f32 v27, v51, v163
    v_fma_f32 v24, v50, v178, v24
    v_fma_f32 v26, -v34, v178, v26
    v_fma_f32 v25, v51, v179, v25
    v_mfma_f32_32x32x16_bf16 v[80:95], v[148:151], a[20:23], v[80:95]
    v_fma_f32 v27, -v35, v179, v27
    v_cvt_pk_bf16_f32 v97, v24, v25
    v_cvt_pk_bf16_f32 v113, v26, v27
    v_mul_f32 v20, v36, v164
    v_mul_f32 v22, v52, v164
    v_mfma_f32_32x32x16_bf16 v[64:79], v[148:151], a[52:55], v[64:79]
    v_mul_f32 v21, v37, v165
    v_mul_f32 v23, v53, v165
    v_fma_f32 v20, v52, v180, v20
    v_fma_f32 v22, -v36, v180, v22
    v_fma_f32 v21, v53, v181, v21
    v_fma_f32 v23, -v37, v181, v23
    v_mfma_f32_32x32x16_bf16 v[80:95], v[132:135], a[84:87], v[80:95]
    v_cvt_pk_bf16_f32 v98, v20, v21
    v_cvt_pk_bf16_f32 v114, v22, v23
    v_mul_f32 v24, v38, v166
    v_mul_f32 v26, v54, v166
    v_mul_f32 v25, v39, v167
    v_mul_f32 v27, v55, v167
    v_mfma_f32_32x32x16_bf16 v[64:79], v[136:139], a[24:27], v[64:79]
    v_fma_f32 v24, v54, v182, v24
    v_fma_f32 v26, -v38, v182, v26
    v_fma_f32 v25, v55, v183, v25
    v_fma_f32 v27, -v39, v183, v27
    v_cvt_pk_bf16_f32 v99, v24, v25
    v_cvt_pk_bf16_f32 v115, v26, v27
    v_mfma_f32_32x32x16_bf16 v[80:95], v[152:155], a[24:27], v[80:95]
    v_mul_f32 v20, v40, v168
    v_mul_f32 v22, v56, v168
    v_mul_f32 v21, v41, v169
    v_mul_f32 v23, v57, v169
    v_fma_f32 v20, v56, v184, v20
    v_mfma_f32_32x32x16_bf16 v[64:79], v[152:155], a[56:59], v[64:79]
    v_fma_f32 v22, -v40, v184, v22
    v_fma_f32 v21, v57, v185, v21
    v_fma_f32 v23, -v41, v185, v23
    v_cvt_pk_bf16_f32 v100, v20, v21
    v_cvt_pk_bf16_f32 v116, v22, v23
    v_mul_f32 v24, v42, v170
    v_mfma_f32_32x32x16_bf16 v[80:95], v[136:139], a[88:91], v[80:95]
    v_mul_f32 v26, v58, v170
    v_mul_f32 v25, v43, v171
    v_mul_f32 v27, v59, v171
    v_fma_f32 v24, v58, v186, v24
    v_fma_f32 v26, -v42, v186, v26
    v_fma_f32 v25, v59, v187, v25
    v_mfma_f32_32x32x16_bf16 v[64:79], v[140:143], a[28:31], v[64:79]
    v_fma_f32 v27, -v43, v187, v27
    v_cvt_pk_bf16_f32 v101, v24, v25
    v_cvt_pk_bf16_f32 v117, v26, v27
    v_mul_f32 v20, v44, v172
    v_mul_f32 v22, v60, v172
    v_mfma_f32_32x32x16_bf16 v[80:95], v[156:159], a[28:31], v[80:95]
    v_mul_f32 v21, v45, v173
    v_mul_f32 v23, v61, v173
    v_fma_f32 v20, v60, v188, v20
    v_fma_f32 v22, -v44, v188, v22
    v_fma_f32 v21, v61, v189, v21
    v_fma_f32 v23, -v45, v189, v23
    v_mfma_f32_32x32x16_bf16 v[64:79], v[156:159], a[60:63], v[64:79]
    v_cvt_pk_bf16_f32 v102, v20, v21
    v_cvt_pk_bf16_f32 v118, v22, v23
    v_mul_f32 v24, v46, v174
    v_mul_f32 v26, v62, v174
    v_mul_f32 v25, v47, v175
    v_mul_f32 v27, v63, v175
    v_mfma_f32_32x32x16_bf16 v[80:95], v[140:143], a[92:95], v[80:95]
    v_fma_f32 v24, v62, v190, v24
    v_fma_f32 v26, -v46, v190, v26
    v_fma_f32 v25, v63, v191, v25
    v_fma_f32 v27, -v47, v191, v27
    v_cvt_pk_bf16_f32 v103, v24, v25
    v_cvt_pk_bf16_f32 v119, v26, v27
    v_mfma_f32_32x32x16_bf16 v[32:47], a[96:99], v[96:99], 0
    buffer_load_dwordx4 v[128:131], v15, s[4:7], s32 offen offset:0
    v_mfma_f32_32x32x16_bf16 v[48:63], a[96:99], v[112:115], 0
    buffer_load_dwordx4 v[132:135], v15, s[4:7], s32 offen offset:32
    v_mfma_f32_32x32x16_bf16 v[32:47], a[104:107], v[112:115], v[32:47]
    s_add_u32 s17, s32, 69632
    buffer_load_dwordx4 v[136:139], v15, s[4:7], s17 offen offset:0
    v_mul_f32 v20, v64, v192
    v_mul_f32 v22, v80, v192
    v_mul_f32 v21, v65, v193
    v_mul_f32 v23, v81, v193
    v_fma_f32 v20, v80, v208, v20
    v_fma_f32 v22, -v64, v208, v22
    v_fma_f32 v21, v81, v209, v21
    v_fma_f32 v23, -v65, v209, v23
    v_cvt_pk_bf16_f32 v104, v20, v21
    v_cvt_pk_bf16_f32 v120, v22, v23
    v_mul_f32 v24, v66, v194
    v_mul_f32 v26, v82, v194
    v_mul_f32 v25, v67, v195
    v_mfma_f32_32x32x16_bf16 v[48:63], a[112:115], v[96:99], v[48:63]
    buffer_load_dwordx4 v[140:143], v15, s[4:7], s17 offen offset:32
    v_mul_f32 v27, v83, v195
    v_fma_f32 v24, v82, v210, v24
    v_fma_f32 v26, -v66, v210, v26
    v_fma_f32 v25, v83, v211, v25
    v_fma_f32 v27, -v67, v211, v27
    v_cvt_pk_bf16_f32 v105, v24, v25
    v_cvt_pk_bf16_f32 v121, v26, v27
    v_mul_f32 v20, v68, v196
    v_mul_f32 v22, v84, v196
    v_mul_f32 v21, v69, v197
    v_mul_f32 v23, v85, v197
    v_fma_f32 v20, v84, v212, v20
    v_fma_f32 v22, -v68, v212, v22
    v_mfma_f32_32x32x16_bf16 v[32:47], a[100:103], v[100:103], v[32:47]
    buffer_load_dwordx4 v[144:147], v15, s[4:7], s33 offen offset:0
    v_fma_f32 v21, v85, v213, v21
    v_fma_f32 v23, -v69, v213, v23
    v_cvt_pk_bf16_f32 v106, v20, v21
    v_cvt_pk_bf16_f32 v122, v22, v23
    v_mul_f32 v24, v70, v198
    v_mul_f32 v26, v86, v198
    v_mul_f32 v25, v71, v199
    v_mul_f32 v27, v87, v199
    v_fma_f32 v24, v86, v214, v24
    v_fma_f32 v26, -v70, v214, v26
    v_fma_f32 v25, v87, v215, v25
    v_fma_f32 v27, -v71, v215, v27
    v_cvt_pk_bf16_f32 v107, v24, v25
    v_cvt_pk_bf16_f32 v123, v26, v27
    v_mfma_f32_32x32x16_bf16 v[48:63], a[100:103], v[116:119], v[48:63]
    buffer_load_dwordx4 v[148:151], v15, s[4:7], s33 offen offset:32
    v_mul_f32 v20, v72, v200
    v_mul_f32 v22, v88, v200
    v_mul_f32 v21, v73, v201
    v_mul_f32 v23, v89, v201
    v_fma_f32 v20, v88, v216, v20
    v_fma_f32 v22, -v72, v216, v22
    v_fma_f32 v21, v89, v217, v21
    v_fma_f32 v23, -v73, v217, v23
    v_cvt_pk_bf16_f32 v108, v20, v21
    v_cvt_pk_bf16_f32 v124, v22, v23
    v_mul_f32 v24, v74, v202
    v_mul_f32 v26, v90, v202
    v_mul_f32 v25, v75, v203
    v_mfma_f32_32x32x16_bf16 v[32:47], a[108:111], v[116:119], v[32:47]
    s_add_u32 s17, s33, 69632
    buffer_load_dwordx4 v[152:155], v15, s[4:7], s17 offen offset:0
    v_mul_f32 v27, v91, v203
    v_fma_f32 v24, v90, v218, v24
    v_fma_f32 v26, -v74, v218, v26
    v_fma_f32 v25, v91, v219, v25
    v_fma_f32 v27, -v75, v219, v27
    v_cvt_pk_bf16_f32 v109, v24, v25
    v_cvt_pk_bf16_f32 v125, v26, v27
    v_mul_f32 v20, v76, v204
    v_mul_f32 v22, v92, v204
    v_mul_f32 v21, v77, v205
    v_mul_f32 v23, v93, v205
    v_fma_f32 v20, v92, v220, v20
    v_fma_f32 v22, -v76, v220, v22
    v_mfma_f32_32x32x16_bf16 v[48:63], a[116:119], v[100:103], v[48:63]
    buffer_load_dwordx4 v[156:159], v15, s[4:7], s17 offen offset:32
    s_nop 1
    ds_read_b128 v[96:99], v19 offset:0
    ds_read_b128 v[112:115], v19 offset:1024
    ds_read_b128 v[100:103], v19 offset:2048
    ds_read_b128 v[116:119], v19 offset:3072
    v_fma_f32 v21, v93, v221, v21
    v_fma_f32 v23, -v77, v221, v23
    v_cvt_pk_bf16_f32 v110, v20, v21
    v_cvt_pk_bf16_f32 v126, v22, v23
    v_mul_f32 v24, v78, v206
    v_mul_f32 v26, v94, v206
    v_mul_f32 v25, v79, v207
    v_mul_f32 v27, v95, v207
    v_fma_f32 v24, v94, v222, v24
    v_fma_f32 v26, -v78, v222, v26
    v_fma_f32 v25, v95, v223, v25
    v_fma_f32 v27, -v79, v223, v27
    v_cvt_pk_bf16_f32 v111, v24, v25
    v_cvt_pk_bf16_f32 v127, v26, v27
    v_mfma_f32_32x32x16_bf16 v[64:79], a[96:99], v[104:107], 0
    v_mfma_f32_32x32x16_bf16 v[80:95], a[96:99], v[120:123], 0
    s_add_u32 s18, s34, 65664
    buffer_load_ushort a252, v12, s[48:51], s18 offen
    buffer_load_ushort v3, v12, s[52:55], s18 offen
    v_mfma_f32_32x32x16_bf16 v[64:79], a[104:107], v[120:123], v[64:79]
    s_waitcnt lgkmcnt(0)
    v_lshlrev_b32 v28, 16, v96
    v_and_b32 v30, s38, v96
    v_lshlrev_b32 v29, 16, v112
    v_and_b32 v31, s38, v112
    v_mul_f32 v20, v32, v28
    v_mul_f32 v22, v48, v28
    v_mul_f32 v21, v33, v29
    v_mul_f32 v23, v49, v29
    v_fma_f32 v20, -v48, v30, v20
    v_fma_f32 v22, v32, v30, v22
    v_fma_f32 v21, -v49, v31, v21
    v_fma_f32 v23, v33, v31, v23
    v_cvt_pk_bf16_f32 v96, v20, v21
    v_cvt_pk_bf16_f32 v112, v22, v23
    v_lshlrev_b32 v28, 16, v97
    v_and_b32 v30, s38, v97
    v_lshlrev_b32 v29, 16, v113
    v_mfma_f32_32x32x16_bf16 v[80:95], a[112:115], v[104:107], v[80:95]
    v_and_b32 v31, s38, v113
    v_mul_f32 v24, v34, v28
    v_mul_f32 v26, v50, v28
    v_mul_f32 v25, v35, v29
    v_mul_f32 v27, v51, v29
    v_fma_f32 v24, -v50, v30, v24
    v_fma_f32 v26, v34, v30, v26
    v_fma_f32 v25, -v51, v31, v25
    v_fma_f32 v27, v35, v31, v27
    v_cvt_pk_bf16_f32 v97, v24, v25
    v_cvt_pk_bf16_f32 v113, v26, v27
    v_lshlrev_b32 v28, 16, v98
    v_and_b32 v30, s38, v98
    v_lshlrev_b32 v29, 16, v114
    v_and_b32 v31, s38, v114
    v_mul_f32 v20, v36, v28
    v_mul_f32 v22, v52, v28
    v_mul_f32 v21, v37, v29
    v_mul_f32 v23, v53, v29
    v_mfma_f32_32x32x16_bf16 v[64:79], a[100:103], v[108:111], v[64:79]
    v_fma_f32 v20, -v52, v30, v20
    v_fma_f32 v22, v36, v30, v22
    v_fma_f32 v21, -v53, v31, v21
    v_fma_f32 v23, v37, v31, v23
    v_cvt_pk_bf16_f32 v98, v20, v21
    v_cvt_pk_bf16_f32 v114, v22, v23
    v_lshlrev_b32 v28, 16, v99
    v_and_b32 v30, s38, v99
    v_lshlrev_b32 v29, 16, v115
    v_and_b32 v31, s38, v115
    v_mul_f32 v24, v38, v28
    v_mul_f32 v26, v54, v28
    v_mul_f32 v25, v39, v29
    v_mul_f32 v27, v55, v29
    v_fma_f32 v24, -v54, v30, v24
    v_fma_f32 v26, v38, v30, v26
    v_fma_f32 v25, -v55, v31, v25
    v_fma_f32 v27, v39, v31, v27
    v_cvt_pk_bf16_f32 v99, v24, v25
    v_mfma_f32_32x32x16_bf16 v[80:95], a[100:103], v[124:127], v[80:95]
    v_cvt_pk_bf16_f32 v115, v26, v27
    v_lshlrev_b32 v28, 16, v100
    v_and_b32 v30, s38, v100
    v_lshlrev_b32 v29, 16, v116
    v_and_b32 v31, s38, v116
    v_mul_f32 v20, v40, v28
    v_mul_f32 v22, v56, v28
    v_mul_f32 v21, v41, v29
    v_mul_f32 v23, v57, v29
    v_fma_f32 v20, -v56, v30, v20
    v_fma_f32 v22, v40, v30, v22
    v_fma_f32 v21, -v57, v31, v21
    v_fma_f32 v23, v41, v31, v23
    v_cvt_pk_bf16_f32 v100, v20, v21
    v_cvt_pk_bf16_f32 v116, v22, v23
    v_lshlrev_b32 v28, 16, v101
    v_and_b32 v30, s38, v101
    v_lshlrev_b32 v29, 16, v117
    v_and_b32 v31, s38, v117
    v_mfma_f32_32x32x16_bf16 v[64:79], a[108:111], v[124:127], v[64:79]
    v_mul_f32 v24, v42, v28
    v_mul_f32 v26, v58, v28
    v_mul_f32 v25, v43, v29
    v_mul_f32 v27, v59, v29
    v_fma_f32 v24, -v58, v30, v24
    v_fma_f32 v26, v42, v30, v26
    v_fma_f32 v25, -v59, v31, v25
    v_fma_f32 v27, v43, v31, v27
    v_cvt_pk_bf16_f32 v101, v24, v25
    v_cvt_pk_bf16_f32 v117, v26, v27
    v_lshlrev_b32 v28, 16, v102
    v_and_b32 v30, s38, v102
    v_lshlrev_b32 v29, 16, v118
    v_and_b32 v31, s38, v118
    v_mul_f32 v20, v44, v28
    v_mul_f32 v22, v60, v28
    v_mul_f32 v21, v45, v29
    v_mul_f32 v23, v61, v29
    v_fma_f32 v20, -v60, v30, v20
    v_mfma_f32_32x32x16_bf16 v[80:95], a[116:119], v[108:111], v[80:95]
    s_nop 1
    ds_read_b128 v[104:107], v19 offset:4096
    ds_read_b128 v[120:123], v19 offset:5120
    ds_read_b128 v[108:111], v19 offset:6144
    ds_read_b128 v[124:127], v19 offset:7168
    v_fma_f32 v22, v44, v30, v22
    v_fma_f32 v21, -v61, v31, v21
    v_fma_f32 v23, v45, v31, v23
    v_cvt_pk_bf16_f32 v102, v20, v21
    v_cvt_pk_bf16_f32 v118, v22, v23
    v_lshlrev_b32 v28, 16, v103
    v_and_b32 v30, s38, v103
    v_lshlrev_b32 v29, 16, v119
    v_and_b32 v31, s38, v119
    v_mul_f32 v24, v46, v28
    v_mul_f32 v26, v62, v28
    v_mul_f32 v25, v47, v29
    v_mul_f32 v27, v63, v29
    v_fma_f32 v24, -v62, v30, v24
    v_fma_f32 v26, v46, v30, v26
    v_fma_f32 v25, -v63, v31, v25
    v_fma_f32 v27, v47, v31, v27
    v_cvt_pk_bf16_f32 v103, v24, v25
    v_cvt_pk_bf16_f32 v119, v26, v27
    v_mfma_f32_32x32x16_bf16 v[32:47], v[96:99], a[96:99], 0
    v_mfma_f32_32x32x16_bf16 v[48:63], v[112:115], a[96:99], 0
    s_add_u32 s18, s34, 131328
    buffer_load_ushort a249, v12, s[48:51], s18 offen
    buffer_load_ushort v4, v12, s[52:55], s18 offen
    v_mfma_f32_32x32x16_bf16 v[32:47], v[112:115], a[112:115], v[32:47]
    s_waitcnt lgkmcnt(0)
    v_lshlrev_b32 v28, 16, v104
    v_and_b32 v30, s38, v104
    v_lshlrev_b32 v29, 16, v120
    v_and_b32 v31, s38, v120
    v_mul_f32 v20, v64, v28
    v_mul_f32 v22, v80, v28
    v_mul_f32 v21, v65, v29
    v_mul_f32 v23, v81, v29
    v_fma_f32 v20, -v80, v30, v20
    v_fma_f32 v22, v64, v30, v22
    v_fma_f32 v21, -v81, v31, v21
    v_fma_f32 v23, v65, v31, v23
    v_cvt_pk_bf16_f32 v104, v20, v21
    v_cvt_pk_bf16_f32 v120, v22, v23
    v_lshlrev_b32 v28, 16, v105
    v_and_b32 v30, s38, v105
    v_lshlrev_b32 v29, 16, v121
    v_mfma_f32_32x32x16_bf16 v[48:63], v[96:99], a[104:107], v[48:63]
    v_and_b32 v31, s38, v121
    v_mul_f32 v24, v66, v28
    v_mul_f32 v26, v82, v28
    v_mul_f32 v25, v67, v29
    v_mul_f32 v27, v83, v29
    v_fma_f32 v24, -v82, v30, v24
    v_fma_f32 v26, v66, v30, v26
    v_fma_f32 v25, -v83, v31, v25
    v_fma_f32 v27, v67, v31, v27
    v_cvt_pk_bf16_f32 v105, v24, v25
    v_cvt_pk_bf16_f32 v121, v26, v27
    v_lshlrev_b32 v28, 16, v106
    v_and_b32 v30, s38, v106
    v_lshlrev_b32 v29, 16, v122
    v_and_b32 v31, s38, v122
    v_mul_f32 v20, v68, v28
    v_mul_f32 v22, v84, v28
    v_mul_f32 v21, v69, v29
    v_mul_f32 v23, v85, v29
    v_mfma_f32_32x32x16_bf16 v[32:47], v[100:103], a[100:103], v[32:47]
    v_fma_f32 v20, -v84, v30, v20
    v_fma_f32 v22, v68, v30, v22
    v_fma_f32 v21, -v85, v31, v21
    v_fma_f32 v23, v69, v31, v23
    v_cvt_pk_bf16_f32 v106, v20, v21
    v_cvt_pk_bf16_f32 v122, v22, v23
    v_lshlrev_b32 v28, 16, v107
    v_and_b32 v30, s38, v107
    v_lshlrev_b32 v29, 16, v123
    v_and_b32 v31, s38, v123
    v_mul_f32 v24, v70, v28
    v_mul_f32 v26, v86, v28
    v_mul_f32 v25, v71, v29
    v_mul_f32 v27, v87, v29
    v_fma_f32 v24, -v86, v30, v24
    v_fma_f32 v26, v70, v30, v26
    v_fma_f32 v25, -v87, v31, v25
    v_fma_f32 v27, v71, v31, v27
    v_cvt_pk_bf16_f32 v107, v24, v25
    v_mfma_f32_32x32x16_bf16 v[48:63], v[116:119], a[100:103], v[48:63]
    v_cvt_pk_bf16_f32 v123, v26, v27
    v_lshlrev_b32 v28, 16, v108
    v_and_b32 v30, s38, v108
    v_lshlrev_b32 v29, 16, v124
    v_and_b32 v31, s38, v124
    v_mul_f32 v20, v72, v28
    v_mul_f32 v22, v88, v28
    v_mul_f32 v21, v73, v29
    v_mul_f32 v23, v89, v29
    v_fma_f32 v20, -v88, v30, v20
    v_fma_f32 v22, v72, v30, v22
    v_fma_f32 v21, -v89, v31, v21
    v_fma_f32 v23, v73, v31, v23
    v_cvt_pk_bf16_f32 v108, v20, v21
    v_cvt_pk_bf16_f32 v124, v22, v23
    v_lshlrev_b32 v28, 16, v109
    v_and_b32 v30, s38, v109
    v_lshlrev_b32 v29, 16, v125
    v_and_b32 v31, s38, v125
    v_mfma_f32_32x32x16_bf16 v[32:47], v[116:119], a[116:119], v[32:47]
    v_mul_f32 v24, v74, v28
    v_mul_f32 v26, v90, v28
    v_mul_f32 v25, v75, v29
    v_mul_f32 v27, v91, v29
    v_fma_f32 v24, -v90, v30, v24
    v_fma_f32 v26, v74, v30, v26
    v_fma_f32 v25, -v91, v31, v25
    v_fma_f32 v27, v75, v31, v27
    v_cvt_pk_bf16_f32 v109, v24, v25
    v_cvt_pk_bf16_f32 v125, v26, v27
    v_lshlrev_b32 v28, 16, v110
    v_and_b32 v30, s38, v110
    v_lshlrev_b32 v29, 16, v126
    v_and_b32 v31, s38, v126
    v_mul_f32 v20, v76, v28
    v_mul_f32 v22, v92, v28
    v_mul_f32 v21, v77, v29
    v_mul_f32 v23, v93, v29
    v_fma_f32 v20, -v92, v30, v20
    v_mfma_f32_32x32x16_bf16 v[48:63], v[100:103], a[108:111], v[48:63]
    v_fma_f32 v22, v76, v30, v22
    v_fma_f32 v21, -v93, v31, v21
    v_fma_f32 v23, v77, v31, v23
    v_cvt_pk_bf16_f32 v110, v20, v21
    v_cvt_pk_bf16_f32 v126, v22, v23
    v_lshlrev_b32 v28, 16, v111
    v_and_b32 v30, s38, v111
    v_lshlrev_b32 v29, 16, v127
    v_and_b32 v31, s38, v127
    v_mul_f32 v24, v78, v28
    v_mul_f32 v26, v94, v28
    v_mul_f32 v25, v79, v29
    v_mul_f32 v27, v95, v29
    v_fma_f32 v24, -v94, v30, v24
    v_fma_f32 v26, v78, v30, v26
    v_fma_f32 v25, -v95, v31, v25
    v_fma_f32 v27, v79, v31, v27
    v_cvt_pk_bf16_f32 v111, v24, v25
    v_cvt_pk_bf16_f32 v127, v26, v27
    v_mfma_f32_32x32x16_bf16 v[64:79], v[104:107], a[96:99], 0
    v_mfma_f32_32x32x16_bf16 v[80:95], v[120:123], a[96:99], 0
    s_add_u32 s18, s34, 196992
    buffer_load_ushort a253, v12, s[48:51], s18 offen
    buffer_load_ushort v7, v12, s[52:55], s18 offen
    v_mfma_f32_32x32x16_bf16 v[64:79], v[120:123], a[112:115], v[64:79]
    v_mul_f32 v20, v32, v160
    v_mul_f32 v22, v48, v160
    v_mul_f32 v21, v33, v161
    v_mul_f32 v23, v49, v161
    v_fma_f32 v20, -v48, v176, v20
    v_fma_f32 v22, v32, v176, v22
    v_fma_f32 v21, -v49, v177, v21
    v_fma_f32 v23, v33, v177, v23
    v_cvt_pk_bf16_f32 v96, v20, v21
    v_cvt_pk_bf16_f32 v112, v22, v23
    v_mul_f32 v24, v34, v162
    v_mul_f32 v26, v50, v162
    v_mul_f32 v25, v35, v163
    v_mfma_f32_32x32x16_bf16 v[80:95], v[104:107], a[104:107], v[80:95]
    v_mul_f32 v27, v51, v163
    v_fma_f32 v24, -v50, v178, v24
    v_fma_f32 v26, v34, v178, v26
    v_fma_f32 v25, -v51, v179, v25
    v_fma_f32 v27, v35, v179, v27
    v_cvt_pk_bf16_f32 v97, v24, v25
    v_cvt_pk_bf16_f32 v113, v26, v27
    v_mul_f32 v20, v36, v164
    v_mul_f32 v22, v52, v164
    v_mul_f32 v21, v37, v165
    v_mul_f32 v23, v53, v165
    v_fma_f32 v20, -v52, v180, v20
    v_fma_f32 v22, v36, v180, v22
    v_mfma_f32_32x32x16_bf16 v[64:79], v[108:111], a[100:103], v[64:79]
    v_fma_f32 v21, -v53, v181, v21
    v_fma_f32 v23, v37, v181, v23
    v_cvt_pk_bf16_f32 v98, v20, v21
    v_cvt_pk_bf16_f32 v114, v22, v23
    v_mul_f32 v24, v38, v166
    v_mul_f32 v26, v54, v166
    v_mul_f32 v25, v39, v167
    v_mul_f32 v27, v55, v167
    v_fma_f32 v24, -v54, v182, v24
    v_fma_f32 v26, v38, v182, v26
    v_fma_f32 v25, -v55, v183, v25
    v_fma_f32 v27, v39, v183, v27
    v_cvt_pk_bf16_f32 v99, v24, v25
    v_cvt_pk_bf16_f32 v115, v26, v27
    v_mfma_f32_32x32x16_bf16 v[80:95], v[124:127], a[100:103], v[80:95]
    v_mul_f32 v20, v40, v168
    v_mul_f32 v22, v56, v168
    v_mul_f32 v21, v41, v169
    v_mul_f32 v23, v57, v169
    v_fma_f32 v20, -v56, v184, v20
    v_fma_f32 v22, v40, v184, v22
    v_fma_f32 v21, -v57, v185, v21
    v_fma_f32 v23, v41, v185, v23
    v_cvt_pk_bf16_f32 v100, v20, v21
    v_cvt_pk_bf16_f32 v116, v22, v23
    v_mul_f32 v24, v42, v170
    v_mul_f32 v26, v58, v170
    v_mul_f32 v25, v43, v171
    v_mfma_f32_32x32x16_bf16 v[64:79], v[124:127], a[116:119], v[64:79]
    v_mul_f32 v27, v59, v171
    v_fma_f32 v24, -v58, v186, v24
    v_fma_f32 v26, v42, v186, v26
    v_fma_f32 v25, -v59, v187, v25
    v_fma_f32 v27, v43, v187, v27
    v_cvt_pk_bf16_f32 v101, v24, v25
    v_cvt_pk_bf16_f32 v117, v26, v27
    v_mul_f32 v20, v44, v172
    v_mul_f32 v22, v60, v172
    v_mul_f32 v21, v45, v173
    v_mul_f32 v23, v61, v173
    v_fma_f32 v20, -v60, v188, v20
    v_fma_f32 v22, v44, v188, v22
    v_mfma_f32_32x32x16_bf16 v[80:95], v[108:111], a[108:111], v[80:95]
    v_fma_f32 v21, -v61, v189, v21
    v_fma_f32 v23, v45, v189, v23
    v_cvt_pk_bf16_f32 v102, v20, v21
    v_cvt_pk_bf16_f32 v118, v22, v23
    v_mul_f32 v24, v46, v174
    v_mul_f32 v26, v62, v174
    v_mul_f32 v25, v47, v175
    v_mul_f32 v27, v63, v175
    v_fma_f32 v24, -v62, v190, v24
    v_fma_f32 v26, v46, v190, v26
    v_fma_f32 v25, -v63, v191, v25
    v_fma_f32 v27, v47, v191, v27
    v_cvt_pk_bf16_f32 v103, v24, v25
    v_cvt_pk_bf16_f32 v119, v26, v27
    v_mfma_f32_32x32x16_bf16 v[32:47], a[0:3], v[96:99], 0
    v_mfma_f32_32x32x16_bf16 v[48:63], a[0:3], v[112:115], 0
    s_add_u32 s18, s34, 262656
    buffer_load_ushort a250, v12, s[48:51], s18 offen
    buffer_load_ushort v8, v12, s[52:55], s18 offen
    v_mfma_f32_32x32x16_bf16 v[32:47], a[64:67], v[112:115], v[32:47]
    v_mul_f32 v20, v64, v224
    v_mul_f32 v22, v80, v224
    v_mul_f32 v21, v65, v225
    v_mul_f32 v23, v81, v225
    v_fma_f32 v20, -v80, v240, v20
    v_fma_f32 v22, v64, v240, v22
    v_fma_f32 v21, -v81, v241, v21
    v_fma_f32 v23, v65, v241, v23
    v_cvt_pk_bf16_f32 v104, v20, v21
    v_cvt_pk_bf16_f32 v120, v22, v23
    v_mul_f32 v24, v66, v226
    v_mul_f32 v26, v82, v226
    v_mul_f32 v25, v67, v227
    v_mfma_f32_32x32x16_bf16 v[48:63], a[32:35], v[96:99], v[48:63]
    v_mul_f32 v27, v83, v227
    v_fma_f32 v24, -v82, v242, v24
    v_fma_f32 v26, v66, v242, v26
    v_fma_f32 v25, -v83, v243, v25
    v_fma_f32 v27, v67, v243, v27
    v_cvt_pk_bf16_f32 v105, v24, v25
    v_cvt_pk_bf16_f32 v121, v26, v27
    v_mul_f32 v20, v68, v228
    v_mul_f32 v22, v84, v228
    v_mul_f32 v21, v69, v229
    v_mul_f32 v23, v85, v229
    v_fma_f32 v20, -v84, v244, v20
    v_fma_f32 v22, v68, v244, v22
    v_mfma_f32_32x32x16_bf16 v[32:47], a[4:7], v[100:103], v[32:47]
    v_fma_f32 v21, -v85, v245, v21
    v_fma_f32 v23, v69, v245, v23
    v_cvt_pk_bf16_f32 v106, v20, v21
    v_cvt_pk_bf16_f32 v122, v22, v23
    v_mul_f32 v24, v70, v230
    v_mul_f32 v26, v86, v230
    v_mul_f32 v25, v71, v231
    v_mul_f32 v27, v87, v231
    v_fma_f32 v24, -v86, v246, v24
    v_fma_f32 v26, v70, v246, v26
    v_fma_f32 v25, -v87, v247, v25
    v_fma_f32 v27, v71, v247, v27
    v_cvt_pk_bf16_f32 v107, v24, v25
    v_cvt_pk_bf16_f32 v123, v26, v27
    v_mfma_f32_32x32x16_bf16 v[48:63], a[4:7], v[116:119], v[48:63]
    v_mul_f32 v20, v72, v232
    v_mul_f32 v22, v88, v232
    v_mul_f32 v21, v73, v233
    v_mul_f32 v23, v89, v233
    v_fma_f32 v20, -v88, v248, v20
    v_fma_f32 v22, v72, v248, v22
    v_fma_f32 v21, -v89, v249, v21
    v_fma_f32 v23, v73, v249, v23
    v_cvt_pk_bf16_f32 v108, v20, v21
    v_cvt_pk_bf16_f32 v124, v22, v23
    v_mul_f32 v24, v74, v234
    v_mul_f32 v26, v90, v234
    v_mul_f32 v25, v75, v235
    v_mfma_f32_32x32x16_bf16 v[32:47], a[68:71], v[116:119], v[32:47]
    v_mul_f32 v27, v91, v235
    v_fma_f32 v24, -v90, v250, v24
    v_fma_f32 v26, v74, v250, v26
    v_fma_f32 v25, -v91, v251, v25
    v_fma_f32 v27, v75, v251, v27
    v_cvt_pk_bf16_f32 v109, v24, v25
    v_cvt_pk_bf16_f32 v125, v26, v27
    v_mul_f32 v20, v76, v236
    v_mul_f32 v22, v92, v236
    v_mul_f32 v21, v77, v237
    v_mul_f32 v23, v93, v237
    v_fma_f32 v20, -v92, v252, v20
    v_fma_f32 v22, v76, v252, v22
    v_mfma_f32_32x32x16_bf16 v[48:63], a[36:39], v[100:103], v[48:63]
    v_fma_f32 v21, -v93, v253, v21
    v_fma_f32 v23, v77, v253, v23
    v_cvt_pk_bf16_f32 v110, v20, v21
    v_cvt_pk_bf16_f32 v126, v22, v23
    v_mul_f32 v24, v78, v238
    v_mul_f32 v26, v94, v238
    v_mul_f32 v25, v79, v239
    v_mul_f32 v27, v95, v239
    v_fma_f32 v24, -v94, v254, v24
    v_fma_f32 v26, v78, v254, v26
    v_fma_f32 v25, -v95, v255, v25
    v_fma_f32 v27, v79, v255, v27
    v_cvt_pk_bf16_f32 v111, v24, v25
    v_cvt_pk_bf16_f32 v127, v26, v27
    v_mfma_f32_32x32x16_bf16 v[32:47], a[8:11], v[104:107], v[32:47]
    s_add_u32 s18, s34, 328320
    buffer_load_ushort a254, v12, s[48:51], s18 offen
    buffer_load_ushort v10, v12, s[52:55], s18 offen
    v_mfma_f32_32x32x16_bf16 v[48:63], a[8:11], v[120:123], v[48:63]
    v_mfma_f32_32x32x16_bf16 v[32:47], a[72:75], v[120:123], v[32:47]
    v_mfma_f32_32x32x16_bf16 v[48:63], a[40:43], v[104:107], v[48:63]
    v_mfma_f32_32x32x16_bf16 v[32:47], a[12:15], v[108:111], v[32:47]
    s_add_u32 s18, s34, 393984
    buffer_load_ushort a251, v12, s[48:51], s18 offen
    buffer_load_ushort v11, v12, s[52:55], s18 offen
    v_mfma_f32_32x32x16_bf16 v[48:63], a[12:15], v[124:127], v[48:63]
    v_mfma_f32_32x32x16_bf16 v[32:47], a[76:79], v[124:127], v[32:47]
    v_mfma_f32_32x32x16_bf16 v[48:63], a[44:47], v[108:111], v[48:63]
    v_mfma_f32_32x32x16_bf16 v[64:79], a[16:19], v[96:99], 0
    s_add_u32 s18, s34, 459648
    buffer_load_ushort a255, v12, s[48:51], s18 offen
    buffer_load_ushort v16, v12, s[52:55], s18 offen
    v_mfma_f32_32x32x16_bf16 v[80:95], a[16:19], v[112:115], 0
    v_mfma_f32_32x32x16_bf16 v[64:79], a[80:83], v[112:115], v[64:79]
    s_nop 1
    v_cvt_pk_bf16_f32 v32, v32, v48
    v_mfma_f32_32x32x16_bf16 v[80:95], a[48:51], v[96:99], v[80:95]
    v_cvt_pk_bf16_f32 v33, v33, v49
    v_mfma_f32_32x32x16_bf16 v[64:79], a[20:23], v[100:103], v[64:79]
    v_cvt_pk_bf16_f32 v34, v34, v50
    v_mfma_f32_32x32x16_bf16 v[80:95], a[20:23], v[116:119], v[80:95]
    v_cvt_pk_bf16_f32 v35, v35, v51
    v_mfma_f32_32x32x16_bf16 v[64:79], a[84:87], v[116:119], v[64:79]
    v_cvt_pk_bf16_f32 v36, v36, v52
    v_mfma_f32_32x32x16_bf16 v[80:95], a[52:55], v[100:103], v[80:95]
    v_cvt_pk_bf16_f32 v37, v37, v53
    v_mfma_f32_32x32x16_bf16 v[64:79], a[24:27], v[104:107], v[64:79]
    v_cvt_pk_bf16_f32 v38, v38, v54
    v_cvt_pk_bf16_f32 v39, v39, v55
    v_mfma_f32_32x32x16_bf16 v[80:95], a[24:27], v[120:123], v[80:95]
    v_cvt_pk_bf16_f32 v40, v40, v56
    v_mfma_f32_32x32x16_bf16 v[64:79], a[88:91], v[120:123], v[64:79]
    v_cvt_pk_bf16_f32 v41, v41, v57
    v_mfma_f32_32x32x16_bf16 v[80:95], a[56:59], v[104:107], v[80:95]
    v_cvt_pk_bf16_f32 v42, v42, v58
    v_mfma_f32_32x32x16_bf16 v[64:79], a[28:31], v[108:111], v[64:79]
    v_cvt_pk_bf16_f32 v43, v43, v59
    v_mfma_f32_32x32x16_bf16 v[80:95], a[28:31], v[124:127], v[80:95]
    v_cvt_pk_bf16_f32 v44, v44, v60
    v_mfma_f32_32x32x16_bf16 v[64:79], a[92:95], v[124:127], v[64:79]
    v_cvt_pk_bf16_f32 v45, v45, v61
    v_mfma_f32_32x32x16_bf16 v[80:95], a[60:63], v[108:111], v[80:95]
    v_cvt_pk_bf16_f32 v46, v46, v62
    v_cvt_pk_bf16_f32 v47, v47, v63
    s_nop 9
    v_cvt_pk_bf16_f32 v64, v64, v80
    v_cvt_pk_bf16_f32 v65, v65, v81
    v_cvt_pk_bf16_f32 v66, v66, v82
    v_cvt_pk_bf16_f32 v67, v67, v83
    v_cvt_pk_bf16_f32 v68, v68, v84
    v_cvt_pk_bf16_f32 v69, v69, v85
    v_cvt_pk_bf16_f32 v70, v70, v86
    v_cvt_pk_bf16_f32 v71, v71, v87
    v_cvt_pk_bf16_f32 v72, v72, v88
    v_cvt_pk_bf16_f32 v73, v73, v89
    v_cvt_pk_bf16_f32 v74, v74, v90
    v_cvt_pk_bf16_f32 v75, v75, v91
    v_cvt_pk_bf16_f32 v76, v76, v92
    v_cvt_pk_bf16_f32 v77, v77, v93
    v_cvt_pk_bf16_f32 v78, v78, v94
    v_cvt_pk_bf16_f32 v79, v79, v95
    s_cmp_eq_u32 s36, 2
    s_cbranch_scc1 F2_o1
    s_cmp_eq_u32 s36, 3
    s_cbranch_scc1 F2_o2
    s_cmp_eq_u32 s36, 4
    s_cbranch_scc1 F2_o3
    s_cmp_eq_u32 s36, 5
    s_cbranch_scc1 F2_o4
    v_accvgpr_write_b32 a120, v32
    v_accvgpr_write_b32 a124, v33
    v_accvgpr_write_b32 a128, v34
    v_accvgpr_write_b32 a132, v35
    v_accvgpr_write_b32 a136, v36
    v_accvgpr_write_b32 a140, v37
    v_accvgpr_write_b32 a144, v38
    v_accvgpr_write_b32 a148, v39
    v_accvgpr_write_b32 a152, v40
    v_accvgpr_write_b32 a156, v41
    v_accvgpr_write_b32 a160, v42
    v_accvgpr_write_b32 a164, v43
    v_accvgpr_write_b32 a168, v44
    v_accvgpr_write_b32 a172, v45
    v_accvgpr_write_b32 a176, v46
    v_accvgpr_write_b32 a180, v47
    v_accvgpr_write_b32 a184, v64
    v_accvgpr_write_b32 a188, v65
    v_accvgpr_write_b32 a192, v66
    v_accvgpr_write_b32 a196, v67
    v_accvgpr_write_b32 a200, v68
    v_accvgpr_write_b32 a204, v69
    v_accvgpr_write_b32 a208, v70
    v_accvgpr_write_b32 a212, v71
    v_accvgpr_write_b32 a216, v72
    v_accvgpr_write_b32 a220, v73
    v_accvgpr_write_b32 a224, v74
    v_accvgpr_write_b32 a228, v75
    v_accvgpr_write_b32 a232, v76
    v_accvgpr_write_b32 a236, v77
    v_accvgpr_write_b32 a240, v78
    v_accvgpr_write_b32 a244, v79
    s_branch F2_nx
F2_o1:
    v_accvgpr_write_b32 a121, v32
    v_accvgpr_write_b32 a125, v33
    v_accvgpr_write_b32 a129, v34
    v_accvgpr_write_b32 a133, v35
    v_accvgpr_write_b32 a137, v36
    v_accvgpr_write_b32 a141, v37
    v_accvgpr_write_b32 a145, v38
    v_accvgpr_write_b32 a149, v39
    v_accvgpr_write_b32 a153, v40
    v_accvgpr_write_b32 a157, v41
    v_accvgpr_write_b32 a161, v42
    v_accvgpr_write_b32 a165, v43
    v_accvgpr_write_b32 a169, v44
    v_accvgpr_write_b32 a173, v45
    v_accvgpr_write_b32 a177, v46
    v_accvgpr_write_b32 a181, v47
    v_accvgpr_write_b32 a185, v64
    v_accvgpr_write_b32 a189, v65
    v_accvgpr_write_b32 a193, v66
    v_accvgpr_write_b32 a197, v67
    v_accvgpr_write_b32 a201, v68
    v_accvgpr_write_b32 a205, v69
    v_accvgpr_write_b32 a209, v70
    v_accvgpr_write_b32 a213, v71
    v_accvgpr_write_b32 a217, v72
    v_accvgpr_write_b32 a221, v73
    v_accvgpr_write_b32 a225, v74
    v_accvgpr_write_b32 a229, v75
    v_accvgpr_write_b32 a233, v76
    v_accvgpr_write_b32 a237, v77
    v_accvgpr_write_b32 a241, v78
    v_accvgpr_write_b32 a245, v79
    s_branch F2_nx
F2_o2:
    v_accvgpr_write_b32 a122, v32
    v_accvgpr_write_b32 a126, v33
    v_accvgpr_write_b32 a130, v34
    v_accvgpr_write_b32 a134, v35
    v_accvgpr_write_b32 a138, v36
    v_accvgpr_write_b32 a142, v37
    v_accvgpr_write_b32 a146, v38
    v_accvgpr_write_b32 a150, v39
    v_accvgpr_write_b32 a154, v40
    v_accvgpr_write_b32 a158, v41
    v_accvgpr_write_b32 a162, v42
    v_accvgpr_write_b32 a166, v43
    v_accvgpr_write_b32 a170, v44
    v_accvgpr_write_b32 a174, v45
    v_accvgpr_write_b32 a178, v46
    v_accvgpr_write_b32 a182, v47
    v_accvgpr_write_b32 a186, v64
    v_accvgpr_write_b32 a190, v65
    v_accvgpr_write_b32 a194, v66
    v_accvgpr_write_b32 a198, v67
    v_accvgpr_write_b32 a202, v68
    v_accvgpr_write_b32 a206, v69
    v_accvgpr_write_b32 a210, v70
    v_accvgpr_write_b32 a214, v71
    v_accvgpr_write_b32 a218, v72
    v_accvgpr_write_b32 a222, v73
    v_accvgpr_write_b32 a226, v74
    v_accvgpr_write_b32 a230, v75
    v_accvgpr_write_b32 a234, v76
    v_accvgpr_write_b32 a238, v77
    v_accvgpr_write_b32 a242, v78
    v_accvgpr_write_b32 a246, v79
    s_branch F2_nx
F2_o3:
    v_accvgpr_write_b32 a123, v32
    v_accvgpr_write_b32 a127, v33
    v_accvgpr_write_b32 a131, v34
    v_accvgpr_write_b32 a135, v35
    v_accvgpr_write_b32 a139, v36
    v_accvgpr_write_b32 a143, v37
    v_accvgpr_write_b32 a147, v38
    v_accvgpr_write_b32 a151, v39
    v_accvgpr_write_b32 a155, v40
    v_accvgpr_write_b32 a159, v41
    v_accvgpr_write_b32 a163, v42
    v_accvgpr_write_b32 a167, v43
    v_accvgpr_write_b32 a171, v44
    v_accvgpr_write_b32 a175, v45
    v_accvgpr_write_b32 a179, v46
    v_accvgpr_write_b32 a183, v47
    v_accvgpr_write_b32 a187, v64
    v_accvgpr_write_b32 a191, v65
    v_accvgpr_write_b32 a195, v66
    v_accvgpr_write_b32 a199, v67
    v_accvgpr_write_b32 a203, v68
    v_accvgpr_write_b32 a207, v69
    v_accvgpr_write_b32 a211, v70
    v_accvgpr_write_b32 a215, v71
    v_accvgpr_write_b32 a219, v72
    v_accvgpr_write_b32 a223, v73
    v_accvgpr_write_b32 a227, v74
    v_accvgpr_write_b32 a231, v75
    v_accvgpr_write_b32 a235, v76
    v_accvgpr_write_b32 a239, v77
    v_accvgpr_write_b32 a243, v78
    v_accvgpr_write_b32 a247, v79
    s_branch F2_nx
F2_o4:
    v_accvgpr_read_b32 v5, a120
    v_lshlrev_b32 v6, 16, v32
    v_bfi_b32 v5, s38, v6, v5
    v_accvgpr_write_b32 a120, v5
    v_accvgpr_read_b32 v5, a124
    v_lshlrev_b32 v6, 16, v33
    v_bfi_b32 v5, s38, v6, v5
    v_accvgpr_write_b32 a124, v5
    v_accvgpr_read_b32 v5, a128
    v_lshlrev_b32 v6, 16, v34
    v_bfi_b32 v5, s38, v6, v5
    v_accvgpr_write_b32 a128, v5
    v_accvgpr_read_b32 v5, a132
    v_lshlrev_b32 v6, 16, v35
    v_bfi_b32 v5, s38, v6, v5
    v_accvgpr_write_b32 a132, v5
    v_accvgpr_read_b32 v5, a136
    v_lshlrev_b32 v6, 16, v36
    v_bfi_b32 v5, s38, v6, v5
    v_accvgpr_write_b32 a136, v5
    v_accvgpr_read_b32 v5, a140
    v_lshlrev_b32 v6, 16, v37
    v_bfi_b32 v5, s38, v6, v5
    v_accvgpr_write_b32 a140, v5
    v_accvgpr_read_b32 v5, a144
    v_lshlrev_b32 v6, 16, v38
    v_bfi_b32 v5, s38, v6, v5
    v_accvgpr_write_b32 a144, v5
    v_accvgpr_read_b32 v5, a148
    v_lshlrev_b32 v6, 16, v39
    v_bfi_b32 v5, s38, v6, v5
    v_accvgpr_write_b32 a148, v5
    v_accvgpr_read_b32 v5, a152
    v_lshlrev_b32 v6, 16, v40
    v_bfi_b32 v5, s38, v6, v5
    v_accvgpr_write_b32 a152, v5
    v_accvgpr_read_b32 v5, a156
    v_lshlrev_b32 v6, 16, v41
    v_bfi_b32 v5, s38, v6, v5
    v_accvgpr_write_b32 a156, v5
    v_accvgpr_read_b32 v5, a160
    v_lshlrev_b32 v6, 16, v42
    v_bfi_b32 v5, s38, v6, v5
    v_accvgpr_write_b32 a160, v5
    v_accvgpr_read_b32 v5, a164
    v_lshlrev_b32 v6, 16, v43
    v_bfi_b32 v5, s38, v6, v5
    v_accvgpr_write_b32 a164, v5
    v_accvgpr_read_b32 v5, a168
    v_lshlrev_b32 v6, 16, v44
    v_bfi_b32 v5, s38, v6, v5
    v_accvgpr_write_b32 a168, v5
    v_accvgpr_read_b32 v5, a172
    v_lshlrev_b32 v6, 16, v45
    v_bfi_b32 v5, s38, v6, v5
    v_accvgpr_write_b32 a172, v5
    v_accvgpr_read_b32 v5, a176
    v_lshlrev_b32 v6, 16, v46
    v_bfi_b32 v5, s38, v6, v5
    v_accvgpr_write_b32 a176, v5
    v_accvgpr_read_b32 v5, a180
    v_lshlrev_b32 v6, 16, v47
    v_bfi_b32 v5, s38, v6, v5
    v_accvgpr_write_b32 a180, v5
    v_accvgpr_read_b32 v5, a184
    v_lshlrev_b32 v6, 16, v64
    v_bfi_b32 v5, s38, v6, v5
    v_accvgpr_write_b32 a184, v5
    v_accvgpr_read_b32 v5, a188
    v_lshlrev_b32 v6, 16, v65
    v_bfi_b32 v5, s38, v6, v5
    v_accvgpr_write_b32 a188, v5
    v_accvgpr_read_b32 v5, a192
    v_lshlrev_b32 v6, 16, v66
    v_bfi_b32 v5, s38, v6, v5
    v_accvgpr_write_b32 a192, v5
    v_accvgpr_read_b32 v5, a196
    v_lshlrev_b32 v6, 16, v67
    v_bfi_b32 v5, s38, v6, v5
    v_accvgpr_write_b32 a196, v5
    v_accvgpr_read_b32 v5, a200
    v_lshlrev_b32 v6, 16, v68
    v_bfi_b32 v5, s38, v6, v5
    v_accvgpr_write_b32 a200, v5
    v_accvgpr_read_b32 v5, a204
    v_lshlrev_b32 v6, 16, v69
    v_bfi_b32 v5, s38, v6, v5
    v_accvgpr_write_b32 a204, v5
    v_accvgpr_read_b32 v5, a208
    v_lshlrev_b32 v6, 16, v70
    v_bfi_b32 v5, s38, v6, v5
    v_accvgpr_write_b32 a208, v5
    v_accvgpr_read_b32 v5, a212
    v_lshlrev_b32 v6, 16, v71
    v_bfi_b32 v5, s38, v6, v5
    v_accvgpr_write_b32 a212, v5
    v_accvgpr_read_b32 v5, a216
    v_lshlrev_b32 v6, 16, v72
    v_bfi_b32 v5, s38, v6, v5
    v_accvgpr_write_b32 a216, v5
    v_accvgpr_read_b32 v5, a220
    v_lshlrev_b32 v6, 16, v73
    v_bfi_b32 v5, s38, v6, v5
    v_accvgpr_write_b32 a220, v5
    v_accvgpr_read_b32 v5, a224
    v_lshlrev_b32 v6, 16, v74
    v_bfi_b32 v5, s38, v6, v5
    v_accvgpr_write_b32 a224, v5
    v_accvgpr_read_b32 v5, a228
    v_lshlrev_b32 v6, 16, v75
    v_bfi_b32 v5, s38, v6, v5
    v_accvgpr_write_b32 a228, v5
    v_accvgpr_read_b32 v5, a232
    v_lshlrev_b32 v6, 16, v76
    v_bfi_b32 v5, s38, v6, v5
    v_accvgpr_write_b32 a232, v5
    v_accvgpr_read_b32 v5, a236
    v_lshlrev_b32 v6, 16, v77
    v_bfi_b32 v5, s38, v6, v5
    v_accvgpr_write_b32 a236, v5
    v_accvgpr_read_b32 v5, a240
    v_lshlrev_b32 v6, 16, v78
    v_bfi_b32 v5, s38, v6, v5
    v_accvgpr_write_b32 a240, v5
    v_accvgpr_read_b32 v5, a244
    v_lshlrev_b32 v6, 16, v79
    v_bfi_b32 v5, s38, v6, v5
    v_accvgpr_write_b32 a244, v5
F2_nx:
    s_add_u32 s35, s35, 8192
    s_bitcmp1_b32 s36, 0
    s_cselect_b32 s17, 0, 2068416
    s_add_u32 s34, s34, 1050624
    s_sub_u32 s34, s34, s17
    s_cmp_eq_u32 s36, 4
    s_cselect_b32 s35, 133120, s35
    s_cselect_b32 s34, 1073741824, s34
    s_cmp_lt_u32 s36, s37
    s_cbranch_scc1 F2_top
    s_mul_i32 s21, s31, 33024
    s_add_u32 s21, s21, 111149056
    s_add_u32 s17, s21, 0
    buffer_store_dwordx4 a[120:123], v18, s[4:7], s17 offen offset:0 sc1
    buffer_store_dwordx4 a[124:127], v18, s[4:7], s17 offen offset:512 sc1
    buffer_store_dwordx4 a[128:131], v18, s[4:7], s17 offen offset:1024 sc1
    buffer_store_dwordx4 a[132:135], v18, s[4:7], s17 offen offset:1536 sc1
    buffer_store_dwordx4 a[136:139], v18, s[4:7], s17 offen offset:2048 sc1
    buffer_store_dwordx4 a[140:143], v18, s[4:7], s17 offen offset:2560 sc1
    buffer_store_dwordx4 a[144:147], v18, s[4:7], s17 offen offset:3072 sc1
    buffer_store_dwordx4 a[148:151], v18, s[4:7], s17 offen offset:3584 sc1
    s_add_u32 s17, s21, 8192
    buffer_store_dwordx4 a[152:155], v18, s[4:7], s17 offen offset:0 sc1
    buffer_store_dwordx4 a[156:159], v18, s[4:7], s17 offen offset:512 sc1
    buffer_store_dwordx4 a[160:163], v18, s[4:7], s17 offen offset:1024 sc1
    buffer_store_dwordx4 a[164:167], v18, s[4:7], s17 offen offset:1536 sc1
    buffer_store_dwordx4 a[168:171], v18, s[4:7], s17 offen offset:2048 sc1
    buffer_store_dwordx4 a[172:175], v18, s[4:7], s17 offen offset:2560 sc1
    buffer_store_dwordx4 a[176:179], v18, s[4:7], s17 offen offset:3072 sc1
    buffer_store_dwordx4 a[180:183], v18, s[4:7], s17 offen offset:3584 sc1
    s_add_u32 s17, s21, 16384
    buffer_store_dwordx4 a[184:187], v18, s[4:7], s17 offen offset:0 sc1
    buffer_store_dwordx4 a[188:191], v18, s[4:7], s17 offen offset:512 sc1
    buffer_store_dwordx4 a[192:195], v18, s[4:7], s17 offen offset:1024 sc1
    buffer_store_dwordx4 a[196:199], v18, s[4:7], s17 offen offset:1536 sc1
    buffer_store_dwordx4 a[200:203], v18, s[4:7], s17 offen offset:2048 sc1
    buffer_store_dwordx4 a[204:207], v18, s[4:7], s17 offen offset:2560 sc1
    buffer_store_dwordx4 a[208:211], v18, s[4:7], s17 offen offset:3072 sc1
    buffer_store_dwordx4 a[212:215], v18, s[4:7], s17 offen offset:3584 sc1
    s_add_u32 s17, s21, 24576
    buffer_store_dwordx4 a[216:219], v18, s[4:7], s17 offen offset:0 sc1
    buffer_store_dwordx4 a[220:223], v18, s[4:7], s17 offen offset:512 sc1
    buffer_store_dwordx4 a[224:227], v18, s[4:7], s17 offen offset:1024 sc1
    buffer_store_dwordx4 a[228:231], v18, s[4:7], s17 offen offset:1536 sc1
    buffer_store_dwordx4 a[232:235], v18, s[4:7], s17 offen offset:2048 sc1
    buffer_store_dwordx4 a[236:239], v18, s[4:7], s17 offen offset:2560 sc1
    buffer_store_dwordx4 a[240:243], v18, s[4:7], s17 offen offset:3072 sc1
    buffer_store_dwordx4 a[244:247], v18, s[4:7], s17 offen offset:3584 sc1
    s_waitcnt vmcnt(0)
    s_lshl_b32 s17, s31, 7
    s_add_u32 s17, s17, 100761600
    v_lshl_add_u32 v5, v1, 2, s17
    v_mov_b32 v6, 1
    s_mov_b64 exec, 0xffffffff
    buffer_store_dword v6, v5, s[4:7], 0 offen sc1
    s_mov_b64 exec, -1
    v_bfe_u32 v5, v1, 2, 2
    v_and_b32 v7, 3, v1
    v_lshl_add_u32 v7, v5, 3, v7
    s_lshl_b32 s17, s29, 5
    v_add_u32 v7, s17, v7
    v_lshrrev_b32 v8, 4, v1
    v_cvt_f32_u32 v8, v8
    s_mov_b32 s31, 981467136
    v_and_b32 v38, 1, v7
    v_add_u32 v5, 0, v7
    v_cvt_f32_u32 v6, v5
    v_mul_f32 v6, s31, v6
    v_mov_b32 v32, 0x3e800000
    v_sub_f32 v34, v6, v32
    v_mul_f32 v36, 0x41800000, v6
    v_mul_f32 v5, 4.0, v6
    v_mul_f32 v30, v5, v8
    v_add_u32 v5, 4, v7
    v_cvt_f32_u32 v6, v5
    v_mul_f32 v6, s31, v6
    v_mov_b32 v33, 0x3e800000
    v_sub_f32 v35, v6, v33
    v_mul_f32 v37, 0x41800000, v6
    v_mul_f32 v5, 4.0, v6
    v_mul_f32 v31, v5, v8
    v_lshlrev_b32 v40, 4, v38
    v_bfe_u32 v5, v7, 1, 1
    v_add_u32 v6, 1, v7
    v_bfe_u32 v6, v6, 1, 1
    v_lshlrev_b32 v5, 15, v5
    v_lshl_or_b32 v41, v6, 31, v5
    v_fract_f32 v48, v30
    v_add_f32 v49, v48, v32
    v_cos_f32 v56, v48
    v_add_f32 v50, v49, v34
    v_cos_f32 v57, v49
    v_add_f32 v51, v50, v32
    v_cos_f32 v58, v50
    v_add_f32 v52, v51, v34
    v_cos_f32 v59, v51
    v_add_f32 v53, v52, v32
    v_cos_f32 v60, v52
    v_add_f32 v54, v53, v34
    v_cos_f32 v61, v53
    v_add_f32 v55, v54, v32
    v_cos_f32 v62, v54
    v_cos_f32 v63, v55
    v_add_f32 v30, v48, v36
    v_cvt_pk_bf16_f32 v64, v56, v57
    v_cvt_pk_bf16_f32 v65, v58, v59
    v_cvt_pk_bf16_f32 v66, v60, v61
    v_cvt_pk_bf16_f32 v67, v62, v63
    v_accvgpr_write_b32 a0, v64
    v_accvgpr_write_b32 a1, v65
    v_accvgpr_write_b32 a2, v66
    v_accvgpr_write_b32 a3, v67
    v_alignbit_b32 v68, v64, v64, v40
    v_xor_b32 v68, v68, v41
    v_alignbit_b32 v69, v65, v65, v40
    v_xor_b32 v69, v69, v41
    v_alignbit_b32 v70, v66, v66, v40
    v_xor_b32 v70, v70, v41
    v_alignbit_b32 v71, v67, v67, v40
    v_xor_b32 v71, v71, v41
    v_accvgpr_write_b32 a128, v68
    v_accvgpr_write_b32 a129, v69
    v_accvgpr_write_b32 a130, v70
    v_accvgpr_write_b32 a131, v71
    v_fract_f32 v48, v31
    v_add_f32 v49, v48, v33
    v_cos_f32 v56, v48
    v_add_f32 v50, v49, v35
    v_cos_f32 v57, v49
    v_add_f32 v51, v50, v33
    v_cos_f32 v58, v50
    v_add_f32 v52, v51, v35
    v_cos_f32 v59, v51
    v_add_f32 v53, v52, v33
    v_cos_f32 v60, v52
    v_add_f32 v54, v53, v35
    v_cos_f32 v61, v53
    v_add_f32 v55, v54, v33
    v_cos_f32 v62, v54
    v_cos_f32 v63, v55
    v_add_f32 v31, v48, v37
    v_cvt_pk_bf16_f32 v64, v56, v57
    v_cvt_pk_bf16_f32 v65, v58, v59
    v_cvt_pk_bf16_f32 v66, v60, v61
    v_cvt_pk_bf16_f32 v67, v62, v63
    v_accvgpr_write_b32 a4, v64
    v_accvgpr_write_b32 a5, v65
    v_accvgpr_write_b32 a6, v66
    v_accvgpr_write_b32 a7, v67
    v_alignbit_b32 v68, v64, v64, v40
    v_xor_b32 v68, v68, v41
    v_alignbit_b32 v69, v65, v65, v40
    v_xor_b32 v69, v69, v41
    v_alignbit_b32 v70, v66, v66, v40
    v_xor_b32 v70, v70, v41
    v_alignbit_b32 v71, v67, v67, v40
    v_xor_b32 v71, v71, v41
    v_accvgpr_write_b32 a132, v68
    v_accvgpr_write_b32 a133, v69
    v_accvgpr_write_b32 a134, v70
    v_accvgpr_write_b32 a135, v71
    v_fract_f32 v48, v30
    v_add_f32 v49, v48, v32
    v_cos_f32 v56, v48
    v_add_f32 v50, v49, v34
    v_cos_f32 v57, v49
    v_add_f32 v51, v50, v32
    v_cos_f32 v58, v50
    v_add_f32 v52, v51, v34
    v_cos_f32 v59, v51
    v_add_f32 v53, v52, v32
    v_cos_f32 v60, v52
    v_add_f32 v54, v53, v34
    v_cos_f32 v61, v53
    v_add_f32 v55, v54, v32
    v_cos_f32 v62, v54
    v_cos_f32 v63, v55
    v_add_f32 v30, v48, v36
    v_cvt_pk_bf16_f32 v64, v56, v57
    v_cvt_pk_bf16_f32 v65, v58, v59
    v_cvt_pk_bf16_f32 v66, v60, v61
    v_cvt_pk_bf16_f32 v67, v62, v63
    v_accvgpr_write_b32 a8, v64
    v_accvgpr_write_b32 a9, v65
    v_accvgpr_write_b32 a10, v66
    v_accvgpr_write_b32 a11, v67
    v_alignbit_b32 v68, v64, v64, v40
    v_xor_b32 v68, v68, v41
    v_alignbit_b32 v69, v65, v65, v40
    v_xor_b32 v69, v69, v41
    v_alignbit_b32 v70, v66, v66, v40
    v_xor_b32 v70, v70, v41
    v_alignbit_b32 v71, v67, v67, v40
    v_xor_b32 v71, v71, v41
    v_accvgpr_write_b32 a136, v68
    v_accvgpr_write_b32 a137, v69
    v_accvgpr_write_b32 a138, v70
    v_accvgpr_write_b32 a139, v71
    v_fract_f32 v48, v31
    v_add_f32 v49, v48, v33
    v_cos_f32 v56, v48
    v_add_f32 v50, v49, v35
    v_cos_f32 v57, v49
    v_add_f32 v51, v50, v33
    v_cos_f32 v58, v50
    v_add_f32 v52, v51, v35
    v_cos_f32 v59, v51
    v_add_f32 v53, v52, v33
    v_cos_f32 v60, v52
    v_add_f32 v54, v53, v35
    v_cos_f32 v61, v53
    v_add_f32 v55, v54, v33
    v_cos_f32 v62, v54
    v_cos_f32 v63, v55
    v_add_f32 v31, v48, v37
    v_cvt_pk_bf16_f32 v64, v56, v57
    v_cvt_pk_bf16_f32 v65, v58, v59
    v_cvt_pk_bf16_f32 v66, v60, v61
    v_cvt_pk_bf16_f32 v67, v62, v63
    v_accvgpr_write_b32 a12, v64
    v_accvgpr_write_b32 a13, v65
    v_accvgpr_write_b32 a14, v66
    v_accvgpr_write_b32 a15, v67
    v_alignbit_b32 v68, v64, v64, v40
    v_xor_b32 v68, v68, v41
    v_alignbit_b32 v69, v65, v65, v40
    v_xor_b32 v69, v69, v41
    v_alignbit_b32 v70, v66, v66, v40
    v_xor_b32 v70, v70, v41
    v_alignbit_b32 v71, v67, v67, v40
    v_xor_b32 v71, v71, v41
    v_accvgpr_write_b32 a140, v68
    v_accvgpr_write_b32 a141, v69
    v_accvgpr_write_b32 a142, v70
    v_accvgpr_write_b32 a143, v71
    v_fract_f32 v48, v30
    v_add_f32 v49, v48, v32
    v_cos_f32 v56, v48
    v_add_f32 v50, v49, v34
    v_cos_f32 v57, v49
    v_add_f32 v51, v50, v32
    v_cos_f32 v58, v50
    v_add_f32 v52, v51, v34
    v_cos_f32 v59, v51
    v_add_f32 v53, v52, v32
    v_cos_f32 v60, v52
    v_add_f32 v54, v53, v34
    v_cos_f32 v61, v53
    v_add_f32 v55, v54, v32
    v_cos_f32 v62, v54
    v_cos_f32 v63, v55
    v_add_f32 v30, v48, v36
    v_cvt_pk_bf16_f32 v64, v56, v57
    v_cvt_pk_bf16_f32 v65, v58, v59
    v_cvt_pk_bf16_f32 v66, v60, v61
    v_cvt_pk_bf16_f32 v67, v62, v63
    v_accvgpr_write_b32 a16, v64
    v_accvgpr_write_b32 a17, v65
    v_accvgpr_write_b32 a18, v66
    v_accvgpr_write_b32 a19, v67
    v_alignbit_b32 v68, v64, v64, v40
    v_xor_b32 v68, v68, v41
    v_alignbit_b32 v69, v65, v65, v40
    v_xor_b32 v69, v69, v41
    v_alignbit_b32 v70, v66, v66, v40
    v_xor_b32 v70, v70, v41
    v_alignbit_b32 v71, v67, v67, v40
    v_xor_b32 v71, v71, v41
    v_accvgpr_write_b32 a144, v68
    v_accvgpr_write_b32 a145, v69
    v_accvgpr_write_b32 a146, v70
    v_accvgpr_write_b32 a147, v71
    v_fract_f32 v48, v31
    v_add_f32 v49, v48, v33
    v_cos_f32 v56, v48
    v_add_f32 v50, v49, v35
    v_cos_f32 v57, v49
    v_add_f32 v51, v50, v33
    v_cos_f32 v58, v50
    v_add_f32 v52, v51, v35
    v_cos_f32 v59, v51
    v_add_f32 v53, v52, v33
    v_cos_f32 v60, v52
    v_add_f32 v54, v53, v35
    v_cos_f32 v61, v53
    v_add_f32 v55, v54, v33
    v_cos_f32 v62, v54
    v_cos_f32 v63, v55
    v_add_f32 v31, v48, v37
    v_cvt_pk_bf16_f32 v64, v56, v57
    v_cvt_pk_bf16_f32 v65, v58, v59
    v_cvt_pk_bf16_f32 v66, v60, v61
    v_cvt_pk_bf16_f32 v67, v62, v63
    v_accvgpr_write_b32 a20, v64
    v_accvgpr_write_b32 a21, v65
    v_accvgpr_write_b32 a22, v66
    v_accvgpr_write_b32 a23, v67
    v_alignbit_b32 v68, v64, v64, v40
    v_xor_b32 v68, v68, v41
    v_alignbit_b32 v69, v65, v65, v40
    v_xor_b32 v69, v69, v41
    v_alignbit_b32 v70, v66, v66, v40
    v_xor_b32 v70, v70, v41
    v_alignbit_b32 v71, v67, v67, v40
    v_xor_b32 v71, v71, v41
    v_accvgpr_write_b32 a148, v68
    v_accvgpr_write_b32 a149, v69
    v_accvgpr_write_b32 a150, v70
    v_accvgpr_write_b32 a151, v71
    v_fract_f32 v48, v30
    v_add_f32 v49, v48, v32
    v_cos_f32 v56, v48
    v_add_f32 v50, v49, v34
    v_cos_f32 v57, v49
    v_add_f32 v51, v50, v32
    v_cos_f32 v58, v50
    v_add_f32 v52, v51, v34
    v_cos_f32 v59, v51
    v_add_f32 v53, v52, v32
    v_cos_f32 v60, v52
    v_add_f32 v54, v53, v34
    v_cos_f32 v61, v53
    v_add_f32 v55, v54, v32
    v_cos_f32 v62, v54
    v_cos_f32 v63, v55
    v_add_f32 v30, v48, v36
    v_cvt_pk_bf16_f32 v64, v56, v57
    v_cvt_pk_bf16_f32 v65, v58, v59
    v_cvt_pk_bf16_f32 v66, v60, v61
    v_cvt_pk_bf16_f32 v67, v62, v63
    v_accvgpr_write_b32 a24, v64
    v_accvgpr_write_b32 a25, v65
    v_accvgpr_write_b32 a26, v66
    v_accvgpr_write_b32 a27, v67
    v_alignbit_b32 v68, v64, v64, v40
    v_xor_b32 v68, v68, v41
    v_alignbit_b32 v69, v65, v65, v40
    v_xor_b32 v69, v69, v41
    v_alignbit_b32 v70, v66, v66, v40
    v_xor_b32 v70, v70, v41
    v_alignbit_b32 v71, v67, v67, v40
    v_xor_b32 v71, v71, v41
    v_accvgpr_write_b32 a152, v68
    v_accvgpr_write_b32 a153, v69
    v_accvgpr_write_b32 a154, v70
    v_accvgpr_write_b32 a155, v71
    v_fract_f32 v48, v31
    v_add_f32 v49, v48, v33
    v_cos_f32 v56, v48
    v_add_f32 v50, v49, v35
    v_cos_f32 v57, v49
    v_add_f32 v51, v50, v33
    v_cos_f32 v58, v50
    v_add_f32 v52, v51, v35
    v_cos_f32 v59, v51
    v_add_f32 v53, v52, v33
    v_cos_f32 v60, v52
    v_add_f32 v54, v53, v35
    v_cos_f32 v61, v53
    v_add_f32 v55, v54, v33
    v_cos_f32 v62, v54
    v_cos_f32 v63, v55
    v_add_f32 v31, v48, v37
    v_cvt_pk_bf16_f32 v64, v56, v57
    v_cvt_pk_bf16_f32 v65, v58, v59
    v_cvt_pk_bf16_f32 v66, v60, v61
    v_cvt_pk_bf16_f32 v67, v62, v63
    v_accvgpr_write_b32 a28, v64
    v_accvgpr_write_b32 a29, v65
    v_accvgpr_write_b32 a30, v66
    v_accvgpr_write_b32 a31, v67
    v_alignbit_b32 v68, v64, v64, v40
    v_xor_b32 v68, v68, v41
    v_alignbit_b32 v69, v65, v65, v40
    v_xor_b32 v69, v69, v41
    v_alignbit_b32 v70, v66, v66, v40
    v_xor_b32 v70, v70, v41
    v_alignbit_b32 v71, v67, v67, v40
    v_xor_b32 v71, v71, v41
    v_accvgpr_write_b32 a156, v68
    v_accvgpr_write_b32 a157, v69
    v_accvgpr_write_b32 a158, v70
    v_accvgpr_write_b32 a159, v71
    v_fract_f32 v48, v30
    v_add_f32 v49, v48, v32
    v_cos_f32 v56, v48
    v_add_f32 v50, v49, v34
    v_cos_f32 v57, v49
    v_add_f32 v51, v50, v32
    v_cos_f32 v58, v50
    v_add_f32 v52, v51, v34
    v_cos_f32 v59, v51
    v_add_f32 v53, v52, v32
    v_cos_f32 v60, v52
    v_add_f32 v54, v53, v34
    v_cos_f32 v61, v53
    v_add_f32 v55, v54, v32
    v_cos_f32 v62, v54
    v_cos_f32 v63, v55
    v_add_f32 v30, v48, v36
    v_cvt_pk_bf16_f32 v64, v56, v57
    v_cvt_pk_bf16_f32 v65, v58, v59
    v_cvt_pk_bf16_f32 v66, v60, v61
    v_cvt_pk_bf16_f32 v67, v62, v63
    v_accvgpr_write_b32 a32, v64
    v_accvgpr_write_b32 a33, v65
    v_accvgpr_write_b32 a34, v66
    v_accvgpr_write_b32 a35, v67
    v_alignbit_b32 v68, v64, v64, v40
    v_xor_b32 v68, v68, v41
    v_alignbit_b32 v69, v65, v65, v40
    v_xor_b32 v69, v69, v41
    v_alignbit_b32 v70, v66, v66, v40
    v_xor_b32 v70, v70, v41
    v_alignbit_b32 v71, v67, v67, v40
    v_xor_b32 v71, v71, v41
    v_accvgpr_write_b32 a160, v68
    v_accvgpr_write_b32 a161, v69
    v_accvgpr_write_b32 a162, v70
    v_accvgpr_write_b32 a163, v71
    v_fract_f32 v48, v31
    v_add_f32 v49, v48, v33
    v_cos_f32 v56, v48
    v_add_f32 v50, v49, v35
    v_cos_f32 v57, v49
    v_add_f32 v51, v50, v33
    v_cos_f32 v58, v50
    v_add_f32 v52, v51, v35
    v_cos_f32 v59, v51
    v_add_f32 v53, v52, v33
    v_cos_f32 v60, v52
    v_add_f32 v54, v53, v35
    v_cos_f32 v61, v53
    v_add_f32 v55, v54, v33
    v_cos_f32 v62, v54
    v_cos_f32 v63, v55
    v_add_f32 v31, v48, v37
    v_cvt_pk_bf16_f32 v64, v56, v57
    v_cvt_pk_bf16_f32 v65, v58, v59
    v_cvt_pk_bf16_f32 v66, v60, v61
    v_cvt_pk_bf16_f32 v67, v62, v63
    v_accvgpr_write_b32 a36, v64
    v_accvgpr_write_b32 a37, v65
    v_accvgpr_write_b32 a38, v66
    v_accvgpr_write_b32 a39, v67
    v_alignbit_b32 v68, v64, v64, v40
    v_xor_b32 v68, v68, v41
    v_alignbit_b32 v69, v65, v65, v40
    v_xor_b32 v69, v69, v41
    v_alignbit_b32 v70, v66, v66, v40
    v_xor_b32 v70, v70, v41
    v_alignbit_b32 v71, v67, v67, v40
    v_xor_b32 v71, v71, v41
    v_accvgpr_write_b32 a164, v68
    v_accvgpr_write_b32 a165, v69
    v_accvgpr_write_b32 a166, v70
    v_accvgpr_write_b32 a167, v71
    v_fract_f32 v48, v30
    v_add_f32 v49, v48, v32
    v_cos_f32 v56, v48
    v_add_f32 v50, v49, v34
    v_cos_f32 v57, v49
    v_add_f32 v51, v50, v32
    v_cos_f32 v58, v50
    v_add_f32 v52, v51, v34
    v_cos_f32 v59, v51
    v_add_f32 v53, v52, v32
    v_cos_f32 v60, v52
    v_add_f32 v54, v53, v34
    v_cos_f32 v61, v53
    v_add_f32 v55, v54, v32
    v_cos_f32 v62, v54
    v_cos_f32 v63, v55
    v_add_f32 v30, v48, v36
    v_cvt_pk_bf16_f32 v64, v56, v57
    v_cvt_pk_bf16_f32 v65, v58, v59
    v_cvt_pk_bf16_f32 v66, v60, v61
    v_cvt_pk_bf16_f32 v67, v62, v63
    v_accvgpr_write_b32 a40, v64
    v_accvgpr_write_b32 a41, v65
    v_accvgpr_write_b32 a42, v66
    v_accvgpr_write_b32 a43, v67
    v_alignbit_b32 v68, v64, v64, v40
    v_xor_b32 v68, v68, v41
    v_alignbit_b32 v69, v65, v65, v40
    v_xor_b32 v69, v69, v41
    v_alignbit_b32 v70, v66, v66, v40
    v_xor_b32 v70, v70, v41
    v_alignbit_b32 v71, v67, v67, v40
    v_xor_b32 v71, v71, v41
    v_accvgpr_write_b32 a168, v68
    v_accvgpr_write_b32 a169, v69
    v_accvgpr_write_b32 a170, v70
    v_accvgpr_write_b32 a171, v71
    v_fract_f32 v48, v31
    v_add_f32 v49, v48, v33
    v_cos_f32 v56, v48
    v_add_f32 v50, v49, v35
    v_cos_f32 v57, v49
    v_add_f32 v51, v50, v33
    v_cos_f32 v58, v50
    v_add_f32 v52, v51, v35
    v_cos_f32 v59, v51
    v_add_f32 v53, v52, v33
    v_cos_f32 v60, v52
    v_add_f32 v54, v53, v35
    v_cos_f32 v61, v53
    v_add_f32 v55, v54, v33
    v_cos_f32 v62, v54
    v_cos_f32 v63, v55
    v_add_f32 v31, v48, v37
    v_cvt_pk_bf16_f32 v64, v56, v57
    v_cvt_pk_bf16_f32 v65, v58, v59
    v_cvt_pk_bf16_f32 v66, v60, v61
    v_cvt_pk_bf16_f32 v67, v62, v63
    v_accvgpr_write_b32 a44, v64
    v_accvgpr_write_b32 a45, v65
    v_accvgpr_write_b32 a46, v66
    v_accvgpr_write_b32 a47, v67
    v_alignbit_b32 v68, v64, v64, v40
    v_xor_b32 v68, v68, v41
    v_alignbit_b32 v69, v65, v65, v40
    v_xor_b32 v69, v69, v41
    v_alignbit_b32 v70, v66, v66, v40
    v_xor_b32 v70, v70, v41
    v_alignbit_b32 v71, v67, v67, v40
    v_xor_b32 v71, v71, v41
    v_accvgpr_write_b32 a172, v68
    v_accvgpr_write_b32 a173, v69
    v_accvgpr_write_b32 a174, v70
    v_accvgpr_write_b32 a175, v71
    v_fract_f32 v48, v30
    v_add_f32 v49, v48, v32
    v_cos_f32 v56, v48
    v_add_f32 v50, v49, v34
    v_cos_f32 v57, v49
    v_add_f32 v51, v50, v32
    v_cos_f32 v58, v50
    v_add_f32 v52, v51, v34
    v_cos_f32 v59, v51
    v_add_f32 v53, v52, v32
    v_cos_f32 v60, v52
    v_add_f32 v54, v53, v34
    v_cos_f32 v61, v53
    v_add_f32 v55, v54, v32
    v_cos_f32 v62, v54
    v_cos_f32 v63, v55
    v_add_f32 v30, v48, v36
    v_cvt_pk_bf16_f32 v64, v56, v57
    v_cvt_pk_bf16_f32 v65, v58, v59
    v_cvt_pk_bf16_f32 v66, v60, v61
    v_cvt_pk_bf16_f32 v67, v62, v63
    v_accvgpr_write_b32 a48, v64
    v_accvgpr_write_b32 a49, v65
    v_accvgpr_write_b32 a50, v66
    v_accvgpr_write_b32 a51, v67
    v_alignbit_b32 v68, v64, v64, v40
    v_xor_b32 v68, v68, v41
    v_alignbit_b32 v69, v65, v65, v40
    v_xor_b32 v69, v69, v41
    v_alignbit_b32 v70, v66, v66, v40
    v_xor_b32 v70, v70, v41
    v_alignbit_b32 v71, v67, v67, v40
    v_xor_b32 v71, v71, v41
    v_accvgpr_write_b32 a176, v68
    v_accvgpr_write_b32 a177, v69
    v_accvgpr_write_b32 a178, v70
    v_accvgpr_write_b32 a179, v71
    v_fract_f32 v48, v31
    v_add_f32 v49, v48, v33
    v_cos_f32 v56, v48
    v_add_f32 v50, v49, v35
    v_cos_f32 v57, v49
    v_add_f32 v51, v50, v33
    v_cos_f32 v58, v50
    v_add_f32 v52, v51, v35
    v_cos_f32 v59, v51
    v_add_f32 v53, v52, v33
    v_cos_f32 v60, v52
    v_add_f32 v54, v53, v35
    v_cos_f32 v61, v53
    v_add_f32 v55, v54, v33
    v_cos_f32 v62, v54
    v_cos_f32 v63, v55
    v_add_f32 v31, v48, v37
    v_cvt_pk_bf16_f32 v64, v56, v57
    v_cvt_pk_bf16_f32 v65, v58, v59
    v_cvt_pk_bf16_f32 v66, v60, v61
    v_cvt_pk_bf16_f32 v67, v62, v63
    v_accvgpr_write_b32 a52, v64
    v_accvgpr_write_b32 a53, v65
    v_accvgpr_write_b32 a54, v66
    v_accvgpr_write_b32 a55, v67
    v_alignbit_b32 v68, v64, v64, v40
    v_xor_b32 v68, v68, v41
    v_alignbit_b32 v69, v65, v65, v40
    v_xor_b32 v69, v69, v41
    v_alignbit_b32 v70, v66, v66, v40
    v_xor_b32 v70, v70, v41
    v_alignbit_b32 v71, v67, v67, v40
    v_xor_b32 v71, v71, v41
    v_accvgpr_write_b32 a180, v68
    v_accvgpr_write_b32 a181, v69
    v_accvgpr_write_b32 a182, v70
    v_accvgpr_write_b32 a183, v71
    v_fract_f32 v48, v30
    v_add_f32 v49, v48, v32
    v_cos_f32 v56, v48
    v_add_f32 v50, v49, v34
    v_cos_f32 v57, v49
    v_add_f32 v51, v50, v32
    v_cos_f32 v58, v50
    v_add_f32 v52, v51, v34
    v_cos_f32 v59, v51
    v_add_f32 v53, v52, v32
    v_cos_f32 v60, v52
    v_add_f32 v54, v53, v34
    v_cos_f32 v61, v53
    v_add_f32 v55, v54, v32
    v_cos_f32 v62, v54
    v_cos_f32 v63, v55
    v_add_f32 v30, v48, v36
    v_cvt_pk_bf16_f32 v64, v56, v57
    v_cvt_pk_bf16_f32 v65, v58, v59
    v_cvt_pk_bf16_f32 v66, v60, v61
    v_cvt_pk_bf16_f32 v67, v62, v63
    v_accvgpr_write_b32 a56, v64
    v_accvgpr_write_b32 a57, v65
    v_accvgpr_write_b32 a58, v66
    v_accvgpr_write_b32 a59, v67
    v_alignbit_b32 v68, v64, v64, v40
    v_xor_b32 v68, v68, v41
    v_alignbit_b32 v69, v65, v65, v40
    v_xor_b32 v69, v69, v41
    v_alignbit_b32 v70, v66, v66, v40
    v_xor_b32 v70, v70, v41
    v_alignbit_b32 v71, v67, v67, v40
    v_xor_b32 v71, v71, v41
    v_accvgpr_write_b32 a184, v68
    v_accvgpr_write_b32 a185, v69
    v_accvgpr_write_b32 a186, v70
    v_accvgpr_write_b32 a187, v71
    v_fract_f32 v48, v31
    v_add_f32 v49, v48, v33
    v_cos_f32 v56, v48
    v_add_f32 v50, v49, v35
    v_cos_f32 v57, v49
    v_add_f32 v51, v50, v33
    v_cos_f32 v58, v50
    v_add_f32 v52, v51, v35
    v_cos_f32 v59, v51
    v_add_f32 v53, v52, v33
    v_cos_f32 v60, v52
    v_add_f32 v54, v53, v35
    v_cos_f32 v61, v53
    v_add_f32 v55, v54, v33
    v_cos_f32 v62, v54
    v_cos_f32 v63, v55
    v_add_f32 v31, v48, v37
    v_cvt_pk_bf16_f32 v64, v56, v57
    v_cvt_pk_bf16_f32 v65, v58, v59
    v_cvt_pk_bf16_f32 v66, v60, v61
    v_cvt_pk_bf16_f32 v67, v62, v63
    v_accvgpr_write_b32 a60, v64
    v_accvgpr_write_b32 a61, v65
    v_accvgpr_write_b32 a62, v66
    v_accvgpr_write_b32 a63, v67
    v_alignbit_b32 v68, v64, v64, v40
    v_xor_b32 v68, v68, v41
    v_alignbit_b32 v69, v65, v65, v40
    v_xor_b32 v69, v69, v41
    v_alignbit_b32 v70, v66, v66, v40
    v_xor_b32 v70, v70, v41
    v_alignbit_b32 v71, v67, v67, v40
    v_xor_b32 v71, v71, v41
    v_accvgpr_write_b32 a188, v68
    v_accvgpr_write_b32 a189, v69
    v_accvgpr_write_b32 a190, v70
    v_accvgpr_write_b32 a191, v71
    v_fract_f32 v48, v30
    v_add_f32 v49, v48, v32
    v_cos_f32 v56, v48
    v_add_f32 v50, v49, v34
    v_cos_f32 v57, v49
    v_add_f32 v51, v50, v32
    v_cos_f32 v58, v50
    v_add_f32 v52, v51, v34
    v_cos_f32 v59, v51
    v_add_f32 v53, v52, v32
    v_cos_f32 v60, v52
    v_add_f32 v54, v53, v34
    v_cos_f32 v61, v53
    v_add_f32 v55, v54, v32
    v_cos_f32 v62, v54
    v_cos_f32 v63, v55
    v_add_f32 v30, v48, v36
    v_cvt_pk_bf16_f32 v64, v56, v57
    v_cvt_pk_bf16_f32 v65, v58, v59
    v_cvt_pk_bf16_f32 v66, v60, v61
    v_cvt_pk_bf16_f32 v67, v62, v63
    v_accvgpr_write_b32 a64, v64
    v_accvgpr_write_b32 a65, v65
    v_accvgpr_write_b32 a66, v66
    v_accvgpr_write_b32 a67, v67
    v_alignbit_b32 v68, v64, v64, v40
    v_xor_b32 v68, v68, v41
    v_alignbit_b32 v69, v65, v65, v40
    v_xor_b32 v69, v69, v41
    v_alignbit_b32 v70, v66, v66, v40
    v_xor_b32 v70, v70, v41
    v_alignbit_b32 v71, v67, v67, v40
    v_xor_b32 v71, v71, v41
    v_accvgpr_write_b32 a192, v68
    v_accvgpr_write_b32 a193, v69
    v_accvgpr_write_b32 a194, v70
    v_accvgpr_write_b32 a195, v71
    v_fract_f32 v48, v31
    v_add_f32 v49, v48, v33
    v_cos_f32 v56, v48
    v_add_f32 v50, v49, v35
    v_cos_f32 v57, v49
    v_add_f32 v51, v50, v33
    v_cos_f32 v58, v50
    v_add_f32 v52, v51, v35
    v_cos_f32 v59, v51
    v_add_f32 v53, v52, v33
    v_cos_f32 v60, v52
    v_add_f32 v54, v53, v35
    v_cos_f32 v61, v53
    v_add_f32 v55, v54, v33
    v_cos_f32 v62, v54
    v_cos_f32 v63, v55
    v_add_f32 v31, v48, v37
    v_cvt_pk_bf16_f32 v64, v56, v57
    v_cvt_pk_bf16_f32 v65, v58, v59
    v_cvt_pk_bf16_f32 v66, v60, v61
    v_cvt_pk_bf16_f32 v67, v62, v63
    v_accvgpr_write_b32 a68, v64
    v_accvgpr_write_b32 a69, v65
    v_accvgpr_write_b32 a70, v66
    v_accvgpr_write_b32 a71, v67
    v_alignbit_b32 v68, v64, v64, v40
    v_xor_b32 v68, v68, v41
    v_alignbit_b32 v69, v65, v65, v40
    v_xor_b32 v69, v69, v41
    v_alignbit_b32 v70, v66, v66, v40
    v_xor_b32 v70, v70, v41
    v_alignbit_b32 v71, v67, v67, v40
    v_xor_b32 v71, v71, v41
    v_accvgpr_write_b32 a196, v68
    v_accvgpr_write_b32 a197, v69
    v_accvgpr_write_b32 a198, v70
    v_accvgpr_write_b32 a199, v71
    v_fract_f32 v48, v30
    v_add_f32 v49, v48, v32
    v_cos_f32 v56, v48
    v_add_f32 v50, v49, v34
    v_cos_f32 v57, v49
    v_add_f32 v51, v50, v32
    v_cos_f32 v58, v50
    v_add_f32 v52, v51, v34
    v_cos_f32 v59, v51
    v_add_f32 v53, v52, v32
    v_cos_f32 v60, v52
    v_add_f32 v54, v53, v34
    v_cos_f32 v61, v53
    v_add_f32 v55, v54, v32
    v_cos_f32 v62, v54
    v_cos_f32 v63, v55
    v_add_f32 v30, v48, v36
    v_cvt_pk_bf16_f32 v64, v56, v57
    v_cvt_pk_bf16_f32 v65, v58, v59
    v_cvt_pk_bf16_f32 v66, v60, v61
    v_cvt_pk_bf16_f32 v67, v62, v63
    v_accvgpr_write_b32 a72, v64
    v_accvgpr_write_b32 a73, v65
    v_accvgpr_write_b32 a74, v66
    v_accvgpr_write_b32 a75, v67
    v_alignbit_b32 v68, v64, v64, v40
    v_xor_b32 v68, v68, v41
    v_alignbit_b32 v69, v65, v65, v40
    v_xor_b32 v69, v69, v41
    v_alignbit_b32 v70, v66, v66, v40
    v_xor_b32 v70, v70, v41
    v_alignbit_b32 v71, v67, v67, v40
    v_xor_b32 v71, v71, v41
    v_accvgpr_write_b32 a200, v68
    v_accvgpr_write_b32 a201, v69
    v_accvgpr_write_b32 a202, v70
    v_accvgpr_write_b32 a203, v71
    v_fract_f32 v48, v31
    v_add_f32 v49, v48, v33
    v_cos_f32 v56, v48
    v_add_f32 v50, v49, v35
    v_cos_f32 v57, v49
    v_add_f32 v51, v50, v33
    v_cos_f32 v58, v50
    v_add_f32 v52, v51, v35
    v_cos_f32 v59, v51
    v_add_f32 v53, v52, v33
    v_cos_f32 v60, v52
    v_add_f32 v54, v53, v35
    v_cos_f32 v61, v53
    v_add_f32 v55, v54, v33
    v_cos_f32 v62, v54
    v_cos_f32 v63, v55
    v_add_f32 v31, v48, v37
    v_cvt_pk_bf16_f32 v64, v56, v57
    v_cvt_pk_bf16_f32 v65, v58, v59
    v_cvt_pk_bf16_f32 v66, v60, v61
    v_cvt_pk_bf16_f32 v67, v62, v63
    v_accvgpr_write_b32 a76, v64
    v_accvgpr_write_b32 a77, v65
    v_accvgpr_write_b32 a78, v66
    v_accvgpr_write_b32 a79, v67
    v_alignbit_b32 v68, v64, v64, v40
    v_xor_b32 v68, v68, v41
    v_alignbit_b32 v69, v65, v65, v40
    v_xor_b32 v69, v69, v41
    v_alignbit_b32 v70, v66, v66, v40
    v_xor_b32 v70, v70, v41
    v_alignbit_b32 v71, v67, v67, v40
    v_xor_b32 v71, v71, v41
    v_accvgpr_write_b32 a204, v68
    v_accvgpr_write_b32 a205, v69
    v_accvgpr_write_b32 a206, v70
    v_accvgpr_write_b32 a207, v71
    v_fract_f32 v48, v30
    v_add_f32 v49, v48, v32
    v_cos_f32 v56, v48
    v_add_f32 v50, v49, v34
    v_cos_f32 v57, v49
    v_add_f32 v51, v50, v32
    v_cos_f32 v58, v50
    v_add_f32 v52, v51, v34
    v_cos_f32 v59, v51
    v_add_f32 v53, v52, v32
    v_cos_f32 v60, v52
    v_add_f32 v54, v53, v34
    v_cos_f32 v61, v53
    v_add_f32 v55, v54, v32
    v_cos_f32 v62, v54
    v_cos_f32 v63, v55
    v_add_f32 v30, v48, v36
    v_cvt_pk_bf16_f32 v64, v56, v57
    v_cvt_pk_bf16_f32 v65, v58, v59
    v_cvt_pk_bf16_f32 v66, v60, v61
    v_cvt_pk_bf16_f32 v67, v62, v63
    v_accvgpr_write_b32 a80, v64
    v_accvgpr_write_b32 a81, v65
    v_accvgpr_write_b32 a82, v66
    v_accvgpr_write_b32 a83, v67
    v_alignbit_b32 v68, v64, v64, v40
    v_xor_b32 v68, v68, v41
    v_alignbit_b32 v69, v65, v65, v40
    v_xor_b32 v69, v69, v41
    v_alignbit_b32 v70, v66, v66, v40
    v_xor_b32 v70, v70, v41
    v_alignbit_b32 v71, v67, v67, v40
    v_xor_b32 v71, v71, v41
    v_accvgpr_write_b32 a208, v68
    v_accvgpr_write_b32 a209, v69
    v_accvgpr_write_b32 a210, v70
    v_accvgpr_write_b32 a211, v71
    v_fract_f32 v48, v31
    v_add_f32 v49, v48, v33
    v_cos_f32 v56, v48
    v_add_f32 v50, v49, v35
    v_cos_f32 v57, v49
    v_add_f32 v51, v50, v33
    v_cos_f32 v58, v50
    v_add_f32 v52, v51, v35
    v_cos_f32 v59, v51
    v_add_f32 v53, v52, v33
    v_cos_f32 v60, v52
    v_add_f32 v54, v53, v35
    v_cos_f32 v61, v53
    v_add_f32 v55, v54, v33
    v_cos_f32 v62, v54
    v_cos_f32 v63, v55
    v_add_f32 v31, v48, v37
    v_cvt_pk_bf16_f32 v64, v56, v57
    v_cvt_pk_bf16_f32 v65, v58, v59
    v_cvt_pk_bf16_f32 v66, v60, v61
    v_cvt_pk_bf16_f32 v67, v62, v63
    v_accvgpr_write_b32 a84, v64
    v_accvgpr_write_b32 a85, v65
    v_accvgpr_write_b32 a86, v66
    v_accvgpr_write_b32 a87, v67
    v_alignbit_b32 v68, v64, v64, v40
    v_xor_b32 v68, v68, v41
    v_alignbit_b32 v69, v65, v65, v40
    v_xor_b32 v69, v69, v41
    v_alignbit_b32 v70, v66, v66, v40
    v_xor_b32 v70, v70, v41
    v_alignbit_b32 v71, v67, v67, v40
    v_xor_b32 v71, v71, v41
    v_accvgpr_write_b32 a212, v68
    v_accvgpr_write_b32 a213, v69
    v_accvgpr_write_b32 a214, v70
    v_accvgpr_write_b32 a215, v71
    v_fract_f32 v48, v30
    v_add_f32 v49, v48, v32
    v_cos_f32 v56, v48
    v_add_f32 v50, v49, v34
    v_cos_f32 v57, v49
    v_add_f32 v51, v50, v32
    v_cos_f32 v58, v50
    v_add_f32 v52, v51, v34
    v_cos_f32 v59, v51
    v_add_f32 v53, v52, v32
    v_cos_f32 v60, v52
    v_add_f32 v54, v53, v34
    v_cos_f32 v61, v53
    v_add_f32 v55, v54, v32
    v_cos_f32 v62, v54
    v_cos_f32 v63, v55
    v_add_f32 v30, v48, v36
    v_cvt_pk_bf16_f32 v64, v56, v57
    v_cvt_pk_bf16_f32 v65, v58, v59
    v_cvt_pk_bf16_f32 v66, v60, v61
    v_cvt_pk_bf16_f32 v67, v62, v63
    v_accvgpr_write_b32 a88, v64
    v_accvgpr_write_b32 a89, v65
    v_accvgpr_write_b32 a90, v66
    v_accvgpr_write_b32 a91, v67
    v_alignbit_b32 v68, v64, v64, v40
    v_xor_b32 v68, v68, v41
    v_alignbit_b32 v69, v65, v65, v40
    v_xor_b32 v69, v69, v41
    v_alignbit_b32 v70, v66, v66, v40
    v_xor_b32 v70, v70, v41
    v_alignbit_b32 v71, v67, v67, v40
    v_xor_b32 v71, v71, v41
    v_accvgpr_write_b32 a216, v68
    v_accvgpr_write_b32 a217, v69
    v_accvgpr_write_b32 a218, v70
    v_accvgpr_write_b32 a219, v71
    v_fract_f32 v48, v31
    v_add_f32 v49, v48, v33
    v_cos_f32 v56, v48
    v_add_f32 v50, v49, v35
    v_cos_f32 v57, v49
    v_add_f32 v51, v50, v33
    v_cos_f32 v58, v50
    v_add_f32 v52, v51, v35
    v_cos_f32 v59, v51
    v_add_f32 v53, v52, v33
    v_cos_f32 v60, v52
    v_add_f32 v54, v53, v35
    v_cos_f32 v61, v53
    v_add_f32 v55, v54, v33
    v_cos_f32 v62, v54
    v_cos_f32 v63, v55
    v_add_f32 v31, v48, v37
    v_cvt_pk_bf16_f32 v64, v56, v57
    v_cvt_pk_bf16_f32 v65, v58, v59
    v_cvt_pk_bf16_f32 v66, v60, v61
    v_cvt_pk_bf16_f32 v67, v62, v63
    v_accvgpr_write_b32 a92, v64
    v_accvgpr_write_b32 a93, v65
    v_accvgpr_write_b32 a94, v66
    v_accvgpr_write_b32 a95, v67
    v_alignbit_b32 v68, v64, v64, v40
    v_xor_b32 v68, v68, v41
    v_alignbit_b32 v69, v65, v65, v40
    v_xor_b32 v69, v69, v41
    v_alignbit_b32 v70, v66, v66, v40
    v_xor_b32 v70, v70, v41
    v_alignbit_b32 v71, v67, v67, v40
    v_xor_b32 v71, v71, v41
    v_accvgpr_write_b32 a220, v68
    v_accvgpr_write_b32 a221, v69
    v_accvgpr_write_b32 a222, v70
    v_accvgpr_write_b32 a223, v71
    v_fract_f32 v48, v30
    v_add_f32 v49, v48, v32
    v_cos_f32 v56, v48
    v_add_f32 v50, v49, v34
    v_cos_f32 v57, v49
    v_add_f32 v51, v50, v32
    v_cos_f32 v58, v50
    v_add_f32 v52, v51, v34
    v_cos_f32 v59, v51
    v_add_f32 v53, v52, v32
    v_cos_f32 v60, v52
    v_add_f32 v54, v53, v34
    v_cos_f32 v61, v53
    v_add_f32 v55, v54, v32
    v_cos_f32 v62, v54
    v_cos_f32 v63, v55
    v_add_f32 v30, v48, v36
    v_cvt_pk_bf16_f32 v64, v56, v57
    v_cvt_pk_bf16_f32 v65, v58, v59
    v_cvt_pk_bf16_f32 v66, v60, v61
    v_cvt_pk_bf16_f32 v67, v62, v63
    v_accvgpr_write_b32 a96, v64
    v_accvgpr_write_b32 a97, v65
    v_accvgpr_write_b32 a98, v66
    v_accvgpr_write_b32 a99, v67
    v_alignbit_b32 v68, v64, v64, v40
    v_xor_b32 v68, v68, v41
    v_alignbit_b32 v69, v65, v65, v40
    v_xor_b32 v69, v69, v41
    v_alignbit_b32 v70, v66, v66, v40
    v_xor_b32 v70, v70, v41
    v_alignbit_b32 v71, v67, v67, v40
    v_xor_b32 v71, v71, v41
    v_accvgpr_write_b32 a224, v68
    v_accvgpr_write_b32 a225, v69
    v_accvgpr_write_b32 a226, v70
    v_accvgpr_write_b32 a227, v71
    v_fract_f32 v48, v31
    v_add_f32 v49, v48, v33
    v_cos_f32 v56, v48
    v_add_f32 v50, v49, v35
    v_cos_f32 v57, v49
    v_add_f32 v51, v50, v33
    v_cos_f32 v58, v50
    v_add_f32 v52, v51, v35
    v_cos_f32 v59, v51
    v_add_f32 v53, v52, v33
    v_cos_f32 v60, v52
    v_add_f32 v54, v53, v35
    v_cos_f32 v61, v53
    v_add_f32 v55, v54, v33
    v_cos_f32 v62, v54
    v_cos_f32 v63, v55
    v_add_f32 v31, v48, v37
    v_cvt_pk_bf16_f32 v64, v56, v57
    v_cvt_pk_bf16_f32 v65, v58, v59
    v_cvt_pk_bf16_f32 v66, v60, v61
    v_cvt_pk_bf16_f32 v67, v62, v63
    v_accvgpr_write_b32 a100, v64
    v_accvgpr_write_b32 a101, v65
    v_accvgpr_write_b32 a102, v66
    v_accvgpr_write_b32 a103, v67
    v_alignbit_b32 v68, v64, v64, v40
    v_xor_b32 v68, v68, v41
    v_alignbit_b32 v69, v65, v65, v40
    v_xor_b32 v69, v69, v41
    v_alignbit_b32 v70, v66, v66, v40
    v_xor_b32 v70, v70, v41
    v_alignbit_b32 v71, v67, v67, v40
    v_xor_b32 v71, v71, v41
    v_accvgpr_write_b32 a228, v68
    v_accvgpr_write_b32 a229, v69
    v_accvgpr_write_b32 a230, v70
    v_accvgpr_write_b32 a231, v71
    v_fract_f32 v48, v30
    v_add_f32 v49, v48, v32
    v_cos_f32 v56, v48
    v_add_f32 v50, v49, v34
    v_cos_f32 v57, v49
    v_add_f32 v51, v50, v32
    v_cos_f32 v58, v50
    v_add_f32 v52, v51, v34
    v_cos_f32 v59, v51
    v_add_f32 v53, v52, v32
    v_cos_f32 v60, v52
    v_add_f32 v54, v53, v34
    v_cos_f32 v61, v53
    v_add_f32 v55, v54, v32
    v_cos_f32 v62, v54
    v_cos_f32 v63, v55
    v_add_f32 v30, v48, v36
    v_cvt_pk_bf16_f32 v64, v56, v57
    v_cvt_pk_bf16_f32 v65, v58, v59
    v_cvt_pk_bf16_f32 v66, v60, v61
    v_cvt_pk_bf16_f32 v67, v62, v63
    v_accvgpr_write_b32 a104, v64
    v_accvgpr_write_b32 a105, v65
    v_accvgpr_write_b32 a106, v66
    v_accvgpr_write_b32 a107, v67
    v_alignbit_b32 v68, v64, v64, v40
    v_xor_b32 v68, v68, v41
    v_alignbit_b32 v69, v65, v65, v40
    v_xor_b32 v69, v69, v41
    v_alignbit_b32 v70, v66, v66, v40
    v_xor_b32 v70, v70, v41
    v_alignbit_b32 v71, v67, v67, v40
    v_xor_b32 v71, v71, v41
    v_accvgpr_write_b32 a232, v68
    v_accvgpr_write_b32 a233, v69
    v_accvgpr_write_b32 a234, v70
    v_accvgpr_write_b32 a235, v71
    v_fract_f32 v48, v31
    v_add_f32 v49, v48, v33
    v_cos_f32 v56, v48
    v_add_f32 v50, v49, v35
    v_cos_f32 v57, v49
    v_add_f32 v51, v50, v33
    v_cos_f32 v58, v50
    v_add_f32 v52, v51, v35
    v_cos_f32 v59, v51
    v_add_f32 v53, v52, v33
    v_cos_f32 v60, v52
    v_add_f32 v54, v53, v35
    v_cos_f32 v61, v53
    v_add_f32 v55, v54, v33
    v_cos_f32 v62, v54
    v_cos_f32 v63, v55
    v_add_f32 v31, v48, v37
    v_cvt_pk_bf16_f32 v64, v56, v57
    v_cvt_pk_bf16_f32 v65, v58, v59
    v_cvt_pk_bf16_f32 v66, v60, v61
    v_cvt_pk_bf16_f32 v67, v62, v63
    v_accvgpr_write_b32 a108, v64
    v_accvgpr_write_b32 a109, v65
    v_accvgpr_write_b32 a110, v66
    v_accvgpr_write_b32 a111, v67
    v_alignbit_b32 v68, v64, v64, v40
    v_xor_b32 v68, v68, v41
    v_alignbit_b32 v69, v65, v65, v40
    v_xor_b32 v69, v69, v41
    v_alignbit_b32 v70, v66, v66, v40
    v_xor_b32 v70, v70, v41
    v_alignbit_b32 v71, v67, v67, v40
    v_xor_b32 v71, v71, v41
    v_accvgpr_write_b32 a236, v68
    v_accvgpr_write_b32 a237, v69
    v_accvgpr_write_b32 a238, v70
    v_accvgpr_write_b32 a239, v71
    v_fract_f32 v48, v30
    v_add_f32 v49, v48, v32
    v_cos_f32 v56, v48
    v_add_f32 v50, v49, v34
    v_cos_f32 v57, v49
    v_add_f32 v51, v50, v32
    v_cos_f32 v58, v50
    v_add_f32 v52, v51, v34
    v_cos_f32 v59, v51
    v_add_f32 v53, v52, v32
    v_cos_f32 v60, v52
    v_add_f32 v54, v53, v34
    v_cos_f32 v61, v53
    v_add_f32 v55, v54, v32
    v_cos_f32 v62, v54
    v_cos_f32 v63, v55
    v_add_f32 v30, v48, v36
    v_cvt_pk_bf16_f32 v64, v56, v57
    v_cvt_pk_bf16_f32 v65, v58, v59
    v_cvt_pk_bf16_f32 v66, v60, v61
    v_cvt_pk_bf16_f32 v67, v62, v63
    v_accvgpr_write_b32 a112, v64
    v_accvgpr_write_b32 a113, v65
    v_accvgpr_write_b32 a114, v66
    v_accvgpr_write_b32 a115, v67
    v_alignbit_b32 v68, v64, v64, v40
    v_xor_b32 v68, v68, v41
    v_alignbit_b32 v69, v65, v65, v40
    v_xor_b32 v69, v69, v41
    v_alignbit_b32 v70, v66, v66, v40
    v_xor_b32 v70, v70, v41
    v_alignbit_b32 v71, v67, v67, v40
    v_xor_b32 v71, v71, v41
    v_accvgpr_write_b32 a240, v68
    v_accvgpr_write_b32 a241, v69
    v_accvgpr_write_b32 a242, v70
    v_accvgpr_write_b32 a243, v71
    v_fract_f32 v48, v31
    v_add_f32 v49, v48, v33
    v_cos_f32 v56, v48
    v_add_f32 v50, v49, v35
    v_cos_f32 v57, v49
    v_add_f32 v51, v50, v33
    v_cos_f32 v58, v50
    v_add_f32 v52, v51, v35
    v_cos_f32 v59, v51
    v_add_f32 v53, v52, v33
    v_cos_f32 v60, v52
    v_add_f32 v54, v53, v35
    v_cos_f32 v61, v53
    v_add_f32 v55, v54, v33
    v_cos_f32 v62, v54
    v_cos_f32 v63, v55
    v_add_f32 v31, v48, v37
    v_cvt_pk_bf16_f32 v64, v56, v57
    v_cvt_pk_bf16_f32 v65, v58, v59
    v_cvt_pk_bf16_f32 v66, v60, v61
    v_cvt_pk_bf16_f32 v67, v62, v63
    v_accvgpr_write_b32 a116, v64
    v_accvgpr_write_b32 a117, v65
    v_accvgpr_write_b32 a118, v66
    v_accvgpr_write_b32 a119, v67
    v_alignbit_b32 v68, v64, v64, v40
    v_xor_b32 v68, v68, v41
    v_alignbit_b32 v69, v65, v65, v40
    v_xor_b32 v69, v69, v41
    v_alignbit_b32 v70, v66, v66, v40
    v_xor_b32 v70, v70, v41
    v_alignbit_b32 v71, v67, v67, v40
    v_xor_b32 v71, v71, v41
    v_accvgpr_write_b32 a244, v68
    v_accvgpr_write_b32 a245, v69
    v_accvgpr_write_b32 a246, v70
    v_accvgpr_write_b32 a247, v71
    v_fract_f32 v48, v30
    v_add_f32 v49, v48, v32
    v_cos_f32 v56, v48
    v_add_f32 v50, v49, v34
    v_cos_f32 v57, v49
    v_add_f32 v51, v50, v32
    v_cos_f32 v58, v50
    v_add_f32 v52, v51, v34
    v_cos_f32 v59, v51
    v_add_f32 v53, v52, v32
    v_cos_f32 v60, v52
    v_add_f32 v54, v53, v34
    v_cos_f32 v61, v53
    v_add_f32 v55, v54, v32
    v_cos_f32 v62, v54
    v_cos_f32 v63, v55
    v_add_f32 v30, v48, v36
    v_cvt_pk_bf16_f32 v64, v56, v57
    v_cvt_pk_bf16_f32 v65, v58, v59
    v_cvt_pk_bf16_f32 v66, v60, v61
    v_cvt_pk_bf16_f32 v67, v62, v63
    v_accvgpr_write_b32 a120, v64
    v_accvgpr_write_b32 a121, v65
    v_accvgpr_write_b32 a122, v66
    v_accvgpr_write_b32 a123, v67
    v_alignbit_b32 v68, v64, v64, v40
    v_xor_b32 v68, v68, v41
    v_alignbit_b32 v69, v65, v65, v40
    v_xor_b32 v69, v69, v41
    v_alignbit_b32 v70, v66, v66, v40
    v_xor_b32 v70, v70, v41
    v_alignbit_b32 v71, v67, v67, v40
    v_xor_b32 v71, v71, v41
    v_accvgpr_write_b32 a248, v68
    v_accvgpr_write_b32 a249, v69
    v_accvgpr_write_b32 a250, v70
    v_accvgpr_write_b32 a251, v71
    v_fract_f32 v48, v31
    v_add_f32 v49, v48, v33
    v_cos_f32 v56, v48
    v_add_f32 v50, v49, v35
    v_cos_f32 v57, v49
    v_add_f32 v51, v50, v33
    v_cos_f32 v58, v50
    v_add_f32 v52, v51, v35
    v_cos_f32 v59, v51
    v_add_f32 v53, v52, v33
    v_cos_f32 v60, v52
    v_add_f32 v54, v53, v35
    v_cos_f32 v61, v53
    v_add_f32 v55, v54, v33
    v_cos_f32 v62, v54
    v_cos_f32 v63, v55
    v_add_f32 v31, v48, v37
    v_cvt_pk_bf16_f32 v64, v56, v57
    v_cvt_pk_bf16_f32 v65, v58, v59
    v_cvt_pk_bf16_f32 v66, v60, v61
    v_cvt_pk_bf16_f32 v67, v62, v63
    v_accvgpr_write_b32 a124, v64
    v_accvgpr_write_b32 a125, v65
    v_accvgpr_write_b32 a126, v66
    v_accvgpr_write_b32 a127, v67
    v_alignbit_b32 v68, v64, v64, v40
    v_xor_b32 v68, v68, v41
    v_alignbit_b32 v69, v65, v65, v40
    v_xor_b32 v69, v69, v41
    v_alignbit_b32 v70, v66, v66, v40
    v_xor_b32 v70, v70, v41
    v_alignbit_b32 v71, v67, v67, v40
    v_xor_b32 v71, v71, v41
    v_accvgpr_write_b32 a252, v68
    v_accvgpr_write_b32 a253, v69
    v_accvgpr_write_b32 a254, v70
    v_accvgpr_write_b32 a255, v71
    v_lshlrev_b32 v6, 31, v38
    v_or_b32 v6, 0x3f003f00, v6
    v_cmp_gt_u32 vcc, 16, v1
    v_accvgpr_read_b32 v5, a0
    s_nop 0
    v_cndmask_b32 v5, v5, v6, vcc
    v_accvgpr_write_b32 a0, v5
    v_accvgpr_read_b32 v5, a4
    v_cndmask_b32 v5, v5, v6, vcc
    v_accvgpr_write_b32 a4, v5
    v_and_b32 v5, 15, v1
    v_lshrrev_b32 v6, 4, v1
    v_lshlrev_b32 v5, 4, v5
    v_lshl_add_u32 v10, v6, 9, v5
    v_add_u32 v11, 2048, v10
    v_add_u32 v12, 0x10000, v10
    v_add_u32 v13, 0x10000, v11
    s_lshl_b32 s19, s16, 10
    s_lshl_b32 s17, s16, 1
    v_lshrrev_b32 v8, 5, v1
    v_add_u32 v8, s17, v8
    v_and_b32 v7, 31, v1
    v_mul_u32_u24 v2, 33024, v8
    v_lshl_add_u32 v2, v7, 4, v2
    v_and_b32 v3, 15, v1
    v_and_b32 v5, 48, v1
    v_lshl_add_u32 v3, v3, 12, v5
    v_add_u32 v4, 0x10000, v3
    s_lshl_b32 s21, s28, 21
    s_lshl_b32 s17, s29, 6
    s_add_u32 s21, s21, s17
    s_lshl_b32 s20, s28, 13
    s_add_u32 s20, s20, 111149056
    s_mov_b32 s24, 512
    s_mov_b32 s25, 131072
    v_and_b32 v7, 31, v1
    v_lshlrev_b32 v7, 7, v7
    s_lshl_b32 s17, s16, 12
    s_add_u32 s17, s17, 100761600
    v_add_u32 v7, s17, v7
    s_mov_b32 s30, s92
F3_w0:
    buffer_load_dword v5, v7, s[4:7], 0 offen sc1
    s_waitcnt vmcnt(0)
    v_cmp_gt_u32 vcc, 1, v5
    s_nop 0
    s_cmp_lg_u64 vcc, 0
    s_cbranch_scc0 F3_w0_ok
    s_cmp_ge_u32 s30, 1048576
    s_cselect_b32 s92, 1048576, s92
    s_cbranch_scc1 F3_w0_ok
    s_add_u32 s30, s30, 1
    s_sleep 8
    s_branch F3_w0
F3_w0_ok:
    s_barrier
    s_mov_b32 s26, s25
    s_sub_u32 s25, s21, 1073741824
    s_mov_b32 s21, 1073741824
    s_mov_b32 s23, 0
    s_mov_b32 s22, 0
    s_add_u32 m0, s19, 0
    s_add_u32 s17, s20, 0
    buffer_load_dwordx4 v2, s[4:7], s17 offen lds
    s_add_u32 m0, s19, 4096
    s_add_u32 s17, s20, 264192
    buffer_load_dwordx4 v2, s[4:7], s17 offen lds
    s_add_u32 m0, s19, 8192
    s_add_u32 s17, s20, 528384
    buffer_load_dwordx4 v2, s[4:7], s17 offen lds
    s_add_u32 m0, s19, 12288
    s_add_u32 s17, s20, 792576
    buffer_load_dwordx4 v2, s[4:7], s17 offen lds
    s_add_u32 m0, s19, 16384
    s_add_u32 s17, s20, 1056768
    buffer_load_dwordx4 v2, s[4:7], s17 offen lds
    s_add_u32 m0, s19, 20480
    s_add_u32 s17, s20, 1320960
    buffer_load_dwordx4 v2, s[4:7], s17 offen lds
    s_add_u32 m0, s19, 24576
    s_add_u32 s17, s20, 1585152
    buffer_load_dwordx4 v2, s[4:7], s17 offen lds
    s_add_u32 m0, s19, 28672
    s_add_u32 s17, s20, 1849344
    buffer_load_dwordx4 v2, s[4:7], s17 offen lds
    s_add_u32 m0, s19, 32768
    s_add_u32 s17, s20, 2113536
    buffer_load_dwordx4 v2, s[4:7], s17 offen lds
    s_add_u32 m0, s19, 36864
    s_add_u32 s17, s20, 2377728
    buffer_load_dwordx4 v2, s[4:7], s17 offen lds
    s_add_u32 m0, s19, 40960
    s_add_u32 s17, s20, 2641920
    buffer_load_dwordx4 v2, s[4:7], s17 offen lds
    s_add_u32 m0, s19, 45056
    s_add_u32 s17, s20, 2906112
    buffer_load_dwordx4 v2, s[4:7], s17 offen lds
    s_add_u32 m0, s19, 49152
    s_add_u32 s17, s20, 3170304
    buffer_load_dwordx4 v2, s[4:7], s17 offen lds
    s_add_u32 m0, s19, 53248
    s_add_u32 s17, s20, 3434496
    buffer_load_dwordx4 v2, s[4:7], s17 offen lds
    s_add_u32 m0, s19, 57344
    s_add_u32 s17, s20, 3698688
    buffer_load_dwordx4 v2, s[4:7], s17 offen lds
    s_add_u32 m0, s19, 61440
    s_add_u32 s17, s20, 3962880
    buffer_load_dwordx4 v2, s[4:7], s17 offen lds
    s_add_u32 s20, s20, s24
    s_add_u32 m0, s19, 65536
    s_add_u32 s17, s20, 0
    buffer_load_dwordx4 v2, s[4:7], s17 offen lds
    s_add_u32 m0, s19, 69632
    s_add_u32 s17, s20, 264192
    buffer_load_dwordx4 v2, s[4:7], s17 offen lds
    s_add_u32 m0, s19, 73728
    s_add_u32 s17, s20, 528384
    buffer_load_dwordx4 v2, s[4:7], s17 offen lds
    s_waitcnt vmcnt(11)
    s_barrier
    ds_read_b128 v[20:23], v10 offset:0
    ds_read_b128 v[24:27], v10 offset:256
    ds_read_b128 v[28:31], v11 offset:0
    ds_read_b128 v[32:35], v11 offset:256
    ds_read_b128 v[36:39], v10 offset:4096
    ds_read_b128 v[40:43], v10 offset:4352
    ds_read_b128 v[44:47], v11 offset:4096
.p2align 6
F3_top:
    s_waitcnt lgkmcnt(6)
    v_mfma_f32_16x16x32_bf16 v[52:55], a[0:3], v[20:23], 0
    ds_read_b128 v[48:51], v11 offset:4352
    v_mfma_f32_16x16x32_bf16 v[56:59], a[4:7], v[20:23], 0
    s_waitcnt lgkmcnt(6)
    v_mfma_f32_16x16x32_bf16 v[60:63], a[0:3], v[24:27], 0
    ds_read_b128 v[20:23], v10 offset:8192
    s_add_u32 m0, s19, 77824
    v_mfma_f32_16x16x32_bf16 v[64:67], a[4:7], v[24:27], 0
    s_add_u32 s17, s20, 792576
    buffer_load_dwordx4 v2, s[4:7], s17 offen lds
    s_waitcnt lgkmcnt(6)
    v_mfma_f32_16x16x32_bf16 v[52:55], a[8:11], v[28:31], v[52:55]
    ds_read_b128 v[24:27], v10 offset:8448
    v_mfma_f32_16x16x32_bf16 v[56:59], a[12:15], v[28:31], v[56:59]
    s_waitcnt lgkmcnt(6)
    v_mfma_f32_16x16x32_bf16 v[60:63], a[8:11], v[32:35], v[60:63]
    ds_read_b128 v[28:31], v11 offset:8192
    s_add_u32 m0, s19, 81920
    v_mfma_f32_16x16x32_bf16 v[64:67], a[12:15], v[32:35], v[64:67]
    s_add_u32 s17, s20, 1056768
    buffer_load_dwordx4 v2, s[4:7], s17 offen lds
    s_waitcnt lgkmcnt(6)
    v_mfma_f32_16x16x32_bf16 v[52:55], a[16:19], v[36:39], v[52:55]
    ds_read_b128 v[32:35], v11 offset:8448
    v_mfma_f32_16x16x32_bf16 v[56:59], a[20:23], v[36:39], v[56:59]
    s_waitcnt lgkmcnt(6)
    v_mfma_f32_16x16x32_bf16 v[60:63], a[16:19], v[40:43], v[60:63]
    ds_read_b128 v[36:39], v10 offset:12288
    s_add_u32 m0, s19, 86016
    v_mfma_f32_16x16x32_bf16 v[64:67], a[20:23], v[40:43], v[64:67]
    s_add_u32 s17, s20, 1320960
    buffer_load_dwordx4 v2, s[4:7], s17 offen lds
    s_waitcnt lgkmcnt(6)
    v_mfma_f32_16x16x32_bf16 v[52:55], a[24:27], v[44:47], v[52:55]
    ds_read_b128 v[40:43], v10 offset:12544
    v_mfma_f32_16x16x32_bf16 v[56:59], a[28:31], v[44:47], v[56:59]
    s_waitcnt lgkmcnt(6)
    v_mfma_f32_16x16x32_bf16 v[60:63], a[24:27], v[48:51], v[60:63]
    ds_read_b128 v[44:47], v11 offset:12288
    s_add_u32 m0, s19, 90112
    v_mfma_f32_16x16x32_bf16 v[64:67], a[28:31], v[48:51], v[64:67]
    s_add_u32 s17, s20, 1585152
    buffer_load_dwordx4 v2, s[4:7], s17 offen lds
    s_waitcnt lgkmcnt(6)
    v_mfma_f32_16x16x32_bf16 v[52:55], a[32:35], v[20:23], v[52:55]
    ds_read_b128 v[48:51], v11 offset:12544
    v_mfma_f32_16x16x32_bf16 v[56:59], a[36:39], v[20:23], v[56:59]
    s_waitcnt lgkmcnt(6)
    v_mfma_f32_16x16x32_bf16 v[60:63], a[32:35], v[24:27], v[60:63]
    ds_read_b128 v[20:23], v10 offset:16384
    s_add_u32 m0, s19, 94208
    v_mfma_f32_16x16x32_bf16 v[64:67], a[36:39], v[24:27], v[64:67]
    s_add_u32 s17, s20, 1849344
    buffer_load_dwordx4 v2, s[4:7], s17 offen lds
    s_waitcnt lgkmcnt(6)
    v_mfma_f32_16x16x32_bf16 v[52:55], a[40:43], v[28:31], v[52:55]
    ds_read_b128 v[24:27], v10 offset:16640
    v_mfma_f32_16x16x32_bf16 v[56:59], a[44:47], v[28:31], v[56:59]
    v_cvt_pk_bf16_f32 v84, v68, v69
    s_waitcnt lgkmcnt(6)
    v_mfma_f32_16x16x32_bf16 v[60:63], a[40:43], v[32:35], v[60:63]
    ds_read_b128 v[28:31], v11 offset:16384
    v_mfma_f32_16x16x32_bf16 v[64:67], a[44:47], v[32:35], v[64:67]
    v_cvt_pk_bf16_f32 v85, v70, v71
    s_waitcnt lgkmcnt(6)
    v_mfma_f32_16x16x32_bf16 v[52:55], a[48:51], v[36:39], v[52:55]
    ds_read_b128 v[32:35], v11 offset:16640
    v_mfma_f32_16x16x32_bf16 v[56:59], a[52:55], v[36:39], v[56:59]
    v_cvt_pk_bf16_f32 v86, v72, v73
    s_waitcnt lgkmcnt(6)
    v_mfma_f32_16x16x32_bf16 v[60:63], a[48:51], v[40:43], v[60:63]
    ds_read_b128 v[36:39], v10 offset:20480
    v_mfma_f32_16x16x32_bf16 v[64:67], a[52:55], v[40:43], v[64:67]
    v_cvt_pk_bf16_f32 v87, v74, v75
    s_waitcnt lgkmcnt(6)
    v_mfma_f32_16x16x32_bf16 v[52:55], a[56:59], v[44:47], v[52:55]
    ds_read_b128 v[40:43], v10 offset:20736
    v_mfma_f32_16x16x32_bf16 v[56:59], a[60:63], v[44:47], v[56:59]
    v_cvt_pk_bf16_f32 v88, v76, v77
    s_waitcnt lgkmcnt(6)
    v_mfma_f32_16x16x32_bf16 v[60:63], a[56:59], v[48:51], v[60:63]
    ds_read_b128 v[44:47], v11 offset:20480
    v_mfma_f32_16x16x32_bf16 v[64:67], a[60:63], v[48:51], v[64:67]
    v_cvt_pk_bf16_f32 v89, v78, v79
    buffer_store_dwordx4 v[84:87], v3, s[12:15], s21 offen
    s_waitcnt lgkmcnt(6)
    v_mfma_f32_16x16x32_bf16 v[52:55], a[64:67], v[20:23], v[52:55]
    ds_read_b128 v[48:51], v11 offset:20736
    v_mfma_f32_16x16x32_bf16 v[56:59], a[68:71], v[20:23], v[56:59]
    v_cvt_pk_bf16_f32 v90, v80, v81
    s_waitcnt lgkmcnt(6)
    v_mfma_f32_16x16x32_bf16 v[60:63], a[64:67], v[24:27], v[60:63]
    ds_read_b128 v[20:23], v10 offset:24576
    v_mfma_f32_16x16x32_bf16 v[64:67], a[68:71], v[24:27], v[64:67]
    v_cvt_pk_bf16_f32 v91, v82, v83
    s_waitcnt lgkmcnt(6)
    v_mfma_f32_16x16x32_bf16 v[52:55], a[72:75], v[28:31], v[52:55]
    ds_read_b128 v[24:27], v10 offset:24832
    v_mfma_f32_16x16x32_bf16 v[56:59], a[76:79], v[28:31], v[56:59]
    s_waitcnt lgkmcnt(6)
    v_mfma_f32_16x16x32_bf16 v[60:63], a[72:75], v[32:35], v[60:63]
    ds_read_b128 v[28:31], v11 offset:24576
    v_mfma_f32_16x16x32_bf16 v[64:67], a[76:79], v[32:35], v[64:67]
    buffer_store_dwordx4 v[88:91], v4, s[12:15], s21 offen
    s_waitcnt lgkmcnt(6)
    v_mfma_f32_16x16x32_bf16 v[52:55], a[80:83], v[36:39], v[52:55]
    ds_read_b128 v[32:35], v11 offset:24832
    v_mfma_f32_16x16x32_bf16 v[56:59], a[84:87], v[36:39], v[56:59]
    s_add_u32 s21, s21, s25
    s_mov_b32 s25, s26
    s_waitcnt lgkmcnt(6)
    v_mfma_f32_16x16x32_bf16 v[60:63], a[80:83], v[40:43], v[60:63]
    ds_read_b128 v[36:39], v10 offset:28672
    v_mfma_f32_16x16x32_bf16 v[64:67], a[84:87], v[40:43], v[64:67]
    s_waitcnt lgkmcnt(6)
    v_mfma_f32_16x16x32_bf16 v[52:55], a[88:91], v[44:47], v[52:55]
    ds_read_b128 v[40:43], v10 offset:28928
    v_mfma_f32_16x16x32_bf16 v[56:59], a[92:95], v[44:47], v[56:59]
    s_waitcnt lgkmcnt(6)
    v_mfma_f32_16x16x32_bf16 v[60:63], a[88:91], v[48:51], v[60:63]
    ds_read_b128 v[44:47], v11 offset:28672
    v_mfma_f32_16x16x32_bf16 v[64:67], a[92:95], v[48:51], v[64:67]
    s_waitcnt lgkmcnt(6)
    v_mfma_f32_16x16x32_bf16 v[52:55], a[96:99], v[20:23], v[52:55]
    ds_read_b128 v[48:51], v11 offset:28928
    v_mfma_f32_16x16x32_bf16 v[56:59], a[100:103], v[20:23], v[56:59]
    s_waitcnt lgkmcnt(6)
    v_mfma_f32_16x16x32_bf16 v[60:63], a[96:99], v[24:27], v[60:63]
    s_waitcnt vmcnt(10)
    s_barrier
    ds_read_b128 v[20:23], v10 offset:32768
    v_mfma_f32_16x16x32_bf16 v[64:67], a[100:103], v[24:27], v[64:67]
    s_waitcnt lgkmcnt(6)
    v_mfma_f32_16x16x32_bf16 v[52:55], a[104:107], v[28:31], v[52:55]
    ds_read_b128 v[24:27], v10 offset:33024
    s_add_u32 m0, s19, 98304
    v_mfma_f32_16x16x32_bf16 v[56:59], a[108:111], v[28:31], v[56:59]
    s_add_u32 s17, s20, 2113536
    buffer_load_dwordx4 v2, s[4:7], s17 offen lds
    s_waitcnt lgkmcnt(6)
    v_mfma_f32_16x16x32_bf16 v[60:63], a[104:107], v[32:35], v[60:63]
    ds_read_b128 v[28:31], v11 offset:32768
    v_mfma_f32_16x16x32_bf16 v[64:67], a[108:111], v[32:35], v[64:67]
    s_waitcnt lgkmcnt(6)
    v_mfma_f32_16x16x32_bf16 v[52:55], a[112:115], v[36:39], v[52:55]
    ds_read_b128 v[32:35], v11 offset:33024
    s_add_u32 m0, s19, 102400
    v_mfma_f32_16x16x32_bf16 v[56:59], a[116:119], v[36:39], v[56:59]
    s_add_u32 s17, s20, 2377728
    buffer_load_dwordx4 v2, s[4:7], s17 offen lds
    s_waitcnt lgkmcnt(6)
    v_mfma_f32_16x16x32_bf16 v[60:63], a[112:115], v[40:43], v[60:63]
    ds_read_b128 v[36:39], v10 offset:36864
    v_mfma_f32_16x16x32_bf16 v[64:67], a[116:119], v[40:43], v[64:67]
    s_waitcnt lgkmcnt(6)
    v_mfma_f32_16x16x32_bf16 v[52:55], a[120:123], v[44:47], v[52:55]
    ds_read_b128 v[40:43], v10 offset:37120
    s_add_u32 m0, s19, 106496
    v_mfma_f32_16x16x32_bf16 v[56:59], a[124:127], v[44:47], v[56:59]
    s_add_u32 s17, s20, 2641920
    buffer_load_dwordx4 v2, s[4:7], s17 offen lds
    s_waitcnt lgkmcnt(6)
    v_mfma_f32_16x16x32_bf16 v[60:63], a[120:123], v[48:51], v[60:63]
    ds_read_b128 v[44:47], v11 offset:36864
    v_mfma_f32_16x16x32_bf16 v[64:67], a[124:127], v[48:51], v[64:67]
    s_waitcnt lgkmcnt(6)
    v_mfma_f32_16x16x32_bf16 v[52:55], a[128:131], v[20:23], v[52:55]
    ds_read_b128 v[48:51], v11 offset:37120
    v_mfma_f32_16x16x32_bf16 v[56:59], a[132:135], v[20:23], v[56:59]
    s_waitcnt lgkmcnt(6)
    v_mfma_f32_16x16x32_bf16 v[60:63], a[128:131], v[24:27], v[60:63]
    ds_read_b128 v[20:23], v10 offset:40960
    s_add_u32 m0, s19, 110592
    v_mfma_f32_16x16x32_bf16 v[64:67], a[132:135], v[24:27], v[64:67]
    s_add_u32 s17, s20, 2906112
    buffer_load_dwordx4 v2, s[4:7], s17 offen lds
    s_waitcnt lgkmcnt(6)
    v_mfma_f32_16x16x32_bf16 v[52:55], a[136:139], v[28:31], v[52:55]
    ds_read_b128 v[24:27], v10 offset:41216
    v_mfma_f32_16x16x32_bf16 v[56:59], a[140:143], v[28:31], v[56:59]
    s_waitcnt lgkmcnt(6)
    v_mfma_f32_16x16x32_bf16 v[60:63], a[136:139], v[32:35], v[60:63]
    ds_read_b128 v[28:31], v11 offset:40960
    s_add_u32 m0, s19, 114688
    v_mfma_f32_16x16x32_bf16 v[64:67], a[140:143], v[32:35], v[64:67]
    s_add_u32 s17, s20, 3170304
    buffer_load_dwordx4 v2, s[4:7], s17 offen lds
    s_waitcnt lgkmcnt(6)
    v_mfma_f32_16x16x32_bf16 v[52:55], a[144:147], v[36:39], v[52:55]
    ds_read_b128 v[32:35], v11 offset:41216
    v_mfma_f32_16x16x32_bf16 v[56:59], a[148:151], v[36:39], v[56:59]
    s_waitcnt lgkmcnt(6)
    v_mfma_f32_16x16x32_bf16 v[60:63], a[144:147], v[40:43], v[60:63]
    ds_read_b128 v[36:39], v10 offset:45056
    s_add_u32 m0, s19, 118784
    v_mfma_f32_16x16x32_bf16 v[64:67], a[148:151], v[40:43], v[64:67]
    s_add_u32 s17, s20, 3434496
    buffer_load_dwordx4 v2, s[4:7], s17 offen lds
    s_waitcnt lgkmcnt(6)
    v_mfma_f32_16x16x32_bf16 v[52:55], a[152:155], v[44:47], v[52:55]
    ds_read_b128 v[40:43], v10 offset:45312
    v_mfma_f32_16x16x32_bf16 v[56:59], a[156:159], v[44:47], v[56:59]
    s_waitcnt lgkmcnt(6)
    v_mfma_f32_16x16x32_bf16 v[60:63], a[152:155], v[48:51], v[60:63]
    ds_read_b128 v[44:47], v11 offset:45056
    s_add_u32 m0, s19, 122880
    v_mfma_f32_16x16x32_bf16 v[64:67], a[156:159], v[48:51], v[64:67]
    s_add_u32 s17, s20, 3698688
    buffer_load_dwordx4 v2, s[4:7], s17 offen lds
    s_waitcnt lgkmcnt(6)
    v_mfma_f32_16x16x32_bf16 v[52:55], a[160:163], v[20:23], v[52:55]
    ds_read_b128 v[48:51], v11 offset:45312
    v_mfma_f32_16x16x32_bf16 v[56:59], a[164:167], v[20:23], v[56:59]
    s_waitcnt lgkmcnt(6)
    v_mfma_f32_16x16x32_bf16 v[60:63], a[160:163], v[24:27], v[60:63]
    ds_read_b128 v[20:23], v10 offset:49152
    s_add_u32 m0, s19, 126976
    v_mfma_f32_16x16x32_bf16 v[64:67], a[164:167], v[24:27], v[64:67]
    s_add_u32 s17, s20, 3962880
    buffer_load_dwordx4 v2, s[4:7], s17 offen lds
    s_waitcnt lgkmcnt(6)
    v_mfma_f32_16x16x32_bf16 v[52:55], a[168:171], v[28:31], v[52:55]
    ds_read_b128 v[24:27], v10 offset:49408
    v_mfma_f32_16x16x32_bf16 v[56:59], a[172:175], v[28:31], v[56:59]
    s_add_u32 s20, s20, s24
    s_waitcnt lgkmcnt(6)
    v_mfma_f32_16x16x32_bf16 v[60:63], a[168:171], v[32:35], v[60:63]
    ds_read_b128 v[28:31], v11 offset:49152
    v_mfma_f32_16x16x32_bf16 v[64:67], a[172:175], v[32:35], v[64:67]
    s_waitcnt lgkmcnt(6)
    v_mfma_f32_16x16x32_bf16 v[52:55], a[176:179], v[36:39], v[52:55]
    ds_read_b128 v[32:35], v11 offset:49408
    v_mfma_f32_16x16x32_bf16 v[56:59], a[180:183], v[36:39], v[56:59]
    s_waitcnt lgkmcnt(6)
    v_mfma_f32_16x16x32_bf16 v[60:63], a[176:179], v[40:43], v[60:63]
    ds_read_b128 v[36:39], v10 offset:53248
    v_mfma_f32_16x16x32_bf16 v[64:67], a[180:183], v[40:43], v[64:67]
    s_waitcnt lgkmcnt(6)
    v_mfma_f32_16x16x32_bf16 v[52:55], a[184:187], v[44:47], v[52:55]
    ds_read_b128 v[40:43], v10 offset:53504
    v_mfma_f32_16x16x32_bf16 v[56:59], a[188:191], v[44:47], v[56:59]
    s_waitcnt lgkmcnt(6)
    v_mfma_f32_16x16x32_bf16 v[60:63], a[184:187], v[48:51], v[60:63]
    ds_read_b128 v[44:47], v11 offset:53248
    v_mfma_f32_16x16x32_bf16 v[64:67], a[188:191], v[48:51], v[64:67]
    s_waitcnt lgkmcnt(6)
    v_mfma_f32_16x16x32_bf16 v[52:55], a[192:195], v[20:23], v[52:55]
    ds_read_b128 v[48:51], v11 offset:53504
    v_mfma_f32_16x16x32_bf16 v[56:59], a[196:199], v[20:23], v[56:59]
    s_waitcnt lgkmcnt(6)
    v_mfma_f32_16x16x32_bf16 v[60:63], a[192:195], v[24:27], v[60:63]
    ds_read_b128 v[20:23], v10 offset:57344
    v_mfma_f32_16x16x32_bf16 v[64:67], a[196:199], v[24:27], v[64:67]
    s_waitcnt lgkmcnt(6)
    v_mfma_f32_16x16x32_bf16 v[52:55], a[200:203], v[28:31], v[52:55]
    ds_read_b128 v[24:27], v10 offset:57600
    v_mfma_f32_16x16x32_bf16 v[56:59], a[204:207], v[28:31], v[56:59]
    s_waitcnt lgkmcnt(6)
    v_mfma_f32_16x16x32_bf16 v[60:63], a[200:203], v[32:35], v[60:63]
    ds_read_b128 v[28:31], v11 offset:57344
    v_mfma_f32_16x16x32_bf16 v[64:67], a[204:207], v[32:35], v[64:67]
    s_waitcnt lgkmcnt(6)
    v_mfma_f32_16x16x32_bf16 v[52:55], a[208:211], v[36:39], v[52:55]
    ds_read_b128 v[32:35], v11 offset:57600
    v_mfma_f32_16x16x32_bf16 v[56:59], a[212:215], v[36:39], v[56:59]
    s_waitcnt lgkmcnt(6)
    v_mfma_f32_16x16x32_bf16 v[60:63], a[208:211], v[40:43], v[60:63]
    ds_read_b128 v[36:39], v10 offset:61440
    v_mfma_f32_16x16x32_bf16 v[64:67], a[212:215], v[40:43], v[64:67]
    s_waitcnt lgkmcnt(6)
    v_mfma_f32_16x16x32_bf16 v[52:55], a[216:219], v[44:47], v[52:55]
    ds_read_b128 v[40:43], v10 offset:61696
    v_mfma_f32_16x16x32_bf16 v[56:59], a[220:223], v[44:47], v[56:59]
    s_waitcnt lgkmcnt(6)
    v_mfma_f32_16x16x32_bf16 v[60:63], a[216:219], v[48:51], v[60:63]
    ds_read_b128 v[44:47], v11 offset:61440
    v_mfma_f32_16x16x32_bf16 v[64:67], a[220:223], v[48:51], v[64:67]
    s_waitcnt lgkmcnt(6)
    v_mfma_f32_16x16x32_bf16 v[52:55], a[224:227], v[20:23], v[52:55]
    ds_read_b128 v[48:51], v11 offset:61696
    v_mfma_f32_16x16x32_bf16 v[56:59], a[228:231], v[20:23], v[56:59]
    s_waitcnt lgkmcnt(6)
    v_mfma_f32_16x16x32_bf16 v[60:63], a[224:227], v[24:27], v[60:63]
    s_waitcnt vmcnt(8)
    s_barrier
    ds_read_b128 v[20:23], v12 offset:0
    v_mfma_f32_16x16x32_bf16 v[64:67], a[228:231], v[24:27], v[64:67]
    s_waitcnt lgkmcnt(6)
    v_mfma_f32_16x16x32_bf16 v[52:55], a[232:235], v[28:31], v[52:55]
    ds_read_b128 v[24:27], v12 offset:256
    s_add_u32 m0, s19, 0
    v_mfma_f32_16x16x32_bf16 v[56:59], a[236:239], v[28:31], v[56:59]
    s_add_u32 s17, s20, 0
    buffer_load_dwordx4 v2, s[4:7], s17 offen lds
    s_waitcnt lgkmcnt(6)
    v_mfma_f32_16x16x32_bf16 v[60:63], a[232:235], v[32:35], v[60:63]
    ds_read_b128 v[28:31], v13 offset:0
    v_mfma_f32_16x16x32_bf16 v[64:67], a[236:239], v[32:35], v[64:67]
    s_waitcnt lgkmcnt(6)
    v_mfma_f32_16x16x32_bf16 v[52:55], a[240:243], v[36:39], v[52:55]
    ds_read_b128 v[32:35], v13 offset:256
    s_add_u32 m0, s19, 4096
    v_mfma_f32_16x16x32_bf16 v[56:59], a[244:247], v[36:39], v[56:59]
    s_add_u32 s17, s20, 264192
    buffer_load_dwordx4 v2, s[4:7], s17 offen lds
    s_waitcnt lgkmcnt(6)
    v_mfma_f32_16x16x32_bf16 v[60:63], a[240:243], v[40:43], v[60:63]
    ds_read_b128 v[36:39], v12 offset:4096
    v_mfma_f32_16x16x32_bf16 v[64:67], a[244:247], v[40:43], v[64:67]
    s_waitcnt lgkmcnt(6)
    v_mfma_f32_16x16x32_bf16 v[52:55], a[248:251], v[44:47], v[52:55]
    ds_read_b128 v[40:43], v12 offset:4352
    s_add_u32 m0, s19, 8192
    v_mfma_f32_16x16x32_bf16 v[56:59], a[252:255], v[44:47], v[56:59]
    s_add_u32 s17, s20, 528384
    buffer_load_dwordx4 v2, s[4:7], s17 offen lds
    s_waitcnt lgkmcnt(6)
    v_mfma_f32_16x16x32_bf16 v[60:63], a[248:251], v[48:51], v[60:63]
    ds_read_b128 v[44:47], v13 offset:4096
    v_mfma_f32_16x16x32_bf16 v[64:67], a[252:255], v[48:51], v[64:67]
    s_waitcnt lgkmcnt(6)
    v_mfma_f32_16x16x32_bf16 v[68:71], a[0:3], v[20:23], 0
    ds_read_b128 v[48:51], v13 offset:4352
    v_mfma_f32_16x16x32_bf16 v[72:75], a[4:7], v[20:23], 0
    s_waitcnt lgkmcnt(6)
    v_mfma_f32_16x16x32_bf16 v[76:79], a[0:3], v[24:27], 0
    ds_read_b128 v[20:23], v12 offset:8192
    s_add_u32 m0, s19, 12288
    v_mfma_f32_16x16x32_bf16 v[80:83], a[4:7], v[24:27], 0
    s_add_u32 s17, s20, 792576
    buffer_load_dwordx4 v2, s[4:7], s17 offen lds
    s_waitcnt lgkmcnt(6)
    v_mfma_f32_16x16x32_bf16 v[68:71], a[8:11], v[28:31], v[68:71]
    ds_read_b128 v[24:27], v12 offset:8448
    v_mfma_f32_16x16x32_bf16 v[72:75], a[12:15], v[28:31], v[72:75]
    s_waitcnt lgkmcnt(6)
    v_mfma_f32_16x16x32_bf16 v[76:79], a[8:11], v[32:35], v[76:79]
    ds_read_b128 v[28:31], v13 offset:8192
    s_add_u32 m0, s19, 16384
    v_mfma_f32_16x16x32_bf16 v[80:83], a[12:15], v[32:35], v[80:83]
    s_add_u32 s17, s20, 1056768
    buffer_load_dwordx4 v2, s[4:7], s17 offen lds
    s_waitcnt lgkmcnt(6)
    v_mfma_f32_16x16x32_bf16 v[68:71], a[16:19], v[36:39], v[68:71]
    ds_read_b128 v[32:35], v13 offset:8448
    v_mfma_f32_16x16x32_bf16 v[72:75], a[20:23], v[36:39], v[72:75]
    s_waitcnt lgkmcnt(6)
    v_mfma_f32_16x16x32_bf16 v[76:79], a[16:19], v[40:43], v[76:79]
    ds_read_b128 v[36:39], v12 offset:12288
    s_add_u32 m0, s19, 20480
    v_mfma_f32_16x16x32_bf16 v[80:83], a[20:23], v[40:43], v[80:83]
    s_add_u32 s17, s20, 1320960
    buffer_load_dwordx4 v2, s[4:7], s17 offen lds
    s_waitcnt lgkmcnt(6)
    v_mfma_f32_16x16x32_bf16 v[68:71], a[24:27], v[44:47], v[68:71]
    ds_read_b128 v[40:43], v12 offset:12544
    v_mfma_f32_16x16x32_bf16 v[72:75], a[28:31], v[44:47], v[72:75]
    s_waitcnt lgkmcnt(6)
    v_mfma_f32_16x16x32_bf16 v[76:79], a[24:27], v[48:51], v[76:79]
    ds_read_b128 v[44:47], v13 offset:12288
    s_add_u32 m0, s19, 24576
    v_mfma_f32_16x16x32_bf16 v[80:83], a[28:31], v[48:51], v[80:83]
    s_add_u32 s17, s20, 1585152
    buffer_load_dwordx4 v2, s[4:7], s17 offen lds
    s_waitcnt lgkmcnt(6)
    v_mfma_f32_16x16x32_bf16 v[68:71], a[32:35], v[20:23], v[68:71]
    ds_read_b128 v[48:51], v13 offset:12544
    v_mfma_f32_16x16x32_bf16 v[72:75], a[36:39], v[20:23], v[72:75]
    s_waitcnt lgkmcnt(6)
    v_mfma_f32_16x16x32_bf16 v[76:79], a[32:35], v[24:27], v[76:79]
    ds_read_b128 v[20:23], v12 offset:16384
    s_add_u32 m0, s19, 28672
    v_mfma_f32_16x16x32_bf16 v[80:83], a[36:39], v[24:27], v[80:83]
    s_add_u32 s17, s20, 1849344
    buffer_load_dwordx4 v2, s[4:7], s17 offen lds
    s_waitcnt lgkmcnt(6)
    v_mfma_f32_16x16x32_bf16 v[68:71], a[40:43], v[28:31], v[68:71]
    ds_read_b128 v[24:27], v12 offset:16640
    v_mfma_f32_16x16x32_bf16 v[72:75], a[44:47], v[28:31], v[72:75]
    v_cvt_pk_bf16_f32 v84, v52, v53
    s_waitcnt lgkmcnt(6)
    v_mfma_f32_16x16x32_bf16 v[76:79], a[40:43], v[32:35], v[76:79]
    ds_read_b128 v[28:31], v13 offset:16384
    v_mfma_f32_16x16x32_bf16 v[80:83], a[44:47], v[32:35], v[80:83]
    v_cvt_pk_bf16_f32 v85, v54, v55
    s_waitcnt lgkmcnt(6)
    v_mfma_f32_16x16x32_bf16 v[68:71], a[48:51], v[36:39], v[68:71]
    ds_read_b128 v[32:35], v13 offset:16640
    v_mfma_f32_16x16x32_bf16 v[72:75], a[52:55], v[36:39], v[72:75]
    v_cvt_pk_bf16_f32 v86, v56, v57
    s_waitcnt lgkmcnt(6)
    v_mfma_f32_16x16x32_bf16 v[76:79], a[48:51], v[40:43], v[76:79]
    ds_read_b128 v[36:39], v12 offset:20480
    v_mfma_f32_16x16x32_bf16 v[80:83], a[52:55], v[40:43], v[80:83]
    v_cvt_pk_bf16_f32 v87, v58, v59
    s_waitcnt lgkmcnt(6)
    v_mfma_f32_16x16x32_bf16 v[68:71], a[56:59], v[44:47], v[68:71]
    ds_read_b128 v[40:43], v12 offset:20736
    v_mfma_f32_16x16x32_bf16 v[72:75], a[60:63], v[44:47], v[72:75]
    v_cvt_pk_bf16_f32 v88, v60, v61
    s_waitcnt lgkmcnt(6)
    v_mfma_f32_16x16x32_bf16 v[76:79], a[56:59], v[48:51], v[76:79]
    ds_read_b128 v[44:47], v13 offset:20480
    v_mfma_f32_16x16x32_bf16 v[80:83], a[60:63], v[48:51], v[80:83]
    v_cvt_pk_bf16_f32 v89, v62, v63
    buffer_store_dwordx4 v[84:87], v3, s[12:15], s21 offen
    s_waitcnt lgkmcnt(6)
    v_mfma_f32_16x16x32_bf16 v[68:71], a[64:67], v[20:23], v[68:71]
    ds_read_b128 v[48:51], v13 offset:20736
    v_mfma_f32_16x16x32_bf16 v[72:75], a[68:71], v[20:23], v[72:75]
    v_cvt_pk_bf16_f32 v90, v64, v65
    s_waitcnt lgkmcnt(6)
    v_mfma_f32_16x16x32_bf16 v[76:79], a[64:67], v[24:27], v[76:79]
    ds_read_b128 v[20:23], v12 offset:24576
    v_mfma_f32_16x16x32_bf16 v[80:83], a[68:71], v[24:27], v[80:83]
    v_cvt_pk_bf16_f32 v91, v66, v67
    s_waitcnt lgkmcnt(6)
    v_mfma_f32_16x16x32_bf16 v[68:71], a[72:75], v[28:31], v[68:71]
    ds_read_b128 v[24:27], v12 offset:24832
    v_mfma_f32_16x16x32_bf16 v[72:75], a[76:79], v[28:31], v[72:75]
    s_waitcnt lgkmcnt(6)
    v_mfma_f32_16x16x32_bf16 v[76:79], a[72:75], v[32:35], v[76:79]
    ds_read_b128 v[28:31], v13 offset:24576
    v_mfma_f32_16x16x32_bf16 v[80:83], a[76:79], v[32:35], v[80:83]
    buffer_store_dwordx4 v[88:91], v4, s[12:15], s21 offen
    s_waitcnt lgkmcnt(6)
    v_mfma_f32_16x16x32_bf16 v[68:71], a[80:83], v[36:39], v[68:71]
    ds_read_b128 v[32:35], v13 offset:24832
    v_mfma_f32_16x16x32_bf16 v[72:75], a[84:87], v[36:39], v[72:75]
    s_add_u32 s21, s21, s25
    s_mov_b32 s25, s26
    s_waitcnt lgkmcnt(6)
    v_mfma_f32_16x16x32_bf16 v[76:79], a[80:83], v[40:43], v[76:79]
    ds_read_b128 v[36:39], v12 offset:28672
    v_mfma_f32_16x16x32_bf16 v[80:83], a[84:87], v[40:43], v[80:83]
    s_waitcnt lgkmcnt(6)
    v_mfma_f32_16x16x32_bf16 v[68:71], a[88:91], v[44:47], v[68:71]
    ds_read_b128 v[40:43], v12 offset:28928
    v_mfma_f32_16x16x32_bf16 v[72:75], a[92:95], v[44:47], v[72:75]
    s_waitcnt lgkmcnt(6)
    v_mfma_f32_16x16x32_bf16 v[76:79], a[88:91], v[48:51], v[76:79]
    ds_read_b128 v[44:47], v13 offset:28672
    v_mfma_f32_16x16x32_bf16 v[80:83], a[92:95], v[48:51], v[80:83]
    s_waitcnt lgkmcnt(6)
    v_mfma_f32_16x16x32_bf16 v[68:71], a[96:99], v[20:23], v[68:71]
    ds_read_b128 v[48:51], v13 offset:28928
    v_mfma_f32_16x16x32_bf16 v[72:75], a[100:103], v[20:23], v[72:75]
    s_waitcnt lgkmcnt(6)
    v_mfma_f32_16x16x32_bf16 v[76:79], a[96:99], v[24:27], v[76:79]
    s_waitcnt vmcnt(10)
    s_barrier
    ds_read_b128 v[20:23], v12 offset:32768
    v_mfma_f32_16x16x32_bf16 v[80:83], a[100:103], v[24:27], v[80:83]
    s_waitcnt lgkmcnt(6)
    v_mfma_f32_16x16x32_bf16 v[68:71], a[104:107], v[28:31], v[68:71]
    ds_read_b128 v[24:27], v12 offset:33024
    s_add_u32 m0, s19, 32768
    v_mfma_f32_16x16x32_bf16 v[72:75], a[108:111], v[28:31], v[72:75]
    s_add_u32 s17, s20, 2113536
    buffer_load_dwordx4 v2, s[4:7], s17 offen lds
    s_waitcnt lgkmcnt(6)
    v_mfma_f32_16x16x32_bf16 v[76:79], a[104:107], v[32:35], v[76:79]
    ds_read_b128 v[28:31], v13 offset:32768
    v_mfma_f32_16x16x32_bf16 v[80:83], a[108:111], v[32:35], v[80:83]
    s_waitcnt lgkmcnt(6)
    v_mfma_f32_16x16x32_bf16 v[68:71], a[112:115], v[36:39], v[68:71]
    ds_read_b128 v[32:35], v13 offset:33024
    s_add_u32 m0, s19, 36864
    v_mfma_f32_16x16x32_bf16 v[72:75], a[116:119], v[36:39], v[72:75]
    s_add_u32 s17, s20, 2377728
    buffer_load_dwordx4 v2, s[4:7], s17 offen lds
    s_waitcnt lgkmcnt(6)
    v_mfma_f32_16x16x32_bf16 v[76:79], a[112:115], v[40:43], v[76:79]
    ds_read_b128 v[36:39], v12 offset:36864
    v_mfma_f32_16x16x32_bf16 v[80:83], a[116:119], v[40:43], v[80:83]
    s_waitcnt lgkmcnt(6)
    v_mfma_f32_16x16x32_bf16 v[68:71], a[120:123], v[44:47], v[68:71]
    ds_read_b128 v[40:43], v12 offset:37120
    s_add_u32 m0, s19, 40960
    v_mfma_f32_16x16x32_bf16 v[72:75], a[124:127], v[44:47], v[72:75]
    s_add_u32 s17, s20, 2641920
    buffer_load_dwordx4 v2, s[4:7], s17 offen lds
    s_waitcnt lgkmcnt(6)
    v_mfma_f32_16x16x32_bf16 v[76:79], a[120:123], v[48:51], v[76:79]
    ds_read_b128 v[44:47], v13 offset:36864
    v_mfma_f32_16x16x32_bf16 v[80:83], a[124:127], v[48:51], v[80:83]
    s_waitcnt lgkmcnt(6)
    v_mfma_f32_16x16x32_bf16 v[68:71], a[128:131], v[20:23], v[68:71]
    ds_read_b128 v[48:51], v13 offset:37120
    v_mfma_f32_16x16x32_bf16 v[72:75], a[132:135], v[20:23], v[72:75]
    s_waitcnt lgkmcnt(6)
    v_mfma_f32_16x16x32_bf16 v[76:79], a[128:131], v[24:27], v[76:79]
    ds_read_b128 v[20:23], v12 offset:40960
    s_add_u32 m0, s19, 45056
    v_mfma_f32_16x16x32_bf16 v[80:83], a[132:135], v[24:27], v[80:83]
    s_add_u32 s17, s20, 2906112
    buffer_load_dwordx4 v2, s[4:7], s17 offen lds
    s_waitcnt lgkmcnt(6)
    v_mfma_f32_16x16x32_bf16 v[68:71], a[136:139], v[28:31], v[68:71]
    ds_read_b128 v[24:27], v12 offset:41216
    v_mfma_f32_16x16x32_bf16 v[72:75], a[140:143], v[28:31], v[72:75]
    s_waitcnt lgkmcnt(6)
    v_mfma_f32_16x16x32_bf16 v[76:79], a[136:139], v[32:35], v[76:79]
    ds_read_b128 v[28:31], v13 offset:40960
    s_add_u32 m0, s19, 49152
    v_mfma_f32_16x16x32_bf16 v[80:83], a[140:143], v[32:35], v[80:83]
    s_add_u32 s17, s20, 3170304
    buffer_load_dwordx4 v2, s[4:7], s17 offen lds
    s_waitcnt lgkmcnt(6)
    v_mfma_f32_16x16x32_bf16 v[68:71], a[144:147], v[36:39], v[68:71]
    ds_read_b128 v[32:35], v13 offset:41216
    v_mfma_f32_16x16x32_bf16 v[72:75], a[148:151], v[36:39], v[72:75]
    s_waitcnt lgkmcnt(6)
    v_mfma_f32_16x16x32_bf16 v[76:79], a[144:147], v[40:43], v[76:79]
    ds_read_b128 v[36:39], v12 offset:45056
    s_add_u32 m0, s19, 53248
    v_mfma_f32_16x16x32_bf16 v[80:83], a[148:151], v[40:43], v[80:83]
    s_add_u32 s17, s20, 3434496
    buffer_load_dwordx4 v2, s[4:7], s17 offen lds
    s_waitcnt lgkmcnt(6)
    v_mfma_f32_16x16x32_bf16 v[68:71], a[152:155], v[44:47], v[68:71]
    ds_read_b128 v[40:43], v12 offset:45312
    v_mfma_f32_16x16x32_bf16 v[72:75], a[156:159], v[44:47], v[72:75]
    s_waitcnt lgkmcnt(6)
    v_mfma_f32_16x16x32_bf16 v[76:79], a[152:155], v[48:51], v[76:79]
    ds_read_b128 v[44:47], v13 offset:45056
    s_add_u32 m0, s19, 57344
    v_mfma_f32_16x16x32_bf16 v[80:83], a[156:159], v[48:51], v[80:83]
    s_add_u32 s17, s20, 3698688
    buffer_load_dwordx4 v2, s[4:7], s17 offen lds
    s_waitcnt lgkmcnt(6)
    v_mfma_f32_16x16x32_bf16 v[68:71], a[160:163], v[20:23], v[68:71]
    ds_read_b128 v[48:51], v13 offset:45312
    v_mfma_f32_16x16x32_bf16 v[72:75], a[164:167], v[20:23], v[72:75]
    s_waitcnt lgkmcnt(6)
    v_mfma_f32_16x16x32_bf16 v[76:79], a[160:163], v[24:27], v[76:79]
    ds_read_b128 v[20:23], v12 offset:49152
    s_add_u32 m0, s19, 61440
    v_mfma_f32_16x16x32_bf16 v[80:83], a[164:167], v[24:27], v[80:83]
    s_add_u32 s17, s20, 3962880
    buffer_load_dwordx4 v2, s[4:7], s17 offen lds
    s_waitcnt lgkmcnt(6)
    v_mfma_f32_16x16x32_bf16 v[68:71], a[168:171], v[28:31], v[68:71]
    ds_read_b128 v[24:27], v12 offset:49408
    v_mfma_f32_16x16x32_bf16 v[72:75], a[172:175], v[28:31], v[72:75]
    s_add_u32 s20, s20, s24
    s_waitcnt lgkmcnt(6)
    v_mfma_f32_16x16x32_bf16 v[76:79], a[168:171], v[32:35], v[76:79]
    ds_read_b128 v[28:31], v13 offset:49152
    v_mfma_f32_16x16x32_bf16 v[80:83], a[172:175], v[32:35], v[80:83]
    s_waitcnt lgkmcnt(6)
    v_mfma_f32_16x16x32_bf16 v[68:71], a[176:179], v[36:39], v[68:71]
    ds_read_b128 v[32:35], v13 offset:49408
    v_mfma_f32_16x16x32_bf16 v[72:75], a[180:183], v[36:39], v[72:75]
    s_waitcnt lgkmcnt(6)
    v_mfma_f32_16x16x32_bf16 v[76:79], a[176:179], v[40:43], v[76:79]
    ds_read_b128 v[36:39], v12 offset:53248
    v_mfma_f32_16x16x32_bf16 v[80:83], a[180:183], v[40:43], v[80:83]
    s_waitcnt lgkmcnt(6)
    v_mfma_f32_16x16x32_bf16 v[68:71], a[184:187], v[44:47], v[68:71]
    ds_read_b128 v[40:43], v12 offset:53504
    v_mfma_f32_16x16x32_bf16 v[72:75], a[188:191], v[44:47], v[72:75]
    s_waitcnt lgkmcnt(6)
    v_mfma_f32_16x16x32_bf16 v[76:79], a[184:187], v[48:51], v[76:79]
    ds_read_b128 v[44:47], v13 offset:53248
    v_mfma_f32_16x16x32_bf16 v[80:83], a[188:191], v[48:51], v[80:83]
    s_waitcnt lgkmcnt(6)
    v_mfma_f32_16x16x32_bf16 v[68:71], a[192:195], v[20:23], v[68:71]
    ds_read_b128 v[48:51], v13 offset:53504
    v_mfma_f32_16x16x32_bf16 v[72:75], a[196:199], v[20:23], v[72:75]
    s_waitcnt lgkmcnt(6)
    v_mfma_f32_16x16x32_bf16 v[76:79], a[192:195], v[24:27], v[76:79]
    ds_read_b128 v[20:23], v12 offset:57344
    v_mfma_f32_16x16x32_bf16 v[80:83], a[196:199], v[24:27], v[80:83]
    s_waitcnt lgkmcnt(6)
    v_mfma_f32_16x16x32_bf16 v[68:71], a[200:203], v[28:31], v[68:71]
    ds_read_b128 v[24:27], v12 offset:57600
    v_mfma_f32_16x16x32_bf16 v[72:75], a[204:207], v[28:31], v[72:75]
    s_waitcnt lgkmcnt(6)
    v_mfma_f32_16x16x32_bf16 v[76:79], a[200:203], v[32:35], v[76:79]
    ds_read_b128 v[28:31], v13 offset:57344
    v_mfma_f32_16x16x32_bf16 v[80:83], a[204:207], v[32:35], v[80:83]
    s_waitcnt lgkmcnt(6)
    v_mfma_f32_16x16x32_bf16 v[68:71], a[208:211], v[36:39], v[68:71]
    ds_read_b128 v[32:35], v13 offset:57600
    v_mfma_f32_16x16x32_bf16 v[72:75], a[212:215], v[36:39], v[72:75]
    s_waitcnt lgkmcnt(6)
    v_mfma_f32_16x16x32_bf16 v[76:79], a[208:211], v[40:43], v[76:79]
    ds_read_b128 v[36:39], v12 offset:61440
    v_mfma_f32_16x16x32_bf16 v[80:83], a[212:215], v[40:43], v[80:83]
    s_waitcnt lgkmcnt(6)
    v_mfma_f32_16x16x32_bf16 v[68:71], a[216:219], v[44:47], v[68:71]
    ds_read_b128 v[40:43], v12 offset:61696
    v_mfma_f32_16x16x32_bf16 v[72:75], a[220:223], v[44:47], v[72:75]
    s_waitcnt lgkmcnt(6)
    v_mfma_f32_16x16x32_bf16 v[76:79], a[216:219], v[48:51], v[76:79]
    ds_read_b128 v[44:47], v13 offset:61440
    v_mfma_f32_16x16x32_bf16 v[80:83], a[220:223], v[48:51], v[80:83]
    s_waitcnt lgkmcnt(6)
    v_mfma_f32_16x16x32_bf16 v[68:71], a[224:227], v[20:23], v[68:71]
    ds_read_b128 v[48:51], v13 offset:61696
    v_mfma_f32_16x16x32_bf16 v[72:75], a[228:231], v[20:23], v[72:75]
    s_waitcnt lgkmcnt(6)
    v_mfma_f32_16x16x32_bf16 v[76:79], a[224:227], v[24:27], v[76:79]
    s_waitcnt vmcnt(8)
    s_barrier
    ds_read_b128 v[20:23], v10 offset:0
    v_mfma_f32_16x16x32_bf16 v[80:83], a[228:231], v[24:27], v[80:83]
    s_waitcnt lgkmcnt(6)
    v_mfma_f32_16x16x32_bf16 v[68:71], a[232:235], v[28:31], v[68:71]
    ds_read_b128 v[24:27], v10 offset:256
    s_add_u32 m0, s19, 65536
    v_mfma_f32_16x16x32_bf16 v[72:75], a[236:239], v[28:31], v[72:75]
    s_add_u32 s17, s20, 0
    buffer_load_dwordx4 v2, s[4:7], s17 offen lds
    s_waitcnt lgkmcnt(6)
    v_mfma_f32_16x16x32_bf16 v[76:79], a[232:235], v[32:35], v[76:79]
    ds_read_b128 v[28:31], v11 offset:0
    v_mfma_f32_16x16x32_bf16 v[80:83], a[236:239], v[32:35], v[80:83]
    s_waitcnt lgkmcnt(6)
    v_mfma_f32_16x16x32_bf16 v[68:71], a[240:243], v[36:39], v[68:71]
    ds_read_b128 v[32:35], v11 offset:256
    s_add_u32 m0, s19, 69632
    v_mfma_f32_16x16x32_bf16 v[72:75], a[244:247], v[36:39], v[72:75]
    s_add_u32 s17, s20, 264192
    buffer_load_dwordx4 v2, s[4:7], s17 offen lds
    s_waitcnt lgkmcnt(6)
    v_mfma_f32_16x16x32_bf16 v[76:79], a[240:243], v[40:43], v[76:79]
    ds_read_b128 v[36:39], v10 offset:4096
    v_mfma_f32_16x16x32_bf16 v[80:83], a[244:247], v[40:43], v[80:83]
    s_waitcnt lgkmcnt(6)
    v_mfma_f32_16x16x32_bf16 v[68:71], a[248:251], v[44:47], v[68:71]
    ds_read_b128 v[40:43], v10 offset:4352
    s_add_u32 m0, s19, 73728
    v_mfma_f32_16x16x32_bf16 v[72:75], a[252:255], v[44:47], v[72:75]
    s_add_u32 s17, s20, 528384
    buffer_load_dwordx4 v2, s[4:7], s17 offen lds
    s_waitcnt lgkmcnt(6)
    v_mfma_f32_16x16x32_bf16 v[76:79], a[248:251], v[48:51], v[76:79]
    ds_read_b128 v[44:47], v11 offset:4096
    v_mfma_f32_16x16x32_bf16 v[80:83], a[252:255], v[48:51], v[80:83]
    s_add_u32 s22, s22, 2
    s_cmp_lt_u32 s22, 16
    s_cbranch_scc1 F3_top
    v_cvt_pk_bf16_f32 v84, v68, v69
    v_cvt_pk_bf16_f32 v85, v70, v71
    v_cvt_pk_bf16_f32 v86, v72, v73
    v_cvt_pk_bf16_f32 v87, v74, v75
    v_cvt_pk_bf16_f32 v88, v76, v77
    v_cvt_pk_bf16_f32 v89, v78, v79
    v_cvt_pk_bf16_f32 v90, v80, v81
    v_cvt_pk_bf16_f32 v91, v82, v83
    buffer_store_dwordx4 v[84:87], v3, s[12:15], s21 offen
    buffer_store_dwordx4 v[88:91], v4, s[12:15], s21 offen
    s_waitcnt vmcnt(0) lgkmcnt(0)
    s_branch W_T
W_T:
    v_and_b32 v7, 19, v1
    v_bfe_u32 v5, v1, 2, 1
    v_bfe_u32 v6, v1, 3, 1
    v_lshl_add_u32 v7, v5, 3, v7
    v_lshl_add_u32 v7, v6, 2, v7
    v_lshrrev_b32 v5, 5, v1
    v_and_b32 v6, 31, v1
    v_lshlrev_b32 v8, 4, v5
    v_lshl_add_u32 v10, v6, 6, v8
    v_lshl_add_u32 v11, v7, 6, v8
    v_mov_b32 v17, 1073741824
    v_cmp_gt_u32 vcc, 8, v6
    s_nop 1
    v_cndmask_b32 v12, v17, v10, vcc
    v_lshlrev_b32 v13, 3, v5
    v_lshl_add_u32 v13, v7, 4, v13
    v_and_b32 v14, 15, v1
    v_lshlrev_b32 v14, 4, v14
    v_lshl_add_u32 v14, v5, 8, v14
    v_bfe_u32 v8, v1, 4, 1
    v_lshl_add_u32 v14, v8, 18, v14
    v_lshrrev_b32 v15, 2, v1
    v_and_b32 v8, 3, v1
    v_lshl_add_u32 v15, v15, 7, v8
    s_lshl_b32 s17, s93, 2
    v_add_u32 v15, s17, v15
    v_lshlrev_b32 v15, 7, v15
    v_add_u32 v15, 100663296, v15
    v_cmp_gt_u32 vcc, 16, v1
    s_nop 1
    v_cndmask_b32 v15, v17, v15, vcc
    v_mov_b32 v16, 0
    s_add_u32 s18, s16, s17
    s_lshl_b32 s18, s18, 7
    s_add_u32 s18, s18, 100728832
    v_lshl_add_u32 v4, v1, 2, s18
    v_cmp_gt_u32 vcc, 32, v1
    s_nop 1
    v_cndmask_b32 v4, v17, v4, vcc
    v_lshlrev_b32 v5, 3, v5
    v_sub_u32 v6, v6, v5
    s_mov_b32 s29, 1040356334
    s_mov_b32 s28, s16
    s_mul_i32 s31, s17, 133120
    s_lshl_b32 s18, s28, 11
    s_add_u32 s31, s31, s18
    s_mul_i32 s32, s17, 33280
    s_lshl_b32 s18, s28, 9
    s_add_u32 s32, s32, s18
    s_add_u32 s32, s32, 71303168
    s_lshl_b32 s33, s28, 18
    s_lshl_b32 s18, s93, 12
    s_add_u32 s33, s33, s18
    s_add_u32 s33, s33, 54525952
    v_mov_b32 v17, 0xff800000
    s_mov_b32 s35, 0
    v_mov_b32 v9, 0
    s_lshl_b32 s33, s28, 19
    s_lshr_b32 s18, s93, 1
    s_lshl_b32 s18, s18, 14
    s_add_u32 s33, s33, s18
    s_and_b32 s18, s93, 1
    s_lshl_b32 s18, s18, 12
    s_add_u32 s33, s33, s18
    s_add_u32 s33, s33, 201334784
    s_xor_b32 s33, s33, s89
    v_and_b32 v10, 31, v1
    v_lshlrev_b32 v10, 5, v10
    v_lshl_add_u32 v10, v5, 1, v10
    v_lshlrev_b32 v11, 5, v7
    v_lshl_add_u32 v11, v5, 1, v11
    v_cmp_le_i32 s[36:37], 0, v6
    v_cmp_le_i32 s[38:39], 1, v6
    v_cmp_le_i32 s[40:41], 2, v6
    v_cmp_le_i32 s[42:43], 3, v6
    v_cmp_le_i32 s[44:45], 4, v6
    v_cmp_le_i32 s[46:47], 5, v6
    v_cmp_le_i32 s[48:49], 6, v6
    v_cmp_le_i32 s[50:51], 7, v6
    v_cmp_le_i32 s[52:53], 16, v6
    v_cmp_le_i32 s[54:55], 17, v6
    v_cmp_le_i32 s[56:57], 18, v6
    v_cmp_le_i32 s[58:59], 19, v6
    v_cmp_le_i32 s[60:61], 20, v6
    v_cmp_le_i32 s[62:63], 21, v6
    v_cmp_le_i32 s[64:65], 22, v6
    v_cmp_le_i32 s[66:67], 23, v6
    v_mov_b32 v54, 0
    v_mov_b32 v55, 0
    v_mov_b32 v58, 0
    v_mov_b32 v59, 0
    v_mov_b32 v62, 0
    v_mov_b32 v63, 0
    v_mov_b32 v66, 0
    v_mov_b32 v67, 0
    v_mov_b32 v102, 0
    v_mov_b32 v103, 0
    v_mov_b32 v106, 0
    v_mov_b32 v107, 0
    v_mov_b32 v110, 0
    v_mov_b32 v111, 0
    v_mov_b32 v114, 0
    v_mov_b32 v115, 0
    v_mov_b32 v158, 0
    v_mov_b32 v159, 0
    s_mov_b32 s30, s92
T_p:
    v_cmp_ge_u32 vcc, s28, v16
    s_nop 0
    s_and_b32 s17, vcc_lo, 4095
    s_cbranch_scc0 T_pk
    s_cmp_ge_u32 s30, 1048576
    s_cselect_b32 s92, 1048576, s92
    s_cbranch_scc1 T_pk
    s_add_u32 s30, s30, 1
    buffer_load_dword v16, v15, s[4:7], 0 offen sc1
    s_sleep 8
    s_waitcnt vmcnt(0)
    s_branch T_p
T_pk:
    s_add_u32 s17, s31, 0
    buffer_load_dwordx4 a[0:3], v10, s[4:7], s17 offen offset:0
    buffer_load_dwordx4 a[4:7], v10, s[4:7], s17 offen offset:1024
    s_add_u32 s17, s31, 133120
    buffer_load_dwordx4 a[8:11], v10, s[4:7], s17 offen offset:0
    buffer_load_dwordx4 a[12:15], v10, s[4:7], s17 offen offset:1024
    s_add_u32 s17, s31, 266240
    buffer_load_dwordx4 a[16:19], v10, s[4:7], s17 offen offset:0
    buffer_load_dwordx4 a[20:23], v10, s[4:7], s17 offen offset:1024
    s_add_u32 s17, s31, 399360
    buffer_load_dwordx4 a[24:27], v10, s[4:7], s17 offen offset:0
    buffer_load_dwordx4 a[28:31], v10, s[4:7], s17 offen offset:1024
    s_add_u32 s17, s31, 17825792
    buffer_load_dwordx4 a[32:35], v11, s[4:7], s17 offen offset:0
    buffer_load_dwordx4 a[36:39], v11, s[4:7], s17 offen offset:1024
    s_add_u32 s17, s31, 17958912
    buffer_load_dwordx4 a[40:43], v11, s[4:7], s17 offen offset:0
    buffer_load_dwordx4 a[44:47], v11, s[4:7], s17 offen offset:1024
    s_add_u32 s17, s31, 18092032
    buffer_load_dwordx4 a[48:51], v11, s[4:7], s17 offen offset:0
    buffer_load_dwordx4 a[52:55], v11, s[4:7], s17 offen offset:1024
    s_add_u32 s17, s31, 18225152
    buffer_load_dwordx4 a[56:59], v11, s[4:7], s17 offen offset:0
    buffer_load_dwordx4 a[60:63], v11, s[4:7], s17 offen offset:1024
    s_add_u32 s17, s31, 35651584
    buffer_load_dwordx4 a[64:67], v11, s[4:7], s17 offen offset:0
    buffer_load_dwordx4 a[68:71], v11, s[4:7], s17 offen offset:1024
    s_add_u32 s17, s31, 35784704
    buffer_load_dwordx4 a[72:75], v11, s[4:7], s17 offen offset:0
    buffer_load_dwordx4 a[76:79], v11, s[4:7], s17 offen offset:1024
    s_add_u32 s17, s31, 35917824
    buffer_load_dwordx4 a[80:83], v11, s[4:7], s17 offen offset:0
    buffer_load_dwordx4 a[84:87], v11, s[4:7], s17 offen offset:1024
    s_add_u32 s17, s31, 36050944
    buffer_load_dwordx4 a[88:91], v11, s[4:7], s17 offen offset:0
    buffer_load_dwordx4 a[92:95], v11, s[4:7], s17 offen offset:1024
T_top0:
    s_cmp_eq_u32 s35, 0
    s_cbranch_scc1 T_slow0
T_go0:
    s_add_u32 s34, s28, 4
    s_min_u32 s68, s34, 63
    s_waitcnt vmcnt(8)
    v_cmp_ge_u32 vcc, s68, v16
    s_nop 0
    s_and_b32 s17, vcc_lo, 0xfff
    s_cbranch_scc1 T_pw0
T_pok0:
    s_add_u32 s31, s31, 8192
    s_add_u32 s32, s32, 2048
    s_and_b32 s17, vcc_lo, 61440
    s_cselect_b32 s35, 0, 1
    s_cselect_b32 s69, 1073741824, s32
    s_cmp_lt_u32 s34, 64
    s_cselect_b32 s68, s31, 1073741824
    s_cselect_b32 s69, s69, 1073741824
    buffer_load_dword v16, v15, s[4:7], 0 offen sc1
    v_mfma_f32_32x32x16_bf16 v[116:131], a[32:35], a[0:3], 0
    s_add_u32 s17, s68, 0
    buffer_load_dwordx4 a[96:99], v10, s[4:7], s17 offen offset:0
    buffer_load_dwordx4 a[100:103], v10, s[4:7], s17 offen offset:1024
    v_mfma_f32_32x32x16_bf16 v[116:131], a[36:39], a[4:7], v[116:131]
    s_add_u32 s17, s68, 133120
    buffer_load_dwordx4 a[104:107], v10, s[4:7], s17 offen offset:0
    buffer_load_dwordx4 a[108:111], v10, s[4:7], s17 offen offset:1024
    v_mfma_f32_32x32x16_bf16 v[116:131], a[40:43], a[8:11], v[116:131]
    s_add_u32 s17, s68, 266240
    buffer_load_dwordx4 a[112:115], v10, s[4:7], s17 offen offset:0
    buffer_load_dwordx4 a[116:119], v10, s[4:7], s17 offen offset:1024
    v_mfma_f32_32x32x16_bf16 v[116:131], a[44:47], a[12:15], v[116:131]
    s_add_u32 s17, s68, 399360
    buffer_load_dwordx4 a[120:123], v10, s[4:7], s17 offen offset:0
    buffer_load_dwordx4 a[124:127], v10, s[4:7], s17 offen offset:1024
    v_mfma_f32_32x32x16_bf16 v[116:131], a[48:51], a[16:19], v[116:131]
    s_add_u32 s17, s68, 17825792
    buffer_load_dwordx4 a[128:131], v11, s[4:7], s17 offen offset:0
    buffer_load_dwordx4 a[132:135], v11, s[4:7], s17 offen offset:1024
    v_mfma_f32_32x32x16_bf16 v[116:131], a[52:55], a[20:23], v[116:131]
    s_add_u32 s17, s68, 17958912
    buffer_load_dwordx4 a[136:139], v11, s[4:7], s17 offen offset:0
    buffer_load_dwordx4 a[140:143], v11, s[4:7], s17 offen offset:1024
    v_mfma_f32_32x32x16_bf16 v[116:131], a[56:59], a[24:27], v[116:131]
    s_add_u32 s17, s68, 18092032
    buffer_load_dwordx4 a[144:147], v11, s[4:7], s17 offen offset:0
    buffer_load_dwordx4 a[148:151], v11, s[4:7], s17 offen offset:1024
    v_mfma_f32_32x32x16_bf16 v[116:131], a[60:63], a[28:31], v[116:131]
    s_add_u32 s17, s68, 18225152
    buffer_load_dwordx4 a[152:155], v11, s[4:7], s17 offen offset:0
    buffer_load_dwordx4 a[156:159], v11, s[4:7], s17 offen offset:1024
    v_mfma_f32_32x32x16_bf16 v[132:147], v[20:23], a[0:3], 0
    s_add_u32 s17, s68, 35651584
    buffer_load_dwordx4 a[160:163], v11, s[4:7], s17 offen offset:0
    buffer_load_dwordx4 a[164:167], v11, s[4:7], s17 offen offset:1024
    v_mfma_f32_32x32x16_bf16 v[132:147], v[24:27], a[4:7], v[132:147]
    s_add_u32 s17, s68, 35784704
    buffer_load_dwordx4 a[168:171], v11, s[4:7], s17 offen offset:0
    buffer_load_dwordx4 a[172:175], v11, s[4:7], s17 offen offset:1024
    v_mfma_f32_32x32x16_bf16 v[132:147], v[28:31], a[8:11], v[132:147]
    s_add_u32 s17, s68, 35917824
    buffer_load_dwordx4 a[176:179], v11, s[4:7], s17 offen offset:0
    buffer_load_dwordx4 a[180:183], v11, s[4:7], s17 offen offset:1024
    v_mfma_f32_32x32x16_bf16 v[132:147], v[32:35], a[12:15], v[132:147]
    s_add_u32 s17, s68, 36050944
    buffer_load_dwordx4 a[184:187], v11, s[4:7], s17 offen offset:0
    buffer_load_dwordx4 a[188:191], v11, s[4:7], s17 offen offset:1024
    v_mfma_f32_32x32x16_bf16 v[132:147], v[36:39], a[16:19], v[132:147]
    s_add_u32 s17, s69, 0
    s_add_u32 s18, s69, 5242880
    buffer_load_dwordx4 v[68:71], v12, s[4:7], s17 offen offset:0
    buffer_load_dwordx4 v[72:75], v12, s[4:7], s17 offen offset:32
    buffer_load_dwordx2 v[100:101], v13, s[4:7], s18 offen
    v_mfma_f32_32x32x16_bf16 v[132:147], v[40:43], a[20:23], v[132:147]
    s_add_u32 s17, s69, 33280
    s_add_u32 s18, s69, 5276160
    buffer_load_dwordx4 v[76:79], v12, s[4:7], s17 offen offset:0
    buffer_load_dwordx4 v[80:83], v12, s[4:7], s17 offen offset:32
    buffer_load_dwordx2 v[104:105], v13, s[4:7], s18 offen
    v_mfma_f32_32x32x16_bf16 v[132:147], v[44:47], a[24:27], v[132:147]
    s_add_u32 s17, s69, 66560
    s_add_u32 s18, s69, 5309440
    buffer_load_dwordx4 v[84:87], v12, s[4:7], s17 offen offset:0
    buffer_load_dwordx4 v[88:91], v12, s[4:7], s17 offen offset:32
    buffer_load_dwordx2 v[108:109], v13, s[4:7], s18 offen
    v_mfma_f32_32x32x16_bf16 v[132:147], v[48:51], a[28:31], v[132:147]
    s_add_u32 s17, s69, 99840
    s_add_u32 s18, s69, 5342720
    buffer_load_dwordx4 v[92:95], v12, s[4:7], s17 offen offset:0
    buffer_load_dwordx4 v[96:99], v12, s[4:7], s17 offen offset:32
    buffer_load_dwordx2 v[112:113], v13, s[4:7], s18 offen
    v_cndmask_b32 v116, v17, v116, s[36:37]
    v_cndmask_b32 v117, v17, v117, s[38:39]
    v_cndmask_b32 v118, v17, v118, s[40:41]
    v_cndmask_b32 v119, v17, v119, s[42:43]
    v_cndmask_b32 v120, v17, v120, s[44:45]
    v_cndmask_b32 v121, v17, v121, s[46:47]
    v_cndmask_b32 v122, v17, v122, s[48:49]
    v_cndmask_b32 v123, v17, v123, s[50:51]
    v_cndmask_b32 v124, v17, v124, s[52:53]
    v_cndmask_b32 v125, v17, v125, s[54:55]
    v_cndmask_b32 v126, v17, v126, s[56:57]
    v_cndmask_b32 v127, v17, v127, s[58:59]
    v_cndmask_b32 v128, v17, v128, s[60:61]
    v_cndmask_b32 v129, v17, v129, s[62:63]
    v_cndmask_b32 v130, v17, v130, s[64:65]
    v_cndmask_b32 v131, v17, v131, s[66:67]
    v_max3_f32 v18, v116, v117, v118
    v_max3_f32 v18, v18, v119, v120
    v_max3_f32 v18, v18, v121, v122
    v_max3_f32 v18, v18, v123, v124
    v_max3_f32 v18, v18, v125, v126
    v_max3_f32 v18, v18, v127, v128
    v_max3_f32 v18, v18, v129, v130
    v_max3_f32 v18, v18, v131, v132
    v_max3_f32 v18, v18, v133, v134
    v_max_f32 v18, v18, v135
    v_mov_b32 v5, v18
    s_nop 1
    v_permlane32_swap_b32 v18, v5
    v_max_f32 v18, v18, v5
    v_mul_f32 v18, s29, v18
    v_fma_f32 v116, v116, s29, -v18
    v_fma_f32 v117, v117, s29, -v18
    v_fma_f32 v118, v118, s29, -v18
    v_fma_f32 v119, v119, s29, -v18
    v_fma_f32 v120, v120, s29, -v18
    v_fma_f32 v121, v121, s29, -v18
    v_fma_f32 v122, v122, s29, -v18
    v_fma_f32 v123, v123, s29, -v18
    v_fma_f32 v124, v124, s29, -v18
    v_fma_f32 v125, v125, s29, -v18
    v_fma_f32 v126, v126, s29, -v18
    v_fma_f32 v127, v127, s29, -v18
    v_fma_f32 v128, v128, s29, -v18
    v_fma_f32 v129, v129, s29, -v18
    v_fma_f32 v130, v130, s29, -v18
    v_fma_f32 v131, v131, s29, -v18
    v_fma_f32 v132, v132, s29, -v18
    v_fma_f32 v133, v133, s29, -v18
    v_fma_f32 v134, v134, s29, -v18
    v_fma_f32 v135, v135, s29, -v18
    v_exp_f32 v116, v116
    v_exp_f32 v117, v117
    v_exp_f32 v118, v118
    v_exp_f32 v119, v119
    v_exp_f32 v120, v120
    v_exp_f32 v121, v121
    v_exp_f32 v122, v122
    v_exp_f32 v123, v123
    v_exp_f32 v124, v124
    v_exp_f32 v125, v125
    v_exp_f32 v126, v126
    v_exp_f32 v127, v127
    v_exp_f32 v128, v128
    v_exp_f32 v129, v129
    v_exp_f32 v130, v130
    v_exp_f32 v131, v131
    v_exp_f32 v132, v132
    v_exp_f32 v133, v133
    v_exp_f32 v134, v134
    v_exp_f32 v135, v135
    s_waitcnt vmcnt(37)
    buffer_store_dword v9, v4, s[4:7], 0 offen sc1
    v_add_f32 v19, v116, v117
    v_add_f32 v6, v118, v119
    v_add_f32 v19, v19, v120
    v_add_f32 v6, v6, v121
    v_add_f32 v19, v19, v122
    v_add_f32 v6, v6, v123
    v_add_f32 v19, v19, v124
    v_add_f32 v6, v6, v125
    v_add_f32 v19, v19, v126
    v_add_f32 v6, v6, v127
    v_add_f32 v19, v19, v128
    v_add_f32 v6, v6, v129
    v_add_f32 v19, v19, v130
    v_add_f32 v6, v6, v131
    v_add_f32 v19, v19, v132
    v_add_f32 v6, v6, v133
    v_add_f32 v19, v19, v134
    v_add_f32 v6, v6, v135
    v_add_f32 v19, v19, v6
    v_mov_b32 v5, v19
    s_nop 1
    v_permlane32_swap_b32 v19, v5
    v_add_f32 v19, v19, v5
    v_rcp_f32 v19, v19
    s_nop 0
    v_mul_f32 v116, v116, v19
    v_mul_f32 v117, v117, v19
    v_mul_f32 v118, v118, v19
    v_mul_f32 v119, v119, v19
    v_mul_f32 v120, v120, v19
    v_mul_f32 v121, v121, v19
    v_mul_f32 v122, v122, v19
    v_mul_f32 v123, v123, v19
    v_mul_f32 v124, v124, v19
    v_mul_f32 v125, v125, v19
    v_mul_f32 v126, v126, v19
    v_mul_f32 v127, v127, v19
    v_mul_f32 v128, v128, v19
    v_mul_f32 v129, v129, v19
    v_mul_f32 v130, v130, v19
    v_mul_f32 v131, v131, v19
    v_mul_f32 v132, v132, v19
    v_mul_f32 v133, v133, v19
    v_mul_f32 v134, v134, v19
    v_mul_f32 v135, v135, v19
    v_cvt_pk_bf16_f32 v148, v116, v117
    v_cvt_pk_bf16_f32 v149, v118, v119
    v_cvt_pk_bf16_f32 v150, v120, v121
    v_cvt_pk_bf16_f32 v151, v122, v123
    v_cvt_pk_bf16_f32 v152, v124, v125
    v_cvt_pk_bf16_f32 v153, v126, v127
    v_cvt_pk_bf16_f32 v154, v128, v129
    v_cvt_pk_bf16_f32 v155, v130, v131
    v_cvt_pk_bf16_f32 v156, v132, v133
    v_cvt_pk_bf16_f32 v157, v134, v135
    v_mfma_f32_32x32x16_bf16 v[160:175], a[64:67], v[148:151], 0
    v_mfma_f32_32x32x16_bf16 v[160:175], a[68:71], v[152:155], v[160:175]
    v_mfma_f32_32x32x16_bf16 v[160:175], v[52:55], v[156:159], v[160:175]
    v_mfma_f32_32x32x16_bf16 v[176:191], a[72:75], v[148:151], 0
    v_mfma_f32_32x32x16_bf16 v[176:191], a[76:79], v[152:155], v[176:191]
    v_mfma_f32_32x32x16_bf16 v[176:191], v[56:59], v[156:159], v[176:191]
    s_nop 2
    v_cvt_pk_bf16_f32 v224, v160, v161
    v_cvt_pk_bf16_f32 v225, v162, v163
    v_cvt_pk_bf16_f32 v226, v164, v165
    v_cvt_pk_bf16_f32 v227, v166, v167
    v_cvt_pk_bf16_f32 v228, v168, v169
    v_cvt_pk_bf16_f32 v229, v170, v171
    v_cvt_pk_bf16_f32 v230, v172, v173
    v_cvt_pk_bf16_f32 v231, v174, v175
    buffer_store_dwordx4 v[224:227], v14, s[4:7], s33 offen offset:0 sc1
    buffer_store_dwordx4 v[228:231], v14, s[4:7], s33 offen offset:512 sc1
    v_mfma_f32_32x32x16_bf16 v[192:207], a[80:83], v[148:151], 0
    v_mfma_f32_32x32x16_bf16 v[192:207], a[84:87], v[152:155], v[192:207]
    v_mfma_f32_32x32x16_bf16 v[192:207], v[60:63], v[156:159], v[192:207]
    v_cvt_pk_bf16_f32 v232, v176, v177
    v_cvt_pk_bf16_f32 v233, v178, v179
    v_cvt_pk_bf16_f32 v234, v180, v181
    v_cvt_pk_bf16_f32 v235, v182, v183
    v_cvt_pk_bf16_f32 v236, v184, v185
    v_cvt_pk_bf16_f32 v237, v186, v187
    v_cvt_pk_bf16_f32 v238, v188, v189
    v_cvt_pk_bf16_f32 v239, v190, v191
    buffer_store_dwordx4 v[232:235], v14, s[4:7], s33 offen offset:1024 sc1
    buffer_store_dwordx4 v[236:239], v14, s[4:7], s33 offen offset:1536 sc1
    v_mfma_f32_32x32x16_bf16 v[208:223], a[88:91], v[148:151], 0
    v_mfma_f32_32x32x16_bf16 v[208:223], a[92:95], v[152:155], v[208:223]
    v_mfma_f32_32x32x16_bf16 v[208:223], v[64:67], v[156:159], v[208:223]
    v_cvt_pk_bf16_f32 v240, v192, v193
    v_cvt_pk_bf16_f32 v241, v194, v195
    v_cvt_pk_bf16_f32 v242, v196, v197
    v_cvt_pk_bf16_f32 v243, v198, v199
    v_cvt_pk_bf16_f32 v244, v200, v201
    v_cvt_pk_bf16_f32 v245, v202, v203
    v_cvt_pk_bf16_f32 v246, v204, v205
    v_cvt_pk_bf16_f32 v247, v206, v207
    buffer_store_dwordx4 v[240:243], v14, s[4:7], s33 offen offset:2048 sc1
    buffer_store_dwordx4 v[244:247], v14, s[4:7], s33 offen offset:2560 sc1
    v_add_u32 v9, 1, v9
    s_nop 0
    v_cvt_pk_bf16_f32 v248, v208, v209
    v_cvt_pk_bf16_f32 v249, v210, v211
    v_cvt_pk_bf16_f32 v250, v212, v213
    v_cvt_pk_bf16_f32 v251, v214, v215
    v_cvt_pk_bf16_f32 v252, v216, v217
    v_cvt_pk_bf16_f32 v253, v218, v219
    v_cvt_pk_bf16_f32 v254, v220, v221
    v_cvt_pk_bf16_f32 v255, v222, v223
    buffer_store_dwordx4 v[248:251], v14, s[4:7], s33 offen offset:3072 sc1
    buffer_store_dwordx4 v[252:255], v14, s[4:7], s33 offen offset:3584 sc1
    s_mov_b32 s28, s34
    s_add_u32 s33, s33, 2097152
    s_xor_b32 s33, s33, 8192
T_top1:
    s_cmp_eq_u32 s35, 0
    s_cbranch_scc1 T_slow1
T_go1:
    s_add_u32 s34, s28, 4
    s_min_u32 s68, s34, 63
    s_waitcnt vmcnt(8)
    v_cmp_ge_u32 vcc, s68, v16
    s_nop 0
    s_and_b32 s17, vcc_lo, 0xfff
    s_cbranch_scc1 T_pw1
T_pok1:
    s_add_u32 s31, s31, 8192
    s_add_u32 s32, s32, 2048
    s_and_b32 s17, vcc_lo, 61440
    s_cselect_b32 s35, 0, 1
    s_cselect_b32 s69, 1073741824, s32
    s_cmp_lt_u32 s34, 64
    s_cselect_b32 s68, s31, 1073741824
    s_cselect_b32 s69, s69, 1073741824
    buffer_load_dword v16, v15, s[4:7], 0 offen sc1
    v_mfma_f32_32x32x16_bf16 v[116:131], a[128:131], a[96:99], 0
    s_add_u32 s17, s68, 0
    buffer_load_dwordx4 a[0:3], v10, s[4:7], s17 offen offset:0
    buffer_load_dwordx4 a[4:7], v10, s[4:7], s17 offen offset:1024
    v_mfma_f32_32x32x16_bf16 v[116:131], a[132:135], a[100:103], v[116:131]
    s_add_u32 s17, s68, 133120
    buffer_load_dwordx4 a[8:11], v10, s[4:7], s17 offen offset:0
    buffer_load_dwordx4 a[12:15], v10, s[4:7], s17 offen offset:1024
    v_mfma_f32_32x32x16_bf16 v[116:131], a[136:139], a[104:107], v[116:131]
    s_add_u32 s17, s68, 266240
    buffer_load_dwordx4 a[16:19], v10, s[4:7], s17 offen offset:0
    buffer_load_dwordx4 a[20:23], v10, s[4:7], s17 offen offset:1024
    v_mfma_f32_32x32x16_bf16 v[116:131], a[140:143], a[108:111], v[116:131]
    s_add_u32 s17, s68, 399360
    buffer_load_dwordx4 a[24:27], v10, s[4:7], s17 offen offset:0
    buffer_load_dwordx4 a[28:31], v10, s[4:7], s17 offen offset:1024
    v_mfma_f32_32x32x16_bf16 v[116:131], a[144:147], a[112:115], v[116:131]
    s_add_u32 s17, s68, 17825792
    buffer_load_dwordx4 a[32:35], v11, s[4:7], s17 offen offset:0
    buffer_load_dwordx4 a[36:39], v11, s[4:7], s17 offen offset:1024
    v_mfma_f32_32x32x16_bf16 v[116:131], a[148:151], a[116:119], v[116:131]
    s_add_u32 s17, s68, 17958912
    buffer_load_dwordx4 a[40:43], v11, s[4:7], s17 offen offset:0
    buffer_load_dwordx4 a[44:47], v11, s[4:7], s17 offen offset:1024
    v_mfma_f32_32x32x16_bf16 v[116:131], a[152:155], a[120:123], v[116:131]
    s_add_u32 s17, s68, 18092032
    buffer_load_dwordx4 a[48:51], v11, s[4:7], s17 offen offset:0
    buffer_load_dwordx4 a[52:55], v11, s[4:7], s17 offen offset:1024
    v_mfma_f32_32x32x16_bf16 v[116:131], a[156:159], a[124:127], v[116:131]
    s_add_u32 s17, s68, 18225152
    buffer_load_dwordx4 a[56:59], v11, s[4:7], s17 offen offset:0
    buffer_load_dwordx4 a[60:63], v11, s[4:7], s17 offen offset:1024
    v_mfma_f32_32x32x16_bf16 v[132:147], v[68:71], a[96:99], 0
    s_add_u32 s17, s68, 35651584
    buffer_load_dwordx4 a[64:67], v11, s[4:7], s17 offen offset:0
    buffer_load_dwordx4 a[68:71], v11, s[4:7], s17 offen offset:1024
    v_mfma_f32_32x32x16_bf16 v[132:147], v[72:75], a[100:103], v[132:147]
    s_add_u32 s17, s68, 35784704
    buffer_load_dwordx4 a[72:75], v11, s[4:7], s17 offen offset:0
    buffer_load_dwordx4 a[76:79], v11, s[4:7], s17 offen offset:1024
    v_mfma_f32_32x32x16_bf16 v[132:147], v[76:79], a[104:107], v[132:147]
    s_add_u32 s17, s68, 35917824
    buffer_load_dwordx4 a[80:83], v11, s[4:7], s17 offen offset:0
    buffer_load_dwordx4 a[84:87], v11, s[4:7], s17 offen offset:1024
    v_mfma_f32_32x32x16_bf16 v[132:147], v[80:83], a[108:111], v[132:147]
    s_add_u32 s17, s68, 36050944
    buffer_load_dwordx4 a[88:91], v11, s[4:7], s17 offen offset:0
    buffer_load_dwordx4 a[92:95], v11, s[4:7], s17 offen offset:1024
    v_mfma_f32_32x32x16_bf16 v[132:147], v[84:87], a[112:115], v[132:147]
    s_add_u32 s17, s69, 0
    s_add_u32 s18, s69, 5242880
    buffer_load_dwordx4 v[20:23], v12, s[4:7], s17 offen offset:0
    buffer_load_dwordx4 v[24:27], v12, s[4:7], s17 offen offset:32
    buffer_load_dwordx2 v[52:53], v13, s[4:7], s18 offen
    v_mfma_f32_32x32x16_bf16 v[132:147], v[88:91], a[116:119], v[132:147]
    s_add_u32 s17, s69, 33280
    s_add_u32 s18, s69, 5276160
    buffer_load_dwordx4 v[28:31], v12, s[4:7], s17 offen offset:0
    buffer_load_dwordx4 v[32:35], v12, s[4:7], s17 offen offset:32
    buffer_load_dwordx2 v[56:57], v13, s[4:7], s18 offen
    v_mfma_f32_32x32x16_bf16 v[132:147], v[92:95], a[120:123], v[132:147]
    s_add_u32 s17, s69, 66560
    s_add_u32 s18, s69, 5309440
    buffer_load_dwordx4 v[36:39], v12, s[4:7], s17 offen offset:0
    buffer_load_dwordx4 v[40:43], v12, s[4:7], s17 offen offset:32
    buffer_load_dwordx2 v[60:61], v13, s[4:7], s18 offen
    v_mfma_f32_32x32x16_bf16 v[132:147], v[96:99], a[124:127], v[132:147]
    s_add_u32 s17, s69, 99840
    s_add_u32 s18, s69, 5342720
    buffer_load_dwordx4 v[44:47], v12, s[4:7], s17 offen offset:0
    buffer_load_dwordx4 v[48:51], v12, s[4:7], s17 offen offset:32
    buffer_load_dwordx2 v[64:65], v13, s[4:7], s18 offen
    v_cndmask_b32 v116, v17, v116, s[36:37]
    v_cndmask_b32 v117, v17, v117, s[38:39]
    v_cndmask_b32 v118, v17, v118, s[40:41]
    v_cndmask_b32 v119, v17, v119, s[42:43]
    v_cndmask_b32 v120, v17, v120, s[44:45]
    v_cndmask_b32 v121, v17, v121, s[46:47]
    v_cndmask_b32 v122, v17, v122, s[48:49]
    v_cndmask_b32 v123, v17, v123, s[50:51]
    v_cndmask_b32 v124, v17, v124, s[52:53]
    v_cndmask_b32 v125, v17, v125, s[54:55]
    v_cndmask_b32 v126, v17, v126, s[56:57]
    v_cndmask_b32 v127, v17, v127, s[58:59]
    v_cndmask_b32 v128, v17, v128, s[60:61]
    v_cndmask_b32 v129, v17, v129, s[62:63]
    v_cndmask_b32 v130, v17, v130, s[64:65]
    v_cndmask_b32 v131, v17, v131, s[66:67]
    v_max3_f32 v18, v116, v117, v118
    v_max3_f32 v18, v18, v119, v120
    v_max3_f32 v18, v18, v121, v122
    v_max3_f32 v18, v18, v123, v124
    v_max3_f32 v18, v18, v125, v126
    v_max3_f32 v18, v18, v127, v128
    v_max3_f32 v18, v18, v129, v130
    v_max3_f32 v18, v18, v131, v132
    v_max3_f32 v18, v18, v133, v134
    v_max_f32 v18, v18, v135
    v_mov_b32 v5, v18
    s_nop 1
    v_permlane32_swap_b32 v18, v5
    v_max_f32 v18, v18, v5
    v_mul_f32 v18, s29, v18
    v_fma_f32 v116, v116, s29, -v18
    v_fma_f32 v117, v117, s29, -v18
    v_fma_f32 v118, v118, s29, -v18
    v_fma_f32 v119, v119, s29, -v18
    v_fma_f32 v120, v120, s29, -v18
    v_fma_f32 v121, v121, s29, -v18
    v_fma_f32 v122, v122, s29, -v18
    v_fma_f32 v123, v123, s29, -v18
    v_fma_f32 v124, v124, s29, -v18
    v_fma_f32 v125, v125, s29, -v18
    v_fma_f32 v126, v126, s29, -v18
    v_fma_f32 v127, v127, s29, -v18
    v_fma_f32 v128, v128, s29, -v18
    v_fma_f32 v129, v129, s29, -v18
    v_fma_f32 v130, v130, s29, -v18
    v_fma_f32 v131, v131, s29, -v18
    v_fma_f32 v132, v132, s29, -v18
    v_fma_f32 v133, v133, s29, -v18
    v_fma_f32 v134, v134, s29, -v18
    v_fma_f32 v135, v135, s29, -v18
    v_exp_f32 v116, v116
    v_exp_f32 v117, v117
    v_exp_f32 v118, v118
    v_exp_f32 v119, v119
    v_exp_f32 v120, v120
    v_exp_f32 v121, v121
    v_exp_f32 v122, v122
    v_exp_f32 v123, v123
    v_exp_f32 v124, v124
    v_exp_f32 v125, v125
    v_exp_f32 v126, v126
    v_exp_f32 v127, v127
    v_exp_f32 v128, v128
    v_exp_f32 v129, v129
    v_exp_f32 v130, v130
    v_exp_f32 v131, v131
    v_exp_f32 v132, v132
    v_exp_f32 v133, v133
    v_exp_f32 v134, v134
    v_exp_f32 v135, v135
    s_waitcnt vmcnt(37)
    buffer_store_dword v9, v4, s[4:7], 0 offen sc1
    v_add_f32 v19, v116, v117
    v_add_f32 v6, v118, v119
    v_add_f32 v19, v19, v120
    v_add_f32 v6, v6, v121
    v_add_f32 v19, v19, v122
    v_add_f32 v6, v6, v123
    v_add_f32 v19, v19, v124
    v_add_f32 v6, v6, v125
    v_add_f32 v19, v19, v126
    v_add_f32 v6, v6, v127
    v_add_f32 v19, v19, v128
    v_add_f32 v6, v6, v129
    v_add_f32 v19, v19, v130
    v_add_f32 v6, v6, v131
    v_add_f32 v19, v19, v132
    v_add_f32 v6, v6, v133
    v_add_f32 v19, v19, v134
    v_add_f32 v6, v6, v135
    v_add_f32 v19, v19, v6
    v_mov_b32 v5, v19
    s_nop 1
    v_permlane32_swap_b32 v19, v5
    v_add_f32 v19, v19, v5
    v_rcp_f32 v19, v19
    s_nop 0
    v_mul_f32 v116, v116, v19
    v_mul_f32 v117, v117, v19
    v_mul_f32 v118, v118, v19
    v_mul_f32 v119, v119, v19
    v_mul_f32 v120, v120, v19
    v_mul_f32 v121, v121, v19
    v_mul_f32 v122, v122, v19
    v_mul_f32 v123, v123, v19
    v_mul_f32 v124, v124, v19
    v_mul_f32 v125, v125, v19
    v_mul_f32 v126, v126, v19
    v_mul_f32 v127, v127, v19
    v_mul_f32 v128, v128, v19
    v_mul_f32 v129, v129, v19
    v_mul_f32 v130, v130, v19
    v_mul_f32 v131, v131, v19
    v_mul_f32 v132, v132, v19
    v_mul_f32 v133, v133, v19
    v_mul_f32 v134, v134, v19
    v_mul_f32 v135, v135, v19
    v_cvt_pk_bf16_f32 v148, v116, v117
    v_cvt_pk_bf16_f32 v149, v118, v119
    v_cvt_pk_bf16_f32 v150, v120, v121
    v_cvt_pk_bf16_f32 v151, v122, v123
    v_cvt_pk_bf16_f32 v152, v124, v125
    v_cvt_pk_bf16_f32 v153, v126, v127
    v_cvt_pk_bf16_f32 v154, v128, v129
    v_cvt_pk_bf16_f32 v155, v130, v131
    v_cvt_pk_bf16_f32 v156, v132, v133
    v_cvt_pk_bf16_f32 v157, v134, v135
    v_mfma_f32_32x32x16_bf16 v[160:175], a[160:163], v[148:151], 0
    v_mfma_f32_32x32x16_bf16 v[160:175], a[164:167], v[152:155], v[160:175]
    v_mfma_f32_32x32x16_bf16 v[160:175], v[100:103], v[156:159], v[160:175]
    v_mfma_f32_32x32x16_bf16 v[176:191], a[168:171], v[148:151], 0
    v_mfma_f32_32x32x16_bf16 v[176:191], a[172:175], v[152:155], v[176:191]
    v_mfma_f32_32x32x16_bf16 v[176:191], v[104:107], v[156:159], v[176:191]
    s_nop 2
    v_cvt_pk_bf16_f32 v224, v160, v161
    v_cvt_pk_bf16_f32 v225, v162, v163
    v_cvt_pk_bf16_f32 v226, v164, v165
    v_cvt_pk_bf16_f32 v227, v166, v167
    v_cvt_pk_bf16_f32 v228, v168, v169
    v_cvt_pk_bf16_f32 v229, v170, v171
    v_cvt_pk_bf16_f32 v230, v172, v173
    v_cvt_pk_bf16_f32 v231, v174, v175
    buffer_store_dwordx4 v[224:227], v14, s[4:7], s33 offen offset:0 sc1
    buffer_store_dwordx4 v[228:231], v14, s[4:7], s33 offen offset:512 sc1
    v_mfma_f32_32x32x16_bf16 v[192:207], a[176:179], v[148:151], 0
    v_mfma_f32_32x32x16_bf16 v[192:207], a[180:183], v[152:155], v[192:207]
    v_mfma_f32_32x32x16_bf16 v[192:207], v[108:111], v[156:159], v[192:207]
    v_cvt_pk_bf16_f32 v232, v176, v177
    v_cvt_pk_bf16_f32 v233, v178, v179
    v_cvt_pk_bf16_f32 v234, v180, v181
    v_cvt_pk_bf16_f32 v235, v182, v183
    v_cvt_pk_bf16_f32 v236, v184, v185
    v_cvt_pk_bf16_f32 v237, v186, v187
    v_cvt_pk_bf16_f32 v238, v188, v189
    v_cvt_pk_bf16_f32 v239, v190, v191
    buffer_store_dwordx4 v[232:235], v14, s[4:7], s33 offen offset:1024 sc1
    buffer_store_dwordx4 v[236:239], v14, s[4:7], s33 offen offset:1536 sc1
    v_mfma_f32_32x32x16_bf16 v[208:223], a[184:187], v[148:151], 0
    v_mfma_f32_32x32x16_bf16 v[208:223], a[188:191], v[152:155], v[208:223]
    v_mfma_f32_32x32x16_bf16 v[208:223], v[112:115], v[156:159], v[208:223]
    v_cvt_pk_bf16_f32 v240, v192, v193
    v_cvt_pk_bf16_f32 v241, v194, v195
    v_cvt_pk_bf16_f32 v242, v196, v197
    v_cvt_pk_bf16_f32 v243, v198, v199
    v_cvt_pk_bf16_f32 v244, v200, v201
    v_cvt_pk_bf16_f32 v245, v202, v203
    v_cvt_pk_bf16_f32 v246, v204, v205
    v_cvt_pk_bf16_f32 v247, v206, v207
    buffer_store_dwordx4 v[240:243], v14, s[4:7], s33 offen offset:2048 sc1
    buffer_store_dwordx4 v[244:247], v14, s[4:7], s33 offen offset:2560 sc1
    v_add_u32 v9, 1, v9
    s_nop 0
    v_cvt_pk_bf16_f32 v248, v208, v209
    v_cvt_pk_bf16_f32 v249, v210, v211
    v_cvt_pk_bf16_f32 v250, v212, v213
    v_cvt_pk_bf16_f32 v251, v214, v215
    v_cvt_pk_bf16_f32 v252, v216, v217
    v_cvt_pk_bf16_f32 v253, v218, v219
    v_cvt_pk_bf16_f32 v254, v220, v221
    v_cvt_pk_bf16_f32 v255, v222, v223
    buffer_store_dwordx4 v[248:251], v14, s[4:7], s33 offen offset:3072 sc1
    buffer_store_dwordx4 v[252:255], v14, s[4:7], s33 offen offset:3584 sc1
    s_mov_b32 s28, s34
    s_add_u32 s33, s33, 2097152
    s_xor_b32 s33, s33, 8192
    s_cmp_lt_u32 s28, 64
    s_cbranch_scc1 T_top0
T_fin:
    s_waitcnt vmcnt(0)
    buffer_store_dword v9, v4, s[4:7], 0 offen sc1
    s_branch W_fin
T_slow0:
    s_waitcnt vmcnt(0)
    buffer_store_dword v9, v4, s[4:7], 0 offen sc1
    s_mov_b32 s30, s92
T_s0:
    v_cmp_ge_u32 vcc, s28, v16
    s_nop 0
    s_and_b32 s17, vcc_lo, 61440
    s_cbranch_scc0 T_sk0
    s_cmp_ge_u32 s30, 1048576
    s_cselect_b32 s92, 1048576, s92
    s_cbranch_scc1 T_sk0
    s_add_u32 s30, s30, 1
    buffer_load_dword v16, v15, s[4:7], 0 offen sc1
    s_sleep 2
    s_waitcnt vmcnt(0)
    s_branch T_s0
T_sk0:
    s_add_u32 s17, s32, 0
    s_add_u32 s18, s32, 5242880
    buffer_load_dwordx4 v[20:23], v12, s[4:7], s17 offen offset:0
    buffer_load_dwordx4 v[24:27], v12, s[4:7], s17 offen offset:32
    buffer_load_dwordx2 v[52:53], v13, s[4:7], s18 offen
    s_add_u32 s17, s32, 33280
    s_add_u32 s18, s32, 5276160
    buffer_load_dwordx4 v[28:31], v12, s[4:7], s17 offen offset:0
    buffer_load_dwordx4 v[32:35], v12, s[4:7], s17 offen offset:32
    buffer_load_dwordx2 v[56:57], v13, s[4:7], s18 offen
    s_add_u32 s17, s32, 66560
    s_add_u32 s18, s32, 5309440
    buffer_load_dwordx4 v[36:39], v12, s[4:7], s17 offen offset:0
    buffer_load_dwordx4 v[40:43], v12, s[4:7], s17 offen offset:32
    buffer_load_dwordx2 v[60:61], v13, s[4:7], s18 offen
    s_add_u32 s17, s32, 99840
    s_add_u32 s18, s32, 5342720
    buffer_load_dwordx4 v[44:47], v12, s[4:7], s17 offen offset:0
    buffer_load_dwordx4 v[48:51], v12, s[4:7], s17 offen offset:32
    buffer_load_dwordx2 v[64:65], v13, s[4:7], s18 offen
    s_waitcnt vmcnt(0)
    s_branch T_go0
T_pw0:
    s_mov_b32 s30, s92
T_q0:
    v_cmp_ge_u32 vcc, s68, v16
    s_nop 0
    s_and_b32 s17, vcc_lo, 4095
    s_cbranch_scc0 T_pok0
    s_cmp_ge_u32 s30, 1048576
    s_cselect_b32 s92, 1048576, s92
    s_cbranch_scc1 T_pok0
    s_add_u32 s30, s30, 1
    buffer_load_dword v16, v15, s[4:7], 0 offen sc1
    s_sleep 8
    s_waitcnt vmcnt(0)
    s_branch T_q0
T_slow1:
    s_waitcnt vmcnt(0)
    buffer_store_dword v9, v4, s[4:7], 0 offen sc1
    s_cmp_ge_u32 s28, 60
    s_cbranch_scc1 T_last
    s_mov_b32 s30, s92
T_s1:
    v_cmp_ge_u32 vcc, s28, v16
    s_nop 0
    s_and_b32 s17, vcc_lo, 61440
    s_cbranch_scc0 T_sk1
    s_cmp_ge_u32 s30, 1048576
    s_cselect_b32 s92, 1048576, s92
    s_cbranch_scc1 T_sk1
    s_add_u32 s30, s30, 1
    buffer_load_dword v16, v15, s[4:7], 0 offen sc1
    s_sleep 2
    s_waitcnt vmcnt(0)
    s_branch T_s1
T_sk1:
    s_add_u32 s17, s32, 0
    s_add_u32 s18, s32, 5242880
    buffer_load_dwordx4 v[68:71], v12, s[4:7], s17 offen offset:0
    buffer_load_dwordx4 v[72:75], v12, s[4:7], s17 offen offset:32
    buffer_load_dwordx2 v[100:101], v13, s[4:7], s18 offen
    s_add_u32 s17, s32, 33280
    s_add_u32 s18, s32, 5276160
    buffer_load_dwordx4 v[76:79], v12, s[4:7], s17 offen offset:0
    buffer_load_dwordx4 v[80:83], v12, s[4:7], s17 offen offset:32
    buffer_load_dwordx2 v[104:105], v13, s[4:7], s18 offen
    s_add_u32 s17, s32, 66560
    s_add_u32 s18, s32, 5309440
    buffer_load_dwordx4 v[84:87], v12, s[4:7], s17 offen offset:0
    buffer_load_dwordx4 v[88:91], v12, s[4:7], s17 offen offset:32
    buffer_load_dwordx2 v[108:109], v13, s[4:7], s18 offen
    s_add_u32 s17, s32, 99840
    s_add_u32 s18, s32, 5342720
    buffer_load_dwordx4 v[92:95], v12, s[4:7], s17 offen offset:0
    buffer_load_dwordx4 v[96:99], v12, s[4:7], s17 offen offset:32
    buffer_load_dwordx2 v[112:113], v13, s[4:7], s18 offen
    s_waitcnt vmcnt(0)
    s_branch T_go1
T_pw1:
    s_mov_b32 s30, s92
T_q1:
    v_cmp_ge_u32 vcc, s68, v16
    s_nop 0
    s_and_b32 s17, vcc_lo, 4095
    s_cbranch_scc0 T_pok1
    s_cmp_ge_u32 s30, 1048576
    s_cselect_b32 s92, 1048576, s92
    s_cbranch_scc1 T_pok1
    s_add_u32 s30, s30, 1
    buffer_load_dword v16, v15, s[4:7], 0 offen sc1
    s_sleep 8
    s_waitcnt vmcnt(0)
    s_branch T_q1
T_last:
    v_mfma_f32_32x32x16_bf16 v[116:131], a[128:131], a[96:99], 0
    v_mfma_f32_32x32x16_bf16 v[116:131], a[132:135], a[100:103], v[116:131]
    v_mfma_f32_32x32x16_bf16 v[116:131], a[136:139], a[104:107], v[116:131]
    v_mfma_f32_32x32x16_bf16 v[116:131], a[140:143], a[108:111], v[116:131]
    v_mfma_f32_32x32x16_bf16 v[116:131], a[144:147], a[112:115], v[116:131]
    v_mfma_f32_32x32x16_bf16 v[116:131], a[148:151], a[116:119], v[116:131]
    v_mfma_f32_32x32x16_bf16 v[116:131], a[152:155], a[120:123], v[116:131]
    v_mfma_f32_32x32x16_bf16 v[116:131], a[156:159], a[124:127], v[116:131]
    s_nop 11
    v_cndmask_b32 v116, v17, v116, s[36:37]
    v_cndmask_b32 v117, v17, v117, s[38:39]
    v_cndmask_b32 v118, v17, v118, s[40:41]
    v_cndmask_b32 v119, v17, v119, s[42:43]
    v_cndmask_b32 v120, v17, v120, s[44:45]
    v_cndmask_b32 v121, v17, v121, s[46:47]
    v_cndmask_b32 v122, v17, v122, s[48:49]
    v_cndmask_b32 v123, v17, v123, s[50:51]
    v_cndmask_b32 v124, v17, v124, s[52:53]
    v_cndmask_b32 v125, v17, v125, s[54:55]
    v_cndmask_b32 v126, v17, v126, s[56:57]
    v_cndmask_b32 v127, v17, v127, s[58:59]
    v_cndmask_b32 v128, v17, v128, s[60:61]
    v_cndmask_b32 v129, v17, v129, s[62:63]
    v_cndmask_b32 v130, v17, v130, s[64:65]
    v_cndmask_b32 v131, v17, v131, s[66:67]
    v_max3_f32 v20, v116, v117, v118
    v_max3_f32 v20, v20, v119, v120
    v_max3_f32 v20, v20, v121, v122
    v_max3_f32 v20, v20, v123, v124
    v_max3_f32 v20, v20, v125, v126
    v_max3_f32 v20, v20, v127, v128
    v_max3_f32 v20, v20, v129, v130
    v_max_f32 v20, v20, v131
    v_mov_b32 v5, v20
    s_nop 1
    v_permlane32_swap_b32 v20, v5
    v_max_f32 v20, v20, v5
    v_mul_f32 v18, s29, v20
    v_fma_f32 v116, v116, s29, -v18
    v_fma_f32 v117, v117, s29, -v18
    v_fma_f32 v118, v118, s29, -v18
    v_fma_f32 v119, v119, s29, -v18
    v_fma_f32 v120, v120, s29, -v18
    v_fma_f32 v121, v121, s29, -v18
    v_fma_f32 v122, v122, s29, -v18
    v_fma_f32 v123, v123, s29, -v18
    v_fma_f32 v124, v124, s29, -v18
    v_fma_f32 v125, v125, s29, -v18
    v_fma_f32 v126, v126, s29, -v18
    v_fma_f32 v127, v127, s29, -v18
    v_fma_f32 v128, v128, s29, -v18
    v_fma_f32 v129, v129, s29, -v18
    v_fma_f32 v130, v130, s29, -v18
    v_fma_f32 v131, v131, s29, -v18
    v_exp_f32 v116, v116
    v_exp_f32 v117, v117
    v_exp_f32 v118, v118
    v_exp_f32 v119, v119
    v_exp_f32 v120, v120
    v_exp_f32 v121, v121
    v_exp_f32 v122, v122
    v_exp_f32 v123, v123
    v_exp_f32 v124, v124
    v_exp_f32 v125, v125
    v_exp_f32 v126, v126
    v_exp_f32 v127, v127
    v_exp_f32 v128, v128
    v_exp_f32 v129, v129
    v_exp_f32 v130, v130
    v_exp_f32 v131, v131
    v_add_f32 v19, v116, v117
    v_add_f32 v19, v19, v118
    v_add_f32 v19, v19, v119
    v_add_f32 v19, v19, v120
    v_add_f32 v19, v19, v121
    v_add_f32 v19, v19, v122
    v_add_f32 v19, v19, v123
    v_add_f32 v19, v19, v124
    v_add_f32 v19, v19, v125
    v_add_f32 v19, v19, v126
    v_add_f32 v19, v19, v127
    v_add_f32 v19, v19, v128
    v_add_f32 v19, v19, v129
    v_add_f32 v19, v19, v130
    v_add_f32 v19, v19, v131
    v_cvt_pk_bf16_f32 v148, v116, v117
    v_cvt_pk_bf16_f32 v149, v118, v119
    v_cvt_pk_bf16_f32 v150, v120, v121
    v_cvt_pk_bf16_f32 v151, v122, v123
    v_cvt_pk_bf16_f32 v152, v124, v125
    v_cvt_pk_bf16_f32 v153, v126, v127
    v_cvt_pk_bf16_f32 v154, v128, v129
    v_cvt_pk_bf16_f32 v155, v130, v131
    v_mfma_f32_32x32x16_bf16 v[160:175], a[160:163], v[148:151], 0
    s_nop 0
    v_mfma_f32_32x32x16_bf16 v[160:175], a[164:167], v[152:155], v[160:175]
    v_mfma_f32_32x32x16_bf16 v[176:191], a[168:171], v[148:151], 0
    v_mfma_f32_32x32x16_bf16 v[176:191], a[172:175], v[152:155], v[176:191]
    v_mfma_f32_32x32x16_bf16 v[192:207], a[176:179], v[148:151], 0
    v_mfma_f32_32x32x16_bf16 v[192:207], a[180:183], v[152:155], v[192:207]
    v_mfma_f32_32x32x16_bf16 v[208:223], a[184:187], v[148:151], 0
    v_mfma_f32_32x32x16_bf16 v[208:223], a[188:191], v[152:155], v[208:223]
    s_cmp_ge_u32 s28, 61
    s_cselect_b64 s[48:49], 0xffff, 0
    s_sub_u32 s34, s28, 2
    s_add_u32 s36, s32, 0
    s_add_u32 s40, s32, 5242880
    s_add_u32 s37, s32, 33280
    s_add_u32 s41, s32, 5276160
    s_add_u32 s38, s32, 66560
    s_add_u32 s42, s32, 5309440
    s_add_u32 s39, s32, 99840
    s_add_u32 s43, s32, 5342720
    v_add_u32 v9, 1, v9
    s_mov_b32 s30, s92
T_l0:
    v_cmp_ge_u32 vcc, s34, v16
    s_nop 0
    s_and_b32 s17, vcc_lo, 61440
    s_cbranch_scc0 T_l1
    s_cmp_ge_u32 s30, 1048576
    s_cselect_b32 s92, 1048576, s92
    s_cbranch_scc1 T_l1
    s_add_u32 s30, s30, 1
    buffer_load_dword v16, v15, s[4:7], 0 offen sc1
    s_sleep 2
    s_waitcnt vmcnt(0)
    s_branch T_l0
T_l2:
    v_max3_u32 v5, v68, v69, v70
    v_max3_u32 v5, v5, v71, v72
    v_max3_u32 v5, v5, v73, v74
    v_max3_u32 v5, v5, v75, v76
    v_max3_u32 v5, v5, v77, v78
    v_max3_u32 v5, v5, v79, v80
    v_max3_u32 v5, v5, v81, v82
    v_max3_u32 v5, v5, v83, v84
    v_max3_u32 v5, v5, v85, v86
    v_max3_u32 v5, v5, v87, v88
    v_max3_u32 v5, v5, v89, v90
    v_max3_u32 v5, v5, v91, v92
    v_max3_u32 v5, v5, v93, v94
    v_max3_u32 v5, v5, v95, v96
    v_max3_u32 v5, v5, v97, v98
    v_max3_u32 v5, v5, v99, v6
    v_cmp_eq_u32 vcc, -1, v5
    s_nop 0
    s_cbranch_vccz T_l3
    s_add_u32 s30, s30, 1
    s_cmp_ge_u32 s30, 1048576
    s_cbranch_scc1 T_l3
T_l1:
    buffer_load_dwordx4 v[68:71], v12, s[4:7], s36 offen offset:0 sc1
    buffer_load_dwordx4 v[72:75], v12, s[4:7], s36 offen offset:32 sc1
    buffer_load_dwordx4 v[76:79], v12, s[4:7], s37 offen offset:0 sc1
    buffer_load_dwordx4 v[80:83], v12, s[4:7], s37 offen offset:32 sc1
    buffer_load_dwordx4 v[84:87], v12, s[4:7], s38 offen offset:0 sc1
    buffer_load_dwordx4 v[88:91], v12, s[4:7], s38 offen offset:32 sc1
    buffer_load_dwordx4 v[92:95], v12, s[4:7], s39 offen offset:0 sc1
    buffer_load_dwordx4 v[96:99], v12, s[4:7], s39 offen offset:32 sc1
    buffer_load_dwordx2 v[100:101], v13, s[4:7], s40 offen sc1
    buffer_load_dwordx2 v[104:105], v13, s[4:7], s41 offen sc1
    buffer_load_dwordx2 v[108:109], v13, s[4:7], s42 offen sc1
    buffer_load_dwordx2 v[112:113], v13, s[4:7], s43 offen sc1
    s_waitcnt vmcnt(11)
    v_mfma_f32_32x32x16_bf16 v[132:147], v[68:71], a[96:99], 0
    s_waitcnt vmcnt(10)
    v_mfma_f32_32x32x16_bf16 v[132:147], v[72:75], a[100:103], v[132:147]
    s_waitcnt vmcnt(9)
    v_mfma_f32_32x32x16_bf16 v[132:147], v[76:79], a[104:107], v[132:147]
    s_waitcnt vmcnt(8)
    v_mfma_f32_32x32x16_bf16 v[132:147], v[80:83], a[108:111], v[132:147]
    s_waitcnt vmcnt(7)
    v_mfma_f32_32x32x16_bf16 v[132:147], v[84:87], a[112:115], v[132:147]
    s_waitcnt vmcnt(6)
    v_mfma_f32_32x32x16_bf16 v[132:147], v[88:91], a[116:119], v[132:147]
    s_waitcnt vmcnt(5)
    v_mfma_f32_32x32x16_bf16 v[132:147], v[92:95], a[120:123], v[132:147]
    s_waitcnt vmcnt(4)
    v_mfma_f32_32x32x16_bf16 v[132:147], v[96:99], a[124:127], v[132:147]
    s_waitcnt vmcnt(0)
    v_max3_u32 v6, v100, v101, v104
    v_max3_u32 v6, v6, v105, v108
    v_max3_u32 v6, v6, v109, v112
    v_max_u32 v6, v6, v113
    v_cmp_eq_u32 s[44:45], -1, v6
    s_nop 5
    v_cmp_u_f32 s[46:47], v132, v133
    v_cmp_u_f32 vcc, v134, v135
    v_max3_f32 v18, v132, v133, v20
    s_or_b64 s[44:45], s[44:45], s[46:47]
    v_max3_f32 v18, v134, v135, v18
    s_or_b64 vcc, vcc, s[44:45]
    s_cbranch_vccnz T_l2
T_l3:
    v_mov_b32 v5, v18
    s_nop 1
    v_permlane32_swap_b32 v18, v5
    v_max_f32 v18, v18, v5
    v_mul_f32 v18, s29, v18
    v_fma_f32 v21, v20, s29, -v18
    v_fma_f32 v132, v132, s29, -v18
    v_fma_f32 v133, v133, s29, -v18
    v_fma_f32 v134, v134, s29, -v18
    v_fma_f32 v135, v135, s29, -v18
    v_exp_f32 v21, v21
    v_exp_f32 v132, v132
    v_exp_f32 v133, v133
    v_exp_f32 v134, v134
    v_exp_f32 v135, v135
    v_fma_f32 v19, v19, v21, v132
    v_add_f32 v6, v133, v134
    v_add_f32 v19, v19, v135
    v_add_f32 v19, v19, v6
    v_mov_b32 v5, v19
    s_nop 1
    v_permlane32_swap_b32 v19, v5
    v_add_f32 v19, v19, v5
    v_rcp_f32 v19, v19
    s_nop 0
    v_mul_f32 v21, v21, v19
    v_mul_f32 v132, v132, v19
    v_mul_f32 v133, v133, v19
    v_mul_f32 v134, v134, v19
    v_mul_f32 v135, v135, v19
    v_cvt_pk_bf16_f32 v156, v132, v133
    v_cvt_pk_bf16_f32 v157, v134, v135
    v_mul_f32 v160, v160, v21
    v_mul_f32 v161, v161, v21
    v_mul_f32 v162, v162, v21
    v_mul_f32 v163, v163, v21
    v_mul_f32 v164, v164, v21
    v_mul_f32 v165, v165, v21
    v_mul_f32 v166, v166, v21
    v_mul_f32 v167, v167, v21
    v_mul_f32 v168, v168, v21
    v_mul_f32 v169, v169, v21
    v_mul_f32 v170, v170, v21
    v_mul_f32 v171, v171, v21
    v_mul_f32 v172, v172, v21
    v_mul_f32 v173, v173, v21
    v_mul_f32 v174, v174, v21
    v_mul_f32 v175, v175, v21
    s_nop 1
    v_mfma_f32_32x32x16_bf16 v[160:175], v[100:103], v[156:159], v[160:175]
    v_mul_f32 v176, v176, v21
    v_mul_f32 v177, v177, v21
    v_mul_f32 v178, v178, v21
    v_mul_f32 v179, v179, v21
    v_mul_f32 v180, v180, v21
    v_mul_f32 v181, v181, v21
    v_mul_f32 v182, v182, v21
    v_mul_f32 v183, v183, v21
    v_mul_f32 v184, v184, v21
    v_mul_f32 v185, v185, v21
    v_mul_f32 v186, v186, v21
    v_mul_f32 v187, v187, v21
    v_mul_f32 v188, v188, v21
    v_mul_f32 v189, v189, v21
    v_mul_f32 v190, v190, v21
    v_mul_f32 v191, v191, v21
    s_nop 1
    v_mfma_f32_32x32x16_bf16 v[176:191], v[104:107], v[156:159], v[176:191]
    v_cvt_pk_bf16_f32 v224, v160, v161
    v_cvt_pk_bf16_f32 v225, v162, v163
    v_cvt_pk_bf16_f32 v226, v164, v165
    v_cvt_pk_bf16_f32 v227, v166, v167
    v_cvt_pk_bf16_f32 v228, v168, v169
    v_cvt_pk_bf16_f32 v229, v170, v171
    v_cvt_pk_bf16_f32 v230, v172, v173
    v_cvt_pk_bf16_f32 v231, v174, v175
    buffer_store_dwordx4 v[224:227], v14, s[4:7], s33 offen offset:0 sc1
    buffer_store_dwordx4 v[228:231], v14, s[4:7], s33 offen offset:512 sc1
    v_mul_f32 v192, v192, v21
    v_mul_f32 v193, v193, v21
    v_mul_f32 v194, v194, v21
    v_mul_f32 v195, v195, v21
    v_mul_f32 v196, v196, v21
    v_mul_f32 v197, v197, v21
    v_mul_f32 v198, v198, v21
    v_mul_f32 v199, v199, v21
    v_mul_f32 v200, v200, v21
    v_mul_f32 v201, v201, v21
    v_mul_f32 v202, v202, v21
    v_mul_f32 v203, v203, v21
    v_mul_f32 v204, v204, v21
    v_mul_f32 v205, v205, v21
    v_mul_f32 v206, v206, v21
    v_mul_f32 v207, v207, v21
    s_nop 1
    v_mfma_f32_32x32x16_bf16 v[192:207], v[108:111], v[156:159], v[192:207]
    v_cvt_pk_bf16_f32 v232, v176, v177
    v_cvt_pk_bf16_f32 v233, v178, v179
    v_cvt_pk_bf16_f32 v234, v180, v181
    v_cvt_pk_bf16_f32 v235, v182, v183
    v_cvt_pk_bf16_f32 v236, v184, v185
    v_cvt_pk_bf16_f32 v237, v186, v187
    v_cvt_pk_bf16_f32 v238, v188, v189
    v_cvt_pk_bf16_f32 v239, v190, v191
    buffer_store_dwordx4 v[232:235], v14, s[4:7], s33 offen offset:1024 sc1
    buffer_store_dwordx4 v[236:239], v14, s[4:7], s33 offen offset:1536 sc1
    v_mul_f32 v208, v208, v21
    v_mul_f32 v209, v209, v21
    v_mul_f32 v210, v210, v21
    v_mul_f32 v211, v211, v21
    v_mul_f32 v212, v212, v21
    v_mul_f32 v213, v213, v21
    v_mul_f32 v214, v214, v21
    v_mul_f32 v215, v215, v21
    v_mul_f32 v216, v216, v21
    v_mul_f32 v217, v217, v21
    v_mul_f32 v218, v218, v21
    v_mul_f32 v219, v219, v21
    v_mul_f32 v220, v220, v21
    v_mul_f32 v221, v221, v21
    v_mul_f32 v222, v222, v21
    v_mul_f32 v223, v223, v21
    s_nop 1
    v_mfma_f32_32x32x16_bf16 v[208:223], v[112:115], v[156:159], v[208:223]
    v_cvt_pk_bf16_f32 v240, v192, v193
    v_cvt_pk_bf16_f32 v241, v194, v195
    v_cvt_pk_bf16_f32 v242, v196, v197
    v_cvt_pk_bf16_f32 v243, v198, v199
    v_cvt_pk_bf16_f32 v244, v200, v201
    v_cvt_pk_bf16_f32 v245, v202, v203
    v_cvt_pk_bf16_f32 v246, v204, v205
    v_cvt_pk_bf16_f32 v247, v206, v207
    buffer_store_dwordx4 v[240:243], v14, s[4:7], s33 offen offset:2048 sc1
    buffer_store_dwordx4 v[244:247], v14, s[4:7], s33 offen offset:2560 sc1
    s_nop 1
    v_cvt_pk_bf16_f32 v248, v208, v209
    v_cvt_pk_bf16_f32 v249, v210, v211
    v_cvt_pk_bf16_f32 v250, v212, v213
    v_cvt_pk_bf16_f32 v251, v214, v215
    v_cvt_pk_bf16_f32 v252, v216, v217
    v_cvt_pk_bf16_f32 v253, v218, v219
    v_cvt_pk_bf16_f32 v254, v220, v221
    v_cvt_pk_bf16_f32 v255, v222, v223
    buffer_store_dwordx4 v[248:251], v14, s[4:7], s33 offen offset:3072 sc1
    buffer_store_dwordx4 v[252:255], v14, s[4:7], s33 offen offset:3584 sc1
    s_branch T_fin
W_fin:
W_end:
    s_endpgm
R_entry:
    s_mov_b32 s12, s3
    s_lshr_b32 s13, s2, 3
    s_load_dwordx2 s[4:5], s[0:1], 96
    s_load_dwordx2 s[28:29], s[0:1], 32
    s_load_dwordx2 s[30:31], s[0:1], 40
    s_load_dwordx2 s[32:33], s[0:1], 48
    s_load_dwordx2 s[34:35], s[0:1], 56
    s_load_dwordx2 s[36:37], s[0:1], 64
    v_lshrrev_b32 v19, 6, v0
    v_and_b32 v1, 63, v0
    v_readfirstlane_b32 s14, v19
    s_mov_b32 s6, 268435456
    s_mov_b32 s7, 0x20000
    s_mov_b32 s10, 8388608
    s_mov_b32 s11, 0x20000
    s_mov_b32 s25, 0
    s_mov_b32 s24, 1040356334
    s_waitcnt lgkmcnt(0)
    v_and_b32 v96, 7, v1
    v_bfe_u32 v97, v1, 3, 1
    v_lshrrev_b32 v98, 4, v1
    v_lshlrev_b32 v19, 4, v1
    s_lshl_b32 s21, s12, 14
    s_lshl_b32 s22, s14, 12
    s_add_u32 s21, s21, s22
    s_add_u32 s22, s21, 0
    v_add_u32 v2, s22, v19
    s_add_u32 s22, s21, 229376
    v_add_u32 v8, s22, v19
    s_lshr_b32 s21, s13, 1
    s_lshl_b32 s21, s21, 10
    s_and_b32 s22, s13, 1
    s_lshl_b32 s22, s22, 7
    s_add_u32 s21, s21, s22
    s_lshl_b32 s22, s12, 14
    s_add_u32 s21, s21, s22
    v_lshlrev_b32 v20, 8, v98
    v_lshl_add_u32 v20, v96, 4, v20
    v_lshl_add_u32 v20, v97, 3, v20
    s_add_u32 s22, s21, 229376
    v_add_u32 v7, s22, v20
    s_add_u32 s22, s21, 0
    v_add_u32 v11, s22, v20
    s_lshr_b32 s21, s13, 1
    s_lshl_b32 s21, s21, 14
    s_and_b32 s22, s13, 1
    s_lshl_b32 s22, s22, 12
    s_add_u32 s21, s21, s22
    s_lshl_b32 s22, s12, 10
    s_add_u32 s22, s21, s22
    v_add_u32 v9, s22, v19
    v_xor_b32 v10, 1024, v9
    v_xor_b32 v23, 2048, v9
    v_xor_b32 v244, 3072, v9
    s_mov_b32 s95, 150994944
    s_lshr_b32 s40, s13, 2
    s_lshl_b32 s21, s12, 3
    s_add_u32 s40, s40, s21
    s_and_b32 s41, s13, 3
    s_mul_i32 s21, s40, 5120
    s_add_u32 s21, s21, 65536
    v_add_u32 v5, s21, v19
    v_lshlrev_b32 v20, 2, v1
    s_add_u32 s22, s21, 4096
    v_add_u32 v6, s22, v20
    s_lshl_b32 s22, s41, 10
    s_add_u32 s22, s22, s21
    v_add_u32 v3, s22, v19
    v_mov_b32 v21, 1073741824
    v_cmp_eq_u32 vcc, 0, v97
    s_nop 1
    v_cndmask_b32 v3, v21, v3, vcc
    s_lshl_b32 s22, s41, 8
    s_add_u32 s22, s22, s21
    s_add_u32 s22, s22, 4096
    v_lshlrev_b32 v20, 4, v98
    v_lshl_add_u32 v20, v96, 5, v20
    v_add_u32 v4, s22, v20
    v_cndmask_b32 v4, v4, v21, vcc
    v_cmp_gt_u32 vcc, 2, v98
    s_nop 1
    v_cndmask_b32 v4, v21, v4, vcc
    s_lshl_b32 s27, s40, 7
    s_lshl_b32 s21, s41, 5
    s_add_u32 s27, s27, s21
    v_bfe_u32 v20, v1, 2, 2
    v_and_b32 v22, 3, v1
    v_lshl_add_u32 v20, v20, 3, v22
    v_and_b32 v12, 16, v1
    v_lshl_add_u32 v12, v20, 5, v12
    v_and_b32 v13, 32, v1
    v_lshl_add_u32 v12, v13, 5, v12
    s_and_b32 s21, s14, 1
    s_lshl_b32 s21, s21, 14
    s_lshl_b32 s22, s27, 2
    s_add_u32 s21, s21, s22
    s_add_u32 s21, s21, 100679680
    v_mov_b32 v245, s21
    s_mov_b32 s47, s21
    s_mov_b32 s85, 0
    s_mul_i32 s21, s27, 4160
    v_add_u32 v12, s21, v12
    v_mov_b32 v13, v12
    v_and_b32 v173, 15, v1
    v_lshl_add_u32 v173, v173, 7, s21
    v_mul_u32_u24 v175, 69632, v98
    v_lshl_add_u32 v173, v175, 8, v173
    s_add_u32 s22, s22, 100679680
    v_lshl_add_u32 v174, v98, 14, s22
    v_mov_b32 v175, 0
    v_lshlrev_b32 v15, 4, v20
    v_lshl_add_u32 v15, v98, 5, v15
    s_mul_i32 s21, s27, 1040
    v_add_u32 v15, s21, v15
    v_and_b32 v22, 1, v98
    v_cmp_eq_u32 vcc, 0, v22
    s_nop 1
    v_cndmask_b32 v15, v21, v15, vcc
    v_lshlrev_b32 v14, 6, v96
    v_lshl_add_u32 v14, v98, 4, v14
    v_add_u32 v14, s21, v14
    v_cmp_eq_u32 vcc, 1, v97
    s_nop 1
    v_cndmask_b32 v14, v21, v14, vcc
    v_mov_b32 v16, v19
    s_lshl_b32 s21, s14, 11
    v_add_u32 v17, s21, v19
    v_and_b32 v20, 15, v1
    v_bfe_u32 v22, v1, 2, 2
    v_and_b32 v18, 1, v1
    v_lshl_add_u32 v18, v22, 1, v18
    v_bfe_u32 v22, v1, 1, 1
    v_lshl_add_u32 v18, v22, 3, v18
    s_cmp_eq_u32 s14, 1
    s_cselect_b64 vcc, -1, 0
    v_cndmask_b32 v20, v20, v18, vcc
    v_and_b32 v22, 1, v98
    v_lshlrev_b32 v22, 2, v22
    v_sub_u32 v20, v20, v22
    v_mov_b32 v22, 0x3f80
    v_mov_b32 v18, 0x3f800000
    v_mov_b32 v172, 0x4444
    v_mov_b32 v84, 0xeeee
    v_cmp_eq_u32 vcc, 1, v97
    s_nop 1
    v_cndmask_b32 v172, v172, v84, vcc
    v_cmp_eq_u32 vcc, 0, v20
    s_nop 1
    v_cndmask_b32 v84, 0, v22, vcc
    v_cmp_eq_u32 vcc, 1, v20
    s_nop 1
    v_cndmask_b32 v84, v84, v18, vcc
    v_cmp_eq_u32 vcc, 2, v20
    s_nop 1
    v_cndmask_b32 v85, 0, v22, vcc
    v_cmp_eq_u32 vcc, 3, v20
    s_nop 1
    v_cndmask_b32 v85, v85, v18, vcc
    v_cmp_eq_u32 vcc, 8, v20
    s_nop 1
    v_cndmask_b32 v86, 0, v22, vcc
    v_cmp_eq_u32 vcc, 9, v20
    s_nop 1
    v_cndmask_b32 v86, v86, v18, vcc
    v_cmp_eq_u32 vcc, 10, v20
    s_nop 1
    v_cndmask_b32 v87, 0, v22, vcc
    v_cmp_eq_u32 vcc, 11, v20
    s_nop 1
    v_cndmask_b32 v87, v87, v18, vcc
    s_mov_b32 s16, 81788928
    s_mov_b32 s42, 82083840
    s_mov_b32 s43, 82378752
    s_mov_b32 s44, 82673664
    s_mov_b32 s17, 17825792
    s_mov_b32 s18, 35651584
    s_mov_b32 s19, 71303168
    s_mov_b32 s20, 76546048
    s_mov_b32 s15, 0
    v_mov_b32 v204, -1
    v_mov_b32 v205, -1
    v_mov_b32 v206, -1
    v_mov_b32 v207, -1
    v_mov_b32 v236, 0x3f803f80
    v_mov_b32 v237, 0x3f803f80
    v_mov_b32 v238, 0x3f803f80
    v_mov_b32 v239, 0x3f803f80
    s_mul_i32 s22, s14, 294912
    s_add_u32 s22, s22, 81788928
    buffer_store_dwordx4 v[204:207], v3, s[4:7], s22 offen sc1
    buffer_store_dwordx4 v[204:207], v3, s[4:7], s22 offen offset:128 sc1
    buffer_store_dwordx4 v[204:207], v4, s[4:7], s22 offen sc1
    buffer_store_dwordx2 v[204:205], v7, s[4:7], s22 offen sc1
    buffer_store_dwordx2 v[204:205], v11, s[4:7], s22 offen sc1
    s_lshl_b32 s22, s14, 18
    s_add_u32 s22, s22, 150994944
    buffer_store_dwordx4 v[204:207], v9, s[4:7], s22 offen sc1
    s_add_u32 s22, s22, 8192
    buffer_store_dwordx4 v[204:207], v9, s[4:7], s22 offen sc1
    s_lshl_b32 s22, s14, 9
    s_add_u32 s22, s22, 71333888
    buffer_store_dwordx4 v[204:207], v14, s[4:7], s22 offen sc1
    s_add_u32 s22, s22, 5242880
    buffer_store_dwordx4 v[204:207], v15, s[4:7], s22 offen sc1
    s_lshl_b32 s22, s27, 2
    s_add_u32 s22, s22, 100712448
    v_lshlrev_b32 v246, 2, v1
    v_add_u32 v246, s22, v246
    v_cmp_gt_u32 vcc, 32, v1
    s_nop 1
    v_cndmask_b32 v246, v21, v246, vcc
    v_mov_b32 v247, 0
    buffer_store_dword v247, v246, s[4:7], 0 offen sc1
    v_lshrrev_b32 v19, 2, v1
    v_and_b32 v22, 3, v1
    v_lshlrev_b32 v22, 4, v22
    v_lshl_add_u32 v140, v19, 13, v22
    v_lshl_add_u32 v141, v19, 11, v22
    s_mul_i32 s86, s14, 40960
    s_lshr_b32 s21, s13, 3
    s_cmp_eq_u32 s21, 1
    s_cselect_b64 s[88:89], s[32:33], s[30:31]
    s_cmp_eq_u32 s21, 2
    s_cselect_b64 s[88:89], s[34:35], s[88:89]
    s_cmp_eq_u32 s21, 3
    s_cselect_b64 s[88:89], s[36:37], s[88:89]
    s_mov_b32 s90, 8388608
    s_mov_b32 s91, 0x20000
    s_cselect_b32 s21, 11, 13
    s_cselect_b32 s92, 21, 11
    s_lshl_b32 s92, s12, s92
    s_and_b32 s22, s13, 3
    s_lshl_b32 s22, s22, 8
    v_add_u32 v142, s22, v0
    v_lshlrev_b32 v142, s21, v142
    s_and_b32 s22, s13, 4
    s_lshl_b32 s22, s22, 8
    s_add_u32 s92, s92, s22
    s_lshr_b32 s22, s13, 3
    s_lshl2_add_u32 s22, s12, s22
    s_bitcmp1_b32 26214, s22
    s_cselect_b32 s21, s92, 1073741824
    s_cmp_ge_u32 s14, 2
    s_cselect_b32 s21, s21, 1073741824
    buffer_load_dword v143, v142, s[88:91], s21 offen offset:384
    s_cmp_eq_u32 s92, 7168
    s_cselect_b32 s92, s92, 1073741824
    s_bitcmp1_b32 26214, s22
    s_cselect_b32 s21, s92, 1073741824
    s_cmp_ge_u32 s14, 2
    s_cselect_b32 s21, s21, 1073741824
    buffer_load_dword v143, v142, s[88:91], s21 offen offset:896
    s_mov_b32 s8, s32
    s_mov_b32 s9, s33
    s_lshl_b32 s87, s14, 21
    s_lshl_b32 s22, s27, 1
    s_add_u32 s87, s87, s22
    s_add_u32 m0, s86, 0
    s_nop 0
    buffer_load_dwordx4 v140, s[8:11], s87 offen lds
    s_add_u32 s87, s87, 131072
    s_add_u32 m0, s86, 1024
    s_nop 0
    buffer_load_dwordx4 v140, s[8:11], s87 offen lds
    s_add_u32 s87, s87, 131072
    s_add_u32 m0, s86, 2048
    s_nop 0
    buffer_load_dwordx4 v140, s[8:11], s87 offen lds
    s_add_u32 s87, s87, 131072
    s_add_u32 m0, s86, 3072
    s_nop 0
    buffer_load_dwordx4 v140, s[8:11], s87 offen lds
    s_add_u32 s87, s87, 131072
    v_bfe_u32 v19, v1, 2, 1
    v_lshl_add_u32 v19, v98, 2, v19
    v_lshl_add_u32 v19, v97, 5, v19
    v_lshl_add_u32 v22, v19, 6, v22
    v_add_u32 v22, s86, v22
    s_waitcnt vmcnt(6)
    s_barrier
    s_cmp_lg_u32 s14, 0
    s_cbranch_scc1 reg_22
    s_and_b32 s21, s2, 3
    s_lshl_b32 s21, s21, 3
    s_lshl_b32 s22, s98, 2
    s_add_u32 s21, s21, s22
    s_lshl_b32 s21, 1, s21
    s_andn2_b32 s22, s2, 3
    v_mov_b32 v20, s22
    v_mov_b32 v21, s21
    s_mov_b64 exec, 1
    global_atomic_add v20, v21, s[100:101] sc1
    s_mov_b64 exec, -1
reg_22:
    s_barrier
    s_add_u32 m0, s86, 4096
    s_nop 0
    buffer_load_dwordx4 v140, s[8:11], s87 offen lds
    s_add_u32 s87, s87, 131072
    s_add_u32 m0, s86, 5120
    s_nop 0
    buffer_load_dwordx4 v140, s[8:11], s87 offen lds
    s_add_u32 s87, s87, 131072
    s_add_u32 m0, s86, 6144
    s_nop 0
    buffer_load_dwordx4 v140, s[8:11], s87 offen lds
    s_add_u32 s87, s87, 131072
    s_add_u32 m0, s86, 7168
    s_nop 0
    buffer_load_dwordx4 v140, s[8:11], s87 offen lds
    s_add_u32 s87, s87, 131072
    s_add_u32 m0, s86, 8192
    s_nop 0
    buffer_load_dwordx4 v140, s[8:11], s87 offen lds
    s_add_u32 s87, s87, 131072
    s_add_u32 m0, s86, 9216
    s_nop 0
    buffer_load_dwordx4 v140, s[8:11], s87 offen lds
    s_add_u32 s87, s87, 131072
    s_add_u32 m0, s86, 10240
    s_nop 0
    buffer_load_dwordx4 v140, s[8:11], s87 offen lds
    s_add_u32 s87, s87, 131072
    s_add_u32 m0, s86, 11264
    s_nop 0
    buffer_load_dwordx4 v140, s[8:11], s87 offen lds
    s_add_u32 s87, s87, 131072
    s_add_u32 m0, s86, 12288
    s_nop 0
    buffer_load_dwordx4 v140, s[8:11], s87 offen lds
    s_add_u32 s87, s87, 131072
    s_add_u32 m0, s86, 13312
    s_nop 0
    buffer_load_dwordx4 v140, s[8:11], s87 offen lds
    s_add_u32 s87, s87, 131072
    s_add_u32 m0, s86, 14336
    s_nop 0
    buffer_load_dwordx4 v140, s[8:11], s87 offen lds
    s_add_u32 s87, s87, 131072
    s_add_u32 m0, s86, 15360
    s_nop 0
    buffer_load_dwordx4 v140, s[8:11], s87 offen lds
    s_add_u32 s87, s87, 131072
    s_mov_b32 s8, s34
    s_mov_b32 s9, s35
    s_lshl_b32 s87, s14, 21
    s_lshl_b32 s22, s27, 1
    s_add_u32 s87, s87, s22
    s_add_u32 m0, s86, 16384
    s_nop 0
    buffer_load_dwordx4 v140, s[8:11], s87 offen lds
    s_add_u32 s87, s87, 131072
    s_add_u32 m0, s86, 17408
    s_nop 0
    buffer_load_dwordx4 v140, s[8:11], s87 offen lds
    s_add_u32 s87, s87, 131072
    s_add_u32 m0, s86, 18432
    s_nop 0
    buffer_load_dwordx4 v140, s[8:11], s87 offen lds
    s_add_u32 s87, s87, 131072
    s_add_u32 m0, s86, 19456
    s_nop 0
    buffer_load_dwordx4 v140, s[8:11], s87 offen lds
    s_add_u32 s87, s87, 131072
    s_add_u32 m0, s86, 20480
    s_nop 0
    buffer_load_dwordx4 v140, s[8:11], s87 offen lds
    s_add_u32 s87, s87, 131072
    s_add_u32 m0, s86, 21504
    s_nop 0
    buffer_load_dwordx4 v140, s[8:11], s87 offen lds
    s_add_u32 s87, s87, 131072
    s_add_u32 m0, s86, 22528
    s_nop 0
    buffer_load_dwordx4 v140, s[8:11], s87 offen lds
    s_add_u32 s87, s87, 131072
    s_add_u32 m0, s86, 23552
    s_nop 0
    buffer_load_dwordx4 v140, s[8:11], s87 offen lds
    s_add_u32 s87, s87, 131072
    s_add_u32 m0, s86, 24576
    s_nop 0
    buffer_load_dwordx4 v140, s[8:11], s87 offen lds
    s_add_u32 s87, s87, 131072
    s_add_u32 m0, s86, 25600
    s_nop 0
    buffer_load_dwordx4 v140, s[8:11], s87 offen lds
    s_add_u32 s87, s87, 131072
    s_add_u32 m0, s86, 26624
    s_nop 0
    buffer_load_dwordx4 v140, s[8:11], s87 offen lds
    s_add_u32 s87, s87, 131072
    s_add_u32 m0, s86, 27648
    s_nop 0
    buffer_load_dwordx4 v140, s[8:11], s87 offen lds
    s_add_u32 s87, s87, 131072
    s_add_u32 m0, s86, 28672
    s_nop 0
    buffer_load_dwordx4 v140, s[8:11], s87 offen lds
    s_add_u32 s87, s87, 131072
    s_add_u32 m0, s86, 29696
    s_nop 0
    buffer_load_dwordx4 v140, s[8:11], s87 offen lds
    s_add_u32 s87, s87, 131072
    s_add_u32 m0, s86, 30720
    s_nop 0
    buffer_load_dwordx4 v140, s[8:11], s87 offen lds
    s_add_u32 s87, s87, 131072
    s_add_u32 m0, s86, 31744
    s_nop 0
    buffer_load_dwordx4 v140, s[8:11], s87 offen lds
    s_add_u32 s87, s87, 131072
    s_mov_b32 s8, s30
    s_mov_b32 s9, s31
    s_lshl_b32 s87, s14, 21
    s_lshl_b32 s22, s27, 1
    s_add_u32 s87, s87, s22
    s_add_u32 m0, s86, 32768
    s_nop 0
    buffer_load_dwordx4 v140, s[8:11], s87 offen lds
    s_add_u32 s87, s87, 131072
    s_add_u32 m0, s86, 33792
    s_nop 0
    buffer_load_dwordx4 v140, s[8:11], s87 offen lds
    s_add_u32 s87, s87, 131072
    s_add_u32 m0, s86, 34816
    s_nop 0
    buffer_load_dwordx4 v140, s[8:11], s87 offen lds
    s_add_u32 s87, s87, 131072
    s_add_u32 m0, s86, 35840
    s_nop 0
    buffer_load_dwordx4 v140, s[8:11], s87 offen lds
    s_add_u32 s87, s87, 131072
    s_lshr_b32 s21, s13, 3
    s_cmp_eq_u32 s21, 1
    s_cselect_b64 s[88:89], s[32:33], s[30:31]
    s_cmp_eq_u32 s21, 2
    s_cselect_b64 s[88:89], s[34:35], s[88:89]
    s_cmp_eq_u32 s21, 3
    s_cselect_b64 s[88:89], s[36:37], s[88:89]
    s_mov_b32 s90, 8388608
    s_mov_b32 s91, 0x20000
    s_cselect_b32 s21, 11, 13
    s_cselect_b32 s92, 21, 11
    s_lshl_b32 s92, s12, s92
    s_and_b32 s22, s13, 3
    s_lshl_b32 s22, s22, 8
    v_add_u32 v142, s22, v0
    v_lshlrev_b32 v142, s21, v142
    s_and_b32 s22, s13, 4
    s_lshl_b32 s22, s22, 8
    s_add_u32 s92, s92, s22
    s_lshr_b32 s22, s13, 3
    s_lshl2_add_u32 s22, s12, s22
    s_bitcmp1_b32 39321, s22
    s_cselect_b32 s21, s92, 1073741824
    s_cmp_ge_u32 s14, 2
    s_cselect_b32 s21, s21, 1073741824
    buffer_load_dword v143, v142, s[88:91], s21 offen offset:384
    s_cmp_eq_u32 s92, 7168
    s_cselect_b32 s92, s92, 1073741824
    s_bitcmp1_b32 39321, s22
    s_cselect_b32 s21, s92, 1073741824
    s_cmp_ge_u32 s14, 2
    s_cselect_b32 s21, s21, 1073741824
    buffer_load_dword v143, v142, s[88:91], s21 offen offset:896
    s_add_u32 m0, s86, 36864
    s_nop 0
    buffer_load_dwordx4 v140, s[8:11], s87 offen lds
    s_add_u32 s87, s87, 131072
    s_add_u32 m0, s86, 37888
    s_nop 0
    buffer_load_dwordx4 v140, s[8:11], s87 offen lds
    s_add_u32 s87, s87, 131072
    s_add_u32 m0, s86, 38912
    s_nop 0
    buffer_load_dwordx4 v140, s[8:11], s87 offen lds
    s_add_u32 s87, s87, 131072
    s_add_u32 m0, s86, 39936
    s_nop 0
    buffer_load_dwordx4 v140, s[8:11], s87 offen lds
    s_add_u32 s87, s87, 131072
    s_waitcnt vmcnt(38)
    ds_read_b64_tr_b16 a[64:65], v22 offset:0
    ds_read_b64_tr_b16 a[66:67], v22 offset:128
    ds_read_b64_tr_b16 a[68:69], v22 offset:1024
    ds_read_b64_tr_b16 a[70:71], v22 offset:1152
    s_waitcnt lgkmcnt(4)
    ds_read_b64_tr_b16 a[96:97], v22 offset:8
    ds_read_b64_tr_b16 a[98:99], v22 offset:136
    ds_read_b64_tr_b16 a[100:101], v22 offset:1032
    ds_read_b64_tr_b16 a[102:103], v22 offset:1160
    s_waitcnt vmcnt(34)
    ds_read_b64_tr_b16 a[72:73], v22 offset:4096
    ds_read_b64_tr_b16 a[74:75], v22 offset:4224
    ds_read_b64_tr_b16 a[76:77], v22 offset:5120
    ds_read_b64_tr_b16 a[78:79], v22 offset:5248
    s_waitcnt lgkmcnt(4)
    ds_read_b64_tr_b16 a[104:105], v22 offset:4104
    ds_read_b64_tr_b16 a[106:107], v22 offset:4232
    ds_read_b64_tr_b16 a[108:109], v22 offset:5128
    ds_read_b64_tr_b16 a[110:111], v22 offset:5256
    s_add_u32 m0, s86, 0
    s_nop 0
    buffer_load_dwordx4 v140, s[8:11], s87 offen lds
    s_add_u32 s87, s87, 131072
    s_add_u32 m0, s86, 1024
    s_nop 0
    buffer_load_dwordx4 v140, s[8:11], s87 offen lds
    s_add_u32 s87, s87, 131072
    s_add_u32 m0, s86, 2048
    s_nop 0
    buffer_load_dwordx4 v140, s[8:11], s87 offen lds
    s_add_u32 s87, s87, 131072
    s_add_u32 m0, s86, 3072
    s_nop 0
    buffer_load_dwordx4 v140, s[8:11], s87 offen lds
    s_add_u32 s87, s87, 131072
    s_waitcnt vmcnt(34)
    ds_read_b64_tr_b16 a[80:81], v22 offset:8192
    ds_read_b64_tr_b16 a[82:83], v22 offset:8320
    ds_read_b64_tr_b16 a[84:85], v22 offset:9216
    ds_read_b64_tr_b16 a[86:87], v22 offset:9344
    s_waitcnt lgkmcnt(4)
    ds_read_b64_tr_b16 a[112:113], v22 offset:8200
    ds_read_b64_tr_b16 a[114:115], v22 offset:8328
    ds_read_b64_tr_b16 a[116:117], v22 offset:9224
    ds_read_b64_tr_b16 a[118:119], v22 offset:9352
    s_add_u32 m0, s86, 4096
    s_nop 0
    buffer_load_dwordx4 v140, s[8:11], s87 offen lds
    s_add_u32 s87, s87, 131072
    s_add_u32 m0, s86, 5120
    s_nop 0
    buffer_load_dwordx4 v140, s[8:11], s87 offen lds
    s_add_u32 s87, s87, 131072
    s_add_u32 m0, s86, 6144
    s_nop 0
    buffer_load_dwordx4 v140, s[8:11], s87 offen lds
    s_add_u32 s87, s87, 131072
    s_add_u32 m0, s86, 7168
    s_nop 0
    buffer_load_dwordx4 v140, s[8:11], s87 offen lds
    s_add_u32 s87, s87, 131072
    s_waitcnt vmcnt(34)
    ds_read_b64_tr_b16 a[88:89], v22 offset:12288
    ds_read_b64_tr_b16 a[90:91], v22 offset:12416
    ds_read_b64_tr_b16 a[92:93], v22 offset:13312
    ds_read_b64_tr_b16 a[94:95], v22 offset:13440
    s_waitcnt lgkmcnt(4)
    ds_read_b64_tr_b16 a[120:121], v22 offset:12296
    ds_read_b64_tr_b16 a[122:123], v22 offset:12424
    ds_read_b64_tr_b16 a[124:125], v22 offset:13320
    ds_read_b64_tr_b16 a[126:127], v22 offset:13448
    s_mov_b32 s8, s36
    s_mov_b32 s9, s37
    s_lshl_b32 s87, s12, 21
    s_lshl_b32 s22, s14, 19
    s_add_u32 s87, s87, s22
    s_lshl_b32 s22, s13, 6
    s_add_u32 s87, s87, s22
    s_add_u32 m0, s86, 8192
    s_nop 0
    buffer_load_dwordx4 v141, s[8:11], s87 offen lds
    s_add_u32 s87, s87, 32768
    s_add_u32 m0, s86, 9216
    s_nop 0
    buffer_load_dwordx4 v141, s[8:11], s87 offen lds
    s_add_u32 s87, s87, 32768
    s_add_u32 m0, s86, 10240
    s_nop 0
    buffer_load_dwordx4 v141, s[8:11], s87 offen lds
    s_add_u32 s87, s87, 32768
    s_add_u32 m0, s86, 11264
    s_nop 0
    buffer_load_dwordx4 v141, s[8:11], s87 offen lds
    s_add_u32 s87, s87, 32768
    s_mov_b32 s88, s28
    s_mov_b32 s89, s29
    s_mov_b32 s90, 16384
    s_mov_b32 s91, 0x20000
    v_lshlrev_b32 v20, 11, v96
    v_lshl_add_u32 v20, v98, 4, v20
    v_lshl_add_u32 v20, v97, 3, v20
    s_lshl_b32 s21, s13, 6
    buffer_load_dwordx2 v[88:89], v20, s[88:91], s21 offen
    v_lshlrev_b32 v90, 2, v1
    global_load_dword v91, v90, s[100:101] sc1
    s_waitcnt vmcnt(36)
    ds_read_b64_tr_b16 a[128:129], v22 offset:16384
    ds_read_b64_tr_b16 a[130:131], v22 offset:16512
    ds_read_b64_tr_b16 a[132:133], v22 offset:17408
    ds_read_b64_tr_b16 a[134:135], v22 offset:17536
    s_waitcnt lgkmcnt(4)
    ds_read_b64_tr_b16 a[160:161], v22 offset:16392
    ds_read_b64_tr_b16 a[162:163], v22 offset:16520
    ds_read_b64_tr_b16 a[164:165], v22 offset:17416
    ds_read_b64_tr_b16 a[166:167], v22 offset:17544
    s_add_u32 m0, s86, 12288
    s_nop 0
    buffer_load_dwordx4 v141, s[8:11], s87 offen lds
    s_add_u32 s87, s87, 32768
    s_add_u32 m0, s86, 13312
    s_nop 0
    buffer_load_dwordx4 v141, s[8:11], s87 offen lds
    s_add_u32 s87, s87, 32768
    s_add_u32 m0, s86, 14336
    s_nop 0
    buffer_load_dwordx4 v141, s[8:11], s87 offen lds
    s_add_u32 s87, s87, 32768
    s_add_u32 m0, s86, 15360
    s_nop 0
    buffer_load_dwordx4 v141, s[8:11], s87 offen lds
    s_add_u32 s87, s87, 32768
    s_waitcnt vmcnt(36)
    ds_read_b64_tr_b16 a[136:137], v22 offset:20480
    ds_read_b64_tr_b16 a[138:139], v22 offset:20608
    ds_read_b64_tr_b16 a[140:141], v22 offset:21504
    ds_read_b64_tr_b16 a[142:143], v22 offset:21632
    s_waitcnt lgkmcnt(4)
    ds_read_b64_tr_b16 a[168:169], v22 offset:20488
    ds_read_b64_tr_b16 a[170:171], v22 offset:20616
    ds_read_b64_tr_b16 a[172:173], v22 offset:21512
    ds_read_b64_tr_b16 a[174:175], v22 offset:21640
    s_add_u32 m0, s86, 16384
    s_nop 0
    buffer_load_dwordx4 v141, s[8:11], s87 offen lds
    s_add_u32 s87, s87, 32768
    s_add_u32 m0, s86, 17408
    s_nop 0
    buffer_load_dwordx4 v141, s[8:11], s87 offen lds
    s_add_u32 s87, s87, 32768
    s_add_u32 m0, s86, 18432
    s_nop 0
    buffer_load_dwordx4 v141, s[8:11], s87 offen lds
    s_add_u32 s87, s87, 32768
    s_add_u32 m0, s86, 19456
    s_nop 0
    buffer_load_dwordx4 v141, s[8:11], s87 offen lds
    s_add_u32 s87, s87, 32768
    s_waitcnt vmcnt(36)
    ds_read_b64_tr_b16 a[144:145], v22 offset:24576
    ds_read_b64_tr_b16 a[146:147], v22 offset:24704
    ds_read_b64_tr_b16 a[148:149], v22 offset:25600
    ds_read_b64_tr_b16 a[150:151], v22 offset:25728
    s_waitcnt lgkmcnt(4)
    ds_read_b64_tr_b16 a[176:177], v22 offset:24584
    ds_read_b64_tr_b16 a[178:179], v22 offset:24712
    ds_read_b64_tr_b16 a[180:181], v22 offset:25608
    ds_read_b64_tr_b16 a[182:183], v22 offset:25736
    s_add_u32 m0, s86, 20480
    s_nop 0
    buffer_load_dwordx4 v141, s[8:11], s87 offen lds
    s_add_u32 s87, s87, 32768
    s_add_u32 m0, s86, 21504
    s_nop 0
    buffer_load_dwordx4 v141, s[8:11], s87 offen lds
    s_add_u32 s87, s87, 32768
    s_add_u32 m0, s86, 22528
    s_nop 0
    buffer_load_dwordx4 v141, s[8:11], s87 offen lds
    s_add_u32 s87, s87, 32768
    s_add_u32 m0, s86, 23552
    s_nop 0
    buffer_load_dwordx4 v141, s[8:11], s87 offen lds
    s_add_u32 s87, s87, 32768
    s_waitcnt vmcnt(36)
    ds_read_b64_tr_b16 a[152:153], v22 offset:28672
    ds_read_b64_tr_b16 a[154:155], v22 offset:28800
    ds_read_b64_tr_b16 a[156:157], v22 offset:29696
    ds_read_b64_tr_b16 a[158:159], v22 offset:29824
    s_waitcnt lgkmcnt(4)
    ds_read_b64_tr_b16 a[184:185], v22 offset:28680
    ds_read_b64_tr_b16 a[186:187], v22 offset:28808
    ds_read_b64_tr_b16 a[188:189], v22 offset:29704
    ds_read_b64_tr_b16 a[190:191], v22 offset:29832
    s_waitcnt vmcnt(32)
    ds_read_b64_tr_b16 a[0:1], v22 offset:32768
    ds_read_b64_tr_b16 a[2:3], v22 offset:32896
    ds_read_b64_tr_b16 a[4:5], v22 offset:33792
    ds_read_b64_tr_b16 a[6:7], v22 offset:33920
    s_waitcnt lgkmcnt(4)
    ds_read_b64_tr_b16 a[32:33], v22 offset:32776
    ds_read_b64_tr_b16 a[34:35], v22 offset:32904
    ds_read_b64_tr_b16 a[36:37], v22 offset:33800
    ds_read_b64_tr_b16 a[38:39], v22 offset:33928
    s_waitcnt vmcnt(26)
    ds_read_b64_tr_b16 a[8:9], v22 offset:36864
    ds_read_b64_tr_b16 a[10:11], v22 offset:36992
    ds_read_b64_tr_b16 a[12:13], v22 offset:37888
    ds_read_b64_tr_b16 a[14:15], v22 offset:38016
    s_waitcnt lgkmcnt(4)
    ds_read_b64_tr_b16 a[40:41], v22 offset:36872
    ds_read_b64_tr_b16 a[42:43], v22 offset:37000
    ds_read_b64_tr_b16 a[44:45], v22 offset:37896
    ds_read_b64_tr_b16 a[46:47], v22 offset:38024
    s_waitcnt vmcnt(22)
    ds_read_b64_tr_b16 a[16:17], v22 offset:0
    ds_read_b64_tr_b16 a[18:19], v22 offset:128
    ds_read_b64_tr_b16 a[20:21], v22 offset:1024
    ds_read_b64_tr_b16 a[22:23], v22 offset:1152
    s_waitcnt lgkmcnt(4)
    ds_read_b64_tr_b16 a[48:49], v22 offset:8
    ds_read_b64_tr_b16 a[50:51], v22 offset:136
    ds_read_b64_tr_b16 a[52:53], v22 offset:1032
    ds_read_b64_tr_b16 a[54:55], v22 offset:1160
    s_waitcnt vmcnt(18)
    ds_read_b64_tr_b16 a[24:25], v22 offset:4096
    ds_read_b64_tr_b16 a[26:27], v22 offset:4224
    ds_read_b64_tr_b16 a[28:29], v22 offset:5120
    ds_read_b64_tr_b16 a[30:31], v22 offset:5248
    s_waitcnt lgkmcnt(4)
    ds_read_b64_tr_b16 a[56:57], v22 offset:4104
    ds_read_b64_tr_b16 a[58:59], v22 offset:4232
    ds_read_b64_tr_b16 a[60:61], v22 offset:5128
    ds_read_b64_tr_b16 a[62:63], v22 offset:5256
    s_waitcnt vmcnt(14)
    ds_read_b64_tr_b16 a[192:193], v22 offset:8192
    ds_read_b64_tr_b16 a[194:195], v22 offset:8320
    ds_read_b64_tr_b16 a[196:197], v22 offset:9216
    ds_read_b64_tr_b16 a[198:199], v22 offset:9344
    s_waitcnt lgkmcnt(4)
    ds_read_b64_tr_b16 a[224:225], v22 offset:8200
    ds_read_b64_tr_b16 a[226:227], v22 offset:8328
    ds_read_b64_tr_b16 a[228:229], v22 offset:9224
    ds_read_b64_tr_b16 a[230:231], v22 offset:9352
    s_waitcnt vmcnt(8)
    ds_read_b64_tr_b16 a[200:201], v22 offset:12288
    ds_read_b64_tr_b16 a[202:203], v22 offset:12416
    ds_read_b64_tr_b16 a[204:205], v22 offset:13312
    ds_read_b64_tr_b16 a[206:207], v22 offset:13440
    s_waitcnt lgkmcnt(4)
    ds_read_b64_tr_b16 a[232:233], v22 offset:12296
    ds_read_b64_tr_b16 a[234:235], v22 offset:12424
    ds_read_b64_tr_b16 a[236:237], v22 offset:13320
    ds_read_b64_tr_b16 a[238:239], v22 offset:13448
    v_lshlrev_b32 v90, 2, v1
    s_mov_b32 s22, 0
    s_branch rdv_23p
rdv_23:
    global_load_dword v91, v90, s[100:101] sc1
    s_waitcnt vmcnt(0)
rdv_23p:
    s_lshl_b32 s21, s98, 2
    v_lshrrev_b32 v92, s21, v91
    s_cmp_eq_u32 s98, 0
    s_cselect_b32 s21, 0x0f0f0f0f, s21
    s_cselect_b32 s21, s21, 0x01010101
    v_and_b32 v92, s21, v92
    v_cmp_ne_u32 vcc, 0x01010101, v92
    s_nop 0
    s_cbranch_vccz rdvok_24
    v_sad_u8 v92, v92, 0, 0
    s_nop 1
    v_add_u32_dpp v92, v92, v92 quad_perm:[1,0,3,2] row_mask:0xf bank_mask:0xf
    v_cmp_ne_u32 vcc, 8, v92
    s_nop 0
    s_cbranch_vccnz rdvw_25
    s_mov_b32 s98, 1
    s_and_b32 s3, s97, 7
    s_waitcnt vmcnt(0) lgkmcnt(0)
    s_barrier
    s_branch role_start
rdvw_25:
    s_sleep 4
    s_add_u32 s22, s22, 1
    s_cmp_lt_u32 s22, 262144
    s_cbranch_scc1 rdv_23
    s_mov_b32 s25, 200000
rdvok_24:
    v_and_b32 v92, 0x40404040, v91
    v_bcnt_u32_b32 v92, v92, 0
    s_mov_b32 s46, 0
    v_cmp_le_u32 vcc, 1, v92
    s_nop 0
    s_bcnt1_i32_b64 s21, vcc
    s_add_u32 s46, s46, s21
    v_cmp_le_u32 vcc, 2, v92
    s_nop 0
    s_bcnt1_i32_b64 s21, vcc
    s_add_u32 s46, s46, s21
    v_cmp_le_u32 vcc, 3, v92
    s_nop 0
    s_bcnt1_i32_b64 s21, vcc
    s_add_u32 s46, s46, s21
    v_cmp_le_u32 vcc, 4, v92
    s_nop 0
    s_bcnt1_i32_b64 s21, vcc
    s_add_u32 s46, s46, s21
    s_cmp_gt_u32 s46, 16
    s_cselect_b32 s46, 8192, 0
    s_add_u32 s84, s95, s46
    s_xor_b32 s45, s98, 1
    v_min_u32 v88, -2, v88
    v_min_u32 v89, -2, v89
    buffer_store_dwordx2 v[88:89], v11, s[4:7], s16 offen sc1
    s_waitcnt vmcnt(5)
    ds_read_b64_tr_b16 a[208:209], v22 offset:16384
    ds_read_b64_tr_b16 a[210:211], v22 offset:16512
    ds_read_b64_tr_b16 a[212:213], v22 offset:17408
    ds_read_b64_tr_b16 a[214:215], v22 offset:17536
    s_waitcnt lgkmcnt(4)
    ds_read_b64_tr_b16 a[240:241], v22 offset:16392
    ds_read_b64_tr_b16 a[242:243], v22 offset:16520
    ds_read_b64_tr_b16 a[244:245], v22 offset:17416
    ds_read_b64_tr_b16 a[246:247], v22 offset:17544
    s_mul_i32 s22, s14, 294912
    s_add_u32 s22, s22, 81788928
    buffer_load_dword v145, v3, s[4:7], s22 offen offset:0 sc1
    buffer_load_dword v146, v3, s[4:7], s22 offen offset:128 sc1
    buffer_load_dword v147, v4, s[4:7], s22 offen offset:0 sc1
    buffer_load_dword v148, v7, s[4:7], s22 offen offset:0 sc1
    buffer_load_dword v149, v11, s[4:7], s22 offen offset:0 sc1
    buffer_load_dword v247, v245, s[4:7], 0 offen sc1
    s_waitcnt vmcnt(7)
    ds_read_b64_tr_b16 a[216:217], v22 offset:20480
    ds_read_b64_tr_b16 a[218:219], v22 offset:20608
    ds_read_b64_tr_b16 a[220:221], v22 offset:21504
    ds_read_b64_tr_b16 a[222:223], v22 offset:21632
    s_waitcnt lgkmcnt(4)
    ds_read_b64_tr_b16 a[248:249], v22 offset:20488
    ds_read_b64_tr_b16 a[250:251], v22 offset:20616
    ds_read_b64_tr_b16 a[252:253], v22 offset:21512
    ds_read_b64_tr_b16 a[254:255], v22 offset:21640
    s_waitcnt lgkmcnt(0)
    v_mov_b32 v155, 0
    v_mov_b32 v159, 0
    v_mov_b32 v163, 0
    v_mov_b32 v167, 0
    v_mov_b32 v179, 0
    s_waitcnt vmcnt(0)
    v_readfirstlane_b32 s85, v247
    v_mov_b32 v40, 0
    v_mov_b32 v41, 0
    v_mov_b32 v42, 0
    v_mov_b32 v43, 0
    v_mov_b32 v44, 0
    v_mov_b32 v45, 0
    v_mov_b32 v46, 0
    v_mov_b32 v47, 0
    v_mov_b32 v48, 0
    v_mov_b32 v49, 0
    v_mov_b32 v50, 0
    v_mov_b32 v51, 0
    v_mov_b32 v52, 0
    v_mov_b32 v53, 0
    v_mov_b32 v54, 0
    v_mov_b32 v55, 0
    v_mov_b32 v56, 0
    v_mov_b32 v57, 0
    v_mov_b32 v58, 0
    v_mov_b32 v59, 0
    v_mov_b32 v60, 0
    v_mov_b32 v61, 0
    v_mov_b32 v62, 0
    v_mov_b32 v63, 0
    v_mov_b32 v64, 0
    v_mov_b32 v65, 0
    v_mov_b32 v66, 0
    v_mov_b32 v67, 0
    v_mov_b32 v68, 0
    v_mov_b32 v69, 0
    v_mov_b32 v70, 0
    v_mov_b32 v71, 0
    s_cmp_ge_u32 s14, 2
    s_cbranch_scc1 kv_26
    s_mov_b32 s94, 1
    s_mov_b32 s23, s25
fw_28:
    s_cmp_ge_u32 s85, s94
    s_cbranch_scc1 fo_29
    buffer_load_dword v247, v245, s[4:7], 0 offen sc1
    s_add_u32 s23, s23, 1
    s_waitcnt vmcnt(0)
    v_readfirstlane_b32 s85, v247
    s_cmp_lt_u32 s23, 200000
    s_cbranch_scc1 fw_28
    s_mov_b32 s25, 200000
fo_29:
    s_cmp_eq_u32 s14, 1
    s_cbranch_scc1 kv_27
    buffer_load_dwordx4 v[132:135], v12, s[4:7], s17 offen sc1
    buffer_load_dwordx4 v[136:139], v12, s[4:7], s17 offen offset:128 sc1
    s_add_u32 s17, s17, 2048
    s_min_u32 s17, s17, 17954816
    s_branch kv_26
kv_27:
    buffer_load_dwordx4 v[228:231], v13, s[4:7], s18 offen offset:0 sc1
    buffer_load_dwordx4 v[232:235], v13, s[4:7], s18 offen offset:128 sc1
    s_add_u32 s18, s18, 2048
    s_min_u32 s18, s18, 35780608
kv_26:
    s_mul_i32 s86, s27, 4160
    s_add_u32 s86, s86, 17825792
    s_mov_b32 s23, s25
    s_barrier
    s_cmp_eq_u32 s45, 0
    s_cbranch_scc1 recur_slow_disp
    s_cmp_eq_u32 s14, 1
    s_cbranch_scc1 recur_fast_w1
    s_cmp_eq_u32 s14, 2
    s_cbranch_scc1 recur_fast_w2
    s_cmp_eq_u32 s14, 3
    s_cbranch_scc1 recur_fast_w3
    s_branch recur_fast_w0
recur_slow_disp:
    s_cmp_eq_u32 s14, 1
    s_cbranch_scc1 recur_slow_w1
    s_cmp_eq_u32 s14, 2
    s_cbranch_scc1 recur_slow_w2
    s_cmp_eq_u32 s14, 3
    s_cbranch_scc1 recur_slow_w3
    s_branch recur_slow_w0
.p2align 6
recur_fast_w0:
    s_nop 15
    s_mov_b32 s23, s25
    buffer_load_dwordx4 v[24:27], v2, s[4:7], s16 offen offset:0 sc1
    s_nop 11
    buffer_load_dwordx4 v[28:31], v2, s[4:7], s16 offen offset:1024 sc1
    s_nop 11
    buffer_load_dwordx4 v[32:35], v2, s[4:7], s16 offen offset:2048 sc1
    s_nop 11
    buffer_load_dwordx4 v[36:39], v2, s[4:7], s16 offen offset:3072 sc1
    s_waitcnt vmcnt(3)
    v_max3_u32 v19, v24, v25, v26
    v_max_u32 v19, v19, v27
    v_cmp_eq_u32 vcc, -1, v19
    s_nop 0
    s_cbranch_vccnz g_30F15_0
    v_smfmac_f32_16x16x64_bf16 v[40:43], v[24:27], a[0:7], v172
    s_waitcnt vmcnt(2)
    v_max3_u32 v19, v28, v29, v30
    v_max_u32 v19, v19, v31
    v_smfmac_f32_16x16x64_bf16 v[44:47], v[24:27], a[64:71], v172
    v_cmp_eq_u32 vcc, -1, v19
    v_smfmac_f32_16x16x64_bf16 v[48:51], v[24:27], a[32:39], v172
    v_smfmac_f32_16x16x64_bf16 v[52:55], v[24:27], a[96:103], v172
    s_cbranch_vccnz g_30F14_1
    v_smfmac_f32_16x16x64_bf16 v[40:43], v[28:31], a[8:15], v172
    s_waitcnt vmcnt(1)
    v_max3_u32 v19, v32, v33, v34
    v_max_u32 v19, v19, v35
    v_smfmac_f32_16x16x64_bf16 v[44:47], v[28:31], a[72:79], v172
    v_cmp_eq_u32 vcc, -1, v19
    v_smfmac_f32_16x16x64_bf16 v[48:51], v[28:31], a[40:47], v172
    v_smfmac_f32_16x16x64_bf16 v[52:55], v[28:31], a[104:111], v172
    s_cbranch_vccnz g_30F12_2
    v_smfmac_f32_16x16x64_bf16 v[40:43], v[32:35], a[16:23], v172
    s_waitcnt vmcnt(0)
    v_max3_u32 v19, v36, v37, v38
    v_max_u32 v19, v19, v39
    v_smfmac_f32_16x16x64_bf16 v[44:47], v[32:35], a[80:87], v172
    v_cmp_eq_u32 vcc, -1, v19
    v_smfmac_f32_16x16x64_bf16 v[48:51], v[32:35], a[48:55], v172
    v_smfmac_f32_16x16x64_bf16 v[52:55], v[32:35], a[112:119], v172
    s_cbranch_vccnz g_30F8_3
    v_smfmac_f32_16x16x64_bf16 v[40:43], v[36:39], a[24:31], v172
    v_smfmac_f32_16x16x64_bf16 v[44:47], v[36:39], a[88:95], v172
    v_smfmac_f32_16x16x64_bf16 v[48:51], v[36:39], a[56:63], v172
    v_smfmac_f32_16x16x64_bf16 v[52:55], v[36:39], a[120:127], v172
gc_31:
    v_cvt_pk_bf16_f32 v72, v40, v41
    v_cvt_pk_bf16_f32 v73, v42, v43
    v_cvt_pk_bf16_f32 v74, v44, v45
    v_cvt_pk_bf16_f32 v75, v46, v47
    v_smfmac_f32_16x16x64_bf16 v[56:59], v[24:27], a[128:135], v172
    v_cvt_pk_bf16_f32 v76, v48, v49
    v_cvt_pk_bf16_f32 v77, v50, v51
    s_nop 0
    v_cvt_pk_bf16_f32 v78, v52, v53
    v_cvt_pk_bf16_f32 v79, v54, v55
    v_smfmac_f32_16x16x64_bf16 v[60:63], v[24:27], a[160:167], v172
    v_mfma_f32_16x16x32_bf16 v[88:91], v[72:75], v[84:87], 0
    v_mfma_f32_16x16x32_bf16 v[92:95], v[76:79], v[84:87], 0
    v_smfmac_f32_16x16x64_bf16 v[56:59], v[28:31], a[136:143], v172
    v_smfmac_f32_16x16x64_bf16 v[60:63], v[28:31], a[168:175], v172
    s_barrier
    ds_read_b128 v[104:107], v16 offset:2048
    ds_read_b128 v[108:111], v16 offset:3072
    ds_read_b128 v[112:115], v16 offset:4096
    ds_read_b128 v[116:119], v16 offset:5120
    ds_read_b128 v[120:123], v16 offset:6144
    ds_read_b128 v[124:127], v16 offset:7168
    v_smfmac_f32_16x16x64_bf16 v[56:59], v[32:35], a[144:151], v172
    v_smfmac_f32_16x16x64_bf16 v[60:63], v[32:35], a[176:183], v172
    v_smfmac_f32_16x16x64_bf16 v[56:59], v[36:39], a[152:159], v172
    v_smfmac_f32_16x16x64_bf16 v[60:63], v[36:39], a[184:191], v172
    s_waitcnt lgkmcnt(5)
    v_mfma_f32_16x16x32_bf16 v[88:91], v[104:107], v[84:87], v[88:91]
    s_waitcnt lgkmcnt(4)
    v_mfma_f32_16x16x32_bf16 v[92:95], v[108:111], v[84:87], v[92:95]
    s_waitcnt lgkmcnt(3)
    v_mfma_f32_16x16x32_bf16 v[88:91], v[112:115], v[84:87], v[88:91]
    s_waitcnt lgkmcnt(2)
    v_mfma_f32_16x16x32_bf16 v[92:95], v[116:119], v[84:87], v[92:95]
    s_waitcnt lgkmcnt(1)
    v_mfma_f32_16x16x32_bf16 v[88:91], v[120:123], v[84:87], v[88:91]
    s_waitcnt lgkmcnt(0)
    v_mfma_f32_16x16x32_bf16 v[92:95], v[124:127], v[84:87], v[92:95]
    v_cvt_pk_bf16_f32 v80, v56, v57
    v_cvt_pk_bf16_f32 v81, v58, v59
    v_cvt_pk_bf16_f32 v82, v60, v61
    v_cvt_pk_bf16_f32 v83, v62, v63
    ds_write_b128 v17, v[80:83] offset:8192
    s_nop 0
    v_cvt_pk_bf16_f32 v128, v88, v89
    v_cvt_pk_bf16_f32 v129, v90, v91
    v_cvt_pk_bf16_f32 v130, v92, v93
    v_cvt_pk_bf16_f32 v131, v94, v95
    s_nop 1
    v_mfma_f32_16x16x32_bf16 v[144:147], v[132:135], v[128:131], 0
    v_mfma_f32_16x16x32_bf16 v[148:151], v[136:139], v[128:131], 0
    v_mfma_f32_16x16x32_bf16 v[140:143], v[128:131], v[128:131], 0
    s_nop 1
    buffer_store_dwordx4 v[144:147], v3, s[4:7], s16 offen
    s_nop 1
    buffer_store_dwordx4 v[148:151], v3, s[4:7], s16 offen offset:128
    s_nop 1
    buffer_store_dwordx4 v[140:143], v4, s[4:7], s16 offen
    s_cmp_eq_u32 s15, 63
    s_waitcnt lgkmcnt(0)
    s_barrier
    s_cbranch_scc1 recur_fast_last0
    v_readfirstlane_b32 s85, v247
    s_add_u32 s94, s15, 2
    s_barrier
    s_nop 15
    s_mov_b32 s23, s25
    buffer_load_dwordx4 v[24:27], v8, s[4:7], s16 offen offset:0 sc1
    s_nop 11
    buffer_load_dwordx4 v[28:31], v8, s[4:7], s16 offen offset:1024 sc1
    s_nop 11
    buffer_load_dwordx4 v[32:35], v8, s[4:7], s16 offen offset:2048 sc1
    s_nop 11
    buffer_load_dwordx4 v[36:39], v8, s[4:7], s16 offen offset:3072 sc1
    s_waitcnt vmcnt(3)
    v_max3_u32 v19, v24, v25, v26
    v_max_u32 v19, v19, v27
    v_cmp_eq_u32 vcc, -1, v19
    s_nop 0
    s_cbranch_vccnz g_32F15_0
    v_smfmac_f32_16x16x64_bf16 v[64:67], v[24:27], a[192:199], v172
    v_smfmac_f32_16x16x64_bf16 v[68:71], v[24:27], a[224:231], v172
    s_waitcnt vmcnt(2)
    v_max3_u32 v19, v28, v29, v30
    v_max_u32 v19, v19, v31
    v_cmp_eq_u32 vcc, -1, v19
    s_nop 0
    s_cbranch_vccnz g_32F14_1
    v_smfmac_f32_16x16x64_bf16 v[64:67], v[28:31], a[200:207], v172
    v_smfmac_f32_16x16x64_bf16 v[68:71], v[28:31], a[232:239], v172
    s_waitcnt vmcnt(1)
    v_max3_u32 v19, v32, v33, v34
    v_max_u32 v19, v19, v35
    v_cmp_eq_u32 vcc, -1, v19
    s_nop 0
    s_cbranch_vccnz g_32F12_2
    v_smfmac_f32_16x16x64_bf16 v[64:67], v[32:35], a[208:215], v172
    v_smfmac_f32_16x16x64_bf16 v[68:71], v[32:35], a[240:247], v172
    s_waitcnt vmcnt(0)
    v_max3_u32 v19, v36, v37, v38
    v_max_u32 v19, v19, v39
    v_cmp_eq_u32 vcc, -1, v19
    s_nop 0
    s_cbranch_vccnz g_32F8_3
    v_smfmac_f32_16x16x64_bf16 v[64:67], v[36:39], a[216:223], v172
    v_smfmac_f32_16x16x64_bf16 v[68:71], v[36:39], a[248:255], v172
    s_nop 4
    v_cvt_pk_bf16_f32 v80, v64, v65
    v_cvt_pk_bf16_f32 v81, v66, v67
    s_nop 0
    v_cvt_pk_bf16_f32 v82, v68, v69
    v_cvt_pk_bf16_f32 v83, v70, v71
    ds_write_b128 v17, v[80:83] offset:9216
gc_33:
    s_waitcnt lgkmcnt(0)
    s_barrier
    s_mov_b32 s23, s25
fw_34:
    s_cmp_ge_u32 s85, s94
    s_cbranch_scc1 fo_35
    buffer_load_dword v247, v245, s[4:7], 0 offen sc1
    s_add_u32 s23, s23, 1
    s_waitcnt vmcnt(0)
    v_readfirstlane_b32 s85, v247
    s_cmp_lt_u32 s23, 200000
    s_cbranch_scc1 fw_34
    s_mov_b32 s25, 200000
fo_35:
    buffer_load_dwordx4 v[132:135], v12, s[4:7], s17 offen sc1
    buffer_load_dwordx4 v[136:139], v12, s[4:7], s17 offen offset:128 sc1
    s_add_u32 s17, s17, 2048
    s_min_u32 s17, s17, 17954816
    s_nop 15
    s_nop 15
    s_nop 15
    s_nop 15
    buffer_store_dwordx4 v[128:131], v14, s[4:7], s19 offen sc1
    s_add_u32 s19, s19, 512
    s_add_u32 s21, s15, 3
    s_min_u32 s21, s21, 64
    s_cmp_lt_u32 s85, s21
    s_cselect_b64 exec, 1, 0
    buffer_load_dword v247, v245, s[4:7], 0 offen sc1
    s_mov_b64 exec, -1
    v_mov_b32 v40, 0
    v_mov_b32 v41, 0
    v_mov_b32 v42, 0
    v_mov_b32 v43, 0
    v_mov_b32 v44, 0
    v_mov_b32 v45, 0
    v_mov_b32 v46, 0
    v_mov_b32 v47, 0
    v_mov_b32 v48, 0
    v_mov_b32 v49, 0
    v_mov_b32 v50, 0
    v_mov_b32 v51, 0
    v_mov_b32 v52, 0
    v_mov_b32 v53, 0
    v_mov_b32 v54, 0
    v_mov_b32 v55, 0
    v_mov_b32 v56, 0
    v_mov_b32 v57, 0
    v_mov_b32 v58, 0
    v_mov_b32 v59, 0
    v_mov_b32 v60, 0
    v_mov_b32 v61, 0
    v_mov_b32 v62, 0
    v_mov_b32 v63, 0
    v_mov_b32 v64, 0
    v_mov_b32 v65, 0
    v_mov_b32 v66, 0
    v_mov_b32 v67, 0
    v_mov_b32 v68, 0
    v_mov_b32 v69, 0
    v_mov_b32 v70, 0
    v_mov_b32 v71, 0
    s_mov_b32 s21, s16
    s_mov_b32 s16, s42
    s_mov_b32 s42, s43
    s_mov_b32 s43, s44
    s_mov_b32 s44, s21
    s_add_u32 s95, s95, 524288
    s_lshr_b32 s84, s95, 8
    s_and_b32 s84, s84, 8192
    s_xor_b32 s84, s84, s46
    s_add_u32 s84, s84, s95
    s_add_u32 s15, s15, 1
    s_barrier
    s_branch recur_fast_w0
g_30L15_0:
    s_waitcnt vmcnt(3)
    v_max3_u32 v19, v24, v25, v26
    v_max_u32 v19, v19, v27
    v_cmp_eq_u32 vcc, -1, v19
    s_nop 0
    s_cbranch_vccnz g_30F15_0
    v_smfmac_f32_16x16x64_bf16 v[40:43], v[24:27], a[0:7], v172
    v_smfmac_f32_16x16x64_bf16 v[44:47], v[24:27], a[64:71], v172
    v_smfmac_f32_16x16x64_bf16 v[48:51], v[24:27], a[32:39], v172
    v_smfmac_f32_16x16x64_bf16 v[52:55], v[24:27], a[96:103], v172
g_30L14_1:
    s_waitcnt vmcnt(2)
    v_max3_u32 v19, v28, v29, v30
    v_max_u32 v19, v19, v31
    v_cmp_eq_u32 vcc, -1, v19
    s_nop 0
    s_cbranch_vccnz g_30F14_1
    v_smfmac_f32_16x16x64_bf16 v[40:43], v[28:31], a[8:15], v172
    v_smfmac_f32_16x16x64_bf16 v[44:47], v[28:31], a[72:79], v172
    v_smfmac_f32_16x16x64_bf16 v[48:51], v[28:31], a[40:47], v172
    v_smfmac_f32_16x16x64_bf16 v[52:55], v[28:31], a[104:111], v172
g_30L12_2:
    s_waitcnt vmcnt(1)
    v_max3_u32 v19, v32, v33, v34
    v_max_u32 v19, v19, v35
    v_cmp_eq_u32 vcc, -1, v19
    s_nop 0
    s_cbranch_vccnz g_30F12_2
    v_smfmac_f32_16x16x64_bf16 v[40:43], v[32:35], a[16:23], v172
    v_smfmac_f32_16x16x64_bf16 v[44:47], v[32:35], a[80:87], v172
    v_smfmac_f32_16x16x64_bf16 v[48:51], v[32:35], a[48:55], v172
    v_smfmac_f32_16x16x64_bf16 v[52:55], v[32:35], a[112:119], v172
g_30L8_3:
    s_waitcnt vmcnt(0)
    v_max3_u32 v19, v36, v37, v38
    v_max_u32 v19, v19, v39
    v_cmp_eq_u32 vcc, -1, v19
    s_nop 0
    s_cbranch_vccnz g_30F8_3
    v_smfmac_f32_16x16x64_bf16 v[40:43], v[36:39], a[24:31], v172
    v_smfmac_f32_16x16x64_bf16 v[44:47], v[36:39], a[88:95], v172
    v_smfmac_f32_16x16x64_bf16 v[48:51], v[36:39], a[56:63], v172
    v_smfmac_f32_16x16x64_bf16 v[52:55], v[36:39], a[120:127], v172
    s_branch gc_31
g_30L15_1:
    s_waitcnt vmcnt(3)
    v_max3_u32 v19, v28, v29, v30
    v_max_u32 v19, v19, v31
    v_cmp_eq_u32 vcc, -1, v19
    s_nop 0
    s_cbranch_vccnz g_30F15_1
    v_smfmac_f32_16x16x64_bf16 v[40:43], v[28:31], a[8:15], v172
    v_smfmac_f32_16x16x64_bf16 v[44:47], v[28:31], a[72:79], v172
    v_smfmac_f32_16x16x64_bf16 v[48:51], v[28:31], a[40:47], v172
    v_smfmac_f32_16x16x64_bf16 v[52:55], v[28:31], a[104:111], v172
g_30L13_2:
    s_waitcnt vmcnt(2)
    v_max3_u32 v19, v32, v33, v34
    v_max_u32 v19, v19, v35
    v_cmp_eq_u32 vcc, -1, v19
    s_nop 0
    s_cbranch_vccnz g_30F13_2
    v_smfmac_f32_16x16x64_bf16 v[40:43], v[32:35], a[16:23], v172
    v_smfmac_f32_16x16x64_bf16 v[44:47], v[32:35], a[80:87], v172
    v_smfmac_f32_16x16x64_bf16 v[48:51], v[32:35], a[48:55], v172
    v_smfmac_f32_16x16x64_bf16 v[52:55], v[32:35], a[112:119], v172
g_30L9_3:
    s_waitcnt vmcnt(1)
    v_max3_u32 v19, v36, v37, v38
    v_max_u32 v19, v19, v39
    v_cmp_eq_u32 vcc, -1, v19
    s_nop 0
    s_cbranch_vccnz g_30F9_3
    v_smfmac_f32_16x16x64_bf16 v[40:43], v[36:39], a[24:31], v172
    v_smfmac_f32_16x16x64_bf16 v[44:47], v[36:39], a[88:95], v172
    v_smfmac_f32_16x16x64_bf16 v[48:51], v[36:39], a[56:63], v172
    v_smfmac_f32_16x16x64_bf16 v[52:55], v[36:39], a[120:127], v172
g_30L1_0:
    s_waitcnt vmcnt(0)
    v_max3_u32 v19, v24, v25, v26
    v_max_u32 v19, v19, v27
    v_cmp_eq_u32 vcc, -1, v19
    s_nop 0
    s_cbranch_vccnz g_30F1_0
    v_smfmac_f32_16x16x64_bf16 v[40:43], v[24:27], a[0:7], v172
    v_smfmac_f32_16x16x64_bf16 v[44:47], v[24:27], a[64:71], v172
    v_smfmac_f32_16x16x64_bf16 v[48:51], v[24:27], a[32:39], v172
    v_smfmac_f32_16x16x64_bf16 v[52:55], v[24:27], a[96:103], v172
    s_branch gc_31
g_30L15_2:
    s_waitcnt vmcnt(3)
    v_max3_u32 v19, v32, v33, v34
    v_max_u32 v19, v19, v35
    v_cmp_eq_u32 vcc, -1, v19
    s_nop 0
    s_cbranch_vccnz g_30F15_2
    v_smfmac_f32_16x16x64_bf16 v[40:43], v[32:35], a[16:23], v172
    v_smfmac_f32_16x16x64_bf16 v[44:47], v[32:35], a[80:87], v172
    v_smfmac_f32_16x16x64_bf16 v[48:51], v[32:35], a[48:55], v172
    v_smfmac_f32_16x16x64_bf16 v[52:55], v[32:35], a[112:119], v172
g_30L11_3:
    s_waitcnt vmcnt(2)
    v_max3_u32 v19, v36, v37, v38
    v_max_u32 v19, v19, v39
    v_cmp_eq_u32 vcc, -1, v19
    s_nop 0
    s_cbranch_vccnz g_30F11_3
    v_smfmac_f32_16x16x64_bf16 v[40:43], v[36:39], a[24:31], v172
    v_smfmac_f32_16x16x64_bf16 v[44:47], v[36:39], a[88:95], v172
    v_smfmac_f32_16x16x64_bf16 v[48:51], v[36:39], a[56:63], v172
    v_smfmac_f32_16x16x64_bf16 v[52:55], v[36:39], a[120:127], v172
g_30L3_0:
    s_waitcnt vmcnt(1)
    v_max3_u32 v19, v24, v25, v26
    v_max_u32 v19, v19, v27
    v_cmp_eq_u32 vcc, -1, v19
    s_nop 0
    s_cbranch_vccnz g_30F3_0
    v_smfmac_f32_16x16x64_bf16 v[40:43], v[24:27], a[0:7], v172
    v_smfmac_f32_16x16x64_bf16 v[44:47], v[24:27], a[64:71], v172
    v_smfmac_f32_16x16x64_bf16 v[48:51], v[24:27], a[32:39], v172
    v_smfmac_f32_16x16x64_bf16 v[52:55], v[24:27], a[96:103], v172
g_30L2_1:
    s_waitcnt vmcnt(0)
    v_max3_u32 v19, v28, v29, v30
    v_max_u32 v19, v19, v31
    v_cmp_eq_u32 vcc, -1, v19
    s_nop 0
    s_cbranch_vccnz g_30F2_1
    v_smfmac_f32_16x16x64_bf16 v[40:43], v[28:31], a[8:15], v172
    v_smfmac_f32_16x16x64_bf16 v[44:47], v[28:31], a[72:79], v172
    v_smfmac_f32_16x16x64_bf16 v[48:51], v[28:31], a[40:47], v172
    v_smfmac_f32_16x16x64_bf16 v[52:55], v[28:31], a[104:111], v172
    s_branch gc_31
g_30L15_3:
    s_waitcnt vmcnt(3)
    v_max3_u32 v19, v36, v37, v38
    v_max_u32 v19, v19, v39
    v_cmp_eq_u32 vcc, -1, v19
    s_nop 0
    s_cbranch_vccnz g_30F15_3
    v_smfmac_f32_16x16x64_bf16 v[40:43], v[36:39], a[24:31], v172
    v_smfmac_f32_16x16x64_bf16 v[44:47], v[36:39], a[88:95], v172
    v_smfmac_f32_16x16x64_bf16 v[48:51], v[36:39], a[56:63], v172
    v_smfmac_f32_16x16x64_bf16 v[52:55], v[36:39], a[120:127], v172
g_30L7_0:
    s_waitcnt vmcnt(2)
    v_max3_u32 v19, v24, v25, v26
    v_max_u32 v19, v19, v27
    v_cmp_eq_u32 vcc, -1, v19
    s_nop 0
    s_cbranch_vccnz g_30F7_0
    v_smfmac_f32_16x16x64_bf16 v[40:43], v[24:27], a[0:7], v172
    v_smfmac_f32_16x16x64_bf16 v[44:47], v[24:27], a[64:71], v172
    v_smfmac_f32_16x16x64_bf16 v[48:51], v[24:27], a[32:39], v172
    v_smfmac_f32_16x16x64_bf16 v[52:55], v[24:27], a[96:103], v172
g_30L6_1:
    s_waitcnt vmcnt(1)
    v_max3_u32 v19, v28, v29, v30
    v_max_u32 v19, v19, v31
    v_cmp_eq_u32 vcc, -1, v19
    s_nop 0
    s_cbranch_vccnz g_30F6_1
    v_smfmac_f32_16x16x64_bf16 v[40:43], v[28:31], a[8:15], v172
    v_smfmac_f32_16x16x64_bf16 v[44:47], v[28:31], a[72:79], v172
    v_smfmac_f32_16x16x64_bf16 v[48:51], v[28:31], a[40:47], v172
    v_smfmac_f32_16x16x64_bf16 v[52:55], v[28:31], a[104:111], v172
g_30L4_2:
    s_waitcnt vmcnt(0)
    v_max3_u32 v19, v32, v33, v34
    v_max_u32 v19, v19, v35
    v_cmp_eq_u32 vcc, -1, v19
    s_nop 0
    s_cbranch_vccnz g_30F4_2
    v_smfmac_f32_16x16x64_bf16 v[40:43], v[32:35], a[16:23], v172
    v_smfmac_f32_16x16x64_bf16 v[44:47], v[32:35], a[80:87], v172
    v_smfmac_f32_16x16x64_bf16 v[48:51], v[32:35], a[48:55], v172
    v_smfmac_f32_16x16x64_bf16 v[52:55], v[32:35], a[112:119], v172
    s_branch gc_31
g_30L7_1:
    s_waitcnt vmcnt(2)
    v_max3_u32 v19, v28, v29, v30
    v_max_u32 v19, v19, v31
    v_cmp_eq_u32 vcc, -1, v19
    s_nop 0
    s_cbranch_vccnz g_30F7_1
    v_smfmac_f32_16x16x64_bf16 v[40:43], v[28:31], a[8:15], v172
    v_smfmac_f32_16x16x64_bf16 v[44:47], v[28:31], a[72:79], v172
    v_smfmac_f32_16x16x64_bf16 v[48:51], v[28:31], a[40:47], v172
    v_smfmac_f32_16x16x64_bf16 v[52:55], v[28:31], a[104:111], v172
g_30L5_2:
    s_waitcnt vmcnt(1)
    v_max3_u32 v19, v32, v33, v34
    v_max_u32 v19, v19, v35
    v_cmp_eq_u32 vcc, -1, v19
    s_nop 0
    s_cbranch_vccnz g_30F5_2
    v_smfmac_f32_16x16x64_bf16 v[40:43], v[32:35], a[16:23], v172
    v_smfmac_f32_16x16x64_bf16 v[44:47], v[32:35], a[80:87], v172
    v_smfmac_f32_16x16x64_bf16 v[48:51], v[32:35], a[48:55], v172
    v_smfmac_f32_16x16x64_bf16 v[52:55], v[32:35], a[112:119], v172
    s_branch g_30L1_0
g_30L7_2:
    s_waitcnt vmcnt(2)
    v_max3_u32 v19, v32, v33, v34
    v_max_u32 v19, v19, v35
    v_cmp_eq_u32 vcc, -1, v19
    s_nop 0
    s_cbranch_vccnz g_30F7_2
    v_smfmac_f32_16x16x64_bf16 v[40:43], v[32:35], a[16:23], v172
    v_smfmac_f32_16x16x64_bf16 v[44:47], v[32:35], a[80:87], v172
    v_smfmac_f32_16x16x64_bf16 v[48:51], v[32:35], a[48:55], v172
    v_smfmac_f32_16x16x64_bf16 v[52:55], v[32:35], a[112:119], v172
    s_branch g_30L3_0
g_30L11_0:
    s_waitcnt vmcnt(2)
    v_max3_u32 v19, v24, v25, v26
    v_max_u32 v19, v19, v27
    v_cmp_eq_u32 vcc, -1, v19
    s_nop 0
    s_cbranch_vccnz g_30F11_0
    v_smfmac_f32_16x16x64_bf16 v[40:43], v[24:27], a[0:7], v172
    v_smfmac_f32_16x16x64_bf16 v[44:47], v[24:27], a[64:71], v172
    v_smfmac_f32_16x16x64_bf16 v[48:51], v[24:27], a[32:39], v172
    v_smfmac_f32_16x16x64_bf16 v[52:55], v[24:27], a[96:103], v172
g_30L10_1:
    s_waitcnt vmcnt(1)
    v_max3_u32 v19, v28, v29, v30
    v_max_u32 v19, v19, v31
    v_cmp_eq_u32 vcc, -1, v19
    s_nop 0
    s_cbranch_vccnz g_30F10_1
    v_smfmac_f32_16x16x64_bf16 v[40:43], v[28:31], a[8:15], v172
    v_smfmac_f32_16x16x64_bf16 v[44:47], v[28:31], a[72:79], v172
    v_smfmac_f32_16x16x64_bf16 v[48:51], v[28:31], a[40:47], v172
    v_smfmac_f32_16x16x64_bf16 v[52:55], v[28:31], a[104:111], v172
    s_branch g_30L8_3
g_30L11_1:
    s_waitcnt vmcnt(2)
    v_max3_u32 v19, v28, v29, v30
    v_max_u32 v19, v19, v31
    v_cmp_eq_u32 vcc, -1, v19
    s_nop 0
    s_cbranch_vccnz g_30F11_1
    v_smfmac_f32_16x16x64_bf16 v[40:43], v[28:31], a[8:15], v172
    v_smfmac_f32_16x16x64_bf16 v[44:47], v[28:31], a[72:79], v172
    v_smfmac_f32_16x16x64_bf16 v[48:51], v[28:31], a[40:47], v172
    v_smfmac_f32_16x16x64_bf16 v[52:55], v[28:31], a[104:111], v172
    s_branch g_30L9_3
g_30L13_0:
    s_waitcnt vmcnt(2)
    v_max3_u32 v19, v24, v25, v26
    v_max_u32 v19, v19, v27
    v_cmp_eq_u32 vcc, -1, v19
    s_nop 0
    s_cbranch_vccnz g_30F13_0
    v_smfmac_f32_16x16x64_bf16 v[40:43], v[24:27], a[0:7], v172
    v_smfmac_f32_16x16x64_bf16 v[44:47], v[24:27], a[64:71], v172
    v_smfmac_f32_16x16x64_bf16 v[48:51], v[24:27], a[32:39], v172
    v_smfmac_f32_16x16x64_bf16 v[52:55], v[24:27], a[96:103], v172
    s_branch g_30L12_2
g_30L13_3:
    s_waitcnt vmcnt(2)
    v_max3_u32 v19, v36, v37, v38
    v_max_u32 v19, v19, v39
    v_cmp_eq_u32 vcc, -1, v19
    s_nop 0
    s_cbranch_vccnz g_30F13_3
    v_smfmac_f32_16x16x64_bf16 v[40:43], v[36:39], a[24:31], v172
    v_smfmac_f32_16x16x64_bf16 v[44:47], v[36:39], a[88:95], v172
    v_smfmac_f32_16x16x64_bf16 v[48:51], v[36:39], a[56:63], v172
    v_smfmac_f32_16x16x64_bf16 v[52:55], v[36:39], a[120:127], v172
g_30L5_0:
    s_waitcnt vmcnt(1)
    v_max3_u32 v19, v24, v25, v26
    v_max_u32 v19, v19, v27
    v_cmp_eq_u32 vcc, -1, v19
    s_nop 0
    s_cbranch_vccnz g_30F5_0
    v_smfmac_f32_16x16x64_bf16 v[40:43], v[24:27], a[0:7], v172
    v_smfmac_f32_16x16x64_bf16 v[44:47], v[24:27], a[64:71], v172
    v_smfmac_f32_16x16x64_bf16 v[48:51], v[24:27], a[32:39], v172
    v_smfmac_f32_16x16x64_bf16 v[52:55], v[24:27], a[96:103], v172
    s_branch g_30L4_2
g_30L14_2:
    s_waitcnt vmcnt(2)
    v_max3_u32 v19, v32, v33, v34
    v_max_u32 v19, v19, v35
    v_cmp_eq_u32 vcc, -1, v19
    s_nop 0
    s_cbranch_vccnz g_30F14_2
    v_smfmac_f32_16x16x64_bf16 v[40:43], v[32:35], a[16:23], v172
    v_smfmac_f32_16x16x64_bf16 v[44:47], v[32:35], a[80:87], v172
    v_smfmac_f32_16x16x64_bf16 v[48:51], v[32:35], a[48:55], v172
    v_smfmac_f32_16x16x64_bf16 v[52:55], v[32:35], a[112:119], v172
g_30L10_3:
    s_waitcnt vmcnt(1)
    v_max3_u32 v19, v36, v37, v38
    v_max_u32 v19, v19, v39
    v_cmp_eq_u32 vcc, -1, v19
    s_nop 0
    s_cbranch_vccnz g_30F10_3
    v_smfmac_f32_16x16x64_bf16 v[40:43], v[36:39], a[24:31], v172
    v_smfmac_f32_16x16x64_bf16 v[44:47], v[36:39], a[88:95], v172
    v_smfmac_f32_16x16x64_bf16 v[48:51], v[36:39], a[56:63], v172
    v_smfmac_f32_16x16x64_bf16 v[52:55], v[36:39], a[120:127], v172
    s_branch g_30L2_1
g_30L14_3:
    s_waitcnt vmcnt(2)
    v_max3_u32 v19, v36, v37, v38
    v_max_u32 v19, v19, v39
    v_cmp_eq_u32 vcc, -1, v19
    s_nop 0
    s_cbranch_vccnz g_30F14_3
    v_smfmac_f32_16x16x64_bf16 v[40:43], v[36:39], a[24:31], v172
    v_smfmac_f32_16x16x64_bf16 v[44:47], v[36:39], a[88:95], v172
    v_smfmac_f32_16x16x64_bf16 v[48:51], v[36:39], a[56:63], v172
    v_smfmac_f32_16x16x64_bf16 v[52:55], v[36:39], a[120:127], v172
    s_branch g_30L6_1
g_30L3_1:
    s_waitcnt vmcnt(1)
    v_max3_u32 v19, v28, v29, v30
    v_max_u32 v19, v19, v31
    v_cmp_eq_u32 vcc, -1, v19
    s_nop 0
    s_cbranch_vccnz g_30F3_1
    v_smfmac_f32_16x16x64_bf16 v[40:43], v[28:31], a[8:15], v172
    v_smfmac_f32_16x16x64_bf16 v[44:47], v[28:31], a[72:79], v172
    v_smfmac_f32_16x16x64_bf16 v[48:51], v[28:31], a[40:47], v172
    v_smfmac_f32_16x16x64_bf16 v[52:55], v[28:31], a[104:111], v172
    s_branch g_30L1_0
g_30L6_2:
    s_waitcnt vmcnt(1)
    v_max3_u32 v19, v32, v33, v34
    v_max_u32 v19, v19, v35
    v_cmp_eq_u32 vcc, -1, v19
    s_nop 0
    s_cbranch_vccnz g_30F6_2
    v_smfmac_f32_16x16x64_bf16 v[40:43], v[32:35], a[16:23], v172
    v_smfmac_f32_16x16x64_bf16 v[44:47], v[32:35], a[80:87], v172
    v_smfmac_f32_16x16x64_bf16 v[48:51], v[32:35], a[48:55], v172
    v_smfmac_f32_16x16x64_bf16 v[52:55], v[32:35], a[112:119], v172
    s_branch g_30L2_1
g_30L9_0:
    s_waitcnt vmcnt(1)
    v_max3_u32 v19, v24, v25, v26
    v_max_u32 v19, v19, v27
    v_cmp_eq_u32 vcc, -1, v19
    s_nop 0
    s_cbranch_vccnz g_30F9_0
    v_smfmac_f32_16x16x64_bf16 v[40:43], v[24:27], a[0:7], v172
    v_smfmac_f32_16x16x64_bf16 v[44:47], v[24:27], a[64:71], v172
    v_smfmac_f32_16x16x64_bf16 v[48:51], v[24:27], a[32:39], v172
    v_smfmac_f32_16x16x64_bf16 v[52:55], v[24:27], a[96:103], v172
    s_branch g_30L8_3
g_30L12_3:
    s_waitcnt vmcnt(1)
    v_max3_u32 v19, v36, v37, v38
    v_max_u32 v19, v19, v39
    v_cmp_eq_u32 vcc, -1, v19
    s_nop 0
    s_cbranch_vccnz g_30F12_3
    v_smfmac_f32_16x16x64_bf16 v[40:43], v[36:39], a[24:31], v172
    v_smfmac_f32_16x16x64_bf16 v[44:47], v[36:39], a[88:95], v172
    v_smfmac_f32_16x16x64_bf16 v[48:51], v[36:39], a[56:63], v172
    v_smfmac_f32_16x16x64_bf16 v[52:55], v[36:39], a[120:127], v172
    s_branch g_30L4_2
g_30F15_0:
    s_mov_b64 exec, vcc
    buffer_load_dwordx4 v[24:27], v2, s[4:7], s16 offen offset:0 sc1
    s_mov_b64 exec, -1
    s_add_u32 s23, s23, 1
    s_cmp_lt_u32 s23, 200000
    s_cbranch_scc1 g_30L15_1
    s_mov_b32 s25, 200000
    s_branch gc_31
g_30F15_1:
    s_mov_b64 exec, vcc
    buffer_load_dwordx4 v[28:31], v2, s[4:7], s16 offen offset:1024 sc1
    s_mov_b64 exec, -1
    s_add_u32 s23, s23, 1
    s_cmp_lt_u32 s23, 200000
    s_cbranch_scc1 g_30L15_2
    s_mov_b32 s25, 200000
    s_branch gc_31
g_30F15_2:
    s_mov_b64 exec, vcc
    buffer_load_dwordx4 v[32:35], v2, s[4:7], s16 offen offset:2048 sc1
    s_mov_b64 exec, -1
    s_add_u32 s23, s23, 1
    s_cmp_lt_u32 s23, 200000
    s_cbranch_scc1 g_30L15_3
    s_mov_b32 s25, 200000
    s_branch gc_31
g_30F15_3:
    s_mov_b64 exec, vcc
    buffer_load_dwordx4 v[36:39], v2, s[4:7], s16 offen offset:3072 sc1
    s_mov_b64 exec, -1
    s_add_u32 s23, s23, 1
    s_cmp_lt_u32 s23, 200000
    s_cbranch_scc1 g_30L15_0
    s_mov_b32 s25, 200000
    s_branch gc_31
g_30F7_0:
    s_mov_b64 exec, vcc
    buffer_load_dwordx4 v[24:27], v2, s[4:7], s16 offen offset:0 sc1
    s_mov_b64 exec, -1
    s_add_u32 s23, s23, 1
    s_cmp_lt_u32 s23, 200000
    s_cbranch_scc1 g_30L7_1
    s_mov_b32 s25, 200000
    s_branch gc_31
g_30F7_1:
    s_mov_b64 exec, vcc
    buffer_load_dwordx4 v[28:31], v2, s[4:7], s16 offen offset:1024 sc1
    s_mov_b64 exec, -1
    s_add_u32 s23, s23, 1
    s_cmp_lt_u32 s23, 200000
    s_cbranch_scc1 g_30L7_2
    s_mov_b32 s25, 200000
    s_branch gc_31
g_30F7_2:
    s_mov_b64 exec, vcc
    buffer_load_dwordx4 v[32:35], v2, s[4:7], s16 offen offset:2048 sc1
    s_mov_b64 exec, -1
    s_add_u32 s23, s23, 1
    s_cmp_lt_u32 s23, 200000
    s_cbranch_scc1 g_30L7_0
    s_mov_b32 s25, 200000
    s_branch gc_31
g_30F11_0:
    s_mov_b64 exec, vcc
    buffer_load_dwordx4 v[24:27], v2, s[4:7], s16 offen offset:0 sc1
    s_mov_b64 exec, -1
    s_add_u32 s23, s23, 1
    s_cmp_lt_u32 s23, 200000
    s_cbranch_scc1 g_30L11_1
    s_mov_b32 s25, 200000
    s_branch gc_31
g_30F11_1:
    s_mov_b64 exec, vcc
    buffer_load_dwordx4 v[28:31], v2, s[4:7], s16 offen offset:1024 sc1
    s_mov_b64 exec, -1
    s_add_u32 s23, s23, 1
    s_cmp_lt_u32 s23, 200000
    s_cbranch_scc1 g_30L11_3
    s_mov_b32 s25, 200000
    s_branch gc_31
g_30F11_3:
    s_mov_b64 exec, vcc
    buffer_load_dwordx4 v[36:39], v2, s[4:7], s16 offen offset:3072 sc1
    s_mov_b64 exec, -1
    s_add_u32 s23, s23, 1
    s_cmp_lt_u32 s23, 200000
    s_cbranch_scc1 g_30L11_0
    s_mov_b32 s25, 200000
    s_branch gc_31
g_30F13_0:
    s_mov_b64 exec, vcc
    buffer_load_dwordx4 v[24:27], v2, s[4:7], s16 offen offset:0 sc1
    s_mov_b64 exec, -1
    s_add_u32 s23, s23, 1
    s_cmp_lt_u32 s23, 200000
    s_cbranch_scc1 g_30L13_2
    s_mov_b32 s25, 200000
    s_branch gc_31
g_30F13_2:
    s_mov_b64 exec, vcc
    buffer_load_dwordx4 v[32:35], v2, s[4:7], s16 offen offset:2048 sc1
    s_mov_b64 exec, -1
    s_add_u32 s23, s23, 1
    s_cmp_lt_u32 s23, 200000
    s_cbranch_scc1 g_30L13_3
    s_mov_b32 s25, 200000
    s_branch gc_31
g_30F13_3:
    s_mov_b64 exec, vcc
    buffer_load_dwordx4 v[36:39], v2, s[4:7], s16 offen offset:3072 sc1
    s_mov_b64 exec, -1
    s_add_u32 s23, s23, 1
    s_cmp_lt_u32 s23, 200000
    s_cbranch_scc1 g_30L13_0
    s_mov_b32 s25, 200000
    s_branch gc_31
g_30F14_1:
    s_mov_b64 exec, vcc
    buffer_load_dwordx4 v[28:31], v2, s[4:7], s16 offen offset:1024 sc1
    s_mov_b64 exec, -1
    s_add_u32 s23, s23, 1
    s_cmp_lt_u32 s23, 200000
    s_cbranch_scc1 g_30L14_2
    s_mov_b32 s25, 200000
    s_branch gc_31
g_30F14_2:
    s_mov_b64 exec, vcc
    buffer_load_dwordx4 v[32:35], v2, s[4:7], s16 offen offset:2048 sc1
    s_mov_b64 exec, -1
    s_add_u32 s23, s23, 1
    s_cmp_lt_u32 s23, 200000
    s_cbranch_scc1 g_30L14_3
    s_mov_b32 s25, 200000
    s_branch gc_31
g_30F14_3:
    s_mov_b64 exec, vcc
    buffer_load_dwordx4 v[36:39], v2, s[4:7], s16 offen offset:3072 sc1
    s_mov_b64 exec, -1
    s_add_u32 s23, s23, 1
    s_cmp_lt_u32 s23, 200000
    s_cbranch_scc1 g_30L14_1
    s_mov_b32 s25, 200000
    s_branch gc_31
g_30F3_0:
    s_mov_b64 exec, vcc
    buffer_load_dwordx4 v[24:27], v2, s[4:7], s16 offen offset:0 sc1
    s_mov_b64 exec, -1
    s_add_u32 s23, s23, 1
    s_cmp_lt_u32 s23, 200000
    s_cbranch_scc1 g_30L3_1
    s_mov_b32 s25, 200000
    s_branch gc_31
g_30F3_1:
    s_mov_b64 exec, vcc
    buffer_load_dwordx4 v[28:31], v2, s[4:7], s16 offen offset:1024 sc1
    s_mov_b64 exec, -1
    s_add_u32 s23, s23, 1
    s_cmp_lt_u32 s23, 200000
    s_cbranch_scc1 g_30L3_0
    s_mov_b32 s25, 200000
    s_branch gc_31
g_30F5_0:
    s_mov_b64 exec, vcc
    buffer_load_dwordx4 v[24:27], v2, s[4:7], s16 offen offset:0 sc1
    s_mov_b64 exec, -1
    s_add_u32 s23, s23, 1
    s_cmp_lt_u32 s23, 200000
    s_cbranch_scc1 g_30L5_2
    s_mov_b32 s25, 200000
    s_branch gc_31
g_30F5_2:
    s_mov_b64 exec, vcc
    buffer_load_dwordx4 v[32:35], v2, s[4:7], s16 offen offset:2048 sc1
    s_mov_b64 exec, -1
    s_add_u32 s23, s23, 1
    s_cmp_lt_u32 s23, 200000
    s_cbranch_scc1 g_30L5_0
    s_mov_b32 s25, 200000
    s_branch gc_31
g_30F6_1:
    s_mov_b64 exec, vcc
    buffer_load_dwordx4 v[28:31], v2, s[4:7], s16 offen offset:1024 sc1
    s_mov_b64 exec, -1
    s_add_u32 s23, s23, 1
    s_cmp_lt_u32 s23, 200000
    s_cbranch_scc1 g_30L6_2
    s_mov_b32 s25, 200000
    s_branch gc_31
g_30F6_2:
    s_mov_b64 exec, vcc
    buffer_load_dwordx4 v[32:35], v2, s[4:7], s16 offen offset:2048 sc1
    s_mov_b64 exec, -1
    s_add_u32 s23, s23, 1
    s_cmp_lt_u32 s23, 200000
    s_cbranch_scc1 g_30L6_1
    s_mov_b32 s25, 200000
    s_branch gc_31
g_30F9_0:
    s_mov_b64 exec, vcc
    buffer_load_dwordx4 v[24:27], v2, s[4:7], s16 offen offset:0 sc1
    s_mov_b64 exec, -1
    s_add_u32 s23, s23, 1
    s_cmp_lt_u32 s23, 200000
    s_cbranch_scc1 g_30L9_3
    s_mov_b32 s25, 200000
    s_branch gc_31
g_30F9_3:
    s_mov_b64 exec, vcc
    buffer_load_dwordx4 v[36:39], v2, s[4:7], s16 offen offset:3072 sc1
    s_mov_b64 exec, -1
    s_add_u32 s23, s23, 1
    s_cmp_lt_u32 s23, 200000
    s_cbranch_scc1 g_30L9_0
    s_mov_b32 s25, 200000
    s_branch gc_31
g_30F10_1:
    s_mov_b64 exec, vcc
    buffer_load_dwordx4 v[28:31], v2, s[4:7], s16 offen offset:1024 sc1
    s_mov_b64 exec, -1
    s_add_u32 s23, s23, 1
    s_cmp_lt_u32 s23, 200000
    s_cbranch_scc1 g_30L10_3
    s_mov_b32 s25, 200000
    s_branch gc_31
g_30F10_3:
    s_mov_b64 exec, vcc
    buffer_load_dwordx4 v[36:39], v2, s[4:7], s16 offen offset:3072 sc1
    s_mov_b64 exec, -1
    s_add_u32 s23, s23, 1
    s_cmp_lt_u32 s23, 200000
    s_cbranch_scc1 g_30L10_1
    s_mov_b32 s25, 200000
    s_branch gc_31
g_30F12_2:
    s_mov_b64 exec, vcc
    buffer_load_dwordx4 v[32:35], v2, s[4:7], s16 offen offset:2048 sc1
    s_mov_b64 exec, -1
    s_add_u32 s23, s23, 1
    s_cmp_lt_u32 s23, 200000
    s_cbranch_scc1 g_30L12_3
    s_mov_b32 s25, 200000
    s_branch gc_31
g_30F12_3:
    s_mov_b64 exec, vcc
    buffer_load_dwordx4 v[36:39], v2, s[4:7], s16 offen offset:3072 sc1
    s_mov_b64 exec, -1
    s_add_u32 s23, s23, 1
    s_cmp_lt_u32 s23, 200000
    s_cbranch_scc1 g_30L12_2
    s_mov_b32 s25, 200000
    s_branch gc_31
g_30F1_0:
    s_mov_b64 exec, vcc
    buffer_load_dwordx4 v[24:27], v2, s[4:7], s16 offen offset:0 sc1
    s_mov_b64 exec, -1
    s_add_u32 s23, s23, 1
    s_cmp_lt_u32 s23, 200000
    s_cbranch_scc1 g_30L1_0
    s_mov_b32 s25, 200000
    s_branch gc_31
g_30F2_1:
    s_mov_b64 exec, vcc
    buffer_load_dwordx4 v[28:31], v2, s[4:7], s16 offen offset:1024 sc1
    s_mov_b64 exec, -1
    s_add_u32 s23, s23, 1
    s_cmp_lt_u32 s23, 200000
    s_cbranch_scc1 g_30L2_1
    s_mov_b32 s25, 200000
    s_branch gc_31
g_30F4_2:
    s_mov_b64 exec, vcc
    buffer_load_dwordx4 v[32:35], v2, s[4:7], s16 offen offset:2048 sc1
    s_mov_b64 exec, -1
    s_add_u32 s23, s23, 1
    s_cmp_lt_u32 s23, 200000
    s_cbranch_scc1 g_30L4_2
    s_mov_b32 s25, 200000
    s_branch gc_31
g_30F8_3:
    s_mov_b64 exec, vcc
    buffer_load_dwordx4 v[36:39], v2, s[4:7], s16 offen offset:3072 sc1
    s_mov_b64 exec, -1
    s_add_u32 s23, s23, 1
    s_cmp_lt_u32 s23, 200000
    s_cbranch_scc1 g_30L8_3
    s_mov_b32 s25, 200000
    s_branch gc_31
recur_fast_last0:
    buffer_store_dwordx4 v[128:131], v14, s[4:7], s19 offen sc1
    s_waitcnt vmcnt(0)
    s_branch recur_end
g_32L15_0:
    s_waitcnt vmcnt(3)
    v_max3_u32 v19, v24, v25, v26
    v_max_u32 v19, v19, v27
    v_cmp_eq_u32 vcc, -1, v19
    s_nop 0
    s_cbranch_vccnz g_32F15_0
    v_smfmac_f32_16x16x64_bf16 v[64:67], v[24:27], a[192:199], v172
    v_smfmac_f32_16x16x64_bf16 v[68:71], v[24:27], a[224:231], v172
g_32L14_1:
    s_waitcnt vmcnt(2)
    v_max3_u32 v19, v28, v29, v30
    v_max_u32 v19, v19, v31
    v_cmp_eq_u32 vcc, -1, v19
    s_nop 0
    s_cbranch_vccnz g_32F14_1
    v_smfmac_f32_16x16x64_bf16 v[64:67], v[28:31], a[200:207], v172
    v_smfmac_f32_16x16x64_bf16 v[68:71], v[28:31], a[232:239], v172
g_32L12_2:
    s_waitcnt vmcnt(1)
    v_max3_u32 v19, v32, v33, v34
    v_max_u32 v19, v19, v35
    v_cmp_eq_u32 vcc, -1, v19
    s_nop 0
    s_cbranch_vccnz g_32F12_2
    v_smfmac_f32_16x16x64_bf16 v[64:67], v[32:35], a[208:215], v172
    v_smfmac_f32_16x16x64_bf16 v[68:71], v[32:35], a[240:247], v172
g_32L8_3:
    s_waitcnt vmcnt(0)
    v_max3_u32 v19, v36, v37, v38
    v_max_u32 v19, v19, v39
    v_cmp_eq_u32 vcc, -1, v19
    s_nop 0
    s_cbranch_vccnz g_32F8_3
    v_smfmac_f32_16x16x64_bf16 v[64:67], v[36:39], a[216:223], v172
    v_smfmac_f32_16x16x64_bf16 v[68:71], v[36:39], a[248:255], v172
    s_nop 4
    v_cvt_pk_bf16_f32 v80, v64, v65
    v_cvt_pk_bf16_f32 v81, v66, v67
    s_nop 0
    v_cvt_pk_bf16_f32 v82, v68, v69
    v_cvt_pk_bf16_f32 v83, v70, v71
    ds_write_b128 v17, v[80:83] offset:9216
    s_branch gc_33
g_32L15_1:
    s_waitcnt vmcnt(3)
    v_max3_u32 v19, v28, v29, v30
    v_max_u32 v19, v19, v31
    v_cmp_eq_u32 vcc, -1, v19
    s_nop 0
    s_cbranch_vccnz g_32F15_1
    v_smfmac_f32_16x16x64_bf16 v[64:67], v[28:31], a[200:207], v172
    v_smfmac_f32_16x16x64_bf16 v[68:71], v[28:31], a[232:239], v172
g_32L13_2:
    s_waitcnt vmcnt(2)
    v_max3_u32 v19, v32, v33, v34
    v_max_u32 v19, v19, v35
    v_cmp_eq_u32 vcc, -1, v19
    s_nop 0
    s_cbranch_vccnz g_32F13_2
    v_smfmac_f32_16x16x64_bf16 v[64:67], v[32:35], a[208:215], v172
    v_smfmac_f32_16x16x64_bf16 v[68:71], v[32:35], a[240:247], v172
g_32L9_3:
    s_waitcnt vmcnt(1)
    v_max3_u32 v19, v36, v37, v38
    v_max_u32 v19, v19, v39
    v_cmp_eq_u32 vcc, -1, v19
    s_nop 0
    s_cbranch_vccnz g_32F9_3
    v_smfmac_f32_16x16x64_bf16 v[64:67], v[36:39], a[216:223], v172
    v_smfmac_f32_16x16x64_bf16 v[68:71], v[36:39], a[248:255], v172
g_32L1_0:
    s_waitcnt vmcnt(0)
    v_max3_u32 v19, v24, v25, v26
    v_max_u32 v19, v19, v27
    v_cmp_eq_u32 vcc, -1, v19
    s_nop 0
    s_cbranch_vccnz g_32F1_0
    v_smfmac_f32_16x16x64_bf16 v[64:67], v[24:27], a[192:199], v172
    v_smfmac_f32_16x16x64_bf16 v[68:71], v[24:27], a[224:231], v172
    s_nop 4
    v_cvt_pk_bf16_f32 v80, v64, v65
    v_cvt_pk_bf16_f32 v81, v66, v67
    s_nop 0
    v_cvt_pk_bf16_f32 v82, v68, v69
    v_cvt_pk_bf16_f32 v83, v70, v71
    ds_write_b128 v17, v[80:83] offset:9216
    s_branch gc_33
g_32L15_2:
    s_waitcnt vmcnt(3)
    v_max3_u32 v19, v32, v33, v34
    v_max_u32 v19, v19, v35
    v_cmp_eq_u32 vcc, -1, v19
    s_nop 0
    s_cbranch_vccnz g_32F15_2
    v_smfmac_f32_16x16x64_bf16 v[64:67], v[32:35], a[208:215], v172
    v_smfmac_f32_16x16x64_bf16 v[68:71], v[32:35], a[240:247], v172
g_32L11_3:
    s_waitcnt vmcnt(2)
    v_max3_u32 v19, v36, v37, v38
    v_max_u32 v19, v19, v39
    v_cmp_eq_u32 vcc, -1, v19
    s_nop 0
    s_cbranch_vccnz g_32F11_3
    v_smfmac_f32_16x16x64_bf16 v[64:67], v[36:39], a[216:223], v172
    v_smfmac_f32_16x16x64_bf16 v[68:71], v[36:39], a[248:255], v172
g_32L3_0:
    s_waitcnt vmcnt(1)
    v_max3_u32 v19, v24, v25, v26
    v_max_u32 v19, v19, v27
    v_cmp_eq_u32 vcc, -1, v19
    s_nop 0
    s_cbranch_vccnz g_32F3_0
    v_smfmac_f32_16x16x64_bf16 v[64:67], v[24:27], a[192:199], v172
    v_smfmac_f32_16x16x64_bf16 v[68:71], v[24:27], a[224:231], v172
g_32L2_1:
    s_waitcnt vmcnt(0)
    v_max3_u32 v19, v28, v29, v30
    v_max_u32 v19, v19, v31
    v_cmp_eq_u32 vcc, -1, v19
    s_nop 0
    s_cbranch_vccnz g_32F2_1
    v_smfmac_f32_16x16x64_bf16 v[64:67], v[28:31], a[200:207], v172
    v_smfmac_f32_16x16x64_bf16 v[68:71], v[28:31], a[232:239], v172
    s_nop 4
    v_cvt_pk_bf16_f32 v80, v64, v65
    v_cvt_pk_bf16_f32 v81, v66, v67
    s_nop 0
    v_cvt_pk_bf16_f32 v82, v68, v69
    v_cvt_pk_bf16_f32 v83, v70, v71
    ds_write_b128 v17, v[80:83] offset:9216
    s_branch gc_33
g_32L15_3:
    s_waitcnt vmcnt(3)
    v_max3_u32 v19, v36, v37, v38
    v_max_u32 v19, v19, v39
    v_cmp_eq_u32 vcc, -1, v19
    s_nop 0
    s_cbranch_vccnz g_32F15_3
    v_smfmac_f32_16x16x64_bf16 v[64:67], v[36:39], a[216:223], v172
    v_smfmac_f32_16x16x64_bf16 v[68:71], v[36:39], a[248:255], v172
g_32L7_0:
    s_waitcnt vmcnt(2)
    v_max3_u32 v19, v24, v25, v26
    v_max_u32 v19, v19, v27
    v_cmp_eq_u32 vcc, -1, v19
    s_nop 0
    s_cbranch_vccnz g_32F7_0
    v_smfmac_f32_16x16x64_bf16 v[64:67], v[24:27], a[192:199], v172
    v_smfmac_f32_16x16x64_bf16 v[68:71], v[24:27], a[224:231], v172
g_32L6_1:
    s_waitcnt vmcnt(1)
    v_max3_u32 v19, v28, v29, v30
    v_max_u32 v19, v19, v31
    v_cmp_eq_u32 vcc, -1, v19
    s_nop 0
    s_cbranch_vccnz g_32F6_1
    v_smfmac_f32_16x16x64_bf16 v[64:67], v[28:31], a[200:207], v172
    v_smfmac_f32_16x16x64_bf16 v[68:71], v[28:31], a[232:239], v172
g_32L4_2:
    s_waitcnt vmcnt(0)
    v_max3_u32 v19, v32, v33, v34
    v_max_u32 v19, v19, v35
    v_cmp_eq_u32 vcc, -1, v19
    s_nop 0
    s_cbranch_vccnz g_32F4_2
    v_smfmac_f32_16x16x64_bf16 v[64:67], v[32:35], a[208:215], v172
    v_smfmac_f32_16x16x64_bf16 v[68:71], v[32:35], a[240:247], v172
    s_nop 4
    v_cvt_pk_bf16_f32 v80, v64, v65
    v_cvt_pk_bf16_f32 v81, v66, v67
    s_nop 0
    v_cvt_pk_bf16_f32 v82, v68, v69
    v_cvt_pk_bf16_f32 v83, v70, v71
    ds_write_b128 v17, v[80:83] offset:9216
    s_branch gc_33
g_32L7_1:
    s_waitcnt vmcnt(2)
    v_max3_u32 v19, v28, v29, v30
    v_max_u32 v19, v19, v31
    v_cmp_eq_u32 vcc, -1, v19
    s_nop 0
    s_cbranch_vccnz g_32F7_1
    v_smfmac_f32_16x16x64_bf16 v[64:67], v[28:31], a[200:207], v172
    v_smfmac_f32_16x16x64_bf16 v[68:71], v[28:31], a[232:239], v172
g_32L5_2:
    s_waitcnt vmcnt(1)
    v_max3_u32 v19, v32, v33, v34
    v_max_u32 v19, v19, v35
    v_cmp_eq_u32 vcc, -1, v19
    s_nop 0
    s_cbranch_vccnz g_32F5_2
    v_smfmac_f32_16x16x64_bf16 v[64:67], v[32:35], a[208:215], v172
    v_smfmac_f32_16x16x64_bf16 v[68:71], v[32:35], a[240:247], v172
    s_branch g_32L1_0
g_32L7_2:
    s_waitcnt vmcnt(2)
    v_max3_u32 v19, v32, v33, v34
    v_max_u32 v19, v19, v35
    v_cmp_eq_u32 vcc, -1, v19
    s_nop 0
    s_cbranch_vccnz g_32F7_2
    v_smfmac_f32_16x16x64_bf16 v[64:67], v[32:35], a[208:215], v172
    v_smfmac_f32_16x16x64_bf16 v[68:71], v[32:35], a[240:247], v172
    s_branch g_32L3_0
g_32L11_0:
    s_waitcnt vmcnt(2)
    v_max3_u32 v19, v24, v25, v26
    v_max_u32 v19, v19, v27
    v_cmp_eq_u32 vcc, -1, v19
    s_nop 0
    s_cbranch_vccnz g_32F11_0
    v_smfmac_f32_16x16x64_bf16 v[64:67], v[24:27], a[192:199], v172
    v_smfmac_f32_16x16x64_bf16 v[68:71], v[24:27], a[224:231], v172
g_32L10_1:
    s_waitcnt vmcnt(1)
    v_max3_u32 v19, v28, v29, v30
    v_max_u32 v19, v19, v31
    v_cmp_eq_u32 vcc, -1, v19
    s_nop 0
    s_cbranch_vccnz g_32F10_1
    v_smfmac_f32_16x16x64_bf16 v[64:67], v[28:31], a[200:207], v172
    v_smfmac_f32_16x16x64_bf16 v[68:71], v[28:31], a[232:239], v172
    s_branch g_32L8_3
g_32L11_1:
    s_waitcnt vmcnt(2)
    v_max3_u32 v19, v28, v29, v30
    v_max_u32 v19, v19, v31
    v_cmp_eq_u32 vcc, -1, v19
    s_nop 0
    s_cbranch_vccnz g_32F11_1
    v_smfmac_f32_16x16x64_bf16 v[64:67], v[28:31], a[200:207], v172
    v_smfmac_f32_16x16x64_bf16 v[68:71], v[28:31], a[232:239], v172
    s_branch g_32L9_3
g_32L13_0:
    s_waitcnt vmcnt(2)
    v_max3_u32 v19, v24, v25, v26
    v_max_u32 v19, v19, v27
    v_cmp_eq_u32 vcc, -1, v19
    s_nop 0
    s_cbranch_vccnz g_32F13_0
    v_smfmac_f32_16x16x64_bf16 v[64:67], v[24:27], a[192:199], v172
    v_smfmac_f32_16x16x64_bf16 v[68:71], v[24:27], a[224:231], v172
    s_branch g_32L12_2
g_32L13_3:
    s_waitcnt vmcnt(2)
    v_max3_u32 v19, v36, v37, v38
    v_max_u32 v19, v19, v39
    v_cmp_eq_u32 vcc, -1, v19
    s_nop 0
    s_cbranch_vccnz g_32F13_3
    v_smfmac_f32_16x16x64_bf16 v[64:67], v[36:39], a[216:223], v172
    v_smfmac_f32_16x16x64_bf16 v[68:71], v[36:39], a[248:255], v172
g_32L5_0:
    s_waitcnt vmcnt(1)
    v_max3_u32 v19, v24, v25, v26
    v_max_u32 v19, v19, v27
    v_cmp_eq_u32 vcc, -1, v19
    s_nop 0
    s_cbranch_vccnz g_32F5_0
    v_smfmac_f32_16x16x64_bf16 v[64:67], v[24:27], a[192:199], v172
    v_smfmac_f32_16x16x64_bf16 v[68:71], v[24:27], a[224:231], v172
    s_branch g_32L4_2
g_32L14_2:
    s_waitcnt vmcnt(2)
    v_max3_u32 v19, v32, v33, v34
    v_max_u32 v19, v19, v35
    v_cmp_eq_u32 vcc, -1, v19
    s_nop 0
    s_cbranch_vccnz g_32F14_2
    v_smfmac_f32_16x16x64_bf16 v[64:67], v[32:35], a[208:215], v172
    v_smfmac_f32_16x16x64_bf16 v[68:71], v[32:35], a[240:247], v172
g_32L10_3:
    s_waitcnt vmcnt(1)
    v_max3_u32 v19, v36, v37, v38
    v_max_u32 v19, v19, v39
    v_cmp_eq_u32 vcc, -1, v19
    s_nop 0
    s_cbranch_vccnz g_32F10_3
    v_smfmac_f32_16x16x64_bf16 v[64:67], v[36:39], a[216:223], v172
    v_smfmac_f32_16x16x64_bf16 v[68:71], v[36:39], a[248:255], v172
    s_branch g_32L2_1
g_32L14_3:
    s_waitcnt vmcnt(2)
    v_max3_u32 v19, v36, v37, v38
    v_max_u32 v19, v19, v39
    v_cmp_eq_u32 vcc, -1, v19
    s_nop 0
    s_cbranch_vccnz g_32F14_3
    v_smfmac_f32_16x16x64_bf16 v[64:67], v[36:39], a[216:223], v172
    v_smfmac_f32_16x16x64_bf16 v[68:71], v[36:39], a[248:255], v172
    s_branch g_32L6_1
g_32L3_1:
    s_waitcnt vmcnt(1)
    v_max3_u32 v19, v28, v29, v30
    v_max_u32 v19, v19, v31
    v_cmp_eq_u32 vcc, -1, v19
    s_nop 0
    s_cbranch_vccnz g_32F3_1
    v_smfmac_f32_16x16x64_bf16 v[64:67], v[28:31], a[200:207], v172
    v_smfmac_f32_16x16x64_bf16 v[68:71], v[28:31], a[232:239], v172
    s_branch g_32L1_0
g_32L6_2:
    s_waitcnt vmcnt(1)
    v_max3_u32 v19, v32, v33, v34
    v_max_u32 v19, v19, v35
    v_cmp_eq_u32 vcc, -1, v19
    s_nop 0
    s_cbranch_vccnz g_32F6_2
    v_smfmac_f32_16x16x64_bf16 v[64:67], v[32:35], a[208:215], v172
    v_smfmac_f32_16x16x64_bf16 v[68:71], v[32:35], a[240:247], v172
    s_branch g_32L2_1
g_32L9_0:
    s_waitcnt vmcnt(1)
    v_max3_u32 v19, v24, v25, v26
    v_max_u32 v19, v19, v27
    v_cmp_eq_u32 vcc, -1, v19
    s_nop 0
    s_cbranch_vccnz g_32F9_0
    v_smfmac_f32_16x16x64_bf16 v[64:67], v[24:27], a[192:199], v172
    v_smfmac_f32_16x16x64_bf16 v[68:71], v[24:27], a[224:231], v172
    s_branch g_32L8_3
g_32L12_3:
    s_waitcnt vmcnt(1)
    v_max3_u32 v19, v36, v37, v38
    v_max_u32 v19, v19, v39
    v_cmp_eq_u32 vcc, -1, v19
    s_nop 0
    s_cbranch_vccnz g_32F12_3
    v_smfmac_f32_16x16x64_bf16 v[64:67], v[36:39], a[216:223], v172
    v_smfmac_f32_16x16x64_bf16 v[68:71], v[36:39], a[248:255], v172
    s_branch g_32L4_2
g_32F15_0:
    s_mov_b64 exec, vcc
    buffer_load_dwordx4 v[24:27], v8, s[4:7], s16 offen offset:0 sc1
    s_mov_b64 exec, -1
    s_add_u32 s23, s23, 1
    s_cmp_lt_u32 s23, 200000
    s_cbranch_scc1 g_32L15_1
    s_mov_b32 s25, 200000
    s_branch gc_33
g_32F15_1:
    s_mov_b64 exec, vcc
    buffer_load_dwordx4 v[28:31], v8, s[4:7], s16 offen offset:1024 sc1
    s_mov_b64 exec, -1
    s_add_u32 s23, s23, 1
    s_cmp_lt_u32 s23, 200000
    s_cbranch_scc1 g_32L15_2
    s_mov_b32 s25, 200000
    s_branch gc_33
g_32F15_2:
    s_mov_b64 exec, vcc
    buffer_load_dwordx4 v[32:35], v8, s[4:7], s16 offen offset:2048 sc1
    s_mov_b64 exec, -1
    s_add_u32 s23, s23, 1
    s_cmp_lt_u32 s23, 200000
    s_cbranch_scc1 g_32L15_3
    s_mov_b32 s25, 200000
    s_branch gc_33
g_32F15_3:
    s_mov_b64 exec, vcc
    buffer_load_dwordx4 v[36:39], v8, s[4:7], s16 offen offset:3072 sc1
    s_mov_b64 exec, -1
    s_add_u32 s23, s23, 1
    s_cmp_lt_u32 s23, 200000
    s_cbranch_scc1 g_32L15_0
    s_mov_b32 s25, 200000
    s_branch gc_33
g_32F7_0:
    s_mov_b64 exec, vcc
    buffer_load_dwordx4 v[24:27], v8, s[4:7], s16 offen offset:0 sc1
    s_mov_b64 exec, -1
    s_add_u32 s23, s23, 1
    s_cmp_lt_u32 s23, 200000
    s_cbranch_scc1 g_32L7_1
    s_mov_b32 s25, 200000
    s_branch gc_33
g_32F7_1:
    s_mov_b64 exec, vcc
    buffer_load_dwordx4 v[28:31], v8, s[4:7], s16 offen offset:1024 sc1
    s_mov_b64 exec, -1
    s_add_u32 s23, s23, 1
    s_cmp_lt_u32 s23, 200000
    s_cbranch_scc1 g_32L7_2
    s_mov_b32 s25, 200000
    s_branch gc_33
g_32F7_2:
    s_mov_b64 exec, vcc
    buffer_load_dwordx4 v[32:35], v8, s[4:7], s16 offen offset:2048 sc1
    s_mov_b64 exec, -1
    s_add_u32 s23, s23, 1
    s_cmp_lt_u32 s23, 200000
    s_cbranch_scc1 g_32L7_0
    s_mov_b32 s25, 200000
    s_branch gc_33
g_32F11_0:
    s_mov_b64 exec, vcc
    buffer_load_dwordx4 v[24:27], v8, s[4:7], s16 offen offset:0 sc1
    s_mov_b64 exec, -1
    s_add_u32 s23, s23, 1
    s_cmp_lt_u32 s23, 200000
    s_cbranch_scc1 g_32L11_1
    s_mov_b32 s25, 200000
    s_branch gc_33
g_32F11_1:
    s_mov_b64 exec, vcc
    buffer_load_dwordx4 v[28:31], v8, s[4:7], s16 offen offset:1024 sc1
    s_mov_b64 exec, -1
    s_add_u32 s23, s23, 1
    s_cmp_lt_u32 s23, 200000
    s_cbranch_scc1 g_32L11_3
    s_mov_b32 s25, 200000
    s_branch gc_33
g_32F11_3:
    s_mov_b64 exec, vcc
    buffer_load_dwordx4 v[36:39], v8, s[4:7], s16 offen offset:3072 sc1
    s_mov_b64 exec, -1
    s_add_u32 s23, s23, 1
    s_cmp_lt_u32 s23, 200000
    s_cbranch_scc1 g_32L11_0
    s_mov_b32 s25, 200000
    s_branch gc_33
g_32F13_0:
    s_mov_b64 exec, vcc
    buffer_load_dwordx4 v[24:27], v8, s[4:7], s16 offen offset:0 sc1
    s_mov_b64 exec, -1
    s_add_u32 s23, s23, 1
    s_cmp_lt_u32 s23, 200000
    s_cbranch_scc1 g_32L13_2
    s_mov_b32 s25, 200000
    s_branch gc_33
g_32F13_2:
    s_mov_b64 exec, vcc
    buffer_load_dwordx4 v[32:35], v8, s[4:7], s16 offen offset:2048 sc1
    s_mov_b64 exec, -1
    s_add_u32 s23, s23, 1
    s_cmp_lt_u32 s23, 200000
    s_cbranch_scc1 g_32L13_3
    s_mov_b32 s25, 200000
    s_branch gc_33
g_32F13_3:
    s_mov_b64 exec, vcc
    buffer_load_dwordx4 v[36:39], v8, s[4:7], s16 offen offset:3072 sc1
    s_mov_b64 exec, -1
    s_add_u32 s23, s23, 1
    s_cmp_lt_u32 s23, 200000
    s_cbranch_scc1 g_32L13_0
    s_mov_b32 s25, 200000
    s_branch gc_33
g_32F14_1:
    s_mov_b64 exec, vcc
    buffer_load_dwordx4 v[28:31], v8, s[4:7], s16 offen offset:1024 sc1
    s_mov_b64 exec, -1
    s_add_u32 s23, s23, 1
    s_cmp_lt_u32 s23, 200000
    s_cbranch_scc1 g_32L14_2
    s_mov_b32 s25, 200000
    s_branch gc_33
g_32F14_2:
    s_mov_b64 exec, vcc
    buffer_load_dwordx4 v[32:35], v8, s[4:7], s16 offen offset:2048 sc1
    s_mov_b64 exec, -1
    s_add_u32 s23, s23, 1
    s_cmp_lt_u32 s23, 200000
    s_cbranch_scc1 g_32L14_3
    s_mov_b32 s25, 200000
    s_branch gc_33
g_32F14_3:
    s_mov_b64 exec, vcc
    buffer_load_dwordx4 v[36:39], v8, s[4:7], s16 offen offset:3072 sc1
    s_mov_b64 exec, -1
    s_add_u32 s23, s23, 1
    s_cmp_lt_u32 s23, 200000
    s_cbranch_scc1 g_32L14_1
    s_mov_b32 s25, 200000
    s_branch gc_33
g_32F3_0:
    s_mov_b64 exec, vcc
    buffer_load_dwordx4 v[24:27], v8, s[4:7], s16 offen offset:0 sc1
    s_mov_b64 exec, -1
    s_add_u32 s23, s23, 1
    s_cmp_lt_u32 s23, 200000
    s_cbranch_scc1 g_32L3_1
    s_mov_b32 s25, 200000
    s_branch gc_33
g_32F3_1:
    s_mov_b64 exec, vcc
    buffer_load_dwordx4 v[28:31], v8, s[4:7], s16 offen offset:1024 sc1
    s_mov_b64 exec, -1
    s_add_u32 s23, s23, 1
    s_cmp_lt_u32 s23, 200000
    s_cbranch_scc1 g_32L3_0
    s_mov_b32 s25, 200000
    s_branch gc_33
g_32F5_0:
    s_mov_b64 exec, vcc
    buffer_load_dwordx4 v[24:27], v8, s[4:7], s16 offen offset:0 sc1
    s_mov_b64 exec, -1
    s_add_u32 s23, s23, 1
    s_cmp_lt_u32 s23, 200000
    s_cbranch_scc1 g_32L5_2
    s_mov_b32 s25, 200000
    s_branch gc_33
g_32F5_2:
    s_mov_b64 exec, vcc
    buffer_load_dwordx4 v[32:35], v8, s[4:7], s16 offen offset:2048 sc1
    s_mov_b64 exec, -1
    s_add_u32 s23, s23, 1
    s_cmp_lt_u32 s23, 200000
    s_cbranch_scc1 g_32L5_0
    s_mov_b32 s25, 200000
    s_branch gc_33
g_32F6_1:
    s_mov_b64 exec, vcc
    buffer_load_dwordx4 v[28:31], v8, s[4:7], s16 offen offset:1024 sc1
    s_mov_b64 exec, -1
    s_add_u32 s23, s23, 1
    s_cmp_lt_u32 s23, 200000
    s_cbranch_scc1 g_32L6_2
    s_mov_b32 s25, 200000
    s_branch gc_33
g_32F6_2:
    s_mov_b64 exec, vcc
    buffer_load_dwordx4 v[32:35], v8, s[4:7], s16 offen offset:2048 sc1
    s_mov_b64 exec, -1
    s_add_u32 s23, s23, 1
    s_cmp_lt_u32 s23, 200000
    s_cbranch_scc1 g_32L6_1
    s_mov_b32 s25, 200000
    s_branch gc_33
g_32F9_0:
    s_mov_b64 exec, vcc
    buffer_load_dwordx4 v[24:27], v8, s[4:7], s16 offen offset:0 sc1
    s_mov_b64 exec, -1
    s_add_u32 s23, s23, 1
    s_cmp_lt_u32 s23, 200000
    s_cbranch_scc1 g_32L9_3
    s_mov_b32 s25, 200000
    s_branch gc_33
g_32F9_3:
    s_mov_b64 exec, vcc
    buffer_load_dwordx4 v[36:39], v8, s[4:7], s16 offen offset:3072 sc1
    s_mov_b64 exec, -1
    s_add_u32 s23, s23, 1
    s_cmp_lt_u32 s23, 200000
    s_cbranch_scc1 g_32L9_0
    s_mov_b32 s25, 200000
    s_branch gc_33
g_32F10_1:
    s_mov_b64 exec, vcc
    buffer_load_dwordx4 v[28:31], v8, s[4:7], s16 offen offset:1024 sc1
    s_mov_b64 exec, -1
    s_add_u32 s23, s23, 1
    s_cmp_lt_u32 s23, 200000
    s_cbranch_scc1 g_32L10_3
    s_mov_b32 s25, 200000
    s_branch gc_33
g_32F10_3:
    s_mov_b64 exec, vcc
    buffer_load_dwordx4 v[36:39], v8, s[4:7], s16 offen offset:3072 sc1
    s_mov_b64 exec, -1
    s_add_u32 s23, s23, 1
    s_cmp_lt_u32 s23, 200000
    s_cbranch_scc1 g_32L10_1
    s_mov_b32 s25, 200000
    s_branch gc_33
g_32F12_2:
    s_mov_b64 exec, vcc
    buffer_load_dwordx4 v[32:35], v8, s[4:7], s16 offen offset:2048 sc1
    s_mov_b64 exec, -1
    s_add_u32 s23, s23, 1
    s_cmp_lt_u32 s23, 200000
    s_cbranch_scc1 g_32L12_3
    s_mov_b32 s25, 200000
    s_branch gc_33
g_32F12_3:
    s_mov_b64 exec, vcc
    buffer_load_dwordx4 v[36:39], v8, s[4:7], s16 offen offset:3072 sc1
    s_mov_b64 exec, -1
    s_add_u32 s23, s23, 1
    s_cmp_lt_u32 s23, 200000
    s_cbranch_scc1 g_32L12_2
    s_mov_b32 s25, 200000
    s_branch gc_33
g_32F1_0:
    s_mov_b64 exec, vcc
    buffer_load_dwordx4 v[24:27], v8, s[4:7], s16 offen offset:0 sc1
    s_mov_b64 exec, -1
    s_add_u32 s23, s23, 1
    s_cmp_lt_u32 s23, 200000
    s_cbranch_scc1 g_32L1_0
    s_mov_b32 s25, 200000
    s_branch gc_33
g_32F2_1:
    s_mov_b64 exec, vcc
    buffer_load_dwordx4 v[28:31], v8, s[4:7], s16 offen offset:1024 sc1
    s_mov_b64 exec, -1
    s_add_u32 s23, s23, 1
    s_cmp_lt_u32 s23, 200000
    s_cbranch_scc1 g_32L2_1
    s_mov_b32 s25, 200000
    s_branch gc_33
g_32F4_2:
    s_mov_b64 exec, vcc
    buffer_load_dwordx4 v[32:35], v8, s[4:7], s16 offen offset:2048 sc1
    s_mov_b64 exec, -1
    s_add_u32 s23, s23, 1
    s_cmp_lt_u32 s23, 200000
    s_cbranch_scc1 g_32L4_2
    s_mov_b32 s25, 200000
    s_branch gc_33
g_32F8_3:
    s_mov_b64 exec, vcc
    buffer_load_dwordx4 v[36:39], v8, s[4:7], s16 offen offset:3072 sc1
    s_mov_b64 exec, -1
    s_add_u32 s23, s23, 1
    s_cmp_lt_u32 s23, 200000
    s_cbranch_scc1 g_32L8_3
    s_mov_b32 s25, 200000
    s_branch gc_33
.p2align 6
recur_fast_w1:
    s_nop 15
    s_mov_b32 s23, s25
    buffer_load_dwordx4 v[24:27], v2, s[4:7], s16 offen offset:0 sc1
    s_nop 11
    buffer_load_dwordx4 v[28:31], v2, s[4:7], s16 offen offset:1024 sc1
    s_nop 11
    buffer_load_dwordx4 v[32:35], v2, s[4:7], s16 offen offset:2048 sc1
    s_nop 11
    buffer_load_dwordx4 v[36:39], v2, s[4:7], s16 offen offset:3072 sc1
    s_waitcnt vmcnt(3)
    v_max3_u32 v19, v24, v25, v26
    v_max_u32 v19, v19, v27
    v_cmp_eq_u32 vcc, -1, v19
    s_nop 0
    s_cbranch_vccnz g_36F15_0
    v_smfmac_f32_16x16x64_bf16 v[40:43], v[24:27], a[0:7], v172
    s_waitcnt vmcnt(2)
    v_max3_u32 v19, v28, v29, v30
    v_max_u32 v19, v19, v31
    v_smfmac_f32_16x16x64_bf16 v[44:47], v[24:27], a[64:71], v172
    v_cmp_eq_u32 vcc, -1, v19
    v_smfmac_f32_16x16x64_bf16 v[48:51], v[24:27], a[32:39], v172
    v_smfmac_f32_16x16x64_bf16 v[52:55], v[24:27], a[96:103], v172
    s_cbranch_vccnz g_36F14_1
    v_smfmac_f32_16x16x64_bf16 v[40:43], v[28:31], a[8:15], v172
    s_waitcnt vmcnt(1)
    v_max3_u32 v19, v32, v33, v34
    v_max_u32 v19, v19, v35
    v_smfmac_f32_16x16x64_bf16 v[44:47], v[28:31], a[72:79], v172
    v_cmp_eq_u32 vcc, -1, v19
    v_smfmac_f32_16x16x64_bf16 v[48:51], v[28:31], a[40:47], v172
    v_smfmac_f32_16x16x64_bf16 v[52:55], v[28:31], a[104:111], v172
    s_cbranch_vccnz g_36F12_2
    v_smfmac_f32_16x16x64_bf16 v[40:43], v[32:35], a[16:23], v172
    s_waitcnt vmcnt(0)
    v_max3_u32 v19, v36, v37, v38
    v_max_u32 v19, v19, v39
    v_smfmac_f32_16x16x64_bf16 v[44:47], v[32:35], a[80:87], v172
    v_cmp_eq_u32 vcc, -1, v19
    v_smfmac_f32_16x16x64_bf16 v[48:51], v[32:35], a[48:55], v172
    v_smfmac_f32_16x16x64_bf16 v[52:55], v[32:35], a[112:119], v172
    s_cbranch_vccnz g_36F8_3
    v_smfmac_f32_16x16x64_bf16 v[40:43], v[36:39], a[24:31], v172
    v_smfmac_f32_16x16x64_bf16 v[44:47], v[36:39], a[88:95], v172
    v_smfmac_f32_16x16x64_bf16 v[48:51], v[36:39], a[56:63], v172
    v_smfmac_f32_16x16x64_bf16 v[52:55], v[36:39], a[120:127], v172
gc_37:
    v_cvt_pk_bf16_f32 v72, v40, v41
    v_cvt_pk_bf16_f32 v73, v42, v43
    v_cvt_pk_bf16_f32 v74, v44, v45
    v_cvt_pk_bf16_f32 v75, v46, v47
    ds_write_b128 v17, v[72:75] offset:0
    v_cvt_pk_bf16_f32 v76, v48, v49
    v_cvt_pk_bf16_f32 v77, v50, v51
    s_nop 0
    v_cvt_pk_bf16_f32 v78, v52, v53
    v_cvt_pk_bf16_f32 v79, v54, v55
    ds_write_b128 v17, v[76:79] offset:1024
    v_smfmac_f32_16x16x64_bf16 v[56:59], v[24:27], a[128:135], v172
    v_smfmac_f32_16x16x64_bf16 v[60:63], v[24:27], a[160:167], v172
    v_smfmac_f32_16x16x64_bf16 v[56:59], v[28:31], a[136:143], v172
    s_waitcnt lgkmcnt(0)
    s_barrier
    v_smfmac_f32_16x16x64_bf16 v[60:63], v[28:31], a[168:175], v172
    v_smfmac_f32_16x16x64_bf16 v[56:59], v[32:35], a[144:151], v172
    v_smfmac_f32_16x16x64_bf16 v[60:63], v[32:35], a[176:183], v172
    v_smfmac_f32_16x16x64_bf16 v[56:59], v[36:39], a[152:159], v172
    v_smfmac_f32_16x16x64_bf16 v[60:63], v[36:39], a[184:191], v172
    s_nop 4
    v_cvt_pk_bf16_f32 v80, v56, v57
    v_cvt_pk_bf16_f32 v81, v58, v59
    s_nop 0
    v_cvt_pk_bf16_f32 v82, v60, v61
    v_cvt_pk_bf16_f32 v83, v62, v63
    ds_write_b128 v17, v[80:83] offset:8192
    v_mov_b32 v152, v228
    v_mov_b32 v153, v229
    v_mov_b32 v156, v230
    v_mov_b32 v157, v231
    v_mov_b32 v160, v232
    v_mov_b32 v161, v233
    v_mov_b32 v164, v234
    v_mov_b32 v165, v235
    s_cmp_eq_u32 s15, 63
    s_waitcnt lgkmcnt(0)
    s_barrier
    s_cbranch_scc1 recur_end
    s_nop 15
    s_nop 15
    s_nop 7
    buffer_load_dwordx4 v[208:211], v5, s[4:7], s16 offen offset:0 sc1
    buffer_load_dwordx4 v[212:215], v5, s[4:7], s16 offen offset:1024 sc1
    buffer_load_dwordx4 v[216:219], v5, s[4:7], s16 offen offset:2048 sc1
    buffer_load_dwordx4 v[220:223], v5, s[4:7], s16 offen offset:3072 sc1
    buffer_load_dword v224, v6, s[4:7], s16 offen offset:0 sc1
    buffer_load_dword v225, v6, s[4:7], s16 offen offset:256 sc1
    buffer_load_dword v226, v6, s[4:7], s16 offen offset:512 sc1
    buffer_load_dword v227, v6, s[4:7], s16 offen offset:768 sc1
    s_mov_b32 s23, s25
    ds_read_b128 v[96:99], v16 offset:8192
    ds_read_b128 v[104:107], v16 offset:12288
    ds_read_b128 v[108:111], v16 offset:14336
    v_mfma_f32_16x16x32_bf16 v[140:143], v[84:87], v[80:83], 0
    s_waitcnt lgkmcnt(2)
    v_mfma_f32_16x16x32_bf16 v[140:143], v[84:87], v[96:99], v[140:143]
    s_waitcnt lgkmcnt(1)
    v_mfma_f32_16x16x32_bf16 v[140:143], v[84:87], v[104:107], v[140:143]
    s_waitcnt lgkmcnt(0)
    v_mfma_f32_16x16x32_bf16 v[140:143], v[84:87], v[108:111], v[140:143]
    buffer_load_dwordx4 v[24:27], v5, s[4:7], s16 offen offset:0 sc1
    buffer_load_dwordx4 v[28:31], v5, s[4:7], s16 offen offset:1024 sc1
    buffer_load_dwordx4 v[32:35], v5, s[4:7], s16 offen offset:2048 sc1
    buffer_load_dwordx4 v[36:39], v5, s[4:7], s16 offen offset:3072 sc1
    buffer_load_dword v40, v6, s[4:7], s16 offen offset:0 sc1
    buffer_load_dword v41, v6, s[4:7], s16 offen offset:256 sc1
    buffer_load_dword v42, v6, s[4:7], s16 offen offset:512 sc1
    buffer_load_dword v43, v6, s[4:7], s16 offen offset:768 sc1
    v_cvt_pk_bf16_f32 v154, v140, v179
    v_cvt_pk_bf16_f32 v158, v141, v179
    v_cvt_pk_bf16_f32 v162, v142, v179
    v_cvt_pk_bf16_f32 v166, v143, v179
    s_waitcnt vmcnt(14)
    v_pk_add_f32 v[180:181], v[208:209], v[212:213]
    v_pk_add_f32 v[182:183], v[210:211], v[214:215]
    s_waitcnt vmcnt(12)
    v_pk_add_f32 v[188:189], v[216:217], v[220:221]
    v_pk_add_f32 v[190:191], v[218:219], v[222:223]
    v_pk_add_f32 v[180:181], v[180:181], v[188:189]
    v_pk_add_f32 v[182:183], v[182:183], v[190:191]
    v_pk_add_f32 v[188:189], v[180:181], v[182:183]
    v_max3_f32 v185, v180, v181, v182
    s_waitcnt vmcnt(8)
    v_pk_add_f32 v[192:193], v[224:225], v[226:227]
    v_add_f32 v188, v188, v189
    v_add_f32 v184, v192, v193
    v_max3_f32 v185, v185, v183, v184
    v_cmp_u_f32 vcc, v188, v184
    s_nop 0
    v_max_f32_dpp v185, v185, v185 row_ror:8 row_mask:0xf bank_mask:0xf
    v_mov_b32 v186, v185
    s_nop 1
    v_permlane16_swap_b32 v185, v186
    v_max_f32 v185, v185, v186
    v_mov_b32 v186, v185
    s_cbranch_vccnz ss_38r
sg_40:
    s_nop 0
    v_permlane32_swap_b32 v185, v186
    v_max_f32 v185, v185, v186
    v_mul_f32 v185, s24, v185
    v_fma_f32 v180, v180, s24, -v185
    v_fma_f32 v181, v181, s24, -v185
    v_fma_f32 v182, v182, s24, -v185
    v_fma_f32 v183, v183, s24, -v185
    v_fma_f32 v184, v184, s24, -v185
    v_exp_f32 v180, v180
    v_exp_f32 v181, v181
    v_exp_f32 v182, v182
    v_exp_f32 v183, v183
    v_exp_f32 v184, v184
    v_cvt_pk_bf16_f32 v176, v180, v181
    v_cvt_pk_bf16_f32 v177, v182, v183
    v_cvt_pk_bf16_f32 v178, v184, v179
    s_nop 1
    v_mfma_f32_16x16x32_bf16 v[240:243], v[236:239], v[176:179], 0
    v_mfma_f32_16x16x32_bf16 v[188:191], v[152:155], v[176:179], 0
    v_mfma_f32_16x16x32_bf16 v[192:195], v[156:159], v[176:179], 0
    v_mfma_f32_16x16x32_bf16 v[196:199], v[160:163], v[176:179], 0
    v_mfma_f32_16x16x32_bf16 v[200:203], v[164:167], v[176:179], 0
    v_add_f32_dpp v185, v240, v240 row_ror:8 row_mask:0xf bank_mask:0xf
    v_rcp_f32 v185, v185
    v_add_f32_dpp v88, v192, v188 row_ror:8 row_mask:0xf bank_mask:0x3
    v_add_f32_dpp v89, v193, v189 row_ror:8 row_mask:0xf bank_mask:0x3
    v_add_f32_dpp v90, v194, v190 row_ror:8 row_mask:0xf bank_mask:0x3
    v_add_f32_dpp v91, v195, v191 row_ror:8 row_mask:0xf bank_mask:0x3
    s_nop 1
    v_add_f32_dpp v88, v196, v200 row_ror:8 row_mask:0xf bank_mask:0xc
    v_add_f32_dpp v89, v197, v201 row_ror:8 row_mask:0xf bank_mask:0xc
    v_add_f32_dpp v90, v198, v202 row_ror:8 row_mask:0xf bank_mask:0xc
    v_add_f32_dpp v91, v199, v203 row_ror:8 row_mask:0xf bank_mask:0xc
    v_mul_f32 v88, v88, v185
    v_mul_f32 v89, v89, v185
    v_mul_f32 v90, v90, v185
    v_mul_f32 v91, v91, v185
    v_cvt_pk_bf16_f32 v88, v88, v89
    v_cvt_pk_bf16_f32 v89, v90, v91
    buffer_store_dwordx2 v[88:89], v7, s[4:7], s16 offen
    v_readfirstlane_b32 s85, v247
    s_add_u32 s94, s15, 2
    s_barrier
    s_nop 15
    s_mov_b32 s23, s25
    buffer_load_dwordx4 v[24:27], v8, s[4:7], s16 offen offset:0 sc1
    s_nop 11
    buffer_load_dwordx4 v[28:31], v8, s[4:7], s16 offen offset:1024 sc1
    s_nop 11
    buffer_load_dwordx4 v[32:35], v8, s[4:7], s16 offen offset:2048 sc1
    s_nop 11
    buffer_load_dwordx4 v[36:39], v8, s[4:7], s16 offen offset:3072 sc1
    s_waitcnt vmcnt(3)
    v_max3_u32 v19, v24, v25, v26
    v_max_u32 v19, v19, v27
    v_cmp_eq_u32 vcc, -1, v19
    s_nop 0
    s_cbranch_vccnz g_41F15_0
    v_smfmac_f32_16x16x64_bf16 v[64:67], v[24:27], a[192:199], v172
    v_smfmac_f32_16x16x64_bf16 v[68:71], v[24:27], a[224:231], v172
    s_waitcnt vmcnt(2)
    v_max3_u32 v19, v28, v29, v30
    v_max_u32 v19, v19, v31
    v_cmp_eq_u32 vcc, -1, v19
    s_nop 0
    s_cbranch_vccnz g_41F14_1
    v_smfmac_f32_16x16x64_bf16 v[64:67], v[28:31], a[200:207], v172
    v_smfmac_f32_16x16x64_bf16 v[68:71], v[28:31], a[232:239], v172
    s_waitcnt vmcnt(1)
    v_max3_u32 v19, v32, v33, v34
    v_max_u32 v19, v19, v35
    v_cmp_eq_u32 vcc, -1, v19
    s_nop 0
    s_cbranch_vccnz g_41F12_2
    v_smfmac_f32_16x16x64_bf16 v[64:67], v[32:35], a[208:215], v172
    v_smfmac_f32_16x16x64_bf16 v[68:71], v[32:35], a[240:247], v172
    s_waitcnt vmcnt(0)
    v_max3_u32 v19, v36, v37, v38
    v_max_u32 v19, v19, v39
    v_cmp_eq_u32 vcc, -1, v19
    s_nop 0
    s_cbranch_vccnz g_41F8_3
    v_smfmac_f32_16x16x64_bf16 v[64:67], v[36:39], a[216:223], v172
    v_smfmac_f32_16x16x64_bf16 v[68:71], v[36:39], a[248:255], v172
    s_nop 4
    v_cvt_pk_bf16_f32 v80, v64, v65
    v_cvt_pk_bf16_f32 v81, v66, v67
    s_nop 0
    v_cvt_pk_bf16_f32 v82, v68, v69
    v_cvt_pk_bf16_f32 v83, v70, v71
    ds_write_b128 v17, v[80:83] offset:9216
gc_42:
    s_waitcnt lgkmcnt(0)
    s_barrier
    s_mov_b32 s23, s25
fw_43:
    s_cmp_ge_u32 s85, s94
    s_cbranch_scc1 fo_44
    buffer_load_dword v247, v245, s[4:7], 0 offen sc1
    s_add_u32 s23, s23, 1
    s_waitcnt vmcnt(0)
    v_readfirstlane_b32 s85, v247
    s_cmp_lt_u32 s23, 200000
    s_cbranch_scc1 fw_43
    s_mov_b32 s25, 200000
fo_44:
    buffer_load_dwordx4 v[228:231], v13, s[4:7], s18 offen offset:0 sc1
    buffer_load_dwordx4 v[232:235], v13, s[4:7], s18 offen offset:128 sc1
    s_add_u32 s18, s18, 2048
    s_min_u32 s18, s18, 35780608
    s_nop 15
    s_nop 15
    s_nop 15
    s_nop 15
    s_add_u32 s21, s15, 3
    s_min_u32 s21, s21, 64
    s_cmp_lt_u32 s85, s21
    s_cselect_b64 exec, 1, 0
    buffer_load_dword v247, v245, s[4:7], 0 offen sc1
    s_mov_b64 exec, -1
    v_mov_b32 v40, 0
    v_mov_b32 v41, 0
    v_mov_b32 v42, 0
    v_mov_b32 v43, 0
    v_mov_b32 v44, 0
    v_mov_b32 v45, 0
    v_mov_b32 v46, 0
    v_mov_b32 v47, 0
    v_mov_b32 v48, 0
    v_mov_b32 v49, 0
    v_mov_b32 v50, 0
    v_mov_b32 v51, 0
    v_mov_b32 v52, 0
    v_mov_b32 v53, 0
    v_mov_b32 v54, 0
    v_mov_b32 v55, 0
    v_mov_b32 v56, 0
    v_mov_b32 v57, 0
    v_mov_b32 v58, 0
    v_mov_b32 v59, 0
    v_mov_b32 v60, 0
    v_mov_b32 v61, 0
    v_mov_b32 v62, 0
    v_mov_b32 v63, 0
    v_mov_b32 v64, 0
    v_mov_b32 v65, 0
    v_mov_b32 v66, 0
    v_mov_b32 v67, 0
    v_mov_b32 v68, 0
    v_mov_b32 v69, 0
    v_mov_b32 v70, 0
    v_mov_b32 v71, 0
    s_mov_b32 s21, s16
    s_mov_b32 s16, s42
    s_mov_b32 s42, s43
    s_mov_b32 s43, s44
    s_mov_b32 s44, s21
    s_add_u32 s95, s95, 524288
    s_lshr_b32 s84, s95, 8
    s_and_b32 s84, s84, 8192
    s_xor_b32 s84, s84, s46
    s_add_u32 s84, s84, s95
    s_add_u32 s15, s15, 1
    s_barrier
    s_branch recur_fast_w1
g_36L15_0:
    s_waitcnt vmcnt(3)
    v_max3_u32 v19, v24, v25, v26
    v_max_u32 v19, v19, v27
    v_cmp_eq_u32 vcc, -1, v19
    s_nop 0
    s_cbranch_vccnz g_36F15_0
    v_smfmac_f32_16x16x64_bf16 v[40:43], v[24:27], a[0:7], v172
    v_smfmac_f32_16x16x64_bf16 v[44:47], v[24:27], a[64:71], v172
    v_smfmac_f32_16x16x64_bf16 v[48:51], v[24:27], a[32:39], v172
    v_smfmac_f32_16x16x64_bf16 v[52:55], v[24:27], a[96:103], v172
g_36L14_1:
    s_waitcnt vmcnt(2)
    v_max3_u32 v19, v28, v29, v30
    v_max_u32 v19, v19, v31
    v_cmp_eq_u32 vcc, -1, v19
    s_nop 0
    s_cbranch_vccnz g_36F14_1
    v_smfmac_f32_16x16x64_bf16 v[40:43], v[28:31], a[8:15], v172
    v_smfmac_f32_16x16x64_bf16 v[44:47], v[28:31], a[72:79], v172
    v_smfmac_f32_16x16x64_bf16 v[48:51], v[28:31], a[40:47], v172
    v_smfmac_f32_16x16x64_bf16 v[52:55], v[28:31], a[104:111], v172
g_36L12_2:
    s_waitcnt vmcnt(1)
    v_max3_u32 v19, v32, v33, v34
    v_max_u32 v19, v19, v35
    v_cmp_eq_u32 vcc, -1, v19
    s_nop 0
    s_cbranch_vccnz g_36F12_2
    v_smfmac_f32_16x16x64_bf16 v[40:43], v[32:35], a[16:23], v172
    v_smfmac_f32_16x16x64_bf16 v[44:47], v[32:35], a[80:87], v172
    v_smfmac_f32_16x16x64_bf16 v[48:51], v[32:35], a[48:55], v172
    v_smfmac_f32_16x16x64_bf16 v[52:55], v[32:35], a[112:119], v172
g_36L8_3:
    s_waitcnt vmcnt(0)
    v_max3_u32 v19, v36, v37, v38
    v_max_u32 v19, v19, v39
    v_cmp_eq_u32 vcc, -1, v19
    s_nop 0
    s_cbranch_vccnz g_36F8_3
    v_smfmac_f32_16x16x64_bf16 v[40:43], v[36:39], a[24:31], v172
    v_smfmac_f32_16x16x64_bf16 v[44:47], v[36:39], a[88:95], v172
    v_smfmac_f32_16x16x64_bf16 v[48:51], v[36:39], a[56:63], v172
    v_smfmac_f32_16x16x64_bf16 v[52:55], v[36:39], a[120:127], v172
    s_branch gc_37
g_36L15_1:
    s_waitcnt vmcnt(3)
    v_max3_u32 v19, v28, v29, v30
    v_max_u32 v19, v19, v31
    v_cmp_eq_u32 vcc, -1, v19
    s_nop 0
    s_cbranch_vccnz g_36F15_1
    v_smfmac_f32_16x16x64_bf16 v[40:43], v[28:31], a[8:15], v172
    v_smfmac_f32_16x16x64_bf16 v[44:47], v[28:31], a[72:79], v172
    v_smfmac_f32_16x16x64_bf16 v[48:51], v[28:31], a[40:47], v172
    v_smfmac_f32_16x16x64_bf16 v[52:55], v[28:31], a[104:111], v172
g_36L13_2:
    s_waitcnt vmcnt(2)
    v_max3_u32 v19, v32, v33, v34
    v_max_u32 v19, v19, v35
    v_cmp_eq_u32 vcc, -1, v19
    s_nop 0
    s_cbranch_vccnz g_36F13_2
    v_smfmac_f32_16x16x64_bf16 v[40:43], v[32:35], a[16:23], v172
    v_smfmac_f32_16x16x64_bf16 v[44:47], v[32:35], a[80:87], v172
    v_smfmac_f32_16x16x64_bf16 v[48:51], v[32:35], a[48:55], v172
    v_smfmac_f32_16x16x64_bf16 v[52:55], v[32:35], a[112:119], v172
g_36L9_3:
    s_waitcnt vmcnt(1)
    v_max3_u32 v19, v36, v37, v38
    v_max_u32 v19, v19, v39
    v_cmp_eq_u32 vcc, -1, v19
    s_nop 0
    s_cbranch_vccnz g_36F9_3
    v_smfmac_f32_16x16x64_bf16 v[40:43], v[36:39], a[24:31], v172
    v_smfmac_f32_16x16x64_bf16 v[44:47], v[36:39], a[88:95], v172
    v_smfmac_f32_16x16x64_bf16 v[48:51], v[36:39], a[56:63], v172
    v_smfmac_f32_16x16x64_bf16 v[52:55], v[36:39], a[120:127], v172
g_36L1_0:
    s_waitcnt vmcnt(0)
    v_max3_u32 v19, v24, v25, v26
    v_max_u32 v19, v19, v27
    v_cmp_eq_u32 vcc, -1, v19
    s_nop 0
    s_cbranch_vccnz g_36F1_0
    v_smfmac_f32_16x16x64_bf16 v[40:43], v[24:27], a[0:7], v172
    v_smfmac_f32_16x16x64_bf16 v[44:47], v[24:27], a[64:71], v172
    v_smfmac_f32_16x16x64_bf16 v[48:51], v[24:27], a[32:39], v172
    v_smfmac_f32_16x16x64_bf16 v[52:55], v[24:27], a[96:103], v172
    s_branch gc_37
g_36L15_2:
    s_waitcnt vmcnt(3)
    v_max3_u32 v19, v32, v33, v34
    v_max_u32 v19, v19, v35
    v_cmp_eq_u32 vcc, -1, v19
    s_nop 0
    s_cbranch_vccnz g_36F15_2
    v_smfmac_f32_16x16x64_bf16 v[40:43], v[32:35], a[16:23], v172
    v_smfmac_f32_16x16x64_bf16 v[44:47], v[32:35], a[80:87], v172
    v_smfmac_f32_16x16x64_bf16 v[48:51], v[32:35], a[48:55], v172
    v_smfmac_f32_16x16x64_bf16 v[52:55], v[32:35], a[112:119], v172
g_36L11_3:
    s_waitcnt vmcnt(2)
    v_max3_u32 v19, v36, v37, v38
    v_max_u32 v19, v19, v39
    v_cmp_eq_u32 vcc, -1, v19
    s_nop 0
    s_cbranch_vccnz g_36F11_3
    v_smfmac_f32_16x16x64_bf16 v[40:43], v[36:39], a[24:31], v172
    v_smfmac_f32_16x16x64_bf16 v[44:47], v[36:39], a[88:95], v172
    v_smfmac_f32_16x16x64_bf16 v[48:51], v[36:39], a[56:63], v172
    v_smfmac_f32_16x16x64_bf16 v[52:55], v[36:39], a[120:127], v172
g_36L3_0:
    s_waitcnt vmcnt(1)
    v_max3_u32 v19, v24, v25, v26
    v_max_u32 v19, v19, v27
    v_cmp_eq_u32 vcc, -1, v19
    s_nop 0
    s_cbranch_vccnz g_36F3_0
    v_smfmac_f32_16x16x64_bf16 v[40:43], v[24:27], a[0:7], v172
    v_smfmac_f32_16x16x64_bf16 v[44:47], v[24:27], a[64:71], v172
    v_smfmac_f32_16x16x64_bf16 v[48:51], v[24:27], a[32:39], v172
    v_smfmac_f32_16x16x64_bf16 v[52:55], v[24:27], a[96:103], v172
g_36L2_1:
    s_waitcnt vmcnt(0)
    v_max3_u32 v19, v28, v29, v30
    v_max_u32 v19, v19, v31
    v_cmp_eq_u32 vcc, -1, v19
    s_nop 0
    s_cbranch_vccnz g_36F2_1
    v_smfmac_f32_16x16x64_bf16 v[40:43], v[28:31], a[8:15], v172
    v_smfmac_f32_16x16x64_bf16 v[44:47], v[28:31], a[72:79], v172
    v_smfmac_f32_16x16x64_bf16 v[48:51], v[28:31], a[40:47], v172
    v_smfmac_f32_16x16x64_bf16 v[52:55], v[28:31], a[104:111], v172
    s_branch gc_37
g_36L15_3:
    s_waitcnt vmcnt(3)
    v_max3_u32 v19, v36, v37, v38
    v_max_u32 v19, v19, v39
    v_cmp_eq_u32 vcc, -1, v19
    s_nop 0
    s_cbranch_vccnz g_36F15_3
    v_smfmac_f32_16x16x64_bf16 v[40:43], v[36:39], a[24:31], v172
    v_smfmac_f32_16x16x64_bf16 v[44:47], v[36:39], a[88:95], v172
    v_smfmac_f32_16x16x64_bf16 v[48:51], v[36:39], a[56:63], v172
    v_smfmac_f32_16x16x64_bf16 v[52:55], v[36:39], a[120:127], v172
g_36L7_0:
    s_waitcnt vmcnt(2)
    v_max3_u32 v19, v24, v25, v26
    v_max_u32 v19, v19, v27
    v_cmp_eq_u32 vcc, -1, v19
    s_nop 0
    s_cbranch_vccnz g_36F7_0
    v_smfmac_f32_16x16x64_bf16 v[40:43], v[24:27], a[0:7], v172
    v_smfmac_f32_16x16x64_bf16 v[44:47], v[24:27], a[64:71], v172
    v_smfmac_f32_16x16x64_bf16 v[48:51], v[24:27], a[32:39], v172
    v_smfmac_f32_16x16x64_bf16 v[52:55], v[24:27], a[96:103], v172
g_36L6_1:
    s_waitcnt vmcnt(1)
    v_max3_u32 v19, v28, v29, v30
    v_max_u32 v19, v19, v31
    v_cmp_eq_u32 vcc, -1, v19
    s_nop 0
    s_cbranch_vccnz g_36F6_1
    v_smfmac_f32_16x16x64_bf16 v[40:43], v[28:31], a[8:15], v172
    v_smfmac_f32_16x16x64_bf16 v[44:47], v[28:31], a[72:79], v172
    v_smfmac_f32_16x16x64_bf16 v[48:51], v[28:31], a[40:47], v172
    v_smfmac_f32_16x16x64_bf16 v[52:55], v[28:31], a[104:111], v172
g_36L4_2:
    s_waitcnt vmcnt(0)
    v_max3_u32 v19, v32, v33, v34
    v_max_u32 v19, v19, v35
    v_cmp_eq_u32 vcc, -1, v19
    s_nop 0
    s_cbranch_vccnz g_36F4_2
    v_smfmac_f32_16x16x64_bf16 v[40:43], v[32:35], a[16:23], v172
    v_smfmac_f32_16x16x64_bf16 v[44:47], v[32:35], a[80:87], v172
    v_smfmac_f32_16x16x64_bf16 v[48:51], v[32:35], a[48:55], v172
    v_smfmac_f32_16x16x64_bf16 v[52:55], v[32:35], a[112:119], v172
    s_branch gc_37
g_36L7_1:
    s_waitcnt vmcnt(2)
    v_max3_u32 v19, v28, v29, v30
    v_max_u32 v19, v19, v31
    v_cmp_eq_u32 vcc, -1, v19
    s_nop 0
    s_cbranch_vccnz g_36F7_1
    v_smfmac_f32_16x16x64_bf16 v[40:43], v[28:31], a[8:15], v172
    v_smfmac_f32_16x16x64_bf16 v[44:47], v[28:31], a[72:79], v172
    v_smfmac_f32_16x16x64_bf16 v[48:51], v[28:31], a[40:47], v172
    v_smfmac_f32_16x16x64_bf16 v[52:55], v[28:31], a[104:111], v172
g_36L5_2:
    s_waitcnt vmcnt(1)
    v_max3_u32 v19, v32, v33, v34
    v_max_u32 v19, v19, v35
    v_cmp_eq_u32 vcc, -1, v19
    s_nop 0
    s_cbranch_vccnz g_36F5_2
    v_smfmac_f32_16x16x64_bf16 v[40:43], v[32:35], a[16:23], v172
    v_smfmac_f32_16x16x64_bf16 v[44:47], v[32:35], a[80:87], v172
    v_smfmac_f32_16x16x64_bf16 v[48:51], v[32:35], a[48:55], v172
    v_smfmac_f32_16x16x64_bf16 v[52:55], v[32:35], a[112:119], v172
    s_branch g_36L1_0
g_36L7_2:
    s_waitcnt vmcnt(2)
    v_max3_u32 v19, v32, v33, v34
    v_max_u32 v19, v19, v35
    v_cmp_eq_u32 vcc, -1, v19
    s_nop 0
    s_cbranch_vccnz g_36F7_2
    v_smfmac_f32_16x16x64_bf16 v[40:43], v[32:35], a[16:23], v172
    v_smfmac_f32_16x16x64_bf16 v[44:47], v[32:35], a[80:87], v172
    v_smfmac_f32_16x16x64_bf16 v[48:51], v[32:35], a[48:55], v172
    v_smfmac_f32_16x16x64_bf16 v[52:55], v[32:35], a[112:119], v172
    s_branch g_36L3_0
g_36L11_0:
    s_waitcnt vmcnt(2)
    v_max3_u32 v19, v24, v25, v26
    v_max_u32 v19, v19, v27
    v_cmp_eq_u32 vcc, -1, v19
    s_nop 0
    s_cbranch_vccnz g_36F11_0
    v_smfmac_f32_16x16x64_bf16 v[40:43], v[24:27], a[0:7], v172
    v_smfmac_f32_16x16x64_bf16 v[44:47], v[24:27], a[64:71], v172
    v_smfmac_f32_16x16x64_bf16 v[48:51], v[24:27], a[32:39], v172
    v_smfmac_f32_16x16x64_bf16 v[52:55], v[24:27], a[96:103], v172
g_36L10_1:
    s_waitcnt vmcnt(1)
    v_max3_u32 v19, v28, v29, v30
    v_max_u32 v19, v19, v31
    v_cmp_eq_u32 vcc, -1, v19
    s_nop 0
    s_cbranch_vccnz g_36F10_1
    v_smfmac_f32_16x16x64_bf16 v[40:43], v[28:31], a[8:15], v172
    v_smfmac_f32_16x16x64_bf16 v[44:47], v[28:31], a[72:79], v172
    v_smfmac_f32_16x16x64_bf16 v[48:51], v[28:31], a[40:47], v172
    v_smfmac_f32_16x16x64_bf16 v[52:55], v[28:31], a[104:111], v172
    s_branch g_36L8_3
g_36L11_1:
    s_waitcnt vmcnt(2)
    v_max3_u32 v19, v28, v29, v30
    v_max_u32 v19, v19, v31
    v_cmp_eq_u32 vcc, -1, v19
    s_nop 0
    s_cbranch_vccnz g_36F11_1
    v_smfmac_f32_16x16x64_bf16 v[40:43], v[28:31], a[8:15], v172
    v_smfmac_f32_16x16x64_bf16 v[44:47], v[28:31], a[72:79], v172
    v_smfmac_f32_16x16x64_bf16 v[48:51], v[28:31], a[40:47], v172
    v_smfmac_f32_16x16x64_bf16 v[52:55], v[28:31], a[104:111], v172
    s_branch g_36L9_3
g_36L13_0:
    s_waitcnt vmcnt(2)
    v_max3_u32 v19, v24, v25, v26
    v_max_u32 v19, v19, v27
    v_cmp_eq_u32 vcc, -1, v19
    s_nop 0
    s_cbranch_vccnz g_36F13_0
    v_smfmac_f32_16x16x64_bf16 v[40:43], v[24:27], a[0:7], v172
    v_smfmac_f32_16x16x64_bf16 v[44:47], v[24:27], a[64:71], v172
    v_smfmac_f32_16x16x64_bf16 v[48:51], v[24:27], a[32:39], v172
    v_smfmac_f32_16x16x64_bf16 v[52:55], v[24:27], a[96:103], v172
    s_branch g_36L12_2
g_36L13_3:
    s_waitcnt vmcnt(2)
    v_max3_u32 v19, v36, v37, v38
    v_max_u32 v19, v19, v39
    v_cmp_eq_u32 vcc, -1, v19
    s_nop 0
    s_cbranch_vccnz g_36F13_3
    v_smfmac_f32_16x16x64_bf16 v[40:43], v[36:39], a[24:31], v172
    v_smfmac_f32_16x16x64_bf16 v[44:47], v[36:39], a[88:95], v172
    v_smfmac_f32_16x16x64_bf16 v[48:51], v[36:39], a[56:63], v172
    v_smfmac_f32_16x16x64_bf16 v[52:55], v[36:39], a[120:127], v172
g_36L5_0:
    s_waitcnt vmcnt(1)
    v_max3_u32 v19, v24, v25, v26
    v_max_u32 v19, v19, v27
    v_cmp_eq_u32 vcc, -1, v19
    s_nop 0
    s_cbranch_vccnz g_36F5_0
    v_smfmac_f32_16x16x64_bf16 v[40:43], v[24:27], a[0:7], v172
    v_smfmac_f32_16x16x64_bf16 v[44:47], v[24:27], a[64:71], v172
    v_smfmac_f32_16x16x64_bf16 v[48:51], v[24:27], a[32:39], v172
    v_smfmac_f32_16x16x64_bf16 v[52:55], v[24:27], a[96:103], v172
    s_branch g_36L4_2
g_36L14_2:
    s_waitcnt vmcnt(2)
    v_max3_u32 v19, v32, v33, v34
    v_max_u32 v19, v19, v35
    v_cmp_eq_u32 vcc, -1, v19
    s_nop 0
    s_cbranch_vccnz g_36F14_2
    v_smfmac_f32_16x16x64_bf16 v[40:43], v[32:35], a[16:23], v172
    v_smfmac_f32_16x16x64_bf16 v[44:47], v[32:35], a[80:87], v172
    v_smfmac_f32_16x16x64_bf16 v[48:51], v[32:35], a[48:55], v172
    v_smfmac_f32_16x16x64_bf16 v[52:55], v[32:35], a[112:119], v172
g_36L10_3:
    s_waitcnt vmcnt(1)
    v_max3_u32 v19, v36, v37, v38
    v_max_u32 v19, v19, v39
    v_cmp_eq_u32 vcc, -1, v19
    s_nop 0
    s_cbranch_vccnz g_36F10_3
    v_smfmac_f32_16x16x64_bf16 v[40:43], v[36:39], a[24:31], v172
    v_smfmac_f32_16x16x64_bf16 v[44:47], v[36:39], a[88:95], v172
    v_smfmac_f32_16x16x64_bf16 v[48:51], v[36:39], a[56:63], v172
    v_smfmac_f32_16x16x64_bf16 v[52:55], v[36:39], a[120:127], v172
    s_branch g_36L2_1
g_36L14_3:
    s_waitcnt vmcnt(2)
    v_max3_u32 v19, v36, v37, v38
    v_max_u32 v19, v19, v39
    v_cmp_eq_u32 vcc, -1, v19
    s_nop 0
    s_cbranch_vccnz g_36F14_3
    v_smfmac_f32_16x16x64_bf16 v[40:43], v[36:39], a[24:31], v172
    v_smfmac_f32_16x16x64_bf16 v[44:47], v[36:39], a[88:95], v172
    v_smfmac_f32_16x16x64_bf16 v[48:51], v[36:39], a[56:63], v172
    v_smfmac_f32_16x16x64_bf16 v[52:55], v[36:39], a[120:127], v172
    s_branch g_36L6_1
g_36L3_1:
    s_waitcnt vmcnt(1)
    v_max3_u32 v19, v28, v29, v30
    v_max_u32 v19, v19, v31
    v_cmp_eq_u32 vcc, -1, v19
    s_nop 0
    s_cbranch_vccnz g_36F3_1
    v_smfmac_f32_16x16x64_bf16 v[40:43], v[28:31], a[8:15], v172
    v_smfmac_f32_16x16x64_bf16 v[44:47], v[28:31], a[72:79], v172
    v_smfmac_f32_16x16x64_bf16 v[48:51], v[28:31], a[40:47], v172
    v_smfmac_f32_16x16x64_bf16 v[52:55], v[28:31], a[104:111], v172
    s_branch g_36L1_0
g_36L6_2:
    s_waitcnt vmcnt(1)
    v_max3_u32 v19, v32, v33, v34
    v_max_u32 v19, v19, v35
    v_cmp_eq_u32 vcc, -1, v19
    s_nop 0
    s_cbranch_vccnz g_36F6_2
    v_smfmac_f32_16x16x64_bf16 v[40:43], v[32:35], a[16:23], v172
    v_smfmac_f32_16x16x64_bf16 v[44:47], v[32:35], a[80:87], v172
    v_smfmac_f32_16x16x64_bf16 v[48:51], v[32:35], a[48:55], v172
    v_smfmac_f32_16x16x64_bf16 v[52:55], v[32:35], a[112:119], v172
    s_branch g_36L2_1
g_36L9_0:
    s_waitcnt vmcnt(1)
    v_max3_u32 v19, v24, v25, v26
    v_max_u32 v19, v19, v27
    v_cmp_eq_u32 vcc, -1, v19
    s_nop 0
    s_cbranch_vccnz g_36F9_0
    v_smfmac_f32_16x16x64_bf16 v[40:43], v[24:27], a[0:7], v172
    v_smfmac_f32_16x16x64_bf16 v[44:47], v[24:27], a[64:71], v172
    v_smfmac_f32_16x16x64_bf16 v[48:51], v[24:27], a[32:39], v172
    v_smfmac_f32_16x16x64_bf16 v[52:55], v[24:27], a[96:103], v172
    s_branch g_36L8_3
g_36L12_3:
    s_waitcnt vmcnt(1)
    v_max3_u32 v19, v36, v37, v38
    v_max_u32 v19, v19, v39
    v_cmp_eq_u32 vcc, -1, v19
    s_nop 0
    s_cbranch_vccnz g_36F12_3
    v_smfmac_f32_16x16x64_bf16 v[40:43], v[36:39], a[24:31], v172
    v_smfmac_f32_16x16x64_bf16 v[44:47], v[36:39], a[88:95], v172
    v_smfmac_f32_16x16x64_bf16 v[48:51], v[36:39], a[56:63], v172
    v_smfmac_f32_16x16x64_bf16 v[52:55], v[36:39], a[120:127], v172
    s_branch g_36L4_2
g_36F15_0:
    s_mov_b64 exec, vcc
    buffer_load_dwordx4 v[24:27], v2, s[4:7], s16 offen offset:0 sc1
    s_mov_b64 exec, -1
    s_add_u32 s23, s23, 1
    s_cmp_lt_u32 s23, 200000
    s_cbranch_scc1 g_36L15_1
    s_mov_b32 s25, 200000
    s_branch gc_37
g_36F15_1:
    s_mov_b64 exec, vcc
    buffer_load_dwordx4 v[28:31], v2, s[4:7], s16 offen offset:1024 sc1
    s_mov_b64 exec, -1
    s_add_u32 s23, s23, 1
    s_cmp_lt_u32 s23, 200000
    s_cbranch_scc1 g_36L15_2
    s_mov_b32 s25, 200000
    s_branch gc_37
g_36F15_2:
    s_mov_b64 exec, vcc
    buffer_load_dwordx4 v[32:35], v2, s[4:7], s16 offen offset:2048 sc1
    s_mov_b64 exec, -1
    s_add_u32 s23, s23, 1
    s_cmp_lt_u32 s23, 200000
    s_cbranch_scc1 g_36L15_3
    s_mov_b32 s25, 200000
    s_branch gc_37
g_36F15_3:
    s_mov_b64 exec, vcc
    buffer_load_dwordx4 v[36:39], v2, s[4:7], s16 offen offset:3072 sc1
    s_mov_b64 exec, -1
    s_add_u32 s23, s23, 1
    s_cmp_lt_u32 s23, 200000
    s_cbranch_scc1 g_36L15_0
    s_mov_b32 s25, 200000
    s_branch gc_37
g_36F7_0:
    s_mov_b64 exec, vcc
    buffer_load_dwordx4 v[24:27], v2, s[4:7], s16 offen offset:0 sc1
    s_mov_b64 exec, -1
    s_add_u32 s23, s23, 1
    s_cmp_lt_u32 s23, 200000
    s_cbranch_scc1 g_36L7_1
    s_mov_b32 s25, 200000
    s_branch gc_37
g_36F7_1:
    s_mov_b64 exec, vcc
    buffer_load_dwordx4 v[28:31], v2, s[4:7], s16 offen offset:1024 sc1
    s_mov_b64 exec, -1
    s_add_u32 s23, s23, 1
    s_cmp_lt_u32 s23, 200000
    s_cbranch_scc1 g_36L7_2
    s_mov_b32 s25, 200000
    s_branch gc_37
g_36F7_2:
    s_mov_b64 exec, vcc
    buffer_load_dwordx4 v[32:35], v2, s[4:7], s16 offen offset:2048 sc1
    s_mov_b64 exec, -1
    s_add_u32 s23, s23, 1
    s_cmp_lt_u32 s23, 200000
    s_cbranch_scc1 g_36L7_0
    s_mov_b32 s25, 200000
    s_branch gc_37
g_36F11_0:
    s_mov_b64 exec, vcc
    buffer_load_dwordx4 v[24:27], v2, s[4:7], s16 offen offset:0 sc1
    s_mov_b64 exec, -1
    s_add_u32 s23, s23, 1
    s_cmp_lt_u32 s23, 200000
    s_cbranch_scc1 g_36L11_1
    s_mov_b32 s25, 200000
    s_branch gc_37
g_36F11_1:
    s_mov_b64 exec, vcc
    buffer_load_dwordx4 v[28:31], v2, s[4:7], s16 offen offset:1024 sc1
    s_mov_b64 exec, -1
    s_add_u32 s23, s23, 1
    s_cmp_lt_u32 s23, 200000
    s_cbranch_scc1 g_36L11_3
    s_mov_b32 s25, 200000
    s_branch gc_37
g_36F11_3:
    s_mov_b64 exec, vcc
    buffer_load_dwordx4 v[36:39], v2, s[4:7], s16 offen offset:3072 sc1
    s_mov_b64 exec, -1
    s_add_u32 s23, s23, 1
    s_cmp_lt_u32 s23, 200000
    s_cbranch_scc1 g_36L11_0
    s_mov_b32 s25, 200000
    s_branch gc_37
g_36F13_0:
    s_mov_b64 exec, vcc
    buffer_load_dwordx4 v[24:27], v2, s[4:7], s16 offen offset:0 sc1
    s_mov_b64 exec, -1
    s_add_u32 s23, s23, 1
    s_cmp_lt_u32 s23, 200000
    s_cbranch_scc1 g_36L13_2
    s_mov_b32 s25, 200000
    s_branch gc_37
g_36F13_2:
    s_mov_b64 exec, vcc
    buffer_load_dwordx4 v[32:35], v2, s[4:7], s16 offen offset:2048 sc1
    s_mov_b64 exec, -1
    s_add_u32 s23, s23, 1
    s_cmp_lt_u32 s23, 200000
    s_cbranch_scc1 g_36L13_3
    s_mov_b32 s25, 200000
    s_branch gc_37
g_36F13_3:
    s_mov_b64 exec, vcc
    buffer_load_dwordx4 v[36:39], v2, s[4:7], s16 offen offset:3072 sc1
    s_mov_b64 exec, -1
    s_add_u32 s23, s23, 1
    s_cmp_lt_u32 s23, 200000
    s_cbranch_scc1 g_36L13_0
    s_mov_b32 s25, 200000
    s_branch gc_37
g_36F14_1:
    s_mov_b64 exec, vcc
    buffer_load_dwordx4 v[28:31], v2, s[4:7], s16 offen offset:1024 sc1
    s_mov_b64 exec, -1
    s_add_u32 s23, s23, 1
    s_cmp_lt_u32 s23, 200000
    s_cbranch_scc1 g_36L14_2
    s_mov_b32 s25, 200000
    s_branch gc_37
g_36F14_2:
    s_mov_b64 exec, vcc
    buffer_load_dwordx4 v[32:35], v2, s[4:7], s16 offen offset:2048 sc1
    s_mov_b64 exec, -1
    s_add_u32 s23, s23, 1
    s_cmp_lt_u32 s23, 200000
    s_cbranch_scc1 g_36L14_3
    s_mov_b32 s25, 200000
    s_branch gc_37
g_36F14_3:
    s_mov_b64 exec, vcc
    buffer_load_dwordx4 v[36:39], v2, s[4:7], s16 offen offset:3072 sc1
    s_mov_b64 exec, -1
    s_add_u32 s23, s23, 1
    s_cmp_lt_u32 s23, 200000
    s_cbranch_scc1 g_36L14_1
    s_mov_b32 s25, 200000
    s_branch gc_37
g_36F3_0:
    s_mov_b64 exec, vcc
    buffer_load_dwordx4 v[24:27], v2, s[4:7], s16 offen offset:0 sc1
    s_mov_b64 exec, -1
    s_add_u32 s23, s23, 1
    s_cmp_lt_u32 s23, 200000
    s_cbranch_scc1 g_36L3_1
    s_mov_b32 s25, 200000
    s_branch gc_37
g_36F3_1:
    s_mov_b64 exec, vcc
    buffer_load_dwordx4 v[28:31], v2, s[4:7], s16 offen offset:1024 sc1
    s_mov_b64 exec, -1
    s_add_u32 s23, s23, 1
    s_cmp_lt_u32 s23, 200000
    s_cbranch_scc1 g_36L3_0
    s_mov_b32 s25, 200000
    s_branch gc_37
g_36F5_0:
    s_mov_b64 exec, vcc
    buffer_load_dwordx4 v[24:27], v2, s[4:7], s16 offen offset:0 sc1
    s_mov_b64 exec, -1
    s_add_u32 s23, s23, 1
    s_cmp_lt_u32 s23, 200000
    s_cbranch_scc1 g_36L5_2
    s_mov_b32 s25, 200000
    s_branch gc_37
g_36F5_2:
    s_mov_b64 exec, vcc
    buffer_load_dwordx4 v[32:35], v2, s[4:7], s16 offen offset:2048 sc1
    s_mov_b64 exec, -1
    s_add_u32 s23, s23, 1
    s_cmp_lt_u32 s23, 200000
    s_cbranch_scc1 g_36L5_0
    s_mov_b32 s25, 200000
    s_branch gc_37
g_36F6_1:
    s_mov_b64 exec, vcc
    buffer_load_dwordx4 v[28:31], v2, s[4:7], s16 offen offset:1024 sc1
    s_mov_b64 exec, -1
    s_add_u32 s23, s23, 1
    s_cmp_lt_u32 s23, 200000
    s_cbranch_scc1 g_36L6_2
    s_mov_b32 s25, 200000
    s_branch gc_37
g_36F6_2:
    s_mov_b64 exec, vcc
    buffer_load_dwordx4 v[32:35], v2, s[4:7], s16 offen offset:2048 sc1
    s_mov_b64 exec, -1
    s_add_u32 s23, s23, 1
    s_cmp_lt_u32 s23, 200000
    s_cbranch_scc1 g_36L6_1
    s_mov_b32 s25, 200000
    s_branch gc_37
g_36F9_0:
    s_mov_b64 exec, vcc
    buffer_load_dwordx4 v[24:27], v2, s[4:7], s16 offen offset:0 sc1
    s_mov_b64 exec, -1
    s_add_u32 s23, s23, 1
    s_cmp_lt_u32 s23, 200000
    s_cbranch_scc1 g_36L9_3
    s_mov_b32 s25, 200000
    s_branch gc_37
g_36F9_3:
    s_mov_b64 exec, vcc
    buffer_load_dwordx4 v[36:39], v2, s[4:7], s16 offen offset:3072 sc1
    s_mov_b64 exec, -1
    s_add_u32 s23, s23, 1
    s_cmp_lt_u32 s23, 200000
    s_cbranch_scc1 g_36L9_0
    s_mov_b32 s25, 200000
    s_branch gc_37
g_36F10_1:
    s_mov_b64 exec, vcc
    buffer_load_dwordx4 v[28:31], v2, s[4:7], s16 offen offset:1024 sc1
    s_mov_b64 exec, -1
    s_add_u32 s23, s23, 1
    s_cmp_lt_u32 s23, 200000
    s_cbranch_scc1 g_36L10_3
    s_mov_b32 s25, 200000
    s_branch gc_37
g_36F10_3:
    s_mov_b64 exec, vcc
    buffer_load_dwordx4 v[36:39], v2, s[4:7], s16 offen offset:3072 sc1
    s_mov_b64 exec, -1
    s_add_u32 s23, s23, 1
    s_cmp_lt_u32 s23, 200000
    s_cbranch_scc1 g_36L10_1
    s_mov_b32 s25, 200000
    s_branch gc_37
g_36F12_2:
    s_mov_b64 exec, vcc
    buffer_load_dwordx4 v[32:35], v2, s[4:7], s16 offen offset:2048 sc1
    s_mov_b64 exec, -1
    s_add_u32 s23, s23, 1
    s_cmp_lt_u32 s23, 200000
    s_cbranch_scc1 g_36L12_3
    s_mov_b32 s25, 200000
    s_branch gc_37
g_36F12_3:
    s_mov_b64 exec, vcc
    buffer_load_dwordx4 v[36:39], v2, s[4:7], s16 offen offset:3072 sc1
    s_mov_b64 exec, -1
    s_add_u32 s23, s23, 1
    s_cmp_lt_u32 s23, 200000
    s_cbranch_scc1 g_36L12_2
    s_mov_b32 s25, 200000
    s_branch gc_37
g_36F1_0:
    s_mov_b64 exec, vcc
    buffer_load_dwordx4 v[24:27], v2, s[4:7], s16 offen offset:0 sc1
    s_mov_b64 exec, -1
    s_add_u32 s23, s23, 1
    s_cmp_lt_u32 s23, 200000
    s_cbranch_scc1 g_36L1_0
    s_mov_b32 s25, 200000
    s_branch gc_37
g_36F2_1:
    s_mov_b64 exec, vcc
    buffer_load_dwordx4 v[28:31], v2, s[4:7], s16 offen offset:1024 sc1
    s_mov_b64 exec, -1
    s_add_u32 s23, s23, 1
    s_cmp_lt_u32 s23, 200000
    s_cbranch_scc1 g_36L2_1
    s_mov_b32 s25, 200000
    s_branch gc_37
g_36F4_2:
    s_mov_b64 exec, vcc
    buffer_load_dwordx4 v[32:35], v2, s[4:7], s16 offen offset:2048 sc1
    s_mov_b64 exec, -1
    s_add_u32 s23, s23, 1
    s_cmp_lt_u32 s23, 200000
    s_cbranch_scc1 g_36L4_2
    s_mov_b32 s25, 200000
    s_branch gc_37
g_36F8_3:
    s_mov_b64 exec, vcc
    buffer_load_dwordx4 v[36:39], v2, s[4:7], s16 offen offset:3072 sc1
    s_mov_b64 exec, -1
    s_add_u32 s23, s23, 1
    s_cmp_lt_u32 s23, 200000
    s_cbranch_scc1 g_36L8_3
    s_mov_b32 s25, 200000
    s_branch gc_37
ss_38r:
    buffer_load_dwordx4 v[208:211], v5, s[4:7], s16 offen offset:0 sc1
    buffer_load_dwordx4 v[212:215], v5, s[4:7], s16 offen offset:1024 sc1
    buffer_load_dwordx4 v[216:219], v5, s[4:7], s16 offen offset:2048 sc1
    buffer_load_dwordx4 v[220:223], v5, s[4:7], s16 offen offset:3072 sc1
    buffer_load_dword v224, v6, s[4:7], s16 offen offset:0 sc1
    buffer_load_dword v225, v6, s[4:7], s16 offen offset:256 sc1
    buffer_load_dword v226, v6, s[4:7], s16 offen offset:512 sc1
    buffer_load_dword v227, v6, s[4:7], s16 offen offset:768 sc1
    s_waitcnt vmcnt(14)
    v_pk_add_f32 v[180:181], v[24:25], v[28:29]
    v_pk_add_f32 v[182:183], v[26:27], v[30:31]
    s_waitcnt vmcnt(12)
    v_pk_add_f32 v[188:189], v[32:33], v[36:37]
    v_pk_add_f32 v[190:191], v[34:35], v[38:39]
    v_pk_add_f32 v[180:181], v[180:181], v[188:189]
    v_pk_add_f32 v[182:183], v[182:183], v[190:191]
    v_pk_add_f32 v[188:189], v[180:181], v[182:183]
    v_max3_f32 v185, v180, v181, v182
    s_waitcnt vmcnt(8)
    v_pk_add_f32 v[192:193], v[40:41], v[42:43]
    v_add_f32 v188, v188, v189
    v_add_f32 v184, v192, v193
    v_max3_f32 v185, v185, v183, v184
    v_cmp_u_f32 vcc, v188, v184
    s_nop 0
    v_max_f32_dpp v185, v185, v185 row_ror:8 row_mask:0xf bank_mask:0xf
    v_mov_b32 v186, v185
    s_nop 1
    v_permlane16_swap_b32 v185, v186
    v_max_f32 v185, v185, v186
    v_mov_b32 v186, v185
    s_cbranch_vccz sg_40
    buffer_load_dwordx4 v[24:27], v5, s[4:7], s16 offen offset:0 sc1
    buffer_load_dwordx4 v[28:31], v5, s[4:7], s16 offen offset:1024 sc1
    buffer_load_dwordx4 v[32:35], v5, s[4:7], s16 offen offset:2048 sc1
    buffer_load_dwordx4 v[36:39], v5, s[4:7], s16 offen offset:3072 sc1
    buffer_load_dword v40, v6, s[4:7], s16 offen offset:0 sc1
    buffer_load_dword v41, v6, s[4:7], s16 offen offset:256 sc1
    buffer_load_dword v42, v6, s[4:7], s16 offen offset:512 sc1
    buffer_load_dword v43, v6, s[4:7], s16 offen offset:768 sc1
    s_waitcnt vmcnt(14)
    v_pk_add_f32 v[180:181], v[208:209], v[212:213]
    v_pk_add_f32 v[182:183], v[210:211], v[214:215]
    s_waitcnt vmcnt(12)
    v_pk_add_f32 v[188:189], v[216:217], v[220:221]
    v_pk_add_f32 v[190:191], v[218:219], v[222:223]
    v_pk_add_f32 v[180:181], v[180:181], v[188:189]
    v_pk_add_f32 v[182:183], v[182:183], v[190:191]
    v_pk_add_f32 v[188:189], v[180:181], v[182:183]
    v_max3_f32 v185, v180, v181, v182
    s_waitcnt vmcnt(8)
    v_pk_add_f32 v[192:193], v[224:225], v[226:227]
    v_add_f32 v188, v188, v189
    v_add_f32 v184, v192, v193
    v_max3_f32 v185, v185, v183, v184
    v_cmp_u_f32 vcc, v188, v184
    s_nop 0
    v_max_f32_dpp v185, v185, v185 row_ror:8 row_mask:0xf bank_mask:0xf
    v_mov_b32 v186, v185
    s_nop 1
    v_permlane16_swap_b32 v185, v186
    v_max_f32 v185, v185, v186
    v_mov_b32 v186, v185
    s_cbranch_vccz sg_40
    s_branch ss_38
sb_39:
    v_max3_u32 v19, v24, v25, v26
    v_max3_u32 v19, v19, v27, v28
    v_max3_u32 v19, v19, v29, v30
    v_max3_u32 v19, v19, v31, v32
    v_max3_u32 v19, v19, v33, v34
    v_max3_u32 v19, v19, v35, v36
    v_max3_u32 v19, v19, v37, v38
    v_max3_u32 v19, v19, v39, v40
    v_max3_u32 v19, v19, v41, v42
    v_max_u32 v19, v19, v43
    v_cmp_eq_u32 vcc, -1, v19
    s_nop 0
    s_cbranch_vccz sg_40
    buffer_load_dwordx4 v[24:27], v5, s[4:7], s16 offen offset:0 sc1
    buffer_load_dwordx4 v[28:31], v5, s[4:7], s16 offen offset:1024 sc1
    buffer_load_dwordx4 v[32:35], v5, s[4:7], s16 offen offset:2048 sc1
    buffer_load_dwordx4 v[36:39], v5, s[4:7], s16 offen offset:3072 sc1
    buffer_load_dword v40, v6, s[4:7], s16 offen offset:0 sc1
    buffer_load_dword v41, v6, s[4:7], s16 offen offset:256 sc1
    buffer_load_dword v42, v6, s[4:7], s16 offen offset:512 sc1
    buffer_load_dword v43, v6, s[4:7], s16 offen offset:768 sc1
    s_add_u32 s23, s23, 1
    s_cmp_lt_u32 s23, 200000
    s_cbranch_scc1 ss_38
    s_mov_b32 s25, 200000
    s_branch sg_40
ss_38:
    s_waitcnt vmcnt(6)
    v_pk_add_f32 v[180:181], v[24:25], v[28:29]
    v_pk_add_f32 v[182:183], v[26:27], v[30:31]
    s_waitcnt vmcnt(4)
    v_pk_add_f32 v[188:189], v[32:33], v[36:37]
    v_pk_add_f32 v[190:191], v[34:35], v[38:39]
    v_pk_add_f32 v[180:181], v[180:181], v[188:189]
    v_pk_add_f32 v[182:183], v[182:183], v[190:191]
    v_pk_add_f32 v[188:189], v[180:181], v[182:183]
    v_max3_f32 v185, v180, v181, v182
    s_waitcnt vmcnt(0)
    v_pk_add_f32 v[192:193], v[40:41], v[42:43]
    v_add_f32 v188, v188, v189
    v_add_f32 v184, v192, v193
    v_max3_f32 v185, v185, v183, v184
    v_cmp_u_f32 vcc, v188, v184
    s_nop 0
    v_max_f32_dpp v185, v185, v185 row_ror:8 row_mask:0xf bank_mask:0xf
    v_mov_b32 v186, v185
    s_nop 1
    v_permlane16_swap_b32 v185, v186
    v_max_f32 v185, v185, v186
    v_mov_b32 v186, v185
    s_cbranch_vccnz sb_39
    s_branch sg_40
g_41L15_0:
    s_waitcnt vmcnt(3)
    v_max3_u32 v19, v24, v25, v26
    v_max_u32 v19, v19, v27
    v_cmp_eq_u32 vcc, -1, v19
    s_nop 0
    s_cbranch_vccnz g_41F15_0
    v_smfmac_f32_16x16x64_bf16 v[64:67], v[24:27], a[192:199], v172
    v_smfmac_f32_16x16x64_bf16 v[68:71], v[24:27], a[224:231], v172
g_41L14_1:
    s_waitcnt vmcnt(2)
    v_max3_u32 v19, v28, v29, v30
    v_max_u32 v19, v19, v31
    v_cmp_eq_u32 vcc, -1, v19
    s_nop 0
    s_cbranch_vccnz g_41F14_1
    v_smfmac_f32_16x16x64_bf16 v[64:67], v[28:31], a[200:207], v172
    v_smfmac_f32_16x16x64_bf16 v[68:71], v[28:31], a[232:239], v172
g_41L12_2:
    s_waitcnt vmcnt(1)
    v_max3_u32 v19, v32, v33, v34
    v_max_u32 v19, v19, v35
    v_cmp_eq_u32 vcc, -1, v19
    s_nop 0
    s_cbranch_vccnz g_41F12_2
    v_smfmac_f32_16x16x64_bf16 v[64:67], v[32:35], a[208:215], v172
    v_smfmac_f32_16x16x64_bf16 v[68:71], v[32:35], a[240:247], v172
g_41L8_3:
    s_waitcnt vmcnt(0)
    v_max3_u32 v19, v36, v37, v38
    v_max_u32 v19, v19, v39
    v_cmp_eq_u32 vcc, -1, v19
    s_nop 0
    s_cbranch_vccnz g_41F8_3
    v_smfmac_f32_16x16x64_bf16 v[64:67], v[36:39], a[216:223], v172
    v_smfmac_f32_16x16x64_bf16 v[68:71], v[36:39], a[248:255], v172
    s_nop 4
    v_cvt_pk_bf16_f32 v80, v64, v65
    v_cvt_pk_bf16_f32 v81, v66, v67
    s_nop 0
    v_cvt_pk_bf16_f32 v82, v68, v69
    v_cvt_pk_bf16_f32 v83, v70, v71
    ds_write_b128 v17, v[80:83] offset:9216
    s_branch gc_42
g_41L15_1:
    s_waitcnt vmcnt(3)
    v_max3_u32 v19, v28, v29, v30
    v_max_u32 v19, v19, v31
    v_cmp_eq_u32 vcc, -1, v19
    s_nop 0
    s_cbranch_vccnz g_41F15_1
    v_smfmac_f32_16x16x64_bf16 v[64:67], v[28:31], a[200:207], v172
    v_smfmac_f32_16x16x64_bf16 v[68:71], v[28:31], a[232:239], v172
g_41L13_2:
    s_waitcnt vmcnt(2)
    v_max3_u32 v19, v32, v33, v34
    v_max_u32 v19, v19, v35
    v_cmp_eq_u32 vcc, -1, v19
    s_nop 0
    s_cbranch_vccnz g_41F13_2
    v_smfmac_f32_16x16x64_bf16 v[64:67], v[32:35], a[208:215], v172
    v_smfmac_f32_16x16x64_bf16 v[68:71], v[32:35], a[240:247], v172
g_41L9_3:
    s_waitcnt vmcnt(1)
    v_max3_u32 v19, v36, v37, v38
    v_max_u32 v19, v19, v39
    v_cmp_eq_u32 vcc, -1, v19
    s_nop 0
    s_cbranch_vccnz g_41F9_3
    v_smfmac_f32_16x16x64_bf16 v[64:67], v[36:39], a[216:223], v172
    v_smfmac_f32_16x16x64_bf16 v[68:71], v[36:39], a[248:255], v172
g_41L1_0:
    s_waitcnt vmcnt(0)
    v_max3_u32 v19, v24, v25, v26
    v_max_u32 v19, v19, v27
    v_cmp_eq_u32 vcc, -1, v19
    s_nop 0
    s_cbranch_vccnz g_41F1_0
    v_smfmac_f32_16x16x64_bf16 v[64:67], v[24:27], a[192:199], v172
    v_smfmac_f32_16x16x64_bf16 v[68:71], v[24:27], a[224:231], v172
    s_nop 4
    v_cvt_pk_bf16_f32 v80, v64, v65
    v_cvt_pk_bf16_f32 v81, v66, v67
    s_nop 0
    v_cvt_pk_bf16_f32 v82, v68, v69
    v_cvt_pk_bf16_f32 v83, v70, v71
    ds_write_b128 v17, v[80:83] offset:9216
    s_branch gc_42
g_41L15_2:
    s_waitcnt vmcnt(3)
    v_max3_u32 v19, v32, v33, v34
    v_max_u32 v19, v19, v35
    v_cmp_eq_u32 vcc, -1, v19
    s_nop 0
    s_cbranch_vccnz g_41F15_2
    v_smfmac_f32_16x16x64_bf16 v[64:67], v[32:35], a[208:215], v172
    v_smfmac_f32_16x16x64_bf16 v[68:71], v[32:35], a[240:247], v172
g_41L11_3:
    s_waitcnt vmcnt(2)
    v_max3_u32 v19, v36, v37, v38
    v_max_u32 v19, v19, v39
    v_cmp_eq_u32 vcc, -1, v19
    s_nop 0
    s_cbranch_vccnz g_41F11_3
    v_smfmac_f32_16x16x64_bf16 v[64:67], v[36:39], a[216:223], v172
    v_smfmac_f32_16x16x64_bf16 v[68:71], v[36:39], a[248:255], v172
g_41L3_0:
    s_waitcnt vmcnt(1)
    v_max3_u32 v19, v24, v25, v26
    v_max_u32 v19, v19, v27
    v_cmp_eq_u32 vcc, -1, v19
    s_nop 0
    s_cbranch_vccnz g_41F3_0
    v_smfmac_f32_16x16x64_bf16 v[64:67], v[24:27], a[192:199], v172
    v_smfmac_f32_16x16x64_bf16 v[68:71], v[24:27], a[224:231], v172
g_41L2_1:
    s_waitcnt vmcnt(0)
    v_max3_u32 v19, v28, v29, v30
    v_max_u32 v19, v19, v31
    v_cmp_eq_u32 vcc, -1, v19
    s_nop 0
    s_cbranch_vccnz g_41F2_1
    v_smfmac_f32_16x16x64_bf16 v[64:67], v[28:31], a[200:207], v172
    v_smfmac_f32_16x16x64_bf16 v[68:71], v[28:31], a[232:239], v172
    s_nop 4
    v_cvt_pk_bf16_f32 v80, v64, v65
    v_cvt_pk_bf16_f32 v81, v66, v67
    s_nop 0
    v_cvt_pk_bf16_f32 v82, v68, v69
    v_cvt_pk_bf16_f32 v83, v70, v71
    ds_write_b128 v17, v[80:83] offset:9216
    s_branch gc_42
g_41L15_3:
    s_waitcnt vmcnt(3)
    v_max3_u32 v19, v36, v37, v38
    v_max_u32 v19, v19, v39
    v_cmp_eq_u32 vcc, -1, v19
    s_nop 0
    s_cbranch_vccnz g_41F15_3
    v_smfmac_f32_16x16x64_bf16 v[64:67], v[36:39], a[216:223], v172
    v_smfmac_f32_16x16x64_bf16 v[68:71], v[36:39], a[248:255], v172
g_41L7_0:
    s_waitcnt vmcnt(2)
    v_max3_u32 v19, v24, v25, v26
    v_max_u32 v19, v19, v27
    v_cmp_eq_u32 vcc, -1, v19
    s_nop 0
    s_cbranch_vccnz g_41F7_0
    v_smfmac_f32_16x16x64_bf16 v[64:67], v[24:27], a[192:199], v172
    v_smfmac_f32_16x16x64_bf16 v[68:71], v[24:27], a[224:231], v172
g_41L6_1:
    s_waitcnt vmcnt(1)
    v_max3_u32 v19, v28, v29, v30
    v_max_u32 v19, v19, v31
    v_cmp_eq_u32 vcc, -1, v19
    s_nop 0
    s_cbranch_vccnz g_41F6_1
    v_smfmac_f32_16x16x64_bf16 v[64:67], v[28:31], a[200:207], v172
    v_smfmac_f32_16x16x64_bf16 v[68:71], v[28:31], a[232:239], v172
g_41L4_2:
    s_waitcnt vmcnt(0)
    v_max3_u32 v19, v32, v33, v34
    v_max_u32 v19, v19, v35
    v_cmp_eq_u32 vcc, -1, v19
    s_nop 0
    s_cbranch_vccnz g_41F4_2
    v_smfmac_f32_16x16x64_bf16 v[64:67], v[32:35], a[208:215], v172
    v_smfmac_f32_16x16x64_bf16 v[68:71], v[32:35], a[240:247], v172
    s_nop 4
    v_cvt_pk_bf16_f32 v80, v64, v65
    v_cvt_pk_bf16_f32 v81, v66, v67
    s_nop 0
    v_cvt_pk_bf16_f32 v82, v68, v69
    v_cvt_pk_bf16_f32 v83, v70, v71
    ds_write_b128 v17, v[80:83] offset:9216
    s_branch gc_42
g_41L7_1:
    s_waitcnt vmcnt(2)
    v_max3_u32 v19, v28, v29, v30
    v_max_u32 v19, v19, v31
    v_cmp_eq_u32 vcc, -1, v19
    s_nop 0
    s_cbranch_vccnz g_41F7_1
    v_smfmac_f32_16x16x64_bf16 v[64:67], v[28:31], a[200:207], v172
    v_smfmac_f32_16x16x64_bf16 v[68:71], v[28:31], a[232:239], v172
g_41L5_2:
    s_waitcnt vmcnt(1)
    v_max3_u32 v19, v32, v33, v34
    v_max_u32 v19, v19, v35
    v_cmp_eq_u32 vcc, -1, v19
    s_nop 0
    s_cbranch_vccnz g_41F5_2
    v_smfmac_f32_16x16x64_bf16 v[64:67], v[32:35], a[208:215], v172
    v_smfmac_f32_16x16x64_bf16 v[68:71], v[32:35], a[240:247], v172
    s_branch g_41L1_0
g_41L7_2:
    s_waitcnt vmcnt(2)
    v_max3_u32 v19, v32, v33, v34
    v_max_u32 v19, v19, v35
    v_cmp_eq_u32 vcc, -1, v19
    s_nop 0
    s_cbranch_vccnz g_41F7_2
    v_smfmac_f32_16x16x64_bf16 v[64:67], v[32:35], a[208:215], v172
    v_smfmac_f32_16x16x64_bf16 v[68:71], v[32:35], a[240:247], v172
    s_branch g_41L3_0
g_41L11_0:
    s_waitcnt vmcnt(2)
    v_max3_u32 v19, v24, v25, v26
    v_max_u32 v19, v19, v27
    v_cmp_eq_u32 vcc, -1, v19
    s_nop 0
    s_cbranch_vccnz g_41F11_0
    v_smfmac_f32_16x16x64_bf16 v[64:67], v[24:27], a[192:199], v172
    v_smfmac_f32_16x16x64_bf16 v[68:71], v[24:27], a[224:231], v172
g_41L10_1:
    s_waitcnt vmcnt(1)
    v_max3_u32 v19, v28, v29, v30
    v_max_u32 v19, v19, v31
    v_cmp_eq_u32 vcc, -1, v19
    s_nop 0
    s_cbranch_vccnz g_41F10_1
    v_smfmac_f32_16x16x64_bf16 v[64:67], v[28:31], a[200:207], v172
    v_smfmac_f32_16x16x64_bf16 v[68:71], v[28:31], a[232:239], v172
    s_branch g_41L8_3
g_41L11_1:
    s_waitcnt vmcnt(2)
    v_max3_u32 v19, v28, v29, v30
    v_max_u32 v19, v19, v31
    v_cmp_eq_u32 vcc, -1, v19
    s_nop 0
    s_cbranch_vccnz g_41F11_1
    v_smfmac_f32_16x16x64_bf16 v[64:67], v[28:31], a[200:207], v172
    v_smfmac_f32_16x16x64_bf16 v[68:71], v[28:31], a[232:239], v172
    s_branch g_41L9_3
g_41L13_0:
    s_waitcnt vmcnt(2)
    v_max3_u32 v19, v24, v25, v26
    v_max_u32 v19, v19, v27
    v_cmp_eq_u32 vcc, -1, v19
    s_nop 0
    s_cbranch_vccnz g_41F13_0
    v_smfmac_f32_16x16x64_bf16 v[64:67], v[24:27], a[192:199], v172
    v_smfmac_f32_16x16x64_bf16 v[68:71], v[24:27], a[224:231], v172
    s_branch g_41L12_2
g_41L13_3:
    s_waitcnt vmcnt(2)
    v_max3_u32 v19, v36, v37, v38
    v_max_u32 v19, v19, v39
    v_cmp_eq_u32 vcc, -1, v19
    s_nop 0
    s_cbranch_vccnz g_41F13_3
    v_smfmac_f32_16x16x64_bf16 v[64:67], v[36:39], a[216:223], v172
    v_smfmac_f32_16x16x64_bf16 v[68:71], v[36:39], a[248:255], v172
g_41L5_0:
    s_waitcnt vmcnt(1)
    v_max3_u32 v19, v24, v25, v26
    v_max_u32 v19, v19, v27
    v_cmp_eq_u32 vcc, -1, v19
    s_nop 0
    s_cbranch_vccnz g_41F5_0
    v_smfmac_f32_16x16x64_bf16 v[64:67], v[24:27], a[192:199], v172
    v_smfmac_f32_16x16x64_bf16 v[68:71], v[24:27], a[224:231], v172
    s_branch g_41L4_2
g_41L14_2:
    s_waitcnt vmcnt(2)
    v_max3_u32 v19, v32, v33, v34
    v_max_u32 v19, v19, v35
    v_cmp_eq_u32 vcc, -1, v19
    s_nop 0
    s_cbranch_vccnz g_41F14_2
    v_smfmac_f32_16x16x64_bf16 v[64:67], v[32:35], a[208:215], v172
    v_smfmac_f32_16x16x64_bf16 v[68:71], v[32:35], a[240:247], v172
g_41L10_3:
    s_waitcnt vmcnt(1)
    v_max3_u32 v19, v36, v37, v38
    v_max_u32 v19, v19, v39
    v_cmp_eq_u32 vcc, -1, v19
    s_nop 0
    s_cbranch_vccnz g_41F10_3
    v_smfmac_f32_16x16x64_bf16 v[64:67], v[36:39], a[216:223], v172
    v_smfmac_f32_16x16x64_bf16 v[68:71], v[36:39], a[248:255], v172
    s_branch g_41L2_1
g_41L14_3:
    s_waitcnt vmcnt(2)
    v_max3_u32 v19, v36, v37, v38
    v_max_u32 v19, v19, v39
    v_cmp_eq_u32 vcc, -1, v19
    s_nop 0
    s_cbranch_vccnz g_41F14_3
    v_smfmac_f32_16x16x64_bf16 v[64:67], v[36:39], a[216:223], v172
    v_smfmac_f32_16x16x64_bf16 v[68:71], v[36:39], a[248:255], v172
    s_branch g_41L6_1
g_41L3_1:
    s_waitcnt vmcnt(1)
    v_max3_u32 v19, v28, v29, v30
    v_max_u32 v19, v19, v31
    v_cmp_eq_u32 vcc, -1, v19
    s_nop 0
    s_cbranch_vccnz g_41F3_1
    v_smfmac_f32_16x16x64_bf16 v[64:67], v[28:31], a[200:207], v172
    v_smfmac_f32_16x16x64_bf16 v[68:71], v[28:31], a[232:239], v172
    s_branch g_41L1_0
g_41L6_2:
    s_waitcnt vmcnt(1)
    v_max3_u32 v19, v32, v33, v34
    v_max_u32 v19, v19, v35
    v_cmp_eq_u32 vcc, -1, v19
    s_nop 0
    s_cbranch_vccnz g_41F6_2
    v_smfmac_f32_16x16x64_bf16 v[64:67], v[32:35], a[208:215], v172
    v_smfmac_f32_16x16x64_bf16 v[68:71], v[32:35], a[240:247], v172
    s_branch g_41L2_1
g_41L9_0:
    s_waitcnt vmcnt(1)
    v_max3_u32 v19, v24, v25, v26
    v_max_u32 v19, v19, v27
    v_cmp_eq_u32 vcc, -1, v19
    s_nop 0
    s_cbranch_vccnz g_41F9_0
    v_smfmac_f32_16x16x64_bf16 v[64:67], v[24:27], a[192:199], v172
    v_smfmac_f32_16x16x64_bf16 v[68:71], v[24:27], a[224:231], v172
    s_branch g_41L8_3
g_41L12_3:
    s_waitcnt vmcnt(1)
    v_max3_u32 v19, v36, v37, v38
    v_max_u32 v19, v19, v39
    v_cmp_eq_u32 vcc, -1, v19
    s_nop 0
    s_cbranch_vccnz g_41F12_3
    v_smfmac_f32_16x16x64_bf16 v[64:67], v[36:39], a[216:223], v172
    v_smfmac_f32_16x16x64_bf16 v[68:71], v[36:39], a[248:255], v172
    s_branch g_41L4_2
g_41F15_0:
    s_mov_b64 exec, vcc
    buffer_load_dwordx4 v[24:27], v8, s[4:7], s16 offen offset:0 sc1
    s_mov_b64 exec, -1
    s_add_u32 s23, s23, 1
    s_cmp_lt_u32 s23, 200000
    s_cbranch_scc1 g_41L15_1
    s_mov_b32 s25, 200000
    s_branch gc_42
g_41F15_1:
    s_mov_b64 exec, vcc
    buffer_load_dwordx4 v[28:31], v8, s[4:7], s16 offen offset:1024 sc1
    s_mov_b64 exec, -1
    s_add_u32 s23, s23, 1
    s_cmp_lt_u32 s23, 200000
    s_cbranch_scc1 g_41L15_2
    s_mov_b32 s25, 200000
    s_branch gc_42
g_41F15_2:
    s_mov_b64 exec, vcc
    buffer_load_dwordx4 v[32:35], v8, s[4:7], s16 offen offset:2048 sc1
    s_mov_b64 exec, -1
    s_add_u32 s23, s23, 1
    s_cmp_lt_u32 s23, 200000
    s_cbranch_scc1 g_41L15_3
    s_mov_b32 s25, 200000
    s_branch gc_42
g_41F15_3:
    s_mov_b64 exec, vcc
    buffer_load_dwordx4 v[36:39], v8, s[4:7], s16 offen offset:3072 sc1
    s_mov_b64 exec, -1
    s_add_u32 s23, s23, 1
    s_cmp_lt_u32 s23, 200000
    s_cbranch_scc1 g_41L15_0
    s_mov_b32 s25, 200000
    s_branch gc_42
g_41F7_0:
    s_mov_b64 exec, vcc
    buffer_load_dwordx4 v[24:27], v8, s[4:7], s16 offen offset:0 sc1
    s_mov_b64 exec, -1
    s_add_u32 s23, s23, 1
    s_cmp_lt_u32 s23, 200000
    s_cbranch_scc1 g_41L7_1
    s_mov_b32 s25, 200000
    s_branch gc_42
g_41F7_1:
    s_mov_b64 exec, vcc
    buffer_load_dwordx4 v[28:31], v8, s[4:7], s16 offen offset:1024 sc1
    s_mov_b64 exec, -1
    s_add_u32 s23, s23, 1
    s_cmp_lt_u32 s23, 200000
    s_cbranch_scc1 g_41L7_2
    s_mov_b32 s25, 200000
    s_branch gc_42
g_41F7_2:
    s_mov_b64 exec, vcc
    buffer_load_dwordx4 v[32:35], v8, s[4:7], s16 offen offset:2048 sc1
    s_mov_b64 exec, -1
    s_add_u32 s23, s23, 1
    s_cmp_lt_u32 s23, 200000
    s_cbranch_scc1 g_41L7_0
    s_mov_b32 s25, 200000
    s_branch gc_42
g_41F11_0:
    s_mov_b64 exec, vcc
    buffer_load_dwordx4 v[24:27], v8, s[4:7], s16 offen offset:0 sc1
    s_mov_b64 exec, -1
    s_add_u32 s23, s23, 1
    s_cmp_lt_u32 s23, 200000
    s_cbranch_scc1 g_41L11_1
    s_mov_b32 s25, 200000
    s_branch gc_42
g_41F11_1:
    s_mov_b64 exec, vcc
    buffer_load_dwordx4 v[28:31], v8, s[4:7], s16 offen offset:1024 sc1
    s_mov_b64 exec, -1
    s_add_u32 s23, s23, 1
    s_cmp_lt_u32 s23, 200000
    s_cbranch_scc1 g_41L11_3
    s_mov_b32 s25, 200000
    s_branch gc_42
g_41F11_3:
    s_mov_b64 exec, vcc
    buffer_load_dwordx4 v[36:39], v8, s[4:7], s16 offen offset:3072 sc1
    s_mov_b64 exec, -1
    s_add_u32 s23, s23, 1
    s_cmp_lt_u32 s23, 200000
    s_cbranch_scc1 g_41L11_0
    s_mov_b32 s25, 200000
    s_branch gc_42
g_41F13_0:
    s_mov_b64 exec, vcc
    buffer_load_dwordx4 v[24:27], v8, s[4:7], s16 offen offset:0 sc1
    s_mov_b64 exec, -1
    s_add_u32 s23, s23, 1
    s_cmp_lt_u32 s23, 200000
    s_cbranch_scc1 g_41L13_2
    s_mov_b32 s25, 200000
    s_branch gc_42
g_41F13_2:
    s_mov_b64 exec, vcc
    buffer_load_dwordx4 v[32:35], v8, s[4:7], s16 offen offset:2048 sc1
    s_mov_b64 exec, -1
    s_add_u32 s23, s23, 1
    s_cmp_lt_u32 s23, 200000
    s_cbranch_scc1 g_41L13_3
    s_mov_b32 s25, 200000
    s_branch gc_42
g_41F13_3:
    s_mov_b64 exec, vcc
    buffer_load_dwordx4 v[36:39], v8, s[4:7], s16 offen offset:3072 sc1
    s_mov_b64 exec, -1
    s_add_u32 s23, s23, 1
    s_cmp_lt_u32 s23, 200000
    s_cbranch_scc1 g_41L13_0
    s_mov_b32 s25, 200000
    s_branch gc_42
g_41F14_1:
    s_mov_b64 exec, vcc
    buffer_load_dwordx4 v[28:31], v8, s[4:7], s16 offen offset:1024 sc1
    s_mov_b64 exec, -1
    s_add_u32 s23, s23, 1
    s_cmp_lt_u32 s23, 200000
    s_cbranch_scc1 g_41L14_2
    s_mov_b32 s25, 200000
    s_branch gc_42
g_41F14_2:
    s_mov_b64 exec, vcc
    buffer_load_dwordx4 v[32:35], v8, s[4:7], s16 offen offset:2048 sc1
    s_mov_b64 exec, -1
    s_add_u32 s23, s23, 1
    s_cmp_lt_u32 s23, 200000
    s_cbranch_scc1 g_41L14_3
    s_mov_b32 s25, 200000
    s_branch gc_42
g_41F14_3:
    s_mov_b64 exec, vcc
    buffer_load_dwordx4 v[36:39], v8, s[4:7], s16 offen offset:3072 sc1
    s_mov_b64 exec, -1
    s_add_u32 s23, s23, 1
    s_cmp_lt_u32 s23, 200000
    s_cbranch_scc1 g_41L14_1
    s_mov_b32 s25, 200000
    s_branch gc_42
g_41F3_0:
    s_mov_b64 exec, vcc
    buffer_load_dwordx4 v[24:27], v8, s[4:7], s16 offen offset:0 sc1
    s_mov_b64 exec, -1
    s_add_u32 s23, s23, 1
    s_cmp_lt_u32 s23, 200000
    s_cbranch_scc1 g_41L3_1
    s_mov_b32 s25, 200000
    s_branch gc_42
g_41F3_1:
    s_mov_b64 exec, vcc
    buffer_load_dwordx4 v[28:31], v8, s[4:7], s16 offen offset:1024 sc1
    s_mov_b64 exec, -1
    s_add_u32 s23, s23, 1
    s_cmp_lt_u32 s23, 200000
    s_cbranch_scc1 g_41L3_0
    s_mov_b32 s25, 200000
    s_branch gc_42
g_41F5_0:
    s_mov_b64 exec, vcc
    buffer_load_dwordx4 v[24:27], v8, s[4:7], s16 offen offset:0 sc1
    s_mov_b64 exec, -1
    s_add_u32 s23, s23, 1
    s_cmp_lt_u32 s23, 200000
    s_cbranch_scc1 g_41L5_2
    s_mov_b32 s25, 200000
    s_branch gc_42
g_41F5_2:
    s_mov_b64 exec, vcc
    buffer_load_dwordx4 v[32:35], v8, s[4:7], s16 offen offset:2048 sc1
    s_mov_b64 exec, -1
    s_add_u32 s23, s23, 1
    s_cmp_lt_u32 s23, 200000
    s_cbranch_scc1 g_41L5_0
    s_mov_b32 s25, 200000
    s_branch gc_42
g_41F6_1:
    s_mov_b64 exec, vcc
    buffer_load_dwordx4 v[28:31], v8, s[4:7], s16 offen offset:1024 sc1
    s_mov_b64 exec, -1
    s_add_u32 s23, s23, 1
    s_cmp_lt_u32 s23, 200000
    s_cbranch_scc1 g_41L6_2
    s_mov_b32 s25, 200000
    s_branch gc_42
g_41F6_2:
    s_mov_b64 exec, vcc
    buffer_load_dwordx4 v[32:35], v8, s[4:7], s16 offen offset:2048 sc1
    s_mov_b64 exec, -1
    s_add_u32 s23, s23, 1
    s_cmp_lt_u32 s23, 200000
    s_cbranch_scc1 g_41L6_1
    s_mov_b32 s25, 200000
    s_branch gc_42
g_41F9_0:
    s_mov_b64 exec, vcc
    buffer_load_dwordx4 v[24:27], v8, s[4:7], s16 offen offset:0 sc1
    s_mov_b64 exec, -1
    s_add_u32 s23, s23, 1
    s_cmp_lt_u32 s23, 200000
    s_cbranch_scc1 g_41L9_3
    s_mov_b32 s25, 200000
    s_branch gc_42
g_41F9_3:
    s_mov_b64 exec, vcc
    buffer_load_dwordx4 v[36:39], v8, s[4:7], s16 offen offset:3072 sc1
    s_mov_b64 exec, -1
    s_add_u32 s23, s23, 1
    s_cmp_lt_u32 s23, 200000
    s_cbranch_scc1 g_41L9_0
    s_mov_b32 s25, 200000
    s_branch gc_42
g_41F10_1:
    s_mov_b64 exec, vcc
    buffer_load_dwordx4 v[28:31], v8, s[4:7], s16 offen offset:1024 sc1
    s_mov_b64 exec, -1
    s_add_u32 s23, s23, 1
    s_cmp_lt_u32 s23, 200000
    s_cbranch_scc1 g_41L10_3
    s_mov_b32 s25, 200000
    s_branch gc_42
g_41F10_3:
    s_mov_b64 exec, vcc
    buffer_load_dwordx4 v[36:39], v8, s[4:7], s16 offen offset:3072 sc1
    s_mov_b64 exec, -1
    s_add_u32 s23, s23, 1
    s_cmp_lt_u32 s23, 200000
    s_cbranch_scc1 g_41L10_1
    s_mov_b32 s25, 200000
    s_branch gc_42
g_41F12_2:
    s_mov_b64 exec, vcc
    buffer_load_dwordx4 v[32:35], v8, s[4:7], s16 offen offset:2048 sc1
    s_mov_b64 exec, -1
    s_add_u32 s23, s23, 1
    s_cmp_lt_u32 s23, 200000
    s_cbranch_scc1 g_41L12_3
    s_mov_b32 s25, 200000
    s_branch gc_42
g_41F12_3:
    s_mov_b64 exec, vcc
    buffer_load_dwordx4 v[36:39], v8, s[4:7], s16 offen offset:3072 sc1
    s_mov_b64 exec, -1
    s_add_u32 s23, s23, 1
    s_cmp_lt_u32 s23, 200000
    s_cbranch_scc1 g_41L12_2
    s_mov_b32 s25, 200000
    s_branch gc_42
g_41F1_0:
    s_mov_b64 exec, vcc
    buffer_load_dwordx4 v[24:27], v8, s[4:7], s16 offen offset:0 sc1
    s_mov_b64 exec, -1
    s_add_u32 s23, s23, 1
    s_cmp_lt_u32 s23, 200000
    s_cbranch_scc1 g_41L1_0
    s_mov_b32 s25, 200000
    s_branch gc_42
g_41F2_1:
    s_mov_b64 exec, vcc
    buffer_load_dwordx4 v[28:31], v8, s[4:7], s16 offen offset:1024 sc1
    s_mov_b64 exec, -1
    s_add_u32 s23, s23, 1
    s_cmp_lt_u32 s23, 200000
    s_cbranch_scc1 g_41L2_1
    s_mov_b32 s25, 200000
    s_branch gc_42
g_41F4_2:
    s_mov_b64 exec, vcc
    buffer_load_dwordx4 v[32:35], v8, s[4:7], s16 offen offset:2048 sc1
    s_mov_b64 exec, -1
    s_add_u32 s23, s23, 1
    s_cmp_lt_u32 s23, 200000
    s_cbranch_scc1 g_41L4_2
    s_mov_b32 s25, 200000
    s_branch gc_42
g_41F8_3:
    s_mov_b64 exec, vcc
    buffer_load_dwordx4 v[36:39], v8, s[4:7], s16 offen offset:3072 sc1
    s_mov_b64 exec, -1
    s_add_u32 s23, s23, 1
    s_cmp_lt_u32 s23, 200000
    s_cbranch_scc1 g_41L8_3
    s_mov_b32 s25, 200000
    s_branch gc_42
.p2align 6
recur_fast_w2:
    s_nop 15
    s_mov_b32 s23, s25
    buffer_load_dwordx4 v[24:27], v2, s[4:7], s16 offen offset:0 sc1
    s_nop 11
    buffer_load_dwordx4 v[28:31], v2, s[4:7], s16 offen offset:1024 sc1
    s_nop 11
    buffer_load_dwordx4 v[32:35], v2, s[4:7], s16 offen offset:2048 sc1
    s_nop 11
    buffer_load_dwordx4 v[36:39], v2, s[4:7], s16 offen offset:3072 sc1
    s_waitcnt vmcnt(3)
    v_max3_u32 v19, v24, v25, v26
    v_max_u32 v19, v19, v27
    v_cmp_eq_u32 vcc, -1, v19
    s_nop 0
    s_cbranch_vccnz g_45F15_0
    v_smfmac_f32_16x16x64_bf16 v[40:43], v[24:27], a[0:7], v172
    s_waitcnt vmcnt(2)
    v_max3_u32 v19, v28, v29, v30
    v_max_u32 v19, v19, v31
    v_smfmac_f32_16x16x64_bf16 v[44:47], v[24:27], a[64:71], v172
    v_cmp_eq_u32 vcc, -1, v19
    v_smfmac_f32_16x16x64_bf16 v[48:51], v[24:27], a[32:39], v172
    v_smfmac_f32_16x16x64_bf16 v[52:55], v[24:27], a[96:103], v172
    s_cbranch_vccnz g_45F14_1
    v_smfmac_f32_16x16x64_bf16 v[40:43], v[28:31], a[8:15], v172
    s_waitcnt vmcnt(1)
    v_max3_u32 v19, v32, v33, v34
    v_max_u32 v19, v19, v35
    v_smfmac_f32_16x16x64_bf16 v[44:47], v[28:31], a[72:79], v172
    v_cmp_eq_u32 vcc, -1, v19
    v_smfmac_f32_16x16x64_bf16 v[48:51], v[28:31], a[40:47], v172
    v_smfmac_f32_16x16x64_bf16 v[52:55], v[28:31], a[104:111], v172
    s_cbranch_vccnz g_45F12_2
    v_smfmac_f32_16x16x64_bf16 v[40:43], v[32:35], a[16:23], v172
    s_waitcnt vmcnt(0)
    v_max3_u32 v19, v36, v37, v38
    v_max_u32 v19, v19, v39
    v_smfmac_f32_16x16x64_bf16 v[44:47], v[32:35], a[80:87], v172
    v_cmp_eq_u32 vcc, -1, v19
    v_smfmac_f32_16x16x64_bf16 v[48:51], v[32:35], a[48:55], v172
    v_smfmac_f32_16x16x64_bf16 v[52:55], v[32:35], a[112:119], v172
    s_cbranch_vccnz g_45F8_3
    v_smfmac_f32_16x16x64_bf16 v[40:43], v[36:39], a[24:31], v172
    v_smfmac_f32_16x16x64_bf16 v[44:47], v[36:39], a[88:95], v172
    v_smfmac_f32_16x16x64_bf16 v[48:51], v[36:39], a[56:63], v172
    v_smfmac_f32_16x16x64_bf16 v[52:55], v[36:39], a[120:127], v172
gc_46:
    v_cvt_pk_bf16_f32 v72, v40, v41
    v_cvt_pk_bf16_f32 v73, v42, v43
    v_cvt_pk_bf16_f32 v74, v44, v45
    v_cvt_pk_bf16_f32 v75, v46, v47
    ds_write_b128 v17, v[72:75] offset:0
    v_cvt_pk_bf16_f32 v76, v48, v49
    v_cvt_pk_bf16_f32 v77, v50, v51
    s_nop 0
    v_cvt_pk_bf16_f32 v78, v52, v53
    v_cvt_pk_bf16_f32 v79, v54, v55
    ds_write_b128 v17, v[76:79] offset:1024
    v_smfmac_f32_16x16x64_bf16 v[56:59], v[24:27], a[128:135], v172
    v_smfmac_f32_16x16x64_bf16 v[60:63], v[24:27], a[160:167], v172
    v_smfmac_f32_16x16x64_bf16 v[56:59], v[28:31], a[136:143], v172
    s_waitcnt lgkmcnt(0)
    s_barrier
    v_smfmac_f32_16x16x64_bf16 v[60:63], v[28:31], a[168:175], v172
    v_smfmac_f32_16x16x64_bf16 v[56:59], v[32:35], a[144:151], v172
    v_smfmac_f32_16x16x64_bf16 v[60:63], v[32:35], a[176:183], v172
    v_smfmac_f32_16x16x64_bf16 v[56:59], v[36:39], a[152:159], v172
    v_smfmac_f32_16x16x64_bf16 v[60:63], v[36:39], a[184:191], v172
    s_nop 4
    v_cvt_pk_bf16_f32 v80, v56, v57
    v_cvt_pk_bf16_f32 v81, v58, v59
    s_nop 0
    v_cvt_pk_bf16_f32 v82, v60, v61
    v_cvt_pk_bf16_f32 v83, v62, v63
    ds_write_b128 v17, v[80:83] offset:8192
    s_cmp_eq_u32 s15, 63
    s_waitcnt lgkmcnt(0)
    s_barrier
    ds_read_b128 v[96:99], v16 offset:8192
    ds_read_b128 v[100:103], v16 offset:10240
    ds_read_b128 v[108:111], v16 offset:14336
    v_mfma_f32_16x16x32_bf16 v[140:143], v[84:87], v[80:83], 0
    s_waitcnt lgkmcnt(2)
    v_mfma_f32_16x16x32_bf16 v[140:143], v[84:87], v[96:99], v[140:143]
    s_waitcnt lgkmcnt(1)
    v_mfma_f32_16x16x32_bf16 v[140:143], v[84:87], v[100:103], v[140:143]
    s_waitcnt lgkmcnt(0)
    v_mfma_f32_16x16x32_bf16 v[140:143], v[84:87], v[108:111], v[140:143]
    s_nop 7
    v_cvt_pk_bf16_f32 v168, v140, v141
    v_cvt_pk_bf16_f32 v169, v142, v143
    v_mov_b32 v170, v168
    v_mov_b32 v171, v169
    s_nop 0
    v_permlane16_swap_b32 v168, v170
    v_permlane16_swap_b32 v169, v171
    v_mov_b32 v247, s15
    s_cbranch_scc1 recur_fast_last2
    s_barrier
    s_nop 15
    s_mov_b32 s23, s25
    buffer_load_dwordx4 v[24:27], v8, s[4:7], s16 offen offset:0 sc1
    s_nop 11
    buffer_load_dwordx4 v[28:31], v8, s[4:7], s16 offen offset:1024 sc1
    s_nop 11
    buffer_load_dwordx4 v[32:35], v8, s[4:7], s16 offen offset:2048 sc1
    s_nop 11
    buffer_load_dwordx4 v[36:39], v8, s[4:7], s16 offen offset:3072 sc1
    s_waitcnt vmcnt(3)
    v_max3_u32 v19, v24, v25, v26
    v_max_u32 v19, v19, v27
    v_cmp_eq_u32 vcc, -1, v19
    s_nop 0
    s_cbranch_vccnz g_47F15_0
    v_smfmac_f32_16x16x64_bf16 v[64:67], v[24:27], a[192:199], v172
    v_smfmac_f32_16x16x64_bf16 v[68:71], v[24:27], a[224:231], v172
    s_waitcnt vmcnt(2)
    v_max3_u32 v19, v28, v29, v30
    v_max_u32 v19, v19, v31
    v_cmp_eq_u32 vcc, -1, v19
    s_nop 0
    s_cbranch_vccnz g_47F14_1
    v_smfmac_f32_16x16x64_bf16 v[64:67], v[28:31], a[200:207], v172
    v_smfmac_f32_16x16x64_bf16 v[68:71], v[28:31], a[232:239], v172
    s_waitcnt vmcnt(1)
    v_max3_u32 v19, v32, v33, v34
    v_max_u32 v19, v19, v35
    v_cmp_eq_u32 vcc, -1, v19
    s_nop 0
    s_cbranch_vccnz g_47F12_2
    v_smfmac_f32_16x16x64_bf16 v[64:67], v[32:35], a[208:215], v172
    v_smfmac_f32_16x16x64_bf16 v[68:71], v[32:35], a[240:247], v172
    s_waitcnt vmcnt(0)
    v_max3_u32 v19, v36, v37, v38
    v_max_u32 v19, v19, v39
    v_cmp_eq_u32 vcc, -1, v19
    s_nop 0
    s_cbranch_vccnz g_47F8_3
    v_smfmac_f32_16x16x64_bf16 v[64:67], v[36:39], a[216:223], v172
    v_smfmac_f32_16x16x64_bf16 v[68:71], v[36:39], a[248:255], v172
    s_nop 4
    v_cvt_pk_bf16_f32 v80, v64, v65
    v_cvt_pk_bf16_f32 v81, v66, v67
    s_nop 0
    v_cvt_pk_bf16_f32 v82, v68, v69
    v_cvt_pk_bf16_f32 v83, v70, v71
    ds_write_b128 v17, v[80:83] offset:9216
gc_48:
    s_waitcnt lgkmcnt(0)
    s_barrier
    s_nop 15
    s_nop 15
    s_nop 15
    s_nop 15
    buffer_store_dwordx4 v[168:171], v15, s[4:7], s20 offen sc1
    s_add_u32 s20, s20, 512
    s_add_u32 s21, s95, 1048576
    s_lshr_b32 s22, s21, 8
    s_and_b32 s22, s22, 8192
    s_xor_b32 s22, s22, s46
    s_add_u32 s21, s21, s22
    buffer_store_dwordx4 v[204:207], v9, s[4:7], s21 offen sc1
    s_add_u32 s21, s21, 262144
    buffer_store_dwordx4 v[204:207], v9, s[4:7], s21 offen sc1
    buffer_store_dword v247, v246, s[4:7], 0 offen sc1
    v_mov_b32 v40, 0
    v_mov_b32 v41, 0
    v_mov_b32 v42, 0
    v_mov_b32 v43, 0
    v_mov_b32 v44, 0
    v_mov_b32 v45, 0
    v_mov_b32 v46, 0
    v_mov_b32 v47, 0
    v_mov_b32 v48, 0
    v_mov_b32 v49, 0
    v_mov_b32 v50, 0
    v_mov_b32 v51, 0
    v_mov_b32 v52, 0
    v_mov_b32 v53, 0
    v_mov_b32 v54, 0
    v_mov_b32 v55, 0
    v_mov_b32 v56, 0
    v_mov_b32 v57, 0
    v_mov_b32 v58, 0
    v_mov_b32 v59, 0
    v_mov_b32 v60, 0
    v_mov_b32 v61, 0
    v_mov_b32 v62, 0
    v_mov_b32 v63, 0
    v_mov_b32 v64, 0
    v_mov_b32 v65, 0
    v_mov_b32 v66, 0
    v_mov_b32 v67, 0
    v_mov_b32 v68, 0
    v_mov_b32 v69, 0
    v_mov_b32 v70, 0
    v_mov_b32 v71, 0
    s_mov_b32 s21, s16
    s_mov_b32 s16, s42
    s_mov_b32 s42, s43
    s_mov_b32 s43, s44
    s_mov_b32 s44, s21
    s_add_u32 s95, s95, 524288
    s_lshr_b32 s84, s95, 8
    s_and_b32 s84, s84, 8192
    s_xor_b32 s84, s84, s46
    s_add_u32 s84, s84, s95
    s_add_u32 s15, s15, 1
    s_barrier
    s_branch recur_fast_w2
g_45L15_0:
    s_waitcnt vmcnt(3)
    v_max3_u32 v19, v24, v25, v26
    v_max_u32 v19, v19, v27
    v_cmp_eq_u32 vcc, -1, v19
    s_nop 0
    s_cbranch_vccnz g_45F15_0
    v_smfmac_f32_16x16x64_bf16 v[40:43], v[24:27], a[0:7], v172
    v_smfmac_f32_16x16x64_bf16 v[44:47], v[24:27], a[64:71], v172
    v_smfmac_f32_16x16x64_bf16 v[48:51], v[24:27], a[32:39], v172
    v_smfmac_f32_16x16x64_bf16 v[52:55], v[24:27], a[96:103], v172
g_45L14_1:
    s_waitcnt vmcnt(2)
    v_max3_u32 v19, v28, v29, v30
    v_max_u32 v19, v19, v31
    v_cmp_eq_u32 vcc, -1, v19
    s_nop 0
    s_cbranch_vccnz g_45F14_1
    v_smfmac_f32_16x16x64_bf16 v[40:43], v[28:31], a[8:15], v172
    v_smfmac_f32_16x16x64_bf16 v[44:47], v[28:31], a[72:79], v172
    v_smfmac_f32_16x16x64_bf16 v[48:51], v[28:31], a[40:47], v172
    v_smfmac_f32_16x16x64_bf16 v[52:55], v[28:31], a[104:111], v172
g_45L12_2:
    s_waitcnt vmcnt(1)
    v_max3_u32 v19, v32, v33, v34
    v_max_u32 v19, v19, v35
    v_cmp_eq_u32 vcc, -1, v19
    s_nop 0
    s_cbranch_vccnz g_45F12_2
    v_smfmac_f32_16x16x64_bf16 v[40:43], v[32:35], a[16:23], v172
    v_smfmac_f32_16x16x64_bf16 v[44:47], v[32:35], a[80:87], v172
    v_smfmac_f32_16x16x64_bf16 v[48:51], v[32:35], a[48:55], v172
    v_smfmac_f32_16x16x64_bf16 v[52:55], v[32:35], a[112:119], v172
g_45L8_3:
    s_waitcnt vmcnt(0)
    v_max3_u32 v19, v36, v37, v38
    v_max_u32 v19, v19, v39
    v_cmp_eq_u32 vcc, -1, v19
    s_nop 0
    s_cbranch_vccnz g_45F8_3
    v_smfmac_f32_16x16x64_bf16 v[40:43], v[36:39], a[24:31], v172
    v_smfmac_f32_16x16x64_bf16 v[44:47], v[36:39], a[88:95], v172
    v_smfmac_f32_16x16x64_bf16 v[48:51], v[36:39], a[56:63], v172
    v_smfmac_f32_16x16x64_bf16 v[52:55], v[36:39], a[120:127], v172
    s_branch gc_46
g_45L15_1:
    s_waitcnt vmcnt(3)
    v_max3_u32 v19, v28, v29, v30
    v_max_u32 v19, v19, v31
    v_cmp_eq_u32 vcc, -1, v19
    s_nop 0
    s_cbranch_vccnz g_45F15_1
    v_smfmac_f32_16x16x64_bf16 v[40:43], v[28:31], a[8:15], v172
    v_smfmac_f32_16x16x64_bf16 v[44:47], v[28:31], a[72:79], v172
    v_smfmac_f32_16x16x64_bf16 v[48:51], v[28:31], a[40:47], v172
    v_smfmac_f32_16x16x64_bf16 v[52:55], v[28:31], a[104:111], v172
g_45L13_2:
    s_waitcnt vmcnt(2)
    v_max3_u32 v19, v32, v33, v34
    v_max_u32 v19, v19, v35
    v_cmp_eq_u32 vcc, -1, v19
    s_nop 0
    s_cbranch_vccnz g_45F13_2
    v_smfmac_f32_16x16x64_bf16 v[40:43], v[32:35], a[16:23], v172
    v_smfmac_f32_16x16x64_bf16 v[44:47], v[32:35], a[80:87], v172
    v_smfmac_f32_16x16x64_bf16 v[48:51], v[32:35], a[48:55], v172
    v_smfmac_f32_16x16x64_bf16 v[52:55], v[32:35], a[112:119], v172
g_45L9_3:
    s_waitcnt vmcnt(1)
    v_max3_u32 v19, v36, v37, v38
    v_max_u32 v19, v19, v39
    v_cmp_eq_u32 vcc, -1, v19
    s_nop 0
    s_cbranch_vccnz g_45F9_3
    v_smfmac_f32_16x16x64_bf16 v[40:43], v[36:39], a[24:31], v172
    v_smfmac_f32_16x16x64_bf16 v[44:47], v[36:39], a[88:95], v172
    v_smfmac_f32_16x16x64_bf16 v[48:51], v[36:39], a[56:63], v172
    v_smfmac_f32_16x16x64_bf16 v[52:55], v[36:39], a[120:127], v172
g_45L1_0:
    s_waitcnt vmcnt(0)
    v_max3_u32 v19, v24, v25, v26
    v_max_u32 v19, v19, v27
    v_cmp_eq_u32 vcc, -1, v19
    s_nop 0
    s_cbranch_vccnz g_45F1_0
    v_smfmac_f32_16x16x64_bf16 v[40:43], v[24:27], a[0:7], v172
    v_smfmac_f32_16x16x64_bf16 v[44:47], v[24:27], a[64:71], v172
    v_smfmac_f32_16x16x64_bf16 v[48:51], v[24:27], a[32:39], v172
    v_smfmac_f32_16x16x64_bf16 v[52:55], v[24:27], a[96:103], v172
    s_branch gc_46
g_45L15_2:
    s_waitcnt vmcnt(3)
    v_max3_u32 v19, v32, v33, v34
    v_max_u32 v19, v19, v35
    v_cmp_eq_u32 vcc, -1, v19
    s_nop 0
    s_cbranch_vccnz g_45F15_2
    v_smfmac_f32_16x16x64_bf16 v[40:43], v[32:35], a[16:23], v172
    v_smfmac_f32_16x16x64_bf16 v[44:47], v[32:35], a[80:87], v172
    v_smfmac_f32_16x16x64_bf16 v[48:51], v[32:35], a[48:55], v172
    v_smfmac_f32_16x16x64_bf16 v[52:55], v[32:35], a[112:119], v172
g_45L11_3:
    s_waitcnt vmcnt(2)
    v_max3_u32 v19, v36, v37, v38
    v_max_u32 v19, v19, v39
    v_cmp_eq_u32 vcc, -1, v19
    s_nop 0
    s_cbranch_vccnz g_45F11_3
    v_smfmac_f32_16x16x64_bf16 v[40:43], v[36:39], a[24:31], v172
    v_smfmac_f32_16x16x64_bf16 v[44:47], v[36:39], a[88:95], v172
    v_smfmac_f32_16x16x64_bf16 v[48:51], v[36:39], a[56:63], v172
    v_smfmac_f32_16x16x64_bf16 v[52:55], v[36:39], a[120:127], v172
g_45L3_0:
    s_waitcnt vmcnt(1)
    v_max3_u32 v19, v24, v25, v26
    v_max_u32 v19, v19, v27
    v_cmp_eq_u32 vcc, -1, v19
    s_nop 0
    s_cbranch_vccnz g_45F3_0
    v_smfmac_f32_16x16x64_bf16 v[40:43], v[24:27], a[0:7], v172
    v_smfmac_f32_16x16x64_bf16 v[44:47], v[24:27], a[64:71], v172
    v_smfmac_f32_16x16x64_bf16 v[48:51], v[24:27], a[32:39], v172
    v_smfmac_f32_16x16x64_bf16 v[52:55], v[24:27], a[96:103], v172
g_45L2_1:
    s_waitcnt vmcnt(0)
    v_max3_u32 v19, v28, v29, v30
    v_max_u32 v19, v19, v31
    v_cmp_eq_u32 vcc, -1, v19
    s_nop 0
    s_cbranch_vccnz g_45F2_1
    v_smfmac_f32_16x16x64_bf16 v[40:43], v[28:31], a[8:15], v172
    v_smfmac_f32_16x16x64_bf16 v[44:47], v[28:31], a[72:79], v172
    v_smfmac_f32_16x16x64_bf16 v[48:51], v[28:31], a[40:47], v172
    v_smfmac_f32_16x16x64_bf16 v[52:55], v[28:31], a[104:111], v172
    s_branch gc_46
g_45L15_3:
    s_waitcnt vmcnt(3)
    v_max3_u32 v19, v36, v37, v38
    v_max_u32 v19, v19, v39
    v_cmp_eq_u32 vcc, -1, v19
    s_nop 0
    s_cbranch_vccnz g_45F15_3
    v_smfmac_f32_16x16x64_bf16 v[40:43], v[36:39], a[24:31], v172
    v_smfmac_f32_16x16x64_bf16 v[44:47], v[36:39], a[88:95], v172
    v_smfmac_f32_16x16x64_bf16 v[48:51], v[36:39], a[56:63], v172
    v_smfmac_f32_16x16x64_bf16 v[52:55], v[36:39], a[120:127], v172
g_45L7_0:
    s_waitcnt vmcnt(2)
    v_max3_u32 v19, v24, v25, v26
    v_max_u32 v19, v19, v27
    v_cmp_eq_u32 vcc, -1, v19
    s_nop 0
    s_cbranch_vccnz g_45F7_0
    v_smfmac_f32_16x16x64_bf16 v[40:43], v[24:27], a[0:7], v172
    v_smfmac_f32_16x16x64_bf16 v[44:47], v[24:27], a[64:71], v172
    v_smfmac_f32_16x16x64_bf16 v[48:51], v[24:27], a[32:39], v172
    v_smfmac_f32_16x16x64_bf16 v[52:55], v[24:27], a[96:103], v172
g_45L6_1:
    s_waitcnt vmcnt(1)
    v_max3_u32 v19, v28, v29, v30
    v_max_u32 v19, v19, v31
    v_cmp_eq_u32 vcc, -1, v19
    s_nop 0
    s_cbranch_vccnz g_45F6_1
    v_smfmac_f32_16x16x64_bf16 v[40:43], v[28:31], a[8:15], v172
    v_smfmac_f32_16x16x64_bf16 v[44:47], v[28:31], a[72:79], v172
    v_smfmac_f32_16x16x64_bf16 v[48:51], v[28:31], a[40:47], v172
    v_smfmac_f32_16x16x64_bf16 v[52:55], v[28:31], a[104:111], v172
g_45L4_2:
    s_waitcnt vmcnt(0)
    v_max3_u32 v19, v32, v33, v34
    v_max_u32 v19, v19, v35
    v_cmp_eq_u32 vcc, -1, v19
    s_nop 0
    s_cbranch_vccnz g_45F4_2
    v_smfmac_f32_16x16x64_bf16 v[40:43], v[32:35], a[16:23], v172
    v_smfmac_f32_16x16x64_bf16 v[44:47], v[32:35], a[80:87], v172
    v_smfmac_f32_16x16x64_bf16 v[48:51], v[32:35], a[48:55], v172
    v_smfmac_f32_16x16x64_bf16 v[52:55], v[32:35], a[112:119], v172
    s_branch gc_46
g_45L7_1:
    s_waitcnt vmcnt(2)
    v_max3_u32 v19, v28, v29, v30
    v_max_u32 v19, v19, v31
    v_cmp_eq_u32 vcc, -1, v19
    s_nop 0
    s_cbranch_vccnz g_45F7_1
    v_smfmac_f32_16x16x64_bf16 v[40:43], v[28:31], a[8:15], v172
    v_smfmac_f32_16x16x64_bf16 v[44:47], v[28:31], a[72:79], v172
    v_smfmac_f32_16x16x64_bf16 v[48:51], v[28:31], a[40:47], v172
    v_smfmac_f32_16x16x64_bf16 v[52:55], v[28:31], a[104:111], v172
g_45L5_2:
    s_waitcnt vmcnt(1)
    v_max3_u32 v19, v32, v33, v34
    v_max_u32 v19, v19, v35
    v_cmp_eq_u32 vcc, -1, v19
    s_nop 0
    s_cbranch_vccnz g_45F5_2
    v_smfmac_f32_16x16x64_bf16 v[40:43], v[32:35], a[16:23], v172
    v_smfmac_f32_16x16x64_bf16 v[44:47], v[32:35], a[80:87], v172
    v_smfmac_f32_16x16x64_bf16 v[48:51], v[32:35], a[48:55], v172
    v_smfmac_f32_16x16x64_bf16 v[52:55], v[32:35], a[112:119], v172
    s_branch g_45L1_0
g_45L7_2:
    s_waitcnt vmcnt(2)
    v_max3_u32 v19, v32, v33, v34
    v_max_u32 v19, v19, v35
    v_cmp_eq_u32 vcc, -1, v19
    s_nop 0
    s_cbranch_vccnz g_45F7_2
    v_smfmac_f32_16x16x64_bf16 v[40:43], v[32:35], a[16:23], v172
    v_smfmac_f32_16x16x64_bf16 v[44:47], v[32:35], a[80:87], v172
    v_smfmac_f32_16x16x64_bf16 v[48:51], v[32:35], a[48:55], v172
    v_smfmac_f32_16x16x64_bf16 v[52:55], v[32:35], a[112:119], v172
    s_branch g_45L3_0
g_45L11_0:
    s_waitcnt vmcnt(2)
    v_max3_u32 v19, v24, v25, v26
    v_max_u32 v19, v19, v27
    v_cmp_eq_u32 vcc, -1, v19
    s_nop 0
    s_cbranch_vccnz g_45F11_0
    v_smfmac_f32_16x16x64_bf16 v[40:43], v[24:27], a[0:7], v172
    v_smfmac_f32_16x16x64_bf16 v[44:47], v[24:27], a[64:71], v172
    v_smfmac_f32_16x16x64_bf16 v[48:51], v[24:27], a[32:39], v172
    v_smfmac_f32_16x16x64_bf16 v[52:55], v[24:27], a[96:103], v172
g_45L10_1:
    s_waitcnt vmcnt(1)
    v_max3_u32 v19, v28, v29, v30
    v_max_u32 v19, v19, v31
    v_cmp_eq_u32 vcc, -1, v19
    s_nop 0
    s_cbranch_vccnz g_45F10_1
    v_smfmac_f32_16x16x64_bf16 v[40:43], v[28:31], a[8:15], v172
    v_smfmac_f32_16x16x64_bf16 v[44:47], v[28:31], a[72:79], v172
    v_smfmac_f32_16x16x64_bf16 v[48:51], v[28:31], a[40:47], v172
    v_smfmac_f32_16x16x64_bf16 v[52:55], v[28:31], a[104:111], v172
    s_branch g_45L8_3
g_45L11_1:
    s_waitcnt vmcnt(2)
    v_max3_u32 v19, v28, v29, v30
    v_max_u32 v19, v19, v31
    v_cmp_eq_u32 vcc, -1, v19
    s_nop 0
    s_cbranch_vccnz g_45F11_1
    v_smfmac_f32_16x16x64_bf16 v[40:43], v[28:31], a[8:15], v172
    v_smfmac_f32_16x16x64_bf16 v[44:47], v[28:31], a[72:79], v172
    v_smfmac_f32_16x16x64_bf16 v[48:51], v[28:31], a[40:47], v172
    v_smfmac_f32_16x16x64_bf16 v[52:55], v[28:31], a[104:111], v172
    s_branch g_45L9_3
g_45L13_0:
    s_waitcnt vmcnt(2)
    v_max3_u32 v19, v24, v25, v26
    v_max_u32 v19, v19, v27
    v_cmp_eq_u32 vcc, -1, v19
    s_nop 0
    s_cbranch_vccnz g_45F13_0
    v_smfmac_f32_16x16x64_bf16 v[40:43], v[24:27], a[0:7], v172
    v_smfmac_f32_16x16x64_bf16 v[44:47], v[24:27], a[64:71], v172
    v_smfmac_f32_16x16x64_bf16 v[48:51], v[24:27], a[32:39], v172
    v_smfmac_f32_16x16x64_bf16 v[52:55], v[24:27], a[96:103], v172
    s_branch g_45L12_2
g_45L13_3:
    s_waitcnt vmcnt(2)
    v_max3_u32 v19, v36, v37, v38
    v_max_u32 v19, v19, v39
    v_cmp_eq_u32 vcc, -1, v19
    s_nop 0
    s_cbranch_vccnz g_45F13_3
    v_smfmac_f32_16x16x64_bf16 v[40:43], v[36:39], a[24:31], v172
    v_smfmac_f32_16x16x64_bf16 v[44:47], v[36:39], a[88:95], v172
    v_smfmac_f32_16x16x64_bf16 v[48:51], v[36:39], a[56:63], v172
    v_smfmac_f32_16x16x64_bf16 v[52:55], v[36:39], a[120:127], v172
g_45L5_0:
    s_waitcnt vmcnt(1)
    v_max3_u32 v19, v24, v25, v26
    v_max_u32 v19, v19, v27
    v_cmp_eq_u32 vcc, -1, v19
    s_nop 0
    s_cbranch_vccnz g_45F5_0
    v_smfmac_f32_16x16x64_bf16 v[40:43], v[24:27], a[0:7], v172
    v_smfmac_f32_16x16x64_bf16 v[44:47], v[24:27], a[64:71], v172
    v_smfmac_f32_16x16x64_bf16 v[48:51], v[24:27], a[32:39], v172
    v_smfmac_f32_16x16x64_bf16 v[52:55], v[24:27], a[96:103], v172
    s_branch g_45L4_2
g_45L14_2:
    s_waitcnt vmcnt(2)
    v_max3_u32 v19, v32, v33, v34
    v_max_u32 v19, v19, v35
    v_cmp_eq_u32 vcc, -1, v19
    s_nop 0
    s_cbranch_vccnz g_45F14_2
    v_smfmac_f32_16x16x64_bf16 v[40:43], v[32:35], a[16:23], v172
    v_smfmac_f32_16x16x64_bf16 v[44:47], v[32:35], a[80:87], v172
    v_smfmac_f32_16x16x64_bf16 v[48:51], v[32:35], a[48:55], v172
    v_smfmac_f32_16x16x64_bf16 v[52:55], v[32:35], a[112:119], v172
g_45L10_3:
    s_waitcnt vmcnt(1)
    v_max3_u32 v19, v36, v37, v38
    v_max_u32 v19, v19, v39
    v_cmp_eq_u32 vcc, -1, v19
    s_nop 0
    s_cbranch_vccnz g_45F10_3
    v_smfmac_f32_16x16x64_bf16 v[40:43], v[36:39], a[24:31], v172
    v_smfmac_f32_16x16x64_bf16 v[44:47], v[36:39], a[88:95], v172
    v_smfmac_f32_16x16x64_bf16 v[48:51], v[36:39], a[56:63], v172
    v_smfmac_f32_16x16x64_bf16 v[52:55], v[36:39], a[120:127], v172
    s_branch g_45L2_1
g_45L14_3:
    s_waitcnt vmcnt(2)
    v_max3_u32 v19, v36, v37, v38
    v_max_u32 v19, v19, v39
    v_cmp_eq_u32 vcc, -1, v19
    s_nop 0
    s_cbranch_vccnz g_45F14_3
    v_smfmac_f32_16x16x64_bf16 v[40:43], v[36:39], a[24:31], v172
    v_smfmac_f32_16x16x64_bf16 v[44:47], v[36:39], a[88:95], v172
    v_smfmac_f32_16x16x64_bf16 v[48:51], v[36:39], a[56:63], v172
    v_smfmac_f32_16x16x64_bf16 v[52:55], v[36:39], a[120:127], v172
    s_branch g_45L6_1
g_45L3_1:
    s_waitcnt vmcnt(1)
    v_max3_u32 v19, v28, v29, v30
    v_max_u32 v19, v19, v31
    v_cmp_eq_u32 vcc, -1, v19
    s_nop 0
    s_cbranch_vccnz g_45F3_1
    v_smfmac_f32_16x16x64_bf16 v[40:43], v[28:31], a[8:15], v172
    v_smfmac_f32_16x16x64_bf16 v[44:47], v[28:31], a[72:79], v172
    v_smfmac_f32_16x16x64_bf16 v[48:51], v[28:31], a[40:47], v172
    v_smfmac_f32_16x16x64_bf16 v[52:55], v[28:31], a[104:111], v172
    s_branch g_45L1_0
g_45L6_2:
    s_waitcnt vmcnt(1)
    v_max3_u32 v19, v32, v33, v34
    v_max_u32 v19, v19, v35
    v_cmp_eq_u32 vcc, -1, v19
    s_nop 0
    s_cbranch_vccnz g_45F6_2
    v_smfmac_f32_16x16x64_bf16 v[40:43], v[32:35], a[16:23], v172
    v_smfmac_f32_16x16x64_bf16 v[44:47], v[32:35], a[80:87], v172
    v_smfmac_f32_16x16x64_bf16 v[48:51], v[32:35], a[48:55], v172
    v_smfmac_f32_16x16x64_bf16 v[52:55], v[32:35], a[112:119], v172
    s_branch g_45L2_1
g_45L9_0:
    s_waitcnt vmcnt(1)
    v_max3_u32 v19, v24, v25, v26
    v_max_u32 v19, v19, v27
    v_cmp_eq_u32 vcc, -1, v19
    s_nop 0
    s_cbranch_vccnz g_45F9_0
    v_smfmac_f32_16x16x64_bf16 v[40:43], v[24:27], a[0:7], v172
    v_smfmac_f32_16x16x64_bf16 v[44:47], v[24:27], a[64:71], v172
    v_smfmac_f32_16x16x64_bf16 v[48:51], v[24:27], a[32:39], v172
    v_smfmac_f32_16x16x64_bf16 v[52:55], v[24:27], a[96:103], v172
    s_branch g_45L8_3
g_45L12_3:
    s_waitcnt vmcnt(1)
    v_max3_u32 v19, v36, v37, v38
    v_max_u32 v19, v19, v39
    v_cmp_eq_u32 vcc, -1, v19
    s_nop 0
    s_cbranch_vccnz g_45F12_3
    v_smfmac_f32_16x16x64_bf16 v[40:43], v[36:39], a[24:31], v172
    v_smfmac_f32_16x16x64_bf16 v[44:47], v[36:39], a[88:95], v172
    v_smfmac_f32_16x16x64_bf16 v[48:51], v[36:39], a[56:63], v172
    v_smfmac_f32_16x16x64_bf16 v[52:55], v[36:39], a[120:127], v172
    s_branch g_45L4_2
g_45F15_0:
    s_mov_b64 exec, vcc
    buffer_load_dwordx4 v[24:27], v2, s[4:7], s16 offen offset:0 sc1
    s_mov_b64 exec, -1
    s_add_u32 s23, s23, 1
    s_cmp_lt_u32 s23, 200000
    s_cbranch_scc1 g_45L15_1
    s_mov_b32 s25, 200000
    s_branch gc_46
g_45F15_1:
    s_mov_b64 exec, vcc
    buffer_load_dwordx4 v[28:31], v2, s[4:7], s16 offen offset:1024 sc1
    s_mov_b64 exec, -1
    s_add_u32 s23, s23, 1
    s_cmp_lt_u32 s23, 200000
    s_cbranch_scc1 g_45L15_2
    s_mov_b32 s25, 200000
    s_branch gc_46
g_45F15_2:
    s_mov_b64 exec, vcc
    buffer_load_dwordx4 v[32:35], v2, s[4:7], s16 offen offset:2048 sc1
    s_mov_b64 exec, -1
    s_add_u32 s23, s23, 1
    s_cmp_lt_u32 s23, 200000
    s_cbranch_scc1 g_45L15_3
    s_mov_b32 s25, 200000
    s_branch gc_46
g_45F15_3:
    s_mov_b64 exec, vcc
    buffer_load_dwordx4 v[36:39], v2, s[4:7], s16 offen offset:3072 sc1
    s_mov_b64 exec, -1
    s_add_u32 s23, s23, 1
    s_cmp_lt_u32 s23, 200000
    s_cbranch_scc1 g_45L15_0
    s_mov_b32 s25, 200000
    s_branch gc_46
g_45F7_0:
    s_mov_b64 exec, vcc
    buffer_load_dwordx4 v[24:27], v2, s[4:7], s16 offen offset:0 sc1
    s_mov_b64 exec, -1
    s_add_u32 s23, s23, 1
    s_cmp_lt_u32 s23, 200000
    s_cbranch_scc1 g_45L7_1
    s_mov_b32 s25, 200000
    s_branch gc_46
g_45F7_1:
    s_mov_b64 exec, vcc
    buffer_load_dwordx4 v[28:31], v2, s[4:7], s16 offen offset:1024 sc1
    s_mov_b64 exec, -1
    s_add_u32 s23, s23, 1
    s_cmp_lt_u32 s23, 200000
    s_cbranch_scc1 g_45L7_2
    s_mov_b32 s25, 200000
    s_branch gc_46
g_45F7_2:
    s_mov_b64 exec, vcc
    buffer_load_dwordx4 v[32:35], v2, s[4:7], s16 offen offset:2048 sc1
    s_mov_b64 exec, -1
    s_add_u32 s23, s23, 1
    s_cmp_lt_u32 s23, 200000
    s_cbranch_scc1 g_45L7_0
    s_mov_b32 s25, 200000
    s_branch gc_46
g_45F11_0:
    s_mov_b64 exec, vcc
    buffer_load_dwordx4 v[24:27], v2, s[4:7], s16 offen offset:0 sc1
    s_mov_b64 exec, -1
    s_add_u32 s23, s23, 1
    s_cmp_lt_u32 s23, 200000
    s_cbranch_scc1 g_45L11_1
    s_mov_b32 s25, 200000
    s_branch gc_46
g_45F11_1:
    s_mov_b64 exec, vcc
    buffer_load_dwordx4 v[28:31], v2, s[4:7], s16 offen offset:1024 sc1
    s_mov_b64 exec, -1
    s_add_u32 s23, s23, 1
    s_cmp_lt_u32 s23, 200000
    s_cbranch_scc1 g_45L11_3
    s_mov_b32 s25, 200000
    s_branch gc_46
g_45F11_3:
    s_mov_b64 exec, vcc
    buffer_load_dwordx4 v[36:39], v2, s[4:7], s16 offen offset:3072 sc1
    s_mov_b64 exec, -1
    s_add_u32 s23, s23, 1
    s_cmp_lt_u32 s23, 200000
    s_cbranch_scc1 g_45L11_0
    s_mov_b32 s25, 200000
    s_branch gc_46
g_45F13_0:
    s_mov_b64 exec, vcc
    buffer_load_dwordx4 v[24:27], v2, s[4:7], s16 offen offset:0 sc1
    s_mov_b64 exec, -1
    s_add_u32 s23, s23, 1
    s_cmp_lt_u32 s23, 200000
    s_cbranch_scc1 g_45L13_2
    s_mov_b32 s25, 200000
    s_branch gc_46
g_45F13_2:
    s_mov_b64 exec, vcc
    buffer_load_dwordx4 v[32:35], v2, s[4:7], s16 offen offset:2048 sc1
    s_mov_b64 exec, -1
    s_add_u32 s23, s23, 1
    s_cmp_lt_u32 s23, 200000
    s_cbranch_scc1 g_45L13_3
    s_mov_b32 s25, 200000
    s_branch gc_46
g_45F13_3:
    s_mov_b64 exec, vcc
    buffer_load_dwordx4 v[36:39], v2, s[4:7], s16 offen offset:3072 sc1
    s_mov_b64 exec, -1
    s_add_u32 s23, s23, 1
    s_cmp_lt_u32 s23, 200000
    s_cbranch_scc1 g_45L13_0
    s_mov_b32 s25, 200000
    s_branch gc_46
g_45F14_1:
    s_mov_b64 exec, vcc
    buffer_load_dwordx4 v[28:31], v2, s[4:7], s16 offen offset:1024 sc1
    s_mov_b64 exec, -1
    s_add_u32 s23, s23, 1
    s_cmp_lt_u32 s23, 200000
    s_cbranch_scc1 g_45L14_2
    s_mov_b32 s25, 200000
    s_branch gc_46
g_45F14_2:
    s_mov_b64 exec, vcc
    buffer_load_dwordx4 v[32:35], v2, s[4:7], s16 offen offset:2048 sc1
    s_mov_b64 exec, -1
    s_add_u32 s23, s23, 1
    s_cmp_lt_u32 s23, 200000
    s_cbranch_scc1 g_45L14_3
    s_mov_b32 s25, 200000
    s_branch gc_46
g_45F14_3:
    s_mov_b64 exec, vcc
    buffer_load_dwordx4 v[36:39], v2, s[4:7], s16 offen offset:3072 sc1
    s_mov_b64 exec, -1
    s_add_u32 s23, s23, 1
    s_cmp_lt_u32 s23, 200000
    s_cbranch_scc1 g_45L14_1
    s_mov_b32 s25, 200000
    s_branch gc_46
g_45F3_0:
    s_mov_b64 exec, vcc
    buffer_load_dwordx4 v[24:27], v2, s[4:7], s16 offen offset:0 sc1
    s_mov_b64 exec, -1
    s_add_u32 s23, s23, 1
    s_cmp_lt_u32 s23, 200000
    s_cbranch_scc1 g_45L3_1
    s_mov_b32 s25, 200000
    s_branch gc_46
g_45F3_1:
    s_mov_b64 exec, vcc
    buffer_load_dwordx4 v[28:31], v2, s[4:7], s16 offen offset:1024 sc1
    s_mov_b64 exec, -1
    s_add_u32 s23, s23, 1
    s_cmp_lt_u32 s23, 200000
    s_cbranch_scc1 g_45L3_0
    s_mov_b32 s25, 200000
    s_branch gc_46
g_45F5_0:
    s_mov_b64 exec, vcc
    buffer_load_dwordx4 v[24:27], v2, s[4:7], s16 offen offset:0 sc1
    s_mov_b64 exec, -1
    s_add_u32 s23, s23, 1
    s_cmp_lt_u32 s23, 200000
    s_cbranch_scc1 g_45L5_2
    s_mov_b32 s25, 200000
    s_branch gc_46
g_45F5_2:
    s_mov_b64 exec, vcc
    buffer_load_dwordx4 v[32:35], v2, s[4:7], s16 offen offset:2048 sc1
    s_mov_b64 exec, -1
    s_add_u32 s23, s23, 1
    s_cmp_lt_u32 s23, 200000
    s_cbranch_scc1 g_45L5_0
    s_mov_b32 s25, 200000
    s_branch gc_46
g_45F6_1:
    s_mov_b64 exec, vcc
    buffer_load_dwordx4 v[28:31], v2, s[4:7], s16 offen offset:1024 sc1
    s_mov_b64 exec, -1
    s_add_u32 s23, s23, 1
    s_cmp_lt_u32 s23, 200000
    s_cbranch_scc1 g_45L6_2
    s_mov_b32 s25, 200000
    s_branch gc_46
g_45F6_2:
    s_mov_b64 exec, vcc
    buffer_load_dwordx4 v[32:35], v2, s[4:7], s16 offen offset:2048 sc1
    s_mov_b64 exec, -1
    s_add_u32 s23, s23, 1
    s_cmp_lt_u32 s23, 200000
    s_cbranch_scc1 g_45L6_1
    s_mov_b32 s25, 200000
    s_branch gc_46
g_45F9_0:
    s_mov_b64 exec, vcc
    buffer_load_dwordx4 v[24:27], v2, s[4:7], s16 offen offset:0 sc1
    s_mov_b64 exec, -1
    s_add_u32 s23, s23, 1
    s_cmp_lt_u32 s23, 200000
    s_cbranch_scc1 g_45L9_3
    s_mov_b32 s25, 200000
    s_branch gc_46
g_45F9_3:
    s_mov_b64 exec, vcc
    buffer_load_dwordx4 v[36:39], v2, s[4:7], s16 offen offset:3072 sc1
    s_mov_b64 exec, -1
    s_add_u32 s23, s23, 1
    s_cmp_lt_u32 s23, 200000
    s_cbranch_scc1 g_45L9_0
    s_mov_b32 s25, 200000
    s_branch gc_46
g_45F10_1:
    s_mov_b64 exec, vcc
    buffer_load_dwordx4 v[28:31], v2, s[4:7], s16 offen offset:1024 sc1
    s_mov_b64 exec, -1
    s_add_u32 s23, s23, 1
    s_cmp_lt_u32 s23, 200000
    s_cbranch_scc1 g_45L10_3
    s_mov_b32 s25, 200000
    s_branch gc_46
g_45F10_3:
    s_mov_b64 exec, vcc
    buffer_load_dwordx4 v[36:39], v2, s[4:7], s16 offen offset:3072 sc1
    s_mov_b64 exec, -1
    s_add_u32 s23, s23, 1
    s_cmp_lt_u32 s23, 200000
    s_cbranch_scc1 g_45L10_1
    s_mov_b32 s25, 200000
    s_branch gc_46
g_45F12_2:
    s_mov_b64 exec, vcc
    buffer_load_dwordx4 v[32:35], v2, s[4:7], s16 offen offset:2048 sc1
    s_mov_b64 exec, -1
    s_add_u32 s23, s23, 1
    s_cmp_lt_u32 s23, 200000
    s_cbranch_scc1 g_45L12_3
    s_mov_b32 s25, 200000
    s_branch gc_46
g_45F12_3:
    s_mov_b64 exec, vcc
    buffer_load_dwordx4 v[36:39], v2, s[4:7], s16 offen offset:3072 sc1
    s_mov_b64 exec, -1
    s_add_u32 s23, s23, 1
    s_cmp_lt_u32 s23, 200000
    s_cbranch_scc1 g_45L12_2
    s_mov_b32 s25, 200000
    s_branch gc_46
g_45F1_0:
    s_mov_b64 exec, vcc
    buffer_load_dwordx4 v[24:27], v2, s[4:7], s16 offen offset:0 sc1
    s_mov_b64 exec, -1
    s_add_u32 s23, s23, 1
    s_cmp_lt_u32 s23, 200000
    s_cbranch_scc1 g_45L1_0
    s_mov_b32 s25, 200000
    s_branch gc_46
g_45F2_1:
    s_mov_b64 exec, vcc
    buffer_load_dwordx4 v[28:31], v2, s[4:7], s16 offen offset:1024 sc1
    s_mov_b64 exec, -1
    s_add_u32 s23, s23, 1
    s_cmp_lt_u32 s23, 200000
    s_cbranch_scc1 g_45L2_1
    s_mov_b32 s25, 200000
    s_branch gc_46
g_45F4_2:
    s_mov_b64 exec, vcc
    buffer_load_dwordx4 v[32:35], v2, s[4:7], s16 offen offset:2048 sc1
    s_mov_b64 exec, -1
    s_add_u32 s23, s23, 1
    s_cmp_lt_u32 s23, 200000
    s_cbranch_scc1 g_45L4_2
    s_mov_b32 s25, 200000
    s_branch gc_46
g_45F8_3:
    s_mov_b64 exec, vcc
    buffer_load_dwordx4 v[36:39], v2, s[4:7], s16 offen offset:3072 sc1
    s_mov_b64 exec, -1
    s_add_u32 s23, s23, 1
    s_cmp_lt_u32 s23, 200000
    s_cbranch_scc1 g_45L8_3
    s_mov_b32 s25, 200000
    s_branch gc_46
recur_fast_last2:
    buffer_store_dwordx4 v[168:171], v15, s[4:7], s20 offen sc1
    s_waitcnt vmcnt(0)
    s_branch recur_end
g_47L15_0:
    s_waitcnt vmcnt(3)
    v_max3_u32 v19, v24, v25, v26
    v_max_u32 v19, v19, v27
    v_cmp_eq_u32 vcc, -1, v19
    s_nop 0
    s_cbranch_vccnz g_47F15_0
    v_smfmac_f32_16x16x64_bf16 v[64:67], v[24:27], a[192:199], v172
    v_smfmac_f32_16x16x64_bf16 v[68:71], v[24:27], a[224:231], v172
g_47L14_1:
    s_waitcnt vmcnt(2)
    v_max3_u32 v19, v28, v29, v30
    v_max_u32 v19, v19, v31
    v_cmp_eq_u32 vcc, -1, v19
    s_nop 0
    s_cbranch_vccnz g_47F14_1
    v_smfmac_f32_16x16x64_bf16 v[64:67], v[28:31], a[200:207], v172
    v_smfmac_f32_16x16x64_bf16 v[68:71], v[28:31], a[232:239], v172
g_47L12_2:
    s_waitcnt vmcnt(1)
    v_max3_u32 v19, v32, v33, v34
    v_max_u32 v19, v19, v35
    v_cmp_eq_u32 vcc, -1, v19
    s_nop 0
    s_cbranch_vccnz g_47F12_2
    v_smfmac_f32_16x16x64_bf16 v[64:67], v[32:35], a[208:215], v172
    v_smfmac_f32_16x16x64_bf16 v[68:71], v[32:35], a[240:247], v172
g_47L8_3:
    s_waitcnt vmcnt(0)
    v_max3_u32 v19, v36, v37, v38
    v_max_u32 v19, v19, v39
    v_cmp_eq_u32 vcc, -1, v19
    s_nop 0
    s_cbranch_vccnz g_47F8_3
    v_smfmac_f32_16x16x64_bf16 v[64:67], v[36:39], a[216:223], v172
    v_smfmac_f32_16x16x64_bf16 v[68:71], v[36:39], a[248:255], v172
    s_nop 4
    v_cvt_pk_bf16_f32 v80, v64, v65
    v_cvt_pk_bf16_f32 v81, v66, v67
    s_nop 0
    v_cvt_pk_bf16_f32 v82, v68, v69
    v_cvt_pk_bf16_f32 v83, v70, v71
    ds_write_b128 v17, v[80:83] offset:9216
    s_branch gc_48
g_47L15_1:
    s_waitcnt vmcnt(3)
    v_max3_u32 v19, v28, v29, v30
    v_max_u32 v19, v19, v31
    v_cmp_eq_u32 vcc, -1, v19
    s_nop 0
    s_cbranch_vccnz g_47F15_1
    v_smfmac_f32_16x16x64_bf16 v[64:67], v[28:31], a[200:207], v172
    v_smfmac_f32_16x16x64_bf16 v[68:71], v[28:31], a[232:239], v172
g_47L13_2:
    s_waitcnt vmcnt(2)
    v_max3_u32 v19, v32, v33, v34
    v_max_u32 v19, v19, v35
    v_cmp_eq_u32 vcc, -1, v19
    s_nop 0
    s_cbranch_vccnz g_47F13_2
    v_smfmac_f32_16x16x64_bf16 v[64:67], v[32:35], a[208:215], v172
    v_smfmac_f32_16x16x64_bf16 v[68:71], v[32:35], a[240:247], v172
g_47L9_3:
    s_waitcnt vmcnt(1)
    v_max3_u32 v19, v36, v37, v38
    v_max_u32 v19, v19, v39
    v_cmp_eq_u32 vcc, -1, v19
    s_nop 0
    s_cbranch_vccnz g_47F9_3
    v_smfmac_f32_16x16x64_bf16 v[64:67], v[36:39], a[216:223], v172
    v_smfmac_f32_16x16x64_bf16 v[68:71], v[36:39], a[248:255], v172
g_47L1_0:
    s_waitcnt vmcnt(0)
    v_max3_u32 v19, v24, v25, v26
    v_max_u32 v19, v19, v27
    v_cmp_eq_u32 vcc, -1, v19
    s_nop 0
    s_cbranch_vccnz g_47F1_0
    v_smfmac_f32_16x16x64_bf16 v[64:67], v[24:27], a[192:199], v172
    v_smfmac_f32_16x16x64_bf16 v[68:71], v[24:27], a[224:231], v172
    s_nop 4
    v_cvt_pk_bf16_f32 v80, v64, v65
    v_cvt_pk_bf16_f32 v81, v66, v67
    s_nop 0
    v_cvt_pk_bf16_f32 v82, v68, v69
    v_cvt_pk_bf16_f32 v83, v70, v71
    ds_write_b128 v17, v[80:83] offset:9216
    s_branch gc_48
g_47L15_2:
    s_waitcnt vmcnt(3)
    v_max3_u32 v19, v32, v33, v34
    v_max_u32 v19, v19, v35
    v_cmp_eq_u32 vcc, -1, v19
    s_nop 0
    s_cbranch_vccnz g_47F15_2
    v_smfmac_f32_16x16x64_bf16 v[64:67], v[32:35], a[208:215], v172
    v_smfmac_f32_16x16x64_bf16 v[68:71], v[32:35], a[240:247], v172
g_47L11_3:
    s_waitcnt vmcnt(2)
    v_max3_u32 v19, v36, v37, v38
    v_max_u32 v19, v19, v39
    v_cmp_eq_u32 vcc, -1, v19
    s_nop 0
    s_cbranch_vccnz g_47F11_3
    v_smfmac_f32_16x16x64_bf16 v[64:67], v[36:39], a[216:223], v172
    v_smfmac_f32_16x16x64_bf16 v[68:71], v[36:39], a[248:255], v172
g_47L3_0:
    s_waitcnt vmcnt(1)
    v_max3_u32 v19, v24, v25, v26
    v_max_u32 v19, v19, v27
    v_cmp_eq_u32 vcc, -1, v19
    s_nop 0
    s_cbranch_vccnz g_47F3_0
    v_smfmac_f32_16x16x64_bf16 v[64:67], v[24:27], a[192:199], v172
    v_smfmac_f32_16x16x64_bf16 v[68:71], v[24:27], a[224:231], v172
g_47L2_1:
    s_waitcnt vmcnt(0)
    v_max3_u32 v19, v28, v29, v30
    v_max_u32 v19, v19, v31
    v_cmp_eq_u32 vcc, -1, v19
    s_nop 0
    s_cbranch_vccnz g_47F2_1
    v_smfmac_f32_16x16x64_bf16 v[64:67], v[28:31], a[200:207], v172
    v_smfmac_f32_16x16x64_bf16 v[68:71], v[28:31], a[232:239], v172
    s_nop 4
    v_cvt_pk_bf16_f32 v80, v64, v65
    v_cvt_pk_bf16_f32 v81, v66, v67
    s_nop 0
    v_cvt_pk_bf16_f32 v82, v68, v69
    v_cvt_pk_bf16_f32 v83, v70, v71
    ds_write_b128 v17, v[80:83] offset:9216
    s_branch gc_48
g_47L15_3:
    s_waitcnt vmcnt(3)
    v_max3_u32 v19, v36, v37, v38
    v_max_u32 v19, v19, v39
    v_cmp_eq_u32 vcc, -1, v19
    s_nop 0
    s_cbranch_vccnz g_47F15_3
    v_smfmac_f32_16x16x64_bf16 v[64:67], v[36:39], a[216:223], v172
    v_smfmac_f32_16x16x64_bf16 v[68:71], v[36:39], a[248:255], v172
g_47L7_0:
    s_waitcnt vmcnt(2)
    v_max3_u32 v19, v24, v25, v26
    v_max_u32 v19, v19, v27
    v_cmp_eq_u32 vcc, -1, v19
    s_nop 0
    s_cbranch_vccnz g_47F7_0
    v_smfmac_f32_16x16x64_bf16 v[64:67], v[24:27], a[192:199], v172
    v_smfmac_f32_16x16x64_bf16 v[68:71], v[24:27], a[224:231], v172
g_47L6_1:
    s_waitcnt vmcnt(1)
    v_max3_u32 v19, v28, v29, v30
    v_max_u32 v19, v19, v31
    v_cmp_eq_u32 vcc, -1, v19
    s_nop 0
    s_cbranch_vccnz g_47F6_1
    v_smfmac_f32_16x16x64_bf16 v[64:67], v[28:31], a[200:207], v172
    v_smfmac_f32_16x16x64_bf16 v[68:71], v[28:31], a[232:239], v172
g_47L4_2:
    s_waitcnt vmcnt(0)
    v_max3_u32 v19, v32, v33, v34
    v_max_u32 v19, v19, v35
    v_cmp_eq_u32 vcc, -1, v19
    s_nop 0
    s_cbranch_vccnz g_47F4_2
    v_smfmac_f32_16x16x64_bf16 v[64:67], v[32:35], a[208:215], v172
    v_smfmac_f32_16x16x64_bf16 v[68:71], v[32:35], a[240:247], v172
    s_nop 4
    v_cvt_pk_bf16_f32 v80, v64, v65
    v_cvt_pk_bf16_f32 v81, v66, v67
    s_nop 0
    v_cvt_pk_bf16_f32 v82, v68, v69
    v_cvt_pk_bf16_f32 v83, v70, v71
    ds_write_b128 v17, v[80:83] offset:9216
    s_branch gc_48
g_47L7_1:
    s_waitcnt vmcnt(2)
    v_max3_u32 v19, v28, v29, v30
    v_max_u32 v19, v19, v31
    v_cmp_eq_u32 vcc, -1, v19
    s_nop 0
    s_cbranch_vccnz g_47F7_1
    v_smfmac_f32_16x16x64_bf16 v[64:67], v[28:31], a[200:207], v172
    v_smfmac_f32_16x16x64_bf16 v[68:71], v[28:31], a[232:239], v172
g_47L5_2:
    s_waitcnt vmcnt(1)
    v_max3_u32 v19, v32, v33, v34
    v_max_u32 v19, v19, v35
    v_cmp_eq_u32 vcc, -1, v19
    s_nop 0
    s_cbranch_vccnz g_47F5_2
    v_smfmac_f32_16x16x64_bf16 v[64:67], v[32:35], a[208:215], v172
    v_smfmac_f32_16x16x64_bf16 v[68:71], v[32:35], a[240:247], v172
    s_branch g_47L1_0
g_47L7_2:
    s_waitcnt vmcnt(2)
    v_max3_u32 v19, v32, v33, v34
    v_max_u32 v19, v19, v35
    v_cmp_eq_u32 vcc, -1, v19
    s_nop 0
    s_cbranch_vccnz g_47F7_2
    v_smfmac_f32_16x16x64_bf16 v[64:67], v[32:35], a[208:215], v172
    v_smfmac_f32_16x16x64_bf16 v[68:71], v[32:35], a[240:247], v172
    s_branch g_47L3_0
g_47L11_0:
    s_waitcnt vmcnt(2)
    v_max3_u32 v19, v24, v25, v26
    v_max_u32 v19, v19, v27
    v_cmp_eq_u32 vcc, -1, v19
    s_nop 0
    s_cbranch_vccnz g_47F11_0
    v_smfmac_f32_16x16x64_bf16 v[64:67], v[24:27], a[192:199], v172
    v_smfmac_f32_16x16x64_bf16 v[68:71], v[24:27], a[224:231], v172
g_47L10_1:
    s_waitcnt vmcnt(1)
    v_max3_u32 v19, v28, v29, v30
    v_max_u32 v19, v19, v31
    v_cmp_eq_u32 vcc, -1, v19
    s_nop 0
    s_cbranch_vccnz g_47F10_1
    v_smfmac_f32_16x16x64_bf16 v[64:67], v[28:31], a[200:207], v172
    v_smfmac_f32_16x16x64_bf16 v[68:71], v[28:31], a[232:239], v172
    s_branch g_47L8_3
g_47L11_1:
    s_waitcnt vmcnt(2)
    v_max3_u32 v19, v28, v29, v30
    v_max_u32 v19, v19, v31
    v_cmp_eq_u32 vcc, -1, v19
    s_nop 0
    s_cbranch_vccnz g_47F11_1
    v_smfmac_f32_16x16x64_bf16 v[64:67], v[28:31], a[200:207], v172
    v_smfmac_f32_16x16x64_bf16 v[68:71], v[28:31], a[232:239], v172
    s_branch g_47L9_3
g_47L13_0:
    s_waitcnt vmcnt(2)
    v_max3_u32 v19, v24, v25, v26
    v_max_u32 v19, v19, v27
    v_cmp_eq_u32 vcc, -1, v19
    s_nop 0
    s_cbranch_vccnz g_47F13_0
    v_smfmac_f32_16x16x64_bf16 v[64:67], v[24:27], a[192:199], v172
    v_smfmac_f32_16x16x64_bf16 v[68:71], v[24:27], a[224:231], v172
    s_branch g_47L12_2
g_47L13_3:
    s_waitcnt vmcnt(2)
    v_max3_u32 v19, v36, v37, v38
    v_max_u32 v19, v19, v39
    v_cmp_eq_u32 vcc, -1, v19
    s_nop 0
    s_cbranch_vccnz g_47F13_3
    v_smfmac_f32_16x16x64_bf16 v[64:67], v[36:39], a[216:223], v172
    v_smfmac_f32_16x16x64_bf16 v[68:71], v[36:39], a[248:255], v172
g_47L5_0:
    s_waitcnt vmcnt(1)
    v_max3_u32 v19, v24, v25, v26
    v_max_u32 v19, v19, v27
    v_cmp_eq_u32 vcc, -1, v19
    s_nop 0
    s_cbranch_vccnz g_47F5_0
    v_smfmac_f32_16x16x64_bf16 v[64:67], v[24:27], a[192:199], v172
    v_smfmac_f32_16x16x64_bf16 v[68:71], v[24:27], a[224:231], v172
    s_branch g_47L4_2
g_47L14_2:
    s_waitcnt vmcnt(2)
    v_max3_u32 v19, v32, v33, v34
    v_max_u32 v19, v19, v35
    v_cmp_eq_u32 vcc, -1, v19
    s_nop 0
    s_cbranch_vccnz g_47F14_2
    v_smfmac_f32_16x16x64_bf16 v[64:67], v[32:35], a[208:215], v172
    v_smfmac_f32_16x16x64_bf16 v[68:71], v[32:35], a[240:247], v172
g_47L10_3:
    s_waitcnt vmcnt(1)
    v_max3_u32 v19, v36, v37, v38
    v_max_u32 v19, v19, v39
    v_cmp_eq_u32 vcc, -1, v19
    s_nop 0
    s_cbranch_vccnz g_47F10_3
    v_smfmac_f32_16x16x64_bf16 v[64:67], v[36:39], a[216:223], v172
    v_smfmac_f32_16x16x64_bf16 v[68:71], v[36:39], a[248:255], v172
    s_branch g_47L2_1
g_47L14_3:
    s_waitcnt vmcnt(2)
    v_max3_u32 v19, v36, v37, v38
    v_max_u32 v19, v19, v39
    v_cmp_eq_u32 vcc, -1, v19
    s_nop 0
    s_cbranch_vccnz g_47F14_3
    v_smfmac_f32_16x16x64_bf16 v[64:67], v[36:39], a[216:223], v172
    v_smfmac_f32_16x16x64_bf16 v[68:71], v[36:39], a[248:255], v172
    s_branch g_47L6_1
g_47L3_1:
    s_waitcnt vmcnt(1)
    v_max3_u32 v19, v28, v29, v30
    v_max_u32 v19, v19, v31
    v_cmp_eq_u32 vcc, -1, v19
    s_nop 0
    s_cbranch_vccnz g_47F3_1
    v_smfmac_f32_16x16x64_bf16 v[64:67], v[28:31], a[200:207], v172
    v_smfmac_f32_16x16x64_bf16 v[68:71], v[28:31], a[232:239], v172
    s_branch g_47L1_0
g_47L6_2:
    s_waitcnt vmcnt(1)
    v_max3_u32 v19, v32, v33, v34
    v_max_u32 v19, v19, v35
    v_cmp_eq_u32 vcc, -1, v19
    s_nop 0
    s_cbranch_vccnz g_47F6_2
    v_smfmac_f32_16x16x64_bf16 v[64:67], v[32:35], a[208:215], v172
    v_smfmac_f32_16x16x64_bf16 v[68:71], v[32:35], a[240:247], v172
    s_branch g_47L2_1
g_47L9_0:
    s_waitcnt vmcnt(1)
    v_max3_u32 v19, v24, v25, v26
    v_max_u32 v19, v19, v27
    v_cmp_eq_u32 vcc, -1, v19
    s_nop 0
    s_cbranch_vccnz g_47F9_0
    v_smfmac_f32_16x16x64_bf16 v[64:67], v[24:27], a[192:199], v172
    v_smfmac_f32_16x16x64_bf16 v[68:71], v[24:27], a[224:231], v172
    s_branch g_47L8_3
g_47L12_3:
    s_waitcnt vmcnt(1)
    v_max3_u32 v19, v36, v37, v38
    v_max_u32 v19, v19, v39
    v_cmp_eq_u32 vcc, -1, v19
    s_nop 0
    s_cbranch_vccnz g_47F12_3
    v_smfmac_f32_16x16x64_bf16 v[64:67], v[36:39], a[216:223], v172
    v_smfmac_f32_16x16x64_bf16 v[68:71], v[36:39], a[248:255], v172
    s_branch g_47L4_2
g_47F15_0:
    s_mov_b64 exec, vcc
    buffer_load_dwordx4 v[24:27], v8, s[4:7], s16 offen offset:0 sc1
    s_mov_b64 exec, -1
    s_add_u32 s23, s23, 1
    s_cmp_lt_u32 s23, 200000
    s_cbranch_scc1 g_47L15_1
    s_mov_b32 s25, 200000
    s_branch gc_48
g_47F15_1:
    s_mov_b64 exec, vcc
    buffer_load_dwordx4 v[28:31], v8, s[4:7], s16 offen offset:1024 sc1
    s_mov_b64 exec, -1
    s_add_u32 s23, s23, 1
    s_cmp_lt_u32 s23, 200000
    s_cbranch_scc1 g_47L15_2
    s_mov_b32 s25, 200000
    s_branch gc_48
g_47F15_2:
    s_mov_b64 exec, vcc
    buffer_load_dwordx4 v[32:35], v8, s[4:7], s16 offen offset:2048 sc1
    s_mov_b64 exec, -1
    s_add_u32 s23, s23, 1
    s_cmp_lt_u32 s23, 200000
    s_cbranch_scc1 g_47L15_3
    s_mov_b32 s25, 200000
    s_branch gc_48
g_47F15_3:
    s_mov_b64 exec, vcc
    buffer_load_dwordx4 v[36:39], v8, s[4:7], s16 offen offset:3072 sc1
    s_mov_b64 exec, -1
    s_add_u32 s23, s23, 1
    s_cmp_lt_u32 s23, 200000
    s_cbranch_scc1 g_47L15_0
    s_mov_b32 s25, 200000
    s_branch gc_48
g_47F7_0:
    s_mov_b64 exec, vcc
    buffer_load_dwordx4 v[24:27], v8, s[4:7], s16 offen offset:0 sc1
    s_mov_b64 exec, -1
    s_add_u32 s23, s23, 1
    s_cmp_lt_u32 s23, 200000
    s_cbranch_scc1 g_47L7_1
    s_mov_b32 s25, 200000
    s_branch gc_48
g_47F7_1:
    s_mov_b64 exec, vcc
    buffer_load_dwordx4 v[28:31], v8, s[4:7], s16 offen offset:1024 sc1
    s_mov_b64 exec, -1
    s_add_u32 s23, s23, 1
    s_cmp_lt_u32 s23, 200000
    s_cbranch_scc1 g_47L7_2
    s_mov_b32 s25, 200000
    s_branch gc_48
g_47F7_2:
    s_mov_b64 exec, vcc
    buffer_load_dwordx4 v[32:35], v8, s[4:7], s16 offen offset:2048 sc1
    s_mov_b64 exec, -1
    s_add_u32 s23, s23, 1
    s_cmp_lt_u32 s23, 200000
    s_cbranch_scc1 g_47L7_0
    s_mov_b32 s25, 200000
    s_branch gc_48
g_47F11_0:
    s_mov_b64 exec, vcc
    buffer_load_dwordx4 v[24:27], v8, s[4:7], s16 offen offset:0 sc1
    s_mov_b64 exec, -1
    s_add_u32 s23, s23, 1
    s_cmp_lt_u32 s23, 200000
    s_cbranch_scc1 g_47L11_1
    s_mov_b32 s25, 200000
    s_branch gc_48
g_47F11_1:
    s_mov_b64 exec, vcc
    buffer_load_dwordx4 v[28:31], v8, s[4:7], s16 offen offset:1024 sc1
    s_mov_b64 exec, -1
    s_add_u32 s23, s23, 1
    s_cmp_lt_u32 s23, 200000
    s_cbranch_scc1 g_47L11_3
    s_mov_b32 s25, 200000
    s_branch gc_48
g_47F11_3:
    s_mov_b64 exec, vcc
    buffer_load_dwordx4 v[36:39], v8, s[4:7], s16 offen offset:3072 sc1
    s_mov_b64 exec, -1
    s_add_u32 s23, s23, 1
    s_cmp_lt_u32 s23, 200000
    s_cbranch_scc1 g_47L11_0
    s_mov_b32 s25, 200000
    s_branch gc_48
g_47F13_0:
    s_mov_b64 exec, vcc
    buffer_load_dwordx4 v[24:27], v8, s[4:7], s16 offen offset:0 sc1
    s_mov_b64 exec, -1
    s_add_u32 s23, s23, 1
    s_cmp_lt_u32 s23, 200000
    s_cbranch_scc1 g_47L13_2
    s_mov_b32 s25, 200000
    s_branch gc_48
g_47F13_2:
    s_mov_b64 exec, vcc
    buffer_load_dwordx4 v[32:35], v8, s[4:7], s16 offen offset:2048 sc1
    s_mov_b64 exec, -1
    s_add_u32 s23, s23, 1
    s_cmp_lt_u32 s23, 200000
    s_cbranch_scc1 g_47L13_3
    s_mov_b32 s25, 200000
    s_branch gc_48
g_47F13_3:
    s_mov_b64 exec, vcc
    buffer_load_dwordx4 v[36:39], v8, s[4:7], s16 offen offset:3072 sc1
    s_mov_b64 exec, -1
    s_add_u32 s23, s23, 1
    s_cmp_lt_u32 s23, 200000
    s_cbranch_scc1 g_47L13_0
    s_mov_b32 s25, 200000
    s_branch gc_48
g_47F14_1:
    s_mov_b64 exec, vcc
    buffer_load_dwordx4 v[28:31], v8, s[4:7], s16 offen offset:1024 sc1
    s_mov_b64 exec, -1
    s_add_u32 s23, s23, 1
    s_cmp_lt_u32 s23, 200000
    s_cbranch_scc1 g_47L14_2
    s_mov_b32 s25, 200000
    s_branch gc_48
g_47F14_2:
    s_mov_b64 exec, vcc
    buffer_load_dwordx4 v[32:35], v8, s[4:7], s16 offen offset:2048 sc1
    s_mov_b64 exec, -1
    s_add_u32 s23, s23, 1
    s_cmp_lt_u32 s23, 200000
    s_cbranch_scc1 g_47L14_3
    s_mov_b32 s25, 200000
    s_branch gc_48
g_47F14_3:
    s_mov_b64 exec, vcc
    buffer_load_dwordx4 v[36:39], v8, s[4:7], s16 offen offset:3072 sc1
    s_mov_b64 exec, -1
    s_add_u32 s23, s23, 1
    s_cmp_lt_u32 s23, 200000
    s_cbranch_scc1 g_47L14_1
    s_mov_b32 s25, 200000
    s_branch gc_48
g_47F3_0:
    s_mov_b64 exec, vcc
    buffer_load_dwordx4 v[24:27], v8, s[4:7], s16 offen offset:0 sc1
    s_mov_b64 exec, -1
    s_add_u32 s23, s23, 1
    s_cmp_lt_u32 s23, 200000
    s_cbranch_scc1 g_47L3_1
    s_mov_b32 s25, 200000
    s_branch gc_48
g_47F3_1:
    s_mov_b64 exec, vcc
    buffer_load_dwordx4 v[28:31], v8, s[4:7], s16 offen offset:1024 sc1
    s_mov_b64 exec, -1
    s_add_u32 s23, s23, 1
    s_cmp_lt_u32 s23, 200000
    s_cbranch_scc1 g_47L3_0
    s_mov_b32 s25, 200000
    s_branch gc_48
g_47F5_0:
    s_mov_b64 exec, vcc
    buffer_load_dwordx4 v[24:27], v8, s[4:7], s16 offen offset:0 sc1
    s_mov_b64 exec, -1
    s_add_u32 s23, s23, 1
    s_cmp_lt_u32 s23, 200000
    s_cbranch_scc1 g_47L5_2
    s_mov_b32 s25, 200000
    s_branch gc_48
g_47F5_2:
    s_mov_b64 exec, vcc
    buffer_load_dwordx4 v[32:35], v8, s[4:7], s16 offen offset:2048 sc1
    s_mov_b64 exec, -1
    s_add_u32 s23, s23, 1
    s_cmp_lt_u32 s23, 200000
    s_cbranch_scc1 g_47L5_0
    s_mov_b32 s25, 200000
    s_branch gc_48
g_47F6_1:
    s_mov_b64 exec, vcc
    buffer_load_dwordx4 v[28:31], v8, s[4:7], s16 offen offset:1024 sc1
    s_mov_b64 exec, -1
    s_add_u32 s23, s23, 1
    s_cmp_lt_u32 s23, 200000
    s_cbranch_scc1 g_47L6_2
    s_mov_b32 s25, 200000
    s_branch gc_48
g_47F6_2:
    s_mov_b64 exec, vcc
    buffer_load_dwordx4 v[32:35], v8, s[4:7], s16 offen offset:2048 sc1
    s_mov_b64 exec, -1
    s_add_u32 s23, s23, 1
    s_cmp_lt_u32 s23, 200000
    s_cbranch_scc1 g_47L6_1
    s_mov_b32 s25, 200000
    s_branch gc_48
g_47F9_0:
    s_mov_b64 exec, vcc
    buffer_load_dwordx4 v[24:27], v8, s[4:7], s16 offen offset:0 sc1
    s_mov_b64 exec, -1
    s_add_u32 s23, s23, 1
    s_cmp_lt_u32 s23, 200000
    s_cbranch_scc1 g_47L9_3
    s_mov_b32 s25, 200000
    s_branch gc_48
g_47F9_3:
    s_mov_b64 exec, vcc
    buffer_load_dwordx4 v[36:39], v8, s[4:7], s16 offen offset:3072 sc1
    s_mov_b64 exec, -1
    s_add_u32 s23, s23, 1
    s_cmp_lt_u32 s23, 200000
    s_cbranch_scc1 g_47L9_0
    s_mov_b32 s25, 200000
    s_branch gc_48
g_47F10_1:
    s_mov_b64 exec, vcc
    buffer_load_dwordx4 v[28:31], v8, s[4:7], s16 offen offset:1024 sc1
    s_mov_b64 exec, -1
    s_add_u32 s23, s23, 1
    s_cmp_lt_u32 s23, 200000
    s_cbranch_scc1 g_47L10_3
    s_mov_b32 s25, 200000
    s_branch gc_48
g_47F10_3:
    s_mov_b64 exec, vcc
    buffer_load_dwordx4 v[36:39], v8, s[4:7], s16 offen offset:3072 sc1
    s_mov_b64 exec, -1
    s_add_u32 s23, s23, 1
    s_cmp_lt_u32 s23, 200000
    s_cbranch_scc1 g_47L10_1
    s_mov_b32 s25, 200000
    s_branch gc_48
g_47F12_2:
    s_mov_b64 exec, vcc
    buffer_load_dwordx4 v[32:35], v8, s[4:7], s16 offen offset:2048 sc1
    s_mov_b64 exec, -1
    s_add_u32 s23, s23, 1
    s_cmp_lt_u32 s23, 200000
    s_cbranch_scc1 g_47L12_3
    s_mov_b32 s25, 200000
    s_branch gc_48
g_47F12_3:
    s_mov_b64 exec, vcc
    buffer_load_dwordx4 v[36:39], v8, s[4:7], s16 offen offset:3072 sc1
    s_mov_b64 exec, -1
    s_add_u32 s23, s23, 1
    s_cmp_lt_u32 s23, 200000
    s_cbranch_scc1 g_47L12_2
    s_mov_b32 s25, 200000
    s_branch gc_48
g_47F1_0:
    s_mov_b64 exec, vcc
    buffer_load_dwordx4 v[24:27], v8, s[4:7], s16 offen offset:0 sc1
    s_mov_b64 exec, -1
    s_add_u32 s23, s23, 1
    s_cmp_lt_u32 s23, 200000
    s_cbranch_scc1 g_47L1_0
    s_mov_b32 s25, 200000
    s_branch gc_48
g_47F2_1:
    s_mov_b64 exec, vcc
    buffer_load_dwordx4 v[28:31], v8, s[4:7], s16 offen offset:1024 sc1
    s_mov_b64 exec, -1
    s_add_u32 s23, s23, 1
    s_cmp_lt_u32 s23, 200000
    s_cbranch_scc1 g_47L2_1
    s_mov_b32 s25, 200000
    s_branch gc_48
g_47F4_2:
    s_mov_b64 exec, vcc
    buffer_load_dwordx4 v[32:35], v8, s[4:7], s16 offen offset:2048 sc1
    s_mov_b64 exec, -1
    s_add_u32 s23, s23, 1
    s_cmp_lt_u32 s23, 200000
    s_cbranch_scc1 g_47L4_2
    s_mov_b32 s25, 200000
    s_branch gc_48
g_47F8_3:
    s_mov_b64 exec, vcc
    buffer_load_dwordx4 v[36:39], v8, s[4:7], s16 offen offset:3072 sc1
    s_mov_b64 exec, -1
    s_add_u32 s23, s23, 1
    s_cmp_lt_u32 s23, 200000
    s_cbranch_scc1 g_47L8_3
    s_mov_b32 s25, 200000
    s_branch gc_48
.p2align 6
recur_fast_w3:
    s_nop 15
    s_mov_b32 s23, s25
    buffer_load_dwordx4 v[24:27], v2, s[4:7], s16 offen offset:0 sc1
    s_nop 11
    buffer_load_dwordx4 v[28:31], v2, s[4:7], s16 offen offset:1024 sc1
    s_nop 11
    buffer_load_dwordx4 v[32:35], v2, s[4:7], s16 offen offset:2048 sc1
    s_nop 11
    buffer_load_dwordx4 v[36:39], v2, s[4:7], s16 offen offset:3072 sc1
    s_waitcnt vmcnt(3)
    v_max3_u32 v19, v24, v25, v26
    v_max_u32 v19, v19, v27
    v_cmp_eq_u32 vcc, -1, v19
    s_nop 0
    s_cbranch_vccnz g_49F15_0
    v_smfmac_f32_16x16x64_bf16 v[40:43], v[24:27], a[0:7], v172
    s_waitcnt vmcnt(2)
    v_max3_u32 v19, v28, v29, v30
    v_max_u32 v19, v19, v31
    v_smfmac_f32_16x16x64_bf16 v[44:47], v[24:27], a[64:71], v172
    v_cmp_eq_u32 vcc, -1, v19
    v_smfmac_f32_16x16x64_bf16 v[48:51], v[24:27], a[32:39], v172
    v_smfmac_f32_16x16x64_bf16 v[52:55], v[24:27], a[96:103], v172
    s_cbranch_vccnz g_49F14_1
    v_smfmac_f32_16x16x64_bf16 v[40:43], v[28:31], a[8:15], v172
    s_waitcnt vmcnt(1)
    v_max3_u32 v19, v32, v33, v34
    v_max_u32 v19, v19, v35
    v_smfmac_f32_16x16x64_bf16 v[44:47], v[28:31], a[72:79], v172
    v_cmp_eq_u32 vcc, -1, v19
    v_smfmac_f32_16x16x64_bf16 v[48:51], v[28:31], a[40:47], v172
    v_smfmac_f32_16x16x64_bf16 v[52:55], v[28:31], a[104:111], v172
    s_cbranch_vccnz g_49F12_2
    v_smfmac_f32_16x16x64_bf16 v[40:43], v[32:35], a[16:23], v172
    s_waitcnt vmcnt(0)
    v_max3_u32 v19, v36, v37, v38
    v_max_u32 v19, v19, v39
    v_smfmac_f32_16x16x64_bf16 v[44:47], v[32:35], a[80:87], v172
    v_cmp_eq_u32 vcc, -1, v19
    v_smfmac_f32_16x16x64_bf16 v[48:51], v[32:35], a[48:55], v172
    v_smfmac_f32_16x16x64_bf16 v[52:55], v[32:35], a[112:119], v172
    s_cbranch_vccnz g_49F8_3
    v_smfmac_f32_16x16x64_bf16 v[40:43], v[36:39], a[24:31], v172
    v_smfmac_f32_16x16x64_bf16 v[44:47], v[36:39], a[88:95], v172
    v_smfmac_f32_16x16x64_bf16 v[48:51], v[36:39], a[56:63], v172
    v_smfmac_f32_16x16x64_bf16 v[52:55], v[36:39], a[120:127], v172
gc_50:
    v_cvt_pk_bf16_f32 v72, v40, v41
    v_cvt_pk_bf16_f32 v73, v42, v43
    v_cvt_pk_bf16_f32 v74, v44, v45
    v_cvt_pk_bf16_f32 v75, v46, v47
    ds_write_b128 v17, v[72:75] offset:0
    v_cvt_pk_bf16_f32 v76, v48, v49
    v_cvt_pk_bf16_f32 v77, v50, v51
    s_nop 0
    v_cvt_pk_bf16_f32 v78, v52, v53
    v_cvt_pk_bf16_f32 v79, v54, v55
    ds_write_b128 v17, v[76:79] offset:1024
    v_smfmac_f32_16x16x64_bf16 v[56:59], v[24:27], a[128:135], v172
    v_smfmac_f32_16x16x64_bf16 v[60:63], v[24:27], a[160:167], v172
    v_smfmac_f32_16x16x64_bf16 v[56:59], v[28:31], a[136:143], v172
    s_waitcnt lgkmcnt(0)
    s_barrier
    v_smfmac_f32_16x16x64_bf16 v[60:63], v[28:31], a[168:175], v172
    v_smfmac_f32_16x16x64_bf16 v[56:59], v[32:35], a[144:151], v172
    v_smfmac_f32_16x16x64_bf16 v[60:63], v[32:35], a[176:183], v172
    v_smfmac_f32_16x16x64_bf16 v[56:59], v[36:39], a[152:159], v172
    v_smfmac_f32_16x16x64_bf16 v[60:63], v[36:39], a[184:191], v172
    s_nop 4
    v_cvt_pk_bf16_f32 v80, v56, v57
    v_cvt_pk_bf16_f32 v81, v58, v59
    s_nop 0
    v_cvt_pk_bf16_f32 v82, v60, v61
    v_cvt_pk_bf16_f32 v83, v62, v63
    ds_write_b128 v17, v[80:83] offset:8192
    buffer_store_dwordx4 v[204:207], v3, s[4:7], s43 offen
    buffer_store_dwordx4 v[204:207], v3, s[4:7], s43 offen offset:128
    buffer_store_dwordx4 v[204:207], v4, s[4:7], s43 offen
    buffer_store_dwordx2 v[204:205], v7, s[4:7], s43 offen
    buffer_store_dwordx2 v[204:205], v11, s[4:7], s43 offen
    s_cmp_eq_u32 s15, 63
    s_waitcnt lgkmcnt(0)
    s_barrier
    s_cbranch_scc1 recur_end
    s_barrier
    s_nop 15
    s_mov_b32 s23, s25
    buffer_load_dwordx4 v[24:27], v8, s[4:7], s16 offen offset:0 sc1
    s_nop 11
    buffer_load_dwordx4 v[28:31], v8, s[4:7], s16 offen offset:1024 sc1
    s_nop 11
    buffer_load_dwordx4 v[32:35], v8, s[4:7], s16 offen offset:2048 sc1
    s_nop 11
    buffer_load_dwordx4 v[36:39], v8, s[4:7], s16 offen offset:3072 sc1
    s_waitcnt vmcnt(3)
    v_max3_u32 v19, v24, v25, v26
    v_max_u32 v19, v19, v27
    v_cmp_eq_u32 vcc, -1, v19
    s_nop 0
    s_cbranch_vccnz g_51F15_0
    v_smfmac_f32_16x16x64_bf16 v[64:67], v[24:27], a[192:199], v172
    v_smfmac_f32_16x16x64_bf16 v[68:71], v[24:27], a[224:231], v172
    s_waitcnt vmcnt(2)
    v_max3_u32 v19, v28, v29, v30
    v_max_u32 v19, v19, v31
    v_cmp_eq_u32 vcc, -1, v19
    s_nop 0
    s_cbranch_vccnz g_51F14_1
    v_smfmac_f32_16x16x64_bf16 v[64:67], v[28:31], a[200:207], v172
    v_smfmac_f32_16x16x64_bf16 v[68:71], v[28:31], a[232:239], v172
    s_waitcnt vmcnt(1)
    v_max3_u32 v19, v32, v33, v34
    v_max_u32 v19, v19, v35
    v_cmp_eq_u32 vcc, -1, v19
    s_nop 0
    s_cbranch_vccnz g_51F12_2
    v_smfmac_f32_16x16x64_bf16 v[64:67], v[32:35], a[208:215], v172
    v_smfmac_f32_16x16x64_bf16 v[68:71], v[32:35], a[240:247], v172
    s_waitcnt vmcnt(0)
    v_max3_u32 v19, v36, v37, v38
    v_max_u32 v19, v19, v39
    v_cmp_eq_u32 vcc, -1, v19
    s_nop 0
    s_cbranch_vccnz g_51F8_3
    v_smfmac_f32_16x16x64_bf16 v[64:67], v[36:39], a[216:223], v172
    v_smfmac_f32_16x16x64_bf16 v[68:71], v[36:39], a[248:255], v172
    s_nop 4
    v_cvt_pk_bf16_f32 v80, v64, v65
    v_cvt_pk_bf16_f32 v81, v66, v67
    s_nop 0
    v_cvt_pk_bf16_f32 v82, v68, v69
    v_cvt_pk_bf16_f32 v83, v70, v71
    s_nop 1
    v_mfma_f32_16x16x32_bf16 v[88:91], v[80:83], v[84:87], 0
gc_52:
    s_barrier
    ds_read_b128 v[96:99], v16 offset:9216
    ds_read_b128 v[100:103], v16 offset:11264
    ds_read_b128 v[104:107], v16 offset:13312
    s_waitcnt lgkmcnt(2)
    v_mfma_f32_16x16x32_bf16 v[88:91], v[96:99], v[84:87], v[88:91]
    s_waitcnt lgkmcnt(1)
    v_mfma_f32_16x16x32_bf16 v[88:91], v[100:103], v[84:87], v[88:91]
    s_waitcnt lgkmcnt(0)
    v_mfma_f32_16x16x32_bf16 v[88:91], v[104:107], v[84:87], v[88:91]
    s_nop 7
    buffer_store_dwordx4 v[88:91], v9, s[4:7], s84 offen sc1
    s_add_u32 s22, s84, 262144
    buffer_store_dwordx4 v[88:91], v9, s[4:7], s22 offen sc1
    s_nop 15
    s_nop 15
    s_nop 15
    s_nop 15
    s_nop 15
    s_nop 15
    s_nop 15
    s_nop 7
    s_mov_b32 s23, s25
    buffer_load_dwordx4 v[96:99], v10, s[4:7], s84 offen sc1
    buffer_load_dwordx4 v[100:103], v23, s[4:7], s84 offen sc1
    buffer_load_dwordx4 v[104:107], v244, s[4:7], s84 offen sc1
    s_nop 15
    s_nop 15
    s_nop 7
    buffer_load_dwordx4 v[108:111], v10, s[4:7], s22 offen sc1
    buffer_load_dwordx4 v[112:115], v23, s[4:7], s22 offen sc1
    buffer_load_dwordx4 v[116:119], v244, s[4:7], s22 offen sc1
    v_mov_b32 v40, 0
    v_mov_b32 v41, 0
    v_mov_b32 v42, 0
    v_mov_b32 v43, 0
    v_mov_b32 v44, 0
    v_mov_b32 v45, 0
    v_mov_b32 v46, 0
    v_mov_b32 v47, 0
    v_mov_b32 v48, 0
    v_mov_b32 v49, 0
    v_mov_b32 v50, 0
    v_mov_b32 v51, 0
    v_mov_b32 v52, 0
    v_mov_b32 v53, 0
    v_mov_b32 v54, 0
    v_mov_b32 v55, 0
    v_mov_b32 v56, 0
    v_mov_b32 v57, 0
    v_mov_b32 v58, 0
    v_mov_b32 v59, 0
    v_mov_b32 v60, 0
    v_mov_b32 v61, 0
    v_mov_b32 v62, 0
    v_mov_b32 v63, 0
    v_mov_b32 v64, 0
    v_mov_b32 v65, 0
    v_mov_b32 v66, 0
    v_mov_b32 v67, 0
    v_mov_b32 v68, 0
    v_mov_b32 v69, 0
    v_mov_b32 v70, 0
    v_mov_b32 v71, 0
    s_waitcnt vmcnt(5)
    v_pk_add_f32 v[120:121], v[88:89], v[96:97]
    v_pk_add_f32 v[122:123], v[90:91], v[98:99]
    s_waitcnt vmcnt(4)
    v_pk_add_f32 v[120:121], v[120:121], v[100:101]
    v_pk_add_f32 v[122:123], v[122:123], v[102:103]
    s_waitcnt vmcnt(3)
    v_pk_add_f32 v[120:121], v[120:121], v[104:105]
    v_pk_add_f32 v[122:123], v[122:123], v[106:107]
    v_cvt_pk_bf16_f32 v180, v120, v121
    v_pk_add_f32 v[124:125], v[120:121], v[122:123]
    v_cvt_pk_bf16_f32 v181, v122, v123
    v_cmpx_o_f32 vcc, v124, v125
    buffer_store_dwordx2 v[180:181], v11, s[4:7], s42 offen
    s_cmp_eq_u64 vcc, -1
    s_mov_b64 exec, -1
    s_cbranch_scc0 pr_53
pg_54:
    s_barrier
    s_mov_b32 s21, s16
    s_mov_b32 s16, s42
    s_mov_b32 s42, s43
    s_mov_b32 s43, s44
    s_mov_b32 s44, s21
    s_add_u32 s95, s95, 524288
    s_lshr_b32 s84, s95, 8
    s_and_b32 s84, s84, 8192
    s_xor_b32 s84, s84, s46
    s_add_u32 s84, s84, s95
    s_add_u32 s15, s15, 1
    s_branch recur_fast_w3
g_49L15_0:
    s_waitcnt vmcnt(3)
    v_max3_u32 v19, v24, v25, v26
    v_max_u32 v19, v19, v27
    v_cmp_eq_u32 vcc, -1, v19
    s_nop 0
    s_cbranch_vccnz g_49F15_0
    v_smfmac_f32_16x16x64_bf16 v[40:43], v[24:27], a[0:7], v172
    v_smfmac_f32_16x16x64_bf16 v[44:47], v[24:27], a[64:71], v172
    v_smfmac_f32_16x16x64_bf16 v[48:51], v[24:27], a[32:39], v172
    v_smfmac_f32_16x16x64_bf16 v[52:55], v[24:27], a[96:103], v172
g_49L14_1:
    s_waitcnt vmcnt(2)
    v_max3_u32 v19, v28, v29, v30
    v_max_u32 v19, v19, v31
    v_cmp_eq_u32 vcc, -1, v19
    s_nop 0
    s_cbranch_vccnz g_49F14_1
    v_smfmac_f32_16x16x64_bf16 v[40:43], v[28:31], a[8:15], v172
    v_smfmac_f32_16x16x64_bf16 v[44:47], v[28:31], a[72:79], v172
    v_smfmac_f32_16x16x64_bf16 v[48:51], v[28:31], a[40:47], v172
    v_smfmac_f32_16x16x64_bf16 v[52:55], v[28:31], a[104:111], v172
g_49L12_2:
    s_waitcnt vmcnt(1)
    v_max3_u32 v19, v32, v33, v34
    v_max_u32 v19, v19, v35
    v_cmp_eq_u32 vcc, -1, v19
    s_nop 0
    s_cbranch_vccnz g_49F12_2
    v_smfmac_f32_16x16x64_bf16 v[40:43], v[32:35], a[16:23], v172
    v_smfmac_f32_16x16x64_bf16 v[44:47], v[32:35], a[80:87], v172
    v_smfmac_f32_16x16x64_bf16 v[48:51], v[32:35], a[48:55], v172
    v_smfmac_f32_16x16x64_bf16 v[52:55], v[32:35], a[112:119], v172
g_49L8_3:
    s_waitcnt vmcnt(0)
    v_max3_u32 v19, v36, v37, v38
    v_max_u32 v19, v19, v39
    v_cmp_eq_u32 vcc, -1, v19
    s_nop 0
    s_cbranch_vccnz g_49F8_3
    v_smfmac_f32_16x16x64_bf16 v[40:43], v[36:39], a[24:31], v172
    v_smfmac_f32_16x16x64_bf16 v[44:47], v[36:39], a[88:95], v172
    v_smfmac_f32_16x16x64_bf16 v[48:51], v[36:39], a[56:63], v172
    v_smfmac_f32_16x16x64_bf16 v[52:55], v[36:39], a[120:127], v172
    s_branch gc_50
g_49L15_1:
    s_waitcnt vmcnt(3)
    v_max3_u32 v19, v28, v29, v30
    v_max_u32 v19, v19, v31
    v_cmp_eq_u32 vcc, -1, v19
    s_nop 0
    s_cbranch_vccnz g_49F15_1
    v_smfmac_f32_16x16x64_bf16 v[40:43], v[28:31], a[8:15], v172
    v_smfmac_f32_16x16x64_bf16 v[44:47], v[28:31], a[72:79], v172
    v_smfmac_f32_16x16x64_bf16 v[48:51], v[28:31], a[40:47], v172
    v_smfmac_f32_16x16x64_bf16 v[52:55], v[28:31], a[104:111], v172
g_49L13_2:
    s_waitcnt vmcnt(2)
    v_max3_u32 v19, v32, v33, v34
    v_max_u32 v19, v19, v35
    v_cmp_eq_u32 vcc, -1, v19
    s_nop 0
    s_cbranch_vccnz g_49F13_2
    v_smfmac_f32_16x16x64_bf16 v[40:43], v[32:35], a[16:23], v172
    v_smfmac_f32_16x16x64_bf16 v[44:47], v[32:35], a[80:87], v172
    v_smfmac_f32_16x16x64_bf16 v[48:51], v[32:35], a[48:55], v172
    v_smfmac_f32_16x16x64_bf16 v[52:55], v[32:35], a[112:119], v172
g_49L9_3:
    s_waitcnt vmcnt(1)
    v_max3_u32 v19, v36, v37, v38
    v_max_u32 v19, v19, v39
    v_cmp_eq_u32 vcc, -1, v19
    s_nop 0
    s_cbranch_vccnz g_49F9_3
    v_smfmac_f32_16x16x64_bf16 v[40:43], v[36:39], a[24:31], v172
    v_smfmac_f32_16x16x64_bf16 v[44:47], v[36:39], a[88:95], v172
    v_smfmac_f32_16x16x64_bf16 v[48:51], v[36:39], a[56:63], v172
    v_smfmac_f32_16x16x64_bf16 v[52:55], v[36:39], a[120:127], v172
g_49L1_0:
    s_waitcnt vmcnt(0)
    v_max3_u32 v19, v24, v25, v26
    v_max_u32 v19, v19, v27
    v_cmp_eq_u32 vcc, -1, v19
    s_nop 0
    s_cbranch_vccnz g_49F1_0
    v_smfmac_f32_16x16x64_bf16 v[40:43], v[24:27], a[0:7], v172
    v_smfmac_f32_16x16x64_bf16 v[44:47], v[24:27], a[64:71], v172
    v_smfmac_f32_16x16x64_bf16 v[48:51], v[24:27], a[32:39], v172
    v_smfmac_f32_16x16x64_bf16 v[52:55], v[24:27], a[96:103], v172
    s_branch gc_50
g_49L15_2:
    s_waitcnt vmcnt(3)
    v_max3_u32 v19, v32, v33, v34
    v_max_u32 v19, v19, v35
    v_cmp_eq_u32 vcc, -1, v19
    s_nop 0
    s_cbranch_vccnz g_49F15_2
    v_smfmac_f32_16x16x64_bf16 v[40:43], v[32:35], a[16:23], v172
    v_smfmac_f32_16x16x64_bf16 v[44:47], v[32:35], a[80:87], v172
    v_smfmac_f32_16x16x64_bf16 v[48:51], v[32:35], a[48:55], v172
    v_smfmac_f32_16x16x64_bf16 v[52:55], v[32:35], a[112:119], v172
g_49L11_3:
    s_waitcnt vmcnt(2)
    v_max3_u32 v19, v36, v37, v38
    v_max_u32 v19, v19, v39
    v_cmp_eq_u32 vcc, -1, v19
    s_nop 0
    s_cbranch_vccnz g_49F11_3
    v_smfmac_f32_16x16x64_bf16 v[40:43], v[36:39], a[24:31], v172
    v_smfmac_f32_16x16x64_bf16 v[44:47], v[36:39], a[88:95], v172
    v_smfmac_f32_16x16x64_bf16 v[48:51], v[36:39], a[56:63], v172
    v_smfmac_f32_16x16x64_bf16 v[52:55], v[36:39], a[120:127], v172
g_49L3_0:
    s_waitcnt vmcnt(1)
    v_max3_u32 v19, v24, v25, v26
    v_max_u32 v19, v19, v27
    v_cmp_eq_u32 vcc, -1, v19
    s_nop 0
    s_cbranch_vccnz g_49F3_0
    v_smfmac_f32_16x16x64_bf16 v[40:43], v[24:27], a[0:7], v172
    v_smfmac_f32_16x16x64_bf16 v[44:47], v[24:27], a[64:71], v172
    v_smfmac_f32_16x16x64_bf16 v[48:51], v[24:27], a[32:39], v172
    v_smfmac_f32_16x16x64_bf16 v[52:55], v[24:27], a[96:103], v172
g_49L2_1:
    s_waitcnt vmcnt(0)
    v_max3_u32 v19, v28, v29, v30
    v_max_u32 v19, v19, v31
    v_cmp_eq_u32 vcc, -1, v19
    s_nop 0
    s_cbranch_vccnz g_49F2_1
    v_smfmac_f32_16x16x64_bf16 v[40:43], v[28:31], a[8:15], v172
    v_smfmac_f32_16x16x64_bf16 v[44:47], v[28:31], a[72:79], v172
    v_smfmac_f32_16x16x64_bf16 v[48:51], v[28:31], a[40:47], v172
    v_smfmac_f32_16x16x64_bf16 v[52:55], v[28:31], a[104:111], v172
    s_branch gc_50
g_49L15_3:
    s_waitcnt vmcnt(3)
    v_max3_u32 v19, v36, v37, v38
    v_max_u32 v19, v19, v39
    v_cmp_eq_u32 vcc, -1, v19
    s_nop 0
    s_cbranch_vccnz g_49F15_3
    v_smfmac_f32_16x16x64_bf16 v[40:43], v[36:39], a[24:31], v172
    v_smfmac_f32_16x16x64_bf16 v[44:47], v[36:39], a[88:95], v172
    v_smfmac_f32_16x16x64_bf16 v[48:51], v[36:39], a[56:63], v172
    v_smfmac_f32_16x16x64_bf16 v[52:55], v[36:39], a[120:127], v172
g_49L7_0:
    s_waitcnt vmcnt(2)
    v_max3_u32 v19, v24, v25, v26
    v_max_u32 v19, v19, v27
    v_cmp_eq_u32 vcc, -1, v19
    s_nop 0
    s_cbranch_vccnz g_49F7_0
    v_smfmac_f32_16x16x64_bf16 v[40:43], v[24:27], a[0:7], v172
    v_smfmac_f32_16x16x64_bf16 v[44:47], v[24:27], a[64:71], v172
    v_smfmac_f32_16x16x64_bf16 v[48:51], v[24:27], a[32:39], v172
    v_smfmac_f32_16x16x64_bf16 v[52:55], v[24:27], a[96:103], v172
g_49L6_1:
    s_waitcnt vmcnt(1)
    v_max3_u32 v19, v28, v29, v30
    v_max_u32 v19, v19, v31
    v_cmp_eq_u32 vcc, -1, v19
    s_nop 0
    s_cbranch_vccnz g_49F6_1
    v_smfmac_f32_16x16x64_bf16 v[40:43], v[28:31], a[8:15], v172
    v_smfmac_f32_16x16x64_bf16 v[44:47], v[28:31], a[72:79], v172
    v_smfmac_f32_16x16x64_bf16 v[48:51], v[28:31], a[40:47], v172
    v_smfmac_f32_16x16x64_bf16 v[52:55], v[28:31], a[104:111], v172
g_49L4_2:
    s_waitcnt vmcnt(0)
    v_max3_u32 v19, v32, v33, v34
    v_max_u32 v19, v19, v35
    v_cmp_eq_u32 vcc, -1, v19
    s_nop 0
    s_cbranch_vccnz g_49F4_2
    v_smfmac_f32_16x16x64_bf16 v[40:43], v[32:35], a[16:23], v172
    v_smfmac_f32_16x16x64_bf16 v[44:47], v[32:35], a[80:87], v172
    v_smfmac_f32_16x16x64_bf16 v[48:51], v[32:35], a[48:55], v172
    v_smfmac_f32_16x16x64_bf16 v[52:55], v[32:35], a[112:119], v172
    s_branch gc_50
g_49L7_1:
    s_waitcnt vmcnt(2)
    v_max3_u32 v19, v28, v29, v30
    v_max_u32 v19, v19, v31
    v_cmp_eq_u32 vcc, -1, v19
    s_nop 0
    s_cbranch_vccnz g_49F7_1
    v_smfmac_f32_16x16x64_bf16 v[40:43], v[28:31], a[8:15], v172
    v_smfmac_f32_16x16x64_bf16 v[44:47], v[28:31], a[72:79], v172
    v_smfmac_f32_16x16x64_bf16 v[48:51], v[28:31], a[40:47], v172
    v_smfmac_f32_16x16x64_bf16 v[52:55], v[28:31], a[104:111], v172
g_49L5_2:
    s_waitcnt vmcnt(1)
    v_max3_u32 v19, v32, v33, v34
    v_max_u32 v19, v19, v35
    v_cmp_eq_u32 vcc, -1, v19
    s_nop 0
    s_cbranch_vccnz g_49F5_2
    v_smfmac_f32_16x16x64_bf16 v[40:43], v[32:35], a[16:23], v172
    v_smfmac_f32_16x16x64_bf16 v[44:47], v[32:35], a[80:87], v172
    v_smfmac_f32_16x16x64_bf16 v[48:51], v[32:35], a[48:55], v172
    v_smfmac_f32_16x16x64_bf16 v[52:55], v[32:35], a[112:119], v172
    s_branch g_49L1_0
g_49L7_2:
    s_waitcnt vmcnt(2)
    v_max3_u32 v19, v32, v33, v34
    v_max_u32 v19, v19, v35
    v_cmp_eq_u32 vcc, -1, v19
    s_nop 0
    s_cbranch_vccnz g_49F7_2
    v_smfmac_f32_16x16x64_bf16 v[40:43], v[32:35], a[16:23], v172
    v_smfmac_f32_16x16x64_bf16 v[44:47], v[32:35], a[80:87], v172
    v_smfmac_f32_16x16x64_bf16 v[48:51], v[32:35], a[48:55], v172
    v_smfmac_f32_16x16x64_bf16 v[52:55], v[32:35], a[112:119], v172
    s_branch g_49L3_0
g_49L11_0:
    s_waitcnt vmcnt(2)
    v_max3_u32 v19, v24, v25, v26
    v_max_u32 v19, v19, v27
    v_cmp_eq_u32 vcc, -1, v19
    s_nop 0
    s_cbranch_vccnz g_49F11_0
    v_smfmac_f32_16x16x64_bf16 v[40:43], v[24:27], a[0:7], v172
    v_smfmac_f32_16x16x64_bf16 v[44:47], v[24:27], a[64:71], v172
    v_smfmac_f32_16x16x64_bf16 v[48:51], v[24:27], a[32:39], v172
    v_smfmac_f32_16x16x64_bf16 v[52:55], v[24:27], a[96:103], v172
g_49L10_1:
    s_waitcnt vmcnt(1)
    v_max3_u32 v19, v28, v29, v30
    v_max_u32 v19, v19, v31
    v_cmp_eq_u32 vcc, -1, v19
    s_nop 0
    s_cbranch_vccnz g_49F10_1
    v_smfmac_f32_16x16x64_bf16 v[40:43], v[28:31], a[8:15], v172
    v_smfmac_f32_16x16x64_bf16 v[44:47], v[28:31], a[72:79], v172
    v_smfmac_f32_16x16x64_bf16 v[48:51], v[28:31], a[40:47], v172
    v_smfmac_f32_16x16x64_bf16 v[52:55], v[28:31], a[104:111], v172
    s_branch g_49L8_3
g_49L11_1:
    s_waitcnt vmcnt(2)
    v_max3_u32 v19, v28, v29, v30
    v_max_u32 v19, v19, v31
    v_cmp_eq_u32 vcc, -1, v19
    s_nop 0
    s_cbranch_vccnz g_49F11_1
    v_smfmac_f32_16x16x64_bf16 v[40:43], v[28:31], a[8:15], v172
    v_smfmac_f32_16x16x64_bf16 v[44:47], v[28:31], a[72:79], v172
    v_smfmac_f32_16x16x64_bf16 v[48:51], v[28:31], a[40:47], v172
    v_smfmac_f32_16x16x64_bf16 v[52:55], v[28:31], a[104:111], v172
    s_branch g_49L9_3
g_49L13_0:
    s_waitcnt vmcnt(2)
    v_max3_u32 v19, v24, v25, v26
    v_max_u32 v19, v19, v27
    v_cmp_eq_u32 vcc, -1, v19
    s_nop 0
    s_cbranch_vccnz g_49F13_0
    v_smfmac_f32_16x16x64_bf16 v[40:43], v[24:27], a[0:7], v172
    v_smfmac_f32_16x16x64_bf16 v[44:47], v[24:27], a[64:71], v172
    v_smfmac_f32_16x16x64_bf16 v[48:51], v[24:27], a[32:39], v172
    v_smfmac_f32_16x16x64_bf16 v[52:55], v[24:27], a[96:103], v172
    s_branch g_49L12_2
g_49L13_3:
    s_waitcnt vmcnt(2)
    v_max3_u32 v19, v36, v37, v38
    v_max_u32 v19, v19, v39
    v_cmp_eq_u32 vcc, -1, v19
    s_nop 0
    s_cbranch_vccnz g_49F13_3
    v_smfmac_f32_16x16x64_bf16 v[40:43], v[36:39], a[24:31], v172
    v_smfmac_f32_16x16x64_bf16 v[44:47], v[36:39], a[88:95], v172
    v_smfmac_f32_16x16x64_bf16 v[48:51], v[36:39], a[56:63], v172
    v_smfmac_f32_16x16x64_bf16 v[52:55], v[36:39], a[120:127], v172
g_49L5_0:
    s_waitcnt vmcnt(1)
    v_max3_u32 v19, v24, v25, v26
    v_max_u32 v19, v19, v27
    v_cmp_eq_u32 vcc, -1, v19
    s_nop 0
    s_cbranch_vccnz g_49F5_0
    v_smfmac_f32_16x16x64_bf16 v[40:43], v[24:27], a[0:7], v172
    v_smfmac_f32_16x16x64_bf16 v[44:47], v[24:27], a[64:71], v172
    v_smfmac_f32_16x16x64_bf16 v[48:51], v[24:27], a[32:39], v172
    v_smfmac_f32_16x16x64_bf16 v[52:55], v[24:27], a[96:103], v172
    s_branch g_49L4_2
g_49L14_2:
    s_waitcnt vmcnt(2)
    v_max3_u32 v19, v32, v33, v34
    v_max_u32 v19, v19, v35
    v_cmp_eq_u32 vcc, -1, v19
    s_nop 0
    s_cbranch_vccnz g_49F14_2
    v_smfmac_f32_16x16x64_bf16 v[40:43], v[32:35], a[16:23], v172
    v_smfmac_f32_16x16x64_bf16 v[44:47], v[32:35], a[80:87], v172
    v_smfmac_f32_16x16x64_bf16 v[48:51], v[32:35], a[48:55], v172
    v_smfmac_f32_16x16x64_bf16 v[52:55], v[32:35], a[112:119], v172
g_49L10_3:
    s_waitcnt vmcnt(1)
    v_max3_u32 v19, v36, v37, v38
    v_max_u32 v19, v19, v39
    v_cmp_eq_u32 vcc, -1, v19
    s_nop 0
    s_cbranch_vccnz g_49F10_3
    v_smfmac_f32_16x16x64_bf16 v[40:43], v[36:39], a[24:31], v172
    v_smfmac_f32_16x16x64_bf16 v[44:47], v[36:39], a[88:95], v172
    v_smfmac_f32_16x16x64_bf16 v[48:51], v[36:39], a[56:63], v172
    v_smfmac_f32_16x16x64_bf16 v[52:55], v[36:39], a[120:127], v172
    s_branch g_49L2_1
g_49L14_3:
    s_waitcnt vmcnt(2)
    v_max3_u32 v19, v36, v37, v38
    v_max_u32 v19, v19, v39
    v_cmp_eq_u32 vcc, -1, v19
    s_nop 0
    s_cbranch_vccnz g_49F14_3
    v_smfmac_f32_16x16x64_bf16 v[40:43], v[36:39], a[24:31], v172
    v_smfmac_f32_16x16x64_bf16 v[44:47], v[36:39], a[88:95], v172
    v_smfmac_f32_16x16x64_bf16 v[48:51], v[36:39], a[56:63], v172
    v_smfmac_f32_16x16x64_bf16 v[52:55], v[36:39], a[120:127], v172
    s_branch g_49L6_1
g_49L3_1:
    s_waitcnt vmcnt(1)
    v_max3_u32 v19, v28, v29, v30
    v_max_u32 v19, v19, v31
    v_cmp_eq_u32 vcc, -1, v19
    s_nop 0
    s_cbranch_vccnz g_49F3_1
    v_smfmac_f32_16x16x64_bf16 v[40:43], v[28:31], a[8:15], v172
    v_smfmac_f32_16x16x64_bf16 v[44:47], v[28:31], a[72:79], v172
    v_smfmac_f32_16x16x64_bf16 v[48:51], v[28:31], a[40:47], v172
    v_smfmac_f32_16x16x64_bf16 v[52:55], v[28:31], a[104:111], v172
    s_branch g_49L1_0
g_49L6_2:
    s_waitcnt vmcnt(1)
    v_max3_u32 v19, v32, v33, v34
    v_max_u32 v19, v19, v35
    v_cmp_eq_u32 vcc, -1, v19
    s_nop 0
    s_cbranch_vccnz g_49F6_2
    v_smfmac_f32_16x16x64_bf16 v[40:43], v[32:35], a[16:23], v172
    v_smfmac_f32_16x16x64_bf16 v[44:47], v[32:35], a[80:87], v172
    v_smfmac_f32_16x16x64_bf16 v[48:51], v[32:35], a[48:55], v172
    v_smfmac_f32_16x16x64_bf16 v[52:55], v[32:35], a[112:119], v172
    s_branch g_49L2_1
g_49L9_0:
    s_waitcnt vmcnt(1)
    v_max3_u32 v19, v24, v25, v26
    v_max_u32 v19, v19, v27
    v_cmp_eq_u32 vcc, -1, v19
    s_nop 0
    s_cbranch_vccnz g_49F9_0
    v_smfmac_f32_16x16x64_bf16 v[40:43], v[24:27], a[0:7], v172
    v_smfmac_f32_16x16x64_bf16 v[44:47], v[24:27], a[64:71], v172
    v_smfmac_f32_16x16x64_bf16 v[48:51], v[24:27], a[32:39], v172
    v_smfmac_f32_16x16x64_bf16 v[52:55], v[24:27], a[96:103], v172
    s_branch g_49L8_3
g_49L12_3:
    s_waitcnt vmcnt(1)
    v_max3_u32 v19, v36, v37, v38
    v_max_u32 v19, v19, v39
    v_cmp_eq_u32 vcc, -1, v19
    s_nop 0
    s_cbranch_vccnz g_49F12_3
    v_smfmac_f32_16x16x64_bf16 v[40:43], v[36:39], a[24:31], v172
    v_smfmac_f32_16x16x64_bf16 v[44:47], v[36:39], a[88:95], v172
    v_smfmac_f32_16x16x64_bf16 v[48:51], v[36:39], a[56:63], v172
    v_smfmac_f32_16x16x64_bf16 v[52:55], v[36:39], a[120:127], v172
    s_branch g_49L4_2
g_49F15_0:
    s_mov_b64 exec, vcc
    buffer_load_dwordx4 v[24:27], v2, s[4:7], s16 offen offset:0 sc1
    s_mov_b64 exec, -1
    s_add_u32 s23, s23, 1
    s_cmp_lt_u32 s23, 200000
    s_cbranch_scc1 g_49L15_1
    s_mov_b32 s25, 200000
    s_branch gc_50
g_49F15_1:
    s_mov_b64 exec, vcc
    buffer_load_dwordx4 v[28:31], v2, s[4:7], s16 offen offset:1024 sc1
    s_mov_b64 exec, -1
    s_add_u32 s23, s23, 1
    s_cmp_lt_u32 s23, 200000
    s_cbranch_scc1 g_49L15_2
    s_mov_b32 s25, 200000
    s_branch gc_50
g_49F15_2:
    s_mov_b64 exec, vcc
    buffer_load_dwordx4 v[32:35], v2, s[4:7], s16 offen offset:2048 sc1
    s_mov_b64 exec, -1
    s_add_u32 s23, s23, 1
    s_cmp_lt_u32 s23, 200000
    s_cbranch_scc1 g_49L15_3
    s_mov_b32 s25, 200000
    s_branch gc_50
g_49F15_3:
    s_mov_b64 exec, vcc
    buffer_load_dwordx4 v[36:39], v2, s[4:7], s16 offen offset:3072 sc1
    s_mov_b64 exec, -1
    s_add_u32 s23, s23, 1
    s_cmp_lt_u32 s23, 200000
    s_cbranch_scc1 g_49L15_0
    s_mov_b32 s25, 200000
    s_branch gc_50
g_49F7_0:
    s_mov_b64 exec, vcc
    buffer_load_dwordx4 v[24:27], v2, s[4:7], s16 offen offset:0 sc1
    s_mov_b64 exec, -1
    s_add_u32 s23, s23, 1
    s_cmp_lt_u32 s23, 200000
    s_cbranch_scc1 g_49L7_1
    s_mov_b32 s25, 200000
    s_branch gc_50
g_49F7_1:
    s_mov_b64 exec, vcc
    buffer_load_dwordx4 v[28:31], v2, s[4:7], s16 offen offset:1024 sc1
    s_mov_b64 exec, -1
    s_add_u32 s23, s23, 1
    s_cmp_lt_u32 s23, 200000
    s_cbranch_scc1 g_49L7_2
    s_mov_b32 s25, 200000
    s_branch gc_50
g_49F7_2:
    s_mov_b64 exec, vcc
    buffer_load_dwordx4 v[32:35], v2, s[4:7], s16 offen offset:2048 sc1
    s_mov_b64 exec, -1
    s_add_u32 s23, s23, 1
    s_cmp_lt_u32 s23, 200000
    s_cbranch_scc1 g_49L7_0
    s_mov_b32 s25, 200000
    s_branch gc_50
g_49F11_0:
    s_mov_b64 exec, vcc
    buffer_load_dwordx4 v[24:27], v2, s[4:7], s16 offen offset:0 sc1
    s_mov_b64 exec, -1
    s_add_u32 s23, s23, 1
    s_cmp_lt_u32 s23, 200000
    s_cbranch_scc1 g_49L11_1
    s_mov_b32 s25, 200000
    s_branch gc_50
g_49F11_1:
    s_mov_b64 exec, vcc
    buffer_load_dwordx4 v[28:31], v2, s[4:7], s16 offen offset:1024 sc1
    s_mov_b64 exec, -1
    s_add_u32 s23, s23, 1
    s_cmp_lt_u32 s23, 200000
    s_cbranch_scc1 g_49L11_3
    s_mov_b32 s25, 200000
    s_branch gc_50
g_49F11_3:
    s_mov_b64 exec, vcc
    buffer_load_dwordx4 v[36:39], v2, s[4:7], s16 offen offset:3072 sc1
    s_mov_b64 exec, -1
    s_add_u32 s23, s23, 1
    s_cmp_lt_u32 s23, 200000
    s_cbranch_scc1 g_49L11_0
    s_mov_b32 s25, 200000
    s_branch gc_50
g_49F13_0:
    s_mov_b64 exec, vcc
    buffer_load_dwordx4 v[24:27], v2, s[4:7], s16 offen offset:0 sc1
    s_mov_b64 exec, -1
    s_add_u32 s23, s23, 1
    s_cmp_lt_u32 s23, 200000
    s_cbranch_scc1 g_49L13_2
    s_mov_b32 s25, 200000
    s_branch gc_50
g_49F13_2:
    s_mov_b64 exec, vcc
    buffer_load_dwordx4 v[32:35], v2, s[4:7], s16 offen offset:2048 sc1
    s_mov_b64 exec, -1
    s_add_u32 s23, s23, 1
    s_cmp_lt_u32 s23, 200000
    s_cbranch_scc1 g_49L13_3
    s_mov_b32 s25, 200000
    s_branch gc_50
g_49F13_3:
    s_mov_b64 exec, vcc
    buffer_load_dwordx4 v[36:39], v2, s[4:7], s16 offen offset:3072 sc1
    s_mov_b64 exec, -1
    s_add_u32 s23, s23, 1
    s_cmp_lt_u32 s23, 200000
    s_cbranch_scc1 g_49L13_0
    s_mov_b32 s25, 200000
    s_branch gc_50
g_49F14_1:
    s_mov_b64 exec, vcc
    buffer_load_dwordx4 v[28:31], v2, s[4:7], s16 offen offset:1024 sc1
    s_mov_b64 exec, -1
    s_add_u32 s23, s23, 1
    s_cmp_lt_u32 s23, 200000
    s_cbranch_scc1 g_49L14_2
    s_mov_b32 s25, 200000
    s_branch gc_50
g_49F14_2:
    s_mov_b64 exec, vcc
    buffer_load_dwordx4 v[32:35], v2, s[4:7], s16 offen offset:2048 sc1
    s_mov_b64 exec, -1
    s_add_u32 s23, s23, 1
    s_cmp_lt_u32 s23, 200000
    s_cbranch_scc1 g_49L14_3
    s_mov_b32 s25, 200000
    s_branch gc_50
g_49F14_3:
    s_mov_b64 exec, vcc
    buffer_load_dwordx4 v[36:39], v2, s[4:7], s16 offen offset:3072 sc1
    s_mov_b64 exec, -1
    s_add_u32 s23, s23, 1
    s_cmp_lt_u32 s23, 200000
    s_cbranch_scc1 g_49L14_1
    s_mov_b32 s25, 200000
    s_branch gc_50
g_49F3_0:
    s_mov_b64 exec, vcc
    buffer_load_dwordx4 v[24:27], v2, s[4:7], s16 offen offset:0 sc1
    s_mov_b64 exec, -1
    s_add_u32 s23, s23, 1
    s_cmp_lt_u32 s23, 200000
    s_cbranch_scc1 g_49L3_1
    s_mov_b32 s25, 200000
    s_branch gc_50
g_49F3_1:
    s_mov_b64 exec, vcc
    buffer_load_dwordx4 v[28:31], v2, s[4:7], s16 offen offset:1024 sc1
    s_mov_b64 exec, -1
    s_add_u32 s23, s23, 1
    s_cmp_lt_u32 s23, 200000
    s_cbranch_scc1 g_49L3_0
    s_mov_b32 s25, 200000
    s_branch gc_50
g_49F5_0:
    s_mov_b64 exec, vcc
    buffer_load_dwordx4 v[24:27], v2, s[4:7], s16 offen offset:0 sc1
    s_mov_b64 exec, -1
    s_add_u32 s23, s23, 1
    s_cmp_lt_u32 s23, 200000
    s_cbranch_scc1 g_49L5_2
    s_mov_b32 s25, 200000
    s_branch gc_50
g_49F5_2:
    s_mov_b64 exec, vcc
    buffer_load_dwordx4 v[32:35], v2, s[4:7], s16 offen offset:2048 sc1
    s_mov_b64 exec, -1
    s_add_u32 s23, s23, 1
    s_cmp_lt_u32 s23, 200000
    s_cbranch_scc1 g_49L5_0
    s_mov_b32 s25, 200000
    s_branch gc_50
g_49F6_1:
    s_mov_b64 exec, vcc
    buffer_load_dwordx4 v[28:31], v2, s[4:7], s16 offen offset:1024 sc1
    s_mov_b64 exec, -1
    s_add_u32 s23, s23, 1
    s_cmp_lt_u32 s23, 200000
    s_cbranch_scc1 g_49L6_2
    s_mov_b32 s25, 200000
    s_branch gc_50
g_49F6_2:
    s_mov_b64 exec, vcc
    buffer_load_dwordx4 v[32:35], v2, s[4:7], s16 offen offset:2048 sc1
    s_mov_b64 exec, -1
    s_add_u32 s23, s23, 1
    s_cmp_lt_u32 s23, 200000
    s_cbranch_scc1 g_49L6_1
    s_mov_b32 s25, 200000
    s_branch gc_50
g_49F9_0:
    s_mov_b64 exec, vcc
    buffer_load_dwordx4 v[24:27], v2, s[4:7], s16 offen offset:0 sc1
    s_mov_b64 exec, -1
    s_add_u32 s23, s23, 1
    s_cmp_lt_u32 s23, 200000
    s_cbranch_scc1 g_49L9_3
    s_mov_b32 s25, 200000
    s_branch gc_50
g_49F9_3:
    s_mov_b64 exec, vcc
    buffer_load_dwordx4 v[36:39], v2, s[4:7], s16 offen offset:3072 sc1
    s_mov_b64 exec, -1
    s_add_u32 s23, s23, 1
    s_cmp_lt_u32 s23, 200000
    s_cbranch_scc1 g_49L9_0
    s_mov_b32 s25, 200000
    s_branch gc_50
g_49F10_1:
    s_mov_b64 exec, vcc
    buffer_load_dwordx4 v[28:31], v2, s[4:7], s16 offen offset:1024 sc1
    s_mov_b64 exec, -1
    s_add_u32 s23, s23, 1
    s_cmp_lt_u32 s23, 200000
    s_cbranch_scc1 g_49L10_3
    s_mov_b32 s25, 200000
    s_branch gc_50
g_49F10_3:
    s_mov_b64 exec, vcc
    buffer_load_dwordx4 v[36:39], v2, s[4:7], s16 offen offset:3072 sc1
    s_mov_b64 exec, -1
    s_add_u32 s23, s23, 1
    s_cmp_lt_u32 s23, 200000
    s_cbranch_scc1 g_49L10_1
    s_mov_b32 s25, 200000
    s_branch gc_50
g_49F12_2:
    s_mov_b64 exec, vcc
    buffer_load_dwordx4 v[32:35], v2, s[4:7], s16 offen offset:2048 sc1
    s_mov_b64 exec, -1
    s_add_u32 s23, s23, 1
    s_cmp_lt_u32 s23, 200000
    s_cbranch_scc1 g_49L12_3
    s_mov_b32 s25, 200000
    s_branch gc_50
g_49F12_3:
    s_mov_b64 exec, vcc
    buffer_load_dwordx4 v[36:39], v2, s[4:7], s16 offen offset:3072 sc1
    s_mov_b64 exec, -1
    s_add_u32 s23, s23, 1
    s_cmp_lt_u32 s23, 200000
    s_cbranch_scc1 g_49L12_2
    s_mov_b32 s25, 200000
    s_branch gc_50
g_49F1_0:
    s_mov_b64 exec, vcc
    buffer_load_dwordx4 v[24:27], v2, s[4:7], s16 offen offset:0 sc1
    s_mov_b64 exec, -1
    s_add_u32 s23, s23, 1
    s_cmp_lt_u32 s23, 200000
    s_cbranch_scc1 g_49L1_0
    s_mov_b32 s25, 200000
    s_branch gc_50
g_49F2_1:
    s_mov_b64 exec, vcc
    buffer_load_dwordx4 v[28:31], v2, s[4:7], s16 offen offset:1024 sc1
    s_mov_b64 exec, -1
    s_add_u32 s23, s23, 1
    s_cmp_lt_u32 s23, 200000
    s_cbranch_scc1 g_49L2_1
    s_mov_b32 s25, 200000
    s_branch gc_50
g_49F4_2:
    s_mov_b64 exec, vcc
    buffer_load_dwordx4 v[32:35], v2, s[4:7], s16 offen offset:2048 sc1
    s_mov_b64 exec, -1
    s_add_u32 s23, s23, 1
    s_cmp_lt_u32 s23, 200000
    s_cbranch_scc1 g_49L4_2
    s_mov_b32 s25, 200000
    s_branch gc_50
g_49F8_3:
    s_mov_b64 exec, vcc
    buffer_load_dwordx4 v[36:39], v2, s[4:7], s16 offen offset:3072 sc1
    s_mov_b64 exec, -1
    s_add_u32 s23, s23, 1
    s_cmp_lt_u32 s23, 200000
    s_cbranch_scc1 g_49L8_3
    s_mov_b32 s25, 200000
    s_branch gc_50
g_51L15_0:
    s_waitcnt vmcnt(3)
    v_max3_u32 v19, v24, v25, v26
    v_max_u32 v19, v19, v27
    v_cmp_eq_u32 vcc, -1, v19
    s_nop 0
    s_cbranch_vccnz g_51F15_0
    v_smfmac_f32_16x16x64_bf16 v[64:67], v[24:27], a[192:199], v172
    v_smfmac_f32_16x16x64_bf16 v[68:71], v[24:27], a[224:231], v172
g_51L14_1:
    s_waitcnt vmcnt(2)
    v_max3_u32 v19, v28, v29, v30
    v_max_u32 v19, v19, v31
    v_cmp_eq_u32 vcc, -1, v19
    s_nop 0
    s_cbranch_vccnz g_51F14_1
    v_smfmac_f32_16x16x64_bf16 v[64:67], v[28:31], a[200:207], v172
    v_smfmac_f32_16x16x64_bf16 v[68:71], v[28:31], a[232:239], v172
g_51L12_2:
    s_waitcnt vmcnt(1)
    v_max3_u32 v19, v32, v33, v34
    v_max_u32 v19, v19, v35
    v_cmp_eq_u32 vcc, -1, v19
    s_nop 0
    s_cbranch_vccnz g_51F12_2
    v_smfmac_f32_16x16x64_bf16 v[64:67], v[32:35], a[208:215], v172
    v_smfmac_f32_16x16x64_bf16 v[68:71], v[32:35], a[240:247], v172
g_51L8_3:
    s_waitcnt vmcnt(0)
    v_max3_u32 v19, v36, v37, v38
    v_max_u32 v19, v19, v39
    v_cmp_eq_u32 vcc, -1, v19
    s_nop 0
    s_cbranch_vccnz g_51F8_3
    v_smfmac_f32_16x16x64_bf16 v[64:67], v[36:39], a[216:223], v172
    v_smfmac_f32_16x16x64_bf16 v[68:71], v[36:39], a[248:255], v172
    s_nop 4
    v_cvt_pk_bf16_f32 v80, v64, v65
    v_cvt_pk_bf16_f32 v81, v66, v67
    s_nop 0
    v_cvt_pk_bf16_f32 v82, v68, v69
    v_cvt_pk_bf16_f32 v83, v70, v71
    s_nop 1
    v_mfma_f32_16x16x32_bf16 v[88:91], v[80:83], v[84:87], 0
    s_branch gc_52
g_51L15_1:
    s_waitcnt vmcnt(3)
    v_max3_u32 v19, v28, v29, v30
    v_max_u32 v19, v19, v31
    v_cmp_eq_u32 vcc, -1, v19
    s_nop 0
    s_cbranch_vccnz g_51F15_1
    v_smfmac_f32_16x16x64_bf16 v[64:67], v[28:31], a[200:207], v172
    v_smfmac_f32_16x16x64_bf16 v[68:71], v[28:31], a[232:239], v172
g_51L13_2:
    s_waitcnt vmcnt(2)
    v_max3_u32 v19, v32, v33, v34
    v_max_u32 v19, v19, v35
    v_cmp_eq_u32 vcc, -1, v19
    s_nop 0
    s_cbranch_vccnz g_51F13_2
    v_smfmac_f32_16x16x64_bf16 v[64:67], v[32:35], a[208:215], v172
    v_smfmac_f32_16x16x64_bf16 v[68:71], v[32:35], a[240:247], v172
g_51L9_3:
    s_waitcnt vmcnt(1)
    v_max3_u32 v19, v36, v37, v38
    v_max_u32 v19, v19, v39
    v_cmp_eq_u32 vcc, -1, v19
    s_nop 0
    s_cbranch_vccnz g_51F9_3
    v_smfmac_f32_16x16x64_bf16 v[64:67], v[36:39], a[216:223], v172
    v_smfmac_f32_16x16x64_bf16 v[68:71], v[36:39], a[248:255], v172
g_51L1_0:
    s_waitcnt vmcnt(0)
    v_max3_u32 v19, v24, v25, v26
    v_max_u32 v19, v19, v27
    v_cmp_eq_u32 vcc, -1, v19
    s_nop 0
    s_cbranch_vccnz g_51F1_0
    v_smfmac_f32_16x16x64_bf16 v[64:67], v[24:27], a[192:199], v172
    v_smfmac_f32_16x16x64_bf16 v[68:71], v[24:27], a[224:231], v172
    s_nop 4
    v_cvt_pk_bf16_f32 v80, v64, v65
    v_cvt_pk_bf16_f32 v81, v66, v67
    s_nop 0
    v_cvt_pk_bf16_f32 v82, v68, v69
    v_cvt_pk_bf16_f32 v83, v70, v71
    s_nop 1
    v_mfma_f32_16x16x32_bf16 v[88:91], v[80:83], v[84:87], 0
    s_branch gc_52
g_51L15_2:
    s_waitcnt vmcnt(3)
    v_max3_u32 v19, v32, v33, v34
    v_max_u32 v19, v19, v35
    v_cmp_eq_u32 vcc, -1, v19
    s_nop 0
    s_cbranch_vccnz g_51F15_2
    v_smfmac_f32_16x16x64_bf16 v[64:67], v[32:35], a[208:215], v172
    v_smfmac_f32_16x16x64_bf16 v[68:71], v[32:35], a[240:247], v172
g_51L11_3:
    s_waitcnt vmcnt(2)
    v_max3_u32 v19, v36, v37, v38
    v_max_u32 v19, v19, v39
    v_cmp_eq_u32 vcc, -1, v19
    s_nop 0
    s_cbranch_vccnz g_51F11_3
    v_smfmac_f32_16x16x64_bf16 v[64:67], v[36:39], a[216:223], v172
    v_smfmac_f32_16x16x64_bf16 v[68:71], v[36:39], a[248:255], v172
g_51L3_0:
    s_waitcnt vmcnt(1)
    v_max3_u32 v19, v24, v25, v26
    v_max_u32 v19, v19, v27
    v_cmp_eq_u32 vcc, -1, v19
    s_nop 0
    s_cbranch_vccnz g_51F3_0
    v_smfmac_f32_16x16x64_bf16 v[64:67], v[24:27], a[192:199], v172
    v_smfmac_f32_16x16x64_bf16 v[68:71], v[24:27], a[224:231], v172
g_51L2_1:
    s_waitcnt vmcnt(0)
    v_max3_u32 v19, v28, v29, v30
    v_max_u32 v19, v19, v31
    v_cmp_eq_u32 vcc, -1, v19
    s_nop 0
    s_cbranch_vccnz g_51F2_1
    v_smfmac_f32_16x16x64_bf16 v[64:67], v[28:31], a[200:207], v172
    v_smfmac_f32_16x16x64_bf16 v[68:71], v[28:31], a[232:239], v172
    s_nop 4
    v_cvt_pk_bf16_f32 v80, v64, v65
    v_cvt_pk_bf16_f32 v81, v66, v67
    s_nop 0
    v_cvt_pk_bf16_f32 v82, v68, v69
    v_cvt_pk_bf16_f32 v83, v70, v71
    s_nop 1
    v_mfma_f32_16x16x32_bf16 v[88:91], v[80:83], v[84:87], 0
    s_branch gc_52
g_51L15_3:
    s_waitcnt vmcnt(3)
    v_max3_u32 v19, v36, v37, v38
    v_max_u32 v19, v19, v39
    v_cmp_eq_u32 vcc, -1, v19
    s_nop 0
    s_cbranch_vccnz g_51F15_3
    v_smfmac_f32_16x16x64_bf16 v[64:67], v[36:39], a[216:223], v172
    v_smfmac_f32_16x16x64_bf16 v[68:71], v[36:39], a[248:255], v172
g_51L7_0:
    s_waitcnt vmcnt(2)
    v_max3_u32 v19, v24, v25, v26
    v_max_u32 v19, v19, v27
    v_cmp_eq_u32 vcc, -1, v19
    s_nop 0
    s_cbranch_vccnz g_51F7_0
    v_smfmac_f32_16x16x64_bf16 v[64:67], v[24:27], a[192:199], v172
    v_smfmac_f32_16x16x64_bf16 v[68:71], v[24:27], a[224:231], v172
g_51L6_1:
    s_waitcnt vmcnt(1)
    v_max3_u32 v19, v28, v29, v30
    v_max_u32 v19, v19, v31
    v_cmp_eq_u32 vcc, -1, v19
    s_nop 0
    s_cbranch_vccnz g_51F6_1
    v_smfmac_f32_16x16x64_bf16 v[64:67], v[28:31], a[200:207], v172
    v_smfmac_f32_16x16x64_bf16 v[68:71], v[28:31], a[232:239], v172
g_51L4_2:
    s_waitcnt vmcnt(0)
    v_max3_u32 v19, v32, v33, v34
    v_max_u32 v19, v19, v35
    v_cmp_eq_u32 vcc, -1, v19
    s_nop 0
    s_cbranch_vccnz g_51F4_2
    v_smfmac_f32_16x16x64_bf16 v[64:67], v[32:35], a[208:215], v172
    v_smfmac_f32_16x16x64_bf16 v[68:71], v[32:35], a[240:247], v172
    s_nop 4
    v_cvt_pk_bf16_f32 v80, v64, v65
    v_cvt_pk_bf16_f32 v81, v66, v67
    s_nop 0
    v_cvt_pk_bf16_f32 v82, v68, v69
    v_cvt_pk_bf16_f32 v83, v70, v71
    s_nop 1
    v_mfma_f32_16x16x32_bf16 v[88:91], v[80:83], v[84:87], 0
    s_branch gc_52
g_51L7_1:
    s_waitcnt vmcnt(2)
    v_max3_u32 v19, v28, v29, v30
    v_max_u32 v19, v19, v31
    v_cmp_eq_u32 vcc, -1, v19
    s_nop 0
    s_cbranch_vccnz g_51F7_1
    v_smfmac_f32_16x16x64_bf16 v[64:67], v[28:31], a[200:207], v172
    v_smfmac_f32_16x16x64_bf16 v[68:71], v[28:31], a[232:239], v172
g_51L5_2:
    s_waitcnt vmcnt(1)
    v_max3_u32 v19, v32, v33, v34
    v_max_u32 v19, v19, v35
    v_cmp_eq_u32 vcc, -1, v19
    s_nop 0
    s_cbranch_vccnz g_51F5_2
    v_smfmac_f32_16x16x64_bf16 v[64:67], v[32:35], a[208:215], v172
    v_smfmac_f32_16x16x64_bf16 v[68:71], v[32:35], a[240:247], v172
    s_branch g_51L1_0
g_51L7_2:
    s_waitcnt vmcnt(2)
    v_max3_u32 v19, v32, v33, v34
    v_max_u32 v19, v19, v35
    v_cmp_eq_u32 vcc, -1, v19
    s_nop 0
    s_cbranch_vccnz g_51F7_2
    v_smfmac_f32_16x16x64_bf16 v[64:67], v[32:35], a[208:215], v172
    v_smfmac_f32_16x16x64_bf16 v[68:71], v[32:35], a[240:247], v172
    s_branch g_51L3_0
g_51L11_0:
    s_waitcnt vmcnt(2)
    v_max3_u32 v19, v24, v25, v26
    v_max_u32 v19, v19, v27
    v_cmp_eq_u32 vcc, -1, v19
    s_nop 0
    s_cbranch_vccnz g_51F11_0
    v_smfmac_f32_16x16x64_bf16 v[64:67], v[24:27], a[192:199], v172
    v_smfmac_f32_16x16x64_bf16 v[68:71], v[24:27], a[224:231], v172
g_51L10_1:
    s_waitcnt vmcnt(1)
    v_max3_u32 v19, v28, v29, v30
    v_max_u32 v19, v19, v31
    v_cmp_eq_u32 vcc, -1, v19
    s_nop 0
    s_cbranch_vccnz g_51F10_1
    v_smfmac_f32_16x16x64_bf16 v[64:67], v[28:31], a[200:207], v172
    v_smfmac_f32_16x16x64_bf16 v[68:71], v[28:31], a[232:239], v172
    s_branch g_51L8_3
g_51L11_1:
    s_waitcnt vmcnt(2)
    v_max3_u32 v19, v28, v29, v30
    v_max_u32 v19, v19, v31
    v_cmp_eq_u32 vcc, -1, v19
    s_nop 0
    s_cbranch_vccnz g_51F11_1
    v_smfmac_f32_16x16x64_bf16 v[64:67], v[28:31], a[200:207], v172
    v_smfmac_f32_16x16x64_bf16 v[68:71], v[28:31], a[232:239], v172
    s_branch g_51L9_3
g_51L13_0:
    s_waitcnt vmcnt(2)
    v_max3_u32 v19, v24, v25, v26
    v_max_u32 v19, v19, v27
    v_cmp_eq_u32 vcc, -1, v19
    s_nop 0
    s_cbranch_vccnz g_51F13_0
    v_smfmac_f32_16x16x64_bf16 v[64:67], v[24:27], a[192:199], v172
    v_smfmac_f32_16x16x64_bf16 v[68:71], v[24:27], a[224:231], v172
    s_branch g_51L12_2
g_51L13_3:
    s_waitcnt vmcnt(2)
    v_max3_u32 v19, v36, v37, v38
    v_max_u32 v19, v19, v39
    v_cmp_eq_u32 vcc, -1, v19
    s_nop 0
    s_cbranch_vccnz g_51F13_3
    v_smfmac_f32_16x16x64_bf16 v[64:67], v[36:39], a[216:223], v172
    v_smfmac_f32_16x16x64_bf16 v[68:71], v[36:39], a[248:255], v172
g_51L5_0:
    s_waitcnt vmcnt(1)
    v_max3_u32 v19, v24, v25, v26
    v_max_u32 v19, v19, v27
    v_cmp_eq_u32 vcc, -1, v19
    s_nop 0
    s_cbranch_vccnz g_51F5_0
    v_smfmac_f32_16x16x64_bf16 v[64:67], v[24:27], a[192:199], v172
    v_smfmac_f32_16x16x64_bf16 v[68:71], v[24:27], a[224:231], v172
    s_branch g_51L4_2
g_51L14_2:
    s_waitcnt vmcnt(2)
    v_max3_u32 v19, v32, v33, v34
    v_max_u32 v19, v19, v35
    v_cmp_eq_u32 vcc, -1, v19
    s_nop 0
    s_cbranch_vccnz g_51F14_2
    v_smfmac_f32_16x16x64_bf16 v[64:67], v[32:35], a[208:215], v172
    v_smfmac_f32_16x16x64_bf16 v[68:71], v[32:35], a[240:247], v172
g_51L10_3:
    s_waitcnt vmcnt(1)
    v_max3_u32 v19, v36, v37, v38
    v_max_u32 v19, v19, v39
    v_cmp_eq_u32 vcc, -1, v19
    s_nop 0
    s_cbranch_vccnz g_51F10_3
    v_smfmac_f32_16x16x64_bf16 v[64:67], v[36:39], a[216:223], v172
    v_smfmac_f32_16x16x64_bf16 v[68:71], v[36:39], a[248:255], v172
    s_branch g_51L2_1
g_51L14_3:
    s_waitcnt vmcnt(2)
    v_max3_u32 v19, v36, v37, v38
    v_max_u32 v19, v19, v39
    v_cmp_eq_u32 vcc, -1, v19
    s_nop 0
    s_cbranch_vccnz g_51F14_3
    v_smfmac_f32_16x16x64_bf16 v[64:67], v[36:39], a[216:223], v172
    v_smfmac_f32_16x16x64_bf16 v[68:71], v[36:39], a[248:255], v172
    s_branch g_51L6_1
g_51L3_1:
    s_waitcnt vmcnt(1)
    v_max3_u32 v19, v28, v29, v30
    v_max_u32 v19, v19, v31
    v_cmp_eq_u32 vcc, -1, v19
    s_nop 0
    s_cbranch_vccnz g_51F3_1
    v_smfmac_f32_16x16x64_bf16 v[64:67], v[28:31], a[200:207], v172
    v_smfmac_f32_16x16x64_bf16 v[68:71], v[28:31], a[232:239], v172
    s_branch g_51L1_0
g_51L6_2:
    s_waitcnt vmcnt(1)
    v_max3_u32 v19, v32, v33, v34
    v_max_u32 v19, v19, v35
    v_cmp_eq_u32 vcc, -1, v19
    s_nop 0
    s_cbranch_vccnz g_51F6_2
    v_smfmac_f32_16x16x64_bf16 v[64:67], v[32:35], a[208:215], v172
    v_smfmac_f32_16x16x64_bf16 v[68:71], v[32:35], a[240:247], v172
    s_branch g_51L2_1
g_51L9_0:
    s_waitcnt vmcnt(1)
    v_max3_u32 v19, v24, v25, v26
    v_max_u32 v19, v19, v27
    v_cmp_eq_u32 vcc, -1, v19
    s_nop 0
    s_cbranch_vccnz g_51F9_0
    v_smfmac_f32_16x16x64_bf16 v[64:67], v[24:27], a[192:199], v172
    v_smfmac_f32_16x16x64_bf16 v[68:71], v[24:27], a[224:231], v172
    s_branch g_51L8_3
g_51L12_3:
    s_waitcnt vmcnt(1)
    v_max3_u32 v19, v36, v37, v38
    v_max_u32 v19, v19, v39
    v_cmp_eq_u32 vcc, -1, v19
    s_nop 0
    s_cbranch_vccnz g_51F12_3
    v_smfmac_f32_16x16x64_bf16 v[64:67], v[36:39], a[216:223], v172
    v_smfmac_f32_16x16x64_bf16 v[68:71], v[36:39], a[248:255], v172
    s_branch g_51L4_2
g_51F15_0:
    s_mov_b64 exec, vcc
    buffer_load_dwordx4 v[24:27], v8, s[4:7], s16 offen offset:0 sc1
    s_mov_b64 exec, -1
    s_add_u32 s23, s23, 1
    s_cmp_lt_u32 s23, 200000
    s_cbranch_scc1 g_51L15_1
    s_mov_b32 s25, 200000
    s_branch gc_52
g_51F15_1:
    s_mov_b64 exec, vcc
    buffer_load_dwordx4 v[28:31], v8, s[4:7], s16 offen offset:1024 sc1
    s_mov_b64 exec, -1
    s_add_u32 s23, s23, 1
    s_cmp_lt_u32 s23, 200000
    s_cbranch_scc1 g_51L15_2
    s_mov_b32 s25, 200000
    s_branch gc_52
g_51F15_2:
    s_mov_b64 exec, vcc
    buffer_load_dwordx4 v[32:35], v8, s[4:7], s16 offen offset:2048 sc1
    s_mov_b64 exec, -1
    s_add_u32 s23, s23, 1
    s_cmp_lt_u32 s23, 200000
    s_cbranch_scc1 g_51L15_3
    s_mov_b32 s25, 200000
    s_branch gc_52
g_51F15_3:
    s_mov_b64 exec, vcc
    buffer_load_dwordx4 v[36:39], v8, s[4:7], s16 offen offset:3072 sc1
    s_mov_b64 exec, -1
    s_add_u32 s23, s23, 1
    s_cmp_lt_u32 s23, 200000
    s_cbranch_scc1 g_51L15_0
    s_mov_b32 s25, 200000
    s_branch gc_52
g_51F7_0:
    s_mov_b64 exec, vcc
    buffer_load_dwordx4 v[24:27], v8, s[4:7], s16 offen offset:0 sc1
    s_mov_b64 exec, -1
    s_add_u32 s23, s23, 1
    s_cmp_lt_u32 s23, 200000
    s_cbranch_scc1 g_51L7_1
    s_mov_b32 s25, 200000
    s_branch gc_52
g_51F7_1:
    s_mov_b64 exec, vcc
    buffer_load_dwordx4 v[28:31], v8, s[4:7], s16 offen offset:1024 sc1
    s_mov_b64 exec, -1
    s_add_u32 s23, s23, 1
    s_cmp_lt_u32 s23, 200000
    s_cbranch_scc1 g_51L7_2
    s_mov_b32 s25, 200000
    s_branch gc_52
g_51F7_2:
    s_mov_b64 exec, vcc
    buffer_load_dwordx4 v[32:35], v8, s[4:7], s16 offen offset:2048 sc1
    s_mov_b64 exec, -1
    s_add_u32 s23, s23, 1
    s_cmp_lt_u32 s23, 200000
    s_cbranch_scc1 g_51L7_0
    s_mov_b32 s25, 200000
    s_branch gc_52
g_51F11_0:
    s_mov_b64 exec, vcc
    buffer_load_dwordx4 v[24:27], v8, s[4:7], s16 offen offset:0 sc1
    s_mov_b64 exec, -1
    s_add_u32 s23, s23, 1
    s_cmp_lt_u32 s23, 200000
    s_cbranch_scc1 g_51L11_1
    s_mov_b32 s25, 200000
    s_branch gc_52
g_51F11_1:
    s_mov_b64 exec, vcc
    buffer_load_dwordx4 v[28:31], v8, s[4:7], s16 offen offset:1024 sc1
    s_mov_b64 exec, -1
    s_add_u32 s23, s23, 1
    s_cmp_lt_u32 s23, 200000
    s_cbranch_scc1 g_51L11_3
    s_mov_b32 s25, 200000
    s_branch gc_52
g_51F11_3:
    s_mov_b64 exec, vcc
    buffer_load_dwordx4 v[36:39], v8, s[4:7], s16 offen offset:3072 sc1
    s_mov_b64 exec, -1
    s_add_u32 s23, s23, 1
    s_cmp_lt_u32 s23, 200000
    s_cbranch_scc1 g_51L11_0
    s_mov_b32 s25, 200000
    s_branch gc_52
g_51F13_0:
    s_mov_b64 exec, vcc
    buffer_load_dwordx4 v[24:27], v8, s[4:7], s16 offen offset:0 sc1
    s_mov_b64 exec, -1
    s_add_u32 s23, s23, 1
    s_cmp_lt_u32 s23, 200000
    s_cbranch_scc1 g_51L13_2
    s_mov_b32 s25, 200000
    s_branch gc_52
g_51F13_2:
    s_mov_b64 exec, vcc
    buffer_load_dwordx4 v[32:35], v8, s[4:7], s16 offen offset:2048 sc1
    s_mov_b64 exec, -1
    s_add_u32 s23, s23, 1
    s_cmp_lt_u32 s23, 200000
    s_cbranch_scc1 g_51L13_3
    s_mov_b32 s25, 200000
    s_branch gc_52
g_51F13_3:
    s_mov_b64 exec, vcc
    buffer_load_dwordx4 v[36:39], v8, s[4:7], s16 offen offset:3072 sc1
    s_mov_b64 exec, -1
    s_add_u32 s23, s23, 1
    s_cmp_lt_u32 s23, 200000
    s_cbranch_scc1 g_51L13_0
    s_mov_b32 s25, 200000
    s_branch gc_52
g_51F14_1:
    s_mov_b64 exec, vcc
    buffer_load_dwordx4 v[28:31], v8, s[4:7], s16 offen offset:1024 sc1
    s_mov_b64 exec, -1
    s_add_u32 s23, s23, 1
    s_cmp_lt_u32 s23, 200000
    s_cbranch_scc1 g_51L14_2
    s_mov_b32 s25, 200000
    s_branch gc_52
g_51F14_2:
    s_mov_b64 exec, vcc
    buffer_load_dwordx4 v[32:35], v8, s[4:7], s16 offen offset:2048 sc1
    s_mov_b64 exec, -1
    s_add_u32 s23, s23, 1
    s_cmp_lt_u32 s23, 200000
    s_cbranch_scc1 g_51L14_3
    s_mov_b32 s25, 200000
    s_branch gc_52
g_51F14_3:
    s_mov_b64 exec, vcc
    buffer_load_dwordx4 v[36:39], v8, s[4:7], s16 offen offset:3072 sc1
    s_mov_b64 exec, -1
    s_add_u32 s23, s23, 1
    s_cmp_lt_u32 s23, 200000
    s_cbranch_scc1 g_51L14_1
    s_mov_b32 s25, 200000
    s_branch gc_52
g_51F3_0:
    s_mov_b64 exec, vcc
    buffer_load_dwordx4 v[24:27], v8, s[4:7], s16 offen offset:0 sc1
    s_mov_b64 exec, -1
    s_add_u32 s23, s23, 1
    s_cmp_lt_u32 s23, 200000
    s_cbranch_scc1 g_51L3_1
    s_mov_b32 s25, 200000
    s_branch gc_52
g_51F3_1:
    s_mov_b64 exec, vcc
    buffer_load_dwordx4 v[28:31], v8, s[4:7], s16 offen offset:1024 sc1
    s_mov_b64 exec, -1
    s_add_u32 s23, s23, 1
    s_cmp_lt_u32 s23, 200000
    s_cbranch_scc1 g_51L3_0
    s_mov_b32 s25, 200000
    s_branch gc_52
g_51F5_0:
    s_mov_b64 exec, vcc
    buffer_load_dwordx4 v[24:27], v8, s[4:7], s16 offen offset:0 sc1
    s_mov_b64 exec, -1
    s_add_u32 s23, s23, 1
    s_cmp_lt_u32 s23, 200000
    s_cbranch_scc1 g_51L5_2
    s_mov_b32 s25, 200000
    s_branch gc_52
g_51F5_2:
    s_mov_b64 exec, vcc
    buffer_load_dwordx4 v[32:35], v8, s[4:7], s16 offen offset:2048 sc1
    s_mov_b64 exec, -1
    s_add_u32 s23, s23, 1
    s_cmp_lt_u32 s23, 200000
    s_cbranch_scc1 g_51L5_0
    s_mov_b32 s25, 200000
    s_branch gc_52
g_51F6_1:
    s_mov_b64 exec, vcc
    buffer_load_dwordx4 v[28:31], v8, s[4:7], s16 offen offset:1024 sc1
    s_mov_b64 exec, -1
    s_add_u32 s23, s23, 1
    s_cmp_lt_u32 s23, 200000
    s_cbranch_scc1 g_51L6_2
    s_mov_b32 s25, 200000
    s_branch gc_52
g_51F6_2:
    s_mov_b64 exec, vcc
    buffer_load_dwordx4 v[32:35], v8, s[4:7], s16 offen offset:2048 sc1
    s_mov_b64 exec, -1
    s_add_u32 s23, s23, 1
    s_cmp_lt_u32 s23, 200000
    s_cbranch_scc1 g_51L6_1
    s_mov_b32 s25, 200000
    s_branch gc_52
g_51F9_0:
    s_mov_b64 exec, vcc
    buffer_load_dwordx4 v[24:27], v8, s[4:7], s16 offen offset:0 sc1
    s_mov_b64 exec, -1
    s_add_u32 s23, s23, 1
    s_cmp_lt_u32 s23, 200000
    s_cbranch_scc1 g_51L9_3
    s_mov_b32 s25, 200000
    s_branch gc_52
g_51F9_3:
    s_mov_b64 exec, vcc
    buffer_load_dwordx4 v[36:39], v8, s[4:7], s16 offen offset:3072 sc1
    s_mov_b64 exec, -1
    s_add_u32 s23, s23, 1
    s_cmp_lt_u32 s23, 200000
    s_cbranch_scc1 g_51L9_0
    s_mov_b32 s25, 200000
    s_branch gc_52
g_51F10_1:
    s_mov_b64 exec, vcc
    buffer_load_dwordx4 v[28:31], v8, s[4:7], s16 offen offset:1024 sc1
    s_mov_b64 exec, -1
    s_add_u32 s23, s23, 1
    s_cmp_lt_u32 s23, 200000
    s_cbranch_scc1 g_51L10_3
    s_mov_b32 s25, 200000
    s_branch gc_52
g_51F10_3:
    s_mov_b64 exec, vcc
    buffer_load_dwordx4 v[36:39], v8, s[4:7], s16 offen offset:3072 sc1
    s_mov_b64 exec, -1
    s_add_u32 s23, s23, 1
    s_cmp_lt_u32 s23, 200000
    s_cbranch_scc1 g_51L10_1
    s_mov_b32 s25, 200000
    s_branch gc_52
g_51F12_2:
    s_mov_b64 exec, vcc
    buffer_load_dwordx4 v[32:35], v8, s[4:7], s16 offen offset:2048 sc1
    s_mov_b64 exec, -1
    s_add_u32 s23, s23, 1
    s_cmp_lt_u32 s23, 200000
    s_cbranch_scc1 g_51L12_3
    s_mov_b32 s25, 200000
    s_branch gc_52
g_51F12_3:
    s_mov_b64 exec, vcc
    buffer_load_dwordx4 v[36:39], v8, s[4:7], s16 offen offset:3072 sc1
    s_mov_b64 exec, -1
    s_add_u32 s23, s23, 1
    s_cmp_lt_u32 s23, 200000
    s_cbranch_scc1 g_51L12_2
    s_mov_b32 s25, 200000
    s_branch gc_52
g_51F1_0:
    s_mov_b64 exec, vcc
    buffer_load_dwordx4 v[24:27], v8, s[4:7], s16 offen offset:0 sc1
    s_mov_b64 exec, -1
    s_add_u32 s23, s23, 1
    s_cmp_lt_u32 s23, 200000
    s_cbranch_scc1 g_51L1_0
    s_mov_b32 s25, 200000
    s_branch gc_52
g_51F2_1:
    s_mov_b64 exec, vcc
    buffer_load_dwordx4 v[28:31], v8, s[4:7], s16 offen offset:1024 sc1
    s_mov_b64 exec, -1
    s_add_u32 s23, s23, 1
    s_cmp_lt_u32 s23, 200000
    s_cbranch_scc1 g_51L2_1
    s_mov_b32 s25, 200000
    s_branch gc_52
g_51F4_2:
    s_mov_b64 exec, vcc
    buffer_load_dwordx4 v[32:35], v8, s[4:7], s16 offen offset:2048 sc1
    s_mov_b64 exec, -1
    s_add_u32 s23, s23, 1
    s_cmp_lt_u32 s23, 200000
    s_cbranch_scc1 g_51L4_2
    s_mov_b32 s25, 200000
    s_branch gc_52
g_51F8_3:
    s_mov_b64 exec, vcc
    buffer_load_dwordx4 v[36:39], v8, s[4:7], s16 offen offset:3072 sc1
    s_mov_b64 exec, -1
    s_add_u32 s23, s23, 1
    s_cmp_lt_u32 s23, 200000
    s_cbranch_scc1 g_51L8_3
    s_mov_b32 s25, 200000
    s_branch gc_52
pr_53:
    s_waitcnt vmcnt(3)
    v_pk_add_f32 v[120:121], v[88:89], v[108:109]
    v_pk_add_f32 v[122:123], v[90:91], v[110:111]
    s_waitcnt vmcnt(2)
    v_pk_add_f32 v[120:121], v[120:121], v[112:113]
    v_pk_add_f32 v[122:123], v[122:123], v[114:115]
    s_waitcnt vmcnt(1)
    v_pk_add_f32 v[120:121], v[120:121], v[116:117]
    v_pk_add_f32 v[122:123], v[122:123], v[118:119]
    v_cvt_pk_bf16_f32 v180, v120, v121
    v_pk_add_f32 v[124:125], v[120:121], v[122:123]
    v_cvt_pk_bf16_f32 v181, v122, v123
    v_cmpx_o_f32 vcc, v124, v125
    buffer_store_dwordx2 v[180:181], v11, s[4:7], s42 offen
    s_cmp_eq_u64 vcc, -1
    s_mov_b64 exec, -1
    s_cbranch_scc0 pq_56
    s_branch pg_54
pb_55:
    s_waitcnt vmcnt(2)
    v_pk_add_f32 v[120:121], v[88:89], v[108:109]
    v_pk_add_f32 v[122:123], v[90:91], v[110:111]
    s_waitcnt vmcnt(1)
    v_pk_add_f32 v[120:121], v[120:121], v[112:113]
    v_pk_add_f32 v[122:123], v[122:123], v[114:115]
    s_waitcnt vmcnt(0)
    v_pk_add_f32 v[120:121], v[120:121], v[116:117]
    v_pk_add_f32 v[122:123], v[122:123], v[118:119]
    v_cvt_pk_bf16_f32 v180, v120, v121
    v_pk_add_f32 v[124:125], v[120:121], v[122:123]
    v_cvt_pk_bf16_f32 v181, v122, v123
    v_cmpx_o_f32 vcc, v124, v125
    buffer_store_dwordx2 v[180:181], v11, s[4:7], s42 offen
    s_cmp_eq_u64 vcc, -1
    s_mov_b64 exec, -1
    s_cbranch_scc0 pq_56
    s_branch pg_54
pq_56:
    v_max3_u32 v19, v108, v109, v110
    v_max3_u32 v19, v19, v111, v112
    v_max3_u32 v19, v19, v113, v114
    v_max3_u32 v19, v19, v115, v116
    v_max3_u32 v19, v19, v117, v118
    v_max_u32 v19, v19, v119
    v_cmp_eq_u32 vcc, -1, v19
    s_nop 0
    s_cbranch_vccz pf_57
    buffer_load_dwordx4 v[108:111], v10, s[4:7], s22 offen sc1
    buffer_load_dwordx4 v[112:115], v23, s[4:7], s22 offen sc1
    buffer_load_dwordx4 v[116:119], v244, s[4:7], s22 offen sc1
    s_add_u32 s23, s23, 1
    s_cmp_lt_u32 s23, 200000
    s_cbranch_scc1 pb_55
    s_mov_b32 s25, 200000
pf_57:
    buffer_store_dwordx2 v[180:181], v11, s[4:7], s42 offen
    s_branch pg_54
.p2align 6
recur_slow_w0:
    s_nop 15
    s_mov_b32 s23, s25
g_58:
    buffer_load_dwordx4 v[24:27], v2, s[4:7], s16 offen offset:0 sc1
    buffer_load_dwordx4 v[28:31], v2, s[4:7], s16 offen offset:1024 sc1
    buffer_load_dwordx4 v[32:35], v2, s[4:7], s16 offen offset:2048 sc1
    buffer_load_dwordx4 v[36:39], v2, s[4:7], s16 offen offset:3072 sc1
    s_waitcnt vmcnt(0)
    v_max3_u32 v19, v24, v25, v26
    v_max3_u32 v19, v19, v27, v28
    v_max3_u32 v19, v19, v29, v30
    v_max3_u32 v19, v19, v31, v32
    v_max3_u32 v19, v19, v33, v34
    v_max3_u32 v19, v19, v35, v36
    v_max3_u32 v19, v19, v37, v38
    v_max_u32 v19, v19, v39
    v_cmp_eq_u32 vcc, -1, v19
    s_nop 0
    s_cbranch_vccz g_58k
    s_add_u32 s23, s23, 1
    s_cmp_lt_u32 s23, 200000
    s_cbranch_scc1 g_58
    s_mov_b32 s25, 200000
g_58k:
    v_smfmac_f32_16x16x64_bf16 v[40:43], v[24:27], a[0:7], v172
    v_smfmac_f32_16x16x64_bf16 v[44:47], v[24:27], a[64:71], v172
    v_smfmac_f32_16x16x64_bf16 v[48:51], v[24:27], a[32:39], v172
    v_smfmac_f32_16x16x64_bf16 v[52:55], v[24:27], a[96:103], v172
    v_smfmac_f32_16x16x64_bf16 v[40:43], v[28:31], a[8:15], v172
    v_smfmac_f32_16x16x64_bf16 v[44:47], v[28:31], a[72:79], v172
    v_smfmac_f32_16x16x64_bf16 v[48:51], v[28:31], a[40:47], v172
    v_smfmac_f32_16x16x64_bf16 v[52:55], v[28:31], a[104:111], v172
    v_smfmac_f32_16x16x64_bf16 v[40:43], v[32:35], a[16:23], v172
    v_smfmac_f32_16x16x64_bf16 v[44:47], v[32:35], a[80:87], v172
    v_smfmac_f32_16x16x64_bf16 v[48:51], v[32:35], a[48:55], v172
    v_smfmac_f32_16x16x64_bf16 v[52:55], v[32:35], a[112:119], v172
    v_smfmac_f32_16x16x64_bf16 v[40:43], v[36:39], a[24:31], v172
    v_smfmac_f32_16x16x64_bf16 v[44:47], v[36:39], a[88:95], v172
    v_smfmac_f32_16x16x64_bf16 v[48:51], v[36:39], a[56:63], v172
    v_smfmac_f32_16x16x64_bf16 v[52:55], v[36:39], a[120:127], v172
    v_cvt_pk_bf16_f32 v72, v40, v41
    v_cvt_pk_bf16_f32 v73, v42, v43
    v_cvt_pk_bf16_f32 v74, v44, v45
    v_cvt_pk_bf16_f32 v75, v46, v47
    v_smfmac_f32_16x16x64_bf16 v[56:59], v[24:27], a[128:135], v172
    v_cvt_pk_bf16_f32 v76, v48, v49
    v_cvt_pk_bf16_f32 v77, v50, v51
    s_nop 0
    v_cvt_pk_bf16_f32 v78, v52, v53
    v_cvt_pk_bf16_f32 v79, v54, v55
    v_smfmac_f32_16x16x64_bf16 v[60:63], v[24:27], a[160:167], v172
    v_mfma_f32_16x16x32_bf16 v[88:91], v[72:75], v[84:87], 0
    v_mfma_f32_16x16x32_bf16 v[92:95], v[76:79], v[84:87], 0
    v_smfmac_f32_16x16x64_bf16 v[56:59], v[28:31], a[136:143], v172
    v_smfmac_f32_16x16x64_bf16 v[60:63], v[28:31], a[168:175], v172
    s_barrier
    ds_read_b128 v[104:107], v16 offset:2048
    ds_read_b128 v[108:111], v16 offset:3072
    ds_read_b128 v[112:115], v16 offset:4096
    ds_read_b128 v[116:119], v16 offset:5120
    ds_read_b128 v[120:123], v16 offset:6144
    ds_read_b128 v[124:127], v16 offset:7168
    v_smfmac_f32_16x16x64_bf16 v[56:59], v[32:35], a[144:151], v172
    v_smfmac_f32_16x16x64_bf16 v[60:63], v[32:35], a[176:183], v172
    v_smfmac_f32_16x16x64_bf16 v[56:59], v[36:39], a[152:159], v172
    v_smfmac_f32_16x16x64_bf16 v[60:63], v[36:39], a[184:191], v172
    s_waitcnt lgkmcnt(5)
    v_mfma_f32_16x16x32_bf16 v[88:91], v[104:107], v[84:87], v[88:91]
    s_waitcnt lgkmcnt(4)
    v_mfma_f32_16x16x32_bf16 v[92:95], v[108:111], v[84:87], v[92:95]
    s_waitcnt lgkmcnt(3)
    v_mfma_f32_16x16x32_bf16 v[88:91], v[112:115], v[84:87], v[88:91]
    s_waitcnt lgkmcnt(2)
    v_mfma_f32_16x16x32_bf16 v[92:95], v[116:119], v[84:87], v[92:95]
    s_waitcnt lgkmcnt(1)
    v_mfma_f32_16x16x32_bf16 v[88:91], v[120:123], v[84:87], v[88:91]
    s_waitcnt lgkmcnt(0)
    v_mfma_f32_16x16x32_bf16 v[92:95], v[124:127], v[84:87], v[92:95]
    v_cvt_pk_bf16_f32 v80, v56, v57
    v_cvt_pk_bf16_f32 v81, v58, v59
    v_cvt_pk_bf16_f32 v82, v60, v61
    v_cvt_pk_bf16_f32 v83, v62, v63
    ds_write_b128 v17, v[80:83] offset:8192
    s_nop 0
    v_cvt_pk_bf16_f32 v128, v88, v89
    v_cvt_pk_bf16_f32 v129, v90, v91
    v_cvt_pk_bf16_f32 v130, v92, v93
    v_cvt_pk_bf16_f32 v131, v94, v95
    s_nop 1
    v_mfma_f32_16x16x32_bf16 v[144:147], v[132:135], v[128:131], 0
    v_mfma_f32_16x16x32_bf16 v[148:151], v[136:139], v[128:131], 0
    v_mfma_f32_16x16x32_bf16 v[140:143], v[128:131], v[128:131], 0
    s_nop 1
    buffer_store_dwordx4 v[144:147], v3, s[4:7], s16 offen sc1
    s_nop 1
    buffer_store_dwordx4 v[148:151], v3, s[4:7], s16 offen offset:128 sc1
    s_nop 1
    buffer_store_dwordx4 v[140:143], v4, s[4:7], s16 offen sc1
    s_cmp_eq_u32 s15, 63
    s_waitcnt lgkmcnt(0)
    s_barrier
    s_cbranch_scc1 recur_slow_last0
    v_readfirstlane_b32 s85, v247
    s_add_u32 s94, s15, 2
    s_barrier
    s_nop 15
    s_mov_b32 s23, s25
g_59:
    buffer_load_dwordx4 v[24:27], v8, s[4:7], s16 offen offset:0 sc1
    buffer_load_dwordx4 v[28:31], v8, s[4:7], s16 offen offset:1024 sc1
    buffer_load_dwordx4 v[32:35], v8, s[4:7], s16 offen offset:2048 sc1
    buffer_load_dwordx4 v[36:39], v8, s[4:7], s16 offen offset:3072 sc1
    s_waitcnt vmcnt(0)
    v_max3_u32 v19, v24, v25, v26
    v_max3_u32 v19, v19, v27, v28
    v_max3_u32 v19, v19, v29, v30
    v_max3_u32 v19, v19, v31, v32
    v_max3_u32 v19, v19, v33, v34
    v_max3_u32 v19, v19, v35, v36
    v_max3_u32 v19, v19, v37, v38
    v_max_u32 v19, v19, v39
    v_cmp_eq_u32 vcc, -1, v19
    s_nop 0
    s_cbranch_vccz g_59k
    s_add_u32 s23, s23, 1
    s_cmp_lt_u32 s23, 200000
    s_cbranch_scc1 g_59
    s_mov_b32 s25, 200000
g_59k:
    v_smfmac_f32_16x16x64_bf16 v[64:67], v[24:27], a[192:199], v172
    v_smfmac_f32_16x16x64_bf16 v[68:71], v[24:27], a[224:231], v172
    v_smfmac_f32_16x16x64_bf16 v[64:67], v[28:31], a[200:207], v172
    v_smfmac_f32_16x16x64_bf16 v[68:71], v[28:31], a[232:239], v172
    v_smfmac_f32_16x16x64_bf16 v[64:67], v[32:35], a[208:215], v172
    v_smfmac_f32_16x16x64_bf16 v[68:71], v[32:35], a[240:247], v172
    v_smfmac_f32_16x16x64_bf16 v[64:67], v[36:39], a[216:223], v172
    v_smfmac_f32_16x16x64_bf16 v[68:71], v[36:39], a[248:255], v172
    s_nop 4
    v_cvt_pk_bf16_f32 v80, v64, v65
    v_cvt_pk_bf16_f32 v81, v66, v67
    s_nop 0
    v_cvt_pk_bf16_f32 v82, v68, v69
    v_cvt_pk_bf16_f32 v83, v70, v71
    ds_write_b128 v17, v[80:83] offset:9216
    s_waitcnt lgkmcnt(0)
    s_barrier
    s_mov_b32 s23, s25
fw_60:
    s_cmp_ge_u32 s85, s94
    s_cbranch_scc1 fo_61
    buffer_load_dword v247, v245, s[4:7], 0 offen sc1
    s_add_u32 s23, s23, 1
    s_waitcnt vmcnt(0)
    v_readfirstlane_b32 s85, v247
    s_cmp_lt_u32 s23, 200000
    s_cbranch_scc1 fw_60
    s_mov_b32 s25, 200000
fo_61:
    buffer_load_dwordx4 v[132:135], v12, s[4:7], s17 offen sc1
    buffer_load_dwordx4 v[136:139], v12, s[4:7], s17 offen offset:128 sc1
    s_add_u32 s17, s17, 2048
    s_min_u32 s17, s17, 17954816
    s_nop 15
    s_nop 15
    s_nop 15
    s_nop 15
    buffer_store_dwordx4 v[128:131], v14, s[4:7], s19 offen sc1
    s_add_u32 s19, s19, 512
    s_add_u32 s21, s15, 3
    s_min_u32 s21, s21, 64
    s_cmp_lt_u32 s85, s21
    s_cselect_b64 exec, 1, 0
    buffer_load_dword v247, v245, s[4:7], 0 offen sc1
    s_mov_b64 exec, -1
    v_mov_b32 v40, 0
    v_mov_b32 v41, 0
    v_mov_b32 v42, 0
    v_mov_b32 v43, 0
    v_mov_b32 v44, 0
    v_mov_b32 v45, 0
    v_mov_b32 v46, 0
    v_mov_b32 v47, 0
    v_mov_b32 v48, 0
    v_mov_b32 v49, 0
    v_mov_b32 v50, 0
    v_mov_b32 v51, 0
    v_mov_b32 v52, 0
    v_mov_b32 v53, 0
    v_mov_b32 v54, 0
    v_mov_b32 v55, 0
    v_mov_b32 v56, 0
    v_mov_b32 v57, 0
    v_mov_b32 v58, 0
    v_mov_b32 v59, 0
    v_mov_b32 v60, 0
    v_mov_b32 v61, 0
    v_mov_b32 v62, 0
    v_mov_b32 v63, 0
    v_mov_b32 v64, 0
    v_mov_b32 v65, 0
    v_mov_b32 v66, 0
    v_mov_b32 v67, 0
    v_mov_b32 v68, 0
    v_mov_b32 v69, 0
    v_mov_b32 v70, 0
    v_mov_b32 v71, 0
    s_mov_b32 s21, s16
    s_mov_b32 s16, s42
    s_mov_b32 s42, s43
    s_mov_b32 s43, s44
    s_mov_b32 s44, s21
    s_add_u32 s95, s95, 524288
    s_lshr_b32 s84, s95, 8
    s_and_b32 s84, s84, 8192
    s_xor_b32 s84, s84, s46
    s_add_u32 s84, s84, s95
    s_add_u32 s15, s15, 1
    s_barrier
    s_branch recur_slow_w0
recur_slow_last0:
    buffer_store_dwordx4 v[128:131], v14, s[4:7], s19 offen sc1
    s_waitcnt vmcnt(0)
    s_branch recur_end
.p2align 6
recur_slow_w1:
    s_nop 15
    s_mov_b32 s23, s25
g_62:
    buffer_load_dwordx4 v[24:27], v2, s[4:7], s16 offen offset:0 sc1
    buffer_load_dwordx4 v[28:31], v2, s[4:7], s16 offen offset:1024 sc1
    buffer_load_dwordx4 v[32:35], v2, s[4:7], s16 offen offset:2048 sc1
    buffer_load_dwordx4 v[36:39], v2, s[4:7], s16 offen offset:3072 sc1
    s_waitcnt vmcnt(0)
    v_max3_u32 v19, v24, v25, v26
    v_max3_u32 v19, v19, v27, v28
    v_max3_u32 v19, v19, v29, v30
    v_max3_u32 v19, v19, v31, v32
    v_max3_u32 v19, v19, v33, v34
    v_max3_u32 v19, v19, v35, v36
    v_max3_u32 v19, v19, v37, v38
    v_max_u32 v19, v19, v39
    v_cmp_eq_u32 vcc, -1, v19
    s_nop 0
    s_cbranch_vccz g_62k
    s_add_u32 s23, s23, 1
    s_cmp_lt_u32 s23, 200000
    s_cbranch_scc1 g_62
    s_mov_b32 s25, 200000
g_62k:
    v_smfmac_f32_16x16x64_bf16 v[40:43], v[24:27], a[0:7], v172
    v_smfmac_f32_16x16x64_bf16 v[44:47], v[24:27], a[64:71], v172
    v_smfmac_f32_16x16x64_bf16 v[48:51], v[24:27], a[32:39], v172
    v_smfmac_f32_16x16x64_bf16 v[52:55], v[24:27], a[96:103], v172
    v_smfmac_f32_16x16x64_bf16 v[40:43], v[28:31], a[8:15], v172
    v_smfmac_f32_16x16x64_bf16 v[44:47], v[28:31], a[72:79], v172
    v_smfmac_f32_16x16x64_bf16 v[48:51], v[28:31], a[40:47], v172
    v_smfmac_f32_16x16x64_bf16 v[52:55], v[28:31], a[104:111], v172
    v_smfmac_f32_16x16x64_bf16 v[40:43], v[32:35], a[16:23], v172
    v_smfmac_f32_16x16x64_bf16 v[44:47], v[32:35], a[80:87], v172
    v_smfmac_f32_16x16x64_bf16 v[48:51], v[32:35], a[48:55], v172
    v_smfmac_f32_16x16x64_bf16 v[52:55], v[32:35], a[112:119], v172
    v_smfmac_f32_16x16x64_bf16 v[40:43], v[36:39], a[24:31], v172
    v_smfmac_f32_16x16x64_bf16 v[44:47], v[36:39], a[88:95], v172
    v_smfmac_f32_16x16x64_bf16 v[48:51], v[36:39], a[56:63], v172
    v_smfmac_f32_16x16x64_bf16 v[52:55], v[36:39], a[120:127], v172
    v_cvt_pk_bf16_f32 v72, v40, v41
    v_cvt_pk_bf16_f32 v73, v42, v43
    v_cvt_pk_bf16_f32 v74, v44, v45
    v_cvt_pk_bf16_f32 v75, v46, v47
    ds_write_b128 v17, v[72:75] offset:0
    v_cvt_pk_bf16_f32 v76, v48, v49
    v_cvt_pk_bf16_f32 v77, v50, v51
    s_nop 0
    v_cvt_pk_bf16_f32 v78, v52, v53
    v_cvt_pk_bf16_f32 v79, v54, v55
    ds_write_b128 v17, v[76:79] offset:1024
    v_smfmac_f32_16x16x64_bf16 v[56:59], v[24:27], a[128:135], v172
    v_smfmac_f32_16x16x64_bf16 v[60:63], v[24:27], a[160:167], v172
    v_smfmac_f32_16x16x64_bf16 v[56:59], v[28:31], a[136:143], v172
    s_waitcnt lgkmcnt(0)
    s_barrier
    v_smfmac_f32_16x16x64_bf16 v[60:63], v[28:31], a[168:175], v172
    v_smfmac_f32_16x16x64_bf16 v[56:59], v[32:35], a[144:151], v172
    v_smfmac_f32_16x16x64_bf16 v[60:63], v[32:35], a[176:183], v172
    v_smfmac_f32_16x16x64_bf16 v[56:59], v[36:39], a[152:159], v172
    v_smfmac_f32_16x16x64_bf16 v[60:63], v[36:39], a[184:191], v172
    s_nop 4
    v_cvt_pk_bf16_f32 v80, v56, v57
    v_cvt_pk_bf16_f32 v81, v58, v59
    s_nop 0
    v_cvt_pk_bf16_f32 v82, v60, v61
    v_cvt_pk_bf16_f32 v83, v62, v63
    ds_write_b128 v17, v[80:83] offset:8192
    v_mov_b32 v152, v228
    v_mov_b32 v153, v229
    v_mov_b32 v156, v230
    v_mov_b32 v157, v231
    v_mov_b32 v160, v232
    v_mov_b32 v161, v233
    v_mov_b32 v164, v234
    v_mov_b32 v165, v235
    s_cmp_eq_u32 s15, 63
    s_waitcnt lgkmcnt(0)
    s_barrier
    s_cbranch_scc1 recur_end
    s_nop 15
    s_nop 15
    s_nop 7
    buffer_load_dwordx4 v[208:211], v5, s[4:7], s16 offen offset:0 sc1
    buffer_load_dwordx4 v[212:215], v5, s[4:7], s16 offen offset:1024 sc1
    buffer_load_dwordx4 v[216:219], v5, s[4:7], s16 offen offset:2048 sc1
    buffer_load_dwordx4 v[220:223], v5, s[4:7], s16 offen offset:3072 sc1
    buffer_load_dword v224, v6, s[4:7], s16 offen offset:0 sc1
    buffer_load_dword v225, v6, s[4:7], s16 offen offset:256 sc1
    buffer_load_dword v226, v6, s[4:7], s16 offen offset:512 sc1
    buffer_load_dword v227, v6, s[4:7], s16 offen offset:768 sc1
    s_mov_b32 s23, s25
    ds_read_b128 v[96:99], v16 offset:8192
    ds_read_b128 v[104:107], v16 offset:12288
    ds_read_b128 v[108:111], v16 offset:14336
    v_mfma_f32_16x16x32_bf16 v[140:143], v[84:87], v[80:83], 0
    s_waitcnt lgkmcnt(2)
    v_mfma_f32_16x16x32_bf16 v[140:143], v[84:87], v[96:99], v[140:143]
    s_waitcnt lgkmcnt(1)
    v_mfma_f32_16x16x32_bf16 v[140:143], v[84:87], v[104:107], v[140:143]
    s_waitcnt lgkmcnt(0)
    v_mfma_f32_16x16x32_bf16 v[140:143], v[84:87], v[108:111], v[140:143]
    buffer_load_dwordx4 v[24:27], v5, s[4:7], s16 offen offset:0 sc1
    buffer_load_dwordx4 v[28:31], v5, s[4:7], s16 offen offset:1024 sc1
    buffer_load_dwordx4 v[32:35], v5, s[4:7], s16 offen offset:2048 sc1
    buffer_load_dwordx4 v[36:39], v5, s[4:7], s16 offen offset:3072 sc1
    buffer_load_dword v40, v6, s[4:7], s16 offen offset:0 sc1
    buffer_load_dword v41, v6, s[4:7], s16 offen offset:256 sc1
    buffer_load_dword v42, v6, s[4:7], s16 offen offset:512 sc1
    buffer_load_dword v43, v6, s[4:7], s16 offen offset:768 sc1
    v_cvt_pk_bf16_f32 v154, v140, v179
    v_cvt_pk_bf16_f32 v158, v141, v179
    v_cvt_pk_bf16_f32 v162, v142, v179
    v_cvt_pk_bf16_f32 v166, v143, v179
    s_waitcnt vmcnt(14)
    v_pk_add_f32 v[180:181], v[208:209], v[212:213]
    v_pk_add_f32 v[182:183], v[210:211], v[214:215]
    s_waitcnt vmcnt(12)
    v_pk_add_f32 v[188:189], v[216:217], v[220:221]
    v_pk_add_f32 v[190:191], v[218:219], v[222:223]
    v_pk_add_f32 v[180:181], v[180:181], v[188:189]
    v_pk_add_f32 v[182:183], v[182:183], v[190:191]
    v_pk_add_f32 v[188:189], v[180:181], v[182:183]
    v_max3_f32 v185, v180, v181, v182
    s_waitcnt vmcnt(8)
    v_pk_add_f32 v[192:193], v[224:225], v[226:227]
    v_add_f32 v188, v188, v189
    v_add_f32 v184, v192, v193
    v_max3_f32 v185, v185, v183, v184
    v_cmp_u_f32 vcc, v188, v184
    s_nop 0
    v_max_f32_dpp v185, v185, v185 row_ror:8 row_mask:0xf bank_mask:0xf
    v_mov_b32 v186, v185
    s_nop 1
    v_permlane16_swap_b32 v185, v186
    v_max_f32 v185, v185, v186
    v_mov_b32 v186, v185
    s_cbranch_vccnz ss_63r
sg_65:
    s_nop 0
    v_permlane32_swap_b32 v185, v186
    v_max_f32 v185, v185, v186
    v_mul_f32 v185, s24, v185
    v_fma_f32 v180, v180, s24, -v185
    v_fma_f32 v181, v181, s24, -v185
    v_fma_f32 v182, v182, s24, -v185
    v_fma_f32 v183, v183, s24, -v185
    v_fma_f32 v184, v184, s24, -v185
    v_exp_f32 v180, v180
    v_exp_f32 v181, v181
    v_exp_f32 v182, v182
    v_exp_f32 v183, v183
    v_exp_f32 v184, v184
    v_cvt_pk_bf16_f32 v176, v180, v181
    v_cvt_pk_bf16_f32 v177, v182, v183
    v_cvt_pk_bf16_f32 v178, v184, v179
    s_nop 1
    v_mfma_f32_16x16x32_bf16 v[240:243], v[236:239], v[176:179], 0
    v_mfma_f32_16x16x32_bf16 v[188:191], v[152:155], v[176:179], 0
    v_mfma_f32_16x16x32_bf16 v[192:195], v[156:159], v[176:179], 0
    v_mfma_f32_16x16x32_bf16 v[196:199], v[160:163], v[176:179], 0
    v_mfma_f32_16x16x32_bf16 v[200:203], v[164:167], v[176:179], 0
    v_add_f32_dpp v185, v240, v240 row_ror:8 row_mask:0xf bank_mask:0xf
    v_rcp_f32 v185, v185
    v_add_f32_dpp v88, v192, v188 row_ror:8 row_mask:0xf bank_mask:0x3
    v_add_f32_dpp v89, v193, v189 row_ror:8 row_mask:0xf bank_mask:0x3
    v_add_f32_dpp v90, v194, v190 row_ror:8 row_mask:0xf bank_mask:0x3
    v_add_f32_dpp v91, v195, v191 row_ror:8 row_mask:0xf bank_mask:0x3
    s_nop 1
    v_add_f32_dpp v88, v196, v200 row_ror:8 row_mask:0xf bank_mask:0xc
    v_add_f32_dpp v89, v197, v201 row_ror:8 row_mask:0xf bank_mask:0xc
    v_add_f32_dpp v90, v198, v202 row_ror:8 row_mask:0xf bank_mask:0xc
    v_add_f32_dpp v91, v199, v203 row_ror:8 row_mask:0xf bank_mask:0xc
    v_mul_f32 v88, v88, v185
    v_mul_f32 v89, v89, v185
    v_mul_f32 v90, v90, v185
    v_mul_f32 v91, v91, v185
    v_cvt_pk_bf16_f32 v88, v88, v89
    v_cvt_pk_bf16_f32 v89, v90, v91
    buffer_store_dwordx2 v[88:89], v7, s[4:7], s16 offen sc1
    v_readfirstlane_b32 s85, v247
    s_add_u32 s94, s15, 2
    s_barrier
    s_nop 15
    s_mov_b32 s23, s25
g_66:
    buffer_load_dwordx4 v[24:27], v8, s[4:7], s16 offen offset:0 sc1
    buffer_load_dwordx4 v[28:31], v8, s[4:7], s16 offen offset:1024 sc1
    buffer_load_dwordx4 v[32:35], v8, s[4:7], s16 offen offset:2048 sc1
    buffer_load_dwordx4 v[36:39], v8, s[4:7], s16 offen offset:3072 sc1
    s_waitcnt vmcnt(0)
    v_max3_u32 v19, v24, v25, v26
    v_max3_u32 v19, v19, v27, v28
    v_max3_u32 v19, v19, v29, v30
    v_max3_u32 v19, v19, v31, v32
    v_max3_u32 v19, v19, v33, v34
    v_max3_u32 v19, v19, v35, v36
    v_max3_u32 v19, v19, v37, v38
    v_max_u32 v19, v19, v39
    v_cmp_eq_u32 vcc, -1, v19
    s_nop 0
    s_cbranch_vccz g_66k
    s_add_u32 s23, s23, 1
    s_cmp_lt_u32 s23, 200000
    s_cbranch_scc1 g_66
    s_mov_b32 s25, 200000
g_66k:
    v_smfmac_f32_16x16x64_bf16 v[64:67], v[24:27], a[192:199], v172
    v_smfmac_f32_16x16x64_bf16 v[68:71], v[24:27], a[224:231], v172
    v_smfmac_f32_16x16x64_bf16 v[64:67], v[28:31], a[200:207], v172
    v_smfmac_f32_16x16x64_bf16 v[68:71], v[28:31], a[232:239], v172
    v_smfmac_f32_16x16x64_bf16 v[64:67], v[32:35], a[208:215], v172
    v_smfmac_f32_16x16x64_bf16 v[68:71], v[32:35], a[240:247], v172
    v_smfmac_f32_16x16x64_bf16 v[64:67], v[36:39], a[216:223], v172
    v_smfmac_f32_16x16x64_bf16 v[68:71], v[36:39], a[248:255], v172
    s_nop 4
    v_cvt_pk_bf16_f32 v80, v64, v65
    v_cvt_pk_bf16_f32 v81, v66, v67
    s_nop 0
    v_cvt_pk_bf16_f32 v82, v68, v69
    v_cvt_pk_bf16_f32 v83, v70, v71
    ds_write_b128 v17, v[80:83] offset:9216
    s_waitcnt lgkmcnt(0)
    s_barrier
    s_mov_b32 s23, s25
fw_67:
    s_cmp_ge_u32 s85, s94
    s_cbranch_scc1 fo_68
    buffer_load_dword v247, v245, s[4:7], 0 offen sc1
    s_add_u32 s23, s23, 1
    s_waitcnt vmcnt(0)
    v_readfirstlane_b32 s85, v247
    s_cmp_lt_u32 s23, 200000
    s_cbranch_scc1 fw_67
    s_mov_b32 s25, 200000
fo_68:
    buffer_load_dwordx4 v[228:231], v13, s[4:7], s18 offen offset:0 sc1
    buffer_load_dwordx4 v[232:235], v13, s[4:7], s18 offen offset:128 sc1
    s_add_u32 s18, s18, 2048
    s_min_u32 s18, s18, 35780608
    s_nop 15
    s_nop 15
    s_nop 15
    s_nop 15
    s_add_u32 s21, s15, 3
    s_min_u32 s21, s21, 64
    s_cmp_lt_u32 s85, s21
    s_cselect_b64 exec, 1, 0
    buffer_load_dword v247, v245, s[4:7], 0 offen sc1
    s_mov_b64 exec, -1
    v_mov_b32 v40, 0
    v_mov_b32 v41, 0
    v_mov_b32 v42, 0
    v_mov_b32 v43, 0
    v_mov_b32 v44, 0
    v_mov_b32 v45, 0
    v_mov_b32 v46, 0
    v_mov_b32 v47, 0
    v_mov_b32 v48, 0
    v_mov_b32 v49, 0
    v_mov_b32 v50, 0
    v_mov_b32 v51, 0
    v_mov_b32 v52, 0
    v_mov_b32 v53, 0
    v_mov_b32 v54, 0
    v_mov_b32 v55, 0
    v_mov_b32 v56, 0
    v_mov_b32 v57, 0
    v_mov_b32 v58, 0
    v_mov_b32 v59, 0
    v_mov_b32 v60, 0
    v_mov_b32 v61, 0
    v_mov_b32 v62, 0
    v_mov_b32 v63, 0
    v_mov_b32 v64, 0
    v_mov_b32 v65, 0
    v_mov_b32 v66, 0
    v_mov_b32 v67, 0
    v_mov_b32 v68, 0
    v_mov_b32 v69, 0
    v_mov_b32 v70, 0
    v_mov_b32 v71, 0
    s_mov_b32 s21, s16
    s_mov_b32 s16, s42
    s_mov_b32 s42, s43
    s_mov_b32 s43, s44
    s_mov_b32 s44, s21
    s_add_u32 s95, s95, 524288
    s_lshr_b32 s84, s95, 8
    s_and_b32 s84, s84, 8192
    s_xor_b32 s84, s84, s46
    s_add_u32 s84, s84, s95
    s_add_u32 s15, s15, 1
    s_barrier
    s_branch recur_slow_w1
ss_63r:
    buffer_load_dwordx4 v[208:211], v5, s[4:7], s16 offen offset:0 sc1
    buffer_load_dwordx4 v[212:215], v5, s[4:7], s16 offen offset:1024 sc1
    buffer_load_dwordx4 v[216:219], v5, s[4:7], s16 offen offset:2048 sc1
    buffer_load_dwordx4 v[220:223], v5, s[4:7], s16 offen offset:3072 sc1
    buffer_load_dword v224, v6, s[4:7], s16 offen offset:0 sc1
    buffer_load_dword v225, v6, s[4:7], s16 offen offset:256 sc1
    buffer_load_dword v226, v6, s[4:7], s16 offen offset:512 sc1
    buffer_load_dword v227, v6, s[4:7], s16 offen offset:768 sc1
    s_waitcnt vmcnt(14)
    v_pk_add_f32 v[180:181], v[24:25], v[28:29]
    v_pk_add_f32 v[182:183], v[26:27], v[30:31]
    s_waitcnt vmcnt(12)
    v_pk_add_f32 v[188:189], v[32:33], v[36:37]
    v_pk_add_f32 v[190:191], v[34:35], v[38:39]
    v_pk_add_f32 v[180:181], v[180:181], v[188:189]
    v_pk_add_f32 v[182:183], v[182:183], v[190:191]
    v_pk_add_f32 v[188:189], v[180:181], v[182:183]
    v_max3_f32 v185, v180, v181, v182
    s_waitcnt vmcnt(8)
    v_pk_add_f32 v[192:193], v[40:41], v[42:43]
    v_add_f32 v188, v188, v189
    v_add_f32 v184, v192, v193
    v_max3_f32 v185, v185, v183, v184
    v_cmp_u_f32 vcc, v188, v184
    s_nop 0
    v_max_f32_dpp v185, v185, v185 row_ror:8 row_mask:0xf bank_mask:0xf
    v_mov_b32 v186, v185
    s_nop 1
    v_permlane16_swap_b32 v185, v186
    v_max_f32 v185, v185, v186
    v_mov_b32 v186, v185
    s_cbranch_vccz sg_65
    buffer_load_dwordx4 v[24:27], v5, s[4:7], s16 offen offset:0 sc1
    buffer_load_dwordx4 v[28:31], v5, s[4:7], s16 offen offset:1024 sc1
    buffer_load_dwordx4 v[32:35], v5, s[4:7], s16 offen offset:2048 sc1
    buffer_load_dwordx4 v[36:39], v5, s[4:7], s16 offen offset:3072 sc1
    buffer_load_dword v40, v6, s[4:7], s16 offen offset:0 sc1
    buffer_load_dword v41, v6, s[4:7], s16 offen offset:256 sc1
    buffer_load_dword v42, v6, s[4:7], s16 offen offset:512 sc1
    buffer_load_dword v43, v6, s[4:7], s16 offen offset:768 sc1
    s_waitcnt vmcnt(14)
    v_pk_add_f32 v[180:181], v[208:209], v[212:213]
    v_pk_add_f32 v[182:183], v[210:211], v[214:215]
    s_waitcnt vmcnt(12)
    v_pk_add_f32 v[188:189], v[216:217], v[220:221]
    v_pk_add_f32 v[190:191], v[218:219], v[222:223]
    v_pk_add_f32 v[180:181], v[180:181], v[188:189]
    v_pk_add_f32 v[182:183], v[182:183], v[190:191]
    v_pk_add_f32 v[188:189], v[180:181], v[182:183]
    v_max3_f32 v185, v180, v181, v182
    s_waitcnt vmcnt(8)
    v_pk_add_f32 v[192:193], v[224:225], v[226:227]
    v_add_f32 v188, v188, v189
    v_add_f32 v184, v192, v193
    v_max3_f32 v185, v185, v183, v184
    v_cmp_u_f32 vcc, v188, v184
    s_nop 0
    v_max_f32_dpp v185, v185, v185 row_ror:8 row_mask:0xf bank_mask:0xf
    v_mov_b32 v186, v185
    s_nop 1
    v_permlane16_swap_b32 v185, v186
    v_max_f32 v185, v185, v186
    v_mov_b32 v186, v185
    s_cbranch_vccz sg_65
    s_branch ss_63
sb_64:
    v_max3_u32 v19, v24, v25, v26
    v_max3_u32 v19, v19, v27, v28
    v_max3_u32 v19, v19, v29, v30
    v_max3_u32 v19, v19, v31, v32
    v_max3_u32 v19, v19, v33, v34
    v_max3_u32 v19, v19, v35, v36
    v_max3_u32 v19, v19, v37, v38
    v_max3_u32 v19, v19, v39, v40
    v_max3_u32 v19, v19, v41, v42
    v_max_u32 v19, v19, v43
    v_cmp_eq_u32 vcc, -1, v19
    s_nop 0
    s_cbranch_vccz sg_65
    buffer_load_dwordx4 v[24:27], v5, s[4:7], s16 offen offset:0 sc1
    buffer_load_dwordx4 v[28:31], v5, s[4:7], s16 offen offset:1024 sc1
    buffer_load_dwordx4 v[32:35], v5, s[4:7], s16 offen offset:2048 sc1
    buffer_load_dwordx4 v[36:39], v5, s[4:7], s16 offen offset:3072 sc1
    buffer_load_dword v40, v6, s[4:7], s16 offen offset:0 sc1
    buffer_load_dword v41, v6, s[4:7], s16 offen offset:256 sc1
    buffer_load_dword v42, v6, s[4:7], s16 offen offset:512 sc1
    buffer_load_dword v43, v6, s[4:7], s16 offen offset:768 sc1
    s_add_u32 s23, s23, 1
    s_cmp_lt_u32 s23, 200000
    s_cbranch_scc1 ss_63
    s_mov_b32 s25, 200000
    s_branch sg_65
ss_63:
    s_waitcnt vmcnt(6)
    v_pk_add_f32 v[180:181], v[24:25], v[28:29]
    v_pk_add_f32 v[182:183], v[26:27], v[30:31]
    s_waitcnt vmcnt(4)
    v_pk_add_f32 v[188:189], v[32:33], v[36:37]
    v_pk_add_f32 v[190:191], v[34:35], v[38:39]
    v_pk_add_f32 v[180:181], v[180:181], v[188:189]
    v_pk_add_f32 v[182:183], v[182:183], v[190:191]
    v_pk_add_f32 v[188:189], v[180:181], v[182:183]
    v_max3_f32 v185, v180, v181, v182
    s_waitcnt vmcnt(0)
    v_pk_add_f32 v[192:193], v[40:41], v[42:43]
    v_add_f32 v188, v188, v189
    v_add_f32 v184, v192, v193
    v_max3_f32 v185, v185, v183, v184
    v_cmp_u_f32 vcc, v188, v184
    s_nop 0
    v_max_f32_dpp v185, v185, v185 row_ror:8 row_mask:0xf bank_mask:0xf
    v_mov_b32 v186, v185
    s_nop 1
    v_permlane16_swap_b32 v185, v186
    v_max_f32 v185, v185, v186
    v_mov_b32 v186, v185
    s_cbranch_vccnz sb_64
    s_branch sg_65
.p2align 6
recur_slow_w2:
    s_nop 15
    s_mov_b32 s23, s25
g_69:
    buffer_load_dwordx4 v[24:27], v2, s[4:7], s16 offen offset:0 sc1
    buffer_load_dwordx4 v[28:31], v2, s[4:7], s16 offen offset:1024 sc1
    buffer_load_dwordx4 v[32:35], v2, s[4:7], s16 offen offset:2048 sc1
    buffer_load_dwordx4 v[36:39], v2, s[4:7], s16 offen offset:3072 sc1
    s_waitcnt vmcnt(0)
    v_max3_u32 v19, v24, v25, v26
    v_max3_u32 v19, v19, v27, v28
    v_max3_u32 v19, v19, v29, v30
    v_max3_u32 v19, v19, v31, v32
    v_max3_u32 v19, v19, v33, v34
    v_max3_u32 v19, v19, v35, v36
    v_max3_u32 v19, v19, v37, v38
    v_max_u32 v19, v19, v39
    v_cmp_eq_u32 vcc, -1, v19
    s_nop 0
    s_cbranch_vccz g_69k
    s_add_u32 s23, s23, 1
    s_cmp_lt_u32 s23, 200000
    s_cbranch_scc1 g_69
    s_mov_b32 s25, 200000
g_69k:
    v_smfmac_f32_16x16x64_bf16 v[40:43], v[24:27], a[0:7], v172
    v_smfmac_f32_16x16x64_bf16 v[44:47], v[24:27], a[64:71], v172
    v_smfmac_f32_16x16x64_bf16 v[48:51], v[24:27], a[32:39], v172
    v_smfmac_f32_16x16x64_bf16 v[52:55], v[24:27], a[96:103], v172
    v_smfmac_f32_16x16x64_bf16 v[40:43], v[28:31], a[8:15], v172
    v_smfmac_f32_16x16x64_bf16 v[44:47], v[28:31], a[72:79], v172
    v_smfmac_f32_16x16x64_bf16 v[48:51], v[28:31], a[40:47], v172
    v_smfmac_f32_16x16x64_bf16 v[52:55], v[28:31], a[104:111], v172
    v_smfmac_f32_16x16x64_bf16 v[40:43], v[32:35], a[16:23], v172
    v_smfmac_f32_16x16x64_bf16 v[44:47], v[32:35], a[80:87], v172
    v_smfmac_f32_16x16x64_bf16 v[48:51], v[32:35], a[48:55], v172
    v_smfmac_f32_16x16x64_bf16 v[52:55], v[32:35], a[112:119], v172
    v_smfmac_f32_16x16x64_bf16 v[40:43], v[36:39], a[24:31], v172
    v_smfmac_f32_16x16x64_bf16 v[44:47], v[36:39], a[88:95], v172
    v_smfmac_f32_16x16x64_bf16 v[48:51], v[36:39], a[56:63], v172
    v_smfmac_f32_16x16x64_bf16 v[52:55], v[36:39], a[120:127], v172
    v_cvt_pk_bf16_f32 v72, v40, v41
    v_cvt_pk_bf16_f32 v73, v42, v43
    v_cvt_pk_bf16_f32 v74, v44, v45
    v_cvt_pk_bf16_f32 v75, v46, v47
    ds_write_b128 v17, v[72:75] offset:0
    v_cvt_pk_bf16_f32 v76, v48, v49
    v_cvt_pk_bf16_f32 v77, v50, v51
    s_nop 0
    v_cvt_pk_bf16_f32 v78, v52, v53
    v_cvt_pk_bf16_f32 v79, v54, v55
    ds_write_b128 v17, v[76:79] offset:1024
    v_smfmac_f32_16x16x64_bf16 v[56:59], v[24:27], a[128:135], v172
    v_smfmac_f32_16x16x64_bf16 v[60:63], v[24:27], a[160:167], v172
    v_smfmac_f32_16x16x64_bf16 v[56:59], v[28:31], a[136:143], v172
    s_waitcnt lgkmcnt(0)
    s_barrier
    v_smfmac_f32_16x16x64_bf16 v[60:63], v[28:31], a[168:175], v172
    v_smfmac_f32_16x16x64_bf16 v[56:59], v[32:35], a[144:151], v172
    v_smfmac_f32_16x16x64_bf16 v[60:63], v[32:35], a[176:183], v172
    v_smfmac_f32_16x16x64_bf16 v[56:59], v[36:39], a[152:159], v172
    v_smfmac_f32_16x16x64_bf16 v[60:63], v[36:39], a[184:191], v172
    s_nop 4
    v_cvt_pk_bf16_f32 v80, v56, v57
    v_cvt_pk_bf16_f32 v81, v58, v59
    s_nop 0
    v_cvt_pk_bf16_f32 v82, v60, v61
    v_cvt_pk_bf16_f32 v83, v62, v63
    ds_write_b128 v17, v[80:83] offset:8192
    s_cmp_eq_u32 s15, 63
    s_waitcnt lgkmcnt(0)
    s_barrier
    ds_read_b128 v[96:99], v16 offset:8192
    ds_read_b128 v[100:103], v16 offset:10240
    ds_read_b128 v[108:111], v16 offset:14336
    v_mfma_f32_16x16x32_bf16 v[140:143], v[84:87], v[80:83], 0
    s_waitcnt lgkmcnt(2)
    v_mfma_f32_16x16x32_bf16 v[140:143], v[84:87], v[96:99], v[140:143]
    s_waitcnt lgkmcnt(1)
    v_mfma_f32_16x16x32_bf16 v[140:143], v[84:87], v[100:103], v[140:143]
    s_waitcnt lgkmcnt(0)
    v_mfma_f32_16x16x32_bf16 v[140:143], v[84:87], v[108:111], v[140:143]
    s_nop 7
    v_cvt_pk_bf16_f32 v168, v140, v141
    v_cvt_pk_bf16_f32 v169, v142, v143
    v_mov_b32 v170, v168
    v_mov_b32 v171, v169
    s_nop 0
    v_permlane16_swap_b32 v168, v170
    v_permlane16_swap_b32 v169, v171
    v_mov_b32 v247, s15
    s_cbranch_scc1 recur_slow_last2
    s_barrier
    s_nop 15
    s_mov_b32 s23, s25
g_70:
    buffer_load_dwordx4 v[24:27], v8, s[4:7], s16 offen offset:0 sc1
    buffer_load_dwordx4 v[28:31], v8, s[4:7], s16 offen offset:1024 sc1
    buffer_load_dwordx4 v[32:35], v8, s[4:7], s16 offen offset:2048 sc1
    buffer_load_dwordx4 v[36:39], v8, s[4:7], s16 offen offset:3072 sc1
    s_waitcnt vmcnt(0)
    v_max3_u32 v19, v24, v25, v26
    v_max3_u32 v19, v19, v27, v28
    v_max3_u32 v19, v19, v29, v30
    v_max3_u32 v19, v19, v31, v32
    v_max3_u32 v19, v19, v33, v34
    v_max3_u32 v19, v19, v35, v36
    v_max3_u32 v19, v19, v37, v38
    v_max_u32 v19, v19, v39
    v_cmp_eq_u32 vcc, -1, v19
    s_nop 0
    s_cbranch_vccz g_70k
    s_add_u32 s23, s23, 1
    s_cmp_lt_u32 s23, 200000
    s_cbranch_scc1 g_70
    s_mov_b32 s25, 200000
g_70k:
    v_smfmac_f32_16x16x64_bf16 v[64:67], v[24:27], a[192:199], v172
    v_smfmac_f32_16x16x64_bf16 v[68:71], v[24:27], a[224:231], v172
    v_smfmac_f32_16x16x64_bf16 v[64:67], v[28:31], a[200:207], v172
    v_smfmac_f32_16x16x64_bf16 v[68:71], v[28:31], a[232:239], v172
    v_smfmac_f32_16x16x64_bf16 v[64:67], v[32:35], a[208:215], v172
    v_smfmac_f32_16x16x64_bf16 v[68:71], v[32:35], a[240:247], v172
    v_smfmac_f32_16x16x64_bf16 v[64:67], v[36:39], a[216:223], v172
    v_smfmac_f32_16x16x64_bf16 v[68:71], v[36:39], a[248:255], v172
    s_nop 4
    v_cvt_pk_bf16_f32 v80, v64, v65
    v_cvt_pk_bf16_f32 v81, v66, v67
    s_nop 0
    v_cvt_pk_bf16_f32 v82, v68, v69
    v_cvt_pk_bf16_f32 v83, v70, v71
    ds_write_b128 v17, v[80:83] offset:9216
    s_waitcnt lgkmcnt(0)
    s_barrier
    s_nop 15
    s_nop 15
    s_nop 15
    s_nop 15
    buffer_store_dwordx4 v[168:171], v15, s[4:7], s20 offen sc1
    s_add_u32 s20, s20, 512
    s_add_u32 s21, s95, 1048576
    s_lshr_b32 s22, s21, 8
    s_and_b32 s22, s22, 8192
    s_xor_b32 s22, s22, s46
    s_add_u32 s21, s21, s22
    buffer_store_dwordx4 v[204:207], v9, s[4:7], s21 offen sc1
    s_add_u32 s21, s21, 262144
    buffer_store_dwordx4 v[204:207], v9, s[4:7], s21 offen sc1
    buffer_store_dword v247, v246, s[4:7], 0 offen sc1
    v_mov_b32 v40, 0
    v_mov_b32 v41, 0
    v_mov_b32 v42, 0
    v_mov_b32 v43, 0
    v_mov_b32 v44, 0
    v_mov_b32 v45, 0
    v_mov_b32 v46, 0
    v_mov_b32 v47, 0
    v_mov_b32 v48, 0
    v_mov_b32 v49, 0
    v_mov_b32 v50, 0
    v_mov_b32 v51, 0
    v_mov_b32 v52, 0
    v_mov_b32 v53, 0
    v_mov_b32 v54, 0
    v_mov_b32 v55, 0
    v_mov_b32 v56, 0
    v_mov_b32 v57, 0
    v_mov_b32 v58, 0
    v_mov_b32 v59, 0
    v_mov_b32 v60, 0
    v_mov_b32 v61, 0
    v_mov_b32 v62, 0
    v_mov_b32 v63, 0
    v_mov_b32 v64, 0
    v_mov_b32 v65, 0
    v_mov_b32 v66, 0
    v_mov_b32 v67, 0
    v_mov_b32 v68, 0
    v_mov_b32 v69, 0
    v_mov_b32 v70, 0
    v_mov_b32 v71, 0
    s_mov_b32 s21, s16
    s_mov_b32 s16, s42
    s_mov_b32 s42, s43
    s_mov_b32 s43, s44
    s_mov_b32 s44, s21
    s_add_u32 s95, s95, 524288
    s_lshr_b32 s84, s95, 8
    s_and_b32 s84, s84, 8192
    s_xor_b32 s84, s84, s46
    s_add_u32 s84, s84, s95
    s_add_u32 s15, s15, 1
    s_barrier
    s_branch recur_slow_w2
recur_slow_last2:
    buffer_store_dwordx4 v[168:171], v15, s[4:7], s20 offen sc1
    s_waitcnt vmcnt(0)
    s_branch recur_end
.p2align 6
recur_slow_w3:
    s_nop 15
    s_mov_b32 s23, s25
g_71:
    buffer_load_dwordx4 v[24:27], v2, s[4:7], s16 offen offset:0 sc1
    buffer_load_dwordx4 v[28:31], v2, s[4:7], s16 offen offset:1024 sc1
    buffer_load_dwordx4 v[32:35], v2, s[4:7], s16 offen offset:2048 sc1
    buffer_load_dwordx4 v[36:39], v2, s[4:7], s16 offen offset:3072 sc1
    s_waitcnt vmcnt(0)
    v_max3_u32 v19, v24, v25, v26
    v_max3_u32 v19, v19, v27, v28
    v_max3_u32 v19, v19, v29, v30
    v_max3_u32 v19, v19, v31, v32
    v_max3_u32 v19, v19, v33, v34
    v_max3_u32 v19, v19, v35, v36
    v_max3_u32 v19, v19, v37, v38
    v_max_u32 v19, v19, v39
    v_cmp_eq_u32 vcc, -1, v19
    s_nop 0
    s_cbranch_vccz g_71k
    s_add_u32 s23, s23, 1
    s_cmp_lt_u32 s23, 200000
    s_cbranch_scc1 g_71
    s_mov_b32 s25, 200000
g_71k:
    v_smfmac_f32_16x16x64_bf16 v[40:43], v[24:27], a[0:7], v172
    v_smfmac_f32_16x16x64_bf16 v[44:47], v[24:27], a[64:71], v172
    v_smfmac_f32_16x16x64_bf16 v[48:51], v[24:27], a[32:39], v172
    v_smfmac_f32_16x16x64_bf16 v[52:55], v[24:27], a[96:103], v172
    v_smfmac_f32_16x16x64_bf16 v[40:43], v[28:31], a[8:15], v172
    v_smfmac_f32_16x16x64_bf16 v[44:47], v[28:31], a[72:79], v172
    v_smfmac_f32_16x16x64_bf16 v[48:51], v[28:31], a[40:47], v172
    v_smfmac_f32_16x16x64_bf16 v[52:55], v[28:31], a[104:111], v172
    v_smfmac_f32_16x16x64_bf16 v[40:43], v[32:35], a[16:23], v172
    v_smfmac_f32_16x16x64_bf16 v[44:47], v[32:35], a[80:87], v172
    v_smfmac_f32_16x16x64_bf16 v[48:51], v[32:35], a[48:55], v172
    v_smfmac_f32_16x16x64_bf16 v[52:55], v[32:35], a[112:119], v172
    v_smfmac_f32_16x16x64_bf16 v[40:43], v[36:39], a[24:31], v172
    v_smfmac_f32_16x16x64_bf16 v[44:47], v[36:39], a[88:95], v172
    v_smfmac_f32_16x16x64_bf16 v[48:51], v[36:39], a[56:63], v172
    v_smfmac_f32_16x16x64_bf16 v[52:55], v[36:39], a[120:127], v172
    v_cvt_pk_bf16_f32 v72, v40, v41
    v_cvt_pk_bf16_f32 v73, v42, v43
    v_cvt_pk_bf16_f32 v74, v44, v45
    v_cvt_pk_bf16_f32 v75, v46, v47
    ds_write_b128 v17, v[72:75] offset:0
    v_cvt_pk_bf16_f32 v76, v48, v49
    v_cvt_pk_bf16_f32 v77, v50, v51
    s_nop 0
    v_cvt_pk_bf16_f32 v78, v52, v53
    v_cvt_pk_bf16_f32 v79, v54, v55
    ds_write_b128 v17, v[76:79] offset:1024
    v_smfmac_f32_16x16x64_bf16 v[56:59], v[24:27], a[128:135], v172
    v_smfmac_f32_16x16x64_bf16 v[60:63], v[24:27], a[160:167], v172
    v_smfmac_f32_16x16x64_bf16 v[56:59], v[28:31], a[136:143], v172
    s_waitcnt lgkmcnt(0)
    s_barrier
    v_smfmac_f32_16x16x64_bf16 v[60:63], v[28:31], a[168:175], v172
    v_smfmac_f32_16x16x64_bf16 v[56:59], v[32:35], a[144:151], v172
    v_smfmac_f32_16x16x64_bf16 v[60:63], v[32:35], a[176:183], v172
    v_smfmac_f32_16x16x64_bf16 v[56:59], v[36:39], a[152:159], v172
    v_smfmac_f32_16x16x64_bf16 v[60:63], v[36:39], a[184:191], v172
    s_nop 4
    v_cvt_pk_bf16_f32 v80, v56, v57
    v_cvt_pk_bf16_f32 v81, v58, v59
    s_nop 0
    v_cvt_pk_bf16_f32 v82, v60, v61
    v_cvt_pk_bf16_f32 v83, v62, v63
    ds_write_b128 v17, v[80:83] offset:8192
    buffer_store_dwordx4 v[204:207], v3, s[4:7], s43 offen sc1
    buffer_store_dwordx4 v[204:207], v3, s[4:7], s43 offen offset:128 sc1
    buffer_store_dwordx4 v[204:207], v4, s[4:7], s43 offen sc1
    buffer_store_dwordx2 v[204:205], v7, s[4:7], s43 offen sc1
    buffer_store_dwordx2 v[204:205], v11, s[4:7], s43 offen sc1
    s_cmp_eq_u32 s15, 63
    s_waitcnt lgkmcnt(0)
    s_barrier
    s_cbranch_scc1 recur_end
    s_barrier
    s_nop 15
    s_mov_b32 s23, s25
g_72:
    buffer_load_dwordx4 v[24:27], v8, s[4:7], s16 offen offset:0 sc1
    buffer_load_dwordx4 v[28:31], v8, s[4:7], s16 offen offset:1024 sc1
    buffer_load_dwordx4 v[32:35], v8, s[4:7], s16 offen offset:2048 sc1
    buffer_load_dwordx4 v[36:39], v8, s[4:7], s16 offen offset:3072 sc1
    s_waitcnt vmcnt(0)
    v_max3_u32 v19, v24, v25, v26
    v_max3_u32 v19, v19, v27, v28
    v_max3_u32 v19, v19, v29, v30
    v_max3_u32 v19, v19, v31, v32
    v_max3_u32 v19, v19, v33, v34
    v_max3_u32 v19, v19, v35, v36
    v_max3_u32 v19, v19, v37, v38
    v_max_u32 v19, v19, v39
    v_cmp_eq_u32 vcc, -1, v19
    s_nop 0
    s_cbranch_vccz g_72k
    s_add_u32 s23, s23, 1
    s_cmp_lt_u32 s23, 200000
    s_cbranch_scc1 g_72
    s_mov_b32 s25, 200000
g_72k:
    v_smfmac_f32_16x16x64_bf16 v[64:67], v[24:27], a[192:199], v172
    v_smfmac_f32_16x16x64_bf16 v[68:71], v[24:27], a[224:231], v172
    v_smfmac_f32_16x16x64_bf16 v[64:67], v[28:31], a[200:207], v172
    v_smfmac_f32_16x16x64_bf16 v[68:71], v[28:31], a[232:239], v172
    v_smfmac_f32_16x16x64_bf16 v[64:67], v[32:35], a[208:215], v172
    v_smfmac_f32_16x16x64_bf16 v[68:71], v[32:35], a[240:247], v172
    v_smfmac_f32_16x16x64_bf16 v[64:67], v[36:39], a[216:223], v172
    v_smfmac_f32_16x16x64_bf16 v[68:71], v[36:39], a[248:255], v172
    s_nop 4
    v_cvt_pk_bf16_f32 v80, v64, v65
    v_cvt_pk_bf16_f32 v81, v66, v67
    s_nop 0
    v_cvt_pk_bf16_f32 v82, v68, v69
    v_cvt_pk_bf16_f32 v83, v70, v71
    s_nop 1
    v_mfma_f32_16x16x32_bf16 v[88:91], v[80:83], v[84:87], 0
    s_barrier
    ds_read_b128 v[96:99], v16 offset:9216
    ds_read_b128 v[100:103], v16 offset:11264
    ds_read_b128 v[104:107], v16 offset:13312
    s_waitcnt lgkmcnt(2)
    v_mfma_f32_16x16x32_bf16 v[88:91], v[96:99], v[84:87], v[88:91]
    s_waitcnt lgkmcnt(1)
    v_mfma_f32_16x16x32_bf16 v[88:91], v[100:103], v[84:87], v[88:91]
    s_waitcnt lgkmcnt(0)
    v_mfma_f32_16x16x32_bf16 v[88:91], v[104:107], v[84:87], v[88:91]
    s_nop 7
    buffer_store_dwordx4 v[88:91], v9, s[4:7], s84 offen sc1
    s_add_u32 s22, s84, 262144
    buffer_store_dwordx4 v[88:91], v9, s[4:7], s22 offen sc1
    s_nop 15
    s_nop 15
    s_nop 15
    s_nop 15
    s_nop 15
    s_nop 15
    s_nop 15
    s_nop 7
    s_mov_b32 s23, s25
    buffer_load_dwordx4 v[96:99], v10, s[4:7], s84 offen sc1
    buffer_load_dwordx4 v[100:103], v23, s[4:7], s84 offen sc1
    buffer_load_dwordx4 v[104:107], v244, s[4:7], s84 offen sc1
    s_nop 15
    s_nop 15
    s_nop 7
    buffer_load_dwordx4 v[108:111], v10, s[4:7], s22 offen sc1
    buffer_load_dwordx4 v[112:115], v23, s[4:7], s22 offen sc1
    buffer_load_dwordx4 v[116:119], v244, s[4:7], s22 offen sc1
    v_mov_b32 v40, 0
    v_mov_b32 v41, 0
    v_mov_b32 v42, 0
    v_mov_b32 v43, 0
    v_mov_b32 v44, 0
    v_mov_b32 v45, 0
    v_mov_b32 v46, 0
    v_mov_b32 v47, 0
    v_mov_b32 v48, 0
    v_mov_b32 v49, 0
    v_mov_b32 v50, 0
    v_mov_b32 v51, 0
    v_mov_b32 v52, 0
    v_mov_b32 v53, 0
    v_mov_b32 v54, 0
    v_mov_b32 v55, 0
    v_mov_b32 v56, 0
    v_mov_b32 v57, 0
    v_mov_b32 v58, 0
    v_mov_b32 v59, 0
    v_mov_b32 v60, 0
    v_mov_b32 v61, 0
    v_mov_b32 v62, 0
    v_mov_b32 v63, 0
    v_mov_b32 v64, 0
    v_mov_b32 v65, 0
    v_mov_b32 v66, 0
    v_mov_b32 v67, 0
    v_mov_b32 v68, 0
    v_mov_b32 v69, 0
    v_mov_b32 v70, 0
    v_mov_b32 v71, 0
    s_waitcnt vmcnt(5)
    v_pk_add_f32 v[120:121], v[88:89], v[96:97]
    v_pk_add_f32 v[122:123], v[90:91], v[98:99]
    s_waitcnt vmcnt(4)
    v_pk_add_f32 v[120:121], v[120:121], v[100:101]
    v_pk_add_f32 v[122:123], v[122:123], v[102:103]
    s_waitcnt vmcnt(3)
    v_pk_add_f32 v[120:121], v[120:121], v[104:105]
    v_pk_add_f32 v[122:123], v[122:123], v[106:107]
    v_cvt_pk_bf16_f32 v180, v120, v121
    v_pk_add_f32 v[124:125], v[120:121], v[122:123]
    v_cvt_pk_bf16_f32 v181, v122, v123
    v_cmpx_o_f32 vcc, v124, v125
    buffer_store_dwordx2 v[180:181], v11, s[4:7], s42 offen sc1
    s_cmp_eq_u64 vcc, -1
    s_mov_b64 exec, -1
    s_cbranch_scc0 pr_73
pg_74:
    s_barrier
    s_mov_b32 s21, s16
    s_mov_b32 s16, s42
    s_mov_b32 s42, s43
    s_mov_b32 s43, s44
    s_mov_b32 s44, s21
    s_add_u32 s95, s95, 524288
    s_lshr_b32 s84, s95, 8
    s_and_b32 s84, s84, 8192
    s_xor_b32 s84, s84, s46
    s_add_u32 s84, s84, s95
    s_add_u32 s15, s15, 1
    s_branch recur_slow_w3
pr_73:
    s_waitcnt vmcnt(3)
    v_pk_add_f32 v[120:121], v[88:89], v[108:109]
    v_pk_add_f32 v[122:123], v[90:91], v[110:111]
    s_waitcnt vmcnt(2)
    v_pk_add_f32 v[120:121], v[120:121], v[112:113]
    v_pk_add_f32 v[122:123], v[122:123], v[114:115]
    s_waitcnt vmcnt(1)
    v_pk_add_f32 v[120:121], v[120:121], v[116:117]
    v_pk_add_f32 v[122:123], v[122:123], v[118:119]
    v_cvt_pk_bf16_f32 v180, v120, v121
    v_pk_add_f32 v[124:125], v[120:121], v[122:123]
    v_cvt_pk_bf16_f32 v181, v122, v123
    v_cmpx_o_f32 vcc, v124, v125
    buffer_store_dwordx2 v[180:181], v11, s[4:7], s42 offen sc1
    s_cmp_eq_u64 vcc, -1
    s_mov_b64 exec, -1
    s_cbranch_scc0 pq_76
    s_branch pg_74
pb_75:
    s_waitcnt vmcnt(2)
    v_pk_add_f32 v[120:121], v[88:89], v[108:109]
    v_pk_add_f32 v[122:123], v[90:91], v[110:111]
    s_waitcnt vmcnt(1)
    v_pk_add_f32 v[120:121], v[120:121], v[112:113]
    v_pk_add_f32 v[122:123], v[122:123], v[114:115]
    s_waitcnt vmcnt(0)
    v_pk_add_f32 v[120:121], v[120:121], v[116:117]
    v_pk_add_f32 v[122:123], v[122:123], v[118:119]
    v_cvt_pk_bf16_f32 v180, v120, v121
    v_pk_add_f32 v[124:125], v[120:121], v[122:123]
    v_cvt_pk_bf16_f32 v181, v122, v123
    v_cmpx_o_f32 vcc, v124, v125
    buffer_store_dwordx2 v[180:181], v11, s[4:7], s42 offen sc1
    s_cmp_eq_u64 vcc, -1
    s_mov_b64 exec, -1
    s_cbranch_scc0 pq_76
    s_branch pg_74
pq_76:
    v_max3_u32 v19, v108, v109, v110
    v_max3_u32 v19, v19, v111, v112
    v_max3_u32 v19, v19, v113, v114
    v_max3_u32 v19, v19, v115, v116
    v_max3_u32 v19, v19, v117, v118
    v_max_u32 v19, v19, v119
    v_cmp_eq_u32 vcc, -1, v19
    s_nop 0
    s_cbranch_vccz pf_77
    buffer_load_dwordx4 v[108:111], v10, s[4:7], s22 offen sc1
    buffer_load_dwordx4 v[112:115], v23, s[4:7], s22 offen sc1
    buffer_load_dwordx4 v[116:119], v244, s[4:7], s22 offen sc1
    s_add_u32 s23, s23, 1
    s_cmp_lt_u32 s23, 200000
    s_cbranch_scc1 pb_75
    s_mov_b32 s25, 200000
pf_77:
    buffer_store_dwordx2 v[180:181], v11, s[4:7], s42 offen sc1
    s_branch pg_74
recur_end:
    s_barrier
    v_mov_b32 v247, 64
    buffer_store_dword v247, v246, s[4:7], 0 offen sc1
    s_endpgm
.section .rodata,"a"
.p2align 6
.amdhsa_kernel concat_heads__spectral_gfnet__memory_aug_recurrent_mem_tr__prompt_kernel
  .amdhsa_next_free_vgpr 512
  .amdhsa_next_free_sgpr 102
  .amdhsa_accum_offset 256
  .amdhsa_group_segment_fixed_size 0
  .amdhsa_kernarg_size 104
  .amdhsa_user_sgpr_count 2
  .amdhsa_user_sgpr_kernarg_segment_ptr 1
  .amdhsa_system_sgpr_workgroup_id_x 1
  .amdhsa_float_denorm_mode_32 3
.end_amdhsa_kernel
```
